```python
import torch

def _softmax(x, axis=-1):
    return torch.softmax(x, dim=axis)
def _gelu(x):
    return torch.nn.functional.gelu(x, approximate="tanh")
def _silu(x):
    return torch.nn.functional.silu(x)
def _sigmoid(x):
    return torch.sigmoid(x)
def _layernorm(x, axis=-1, eps=1e-5):
    m = x.mean(dim=axis, keepdim=True)
    v = x.var(dim=axis, keepdim=True, unbiased=False)
    return (x - m) / torch.sqrt(v + eps)
def _scatter_add(tgt, idx, src, axis=0):
    return tgt.clone().index_add_(axis, idx, src)
def _segment_sum(src, seg, n):
    out = torch.zeros((n,) + src.shape[1:], dtype=src.dtype)
    return out.index_add_(0, seg, src)
def _pad(x, pw):
    flat = tuple(v for pair in reversed(pw) for v in pair)
    return torch.nn.functional.pad(x, flat)

kernel_name = 'gated_mix__compressed_kv_cla__moe_arch_mod__prompt'

def setup_inputs():

    _w = (lambda a: (lambda t: t.to(torch.bfloat16) if t.is_floating_point() else t)(torch.as_tensor(a)))
    def _A_setup():
        B, H, Sq, Sk, D, M = 1, 16, 2048, 2048, 256, 448
        Dc = 4 * D
        return {
            "x": _w((lambda *s: torch.randn(*s, dtype=torch.bfloat16) * 0.05)(B, Sq, M)),
            "c_kv": _w((lambda *s: torch.randn(*s, dtype=torch.bfloat16) * 0.8)(B, Sk, Dc)),
            "w_q": _w((lambda *s: torch.randn(*s, dtype=torch.bfloat16) * 6.4)(M, H, D) * (M ** -0.5)),
            "w_uk": _w((lambda *s: torch.randn(*s, dtype=torch.bfloat16) * 6.4)(Dc, H, D) * (Dc ** -0.5)),
            "w_uv": _w((lambda *s: torch.randn(*s, dtype=torch.bfloat16) * 0.8)(Dc, H, D) * (Dc ** -0.5)),
            "w_o": _w((lambda *s: torch.randn(*s, dtype=torch.bfloat16) * 0.8)(H, D, M) * ((H * D) ** -0.5)),
        }
    _A_in = _A_setup()

    def _B_setup():
        B, S, D, F, C = 1, 2048, 448, 1792, 2
        return {
            "x": _w((lambda *s: torch.randn(*s, dtype=torch.bfloat16) * 0.05)(B, S, D)),
            "w_r": _w((lambda *s: torch.randn(*s, dtype=torch.bfloat16) * 3.2)(D)),
            "w_gate": _w((lambda *s: torch.randn(*s, dtype=torch.bfloat16) * 0.4)(D, F)),
            "w_up": _w((lambda *s: torch.randn(*s, dtype=torch.bfloat16) * 0.4)(D, F)),
            "w_down": _w((lambda *s: torch.randn(*s, dtype=torch.bfloat16) * 0.4)(F, D)),
        }
    _B_in = _B_setup()

    return {
        "A_x": _A_in["x"],
        "A_c_kv": _A_in["c_kv"],
        "A_w_q": _A_in["w_q"],
        "A_w_uk": _A_in["w_uk"],
        "A_w_uv": _A_in["w_uv"],
        "A_w_o": _A_in["w_o"],
        "B_x": _B_in["x"],
        "B_w_r": _B_in["w_r"],
        "B_w_gate": _B_in["w_gate"],
        "B_w_up": _B_in["w_up"],
        "B_w_down": _B_in["w_down"],
        "gate_w": _w((lambda *s: torch.randn(*s, dtype=torch.bfloat16) * 0.05)(448) * 16.0),
    }

def reference(A_x, A_c_kv, A_w_q, A_w_uk, A_w_uv, A_w_o, B_x, B_w_r, B_w_gate, B_w_up, B_w_down, gate_w):
    def _A_ref(x, c_kv, w_q, w_uk, w_uv, w_o):
        B, Sq, M = x.shape[0], x.shape[1], x.shape[2]
        Sk = c_kv.shape[1]
        H, D = w_q.shape[1], w_q.shape[2]
        q = torch.einsum("bqm,mhd->bhqd", x, w_q)
        k = torch.einsum("bkc,chd->bhkd", c_kv, w_uk)
        v = torch.einsum("bkc,chd->bhkd", c_kv, w_uv)
        scores = torch.einsum("bhqd,bhkd->bhqk", q, k) * (D ** -0.5)
        off = Sk - Sq
        qi = torch.arange(Sq)[:, None]
        kj = torch.arange(Sk)[None, :]
        cmask = kj <= (qi + off)
        scores = torch.where(cmask[None, None], scores, -1e9)
        p = _softmax(scores, axis=-1)
        ctx = torch.einsum("bhqk,bhkd->bhqd", p, v)
        return torch.einsum("bhqd,hdm->bqm", ctx, w_o)

    def _B_ref(x, w_r, w_gate, w_up, w_down):
        B, S, D = x.shape
        C = 2
        r = x @ w_r
        idx = torch.argsort(-r, axis=-1)[:, :C]
        idx_e = (lambda x, n, axis: torch.repeat_interleave(x, n, dim=axis))(idx.reshape(B, C, 1), D, axis=2)
        x_sel = (lambda x, i, axis: torch.take_along_dim(x, i, dim=axis))(x, idx_e, axis=1)
        g = _silu(x_sel @ w_gate)
        u = x_sel @ w_up
        y = (g * u) @ w_down
        r_sel = _sigmoid((lambda x, i, axis: torch.take_along_dim(x, i, dim=axis))(r, idx, axis=1))
        y = y * r_sel.reshape(B, C, 1)
        b_off = (torch.arange(B) * S).reshape(B, 1)
        flat_idx = (idx + b_off).reshape(B * C)
        zero = (x * 0.0).reshape(B * S, D)
        upd = _scatter_add(zero, flat_idx, y.reshape(B * C, D), axis=0)
        return x + upd.reshape(B, S, D)

    x = A_x
    g = _sigmoid((x * gate_w).sum(-1, keepdims=True))
    a = _A_ref(x, A_c_kv, A_w_q, A_w_uk, A_w_uv, A_w_o)
    b = _B_ref(x, B_w_r, B_w_gate, B_w_up, B_w_down)
    return g * a + (1 - g) * b
```

```asm
; @launch grid=(256,1,1) block=(256,1,1) lds=163840
.amdgcn_target "amdgcn-amd-amdhsa--gfx950"
.text
.macro M d, a, b, c
v_mfma_f32_16x16x32_bf16 \d, \a, \b, \c
.endm
.globl gated_mix__compressed_kv_cla__moe_arch_mod__prompt_kernel
.p2align 8
.type gated_mix__compressed_kv_cla__moe_arch_mod__prompt_kernel,@function
gated_mix__compressed_kv_cla__moe_arch_mod__prompt_kernel:
 s_cmp_lt_u32 s2, 256
 s_cbranch_scc1 L_go
 s_endpgm
L_go:
 s_load_dwordx8 s[80:87], s[0:1], 0
 s_load_dwordx4 s[88:91], s[0:1], 32
 s_load_dwordx2 s[92:93], s[0:1], 56
 s_load_dwordx2 s[30:31], s[0:1], 88
 s_load_dwordx4 s[4:7], s[0:1], 104
 v_lshrrev_b32 v24, 6, v0
 v_and_b32 v0, 63, v0
 v_readfirstlane_b32 s20, v24
 s_getpc_b64 s[76:77]
L_pc0:
 s_and_b32 s77, s77, 0xffff
 s_mov_b32 s78, L_code_end-L_pc0
 s_mov_b32 s79, 0x20000
 s_lshr_b32 s64, s2, 3
 s_lshl_b32 s64, s64, 2
 s_add_u32 s64, s64, s20
 s_lshl_b32 s95, s64, 11
 v_lshl_add_u32 v29, v0, 7, s95
 v_and_b32 v28, 48, v0
 v_lshl_add_u32 v28, v28, 24, v29
 buffer_load_dword a240, v28, s[76:79], 0 offen offset:0
 s_and_b32 s41, s2, 7
 s_lshr_b32 s42, s2, 3
 s_lshr_b32 s64, s42, 4
 s_lshl_b32 s64, s64, 3
 s_add_u32 s41, s41, s64
 s_and_b32 s42, s42, 15
 s_lshr_b32 s45, s42, 3
 s_xor_b32 s45, s45, 1
 s_mov_b32 s44, 0
 v_accvgpr_write_b32 a250, 0
 v_accvgpr_write_b32 a251, 0
 v_and_b32 v24, 15, v0
 v_lshrrev_b32 v25, 4, v0
 v_lshlrev_b32 v7, 4, v0
 s_and_b32 s65, s20, 1
 s_lshr_b32 s66, s20, 1
 v_or_b32 v28, 0, v25
 v_lshlrev_b32 v28, 1, v28
 v_xor_b32 v28, v28, v24
 v_lshrrev_b32 v29, 3, v28
 v_lshlrev_b32 v29, 8, v29
 v_and_b32 v28, 7, v28
 v_lshl_add_u32 v28, v28, 4, v29
 v_lshl_add_u32 v28, v25, 13, v28
 s_lshl_b32 s64, s20, 17
 s_add_u32 s64, s64, 0
 v_add_u32 v8, s64, v28
 v_add_u32 v9, 31744, v8
 v_or_b32 v28, 4, v25
 v_lshlrev_b32 v28, 1, v28
 v_xor_b32 v28, v28, v24
 v_lshrrev_b32 v29, 3, v28
 v_lshlrev_b32 v29, 8, v29
 v_and_b32 v28, 7, v28
 v_lshl_add_u32 v28, v28, 4, v29
 v_lshl_add_u32 v28, v25, 13, v28
 s_lshl_b32 s64, s20, 17
 s_add_u32 s64, s64, 63488
 v_add_u32 v10, s64, v28
 v_add_u32 v11, 31744, v10
 v_add_u32 v28, 0, v25
 v_and_b32 v29, 7, v0
 v_xor_b32 v28, v28, v29
 v_lshlrev_b32 v28, 4, v28
 v_lshrrev_b32 v29, 3, v0
 v_lshl_add_u32 v30, v29, 11, v28
 s_lshl_b32 s64, s66, 19
 s_lshl_b32 s67, s65, 20
 s_add_u32 s64, s64, s67
 s_add_u32 s64, s64, 0
 v_add_u32 v12, s64, v30
 v_add_u32 v14, 30720, v12
 v_add_u32 v28, 4, v25
 v_and_b32 v29, 7, v0
 v_xor_b32 v28, v28, v29
 v_lshlrev_b32 v28, 4, v28
 v_lshrrev_b32 v29, 3, v0
 v_lshl_add_u32 v30, v29, 11, v28
 s_lshl_b32 s64, s66, 19
 s_lshl_b32 s67, s65, 20
 s_add_u32 s64, s64, s67
 s_add_u32 s64, s64, 15360
 v_add_u32 v13, s64, v30
 v_add_u32 v15, 30720, v13
 s_mov_b32 s21, 0
 s_mov_b32 s22, 0
 s_lshl_b32 s23, s20, 12
 s_add_u32 s24, s23, 65536
 s_lshl_b32 s74, s41, 9
 s_sub_u32 s18, 8388608, s74
 s_mov_b32 s19, 0x20000
 s_and_b32 s75, s42, 7
 s_lshl_b32 s75, s75, 16
 s_sub_u32 s50, 4194304, s75
 s_mov_b32 s51, 0x20000
 s_mov_b32 m0, s23
 s_cmp_eq_u32 s45, 0
 s_waitcnt lgkmcnt(0)
 s_cselect_b64 s[72:73], s[86:87], s[88:89]
 s_add_u32 s16, s72, s74
 s_addc_u32 s17, s73, 0
 s_and_b32 s17, s17, 0xffff
 buffer_load_dwordx4 v8, s[16:19], s21 offen offset:0  nt lds
 buffer_load_dwordx4 v9, s[16:19], s21 offen offset:1024  nt lds
 buffer_load_dwordx4 v10, s[16:19], s21 offen offset:2048  nt lds
 buffer_load_dwordx4 v11, s[16:19], s21 offen offset:3072  nt lds
 s_add_u32 s21, s21, 128
 s_add_u32 s48, s82, s75
 s_addc_u32 s49, s83, 0
 s_and_b32 s49, s49, 0xffff
 s_add_u32 m0, s24, 0
 s_nop 0
 buffer_load_dwordx4 v12, s[48:51], s22 offen offset:0   lds
 buffer_load_dwordx4 v13, s[48:51], s22 offen offset:1024   lds
 buffer_load_dwordx4 v14, s[48:51], s22 offen offset:2048   lds
 buffer_load_dwordx4 v15, s[48:51], s22 offen offset:3072   lds
 s_add_u32 s22, s22, 2097152
 s_add_u32 m0, s23, 16384
 s_nop 0
 buffer_load_dwordx4 v8, s[16:19], s21 offen offset:0  nt lds
 buffer_load_dwordx4 v9, s[16:19], s21 offen offset:1024  nt lds
 buffer_load_dwordx4 v10, s[16:19], s21 offen offset:2048  nt lds
 buffer_load_dwordx4 v11, s[16:19], s21 offen offset:3072  nt lds
 s_add_u32 s21, s21, 524160
 v_lshrrev_b32 v26, 2, v24
 v_and_b32 v28, 1, v25
 v_lshl_or_b32 v28, v28, 2, v26
 v_lshl_add_u32 v29, v25, 3, v26
 v_lshlrev_b32 v29, 8, v29
 v_and_b32 v30, 3, v0
 v_lshl_add_u32 v29, v30, 3, v29
 s_lshl_b32 s64, s65, 2
 s_add_u32 s64, s64, 0
 v_xor_b32 v30, s64, v28
 v_lshl_add_u32 v1, v30, 5, v29
 s_lshl_b32 s64, s65, 2
 s_add_u32 s64, s64, 1
 v_xor_b32 v30, s64, v28
 v_lshl_add_u32 v2, v30, 5, v29
 s_lshl_b32 s64, s65, 2
 s_add_u32 s64, s64, 2
 v_xor_b32 v30, s64, v28
 v_lshl_add_u32 v3, v30, 5, v29
 s_lshl_b32 s64, s65, 2
 s_add_u32 s64, s64, 3
 v_xor_b32 v30, s64, v28
 v_lshl_add_u32 v4, v30, 5, v29
 v_add_u32 v28, 0, v25
 v_lshrrev_b32 v29, 1, v24
 v_xor_b32 v28, v28, v29
 v_lshlrev_b32 v28, 4, v28
 v_lshl_add_u32 v28, v24, 7, v28
 s_lshl_b32 s64, s66, 13
 s_add_u32 s64, s64, 65536
 v_add_u32 v5, s64, v28
 v_add_u32 v28, 4, v25
 v_lshrrev_b32 v29, 1, v24
 v_xor_b32 v28, v28, v29
 v_lshlrev_b32 v28, 4, v28
 v_lshl_add_u32 v28, v24, 7, v28
 s_lshl_b32 s64, s66, 13
 s_add_u32 s64, s64, 65536
 v_add_u32 v6, s64, v28
 s_lshl_b32 s64, s2, 2
 s_add_u32 s64, s64, s20
 s_lshl_b32 s64, s64, 12
 v_lshrrev_b32 v28, 2, v0
 v_and_b32 v29, 3, v0
 v_lshlrev_b32 v29, 7, v29
 v_lshl_add_u32 v28, v28, 11, v29
 v_add_u32 v24, s64, v28
 v_and_b32 v28, 56, v0
 v_lshl_add_u32 v24, v28, 24, v24
 s_mov_b32 s32, s82
 s_and_b32 s33, s83, 0xffff
 s_mov_b32 s34, 4194304
 s_mov_b32 s35, 0x20000
 s_mov_b32 s56, s80
 s_and_b32 s57, s81, 0xffff
 s_mov_b32 s58, 1835008
 s_mov_b32 s59, 0x20000
 s_mov_b32 s60, s92
 s_and_b32 s61, s93, 0xffff
 s_mov_b32 s62, 896
 s_mov_b32 s63, 0x20000
 s_mov_b32 s68, s30
 s_and_b32 s69, s31, 0xffff
 s_mov_b32 s70, 896
 s_mov_b32 s71, 0x20000
 s_mov_b32 s8, s6
 s_and_b32 s9, s7, 0xffff
 s_mov_b32 s10, 268435456
 s_mov_b32 s11, 0x20000
 s_mov_b32 s12, s4
 s_and_b32 s13, s5, 0xffff
 s_mov_b32 s14, 256
 s_mov_b32 s15, 0x20000
 s_add_u32 s72, s84, s74
 s_addc_u32 s73, s85, 0
 s_sub_u32 s75, 3670016, s74
 s_mov_b32 s52, s72
 s_and_b32 s53, s73, 0xffff
 s_mov_b32 s54, s75
 s_mov_b32 s55, 0x20000
 s_mov_b32 s5, 0x3db8aa3b
 s_mov_b32 s28, 0
 s_mul_i32 s29, s42, 114688
 s_lshl_b32 s72, s45, 24
 s_lshl_b32 s73, s41, 20
 s_add_u32 s72, s72, s73
 s_bfe_u32 s64, s42, 0x20001
 s_lshl_b32 s64, s64, 15
 s_add_u32 s72, s72, s64
 s_lshl_b32 s64, s66, 17
 s_add_u32 s72, s72, s64
 s_and_b32 s67, s42, 1
 s_cmp_eq_u32 s45, 0
 s_cselect_b32 s64, 12, 14
 s_cselect_b32 s75, 14, 10
 s_lshl_b32 s67, s67, s75
 s_add_u32 s72, s72, s67
 s_lshl_b32 s64, s65, s64
 s_add_u32 s93, s72, s64
 s_load_dwordx4 s[80:83], s[0:1], 64
 s_load_dwordx2 s[84:85], s[0:1], 80
 s_load_dwordx2 s[96:97], s[0:1], 96
 s_cmp_lt_u32 s42, 8
 s_cbranch_scc0 L_kv1
L_kv0:
 s_lshl_b32 s64, s42, 4
 s_add_u32 s64, s64, s41
 s_lshl_b32 s64, s64, 2
 s_add_u32 s64, s64, s20
 s_cmp_lt_u32 s64, 41
 s_cselect_b32 s39, 0, 536870912
 s_min_u32 s64, s64, 41
 s_lshl_b32 s38, s64, 2
 s_max_u32 s67, s64, 8
 s_sub_u32 s67, s67, 8
 s_mul_i32 s67, s67, 3328
 s_lshl_b32 s64, s64, 10
 s_add_u32 s64, s64, s67
 s_add_u32 s73, s64, 104914944
 v_or_b32 v64, s39, v7
 v_mov_b32 v68, 0
 v_mov_b32 v69, 0
 v_mov_b32 v70, 0
 v_mov_b32 v71, 0
 s_lshl_b32 s30, s41, 3
 s_add_u32 s30, s30, s42
 s_lshl_b32 s64, s30, 2
 s_add_u32 s64, s64, s20
 s_mul_i32 s72, s64, 3584
 v_mov_b32 v32, 536870912
 v_cmp_gt_u32 vcc, 56, v0
 s_lshl_b32 s67, s64, 2
 s_nop 0
 v_cndmask_b32 v32, v32, v7, vcc
 buffer_load_dwordx4 v[40:43], v32, s[56:59], s72 offen offset:0
 buffer_load_dwordx4 v[44:47], v32, s[56:59], s72 offen offset:896
 buffer_load_dwordx4 v[48:51], v32, s[56:59], s72 offen offset:1792
 buffer_load_dwordx4 v[52:55], v32, s[56:59], s72 offen offset:2688
 buffer_load_dwordx4 v[56:59], v32, s[60:63], 0 offen
 buffer_load_dwordx4 v[60:63], v32, s[68:71], 0 offen
 buffer_store_dwordx4 v[68:71], v64, s[8:11], s73 offen offset:0 sc1
 buffer_store_dwordx4 v[68:71], v64, s[8:11], s73 offen offset:1024 sc1
 buffer_store_dwordx4 v[68:71], v64, s[8:11], s73 offen offset:2048 sc1
 s_waitcnt vmcnt(13) lgkmcnt(0)
 s_barrier
 ds_read_b128 a[160:163], v5 offset:0
 ds_read_b128 a[164:167], v6 offset:0
 ds_read_b64_tr_b16 a[32:33], v1 offset:0
 ds_read_b64_tr_b16 a[34:35], v1 offset:1024
 ds_read_b64_tr_b16 a[36:37], v1 offset:8192
 ds_read_b64_tr_b16 a[38:39], v1 offset:9216
 ds_read_b64_tr_b16 a[40:41], v2 offset:0
 ds_read_b64_tr_b16 a[42:43], v2 offset:1024
 ds_read_b64_tr_b16 a[44:45], v2 offset:8192
 ds_read_b64_tr_b16 a[46:47], v2 offset:9216
 ds_read_b128 a[168:171], v5 offset:2048
 ds_read_b128 a[172:175], v6 offset:2048
 ds_read_b64_tr_b16 a[48:49], v3 offset:0
 ds_read_b64_tr_b16 a[50:51], v3 offset:1024
 ds_read_b64_tr_b16 a[52:53], v3 offset:8192
 ds_read_b64_tr_b16 a[54:55], v3 offset:9216
 ds_read_b64_tr_b16 a[56:57], v4 offset:0
 ds_read_b64_tr_b16 a[58:59], v4 offset:1024
 ds_read_b64_tr_b16 a[60:61], v4 offset:8192
 ds_read_b64_tr_b16 a[62:63], v4 offset:9216
 ds_read_b128 a[176:179], v5 offset:4096
 ds_read_b128 a[180:183], v6 offset:4096
 ds_read_b128 a[184:187], v5 offset:6144
 ds_read_b128 a[188:191], v6 offset:6144
 s_add_u32 m0, s24, 16384
 s_nop 0
 buffer_load_dwordx4 v12, s[48:51], s22 offen offset:0   lds
 buffer_load_dwordx4 v13, s[48:51], s22 offen offset:1024   lds
 buffer_load_dwordx4 v14, s[48:51], s22 offen offset:2048   lds
 buffer_load_dwordx4 v15, s[48:51], s22 offen offset:3072   lds
 s_sub_u32 s22, s22, 2097024
 s_add_u32 m0, s23, 32768
 s_nop 0
 buffer_load_dwordx4 v8, s[16:19], s21 offen offset:0  nt lds
 buffer_load_dwordx4 v9, s[16:19], s21 offen offset:1024  nt lds
 buffer_load_dwordx4 v10, s[16:19], s21 offen offset:2048  nt lds
 buffer_load_dwordx4 v11, s[16:19], s21 offen offset:3072  nt lds
 s_add_u32 s21, s21, 128
 v_mov_b32 v72, 0
 v_mov_b32 v73, 0
 v_mov_b32 v74, 0
 v_mov_b32 v75, 0
 v_mov_b32 v76, 0
 v_mov_b32 v77, 0
 v_mov_b32 v78, 0
 v_mov_b32 v79, 0
 s_waitcnt vmcnt(12)
 v_dot2c_f32_bf16 v72, v40, v56
 v_dot2c_f32_bf16 v73, v44, v56
 v_dot2c_f32_bf16 v74, v48, v56
 v_dot2c_f32_bf16 v75, v52, v56
 s_waitcnt vmcnt(11)
 v_dot2c_f32_bf16 v76, v40, v60
 v_dot2c_f32_bf16 v77, v44, v60
 v_dot2c_f32_bf16 v78, v48, v60
 v_dot2c_f32_bf16 v79, v52, v60
 v_dot2c_f32_bf16 v72, v41, v57
 v_dot2c_f32_bf16 v73, v45, v57
 v_dot2c_f32_bf16 v74, v49, v57
 v_dot2c_f32_bf16 v75, v53, v57
 v_dot2c_f32_bf16 v76, v41, v61
 v_dot2c_f32_bf16 v77, v45, v61
 v_dot2c_f32_bf16 v78, v49, v61
 v_dot2c_f32_bf16 v79, v53, v61
 v_dot2c_f32_bf16 v72, v42, v58
 v_dot2c_f32_bf16 v73, v46, v58
 v_dot2c_f32_bf16 v74, v50, v58
 v_dot2c_f32_bf16 v75, v54, v58
 v_dot2c_f32_bf16 v76, v42, v62
 v_dot2c_f32_bf16 v77, v46, v62
 v_dot2c_f32_bf16 v78, v50, v62
 v_dot2c_f32_bf16 v79, v54, v62
 v_dot2c_f32_bf16 v72, v43, v59
 v_dot2c_f32_bf16 v73, v47, v59
 v_dot2c_f32_bf16 v74, v51, v59
 v_dot2c_f32_bf16 v75, v55, v59
 v_dot2c_f32_bf16 v76, v43, v63
 v_dot2c_f32_bf16 v77, v47, v63
 v_dot2c_f32_bf16 v78, v51, v63
 v_dot2c_f32_bf16 v79, v55, v63
 v_permlane32_swap_b32 v72, v74
 v_permlane32_swap_b32 v73, v75
 v_permlane32_swap_b32 v76, v78
 v_permlane32_swap_b32 v77, v79
 v_add_f32 v72, v72, v74
 v_add_f32 v73, v73, v75
 v_add_f32 v76, v76, v78
 v_add_f32 v77, v77, v79
 v_lshrrev_b32 v80, 4, v0
 v_permlane16_swap_b32 v72, v73
 v_permlane16_swap_b32 v76, v77
 v_add_f32 v72, v72, v73
 v_add_f32 v76, v76, v77
 v_add_u32 v81, s67, v80
 v_add_f32 v72, v72, v72 row_ror:8 row_mask:0xf bank_mask:0xf
 v_add_f32 v76, v76, v76 row_ror:8 row_mask:0xf bank_mask:0xf
 s_nop 0
 v_add_f32 v72, v72, v72 row_ror:4 row_mask:0xf bank_mask:0xf
 v_add_f32 v76, v76, v76 row_ror:4 row_mask:0xf bank_mask:0xf
 s_nop 0
 v_add_f32 v72, v72, v72 row_ror:2 row_mask:0xf bank_mask:0xf
 v_add_f32 v76, v76, v76 row_ror:2 row_mask:0xf bank_mask:0xf
 s_nop 0
 v_add_f32 v72, v72, v72 row_ror:1 row_mask:0xf bank_mask:0xf
 v_add_f32 v76, v76, v76 row_ror:1 row_mask:0xf bank_mask:0xf
 v_ashrrev_i32 v82, 31, v72
 v_or_b32 v82, 0x80000000, v82
 v_xor_b32 v82, v82, v72
 v_and_b32 v82, 0xfffff800, v82
 v_sub_u32 v81, 2047, v81
 v_or_b32 v82, v82, v81
 v_max_u32 v82, 1, v82
 v_mul_f32 v77, 0xbfb8aa3b, v76
 v_exp_f32 v77, v77
 s_nop 0
 v_add_f32 v77, 1.0, v77
 v_rcp_f32 v76, v77
 s_lshl_b32 s72, s20, 4
 s_add_u32 s72, s72, 163584
 v_lshl_add_u32 v80, v80, 2, s72
 ds_write_b32 v80, v82
 ds_write_b32 v80, v72 offset:64
 ds_write_b32 v80, v76 offset:128
 s_waitcnt lgkmcnt(15)
M a[0:3], a[160:163], a[32:35], 0
M a[0:3], a[164:167], a[36:39], a[0:3]
M a[4:7], a[164:167], a[44:47], 0
M a[4:7], a[160:163], a[40:43], a[4:7]
 s_waitcnt lgkmcnt(11)
M a[8:11], a[160:163], a[48:51], 0
M a[8:11], a[164:167], a[52:55], a[8:11]
 s_waitcnt lgkmcnt(7)
M a[12:15], a[164:167], a[60:63], 0
 s_add_u32 m0, s23, 49152
M a[12:15], a[160:163], a[56:59], a[12:15]
 buffer_load_dwordx4 v8, s[16:19], s21 offen offset:0  nt lds
M v[32:35], a[168:171], a[32:35], 0
 buffer_load_dwordx4 v9, s[16:19], s21 offen offset:1024  nt lds
M v[32:35], a[172:175], a[36:39], v[32:35]
M v[36:39], a[172:175], a[44:47], 0
 buffer_load_dwordx4 v10, s[16:19], s21 offen offset:2048  nt lds
M v[36:39], a[168:171], a[40:43], v[36:39]
M v[40:43], a[168:171], a[48:51], 0
 buffer_load_dwordx4 v11, s[16:19], s21 offen offset:3072  nt lds
M v[40:43], a[172:175], a[52:55], v[40:43]
 s_add_u32 s21, s21, 524160
M v[44:47], a[172:175], a[60:63], 0
 s_waitcnt lgkmcnt(0)
M v[44:47], a[168:171], a[56:59], v[44:47]
 s_barrier
M v[64:67], a[176:179], a[32:35], 0
 s_add_u32 m0, s24, 32768
 ds_read_b64_tr_b16 a[64:65], v1 offset:16384
 ds_read_b64_tr_b16 a[66:67], v1 offset:17408
M v[64:67], a[180:183], a[36:39], v[64:67]
 ds_read_b64_tr_b16 a[68:69], v1 offset:24576
 ds_read_b64_tr_b16 a[70:71], v1 offset:25600
M v[68:71], a[180:183], a[44:47], 0
 buffer_load_dwordx4 v12, s[48:51], s22 offen offset:0   lds
M v[68:71], a[176:179], a[40:43], v[68:71]
 ds_read_b64_tr_b16 a[72:73], v2 offset:16384
 ds_read_b64_tr_b16 a[74:75], v2 offset:17408
M v[72:75], a[176:179], a[48:51], 0
 ds_read_b64_tr_b16 a[76:77], v2 offset:24576
 ds_read_b64_tr_b16 a[78:79], v2 offset:25600
M v[72:75], a[180:183], a[52:55], v[72:75]
 buffer_load_dwordx4 v13, s[48:51], s22 offen offset:1024   lds
M v[76:79], a[180:183], a[60:63], 0
 ds_read_b64_tr_b16 a[80:81], v3 offset:16384
 ds_read_b64_tr_b16 a[82:83], v3 offset:17408
M v[76:79], a[176:179], a[56:59], v[76:79]
 ds_read_b64_tr_b16 a[84:85], v3 offset:24576
 ds_read_b64_tr_b16 a[86:87], v3 offset:25600
M v[96:99], a[184:187], a[32:35], 0
 buffer_load_dwordx4 v14, s[48:51], s22 offen offset:2048   lds
M v[96:99], a[188:191], a[36:39], v[96:99]
 ds_read_b64_tr_b16 a[88:89], v4 offset:16384
 ds_read_b64_tr_b16 a[90:91], v4 offset:17408
M v[100:103], a[188:191], a[44:47], 0
 ds_read_b64_tr_b16 a[92:93], v4 offset:24576
 ds_read_b64_tr_b16 a[94:95], v4 offset:25600
M v[100:103], a[184:187], a[40:43], v[100:103]
 buffer_load_dwordx4 v15, s[48:51], s22 offen offset:3072   lds
M v[104:107], a[184:187], a[48:51], 0
 s_add_u32 s22, s22, 2097152
 v_max3_f32 v20, |v32|, |v33|, |v34|
 v_max3_f32 v20, |v35|, |v36|, v20
M v[104:107], a[188:191], a[52:55], v[104:107]
 v_max3_f32 v20, |v37|, |v38|, v20
 v_max3_f32 v21, |v64|, |v65|, |v66|
M v[108:111], a[188:191], a[60:63], 0
 s_add_u32 m0, s23, 0
 v_max3_f32 v21, |v67|, |v68|, v21
 v_max3_f32 v21, |v69|, |v70|, v21
M v[108:111], a[184:187], a[56:59], v[108:111]
 s_waitcnt lgkmcnt(0)
 v_min_f32 v20, v20, v21
 v_mul_f32 v20, 0x41000000, v20
M a[16:19], a[160:163], a[64:67], 0
 buffer_load_dwordx4 v8, s[16:19], s21 offen offset:0  nt lds
M a[16:19], a[164:167], a[68:71], a[16:19]
 v_mov_b32 v21, v20
 v_mov_b32 v22, v20
M a[20:23], a[164:167], a[76:79], 0
 buffer_load_dwordx4 v9, s[16:19], s21 offen offset:1024  nt lds
M a[20:23], a[160:163], a[72:75], a[20:23]
 v_mov_b32 v23, v20
 v_accvgpr_write_b32 a241, v20
M a[24:27], a[160:163], a[80:83], 0
M a[24:27], a[164:167], a[84:87], a[24:27]
M a[28:31], a[164:167], a[92:95], 0
 buffer_load_dwordx4 v10, s[16:19], s21 offen offset:2048  nt lds
M a[28:31], a[160:163], a[88:91], a[28:31]
M v[48:51], a[168:171], a[64:67], v[20:23]
M v[48:51], a[172:175], a[68:71], v[48:51]
 buffer_load_dwordx4 v11, s[16:19], s21 offen offset:3072  nt lds
M v[52:55], a[172:175], a[76:79], v[20:23]
 s_add_u32 s21, s21, 128
M v[52:55], a[168:171], a[72:75], v[52:55]
M v[56:59], a[168:171], a[80:83], v[20:23]
M v[56:59], a[172:175], a[84:87], v[56:59]
M v[60:63], a[172:175], a[92:95], v[20:23]
 s_waitcnt vmcnt(12)
M v[60:63], a[168:171], a[88:91], v[60:63]
 s_barrier
M v[80:83], a[176:179], a[64:67], v[20:23]
 s_add_u32 m0, s24, 49152
 ds_read_b128 a[160:163], v5 offset:16384
 ds_read_b128 a[164:167], v6 offset:16384
M v[80:83], a[180:183], a[68:71], v[80:83]
 buffer_load_dwordx4 v12, s[48:51], s22 offen offset:0   lds
M v[84:87], a[180:183], a[76:79], v[20:23]
 ds_read_b64_tr_b16 a[96:97], v1 offset:32768
 ds_read_b64_tr_b16 a[98:99], v1 offset:33792
M v[84:87], a[176:179], a[72:75], v[84:87]
M v[88:91], a[176:179], a[80:83], v[20:23]
 buffer_load_dwordx4 v13, s[48:51], s22 offen offset:1024   lds
M v[88:91], a[180:183], a[84:87], v[88:91]
 ds_read_b64_tr_b16 a[100:101], v1 offset:40960
 ds_read_b64_tr_b16 a[102:103], v1 offset:41984
M v[92:95], a[180:183], a[92:95], v[20:23]
M v[92:95], a[176:179], a[88:91], v[92:95]
M v[112:115], a[184:187], a[64:67], v[20:23]
 ds_read_b64_tr_b16 a[104:105], v2 offset:32768
 ds_read_b64_tr_b16 a[106:107], v2 offset:33792
M v[112:115], a[188:191], a[68:71], v[112:115]
 buffer_load_dwordx4 v14, s[48:51], s22 offen offset:2048   lds
M v[116:119], a[188:191], a[76:79], v[20:23]
M v[116:119], a[184:187], a[72:75], v[116:119]
 ds_read_b64_tr_b16 a[108:109], v2 offset:40960
 ds_read_b64_tr_b16 a[110:111], v2 offset:41984
M v[120:123], a[184:187], a[80:83], v[20:23]
 buffer_load_dwordx4 v15, s[48:51], s22 offen offset:3072   lds
M v[120:123], a[188:191], a[84:87], v[120:123]
 s_waitcnt lgkmcnt(8)
M v[124:127], a[188:191], a[92:95], v[20:23]
 s_sub_u32 s22, s22, 2097024
M v[124:127], a[184:187], a[88:91], v[124:127]
 s_add_u32 m0, s23, 16384
 ds_read_b64_tr_b16 a[112:113], v3 offset:32768
 ds_read_b64_tr_b16 a[114:115], v3 offset:33792
M v[128:131], a[160:163], a[32:35], v[20:23]
 ds_read_b128 a[168:171], v5 offset:18432
 ds_read_b128 a[172:175], v6 offset:18432
M v[128:131], a[164:167], a[36:39], v[128:131]
 buffer_load_dwordx4 v8, s[16:19], s21 offen offset:0  nt lds
M v[132:135], a[164:167], a[44:47], v[20:23]
 ds_read_b64_tr_b16 a[116:117], v3 offset:40960
 ds_read_b64_tr_b16 a[118:119], v3 offset:41984
M v[132:135], a[160:163], a[40:43], v[132:135]
 buffer_load_dwordx4 v9, s[16:19], s21 offen offset:1024  nt lds
M v[136:139], a[160:163], a[48:51], v[20:23]
M v[136:139], a[164:167], a[52:55], v[136:139]
 ds_read_b64_tr_b16 a[120:121], v4 offset:32768
 ds_read_b64_tr_b16 a[122:123], v4 offset:33792
M v[140:143], a[164:167], a[60:63], v[20:23]
 buffer_load_dwordx4 v10, s[16:19], s21 offen offset:2048  nt lds
M v[140:143], a[160:163], a[56:59], v[140:143]
M v[144:147], a[160:163], a[64:67], v[20:23]
 ds_read_b64_tr_b16 a[124:125], v4 offset:40960
 ds_read_b64_tr_b16 a[126:127], v4 offset:41984
M v[144:147], a[164:167], a[68:71], v[144:147]
 buffer_load_dwordx4 v11, s[16:19], s21 offen offset:3072  nt lds
M v[148:151], a[164:167], a[76:79], v[20:23]
 s_add_u32 s21, s21, 524160
M v[148:151], a[160:163], a[72:75], v[148:151]
M v[152:155], a[160:163], a[80:83], v[20:23]
M v[152:155], a[164:167], a[84:87], v[152:155]
 s_waitcnt lgkmcnt(6)
M v[156:159], a[164:167], a[92:95], v[20:23]
 s_waitcnt vmcnt(16) lgkmcnt(0)
M v[156:159], a[160:163], a[88:91], v[156:159]
 s_barrier
M v[160:163], a[168:171], a[32:35], v[20:23]
 s_add_u32 m0, s24, 0
 ds_read_b128 a[160:163], v5 offset:20480
 ds_read_b128 a[164:167], v6 offset:20480
M v[160:163], a[172:175], a[36:39], v[160:163]
 buffer_load_dwordx4 v12, s[48:51], s22 offen offset:0   lds
M v[164:167], a[172:175], a[44:47], v[20:23]
 ds_read_b64_tr_b16 a[128:129], v1 offset:49152
 ds_read_b64_tr_b16 a[130:131], v1 offset:50176
M v[164:167], a[168:171], a[40:43], v[164:167]
M v[168:171], a[168:171], a[48:51], v[20:23]
 buffer_load_dwordx4 v13, s[48:51], s22 offen offset:1024   lds
M v[168:171], a[172:175], a[52:55], v[168:171]
 ds_read_b64_tr_b16 a[132:133], v1 offset:57344
 ds_read_b64_tr_b16 a[134:135], v1 offset:58368
M v[172:175], a[172:175], a[60:63], v[20:23]
M v[172:175], a[168:171], a[56:59], v[172:175]
M v[176:179], a[168:171], a[64:67], v[20:23]
 ds_read_b64_tr_b16 a[136:137], v2 offset:49152
 ds_read_b64_tr_b16 a[138:139], v2 offset:50176
M v[176:179], a[172:175], a[68:71], v[176:179]
 buffer_load_dwordx4 v14, s[48:51], s22 offen offset:2048   lds
M v[180:183], a[172:175], a[76:79], v[20:23]
M v[180:183], a[168:171], a[72:75], v[180:183]
 ds_read_b64_tr_b16 a[140:141], v2 offset:57344
 ds_read_b64_tr_b16 a[142:143], v2 offset:58368
M v[184:187], a[168:171], a[80:83], v[20:23]
 buffer_load_dwordx4 v15, s[48:51], s22 offen offset:3072   lds
M v[184:187], a[172:175], a[84:87], v[184:187]
 s_waitcnt lgkmcnt(8)
M v[188:191], a[172:175], a[92:95], v[20:23]
 s_add_u32 s22, s22, 2097152
M v[188:191], a[168:171], a[88:91], v[188:191]
 s_add_u32 m0, s23, 32768
 ds_read_b64_tr_b16 a[144:145], v3 offset:49152
 ds_read_b64_tr_b16 a[146:147], v3 offset:50176
M v[192:195], a[160:163], a[32:35], v[20:23]
 ds_read_b128 a[168:171], v5 offset:22528
 ds_read_b128 a[172:175], v6 offset:22528
M v[192:195], a[164:167], a[36:39], v[192:195]
 buffer_load_dwordx4 v8, s[16:19], s21 offen offset:0  nt lds
M v[196:199], a[164:167], a[44:47], v[20:23]
 ds_read_b64_tr_b16 a[148:149], v3 offset:57344
 ds_read_b64_tr_b16 a[150:151], v3 offset:58368
M v[196:199], a[160:163], a[40:43], v[196:199]
 buffer_load_dwordx4 v9, s[16:19], s21 offen offset:1024  nt lds
M v[200:203], a[160:163], a[48:51], v[20:23]
M v[200:203], a[164:167], a[52:55], v[200:203]
 ds_read_b64_tr_b16 a[152:153], v4 offset:49152
 ds_read_b64_tr_b16 a[154:155], v4 offset:50176
M v[204:207], a[164:167], a[60:63], v[20:23]
 buffer_load_dwordx4 v10, s[16:19], s21 offen offset:2048  nt lds
M v[204:207], a[160:163], a[56:59], v[204:207]
M v[208:211], a[160:163], a[64:67], v[20:23]
 ds_read_b64_tr_b16 a[156:157], v4 offset:57344
 ds_read_b64_tr_b16 a[158:159], v4 offset:58368
M v[208:211], a[164:167], a[68:71], v[208:211]
 buffer_load_dwordx4 v11, s[16:19], s21 offen offset:3072  nt lds
M v[212:215], a[164:167], a[76:79], v[20:23]
 s_add_u32 s21, s21, 128
M v[212:215], a[160:163], a[72:75], v[212:215]
M v[216:219], a[160:163], a[80:83], v[20:23]
M v[216:219], a[164:167], a[84:87], v[216:219]
 s_waitcnt lgkmcnt(6)
M v[220:223], a[164:167], a[92:95], v[20:23]
 s_waitcnt vmcnt(16) lgkmcnt(0)
M v[220:223], a[160:163], a[88:91], v[220:223]
 s_barrier
M v[224:227], a[168:171], a[32:35], v[20:23]
 ds_read_b128 a[160:163], v5 offset:32768
 ds_read_b128 a[164:167], v6 offset:32768
M v[224:227], a[172:175], a[36:39], v[224:227]
 buffer_load_dword a240, v24, s[32:35], 0 offen offset:512
M v[228:231], a[172:175], a[44:47], v[20:23]
M v[228:231], a[168:171], a[40:43], v[228:231]
M v[232:235], a[168:171], a[48:51], v[20:23]
M v[232:235], a[172:175], a[52:55], v[232:235]
M v[236:239], a[172:175], a[60:63], v[20:23]
M v[236:239], a[168:171], a[56:59], v[236:239]
M v[240:243], a[168:171], a[64:67], v[20:23]
M v[240:243], a[172:175], a[68:71], v[240:243]
M v[244:247], a[172:175], a[76:79], v[20:23]
M v[244:247], a[168:171], a[72:75], v[244:247]
M v[248:251], a[168:171], a[80:83], v[20:23]
M v[248:251], a[172:175], a[84:87], v[248:251]
 s_waitcnt lgkmcnt(0)
M v[252:255], a[172:175], a[92:95], v[20:23]
M v[252:255], a[168:171], a[88:91], v[252:255]
M a[0:3], a[160:163], a[96:99], a[0:3]
 ds_read_b128 a[168:171], v5 offset:34816
 ds_read_b128 a[172:175], v6 offset:34816
M a[0:3], a[164:167], a[100:103], a[0:3]
 ds_read_b64_tr_b16 a[32:33], v1 offset:0
 ds_read_b64_tr_b16 a[34:35], v1 offset:1024
M a[4:7], a[164:167], a[108:111], a[4:7]
 s_add_u32 m0, s24, 16384
M a[4:7], a[160:163], a[104:107], a[4:7]
 buffer_load_dwordx4 v12, s[48:51], s22 offen offset:0   lds
M a[8:11], a[160:163], a[112:115], a[8:11]
M a[8:11], a[164:167], a[116:119], a[8:11]
M a[12:15], a[164:167], a[124:127], a[12:15]
 ds_read_b64_tr_b16 a[36:37], v1 offset:8192
 ds_read_b64_tr_b16 a[38:39], v1 offset:9216
M a[12:15], a[160:163], a[120:123], a[12:15]
M a[16:19], a[160:163], a[128:131], a[16:19]
 buffer_load_dwordx4 v13, s[48:51], s22 offen offset:1024   lds
M a[16:19], a[164:167], a[132:135], a[16:19]
M a[20:23], a[164:167], a[140:143], a[20:23]
M a[20:23], a[160:163], a[136:139], a[20:23]
 ds_read_b64_tr_b16 a[40:41], v2 offset:0
 ds_read_b64_tr_b16 a[42:43], v2 offset:1024
M a[24:27], a[160:163], a[144:147], a[24:27]
M a[24:27], a[164:167], a[148:151], a[24:27]
 s_waitcnt lgkmcnt(6)
M a[28:31], a[164:167], a[156:159], a[28:31]
 buffer_load_dwordx4 v14, s[48:51], s22 offen offset:2048   lds
M a[28:31], a[160:163], a[152:155], a[28:31]
M v[32:35], a[168:171], a[96:99], v[32:35]
 ds_read_b128 a[160:163], v5 offset:36864
 ds_read_b128 a[164:167], v6 offset:36864
M v[32:35], a[172:175], a[100:103], v[32:35]
 ds_read_b64_tr_b16 a[44:45], v2 offset:8192
 ds_read_b64_tr_b16 a[46:47], v2 offset:9216
M v[36:39], a[172:175], a[108:111], v[36:39]
 buffer_load_dwordx4 v15, s[48:51], s22 offen offset:3072   lds
M v[36:39], a[168:171], a[104:107], v[36:39]
 s_sub_u32 s22, s22, 2097024
M v[40:43], a[168:171], a[112:115], v[40:43]
M v[40:43], a[172:175], a[116:119], v[40:43]
 ds_read_b64_tr_b16 a[48:49], v3 offset:0
 ds_read_b64_tr_b16 a[50:51], v3 offset:1024
M v[44:47], a[172:175], a[124:127], v[44:47]
 s_add_u32 m0, s23, 49152
M v[44:47], a[168:171], a[120:123], v[44:47]
 buffer_load_dwordx4 v8, s[16:19], s21 offen offset:0  nt lds
M v[48:51], a[168:171], a[128:131], v[48:51]
M v[48:51], a[172:175], a[132:135], v[48:51]
M v[52:55], a[172:175], a[140:143], v[52:55]
 ds_read_b64_tr_b16 a[52:53], v3 offset:8192
 ds_read_b64_tr_b16 a[54:55], v3 offset:9216
M v[52:55], a[168:171], a[136:139], v[52:55]
M v[56:59], a[168:171], a[144:147], v[56:59]
 buffer_load_dwordx4 v9, s[16:19], s21 offen offset:1024  nt lds
M v[56:59], a[172:175], a[148:151], v[56:59]
 s_waitcnt lgkmcnt(6)
M v[60:63], a[172:175], a[156:159], v[60:63]
M v[60:63], a[168:171], a[152:155], v[60:63]
 ds_read_b64_tr_b16 a[56:57], v4 offset:0
 ds_read_b64_tr_b16 a[58:59], v4 offset:1024
M v[64:67], a[160:163], a[96:99], v[64:67]
 ds_read_b128 a[168:171], v5 offset:38912
 ds_read_b128 a[172:175], v6 offset:38912
M v[64:67], a[164:167], a[100:103], v[64:67]
 buffer_load_dwordx4 v10, s[16:19], s21 offen offset:2048  nt lds
M v[68:71], a[164:167], a[108:111], v[68:71]
M v[68:71], a[160:163], a[104:107], v[68:71]
M v[72:75], a[160:163], a[112:115], v[72:75]
 ds_read_b64_tr_b16 a[60:61], v4 offset:8192
 ds_read_b64_tr_b16 a[62:63], v4 offset:9216
M v[72:75], a[164:167], a[116:119], v[72:75]
M v[76:79], a[164:167], a[124:127], v[76:79]
 buffer_load_dwordx4 v11, s[16:19], s21 offen offset:3072  nt lds
M v[76:79], a[160:163], a[120:123], v[76:79]
 s_add_u32 s21, s21, 524160
M v[80:83], a[160:163], a[128:131], v[80:83]
M v[80:83], a[164:167], a[132:135], v[80:83]
M v[84:87], a[164:167], a[140:143], v[84:87]
M v[84:87], a[160:163], a[136:139], v[84:87]
M v[88:91], a[160:163], a[144:147], v[88:91]
M v[88:91], a[164:167], a[148:151], v[88:91]
 s_waitcnt lgkmcnt(2)
M v[92:95], a[164:167], a[156:159], v[92:95]
 s_waitcnt vmcnt(17) lgkmcnt(0)
M v[92:95], a[160:163], a[152:155], v[92:95]
 s_barrier
M v[96:99], a[168:171], a[96:99], v[96:99]
 ds_read_b128 a[160:163], v5 offset:49152
 ds_read_b128 a[164:167], v6 offset:49152
M v[96:99], a[172:175], a[100:103], v[96:99]
M v[100:103], a[172:175], a[108:111], v[100:103]
 s_add_u32 m0, s24, 32768
 ds_read_b64_tr_b16 a[64:65], v1 offset:16384
 ds_read_b64_tr_b16 a[66:67], v1 offset:17408
M v[100:103], a[168:171], a[104:107], v[100:103]
 buffer_load_dwordx4 v12, s[48:51], s22 offen offset:0   lds
M v[104:107], a[168:171], a[112:115], v[104:107]
M v[104:107], a[172:175], a[116:119], v[104:107]
M v[108:111], a[172:175], a[124:127], v[108:111]
M v[108:111], a[168:171], a[120:123], v[108:111]
M v[112:115], a[168:171], a[128:131], v[112:115]
M v[112:115], a[172:175], a[132:135], v[112:115]
 ds_read_b64_tr_b16 a[68:69], v1 offset:24576
 ds_read_b64_tr_b16 a[70:71], v1 offset:25600
M v[116:119], a[172:175], a[140:143], v[116:119]
 buffer_load_dwordx4 v13, s[48:51], s22 offen offset:1024   lds
M v[116:119], a[168:171], a[136:139], v[116:119]
M v[120:123], a[168:171], a[144:147], v[120:123]
M v[120:123], a[172:175], a[148:151], v[120:123]
 s_waitcnt lgkmcnt(4)
M v[124:127], a[172:175], a[156:159], v[124:127]
M v[124:127], a[168:171], a[152:155], v[124:127]
M v[128:131], a[160:163], a[96:99], v[128:131]
 ds_read_b128 a[168:171], v5 offset:51200
 ds_read_b128 a[172:175], v6 offset:51200
M v[128:131], a[164:167], a[100:103], v[128:131]
 ds_read_b64_tr_b16 a[72:73], v2 offset:16384
 ds_read_b64_tr_b16 a[74:75], v2 offset:17408
M v[132:135], a[164:167], a[108:111], v[132:135]
 buffer_load_dwordx4 v14, s[48:51], s22 offen offset:2048   lds
M v[132:135], a[160:163], a[104:107], v[132:135]
M v[136:139], a[160:163], a[112:115], v[136:139]
M v[136:139], a[164:167], a[116:119], v[136:139]
M v[140:143], a[164:167], a[124:127], v[140:143]
M v[140:143], a[160:163], a[120:123], v[140:143]
 ds_read_b64_tr_b16 a[76:77], v2 offset:24576
 ds_read_b64_tr_b16 a[78:79], v2 offset:25600
M v[144:147], a[160:163], a[128:131], v[144:147]
 buffer_load_dwordx4 v15, s[48:51], s22 offen offset:3072   lds
M v[144:147], a[164:167], a[132:135], v[144:147]
 s_add_u32 s22, s22, 2097152
M v[148:151], a[164:167], a[140:143], v[148:151]
M v[148:151], a[160:163], a[136:139], v[148:151]
M v[152:155], a[160:163], a[144:147], v[152:155]
M v[152:155], a[164:167], a[148:151], v[152:155]
 s_waitcnt lgkmcnt(4)
M v[156:159], a[164:167], a[156:159], v[156:159]
 s_add_u32 m0, s23, 0
 ds_read_b64_tr_b16 a[80:81], v3 offset:16384
 ds_read_b64_tr_b16 a[82:83], v3 offset:17408
M v[156:159], a[160:163], a[152:155], v[156:159]
 buffer_load_dwordx4 v8, s[16:19], s21 offen offset:0  nt lds
M v[160:163], a[168:171], a[96:99], v[160:163]
 ds_read_b128 a[160:163], v5 offset:53248
 ds_read_b128 a[164:167], v6 offset:53248
M v[160:163], a[172:175], a[100:103], v[160:163]
M v[164:167], a[172:175], a[108:111], v[164:167]
M v[164:167], a[168:171], a[104:107], v[164:167]
M v[168:171], a[168:171], a[112:115], v[168:171]
M v[168:171], a[172:175], a[116:119], v[168:171]
 ds_read_b64_tr_b16 a[84:85], v3 offset:24576
 ds_read_b64_tr_b16 a[86:87], v3 offset:25600
M v[172:175], a[172:175], a[124:127], v[172:175]
 buffer_load_dwordx4 v9, s[16:19], s21 offen offset:1024  nt lds
M v[172:175], a[168:171], a[120:123], v[172:175]
M v[176:179], a[168:171], a[128:131], v[176:179]
M v[176:179], a[172:175], a[132:135], v[176:179]
M v[180:183], a[172:175], a[140:143], v[180:183]
M v[180:183], a[168:171], a[136:139], v[180:183]
M v[184:187], a[168:171], a[144:147], v[184:187]
 ds_read_b64_tr_b16 a[88:89], v4 offset:16384
 ds_read_b64_tr_b16 a[90:91], v4 offset:17408
M v[184:187], a[172:175], a[148:151], v[184:187]
 s_waitcnt lgkmcnt(4)
M v[188:191], a[172:175], a[156:159], v[188:191]
 buffer_load_dwordx4 v10, s[16:19], s21 offen offset:2048  nt lds
M v[188:191], a[168:171], a[152:155], v[188:191]
M v[192:195], a[160:163], a[96:99], v[192:195]
 ds_read_b128 a[168:171], v5 offset:55296
 ds_read_b128 a[172:175], v6 offset:55296
M v[192:195], a[164:167], a[100:103], v[192:195]
M v[196:199], a[164:167], a[108:111], v[196:199]
M v[196:199], a[160:163], a[104:107], v[196:199]
 ds_read_b64_tr_b16 a[92:93], v4 offset:24576
 ds_read_b64_tr_b16 a[94:95], v4 offset:25600
M v[200:203], a[160:163], a[112:115], v[200:203]
 buffer_load_dwordx4 v11, s[16:19], s21 offen offset:3072  nt lds
M v[200:203], a[164:167], a[116:119], v[200:203]
 s_add_u32 s21, s21, 128
M v[204:207], a[164:167], a[124:127], v[204:207]
M v[204:207], a[160:163], a[120:123], v[204:207]
M v[208:211], a[160:163], a[128:131], v[208:211]
M v[208:211], a[164:167], a[132:135], v[208:211]
M v[212:215], a[164:167], a[140:143], v[212:215]
M v[212:215], a[160:163], a[136:139], v[212:215]
M v[216:219], a[160:163], a[144:147], v[216:219]
M v[216:219], a[164:167], a[148:151], v[216:219]
 s_waitcnt lgkmcnt(2)
M v[220:223], a[164:167], a[156:159], v[220:223]
 s_waitcnt vmcnt(17) lgkmcnt(0)
M v[220:223], a[160:163], a[152:155], v[220:223]
 s_barrier
M v[224:227], a[168:171], a[96:99], v[224:227]
 ds_read_b128 a[160:163], v5 offset:0
 ds_read_b128 a[164:167], v6 offset:0
M v[224:227], a[172:175], a[100:103], v[224:227]
 v_min_u32 v16, 1, v0
 v_lshlrev_b32 v16, 29, v16
M v[228:231], a[172:175], a[108:111], v[228:231]
 v_or_b32 v16, s39, v16
 v_mov_b32 v17, 1
M v[228:231], a[168:171], a[104:107], v[228:231]
M v[232:235], a[168:171], a[112:115], v[232:235]
 buffer_store_dword v17, v16, s[12:15], s38 offen offset:64 sc1
M v[232:235], a[172:175], a[116:119], v[232:235]
M v[236:239], a[172:175], a[124:127], v[236:239]
M v[236:239], a[168:171], a[120:123], v[236:239]
M v[240:243], a[168:171], a[128:131], v[240:243]
M v[240:243], a[172:175], a[132:135], v[240:243]
M v[244:247], a[172:175], a[140:143], v[244:247]
M v[244:247], a[168:171], a[136:139], v[244:247]
M v[248:251], a[168:171], a[144:147], v[248:251]
M v[248:251], a[172:175], a[148:151], v[248:251]
 s_waitcnt lgkmcnt(0)
M v[252:255], a[172:175], a[156:159], v[252:255]
M v[252:255], a[168:171], a[152:155], v[252:255]
M a[0:3], a[160:163], a[32:35], a[0:3]
 ds_read_b128 a[168:171], v5 offset:2048
 ds_read_b128 a[172:175], v6 offset:2048
M a[0:3], a[164:167], a[36:39], a[0:3]
 ds_read_b64_tr_b16 a[96:97], v1 offset:32768
 ds_read_b64_tr_b16 a[98:99], v1 offset:33792
M a[4:7], a[164:167], a[44:47], a[4:7]
 s_add_u32 m0, s24, 49152
M a[4:7], a[160:163], a[40:43], a[4:7]
 buffer_load_dwordx4 v12, s[48:51], s22 offen offset:0   lds
M a[8:11], a[160:163], a[48:51], a[8:11]
 v_and_b32 v20, 31, v0
M a[8:11], a[164:167], a[52:55], a[8:11]
 v_lshlrev_b32 v20, 2, v20
M a[12:15], a[164:167], a[60:63], a[12:15]
 ds_read_b64_tr_b16 a[100:101], v1 offset:40960
 ds_read_b64_tr_b16 a[102:103], v1 offset:41984
M a[12:15], a[160:163], a[56:59], a[12:15]
 v_add_u32 v21, 163584, v20
M a[16:19], a[160:163], a[64:67], a[16:19]
 buffer_load_dwordx4 v13, s[48:51], s22 offen offset:1024   lds
M a[16:19], a[164:167], a[68:71], a[16:19]
 ds_read_b32 v19, v21
M a[20:23], a[164:167], a[76:79], a[20:23]
 ds_read_b32 v21, v21 offset:64
M a[20:23], a[160:163], a[72:75], a[20:23]
 s_min_u32 s64, s20, 1
 ds_read_b64_tr_b16 a[104:105], v2 offset:32768
 ds_read_b64_tr_b16 a[106:107], v2 offset:33792
M a[24:27], a[160:163], a[80:83], a[24:27]
 s_lshl_b32 s64, s64, 29
 v_and_b32 v22, 32, v0
M a[24:27], a[164:167], a[84:87], a[24:27]
 s_waitcnt lgkmcnt(8)
 v_lshl_or_b32 v20, v22, 24, v20
M a[28:31], a[164:167], a[92:95], a[28:31]
 buffer_load_dwordx4 v14, s[48:51], s22 offen offset:2048   lds
M a[28:31], a[160:163], a[88:91], a[28:31]
 v_or_b32 v20, s64, v20
M v[32:35], a[168:171], a[32:35], v[32:35]
 ds_read_b128 a[160:163], v5 offset:4096
 ds_read_b128 a[164:167], v6 offset:4096
M v[32:35], a[172:175], a[36:39], v[32:35]
 ds_read_b64_tr_b16 a[108:109], v2 offset:40960
 ds_read_b64_tr_b16 a[110:111], v2 offset:41984
M v[36:39], a[172:175], a[44:47], v[36:39]
 buffer_load_dwordx4 v15, s[48:51], s22 offen offset:3072   lds
M v[36:39], a[168:171], a[40:43], v[36:39]
 s_sub_u32 s22, s22, 2097024
 v_and_b32 v22, 16, v0
M v[40:43], a[168:171], a[48:51], v[40:43]
 v_lshl_or_b32 v18, v22, 25, v20
M v[40:43], a[172:175], a[52:55], v[40:43]
 s_lshl_b32 s72, s30, 7
 ds_read_b64_tr_b16 a[112:113], v3 offset:32768
 ds_read_b64_tr_b16 a[114:115], v3 offset:33792
M v[44:47], a[172:175], a[60:63], v[44:47]
 s_add_u32 m0, s23, 16384
 s_add_u32 s72, s72, 104857600
M v[44:47], a[168:171], a[56:59], v[44:47]
 buffer_load_dwordx4 v8, s[16:19], s21 offen offset:0  nt lds
M v[48:51], a[168:171], a[64:67], v[48:51]
M v[48:51], a[172:175], a[68:71], v[48:51]
M v[52:55], a[172:175], a[76:79], v[52:55]
 ds_read_b64_tr_b16 a[116:117], v3 offset:40960
 ds_read_b64_tr_b16 a[118:119], v3 offset:41984
M v[52:55], a[168:171], a[72:75], v[52:55]
M v[56:59], a[168:171], a[80:83], v[56:59]
 buffer_load_dwordx4 v9, s[16:19], s21 offen offset:1024  nt lds
M v[56:59], a[172:175], a[84:87], v[56:59]
 s_waitcnt lgkmcnt(6)
M v[60:63], a[172:175], a[92:95], v[60:63]
 buffer_store_dword v21, v20, s[8:11], s72 offen sc1
M v[60:63], a[168:171], a[88:91], v[60:63]
 ds_read_b64_tr_b16 a[120:121], v4 offset:32768
 ds_read_b64_tr_b16 a[122:123], v4 offset:33792
M v[64:67], a[160:163], a[32:35], v[64:67]
 ds_read_b128 a[168:171], v5 offset:6144
 ds_read_b128 a[172:175], v6 offset:6144
M v[64:67], a[164:167], a[36:39], v[64:67]
 buffer_load_dwordx4 v10, s[16:19], s21 offen offset:2048  nt lds
M v[68:71], a[164:167], a[44:47], v[68:71]
M v[68:71], a[160:163], a[40:43], v[68:71]
M v[72:75], a[160:163], a[48:51], v[72:75]
 ds_read_b64_tr_b16 a[124:125], v4 offset:40960
 ds_read_b64_tr_b16 a[126:127], v4 offset:41984
M v[72:75], a[164:167], a[52:55], v[72:75]
M v[76:79], a[164:167], a[60:63], v[76:79]
 buffer_load_dwordx4 v11, s[16:19], s21 offen offset:3072  nt lds
M v[76:79], a[160:163], a[56:59], v[76:79]
 s_add_u32 s21, s21, 524160
M v[80:83], a[160:163], a[64:67], v[80:83]
M v[80:83], a[164:167], a[68:71], v[80:83]
M v[84:87], a[164:167], a[76:79], v[84:87]
M v[84:87], a[160:163], a[72:75], v[84:87]
 s_and_b32 s86, s41, 7
M v[88:91], a[160:163], a[80:83], v[88:91]
 s_mul_i32 s86, s86, 14
 s_lshr_b32 s64, s41, 3
 s_mul_i32 s64, s64, 7
M v[88:91], a[164:167], a[84:87], v[88:91]
 s_waitcnt lgkmcnt(2)
 s_add_u32 s86, s86, s64
 s_min_u32 s64, s42, 6
M v[92:95], a[164:167], a[92:95], v[92:95]
 s_waitcnt vmcnt(18) lgkmcnt(0)
 s_add_u32 s86, s86, s64
 s_sub_u32 s64, 6, s42
M v[92:95], a[160:163], a[88:91], v[92:95]
 s_barrier
M v[96:99], a[168:171], a[32:35], v[96:99]
 ds_read_b128 a[160:163], v5 offset:16384
 ds_read_b128 a[164:167], v6 offset:16384
M v[96:99], a[172:175], a[36:39], v[96:99]
 s_and_b32 s88, s64, 536870912
 s_mul_i32 s87, s20, 7168
M v[100:103], a[172:175], a[44:47], v[100:103]
 s_add_u32 m0, s24, 0
 ds_read_b64_tr_b16 a[128:129], v1 offset:49152
 ds_read_b64_tr_b16 a[130:131], v1 offset:50176
M v[100:103], a[168:171], a[40:43], v[100:103]
 buffer_load_dwordx4 v12, s[48:51], s22 offen offset:0   lds
M v[104:107], a[168:171], a[48:51], v[104:107]
 s_add_u32 s87, s87, 131072
M v[104:107], a[172:175], a[52:55], v[104:107]
 s_cmp_lt_u32 s20, 2
M v[108:111], a[172:175], a[60:63], v[108:111]
 s_cselect_b64 s[72:73], s[80:81], s[82:83]
M v[108:111], a[168:171], a[56:59], v[108:111]
 s_mov_b32 s60, s72
M v[112:115], a[168:171], a[64:67], v[112:115]
 s_and_b32 s61, s73, 0xffff
M v[112:115], a[172:175], a[68:71], v[112:115]
 s_mov_b32 s62, 1605632
 ds_read_b64_tr_b16 a[132:133], v1 offset:57344
 ds_read_b64_tr_b16 a[134:135], v1 offset:58368
M v[116:119], a[172:175], a[76:79], v[116:119]
 buffer_load_dwordx4 v13, s[48:51], s22 offen offset:1024   lds
M v[116:119], a[168:171], a[72:75], v[116:119]
 s_mov_b32 s63, 0x20000
M v[120:123], a[168:171], a[80:83], v[120:123]
 s_mov_b32 s68, s84
 s_and_b32 s69, s85, 0xffff
 s_mov_b32 s70, 1605632
M v[120:123], a[172:175], a[84:87], v[120:123]
 s_waitcnt lgkmcnt(4)
 s_mov_b32 s71, 0x20000
M v[124:127], a[172:175], a[92:95], v[124:127]
 s_lshl_b32 s89, s86, 5
 s_and_b32 s64, s20, 1
 s_mul_i32 s64, s64, 802816
M v[124:127], a[168:171], a[88:91], v[124:127]
 buffer_load_dwordx4 v14, s[48:51], s22 offen offset:2048   lds
M v[128:131], a[160:163], a[32:35], v[128:131]
 ds_read_b128 a[168:171], v5 offset:18432
 ds_read_b128 a[172:175], v6 offset:18432
M v[128:131], a[164:167], a[36:39], v[128:131]
 ds_read_b64_tr_b16 a[136:137], v2 offset:49152
 ds_read_b64_tr_b16 a[138:139], v2 offset:50176
M v[132:135], a[164:167], a[44:47], v[132:135]
 s_add_u32 s89, s89, s64
 v_lshrrev_b32 v28, 1, v0
M v[132:135], a[160:163], a[40:43], v[132:135]
 v_mul_u32_u24 v28, 3584, v28
 v_and_b32 v29, 1, v0
M v[136:139], a[160:163], a[48:51], v[136:139]
 v_lshl_add_u32 v25, v29, 4, v28
 v_or_b32 v25, s88, v25
M v[136:139], a[164:167], a[52:55], v[136:139]
M v[140:143], a[164:167], a[60:63], v[140:143]
 buffer_load_dwordx4 v15, s[48:51], s22 offen offset:3072   lds
M v[140:143], a[160:163], a[56:59], v[140:143]
 s_add_u32 s22, s22, 2097152
 ds_read_b64_tr_b16 a[140:141], v2 offset:57344
 ds_read_b64_tr_b16 a[142:143], v2 offset:58368
M v[144:147], a[160:163], a[64:67], v[144:147]
M v[144:147], a[164:167], a[68:71], v[144:147]
M v[148:151], a[164:167], a[76:79], v[148:151]
M v[148:151], a[160:163], a[72:75], v[148:151]
 s_add_u32 m0, s23, 32768
M v[152:155], a[160:163], a[80:83], v[152:155]
 buffer_load_dwordx4 v8, s[16:19], s21 offen offset:0  nt lds
M v[152:155], a[164:167], a[84:87], v[152:155]
 s_waitcnt lgkmcnt(4)
M v[156:159], a[164:167], a[92:95], v[156:159]
 ds_read_b64_tr_b16 a[144:145], v3 offset:49152
 ds_read_b64_tr_b16 a[146:147], v3 offset:50176
M v[156:159], a[160:163], a[88:91], v[156:159]
M v[160:163], a[168:171], a[32:35], v[160:163]
 ds_read_b128 a[160:163], v5 offset:20480
 ds_read_b128 a[164:167], v6 offset:20480
M v[160:163], a[172:175], a[36:39], v[160:163]
M v[164:167], a[172:175], a[44:47], v[164:167]
 buffer_load_dwordx4 v9, s[16:19], s21 offen offset:1024  nt lds
M v[164:167], a[168:171], a[40:43], v[164:167]
M v[168:171], a[168:171], a[48:51], v[168:171]
M v[168:171], a[172:175], a[52:55], v[168:171]
 ds_read_b64_tr_b16 a[148:149], v3 offset:57344
 ds_read_b64_tr_b16 a[150:151], v3 offset:58368
M v[172:175], a[172:175], a[60:63], v[172:175]
M v[172:175], a[168:171], a[56:59], v[172:175]
M v[176:179], a[168:171], a[64:67], v[176:179]
M v[176:179], a[172:175], a[68:71], v[176:179]
 buffer_load_dwordx4 v10, s[16:19], s21 offen offset:2048  nt lds
M v[180:183], a[172:175], a[76:79], v[180:183]
M v[180:183], a[168:171], a[72:75], v[180:183]
M v[184:187], a[168:171], a[80:83], v[184:187]
 ds_read_b64_tr_b16 a[152:153], v4 offset:49152
 ds_read_b64_tr_b16 a[154:155], v4 offset:50176
M v[184:187], a[172:175], a[84:87], v[184:187]
 s_waitcnt lgkmcnt(4)
M v[188:191], a[172:175], a[92:95], v[188:191]
M v[188:191], a[168:171], a[88:91], v[188:191]
 buffer_load_dwordx4 v11, s[16:19], s21 offen offset:3072  nt lds
M v[192:195], a[160:163], a[32:35], v[192:195]
 s_add_u32 s21, s21, 128
 ds_read_b128 a[168:171], v5 offset:22528
 ds_read_b128 a[172:175], v6 offset:22528
M v[192:195], a[164:167], a[36:39], v[192:195]
M v[196:199], a[164:167], a[44:47], v[196:199]
M v[196:199], a[160:163], a[40:43], v[196:199]
 ds_read_b64_tr_b16 a[156:157], v4 offset:57344
 ds_read_b64_tr_b16 a[158:159], v4 offset:58368
M v[200:203], a[160:163], a[48:51], v[200:203]
 s_add_u32 m0, s87, 0
M v[200:203], a[164:167], a[52:55], v[200:203]
 buffer_load_dwordx4 v25, s[60:63], s89 offen offset:0 nt lds
M v[204:207], a[164:167], a[60:63], v[204:207]
 s_add_u32 s89, s89, 114688
M v[204:207], a[160:163], a[56:59], v[204:207]
M v[208:211], a[160:163], a[64:67], v[208:211]
M v[208:211], a[164:167], a[68:71], v[208:211]
M v[212:215], a[164:167], a[76:79], v[212:215]
M v[212:215], a[160:163], a[72:75], v[212:215]
M v[216:219], a[160:163], a[80:83], v[216:219]
M v[216:219], a[164:167], a[84:87], v[216:219]
 s_waitcnt lgkmcnt(2)
M v[220:223], a[164:167], a[92:95], v[220:223]
 s_waitcnt vmcnt(19) lgkmcnt(0)
M v[220:223], a[160:163], a[88:91], v[220:223]
 s_barrier
M v[224:227], a[168:171], a[32:35], v[224:227]
 ds_read_b128 a[160:163], v5 offset:32768
 ds_read_b128 a[164:167], v6 offset:32768
M v[224:227], a[172:175], a[36:39], v[224:227]
M v[228:231], a[172:175], a[44:47], v[228:231]
M v[228:231], a[168:171], a[40:43], v[228:231]
M v[232:235], a[168:171], a[48:51], v[232:235]
M v[232:235], a[172:175], a[52:55], v[232:235]
M v[236:239], a[172:175], a[60:63], v[236:239]
M v[236:239], a[168:171], a[56:59], v[236:239]
M v[240:243], a[168:171], a[64:67], v[240:243]
M v[240:243], a[172:175], a[68:71], v[240:243]
M v[244:247], a[172:175], a[76:79], v[244:247]
M v[244:247], a[168:171], a[72:75], v[244:247]
M v[248:251], a[168:171], a[80:83], v[248:251]
M v[248:251], a[172:175], a[84:87], v[248:251]
 s_waitcnt lgkmcnt(0)
M v[252:255], a[172:175], a[92:95], v[252:255]
M v[252:255], a[168:171], a[88:91], v[252:255]
M a[0:3], a[160:163], a[96:99], a[0:3]
 ds_read_b128 a[168:171], v5 offset:34816
 ds_read_b128 a[172:175], v6 offset:34816
M a[0:3], a[164:167], a[100:103], a[0:3]
 ds_read_b64_tr_b16 a[32:33], v1 offset:0
 ds_read_b64_tr_b16 a[34:35], v1 offset:1024
M a[4:7], a[164:167], a[108:111], a[4:7]
 s_add_u32 m0, s24, 16384
M a[4:7], a[160:163], a[104:107], a[4:7]
 buffer_load_dwordx4 v12, s[48:51], s22 offen offset:0   lds
M a[8:11], a[160:163], a[112:115], a[8:11]
M a[8:11], a[164:167], a[116:119], a[8:11]
M a[12:15], a[164:167], a[124:127], a[12:15]
 ds_read_b64_tr_b16 a[36:37], v1 offset:8192
 ds_read_b64_tr_b16 a[38:39], v1 offset:9216
M a[12:15], a[160:163], a[120:123], a[12:15]
M a[16:19], a[160:163], a[128:131], a[16:19]
 buffer_load_dwordx4 v13, s[48:51], s22 offen offset:1024   lds
M a[16:19], a[164:167], a[132:135], a[16:19]
M a[20:23], a[164:167], a[140:143], a[20:23]
M a[20:23], a[160:163], a[136:139], a[20:23]
 ds_read_b64_tr_b16 a[40:41], v2 offset:0
 ds_read_b64_tr_b16 a[42:43], v2 offset:1024
M a[24:27], a[160:163], a[144:147], a[24:27]
M a[24:27], a[164:167], a[148:151], a[24:27]
 s_waitcnt lgkmcnt(6)
M a[28:31], a[164:167], a[156:159], a[28:31]
 buffer_load_dwordx4 v14, s[48:51], s22 offen offset:2048   lds
M a[28:31], a[160:163], a[152:155], a[28:31]
M v[32:35], a[168:171], a[96:99], v[32:35]
 ds_read_b128 a[160:163], v5 offset:36864
 ds_read_b128 a[164:167], v6 offset:36864
M v[32:35], a[172:175], a[100:103], v[32:35]
 ds_read_b64_tr_b16 a[44:45], v2 offset:8192
 ds_read_b64_tr_b16 a[46:47], v2 offset:9216
M v[36:39], a[172:175], a[108:111], v[36:39]
 buffer_load_dwordx4 v15, s[48:51], s22 offen offset:3072   lds
M v[36:39], a[168:171], a[104:107], v[36:39]
 s_sub_u32 s22, s22, 2097024
M v[40:43], a[168:171], a[112:115], v[40:43]
M v[40:43], a[172:175], a[116:119], v[40:43]
 ds_read_b64_tr_b16 a[48:49], v3 offset:0
 ds_read_b64_tr_b16 a[50:51], v3 offset:1024
M v[44:47], a[172:175], a[124:127], v[44:47]
 s_add_u32 m0, s23, 49152
M v[44:47], a[168:171], a[120:123], v[44:47]
 buffer_load_dwordx4 v8, s[16:19], s21 offen offset:0  nt lds
M v[48:51], a[168:171], a[128:131], v[48:51]
M v[48:51], a[172:175], a[132:135], v[48:51]
M v[52:55], a[172:175], a[140:143], v[52:55]
 ds_read_b64_tr_b16 a[52:53], v3 offset:8192
 ds_read_b64_tr_b16 a[54:55], v3 offset:9216
M v[52:55], a[168:171], a[136:139], v[52:55]
M v[56:59], a[168:171], a[144:147], v[56:59]
 buffer_load_dwordx4 v9, s[16:19], s21 offen offset:1024  nt lds
M v[56:59], a[172:175], a[148:151], v[56:59]
 s_waitcnt lgkmcnt(6)
M v[60:63], a[172:175], a[156:159], v[60:63]
M v[60:63], a[168:171], a[152:155], v[60:63]
 ds_read_b64_tr_b16 a[56:57], v4 offset:0
 ds_read_b64_tr_b16 a[58:59], v4 offset:1024
M v[64:67], a[160:163], a[96:99], v[64:67]
 ds_read_b128 a[168:171], v5 offset:38912
 ds_read_b128 a[172:175], v6 offset:38912
M v[64:67], a[164:167], a[100:103], v[64:67]
 buffer_load_dwordx4 v10, s[16:19], s21 offen offset:2048  nt lds
M v[68:71], a[164:167], a[108:111], v[68:71]
M v[68:71], a[160:163], a[104:107], v[68:71]
M v[72:75], a[160:163], a[112:115], v[72:75]
 ds_read_b64_tr_b16 a[60:61], v4 offset:8192
 ds_read_b64_tr_b16 a[62:63], v4 offset:9216
M v[72:75], a[164:167], a[116:119], v[72:75]
M v[76:79], a[164:167], a[124:127], v[76:79]
 buffer_load_dwordx4 v11, s[16:19], s21 offen offset:3072  nt lds
M v[76:79], a[160:163], a[120:123], v[76:79]
 s_add_u32 s21, s21, 524160
M v[80:83], a[160:163], a[128:131], v[80:83]
M v[80:83], a[164:167], a[132:135], v[80:83]
M v[84:87], a[164:167], a[140:143], v[84:87]
M v[84:87], a[160:163], a[136:139], v[84:87]
M v[88:91], a[160:163], a[144:147], v[88:91]
M v[88:91], a[164:167], a[148:151], v[88:91]
 s_waitcnt lgkmcnt(2)
M v[92:95], a[164:167], a[156:159], v[92:95]
 s_waitcnt vmcnt(17) lgkmcnt(0)
M v[92:95], a[160:163], a[152:155], v[92:95]
 s_barrier
M v[96:99], a[168:171], a[96:99], v[96:99]
 ds_read_b128 a[160:163], v5 offset:49152
 ds_read_b128 a[164:167], v6 offset:49152
M v[96:99], a[172:175], a[100:103], v[96:99]
M v[100:103], a[172:175], a[108:111], v[100:103]
 s_add_u32 m0, s24, 32768
 ds_read_b64_tr_b16 a[64:65], v1 offset:16384
 ds_read_b64_tr_b16 a[66:67], v1 offset:17408
M v[100:103], a[168:171], a[104:107], v[100:103]
 buffer_load_dwordx4 v12, s[48:51], s22 offen offset:0   lds
M v[104:107], a[168:171], a[112:115], v[104:107]
 v_min_u32 v16, 40, v0
 v_lshlrev_b32 v16, 2, v16
M v[104:107], a[172:175], a[116:119], v[104:107]
 buffer_load_dword v17, v16, s[12:15], 0 offen offset:64 sc1
M v[108:111], a[172:175], a[124:127], v[108:111]
M v[108:111], a[168:171], a[120:123], v[108:111]
M v[112:115], a[168:171], a[128:131], v[112:115]
M v[112:115], a[172:175], a[132:135], v[112:115]
 ds_read_b64_tr_b16 a[68:69], v1 offset:24576
 ds_read_b64_tr_b16 a[70:71], v1 offset:25600
M v[116:119], a[172:175], a[140:143], v[116:119]
 buffer_load_dwordx4 v13, s[48:51], s22 offen offset:1024   lds
M v[116:119], a[168:171], a[136:139], v[116:119]
M v[120:123], a[168:171], a[144:147], v[120:123]
M v[120:123], a[172:175], a[148:151], v[120:123]
 s_waitcnt lgkmcnt(4)
M v[124:127], a[172:175], a[156:159], v[124:127]
M v[124:127], a[168:171], a[152:155], v[124:127]
 buffer_load_dwordx4 v14, s[48:51], s22 offen offset:2048   lds
M v[128:131], a[160:163], a[96:99], v[128:131]
 ds_read_b128 a[168:171], v5 offset:51200
 ds_read_b128 a[172:175], v6 offset:51200
M v[128:131], a[164:167], a[100:103], v[128:131]
 ds_read_b64_tr_b16 a[72:73], v2 offset:16384
 ds_read_b64_tr_b16 a[74:75], v2 offset:17408
M v[132:135], a[164:167], a[108:111], v[132:135]
M v[132:135], a[160:163], a[104:107], v[132:135]
M v[136:139], a[160:163], a[112:115], v[136:139]
M v[136:139], a[164:167], a[116:119], v[136:139]
M v[140:143], a[164:167], a[124:127], v[140:143]
 buffer_load_dwordx4 v15, s[48:51], s22 offen offset:3072   lds
M v[140:143], a[160:163], a[120:123], v[140:143]
 s_add_u32 s22, s22, 2097152
 ds_read_b64_tr_b16 a[76:77], v2 offset:24576
 ds_read_b64_tr_b16 a[78:79], v2 offset:25600
M v[144:147], a[160:163], a[128:131], v[144:147]
M v[144:147], a[164:167], a[132:135], v[144:147]
M v[148:151], a[164:167], a[140:143], v[148:151]
M v[148:151], a[160:163], a[136:139], v[148:151]
 s_add_u32 m0, s23, 0
M v[152:155], a[160:163], a[144:147], v[152:155]
 buffer_load_dwordx4 v8, s[16:19], s21 offen offset:0  nt lds
M v[152:155], a[164:167], a[148:151], v[152:155]
 s_waitcnt lgkmcnt(4)
M v[156:159], a[164:167], a[156:159], v[156:159]
 ds_read_b64_tr_b16 a[80:81], v3 offset:16384
 ds_read_b64_tr_b16 a[82:83], v3 offset:17408
M v[156:159], a[160:163], a[152:155], v[156:159]
M v[160:163], a[168:171], a[96:99], v[160:163]
 ds_read_b128 a[160:163], v5 offset:53248
 ds_read_b128 a[164:167], v6 offset:53248
M v[160:163], a[172:175], a[100:103], v[160:163]
M v[164:167], a[172:175], a[108:111], v[164:167]
 buffer_load_dwordx4 v9, s[16:19], s21 offen offset:1024  nt lds
M v[164:167], a[168:171], a[104:107], v[164:167]
M v[168:171], a[168:171], a[112:115], v[168:171]
M v[168:171], a[172:175], a[116:119], v[168:171]
 ds_read_b64_tr_b16 a[84:85], v3 offset:24576
 ds_read_b64_tr_b16 a[86:87], v3 offset:25600
M v[172:175], a[172:175], a[124:127], v[172:175]
M v[172:175], a[168:171], a[120:123], v[172:175]
M v[176:179], a[168:171], a[128:131], v[176:179]
M v[176:179], a[172:175], a[132:135], v[176:179]
 buffer_load_dwordx4 v10, s[16:19], s21 offen offset:2048  nt lds
M v[180:183], a[172:175], a[140:143], v[180:183]
M v[180:183], a[168:171], a[136:139], v[180:183]
M v[184:187], a[168:171], a[144:147], v[184:187]
 ds_read_b64_tr_b16 a[88:89], v4 offset:16384
 ds_read_b64_tr_b16 a[90:91], v4 offset:17408
M v[184:187], a[172:175], a[148:151], v[184:187]
 s_waitcnt lgkmcnt(4)
M v[188:191], a[172:175], a[156:159], v[188:191]
M v[188:191], a[168:171], a[152:155], v[188:191]
 buffer_load_dwordx4 v11, s[16:19], s21 offen offset:3072  nt lds
M v[192:195], a[160:163], a[96:99], v[192:195]
 s_add_u32 s21, s21, 128
 ds_read_b128 a[168:171], v5 offset:55296
 ds_read_b128 a[172:175], v6 offset:55296
M v[192:195], a[164:167], a[100:103], v[192:195]
M v[196:199], a[164:167], a[108:111], v[196:199]
M v[196:199], a[160:163], a[104:107], v[196:199]
 ds_read_b64_tr_b16 a[92:93], v4 offset:24576
 ds_read_b64_tr_b16 a[94:95], v4 offset:25600
M v[200:203], a[160:163], a[112:115], v[200:203]
 s_add_u32 m0, s87, 1024
M v[200:203], a[164:167], a[116:119], v[200:203]
 buffer_load_dwordx4 v25, s[60:63], s89 offen offset:0 nt lds
M v[204:207], a[164:167], a[124:127], v[204:207]
 s_add_u32 s89, s89, 114688
M v[204:207], a[160:163], a[120:123], v[204:207]
M v[208:211], a[160:163], a[128:131], v[208:211]
M v[208:211], a[164:167], a[132:135], v[208:211]
M v[212:215], a[164:167], a[140:143], v[212:215]
M v[212:215], a[160:163], a[136:139], v[212:215]
M v[216:219], a[160:163], a[144:147], v[216:219]
M v[216:219], a[164:167], a[148:151], v[216:219]
 s_waitcnt lgkmcnt(2)
M v[220:223], a[164:167], a[156:159], v[220:223]
 s_waitcnt vmcnt(19) lgkmcnt(0)
M v[220:223], a[160:163], a[152:155], v[220:223]
 s_barrier
M v[224:227], a[168:171], a[96:99], v[224:227]
 ds_read_b128 a[160:163], v5 offset:0
 ds_read_b128 a[164:167], v6 offset:0
M v[224:227], a[172:175], a[100:103], v[224:227]
M v[228:231], a[172:175], a[108:111], v[228:231]
M v[228:231], a[168:171], a[104:107], v[228:231]
M v[232:235], a[168:171], a[112:115], v[232:235]
M v[232:235], a[172:175], a[116:119], v[232:235]
M v[236:239], a[172:175], a[124:127], v[236:239]
M v[236:239], a[168:171], a[120:123], v[236:239]
M v[240:243], a[168:171], a[128:131], v[240:243]
M v[240:243], a[172:175], a[132:135], v[240:243]
M v[244:247], a[172:175], a[140:143], v[244:247]
M v[244:247], a[168:171], a[136:139], v[244:247]
M v[248:251], a[168:171], a[144:147], v[248:251]
M v[248:251], a[172:175], a[148:151], v[248:251]
 s_waitcnt lgkmcnt(0)
M v[252:255], a[172:175], a[156:159], v[252:255]
M v[252:255], a[168:171], a[152:155], v[252:255]
M a[0:3], a[160:163], a[32:35], a[0:3]
 ds_read_b128 a[168:171], v5 offset:2048
 ds_read_b128 a[172:175], v6 offset:2048
M a[0:3], a[164:167], a[36:39], a[0:3]
 ds_read_b64_tr_b16 a[96:97], v1 offset:32768
 ds_read_b64_tr_b16 a[98:99], v1 offset:33792
M a[4:7], a[164:167], a[44:47], a[4:7]
 s_add_u32 m0, s24, 49152
M a[4:7], a[160:163], a[40:43], a[4:7]
 buffer_load_dwordx4 v12, s[48:51], s22 offen offset:0   lds
M a[8:11], a[160:163], a[48:51], a[8:11]
M a[8:11], a[164:167], a[52:55], a[8:11]
M a[12:15], a[164:167], a[60:63], a[12:15]
 ds_read_b64_tr_b16 a[100:101], v1 offset:40960
 ds_read_b64_tr_b16 a[102:103], v1 offset:41984
M a[12:15], a[160:163], a[56:59], a[12:15]
M a[16:19], a[160:163], a[64:67], a[16:19]
 buffer_load_dwordx4 v13, s[48:51], s22 offen offset:1024   lds
M a[16:19], a[164:167], a[68:71], a[16:19]
M a[20:23], a[164:167], a[76:79], a[20:23]
M a[20:23], a[160:163], a[72:75], a[20:23]
 ds_read_b64_tr_b16 a[104:105], v2 offset:32768
 ds_read_b64_tr_b16 a[106:107], v2 offset:33792
M a[24:27], a[160:163], a[80:83], a[24:27]
M a[24:27], a[164:167], a[84:87], a[24:27]
 s_waitcnt lgkmcnt(6)
M a[28:31], a[164:167], a[92:95], a[28:31]
 buffer_load_dwordx4 v14, s[48:51], s22 offen offset:2048   lds
M a[28:31], a[160:163], a[88:91], a[28:31]
M v[32:35], a[168:171], a[32:35], v[32:35]
 ds_read_b128 a[160:163], v5 offset:4096
 ds_read_b128 a[164:167], v6 offset:4096
M v[32:35], a[172:175], a[36:39], v[32:35]
 ds_read_b64_tr_b16 a[108:109], v2 offset:40960
 ds_read_b64_tr_b16 a[110:111], v2 offset:41984
M v[36:39], a[172:175], a[44:47], v[36:39]
 buffer_load_dwordx4 v15, s[48:51], s22 offen offset:3072   lds
M v[36:39], a[168:171], a[40:43], v[36:39]
 s_sub_u32 s22, s22, 2097024
M v[40:43], a[168:171], a[48:51], v[40:43]
M v[40:43], a[172:175], a[52:55], v[40:43]
 ds_read_b64_tr_b16 a[112:113], v3 offset:32768
 ds_read_b64_tr_b16 a[114:115], v3 offset:33792
M v[44:47], a[172:175], a[60:63], v[44:47]
 s_add_u32 m0, s23, 16384
M v[44:47], a[168:171], a[56:59], v[44:47]
 buffer_load_dwordx4 v8, s[16:19], s21 offen offset:0  nt lds
M v[48:51], a[168:171], a[64:67], v[48:51]
M v[48:51], a[172:175], a[68:71], v[48:51]
M v[52:55], a[172:175], a[76:79], v[52:55]
 ds_read_b64_tr_b16 a[116:117], v3 offset:40960
 ds_read_b64_tr_b16 a[118:119], v3 offset:41984
M v[52:55], a[168:171], a[72:75], v[52:55]
M v[56:59], a[168:171], a[80:83], v[56:59]
 buffer_load_dwordx4 v9, s[16:19], s21 offen offset:1024  nt lds
M v[56:59], a[172:175], a[84:87], v[56:59]
 s_waitcnt lgkmcnt(6)
M v[60:63], a[172:175], a[92:95], v[60:63]
M v[60:63], a[168:171], a[88:91], v[60:63]
 ds_read_b64_tr_b16 a[120:121], v4 offset:32768
 ds_read_b64_tr_b16 a[122:123], v4 offset:33792
M v[64:67], a[160:163], a[32:35], v[64:67]
 ds_read_b128 a[168:171], v5 offset:6144
 ds_read_b128 a[172:175], v6 offset:6144
M v[64:67], a[164:167], a[36:39], v[64:67]
 buffer_load_dwordx4 v10, s[16:19], s21 offen offset:2048  nt lds
M v[68:71], a[164:167], a[44:47], v[68:71]
M v[68:71], a[160:163], a[40:43], v[68:71]
M v[72:75], a[160:163], a[48:51], v[72:75]
 ds_read_b64_tr_b16 a[124:125], v4 offset:40960
 ds_read_b64_tr_b16 a[126:127], v4 offset:41984
M v[72:75], a[164:167], a[52:55], v[72:75]
M v[76:79], a[164:167], a[60:63], v[76:79]
 buffer_load_dwordx4 v11, s[16:19], s21 offen offset:3072  nt lds
M v[76:79], a[160:163], a[56:59], v[76:79]
 s_add_u32 s21, s21, 524160
M v[80:83], a[160:163], a[64:67], v[80:83]
M v[80:83], a[164:167], a[68:71], v[80:83]
M v[84:87], a[164:167], a[76:79], v[84:87]
M v[84:87], a[160:163], a[72:75], v[84:87]
M v[88:91], a[160:163], a[80:83], v[88:91]
M v[88:91], a[164:167], a[84:87], v[88:91]
 s_waitcnt lgkmcnt(2)
M v[92:95], a[164:167], a[92:95], v[92:95]
 s_waitcnt vmcnt(18) lgkmcnt(0)
M v[92:95], a[160:163], a[88:91], v[92:95]
 s_barrier
M v[96:99], a[168:171], a[32:35], v[96:99]
 ds_read_b128 a[160:163], v5 offset:16384
 ds_read_b128 a[164:167], v6 offset:16384
M v[96:99], a[172:175], a[36:39], v[96:99]
M v[100:103], a[172:175], a[44:47], v[100:103]
 s_add_u32 m0, s24, 0
 ds_read_b64_tr_b16 a[128:129], v1 offset:49152
 ds_read_b64_tr_b16 a[130:131], v1 offset:50176
M v[100:103], a[168:171], a[40:43], v[100:103]
 buffer_load_dwordx4 v12, s[48:51], s22 offen offset:0   lds
M v[104:107], a[168:171], a[48:51], v[104:107]
M v[104:107], a[172:175], a[52:55], v[104:107]
M v[108:111], a[172:175], a[60:63], v[108:111]
M v[108:111], a[168:171], a[56:59], v[108:111]
M v[112:115], a[168:171], a[64:67], v[112:115]
M v[112:115], a[172:175], a[68:71], v[112:115]
 ds_read_b64_tr_b16 a[132:133], v1 offset:57344
 ds_read_b64_tr_b16 a[134:135], v1 offset:58368
M v[116:119], a[172:175], a[76:79], v[116:119]
 buffer_load_dwordx4 v13, s[48:51], s22 offen offset:1024   lds
M v[116:119], a[168:171], a[72:75], v[116:119]
M v[120:123], a[168:171], a[80:83], v[120:123]
M v[120:123], a[172:175], a[84:87], v[120:123]
 s_waitcnt lgkmcnt(4)
M v[124:127], a[172:175], a[92:95], v[124:127]
M v[124:127], a[168:171], a[88:91], v[124:127]
 buffer_load_dwordx4 v14, s[48:51], s22 offen offset:2048   lds
M v[128:131], a[160:163], a[32:35], v[128:131]
 ds_read_b128 a[168:171], v5 offset:18432
 ds_read_b128 a[172:175], v6 offset:18432
M v[128:131], a[164:167], a[36:39], v[128:131]
 ds_read_b64_tr_b16 a[136:137], v2 offset:49152
 ds_read_b64_tr_b16 a[138:139], v2 offset:50176
M v[132:135], a[164:167], a[44:47], v[132:135]
M v[132:135], a[160:163], a[40:43], v[132:135]
M v[136:139], a[160:163], a[48:51], v[136:139]
M v[136:139], a[164:167], a[52:55], v[136:139]
M v[140:143], a[164:167], a[60:63], v[140:143]
 buffer_load_dwordx4 v15, s[48:51], s22 offen offset:3072   lds
M v[140:143], a[160:163], a[56:59], v[140:143]
 s_add_u32 s22, s22, 2097152
 ds_read_b64_tr_b16 a[140:141], v2 offset:57344
 ds_read_b64_tr_b16 a[142:143], v2 offset:58368
M v[144:147], a[160:163], a[64:67], v[144:147]
M v[144:147], a[164:167], a[68:71], v[144:147]
M v[148:151], a[164:167], a[76:79], v[148:151]
M v[148:151], a[160:163], a[72:75], v[148:151]
 s_add_u32 m0, s23, 32768
M v[152:155], a[160:163], a[80:83], v[152:155]
 buffer_load_dwordx4 v8, s[16:19], s21 offen offset:0  nt lds
M v[152:155], a[164:167], a[84:87], v[152:155]
 s_waitcnt lgkmcnt(4)
M v[156:159], a[164:167], a[92:95], v[156:159]
 ds_read_b64_tr_b16 a[144:145], v3 offset:49152
 ds_read_b64_tr_b16 a[146:147], v3 offset:50176
M v[156:159], a[160:163], a[88:91], v[156:159]
M v[160:163], a[168:171], a[32:35], v[160:163]
 ds_read_b128 a[160:163], v5 offset:20480
 ds_read_b128 a[164:167], v6 offset:20480
M v[160:163], a[172:175], a[36:39], v[160:163]
M v[164:167], a[172:175], a[44:47], v[164:167]
 buffer_load_dwordx4 v9, s[16:19], s21 offen offset:1024  nt lds
M v[164:167], a[168:171], a[40:43], v[164:167]
M v[168:171], a[168:171], a[48:51], v[168:171]
M v[168:171], a[172:175], a[52:55], v[168:171]
 ds_read_b64_tr_b16 a[148:149], v3 offset:57344
 ds_read_b64_tr_b16 a[150:151], v3 offset:58368
M v[172:175], a[172:175], a[60:63], v[172:175]
M v[172:175], a[168:171], a[56:59], v[172:175]
M v[176:179], a[168:171], a[64:67], v[176:179]
M v[176:179], a[172:175], a[68:71], v[176:179]
 buffer_load_dwordx4 v10, s[16:19], s21 offen offset:2048  nt lds
M v[180:183], a[172:175], a[76:79], v[180:183]
M v[180:183], a[168:171], a[72:75], v[180:183]
M v[184:187], a[168:171], a[80:83], v[184:187]
 ds_read_b64_tr_b16 a[152:153], v4 offset:49152
 ds_read_b64_tr_b16 a[154:155], v4 offset:50176
M v[184:187], a[172:175], a[84:87], v[184:187]
 s_waitcnt lgkmcnt(4)
M v[188:191], a[172:175], a[92:95], v[188:191]
M v[188:191], a[168:171], a[88:91], v[188:191]
 buffer_load_dwordx4 v11, s[16:19], s21 offen offset:3072  nt lds
M v[192:195], a[160:163], a[32:35], v[192:195]
 s_add_u32 s21, s21, 128
 ds_read_b128 a[168:171], v5 offset:22528
 ds_read_b128 a[172:175], v6 offset:22528
M v[192:195], a[164:167], a[36:39], v[192:195]
M v[196:199], a[164:167], a[44:47], v[196:199]
M v[196:199], a[160:163], a[40:43], v[196:199]
 ds_read_b64_tr_b16 a[156:157], v4 offset:57344
 ds_read_b64_tr_b16 a[158:159], v4 offset:58368
M v[200:203], a[160:163], a[48:51], v[200:203]
 s_add_u32 m0, s87, 2048
M v[200:203], a[164:167], a[52:55], v[200:203]
 buffer_load_dwordx4 v25, s[60:63], s89 offen offset:0 nt lds
M v[204:207], a[164:167], a[60:63], v[204:207]
 s_add_u32 s89, s89, 114688
M v[204:207], a[160:163], a[56:59], v[204:207]
M v[208:211], a[160:163], a[64:67], v[208:211]
M v[208:211], a[164:167], a[68:71], v[208:211]
M v[212:215], a[164:167], a[76:79], v[212:215]
M v[212:215], a[160:163], a[72:75], v[212:215]
M v[216:219], a[160:163], a[80:83], v[216:219]
M v[216:219], a[164:167], a[84:87], v[216:219]
 s_waitcnt lgkmcnt(2)
M v[220:223], a[164:167], a[92:95], v[220:223]
 s_waitcnt vmcnt(18) lgkmcnt(0)
M v[220:223], a[160:163], a[88:91], v[220:223]
 s_barrier
M v[224:227], a[168:171], a[32:35], v[224:227]
 ds_read_b128 a[160:163], v5 offset:32768
 ds_read_b128 a[164:167], v6 offset:32768
M v[224:227], a[172:175], a[36:39], v[224:227]
 v_cmp_ne_u32 vcc, 1, v17
M v[228:231], a[172:175], a[44:47], v[228:231]
 s_nop 0
M v[228:231], a[168:171], a[40:43], v[228:231]
 s_cbranch_vccnz L_zs0
L_zr0:
M v[232:235], a[168:171], a[48:51], v[232:235]
 buffer_load_dword a240, v24, s[32:35], 0 offen offset:1024
M v[232:235], a[172:175], a[52:55], v[232:235]
 s_lshl_b32 s72, s30, 6
M v[236:239], a[172:175], a[60:63], v[236:239]
 s_add_u32 s72, s72, 104914944
M v[236:239], a[168:171], a[56:59], v[236:239]
M v[240:243], a[168:171], a[64:67], v[240:243]
 buffer_store_dword v19, v18, s[8:11], s72 offen sc1
M v[240:243], a[172:175], a[68:71], v[240:243]
M v[244:247], a[172:175], a[76:79], v[244:247]
M v[244:247], a[168:171], a[72:75], v[244:247]
M v[248:251], a[168:171], a[80:83], v[248:251]
M v[248:251], a[172:175], a[84:87], v[248:251]
 s_waitcnt lgkmcnt(0)
M v[252:255], a[172:175], a[92:95], v[252:255]
M v[252:255], a[168:171], a[88:91], v[252:255]
M a[0:3], a[160:163], a[96:99], a[0:3]
 ds_read_b128 a[168:171], v5 offset:34816
 ds_read_b128 a[172:175], v6 offset:34816
M a[0:3], a[164:167], a[100:103], a[0:3]
 ds_read_b64_tr_b16 a[32:33], v1 offset:0
 ds_read_b64_tr_b16 a[34:35], v1 offset:1024
M a[4:7], a[164:167], a[108:111], a[4:7]
 s_add_u32 m0, s24, 16384
M a[4:7], a[160:163], a[104:107], a[4:7]
 buffer_load_dwordx4 v12, s[48:51], s22 offen offset:0   lds
M a[8:11], a[160:163], a[112:115], a[8:11]
M a[8:11], a[164:167], a[116:119], a[8:11]
M a[12:15], a[164:167], a[124:127], a[12:15]
 ds_read_b64_tr_b16 a[36:37], v1 offset:8192
 ds_read_b64_tr_b16 a[38:39], v1 offset:9216
M a[12:15], a[160:163], a[120:123], a[12:15]
M a[16:19], a[160:163], a[128:131], a[16:19]
 buffer_load_dwordx4 v13, s[48:51], s22 offen offset:1024   lds
M a[16:19], a[164:167], a[132:135], a[16:19]
M a[20:23], a[164:167], a[140:143], a[20:23]
M a[20:23], a[160:163], a[136:139], a[20:23]
 ds_read_b64_tr_b16 a[40:41], v2 offset:0
 ds_read_b64_tr_b16 a[42:43], v2 offset:1024
M a[24:27], a[160:163], a[144:147], a[24:27]
M a[24:27], a[164:167], a[148:151], a[24:27]
 s_waitcnt lgkmcnt(6)
M a[28:31], a[164:167], a[156:159], a[28:31]
 buffer_load_dwordx4 v14, s[48:51], s22 offen offset:2048   lds
M a[28:31], a[160:163], a[152:155], a[28:31]
M v[32:35], a[168:171], a[96:99], v[32:35]
 ds_read_b128 a[160:163], v5 offset:36864
 ds_read_b128 a[164:167], v6 offset:36864
M v[32:35], a[172:175], a[100:103], v[32:35]
 ds_read_b64_tr_b16 a[44:45], v2 offset:8192
 ds_read_b64_tr_b16 a[46:47], v2 offset:9216
M v[36:39], a[172:175], a[108:111], v[36:39]
 buffer_load_dwordx4 v15, s[48:51], s22 offen offset:3072   lds
M v[36:39], a[168:171], a[104:107], v[36:39]
 s_sub_u32 s22, s22, 2097024
M v[40:43], a[168:171], a[112:115], v[40:43]
M v[40:43], a[172:175], a[116:119], v[40:43]
 ds_read_b64_tr_b16 a[48:49], v3 offset:0
 ds_read_b64_tr_b16 a[50:51], v3 offset:1024
M v[44:47], a[172:175], a[124:127], v[44:47]
 s_add_u32 m0, s23, 49152
M v[44:47], a[168:171], a[120:123], v[44:47]
 buffer_load_dwordx4 v8, s[16:19], s21 offen offset:0  nt lds
M v[48:51], a[168:171], a[128:131], v[48:51]
M v[48:51], a[172:175], a[132:135], v[48:51]
M v[52:55], a[172:175], a[140:143], v[52:55]
 ds_read_b64_tr_b16 a[52:53], v3 offset:8192
 ds_read_b64_tr_b16 a[54:55], v3 offset:9216
M v[52:55], a[168:171], a[136:139], v[52:55]
M v[56:59], a[168:171], a[144:147], v[56:59]
 buffer_load_dwordx4 v9, s[16:19], s21 offen offset:1024  nt lds
M v[56:59], a[172:175], a[148:151], v[56:59]
 s_waitcnt lgkmcnt(6)
M v[60:63], a[172:175], a[156:159], v[60:63]
M v[60:63], a[168:171], a[152:155], v[60:63]
 ds_read_b64_tr_b16 a[56:57], v4 offset:0
 ds_read_b64_tr_b16 a[58:59], v4 offset:1024
M v[64:67], a[160:163], a[96:99], v[64:67]
 ds_read_b128 a[168:171], v5 offset:38912
 ds_read_b128 a[172:175], v6 offset:38912
M v[64:67], a[164:167], a[100:103], v[64:67]
 buffer_load_dwordx4 v10, s[16:19], s21 offen offset:2048  nt lds
M v[68:71], a[164:167], a[108:111], v[68:71]
M v[68:71], a[160:163], a[104:107], v[68:71]
M v[72:75], a[160:163], a[112:115], v[72:75]
 ds_read_b64_tr_b16 a[60:61], v4 offset:8192
 ds_read_b64_tr_b16 a[62:63], v4 offset:9216
M v[72:75], a[164:167], a[116:119], v[72:75]
M v[76:79], a[164:167], a[124:127], v[76:79]
 buffer_load_dwordx4 v11, s[16:19], s21 offen offset:3072  nt lds
M v[76:79], a[160:163], a[120:123], v[76:79]
 s_add_u32 s21, s21, 524160
M v[80:83], a[160:163], a[128:131], v[80:83]
M v[80:83], a[164:167], a[132:135], v[80:83]
M v[84:87], a[164:167], a[140:143], v[84:87]
M v[84:87], a[160:163], a[136:139], v[84:87]
M v[88:91], a[160:163], a[144:147], v[88:91]
M v[88:91], a[164:167], a[148:151], v[88:91]
 s_waitcnt lgkmcnt(2)
M v[92:95], a[164:167], a[156:159], v[92:95]
 s_waitcnt vmcnt(19) lgkmcnt(0)
M v[92:95], a[160:163], a[152:155], v[92:95]
 s_barrier
M v[96:99], a[168:171], a[96:99], v[96:99]
 ds_read_b128 a[160:163], v5 offset:49152
 ds_read_b128 a[164:167], v6 offset:49152
M v[96:99], a[172:175], a[100:103], v[96:99]
M v[100:103], a[172:175], a[108:111], v[100:103]
 s_add_u32 m0, s24, 32768
 ds_read_b64_tr_b16 a[64:65], v1 offset:16384
 ds_read_b64_tr_b16 a[66:67], v1 offset:17408
M v[100:103], a[168:171], a[104:107], v[100:103]
 buffer_load_dwordx4 v12, s[48:51], s22 offen offset:0   lds
M v[104:107], a[168:171], a[112:115], v[104:107]
M v[104:107], a[172:175], a[116:119], v[104:107]
M v[108:111], a[172:175], a[124:127], v[108:111]
M v[108:111], a[168:171], a[120:123], v[108:111]
M v[112:115], a[168:171], a[128:131], v[112:115]
M v[112:115], a[172:175], a[132:135], v[112:115]
 ds_read_b64_tr_b16 a[68:69], v1 offset:24576
 ds_read_b64_tr_b16 a[70:71], v1 offset:25600
M v[116:119], a[172:175], a[140:143], v[116:119]
 buffer_load_dwordx4 v13, s[48:51], s22 offen offset:1024   lds
M v[116:119], a[168:171], a[136:139], v[116:119]
M v[120:123], a[168:171], a[144:147], v[120:123]
M v[120:123], a[172:175], a[148:151], v[120:123]
 s_waitcnt lgkmcnt(4)
M v[124:127], a[172:175], a[156:159], v[124:127]
M v[124:127], a[168:171], a[152:155], v[124:127]
 buffer_load_dwordx4 v14, s[48:51], s22 offen offset:2048   lds
M v[128:131], a[160:163], a[96:99], v[128:131]
 ds_read_b128 a[168:171], v5 offset:51200
 ds_read_b128 a[172:175], v6 offset:51200
M v[128:131], a[164:167], a[100:103], v[128:131]
 ds_read_b64_tr_b16 a[72:73], v2 offset:16384
 ds_read_b64_tr_b16 a[74:75], v2 offset:17408
M v[132:135], a[164:167], a[108:111], v[132:135]
M v[132:135], a[160:163], a[104:107], v[132:135]
M v[136:139], a[160:163], a[112:115], v[136:139]
M v[136:139], a[164:167], a[116:119], v[136:139]
M v[140:143], a[164:167], a[124:127], v[140:143]
 buffer_load_dwordx4 v15, s[48:51], s22 offen offset:3072   lds
M v[140:143], a[160:163], a[120:123], v[140:143]
 s_add_u32 s22, s22, 2097152
 ds_read_b64_tr_b16 a[76:77], v2 offset:24576
 ds_read_b64_tr_b16 a[78:79], v2 offset:25600
M v[144:147], a[160:163], a[128:131], v[144:147]
M v[144:147], a[164:167], a[132:135], v[144:147]
M v[148:151], a[164:167], a[140:143], v[148:151]
M v[148:151], a[160:163], a[136:139], v[148:151]
 s_add_u32 m0, s23, 0
M v[152:155], a[160:163], a[144:147], v[152:155]
 buffer_load_dwordx4 v8, s[16:19], s21 offen offset:0  nt lds
M v[152:155], a[164:167], a[148:151], v[152:155]
 s_waitcnt lgkmcnt(4)
M v[156:159], a[164:167], a[156:159], v[156:159]
 ds_read_b64_tr_b16 a[80:81], v3 offset:16384
 ds_read_b64_tr_b16 a[82:83], v3 offset:17408
M v[156:159], a[160:163], a[152:155], v[156:159]
M v[160:163], a[168:171], a[96:99], v[160:163]
 ds_read_b128 a[160:163], v5 offset:53248
 ds_read_b128 a[164:167], v6 offset:53248
M v[160:163], a[172:175], a[100:103], v[160:163]
M v[164:167], a[172:175], a[108:111], v[164:167]
 buffer_load_dwordx4 v9, s[16:19], s21 offen offset:1024  nt lds
M v[164:167], a[168:171], a[104:107], v[164:167]
M v[168:171], a[168:171], a[112:115], v[168:171]
M v[168:171], a[172:175], a[116:119], v[168:171]
 ds_read_b64_tr_b16 a[84:85], v3 offset:24576
 ds_read_b64_tr_b16 a[86:87], v3 offset:25600
M v[172:175], a[172:175], a[124:127], v[172:175]
M v[172:175], a[168:171], a[120:123], v[172:175]
M v[176:179], a[168:171], a[128:131], v[176:179]
M v[176:179], a[172:175], a[132:135], v[176:179]
 buffer_load_dwordx4 v10, s[16:19], s21 offen offset:2048  nt lds
M v[180:183], a[172:175], a[140:143], v[180:183]
M v[180:183], a[168:171], a[136:139], v[180:183]
M v[184:187], a[168:171], a[144:147], v[184:187]
 ds_read_b64_tr_b16 a[88:89], v4 offset:16384
 ds_read_b64_tr_b16 a[90:91], v4 offset:17408
M v[184:187], a[172:175], a[148:151], v[184:187]
 s_waitcnt lgkmcnt(4)
M v[188:191], a[172:175], a[156:159], v[188:191]
M v[188:191], a[168:171], a[152:155], v[188:191]
 buffer_load_dwordx4 v11, s[16:19], s21 offen offset:3072  nt lds
M v[192:195], a[160:163], a[96:99], v[192:195]
 s_add_u32 s21, s21, 128
 ds_read_b128 a[168:171], v5 offset:55296
 ds_read_b128 a[172:175], v6 offset:55296
M v[192:195], a[164:167], a[100:103], v[192:195]
M v[196:199], a[164:167], a[108:111], v[196:199]
M v[196:199], a[160:163], a[104:107], v[196:199]
 ds_read_b64_tr_b16 a[92:93], v4 offset:24576
 ds_read_b64_tr_b16 a[94:95], v4 offset:25600
M v[200:203], a[160:163], a[112:115], v[200:203]
 s_add_u32 m0, s87, 3072
M v[200:203], a[164:167], a[116:119], v[200:203]
 buffer_load_dwordx4 v25, s[60:63], s89 offen offset:0 nt lds
M v[204:207], a[164:167], a[124:127], v[204:207]
 s_add_u32 s89, s89, 114688
M v[204:207], a[160:163], a[120:123], v[204:207]
M v[208:211], a[160:163], a[128:131], v[208:211]
M v[208:211], a[164:167], a[132:135], v[208:211]
M v[212:215], a[164:167], a[140:143], v[212:215]
M v[212:215], a[160:163], a[136:139], v[212:215]
M v[216:219], a[160:163], a[144:147], v[216:219]
M v[216:219], a[164:167], a[148:151], v[216:219]
 s_waitcnt lgkmcnt(2)
M v[220:223], a[164:167], a[156:159], v[220:223]
 s_waitcnt vmcnt(20) lgkmcnt(0)
M v[220:223], a[160:163], a[152:155], v[220:223]
 s_barrier
M v[224:227], a[168:171], a[96:99], v[224:227]
 ds_read_b128 a[160:163], v5 offset:0
 ds_read_b128 a[164:167], v6 offset:0
M v[224:227], a[172:175], a[100:103], v[224:227]
M v[228:231], a[172:175], a[108:111], v[228:231]
M v[228:231], a[168:171], a[104:107], v[228:231]
M v[232:235], a[168:171], a[112:115], v[232:235]
M v[232:235], a[172:175], a[116:119], v[232:235]
M v[236:239], a[172:175], a[124:127], v[236:239]
M v[236:239], a[168:171], a[120:123], v[236:239]
M v[240:243], a[168:171], a[128:131], v[240:243]
M v[240:243], a[172:175], a[132:135], v[240:243]
M v[244:247], a[172:175], a[140:143], v[244:247]
M v[244:247], a[168:171], a[136:139], v[244:247]
M v[248:251], a[168:171], a[144:147], v[248:251]
M v[248:251], a[172:175], a[148:151], v[248:251]
 s_waitcnt lgkmcnt(0)
M v[252:255], a[172:175], a[156:159], v[252:255]
M v[252:255], a[168:171], a[152:155], v[252:255]
M a[0:3], a[160:163], a[32:35], a[0:3]
 ds_read_b128 a[168:171], v5 offset:2048
 ds_read_b128 a[172:175], v6 offset:2048
M a[0:3], a[164:167], a[36:39], a[0:3]
 ds_read_b64_tr_b16 a[96:97], v1 offset:32768
 ds_read_b64_tr_b16 a[98:99], v1 offset:33792
M a[4:7], a[164:167], a[44:47], a[4:7]
 s_add_u32 m0, s24, 49152
M a[4:7], a[160:163], a[40:43], a[4:7]
 buffer_load_dwordx4 v12, s[48:51], s22 offen offset:0   lds
M a[8:11], a[160:163], a[48:51], a[8:11]
M a[8:11], a[164:167], a[52:55], a[8:11]
M a[12:15], a[164:167], a[60:63], a[12:15]
 ds_read_b64_tr_b16 a[100:101], v1 offset:40960
 ds_read_b64_tr_b16 a[102:103], v1 offset:41984
M a[12:15], a[160:163], a[56:59], a[12:15]
M a[16:19], a[160:163], a[64:67], a[16:19]
 buffer_load_dwordx4 v13, s[48:51], s22 offen offset:1024   lds
M a[16:19], a[164:167], a[68:71], a[16:19]
M a[20:23], a[164:167], a[76:79], a[20:23]
M a[20:23], a[160:163], a[72:75], a[20:23]
 ds_read_b64_tr_b16 a[104:105], v2 offset:32768
 ds_read_b64_tr_b16 a[106:107], v2 offset:33792
M a[24:27], a[160:163], a[80:83], a[24:27]
M a[24:27], a[164:167], a[84:87], a[24:27]
 s_waitcnt lgkmcnt(6)
M a[28:31], a[164:167], a[92:95], a[28:31]
 buffer_load_dwordx4 v14, s[48:51], s22 offen offset:2048   lds
M a[28:31], a[160:163], a[88:91], a[28:31]
M v[32:35], a[168:171], a[32:35], v[32:35]
 ds_read_b128 a[160:163], v5 offset:4096
 ds_read_b128 a[164:167], v6 offset:4096
M v[32:35], a[172:175], a[36:39], v[32:35]
 ds_read_b64_tr_b16 a[108:109], v2 offset:40960
 ds_read_b64_tr_b16 a[110:111], v2 offset:41984
M v[36:39], a[172:175], a[44:47], v[36:39]
 buffer_load_dwordx4 v15, s[48:51], s22 offen offset:3072   lds
M v[36:39], a[168:171], a[40:43], v[36:39]
 s_sub_u32 s22, s22, 2097024
M v[40:43], a[168:171], a[48:51], v[40:43]
M v[40:43], a[172:175], a[52:55], v[40:43]
 ds_read_b64_tr_b16 a[112:113], v3 offset:32768
 ds_read_b64_tr_b16 a[114:115], v3 offset:33792
M v[44:47], a[172:175], a[60:63], v[44:47]
 s_add_u32 m0, s23, 16384
M v[44:47], a[168:171], a[56:59], v[44:47]
 buffer_load_dwordx4 v8, s[16:19], s21 offen offset:0  nt lds
M v[48:51], a[168:171], a[64:67], v[48:51]
M v[48:51], a[172:175], a[68:71], v[48:51]
M v[52:55], a[172:175], a[76:79], v[52:55]
 ds_read_b64_tr_b16 a[116:117], v3 offset:40960
 ds_read_b64_tr_b16 a[118:119], v3 offset:41984
M v[52:55], a[168:171], a[72:75], v[52:55]
M v[56:59], a[168:171], a[80:83], v[56:59]
 buffer_load_dwordx4 v9, s[16:19], s21 offen offset:1024  nt lds
M v[56:59], a[172:175], a[84:87], v[56:59]
 s_waitcnt lgkmcnt(6)
M v[60:63], a[172:175], a[92:95], v[60:63]
M v[60:63], a[168:171], a[88:91], v[60:63]
 ds_read_b64_tr_b16 a[120:121], v4 offset:32768
 ds_read_b64_tr_b16 a[122:123], v4 offset:33792
M v[64:67], a[160:163], a[32:35], v[64:67]
 ds_read_b128 a[168:171], v5 offset:6144
 ds_read_b128 a[172:175], v6 offset:6144
M v[64:67], a[164:167], a[36:39], v[64:67]
 buffer_load_dwordx4 v10, s[16:19], s21 offen offset:2048  nt lds
M v[68:71], a[164:167], a[44:47], v[68:71]
M v[68:71], a[160:163], a[40:43], v[68:71]
M v[72:75], a[160:163], a[48:51], v[72:75]
 ds_read_b64_tr_b16 a[124:125], v4 offset:40960
 ds_read_b64_tr_b16 a[126:127], v4 offset:41984
M v[72:75], a[164:167], a[52:55], v[72:75]
M v[76:79], a[164:167], a[60:63], v[76:79]
 buffer_load_dwordx4 v11, s[16:19], s21 offen offset:3072  nt lds
M v[76:79], a[160:163], a[56:59], v[76:79]
 s_add_u32 s21, s21, 524160
M v[80:83], a[160:163], a[64:67], v[80:83]
M v[80:83], a[164:167], a[68:71], v[80:83]
M v[84:87], a[164:167], a[76:79], v[84:87]
M v[84:87], a[160:163], a[72:75], v[84:87]
M v[88:91], a[160:163], a[80:83], v[88:91]
M v[88:91], a[164:167], a[84:87], v[88:91]
 s_waitcnt lgkmcnt(2)
M v[92:95], a[164:167], a[92:95], v[92:95]
 s_waitcnt vmcnt(17) lgkmcnt(0)
M v[92:95], a[160:163], a[88:91], v[92:95]
 s_barrier
M v[96:99], a[168:171], a[32:35], v[96:99]
 ds_read_b128 a[160:163], v5 offset:16384
 ds_read_b128 a[164:167], v6 offset:16384
M v[96:99], a[172:175], a[36:39], v[96:99]
M v[100:103], a[172:175], a[44:47], v[100:103]
 s_add_u32 m0, s24, 0
 ds_read_b64_tr_b16 a[128:129], v1 offset:49152
 ds_read_b64_tr_b16 a[130:131], v1 offset:50176
M v[100:103], a[168:171], a[40:43], v[100:103]
 buffer_load_dwordx4 v12, s[48:51], s22 offen offset:0   lds
M v[104:107], a[168:171], a[48:51], v[104:107]
M v[104:107], a[172:175], a[52:55], v[104:107]
M v[108:111], a[172:175], a[60:63], v[108:111]
M v[108:111], a[168:171], a[56:59], v[108:111]
M v[112:115], a[168:171], a[64:67], v[112:115]
M v[112:115], a[172:175], a[68:71], v[112:115]
 ds_read_b64_tr_b16 a[132:133], v1 offset:57344
 ds_read_b64_tr_b16 a[134:135], v1 offset:58368
M v[116:119], a[172:175], a[76:79], v[116:119]
 buffer_load_dwordx4 v13, s[48:51], s22 offen offset:1024   lds
M v[116:119], a[168:171], a[72:75], v[116:119]
M v[120:123], a[168:171], a[80:83], v[120:123]
M v[120:123], a[172:175], a[84:87], v[120:123]
 s_waitcnt lgkmcnt(4)
M v[124:127], a[172:175], a[92:95], v[124:127]
M v[124:127], a[168:171], a[88:91], v[124:127]
 buffer_load_dwordx4 v14, s[48:51], s22 offen offset:2048   lds
M v[128:131], a[160:163], a[32:35], v[128:131]
 ds_read_b128 a[168:171], v5 offset:18432
 ds_read_b128 a[172:175], v6 offset:18432
M v[128:131], a[164:167], a[36:39], v[128:131]
 ds_read_b64_tr_b16 a[136:137], v2 offset:49152
 ds_read_b64_tr_b16 a[138:139], v2 offset:50176
M v[132:135], a[164:167], a[44:47], v[132:135]
M v[132:135], a[160:163], a[40:43], v[132:135]
M v[136:139], a[160:163], a[48:51], v[136:139]
M v[136:139], a[164:167], a[52:55], v[136:139]
M v[140:143], a[164:167], a[60:63], v[140:143]
 buffer_load_dwordx4 v15, s[48:51], s22 offen offset:3072   lds
M v[140:143], a[160:163], a[56:59], v[140:143]
 s_add_u32 s22, s22, 2097152
 ds_read_b64_tr_b16 a[140:141], v2 offset:57344
 ds_read_b64_tr_b16 a[142:143], v2 offset:58368
M v[144:147], a[160:163], a[64:67], v[144:147]
M v[144:147], a[164:167], a[68:71], v[144:147]
M v[148:151], a[164:167], a[76:79], v[148:151]
M v[148:151], a[160:163], a[72:75], v[148:151]
 s_add_u32 m0, s23, 32768
M v[152:155], a[160:163], a[80:83], v[152:155]
 buffer_load_dwordx4 v8, s[16:19], s21 offen offset:0  nt lds
M v[152:155], a[164:167], a[84:87], v[152:155]
 s_waitcnt lgkmcnt(4)
M v[156:159], a[164:167], a[92:95], v[156:159]
 ds_read_b64_tr_b16 a[144:145], v3 offset:49152
 ds_read_b64_tr_b16 a[146:147], v3 offset:50176
M v[156:159], a[160:163], a[88:91], v[156:159]
M v[160:163], a[168:171], a[32:35], v[160:163]
 ds_read_b128 a[160:163], v5 offset:20480
 ds_read_b128 a[164:167], v6 offset:20480
M v[160:163], a[172:175], a[36:39], v[160:163]
M v[164:167], a[172:175], a[44:47], v[164:167]
 buffer_load_dwordx4 v9, s[16:19], s21 offen offset:1024  nt lds
M v[164:167], a[168:171], a[40:43], v[164:167]
M v[168:171], a[168:171], a[48:51], v[168:171]
M v[168:171], a[172:175], a[52:55], v[168:171]
 ds_read_b64_tr_b16 a[148:149], v3 offset:57344
 ds_read_b64_tr_b16 a[150:151], v3 offset:58368
M v[172:175], a[172:175], a[60:63], v[172:175]
M v[172:175], a[168:171], a[56:59], v[172:175]
M v[176:179], a[168:171], a[64:67], v[176:179]
M v[176:179], a[172:175], a[68:71], v[176:179]
 buffer_load_dwordx4 v10, s[16:19], s21 offen offset:2048  nt lds
M v[180:183], a[172:175], a[76:79], v[180:183]
M v[180:183], a[168:171], a[72:75], v[180:183]
M v[184:187], a[168:171], a[80:83], v[184:187]
 ds_read_b64_tr_b16 a[152:153], v4 offset:49152
 ds_read_b64_tr_b16 a[154:155], v4 offset:50176
M v[184:187], a[172:175], a[84:87], v[184:187]
 s_waitcnt lgkmcnt(4)
M v[188:191], a[172:175], a[92:95], v[188:191]
M v[188:191], a[168:171], a[88:91], v[188:191]
 buffer_load_dwordx4 v11, s[16:19], s21 offen offset:3072  nt lds
M v[192:195], a[160:163], a[32:35], v[192:195]
 s_add_u32 s21, s21, 128
 ds_read_b128 a[168:171], v5 offset:22528
 ds_read_b128 a[172:175], v6 offset:22528
M v[192:195], a[164:167], a[36:39], v[192:195]
M v[196:199], a[164:167], a[44:47], v[196:199]
M v[196:199], a[160:163], a[40:43], v[196:199]
 ds_read_b64_tr_b16 a[156:157], v4 offset:57344
 ds_read_b64_tr_b16 a[158:159], v4 offset:58368
M v[200:203], a[160:163], a[48:51], v[200:203]
 s_add_u32 m0, s87, 4096
M v[200:203], a[164:167], a[52:55], v[200:203]
 buffer_load_dwordx4 v25, s[60:63], s89 offen offset:0 nt lds
M v[204:207], a[164:167], a[60:63], v[204:207]
 s_add_u32 s89, s89, 114688
M v[204:207], a[160:163], a[56:59], v[204:207]
M v[208:211], a[160:163], a[64:67], v[208:211]
M v[208:211], a[164:167], a[68:71], v[208:211]
M v[212:215], a[164:167], a[76:79], v[212:215]
M v[212:215], a[160:163], a[72:75], v[212:215]
M v[216:219], a[160:163], a[80:83], v[216:219]
M v[216:219], a[164:167], a[84:87], v[216:219]
 s_waitcnt lgkmcnt(2)
M v[220:223], a[164:167], a[92:95], v[220:223]
 s_waitcnt vmcnt(18) lgkmcnt(0)
M v[220:223], a[160:163], a[88:91], v[220:223]
 s_barrier
M v[224:227], a[168:171], a[32:35], v[224:227]
 ds_read_b128 a[160:163], v5 offset:32768
 ds_read_b128 a[164:167], v6 offset:32768
M v[224:227], a[172:175], a[36:39], v[224:227]
 v_and_b32 v26, 48, v0
 v_lshlrev_b32 v26, 17, v26
M v[228:231], a[172:175], a[44:47], v[228:231]
 v_or_b32 v26, v26, v0
 v_lshl_add_u32 v26, v26, 7, s95
M v[228:231], a[168:171], a[40:43], v[228:231]
 buffer_load_dword a240, v26, s[76:79], 0 offen offset:0
M v[232:235], a[168:171], a[48:51], v[232:235]
M v[232:235], a[172:175], a[52:55], v[232:235]
M v[236:239], a[172:175], a[60:63], v[236:239]
M v[236:239], a[168:171], a[56:59], v[236:239]
M v[240:243], a[168:171], a[64:67], v[240:243]
M v[240:243], a[172:175], a[68:71], v[240:243]
M v[244:247], a[172:175], a[76:79], v[244:247]
M v[244:247], a[168:171], a[72:75], v[244:247]
M v[248:251], a[168:171], a[80:83], v[248:251]
M v[248:251], a[172:175], a[84:87], v[248:251]
 s_waitcnt lgkmcnt(0)
M v[252:255], a[172:175], a[92:95], v[252:255]
M v[252:255], a[168:171], a[88:91], v[252:255]
M a[0:3], a[160:163], a[96:99], a[0:3]
 ds_read_b128 a[168:171], v5 offset:34816
 ds_read_b128 a[172:175], v6 offset:34816
M a[0:3], a[164:167], a[100:103], a[0:3]
 ds_read_b64_tr_b16 a[32:33], v1 offset:0
 ds_read_b64_tr_b16 a[34:35], v1 offset:1024
M a[4:7], a[164:167], a[108:111], a[4:7]
 s_add_u32 m0, s24, 16384
M a[4:7], a[160:163], a[104:107], a[4:7]
 buffer_load_dwordx4 v12, s[48:51], s22 offen offset:0   lds
M a[8:11], a[160:163], a[112:115], a[8:11]
M a[8:11], a[164:167], a[116:119], a[8:11]
 s_lshl_b32 s67, s20, 11
M a[12:15], a[164:167], a[124:127], a[12:15]
 s_add_u32 s67, s67, 104914944
 ds_read_b64_tr_b16 a[36:37], v1 offset:8192
 ds_read_b64_tr_b16 a[38:39], v1 offset:9216
M a[12:15], a[160:163], a[120:123], a[12:15]
M a[16:19], a[160:163], a[128:131], a[16:19]
 buffer_load_dwordx4 v13, s[48:51], s22 offen offset:1024   lds
M a[16:19], a[164:167], a[132:135], a[16:19]
M a[20:23], a[164:167], a[140:143], a[20:23]
 buffer_load_dwordx4 v[16:19], v7, s[8:11], s67 offen offset:0 sc1
M a[20:23], a[160:163], a[136:139], a[20:23]
 ds_read_b64_tr_b16 a[40:41], v2 offset:0
 ds_read_b64_tr_b16 a[42:43], v2 offset:1024
M a[24:27], a[160:163], a[144:147], a[24:27]
 buffer_load_dwordx4 v[20:23], v7, s[8:11], s67 offen offset:1024 sc1
M a[24:27], a[164:167], a[148:151], a[24:27]
 s_waitcnt lgkmcnt(6)
M a[28:31], a[164:167], a[156:159], a[28:31]
 buffer_load_dwordx4 v14, s[48:51], s22 offen offset:2048   lds
M a[28:31], a[160:163], a[152:155], a[28:31]
M v[32:35], a[168:171], a[96:99], v[32:35]
 ds_read_b128 a[160:163], v5 offset:36864
 ds_read_b128 a[164:167], v6 offset:36864
M v[32:35], a[172:175], a[100:103], v[32:35]
 ds_read_b64_tr_b16 a[44:45], v2 offset:8192
 ds_read_b64_tr_b16 a[46:47], v2 offset:9216
M v[36:39], a[172:175], a[108:111], v[36:39]
 buffer_load_dwordx4 v15, s[48:51], s22 offen offset:3072   lds
M v[36:39], a[168:171], a[104:107], v[36:39]
 s_sub_u32 s22, s22, 2097024
M v[40:43], a[168:171], a[112:115], v[40:43]
M v[40:43], a[172:175], a[116:119], v[40:43]
 ds_read_b64_tr_b16 a[48:49], v3 offset:0
 ds_read_b64_tr_b16 a[50:51], v3 offset:1024
M v[44:47], a[172:175], a[124:127], v[44:47]
 s_add_u32 m0, s23, 49152
M v[44:47], a[168:171], a[120:123], v[44:47]
 buffer_load_dwordx4 v8, s[16:19], s21 offen offset:0  nt lds
M v[48:51], a[168:171], a[128:131], v[48:51]
M v[48:51], a[172:175], a[132:135], v[48:51]
M v[52:55], a[172:175], a[140:143], v[52:55]
 ds_read_b64_tr_b16 a[52:53], v3 offset:8192
 ds_read_b64_tr_b16 a[54:55], v3 offset:9216
M v[52:55], a[168:171], a[136:139], v[52:55]
M v[56:59], a[168:171], a[144:147], v[56:59]
 buffer_load_dwordx4 v9, s[16:19], s21 offen offset:1024  nt lds
M v[56:59], a[172:175], a[148:151], v[56:59]
 s_waitcnt lgkmcnt(6)
M v[60:63], a[172:175], a[156:159], v[60:63]
M v[60:63], a[168:171], a[152:155], v[60:63]
 ds_read_b64_tr_b16 a[56:57], v4 offset:0
 ds_read_b64_tr_b16 a[58:59], v4 offset:1024
M v[64:67], a[160:163], a[96:99], v[64:67]
 ds_read_b128 a[168:171], v5 offset:38912
 ds_read_b128 a[172:175], v6 offset:38912
M v[64:67], a[164:167], a[100:103], v[64:67]
 buffer_load_dwordx4 v10, s[16:19], s21 offen offset:2048  nt lds
M v[68:71], a[164:167], a[108:111], v[68:71]
M v[68:71], a[160:163], a[104:107], v[68:71]
M v[72:75], a[160:163], a[112:115], v[72:75]
 ds_read_b64_tr_b16 a[60:61], v4 offset:8192
 ds_read_b64_tr_b16 a[62:63], v4 offset:9216
M v[72:75], a[164:167], a[116:119], v[72:75]
M v[76:79], a[164:167], a[124:127], v[76:79]
 buffer_load_dwordx4 v11, s[16:19], s21 offen offset:3072  nt lds
M v[76:79], a[160:163], a[120:123], v[76:79]
 s_add_u32 s21, s21, 524160
M v[80:83], a[160:163], a[128:131], v[80:83]
M v[80:83], a[164:167], a[132:135], v[80:83]
M v[84:87], a[164:167], a[140:143], v[84:87]
M v[84:87], a[160:163], a[136:139], v[84:87]
M v[88:91], a[160:163], a[144:147], v[88:91]
M v[88:91], a[164:167], a[148:151], v[88:91]
 s_waitcnt lgkmcnt(2)
M v[92:95], a[164:167], a[156:159], v[92:95]
 s_waitcnt vmcnt(20) lgkmcnt(0)
M v[92:95], a[160:163], a[152:155], v[92:95]
 s_barrier
M v[96:99], a[168:171], a[96:99], v[96:99]
 ds_read_b128 a[160:163], v5 offset:49152
 ds_read_b128 a[164:167], v6 offset:49152
M v[96:99], a[172:175], a[100:103], v[96:99]
M v[100:103], a[172:175], a[108:111], v[100:103]
 s_add_u32 m0, s24, 32768
 ds_read_b64_tr_b16 a[64:65], v1 offset:16384
 ds_read_b64_tr_b16 a[66:67], v1 offset:17408
M v[100:103], a[168:171], a[104:107], v[100:103]
 buffer_load_dwordx4 v12, s[48:51], s22 offen offset:0   lds
M v[104:107], a[168:171], a[112:115], v[104:107]
M v[104:107], a[172:175], a[116:119], v[104:107]
M v[108:111], a[172:175], a[124:127], v[108:111]
M v[108:111], a[168:171], a[120:123], v[108:111]
M v[112:115], a[168:171], a[128:131], v[112:115]
M v[112:115], a[172:175], a[132:135], v[112:115]
 ds_read_b64_tr_b16 a[68:69], v1 offset:24576
 ds_read_b64_tr_b16 a[70:71], v1 offset:25600
M v[116:119], a[172:175], a[140:143], v[116:119]
 buffer_load_dwordx4 v13, s[48:51], s22 offen offset:1024   lds
M v[116:119], a[168:171], a[136:139], v[116:119]
M v[120:123], a[168:171], a[144:147], v[120:123]
M v[120:123], a[172:175], a[148:151], v[120:123]
 s_waitcnt lgkmcnt(4)
M v[124:127], a[172:175], a[156:159], v[124:127]
M v[124:127], a[168:171], a[152:155], v[124:127]
 buffer_load_dwordx4 v14, s[48:51], s22 offen offset:2048   lds
M v[128:131], a[160:163], a[96:99], v[128:131]
 ds_read_b128 a[168:171], v5 offset:51200
 ds_read_b128 a[172:175], v6 offset:51200
M v[128:131], a[164:167], a[100:103], v[128:131]
 ds_read_b64_tr_b16 a[72:73], v2 offset:16384
 ds_read_b64_tr_b16 a[74:75], v2 offset:17408
M v[132:135], a[164:167], a[108:111], v[132:135]
M v[132:135], a[160:163], a[104:107], v[132:135]
M v[136:139], a[160:163], a[112:115], v[136:139]
M v[136:139], a[164:167], a[116:119], v[136:139]
M v[140:143], a[164:167], a[124:127], v[140:143]
 buffer_load_dwordx4 v15, s[48:51], s22 offen offset:3072   lds
M v[140:143], a[160:163], a[120:123], v[140:143]
 s_add_u32 s22, s22, 2097152
 ds_read_b64_tr_b16 a[76:77], v2 offset:24576
 ds_read_b64_tr_b16 a[78:79], v2 offset:25600
M v[144:147], a[160:163], a[128:131], v[144:147]
M v[144:147], a[164:167], a[132:135], v[144:147]
M v[148:151], a[164:167], a[140:143], v[148:151]
M v[148:151], a[160:163], a[136:139], v[148:151]
 s_add_u32 m0, s23, 0
M v[152:155], a[160:163], a[144:147], v[152:155]
 buffer_load_dwordx4 v8, s[16:19], s21 offen offset:0  nt lds
M v[152:155], a[164:167], a[148:151], v[152:155]
 s_waitcnt lgkmcnt(4)
M v[156:159], a[164:167], a[156:159], v[156:159]
 ds_read_b64_tr_b16 a[80:81], v3 offset:16384
 ds_read_b64_tr_b16 a[82:83], v3 offset:17408
M v[156:159], a[160:163], a[152:155], v[156:159]
M v[160:163], a[168:171], a[96:99], v[160:163]
 ds_read_b128 a[160:163], v5 offset:53248
 ds_read_b128 a[164:167], v6 offset:53248
M v[160:163], a[172:175], a[100:103], v[160:163]
M v[164:167], a[172:175], a[108:111], v[164:167]
 buffer_load_dwordx4 v9, s[16:19], s21 offen offset:1024  nt lds
M v[164:167], a[168:171], a[104:107], v[164:167]
M v[168:171], a[168:171], a[112:115], v[168:171]
M v[168:171], a[172:175], a[116:119], v[168:171]
 ds_read_b64_tr_b16 a[84:85], v3 offset:24576
 ds_read_b64_tr_b16 a[86:87], v3 offset:25600
M v[172:175], a[172:175], a[124:127], v[172:175]
M v[172:175], a[168:171], a[120:123], v[172:175]
M v[176:179], a[168:171], a[128:131], v[176:179]
M v[176:179], a[172:175], a[132:135], v[176:179]
 buffer_load_dwordx4 v10, s[16:19], s21 offen offset:2048  nt lds
M v[180:183], a[172:175], a[140:143], v[180:183]
M v[180:183], a[168:171], a[136:139], v[180:183]
M v[184:187], a[168:171], a[144:147], v[184:187]
 ds_read_b64_tr_b16 a[88:89], v4 offset:16384
 ds_read_b64_tr_b16 a[90:91], v4 offset:17408
M v[184:187], a[172:175], a[148:151], v[184:187]
 s_waitcnt lgkmcnt(4)
M v[188:191], a[172:175], a[156:159], v[188:191]
M v[188:191], a[168:171], a[152:155], v[188:191]
 buffer_load_dwordx4 v11, s[16:19], s21 offen offset:3072  nt lds
M v[192:195], a[160:163], a[96:99], v[192:195]
 s_add_u32 s21, s21, 128
 ds_read_b128 a[168:171], v5 offset:55296
 ds_read_b128 a[172:175], v6 offset:55296
M v[192:195], a[164:167], a[100:103], v[192:195]
M v[196:199], a[164:167], a[108:111], v[196:199]
M v[196:199], a[160:163], a[104:107], v[196:199]
 ds_read_b64_tr_b16 a[92:93], v4 offset:24576
 ds_read_b64_tr_b16 a[94:95], v4 offset:25600
M v[200:203], a[160:163], a[112:115], v[200:203]
 s_add_u32 m0, s87, 5120
M v[200:203], a[164:167], a[116:119], v[200:203]
 buffer_load_dwordx4 v25, s[60:63], s89 offen offset:0 nt lds
M v[204:207], a[164:167], a[124:127], v[204:207]
 s_add_u32 s89, s89, 114688
M v[204:207], a[160:163], a[120:123], v[204:207]
M v[208:211], a[160:163], a[128:131], v[208:211]
M v[208:211], a[164:167], a[132:135], v[208:211]
M v[212:215], a[164:167], a[140:143], v[212:215]
M v[212:215], a[160:163], a[136:139], v[212:215]
M v[216:219], a[160:163], a[144:147], v[216:219]
M v[216:219], a[164:167], a[148:151], v[216:219]
 s_waitcnt lgkmcnt(2)
M v[220:223], a[164:167], a[156:159], v[220:223]
 s_waitcnt vmcnt(21) lgkmcnt(0)
M v[220:223], a[160:163], a[152:155], v[220:223]
 s_barrier
M v[224:227], a[168:171], a[96:99], v[224:227]
 ds_read_b128 a[160:163], v5 offset:0
 ds_read_b128 a[164:167], v6 offset:0
M v[224:227], a[172:175], a[100:103], v[224:227]
M v[228:231], a[172:175], a[108:111], v[228:231]
M v[228:231], a[168:171], a[104:107], v[228:231]
M v[232:235], a[168:171], a[112:115], v[232:235]
M v[232:235], a[172:175], a[116:119], v[232:235]
M v[236:239], a[172:175], a[124:127], v[236:239]
M v[236:239], a[168:171], a[120:123], v[236:239]
M v[240:243], a[168:171], a[128:131], v[240:243]
M v[240:243], a[172:175], a[132:135], v[240:243]
M v[244:247], a[172:175], a[140:143], v[244:247]
M v[244:247], a[168:171], a[136:139], v[244:247]
M v[248:251], a[168:171], a[144:147], v[248:251]
M v[248:251], a[172:175], a[148:151], v[248:251]
 s_waitcnt lgkmcnt(0)
M v[252:255], a[172:175], a[156:159], v[252:255]
M v[252:255], a[168:171], a[152:155], v[252:255]
M a[0:3], a[160:163], a[32:35], a[0:3]
 ds_read_b128 a[168:171], v5 offset:2048
 ds_read_b128 a[172:175], v6 offset:2048
M a[0:3], a[164:167], a[36:39], a[0:3]
 ds_read_b64_tr_b16 a[96:97], v1 offset:32768
 ds_read_b64_tr_b16 a[98:99], v1 offset:33792
M a[4:7], a[164:167], a[44:47], a[4:7]
 s_add_u32 m0, s24, 49152
M a[4:7], a[160:163], a[40:43], a[4:7]
 buffer_load_dwordx4 v12, s[48:51], s22 offen offset:0   lds
M a[8:11], a[160:163], a[48:51], a[8:11]
M a[8:11], a[164:167], a[52:55], a[8:11]
M a[12:15], a[164:167], a[60:63], a[12:15]
 ds_read_b64_tr_b16 a[100:101], v1 offset:40960
 ds_read_b64_tr_b16 a[102:103], v1 offset:41984
M a[12:15], a[160:163], a[56:59], a[12:15]
M a[16:19], a[160:163], a[64:67], a[16:19]
 buffer_load_dwordx4 v13, s[48:51], s22 offen offset:1024   lds
M a[16:19], a[164:167], a[68:71], a[16:19]
M a[20:23], a[164:167], a[76:79], a[20:23]
 s_waitcnt vmcnt(18)
 v_min3_u32 v28, v16, v17, v18
M a[20:23], a[160:163], a[72:75], a[20:23]
 ds_read_b64_tr_b16 a[104:105], v2 offset:32768
 ds_read_b64_tr_b16 a[106:107], v2 offset:33792
M a[24:27], a[160:163], a[80:83], a[24:27]
 s_waitcnt vmcnt(17)
 v_min3_u32 v28, v28, v19, v20
M a[24:27], a[164:167], a[84:87], a[24:27]
 s_waitcnt lgkmcnt(6)
 v_min3_u32 v28, v28, v21, v22
M a[28:31], a[164:167], a[92:95], a[28:31]
 buffer_load_dwordx4 v14, s[48:51], s22 offen offset:2048   lds
M a[28:31], a[160:163], a[88:91], a[28:31]
 v_min_u32 v28, v28, v23
M v[32:35], a[168:171], a[32:35], v[32:35]
 ds_read_b128 a[160:163], v5 offset:4096
 ds_read_b128 a[164:167], v6 offset:4096
M v[32:35], a[172:175], a[36:39], v[32:35]
 ds_read_b64_tr_b16 a[108:109], v2 offset:40960
 ds_read_b64_tr_b16 a[110:111], v2 offset:41984
M v[36:39], a[172:175], a[44:47], v[36:39]
 buffer_load_dwordx4 v15, s[48:51], s22 offen offset:3072   lds
M v[36:39], a[168:171], a[40:43], v[36:39]
 s_sub_u32 s22, s22, 2097024
 v_cmp_eq_u32 vcc, 0, v28
M v[40:43], a[168:171], a[48:51], v[40:43]
 s_nop 0
M v[40:43], a[172:175], a[52:55], v[40:43]
 s_cbranch_vccnz L_hs
L_hr:
 ds_read_b64_tr_b16 a[112:113], v3 offset:32768
 ds_read_b64_tr_b16 a[114:115], v3 offset:33792
M v[44:47], a[172:175], a[60:63], v[44:47]
 s_add_u32 m0, s23, 16384
 v_max_u32 v28, v16, v17
M v[44:47], a[168:171], a[56:59], v[44:47]
 buffer_load_dwordx4 v8, s[16:19], s21 offen offset:0  nt lds
M v[48:51], a[168:171], a[64:67], v[48:51]
 v_min_u32 v29, v16, v17
M v[48:51], a[172:175], a[68:71], v[48:51]
 v_med3_u32 v29, v28, v29, v18
M v[52:55], a[172:175], a[76:79], v[52:55]
 ds_read_b64_tr_b16 a[116:117], v3 offset:40960
 ds_read_b64_tr_b16 a[118:119], v3 offset:41984
M v[52:55], a[168:171], a[72:75], v[52:55]
 v_max_u32 v28, v28, v18
M v[56:59], a[168:171], a[80:83], v[56:59]
 buffer_load_dwordx4 v9, s[16:19], s21 offen offset:1024  nt lds
M v[56:59], a[172:175], a[84:87], v[56:59]
 s_waitcnt lgkmcnt(6)
 v_med3_u32 v29, v28, v29, v19
M v[60:63], a[172:175], a[92:95], v[60:63]
 v_max_u32 v28, v28, v19
M v[60:63], a[168:171], a[88:91], v[60:63]
 ds_read_b64_tr_b16 a[120:121], v4 offset:32768
 ds_read_b64_tr_b16 a[122:123], v4 offset:33792
M v[64:67], a[160:163], a[32:35], v[64:67]
 ds_read_b128 a[168:171], v5 offset:6144
 ds_read_b128 a[172:175], v6 offset:6144
M v[64:67], a[164:167], a[36:39], v[64:67]
 buffer_load_dwordx4 v10, s[16:19], s21 offen offset:2048  nt lds
M v[68:71], a[164:167], a[44:47], v[68:71]
 v_med3_u32 v29, v28, v29, v20
M v[68:71], a[160:163], a[40:43], v[68:71]
 v_max_u32 v28, v28, v20
M v[72:75], a[160:163], a[48:51], v[72:75]
 ds_read_b64_tr_b16 a[124:125], v4 offset:40960
 ds_read_b64_tr_b16 a[126:127], v4 offset:41984
M v[72:75], a[164:167], a[52:55], v[72:75]
 v_med3_u32 v29, v28, v29, v21
M v[76:79], a[164:167], a[60:63], v[76:79]
 buffer_load_dwordx4 v11, s[16:19], s21 offen offset:3072  nt lds
M v[76:79], a[160:163], a[56:59], v[76:79]
 s_add_u32 s21, s21, 524160
 v_max_u32 v28, v28, v21
M v[80:83], a[160:163], a[64:67], v[80:83]
 v_med3_u32 v29, v28, v29, v22
M v[80:83], a[164:167], a[68:71], v[80:83]
 v_max_u32 v28, v28, v22
M v[84:87], a[164:167], a[76:79], v[84:87]
 v_med3_u32 v29, v28, v29, v23
M v[84:87], a[160:163], a[72:75], v[84:87]
 v_max_u32 v28, v28, v23
M v[88:91], a[160:163], a[80:83], v[88:91]
 s_nop 0
 v_mov_b32 v30, v28 row_ror:8 row_mask:0xf bank_mask:0xf
M v[88:91], a[164:167], a[84:87], v[88:91]
 s_waitcnt lgkmcnt(2)
 v_mov_b32 v31, v29 row_ror:8 row_mask:0xf bank_mask:0xf
M v[92:95], a[164:167], a[92:95], v[92:95]
 s_waitcnt vmcnt(17) lgkmcnt(0)
 v_min_u32 v16, v28, v30
M v[92:95], a[160:163], a[88:91], v[92:95]
 s_barrier
M v[96:99], a[168:171], a[32:35], v[96:99]
 ds_read_b128 a[160:163], v5 offset:16384
 ds_read_b128 a[164:167], v6 offset:16384
M v[96:99], a[172:175], a[36:39], v[96:99]
 v_max_u32 v28, v28, v30
M v[100:103], a[172:175], a[44:47], v[100:103]
 s_add_u32 m0, s24, 0
 ds_read_b64_tr_b16 a[128:129], v1 offset:49152
 ds_read_b64_tr_b16 a[130:131], v1 offset:50176
M v[100:103], a[168:171], a[40:43], v[100:103]
 buffer_load_dwordx4 v12, s[48:51], s22 offen offset:0   lds
M v[104:107], a[168:171], a[48:51], v[104:107]
 v_max3_u32 v29, v29, v31, v16
M v[104:107], a[172:175], a[52:55], v[104:107]
 v_mov_b32 v30, v28 row_ror:4 row_mask:0xf bank_mask:0xf
M v[108:111], a[172:175], a[60:63], v[108:111]
 v_mov_b32 v31, v29 row_ror:4 row_mask:0xf bank_mask:0xf
M v[108:111], a[168:171], a[56:59], v[108:111]
 v_min_u32 v16, v28, v30
M v[112:115], a[168:171], a[64:67], v[112:115]
 v_max_u32 v28, v28, v30
M v[112:115], a[172:175], a[68:71], v[112:115]
 ds_read_b64_tr_b16 a[132:133], v1 offset:57344
 ds_read_b64_tr_b16 a[134:135], v1 offset:58368
M v[116:119], a[172:175], a[76:79], v[116:119]
 buffer_load_dwordx4 v13, s[48:51], s22 offen offset:1024   lds
M v[116:119], a[168:171], a[72:75], v[116:119]
 v_max3_u32 v29, v29, v31, v16
M v[120:123], a[168:171], a[80:83], v[120:123]
 v_mov_b32 v30, v28 row_ror:2 row_mask:0xf bank_mask:0xf
M v[120:123], a[172:175], a[84:87], v[120:123]
 s_waitcnt lgkmcnt(4)
 v_mov_b32 v31, v29 row_ror:2 row_mask:0xf bank_mask:0xf
M v[124:127], a[172:175], a[92:95], v[124:127]
 v_min_u32 v16, v28, v30
M v[124:127], a[168:171], a[88:91], v[124:127]
 buffer_load_dwordx4 v14, s[48:51], s22 offen offset:2048   lds
M v[128:131], a[160:163], a[32:35], v[128:131]
 ds_read_b128 a[168:171], v5 offset:18432
 ds_read_b128 a[172:175], v6 offset:18432
M v[128:131], a[164:167], a[36:39], v[128:131]
 ds_read_b64_tr_b16 a[136:137], v2 offset:49152
 ds_read_b64_tr_b16 a[138:139], v2 offset:50176
M v[132:135], a[164:167], a[44:47], v[132:135]
 v_max_u32 v28, v28, v30
M v[132:135], a[160:163], a[40:43], v[132:135]
 v_max3_u32 v29, v29, v31, v16
M v[136:139], a[160:163], a[48:51], v[136:139]
 v_mov_b32 v30, v28 row_ror:1 row_mask:0xf bank_mask:0xf
M v[136:139], a[164:167], a[52:55], v[136:139]
 v_mov_b32 v31, v29 row_ror:1 row_mask:0xf bank_mask:0xf
M v[140:143], a[164:167], a[60:63], v[140:143]
 buffer_load_dwordx4 v15, s[48:51], s22 offen offset:3072   lds
M v[140:143], a[160:163], a[56:59], v[140:143]
 s_add_u32 s22, s22, 2097152
 ds_read_b64_tr_b16 a[140:141], v2 offset:57344
 ds_read_b64_tr_b16 a[142:143], v2 offset:58368
M v[144:147], a[160:163], a[64:67], v[144:147]
 v_min_u32 v16, v28, v30
M v[144:147], a[164:167], a[68:71], v[144:147]
 v_max_u32 v28, v28, v30
M v[148:151], a[164:167], a[76:79], v[148:151]
 v_max3_u32 v29, v29, v31, v16
M v[148:151], a[160:163], a[72:75], v[148:151]
 s_add_u32 m0, s23, 32768
 v_mov_b32 v30, v28
M v[152:155], a[160:163], a[80:83], v[152:155]
 buffer_load_dwordx4 v8, s[16:19], s21 offen offset:0  nt lds
M v[152:155], a[164:167], a[84:87], v[152:155]
 s_waitcnt lgkmcnt(4)
 v_mov_b32 v31, v29
M v[156:159], a[164:167], a[92:95], v[156:159]
 ds_read_b64_tr_b16 a[144:145], v3 offset:49152
 ds_read_b64_tr_b16 a[146:147], v3 offset:50176
M v[156:159], a[160:163], a[88:91], v[156:159]
 v_permlane16_swap_b32 v30, v28
M v[160:163], a[168:171], a[32:35], v[160:163]
 ds_read_b128 a[160:163], v5 offset:20480
 ds_read_b128 a[164:167], v6 offset:20480
M v[160:163], a[172:175], a[36:39], v[160:163]
 v_permlane16_swap_b32 v31, v29
M v[164:167], a[172:175], a[44:47], v[164:167]
 buffer_load_dwordx4 v9, s[16:19], s21 offen offset:1024  nt lds
M v[164:167], a[168:171], a[40:43], v[164:167]
 v_min_u32 v16, v28, v30
M v[168:171], a[168:171], a[48:51], v[168:171]
 v_max_u32 v28, v28, v30
M v[168:171], a[172:175], a[52:55], v[168:171]
 ds_read_b64_tr_b16 a[148:149], v3 offset:57344
 ds_read_b64_tr_b16 a[150:151], v3 offset:58368
M v[172:175], a[172:175], a[60:63], v[172:175]
 v_max3_u32 v29, v29, v31, v16
M v[172:175], a[168:171], a[56:59], v[172:175]
 v_mov_b32 v30, v28
M v[176:179], a[168:171], a[64:67], v[176:179]
 v_mov_b32 v31, v29
M v[176:179], a[172:175], a[68:71], v[176:179]
 buffer_load_dwordx4 v10, s[16:19], s21 offen offset:2048  nt lds
M v[180:183], a[172:175], a[76:79], v[180:183]
 v_permlane32_swap_b32 v30, v28
M v[180:183], a[168:171], a[72:75], v[180:183]
 v_permlane32_swap_b32 v31, v29
M v[184:187], a[168:171], a[80:83], v[184:187]
 ds_read_b64_tr_b16 a[152:153], v4 offset:49152
 ds_read_b64_tr_b16 a[154:155], v4 offset:50176
M v[184:187], a[172:175], a[84:87], v[184:187]
 s_waitcnt lgkmcnt(4)
 v_min_u32 v16, v28, v30
M v[188:191], a[172:175], a[92:95], v[188:191]
 v_max_u32 v28, v28, v30
M v[188:191], a[168:171], a[88:91], v[188:191]
 buffer_load_dwordx4 v11, s[16:19], s21 offen offset:3072  nt lds
M v[192:195], a[160:163], a[32:35], v[192:195]
 s_add_u32 s21, s21, 128
 ds_read_b128 a[168:171], v5 offset:22528
 ds_read_b128 a[172:175], v6 offset:22528
M v[192:195], a[164:167], a[36:39], v[192:195]
 v_max3_u32 v29, v29, v31, v16
M v[196:199], a[164:167], a[44:47], v[196:199]
 s_lshl_b32 s64, s20, 3
M v[196:199], a[160:163], a[40:43], v[196:199]
 s_add_u32 s64, s64, 159744
 ds_read_b64_tr_b16 a[156:157], v4 offset:57344
 ds_read_b64_tr_b16 a[158:159], v4 offset:58368
M v[200:203], a[160:163], a[48:51], v[200:203]
 s_add_u32 m0, s87, 6144
 v_mov_b32 v16, s64
M v[200:203], a[164:167], a[52:55], v[200:203]
 buffer_load_dwordx4 v25, s[60:63], s89 offen offset:0 nt lds
M v[204:207], a[164:167], a[60:63], v[204:207]
 s_add_u32 s89, s89, 114688
 ds_write_b64 v16, v[28:29]
M v[204:207], a[160:163], a[56:59], v[204:207]
M v[208:211], a[160:163], a[64:67], v[208:211]
M v[208:211], a[164:167], a[68:71], v[208:211]
M v[212:215], a[164:167], a[76:79], v[212:215]
M v[212:215], a[160:163], a[72:75], v[212:215]
M v[216:219], a[160:163], a[80:83], v[216:219]
M v[216:219], a[164:167], a[84:87], v[216:219]
 s_waitcnt lgkmcnt(3)
M v[220:223], a[164:167], a[92:95], v[220:223]
 s_waitcnt vmcnt(18) lgkmcnt(0)
M v[220:223], a[160:163], a[88:91], v[220:223]
 s_barrier
M v[224:227], a[168:171], a[32:35], v[224:227]
 ds_read_b128 a[160:163], v5 offset:32768
 ds_read_b128 a[164:167], v6 offset:32768
M v[224:227], a[172:175], a[36:39], v[224:227]
 buffer_load_dword a240, v24, s[32:35], 0 offen offset:1536
M v[228:231], a[172:175], a[44:47], v[228:231]
M v[228:231], a[168:171], a[40:43], v[228:231]
M v[232:235], a[168:171], a[48:51], v[232:235]
M v[232:235], a[172:175], a[52:55], v[232:235]
M v[236:239], a[172:175], a[60:63], v[236:239]
M v[236:239], a[168:171], a[56:59], v[236:239]
M v[240:243], a[168:171], a[64:67], v[240:243]
M v[240:243], a[172:175], a[68:71], v[240:243]
M v[244:247], a[172:175], a[76:79], v[244:247]
M v[244:247], a[168:171], a[72:75], v[244:247]
M v[248:251], a[168:171], a[80:83], v[248:251]
M v[248:251], a[172:175], a[84:87], v[248:251]
 s_waitcnt lgkmcnt(0)
M v[252:255], a[172:175], a[92:95], v[252:255]
M v[252:255], a[168:171], a[88:91], v[252:255]
M a[0:3], a[160:163], a[96:99], a[0:3]
 ds_read_b128 a[168:171], v5 offset:34816
 ds_read_b128 a[172:175], v6 offset:34816
M a[0:3], a[164:167], a[100:103], a[0:3]
 ds_read_b64_tr_b16 a[32:33], v1 offset:0
 ds_read_b64_tr_b16 a[34:35], v1 offset:1024
M a[4:7], a[164:167], a[108:111], a[4:7]
 s_add_u32 m0, s24, 16384
M a[4:7], a[160:163], a[104:107], a[4:7]
 buffer_load_dwordx4 v12, s[48:51], s22 offen offset:0   lds
M a[8:11], a[160:163], a[112:115], a[8:11]
 v_mov_b32 v28, 159744
M a[8:11], a[164:167], a[116:119], a[8:11]
 ds_read_b128 v[16:19], v28
M a[12:15], a[164:167], a[124:127], a[12:15]
 ds_read_b64_tr_b16 a[36:37], v1 offset:8192
 ds_read_b64_tr_b16 a[38:39], v1 offset:9216
M a[12:15], a[160:163], a[120:123], a[12:15]
 ds_read_b128 v[20:23], v28 offset:16
M a[16:19], a[160:163], a[128:131], a[16:19]
 buffer_load_dwordx4 v13, s[48:51], s22 offen offset:1024   lds
M a[16:19], a[164:167], a[132:135], a[16:19]
M a[20:23], a[164:167], a[140:143], a[20:23]
M a[20:23], a[160:163], a[136:139], a[20:23]
 ds_read_b64_tr_b16 a[40:41], v2 offset:0
 ds_read_b64_tr_b16 a[42:43], v2 offset:1024
M a[24:27], a[160:163], a[144:147], a[24:27]
M a[24:27], a[164:167], a[148:151], a[24:27]
 s_waitcnt lgkmcnt(8)
M a[28:31], a[164:167], a[156:159], a[28:31]
 buffer_load_dwordx4 v14, s[48:51], s22 offen offset:2048   lds
M a[28:31], a[160:163], a[152:155], a[28:31]
M v[32:35], a[168:171], a[96:99], v[32:35]
 ds_read_b128 a[160:163], v5 offset:36864
 ds_read_b128 a[164:167], v6 offset:36864
M v[32:35], a[172:175], a[100:103], v[32:35]
 ds_read_b64_tr_b16 a[44:45], v2 offset:8192
 ds_read_b64_tr_b16 a[46:47], v2 offset:9216
M v[36:39], a[172:175], a[108:111], v[36:39]
 buffer_load_dwordx4 v15, s[48:51], s22 offen offset:3072   lds
M v[36:39], a[168:171], a[104:107], v[36:39]
 s_sub_u32 s22, s22, 2097024
 s_waitcnt lgkmcnt(9)
 v_min_u32 v28, v16, v18
M v[40:43], a[168:171], a[112:115], v[40:43]
 v_max_u32 v16, v16, v18
M v[40:43], a[172:175], a[116:119], v[40:43]
 ds_read_b64_tr_b16 a[48:49], v3 offset:0
 ds_read_b64_tr_b16 a[50:51], v3 offset:1024
M v[44:47], a[172:175], a[124:127], v[44:47]
 s_add_u32 m0, s23, 49152
 v_max3_u32 v17, v17, v19, v28
M v[44:47], a[168:171], a[120:123], v[44:47]
 buffer_load_dwordx4 v8, s[16:19], s21 offen offset:0  nt lds
M v[48:51], a[168:171], a[128:131], v[48:51]
 s_waitcnt lgkmcnt(8)
 v_min_u32 v29, v20, v22
M v[48:51], a[172:175], a[132:135], v[48:51]
 v_max_u32 v20, v20, v22
M v[52:55], a[172:175], a[140:143], v[52:55]
 ds_read_b64_tr_b16 a[52:53], v3 offset:8192
 ds_read_b64_tr_b16 a[54:55], v3 offset:9216
M v[52:55], a[168:171], a[136:139], v[52:55]
 v_max3_u32 v21, v21, v23, v29
M v[56:59], a[168:171], a[144:147], v[56:59]
 buffer_load_dwordx4 v9, s[16:19], s21 offen offset:1024  nt lds
M v[56:59], a[172:175], a[148:151], v[56:59]
 s_waitcnt lgkmcnt(6)
 v_min_u32 v28, v16, v20
M v[60:63], a[172:175], a[156:159], v[60:63]
 v_max_u32 v16, v16, v20
M v[60:63], a[168:171], a[152:155], v[60:63]
 ds_read_b64_tr_b16 a[56:57], v4 offset:0
 ds_read_b64_tr_b16 a[58:59], v4 offset:1024
M v[64:67], a[160:163], a[96:99], v[64:67]
 ds_read_b128 a[168:171], v5 offset:38912
 ds_read_b128 a[172:175], v6 offset:38912
M v[64:67], a[164:167], a[100:103], v[64:67]
 buffer_load_dwordx4 v10, s[16:19], s21 offen offset:2048  nt lds
M v[68:71], a[164:167], a[108:111], v[68:71]
 v_max3_u32 v17, v17, v21, v28
M v[68:71], a[160:163], a[104:107], v[68:71]
 v_and_b32 v28, 1, v0
M v[72:75], a[160:163], a[112:115], v[72:75]
 ds_read_b64_tr_b16 a[60:61], v4 offset:8192
 ds_read_b64_tr_b16 a[62:63], v4 offset:9216
M v[72:75], a[164:167], a[116:119], v[72:75]
 v_cmp_eq_u32 vcc, 0, v28
M v[76:79], a[164:167], a[124:127], v[76:79]
 buffer_load_dwordx4 v11, s[16:19], s21 offen offset:3072  nt lds
M v[76:79], a[160:163], a[120:123], v[76:79]
 s_add_u32 s21, s21, 524160
 s_and_b32 s64, s20, 1
M v[80:83], a[160:163], a[128:131], v[80:83]
 s_mul_i32 s64, s64, 448
 v_cndmask_b32 v24, v17, v16, vcc
M v[80:83], a[164:167], a[132:135], v[80:83]
 v_and_b32 v24, 0x7ff, v24
M v[84:87], a[164:167], a[140:143], v[84:87]
 v_sub_u32 v24, 2047, v24
M v[84:87], a[160:163], a[136:139], v[84:87]
 v_mul_u32_u24 v28, 896, v24
M v[88:91], a[160:163], a[144:147], v[88:91]
 v_lshrrev_b32 v29, 4, v0
M v[88:91], a[164:167], a[148:151], v[88:91]
 s_waitcnt lgkmcnt(2)
 v_lshl_add_u32 v28, v29, 4, v28
M v[92:95], a[164:167], a[156:159], v[92:95]
 s_waitcnt vmcnt(18) lgkmcnt(0)
 v_bfe_u32 v30, v0, 1, 3
M v[92:95], a[160:163], a[152:155], v[92:95]
 s_barrier
M v[96:99], a[168:171], a[96:99], v[96:99]
 ds_read_b128 a[160:163], v5 offset:49152
 ds_read_b128 a[164:167], v6 offset:49152
M v[96:99], a[172:175], a[100:103], v[96:99]
 v_lshl_or_b32 v28, v30, 26, v28
M v[100:103], a[172:175], a[108:111], v[100:103]
 s_add_u32 m0, s24, 32768
 ds_read_b64_tr_b16 a[64:65], v1 offset:16384
 ds_read_b64_tr_b16 a[66:67], v1 offset:17408
M v[100:103], a[168:171], a[104:107], v[100:103]
 buffer_load_dwordx4 v12, s[48:51], s22 offen offset:0   lds
M v[104:107], a[168:171], a[112:115], v[104:107]
M v[104:107], a[172:175], a[116:119], v[104:107]
M v[108:111], a[172:175], a[124:127], v[108:111]
 buffer_load_dwordx4 a[208:211], v28, s[56:59], s64 offen offset:0
M v[108:111], a[168:171], a[120:123], v[108:111]
M v[112:115], a[168:171], a[128:131], v[112:115]
 buffer_load_dwordx4 a[212:215], v28, s[56:59], s64 offen offset:64
M v[112:115], a[172:175], a[132:135], v[112:115]
 ds_read_b64_tr_b16 a[68:69], v1 offset:24576
 ds_read_b64_tr_b16 a[70:71], v1 offset:25600
M v[116:119], a[172:175], a[140:143], v[116:119]
 buffer_load_dwordx4 v13, s[48:51], s22 offen offset:1024   lds
M v[116:119], a[168:171], a[136:139], v[116:119]
M v[120:123], a[168:171], a[144:147], v[120:123]
M v[120:123], a[172:175], a[148:151], v[120:123]
 s_waitcnt lgkmcnt(4)
M v[124:127], a[172:175], a[156:159], v[124:127]
 buffer_load_dwordx4 a[216:219], v28, s[56:59], s64 offen offset:128
M v[124:127], a[168:171], a[152:155], v[124:127]
M v[128:131], a[160:163], a[96:99], v[128:131]
 ds_read_b128 a[168:171], v5 offset:51200
 ds_read_b128 a[172:175], v6 offset:51200
M v[128:131], a[164:167], a[100:103], v[128:131]
 ds_read_b64_tr_b16 a[72:73], v2 offset:16384
 ds_read_b64_tr_b16 a[74:75], v2 offset:17408
M v[132:135], a[164:167], a[108:111], v[132:135]
 buffer_load_dwordx4 v14, s[48:51], s22 offen offset:2048   lds
M v[132:135], a[160:163], a[104:107], v[132:135]
M v[136:139], a[160:163], a[112:115], v[136:139]
 buffer_load_dwordx4 a[220:223], v28, s[56:59], s64 offen offset:192
M v[136:139], a[164:167], a[116:119], v[136:139]
M v[140:143], a[164:167], a[124:127], v[140:143]
 buffer_load_dwordx4 a[224:227], v28, s[56:59], s64 offen offset:256
M v[140:143], a[160:163], a[120:123], v[140:143]
 ds_read_b64_tr_b16 a[76:77], v2 offset:24576
 ds_read_b64_tr_b16 a[78:79], v2 offset:25600
M v[144:147], a[160:163], a[128:131], v[144:147]
 buffer_load_dwordx4 v15, s[48:51], s22 offen offset:3072   lds
M v[144:147], a[164:167], a[132:135], v[144:147]
 s_add_u32 s22, s22, 2097152
M v[148:151], a[164:167], a[140:143], v[148:151]
M v[148:151], a[160:163], a[136:139], v[148:151]
 buffer_load_dwordx4 a[228:231], v28, s[56:59], s64 offen offset:320
M v[152:155], a[160:163], a[144:147], v[152:155]
M v[152:155], a[164:167], a[148:151], v[152:155]
 s_waitcnt lgkmcnt(4)
M v[156:159], a[164:167], a[156:159], v[156:159]
 s_add_u32 m0, s23, 0
 ds_read_b64_tr_b16 a[80:81], v3 offset:16384
 ds_read_b64_tr_b16 a[82:83], v3 offset:17408
M v[156:159], a[160:163], a[152:155], v[156:159]
 buffer_load_dwordx4 v8, s[16:19], s21 offen offset:0  nt lds
M v[160:163], a[168:171], a[96:99], v[160:163]
 ds_read_b128 a[160:163], v5 offset:53248
 ds_read_b128 a[164:167], v6 offset:53248
M v[160:163], a[172:175], a[100:103], v[160:163]
 buffer_load_dwordx4 a[232:235], v28, s[56:59], s64 offen offset:384
M v[164:167], a[172:175], a[108:111], v[164:167]
 v_lshrrev_b32 v28, 4, v24
M v[164:167], a[168:171], a[104:107], v[164:167]
 v_lshlrev_b32 v28, 5, v28
M v[168:171], a[168:171], a[112:115], v[168:171]
 v_and_b32 v30, 15, v24
M v[168:171], a[172:175], a[116:119], v[168:171]
 ds_read_b64_tr_b16 a[84:85], v3 offset:24576
 ds_read_b64_tr_b16 a[86:87], v3 offset:25600
M v[172:175], a[172:175], a[124:127], v[172:175]
 buffer_load_dwordx4 v9, s[16:19], s21 offen offset:1024  nt lds
M v[172:175], a[168:171], a[120:123], v[172:175]
 v_add_lshl_u32 v28, v28, v30, 2
M v[176:179], a[168:171], a[128:131], v[176:179]
 v_lshrrev_b32 v30, 1, v0
M v[176:179], a[172:175], a[132:135], v[176:179]
 v_min_u32 v30, 1, v30
M v[180:183], a[172:175], a[140:143], v[180:183]
 v_lshl_or_b32 v28, v30, 29, v28
M v[180:183], a[168:171], a[136:139], v[180:183]
 s_mov_b32 s64, 104857600
M v[184:187], a[168:171], a[144:147], v[184:187]
 ds_read_b64_tr_b16 a[88:89], v4 offset:16384
 ds_read_b64_tr_b16 a[90:91], v4 offset:17408
M v[184:187], a[172:175], a[148:151], v[184:187]
 s_waitcnt lgkmcnt(4)
M v[188:191], a[172:175], a[156:159], v[188:191]
 buffer_load_dwordx4 v10, s[16:19], s21 offen offset:2048  nt lds
M v[188:191], a[168:171], a[152:155], v[188:191]
 buffer_load_dword v23, v28, s[8:11], s64 offen sc1
M v[192:195], a[160:163], a[96:99], v[192:195]
 ds_read_b128 a[168:171], v5 offset:55296
 ds_read_b128 a[172:175], v6 offset:55296
M v[192:195], a[164:167], a[100:103], v[192:195]
 v_bfe_u32 v28, v0, 2, 2
M v[196:199], a[164:167], a[108:111], v[196:199]
 v_lshl_add_u32 v28, v29, 3, v28
M v[196:199], a[160:163], a[104:107], v[196:199]
 ds_read_b64_tr_b16 a[92:93], v4 offset:24576
 ds_read_b64_tr_b16 a[94:95], v4 offset:25600
M v[200:203], a[160:163], a[112:115], v[200:203]
 buffer_load_dwordx4 v11, s[16:19], s21 offen offset:3072  nt lds
M v[200:203], a[164:167], a[116:119], v[200:203]
 s_add_u32 s21, s21, 128
 v_lshlrev_b32 v28, 5, v28
M v[204:207], a[164:167], a[124:127], v[204:207]
 v_and_b32 v30, 3, v0
M v[204:207], a[160:163], a[120:123], v[204:207]
 v_lshl_add_u32 v28, v30, 3, v28
M v[208:211], a[160:163], a[128:131], v[208:211]
 v_add_u32 v22, s87, v28
M v[208:211], a[164:167], a[132:135], v[208:211]
M v[212:215], a[164:167], a[140:143], v[212:215]
M v[212:215], a[160:163], a[136:139], v[212:215]
M v[216:219], a[160:163], a[144:147], v[216:219]
M v[216:219], a[164:167], a[148:151], v[216:219]
 s_waitcnt lgkmcnt(2)
M v[220:223], a[164:167], a[156:159], v[220:223]
 s_waitcnt vmcnt(26) lgkmcnt(0)
M v[220:223], a[160:163], a[152:155], v[220:223]
 s_barrier
M v[224:227], a[168:171], a[96:99], v[224:227]
 ds_read_b128 a[160:163], v5 offset:0
 ds_read_b128 a[164:167], v6 offset:0
M v[224:227], a[172:175], a[100:103], v[224:227]
M v[228:231], a[172:175], a[108:111], v[228:231]
M v[228:231], a[168:171], a[104:107], v[228:231]
M v[232:235], a[168:171], a[112:115], v[232:235]
M v[232:235], a[172:175], a[116:119], v[232:235]
M v[236:239], a[172:175], a[124:127], v[236:239]
M v[236:239], a[168:171], a[120:123], v[236:239]
M v[240:243], a[168:171], a[128:131], v[240:243]
M v[240:243], a[172:175], a[132:135], v[240:243]
M v[244:247], a[172:175], a[140:143], v[244:247]
M v[244:247], a[168:171], a[136:139], v[244:247]
M v[248:251], a[168:171], a[144:147], v[248:251]
M v[248:251], a[172:175], a[148:151], v[248:251]
 s_waitcnt lgkmcnt(0)
M v[252:255], a[172:175], a[156:159], v[252:255]
M v[252:255], a[168:171], a[152:155], v[252:255]
M a[0:3], a[160:163], a[32:35], a[0:3]
 ds_read_b128 a[168:171], v5 offset:2048
 ds_read_b128 a[172:175], v6 offset:2048
M a[0:3], a[164:167], a[36:39], a[0:3]
 ds_read_b64_tr_b16 a[96:97], v1 offset:32768
 ds_read_b64_tr_b16 a[98:99], v1 offset:33792
M a[4:7], a[164:167], a[44:47], a[4:7]
 s_add_u32 m0, s24, 49152
M a[4:7], a[160:163], a[40:43], a[4:7]
 buffer_load_dwordx4 v12, s[48:51], s22 offen offset:0   lds
M a[8:11], a[160:163], a[48:51], a[8:11]
M a[8:11], a[164:167], a[52:55], a[8:11]
M a[12:15], a[164:167], a[60:63], a[12:15]
 ds_read_b64_tr_b16 a[100:101], v1 offset:40960
 ds_read_b64_tr_b16 a[102:103], v1 offset:41984
M a[12:15], a[160:163], a[56:59], a[12:15]
M a[16:19], a[160:163], a[64:67], a[16:19]
 buffer_load_dwordx4 v13, s[48:51], s22 offen offset:1024   lds
M a[16:19], a[164:167], a[68:71], a[16:19]
M a[20:23], a[164:167], a[76:79], a[20:23]
M a[20:23], a[160:163], a[72:75], a[20:23]
 ds_read_b64_tr_b16 a[104:105], v2 offset:32768
 ds_read_b64_tr_b16 a[106:107], v2 offset:33792
M a[24:27], a[160:163], a[80:83], a[24:27]
M a[24:27], a[164:167], a[84:87], a[24:27]
 s_waitcnt lgkmcnt(6)
M a[28:31], a[164:167], a[92:95], a[28:31]
 buffer_load_dwordx4 v14, s[48:51], s22 offen offset:2048   lds
M a[28:31], a[160:163], a[88:91], a[28:31]
M v[32:35], a[168:171], a[32:35], v[32:35]
 ds_read_b128 a[160:163], v5 offset:4096
 ds_read_b128 a[164:167], v6 offset:4096
M v[32:35], a[172:175], a[36:39], v[32:35]
 ds_read_b64_tr_b16 a[108:109], v2 offset:40960
 ds_read_b64_tr_b16 a[110:111], v2 offset:41984
M v[36:39], a[172:175], a[44:47], v[36:39]
 buffer_load_dwordx4 v15, s[48:51], s22 offen offset:3072   lds
M v[36:39], a[168:171], a[40:43], v[36:39]
 s_sub_u32 s22, s22, 2097024
M v[40:43], a[168:171], a[48:51], v[40:43]
M v[40:43], a[172:175], a[52:55], v[40:43]
 ds_read_b64_tr_b16 a[112:113], v3 offset:32768
 ds_read_b64_tr_b16 a[114:115], v3 offset:33792
M v[44:47], a[172:175], a[60:63], v[44:47]
 s_add_u32 m0, s23, 16384
M v[44:47], a[168:171], a[56:59], v[44:47]
 buffer_load_dwordx4 v8, s[16:19], s21 offen offset:0  nt lds
M v[48:51], a[168:171], a[64:67], v[48:51]
M v[48:51], a[172:175], a[68:71], v[48:51]
M v[52:55], a[172:175], a[76:79], v[52:55]
 ds_read_b64_tr_b16 a[116:117], v3 offset:40960
 ds_read_b64_tr_b16 a[118:119], v3 offset:41984
M v[52:55], a[168:171], a[72:75], v[52:55]
M v[56:59], a[168:171], a[80:83], v[56:59]
 buffer_load_dwordx4 v9, s[16:19], s21 offen offset:1024  nt lds
M v[56:59], a[172:175], a[84:87], v[56:59]
 s_waitcnt lgkmcnt(6)
M v[60:63], a[172:175], a[92:95], v[60:63]
M v[60:63], a[168:171], a[88:91], v[60:63]
 ds_read_b64_tr_b16 a[120:121], v4 offset:32768
 ds_read_b64_tr_b16 a[122:123], v4 offset:33792
M v[64:67], a[160:163], a[32:35], v[64:67]
 ds_read_b128 a[168:171], v5 offset:6144
 ds_read_b128 a[172:175], v6 offset:6144
M v[64:67], a[164:167], a[36:39], v[64:67]
 buffer_load_dwordx4 v10, s[16:19], s21 offen offset:2048  nt lds
M v[68:71], a[164:167], a[44:47], v[68:71]
M v[68:71], a[160:163], a[40:43], v[68:71]
M v[72:75], a[160:163], a[48:51], v[72:75]
 ds_read_b64_tr_b16 a[124:125], v4 offset:40960
 ds_read_b64_tr_b16 a[126:127], v4 offset:41984
M v[72:75], a[164:167], a[52:55], v[72:75]
M v[76:79], a[164:167], a[60:63], v[76:79]
 buffer_load_dwordx4 v11, s[16:19], s21 offen offset:3072  nt lds
M v[76:79], a[160:163], a[56:59], v[76:79]
 s_add_u32 s21, s21, 524160
M v[80:83], a[160:163], a[64:67], v[80:83]
M v[80:83], a[164:167], a[68:71], v[80:83]
M v[84:87], a[164:167], a[76:79], v[84:87]
M v[84:87], a[160:163], a[72:75], v[84:87]
M v[88:91], a[160:163], a[80:83], v[88:91]
M v[88:91], a[164:167], a[84:87], v[88:91]
 s_waitcnt lgkmcnt(2)
M v[92:95], a[164:167], a[92:95], v[92:95]
 s_waitcnt vmcnt(24) lgkmcnt(0)
M v[92:95], a[160:163], a[88:91], v[92:95]
 s_barrier
M v[96:99], a[168:171], a[32:35], v[96:99]
 ds_read_b128 a[160:163], v5 offset:16384
 ds_read_b128 a[164:167], v6 offset:16384
M v[96:99], a[172:175], a[36:39], v[96:99]
M v[100:103], a[172:175], a[44:47], v[100:103]
 s_add_u32 m0, s24, 0
 ds_read_b64_tr_b16 a[128:129], v1 offset:49152
 ds_read_b64_tr_b16 a[130:131], v1 offset:50176
M v[100:103], a[168:171], a[40:43], v[100:103]
 buffer_load_dwordx4 v12, s[48:51], s22 offen offset:0   lds
M v[104:107], a[168:171], a[48:51], v[104:107]
 ds_read_b64_tr_b16 a[176:177], v22 offset:0
M v[104:107], a[172:175], a[52:55], v[104:107]
 ds_read_b64_tr_b16 a[178:179], v22 offset:128
 ds_read_b64_tr_b16 a[180:181], v22 offset:1024
M v[108:111], a[172:175], a[60:63], v[108:111]
 ds_read_b64_tr_b16 a[182:183], v22 offset:1152
M v[108:111], a[168:171], a[56:59], v[108:111]
 ds_read_b64_tr_b16 a[184:185], v22 offset:2048
 ds_read_b64_tr_b16 a[186:187], v22 offset:2176
M v[112:115], a[168:171], a[64:67], v[112:115]
 ds_read_b64_tr_b16 a[188:189], v22 offset:3072
M v[112:115], a[172:175], a[68:71], v[112:115]
 ds_read_b64_tr_b16 a[132:133], v1 offset:57344
 ds_read_b64_tr_b16 a[134:135], v1 offset:58368
M v[116:119], a[172:175], a[76:79], v[116:119]
 buffer_load_dwordx4 v13, s[48:51], s22 offen offset:1024   lds
M v[116:119], a[168:171], a[72:75], v[116:119]
 ds_read_b64_tr_b16 a[190:191], v22 offset:3200
M v[120:123], a[168:171], a[80:83], v[120:123]
M v[120:123], a[172:175], a[84:87], v[120:123]
 s_waitcnt lgkmcnt(12)
M v[124:127], a[172:175], a[92:95], v[124:127]
M v[124:127], a[168:171], a[88:91], v[124:127]
M v[128:131], a[160:163], a[32:35], v[128:131]
 ds_read_b128 a[168:171], v5 offset:18432
 ds_read_b128 a[172:175], v6 offset:18432
M v[128:131], a[164:167], a[36:39], v[128:131]
 ds_read_b64_tr_b16 a[136:137], v2 offset:49152
 ds_read_b64_tr_b16 a[138:139], v2 offset:50176
M v[132:135], a[164:167], a[44:47], v[132:135]
 buffer_load_dwordx4 v14, s[48:51], s22 offen offset:2048   lds
M v[132:135], a[160:163], a[40:43], v[132:135]
M v[136:139], a[160:163], a[48:51], v[136:139]
M v[136:139], a[164:167], a[52:55], v[136:139]
M v[140:143], a[164:167], a[60:63], v[140:143]
M v[140:143], a[160:163], a[56:59], v[140:143]
 ds_read_b64_tr_b16 a[140:141], v2 offset:57344
 ds_read_b64_tr_b16 a[142:143], v2 offset:58368
M v[144:147], a[160:163], a[64:67], v[144:147]
 buffer_load_dwordx4 v15, s[48:51], s22 offen offset:3072   lds
M v[144:147], a[164:167], a[68:71], v[144:147]
 s_add_u32 s22, s22, 2097152
M v[148:151], a[164:167], a[76:79], v[148:151]
M v[148:151], a[160:163], a[72:75], v[148:151]
M v[152:155], a[160:163], a[80:83], v[152:155]
M v[152:155], a[164:167], a[84:87], v[152:155]
 s_waitcnt lgkmcnt(4)
M v[156:159], a[164:167], a[92:95], v[156:159]
 s_add_u32 m0, s23, 32768
 ds_read_b64_tr_b16 a[144:145], v3 offset:49152
 ds_read_b64_tr_b16 a[146:147], v3 offset:50176
M v[156:159], a[160:163], a[88:91], v[156:159]
 buffer_load_dwordx4 v8, s[16:19], s21 offen offset:0  nt lds
 s_waitcnt vmcnt(27)
M v[16:19], a[176:179], a[208:211], 0
 s_waitcnt vmcnt(26)
M v[16:19], a[180:183], a[212:215], v[16:19]
 s_waitcnt vmcnt(24)
M v[16:19], a[184:187], a[216:219], v[16:19]
 s_waitcnt vmcnt(22)
M v[16:19], a[188:191], a[220:223], v[16:19]
M v[160:163], a[168:171], a[32:35], v[160:163]
 ds_read_b128 a[160:163], v5 offset:20480
 ds_read_b128 a[164:167], v6 offset:20480
M v[160:163], a[172:175], a[36:39], v[160:163]
 ds_read_b64_tr_b16 a[176:177], v22 offset:4096
M v[164:167], a[172:175], a[44:47], v[164:167]
 ds_read_b64_tr_b16 a[178:179], v22 offset:4224
 ds_read_b64_tr_b16 a[180:181], v22 offset:5120
M v[164:167], a[168:171], a[40:43], v[164:167]
 ds_read_b64_tr_b16 a[182:183], v22 offset:5248
M v[168:171], a[168:171], a[48:51], v[168:171]
 ds_read_b64_tr_b16 a[184:185], v22 offset:6144
M v[168:171], a[172:175], a[52:55], v[168:171]
 ds_read_b64_tr_b16 a[148:149], v3 offset:57344
 ds_read_b64_tr_b16 a[150:151], v3 offset:58368
M v[172:175], a[172:175], a[60:63], v[172:175]
 buffer_load_dwordx4 v9, s[16:19], s21 offen offset:1024  nt lds
M v[172:175], a[168:171], a[56:59], v[172:175]
 ds_read_b64_tr_b16 a[186:187], v22 offset:6272
M v[176:179], a[168:171], a[64:67], v[176:179]
M v[176:179], a[172:175], a[68:71], v[176:179]
M v[180:183], a[172:175], a[76:79], v[180:183]
M v[180:183], a[168:171], a[72:75], v[180:183]
M v[184:187], a[168:171], a[80:83], v[184:187]
 ds_read_b64_tr_b16 a[152:153], v4 offset:49152
 ds_read_b64_tr_b16 a[154:155], v4 offset:50176
M v[184:187], a[172:175], a[84:87], v[184:187]
 s_waitcnt lgkmcnt(10)
M v[188:191], a[172:175], a[92:95], v[188:191]
 buffer_load_dwordx4 v10, s[16:19], s21 offen offset:2048  nt lds
M v[188:191], a[168:171], a[88:91], v[188:191]
M v[192:195], a[160:163], a[32:35], v[192:195]
 ds_read_b128 a[168:171], v5 offset:22528
 ds_read_b128 a[172:175], v6 offset:22528
M v[192:195], a[164:167], a[36:39], v[192:195]
M v[196:199], a[164:167], a[44:47], v[196:199]
M v[196:199], a[160:163], a[40:43], v[196:199]
 ds_read_b64_tr_b16 a[156:157], v4 offset:57344
 ds_read_b64_tr_b16 a[158:159], v4 offset:58368
M v[200:203], a[160:163], a[48:51], v[200:203]
 buffer_load_dwordx4 v11, s[16:19], s21 offen offset:3072  nt lds
M v[200:203], a[164:167], a[52:55], v[200:203]
 s_add_u32 s21, s21, 128
M v[204:207], a[164:167], a[60:63], v[204:207]
M v[204:207], a[160:163], a[56:59], v[204:207]
M v[208:211], a[160:163], a[64:67], v[208:211]
M v[208:211], a[164:167], a[68:71], v[208:211]
M v[212:215], a[164:167], a[76:79], v[212:215]
M v[212:215], a[160:163], a[72:75], v[212:215]
M v[216:219], a[160:163], a[80:83], v[216:219]
M v[216:219], a[164:167], a[84:87], v[216:219]
 s_waitcnt lgkmcnt(2)
M v[220:223], a[164:167], a[92:95], v[220:223]
 s_waitcnt vmcnt(16) lgkmcnt(0)
M v[220:223], a[160:163], a[88:91], v[220:223]
 s_barrier
M v[16:19], a[176:179], a[224:227], v[16:19]
M v[16:19], a[180:183], a[228:231], v[16:19]
M v[16:19], a[184:187], a[232:235], v[16:19]
M v[224:227], a[168:171], a[32:35], v[224:227]
 ds_read_b128 a[160:163], v5 offset:32768
 ds_read_b128 a[164:167], v6 offset:32768
M v[224:227], a[172:175], a[36:39], v[224:227]
M v[228:231], a[172:175], a[44:47], v[228:231]
M v[228:231], a[168:171], a[40:43], v[228:231]
M v[232:235], a[168:171], a[48:51], v[232:235]
M v[232:235], a[172:175], a[52:55], v[232:235]
M v[236:239], a[172:175], a[60:63], v[236:239]
M v[236:239], a[168:171], a[56:59], v[236:239]
M v[240:243], a[168:171], a[64:67], v[240:243]
M v[240:243], a[172:175], a[68:71], v[240:243]
M v[244:247], a[172:175], a[76:79], v[244:247]
M v[244:247], a[168:171], a[72:75], v[244:247]
M v[248:251], a[168:171], a[80:83], v[248:251]
M v[248:251], a[172:175], a[84:87], v[248:251]
 s_waitcnt lgkmcnt(0)
M v[252:255], a[172:175], a[92:95], v[252:255]
M v[252:255], a[168:171], a[88:91], v[252:255]
M a[0:3], a[160:163], a[96:99], a[0:3]
 ds_read_b128 a[168:171], v5 offset:34816
 ds_read_b128 a[172:175], v6 offset:34816
M a[0:3], a[164:167], a[100:103], a[0:3]
 ds_read_b64_tr_b16 a[32:33], v1 offset:0
 ds_read_b64_tr_b16 a[34:35], v1 offset:1024
M a[4:7], a[164:167], a[108:111], a[4:7]
 s_add_u32 m0, s24, 16384
M a[4:7], a[160:163], a[104:107], a[4:7]
 buffer_load_dwordx4 v12, s[48:51], s22 offen offset:0   lds
M a[8:11], a[160:163], a[112:115], a[8:11]
M a[8:11], a[164:167], a[116:119], a[8:11]
 s_lshl_b32 s64, s20, 10
M a[12:15], a[164:167], a[124:127], a[12:15]
 s_add_u32 s64, s64, 159744
 ds_read_b64_tr_b16 a[36:37], v1 offset:8192
 ds_read_b64_tr_b16 a[38:39], v1 offset:9216
M a[12:15], a[160:163], a[120:123], a[12:15]
 v_add_u32 v21, s64, v7
 ds_write_b128 v21, v[16:19]
M a[16:19], a[160:163], a[128:131], a[16:19]
 buffer_load_dwordx4 v13, s[48:51], s22 offen offset:1024   lds
M a[16:19], a[164:167], a[132:135], a[16:19]
 s_mul_i32 s67, s86, 14336
M a[20:23], a[164:167], a[140:143], a[20:23]
 s_mul_i32 s64, s20, 224
M a[20:23], a[160:163], a[136:139], a[20:23]
 s_add_u32 s67, s67, s64
 ds_read_b64_tr_b16 a[40:41], v2 offset:0
 ds_read_b64_tr_b16 a[42:43], v2 offset:1024
M a[24:27], a[160:163], a[144:147], a[24:27]
 v_lshrrev_b32 v28, 4, v0
 v_mul_u32_u24 v28, 896, v28
M a[24:27], a[164:167], a[148:151], a[24:27]
 s_waitcnt lgkmcnt(7)
 v_and_b32 v29, 15, v0
 v_lshl_add_u32 v28, v29, 4, v28
M a[28:31], a[164:167], a[156:159], a[28:31]
 buffer_load_dwordx4 v14, s[48:51], s22 offen offset:2048   lds
M a[28:31], a[160:163], a[152:155], a[28:31]
 v_mov_b32 v30, 536870912
 v_cmp_gt_u32 vcc, 14, v29
M v[32:35], a[168:171], a[96:99], v[32:35]
 s_nop 0
 ds_read_b128 a[160:163], v5 offset:36864
 ds_read_b128 a[164:167], v6 offset:36864
M v[32:35], a[172:175], a[100:103], v[32:35]
 s_nop 0
 ds_read_b64_tr_b16 a[44:45], v2 offset:8192
 ds_read_b64_tr_b16 a[46:47], v2 offset:9216
M v[36:39], a[172:175], a[108:111], v[36:39]
 buffer_load_dwordx4 v15, s[48:51], s22 offen offset:3072   lds
M v[36:39], a[168:171], a[104:107], v[36:39]
 s_sub_u32 s22, s22, 2097024
 v_cndmask_b32 v28, v30, v28, vcc
 v_add_u32 v29, 2560, v28
M v[40:43], a[168:171], a[112:115], v[40:43]
 v_add_u32 v30, 5120, v28
 v_add_u32 v31, 7680, v28
M v[40:43], a[172:175], a[116:119], v[40:43]
 ds_read_b64_tr_b16 a[48:49], v3 offset:0
 ds_read_b64_tr_b16 a[50:51], v3 offset:1024
M v[44:47], a[172:175], a[124:127], v[44:47]
 s_add_u32 m0, s23, 49152
M v[44:47], a[168:171], a[120:123], v[44:47]
 buffer_load_dwordx4 v8, s[16:19], s21 offen offset:0  nt lds
M v[48:51], a[168:171], a[128:131], v[48:51]
M v[48:51], a[172:175], a[132:135], v[48:51]
M v[52:55], a[172:175], a[140:143], v[52:55]
 ds_read_b64_tr_b16 a[52:53], v3 offset:8192
 ds_read_b64_tr_b16 a[54:55], v3 offset:9216
M v[52:55], a[168:171], a[136:139], v[52:55]
M v[56:59], a[168:171], a[144:147], v[56:59]
 buffer_load_dwordx4 v9, s[16:19], s21 offen offset:1024  nt lds
M v[56:59], a[172:175], a[148:151], v[56:59]
 s_waitcnt lgkmcnt(6)
M v[60:63], a[172:175], a[156:159], v[60:63]
M v[60:63], a[168:171], a[152:155], v[60:63]
 ds_read_b64_tr_b16 a[56:57], v4 offset:0
 ds_read_b64_tr_b16 a[58:59], v4 offset:1024
M v[64:67], a[160:163], a[96:99], v[64:67]
 ds_read_b128 a[168:171], v5 offset:38912
 ds_read_b128 a[172:175], v6 offset:38912
M v[64:67], a[164:167], a[100:103], v[64:67]
 buffer_load_dwordx4 v10, s[16:19], s21 offen offset:2048  nt lds
M v[68:71], a[164:167], a[108:111], v[68:71]
M v[68:71], a[160:163], a[104:107], v[68:71]
M v[72:75], a[160:163], a[112:115], v[72:75]
 ds_read_b64_tr_b16 a[60:61], v4 offset:8192
 ds_read_b64_tr_b16 a[62:63], v4 offset:9216
M v[72:75], a[164:167], a[116:119], v[72:75]
M v[76:79], a[164:167], a[124:127], v[76:79]
 buffer_load_dwordx4 v11, s[16:19], s21 offen offset:3072  nt lds
M v[76:79], a[160:163], a[120:123], v[76:79]
 s_add_u32 s21, s21, 524160
M v[80:83], a[160:163], a[128:131], v[80:83]
M v[80:83], a[164:167], a[132:135], v[80:83]
M v[84:87], a[164:167], a[140:143], v[84:87]
M v[84:87], a[160:163], a[136:139], v[84:87]
M v[88:91], a[160:163], a[144:147], v[88:91]
M v[88:91], a[164:167], a[148:151], v[88:91]
 s_waitcnt lgkmcnt(2)
M v[92:95], a[164:167], a[156:159], v[92:95]
 s_waitcnt vmcnt(16) lgkmcnt(0)
M v[92:95], a[160:163], a[152:155], v[92:95]
 s_barrier
M v[96:99], a[168:171], a[96:99], v[96:99]
 ds_read_b128 a[160:163], v5 offset:49152
 ds_read_b128 a[164:167], v6 offset:49152
M v[96:99], a[172:175], a[100:103], v[96:99]
M v[100:103], a[172:175], a[108:111], v[100:103]
 s_add_u32 m0, s24, 32768
 ds_read_b64_tr_b16 a[64:65], v1 offset:16384
 ds_read_b64_tr_b16 a[66:67], v1 offset:17408
M v[100:103], a[168:171], a[104:107], v[100:103]
 buffer_load_dwordx4 v12, s[48:51], s22 offen offset:0   lds
M v[104:107], a[168:171], a[112:115], v[104:107]
M v[104:107], a[172:175], a[116:119], v[104:107]
M v[108:111], a[172:175], a[124:127], v[108:111]
M v[108:111], a[168:171], a[120:123], v[108:111]
 buffer_load_dwordx4 v13, s[48:51], s22 offen offset:1024   lds
M v[112:115], a[168:171], a[128:131], v[112:115]
M v[112:115], a[172:175], a[132:135], v[112:115]
 ds_read_b64_tr_b16 a[68:69], v1 offset:24576
 ds_read_b64_tr_b16 a[70:71], v1 offset:25600
M v[116:119], a[172:175], a[140:143], v[116:119]
M v[116:119], a[168:171], a[136:139], v[116:119]
M v[120:123], a[168:171], a[144:147], v[120:123]
 buffer_load_dwordx4 v14, s[48:51], s22 offen offset:2048   lds
M v[120:123], a[172:175], a[148:151], v[120:123]
 s_waitcnt lgkmcnt(4)
M v[124:127], a[172:175], a[156:159], v[124:127]
M v[124:127], a[168:171], a[152:155], v[124:127]
M v[128:131], a[160:163], a[96:99], v[128:131]
 ds_read_b128 a[168:171], v5 offset:51200
 ds_read_b128 a[172:175], v6 offset:51200
M v[128:131], a[164:167], a[100:103], v[128:131]
 ds_read_b64_tr_b16 a[72:73], v2 offset:16384
 ds_read_b64_tr_b16 a[74:75], v2 offset:17408
M v[132:135], a[164:167], a[108:111], v[132:135]
 buffer_load_dwordx4 v15, s[48:51], s22 offen offset:3072   lds
M v[132:135], a[160:163], a[104:107], v[132:135]
 s_add_u32 s22, s22, 2097152
M v[136:139], a[160:163], a[112:115], v[136:139]
M v[136:139], a[164:167], a[116:119], v[136:139]
 s_add_u32 m0, s23, 0
M v[140:143], a[164:167], a[124:127], v[140:143]
 buffer_load_dwordx4 v8, s[16:19], s21 offen offset:0  nt lds
M v[140:143], a[160:163], a[120:123], v[140:143]
 ds_read_b64_tr_b16 a[76:77], v2 offset:24576
 ds_read_b64_tr_b16 a[78:79], v2 offset:25600
M v[144:147], a[160:163], a[128:131], v[144:147]
M v[144:147], a[164:167], a[132:135], v[144:147]
M v[148:151], a[164:167], a[140:143], v[148:151]
 buffer_load_dwordx4 v9, s[16:19], s21 offen offset:1024  nt lds
M v[148:151], a[160:163], a[136:139], v[148:151]
M v[152:155], a[160:163], a[144:147], v[152:155]
M v[152:155], a[164:167], a[148:151], v[152:155]
 s_waitcnt lgkmcnt(4)
M v[156:159], a[164:167], a[156:159], v[156:159]
 ds_read_b64_tr_b16 a[80:81], v3 offset:16384
 ds_read_b64_tr_b16 a[82:83], v3 offset:17408
M v[156:159], a[160:163], a[152:155], v[156:159]
 buffer_load_dwordx4 v10, s[16:19], s21 offen offset:2048  nt lds
M v[160:163], a[168:171], a[96:99], v[160:163]
 ds_read_b128 a[160:163], v5 offset:53248
 ds_read_b128 a[164:167], v6 offset:53248
M v[160:163], a[172:175], a[100:103], v[160:163]
M v[164:167], a[172:175], a[108:111], v[164:167]
M v[164:167], a[168:171], a[104:107], v[164:167]
M v[168:171], a[168:171], a[112:115], v[168:171]
 buffer_load_dwordx4 v11, s[16:19], s21 offen offset:3072  nt lds
M v[168:171], a[172:175], a[116:119], v[168:171]
 s_add_u32 s21, s21, 128
 ds_read_b64_tr_b16 a[84:85], v3 offset:24576
 ds_read_b64_tr_b16 a[86:87], v3 offset:25600
M v[172:175], a[172:175], a[124:127], v[172:175]
M v[172:175], a[168:171], a[120:123], v[172:175]
M v[176:179], a[168:171], a[128:131], v[176:179]
 s_add_u32 m0, s87, 0
M v[176:179], a[172:175], a[132:135], v[176:179]
 buffer_load_dwordx4 v28, s[68:71], s67 offen offset:0 nt lds
M v[180:183], a[172:175], a[140:143], v[180:183]
M v[180:183], a[168:171], a[136:139], v[180:183]
M v[184:187], a[168:171], a[144:147], v[184:187]
 ds_read_b64_tr_b16 a[88:89], v4 offset:16384
 ds_read_b64_tr_b16 a[90:91], v4 offset:17408
M v[184:187], a[172:175], a[148:151], v[184:187]
 s_waitcnt lgkmcnt(4)
M v[188:191], a[172:175], a[156:159], v[188:191]
 buffer_load_dwordx4 v29, s[68:71], s67 offen offset:1024 nt lds
M v[188:191], a[168:171], a[152:155], v[188:191]
M v[192:195], a[160:163], a[96:99], v[192:195]
 ds_read_b128 a[168:171], v5 offset:55296
 ds_read_b128 a[172:175], v6 offset:55296
M v[192:195], a[164:167], a[100:103], v[192:195]
M v[196:199], a[164:167], a[108:111], v[196:199]
 buffer_load_dwordx4 v30, s[68:71], s67 offen offset:2048 nt lds
M v[196:199], a[160:163], a[104:107], v[196:199]
 ds_read_b64_tr_b16 a[92:93], v4 offset:24576
 ds_read_b64_tr_b16 a[94:95], v4 offset:25600
M v[200:203], a[160:163], a[112:115], v[200:203]
M v[200:203], a[164:167], a[116:119], v[200:203]
M v[204:207], a[164:167], a[124:127], v[204:207]
M v[204:207], a[160:163], a[120:123], v[204:207]
 buffer_load_dwordx4 v31, s[68:71], s67 offen offset:3072 nt lds
M v[208:211], a[160:163], a[128:131], v[208:211]
 s_add_u32 s67, s67, 0
M v[208:211], a[164:167], a[132:135], v[208:211]
M v[212:215], a[164:167], a[140:143], v[212:215]
M v[212:215], a[160:163], a[136:139], v[212:215]
M v[216:219], a[160:163], a[144:147], v[216:219]
M v[216:219], a[164:167], a[148:151], v[216:219]
 s_waitcnt lgkmcnt(2)
M v[220:223], a[164:167], a[156:159], v[220:223]
 s_waitcnt vmcnt(20) lgkmcnt(0)
M v[220:223], a[160:163], a[152:155], v[220:223]
 s_barrier
M v[224:227], a[168:171], a[96:99], v[224:227]
 ds_read_b128 a[160:163], v5 offset:0
 ds_read_b128 a[164:167], v6 offset:0
M v[224:227], a[172:175], a[100:103], v[224:227]
M v[228:231], a[172:175], a[108:111], v[228:231]
M v[228:231], a[168:171], a[104:107], v[228:231]
M v[232:235], a[168:171], a[112:115], v[232:235]
M v[232:235], a[172:175], a[116:119], v[232:235]
M v[236:239], a[172:175], a[124:127], v[236:239]
M v[236:239], a[168:171], a[120:123], v[236:239]
M v[240:243], a[168:171], a[128:131], v[240:243]
M v[240:243], a[172:175], a[132:135], v[240:243]
M v[244:247], a[172:175], a[140:143], v[244:247]
M v[244:247], a[168:171], a[136:139], v[244:247]
M v[248:251], a[168:171], a[144:147], v[248:251]
M v[248:251], a[172:175], a[148:151], v[248:251]
 s_waitcnt lgkmcnt(0)
M v[252:255], a[172:175], a[156:159], v[252:255]
M v[252:255], a[168:171], a[152:155], v[252:255]
M a[0:3], a[160:163], a[32:35], a[0:3]
 ds_read_b128 a[168:171], v5 offset:2048
 ds_read_b128 a[172:175], v6 offset:2048
M a[0:3], a[164:167], a[36:39], a[0:3]
 ds_read_b64_tr_b16 a[96:97], v1 offset:32768
 ds_read_b64_tr_b16 a[98:99], v1 offset:33792
M a[4:7], a[164:167], a[44:47], a[4:7]
 s_add_u32 m0, s24, 49152
 v_cvt_pk_bf16_f32 v23, v23, v23
 v_accvgpr_read_b32 v27, a241
M a[4:7], a[160:163], a[40:43], a[4:7]
 buffer_load_dwordx4 v12, s[48:51], s22 offen offset:0   lds
M a[8:11], a[160:163], a[48:51], a[8:11]
 v_and_b32 v23, 0xffff0000, v23
M a[8:11], a[164:167], a[52:55], a[8:11]
 v_mul_f32 v22, 0xbfb8aa3b, v23
M a[12:15], a[164:167], a[60:63], a[12:15]
 ds_read_b64_tr_b16 a[100:101], v1 offset:40960
 ds_read_b64_tr_b16 a[102:103], v1 offset:41984
M a[12:15], a[160:163], a[56:59], a[12:15]
 v_exp_f32 v22, v22
M a[16:19], a[160:163], a[64:67], a[16:19]
 buffer_load_dwordx4 v13, s[48:51], s22 offen offset:1024   lds
M a[16:19], a[164:167], a[68:71], a[16:19]
 v_add_f32 v22, 1.0, v22
M a[20:23], a[164:167], a[76:79], a[20:23]
 v_rcp_f32 v23, v22
M a[20:23], a[160:163], a[72:75], a[20:23]
 s_or_b32 s64, s86, s20
 ds_read_b64_tr_b16 a[104:105], v2 offset:32768
 ds_read_b64_tr_b16 a[106:107], v2 offset:33792
M a[24:27], a[160:163], a[80:83], a[24:27]
 s_min_u32 s64, s64, 1
 s_lshl_b32 s64, s64, 29
 v_lshrrev_b32 v22, 1, v0
M a[24:27], a[164:167], a[84:87], a[24:27]
 s_waitcnt lgkmcnt(6)
 v_min_u32 v22, 1, v22
M a[28:31], a[164:167], a[92:95], a[28:31]
 buffer_load_dwordx4 v14, s[48:51], s22 offen offset:2048   lds
M a[28:31], a[160:163], a[88:91], a[28:31]
 v_lshlrev_b32 v22, 29, v22
M v[32:35], a[168:171], a[32:35], v[32:35]
 ds_read_b128 a[160:163], v5 offset:4096
 ds_read_b128 a[164:167], v6 offset:4096
M v[32:35], a[172:175], a[36:39], v[32:35]
 ds_read_b64_tr_b16 a[108:109], v2 offset:40960
 ds_read_b64_tr_b16 a[110:111], v2 offset:41984
M v[36:39], a[172:175], a[44:47], v[36:39]
 buffer_load_dwordx4 v15, s[48:51], s22 offen offset:3072   lds
M v[36:39], a[168:171], a[40:43], v[36:39]
 s_sub_u32 s22, s22, 2097024
 v_lshl_or_b32 v22, v0, 2, v22
M v[40:43], a[168:171], a[48:51], v[40:43]
 v_or_b32 v22, s64, v22
M v[40:43], a[172:175], a[52:55], v[40:43]
 ds_read_b64_tr_b16 a[112:113], v3 offset:32768
 ds_read_b64_tr_b16 a[114:115], v3 offset:33792
M v[44:47], a[172:175], a[60:63], v[44:47]
 s_add_u32 m0, s23, 16384
 v_cvt_pk_bf16_f32 v23, v23, v23
M v[44:47], a[168:171], a[56:59], v[44:47]
 buffer_load_dwordx4 v8, s[16:19], s21 offen offset:0  nt lds
M v[48:51], a[168:171], a[64:67], v[48:51]
 v_and_b32 v23, 0xffff0000, v23
M v[48:51], a[172:175], a[68:71], v[48:51]
 s_mov_b32 s64, 104890368
M v[52:55], a[172:175], a[76:79], v[52:55]
 ds_read_b64_tr_b16 a[116:117], v3 offset:40960
 ds_read_b64_tr_b16 a[118:119], v3 offset:41984
M v[52:55], a[168:171], a[72:75], v[52:55]
 buffer_store_dword v24, v22, s[8:11], s64 offen sc1
M v[56:59], a[168:171], a[80:83], v[56:59]
 buffer_load_dwordx4 v9, s[16:19], s21 offen offset:1024  nt lds
M v[56:59], a[172:175], a[84:87], v[56:59]
 s_waitcnt lgkmcnt(6)
M v[60:63], a[172:175], a[92:95], v[60:63]
 buffer_store_dword v23, v22, s[8:11], s64 offen offset:8 sc1
M v[60:63], a[168:171], a[88:91], v[60:63]
 ds_read_b64_tr_b16 a[120:121], v4 offset:32768
 ds_read_b64_tr_b16 a[122:123], v4 offset:33792
M v[64:67], a[160:163], a[32:35], v[64:67]
 ds_read_b128 a[168:171], v5 offset:6144
 ds_read_b128 a[172:175], v6 offset:6144
M v[64:67], a[164:167], a[36:39], v[64:67]
 buffer_load_dwordx4 v10, s[16:19], s21 offen offset:2048  nt lds
M v[68:71], a[164:167], a[44:47], v[68:71]
 v_add_u32 v25, 159744, v7
M v[68:71], a[160:163], a[40:43], v[68:71]
 ds_read_b128 v[16:19], v25
M v[72:75], a[160:163], a[48:51], v[72:75]
 ds_read_b64_tr_b16 a[124:125], v4 offset:40960
 ds_read_b64_tr_b16 a[126:127], v4 offset:41984
M v[72:75], a[164:167], a[52:55], v[72:75]
 ds_read_b128 v[28:31], v25 offset:1024
 v_sub_f32 v48, v48, v27
M v[76:79], a[164:167], a[60:63], v[76:79]
 buffer_load_dwordx4 v11, s[16:19], s21 offen offset:3072  nt lds
M v[76:79], a[160:163], a[56:59], v[76:79]
 s_add_u32 s21, s21, 524160
 ds_read_b128 v[20:23], v25 offset:2048
 v_sub_f32 v49, v49, v27
M v[80:83], a[160:163], a[64:67], v[80:83]
 v_sub_f32 v50, v50, v27
 v_sub_f32 v51, v51, v27
M v[80:83], a[164:167], a[68:71], v[80:83]
 v_sub_f32 v52, v52, v27
 v_sub_f32 v53, v53, v27
M v[84:87], a[164:167], a[76:79], v[84:87]
 v_sub_f32 v54, v54, v27
 v_sub_f32 v55, v55, v27
M v[84:87], a[160:163], a[72:75], v[84:87]
 v_sub_f32 v56, v56, v27
 v_sub_f32 v57, v57, v27
M v[88:91], a[160:163], a[80:83], v[88:91]
 v_sub_f32 v58, v58, v27
 v_sub_f32 v59, v59, v27
M v[88:91], a[164:167], a[84:87], v[88:91]
 s_waitcnt lgkmcnt(5)
 v_sub_f32 v60, v60, v27
 v_sub_f32 v61, v61, v27
M v[92:95], a[164:167], a[92:95], v[92:95]
 s_waitcnt vmcnt(22) lgkmcnt(0)
 v_sub_f32 v62, v62, v27
 v_sub_f32 v63, v63, v27
M v[92:95], a[160:163], a[88:91], v[92:95]
 s_barrier
M v[96:99], a[168:171], a[32:35], v[96:99]
 ds_read_b128 a[160:163], v5 offset:16384
 ds_read_b128 a[164:167], v6 offset:16384
M v[96:99], a[172:175], a[36:39], v[96:99]
 v_add_f32 v16, v28, v16
M v[100:103], a[172:175], a[44:47], v[100:103]
 s_add_u32 m0, s24, 0
 ds_read_b64_tr_b16 a[128:129], v1 offset:49152
 ds_read_b64_tr_b16 a[130:131], v1 offset:50176
M v[100:103], a[168:171], a[40:43], v[100:103]
 buffer_load_dwordx4 v12, s[48:51], s22 offen offset:0   lds
M v[104:107], a[168:171], a[48:51], v[104:107]
 v_add_f32 v17, v29, v17
 v_sub_f32 v80, v80, v27
M v[104:107], a[172:175], a[52:55], v[104:107]
 v_add_f32 v18, v30, v18
 v_sub_f32 v81, v81, v27
M v[108:111], a[172:175], a[60:63], v[108:111]
 v_add_f32 v19, v31, v19
 v_sub_f32 v82, v82, v27
M v[108:111], a[168:171], a[56:59], v[108:111]
 ds_read_b128 v[28:31], v25 offset:3072
 v_sub_f32 v83, v83, v27
M v[112:115], a[168:171], a[64:67], v[112:115]
 v_cvt_pk_bf16_f32 v25, v16, v17
 v_sub_f32 v84, v84, v27
M v[112:115], a[172:175], a[68:71], v[112:115]
 ds_read_b64_tr_b16 a[132:133], v1 offset:57344
 ds_read_b64_tr_b16 a[134:135], v1 offset:58368
M v[116:119], a[172:175], a[76:79], v[116:119]
 buffer_load_dwordx4 v13, s[48:51], s22 offen offset:1024   lds
M v[116:119], a[168:171], a[72:75], v[116:119]
 v_lshlrev_b32 v16, 16, v25
 v_sub_f32 v85, v85, v27
M v[120:123], a[168:171], a[80:83], v[120:123]
 v_and_b32 v17, 0xffff0000, v25
 v_sub_f32 v86, v86, v27
M v[120:123], a[172:175], a[84:87], v[120:123]
 s_waitcnt lgkmcnt(5)
 v_cvt_pk_bf16_f32 v25, v18, v19
 v_sub_f32 v87, v87, v27
M v[124:127], a[172:175], a[92:95], v[124:127]
 v_lshlrev_b32 v18, 16, v25
 v_sub_f32 v88, v88, v27
M v[124:127], a[168:171], a[88:91], v[124:127]
 v_and_b32 v19, 0xffff0000, v25
 v_sub_f32 v89, v89, v27
M v[128:131], a[160:163], a[32:35], v[128:131]
 ds_read_b128 a[168:171], v5 offset:18432
 ds_read_b128 a[172:175], v6 offset:18432
M v[128:131], a[164:167], a[36:39], v[128:131]
 ds_read_b64_tr_b16 a[136:137], v2 offset:49152
 ds_read_b64_tr_b16 a[138:139], v2 offset:50176
M v[132:135], a[164:167], a[44:47], v[132:135]
 buffer_load_dwordx4 v14, s[48:51], s22 offen offset:2048   lds
M v[132:135], a[160:163], a[40:43], v[132:135]
 s_waitcnt lgkmcnt(6)
 v_add_f32 v20, v28, v20
 v_sub_f32 v90, v90, v27
M v[136:139], a[160:163], a[48:51], v[136:139]
 v_add_f32 v21, v29, v21
 v_sub_f32 v91, v91, v27
M v[136:139], a[164:167], a[52:55], v[136:139]
 v_add_f32 v22, v30, v22
 v_sub_f32 v92, v92, v27
M v[140:143], a[164:167], a[60:63], v[140:143]
 v_add_f32 v23, v31, v23
 v_sub_f32 v93, v93, v27
M v[140:143], a[160:163], a[56:59], v[140:143]
 ds_read_b64_tr_b16 a[140:141], v2 offset:57344
 ds_read_b64_tr_b16 a[142:143], v2 offset:58368
M v[144:147], a[160:163], a[64:67], v[144:147]
 buffer_load_dwordx4 v15, s[48:51], s22 offen offset:3072   lds
M v[144:147], a[164:167], a[68:71], v[144:147]
 s_add_u32 s22, s22, 2097152
 v_mul_f32 v28, 0xbfb8aa3b, v16
 v_sub_f32 v94, v94, v27
M v[148:151], a[164:167], a[76:79], v[148:151]
 v_mul_f32 v29, 0xbfb8aa3b, v17
 v_sub_f32 v95, v95, v27
M v[148:151], a[160:163], a[72:75], v[148:151]
 v_mul_f32 v30, 0xbfb8aa3b, v18
 v_sub_f32 v112, v112, v27
M v[152:155], a[160:163], a[80:83], v[152:155]
 v_mul_f32 v31, 0xbfb8aa3b, v19
 v_sub_f32 v113, v113, v27
M v[152:155], a[164:167], a[84:87], v[152:155]
 s_waitcnt lgkmcnt(4)
 v_exp_f32 v28, v28
M v[156:159], a[164:167], a[92:95], v[156:159]
 s_add_u32 m0, s23, 32768
 ds_read_b64_tr_b16 a[144:145], v3 offset:49152
 ds_read_b64_tr_b16 a[146:147], v3 offset:50176
M v[156:159], a[160:163], a[88:91], v[156:159]
 buffer_load_dwordx4 v8, s[16:19], s21 offen offset:0  nt lds
M v[160:163], a[168:171], a[32:35], v[160:163]
 ds_read_b128 a[160:163], v5 offset:20480
 ds_read_b128 a[164:167], v6 offset:20480
M v[160:163], a[172:175], a[36:39], v[160:163]
 v_exp_f32 v29, v29
M v[164:167], a[172:175], a[44:47], v[164:167]
 v_exp_f32 v30, v30
M v[164:167], a[168:171], a[40:43], v[164:167]
 v_exp_f32 v31, v31
M v[168:171], a[168:171], a[48:51], v[168:171]
 v_cvt_pk_bf16_f32 v25, v20, v21
 v_sub_f32 v114, v114, v27
M v[168:171], a[172:175], a[52:55], v[168:171]
 ds_read_b64_tr_b16 a[148:149], v3 offset:57344
 ds_read_b64_tr_b16 a[150:151], v3 offset:58368
M v[172:175], a[172:175], a[60:63], v[172:175]
 buffer_load_dwordx4 v9, s[16:19], s21 offen offset:1024  nt lds
M v[172:175], a[168:171], a[56:59], v[172:175]
 v_lshlrev_b32 v20, 16, v25
 v_sub_f32 v115, v115, v27
M v[176:179], a[168:171], a[64:67], v[176:179]
 v_and_b32 v21, 0xffff0000, v25
 v_sub_f32 v116, v116, v27
M v[176:179], a[172:175], a[68:71], v[176:179]
 v_cvt_pk_bf16_f32 v25, v22, v23
 v_sub_f32 v117, v117, v27
M v[180:183], a[172:175], a[76:79], v[180:183]
 v_lshlrev_b32 v22, 16, v25
 v_sub_f32 v118, v118, v27
M v[180:183], a[168:171], a[72:75], v[180:183]
 v_and_b32 v23, 0xffff0000, v25
 v_sub_f32 v119, v119, v27
M v[184:187], a[168:171], a[80:83], v[184:187]
 ds_read_b64_tr_b16 a[152:153], v4 offset:49152
 ds_read_b64_tr_b16 a[154:155], v4 offset:50176
M v[184:187], a[172:175], a[84:87], v[184:187]
 s_waitcnt lgkmcnt(4)
 v_add_f32 v28, 1.0, v28
 v_sub_f32 v120, v120, v27
M v[188:191], a[172:175], a[92:95], v[188:191]
 buffer_load_dwordx4 v10, s[16:19], s21 offen offset:2048  nt lds
M v[188:191], a[168:171], a[88:91], v[188:191]
 v_add_f32 v29, 1.0, v29
 v_sub_f32 v121, v121, v27
M v[192:195], a[160:163], a[32:35], v[192:195]
 ds_read_b128 a[168:171], v5 offset:22528
 ds_read_b128 a[172:175], v6 offset:22528
M v[192:195], a[164:167], a[36:39], v[192:195]
 v_add_f32 v30, 1.0, v30
 v_sub_f32 v122, v122, v27
M v[196:199], a[164:167], a[44:47], v[196:199]
 v_add_f32 v31, 1.0, v31
 v_sub_f32 v123, v123, v27
M v[196:199], a[160:163], a[40:43], v[196:199]
 ds_read_b64_tr_b16 a[156:157], v4 offset:57344
 ds_read_b64_tr_b16 a[158:159], v4 offset:58368
M v[200:203], a[160:163], a[48:51], v[200:203]
 buffer_load_dwordx4 v11, s[16:19], s21 offen offset:3072  nt lds
M v[200:203], a[164:167], a[52:55], v[200:203]
 s_add_u32 s21, s21, 128
 v_rcp_f32 v28, v28
M v[204:207], a[164:167], a[60:63], v[204:207]
 v_rcp_f32 v29, v29
M v[204:207], a[160:163], a[56:59], v[204:207]
 v_rcp_f32 v30, v30
M v[208:211], a[160:163], a[64:67], v[208:211]
 v_rcp_f32 v31, v31
M v[208:211], a[164:167], a[68:71], v[208:211]
 v_mul_f32 v16, v28, v16
 v_sub_f32 v124, v124, v27
M v[212:215], a[164:167], a[76:79], v[212:215]
 v_mul_f32 v17, v29, v17
 v_sub_f32 v125, v125, v27
M v[212:215], a[160:163], a[72:75], v[212:215]
 v_mul_f32 v18, v30, v18
 v_sub_f32 v126, v126, v27
M v[216:219], a[160:163], a[80:83], v[216:219]
 v_mul_f32 v19, v31, v19
 v_sub_f32 v127, v127, v27
M v[216:219], a[164:167], a[84:87], v[216:219]
 s_waitcnt lgkmcnt(2)
 v_cvt_pk_bf16_f32 v25, v16, v17
 v_sub_f32 v128, v128, v27
M v[220:223], a[164:167], a[92:95], v[220:223]
 s_waitcnt vmcnt(22) lgkmcnt(0)
 v_lshlrev_b32 v16, 16, v25
 v_sub_f32 v129, v129, v27
M v[220:223], a[160:163], a[88:91], v[220:223]
 s_barrier
M v[224:227], a[168:171], a[32:35], v[224:227]
 ds_read_b128 a[160:163], v5 offset:32768
 ds_read_b128 a[164:167], v6 offset:32768
M v[224:227], a[172:175], a[36:39], v[224:227]
 v_and_b32 v17, 0xffff0000, v25
 v_sub_f32 v130, v130, v27
M v[228:231], a[172:175], a[44:47], v[228:231]
 v_cvt_pk_bf16_f32 v25, v18, v19
 v_sub_f32 v131, v131, v27
M v[228:231], a[168:171], a[40:43], v[228:231]
 v_lshlrev_b32 v18, 16, v25
 v_sub_f32 v132, v132, v27
M v[232:235], a[168:171], a[48:51], v[232:235]
 v_and_b32 v19, 0xffff0000, v25
 v_sub_f32 v133, v133, v27
M v[232:235], a[172:175], a[52:55], v[232:235]
 v_mul_f32 v16, v20, v16
 v_sub_f32 v134, v134, v27
M v[236:239], a[172:175], a[60:63], v[236:239]
 v_mul_f32 v17, v21, v17
 v_sub_f32 v135, v135, v27
M v[236:239], a[168:171], a[56:59], v[236:239]
 v_mul_f32 v18, v22, v18
 v_sub_f32 v136, v136, v27
M v[240:243], a[168:171], a[64:67], v[240:243]
 v_mul_f32 v19, v23, v19
 v_sub_f32 v137, v137, v27
M v[240:243], a[172:175], a[68:71], v[240:243]
 v_cvt_pk_bf16_f32 v16, v16, v17
 v_sub_f32 v138, v138, v27
M v[244:247], a[172:175], a[76:79], v[244:247]
 v_cvt_pk_bf16_f32 v17, v18, v19
 v_sub_f32 v139, v139, v27
M v[244:247], a[168:171], a[72:75], v[244:247]
 v_sub_f32 v140, v140, v27
 v_sub_f32 v141, v141, v27
M v[248:251], a[168:171], a[80:83], v[248:251]
 v_sub_f32 v142, v142, v27
 v_sub_f32 v143, v143, v27
M v[248:251], a[172:175], a[84:87], v[248:251]
 s_waitcnt lgkmcnt(0)
 v_sub_f32 v144, v144, v27
 v_sub_f32 v145, v145, v27
M v[252:255], a[172:175], a[92:95], v[252:255]
 v_sub_f32 v146, v146, v27
 v_sub_f32 v147, v147, v27
M v[252:255], a[168:171], a[88:91], v[252:255]
 v_sub_f32 v148, v148, v27
 v_sub_f32 v149, v149, v27
M a[0:3], a[160:163], a[96:99], a[0:3]
 ds_read_b128 a[168:171], v5 offset:34816
 ds_read_b128 a[172:175], v6 offset:34816
M a[0:3], a[164:167], a[100:103], a[0:3]
 ds_read_b64_tr_b16 a[32:33], v1 offset:0
 ds_read_b64_tr_b16 a[34:35], v1 offset:1024
M a[4:7], a[164:167], a[108:111], a[4:7]
 s_add_u32 m0, s24, 16384
 v_lshrrev_b32 v28, 2, v0
 v_lshlrev_b32 v28, 8, v28
M a[4:7], a[160:163], a[104:107], a[4:7]
 buffer_load_dwordx4 v12, s[48:51], s22 offen offset:0   lds
M a[8:11], a[160:163], a[112:115], a[8:11]
 v_and_b32 v29, 3, v0
 v_lshl_add_u32 v28, v29, 3, v28
M a[8:11], a[164:167], a[116:119], a[8:11]
 v_add_u32 v28, s87, v28
 v_sub_f32 v150, v150, v27
M a[12:15], a[164:167], a[124:127], a[12:15]
 s_waitcnt vmcnt(19)
 ds_read_b64_tr_b16 a[36:37], v1 offset:8192
 ds_read_b64_tr_b16 a[38:39], v1 offset:9216
M a[12:15], a[160:163], a[120:123], a[12:15]
 ds_read_b64_tr_b16 a[176:177], v28 offset:0
 v_sub_f32 v151, v151, v27
M a[16:19], a[160:163], a[128:131], a[16:19]
 buffer_load_dwordx4 v13, s[48:51], s22 offen offset:1024   lds
M a[16:19], a[164:167], a[132:135], a[16:19]
 ds_read_b64_tr_b16 a[178:179], v28 offset:32
 ds_read_b64_tr_b16 a[180:181], v28 offset:64
M a[20:23], a[164:167], a[140:143], a[20:23]
 ds_read_b64_tr_b16 a[182:183], v28 offset:96
 v_sub_f32 v152, v152, v27
M a[20:23], a[160:163], a[136:139], a[20:23]
 ds_read_b64_tr_b16 a[40:41], v2 offset:0
 ds_read_b64_tr_b16 a[42:43], v2 offset:1024
M a[24:27], a[160:163], a[144:147], a[24:27]
 ds_read_b64_tr_b16 a[184:185], v28 offset:128
 v_sub_f32 v153, v153, v27
M a[24:27], a[164:167], a[148:151], a[24:27]
 s_waitcnt lgkmcnt(11)
 ds_read_b64_tr_b16 a[186:187], v28 offset:160
 ds_read_b64_tr_b16 a[188:189], v28 offset:192
M a[28:31], a[164:167], a[156:159], a[28:31]
 buffer_load_dwordx4 v14, s[48:51], s22 offen offset:2048   lds
M a[28:31], a[160:163], a[152:155], a[28:31]
 v_sub_f32 v154, v154, v27
 v_sub_f32 v155, v155, v27
M v[32:35], a[168:171], a[96:99], v[32:35]
 ds_read_b128 a[160:163], v5 offset:36864
 ds_read_b128 a[164:167], v6 offset:36864
M v[32:35], a[172:175], a[100:103], v[32:35]
 ds_read_b64_tr_b16 a[44:45], v2 offset:8192
 ds_read_b64_tr_b16 a[46:47], v2 offset:9216
M v[36:39], a[172:175], a[108:111], v[36:39]
 buffer_load_dwordx4 v15, s[48:51], s22 offen offset:3072   lds
M v[36:39], a[168:171], a[104:107], v[36:39]
 s_sub_u32 s22, s22, 2097024
 v_sub_f32 v156, v156, v27
 v_sub_f32 v157, v157, v27
M v[40:43], a[168:171], a[112:115], v[40:43]
 v_sub_f32 v158, v158, v27
 v_sub_f32 v159, v159, v27
M v[40:43], a[172:175], a[116:119], v[40:43]
 ds_read_b64_tr_b16 a[48:49], v3 offset:0
 ds_read_b64_tr_b16 a[50:51], v3 offset:1024
M v[44:47], a[172:175], a[124:127], v[44:47]
 s_add_u32 m0, s23, 49152
M v[44:47], a[168:171], a[120:123], v[44:47]
 buffer_load_dwordx4 v8, s[16:19], s21 offen offset:0  nt lds
M v[48:51], a[168:171], a[128:131], v[48:51]
M v[48:51], a[172:175], a[132:135], v[48:51]
M v[52:55], a[172:175], a[140:143], v[52:55]
 ds_read_b64_tr_b16 a[52:53], v3 offset:8192
 ds_read_b64_tr_b16 a[54:55], v3 offset:9216
M v[52:55], a[168:171], a[136:139], v[52:55]
M v[56:59], a[168:171], a[144:147], v[56:59]
 buffer_load_dwordx4 v9, s[16:19], s21 offen offset:1024  nt lds
M v[56:59], a[172:175], a[148:151], v[56:59]
 s_waitcnt lgkmcnt(6)
M v[60:63], a[172:175], a[156:159], v[60:63]
M v[60:63], a[168:171], a[152:155], v[60:63]
 ds_read_b64_tr_b16 a[56:57], v4 offset:0
 ds_read_b64_tr_b16 a[58:59], v4 offset:1024
M v[64:67], a[160:163], a[96:99], v[64:67]
 ds_read_b128 a[168:171], v5 offset:38912
 ds_read_b128 a[172:175], v6 offset:38912
M v[64:67], a[164:167], a[100:103], v[64:67]
 buffer_load_dwordx4 v10, s[16:19], s21 offen offset:2048  nt lds
M v[68:71], a[164:167], a[108:111], v[68:71]
M v[68:71], a[160:163], a[104:107], v[68:71]
M v[72:75], a[160:163], a[112:115], v[72:75]
 ds_read_b64_tr_b16 a[60:61], v4 offset:8192
 ds_read_b64_tr_b16 a[62:63], v4 offset:9216
M v[72:75], a[164:167], a[116:119], v[72:75]
M v[76:79], a[164:167], a[124:127], v[76:79]
 buffer_load_dwordx4 v11, s[16:19], s21 offen offset:3072  nt lds
M v[76:79], a[160:163], a[120:123], v[76:79]
 s_add_u32 s21, s21, 524160
M v[80:83], a[160:163], a[128:131], v[80:83]
M v[80:83], a[164:167], a[132:135], v[80:83]
M v[84:87], a[164:167], a[140:143], v[84:87]
M v[84:87], a[160:163], a[136:139], v[84:87]
M v[88:91], a[160:163], a[144:147], v[88:91]
M v[88:91], a[164:167], a[148:151], v[88:91]
 s_waitcnt lgkmcnt(2)
M v[92:95], a[164:167], a[156:159], v[92:95]
 s_waitcnt vmcnt(16) lgkmcnt(0)
M v[92:95], a[160:163], a[152:155], v[92:95]
 s_barrier
 v_mfma_f32_16x16x16_bf16 a[208:211], a[176:177], v[16:17], 0
 v_mfma_f32_16x16x16_bf16 a[212:215], a[178:179], v[16:17], 0
 v_mfma_f32_16x16x16_bf16 a[216:219], a[180:181], v[16:17], 0
 v_mfma_f32_16x16x16_bf16 a[220:223], a[182:183], v[16:17], 0
 v_mfma_f32_16x16x16_bf16 a[224:227], a[184:185], v[16:17], 0
 v_mfma_f32_16x16x16_bf16 a[228:231], a[186:187], v[16:17], 0
 v_mfma_f32_16x16x16_bf16 a[232:235], a[188:189], v[16:17], 0
M v[96:99], a[168:171], a[96:99], v[96:99]
 ds_read_b128 a[160:163], v5 offset:49152
 ds_read_b128 a[164:167], v6 offset:49152
M v[96:99], a[172:175], a[100:103], v[96:99]
M v[100:103], a[172:175], a[108:111], v[100:103]
 s_add_u32 m0, s24, 32768
 ds_read_b64_tr_b16 a[64:65], v1 offset:16384
 ds_read_b64_tr_b16 a[66:67], v1 offset:17408
M v[100:103], a[168:171], a[104:107], v[100:103]
 buffer_load_dwordx4 v12, s[48:51], s22 offen offset:0   lds
M v[104:107], a[168:171], a[112:115], v[104:107]
M v[104:107], a[172:175], a[116:119], v[104:107]
M v[108:111], a[172:175], a[124:127], v[108:111]
M v[108:111], a[168:171], a[120:123], v[108:111]
M v[112:115], a[168:171], a[128:131], v[112:115]
M v[112:115], a[172:175], a[132:135], v[112:115]
 ds_read_b64_tr_b16 a[68:69], v1 offset:24576
 ds_read_b64_tr_b16 a[70:71], v1 offset:25600
M v[116:119], a[172:175], a[140:143], v[116:119]
 buffer_load_dwordx4 v13, s[48:51], s22 offen offset:1024   lds
M v[116:119], a[168:171], a[136:139], v[116:119]
M v[120:123], a[168:171], a[144:147], v[120:123]
M v[120:123], a[172:175], a[148:151], v[120:123]
 s_waitcnt lgkmcnt(4)
M v[124:127], a[172:175], a[156:159], v[124:127]
M v[124:127], a[168:171], a[152:155], v[124:127]
M v[128:131], a[160:163], a[96:99], v[128:131]
 ds_read_b128 a[168:171], v5 offset:51200
 ds_read_b128 a[172:175], v6 offset:51200
M v[128:131], a[164:167], a[100:103], v[128:131]
 ds_read_b64_tr_b16 a[72:73], v2 offset:16384
 ds_read_b64_tr_b16 a[74:75], v2 offset:17408
M v[132:135], a[164:167], a[108:111], v[132:135]
 buffer_load_dwordx4 v14, s[48:51], s22 offen offset:2048   lds
M v[132:135], a[160:163], a[104:107], v[132:135]
M v[136:139], a[160:163], a[112:115], v[136:139]
M v[136:139], a[164:167], a[116:119], v[136:139]
M v[140:143], a[164:167], a[124:127], v[140:143]
M v[140:143], a[160:163], a[120:123], v[140:143]
 ds_read_b64_tr_b16 a[76:77], v2 offset:24576
 ds_read_b64_tr_b16 a[78:79], v2 offset:25600
M v[144:147], a[160:163], a[128:131], v[144:147]
 buffer_load_dwordx4 v15, s[48:51], s22 offen offset:3072   lds
M v[144:147], a[164:167], a[132:135], v[144:147]
 s_add_u32 s22, s22, 2097152
M v[148:151], a[164:167], a[140:143], v[148:151]
M v[148:151], a[160:163], a[136:139], v[148:151]
M v[152:155], a[160:163], a[144:147], v[152:155]
M v[152:155], a[164:167], a[148:151], v[152:155]
 s_waitcnt lgkmcnt(4)
M v[156:159], a[164:167], a[156:159], v[156:159]
 s_add_u32 m0, s23, 0
 ds_read_b64_tr_b16 a[80:81], v3 offset:16384
 ds_read_b64_tr_b16 a[82:83], v3 offset:17408
M v[156:159], a[160:163], a[152:155], v[156:159]
 buffer_load_dwordx4 v8, s[52:55], s28 offen offset:0   lds
M v[160:163], a[168:171], a[96:99], v[160:163]
 ds_read_b128 a[160:163], v5 offset:53248
 ds_read_b128 a[164:167], v6 offset:53248
M v[160:163], a[172:175], a[100:103], v[160:163]
M v[164:167], a[172:175], a[108:111], v[164:167]
M v[164:167], a[168:171], a[104:107], v[164:167]
M v[168:171], a[168:171], a[112:115], v[168:171]
M v[168:171], a[172:175], a[116:119], v[168:171]
 ds_read_b64_tr_b16 a[84:85], v3 offset:24576
 ds_read_b64_tr_b16 a[86:87], v3 offset:25600
M v[172:175], a[172:175], a[124:127], v[172:175]
 buffer_load_dwordx4 v9, s[52:55], s28 offen offset:1024   lds
M v[172:175], a[168:171], a[120:123], v[172:175]
M v[176:179], a[168:171], a[128:131], v[176:179]
M v[176:179], a[172:175], a[132:135], v[176:179]
M v[180:183], a[172:175], a[140:143], v[180:183]
M v[180:183], a[168:171], a[136:139], v[180:183]
M v[184:187], a[168:171], a[144:147], v[184:187]
 ds_read_b64_tr_b16 a[88:89], v4 offset:16384
 ds_read_b64_tr_b16 a[90:91], v4 offset:17408
M v[184:187], a[172:175], a[148:151], v[184:187]
 s_waitcnt lgkmcnt(4)
M v[188:191], a[172:175], a[156:159], v[188:191]
 buffer_load_dwordx4 v10, s[52:55], s28 offen offset:2048   lds
M v[188:191], a[168:171], a[152:155], v[188:191]
M v[192:195], a[160:163], a[96:99], v[192:195]
 ds_read_b128 a[168:171], v5 offset:55296
 ds_read_b128 a[172:175], v6 offset:55296
M v[192:195], a[164:167], a[100:103], v[192:195]
M v[196:199], a[164:167], a[108:111], v[196:199]
M v[196:199], a[160:163], a[104:107], v[196:199]
 ds_read_b64_tr_b16 a[92:93], v4 offset:24576
 ds_read_b64_tr_b16 a[94:95], v4 offset:25600
M v[200:203], a[160:163], a[112:115], v[200:203]
 buffer_load_dwordx4 v11, s[52:55], s28 offen offset:3072   lds
M v[200:203], a[164:167], a[116:119], v[200:203]
 s_add_u32 s28, s28, 128
 v_sub_f32 v160, v160, v27
 v_sub_f32 v161, v161, v27
M v[204:207], a[164:167], a[124:127], v[204:207]
 v_sub_f32 v162, v162, v27
 v_sub_f32 v163, v163, v27
M v[204:207], a[160:163], a[120:123], v[204:207]
 v_sub_f32 v164, v164, v27
 v_sub_f32 v165, v165, v27
M v[208:211], a[160:163], a[128:131], v[208:211]
 v_sub_f32 v166, v166, v27
 v_sub_f32 v167, v167, v27
M v[208:211], a[164:167], a[132:135], v[208:211]
 v_sub_f32 v168, v168, v27
 v_sub_f32 v169, v169, v27
M v[212:215], a[164:167], a[140:143], v[212:215]
 v_sub_f32 v170, v170, v27
 v_sub_f32 v171, v171, v27
M v[212:215], a[160:163], a[136:139], v[212:215]
 v_sub_f32 v172, v172, v27
 v_sub_f32 v173, v173, v27
M v[216:219], a[160:163], a[144:147], v[216:219]
 v_sub_f32 v174, v174, v27
 v_sub_f32 v175, v175, v27
M v[216:219], a[164:167], a[148:151], v[216:219]
 s_waitcnt lgkmcnt(2)
 v_sub_f32 v176, v176, v27
 v_sub_f32 v177, v177, v27
M v[220:223], a[164:167], a[156:159], v[220:223]
 s_waitcnt vmcnt(16) lgkmcnt(0)
 v_sub_f32 v178, v178, v27
 v_sub_f32 v179, v179, v27
M v[220:223], a[160:163], a[152:155], v[220:223]
 s_barrier
M v[224:227], a[168:171], a[96:99], v[224:227]
 ds_read_b128 a[160:163], v5 offset:0
 ds_read_b128 a[164:167], v6 offset:0
M v[224:227], a[172:175], a[100:103], v[224:227]
 v_and_b32 v26, 48, v0
 v_lshlrev_b32 v26, 17, v26
M v[228:231], a[172:175], a[108:111], v[228:231]
 v_or_b32 v26, v26, v0
 v_lshl_add_u32 v26, v26, 7, s95
M v[228:231], a[168:171], a[104:107], v[228:231]
 buffer_load_dword a240, v26, s[76:79], 0 offen offset:0
M v[232:235], a[168:171], a[112:115], v[232:235]
 v_sub_f32 v180, v180, v27
 v_sub_f32 v181, v181, v27
M v[232:235], a[172:175], a[116:119], v[232:235]
 v_sub_f32 v182, v182, v27
 v_sub_f32 v183, v183, v27
M v[236:239], a[172:175], a[124:127], v[236:239]
 v_sub_f32 v184, v184, v27
 v_sub_f32 v185, v185, v27
M v[236:239], a[168:171], a[120:123], v[236:239]
 v_sub_f32 v186, v186, v27
 v_sub_f32 v187, v187, v27
M v[240:243], a[168:171], a[128:131], v[240:243]
 v_sub_f32 v188, v188, v27
 v_sub_f32 v189, v189, v27
M v[240:243], a[172:175], a[132:135], v[240:243]
 v_sub_f32 v190, v190, v27
 v_sub_f32 v191, v191, v27
M v[244:247], a[172:175], a[140:143], v[244:247]
 v_sub_f32 v192, v192, v27
 v_sub_f32 v193, v193, v27
M v[244:247], a[168:171], a[136:139], v[244:247]
 v_sub_f32 v194, v194, v27
 v_sub_f32 v195, v195, v27
M v[248:251], a[168:171], a[144:147], v[248:251]
 v_sub_f32 v196, v196, v27
 v_sub_f32 v197, v197, v27
M v[248:251], a[172:175], a[148:151], v[248:251]
 s_waitcnt lgkmcnt(0)
 v_sub_f32 v198, v198, v27
 v_sub_f32 v199, v199, v27
M v[252:255], a[172:175], a[156:159], v[252:255]
 v_sub_f32 v200, v200, v27
 v_sub_f32 v201, v201, v27
M v[252:255], a[168:171], a[152:155], v[252:255]
 v_sub_f32 v202, v202, v27
 v_sub_f32 v203, v203, v27
M a[0:3], a[160:163], a[32:35], a[0:3]
 ds_read_b128 a[168:171], v5 offset:2048
 ds_read_b128 a[172:175], v6 offset:2048
M a[0:3], a[164:167], a[36:39], a[0:3]
 ds_read_b64_tr_b16 a[96:97], v1 offset:32768
 ds_read_b64_tr_b16 a[98:99], v1 offset:33792
M a[4:7], a[164:167], a[44:47], a[4:7]
 s_add_u32 m0, s24, 49152
 v_lshrrev_b32 v28, 4, v0
 v_add_u32 v28, 0, v28
M a[4:7], a[160:163], a[40:43], a[4:7]
 buffer_load_dwordx4 v12, s[48:51], s22 offen offset:0   lds
M a[8:11], a[160:163], a[48:51], a[8:11]
 v_and_b32 v29, 7, v0
 v_xor_b32 v28, v28, v29
M a[8:11], a[164:167], a[52:55], a[8:11]
 v_lshlrev_b32 v28, 4, v28
 v_lshrrev_b32 v29, 3, v0
M a[12:15], a[164:167], a[60:63], a[12:15]
 ds_read_b64_tr_b16 a[100:101], v1 offset:40960
 ds_read_b64_tr_b16 a[102:103], v1 offset:41984
M a[12:15], a[160:163], a[56:59], a[12:15]
 buffer_load_dwordx4 v13, s[48:51], s22 offen offset:1024   lds
M a[16:19], a[160:163], a[64:67], a[16:19]
 v_mul_u32_u24 v29, 896, v29
 s_mul_i32 s64, s20, 28672
M a[16:19], a[164:167], a[68:71], a[16:19]
 buffer_load_dwordx4 v14, s[48:51], s22 offen offset:2048   lds
M a[20:23], a[164:167], a[76:79], a[20:23]
 s_add_u32 s64, s64, 0
 v_add3_u32 v16, v29, v28, s64
M a[20:23], a[160:163], a[72:75], a[20:23]
 ds_read_b64_tr_b16 a[104:105], v2 offset:32768
 ds_read_b64_tr_b16 a[106:107], v2 offset:33792
M a[24:27], a[160:163], a[80:83], a[24:27]
 v_add_u32 v18, 12288, v16
 v_lshrrev_b32 v28, 4, v0
M a[24:27], a[164:167], a[84:87], a[24:27]
 s_waitcnt lgkmcnt(6)
 v_add_u32 v28, 4, v28
 v_and_b32 v29, 7, v0
M a[28:31], a[164:167], a[92:95], a[28:31]
 buffer_load_dwordx4 v15, s[48:51], s22 offen offset:3072   lds
M a[28:31], a[160:163], a[88:91], a[28:31]
 s_sub_u32 s22, s22, 2097024
 v_xor_b32 v28, v28, v29
 v_lshlrev_b32 v28, 4, v28
M v[32:35], a[168:171], a[32:35], v[32:35]
 s_add_u32 m0, s23, 16384
 ds_read_b128 a[160:163], v5 offset:4096
 ds_read_b128 a[164:167], v6 offset:4096
M v[32:35], a[172:175], a[36:39], v[32:35]
 ds_read_b64_tr_b16 a[108:109], v2 offset:40960
 ds_read_b64_tr_b16 a[110:111], v2 offset:41984
M v[36:39], a[172:175], a[44:47], v[36:39]
 buffer_load_dwordx4 v8, s[52:55], s28 offen offset:0   lds
M v[36:39], a[168:171], a[40:43], v[36:39]
 v_lshrrev_b32 v29, 3, v0
 v_mul_u32_u24 v29, 896, v29
M v[40:43], a[168:171], a[48:51], v[40:43]
 buffer_load_dwordx4 v9, s[52:55], s28 offen offset:1024   lds
M v[40:43], a[172:175], a[52:55], v[40:43]
 ds_read_b64_tr_b16 a[112:113], v3 offset:32768
 ds_read_b64_tr_b16 a[114:115], v3 offset:33792
M v[44:47], a[172:175], a[60:63], v[44:47]
 s_mul_i32 s64, s20, 28672
 s_add_u32 s64, s64, 6144
M v[44:47], a[168:171], a[56:59], v[44:47]
 buffer_load_dwordx4 v10, s[52:55], s28 offen offset:2048   lds
M v[48:51], a[168:171], a[64:67], v[48:51]
 v_add3_u32 v17, v29, v28, s64
 v_add_u32 v19, 12288, v17
M v[48:51], a[172:175], a[68:71], v[48:51]
 v_add_u32 v20, 0x20000, v1
 v_add_u32 v21, 0x20000, v2
M v[52:55], a[172:175], a[76:79], v[52:55]
 ds_read_b64_tr_b16 a[116:117], v3 offset:40960
 ds_read_b64_tr_b16 a[118:119], v3 offset:41984
M v[52:55], a[168:171], a[72:75], v[52:55]
 buffer_load_dwordx4 v11, s[52:55], s28 offen offset:3072   lds
M v[56:59], a[168:171], a[80:83], v[56:59]
 s_add_u32 s28, s28, 1048448
 v_add_u32 v22, 0x20000, v3
 v_add_u32 v23, 0x20000, v4
M v[56:59], a[172:175], a[84:87], v[56:59]
 s_waitcnt lgkmcnt(6)
 v_sub_f32 v204, v204, v27
 v_sub_f32 v205, v205, v27
M v[60:63], a[172:175], a[92:95], v[60:63]
 s_add_u32 m0, s23, 131072
 v_sub_f32 v206, v206, v27
 v_sub_f32 v207, v207, v27
M v[60:63], a[168:171], a[88:91], v[60:63]
 ds_read_b64_tr_b16 a[120:121], v4 offset:32768
 ds_read_b64_tr_b16 a[122:123], v4 offset:33792
M v[64:67], a[160:163], a[32:35], v[64:67]
 ds_read_b128 a[168:171], v5 offset:6144
 ds_read_b128 a[172:175], v6 offset:6144
M v[64:67], a[164:167], a[36:39], v[64:67]
 buffer_load_dwordx4 v8, s[52:55], s28 offen offset:0   lds
M v[68:71], a[164:167], a[44:47], v[68:71]
 buffer_load_dwordx4 v9, s[52:55], s28 offen offset:1024   lds
M v[68:71], a[160:163], a[40:43], v[68:71]
 v_sub_f32 v208, v208, v27
 v_sub_f32 v209, v209, v27
M v[72:75], a[160:163], a[48:51], v[72:75]
 ds_read_b64_tr_b16 a[124:125], v4 offset:40960
 ds_read_b64_tr_b16 a[126:127], v4 offset:41984
M v[72:75], a[164:167], a[52:55], v[72:75]
 buffer_load_dwordx4 v10, s[52:55], s28 offen offset:2048   lds
M v[76:79], a[164:167], a[60:63], v[76:79]
 v_sub_f32 v210, v210, v27
 v_sub_f32 v211, v211, v27
M v[76:79], a[160:163], a[56:59], v[76:79]
 v_sub_f32 v212, v212, v27
 v_sub_f32 v213, v213, v27
M v[80:83], a[160:163], a[64:67], v[80:83]
 buffer_load_dwordx4 v11, s[52:55], s28 offen offset:3072   lds
M v[80:83], a[164:167], a[68:71], v[80:83]
 s_sub_u32 s28, s28, 524288
 v_sub_f32 v214, v214, v27
 v_sub_f32 v215, v215, v27
M v[84:87], a[164:167], a[76:79], v[84:87]
 v_sub_f32 v216, v216, v27
 v_sub_f32 v217, v217, v27
M v[84:87], a[160:163], a[72:75], v[84:87]
 v_sub_f32 v218, v218, v27
 v_sub_f32 v219, v219, v27
M v[88:91], a[160:163], a[80:83], v[88:91]
 v_sub_f32 v220, v220, v27
 v_sub_f32 v221, v221, v27
M v[88:91], a[164:167], a[84:87], v[88:91]
 s_waitcnt lgkmcnt(2)
 v_sub_f32 v222, v222, v27
 v_sub_f32 v223, v223, v27
M v[92:95], a[164:167], a[92:95], v[92:95]
 s_waitcnt vmcnt(21) lgkmcnt(0)
 v_sub_f32 v224, v224, v27
 v_sub_f32 v225, v225, v27
M v[92:95], a[160:163], a[88:91], v[92:95]
 s_barrier
M v[96:99], a[168:171], a[32:35], v[96:99]
 ds_read_b128 a[160:163], v5 offset:16384
 ds_read_b128 a[164:167], v6 offset:16384
M v[96:99], a[172:175], a[36:39], v[96:99]
 v_sub_f32 v226, v226, v27
 v_sub_f32 v227, v227, v27
M v[100:103], a[172:175], a[44:47], v[100:103]
 s_add_u32 m0, s24, 0
 ds_read_b64_tr_b16 a[128:129], v1 offset:49152
 ds_read_b64_tr_b16 a[130:131], v1 offset:50176
M v[100:103], a[168:171], a[40:43], v[100:103]
 buffer_load_dwordx4 v16, s[56:59], s29 offen offset:0   lds
M v[104:107], a[168:171], a[48:51], v[104:107]
 s_mul_i32 s72, s41, 4352
 v_sub_f32 v228, v228, v27
M v[104:107], a[172:175], a[52:55], v[104:107]
 s_add_u32 s46, s72, 104923136
 v_sub_f32 v229, v229, v27
 v_sub_f32 v230, v230, v27
M v[108:111], a[172:175], a[60:63], v[108:111]
 s_lshl_b32 s45, s42, 7
 s_add_u32 s45, s45, s46
 s_sub_u32 s66, 15, s42
M v[108:111], a[168:171], a[56:59], v[108:111]
 buffer_load_dwordx4 v17, s[56:59], s29 offen offset:1024   lds
M v[112:115], a[168:171], a[64:67], v[112:115]
 s_min_u32 s66, s66, s42
 v_sub_f32 v231, v231, v27
M v[112:115], a[172:175], a[68:71], v[112:115]
 s_lshl_b32 s47, s66, 7
 ds_read_b64_tr_b16 a[132:133], v1 offset:57344
 ds_read_b64_tr_b16 a[134:135], v1 offset:58368
M v[116:119], a[172:175], a[76:79], v[116:119]
 s_add_u32 s47, s47, s46
 v_sub_f32 v232, v232, v27
 v_sub_f32 v233, v233, v27
M v[116:119], a[168:171], a[72:75], v[116:119]
 s_add_u32 s47, s47, 2112
 s_lshl_b32 s65, s41, 3
 s_add_u32 s65, s65, s66
M v[120:123], a[168:171], a[80:83], v[120:123]
 buffer_load_dwordx4 v18, s[56:59], s29 offen offset:2048   lds
M v[120:123], a[172:175], a[84:87], v[120:123]
 s_waitcnt lgkmcnt(4)
 s_mul_i32 s34, s65, 73728
 v_sub_f32 v234, v234, v27
M v[124:127], a[172:175], a[92:95], v[124:127]
 s_add_u32 s34, s34, 50331648
 v_sub_f32 v235, v235, v27
 v_sub_f32 v236, v236, v27
M v[124:127], a[168:171], a[88:91], v[124:127]
 s_lshl_b32 s65, s42, 4
 v_sub_f32 v237, v237, v27
 v_sub_f32 v238, v238, v27
M v[128:131], a[160:163], a[32:35], v[128:131]
 s_add_u32 s65, s65, s41
 ds_read_b128 a[168:171], v5 offset:18432
 ds_read_b128 a[172:175], v6 offset:18432
M v[128:131], a[164:167], a[36:39], v[128:131]
 s_mul_i32 s33, s65, 114688
 ds_read_b64_tr_b16 a[136:137], v2 offset:49152
 ds_read_b64_tr_b16 a[138:139], v2 offset:50176
M v[132:135], a[164:167], a[44:47], v[132:135]
 buffer_load_dwordx4 v19, s[56:59], s29 offen offset:3072   lds
M v[132:135], a[160:163], a[40:43], v[132:135]
 s_add_u32 s29, s29, 128
 s_mul_i32 s65, s20, 28672
 v_sub_f32 v239, v239, v27
M v[136:139], a[160:163], a[48:51], v[136:139]
 s_add_u32 s33, s33, s65
 s_add_u32 s33, s33, 67108864
 s_sub_u32 s65, 15, s66
M v[136:139], a[164:167], a[52:55], v[136:139]
 s_add_u32 m0, s23, 32768
 s_lshl_b32 s65, s65, 16
 s_lshl_b32 s64, s41, 20
M v[140:143], a[164:167], a[60:63], v[140:143]
 buffer_load_dwordx4 v8, s[52:55], s28 offen offset:0   lds
M v[140:143], a[160:163], a[56:59], v[140:143]
 ds_read_b64_tr_b16 a[140:141], v2 offset:57344
 ds_read_b64_tr_b16 a[142:143], v2 offset:58368
M v[144:147], a[160:163], a[64:67], v[144:147]
 s_add_u32 s32, s64, s65
 v_sub_f32 v240, v240, v27
M v[144:147], a[164:167], a[68:71], v[144:147]
 s_lshl_b32 s65, s20, 14
 s_add_u32 s32, s32, s65
 s_add_u32 s32, s32, 33554432
M v[148:151], a[164:167], a[76:79], v[148:151]
 buffer_load_dwordx4 v9, s[52:55], s28 offen offset:1024   lds
M v[148:151], a[160:163], a[72:75], v[148:151]
 s_mov_b32 s31, 0x53800000
 v_sub_f32 v241, v241, v27
M v[152:155], a[160:163], a[80:83], v[152:155]
 s_mov_b32 s40, 1
 s_sub_u32 s64, s42, 10
 s_and_b32 s35, s64, 536870912
M v[152:155], a[164:167], a[84:87], v[152:155]
 s_waitcnt lgkmcnt(4)
 v_sub_f32 v242, v242, v27
 v_sub_f32 v243, v243, v27
M v[156:159], a[164:167], a[92:95], v[156:159]
 ds_read_b64_tr_b16 a[144:145], v3 offset:49152
 ds_read_b64_tr_b16 a[146:147], v3 offset:50176
M v[156:159], a[160:163], a[88:91], v[156:159]
 buffer_load_dwordx4 v10, s[52:55], s28 offen offset:2048   lds
M v[160:163], a[168:171], a[32:35], v[160:163]
 ds_read_b128 a[160:163], v5 offset:20480
 ds_read_b128 a[164:167], v6 offset:20480
M v[160:163], a[172:175], a[36:39], v[160:163]
 v_sub_f32 v244, v244, v27
 v_sub_f32 v245, v245, v27
M v[164:167], a[172:175], a[44:47], v[164:167]
 v_sub_f32 v246, v246, v27
 v_sub_f32 v247, v247, v27
M v[164:167], a[168:171], a[40:43], v[164:167]
 v_sub_f32 v248, v248, v27
 v_sub_f32 v249, v249, v27
M v[168:171], a[168:171], a[48:51], v[168:171]
 buffer_load_dwordx4 v11, s[52:55], s28 offen offset:3072   lds
M v[168:171], a[172:175], a[52:55], v[168:171]
 s_add_u32 s28, s28, 524416
 ds_read_b64_tr_b16 a[148:149], v3 offset:57344
 ds_read_b64_tr_b16 a[150:151], v3 offset:58368
M v[172:175], a[172:175], a[60:63], v[172:175]
 v_sub_f32 v250, v250, v27
 v_sub_f32 v251, v251, v27
M v[172:175], a[168:171], a[56:59], v[172:175]
 v_sub_f32 v252, v252, v27
 v_sub_f32 v253, v253, v27
M v[176:179], a[168:171], a[64:67], v[176:179]
 s_add_u32 m0, s23, 147456
 v_sub_f32 v254, v254, v27
 v_sub_f32 v255, v255, v27
M v[176:179], a[172:175], a[68:71], v[176:179]
 buffer_load_dwordx4 v8, s[52:55], s28 offen offset:0   lds
M v[180:183], a[172:175], a[76:79], v[180:183]
M v[180:183], a[168:171], a[72:75], v[180:183]
M v[184:187], a[168:171], a[80:83], v[184:187]
 ds_read_b64_tr_b16 a[152:153], v4 offset:49152
 ds_read_b64_tr_b16 a[154:155], v4 offset:50176
M v[184:187], a[172:175], a[84:87], v[184:187]
 s_waitcnt lgkmcnt(4)
M v[188:191], a[172:175], a[92:95], v[188:191]
 buffer_load_dwordx4 v9, s[52:55], s28 offen offset:1024   lds
M v[188:191], a[168:171], a[88:91], v[188:191]
M v[192:195], a[160:163], a[32:35], v[192:195]
 ds_read_b128 a[168:171], v5 offset:22528
 ds_read_b128 a[172:175], v6 offset:22528
M v[192:195], a[164:167], a[36:39], v[192:195]
M v[196:199], a[164:167], a[44:47], v[196:199]
 buffer_load_dwordx4 v10, s[52:55], s28 offen offset:2048   lds
M v[196:199], a[160:163], a[40:43], v[196:199]
 ds_read_b64_tr_b16 a[156:157], v4 offset:57344
 ds_read_b64_tr_b16 a[158:159], v4 offset:58368
M v[200:203], a[160:163], a[48:51], v[200:203]
M v[200:203], a[164:167], a[52:55], v[200:203]
M v[204:207], a[164:167], a[60:63], v[204:207]
M v[204:207], a[160:163], a[56:59], v[204:207]
 buffer_load_dwordx4 v11, s[52:55], s28 offen offset:3072   lds
M v[208:211], a[160:163], a[64:67], v[208:211]
 s_sub_u32 s28, s28, 524288
M v[208:211], a[164:167], a[68:71], v[208:211]
M v[212:215], a[164:167], a[76:79], v[212:215]
M v[212:215], a[160:163], a[72:75], v[212:215]
M v[216:219], a[160:163], a[80:83], v[216:219]
M v[216:219], a[164:167], a[84:87], v[216:219]
 s_waitcnt lgkmcnt(2)
M v[220:223], a[164:167], a[92:95], v[220:223]
 s_waitcnt vmcnt(25) lgkmcnt(0)
M v[220:223], a[160:163], a[88:91], v[220:223]
 s_barrier
M v[224:227], a[168:171], a[32:35], v[224:227]
 ds_read_b128 a[160:163], v5 offset:32768
 ds_read_b128 a[164:167], v6 offset:32768
M v[224:227], a[172:175], a[36:39], v[224:227]
M v[228:231], a[172:175], a[44:47], v[228:231]
M v[228:231], a[168:171], a[40:43], v[228:231]
M v[232:235], a[168:171], a[48:51], v[232:235]
M v[232:235], a[172:175], a[52:55], v[232:235]
M v[236:239], a[172:175], a[60:63], v[236:239]
M v[236:239], a[168:171], a[56:59], v[236:239]
M v[240:243], a[168:171], a[64:67], v[240:243]
M v[240:243], a[172:175], a[68:71], v[240:243]
M v[244:247], a[172:175], a[76:79], v[244:247]
M v[244:247], a[168:171], a[72:75], v[244:247]
M v[248:251], a[168:171], a[80:83], v[248:251]
M v[248:251], a[172:175], a[84:87], v[248:251]
 s_waitcnt lgkmcnt(0)
M v[252:255], a[172:175], a[92:95], v[252:255]
M v[252:255], a[168:171], a[88:91], v[252:255]
M a[0:3], a[160:163], a[96:99], a[0:3]
 ds_read_b128 a[168:171], v5 offset:34816
 ds_read_b128 a[172:175], v6 offset:34816
M a[0:3], a[164:167], a[100:103], a[0:3]
 ds_read_b64_tr_b16 a[32:33], v1 offset:0
 ds_read_b64_tr_b16 a[34:35], v1 offset:1024
M a[4:7], a[164:167], a[108:111], a[4:7]
 s_add_u32 m0, s24, 16384
M a[4:7], a[160:163], a[104:107], a[4:7]
 buffer_load_dwordx4 v16, s[56:59], s29 offen offset:0   lds
M a[8:11], a[160:163], a[112:115], a[8:11]
M a[8:11], a[164:167], a[116:119], a[8:11]
M a[12:15], a[164:167], a[124:127], a[12:15]
 ds_read_b64_tr_b16 a[36:37], v1 offset:8192
 ds_read_b64_tr_b16 a[38:39], v1 offset:9216
M a[12:15], a[160:163], a[120:123], a[12:15]
M a[16:19], a[160:163], a[128:131], a[16:19]
 buffer_load_dwordx4 v17, s[56:59], s29 offen offset:1024   lds
M a[16:19], a[164:167], a[132:135], a[16:19]
M a[20:23], a[164:167], a[140:143], a[20:23]
M a[20:23], a[160:163], a[136:139], a[20:23]
 ds_read_b64_tr_b16 a[40:41], v2 offset:0
 ds_read_b64_tr_b16 a[42:43], v2 offset:1024
M a[24:27], a[160:163], a[144:147], a[24:27]
M a[24:27], a[164:167], a[148:151], a[24:27]
 s_waitcnt lgkmcnt(6)
 buffer_load_dwordx4 v18, s[56:59], s29 offen offset:2048   lds
M a[28:31], a[164:167], a[156:159], a[28:31]
M a[28:31], a[160:163], a[152:155], a[28:31]
M v[32:35], a[168:171], a[96:99], v[32:35]
 ds_read_b128 a[160:163], v5 offset:36864
 ds_read_b128 a[164:167], v6 offset:36864
M v[32:35], a[172:175], a[100:103], v[32:35]
 ds_read_b64_tr_b16 a[44:45], v2 offset:8192
 ds_read_b64_tr_b16 a[46:47], v2 offset:9216
M v[36:39], a[172:175], a[108:111], v[36:39]
 buffer_load_dwordx4 v19, s[56:59], s29 offen offset:3072   lds
M v[36:39], a[168:171], a[104:107], v[36:39]
 s_add_u32 s29, s29, 128
M v[40:43], a[168:171], a[112:115], v[40:43]
M v[40:43], a[172:175], a[116:119], v[40:43]
 ds_read_b64_tr_b16 a[48:49], v3 offset:0
 ds_read_b64_tr_b16 a[50:51], v3 offset:1024
M v[44:47], a[172:175], a[124:127], v[44:47]
 s_add_u32 m0, s23, 49152
 v_accvgpr_read_b32 v24, a0
 v_accvgpr_read_b32 v25, a1
M v[44:47], a[168:171], a[120:123], v[44:47]
 buffer_load_dwordx4 v8, s[52:55], s28 offen offset:0   lds
M v[48:51], a[168:171], a[128:131], v[48:51]
 v_accvgpr_read_b32 v26, a2
 v_accvgpr_read_b32 v27, a3
M v[48:51], a[172:175], a[132:135], v[48:51]
 v_cvt_pk_bf16_f32 v24, v24, v25
 v_cvt_pk_bf16_f32 v25, v26, v27
M v[52:55], a[172:175], a[140:143], v[52:55]
 ds_read_b64_tr_b16 a[52:53], v3 offset:8192
 ds_read_b64_tr_b16 a[54:55], v3 offset:9216
M v[52:55], a[168:171], a[136:139], v[52:55]
 v_cvt_pk_bf16_f32 v26, v32, v33
 v_cvt_pk_bf16_f32 v27, v34, v35
M v[56:59], a[168:171], a[144:147], v[56:59]
 s_add_u32 s3, s93, 0
 buffer_load_dwordx4 v9, s[52:55], s28 offen offset:1024   lds
M v[56:59], a[172:175], a[148:151], v[56:59]
 s_waitcnt lgkmcnt(6)
M v[60:63], a[172:175], a[156:159], v[60:63]
 buffer_store_dwordx4 v[24:27], v7, s[8:11], s3 offen offset:0 sc1
M v[60:63], a[168:171], a[152:155], v[60:63]
 ds_read_b64_tr_b16 a[56:57], v4 offset:0
 ds_read_b64_tr_b16 a[58:59], v4 offset:1024
M v[64:67], a[160:163], a[96:99], v[64:67]
 ds_read_b128 a[168:171], v5 offset:38912
 ds_read_b128 a[172:175], v6 offset:38912
M v[64:67], a[164:167], a[100:103], v[64:67]
 buffer_load_dwordx4 v10, s[52:55], s28 offen offset:2048   lds
M v[68:71], a[164:167], a[108:111], v[68:71]
 v_accvgpr_read_b32 v24, a4
 v_accvgpr_read_b32 v25, a5
M v[68:71], a[160:163], a[104:107], v[68:71]
 v_accvgpr_read_b32 v26, a6
 v_accvgpr_read_b32 v27, a7
M v[72:75], a[160:163], a[112:115], v[72:75]
 ds_read_b64_tr_b16 a[60:61], v4 offset:8192
 ds_read_b64_tr_b16 a[62:63], v4 offset:9216
M v[72:75], a[164:167], a[116:119], v[72:75]
 v_cvt_pk_bf16_f32 v24, v24, v25
 v_cvt_pk_bf16_f32 v25, v26, v27
M v[76:79], a[164:167], a[124:127], v[76:79]
 buffer_load_dwordx4 v11, s[52:55], s28 offen offset:3072   lds
M v[76:79], a[160:163], a[120:123], v[76:79]
 s_add_u32 s28, s28, 1048448
 v_cvt_pk_bf16_f32 v26, v36, v37
 v_cvt_pk_bf16_f32 v27, v38, v39
M v[80:83], a[160:163], a[128:131], v[80:83]
M v[80:83], a[164:167], a[132:135], v[80:83]
M v[84:87], a[164:167], a[140:143], v[84:87]
 buffer_store_dwordx4 v[24:27], v7, s[8:11], s3 offen offset:2048 sc1
M v[84:87], a[160:163], a[136:139], v[84:87]
M v[88:91], a[160:163], a[144:147], v[88:91]
M v[88:91], a[164:167], a[148:151], v[88:91]
 s_waitcnt lgkmcnt(2)
M v[92:95], a[164:167], a[156:159], v[92:95]
 s_waitcnt vmcnt(26) lgkmcnt(0)
 v_accvgpr_read_b32 v24, a8
 v_accvgpr_read_b32 v25, a9
M v[92:95], a[160:163], a[152:155], v[92:95]
 s_barrier
M v[96:99], a[168:171], a[96:99], v[96:99]
 ds_read_b128 a[160:163], v5 offset:49152
 ds_read_b128 a[164:167], v6 offset:49152
M v[96:99], a[172:175], a[100:103], v[96:99]
 v_accvgpr_read_b32 v26, a10
 v_accvgpr_read_b32 v27, a11
M v[100:103], a[172:175], a[108:111], v[100:103]
 s_add_u32 m0, s24, 32768
 ds_read_b64_tr_b16 a[64:65], v1 offset:16384
 ds_read_b64_tr_b16 a[66:67], v1 offset:17408
M v[100:103], a[168:171], a[104:107], v[100:103]
 buffer_load_dwordx4 v16, s[56:59], s29 offen offset:0   lds
M v[104:107], a[168:171], a[112:115], v[104:107]
 v_cvt_pk_bf16_f32 v24, v24, v25
 v_cvt_pk_bf16_f32 v25, v26, v27
M v[104:107], a[172:175], a[116:119], v[104:107]
 v_cvt_pk_bf16_f32 v26, v40, v41
 v_cvt_pk_bf16_f32 v27, v42, v43
M v[108:111], a[172:175], a[124:127], v[108:111]
 s_add_u32 s3, s93, 4096
 buffer_store_dwordx4 v[24:27], v7, s[8:11], s3 offen offset:0 sc1
M v[108:111], a[168:171], a[120:123], v[108:111]
 v_cvt_pk_bf16_f32 v64, v64, v65
 v_cvt_pk_bf16_f32 v65, v66, v67
M v[112:115], a[168:171], a[128:131], v[112:115]
 v_cvt_pk_bf16_f32 v66, v96, v97
 v_cvt_pk_bf16_f32 v67, v98, v99
M v[112:115], a[172:175], a[132:135], v[112:115]
 ds_read_b64_tr_b16 a[68:69], v1 offset:24576
 ds_read_b64_tr_b16 a[70:71], v1 offset:25600
M v[116:119], a[172:175], a[140:143], v[116:119]
 buffer_load_dwordx4 v17, s[56:59], s29 offen offset:1024   lds
M v[116:119], a[168:171], a[136:139], v[116:119]
 v_accvgpr_read_b32 v24, a12
 v_accvgpr_read_b32 v25, a13
M v[120:123], a[168:171], a[144:147], v[120:123]
 v_accvgpr_read_b32 v26, a14
 v_accvgpr_read_b32 v27, a15
M v[120:123], a[172:175], a[148:151], v[120:123]
 s_waitcnt lgkmcnt(4)
 v_cvt_pk_bf16_f32 v24, v24, v25
 v_cvt_pk_bf16_f32 v25, v26, v27
M v[124:127], a[172:175], a[156:159], v[124:127]
 v_cvt_pk_bf16_f32 v26, v44, v45
 v_cvt_pk_bf16_f32 v27, v46, v47
M v[124:127], a[168:171], a[152:155], v[124:127]
 buffer_store_dwordx4 v[24:27], v7, s[8:11], s3 offen offset:2048 sc1
M v[128:131], a[160:163], a[96:99], v[128:131]
 ds_read_b128 a[168:171], v5 offset:51200
 ds_read_b128 a[172:175], v6 offset:51200
M v[128:131], a[164:167], a[100:103], v[128:131]
 ds_read_b64_tr_b16 a[72:73], v2 offset:16384
 ds_read_b64_tr_b16 a[74:75], v2 offset:17408
M v[132:135], a[164:167], a[108:111], v[132:135]
 buffer_load_dwordx4 v18, s[56:59], s29 offen offset:2048   lds
M v[132:135], a[160:163], a[104:107], v[132:135]
 v_cvt_pk_bf16_f32 v68, v68, v69
 v_cvt_pk_bf16_f32 v69, v70, v71
M v[136:139], a[160:163], a[112:115], v[136:139]
 v_cvt_pk_bf16_f32 v70, v100, v101
 v_cvt_pk_bf16_f32 v71, v102, v103
M v[136:139], a[164:167], a[116:119], v[136:139]
 v_cvt_pk_bf16_f32 v72, v72, v73
 v_cvt_pk_bf16_f32 v73, v74, v75
M v[140:143], a[164:167], a[124:127], v[140:143]
 v_accvgpr_read_b32 v24, a16
 v_accvgpr_read_b32 v25, a17
M v[140:143], a[160:163], a[120:123], v[140:143]
 ds_read_b64_tr_b16 a[76:77], v2 offset:24576
 ds_read_b64_tr_b16 a[78:79], v2 offset:25600
M v[144:147], a[160:163], a[128:131], v[144:147]
 buffer_load_dwordx4 v19, s[56:59], s29 offen offset:3072   lds
M v[144:147], a[164:167], a[132:135], v[144:147]
 s_add_u32 s29, s29, 128
 v_accvgpr_read_b32 v26, a18
 v_accvgpr_read_b32 v27, a19
M v[148:151], a[164:167], a[140:143], v[148:151]
 v_cvt_pk_bf16_f32 v24, v24, v25
 v_cvt_pk_bf16_f32 v25, v26, v27
M v[148:151], a[160:163], a[136:139], v[148:151]
 v_cvt_pk_bf16_f32 v26, v48, v49
 v_cvt_pk_bf16_f32 v27, v50, v51
M v[152:155], a[160:163], a[144:147], v[152:155]
 s_add_u32 s3, s93, 8192
 buffer_store_dwordx4 v[24:27], v7, s[8:11], s3 offen offset:0 sc1
M v[152:155], a[164:167], a[148:151], v[152:155]
 s_waitcnt lgkmcnt(4)
 v_cvt_pk_bf16_f32 v74, v104, v105
 v_cvt_pk_bf16_f32 v75, v106, v107
M v[156:159], a[164:167], a[156:159], v[156:159]
 s_add_u32 m0, s23, 0
 ds_read_b64_tr_b16 a[80:81], v3 offset:16384
 ds_read_b64_tr_b16 a[82:83], v3 offset:17408
M v[156:159], a[160:163], a[152:155], v[156:159]
 buffer_load_dwordx4 v8, s[52:55], s28 offen offset:0   lds
M v[160:163], a[168:171], a[96:99], v[160:163]
 ds_read_b128 a[160:163], v5 offset:53248
 ds_read_b128 a[164:167], v6 offset:53248
M v[160:163], a[172:175], a[100:103], v[160:163]
 v_cvt_pk_bf16_f32 v76, v76, v77
 v_cvt_pk_bf16_f32 v77, v78, v79
M v[164:167], a[172:175], a[108:111], v[164:167]
 v_accvgpr_read_b32 v24, a20
 v_accvgpr_read_b32 v25, a21
M v[164:167], a[168:171], a[104:107], v[164:167]
 v_accvgpr_read_b32 v26, a22
 v_accvgpr_read_b32 v27, a23
M v[168:171], a[168:171], a[112:115], v[168:171]
 v_cvt_pk_bf16_f32 v24, v24, v25
 v_cvt_pk_bf16_f32 v25, v26, v27
M v[168:171], a[172:175], a[116:119], v[168:171]
 ds_read_b64_tr_b16 a[84:85], v3 offset:24576
 ds_read_b64_tr_b16 a[86:87], v3 offset:25600
M v[172:175], a[172:175], a[124:127], v[172:175]
 buffer_load_dwordx4 v9, s[52:55], s28 offen offset:1024   lds
M v[172:175], a[168:171], a[120:123], v[172:175]
 v_cvt_pk_bf16_f32 v26, v52, v53
 v_cvt_pk_bf16_f32 v27, v54, v55
M v[176:179], a[168:171], a[128:131], v[176:179]
 v_cvt_pk_bf16_f32 v78, v108, v109
 v_cvt_pk_bf16_f32 v79, v110, v111
M v[176:179], a[172:175], a[132:135], v[176:179]
 buffer_store_dwordx4 v[24:27], v7, s[8:11], s3 offen offset:2048 sc1
M v[180:183], a[172:175], a[140:143], v[180:183]
 v_cvt_pk_bf16_f32 v80, v80, v81
 v_cvt_pk_bf16_f32 v81, v82, v83
M v[180:183], a[168:171], a[136:139], v[180:183]
 v_cvt_pk_bf16_f32 v82, v112, v113
 v_cvt_pk_bf16_f32 v83, v114, v115
M v[184:187], a[168:171], a[144:147], v[184:187]
 ds_read_b64_tr_b16 a[88:89], v4 offset:16384
 ds_read_b64_tr_b16 a[90:91], v4 offset:17408
M v[184:187], a[172:175], a[148:151], v[184:187]
 s_waitcnt lgkmcnt(4)
 buffer_load_dwordx4 v10, s[52:55], s28 offen offset:2048   lds
M v[188:191], a[172:175], a[156:159], v[188:191]
 v_accvgpr_read_b32 v24, a24
 v_accvgpr_read_b32 v25, a25
M v[188:191], a[168:171], a[152:155], v[188:191]
 v_accvgpr_read_b32 v26, a26
 v_accvgpr_read_b32 v27, a27
M v[192:195], a[160:163], a[96:99], v[192:195]
 ds_read_b128 a[168:171], v5 offset:55296
 ds_read_b128 a[172:175], v6 offset:55296
M v[192:195], a[164:167], a[100:103], v[192:195]
 v_cvt_pk_bf16_f32 v24, v24, v25
 v_cvt_pk_bf16_f32 v25, v26, v27
M v[196:199], a[164:167], a[108:111], v[196:199]
 v_cvt_pk_bf16_f32 v26, v56, v57
 v_cvt_pk_bf16_f32 v27, v58, v59
M v[196:199], a[160:163], a[104:107], v[196:199]
 s_add_u32 s3, s93, 12288
 ds_read_b64_tr_b16 a[92:93], v4 offset:24576
 ds_read_b64_tr_b16 a[94:95], v4 offset:25600
M v[200:203], a[160:163], a[112:115], v[200:203]
 buffer_load_dwordx4 v11, s[52:55], s28 offen offset:3072   lds
M v[200:203], a[164:167], a[116:119], v[200:203]
 s_add_u32 s28, s28, 128
 v_cvt_pk_bf16_f32 v84, v84, v85
 v_cvt_pk_bf16_f32 v85, v86, v87
M v[204:207], a[164:167], a[124:127], v[204:207]
 v_cvt_pk_bf16_f32 v86, v116, v117
 v_cvt_pk_bf16_f32 v87, v118, v119
M v[204:207], a[160:163], a[120:123], v[204:207]
 v_cvt_pk_bf16_f32 v88, v88, v89
 v_cvt_pk_bf16_f32 v89, v90, v91
M v[208:211], a[160:163], a[128:131], v[208:211]
 buffer_store_dwordx4 v[24:27], v7, s[8:11], s3 offen offset:0 sc1
M v[208:211], a[164:167], a[132:135], v[208:211]
 v_cvt_pk_bf16_f32 v90, v120, v121
 v_cvt_pk_bf16_f32 v91, v122, v123
M v[212:215], a[164:167], a[140:143], v[212:215]
 v_accvgpr_read_b32 v24, a28
 v_accvgpr_read_b32 v25, a29
M v[212:215], a[160:163], a[136:139], v[212:215]
 v_accvgpr_read_b32 v26, a30
 v_accvgpr_read_b32 v27, a31
M v[216:219], a[160:163], a[144:147], v[216:219]
 v_cvt_pk_bf16_f32 v24, v24, v25
 v_cvt_pk_bf16_f32 v25, v26, v27
M v[216:219], a[164:167], a[148:151], v[216:219]
 s_waitcnt lgkmcnt(2)
 v_cvt_pk_bf16_f32 v26, v60, v61
 v_cvt_pk_bf16_f32 v27, v62, v63
M v[220:223], a[164:167], a[156:159], v[220:223]
 s_waitcnt vmcnt(27) lgkmcnt(0)
 buffer_store_dwordx4 v[24:27], v7, s[8:11], s3 offen offset:2048 sc1
M v[220:223], a[160:163], a[152:155], v[220:223]
 s_barrier
M v[224:227], a[168:171], a[96:99], v[224:227]
 ds_read_b128 a[160:163], v5 offset:0
 ds_read_b128 a[164:167], v6 offset:0
M v[224:227], a[172:175], a[100:103], v[224:227]
 v_cvt_pk_bf16_f32 v92, v92, v93
 v_cvt_pk_bf16_f32 v93, v94, v95
M v[228:231], a[172:175], a[108:111], v[228:231]
 v_cvt_pk_bf16_f32 v94, v124, v125
 v_cvt_pk_bf16_f32 v95, v126, v127
M v[228:231], a[168:171], a[104:107], v[228:231]
 v_cvt_pk_bf16_f32 v128, v128, v129
 v_cvt_pk_bf16_f32 v129, v130, v131
M v[232:235], a[168:171], a[112:115], v[232:235]
 v_cvt_pk_bf16_f32 v130, v160, v161
 v_cvt_pk_bf16_f32 v131, v162, v163
M v[232:235], a[172:175], a[116:119], v[232:235]
 v_cvt_pk_bf16_f32 v132, v132, v133
 v_cvt_pk_bf16_f32 v133, v134, v135
M v[236:239], a[172:175], a[124:127], v[236:239]
 v_cvt_pk_bf16_f32 v134, v164, v165
 v_cvt_pk_bf16_f32 v135, v166, v167
M v[236:239], a[168:171], a[120:123], v[236:239]
 v_cvt_pk_bf16_f32 v136, v136, v137
 v_cvt_pk_bf16_f32 v137, v138, v139
M v[240:243], a[168:171], a[128:131], v[240:243]
 v_cvt_pk_bf16_f32 v138, v168, v169
 v_cvt_pk_bf16_f32 v139, v170, v171
M v[240:243], a[172:175], a[132:135], v[240:243]
 v_cvt_pk_bf16_f32 v140, v140, v141
 v_cvt_pk_bf16_f32 v141, v142, v143
M v[244:247], a[172:175], a[140:143], v[244:247]
 v_cvt_pk_bf16_f32 v142, v172, v173
 v_cvt_pk_bf16_f32 v143, v174, v175
M v[244:247], a[168:171], a[136:139], v[244:247]
 v_cvt_pk_bf16_f32 v144, v144, v145
 v_cvt_pk_bf16_f32 v145, v146, v147
M v[248:251], a[168:171], a[144:147], v[248:251]
 v_cvt_pk_bf16_f32 v146, v176, v177
 v_cvt_pk_bf16_f32 v147, v178, v179
M v[248:251], a[172:175], a[148:151], v[248:251]
 s_waitcnt lgkmcnt(0)
 v_cvt_pk_bf16_f32 v148, v148, v149
 v_cvt_pk_bf16_f32 v149, v150, v151
M v[252:255], a[172:175], a[156:159], v[252:255]
 v_cvt_pk_bf16_f32 v150, v180, v181
 v_cvt_pk_bf16_f32 v151, v182, v183
M v[252:255], a[168:171], a[152:155], v[252:255]
 v_cvt_pk_bf16_f32 v152, v152, v153
 v_cvt_pk_bf16_f32 v153, v154, v155
M v[32:35], a[32:35], a[160:163], 0
 s_add_u32 m0, s23, 16384
 ds_read_b128 a[168:171], v5 offset:2048
 ds_read_b128 a[172:175], v6 offset:2048
M v[32:35], a[36:39], a[164:167], v[32:35]
 ds_read_b64_tr_b16 a[96:97], v1 offset:32768
 ds_read_b64_tr_b16 a[98:99], v1 offset:33792
M v[36:39], a[44:47], a[164:167], 0
 buffer_load_dwordx4 v8, s[52:55], s28 offen offset:0   lds
M v[36:39], a[40:43], a[160:163], v[36:39]
 v_cvt_pk_bf16_f32 v154, v184, v185
 v_cvt_pk_bf16_f32 v155, v186, v187
M v[40:43], a[48:51], a[160:163], 0
 ds_read_b64_tr_b16 a[100:101], v1 offset:40960
 ds_read_b64_tr_b16 a[102:103], v1 offset:41984
M v[40:43], a[52:55], a[164:167], v[40:43]
 buffer_load_dwordx4 v9, s[52:55], s28 offen offset:1024   lds
M v[44:47], a[60:63], a[164:167], 0
 v_cvt_pk_bf16_f32 v156, v156, v157
 v_cvt_pk_bf16_f32 v157, v158, v159
M v[44:47], a[56:59], a[160:163], v[44:47]
 ds_read_b64_tr_b16 a[104:105], v2 offset:32768
 ds_read_b64_tr_b16 a[106:107], v2 offset:33792
M v[48:51], a[64:67], a[160:163], 0
 v_cvt_pk_bf16_f32 v158, v188, v189
 v_cvt_pk_bf16_f32 v159, v190, v191
M v[48:51], a[68:71], a[164:167], v[48:51]
 v_cvt_pk_bf16_f32 v192, v192, v193
 v_cvt_pk_bf16_f32 v193, v194, v195
M v[52:55], a[76:79], a[164:167], 0
 ds_read_b64_tr_b16 a[108:109], v2 offset:40960
 ds_read_b64_tr_b16 a[110:111], v2 offset:41984
M v[52:55], a[72:75], a[160:163], v[52:55]
 buffer_load_dwordx4 v10, s[52:55], s28 offen offset:2048   lds
M v[56:59], a[80:83], a[160:163], 0
 v_cvt_pk_bf16_f32 v194, v224, v225
 v_cvt_pk_bf16_f32 v195, v226, v227
M v[56:59], a[84:87], a[164:167], v[56:59]
 s_waitcnt lgkmcnt(8)
 ds_read_b64_tr_b16 a[112:113], v3 offset:32768
 ds_read_b64_tr_b16 a[114:115], v3 offset:33792
M v[60:63], a[92:95], a[164:167], 0
 v_cvt_pk_bf16_f32 v196, v196, v197
 v_cvt_pk_bf16_f32 v197, v198, v199
M v[60:63], a[88:91], a[160:163], v[60:63]
 buffer_load_dwordx4 v11, s[52:55], s28 offen offset:3072   lds
M v[96:99], a[32:35], a[168:171], 0
 s_add_u32 s28, s28, 524160
 ds_read_b128 a[160:163], v5 offset:4096
 ds_read_b128 a[164:167], v6 offset:4096
M v[96:99], a[36:39], a[172:175], v[96:99]
 ds_read_b64_tr_b16 a[116:117], v3 offset:40960
 ds_read_b64_tr_b16 a[118:119], v3 offset:41984
M v[100:103], a[44:47], a[172:175], 0
 v_cvt_pk_bf16_f32 v198, v228, v229
 v_cvt_pk_bf16_f32 v199, v230, v231
M v[100:103], a[40:43], a[168:171], v[100:103]
 s_add_u32 m0, s24, 49152
 ds_read_b64_tr_b16 a[120:121], v4 offset:32768
 ds_read_b64_tr_b16 a[122:123], v4 offset:33792
M v[104:107], a[48:51], a[168:171], 0
 buffer_load_dwordx4 v16, s[56:59], s29 offen offset:0   lds
M v[104:107], a[52:55], a[172:175], v[104:107]
 v_cvt_pk_bf16_f32 v200, v200, v201
 v_cvt_pk_bf16_f32 v201, v202, v203
M v[108:111], a[60:63], a[172:175], 0
 ds_read_b64_tr_b16 a[124:125], v4 offset:40960
 ds_read_b64_tr_b16 a[126:127], v4 offset:41984
M v[108:111], a[56:59], a[168:171], v[108:111]
 v_cvt_pk_bf16_f32 v202, v232, v233
 v_cvt_pk_bf16_f32 v203, v234, v235
M v[112:115], a[64:67], a[168:171], 0
 v_cvt_pk_bf16_f32 v204, v204, v205
 v_cvt_pk_bf16_f32 v205, v206, v207
M v[112:115], a[68:71], a[172:175], v[112:115]
 buffer_load_dwordx4 v17, s[56:59], s29 offen offset:1024   lds
M v[116:119], a[76:79], a[172:175], 0
 v_cvt_pk_bf16_f32 v206, v236, v237
 v_cvt_pk_bf16_f32 v207, v238, v239
M v[116:119], a[72:75], a[168:171], v[116:119]
 v_cvt_pk_bf16_f32 v208, v208, v209
 v_cvt_pk_bf16_f32 v209, v210, v211
M v[120:123], a[80:83], a[168:171], 0
 v_cvt_pk_bf16_f32 v210, v240, v241
 v_cvt_pk_bf16_f32 v211, v242, v243
M v[120:123], a[84:87], a[172:175], v[120:123]
 s_waitcnt lgkmcnt(6)
 v_cvt_pk_bf16_f32 v212, v212, v213
 v_cvt_pk_bf16_f32 v213, v214, v215
M v[124:127], a[92:95], a[172:175], 0
 s_waitcnt vmcnt(21) lgkmcnt(0)
 buffer_load_dwordx4 v18, s[56:59], s29 offen offset:2048   lds
M v[124:127], a[88:91], a[168:171], v[124:127]
 s_barrier
M v[160:163], a[32:35], a[160:163], 0
 ds_read_b128 a[168:171], v5 offset:6144
 ds_read_b128 a[172:175], v6 offset:6144
M v[160:163], a[36:39], a[164:167], v[160:163]
 ds_read_b64_tr_b16 a[128:129], v1 offset:49152
 ds_read_b64_tr_b16 a[130:131], v1 offset:50176
M v[164:167], a[44:47], a[164:167], 0
 v_cvt_pk_bf16_f32 v214, v244, v245
 v_cvt_pk_bf16_f32 v215, v246, v247
M v[164:167], a[40:43], a[160:163], v[164:167]
 buffer_load_dwordx4 v19, s[56:59], s29 offen offset:3072   lds
M v[168:171], a[48:51], a[160:163], 0
 s_add_u32 s29, s29, 128
 ds_read_b64_tr_b16 a[132:133], v1 offset:57344
 ds_read_b64_tr_b16 a[134:135], v1 offset:58368
M v[168:171], a[52:55], a[164:167], v[168:171]
 v_cvt_pk_bf16_f32 v216, v216, v217
 v_cvt_pk_bf16_f32 v217, v218, v219
M v[172:175], a[60:63], a[164:167], 0
 v_cvt_pk_bf16_f32 v218, v248, v249
 v_cvt_pk_bf16_f32 v219, v250, v251
M v[172:175], a[56:59], a[160:163], v[172:175]
 s_add_u32 m0, s23, 32768
 ds_read_b64_tr_b16 a[136:137], v2 offset:49152
 ds_read_b64_tr_b16 a[138:139], v2 offset:50176
M v[176:179], a[64:67], a[160:163], 0
 buffer_load_dwordx4 v8, s[52:55], s28 offen offset:0   lds
M v[176:179], a[68:71], a[164:167], v[176:179]
 v_cvt_pk_bf16_f32 v220, v220, v221
 v_cvt_pk_bf16_f32 v221, v222, v223
M v[180:183], a[76:79], a[164:167], 0
 ds_read_b64_tr_b16 a[140:141], v2 offset:57344
 ds_read_b64_tr_b16 a[142:143], v2 offset:58368
M v[180:183], a[72:75], a[160:163], v[180:183]
 v_cvt_pk_bf16_f32 v222, v252, v253
 v_cvt_pk_bf16_f32 v223, v254, v255
M v[184:187], a[80:83], a[160:163], 0
 s_add_u32 s3, s93, 262144
 v_mov_b32 v12, 1
 v_or_b32 v15, s20, v0
M v[184:187], a[84:87], a[164:167], v[184:187]
 s_waitcnt lgkmcnt(8)
 ds_read_b64_tr_b16 a[144:145], v3 offset:49152
 ds_read_b64_tr_b16 a[146:147], v3 offset:50176
M v[188:191], a[92:95], a[164:167], 0
 buffer_load_dwordx4 v9, s[52:55], s28 offen offset:1024   lds
M v[188:191], a[88:91], a[160:163], v[188:191]
 v_min_u32 v15, 1, v15
 v_lshlrev_b32 v15, 29, v15
M v[224:227], a[32:35], a[168:171], 0
 ds_read_b128 a[160:163], v5 offset:16384
 ds_read_b128 a[164:167], v6 offset:16384
M v[224:227], a[36:39], a[172:175], v[224:227]
 ds_read_b64_tr_b16 a[148:149], v3 offset:57344
 ds_read_b64_tr_b16 a[150:151], v3 offset:58368
M v[228:231], a[44:47], a[172:175], 0
 buffer_load_dwordx4 v10, s[52:55], s28 offen offset:2048   lds
M v[228:231], a[40:43], a[168:171], v[228:231]
 ds_read_b64_tr_b16 a[152:153], v4 offset:49152
 ds_read_b64_tr_b16 a[154:155], v4 offset:50176
M v[232:235], a[48:51], a[168:171], 0
 buffer_store_dwordx4 v[64:67], v7, s[8:11], s3 offen offset:0 sc1
M v[232:235], a[52:55], a[172:175], v[232:235]
M v[236:239], a[60:63], a[172:175], 0
 ds_read_b64_tr_b16 a[156:157], v4 offset:57344
 ds_read_b64_tr_b16 a[158:159], v4 offset:58368
M v[236:239], a[56:59], a[168:171], v[236:239]
 buffer_load_dwordx4 v11, s[52:55], s28 offen offset:3072   lds
M v[240:243], a[64:67], a[168:171], 0
 s_add_u32 s28, s28, 128
M v[240:243], a[68:71], a[172:175], v[240:243]
 buffer_store_dwordx4 v[68:71], v7, s[8:11], s3 offen offset:2048 sc1
M v[244:247], a[76:79], a[172:175], 0
M v[244:247], a[72:75], a[168:171], v[244:247]
M v[248:251], a[80:83], a[168:171], 0
M v[248:251], a[84:87], a[172:175], v[248:251]
 s_waitcnt lgkmcnt(6)
M v[252:255], a[92:95], a[172:175], 0
 s_waitcnt vmcnt(14) lgkmcnt(0)
M v[252:255], a[88:91], a[168:171], v[252:255]
 s_barrier
M v[32:35], a[96:99], a[160:163], v[32:35]
 s_add_u32 m0, s23, 49152
 ds_read_b128 a[168:171], v5 offset:18432
 ds_read_b128 a[172:175], v6 offset:18432
M v[32:35], a[100:103], a[164:167], v[32:35]
 ds_read_b64_tr_b16 a[32:33], v20 offset:0
 ds_read_b64_tr_b16 a[34:35], v20 offset:1024
M v[36:39], a[108:111], a[164:167], v[36:39]
 s_mov_b32 s39, 67
 buffer_load_dwordx4 v8, s[52:55], s28 offen offset:0   lds
M v[36:39], a[104:107], a[160:163], v[36:39]
 s_cmp_lt_u32 s42, 2
 buffer_store_dword v12, v15, s[8:11], s45 offen sc1
M v[40:43], a[112:115], a[160:163], v[40:43]
 s_cselect_b32 s39, 4, s39
 ds_read_b64_tr_b16 a[36:37], v20 offset:8192
 ds_read_b64_tr_b16 a[38:39], v20 offset:9216
M v[40:43], a[116:119], a[164:167], v[40:43]
 s_lshl_b32 s64, s20, 14
 buffer_load_dwordx4 v9, s[52:55], s28 offen offset:1024   lds
M v[44:47], a[124:127], a[164:167], v[44:47]
 s_add_u32 s12, s64, s34
 s_add_u32 s3, s93, 266240
M v[44:47], a[120:123], a[160:163], v[44:47]
 s_add_u32 s13, s12, 4096
 ds_read_b64_tr_b16 a[40:41], v21 offset:0
 ds_read_b64_tr_b16 a[42:43], v21 offset:1024
M v[48:51], a[128:131], a[160:163], v[48:51]
 s_add_u32 s14, s12, 8192
 buffer_store_dwordx4 v[72:75], v7, s[8:11], s3 offen offset:0 sc1
M v[48:51], a[132:135], a[164:167], v[48:51]
 s_add_u32 s15, s12, 12288
M v[52:55], a[140:143], a[164:167], v[52:55]
 ds_read_b64_tr_b16 a[44:45], v21 offset:8192
 ds_read_b64_tr_b16 a[46:47], v21 offset:9216
M v[52:55], a[136:139], a[160:163], v[52:55]
 buffer_load_dwordx4 v10, s[52:55], s28 offen offset:2048   lds
M v[56:59], a[144:147], a[160:163], v[56:59]
M v[56:59], a[148:151], a[164:167], v[56:59]
 s_waitcnt lgkmcnt(8)
 ds_read_b64_tr_b16 a[48:49], v22 offset:0
 ds_read_b64_tr_b16 a[50:51], v22 offset:1024
M v[60:63], a[156:159], a[164:167], v[60:63]
M v[60:63], a[152:155], a[160:163], v[60:63]
 buffer_load_dwordx4 v11, s[52:55], s28 offen offset:3072   lds
M v[96:99], a[96:99], a[168:171], v[96:99]
 s_add_u32 s28, s28, 524160
 ds_read_b128 a[160:163], v5 offset:20480
 ds_read_b128 a[164:167], v6 offset:20480
M v[96:99], a[100:103], a[172:175], v[96:99]
 ds_read_b64_tr_b16 a[52:53], v22 offset:8192
 ds_read_b64_tr_b16 a[54:55], v22 offset:9216
M v[100:103], a[108:111], a[172:175], v[100:103]
M v[100:103], a[104:107], a[168:171], v[100:103]
 s_add_u32 m0, s24, 0
 ds_read_b64_tr_b16 a[56:57], v23 offset:0
 ds_read_b64_tr_b16 a[58:59], v23 offset:1024
M v[104:107], a[112:115], a[168:171], v[104:107]
 buffer_load_dwordx4 v16, s[56:59], s29 offen offset:0   lds
M v[104:107], a[116:119], a[172:175], v[104:107]
M v[108:111], a[124:127], a[172:175], v[108:111]
 ds_read_b64_tr_b16 a[60:61], v23 offset:8192
 ds_read_b64_tr_b16 a[62:63], v23 offset:9216
M v[108:111], a[120:123], a[168:171], v[108:111]
M v[112:115], a[128:131], a[168:171], v[112:115]
M v[112:115], a[132:135], a[172:175], v[112:115]
 buffer_load_dwordx4 v17, s[56:59], s29 offen offset:1024   lds
M v[116:119], a[140:143], a[172:175], v[116:119]
M v[116:119], a[136:139], a[168:171], v[116:119]
M v[120:123], a[144:147], a[168:171], v[120:123]
M v[120:123], a[148:151], a[172:175], v[120:123]
 s_waitcnt lgkmcnt(6)
M v[124:127], a[156:159], a[172:175], v[124:127]
 s_waitcnt lgkmcnt(0)
 buffer_load_dwordx4 v18, s[56:59], s29 offen offset:2048   lds
M v[124:127], a[152:155], a[168:171], v[124:127]
 s_barrier
M v[160:163], a[96:99], a[160:163], v[160:163]
 ds_read_b128 a[168:171], v5 offset:22528
 ds_read_b128 a[172:175], v6 offset:22528
M v[160:163], a[100:103], a[164:167], v[160:163]
 ds_read_b64_tr_b16 a[64:65], v20 offset:16384
 ds_read_b64_tr_b16 a[66:67], v20 offset:17408
M v[164:167], a[108:111], a[164:167], v[164:167]
M v[164:167], a[104:107], a[160:163], v[164:167]
 buffer_load_dwordx4 v19, s[56:59], s29 offen offset:3072   lds
M v[168:171], a[112:115], a[160:163], v[168:171]
 s_add_u32 s29, s29, 128
 ds_read_b64_tr_b16 a[68:69], v20 offset:24576
 ds_read_b64_tr_b16 a[70:71], v20 offset:25600
M v[168:171], a[116:119], a[164:167], v[168:171]
 buffer_store_dwordx4 v[76:79], v7, s[8:11], s3 offen offset:2048 sc1
M v[172:175], a[124:127], a[164:167], v[172:175]
M v[172:175], a[120:123], a[160:163], v[172:175]
 s_add_u32 m0, s23, 131072
 ds_read_b64_tr_b16 a[72:73], v21 offset:16384
 ds_read_b64_tr_b16 a[74:75], v21 offset:17408
M v[176:179], a[128:131], a[160:163], v[176:179]
 buffer_load_dwordx4 v8, s[52:55], s28 offen offset:0   lds
M v[176:179], a[132:135], a[164:167], v[176:179]
M v[180:183], a[140:143], a[164:167], v[180:183]
 ds_read_b64_tr_b16 a[76:77], v21 offset:24576
 ds_read_b64_tr_b16 a[78:79], v21 offset:25600
M v[180:183], a[136:139], a[160:163], v[180:183]
M v[184:187], a[144:147], a[160:163], v[184:187]
M v[184:187], a[148:151], a[164:167], v[184:187]
 s_waitcnt lgkmcnt(8)
 ds_read_b64_tr_b16 a[80:81], v22 offset:16384
 ds_read_b64_tr_b16 a[82:83], v22 offset:17408
M v[188:191], a[156:159], a[164:167], v[188:191]
 buffer_load_dwordx4 v9, s[52:55], s28 offen offset:1024   lds
M v[188:191], a[152:155], a[160:163], v[188:191]
M v[224:227], a[96:99], a[168:171], v[224:227]
 ds_read_b128 a[160:163], v5 offset:32768
 ds_read_b128 a[164:167], v6 offset:32768
M v[224:227], a[100:103], a[172:175], v[224:227]
 ds_read_b64_tr_b16 a[84:85], v22 offset:24576
 ds_read_b64_tr_b16 a[86:87], v22 offset:25600
M v[228:231], a[108:111], a[172:175], v[228:231]
 buffer_load_dwordx4 v10, s[52:55], s28 offen offset:2048   lds
M v[228:231], a[104:107], a[168:171], v[228:231]
 ds_read_b64_tr_b16 a[88:89], v23 offset:16384
 ds_read_b64_tr_b16 a[90:91], v23 offset:17408
M v[232:235], a[112:115], a[168:171], v[232:235]
M v[232:235], a[116:119], a[172:175], v[232:235]
M v[236:239], a[124:127], a[172:175], v[236:239]
 ds_read_b64_tr_b16 a[92:93], v23 offset:24576
 ds_read_b64_tr_b16 a[94:95], v23 offset:25600
M v[236:239], a[120:123], a[168:171], v[236:239]
 buffer_load_dwordx4 v11, s[52:55], s28 offen offset:3072   lds
M v[240:243], a[128:131], a[168:171], v[240:243]
 s_add_u32 s28, s28, 128
M v[240:243], a[132:135], a[172:175], v[240:243]
M v[244:247], a[140:143], a[172:175], v[244:247]
M v[244:247], a[136:139], a[168:171], v[244:247]
M v[248:251], a[144:147], a[168:171], v[248:251]
M v[248:251], a[148:151], a[172:175], v[248:251]
 s_waitcnt lgkmcnt(6)
M v[252:255], a[156:159], a[172:175], v[252:255]
 s_waitcnt lgkmcnt(0)
M v[252:255], a[152:155], a[168:171], v[252:255]
 s_barrier
M v[32:35], a[32:35], a[160:163], v[32:35]
 s_add_u32 m0, s23, 147456
 ds_read_b128 a[168:171], v5 offset:34816
 ds_read_b128 a[172:175], v6 offset:34816
M v[32:35], a[36:39], a[164:167], v[32:35]
 ds_read_b64_tr_b16 a[96:97], v1 offset:0
 ds_read_b64_tr_b16 a[98:99], v1 offset:1024
M v[36:39], a[44:47], a[164:167], v[36:39]
 buffer_load_dwordx4 v8, s[52:55], s28 offen offset:0   lds
M v[36:39], a[40:43], a[160:163], v[36:39]
 v_and_b32 v29, 15, v0
 v_mul_u32_u24 v30, 1792, v29
M v[40:43], a[48:51], a[160:163], v[40:43]
 s_add_u32 s3, s93, 270336
 ds_read_b64_tr_b16 a[100:101], v1 offset:8192
 ds_read_b64_tr_b16 a[102:103], v1 offset:9216
M v[40:43], a[52:55], a[164:167], v[40:43]
 buffer_load_dwordx4 v9, s[52:55], s28 offen offset:1024   lds
M v[44:47], a[60:63], a[164:167], v[44:47]
 v_lshrrev_b32 v31, 4, v0
 v_lshl_add_u32 v30, v31, 4, v30
M v[44:47], a[56:59], a[160:163], v[44:47]
 ds_read_b64_tr_b16 a[104:105], v2 offset:0
 ds_read_b64_tr_b16 a[106:107], v2 offset:1024
M v[48:51], a[64:67], a[160:163], v[48:51]
 v_lshrrev_b32 v29, 1, v29
 v_min_u32 v29, 1, v29
M v[48:51], a[68:71], a[164:167], v[48:51]
 v_lshl_or_b32 v30, v29, 29, v30
 v_or_b32 v30, s88, v30
M v[52:55], a[76:79], a[164:167], v[52:55]
 s_mul_i32 s89, s86, 3584
 ds_read_b64_tr_b16 a[108:109], v2 offset:8192
 ds_read_b64_tr_b16 a[110:111], v2 offset:9216
M v[52:55], a[72:75], a[160:163], v[52:55]
 s_mul_i32 s64, s20, 448
 buffer_load_dwordx4 v10, s[52:55], s28 offen offset:2048   lds
M v[56:59], a[80:83], a[160:163], v[56:59]
 s_add_u32 s89, s89, s64
 s_add_u32 s89, s89, 105906176
M v[56:59], a[84:87], a[164:167], v[56:59]
 s_waitcnt lgkmcnt(8)
 ds_read_b64_tr_b16 a[112:113], v3 offset:0
 ds_read_b64_tr_b16 a[114:115], v3 offset:1024
M v[60:63], a[92:95], a[164:167], v[60:63]
 buffer_store_dwordx4 v[80:83], v7, s[8:11], s3 offen offset:0 sc1
M v[60:63], a[88:91], a[160:163], v[60:63]
 buffer_load_dwordx4 v11, s[52:55], s28 offen offset:3072   lds
M v[96:99], a[32:35], a[168:171], v[96:99]
 s_add_u32 s28, s28, 524160
 ds_read_b128 a[160:163], v5 offset:36864
 ds_read_b128 a[164:167], v6 offset:36864
M v[96:99], a[36:39], a[172:175], v[96:99]
 ds_read_b64_tr_b16 a[116:117], v3 offset:8192
 ds_read_b64_tr_b16 a[118:119], v3 offset:9216
M v[100:103], a[44:47], a[172:175], v[100:103]
M v[100:103], a[40:43], a[168:171], v[100:103]
 s_add_u32 m0, s24, 16384
 ds_read_b64_tr_b16 a[120:121], v4 offset:0
 ds_read_b64_tr_b16 a[122:123], v4 offset:1024
M v[104:107], a[48:51], a[168:171], v[104:107]
 buffer_load_dwordx4 v16, s[56:59], s29 offen offset:0   lds
M v[104:107], a[52:55], a[172:175], v[104:107]
M v[108:111], a[60:63], a[172:175], v[108:111]
 ds_read_b64_tr_b16 a[124:125], v4 offset:8192
 ds_read_b64_tr_b16 a[126:127], v4 offset:9216
M v[108:111], a[56:59], a[168:171], v[108:111]
M v[112:115], a[64:67], a[168:171], v[112:115]
M v[112:115], a[68:71], a[172:175], v[112:115]
 buffer_load_dwordx4 v17, s[56:59], s29 offen offset:1024   lds
M v[116:119], a[76:79], a[172:175], v[116:119]
M v[116:119], a[72:75], a[168:171], v[116:119]
M v[120:123], a[80:83], a[168:171], v[120:123]
M v[120:123], a[84:87], a[172:175], v[120:123]
 s_waitcnt lgkmcnt(6)
M v[124:127], a[92:95], a[172:175], v[124:127]
 s_waitcnt vmcnt(28) lgkmcnt(0)
 buffer_load_dwordx4 v18, s[56:59], s29 offen offset:2048   lds
M v[124:127], a[88:91], a[168:171], v[124:127]
 s_barrier
M v[160:163], a[32:35], a[160:163], v[160:163]
 ds_read_b128 a[168:171], v5 offset:38912
 ds_read_b128 a[172:175], v6 offset:38912
M v[160:163], a[36:39], a[164:167], v[160:163]
 ds_read_b64_tr_b16 a[128:129], v1 offset:16384
 ds_read_b64_tr_b16 a[130:131], v1 offset:17408
M v[164:167], a[44:47], a[164:167], v[164:167]
M v[164:167], a[40:43], a[160:163], v[164:167]
 buffer_load_dwordx4 v19, s[56:59], s29 offen offset:3072   lds
M v[168:171], a[48:51], a[160:163], v[168:171]
 s_add_u32 s29, s29, 128
 ds_read_b64_tr_b16 a[132:133], v1 offset:24576
 ds_read_b64_tr_b16 a[134:135], v1 offset:25600
M v[168:171], a[52:55], a[164:167], v[168:171]
 buffer_store_dwordx4 v[84:87], v7, s[8:11], s3 offen offset:2048 sc1
M v[172:175], a[60:63], a[164:167], v[172:175]
M v[172:175], a[56:59], a[160:163], v[172:175]
 s_add_u32 m0, s23, 0
 ds_read_b64_tr_b16 a[136:137], v2 offset:16384
 ds_read_b64_tr_b16 a[138:139], v2 offset:17408
M v[176:179], a[64:67], a[160:163], v[176:179]
 buffer_load_dwordx4 v8, s[52:55], s28 offen offset:0   lds
M v[176:179], a[68:71], a[164:167], v[176:179]
M v[180:183], a[76:79], a[164:167], v[180:183]
 ds_read_b64_tr_b16 a[140:141], v2 offset:24576
 ds_read_b64_tr_b16 a[142:143], v2 offset:25600
M v[180:183], a[72:75], a[160:163], v[180:183]
M v[184:187], a[80:83], a[160:163], v[184:187]
M v[184:187], a[84:87], a[164:167], v[184:187]
 s_waitcnt lgkmcnt(8)
 ds_read_b64_tr_b16 a[144:145], v3 offset:16384
 ds_read_b64_tr_b16 a[146:147], v3 offset:17408
M v[188:191], a[92:95], a[164:167], v[188:191]
 buffer_load_dwordx4 v9, s[52:55], s28 offen offset:1024   lds
M v[188:191], a[88:91], a[160:163], v[188:191]
M v[224:227], a[32:35], a[168:171], v[224:227]
 ds_read_b128 a[160:163], v5 offset:49152
 ds_read_b128 a[164:167], v6 offset:49152
M v[224:227], a[36:39], a[172:175], v[224:227]
 ds_read_b64_tr_b16 a[148:149], v3 offset:24576
 ds_read_b64_tr_b16 a[150:151], v3 offset:25600
M v[228:231], a[44:47], a[172:175], v[228:231]
 buffer_load_dwordx4 v10, s[52:55], s28 offen offset:2048   lds
M v[228:231], a[40:43], a[168:171], v[228:231]
 ds_read_b64_tr_b16 a[152:153], v4 offset:16384
 ds_read_b64_tr_b16 a[154:155], v4 offset:17408
M v[232:235], a[48:51], a[168:171], v[232:235]
M v[232:235], a[52:55], a[172:175], v[232:235]
M v[236:239], a[60:63], a[172:175], v[236:239]
 ds_read_b64_tr_b16 a[156:157], v4 offset:24576
 ds_read_b64_tr_b16 a[158:159], v4 offset:25600
M v[236:239], a[56:59], a[168:171], v[236:239]
 buffer_load_dwordx4 v11, s[52:55], s28 offen offset:3072   lds
M v[240:243], a[64:67], a[168:171], v[240:243]
 s_add_u32 s28, s28, 128
M v[240:243], a[68:71], a[172:175], v[240:243]
M v[244:247], a[76:79], a[172:175], v[244:247]
M v[244:247], a[72:75], a[168:171], v[244:247]
M v[248:251], a[80:83], a[168:171], v[248:251]
M v[248:251], a[84:87], a[172:175], v[248:251]
 s_waitcnt lgkmcnt(6)
M v[252:255], a[92:95], a[172:175], v[252:255]
 s_waitcnt vmcnt(30) lgkmcnt(0)
M v[252:255], a[88:91], a[168:171], v[252:255]
 s_barrier
M v[32:35], a[96:99], a[160:163], v[32:35]
 s_add_u32 m0, s23, 16384
 ds_read_b128 a[168:171], v5 offset:51200
 ds_read_b128 a[172:175], v6 offset:51200
M v[32:35], a[100:103], a[164:167], v[32:35]
 ds_read_b64_tr_b16 a[32:33], v1 offset:32768
 ds_read_b64_tr_b16 a[34:35], v1 offset:33792
M v[36:39], a[108:111], a[164:167], v[36:39]
 buffer_load_dwordx4 v8, s[52:55], s28 offen offset:0   lds
M v[36:39], a[104:107], a[160:163], v[36:39]
 v_min_u32 v25, 15, v0
 v_lshlrev_b32 v25, 7, v25
M v[40:43], a[112:115], a[160:163], v[40:43]
 s_add_u32 s3, s93, 274432
 ds_read_b64_tr_b16 a[36:37], v1 offset:40960
 ds_read_b64_tr_b16 a[38:39], v1 offset:41984
M v[40:43], a[116:119], a[164:167], v[40:43]
 v_max_u32 v13, 1024, v25
M v[44:47], a[124:127], a[164:167], v[44:47]
 buffer_store_dwordx4 v[88:91], v7, s[8:11], s3 offen offset:0 sc1
M v[44:47], a[120:123], a[160:163], v[44:47]
 ds_read_b64_tr_b16 a[40:41], v2 offset:32768
 ds_read_b64_tr_b16 a[42:43], v2 offset:33792
M v[48:51], a[128:131], a[160:163], v[48:51]
 buffer_load_dwordx4 v9, s[52:55], s28 offen offset:1024   lds
M v[48:51], a[132:135], a[164:167], v[48:51]
M v[52:55], a[140:143], a[164:167], v[52:55]
 ds_read_b64_tr_b16 a[44:45], v2 offset:40960
 ds_read_b64_tr_b16 a[46:47], v2 offset:41984
M v[52:55], a[136:139], a[160:163], v[52:55]
M v[56:59], a[144:147], a[160:163], v[56:59]
M v[56:59], a[148:151], a[164:167], v[56:59]
 s_waitcnt lgkmcnt(8)
 ds_read_b64_tr_b16 a[48:49], v3 offset:32768
 ds_read_b64_tr_b16 a[50:51], v3 offset:33792
M v[60:63], a[156:159], a[164:167], v[60:63]
 buffer_load_dwordx4 v10, s[52:55], s28 offen offset:2048   lds
M v[60:63], a[152:155], a[160:163], v[60:63]
M v[96:99], a[96:99], a[168:171], v[96:99]
 ds_read_b128 a[160:163], v5 offset:53248
 ds_read_b128 a[164:167], v6 offset:53248
M v[96:99], a[100:103], a[172:175], v[96:99]
 ds_read_b64_tr_b16 a[52:53], v3 offset:40960
 ds_read_b64_tr_b16 a[54:55], v3 offset:41984
M v[100:103], a[108:111], a[172:175], v[100:103]
 buffer_store_dwordx4 v[92:95], v7, s[8:11], s3 offen offset:2048 sc1
M v[100:103], a[104:107], a[168:171], v[100:103]
 ds_read_b64_tr_b16 a[56:57], v4 offset:32768
 ds_read_b64_tr_b16 a[58:59], v4 offset:33792
M v[104:107], a[112:115], a[168:171], v[104:107]
M v[104:107], a[116:119], a[172:175], v[104:107]
 buffer_load_dwordx4 v11, s[52:55], s28 offen offset:3072   lds
M v[108:111], a[124:127], a[172:175], v[108:111]
 s_add_u32 s28, s28, 524160
 ds_read_b64_tr_b16 a[60:61], v4 offset:40960
 ds_read_b64_tr_b16 a[62:63], v4 offset:41984
M v[108:111], a[120:123], a[168:171], v[108:111]
M v[112:115], a[128:131], a[168:171], v[112:115]
M v[112:115], a[132:135], a[172:175], v[112:115]
M v[116:119], a[140:143], a[172:175], v[116:119]
M v[116:119], a[136:139], a[168:171], v[116:119]
M v[120:123], a[144:147], a[168:171], v[120:123]
M v[120:123], a[148:151], a[172:175], v[120:123]
 s_waitcnt lgkmcnt(6)
M v[124:127], a[156:159], a[172:175], v[124:127]
 s_waitcnt vmcnt(25) lgkmcnt(0)
M v[124:127], a[152:155], a[168:171], v[124:127]
 s_barrier
M v[160:163], a[96:99], a[160:163], v[160:163]
 ds_read_b128 a[168:171], v5 offset:55296
 ds_read_b128 a[172:175], v6 offset:55296
M v[160:163], a[100:103], a[164:167], v[160:163]
 ds_read_b64_tr_b16 a[64:65], v1 offset:49152
 ds_read_b64_tr_b16 a[66:67], v1 offset:50176
M v[164:167], a[108:111], a[164:167], v[164:167]
 buffer_store_dwordx4 a[208:211], v30, s[8:11], s89 offen offset:0 sc1
M v[164:167], a[104:107], a[160:163], v[164:167]
M v[168:171], a[112:115], a[160:163], v[168:171]
 ds_read_b64_tr_b16 a[68:69], v1 offset:57344
 ds_read_b64_tr_b16 a[70:71], v1 offset:58368
M v[168:171], a[116:119], a[164:167], v[168:171]
M v[172:175], a[124:127], a[164:167], v[172:175]
M v[172:175], a[120:123], a[160:163], v[172:175]
 ds_read_b64_tr_b16 a[72:73], v2 offset:49152
 ds_read_b64_tr_b16 a[74:75], v2 offset:50176
M v[176:179], a[128:131], a[160:163], v[176:179]
M v[176:179], a[132:135], a[164:167], v[176:179]
M v[180:183], a[140:143], a[164:167], v[180:183]
 ds_read_b64_tr_b16 a[76:77], v2 offset:57344
 ds_read_b64_tr_b16 a[78:79], v2 offset:58368
M v[180:183], a[136:139], a[160:163], v[180:183]
M v[184:187], a[144:147], a[160:163], v[184:187]
M v[184:187], a[148:151], a[164:167], v[184:187]
 s_waitcnt lgkmcnt(8)
 ds_read_b64_tr_b16 a[80:81], v3 offset:49152
 ds_read_b64_tr_b16 a[82:83], v3 offset:50176
M v[188:191], a[156:159], a[164:167], v[188:191]
 buffer_store_dwordx4 a[212:215], v30, s[8:11], s89 offen offset:64 sc1
M v[188:191], a[152:155], a[160:163], v[188:191]
M v[224:227], a[96:99], a[168:171], v[224:227]
 ds_read_b128 a[160:163], v5 offset:0
 ds_read_b128 a[164:167], v6 offset:0
M v[224:227], a[100:103], a[172:175], v[224:227]
 ds_read_b64_tr_b16 a[84:85], v3 offset:57344
 ds_read_b64_tr_b16 a[86:87], v3 offset:58368
M v[228:231], a[108:111], a[172:175], v[228:231]
M v[228:231], a[104:107], a[168:171], v[228:231]
 ds_read_b64_tr_b16 a[88:89], v4 offset:49152
 ds_read_b64_tr_b16 a[90:91], v4 offset:50176
M v[232:235], a[112:115], a[168:171], v[232:235]
M v[232:235], a[116:119], a[172:175], v[232:235]
M v[236:239], a[124:127], a[172:175], v[236:239]
 ds_read_b64_tr_b16 a[92:93], v4 offset:57344
 ds_read_b64_tr_b16 a[94:95], v4 offset:58368
M v[236:239], a[120:123], a[168:171], v[236:239]
M v[240:243], a[128:131], a[168:171], v[240:243]
M v[240:243], a[132:135], a[172:175], v[240:243]
M v[244:247], a[140:143], a[172:175], v[244:247]
M v[244:247], a[136:139], a[168:171], v[244:247]
M v[248:251], a[144:147], a[168:171], v[248:251]
M v[248:251], a[148:151], a[172:175], v[248:251]
 s_waitcnt lgkmcnt(6)
M v[252:255], a[156:159], a[172:175], v[252:255]
 s_waitcnt vmcnt(22) lgkmcnt(0)
M v[252:255], a[152:155], a[168:171], v[252:255]
 s_barrier
M v[32:35], a[32:35], a[160:163], v[32:35]
 s_add_u32 m0, s23, 32768
 ds_read_b128 a[168:171], v5 offset:2048
 ds_read_b128 a[172:175], v6 offset:2048
M v[32:35], a[36:39], a[164:167], v[32:35]
 ds_read_b64_tr_b16 a[96:97], v20 offset:0
 ds_read_b64_tr_b16 a[98:99], v20 offset:1024
M v[36:39], a[44:47], a[164:167], v[36:39]
 buffer_load_dwordx4 v16, s[56:59], s29 offen offset:0   lds
M v[36:39], a[40:43], a[160:163], v[36:39]
 buffer_store_dwordx4 a[216:219], v30, s[8:11], s89 offen offset:128 sc1
M v[40:43], a[48:51], a[160:163], v[40:43]
 ds_read_b64_tr_b16 a[100:101], v20 offset:8192
 ds_read_b64_tr_b16 a[102:103], v20 offset:9216
M v[40:43], a[52:55], a[164:167], v[40:43]
 buffer_load_dwordx4 v17, s[56:59], s29 offen offset:1024   lds
M v[44:47], a[60:63], a[164:167], v[44:47]
M v[44:47], a[56:59], a[160:163], v[44:47]
 ds_read_b64_tr_b16 a[104:105], v21 offset:0
 ds_read_b64_tr_b16 a[106:107], v21 offset:1024
M v[48:51], a[64:67], a[160:163], v[48:51]
M v[48:51], a[68:71], a[164:167], v[48:51]
 buffer_load_dwordx4 v18, s[56:59], s29 offen offset:2048   lds
M v[52:55], a[76:79], a[164:167], v[52:55]
 ds_read_b64_tr_b16 a[108:109], v21 offset:8192
 ds_read_b64_tr_b16 a[110:111], v21 offset:9216
M v[52:55], a[72:75], a[160:163], v[52:55]
 buffer_store_dwordx4 a[220:223], v30, s[8:11], s89 offen offset:192 sc1
M v[56:59], a[80:83], a[160:163], v[56:59]
M v[56:59], a[84:87], a[164:167], v[56:59]
 s_waitcnt lgkmcnt(8)
 ds_read_b64_tr_b16 a[112:113], v22 offset:0
 ds_read_b64_tr_b16 a[114:115], v22 offset:1024
M v[60:63], a[92:95], a[164:167], v[60:63]
 buffer_load_dwordx4 v19, s[56:59], s29 offen offset:3072   lds
M v[60:63], a[88:91], a[160:163], v[60:63]
 s_add_u32 s29, s29, 128
M v[96:99], a[32:35], a[168:171], v[96:99]
 ds_read_b128 a[160:163], v5 offset:4096
 ds_read_b128 a[164:167], v6 offset:4096
M v[96:99], a[36:39], a[172:175], v[96:99]
 ds_read_b64_tr_b16 a[116:117], v22 offset:8192
 ds_read_b64_tr_b16 a[118:119], v22 offset:9216
M v[100:103], a[44:47], a[172:175], v[100:103]
 s_lshl_b32 s28, s20, 13
 buffer_store_dwordx4 a[224:227], v30, s[8:11], s89 offen offset:256 sc1
M v[100:103], a[40:43], a[168:171], v[100:103]
 s_lshl_b32 s21, s41, 20
 ds_read_b64_tr_b16 a[120:121], v23 offset:0
 ds_read_b64_tr_b16 a[122:123], v23 offset:1024
M v[104:107], a[48:51], a[168:171], v[104:107]
 s_mov_b32 s22, 0
M v[104:107], a[52:55], a[172:175], v[104:107]
 s_lshl_b32 s7, s41, 18
M v[108:111], a[60:63], a[172:175], v[108:111]
 s_add_u32 s7, s7, 100663296
 ds_read_b64_tr_b16 a[124:125], v23 offset:8192
 ds_read_b64_tr_b16 a[126:127], v23 offset:9216
M v[108:111], a[56:59], a[168:171], v[108:111]
 s_add_u32 s38, s7, 65536
 buffer_store_dwordx4 a[228:231], v30, s[8:11], s89 offen offset:320 sc1
M v[112:115], a[64:67], a[168:171], v[112:115]
 s_sub_u32 s27, s42, 1
M v[112:115], a[68:71], a[172:175], v[112:115]
 s_mov_b32 s43, 32767
M v[116:119], a[76:79], a[172:175], v[116:119]
 s_mov_b32 s4, 0
 buffer_load_dword v24, v13, s[8:11], s46 offen sc1
M v[116:119], a[72:75], a[168:171], v[116:119]
 s_add_u32 s26, s21, 655360
 buffer_store_dwordx4 a[232:235], v30, s[8:11], s89 offen offset:384 sc1
M v[120:123], a[80:83], a[168:171], v[120:123]
 s_lshl_b32 s64, s42, 1
 s_add_u32 s65, s64, 4
 s_add_u32 s64, s64, 2
M v[120:123], a[84:87], a[172:175], v[120:123]
 s_waitcnt lgkmcnt(6)
 s_add_u32 s3, s93, 524288
M v[124:127], a[92:95], a[172:175], v[124:127]
 s_waitcnt vmcnt(23) lgkmcnt(0)
M v[124:127], a[88:91], a[168:171], v[124:127]
 s_barrier
M v[160:163], a[32:35], a[160:163], v[160:163]
 s_cmp_le_u32 s42, 5
 ds_read_b128 a[168:171], v5 offset:6144
 ds_read_b128 a[172:175], v6 offset:6144
M v[160:163], a[36:39], a[164:167], v[160:163]
 s_cselect_b32 s25, s65, 32767
 ds_read_b64_tr_b16 a[128:129], v20 offset:16384
 ds_read_b64_tr_b16 a[130:131], v20 offset:17408
M v[164:167], a[44:47], a[164:167], v[164:167]
 s_cselect_b32 s6, 14, s64
 buffer_store_dwordx4 v[128:131], v7, s[8:11], s3 offen offset:0 sc1
M v[164:167], a[40:43], a[160:163], v[164:167]
 s_mov_b32 s23, 0
M v[168:171], a[48:51], a[160:163], v[168:171]
 ds_read_b64_tr_b16 a[132:133], v20 offset:24576
 ds_read_b64_tr_b16 a[134:135], v20 offset:25600
M v[168:171], a[52:55], a[164:167], v[168:171]
M v[172:175], a[60:63], a[164:167], v[172:175]
 buffer_store_dwordx4 v[132:135], v7, s[8:11], s3 offen offset:2048 sc1
M v[172:175], a[56:59], a[160:163], v[172:175]
 s_add_u32 s3, s93, 528384
 ds_read_b64_tr_b16 a[136:137], v21 offset:16384
 ds_read_b64_tr_b16 a[138:139], v21 offset:17408
M v[176:179], a[64:67], a[160:163], v[176:179]
M v[176:179], a[68:71], a[164:167], v[176:179]
M v[180:183], a[76:79], a[164:167], v[180:183]
 ds_read_b64_tr_b16 a[140:141], v21 offset:24576
 ds_read_b64_tr_b16 a[142:143], v21 offset:25600
M v[180:183], a[72:75], a[160:163], v[180:183]
 buffer_store_dwordx4 v[136:139], v7, s[8:11], s3 offen offset:0 sc1
M v[184:187], a[80:83], a[160:163], v[184:187]
M v[184:187], a[84:87], a[164:167], v[184:187]
 s_waitcnt lgkmcnt(8)
 ds_read_b64_tr_b16 a[144:145], v22 offset:16384
 ds_read_b64_tr_b16 a[146:147], v22 offset:17408
M v[188:191], a[92:95], a[164:167], v[188:191]
M v[188:191], a[88:91], a[160:163], v[188:191]
 buffer_store_dwordx4 v[140:143], v7, s[8:11], s3 offen offset:2048 sc1
M v[224:227], a[32:35], a[168:171], v[224:227]
 ds_read_b128 a[160:163], v5 offset:16384
 ds_read_b128 a[164:167], v6 offset:16384
M v[224:227], a[36:39], a[172:175], v[224:227]
 s_add_u32 s3, s93, 532480
 ds_read_b64_tr_b16 a[148:149], v22 offset:24576
 ds_read_b64_tr_b16 a[150:151], v22 offset:25600
M v[228:231], a[44:47], a[172:175], v[228:231]
M v[228:231], a[40:43], a[168:171], v[228:231]
 ds_read_b64_tr_b16 a[152:153], v23 offset:16384
 ds_read_b64_tr_b16 a[154:155], v23 offset:17408
M v[232:235], a[48:51], a[168:171], v[232:235]
 buffer_store_dwordx4 v[144:147], v7, s[8:11], s3 offen offset:0 sc1
M v[232:235], a[52:55], a[172:175], v[232:235]
M v[236:239], a[60:63], a[172:175], v[236:239]
 ds_read_b64_tr_b16 a[156:157], v23 offset:24576
 ds_read_b64_tr_b16 a[158:159], v23 offset:25600
M v[236:239], a[56:59], a[168:171], v[236:239]
M v[240:243], a[64:67], a[168:171], v[240:243]
M v[240:243], a[68:71], a[172:175], v[240:243]
M v[244:247], a[76:79], a[172:175], v[244:247]
M v[244:247], a[72:75], a[168:171], v[244:247]
M v[248:251], a[80:83], a[168:171], v[248:251]
M v[248:251], a[84:87], a[172:175], v[248:251]
 s_waitcnt lgkmcnt(6)
M v[252:255], a[92:95], a[172:175], v[252:255]
 s_waitcnt vmcnt(23) lgkmcnt(0)
M v[252:255], a[88:91], a[168:171], v[252:255]
 s_barrier
M v[32:35], a[96:99], a[160:163], v[32:35]
 ds_read_b128 a[168:171], v5 offset:18432
 ds_read_b128 a[172:175], v6 offset:18432
M v[32:35], a[100:103], a[164:167], v[32:35]
 ds_read_b64_tr_b16 a[32:33], v1 offset:0
 ds_read_b64_tr_b16 a[34:35], v1 offset:1024
M v[36:39], a[108:111], a[164:167], v[36:39]
 v_add_u32 v10, s28, v7
 v_add_u32 v11, 0x1000, v10
M v[36:39], a[104:107], a[160:163], v[36:39]
 s_waitcnt vmcnt(6)
 v_cmp_eq_u32 vcc, 0, v24
M v[40:43], a[112:115], a[160:163], v[40:43]
 s_lshl_b32 s64, s20, 10
 ds_read_b64_tr_b16 a[36:37], v1 offset:8192
 ds_read_b64_tr_b16 a[38:39], v1 offset:9216
M v[40:43], a[116:119], a[164:167], v[40:43]
 s_cbranch_vccnz L_f1s04
L_f1r04:
M v[44:47], a[124:127], a[164:167], v[44:47]
 s_add_u32 m0, s28, 98304
 s_nop 0
 buffer_load_dwordx4 v10, s[8:11], s21 offen offset:0 sc1 lds
M v[44:47], a[120:123], a[160:163], v[44:47]
 ds_read_b64_tr_b16 a[40:41], v2 offset:0
 ds_read_b64_tr_b16 a[42:43], v2 offset:1024
M v[48:51], a[128:131], a[160:163], v[48:51]
 buffer_store_dwordx4 v[148:151], v7, s[8:11], s3 offen offset:2048 sc1
M v[48:51], a[132:135], a[164:167], v[48:51]
M v[52:55], a[140:143], a[164:167], v[52:55]
 ds_read_b64_tr_b16 a[44:45], v2 offset:8192
 ds_read_b64_tr_b16 a[46:47], v2 offset:9216
M v[52:55], a[136:139], a[160:163], v[52:55]
 buffer_load_dwordx4 v10, s[8:11], s21 offen offset:1024 sc1 lds
M v[56:59], a[144:147], a[160:163], v[56:59]
M v[56:59], a[148:151], a[164:167], v[56:59]
 s_waitcnt lgkmcnt(8)
 ds_read_b64_tr_b16 a[48:49], v3 offset:0
 ds_read_b64_tr_b16 a[50:51], v3 offset:1024
M v[60:63], a[156:159], a[164:167], v[60:63]
M v[60:63], a[152:155], a[160:163], v[60:63]
 s_add_u32 s3, s93, 536576
 buffer_load_dwordx4 v10, s[8:11], s21 offen offset:2048 sc1 lds
M v[96:99], a[96:99], a[168:171], v[96:99]
 ds_read_b128 a[160:163], v5 offset:20480
 ds_read_b128 a[164:167], v6 offset:20480
M v[96:99], a[100:103], a[172:175], v[96:99]
 ds_read_b64_tr_b16 a[52:53], v3 offset:8192
 ds_read_b64_tr_b16 a[54:55], v3 offset:9216
M v[100:103], a[108:111], a[172:175], v[100:103]
 buffer_store_dwordx4 v[152:155], v7, s[8:11], s3 offen offset:0 sc1
M v[100:103], a[104:107], a[168:171], v[100:103]
 ds_read_b64_tr_b16 a[56:57], v4 offset:0
 ds_read_b64_tr_b16 a[58:59], v4 offset:1024
M v[104:107], a[112:115], a[168:171], v[104:107]
 buffer_load_dwordx4 v10, s[8:11], s21 offen offset:3072 sc1 lds
M v[104:107], a[116:119], a[172:175], v[104:107]
 s_add_u32 m0, s28, 102400
M v[108:111], a[124:127], a[172:175], v[108:111]
 ds_read_b64_tr_b16 a[60:61], v4 offset:8192
 ds_read_b64_tr_b16 a[62:63], v4 offset:9216
M v[108:111], a[120:123], a[168:171], v[108:111]
M v[112:115], a[128:131], a[168:171], v[112:115]
 buffer_load_dwordx4 v11, s[8:11], s21 offen offset:0 sc1 lds
M v[112:115], a[132:135], a[172:175], v[112:115]
M v[116:119], a[140:143], a[172:175], v[116:119]
 buffer_store_dwordx4 v[156:159], v7, s[8:11], s3 offen offset:2048 sc1
M v[116:119], a[136:139], a[168:171], v[116:119]
M v[120:123], a[144:147], a[168:171], v[120:123]
 buffer_load_dwordx4 v11, s[8:11], s21 offen offset:1024 sc1 lds
M v[120:123], a[148:151], a[172:175], v[120:123]
 s_waitcnt lgkmcnt(6)
M v[124:127], a[156:159], a[172:175], v[124:127]
 s_waitcnt lgkmcnt(0)
 buffer_load_dwordx4 v11, s[8:11], s21 offen offset:2048 sc1 lds
M v[124:127], a[152:155], a[168:171], v[124:127]
 s_barrier
M v[160:163], a[96:99], a[160:163], v[160:163]
 ds_read_b128 a[168:171], v5 offset:22528
 ds_read_b128 a[172:175], v6 offset:22528
M v[160:163], a[100:103], a[164:167], v[160:163]
 ds_read_b64_tr_b16 a[64:65], v1 offset:16384
 ds_read_b64_tr_b16 a[66:67], v1 offset:17408
M v[164:167], a[108:111], a[164:167], v[164:167]
 buffer_load_dwordx4 v11, s[8:11], s21 offen offset:3072 sc1 lds
M v[164:167], a[104:107], a[160:163], v[164:167]
 s_add_u32 s24, s23, 16777216
M v[168:171], a[112:115], a[160:163], v[168:171]
 s_mov_b32 s23, s21
 ds_read_b64_tr_b16 a[68:69], v1 offset:24576
 ds_read_b64_tr_b16 a[70:71], v1 offset:25600
M v[168:171], a[116:119], a[164:167], v[168:171]
 s_add_u32 s21, s21, 32768
 s_add_u32 s3, s93, 786432
M v[172:175], a[124:127], a[164:167], v[172:175]
 s_add_u32 s22, s22, 1
 buffer_store_dwordx4 v[192:195], v7, s[8:11], s3 offen offset:0 sc1
M v[172:175], a[120:123], a[160:163], v[172:175]
 s_cmp_eq_u32 s22, s25
 ds_read_b64_tr_b16 a[72:73], v2 offset:16384
 ds_read_b64_tr_b16 a[74:75], v2 offset:17408
M v[176:179], a[128:131], a[160:163], v[176:179]
 s_cselect_b32 s21, s26, s21
 v_subrev_u32 v5, 0x10000, v5
 v_subrev_u32 v6, 0x10000, v6
M v[176:179], a[132:135], a[164:167], v[176:179]
 s_cmp_eq_u32 s22, s43
M v[180:183], a[140:143], a[164:167], v[180:183]
 s_cselect_b32 s21, s4, s21
 ds_read_b64_tr_b16 a[76:77], v2 offset:24576
 ds_read_b64_tr_b16 a[78:79], v2 offset:25600
M v[180:183], a[136:139], a[160:163], v[180:183]
 s_cmp_eq_u32 s22, s6
M v[184:187], a[144:147], a[160:163], v[184:187]
 s_cselect_b32 s21, s7, s21
 v_mov_b32 v9, v25
 v_lshrrev_b32 v24, 4, v0
M v[184:187], a[148:151], a[164:167], v[184:187]
 s_waitcnt lgkmcnt(8)
 ds_read_b64_tr_b16 a[80:81], v3 offset:16384
 ds_read_b64_tr_b16 a[82:83], v3 offset:17408
M v[188:191], a[156:159], a[164:167], v[188:191]
 v_lshlrev_b32 v24, 2, v24
 v_and_b32 v25, 15, v0
M v[188:191], a[152:155], a[160:163], v[188:191]
 v_sub_u32 v24, v24, v25
M v[224:227], a[96:99], a[168:171], v[224:227]
 s_add_u32 s64, s64, s34
 ds_read_b128 a[160:163], v5 offset:32768
 ds_read_b128 a[164:167], v6 offset:32768
M v[224:227], a[100:103], a[172:175], v[224:227]
 s_add_u32 s52, s64, 65536
 ds_read_b64_tr_b16 a[84:85], v3 offset:24576
 ds_read_b64_tr_b16 a[86:87], v3 offset:25600
M v[228:231], a[108:111], a[172:175], v[228:231]
 s_mov_b32 s55, 0x21800000
 buffer_store_dwordx4 v[196:199], v7, s[8:11], s3 offen offset:2048 sc1
M v[228:231], a[104:107], a[168:171], v[228:231]
 s_cmp_eq_u32 s20, 0
 ds_read_b64_tr_b16 a[88:89], v4 offset:16384
 ds_read_b64_tr_b16 a[90:91], v4 offset:17408
M v[232:235], a[112:115], a[168:171], v[232:235]
 s_cselect_b32 s54, s39, 0
M v[232:235], a[116:119], a[172:175], v[232:235]
 s_lshr_b32 s64, s20, 1
M v[236:239], a[124:127], a[172:175], v[236:239]
 s_lshl_b32 s64, s64, 17
 ds_read_b64_tr_b16 a[92:93], v4 offset:24576
 ds_read_b64_tr_b16 a[94:95], v4 offset:25600
M v[236:239], a[120:123], a[168:171], v[236:239]
 s_and_b32 s65, s20, 1
M v[240:243], a[128:131], a[168:171], v[240:243]
 s_lshl_b32 s65, s65, 12
M v[240:243], a[132:135], a[172:175], v[240:243]
 s_add_u32 s64, s64, s65
 v_add_u32 v14, s64, v7
 v_mov_b32 v8, 0xff800000
M v[244:247], a[140:143], a[172:175], v[244:247]
 v_cmp_lt_i32 s[16:17], 0, v24
 v_cmp_lt_i32 s[18:19], -1, v24
M v[244:247], a[136:139], a[168:171], v[244:247]
 v_cmp_lt_i32 s[48:49], -2, v24
 v_cmp_lt_i32 s[50:51], -3, v24
M v[248:251], a[144:147], a[168:171], v[248:251]
M v[248:251], a[148:151], a[172:175], v[248:251]
 s_waitcnt lgkmcnt(6)
M v[252:255], a[156:159], a[172:175], v[252:255]
 s_waitcnt lgkmcnt(0)
M v[252:255], a[152:155], a[168:171], v[252:255]
 s_barrier
M v[32:35], a[32:35], a[160:163], v[32:35]
 ds_read_b128 a[168:171], v5 offset:34816
 ds_read_b128 a[172:175], v6 offset:34816
M v[32:35], a[36:39], a[164:167], v[32:35]
 buffer_load_dword v24, v9, s[8:11], s46 offen sc1
M v[36:39], a[44:47], a[164:167], v[36:39]
 v_mov_b32 v1, v15
 v_add_u32 v2, 0x10000, v7
M v[36:39], a[40:43], a[160:163], v[36:39]
 v_mov_b32 v3, v10
 v_mov_b32 v4, v11
M v[40:43], a[48:51], a[160:163], v[40:43]
 s_mov_b64 s[60:61], s[76:77]
M v[40:43], a[52:55], a[164:167], v[40:43]
 s_mov_b32 s62, s78
M v[44:47], a[60:63], a[164:167], v[44:47]
 s_mov_b32 s63, 0x20000
 v_lshl_add_u32 v10, v0, 7, s95
 v_and_b32 v0, 48, v0
M v[44:47], a[56:59], a[160:163], v[44:47]
 v_lshl_add_u32 v0, v0, 24, v10
 v_mul_f32 v32, s5, v32
M v[48:51], a[64:67], a[160:163], v[48:51]
 v_mul_f32 v33, s5, v33
 v_mul_f32 v34, s5, v34
M v[48:51], a[68:71], a[164:167], v[48:51]
 v_mul_f32 v35, s5, v35
 v_mul_f32 v36, s5, v36
M v[52:55], a[76:79], a[164:167], v[52:55]
 v_mul_f32 v37, s5, v37
 v_mul_f32 v38, s5, v38
M v[52:55], a[72:75], a[160:163], v[52:55]
 v_mul_f32 v39, s5, v39
 v_cvt_pk_bf16_f32 v32, v32, v33
M v[56:59], a[80:83], a[160:163], v[56:59]
 v_cvt_pk_bf16_f32 v33, v34, v35
 v_cvt_pk_bf16_f32 v34, v36, v37
M v[56:59], a[84:87], a[164:167], v[56:59]
 s_waitcnt lgkmcnt(0)
 v_cvt_pk_bf16_f32 v35, v38, v39
 ds_write_b128 v14, v[32:35] offset:0
M v[60:63], a[92:95], a[164:167], v[60:63]
 s_add_u32 s3, s93, 790528
 buffer_store_dwordx4 v[200:203], v7, s[8:11], s3 offen offset:0 sc1
M v[60:63], a[88:91], a[160:163], v[60:63]
 v_mul_f32 v40, s5, v40
 v_mul_f32 v41, s5, v41
M v[96:99], a[32:35], a[168:171], v[96:99]
 ds_read_b128 a[160:163], v5 offset:36864
 ds_read_b128 a[164:167], v6 offset:36864
M v[96:99], a[36:39], a[172:175], v[96:99]
 v_mul_f32 v42, s5, v42
 v_mul_f32 v43, s5, v43
M v[100:103], a[44:47], a[172:175], v[100:103]
 v_mul_f32 v44, s5, v44
 v_mul_f32 v45, s5, v45
M v[100:103], a[40:43], a[168:171], v[100:103]
 v_mul_f32 v46, s5, v46
 v_mul_f32 v47, s5, v47
M v[104:107], a[48:51], a[168:171], v[104:107]
 v_cvt_pk_bf16_f32 v40, v40, v41
 v_cvt_pk_bf16_f32 v41, v42, v43
M v[104:107], a[52:55], a[172:175], v[104:107]
 v_cvt_pk_bf16_f32 v42, v44, v45
 v_cvt_pk_bf16_f32 v43, v46, v47
M v[108:111], a[60:63], a[172:175], v[108:111]
 ds_write_b128 v14, v[40:43] offset:1024
M v[108:111], a[56:59], a[168:171], v[108:111]
 buffer_store_dwordx4 v[204:207], v7, s[8:11], s3 offen offset:2048 sc1
M v[112:115], a[64:67], a[168:171], v[112:115]
 v_mul_f32 v48, s5, v48
 v_mul_f32 v49, s5, v49
M v[112:115], a[68:71], a[172:175], v[112:115]
 v_mul_f32 v50, s5, v50
 v_mul_f32 v51, s5, v51
M v[116:119], a[76:79], a[172:175], v[116:119]
 v_mul_f32 v52, s5, v52
 v_mul_f32 v53, s5, v53
M v[116:119], a[72:75], a[168:171], v[116:119]
 v_mul_f32 v54, s5, v54
 v_mul_f32 v55, s5, v55
M v[120:123], a[80:83], a[168:171], v[120:123]
 v_cvt_pk_bf16_f32 v48, v48, v49
 v_cvt_pk_bf16_f32 v49, v50, v51
M v[120:123], a[84:87], a[172:175], v[120:123]
 s_waitcnt lgkmcnt(1)
 v_cvt_pk_bf16_f32 v50, v52, v53
 v_cvt_pk_bf16_f32 v51, v54, v55
M v[124:127], a[92:95], a[172:175], v[124:127]
 ds_write_b128 v14, v[48:51] offset:2048
M v[124:127], a[88:91], a[168:171], v[124:127]
 s_add_u32 s3, s93, 794624
 buffer_store_dwordx4 v[208:211], v7, s[8:11], s3 offen offset:0 sc1
M v[160:163], a[32:35], a[160:163], v[160:163]
 ds_read_b128 a[168:171], v5 offset:38912
 ds_read_b128 a[172:175], v6 offset:38912
M v[160:163], a[36:39], a[164:167], v[160:163]
 v_mul_f32 v56, s5, v56
 v_mul_f32 v57, s5, v57
M v[164:167], a[44:47], a[164:167], v[164:167]
 v_mul_f32 v58, s5, v58
 v_mul_f32 v59, s5, v59
M v[164:167], a[40:43], a[160:163], v[164:167]
 v_mul_f32 v60, s5, v60
 v_mul_f32 v61, s5, v61
M v[168:171], a[48:51], a[160:163], v[168:171]
 v_mul_f32 v62, s5, v62
 v_mul_f32 v63, s5, v63
M v[168:171], a[52:55], a[164:167], v[168:171]
 v_cvt_pk_bf16_f32 v56, v56, v57
 v_cvt_pk_bf16_f32 v57, v58, v59
M v[172:175], a[60:63], a[164:167], v[172:175]
 v_cvt_pk_bf16_f32 v58, v60, v61
 v_cvt_pk_bf16_f32 v59, v62, v63
M v[172:175], a[56:59], a[160:163], v[172:175]
 s_waitcnt lgkmcnt(0)
 ds_write_b128 v14, v[56:59] offset:3072
M v[176:179], a[64:67], a[160:163], v[176:179]
 s_barrier
M v[176:179], a[68:71], a[164:167], v[176:179]
M v[180:183], a[76:79], a[164:167], v[180:183]
 s_add_u32 m0, s28, 32768
 s_nop 0
 buffer_load_dwordx4 v3, s[8:11], s21 offen offset:0 sc1 lds
M v[180:183], a[72:75], a[160:163], v[180:183]
M v[184:187], a[80:83], a[160:163], v[184:187]
 buffer_store_dwordx4 v[212:215], v7, s[8:11], s3 offen offset:2048 sc1
M v[184:187], a[84:87], a[164:167], v[184:187]
 v_mul_f32 v96, s5, v96
 v_mul_f32 v97, s5, v97
M v[188:191], a[92:95], a[164:167], v[188:191]
 buffer_load_dwordx4 v3, s[8:11], s21 offen offset:1024 sc1 lds
M v[188:191], a[88:91], a[160:163], v[188:191]
 v_mul_f32 v98, s5, v98
 v_mul_f32 v99, s5, v99
M v[224:227], a[32:35], a[168:171], v[224:227]
 v_mul_f32 v100, s5, v100
 v_mul_f32 v101, s5, v101
M v[224:227], a[36:39], a[172:175], v[224:227]
 v_mul_f32 v102, s5, v102
 v_mul_f32 v103, s5, v103
M v[228:231], a[44:47], a[172:175], v[228:231]
 buffer_load_dwordx4 v3, s[8:11], s21 offen offset:2048 sc1 lds
M v[228:231], a[40:43], a[168:171], v[228:231]
 v_cvt_pk_bf16_f32 v96, v96, v97
 v_cvt_pk_bf16_f32 v97, v98, v99
M v[232:235], a[48:51], a[168:171], v[232:235]
 v_cvt_pk_bf16_f32 v98, v100, v101
 v_cvt_pk_bf16_f32 v99, v102, v103
M v[232:235], a[52:55], a[172:175], v[232:235]
 ds_write_b128 v14, v[96:99] offset:8192
M v[236:239], a[60:63], a[172:175], v[236:239]
 s_add_u32 s3, s93, 798720
 buffer_load_dwordx4 v3, s[8:11], s21 offen offset:3072 sc1 lds
M v[236:239], a[56:59], a[168:171], v[236:239]
 s_add_u32 m0, s28, 36864
M v[240:243], a[64:67], a[168:171], v[240:243]
 buffer_store_dwordx4 v[216:219], v7, s[8:11], s3 offen offset:0 sc1
M v[240:243], a[68:71], a[172:175], v[240:243]
 v_mul_f32 v104, s5, v104
 v_mul_f32 v105, s5, v105
M v[244:247], a[76:79], a[172:175], v[244:247]
 buffer_load_dwordx4 v4, s[8:11], s21 offen offset:0 sc1 lds
M v[244:247], a[72:75], a[168:171], v[244:247]
 v_mul_f32 v106, s5, v106
 v_mul_f32 v107, s5, v107
M v[248:251], a[80:83], a[168:171], v[248:251]
 v_mul_f32 v108, s5, v108
 v_mul_f32 v109, s5, v109
M v[248:251], a[84:87], a[172:175], v[248:251]
 v_mul_f32 v110, s5, v110
 v_mul_f32 v111, s5, v111
M v[252:255], a[92:95], a[172:175], v[252:255]
 buffer_load_dwordx4 v4, s[8:11], s21 offen offset:1024 sc1 lds
M v[252:255], a[88:91], a[168:171], v[252:255]
 buffer_load_dwordx4 v4, s[8:11], s21 offen offset:2048 sc1 lds
 buffer_load_dwordx4 v4, s[8:11], s21 offen offset:3072 sc1 lds
 s_add_u32 s24, s23, 16777216
 s_mov_b32 s23, s21
 s_add_u32 s21, s21, 32768
 s_add_u32 s22, s22, 1
 s_cmp_eq_u32 s22, s25
 s_cselect_b32 s21, s26, s21
 s_cmp_eq_u32 s22, s43
 s_cselect_b32 s21, s4, s21
 s_cmp_eq_u32 s22, s6
 s_cselect_b32 s21, s7, s21
 v_cvt_pk_bf16_f32 v104, v104, v105
 v_cvt_pk_bf16_f32 v105, v106, v107
 v_cvt_pk_bf16_f32 v106, v108, v109
 v_cvt_pk_bf16_f32 v107, v110, v111
 ds_write_b128 v14, v[104:107] offset:9216
 buffer_store_dwordx4 v[220:223], v7, s[8:11], s3 offen offset:2048 sc1
 v_pk_mul_f32 v[112:113], v[112:113], s[4:5] op_sel:[0,1] op_sel_hi:[1,1]
 v_pk_mul_f32 v[114:115], v[114:115], s[4:5] op_sel:[0,1] op_sel_hi:[1,1]
 v_pk_mul_f32 v[116:117], v[116:117], s[4:5] op_sel:[0,1] op_sel_hi:[1,1]
 v_pk_mul_f32 v[118:119], v[118:119], s[4:5] op_sel:[0,1] op_sel_hi:[1,1]
 v_cvt_pk_bf16_f32 v112, v112, v113
 v_cvt_pk_bf16_f32 v113, v114, v115
 v_cvt_pk_bf16_f32 v114, v116, v117
 v_cvt_pk_bf16_f32 v115, v118, v119
 ds_write_b128 v14, v[112:115] offset:10240
 v_pk_mul_f32 v[120:121], v[120:121], s[4:5] op_sel:[0,1] op_sel_hi:[1,1]
 v_pk_mul_f32 v[122:123], v[122:123], s[4:5] op_sel:[0,1] op_sel_hi:[1,1]
 v_pk_mul_f32 v[124:125], v[124:125], s[4:5] op_sel:[0,1] op_sel_hi:[1,1]
 v_pk_mul_f32 v[126:127], v[126:127], s[4:5] op_sel:[0,1] op_sel_hi:[1,1]
 v_cvt_pk_bf16_f32 v120, v120, v121
 v_cvt_pk_bf16_f32 v121, v122, v123
 v_cvt_pk_bf16_f32 v122, v124, v125
 v_cvt_pk_bf16_f32 v123, v126, v127
 ds_write_b128 v14, v[120:123] offset:11264
 v_pk_mul_f32 v[160:161], v[160:161], s[4:5] op_sel:[0,1] op_sel_hi:[1,1]
 v_pk_mul_f32 v[162:163], v[162:163], s[4:5] op_sel:[0,1] op_sel_hi:[1,1]
 v_pk_mul_f32 v[164:165], v[164:165], s[4:5] op_sel:[0,1] op_sel_hi:[1,1]
 v_pk_mul_f32 v[166:167], v[166:167], s[4:5] op_sel:[0,1] op_sel_hi:[1,1]
 v_cvt_pk_bf16_f32 v160, v160, v161
 v_cvt_pk_bf16_f32 v161, v162, v163
 v_cvt_pk_bf16_f32 v162, v164, v165
 v_cvt_pk_bf16_f32 v163, v166, v167
 ds_write_b128 v14, v[160:163] offset:16384
 v_pk_mul_f32 v[168:169], v[168:169], s[4:5] op_sel:[0,1] op_sel_hi:[1,1]
 v_pk_mul_f32 v[170:171], v[170:171], s[4:5] op_sel:[0,1] op_sel_hi:[1,1]
 v_pk_mul_f32 v[172:173], v[172:173], s[4:5] op_sel:[0,1] op_sel_hi:[1,1]
 v_pk_mul_f32 v[174:175], v[174:175], s[4:5] op_sel:[0,1] op_sel_hi:[1,1]
 v_cvt_pk_bf16_f32 v168, v168, v169
 v_cvt_pk_bf16_f32 v169, v170, v171
 v_cvt_pk_bf16_f32 v170, v172, v173
 v_cvt_pk_bf16_f32 v171, v174, v175
 ds_write_b128 v14, v[168:171] offset:17408
 v_pk_mul_f32 v[176:177], v[176:177], s[4:5] op_sel:[0,1] op_sel_hi:[1,1]
 v_pk_mul_f32 v[178:179], v[178:179], s[4:5] op_sel:[0,1] op_sel_hi:[1,1]
 v_pk_mul_f32 v[180:181], v[180:181], s[4:5] op_sel:[0,1] op_sel_hi:[1,1]
 v_pk_mul_f32 v[182:183], v[182:183], s[4:5] op_sel:[0,1] op_sel_hi:[1,1]
 v_cvt_pk_bf16_f32 v176, v176, v177
 v_cvt_pk_bf16_f32 v177, v178, v179
 v_cvt_pk_bf16_f32 v178, v180, v181
 v_cvt_pk_bf16_f32 v179, v182, v183
 ds_write_b128 v14, v[176:179] offset:18432
 v_pk_mul_f32 v[184:185], v[184:185], s[4:5] op_sel:[0,1] op_sel_hi:[1,1]
 v_pk_mul_f32 v[186:187], v[186:187], s[4:5] op_sel:[0,1] op_sel_hi:[1,1]
 v_pk_mul_f32 v[188:189], v[188:189], s[4:5] op_sel:[0,1] op_sel_hi:[1,1]
 v_pk_mul_f32 v[190:191], v[190:191], s[4:5] op_sel:[0,1] op_sel_hi:[1,1]
 v_cvt_pk_bf16_f32 v184, v184, v185
 v_cvt_pk_bf16_f32 v185, v186, v187
 v_cvt_pk_bf16_f32 v186, v188, v189
 v_cvt_pk_bf16_f32 v187, v190, v191
 ds_write_b128 v14, v[184:187] offset:19456
 v_pk_mul_f32 v[224:225], v[224:225], s[4:5] op_sel:[0,1] op_sel_hi:[1,1]
 v_pk_mul_f32 v[226:227], v[226:227], s[4:5] op_sel:[0,1] op_sel_hi:[1,1]
 v_pk_mul_f32 v[228:229], v[228:229], s[4:5] op_sel:[0,1] op_sel_hi:[1,1]
 v_pk_mul_f32 v[230:231], v[230:231], s[4:5] op_sel:[0,1] op_sel_hi:[1,1]
 v_cvt_pk_bf16_f32 v224, v224, v225
 v_cvt_pk_bf16_f32 v225, v226, v227
 v_cvt_pk_bf16_f32 v226, v228, v229
 v_cvt_pk_bf16_f32 v227, v230, v231
 ds_write_b128 v14, v[224:227] offset:24576
 v_pk_mul_f32 v[232:233], v[232:233], s[4:5] op_sel:[0,1] op_sel_hi:[1,1]
 v_pk_mul_f32 v[234:235], v[234:235], s[4:5] op_sel:[0,1] op_sel_hi:[1,1]
 v_pk_mul_f32 v[236:237], v[236:237], s[4:5] op_sel:[0,1] op_sel_hi:[1,1]
 v_pk_mul_f32 v[238:239], v[238:239], s[4:5] op_sel:[0,1] op_sel_hi:[1,1]
 v_cvt_pk_bf16_f32 v232, v232, v233
 v_cvt_pk_bf16_f32 v233, v234, v235
 v_cvt_pk_bf16_f32 v234, v236, v237
 v_cvt_pk_bf16_f32 v235, v238, v239
 ds_write_b128 v14, v[232:235] offset:25600
 v_pk_mul_f32 v[240:241], v[240:241], s[4:5] op_sel:[0,1] op_sel_hi:[1,1]
 v_pk_mul_f32 v[242:243], v[242:243], s[4:5] op_sel:[0,1] op_sel_hi:[1,1]
 v_pk_mul_f32 v[244:245], v[244:245], s[4:5] op_sel:[0,1] op_sel_hi:[1,1]
 v_pk_mul_f32 v[246:247], v[246:247], s[4:5] op_sel:[0,1] op_sel_hi:[1,1]
 v_cvt_pk_bf16_f32 v240, v240, v241
 v_cvt_pk_bf16_f32 v241, v242, v243
 v_cvt_pk_bf16_f32 v242, v244, v245
 v_cvt_pk_bf16_f32 v243, v246, v247
 ds_write_b128 v14, v[240:243] offset:26624
 v_pk_mul_f32 v[248:249], v[248:249], s[4:5] op_sel:[0,1] op_sel_hi:[1,1]
 v_pk_mul_f32 v[250:251], v[250:251], s[4:5] op_sel:[0,1] op_sel_hi:[1,1]
 v_pk_mul_f32 v[252:253], v[252:253], s[4:5] op_sel:[0,1] op_sel_hi:[1,1]
 v_pk_mul_f32 v[254:255], v[254:255], s[4:5] op_sel:[0,1] op_sel_hi:[1,1]
 v_cvt_pk_bf16_f32 v248, v248, v249
 v_cvt_pk_bf16_f32 v249, v250, v251
 v_cvt_pk_bf16_f32 v250, v252, v253
 v_cvt_pk_bf16_f32 v251, v254, v255
 ds_write_b128 v14, v[248:251] offset:27648
 s_waitcnt vmcnt(17) lgkmcnt(0)
 s_barrier
 ds_read_b128 a[64:67], v2 offset:32768
 ds_read_b128 a[68:71], v2 offset:33792
 ds_read_b128 a[72:75], v2 offset:34816
 ds_read_b128 a[76:79], v2 offset:35840
 ds_read_b128 a[80:83], v2 offset:36864
 ds_read_b128 a[84:87], v2 offset:37888
 ds_read_b128 a[88:91], v2 offset:38912
 ds_read_b128 a[92:95], v2 offset:39936
 s_lshl_b32 s64, s20, 13
 s_sub_u32 s65, 155648, s64
 v_add_u32 v10, s64, v7
 v_add_u32 v11, s65, v7
 ds_read_b128 a[0:3], v10 offset:0
 ds_read_b128 a[4:7], v10 offset:1024
 ds_read_b128 a[8:11], v10 offset:2048
 ds_read_b128 a[12:15], v10 offset:3072
 ds_read_b128 a[16:19], v10 offset:4096
 ds_read_b128 a[20:23], v10 offset:5120
 ds_read_b128 a[24:27], v10 offset:6144
 ds_read_b128 a[28:31], v10 offset:7168
 ds_read_b128 a[32:35], v11 offset:0
 ds_read_b128 a[36:39], v11 offset:1024
 ds_read_b128 a[40:43], v11 offset:2048
 ds_read_b128 a[44:47], v11 offset:3072
 ds_read_b128 a[48:51], v11 offset:4096
 ds_read_b128 a[52:55], v11 offset:5120
 ds_read_b128 a[56:59], v11 offset:6144
 ds_read_b128 a[60:63], v11 offset:7168
 s_waitcnt vmcnt(14)
 v_cmp_eq_u32 vcc, 0, v24
 v_mov_b32 v17, 4
 v_or_b32 v6, s35, v7
 s_cbranch_vccnz L_f1s05
L_f1r05:
 s_mov_b32 s30, s93
 s_mov_b32 s29, s94
 s_cmp_eq_u32 s20, 0
 s_cselect_b32 s5, 0, 0
 v_mov_b32 v32, 0xc1800000
 v_mov_b32 v33, 0xc1800000
 v_mov_b32 v34, 0xc1800000
 v_mov_b32 v35, 0xc1800000
 v_mov_b32 v36, 0xc1800000
 v_mov_b32 v37, 0xc1800000
 v_mov_b32 v38, 0xc1800000
 v_mov_b32 v39, 0xc1800000
 s_waitcnt lgkmcnt(0)
M v[64:67], a[64:67], a[0:3], v[32:35]
 ds_read_b128 a[96:99], v2 offset:40960
 v_mov_b32 v30, 0
M v[64:67], a[68:71], a[4:7], v[64:67]
 s_add_u32 m0, s28, 65536
 ds_read_b128 a[100:103], v2 offset:41984
 v_mov_b32 v31, 0
M v[64:67], a[72:75], a[8:11], v[64:67]
 buffer_load_dwordx4 v3, s[8:11], s24 offen offset:0 sc1 lds
M v[64:67], a[76:79], a[12:15], v[64:67]
 ds_read_b128 a[104:107], v2 offset:43008
M v[64:67], a[80:83], a[16:19], v[64:67]
 ds_read_b128 a[108:111], v2 offset:44032
M v[64:67], a[84:87], a[20:23], v[64:67]
 buffer_load_dwordx4 v3, s[8:11], s24 offen offset:1024 sc1 lds
M v[64:67], a[88:91], a[24:27], v[64:67]
 ds_read_b128 a[112:115], v2 offset:45056
M v[64:67], a[92:95], a[28:31], v[64:67]
 ds_read_b128 a[116:119], v2 offset:46080
M v[68:71], a[92:95], a[60:63], v[36:39]
M v[68:71], a[88:91], a[56:59], v[68:71]
 ds_read_b128 a[120:123], v2 offset:47104
M v[68:71], a[84:87], a[52:55], v[68:71]
 ds_read_b128 a[124:127], v2 offset:48128
M v[68:71], a[80:83], a[48:51], v[68:71]
 buffer_load_dwordx4 v3, s[8:11], s24 offen offset:2048 sc1 lds
M v[68:71], a[76:79], a[44:47], v[68:71]
 v_exp_f32 v18, v64
M v[68:71], a[72:75], a[40:43], v[68:71]
 v_exp_f32 v19, v65
M v[68:71], a[68:71], a[36:39], v[68:71]
 v_exp_f32 v20, v66
M v[68:71], a[64:67], a[32:35], v[68:71]
 s_waitcnt lgkmcnt(0)
 v_exp_f32 v21, v67
M v[72:75], a[96:99], a[0:3], v[32:35]
 ds_read_b128 a[64:67], v2 offset:49152
 v_add_f32 v26, v18, v19
M v[72:75], a[100:103], a[4:7], v[72:75]
 ds_read_b128 a[68:71], v2 offset:50176
 v_cvt_pk_bf16_f32 v40, v18, v19
M v[72:75], a[104:107], a[8:11], v[72:75]
 buffer_load_dwordx4 v3, s[8:11], s24 offen offset:3072 sc1 lds
M v[72:75], a[108:111], a[12:15], v[72:75]
 ds_read_b128 a[72:75], v2 offset:51200
 v_add_f32 v26, v20, v26
M v[72:75], a[112:115], a[16:19], v[72:75]
 s_add_u32 m0, s28, 69632
 ds_read_b128 a[76:79], v2 offset:52224
 v_cvt_pk_bf16_f32 v41, v20, v21
M v[72:75], a[116:119], a[20:23], v[72:75]
 buffer_load_dwordx4 v4, s[8:11], s24 offen offset:0 sc1 lds
M v[72:75], a[120:123], a[24:27], v[72:75]
 ds_read_b128 a[80:83], v2 offset:53248
 v_add_f32 v26, v21, v26
M v[72:75], a[124:127], a[28:31], v[72:75]
 ds_read_b128 a[84:87], v2 offset:54272
M v[76:79], a[124:127], a[60:63], v[36:39]
 v_exp_f32 v22, v68
M v[76:79], a[120:123], a[56:59], v[76:79]
 ds_read_b128 a[88:91], v2 offset:55296
M v[76:79], a[116:119], a[52:55], v[76:79]
 ds_read_b128 a[92:95], v2 offset:56320
M v[76:79], a[112:115], a[48:51], v[76:79]
 buffer_load_dwordx4 v4, s[8:11], s24 offen offset:1024 sc1 lds
M v[76:79], a[108:111], a[44:47], v[76:79]
 v_exp_f32 v23, v69
M v[76:79], a[104:107], a[40:43], v[76:79]
 v_exp_f32 v24, v70
M v[76:79], a[100:103], a[36:39], v[76:79]
 buffer_load_dwordx4 v4, s[8:11], s24 offen offset:2048 sc1 lds
M v[76:79], a[96:99], a[32:35], v[76:79]
 s_waitcnt lgkmcnt(0)
 v_exp_f32 v25, v71
M v[80:83], a[64:67], a[0:3], v[32:35]
 ds_read_b128 a[96:99], v2 offset:57344
 v_add_f32 v27, v22, v23
M v[80:83], a[68:71], a[4:7], v[80:83]
 ds_read_b128 a[100:103], v2 offset:58368
 v_cvt_pk_bf16_f32 v44, v22, v23
M v[80:83], a[72:75], a[8:11], v[80:83]
 v_exp_f32 v18, v72
M v[80:83], a[76:79], a[12:15], v[80:83]
 ds_read_b128 a[104:107], v2 offset:59392
 v_add_f32 v27, v24, v27
M v[80:83], a[80:83], a[16:19], v[80:83]
 ds_read_b128 a[108:111], v2 offset:60416
 v_cvt_pk_bf16_f32 v45, v24, v25
M v[80:83], a[84:87], a[20:23], v[80:83]
 buffer_load_dwordx4 v4, s[8:11], s24 offen offset:3072 sc1 lds
M v[80:83], a[88:91], a[24:27], v[80:83]
 ds_read_b128 a[112:115], v2 offset:61440
 v_add_f32 v27, v25, v27
M v[80:83], a[92:95], a[28:31], v[80:83]
 ds_read_b128 a[116:119], v2 offset:62464
M v[84:87], a[92:95], a[60:63], v[36:39]
 v_exp_f32 v19, v73
M v[84:87], a[88:91], a[56:59], v[84:87]
 ds_read_b128 a[120:123], v2 offset:63488
 v_add_f32 v26, v18, v26
M v[84:87], a[84:87], a[52:55], v[84:87]
 ds_read_b128 a[124:127], v2 offset:64512
 v_cvt_pk_bf16_f32 v42, v18, v19
M v[84:87], a[80:83], a[48:51], v[84:87]
 v_exp_f32 v20, v74
M v[84:87], a[76:79], a[44:47], v[84:87]
 v_exp_f32 v21, v75
M v[84:87], a[72:75], a[40:43], v[84:87]
 v_exp_f32 v22, v76
M v[84:87], a[68:71], a[36:39], v[84:87]
 s_waitcnt vmcnt(8) lgkmcnt(0)
 v_exp_f32 v23, v77
M v[84:87], a[64:67], a[32:35], v[84:87]
 s_barrier
M v[88:91], a[96:99], a[0:3], v[32:35]
 ds_read_b128 a[64:67], v7 offset:32768
 v_add_f32 v26, v19, v26
M v[88:91], a[100:103], a[4:7], v[88:91]
 ds_read_b128 a[68:71], v7 offset:33792
 v_add_f32 v26, v20, v26
M v[88:91], a[104:107], a[8:11], v[88:91]
 buffer_store_dword v17, v1, s[8:11], s45 offen sc1
M v[88:91], a[108:111], a[12:15], v[88:91]
 ds_read_b128 a[72:75], v7 offset:34816
 v_cvt_pk_bf16_f32 v43, v20, v21
M v[88:91], a[112:115], a[16:19], v[88:91]
 ds_read_b128 a[76:79], v7 offset:35840
 v_add_f32 v26, v21, v26
M v[88:91], a[116:119], a[20:23], v[88:91]
 v_exp_f32 v24, v78
M v[88:91], a[120:123], a[24:27], v[88:91]
 ds_read_b128 a[80:83], v7 offset:36864
 v_add_f32 v27, v22, v27
M v[88:91], a[124:127], a[28:31], v[88:91]
 ds_read_b128 a[84:87], v7 offset:37888
 v_cvt_pk_bf16_f32 v46, v22, v23
M v[92:95], a[124:127], a[60:63], v[36:39]
 v_exp_f32 v25, v79
M v[92:95], a[120:123], a[56:59], v[92:95]
 ds_read_b128 a[88:91], v7 offset:38912
 v_add_f32 v27, v23, v27
M v[92:95], a[116:119], a[52:55], v[92:95]
 ds_read_b128 a[92:95], v7 offset:39936
 v_add_f32 v27, v24, v27
M v[92:95], a[112:115], a[48:51], v[92:95]
 v_cvt_pk_bf16_f32 v47, v24, v25
 v_add_f32 v27, v25, v27
M v[92:95], a[108:111], a[44:47], v[92:95]
M v[92:95], a[104:107], a[40:43], v[92:95]
M v[92:95], a[100:103], a[36:39], v[92:95]
 s_waitcnt lgkmcnt(0)
M v[92:95], a[96:99], a[32:35], v[92:95]
 s_cmp_eq_u32 s42, 0
 s_cbranch_scc1 L_j0
M v[96:99], a[64:67], a[0:3], v[32:35]
 s_add_u32 m0, s28, 98304
 ds_read_b128 a[96:99], v7 offset:40960
M v[96:99], a[68:71], a[4:7], v[96:99]
 ds_read_b128 a[100:103], v7 offset:41984
M v[96:99], a[72:75], a[8:11], v[96:99]
 buffer_load_dwordx4 v3, s[8:11], s21 offen offset:0 sc1 lds
M v[96:99], a[76:79], a[12:15], v[96:99]
 s_cmp_eq_u32 s20, 0
 ds_read_b128 a[104:107], v7 offset:43008
M v[96:99], a[80:83], a[16:19], v[96:99]
 s_cselect_b64 s[64:65], s[16:17], 0
 ds_read_b128 a[108:111], v7 offset:44032
M v[96:99], a[84:87], a[20:23], v[96:99]
 buffer_load_dwordx4 v3, s[8:11], s21 offen offset:1024 sc1 lds
M v[96:99], a[88:91], a[24:27], v[96:99]
 s_cselect_b64 s[66:67], s[18:19], 0
 ds_read_b128 a[112:115], v7 offset:45056
M v[96:99], a[92:95], a[28:31], v[96:99]
 s_cselect_b64 s[68:69], s[48:49], 0
 ds_read_b128 a[116:119], v7 offset:46080
M v[100:103], a[92:95], a[60:63], v[36:39]
 s_cselect_b64 s[70:71], s[50:51], 0
 v_exp_f32 v18, v80
M v[100:103], a[88:91], a[56:59], v[100:103]
 s_cmp_lt_u32 s20, 1
 ds_read_b128 a[120:123], v7 offset:47104
M v[100:103], a[84:87], a[52:55], v[100:103]
 s_cselect_b64 s[78:79], -1, 0
 ds_read_b128 a[124:127], v7 offset:48128
M v[100:103], a[80:83], a[48:51], v[100:103]
 buffer_load_dwordx4 v3, s[8:11], s21 offen offset:2048 sc1 lds
M v[100:103], a[76:79], a[44:47], v[100:103]
 s_cmp_eq_u32 s20, 1
 v_exp_f32 v19, v81
M v[100:103], a[72:75], a[40:43], v[100:103]
 s_cselect_b64 s[72:73], s[16:17], s[78:79]
 v_exp_f32 v20, v82
M v[100:103], a[68:71], a[36:39], v[100:103]
 s_cselect_b64 s[74:75], s[18:19], s[78:79]
 v_exp_f32 v21, v83
M v[100:103], a[64:67], a[32:35], v[100:103]
 s_waitcnt lgkmcnt(0)
 v_exp_f32 v22, v88
M v[104:107], a[96:99], a[0:3], v[32:35]
 s_cselect_b64 s[76:77], s[48:49], s[78:79]
 ds_read_b128 a[64:67], v7 offset:49152
 v_add_f32 v26, v18, v26
M v[104:107], a[100:103], a[4:7], v[104:107]
 s_cselect_b64 s[78:79], s[50:51], s[78:79]
 ds_read_b128 a[68:71], v7 offset:50176
 v_cvt_pk_bf16_f32 v56, v18, v19
M v[104:107], a[104:107], a[8:11], v[104:107]
 buffer_load_dwordx4 v3, s[8:11], s21 offen offset:3072 sc1 lds
M v[104:107], a[108:111], a[12:15], v[104:107]
 s_add_u32 m0, s28, 102400
 ds_read_b128 a[72:75], v7 offset:51200
 v_add_f32 v26, v19, v26
M v[104:107], a[112:115], a[16:19], v[104:107]
 s_cmp_lt_u32 s20, 2
 ds_read_b128 a[76:79], v7 offset:52224
 v_add_f32 v26, v20, v26
M v[104:107], a[116:119], a[20:23], v[104:107]
 buffer_load_dwordx4 v4, s[8:11], s21 offen offset:0 sc1 lds
M v[104:107], a[120:123], a[24:27], v[104:107]
 s_cselect_b64 s[86:87], -1, 0
 ds_read_b128 a[80:83], v7 offset:53248
 v_cvt_pk_bf16_f32 v57, v20, v21
M v[104:107], a[124:127], a[28:31], v[104:107]
 s_cmp_eq_u32 s20, 2
 ds_read_b128 a[84:87], v7 offset:54272
 v_add_f32 v26, v21, v26
M v[108:111], a[124:127], a[60:63], v[36:39]
 s_cselect_b64 s[80:81], s[16:17], s[86:87]
 v_exp_f32 v23, v89
M v[108:111], a[120:123], a[56:59], v[108:111]
 s_cselect_b64 s[82:83], s[18:19], s[86:87]
 ds_read_b128 a[88:91], v7 offset:55296
 v_add_f32 v26, v22, v26
M v[108:111], a[116:119], a[52:55], v[108:111]
 s_cselect_b64 s[84:85], s[48:49], s[86:87]
 ds_read_b128 a[92:95], v7 offset:56320
 v_cvt_pk_bf16_f32 v58, v22, v23
M v[108:111], a[112:115], a[48:51], v[108:111]
 buffer_load_dwordx4 v4, s[8:11], s21 offen offset:1024 sc1 lds
M v[108:111], a[108:111], a[44:47], v[108:111]
 s_cselect_b64 s[86:87], s[50:51], s[86:87]
 v_exp_f32 v24, v90
M v[108:111], a[104:107], a[40:43], v[108:111]
 s_cmp_eq_u32 s20, 3
 v_exp_f32 v25, v91
M v[108:111], a[100:103], a[36:39], v[108:111]
 buffer_load_dwordx4 v4, s[8:11], s21 offen offset:2048 sc1 lds
M v[108:111], a[96:99], a[32:35], v[108:111]
 s_waitcnt lgkmcnt(0)
 v_exp_f32 v18, v84
M v[112:115], a[64:67], a[0:3], v[32:35]
 s_cselect_b64 s[88:89], s[16:17], -1
 ds_read_b128 a[96:99], v7 offset:57344
 v_add_f32 v26, v23, v26
M v[112:115], a[68:71], a[4:7], v[112:115]
 s_cselect_b64 s[90:91], s[18:19], -1
 ds_read_b128 a[100:103], v7 offset:58368
 v_add_f32 v26, v24, v26
M v[112:115], a[72:75], a[8:11], v[112:115]
 s_cselect_b64 s[92:93], s[48:49], -1
 v_exp_f32 v19, v85
M v[112:115], a[76:79], a[12:15], v[112:115]
 s_cselect_b64 s[94:95], s[50:51], -1
 ds_read_b128 a[104:107], v7 offset:59392
 v_cvt_pk_bf16_f32 v59, v24, v25
M v[112:115], a[80:83], a[16:19], v[112:115]
 ds_read_b128 a[108:111], v7 offset:60416
 v_add_f32 v26, v25, v26
M v[112:115], a[84:87], a[20:23], v[112:115]
 buffer_load_dwordx4 v4, s[8:11], s21 offen offset:3072 sc1 lds
M v[112:115], a[88:91], a[24:27], v[112:115]
 s_add_u32 s24, s23, 16777216
 ds_read_b128 a[112:115], v7 offset:61440
 v_add_f32 v27, v18, v27
M v[112:115], a[92:95], a[28:31], v[112:115]
 s_mov_b32 s23, s21
 ds_read_b128 a[116:119], v7 offset:62464
 v_cvt_pk_bf16_f32 v60, v18, v19
M v[116:119], a[92:95], a[60:63], v[36:39]
 s_add_u32 s21, s21, 32768
 v_exp_f32 v20, v86
M v[116:119], a[88:91], a[56:59], v[116:119]
 s_add_u32 s22, s22, 1
 ds_read_b128 a[120:123], v7 offset:63488
 v_add_f32 v27, v19, v27
M v[116:119], a[84:87], a[52:55], v[116:119]
 s_cmp_eq_u32 s22, s25
 ds_read_b128 a[124:127], v7 offset:64512
M v[116:119], a[80:83], a[48:51], v[116:119]
 s_cselect_b32 s21, s26, s21
 v_exp_f32 v21, v87
M v[116:119], a[76:79], a[44:47], v[116:119]
 s_cmp_eq_u32 s22, s43
 v_exp_f32 v22, v92
M v[116:119], a[72:75], a[40:43], v[116:119]
 s_cselect_b32 s21, s4, s21
 v_exp_f32 v23, v93
M v[116:119], a[68:71], a[36:39], v[116:119]
 s_waitcnt vmcnt(9) lgkmcnt(0)
 v_add_f32 v27, v20, v27
 v_cvt_pk_bf16_f32 v61, v20, v21
M v[116:119], a[64:67], a[32:35], v[116:119]
 s_barrier
M v[120:123], a[96:99], a[0:3], v[32:35]
 s_cmp_eq_u32 s22, s6
 ds_read_b128 a[64:67], v2 offset:0
 v_add_f32 v27, v21, v27
M v[120:123], a[100:103], a[4:7], v[120:123]
 s_cselect_b32 s21, s7, s21
 ds_read_b128 a[68:71], v2 offset:1024
 v_add_f32 v27, v22, v27
M v[120:123], a[104:107], a[8:11], v[120:123]
 v_exp_f32 v24, v94
M v[120:123], a[108:111], a[12:15], v[120:123]
 ds_read_b128 a[72:75], v2 offset:2048
 v_cvt_pk_bf16_f32 v62, v22, v23
M v[120:123], a[112:115], a[16:19], v[120:123]
 ds_read_b128 a[76:79], v2 offset:3072
 v_add_f32 v27, v23, v27
M v[120:123], a[116:119], a[20:23], v[120:123]
 v_exp_f32 v25, v95
M v[120:123], a[120:123], a[24:27], v[120:123]
 ds_read_b128 a[80:83], v2 offset:4096
 v_add_f32 v27, v24, v27
M v[120:123], a[124:127], a[28:31], v[120:123]
 ds_read_b128 a[84:87], v2 offset:5120
 v_cvt_pk_bf16_f32 v63, v24, v25
M v[124:127], a[124:127], a[60:63], v[36:39]
 v_add_f32 v27, v25, v27
M v[124:127], a[120:123], a[56:59], v[124:127]
 ds_read_b128 a[88:91], v2 offset:6144
 v_max_f32 v10, v26, v27
M v[124:127], a[116:119], a[52:55], v[124:127]
 ds_read_b128 a[92:95], v2 offset:7168
 v_min_f32 v11, v26, v27
M v[124:127], a[112:115], a[48:51], v[124:127]
 v_cmp_lt_f32 s[36:37], s31, v10
M v[124:127], a[108:111], a[44:47], v[124:127]
 v_cmp_gt_f32 vcc, s55, v11
M v[124:127], a[104:107], a[40:43], v[124:127]
M v[124:127], a[100:103], a[36:39], v[124:127]
 s_waitcnt lgkmcnt(0)
 s_or_b64 vcc, vcc, s[36:37]
M v[124:127], a[96:99], a[32:35], v[124:127]
 s_cbranch_vccnz L_st10
L_rt10:
M v[128:131], a[64:67], v[40:43], 0
 s_add_u32 m0, s28, 0
 ds_read_b128 a[96:99], v2 offset:8192
 ds_read_b128 a[100:103], v2 offset:9216
M v[128:131], a[68:71], v[56:59], v[128:131]
 buffer_load_dwordx4 v3, s[8:11], s24 offen offset:0 sc1 lds
M v[132:135], a[68:71], v[60:63], 0
 v_exp_f32 v18, v96
M v[132:135], a[64:67], v[44:47], v[132:135]
 ds_read_b128 a[104:107], v2 offset:10240
 ds_read_b128 a[108:111], v2 offset:11264
M v[136:139], a[72:75], v[40:43], 0
 buffer_load_dwordx4 v3, s[8:11], s24 offen offset:1024 sc1 lds
M v[136:139], a[76:79], v[56:59], v[136:139]
 v_exp_f32 v19, v97
M v[140:143], a[76:79], v[60:63], 0
 ds_read_b128 a[112:115], v2 offset:12288
 ds_read_b128 a[116:119], v2 offset:13312
M v[140:143], a[72:75], v[44:47], v[140:143]
 buffer_load_dwordx4 v3, s[8:11], s24 offen offset:2048 sc1 lds
M v[144:147], a[80:83], v[40:43], 0
 v_exp_f32 v20, v98
M v[144:147], a[84:87], v[56:59], v[144:147]
 ds_read_b128 a[120:123], v2 offset:14336
 ds_read_b128 a[124:127], v2 offset:15360
M v[148:151], a[84:87], v[60:63], 0
 buffer_load_dwordx4 v3, s[8:11], s24 offen offset:3072 sc1 lds
M v[148:151], a[80:83], v[44:47], v[148:151]
 s_add_u32 m0, s28, 4096
 v_exp_f32 v21, v99
M v[152:155], a[88:91], v[40:43], 0
 buffer_load_dwordx4 v4, s[8:11], s24 offen offset:0 sc1 lds
M v[152:155], a[92:95], v[56:59], v[152:155]
 v_add_f32 v30, v26, v30
 v_add_f32 v31, v27, v31
M v[156:159], a[92:95], v[60:63], 0
 v_exp_f32 v22, v104
M v[156:159], a[88:91], v[44:47], v[156:159]
 s_waitcnt lgkmcnt(0)
 v_add_f32 v28, v18, v19
 v_cvt_pk_bf16_f32 v48, v18, v19
M v[160:163], a[96:99], v[40:43], 0
 ds_read_b128 a[64:67], v2 offset:16384
 ds_read_b128 a[68:71], v2 offset:17408
M v[160:163], a[100:103], v[56:59], v[160:163]
 buffer_load_dwordx4 v4, s[8:11], s24 offen offset:1024 sc1 lds
M v[164:167], a[100:103], v[60:63], 0
 v_exp_f32 v23, v105
M v[164:167], a[96:99], v[44:47], v[164:167]
 ds_read_b128 a[72:75], v2 offset:18432
 ds_read_b128 a[76:79], v2 offset:19456
M v[168:171], a[104:107], v[40:43], 0
 buffer_load_dwordx4 v4, s[8:11], s24 offen offset:2048 sc1 lds
M v[168:171], a[108:111], v[56:59], v[168:171]
 v_add_f32 v28, v20, v28
 v_cvt_pk_bf16_f32 v49, v20, v21
M v[172:175], a[108:111], v[60:63], 0
 ds_read_b128 a[80:83], v2 offset:20480
 ds_read_b128 a[84:87], v2 offset:21504
M v[172:175], a[104:107], v[44:47], v[172:175]
 buffer_load_dwordx4 v4, s[8:11], s24 offen offset:3072 sc1 lds
M v[176:179], a[112:115], v[40:43], 0
 v_exp_f32 v24, v106
M v[176:179], a[116:119], v[56:59], v[176:179]
 s_add_u32 m0, s28, 32768
 ds_read_b128 a[88:91], v2 offset:22528
 ds_read_b128 a[92:95], v2 offset:23552
M v[180:183], a[116:119], v[60:63], 0
 buffer_load_dwordx4 v3, s[8:11], s21 offen offset:0 sc1 lds
M v[180:183], a[112:115], v[44:47], v[180:183]
 v_exp_f32 v25, v107
M v[184:187], a[120:123], v[40:43], 0
 buffer_load_dwordx4 v3, s[8:11], s21 offen offset:1024 sc1 lds
M v[184:187], a[124:127], v[56:59], v[184:187]
 v_exp_f32 v18, v100
M v[188:191], a[124:127], v[60:63], 0
 buffer_load_dwordx4 v3, s[8:11], s21 offen offset:2048 sc1 lds
M v[188:191], a[120:123], v[44:47], v[188:191]
 s_waitcnt lgkmcnt(0)
 v_add_f32 v28, v21, v28
 v_add_f32 v28, v22, v28
M v[192:195], a[64:67], v[40:43], 0
 ds_read_b128 a[96:99], v2 offset:24576
 ds_read_b128 a[100:103], v2 offset:25600
M v[192:195], a[68:71], v[56:59], v[192:195]
 buffer_load_dwordx4 v3, s[8:11], s21 offen offset:3072 sc1 lds
M v[196:199], a[68:71], v[60:63], 0
 v_exp_f32 v19, v101
M v[196:199], a[64:67], v[44:47], v[196:199]
 s_add_u32 m0, s28, 36864
 ds_read_b128 a[104:107], v2 offset:26624
 ds_read_b128 a[108:111], v2 offset:27648
M v[200:203], a[72:75], v[40:43], 0
 buffer_load_dwordx4 v4, s[8:11], s21 offen offset:0 sc1 lds
M v[200:203], a[76:79], v[56:59], v[200:203]
 v_exp_f32 v20, v102
M v[204:207], a[76:79], v[60:63], 0
 ds_read_b128 a[112:115], v2 offset:28672
 ds_read_b128 a[116:119], v2 offset:29696
M v[204:207], a[72:75], v[44:47], v[204:207]
 buffer_load_dwordx4 v4, s[8:11], s21 offen offset:1024 sc1 lds
M v[208:211], a[80:83], v[40:43], 0
 v_exp_f32 v21, v103
M v[208:211], a[84:87], v[56:59], v[208:211]
 ds_read_b128 a[120:123], v2 offset:30720
 ds_read_b128 a[124:127], v2 offset:31744
M v[212:215], a[84:87], v[60:63], 0
 buffer_load_dwordx4 v4, s[8:11], s21 offen offset:2048 sc1 lds
M v[212:215], a[80:83], v[44:47], v[212:215]
 v_cvt_pk_bf16_f32 v50, v22, v23
 v_add_f32 v28, v23, v28
M v[216:219], a[88:91], v[40:43], 0
 v_exp_f32 v22, v108
M v[216:219], a[92:95], v[56:59], v[216:219]
 buffer_load_dwordx4 v4, s[8:11], s21 offen offset:3072 sc1 lds
M v[220:223], a[92:95], v[60:63], 0
 s_waitcnt vmcnt(16) lgkmcnt(0)
 s_add_u32 s24, s23, 16777216
 s_mov_b32 s23, s21
M v[220:223], a[88:91], v[44:47], v[220:223]
 s_barrier
M v[224:227], a[96:99], v[40:43], 0
 ds_read_b128 a[64:67], v2 offset:32768
 ds_read_b128 a[68:71], v2 offset:33792
M v[224:227], a[100:103], v[56:59], v[224:227]
 s_add_u32 s21, s21, 32768
 v_add_f32 v28, v24, v28
M v[228:231], a[100:103], v[60:63], 0
 s_add_u32 s22, s22, 1
 v_exp_f32 v23, v109
M v[228:231], a[96:99], v[44:47], v[228:231]
 s_cmp_eq_u32 s22, s25
 ds_read_b128 a[72:75], v2 offset:34816
 ds_read_b128 a[76:79], v2 offset:35840
M v[232:235], a[104:107], v[40:43], 0
 s_cselect_b32 s21, s26, s21
 v_cvt_pk_bf16_f32 v51, v24, v25
 v_add_f32 v28, v25, v28
M v[232:235], a[108:111], v[56:59], v[232:235]
 s_cmp_eq_u32 s22, s43
 v_exp_f32 v24, v110
M v[236:239], a[108:111], v[60:63], 0
 s_cselect_b32 s21, s4, s21
 ds_read_b128 a[80:83], v2 offset:36864
 ds_read_b128 a[84:87], v2 offset:37888
M v[236:239], a[104:107], v[44:47], v[236:239]
 s_cmp_eq_u32 s22, s6
 v_exp_f32 v25, v111
M v[240:243], a[112:115], v[40:43], 0
 s_cselect_b32 s21, s7, s21
 v_add_f32 v29, v18, v19
 v_cvt_pk_bf16_f32 v52, v18, v19
M v[240:243], a[116:119], v[56:59], v[240:243]
 ds_read_b128 a[88:91], v2 offset:38912
 ds_read_b128 a[92:95], v2 offset:39936
M v[244:247], a[116:119], v[60:63], 0
 v_add_f32 v29, v20, v29
 v_cvt_pk_bf16_f32 v53, v20, v21
M v[244:247], a[112:115], v[44:47], v[244:247]
 v_add_f32 v29, v21, v29
 v_add_f32 v29, v22, v29
M v[248:251], a[120:123], v[40:43], 0
 v_cvt_pk_bf16_f32 v54, v22, v23
 v_add_f32 v29, v23, v29
M v[248:251], a[124:127], v[56:59], v[248:251]
 s_cmp_lg_u32 s27, 0
 v_add_f32 v29, v24, v29
 v_cvt_pk_bf16_f32 v55, v24, v25
M v[252:255], a[124:127], v[60:63], 0
 s_waitcnt lgkmcnt(0)
 v_add_f32 v29, v25, v29
M v[252:255], a[120:123], v[44:47], v[252:255]
 s_cbranch_scc1 L_loop_top
 s_branch L_p1
L_j0:
 s_cmp_eq_u32 s20, 0
 s_cselect_b64 s[64:65], s[16:17], 0
 s_cselect_b64 s[66:67], s[18:19], 0
 s_cselect_b64 s[68:69], s[48:49], 0
 s_cselect_b64 s[70:71], s[50:51], 0
 s_cmp_lt_u32 s20, 1
 s_cselect_b64 s[78:79], -1, 0
 s_cmp_eq_u32 s20, 1
 s_cselect_b64 s[72:73], s[16:17], s[78:79]
 s_cselect_b64 s[74:75], s[18:19], s[78:79]
 s_cselect_b64 s[76:77], s[48:49], s[78:79]
 s_cselect_b64 s[78:79], s[50:51], s[78:79]
 s_cmp_lt_u32 s20, 2
 s_cselect_b64 s[86:87], -1, 0
 s_cmp_eq_u32 s20, 2
 s_cselect_b64 s[80:81], s[16:17], s[86:87]
 s_cselect_b64 s[82:83], s[18:19], s[86:87]
 s_cselect_b64 s[84:85], s[48:49], s[86:87]
 s_cselect_b64 s[86:87], s[50:51], s[86:87]
 s_cmp_eq_u32 s20, 3
 s_cselect_b64 s[88:89], s[16:17], -1
 s_cselect_b64 s[90:91], s[18:19], -1
 s_cselect_b64 s[92:93], s[48:49], -1
 s_cselect_b64 s[94:95], s[50:51], -1
 v_mov_b32 v56, 0
 v_mov_b32 v57, 0
 v_mov_b32 v58, 0
 v_mov_b32 v59, 0
 v_cndmask_b32 v64, v64, v8, s[64:65]
 v_cndmask_b32 v65, v65, v8, s[66:67]
 v_cndmask_b32 v66, v66, v8, s[68:69]
 v_cndmask_b32 v67, v67, v8, s[70:71]
 v_cndmask_b32 v72, v72, v8, s[72:73]
 v_cndmask_b32 v73, v73, v8, s[74:75]
 v_cndmask_b32 v74, v74, v8, s[76:77]
 v_cndmask_b32 v75, v75, v8, s[78:79]
 v_cndmask_b32 v80, v80, v8, s[80:81]
 v_cndmask_b32 v81, v81, v8, s[82:83]
 v_cndmask_b32 v82, v82, v8, s[84:85]
 v_cndmask_b32 v83, v83, v8, s[86:87]
 v_cndmask_b32 v88, v88, v8, s[88:89]
 v_cndmask_b32 v89, v89, v8, s[90:91]
 v_cndmask_b32 v90, v90, v8, s[92:93]
 v_cndmask_b32 v91, v91, v8, s[94:95]
 s_cmp_eq_u32 s20, 3
 s_cselect_b64 s[64:65], s[16:17], 0
 s_cselect_b64 s[66:67], s[18:19], 0
 s_cselect_b64 s[68:69], s[48:49], 0
 s_cselect_b64 s[70:71], s[50:51], 0
 s_cmp_gt_u32 s20, 2
 s_cselect_b64 s[78:79], -1, 0
 s_cmp_eq_u32 s20, 2
 s_cselect_b64 s[72:73], s[16:17], s[78:79]
 s_cselect_b64 s[74:75], s[18:19], s[78:79]
 s_cselect_b64 s[76:77], s[48:49], s[78:79]
 s_cselect_b64 s[78:79], s[50:51], s[78:79]
 s_cmp_gt_u32 s20, 1
 s_cselect_b64 s[86:87], -1, 0
 s_cmp_eq_u32 s20, 1
 s_cselect_b64 s[80:81], s[16:17], s[86:87]
 s_cselect_b64 s[82:83], s[18:19], s[86:87]
 s_cselect_b64 s[84:85], s[48:49], s[86:87]
 s_cselect_b64 s[86:87], s[50:51], s[86:87]
 s_cmp_eq_u32 s20, 0
 s_cselect_b64 s[88:89], s[16:17], -1
 s_cselect_b64 s[90:91], s[18:19], -1
 s_cselect_b64 s[92:93], s[48:49], -1
 s_cselect_b64 s[94:95], s[50:51], -1
 s_add_u32 m0, s28, 98304
 v_max3_f32 v10, v64, v65, v66
 buffer_load_dwordx4 v3, s[8:11], s21 offen offset:0 sc1 lds
 v_max3_f32 v10, v67, v72, v10
 v_max3_f32 v10, v73, v74, v10
 v_max3_f32 v10, v75, v80, v10
 v_max3_f32 v10, v81, v82, v10
 v_max3_f32 v10, v83, v88, v10
 v_max3_f32 v10, v89, v90, v10
 v_max_f32 v10, v91, v10
 v_max3_f32 v11, v68, v69, v70
 v_max3_f32 v11, v71, v76, v11
 v_max3_f32 v11, v77, v78, v11
 v_max3_f32 v11, v79, v84, v11
 v_mfma_f32_32x32x16_bf16 v[128:143], v[56:59], v[56:59], 0
 buffer_load_dwordx4 v3, s[8:11], s21 offen offset:1024 sc1 lds
 v_max3_f32 v11, v85, v86, v11
 v_max3_f32 v11, v87, v92, v11
 v_max3_f32 v11, v93, v94, v11
 v_max_f32 v11, v95, v11
 v_mov_b32 v12, v10
 v_mov_b32 v13, v11
 s_nop 0
 v_permlane16_swap_b32 v12, v10
 v_permlane16_swap_b32 v13, v11
 v_max_f32 v10, v12, v10
 v_max_f32 v11, v13, v11
 v_mov_b32 v12, v10
 buffer_load_dwordx4 v3, s[8:11], s21 offen offset:2048 sc1 lds
 v_mov_b32 v13, v11
 v_mfma_f32_32x32x16_bf16 v[144:159], v[56:59], v[56:59], 0
 v_permlane32_swap_b32 v12, v10
 v_permlane32_swap_b32 v13, v11
 v_max_f32 v10, v12, v10
 v_max_f32 v11, v13, v11
 v_ceil_f32 v10, v10
 v_ceil_f32 v11, v11
 v_sub_f32 v32, v32, v10
 v_sub_f32 v33, v33, v10
 v_sub_f32 v34, v34, v10
 v_sub_f32 v35, v35, v10
 buffer_load_dwordx4 v3, s[8:11], s21 offen offset:3072 sc1 lds
 v_sub_f32 v36, v36, v11
 v_sub_f32 v37, v37, v11
 v_sub_f32 v38, v38, v11
 v_mfma_f32_32x32x16_bf16 v[160:175], v[56:59], v[56:59], 0
 v_sub_f32 v39, v39, v11
 v_sub_f32 v64, v64, v10
 v_sub_f32 v65, v65, v10
 v_sub_f32 v66, v66, v10
 v_sub_f32 v67, v67, v10
 v_sub_f32 v68, v68, v11
 v_sub_f32 v69, v69, v11
 s_add_u32 m0, s28, 102400
 v_sub_f32 v70, v70, v11
 buffer_load_dwordx4 v4, s[8:11], s21 offen offset:0 sc1 lds
 v_sub_f32 v71, v71, v11
 v_sub_f32 v72, v72, v10
 v_sub_f32 v73, v73, v10
 v_sub_f32 v74, v74, v10
 v_mfma_f32_32x32x16_bf16 v[176:191], v[56:59], v[56:59], 0
 v_sub_f32 v75, v75, v10
 v_sub_f32 v76, v76, v11
 v_sub_f32 v77, v77, v11
 v_sub_f32 v78, v78, v11
 v_sub_f32 v79, v79, v11
 v_sub_f32 v80, v80, v10
 v_sub_f32 v81, v81, v10
 buffer_load_dwordx4 v4, s[8:11], s21 offen offset:1024 sc1 lds
 v_sub_f32 v82, v82, v10
 v_sub_f32 v83, v83, v10
 v_sub_f32 v84, v84, v11
 v_sub_f32 v85, v85, v11
 v_sub_f32 v86, v86, v11
 v_sub_f32 v87, v87, v11
 v_mfma_f32_32x32x16_bf16 v[192:207], v[56:59], v[56:59], 0
 v_sub_f32 v88, v88, v10
 v_sub_f32 v89, v89, v10
 v_sub_f32 v90, v90, v10
 v_sub_f32 v91, v91, v10
 v_sub_f32 v92, v92, v11
 buffer_load_dwordx4 v4, s[8:11], s21 offen offset:2048 sc1 lds
 v_sub_f32 v93, v93, v11
 v_sub_f32 v94, v94, v11
 v_sub_f32 v95, v95, v11
 v_exp_f32 v18, v64
 v_exp_f32 v19, v65
 v_exp_f32 v20, v66
 v_add_f32 v26, v18, v19
 v_cvt_pk_bf16_f32 v40, v18, v19
 v_mfma_f32_32x32x16_bf16 v[208:223], v[56:59], v[56:59], 0
 v_exp_f32 v21, v67
 v_exp_f32 v22, v72
 v_add_f32 v26, v20, v26
 buffer_load_dwordx4 v4, s[8:11], s21 offen offset:3072 sc1 lds
 v_cvt_pk_bf16_f32 v41, v20, v21
 v_exp_f32 v23, v73
 v_add_f32 v26, v21, v26
 v_exp_f32 v24, v74
 v_add_f32 v26, v22, v26
 v_cvt_pk_bf16_f32 v42, v22, v23
 v_exp_f32 v25, v75
 v_add_f32 v26, v23, v26
 v_exp_f32 v18, v68
 v_add_f32 v26, v24, v26
 v_mfma_f32_32x32x16_bf16 v[224:239], v[56:59], v[56:59], 0
 s_add_u32 s24, s23, 16777216
 s_mov_b32 s23, s21
 s_add_u32 s21, s21, 32768
 s_add_u32 s22, s22, 1
 s_cmp_eq_u32 s22, s25
 s_cselect_b32 s21, s26, s21
 s_cmp_eq_u32 s22, s43
 s_cselect_b32 s21, s4, s21
 s_cmp_eq_u32 s22, s6
 s_cselect_b32 s21, s7, s21
 v_cvt_pk_bf16_f32 v43, v24, v25
 buffer_load_dword v5, off, s[8:11], s47 sc1
 v_exp_f32 v19, v69
 v_add_f32 v26, v25, v26
 v_mfma_f32_32x32x16_bf16 v[240:255], v[56:59], v[56:59], 0
 v_exp_f32 v20, v70
 v_add_f32 v27, v18, v19
 v_cvt_pk_bf16_f32 v44, v18, v19
 v_exp_f32 v21, v71
 v_exp_f32 v22, v76
 v_add_f32 v27, v20, v27
 v_cvt_pk_bf16_f32 v45, v20, v21
 v_exp_f32 v23, v77
 v_add_f32 v27, v21, v27
 v_exp_f32 v24, v78
 v_add_f32 v27, v22, v27
 v_cvt_pk_bf16_f32 v46, v22, v23
 v_exp_f32 v25, v79
 v_add_f32 v27, v23, v27
 v_add_f32 v27, v24, v27
 v_cvt_pk_bf16_f32 v47, v24, v25
 v_add_f32 v27, v25, v27
 v_cndmask_b32 v100, v36, v8, s[64:65]
 v_cndmask_b32 v101, v36, v8, s[66:67]
 v_cndmask_b32 v102, v36, v8, s[68:69]
 v_cndmask_b32 v103, v36, v8, s[70:71]
 v_cndmask_b32 v108, v36, v8, s[72:73]
 v_cndmask_b32 v109, v36, v8, s[74:75]
 v_cndmask_b32 v110, v36, v8, s[76:77]
 v_cndmask_b32 v111, v36, v8, s[78:79]
 v_cndmask_b32 v116, v36, v8, s[80:81]
 v_cndmask_b32 v117, v36, v8, s[82:83]
 v_cndmask_b32 v118, v36, v8, s[84:85]
 v_cndmask_b32 v119, v36, v8, s[86:87]
 v_cndmask_b32 v124, v36, v8, s[88:89]
 v_cndmask_b32 v125, v36, v8, s[90:91]
 v_cndmask_b32 v126, v36, v8, s[92:93]
 v_cndmask_b32 v127, v36, v8, s[94:95]
 s_branch L_p2
L_kv1:
 s_mov_b32 s60, s90
 s_and_b32 s61, s91, 0xffff
 s_mov_b32 s62, 3670016
 s_mov_b32 s63, 0x20000
 s_waitcnt vmcnt(4) lgkmcnt(0)
 s_barrier
 ds_read_b128 a[160:163], v5 offset:0
 ds_read_b128 a[164:167], v6 offset:0
 ds_read_b64_tr_b16 a[32:33], v1 offset:0
 ds_read_b64_tr_b16 a[34:35], v1 offset:1024
 ds_read_b64_tr_b16 a[36:37], v1 offset:8192
 ds_read_b64_tr_b16 a[38:39], v1 offset:9216
 ds_read_b64_tr_b16 a[40:41], v2 offset:0
 ds_read_b64_tr_b16 a[42:43], v2 offset:1024
 ds_read_b64_tr_b16 a[44:45], v2 offset:8192
 ds_read_b64_tr_b16 a[46:47], v2 offset:9216
 ds_read_b128 a[168:171], v5 offset:2048
 ds_read_b128 a[172:175], v6 offset:2048
 ds_read_b64_tr_b16 a[48:49], v3 offset:0
 ds_read_b64_tr_b16 a[50:51], v3 offset:1024
 ds_read_b64_tr_b16 a[52:53], v3 offset:8192
 ds_read_b64_tr_b16 a[54:55], v3 offset:9216
 ds_read_b64_tr_b16 a[56:57], v4 offset:0
 ds_read_b64_tr_b16 a[58:59], v4 offset:1024
 ds_read_b64_tr_b16 a[60:61], v4 offset:8192
 ds_read_b64_tr_b16 a[62:63], v4 offset:9216
 ds_read_b128 a[176:179], v5 offset:4096
 ds_read_b128 a[180:183], v6 offset:4096
 ds_read_b128 a[184:187], v5 offset:6144
 ds_read_b128 a[188:191], v6 offset:6144
 s_add_u32 m0, s24, 16384
 s_nop 0
 buffer_load_dwordx4 v12, s[48:51], s22 offen offset:0   lds
 buffer_load_dwordx4 v13, s[48:51], s22 offen offset:1024   lds
 buffer_load_dwordx4 v14, s[48:51], s22 offen offset:2048   lds
 buffer_load_dwordx4 v15, s[48:51], s22 offen offset:3072   lds
 s_sub_u32 s22, s22, 2097024
 s_add_u32 m0, s23, 32768
 s_nop 0
 buffer_load_dwordx4 v8, s[16:19], s21 offen offset:0  nt lds
 buffer_load_dwordx4 v9, s[16:19], s21 offen offset:1024  nt lds
 buffer_load_dwordx4 v10, s[16:19], s21 offen offset:2048  nt lds
 buffer_load_dwordx4 v11, s[16:19], s21 offen offset:3072  nt lds
 s_add_u32 s21, s21, 128
 s_waitcnt lgkmcnt(15)
M a[0:3], a[32:35], a[160:163], 0
M a[0:3], a[36:39], a[164:167], a[0:3]
 s_waitcnt lgkmcnt(14)
M a[4:7], a[44:47], a[164:167], 0
M a[4:7], a[40:43], a[160:163], a[4:7]
 s_waitcnt lgkmcnt(8)
M a[8:11], a[48:51], a[160:163], 0
M a[8:11], a[52:55], a[164:167], a[8:11]
 s_waitcnt lgkmcnt(4)
M a[12:15], a[60:63], a[164:167], 0
 s_add_u32 m0, s23, 49152
M a[12:15], a[56:59], a[160:163], a[12:15]
 buffer_load_dwordx4 v8, s[16:19], s21 offen offset:0  nt lds
M v[32:35], a[32:35], a[168:171], 0
 buffer_load_dwordx4 v9, s[16:19], s21 offen offset:1024  nt lds
M v[32:35], a[36:39], a[172:175], v[32:35]
M v[36:39], a[44:47], a[172:175], 0
 buffer_load_dwordx4 v10, s[16:19], s21 offen offset:2048  nt lds
M v[36:39], a[40:43], a[168:171], v[36:39]
M v[40:43], a[48:51], a[168:171], 0
 buffer_load_dwordx4 v11, s[16:19], s21 offen offset:3072  nt lds
M v[40:43], a[52:55], a[172:175], v[40:43]
 s_add_u32 s21, s21, 524160
M v[44:47], a[60:63], a[172:175], 0
 s_waitcnt vmcnt(12) lgkmcnt(0)
M v[44:47], a[56:59], a[168:171], v[44:47]
 s_barrier
M v[64:67], a[32:35], a[176:179], 0
 s_add_u32 m0, s24, 32768
 ds_read_b64_tr_b16 a[64:65], v1 offset:16384
 ds_read_b64_tr_b16 a[66:67], v1 offset:17408
M v[64:67], a[36:39], a[180:183], v[64:67]
 ds_read_b64_tr_b16 a[68:69], v1 offset:24576
 ds_read_b64_tr_b16 a[70:71], v1 offset:25600
M v[68:71], a[44:47], a[180:183], 0
 buffer_load_dwordx4 v12, s[48:51], s22 offen offset:0   lds
M v[68:71], a[40:43], a[176:179], v[68:71]
 ds_read_b64_tr_b16 a[72:73], v2 offset:16384
 ds_read_b64_tr_b16 a[74:75], v2 offset:17408
M v[72:75], a[48:51], a[176:179], 0
 ds_read_b64_tr_b16 a[76:77], v2 offset:24576
 ds_read_b64_tr_b16 a[78:79], v2 offset:25600
M v[72:75], a[52:55], a[180:183], v[72:75]
 buffer_load_dwordx4 v13, s[48:51], s22 offen offset:1024   lds
M v[76:79], a[60:63], a[180:183], 0
 ds_read_b64_tr_b16 a[80:81], v3 offset:16384
 ds_read_b64_tr_b16 a[82:83], v3 offset:17408
M v[76:79], a[56:59], a[176:179], v[76:79]
 ds_read_b64_tr_b16 a[84:85], v3 offset:24576
 ds_read_b64_tr_b16 a[86:87], v3 offset:25600
M v[96:99], a[32:35], a[184:187], 0
 buffer_load_dwordx4 v14, s[48:51], s22 offen offset:2048   lds
M v[96:99], a[36:39], a[188:191], v[96:99]
 ds_read_b64_tr_b16 a[88:89], v4 offset:16384
 ds_read_b64_tr_b16 a[90:91], v4 offset:17408
M v[100:103], a[44:47], a[188:191], 0
 ds_read_b64_tr_b16 a[92:93], v4 offset:24576
 ds_read_b64_tr_b16 a[94:95], v4 offset:25600
M v[100:103], a[40:43], a[184:187], v[100:103]
 buffer_load_dwordx4 v15, s[48:51], s22 offen offset:3072   lds
M v[104:107], a[48:51], a[184:187], 0
 s_add_u32 s22, s22, 2097152
 v_max3_f32 v20, |v32|, |v33|, |v34|
 v_max3_f32 v20, |v35|, |v36|, v20
M v[104:107], a[52:55], a[188:191], v[104:107]
 v_max3_f32 v20, |v37|, |v38|, v20
 v_max3_f32 v21, |v64|, |v65|, |v66|
M v[108:111], a[60:63], a[188:191], 0
 s_add_u32 m0, s23, 0
 v_max3_f32 v21, |v67|, |v68|, v21
 v_max3_f32 v21, |v69|, |v70|, v21
M v[108:111], a[56:59], a[184:187], v[108:111]
 s_waitcnt lgkmcnt(0)
 v_min_f32 v20, v20, v21
 v_mul_f32 v20, 0x41000000, v20
M a[16:19], a[64:67], a[160:163], 0
 buffer_load_dwordx4 v8, s[16:19], s21 offen offset:0  nt lds
M a[16:19], a[68:71], a[164:167], a[16:19]
 v_mov_b32 v21, v20
 v_mov_b32 v22, v20
M a[20:23], a[76:79], a[164:167], 0
 buffer_load_dwordx4 v9, s[16:19], s21 offen offset:1024  nt lds
M a[20:23], a[72:75], a[160:163], a[20:23]
 v_mov_b32 v23, v20
 v_accvgpr_write_b32 a241, v20
M a[24:27], a[80:83], a[160:163], 0
M a[24:27], a[84:87], a[164:167], a[24:27]
M a[28:31], a[92:95], a[164:167], 0
 buffer_load_dwordx4 v10, s[16:19], s21 offen offset:2048  nt lds
M a[28:31], a[88:91], a[160:163], a[28:31]
M v[48:51], a[64:67], a[168:171], v[20:23]
M v[48:51], a[68:71], a[172:175], v[48:51]
 buffer_load_dwordx4 v11, s[16:19], s21 offen offset:3072  nt lds
M v[52:55], a[76:79], a[172:175], v[20:23]
 s_add_u32 s21, s21, 128
M v[52:55], a[72:75], a[168:171], v[52:55]
M v[56:59], a[80:83], a[168:171], v[20:23]
M v[56:59], a[84:87], a[172:175], v[56:59]
M v[60:63], a[92:95], a[172:175], v[20:23]
 s_waitcnt vmcnt(12)
M v[60:63], a[88:91], a[168:171], v[60:63]
 s_barrier
M v[80:83], a[64:67], a[176:179], v[20:23]
 s_add_u32 m0, s24, 49152
 ds_read_b128 a[160:163], v5 offset:16384
 ds_read_b128 a[164:167], v6 offset:16384
M v[80:83], a[68:71], a[180:183], v[80:83]
 buffer_load_dwordx4 v12, s[48:51], s22 offen offset:0   lds
M v[84:87], a[76:79], a[180:183], v[20:23]
 ds_read_b64_tr_b16 a[96:97], v1 offset:32768
 ds_read_b64_tr_b16 a[98:99], v1 offset:33792
M v[84:87], a[72:75], a[176:179], v[84:87]
M v[88:91], a[80:83], a[176:179], v[20:23]
 buffer_load_dwordx4 v13, s[48:51], s22 offen offset:1024   lds
M v[88:91], a[84:87], a[180:183], v[88:91]
 ds_read_b64_tr_b16 a[100:101], v1 offset:40960
 ds_read_b64_tr_b16 a[102:103], v1 offset:41984
M v[92:95], a[92:95], a[180:183], v[20:23]
M v[92:95], a[88:91], a[176:179], v[92:95]
M v[112:115], a[64:67], a[184:187], v[20:23]
 ds_read_b64_tr_b16 a[104:105], v2 offset:32768
 ds_read_b64_tr_b16 a[106:107], v2 offset:33792
M v[112:115], a[68:71], a[188:191], v[112:115]
 buffer_load_dwordx4 v14, s[48:51], s22 offen offset:2048   lds
M v[116:119], a[76:79], a[188:191], v[20:23]
M v[116:119], a[72:75], a[184:187], v[116:119]
 ds_read_b64_tr_b16 a[108:109], v2 offset:40960
 ds_read_b64_tr_b16 a[110:111], v2 offset:41984
M v[120:123], a[80:83], a[184:187], v[20:23]
 buffer_load_dwordx4 v15, s[48:51], s22 offen offset:3072   lds
M v[120:123], a[84:87], a[188:191], v[120:123]
 s_waitcnt lgkmcnt(8)
M v[124:127], a[92:95], a[188:191], v[20:23]
 s_sub_u32 s22, s22, 2097024
M v[124:127], a[88:91], a[184:187], v[124:127]
 s_add_u32 m0, s23, 16384
 ds_read_b64_tr_b16 a[112:113], v3 offset:32768
 ds_read_b64_tr_b16 a[114:115], v3 offset:33792
M v[128:131], a[32:35], a[160:163], v[20:23]
 ds_read_b128 a[168:171], v5 offset:18432
 ds_read_b128 a[172:175], v6 offset:18432
M v[128:131], a[36:39], a[164:167], v[128:131]
 buffer_load_dwordx4 v8, s[16:19], s21 offen offset:0  nt lds
M v[132:135], a[44:47], a[164:167], v[20:23]
 ds_read_b64_tr_b16 a[116:117], v3 offset:40960
 ds_read_b64_tr_b16 a[118:119], v3 offset:41984
M v[132:135], a[40:43], a[160:163], v[132:135]
 buffer_load_dwordx4 v9, s[16:19], s21 offen offset:1024  nt lds
M v[136:139], a[48:51], a[160:163], v[20:23]
M v[136:139], a[52:55], a[164:167], v[136:139]
 ds_read_b64_tr_b16 a[120:121], v4 offset:32768
 ds_read_b64_tr_b16 a[122:123], v4 offset:33792
M v[140:143], a[60:63], a[164:167], v[20:23]
 buffer_load_dwordx4 v10, s[16:19], s21 offen offset:2048  nt lds
M v[140:143], a[56:59], a[160:163], v[140:143]
M v[144:147], a[64:67], a[160:163], v[20:23]
 ds_read_b64_tr_b16 a[124:125], v4 offset:40960
 ds_read_b64_tr_b16 a[126:127], v4 offset:41984
M v[144:147], a[68:71], a[164:167], v[144:147]
 buffer_load_dwordx4 v11, s[16:19], s21 offen offset:3072  nt lds
M v[148:151], a[76:79], a[164:167], v[20:23]
 s_add_u32 s21, s21, 524160
M v[148:151], a[72:75], a[160:163], v[148:151]
M v[152:155], a[80:83], a[160:163], v[20:23]
M v[152:155], a[84:87], a[164:167], v[152:155]
 s_waitcnt lgkmcnt(6)
M v[156:159], a[92:95], a[164:167], v[20:23]
 s_waitcnt vmcnt(16) lgkmcnt(0)
M v[156:159], a[88:91], a[160:163], v[156:159]
 s_barrier
M v[160:163], a[32:35], a[168:171], v[20:23]
 s_add_u32 m0, s24, 0
 ds_read_b128 a[160:163], v5 offset:20480
 ds_read_b128 a[164:167], v6 offset:20480
M v[160:163], a[36:39], a[172:175], v[160:163]
 buffer_load_dwordx4 v12, s[48:51], s22 offen offset:0   lds
M v[164:167], a[44:47], a[172:175], v[20:23]
 ds_read_b64_tr_b16 a[128:129], v1 offset:49152
 ds_read_b64_tr_b16 a[130:131], v1 offset:50176
M v[164:167], a[40:43], a[168:171], v[164:167]
M v[168:171], a[48:51], a[168:171], v[20:23]
 buffer_load_dwordx4 v13, s[48:51], s22 offen offset:1024   lds
M v[168:171], a[52:55], a[172:175], v[168:171]
 ds_read_b64_tr_b16 a[132:133], v1 offset:57344
 ds_read_b64_tr_b16 a[134:135], v1 offset:58368
M v[172:175], a[60:63], a[172:175], v[20:23]
M v[172:175], a[56:59], a[168:171], v[172:175]
M v[176:179], a[64:67], a[168:171], v[20:23]
 ds_read_b64_tr_b16 a[136:137], v2 offset:49152
 ds_read_b64_tr_b16 a[138:139], v2 offset:50176
M v[176:179], a[68:71], a[172:175], v[176:179]
 buffer_load_dwordx4 v14, s[48:51], s22 offen offset:2048   lds
M v[180:183], a[76:79], a[172:175], v[20:23]
M v[180:183], a[72:75], a[168:171], v[180:183]
 ds_read_b64_tr_b16 a[140:141], v2 offset:57344
 ds_read_b64_tr_b16 a[142:143], v2 offset:58368
M v[184:187], a[80:83], a[168:171], v[20:23]
 buffer_load_dwordx4 v15, s[48:51], s22 offen offset:3072   lds
M v[184:187], a[84:87], a[172:175], v[184:187]
 s_waitcnt lgkmcnt(8)
M v[188:191], a[92:95], a[172:175], v[20:23]
 s_add_u32 s22, s22, 2097152
M v[188:191], a[88:91], a[168:171], v[188:191]
 s_add_u32 m0, s23, 32768
 ds_read_b64_tr_b16 a[144:145], v3 offset:49152
 ds_read_b64_tr_b16 a[146:147], v3 offset:50176
M v[192:195], a[32:35], a[160:163], v[20:23]
 ds_read_b128 a[168:171], v5 offset:22528
 ds_read_b128 a[172:175], v6 offset:22528
M v[192:195], a[36:39], a[164:167], v[192:195]
 buffer_load_dwordx4 v8, s[16:19], s21 offen offset:0  nt lds
M v[196:199], a[44:47], a[164:167], v[20:23]
 ds_read_b64_tr_b16 a[148:149], v3 offset:57344
 ds_read_b64_tr_b16 a[150:151], v3 offset:58368
M v[196:199], a[40:43], a[160:163], v[196:199]
 buffer_load_dwordx4 v9, s[16:19], s21 offen offset:1024  nt lds
M v[200:203], a[48:51], a[160:163], v[20:23]
M v[200:203], a[52:55], a[164:167], v[200:203]
 ds_read_b64_tr_b16 a[152:153], v4 offset:49152
 ds_read_b64_tr_b16 a[154:155], v4 offset:50176
M v[204:207], a[60:63], a[164:167], v[20:23]
 buffer_load_dwordx4 v10, s[16:19], s21 offen offset:2048  nt lds
M v[204:207], a[56:59], a[160:163], v[204:207]
M v[208:211], a[64:67], a[160:163], v[20:23]
 ds_read_b64_tr_b16 a[156:157], v4 offset:57344
 ds_read_b64_tr_b16 a[158:159], v4 offset:58368
M v[208:211], a[68:71], a[164:167], v[208:211]
 buffer_load_dwordx4 v11, s[16:19], s21 offen offset:3072  nt lds
M v[212:215], a[76:79], a[164:167], v[20:23]
 s_add_u32 s21, s21, 128
M v[212:215], a[72:75], a[160:163], v[212:215]
M v[216:219], a[80:83], a[160:163], v[20:23]
M v[216:219], a[84:87], a[164:167], v[216:219]
 s_waitcnt lgkmcnt(6)
M v[220:223], a[92:95], a[164:167], v[20:23]
 s_waitcnt vmcnt(16) lgkmcnt(0)
M v[220:223], a[88:91], a[160:163], v[220:223]
 s_barrier
M v[224:227], a[32:35], a[168:171], v[20:23]
 ds_read_b128 a[160:163], v5 offset:32768
 ds_read_b128 a[164:167], v6 offset:32768
M v[224:227], a[36:39], a[172:175], v[224:227]
 buffer_load_dword a240, v24, s[32:35], 0 offen offset:512
M v[228:231], a[44:47], a[172:175], v[20:23]
M v[228:231], a[40:43], a[168:171], v[228:231]
M v[232:235], a[48:51], a[168:171], v[20:23]
M v[232:235], a[52:55], a[172:175], v[232:235]
M v[236:239], a[60:63], a[172:175], v[20:23]
M v[236:239], a[56:59], a[168:171], v[236:239]
M v[240:243], a[64:67], a[168:171], v[20:23]
M v[240:243], a[68:71], a[172:175], v[240:243]
M v[244:247], a[76:79], a[172:175], v[20:23]
M v[244:247], a[72:75], a[168:171], v[244:247]
M v[248:251], a[80:83], a[168:171], v[20:23]
M v[248:251], a[84:87], a[172:175], v[248:251]
 s_waitcnt lgkmcnt(0)
M v[252:255], a[92:95], a[172:175], v[20:23]
M v[252:255], a[88:91], a[168:171], v[252:255]
M a[0:3], a[96:99], a[160:163], a[0:3]
 ds_read_b128 a[168:171], v5 offset:34816
 ds_read_b128 a[172:175], v6 offset:34816
M a[0:3], a[100:103], a[164:167], a[0:3]
 ds_read_b64_tr_b16 a[32:33], v1 offset:0
 ds_read_b64_tr_b16 a[34:35], v1 offset:1024
M a[4:7], a[108:111], a[164:167], a[4:7]
 s_add_u32 m0, s24, 16384
M a[4:7], a[104:107], a[160:163], a[4:7]
 buffer_load_dwordx4 v12, s[48:51], s22 offen offset:0   lds
M a[8:11], a[112:115], a[160:163], a[8:11]
M a[8:11], a[116:119], a[164:167], a[8:11]
M a[12:15], a[124:127], a[164:167], a[12:15]
 ds_read_b64_tr_b16 a[36:37], v1 offset:8192
 ds_read_b64_tr_b16 a[38:39], v1 offset:9216
M a[12:15], a[120:123], a[160:163], a[12:15]
M a[16:19], a[128:131], a[160:163], a[16:19]
 buffer_load_dwordx4 v13, s[48:51], s22 offen offset:1024   lds
M a[16:19], a[132:135], a[164:167], a[16:19]
M a[20:23], a[140:143], a[164:167], a[20:23]
M a[20:23], a[136:139], a[160:163], a[20:23]
 ds_read_b64_tr_b16 a[40:41], v2 offset:0
 ds_read_b64_tr_b16 a[42:43], v2 offset:1024
M a[24:27], a[144:147], a[160:163], a[24:27]
M a[24:27], a[148:151], a[164:167], a[24:27]
 s_waitcnt lgkmcnt(6)
M a[28:31], a[156:159], a[164:167], a[28:31]
 buffer_load_dwordx4 v14, s[48:51], s22 offen offset:2048   lds
M a[28:31], a[152:155], a[160:163], a[28:31]
M v[32:35], a[96:99], a[168:171], v[32:35]
 ds_read_b128 a[160:163], v5 offset:36864
 ds_read_b128 a[164:167], v6 offset:36864
M v[32:35], a[100:103], a[172:175], v[32:35]
 ds_read_b64_tr_b16 a[44:45], v2 offset:8192
 ds_read_b64_tr_b16 a[46:47], v2 offset:9216
M v[36:39], a[108:111], a[172:175], v[36:39]
 buffer_load_dwordx4 v15, s[48:51], s22 offen offset:3072   lds
M v[36:39], a[104:107], a[168:171], v[36:39]
 s_sub_u32 s22, s22, 2097024
M v[40:43], a[112:115], a[168:171], v[40:43]
M v[40:43], a[116:119], a[172:175], v[40:43]
 ds_read_b64_tr_b16 a[48:49], v3 offset:0
 ds_read_b64_tr_b16 a[50:51], v3 offset:1024
M v[44:47], a[124:127], a[172:175], v[44:47]
 s_add_u32 m0, s23, 49152
M v[44:47], a[120:123], a[168:171], v[44:47]
 buffer_load_dwordx4 v8, s[16:19], s21 offen offset:0  nt lds
M v[48:51], a[128:131], a[168:171], v[48:51]
M v[48:51], a[132:135], a[172:175], v[48:51]
M v[52:55], a[140:143], a[172:175], v[52:55]
 ds_read_b64_tr_b16 a[52:53], v3 offset:8192
 ds_read_b64_tr_b16 a[54:55], v3 offset:9216
M v[52:55], a[136:139], a[168:171], v[52:55]
M v[56:59], a[144:147], a[168:171], v[56:59]
 buffer_load_dwordx4 v9, s[16:19], s21 offen offset:1024  nt lds
M v[56:59], a[148:151], a[172:175], v[56:59]
 s_waitcnt lgkmcnt(6)
M v[60:63], a[156:159], a[172:175], v[60:63]
M v[60:63], a[152:155], a[168:171], v[60:63]
 ds_read_b64_tr_b16 a[56:57], v4 offset:0
 ds_read_b64_tr_b16 a[58:59], v4 offset:1024
M v[64:67], a[96:99], a[160:163], v[64:67]
 ds_read_b128 a[168:171], v5 offset:38912
 ds_read_b128 a[172:175], v6 offset:38912
M v[64:67], a[100:103], a[164:167], v[64:67]
 buffer_load_dwordx4 v10, s[16:19], s21 offen offset:2048  nt lds
M v[68:71], a[108:111], a[164:167], v[68:71]
M v[68:71], a[104:107], a[160:163], v[68:71]
M v[72:75], a[112:115], a[160:163], v[72:75]
 ds_read_b64_tr_b16 a[60:61], v4 offset:8192
 ds_read_b64_tr_b16 a[62:63], v4 offset:9216
M v[72:75], a[116:119], a[164:167], v[72:75]
M v[76:79], a[124:127], a[164:167], v[76:79]
 buffer_load_dwordx4 v11, s[16:19], s21 offen offset:3072  nt lds
M v[76:79], a[120:123], a[160:163], v[76:79]
 s_add_u32 s21, s21, 524160
M v[80:83], a[128:131], a[160:163], v[80:83]
M v[80:83], a[132:135], a[164:167], v[80:83]
M v[84:87], a[140:143], a[164:167], v[84:87]
M v[84:87], a[136:139], a[160:163], v[84:87]
M v[88:91], a[144:147], a[160:163], v[88:91]
M v[88:91], a[148:151], a[164:167], v[88:91]
 s_waitcnt lgkmcnt(2)
M v[92:95], a[156:159], a[164:167], v[92:95]
 s_waitcnt vmcnt(17) lgkmcnt(0)
M v[92:95], a[152:155], a[160:163], v[92:95]
 s_barrier
M v[96:99], a[96:99], a[168:171], v[96:99]
 ds_read_b128 a[160:163], v5 offset:49152
 ds_read_b128 a[164:167], v6 offset:49152
M v[96:99], a[100:103], a[172:175], v[96:99]
M v[100:103], a[108:111], a[172:175], v[100:103]
 s_add_u32 m0, s24, 32768
 ds_read_b64_tr_b16 a[64:65], v1 offset:16384
 ds_read_b64_tr_b16 a[66:67], v1 offset:17408
M v[100:103], a[104:107], a[168:171], v[100:103]
 buffer_load_dwordx4 v12, s[48:51], s22 offen offset:0   lds
M v[104:107], a[112:115], a[168:171], v[104:107]
M v[104:107], a[116:119], a[172:175], v[104:107]
M v[108:111], a[124:127], a[172:175], v[108:111]
M v[108:111], a[120:123], a[168:171], v[108:111]
M v[112:115], a[128:131], a[168:171], v[112:115]
M v[112:115], a[132:135], a[172:175], v[112:115]
 ds_read_b64_tr_b16 a[68:69], v1 offset:24576
 ds_read_b64_tr_b16 a[70:71], v1 offset:25600
M v[116:119], a[140:143], a[172:175], v[116:119]
 buffer_load_dwordx4 v13, s[48:51], s22 offen offset:1024   lds
M v[116:119], a[136:139], a[168:171], v[116:119]
M v[120:123], a[144:147], a[168:171], v[120:123]
M v[120:123], a[148:151], a[172:175], v[120:123]
 s_waitcnt lgkmcnt(4)
M v[124:127], a[156:159], a[172:175], v[124:127]
M v[124:127], a[152:155], a[168:171], v[124:127]
M v[128:131], a[96:99], a[160:163], v[128:131]
 ds_read_b128 a[168:171], v5 offset:51200
 ds_read_b128 a[172:175], v6 offset:51200
M v[128:131], a[100:103], a[164:167], v[128:131]
 ds_read_b64_tr_b16 a[72:73], v2 offset:16384
 ds_read_b64_tr_b16 a[74:75], v2 offset:17408
M v[132:135], a[108:111], a[164:167], v[132:135]
 buffer_load_dwordx4 v14, s[48:51], s22 offen offset:2048   lds
M v[132:135], a[104:107], a[160:163], v[132:135]
M v[136:139], a[112:115], a[160:163], v[136:139]
M v[136:139], a[116:119], a[164:167], v[136:139]
M v[140:143], a[124:127], a[164:167], v[140:143]
M v[140:143], a[120:123], a[160:163], v[140:143]
 ds_read_b64_tr_b16 a[76:77], v2 offset:24576
 ds_read_b64_tr_b16 a[78:79], v2 offset:25600
M v[144:147], a[128:131], a[160:163], v[144:147]
 buffer_load_dwordx4 v15, s[48:51], s22 offen offset:3072   lds
M v[144:147], a[132:135], a[164:167], v[144:147]
 s_add_u32 s22, s22, 2097152
M v[148:151], a[140:143], a[164:167], v[148:151]
M v[148:151], a[136:139], a[160:163], v[148:151]
M v[152:155], a[144:147], a[160:163], v[152:155]
M v[152:155], a[148:151], a[164:167], v[152:155]
 s_waitcnt lgkmcnt(4)
M v[156:159], a[156:159], a[164:167], v[156:159]
 s_add_u32 m0, s23, 0
 ds_read_b64_tr_b16 a[80:81], v3 offset:16384
 ds_read_b64_tr_b16 a[82:83], v3 offset:17408
M v[156:159], a[152:155], a[160:163], v[156:159]
 buffer_load_dwordx4 v8, s[16:19], s21 offen offset:0  nt lds
M v[160:163], a[96:99], a[168:171], v[160:163]
 ds_read_b128 a[160:163], v5 offset:53248
 ds_read_b128 a[164:167], v6 offset:53248
M v[160:163], a[100:103], a[172:175], v[160:163]
M v[164:167], a[108:111], a[172:175], v[164:167]
M v[164:167], a[104:107], a[168:171], v[164:167]
M v[168:171], a[112:115], a[168:171], v[168:171]
M v[168:171], a[116:119], a[172:175], v[168:171]
 ds_read_b64_tr_b16 a[84:85], v3 offset:24576
 ds_read_b64_tr_b16 a[86:87], v3 offset:25600
M v[172:175], a[124:127], a[172:175], v[172:175]
 buffer_load_dwordx4 v9, s[16:19], s21 offen offset:1024  nt lds
M v[172:175], a[120:123], a[168:171], v[172:175]
M v[176:179], a[128:131], a[168:171], v[176:179]
M v[176:179], a[132:135], a[172:175], v[176:179]
M v[180:183], a[140:143], a[172:175], v[180:183]
M v[180:183], a[136:139], a[168:171], v[180:183]
M v[184:187], a[144:147], a[168:171], v[184:187]
 ds_read_b64_tr_b16 a[88:89], v4 offset:16384
 ds_read_b64_tr_b16 a[90:91], v4 offset:17408
M v[184:187], a[148:151], a[172:175], v[184:187]
 s_waitcnt lgkmcnt(4)
M v[188:191], a[156:159], a[172:175], v[188:191]
 buffer_load_dwordx4 v10, s[16:19], s21 offen offset:2048  nt lds
M v[188:191], a[152:155], a[168:171], v[188:191]
M v[192:195], a[96:99], a[160:163], v[192:195]
 ds_read_b128 a[168:171], v5 offset:55296
 ds_read_b128 a[172:175], v6 offset:55296
M v[192:195], a[100:103], a[164:167], v[192:195]
M v[196:199], a[108:111], a[164:167], v[196:199]
M v[196:199], a[104:107], a[160:163], v[196:199]
 ds_read_b64_tr_b16 a[92:93], v4 offset:24576
 ds_read_b64_tr_b16 a[94:95], v4 offset:25600
M v[200:203], a[112:115], a[160:163], v[200:203]
 buffer_load_dwordx4 v11, s[16:19], s21 offen offset:3072  nt lds
M v[200:203], a[116:119], a[164:167], v[200:203]
 s_add_u32 s21, s21, 128
M v[204:207], a[124:127], a[164:167], v[204:207]
M v[204:207], a[120:123], a[160:163], v[204:207]
M v[208:211], a[128:131], a[160:163], v[208:211]
M v[208:211], a[132:135], a[164:167], v[208:211]
M v[212:215], a[140:143], a[164:167], v[212:215]
M v[212:215], a[136:139], a[160:163], v[212:215]
M v[216:219], a[144:147], a[160:163], v[216:219]
M v[216:219], a[148:151], a[164:167], v[216:219]
 s_waitcnt lgkmcnt(2)
M v[220:223], a[156:159], a[164:167], v[220:223]
 s_waitcnt vmcnt(17) lgkmcnt(0)
M v[220:223], a[152:155], a[160:163], v[220:223]
 s_barrier
M v[224:227], a[96:99], a[168:171], v[224:227]
 ds_read_b128 a[160:163], v5 offset:0
 ds_read_b128 a[164:167], v6 offset:0
M v[224:227], a[100:103], a[172:175], v[224:227]
M v[228:231], a[108:111], a[172:175], v[228:231]
M v[228:231], a[104:107], a[168:171], v[228:231]
M v[232:235], a[112:115], a[168:171], v[232:235]
M v[232:235], a[116:119], a[172:175], v[232:235]
M v[236:239], a[124:127], a[172:175], v[236:239]
M v[236:239], a[120:123], a[168:171], v[236:239]
M v[240:243], a[128:131], a[168:171], v[240:243]
M v[240:243], a[132:135], a[172:175], v[240:243]
M v[244:247], a[140:143], a[172:175], v[244:247]
M v[244:247], a[136:139], a[168:171], v[244:247]
M v[248:251], a[144:147], a[168:171], v[248:251]
M v[248:251], a[148:151], a[172:175], v[248:251]
 s_waitcnt lgkmcnt(0)
M v[252:255], a[156:159], a[172:175], v[252:255]
M v[252:255], a[152:155], a[168:171], v[252:255]
M a[0:3], a[32:35], a[160:163], a[0:3]
 ds_read_b128 a[168:171], v5 offset:2048
 ds_read_b128 a[172:175], v6 offset:2048
M a[0:3], a[36:39], a[164:167], a[0:3]
 ds_read_b64_tr_b16 a[96:97], v1 offset:32768
 ds_read_b64_tr_b16 a[98:99], v1 offset:33792
M a[4:7], a[44:47], a[164:167], a[4:7]
 s_add_u32 m0, s24, 49152
M a[4:7], a[40:43], a[160:163], a[4:7]
 buffer_load_dwordx4 v12, s[48:51], s22 offen offset:0   lds
M a[8:11], a[48:51], a[160:163], a[8:11]
M a[8:11], a[52:55], a[164:167], a[8:11]
M a[12:15], a[60:63], a[164:167], a[12:15]
 ds_read_b64_tr_b16 a[100:101], v1 offset:40960
 ds_read_b64_tr_b16 a[102:103], v1 offset:41984
M a[12:15], a[56:59], a[160:163], a[12:15]
M a[16:19], a[64:67], a[160:163], a[16:19]
 buffer_load_dwordx4 v13, s[48:51], s22 offen offset:1024   lds
M a[16:19], a[68:71], a[164:167], a[16:19]
M a[20:23], a[76:79], a[164:167], a[20:23]
 v_mov_b32 v16, 0x3f80
M a[20:23], a[72:75], a[160:163], a[20:23]
 ds_read_b64_tr_b16 a[104:105], v2 offset:32768
 ds_read_b64_tr_b16 a[106:107], v2 offset:33792
M a[24:27], a[80:83], a[160:163], a[24:27]
 v_lshrrev_b32 v17, 8, v7
M a[24:27], a[84:87], a[164:167], a[24:27]
 s_waitcnt lgkmcnt(6)
 v_bfe_u32 v18, v7, 6, 2
M a[28:31], a[92:95], a[164:167], a[28:31]
 buffer_load_dwordx4 v14, s[48:51], s22 offen offset:2048   lds
M a[28:31], a[88:91], a[160:163], a[28:31]
 v_and_b32 v19, 16, v7
M v[32:35], a[32:35], a[168:171], v[32:35]
 ds_read_b128 a[160:163], v5 offset:4096
 ds_read_b128 a[164:167], v6 offset:4096
M v[32:35], a[36:39], a[172:175], v[32:35]
 ds_read_b64_tr_b16 a[108:109], v2 offset:40960
 ds_read_b64_tr_b16 a[110:111], v2 offset:41984
M v[36:39], a[44:47], a[172:175], v[36:39]
 buffer_load_dwordx4 v15, s[48:51], s22 offen offset:3072   lds
M v[36:39], a[40:43], a[168:171], v[36:39]
 s_sub_u32 s22, s22, 2097024
 v_lshlrev_b32 v19, v19, v16
M v[40:43], a[48:51], a[168:171], v[40:43]
 v_cmp_eq_u32 vcc, v17, v18
M v[40:43], a[52:55], a[172:175], v[40:43]
 ds_read_b64_tr_b16 a[112:113], v3 offset:32768
 ds_read_b64_tr_b16 a[114:115], v3 offset:33792
M v[44:47], a[60:63], a[172:175], v[44:47]
 s_add_u32 m0, s23, 16384
 v_and_b32 v16, 32, v7
M v[44:47], a[56:59], a[168:171], v[44:47]
 buffer_load_dwordx4 v8, s[16:19], s21 offen offset:0  nt lds
M v[48:51], a[64:67], a[168:171], v[48:51]
 v_accvgpr_write_b32 a244, 0
M v[48:51], a[68:71], a[172:175], v[48:51]
 v_accvgpr_write_b32 a245, 0
M v[52:55], a[76:79], a[172:175], v[52:55]
 ds_read_b64_tr_b16 a[116:117], v3 offset:40960
 ds_read_b64_tr_b16 a[118:119], v3 offset:41984
M v[52:55], a[72:75], a[168:171], v[52:55]
 v_cndmask_b32 v19, 0, v19, vcc
M v[56:59], a[80:83], a[168:171], v[56:59]
 buffer_load_dwordx4 v9, s[16:19], s21 offen offset:1024  nt lds
M v[56:59], a[84:87], a[172:175], v[56:59]
 s_waitcnt lgkmcnt(6)
 v_cmp_eq_u32 vcc, 0, v16
M v[60:63], a[92:95], a[172:175], v[60:63]
 v_accvgpr_write_b32 a248, 0
M v[60:63], a[88:91], a[168:171], v[60:63]
 ds_read_b64_tr_b16 a[120:121], v4 offset:32768
 ds_read_b64_tr_b16 a[122:123], v4 offset:33792
M v[64:67], a[32:35], a[160:163], v[64:67]
 ds_read_b128 a[168:171], v5 offset:6144
 ds_read_b128 a[172:175], v6 offset:6144
M v[64:67], a[36:39], a[164:167], v[64:67]
 buffer_load_dwordx4 v10, s[16:19], s21 offen offset:2048  nt lds
M v[68:71], a[44:47], a[164:167], v[68:71]
 v_accvgpr_write_b32 a249, 0
M v[68:71], a[40:43], a[160:163], v[68:71]
 v_cndmask_b32 v17, 0, v19, vcc
M v[72:75], a[48:51], a[160:163], v[72:75]
 ds_read_b64_tr_b16 a[124:125], v4 offset:40960
 ds_read_b64_tr_b16 a[126:127], v4 offset:41984
M v[72:75], a[52:55], a[164:167], v[72:75]
 v_sub_u32 v18, v19, v17
M v[76:79], a[60:63], a[164:167], v[76:79]
 buffer_load_dwordx4 v11, s[16:19], s21 offen offset:3072  nt lds
M v[76:79], a[56:59], a[160:163], v[76:79]
 s_add_u32 s21, s21, 524160
 v_accvgpr_write_b32 a246, v17
M v[80:83], a[64:67], a[160:163], v[80:83]
 v_accvgpr_write_b32 a247, v18
M v[80:83], a[68:71], a[164:167], v[80:83]
M v[84:87], a[76:79], a[164:167], v[84:87]
M v[84:87], a[72:75], a[160:163], v[84:87]
M v[88:91], a[80:83], a[160:163], v[88:91]
M v[88:91], a[84:87], a[164:167], v[88:91]
 s_waitcnt lgkmcnt(2)
M v[92:95], a[92:95], a[164:167], v[92:95]
 s_waitcnt vmcnt(16) lgkmcnt(0)
M v[92:95], a[88:91], a[160:163], v[92:95]
 s_barrier
M v[96:99], a[32:35], a[168:171], v[96:99]
 ds_read_b128 a[160:163], v5 offset:16384
 ds_read_b128 a[164:167], v6 offset:16384
M v[96:99], a[36:39], a[172:175], v[96:99]
M v[100:103], a[44:47], a[172:175], v[100:103]
 s_add_u32 m0, s24, 0
 ds_read_b64_tr_b16 a[128:129], v1 offset:49152
 ds_read_b64_tr_b16 a[130:131], v1 offset:50176
M v[100:103], a[40:43], a[168:171], v[100:103]
 buffer_load_dwordx4 v12, s[48:51], s22 offen offset:0   lds
M v[104:107], a[48:51], a[168:171], v[104:107]
M v[104:107], a[52:55], a[172:175], v[104:107]
M v[108:111], a[60:63], a[172:175], v[108:111]
M v[108:111], a[56:59], a[168:171], v[108:111]
M v[112:115], a[64:67], a[168:171], v[112:115]
M v[112:115], a[68:71], a[172:175], v[112:115]
 ds_read_b64_tr_b16 a[132:133], v1 offset:57344
 ds_read_b64_tr_b16 a[134:135], v1 offset:58368
M v[116:119], a[76:79], a[172:175], v[116:119]
 buffer_load_dwordx4 v13, s[48:51], s22 offen offset:1024   lds
M v[116:119], a[72:75], a[168:171], v[116:119]
M v[120:123], a[80:83], a[168:171], v[120:123]
M v[120:123], a[84:87], a[172:175], v[120:123]
 s_waitcnt lgkmcnt(4)
M v[124:127], a[92:95], a[172:175], v[124:127]
M v[124:127], a[88:91], a[168:171], v[124:127]
M v[128:131], a[32:35], a[160:163], v[128:131]
 ds_read_b128 a[168:171], v5 offset:18432
 ds_read_b128 a[172:175], v6 offset:18432
M v[128:131], a[36:39], a[164:167], v[128:131]
 ds_read_b64_tr_b16 a[136:137], v2 offset:49152
 ds_read_b64_tr_b16 a[138:139], v2 offset:50176
M v[132:135], a[44:47], a[164:167], v[132:135]
 buffer_load_dwordx4 v14, s[48:51], s22 offen offset:2048   lds
M v[132:135], a[40:43], a[160:163], v[132:135]
M v[136:139], a[48:51], a[160:163], v[136:139]
M v[136:139], a[52:55], a[164:167], v[136:139]
M v[140:143], a[60:63], a[164:167], v[140:143]
M v[140:143], a[56:59], a[160:163], v[140:143]
 ds_read_b64_tr_b16 a[140:141], v2 offset:57344
 ds_read_b64_tr_b16 a[142:143], v2 offset:58368
M v[144:147], a[64:67], a[160:163], v[144:147]
 buffer_load_dwordx4 v15, s[48:51], s22 offen offset:3072   lds
M v[144:147], a[68:71], a[164:167], v[144:147]
 s_add_u32 s22, s22, 2097152
M v[148:151], a[76:79], a[164:167], v[148:151]
M v[148:151], a[72:75], a[160:163], v[148:151]
M v[152:155], a[80:83], a[160:163], v[152:155]
M v[152:155], a[84:87], a[164:167], v[152:155]
 s_waitcnt lgkmcnt(4)
M v[156:159], a[92:95], a[164:167], v[156:159]
 s_add_u32 m0, s23, 32768
 ds_read_b64_tr_b16 a[144:145], v3 offset:49152
 ds_read_b64_tr_b16 a[146:147], v3 offset:50176
M v[156:159], a[88:91], a[160:163], v[156:159]
 buffer_load_dwordx4 v8, s[16:19], s21 offen offset:0  nt lds
M v[160:163], a[32:35], a[168:171], v[160:163]
 ds_read_b128 a[160:163], v5 offset:20480
 ds_read_b128 a[164:167], v6 offset:20480
M v[160:163], a[36:39], a[172:175], v[160:163]
M v[164:167], a[44:47], a[172:175], v[164:167]
M v[164:167], a[40:43], a[168:171], v[164:167]
M v[168:171], a[48:51], a[168:171], v[168:171]
M v[168:171], a[52:55], a[172:175], v[168:171]
 ds_read_b64_tr_b16 a[148:149], v3 offset:57344
 ds_read_b64_tr_b16 a[150:151], v3 offset:58368
M v[172:175], a[60:63], a[172:175], v[172:175]
 buffer_load_dwordx4 v9, s[16:19], s21 offen offset:1024  nt lds
M v[172:175], a[56:59], a[168:171], v[172:175]
M v[176:179], a[64:67], a[168:171], v[176:179]
M v[176:179], a[68:71], a[172:175], v[176:179]
M v[180:183], a[76:79], a[172:175], v[180:183]
M v[180:183], a[72:75], a[168:171], v[180:183]
M v[184:187], a[80:83], a[168:171], v[184:187]
 ds_read_b64_tr_b16 a[152:153], v4 offset:49152
 ds_read_b64_tr_b16 a[154:155], v4 offset:50176
M v[184:187], a[84:87], a[172:175], v[184:187]
 s_waitcnt lgkmcnt(4)
M v[188:191], a[92:95], a[172:175], v[188:191]
 buffer_load_dwordx4 v10, s[16:19], s21 offen offset:2048  nt lds
M v[188:191], a[88:91], a[168:171], v[188:191]
M v[192:195], a[32:35], a[160:163], v[192:195]
 ds_read_b128 a[168:171], v5 offset:22528
 ds_read_b128 a[172:175], v6 offset:22528
M v[192:195], a[36:39], a[164:167], v[192:195]
M v[196:199], a[44:47], a[164:167], v[196:199]
M v[196:199], a[40:43], a[160:163], v[196:199]
 ds_read_b64_tr_b16 a[156:157], v4 offset:57344
 ds_read_b64_tr_b16 a[158:159], v4 offset:58368
M v[200:203], a[48:51], a[160:163], v[200:203]
 buffer_load_dwordx4 v11, s[16:19], s21 offen offset:3072  nt lds
M v[200:203], a[52:55], a[164:167], v[200:203]
 s_add_u32 s21, s21, 128
M v[204:207], a[60:63], a[164:167], v[204:207]
M v[204:207], a[56:59], a[160:163], v[204:207]
M v[208:211], a[64:67], a[160:163], v[208:211]
M v[208:211], a[68:71], a[164:167], v[208:211]
M v[212:215], a[76:79], a[164:167], v[212:215]
M v[212:215], a[72:75], a[160:163], v[212:215]
M v[216:219], a[80:83], a[160:163], v[216:219]
M v[216:219], a[84:87], a[164:167], v[216:219]
 s_waitcnt lgkmcnt(2)
M v[220:223], a[92:95], a[164:167], v[220:223]
 s_waitcnt vmcnt(16) lgkmcnt(0)
M v[220:223], a[88:91], a[160:163], v[220:223]
 s_barrier
M v[224:227], a[32:35], a[168:171], v[224:227]
 ds_read_b128 a[160:163], v5 offset:32768
 ds_read_b128 a[164:167], v6 offset:32768
M v[224:227], a[36:39], a[172:175], v[224:227]
M v[228:231], a[44:47], a[172:175], v[228:231]
M v[228:231], a[40:43], a[168:171], v[228:231]
M v[232:235], a[48:51], a[168:171], v[232:235]
M v[232:235], a[52:55], a[172:175], v[232:235]
M v[236:239], a[60:63], a[172:175], v[236:239]
M v[236:239], a[56:59], a[168:171], v[236:239]
M v[240:243], a[64:67], a[168:171], v[240:243]
M v[240:243], a[68:71], a[172:175], v[240:243]
M v[244:247], a[76:79], a[172:175], v[244:247]
M v[244:247], a[72:75], a[168:171], v[244:247]
M v[248:251], a[80:83], a[168:171], v[248:251]
M v[248:251], a[84:87], a[172:175], v[248:251]
 s_waitcnt lgkmcnt(0)
M v[252:255], a[92:95], a[172:175], v[252:255]
M v[252:255], a[88:91], a[168:171], v[252:255]
M a[0:3], a[96:99], a[160:163], a[0:3]
 ds_read_b128 a[168:171], v5 offset:34816
 ds_read_b128 a[172:175], v6 offset:34816
M a[0:3], a[100:103], a[164:167], a[0:3]
 ds_read_b64_tr_b16 a[32:33], v1 offset:0
 ds_read_b64_tr_b16 a[34:35], v1 offset:1024
M a[4:7], a[108:111], a[164:167], a[4:7]
 s_add_u32 m0, s24, 16384
M a[4:7], a[104:107], a[160:163], a[4:7]
 buffer_load_dwordx4 v12, s[48:51], s22 offen offset:0   lds
M a[8:11], a[112:115], a[160:163], a[8:11]
M a[8:11], a[116:119], a[164:167], a[8:11]
M a[12:15], a[124:127], a[164:167], a[12:15]
 ds_read_b64_tr_b16 a[36:37], v1 offset:8192
 ds_read_b64_tr_b16 a[38:39], v1 offset:9216
M a[12:15], a[120:123], a[160:163], a[12:15]
M a[16:19], a[128:131], a[160:163], a[16:19]
 buffer_load_dwordx4 v13, s[48:51], s22 offen offset:1024   lds
M a[16:19], a[132:135], a[164:167], a[16:19]
M a[20:23], a[140:143], a[164:167], a[20:23]
M a[20:23], a[136:139], a[160:163], a[20:23]
 ds_read_b64_tr_b16 a[40:41], v2 offset:0
 ds_read_b64_tr_b16 a[42:43], v2 offset:1024
M a[24:27], a[144:147], a[160:163], a[24:27]
M a[24:27], a[148:151], a[164:167], a[24:27]
 s_waitcnt lgkmcnt(6)
M a[28:31], a[156:159], a[164:167], a[28:31]
 buffer_load_dwordx4 v14, s[48:51], s22 offen offset:2048   lds
M a[28:31], a[152:155], a[160:163], a[28:31]
M v[32:35], a[96:99], a[168:171], v[32:35]
 ds_read_b128 a[160:163], v5 offset:36864
 ds_read_b128 a[164:167], v6 offset:36864
M v[32:35], a[100:103], a[172:175], v[32:35]
 ds_read_b64_tr_b16 a[44:45], v2 offset:8192
 ds_read_b64_tr_b16 a[46:47], v2 offset:9216
M v[36:39], a[108:111], a[172:175], v[36:39]
 buffer_load_dwordx4 v15, s[48:51], s22 offen offset:3072   lds
M v[36:39], a[104:107], a[168:171], v[36:39]
 s_sub_u32 s22, s22, 2097024
M v[40:43], a[112:115], a[168:171], v[40:43]
M v[40:43], a[116:119], a[172:175], v[40:43]
 ds_read_b64_tr_b16 a[48:49], v3 offset:0
 ds_read_b64_tr_b16 a[50:51], v3 offset:1024
M v[44:47], a[124:127], a[172:175], v[44:47]
 s_add_u32 m0, s23, 49152
M v[44:47], a[120:123], a[168:171], v[44:47]
 buffer_load_dwordx4 v8, s[16:19], s21 offen offset:0  nt lds
M v[48:51], a[128:131], a[168:171], v[48:51]
M v[48:51], a[132:135], a[172:175], v[48:51]
M v[52:55], a[140:143], a[172:175], v[52:55]
 ds_read_b64_tr_b16 a[52:53], v3 offset:8192
 ds_read_b64_tr_b16 a[54:55], v3 offset:9216
M v[52:55], a[136:139], a[168:171], v[52:55]
M v[56:59], a[144:147], a[168:171], v[56:59]
 buffer_load_dwordx4 v9, s[16:19], s21 offen offset:1024  nt lds
M v[56:59], a[148:151], a[172:175], v[56:59]
 s_waitcnt lgkmcnt(6)
M v[60:63], a[156:159], a[172:175], v[60:63]
M v[60:63], a[152:155], a[168:171], v[60:63]
 ds_read_b64_tr_b16 a[56:57], v4 offset:0
 ds_read_b64_tr_b16 a[58:59], v4 offset:1024
M v[64:67], a[96:99], a[160:163], v[64:67]
 ds_read_b128 a[168:171], v5 offset:38912
 ds_read_b128 a[172:175], v6 offset:38912
M v[64:67], a[100:103], a[164:167], v[64:67]
 buffer_load_dwordx4 v10, s[16:19], s21 offen offset:2048  nt lds
M v[68:71], a[108:111], a[164:167], v[68:71]
M v[68:71], a[104:107], a[160:163], v[68:71]
M v[72:75], a[112:115], a[160:163], v[72:75]
 ds_read_b64_tr_b16 a[60:61], v4 offset:8192
 ds_read_b64_tr_b16 a[62:63], v4 offset:9216
M v[72:75], a[116:119], a[164:167], v[72:75]
M v[76:79], a[124:127], a[164:167], v[76:79]
 buffer_load_dwordx4 v11, s[16:19], s21 offen offset:3072  nt lds
M v[76:79], a[120:123], a[160:163], v[76:79]
 s_add_u32 s21, s21, 524160
M v[80:83], a[128:131], a[160:163], v[80:83]
M v[80:83], a[132:135], a[164:167], v[80:83]
M v[84:87], a[140:143], a[164:167], v[84:87]
M v[84:87], a[136:139], a[160:163], v[84:87]
M v[88:91], a[144:147], a[160:163], v[88:91]
M v[88:91], a[148:151], a[164:167], v[88:91]
 s_waitcnt lgkmcnt(2)
M v[92:95], a[156:159], a[164:167], v[92:95]
 s_waitcnt vmcnt(16) lgkmcnt(0)
M v[92:95], a[152:155], a[160:163], v[92:95]
 s_barrier
M v[96:99], a[96:99], a[168:171], v[96:99]
 ds_read_b128 a[160:163], v5 offset:49152
 ds_read_b128 a[164:167], v6 offset:49152
M v[96:99], a[100:103], a[172:175], v[96:99]
M v[100:103], a[108:111], a[172:175], v[100:103]
 s_add_u32 m0, s24, 32768
 ds_read_b64_tr_b16 a[64:65], v1 offset:16384
 ds_read_b64_tr_b16 a[66:67], v1 offset:17408
M v[100:103], a[104:107], a[168:171], v[100:103]
 buffer_load_dwordx4 v12, s[48:51], s22 offen offset:0   lds
M v[104:107], a[112:115], a[168:171], v[104:107]
 v_min_u32 v16, 40, v0
 v_lshlrev_b32 v16, 2, v16
M v[104:107], a[116:119], a[172:175], v[104:107]
 buffer_load_dword v17, v16, s[12:15], 0 offen offset:64 sc1
M v[108:111], a[124:127], a[172:175], v[108:111]
M v[108:111], a[120:123], a[168:171], v[108:111]
M v[112:115], a[128:131], a[168:171], v[112:115]
M v[112:115], a[132:135], a[172:175], v[112:115]
 ds_read_b64_tr_b16 a[68:69], v1 offset:24576
 ds_read_b64_tr_b16 a[70:71], v1 offset:25600
M v[116:119], a[140:143], a[172:175], v[116:119]
 buffer_load_dwordx4 v13, s[48:51], s22 offen offset:1024   lds
M v[116:119], a[136:139], a[168:171], v[116:119]
M v[120:123], a[144:147], a[168:171], v[120:123]
M v[120:123], a[148:151], a[172:175], v[120:123]
 s_waitcnt lgkmcnt(4)
M v[124:127], a[156:159], a[172:175], v[124:127]
M v[124:127], a[152:155], a[168:171], v[124:127]
M v[128:131], a[96:99], a[160:163], v[128:131]
 ds_read_b128 a[168:171], v5 offset:51200
 ds_read_b128 a[172:175], v6 offset:51200
M v[128:131], a[100:103], a[164:167], v[128:131]
 ds_read_b64_tr_b16 a[72:73], v2 offset:16384
 ds_read_b64_tr_b16 a[74:75], v2 offset:17408
M v[132:135], a[108:111], a[164:167], v[132:135]
 buffer_load_dwordx4 v14, s[48:51], s22 offen offset:2048   lds
M v[132:135], a[104:107], a[160:163], v[132:135]
M v[136:139], a[112:115], a[160:163], v[136:139]
M v[136:139], a[116:119], a[164:167], v[136:139]
M v[140:143], a[124:127], a[164:167], v[140:143]
M v[140:143], a[120:123], a[160:163], v[140:143]
 ds_read_b64_tr_b16 a[76:77], v2 offset:24576
 ds_read_b64_tr_b16 a[78:79], v2 offset:25600
M v[144:147], a[128:131], a[160:163], v[144:147]
 buffer_load_dwordx4 v15, s[48:51], s22 offen offset:3072   lds
M v[144:147], a[132:135], a[164:167], v[144:147]
 s_add_u32 s22, s22, 2097152
M v[148:151], a[140:143], a[164:167], v[148:151]
M v[148:151], a[136:139], a[160:163], v[148:151]
M v[152:155], a[144:147], a[160:163], v[152:155]
M v[152:155], a[148:151], a[164:167], v[152:155]
 s_waitcnt lgkmcnt(4)
M v[156:159], a[156:159], a[164:167], v[156:159]
 s_add_u32 m0, s23, 0
 ds_read_b64_tr_b16 a[80:81], v3 offset:16384
 ds_read_b64_tr_b16 a[82:83], v3 offset:17408
M v[156:159], a[152:155], a[160:163], v[156:159]
 buffer_load_dwordx4 v8, s[16:19], s21 offen offset:0  nt lds
M v[160:163], a[96:99], a[168:171], v[160:163]
 ds_read_b128 a[160:163], v5 offset:53248
 ds_read_b128 a[164:167], v6 offset:53248
M v[160:163], a[100:103], a[172:175], v[160:163]
M v[164:167], a[108:111], a[172:175], v[164:167]
M v[164:167], a[104:107], a[168:171], v[164:167]
M v[168:171], a[112:115], a[168:171], v[168:171]
M v[168:171], a[116:119], a[172:175], v[168:171]
 ds_read_b64_tr_b16 a[84:85], v3 offset:24576
 ds_read_b64_tr_b16 a[86:87], v3 offset:25600
M v[172:175], a[124:127], a[172:175], v[172:175]
 buffer_load_dwordx4 v9, s[16:19], s21 offen offset:1024  nt lds
M v[172:175], a[120:123], a[168:171], v[172:175]
M v[176:179], a[128:131], a[168:171], v[176:179]
M v[176:179], a[132:135], a[172:175], v[176:179]
M v[180:183], a[140:143], a[172:175], v[180:183]
M v[180:183], a[136:139], a[168:171], v[180:183]
M v[184:187], a[144:147], a[168:171], v[184:187]
 ds_read_b64_tr_b16 a[88:89], v4 offset:16384
 ds_read_b64_tr_b16 a[90:91], v4 offset:17408
M v[184:187], a[148:151], a[172:175], v[184:187]
 s_waitcnt lgkmcnt(4)
M v[188:191], a[156:159], a[172:175], v[188:191]
 buffer_load_dwordx4 v10, s[16:19], s21 offen offset:2048  nt lds
M v[188:191], a[152:155], a[168:171], v[188:191]
M v[192:195], a[96:99], a[160:163], v[192:195]
 ds_read_b128 a[168:171], v5 offset:55296
 ds_read_b128 a[172:175], v6 offset:55296
M v[192:195], a[100:103], a[164:167], v[192:195]
M v[196:199], a[108:111], a[164:167], v[196:199]
M v[196:199], a[104:107], a[160:163], v[196:199]
 ds_read_b64_tr_b16 a[92:93], v4 offset:24576
 ds_read_b64_tr_b16 a[94:95], v4 offset:25600
M v[200:203], a[112:115], a[160:163], v[200:203]
 buffer_load_dwordx4 v11, s[16:19], s21 offen offset:3072  nt lds
M v[200:203], a[116:119], a[164:167], v[200:203]
 s_add_u32 s21, s21, 128
M v[204:207], a[124:127], a[164:167], v[204:207]
M v[204:207], a[120:123], a[160:163], v[204:207]
M v[208:211], a[128:131], a[160:163], v[208:211]
M v[208:211], a[132:135], a[164:167], v[208:211]
M v[212:215], a[140:143], a[164:167], v[212:215]
M v[212:215], a[136:139], a[160:163], v[212:215]
M v[216:219], a[144:147], a[160:163], v[216:219]
M v[216:219], a[148:151], a[164:167], v[216:219]
 s_waitcnt lgkmcnt(2)
M v[220:223], a[156:159], a[164:167], v[220:223]
 s_waitcnt vmcnt(17) lgkmcnt(0)
M v[220:223], a[152:155], a[160:163], v[220:223]
 s_barrier
M v[224:227], a[96:99], a[168:171], v[224:227]
 ds_read_b128 a[160:163], v5 offset:0
 ds_read_b128 a[164:167], v6 offset:0
M v[224:227], a[100:103], a[172:175], v[224:227]
M v[228:231], a[108:111], a[172:175], v[228:231]
M v[228:231], a[104:107], a[168:171], v[228:231]
M v[232:235], a[112:115], a[168:171], v[232:235]
M v[232:235], a[116:119], a[172:175], v[232:235]
M v[236:239], a[124:127], a[172:175], v[236:239]
M v[236:239], a[120:123], a[168:171], v[236:239]
M v[240:243], a[128:131], a[168:171], v[240:243]
M v[240:243], a[132:135], a[172:175], v[240:243]
M v[244:247], a[140:143], a[172:175], v[244:247]
M v[244:247], a[136:139], a[168:171], v[244:247]
M v[248:251], a[144:147], a[168:171], v[248:251]
M v[248:251], a[148:151], a[172:175], v[248:251]
 s_waitcnt lgkmcnt(0)
M v[252:255], a[156:159], a[172:175], v[252:255]
M v[252:255], a[152:155], a[168:171], v[252:255]
M a[0:3], a[32:35], a[160:163], a[0:3]
 ds_read_b128 a[168:171], v5 offset:2048
 ds_read_b128 a[172:175], v6 offset:2048
M a[0:3], a[36:39], a[164:167], a[0:3]
 ds_read_b64_tr_b16 a[96:97], v1 offset:32768
 ds_read_b64_tr_b16 a[98:99], v1 offset:33792
M a[4:7], a[44:47], a[164:167], a[4:7]
 s_add_u32 m0, s24, 49152
M a[4:7], a[40:43], a[160:163], a[4:7]
 buffer_load_dwordx4 v12, s[48:51], s22 offen offset:0   lds
M a[8:11], a[48:51], a[160:163], a[8:11]
M a[8:11], a[52:55], a[164:167], a[8:11]
M a[12:15], a[60:63], a[164:167], a[12:15]
 ds_read_b64_tr_b16 a[100:101], v1 offset:40960
 ds_read_b64_tr_b16 a[102:103], v1 offset:41984
M a[12:15], a[56:59], a[160:163], a[12:15]
M a[16:19], a[64:67], a[160:163], a[16:19]
 buffer_load_dwordx4 v13, s[48:51], s22 offen offset:1024   lds
M a[16:19], a[68:71], a[164:167], a[16:19]
M a[20:23], a[76:79], a[164:167], a[20:23]
M a[20:23], a[72:75], a[160:163], a[20:23]
 ds_read_b64_tr_b16 a[104:105], v2 offset:32768
 ds_read_b64_tr_b16 a[106:107], v2 offset:33792
M a[24:27], a[80:83], a[160:163], a[24:27]
M a[24:27], a[84:87], a[164:167], a[24:27]
 s_waitcnt lgkmcnt(6)
M a[28:31], a[92:95], a[164:167], a[28:31]
 buffer_load_dwordx4 v14, s[48:51], s22 offen offset:2048   lds
M a[28:31], a[88:91], a[160:163], a[28:31]
M v[32:35], a[32:35], a[168:171], v[32:35]
 ds_read_b128 a[160:163], v5 offset:4096
 ds_read_b128 a[164:167], v6 offset:4096
M v[32:35], a[36:39], a[172:175], v[32:35]
 ds_read_b64_tr_b16 a[108:109], v2 offset:40960
 ds_read_b64_tr_b16 a[110:111], v2 offset:41984
M v[36:39], a[44:47], a[172:175], v[36:39]
 buffer_load_dwordx4 v15, s[48:51], s22 offen offset:3072   lds
M v[36:39], a[40:43], a[168:171], v[36:39]
 s_sub_u32 s22, s22, 2097024
M v[40:43], a[48:51], a[168:171], v[40:43]
M v[40:43], a[52:55], a[172:175], v[40:43]
 ds_read_b64_tr_b16 a[112:113], v3 offset:32768
 ds_read_b64_tr_b16 a[114:115], v3 offset:33792
M v[44:47], a[60:63], a[172:175], v[44:47]
 s_add_u32 m0, s23, 16384
M v[44:47], a[56:59], a[168:171], v[44:47]
 buffer_load_dwordx4 v8, s[16:19], s21 offen offset:0  nt lds
M v[48:51], a[64:67], a[168:171], v[48:51]
M v[48:51], a[68:71], a[172:175], v[48:51]
M v[52:55], a[76:79], a[172:175], v[52:55]
 ds_read_b64_tr_b16 a[116:117], v3 offset:40960
 ds_read_b64_tr_b16 a[118:119], v3 offset:41984
M v[52:55], a[72:75], a[168:171], v[52:55]
M v[56:59], a[80:83], a[168:171], v[56:59]
 buffer_load_dwordx4 v9, s[16:19], s21 offen offset:1024  nt lds
M v[56:59], a[84:87], a[172:175], v[56:59]
 s_waitcnt lgkmcnt(6)
M v[60:63], a[92:95], a[172:175], v[60:63]
M v[60:63], a[88:91], a[168:171], v[60:63]
 ds_read_b64_tr_b16 a[120:121], v4 offset:32768
 ds_read_b64_tr_b16 a[122:123], v4 offset:33792
M v[64:67], a[32:35], a[160:163], v[64:67]
 ds_read_b128 a[168:171], v5 offset:6144
 ds_read_b128 a[172:175], v6 offset:6144
M v[64:67], a[36:39], a[164:167], v[64:67]
 buffer_load_dwordx4 v10, s[16:19], s21 offen offset:2048  nt lds
M v[68:71], a[44:47], a[164:167], v[68:71]
M v[68:71], a[40:43], a[160:163], v[68:71]
M v[72:75], a[48:51], a[160:163], v[72:75]
 ds_read_b64_tr_b16 a[124:125], v4 offset:40960
 ds_read_b64_tr_b16 a[126:127], v4 offset:41984
M v[72:75], a[52:55], a[164:167], v[72:75]
M v[76:79], a[60:63], a[164:167], v[76:79]
 buffer_load_dwordx4 v11, s[16:19], s21 offen offset:3072  nt lds
M v[76:79], a[56:59], a[160:163], v[76:79]
 s_add_u32 s21, s21, 524160
M v[80:83], a[64:67], a[160:163], v[80:83]
M v[80:83], a[68:71], a[164:167], v[80:83]
M v[84:87], a[76:79], a[164:167], v[84:87]
M v[84:87], a[72:75], a[160:163], v[84:87]
M v[88:91], a[80:83], a[160:163], v[88:91]
M v[88:91], a[84:87], a[164:167], v[88:91]
 s_waitcnt lgkmcnt(2)
M v[92:95], a[92:95], a[164:167], v[92:95]
 s_waitcnt vmcnt(17) lgkmcnt(0)
M v[92:95], a[88:91], a[160:163], v[92:95]
 s_barrier
M v[96:99], a[32:35], a[168:171], v[96:99]
 ds_read_b128 a[160:163], v5 offset:16384
 ds_read_b128 a[164:167], v6 offset:16384
M v[96:99], a[36:39], a[172:175], v[96:99]
M v[100:103], a[44:47], a[172:175], v[100:103]
 s_add_u32 m0, s24, 0
 ds_read_b64_tr_b16 a[128:129], v1 offset:49152
 ds_read_b64_tr_b16 a[130:131], v1 offset:50176
M v[100:103], a[40:43], a[168:171], v[100:103]
 buffer_load_dwordx4 v12, s[48:51], s22 offen offset:0   lds
M v[104:107], a[48:51], a[168:171], v[104:107]
M v[104:107], a[52:55], a[172:175], v[104:107]
M v[108:111], a[60:63], a[172:175], v[108:111]
M v[108:111], a[56:59], a[168:171], v[108:111]
M v[112:115], a[64:67], a[168:171], v[112:115]
M v[112:115], a[68:71], a[172:175], v[112:115]
 ds_read_b64_tr_b16 a[132:133], v1 offset:57344
 ds_read_b64_tr_b16 a[134:135], v1 offset:58368
M v[116:119], a[76:79], a[172:175], v[116:119]
 buffer_load_dwordx4 v13, s[48:51], s22 offen offset:1024   lds
M v[116:119], a[72:75], a[168:171], v[116:119]
M v[120:123], a[80:83], a[168:171], v[120:123]
M v[120:123], a[84:87], a[172:175], v[120:123]
 s_waitcnt lgkmcnt(4)
M v[124:127], a[92:95], a[172:175], v[124:127]
M v[124:127], a[88:91], a[168:171], v[124:127]
M v[128:131], a[32:35], a[160:163], v[128:131]
 ds_read_b128 a[168:171], v5 offset:18432
 ds_read_b128 a[172:175], v6 offset:18432
M v[128:131], a[36:39], a[164:167], v[128:131]
 ds_read_b64_tr_b16 a[136:137], v2 offset:49152
 ds_read_b64_tr_b16 a[138:139], v2 offset:50176
M v[132:135], a[44:47], a[164:167], v[132:135]
 buffer_load_dwordx4 v14, s[48:51], s22 offen offset:2048   lds
M v[132:135], a[40:43], a[160:163], v[132:135]
M v[136:139], a[48:51], a[160:163], v[136:139]
M v[136:139], a[52:55], a[164:167], v[136:139]
M v[140:143], a[60:63], a[164:167], v[140:143]
M v[140:143], a[56:59], a[160:163], v[140:143]
 ds_read_b64_tr_b16 a[140:141], v2 offset:57344
 ds_read_b64_tr_b16 a[142:143], v2 offset:58368
M v[144:147], a[64:67], a[160:163], v[144:147]
 buffer_load_dwordx4 v15, s[48:51], s22 offen offset:3072   lds
M v[144:147], a[68:71], a[164:167], v[144:147]
 s_add_u32 s22, s22, 2097152
M v[148:151], a[76:79], a[164:167], v[148:151]
M v[148:151], a[72:75], a[160:163], v[148:151]
M v[152:155], a[80:83], a[160:163], v[152:155]
M v[152:155], a[84:87], a[164:167], v[152:155]
 s_waitcnt lgkmcnt(4)
M v[156:159], a[92:95], a[164:167], v[156:159]
 s_add_u32 m0, s23, 32768
 ds_read_b64_tr_b16 a[144:145], v3 offset:49152
 ds_read_b64_tr_b16 a[146:147], v3 offset:50176
M v[156:159], a[88:91], a[160:163], v[156:159]
 buffer_load_dwordx4 v8, s[16:19], s21 offen offset:0  nt lds
M v[160:163], a[32:35], a[168:171], v[160:163]
 ds_read_b128 a[160:163], v5 offset:20480
 ds_read_b128 a[164:167], v6 offset:20480
M v[160:163], a[36:39], a[172:175], v[160:163]
M v[164:167], a[44:47], a[172:175], v[164:167]
M v[164:167], a[40:43], a[168:171], v[164:167]
M v[168:171], a[48:51], a[168:171], v[168:171]
M v[168:171], a[52:55], a[172:175], v[168:171]
 ds_read_b64_tr_b16 a[148:149], v3 offset:57344
 ds_read_b64_tr_b16 a[150:151], v3 offset:58368
M v[172:175], a[60:63], a[172:175], v[172:175]
 buffer_load_dwordx4 v9, s[16:19], s21 offen offset:1024  nt lds
M v[172:175], a[56:59], a[168:171], v[172:175]
M v[176:179], a[64:67], a[168:171], v[176:179]
M v[176:179], a[68:71], a[172:175], v[176:179]
M v[180:183], a[76:79], a[172:175], v[180:183]
M v[180:183], a[72:75], a[168:171], v[180:183]
M v[184:187], a[80:83], a[168:171], v[184:187]
 ds_read_b64_tr_b16 a[152:153], v4 offset:49152
 ds_read_b64_tr_b16 a[154:155], v4 offset:50176
M v[184:187], a[84:87], a[172:175], v[184:187]
 s_waitcnt lgkmcnt(4)
M v[188:191], a[92:95], a[172:175], v[188:191]
 buffer_load_dwordx4 v10, s[16:19], s21 offen offset:2048  nt lds
M v[188:191], a[88:91], a[168:171], v[188:191]
M v[192:195], a[32:35], a[160:163], v[192:195]
 ds_read_b128 a[168:171], v5 offset:22528
 ds_read_b128 a[172:175], v6 offset:22528
M v[192:195], a[36:39], a[164:167], v[192:195]
M v[196:199], a[44:47], a[164:167], v[196:199]
M v[196:199], a[40:43], a[160:163], v[196:199]
 ds_read_b64_tr_b16 a[156:157], v4 offset:57344
 ds_read_b64_tr_b16 a[158:159], v4 offset:58368
M v[200:203], a[48:51], a[160:163], v[200:203]
 buffer_load_dwordx4 v11, s[16:19], s21 offen offset:3072  nt lds
M v[200:203], a[52:55], a[164:167], v[200:203]
 s_add_u32 s21, s21, 128
M v[204:207], a[60:63], a[164:167], v[204:207]
M v[204:207], a[56:59], a[160:163], v[204:207]
M v[208:211], a[64:67], a[160:163], v[208:211]
M v[208:211], a[68:71], a[164:167], v[208:211]
M v[212:215], a[76:79], a[164:167], v[212:215]
M v[212:215], a[72:75], a[160:163], v[212:215]
M v[216:219], a[80:83], a[160:163], v[216:219]
M v[216:219], a[84:87], a[164:167], v[216:219]
 s_waitcnt lgkmcnt(2)
M v[220:223], a[92:95], a[164:167], v[220:223]
 s_waitcnt vmcnt(16) lgkmcnt(0)
M v[220:223], a[88:91], a[160:163], v[220:223]
 s_barrier
M v[224:227], a[32:35], a[168:171], v[224:227]
 ds_read_b128 a[160:163], v5 offset:32768
 ds_read_b128 a[164:167], v6 offset:32768
M v[224:227], a[36:39], a[172:175], v[224:227]
 v_cmp_ne_u32 vcc, 1, v17
M v[228:231], a[44:47], a[172:175], v[228:231]
 s_nop 0
M v[228:231], a[40:43], a[168:171], v[228:231]
 s_cbranch_vccnz L_zs1
L_zr1:
M v[232:235], a[48:51], a[168:171], v[232:235]
 buffer_load_dword a240, v24, s[32:35], 0 offen offset:1024
M v[232:235], a[52:55], a[172:175], v[232:235]
M v[236:239], a[60:63], a[172:175], v[236:239]
M v[236:239], a[56:59], a[168:171], v[236:239]
M v[240:243], a[64:67], a[168:171], v[240:243]
M v[240:243], a[68:71], a[172:175], v[240:243]
M v[244:247], a[76:79], a[172:175], v[244:247]
M v[244:247], a[72:75], a[168:171], v[244:247]
M v[248:251], a[80:83], a[168:171], v[248:251]
M v[248:251], a[84:87], a[172:175], v[248:251]
 s_waitcnt lgkmcnt(0)
M v[252:255], a[92:95], a[172:175], v[252:255]
M v[252:255], a[88:91], a[168:171], v[252:255]
M a[0:3], a[96:99], a[160:163], a[0:3]
 ds_read_b128 a[168:171], v5 offset:34816
 ds_read_b128 a[172:175], v6 offset:34816
M a[0:3], a[100:103], a[164:167], a[0:3]
 ds_read_b64_tr_b16 a[32:33], v1 offset:0
 ds_read_b64_tr_b16 a[34:35], v1 offset:1024
M a[4:7], a[108:111], a[164:167], a[4:7]
 s_add_u32 m0, s24, 16384
M a[4:7], a[104:107], a[160:163], a[4:7]
 buffer_load_dwordx4 v12, s[48:51], s22 offen offset:0   lds
M a[8:11], a[112:115], a[160:163], a[8:11]
M a[8:11], a[116:119], a[164:167], a[8:11]
M a[12:15], a[124:127], a[164:167], a[12:15]
 ds_read_b64_tr_b16 a[36:37], v1 offset:8192
 ds_read_b64_tr_b16 a[38:39], v1 offset:9216
M a[12:15], a[120:123], a[160:163], a[12:15]
M a[16:19], a[128:131], a[160:163], a[16:19]
 buffer_load_dwordx4 v13, s[48:51], s22 offen offset:1024   lds
M a[16:19], a[132:135], a[164:167], a[16:19]
M a[20:23], a[140:143], a[164:167], a[20:23]
M a[20:23], a[136:139], a[160:163], a[20:23]
 ds_read_b64_tr_b16 a[40:41], v2 offset:0
 ds_read_b64_tr_b16 a[42:43], v2 offset:1024
M a[24:27], a[144:147], a[160:163], a[24:27]
M a[24:27], a[148:151], a[164:167], a[24:27]
 s_waitcnt lgkmcnt(6)
M a[28:31], a[156:159], a[164:167], a[28:31]
 buffer_load_dwordx4 v14, s[48:51], s22 offen offset:2048   lds
M a[28:31], a[152:155], a[160:163], a[28:31]
M v[32:35], a[96:99], a[168:171], v[32:35]
 ds_read_b128 a[160:163], v5 offset:36864
 ds_read_b128 a[164:167], v6 offset:36864
M v[32:35], a[100:103], a[172:175], v[32:35]
 ds_read_b64_tr_b16 a[44:45], v2 offset:8192
 ds_read_b64_tr_b16 a[46:47], v2 offset:9216
M v[36:39], a[108:111], a[172:175], v[36:39]
 buffer_load_dwordx4 v15, s[48:51], s22 offen offset:3072   lds
M v[36:39], a[104:107], a[168:171], v[36:39]
 s_sub_u32 s22, s22, 2097024
M v[40:43], a[112:115], a[168:171], v[40:43]
M v[40:43], a[116:119], a[172:175], v[40:43]
 ds_read_b64_tr_b16 a[48:49], v3 offset:0
 ds_read_b64_tr_b16 a[50:51], v3 offset:1024
M v[44:47], a[124:127], a[172:175], v[44:47]
 s_add_u32 m0, s23, 49152
M v[44:47], a[120:123], a[168:171], v[44:47]
 buffer_load_dwordx4 v8, s[16:19], s21 offen offset:0  nt lds
M v[48:51], a[128:131], a[168:171], v[48:51]
M v[48:51], a[132:135], a[172:175], v[48:51]
M v[52:55], a[140:143], a[172:175], v[52:55]
 ds_read_b64_tr_b16 a[52:53], v3 offset:8192
 ds_read_b64_tr_b16 a[54:55], v3 offset:9216
M v[52:55], a[136:139], a[168:171], v[52:55]
M v[56:59], a[144:147], a[168:171], v[56:59]
 buffer_load_dwordx4 v9, s[16:19], s21 offen offset:1024  nt lds
M v[56:59], a[148:151], a[172:175], v[56:59]
 s_waitcnt lgkmcnt(6)
M v[60:63], a[156:159], a[172:175], v[60:63]
M v[60:63], a[152:155], a[168:171], v[60:63]
 ds_read_b64_tr_b16 a[56:57], v4 offset:0
 ds_read_b64_tr_b16 a[58:59], v4 offset:1024
M v[64:67], a[96:99], a[160:163], v[64:67]
 ds_read_b128 a[168:171], v5 offset:38912
 ds_read_b128 a[172:175], v6 offset:38912
M v[64:67], a[100:103], a[164:167], v[64:67]
 buffer_load_dwordx4 v10, s[16:19], s21 offen offset:2048  nt lds
M v[68:71], a[108:111], a[164:167], v[68:71]
M v[68:71], a[104:107], a[160:163], v[68:71]
M v[72:75], a[112:115], a[160:163], v[72:75]
 ds_read_b64_tr_b16 a[60:61], v4 offset:8192
 ds_read_b64_tr_b16 a[62:63], v4 offset:9216
M v[72:75], a[116:119], a[164:167], v[72:75]
M v[76:79], a[124:127], a[164:167], v[76:79]
 buffer_load_dwordx4 v11, s[16:19], s21 offen offset:3072  nt lds
M v[76:79], a[120:123], a[160:163], v[76:79]
 s_add_u32 s21, s21, 524160
M v[80:83], a[128:131], a[160:163], v[80:83]
M v[80:83], a[132:135], a[164:167], v[80:83]
M v[84:87], a[140:143], a[164:167], v[84:87]
M v[84:87], a[136:139], a[160:163], v[84:87]
 s_and_b32 s64, s42, 7
M v[88:91], a[144:147], a[160:163], v[88:91]
 s_lshl_b32 s72, s41, 3
 s_add_u32 s64, s64, s72
 s_lshl_b32 s64, s64, 2
M v[88:91], a[148:151], a[164:167], v[88:91]
 s_waitcnt lgkmcnt(2)
 s_add_u32 s64, s64, s20
 s_mul_i32 s67, s64, 7168
M v[92:95], a[156:159], a[164:167], v[92:95]
 s_waitcnt vmcnt(17) lgkmcnt(0)
 s_mul_i32 s86, s20, 7168
 s_add_u32 s86, s86, 131072
M v[92:95], a[152:155], a[160:163], v[92:95]
 s_barrier
M v[96:99], a[96:99], a[168:171], v[96:99]
 ds_read_b128 a[160:163], v5 offset:49152
 ds_read_b128 a[164:167], v6 offset:49152
M v[96:99], a[100:103], a[172:175], v[96:99]
M v[100:103], a[108:111], a[172:175], v[100:103]
 s_add_u32 m0, s24, 32768
 ds_read_b64_tr_b16 a[64:65], v1 offset:16384
 ds_read_b64_tr_b16 a[66:67], v1 offset:17408
M v[100:103], a[104:107], a[168:171], v[100:103]
 buffer_load_dwordx4 v12, s[48:51], s22 offen offset:0   lds
M v[104:107], a[112:115], a[168:171], v[104:107]
M v[104:107], a[116:119], a[172:175], v[104:107]
M v[108:111], a[124:127], a[172:175], v[108:111]
M v[108:111], a[120:123], a[168:171], v[108:111]
 buffer_load_dwordx4 v13, s[48:51], s22 offen offset:1024   lds
M v[112:115], a[128:131], a[168:171], v[112:115]
M v[112:115], a[132:135], a[172:175], v[112:115]
 ds_read_b64_tr_b16 a[68:69], v1 offset:24576
 ds_read_b64_tr_b16 a[70:71], v1 offset:25600
M v[116:119], a[140:143], a[172:175], v[116:119]
M v[116:119], a[136:139], a[168:171], v[116:119]
M v[120:123], a[144:147], a[168:171], v[120:123]
 buffer_load_dwordx4 v14, s[48:51], s22 offen offset:2048   lds
M v[120:123], a[148:151], a[172:175], v[120:123]
 s_waitcnt lgkmcnt(4)
M v[124:127], a[156:159], a[172:175], v[124:127]
M v[124:127], a[152:155], a[168:171], v[124:127]
M v[128:131], a[96:99], a[160:163], v[128:131]
 ds_read_b128 a[168:171], v5 offset:51200
 ds_read_b128 a[172:175], v6 offset:51200
M v[128:131], a[100:103], a[164:167], v[128:131]
 ds_read_b64_tr_b16 a[72:73], v2 offset:16384
 ds_read_b64_tr_b16 a[74:75], v2 offset:17408
M v[132:135], a[108:111], a[164:167], v[132:135]
 buffer_load_dwordx4 v15, s[48:51], s22 offen offset:3072   lds
M v[132:135], a[104:107], a[160:163], v[132:135]
 s_add_u32 s22, s22, 2097152
M v[136:139], a[112:115], a[160:163], v[136:139]
M v[136:139], a[116:119], a[164:167], v[136:139]
 s_add_u32 m0, s23, 0
M v[140:143], a[124:127], a[164:167], v[140:143]
 buffer_load_dwordx4 v8, s[16:19], s21 offen offset:0  nt lds
M v[140:143], a[120:123], a[160:163], v[140:143]
 ds_read_b64_tr_b16 a[76:77], v2 offset:24576
 ds_read_b64_tr_b16 a[78:79], v2 offset:25600
M v[144:147], a[128:131], a[160:163], v[144:147]
M v[144:147], a[132:135], a[164:167], v[144:147]
M v[148:151], a[140:143], a[164:167], v[148:151]
 buffer_load_dwordx4 v9, s[16:19], s21 offen offset:1024  nt lds
M v[148:151], a[136:139], a[160:163], v[148:151]
M v[152:155], a[144:147], a[160:163], v[152:155]
M v[152:155], a[148:151], a[164:167], v[152:155]
 s_waitcnt lgkmcnt(4)
M v[156:159], a[156:159], a[164:167], v[156:159]
 ds_read_b64_tr_b16 a[80:81], v3 offset:16384
 ds_read_b64_tr_b16 a[82:83], v3 offset:17408
M v[156:159], a[152:155], a[160:163], v[156:159]
 buffer_load_dwordx4 v10, s[16:19], s21 offen offset:2048  nt lds
M v[160:163], a[96:99], a[168:171], v[160:163]
 ds_read_b128 a[160:163], v5 offset:53248
 ds_read_b128 a[164:167], v6 offset:53248
M v[160:163], a[100:103], a[172:175], v[160:163]
M v[164:167], a[108:111], a[172:175], v[164:167]
M v[164:167], a[104:107], a[168:171], v[164:167]
M v[168:171], a[112:115], a[168:171], v[168:171]
 buffer_load_dwordx4 v11, s[16:19], s21 offen offset:3072  nt lds
M v[168:171], a[116:119], a[172:175], v[168:171]
 s_add_u32 s21, s21, 128
 ds_read_b64_tr_b16 a[84:85], v3 offset:24576
 ds_read_b64_tr_b16 a[86:87], v3 offset:25600
M v[172:175], a[124:127], a[172:175], v[172:175]
M v[172:175], a[120:123], a[168:171], v[172:175]
M v[176:179], a[128:131], a[168:171], v[176:179]
 s_add_u32 m0, s86, 0
M v[176:179], a[132:135], a[172:175], v[176:179]
 buffer_load_dwordx4 v7, s[60:63], s67 offen offset:0 nt lds
M v[180:183], a[140:143], a[172:175], v[180:183]
M v[180:183], a[136:139], a[168:171], v[180:183]
M v[184:187], a[144:147], a[168:171], v[184:187]
 ds_read_b64_tr_b16 a[88:89], v4 offset:16384
 ds_read_b64_tr_b16 a[90:91], v4 offset:17408
M v[184:187], a[148:151], a[172:175], v[184:187]
 s_waitcnt lgkmcnt(4)
M v[188:191], a[156:159], a[172:175], v[188:191]
 buffer_load_dwordx4 v7, s[60:63], s67 offen offset:1024 nt lds
M v[188:191], a[152:155], a[168:171], v[188:191]
M v[192:195], a[96:99], a[160:163], v[192:195]
 ds_read_b128 a[168:171], v5 offset:55296
 ds_read_b128 a[172:175], v6 offset:55296
M v[192:195], a[100:103], a[164:167], v[192:195]
M v[196:199], a[108:111], a[164:167], v[196:199]
 buffer_load_dwordx4 v7, s[60:63], s67 offen offset:2048 nt lds
M v[196:199], a[104:107], a[160:163], v[196:199]
 ds_read_b64_tr_b16 a[92:93], v4 offset:24576
 ds_read_b64_tr_b16 a[94:95], v4 offset:25600
M v[200:203], a[112:115], a[160:163], v[200:203]
M v[200:203], a[116:119], a[164:167], v[200:203]
M v[204:207], a[124:127], a[164:167], v[204:207]
M v[204:207], a[120:123], a[160:163], v[204:207]
 buffer_load_dwordx4 v7, s[60:63], s67 offen offset:3072 nt lds
M v[208:211], a[128:131], a[160:163], v[208:211]
 s_add_u32 s67, s67, 4096
M v[208:211], a[132:135], a[164:167], v[208:211]
M v[212:215], a[140:143], a[164:167], v[212:215]
M v[212:215], a[136:139], a[160:163], v[212:215]
M v[216:219], a[144:147], a[160:163], v[216:219]
M v[216:219], a[148:151], a[164:167], v[216:219]
 s_waitcnt lgkmcnt(2)
M v[220:223], a[156:159], a[164:167], v[220:223]
 s_waitcnt vmcnt(21) lgkmcnt(0)
M v[220:223], a[152:155], a[160:163], v[220:223]
 s_barrier
M v[224:227], a[96:99], a[168:171], v[224:227]
 ds_read_b128 a[160:163], v5 offset:0
 ds_read_b128 a[164:167], v6 offset:0
M v[224:227], a[100:103], a[172:175], v[224:227]
M v[228:231], a[108:111], a[172:175], v[228:231]
M v[228:231], a[104:107], a[168:171], v[228:231]
M v[232:235], a[112:115], a[168:171], v[232:235]
M v[232:235], a[116:119], a[172:175], v[232:235]
M v[236:239], a[124:127], a[172:175], v[236:239]
M v[236:239], a[120:123], a[168:171], v[236:239]
M v[240:243], a[128:131], a[168:171], v[240:243]
M v[240:243], a[132:135], a[172:175], v[240:243]
M v[244:247], a[140:143], a[172:175], v[244:247]
M v[244:247], a[136:139], a[168:171], v[244:247]
M v[248:251], a[144:147], a[168:171], v[248:251]
M v[248:251], a[148:151], a[172:175], v[248:251]
 s_waitcnt lgkmcnt(0)
M v[252:255], a[156:159], a[172:175], v[252:255]
M v[252:255], a[152:155], a[168:171], v[252:255]
M a[0:3], a[32:35], a[160:163], a[0:3]
 ds_read_b128 a[168:171], v5 offset:2048
 ds_read_b128 a[172:175], v6 offset:2048
M a[0:3], a[36:39], a[164:167], a[0:3]
 ds_read_b64_tr_b16 a[96:97], v1 offset:32768
 ds_read_b64_tr_b16 a[98:99], v1 offset:33792
M a[4:7], a[44:47], a[164:167], a[4:7]
 s_add_u32 m0, s24, 49152
M a[4:7], a[40:43], a[160:163], a[4:7]
 buffer_load_dwordx4 v12, s[48:51], s22 offen offset:0   lds
M a[8:11], a[48:51], a[160:163], a[8:11]
M a[8:11], a[52:55], a[164:167], a[8:11]
M a[12:15], a[60:63], a[164:167], a[12:15]
 ds_read_b64_tr_b16 a[100:101], v1 offset:40960
 ds_read_b64_tr_b16 a[102:103], v1 offset:41984
M a[12:15], a[56:59], a[160:163], a[12:15]
M a[16:19], a[64:67], a[160:163], a[16:19]
 buffer_load_dwordx4 v13, s[48:51], s22 offen offset:1024   lds
M a[16:19], a[68:71], a[164:167], a[16:19]
M a[20:23], a[76:79], a[164:167], a[20:23]
M a[20:23], a[72:75], a[160:163], a[20:23]
 ds_read_b64_tr_b16 a[104:105], v2 offset:32768
 ds_read_b64_tr_b16 a[106:107], v2 offset:33792
M a[24:27], a[80:83], a[160:163], a[24:27]
M a[24:27], a[84:87], a[164:167], a[24:27]
 s_waitcnt lgkmcnt(6)
M a[28:31], a[92:95], a[164:167], a[28:31]
 buffer_load_dwordx4 v14, s[48:51], s22 offen offset:2048   lds
M a[28:31], a[88:91], a[160:163], a[28:31]
M v[32:35], a[32:35], a[168:171], v[32:35]
 ds_read_b128 a[160:163], v5 offset:4096
 ds_read_b128 a[164:167], v6 offset:4096
M v[32:35], a[36:39], a[172:175], v[32:35]
 ds_read_b64_tr_b16 a[108:109], v2 offset:40960
 ds_read_b64_tr_b16 a[110:111], v2 offset:41984
M v[36:39], a[44:47], a[172:175], v[36:39]
 buffer_load_dwordx4 v15, s[48:51], s22 offen offset:3072   lds
M v[36:39], a[40:43], a[168:171], v[36:39]
 s_sub_u32 s22, s22, 2097024
M v[40:43], a[48:51], a[168:171], v[40:43]
M v[40:43], a[52:55], a[172:175], v[40:43]
 ds_read_b64_tr_b16 a[112:113], v3 offset:32768
 ds_read_b64_tr_b16 a[114:115], v3 offset:33792
M v[44:47], a[60:63], a[172:175], v[44:47]
 s_add_u32 m0, s23, 16384
M v[44:47], a[56:59], a[168:171], v[44:47]
 buffer_load_dwordx4 v8, s[16:19], s21 offen offset:0  nt lds
M v[48:51], a[64:67], a[168:171], v[48:51]
M v[48:51], a[68:71], a[172:175], v[48:51]
M v[52:55], a[76:79], a[172:175], v[52:55]
 ds_read_b64_tr_b16 a[116:117], v3 offset:40960
 ds_read_b64_tr_b16 a[118:119], v3 offset:41984
M v[52:55], a[72:75], a[168:171], v[52:55]
M v[56:59], a[80:83], a[168:171], v[56:59]
 buffer_load_dwordx4 v9, s[16:19], s21 offen offset:1024  nt lds
M v[56:59], a[84:87], a[172:175], v[56:59]
 s_waitcnt lgkmcnt(6)
M v[60:63], a[92:95], a[172:175], v[60:63]
M v[60:63], a[88:91], a[168:171], v[60:63]
 ds_read_b64_tr_b16 a[120:121], v4 offset:32768
 ds_read_b64_tr_b16 a[122:123], v4 offset:33792
M v[64:67], a[32:35], a[160:163], v[64:67]
 ds_read_b128 a[168:171], v5 offset:6144
 ds_read_b128 a[172:175], v6 offset:6144
M v[64:67], a[36:39], a[164:167], v[64:67]
 buffer_load_dwordx4 v10, s[16:19], s21 offen offset:2048  nt lds
M v[68:71], a[44:47], a[164:167], v[68:71]
M v[68:71], a[40:43], a[160:163], v[68:71]
M v[72:75], a[48:51], a[160:163], v[72:75]
 ds_read_b64_tr_b16 a[124:125], v4 offset:40960
 ds_read_b64_tr_b16 a[126:127], v4 offset:41984
M v[72:75], a[52:55], a[164:167], v[72:75]
M v[76:79], a[60:63], a[164:167], v[76:79]
 buffer_load_dwordx4 v11, s[16:19], s21 offen offset:3072  nt lds
M v[76:79], a[56:59], a[160:163], v[76:79]
 s_add_u32 s21, s21, 524160
M v[80:83], a[64:67], a[160:163], v[80:83]
M v[80:83], a[68:71], a[164:167], v[80:83]
M v[84:87], a[76:79], a[164:167], v[84:87]
M v[84:87], a[72:75], a[160:163], v[84:87]
M v[88:91], a[80:83], a[160:163], v[88:91]
M v[88:91], a[84:87], a[164:167], v[88:91]
 s_waitcnt lgkmcnt(2)
M v[92:95], a[92:95], a[164:167], v[92:95]
 s_waitcnt vmcnt(20) lgkmcnt(0)
M v[92:95], a[88:91], a[160:163], v[92:95]
 s_barrier
M v[96:99], a[32:35], a[168:171], v[96:99]
 ds_read_b128 a[160:163], v5 offset:16384
 ds_read_b128 a[164:167], v6 offset:16384
M v[96:99], a[36:39], a[172:175], v[96:99]
M v[100:103], a[44:47], a[172:175], v[100:103]
 s_add_u32 m0, s24, 0
 ds_read_b64_tr_b16 a[128:129], v1 offset:49152
 ds_read_b64_tr_b16 a[130:131], v1 offset:50176
M v[100:103], a[40:43], a[168:171], v[100:103]
 buffer_load_dwordx4 v12, s[48:51], s22 offen offset:0   lds
M v[104:107], a[48:51], a[168:171], v[104:107]
M v[104:107], a[52:55], a[172:175], v[104:107]
M v[108:111], a[60:63], a[172:175], v[108:111]
M v[108:111], a[56:59], a[168:171], v[108:111]
M v[112:115], a[64:67], a[168:171], v[112:115]
 buffer_load_dwordx4 v13, s[48:51], s22 offen offset:1024   lds
M v[112:115], a[68:71], a[172:175], v[112:115]
 ds_read_b64_tr_b16 a[132:133], v1 offset:57344
 ds_read_b64_tr_b16 a[134:135], v1 offset:58368
M v[116:119], a[76:79], a[172:175], v[116:119]
M v[116:119], a[72:75], a[168:171], v[116:119]
M v[120:123], a[80:83], a[168:171], v[120:123]
M v[120:123], a[84:87], a[172:175], v[120:123]
 s_waitcnt lgkmcnt(4)
M v[124:127], a[92:95], a[172:175], v[124:127]
 buffer_load_dwordx4 v14, s[48:51], s22 offen offset:2048   lds
M v[124:127], a[88:91], a[168:171], v[124:127]
M v[128:131], a[32:35], a[160:163], v[128:131]
 ds_read_b128 a[168:171], v5 offset:18432
 ds_read_b128 a[172:175], v6 offset:18432
M v[128:131], a[36:39], a[164:167], v[128:131]
 ds_read_b64_tr_b16 a[136:137], v2 offset:49152
 ds_read_b64_tr_b16 a[138:139], v2 offset:50176
M v[132:135], a[44:47], a[164:167], v[132:135]
 buffer_load_dwordx4 v15, s[48:51], s22 offen offset:3072   lds
M v[132:135], a[40:43], a[160:163], v[132:135]
 s_add_u32 s22, s22, 2097152
M v[136:139], a[48:51], a[160:163], v[136:139]
M v[136:139], a[52:55], a[164:167], v[136:139]
M v[140:143], a[60:63], a[164:167], v[140:143]
 s_add_u32 m0, s23, 32768
M v[140:143], a[56:59], a[160:163], v[140:143]
 ds_read_b64_tr_b16 a[140:141], v2 offset:57344
 ds_read_b64_tr_b16 a[142:143], v2 offset:58368
M v[144:147], a[64:67], a[160:163], v[144:147]
 buffer_load_dwordx4 v8, s[16:19], s21 offen offset:0  nt lds
M v[144:147], a[68:71], a[164:167], v[144:147]
M v[148:151], a[76:79], a[164:167], v[148:151]
M v[148:151], a[72:75], a[160:163], v[148:151]
M v[152:155], a[80:83], a[160:163], v[152:155]
 buffer_load_dwordx4 v9, s[16:19], s21 offen offset:1024  nt lds
M v[152:155], a[84:87], a[164:167], v[152:155]
 s_waitcnt lgkmcnt(4)
M v[156:159], a[92:95], a[164:167], v[156:159]
 ds_read_b64_tr_b16 a[144:145], v3 offset:49152
 ds_read_b64_tr_b16 a[146:147], v3 offset:50176
M v[156:159], a[88:91], a[160:163], v[156:159]
M v[160:163], a[32:35], a[168:171], v[160:163]
 ds_read_b128 a[160:163], v5 offset:20480
 ds_read_b128 a[164:167], v6 offset:20480
M v[160:163], a[36:39], a[172:175], v[160:163]
M v[164:167], a[44:47], a[172:175], v[164:167]
 buffer_load_dwordx4 v10, s[16:19], s21 offen offset:2048  nt lds
M v[164:167], a[40:43], a[168:171], v[164:167]
M v[168:171], a[48:51], a[168:171], v[168:171]
M v[168:171], a[52:55], a[172:175], v[168:171]
 ds_read_b64_tr_b16 a[148:149], v3 offset:57344
 ds_read_b64_tr_b16 a[150:151], v3 offset:58368
M v[172:175], a[60:63], a[172:175], v[172:175]
M v[172:175], a[56:59], a[168:171], v[172:175]
 buffer_load_dwordx4 v11, s[16:19], s21 offen offset:3072  nt lds
M v[176:179], a[64:67], a[168:171], v[176:179]
 s_add_u32 s21, s21, 128
M v[176:179], a[68:71], a[172:175], v[176:179]
M v[180:183], a[76:79], a[172:175], v[180:183]
M v[180:183], a[72:75], a[168:171], v[180:183]
 s_add_u32 m0, s86, 4096
M v[184:187], a[80:83], a[168:171], v[184:187]
 ds_read_b64_tr_b16 a[152:153], v4 offset:49152
 ds_read_b64_tr_b16 a[154:155], v4 offset:50176
M v[184:187], a[84:87], a[172:175], v[184:187]
 s_waitcnt lgkmcnt(4)
M v[188:191], a[92:95], a[172:175], v[188:191]
 buffer_load_dwordx4 v7, s[60:63], s67 offen offset:0 nt lds
M v[188:191], a[88:91], a[168:171], v[188:191]
M v[192:195], a[32:35], a[160:163], v[192:195]
 ds_read_b128 a[168:171], v5 offset:22528
 ds_read_b128 a[172:175], v6 offset:22528
M v[192:195], a[36:39], a[164:167], v[192:195]
 buffer_load_dwordx4 v7, s[60:63], s67 offen offset:1024 nt lds
M v[196:199], a[44:47], a[164:167], v[196:199]
M v[196:199], a[40:43], a[160:163], v[196:199]
 ds_read_b64_tr_b16 a[156:157], v4 offset:57344
 ds_read_b64_tr_b16 a[158:159], v4 offset:58368
M v[200:203], a[48:51], a[160:163], v[200:203]
M v[200:203], a[52:55], a[164:167], v[200:203]
M v[204:207], a[60:63], a[164:167], v[204:207]
 buffer_load_dwordx4 v7, s[60:63], s67 offen offset:2048 nt lds
M v[204:207], a[56:59], a[160:163], v[204:207]
 s_add_u32 s67, s67, 4096
M v[208:211], a[64:67], a[160:163], v[208:211]
M v[208:211], a[68:71], a[164:167], v[208:211]
M v[212:215], a[76:79], a[164:167], v[212:215]
M v[212:215], a[72:75], a[160:163], v[212:215]
M v[216:219], a[80:83], a[160:163], v[216:219]
M v[216:219], a[84:87], a[164:167], v[216:219]
 s_waitcnt lgkmcnt(2)
M v[220:223], a[92:95], a[164:167], v[220:223]
 s_waitcnt vmcnt(23) lgkmcnt(0)
M v[220:223], a[88:91], a[160:163], v[220:223]
 s_barrier
M v[224:227], a[32:35], a[168:171], v[224:227]
 ds_read_b128 a[160:163], v5 offset:32768
 ds_read_b128 a[164:167], v6 offset:32768
M v[224:227], a[36:39], a[172:175], v[224:227]
 v_and_b32 v26, 48, v0
 v_lshlrev_b32 v26, 17, v26
M v[228:231], a[44:47], a[172:175], v[228:231]
 v_or_b32 v26, v26, v0
 v_lshl_add_u32 v26, v26, 7, s95
M v[228:231], a[40:43], a[168:171], v[228:231]
 buffer_load_dword a240, v26, s[76:79], 0 offen offset:0
M v[232:235], a[48:51], a[168:171], v[232:235]
M v[232:235], a[52:55], a[172:175], v[232:235]
M v[236:239], a[60:63], a[172:175], v[236:239]
M v[236:239], a[56:59], a[168:171], v[236:239]
M v[240:243], a[64:67], a[168:171], v[240:243]
M v[240:243], a[68:71], a[172:175], v[240:243]
M v[244:247], a[76:79], a[172:175], v[244:247]
M v[244:247], a[72:75], a[168:171], v[244:247]
M v[248:251], a[80:83], a[168:171], v[248:251]
M v[248:251], a[84:87], a[172:175], v[248:251]
 s_waitcnt lgkmcnt(0)
M v[252:255], a[92:95], a[172:175], v[252:255]
M v[252:255], a[88:91], a[168:171], v[252:255]
M a[0:3], a[96:99], a[160:163], a[0:3]
 ds_read_b128 a[168:171], v5 offset:34816
 ds_read_b128 a[172:175], v6 offset:34816
M a[0:3], a[100:103], a[164:167], a[0:3]
 ds_read_b64_tr_b16 a[32:33], v1 offset:0
 ds_read_b64_tr_b16 a[34:35], v1 offset:1024
M a[4:7], a[108:111], a[164:167], a[4:7]
 s_add_u32 m0, s24, 16384
M a[4:7], a[104:107], a[160:163], a[4:7]
 buffer_load_dwordx4 v12, s[48:51], s22 offen offset:0   lds
M a[8:11], a[112:115], a[160:163], a[8:11]
M a[8:11], a[116:119], a[164:167], a[8:11]
M a[12:15], a[124:127], a[164:167], a[12:15]
 ds_read_b64_tr_b16 a[36:37], v1 offset:8192
 ds_read_b64_tr_b16 a[38:39], v1 offset:9216
M a[12:15], a[120:123], a[160:163], a[12:15]
M a[16:19], a[128:131], a[160:163], a[16:19]
 buffer_load_dwordx4 v13, s[48:51], s22 offen offset:1024   lds
M a[16:19], a[132:135], a[164:167], a[16:19]
M a[20:23], a[140:143], a[164:167], a[20:23]
M a[20:23], a[136:139], a[160:163], a[20:23]
 ds_read_b64_tr_b16 a[40:41], v2 offset:0
 ds_read_b64_tr_b16 a[42:43], v2 offset:1024
M a[24:27], a[144:147], a[160:163], a[24:27]
M a[24:27], a[148:151], a[164:167], a[24:27]
 s_waitcnt lgkmcnt(6)
M a[28:31], a[156:159], a[164:167], a[28:31]
 buffer_load_dwordx4 v14, s[48:51], s22 offen offset:2048   lds
M a[28:31], a[152:155], a[160:163], a[28:31]
M v[32:35], a[96:99], a[168:171], v[32:35]
 ds_read_b128 a[160:163], v5 offset:36864
 ds_read_b128 a[164:167], v6 offset:36864
M v[32:35], a[100:103], a[172:175], v[32:35]
 ds_read_b64_tr_b16 a[44:45], v2 offset:8192
 ds_read_b64_tr_b16 a[46:47], v2 offset:9216
M v[36:39], a[108:111], a[172:175], v[36:39]
 buffer_load_dwordx4 v15, s[48:51], s22 offen offset:3072   lds
M v[36:39], a[104:107], a[168:171], v[36:39]
 s_sub_u32 s22, s22, 2097024
M v[40:43], a[112:115], a[168:171], v[40:43]
M v[40:43], a[116:119], a[172:175], v[40:43]
 ds_read_b64_tr_b16 a[48:49], v3 offset:0
 ds_read_b64_tr_b16 a[50:51], v3 offset:1024
M v[44:47], a[124:127], a[172:175], v[44:47]
 s_add_u32 m0, s23, 49152
M v[44:47], a[120:123], a[168:171], v[44:47]
 buffer_load_dwordx4 v8, s[16:19], s21 offen offset:0  nt lds
M v[48:51], a[128:131], a[168:171], v[48:51]
M v[48:51], a[132:135], a[172:175], v[48:51]
M v[52:55], a[140:143], a[172:175], v[52:55]
 ds_read_b64_tr_b16 a[52:53], v3 offset:8192
 ds_read_b64_tr_b16 a[54:55], v3 offset:9216
M v[52:55], a[136:139], a[168:171], v[52:55]
M v[56:59], a[144:147], a[168:171], v[56:59]
 buffer_load_dwordx4 v9, s[16:19], s21 offen offset:1024  nt lds
M v[56:59], a[148:151], a[172:175], v[56:59]
 s_waitcnt lgkmcnt(6)
M v[60:63], a[156:159], a[172:175], v[60:63]
M v[60:63], a[152:155], a[168:171], v[60:63]
 ds_read_b64_tr_b16 a[56:57], v4 offset:0
 ds_read_b64_tr_b16 a[58:59], v4 offset:1024
M v[64:67], a[96:99], a[160:163], v[64:67]
 ds_read_b128 a[168:171], v5 offset:38912
 ds_read_b128 a[172:175], v6 offset:38912
M v[64:67], a[100:103], a[164:167], v[64:67]
 buffer_load_dwordx4 v10, s[16:19], s21 offen offset:2048  nt lds
M v[68:71], a[108:111], a[164:167], v[68:71]
M v[68:71], a[104:107], a[160:163], v[68:71]
M v[72:75], a[112:115], a[160:163], v[72:75]
 ds_read_b64_tr_b16 a[60:61], v4 offset:8192
 ds_read_b64_tr_b16 a[62:63], v4 offset:9216
M v[72:75], a[116:119], a[164:167], v[72:75]
M v[76:79], a[124:127], a[164:167], v[76:79]
 buffer_load_dwordx4 v11, s[16:19], s21 offen offset:3072  nt lds
M v[76:79], a[120:123], a[160:163], v[76:79]
 s_add_u32 s21, s21, 524160
M v[80:83], a[128:131], a[160:163], v[80:83]
M v[80:83], a[132:135], a[164:167], v[80:83]
M v[84:87], a[140:143], a[164:167], v[84:87]
M v[84:87], a[136:139], a[160:163], v[84:87]
M v[88:91], a[144:147], a[160:163], v[88:91]
M v[88:91], a[148:151], a[164:167], v[88:91]
 s_waitcnt lgkmcnt(2)
M v[92:95], a[156:159], a[164:167], v[92:95]
 s_waitcnt vmcnt(20) lgkmcnt(0)
M v[92:95], a[152:155], a[160:163], v[92:95]
 s_barrier
M v[96:99], a[96:99], a[168:171], v[96:99]
 ds_read_b128 a[160:163], v5 offset:49152
 ds_read_b128 a[164:167], v6 offset:49152
M v[96:99], a[100:103], a[172:175], v[96:99]
M v[100:103], a[108:111], a[172:175], v[100:103]
 s_add_u32 m0, s24, 32768
 ds_read_b64_tr_b16 a[64:65], v1 offset:16384
 ds_read_b64_tr_b16 a[66:67], v1 offset:17408
M v[100:103], a[104:107], a[168:171], v[100:103]
 buffer_load_dwordx4 v12, s[48:51], s22 offen offset:0   lds
M v[104:107], a[112:115], a[168:171], v[104:107]
M v[104:107], a[116:119], a[172:175], v[104:107]
M v[108:111], a[124:127], a[172:175], v[108:111]
M v[108:111], a[120:123], a[168:171], v[108:111]
M v[112:115], a[128:131], a[168:171], v[112:115]
M v[112:115], a[132:135], a[172:175], v[112:115]
 ds_read_b64_tr_b16 a[68:69], v1 offset:24576
 ds_read_b64_tr_b16 a[70:71], v1 offset:25600
M v[116:119], a[140:143], a[172:175], v[116:119]
 buffer_load_dwordx4 v13, s[48:51], s22 offen offset:1024   lds
M v[116:119], a[136:139], a[168:171], v[116:119]
M v[120:123], a[144:147], a[168:171], v[120:123]
M v[120:123], a[148:151], a[172:175], v[120:123]
 s_waitcnt lgkmcnt(4)
M v[124:127], a[156:159], a[172:175], v[124:127]
M v[124:127], a[152:155], a[168:171], v[124:127]
M v[128:131], a[96:99], a[160:163], v[128:131]
 ds_read_b128 a[168:171], v5 offset:51200
 ds_read_b128 a[172:175], v6 offset:51200
M v[128:131], a[100:103], a[164:167], v[128:131]
 ds_read_b64_tr_b16 a[72:73], v2 offset:16384
 ds_read_b64_tr_b16 a[74:75], v2 offset:17408
M v[132:135], a[108:111], a[164:167], v[132:135]
 buffer_load_dwordx4 v14, s[48:51], s22 offen offset:2048   lds
M v[132:135], a[104:107], a[160:163], v[132:135]
M v[136:139], a[112:115], a[160:163], v[136:139]
M v[136:139], a[116:119], a[164:167], v[136:139]
M v[140:143], a[124:127], a[164:167], v[140:143]
M v[140:143], a[120:123], a[160:163], v[140:143]
 ds_read_b64_tr_b16 a[76:77], v2 offset:24576
 ds_read_b64_tr_b16 a[78:79], v2 offset:25600
M v[144:147], a[128:131], a[160:163], v[144:147]
 buffer_load_dwordx4 v15, s[48:51], s22 offen offset:3072   lds
M v[144:147], a[132:135], a[164:167], v[144:147]
 s_add_u32 s22, s22, 2097152
M v[148:151], a[140:143], a[164:167], v[148:151]
M v[148:151], a[136:139], a[160:163], v[148:151]
M v[152:155], a[144:147], a[160:163], v[152:155]
M v[152:155], a[148:151], a[164:167], v[152:155]
 s_waitcnt lgkmcnt(4)
M v[156:159], a[156:159], a[164:167], v[156:159]
 s_add_u32 m0, s23, 0
 ds_read_b64_tr_b16 a[80:81], v3 offset:16384
 ds_read_b64_tr_b16 a[82:83], v3 offset:17408
M v[156:159], a[152:155], a[160:163], v[156:159]
 buffer_load_dwordx4 v8, s[16:19], s21 offen offset:0  nt lds
M v[160:163], a[96:99], a[168:171], v[160:163]
 ds_read_b128 a[160:163], v5 offset:53248
 ds_read_b128 a[164:167], v6 offset:53248
M v[160:163], a[100:103], a[172:175], v[160:163]
M v[164:167], a[108:111], a[172:175], v[164:167]
M v[164:167], a[104:107], a[168:171], v[164:167]
M v[168:171], a[112:115], a[168:171], v[168:171]
M v[168:171], a[116:119], a[172:175], v[168:171]
 ds_read_b64_tr_b16 a[84:85], v3 offset:24576
 ds_read_b64_tr_b16 a[86:87], v3 offset:25600
M v[172:175], a[124:127], a[172:175], v[172:175]
 buffer_load_dwordx4 v9, s[16:19], s21 offen offset:1024  nt lds
M v[172:175], a[120:123], a[168:171], v[172:175]
M v[176:179], a[128:131], a[168:171], v[176:179]
M v[176:179], a[132:135], a[172:175], v[176:179]
M v[180:183], a[140:143], a[172:175], v[180:183]
M v[180:183], a[136:139], a[168:171], v[180:183]
M v[184:187], a[144:147], a[168:171], v[184:187]
 ds_read_b64_tr_b16 a[88:89], v4 offset:16384
 ds_read_b64_tr_b16 a[90:91], v4 offset:17408
M v[184:187], a[148:151], a[172:175], v[184:187]
 s_waitcnt lgkmcnt(4)
M v[188:191], a[156:159], a[172:175], v[188:191]
 buffer_load_dwordx4 v10, s[16:19], s21 offen offset:2048  nt lds
M v[188:191], a[152:155], a[168:171], v[188:191]
M v[192:195], a[96:99], a[160:163], v[192:195]
 ds_read_b128 a[168:171], v5 offset:55296
 ds_read_b128 a[172:175], v6 offset:55296
M v[192:195], a[100:103], a[164:167], v[192:195]
M v[196:199], a[108:111], a[164:167], v[196:199]
M v[196:199], a[104:107], a[160:163], v[196:199]
 ds_read_b64_tr_b16 a[92:93], v4 offset:24576
 ds_read_b64_tr_b16 a[94:95], v4 offset:25600
M v[200:203], a[112:115], a[160:163], v[200:203]
 buffer_load_dwordx4 v11, s[16:19], s21 offen offset:3072  nt lds
M v[200:203], a[116:119], a[164:167], v[200:203]
 s_add_u32 s21, s21, 128
M v[204:207], a[124:127], a[164:167], v[204:207]
M v[204:207], a[120:123], a[160:163], v[204:207]
M v[208:211], a[128:131], a[160:163], v[208:211]
M v[208:211], a[132:135], a[164:167], v[208:211]
M v[212:215], a[140:143], a[164:167], v[212:215]
M v[212:215], a[136:139], a[160:163], v[212:215]
M v[216:219], a[144:147], a[160:163], v[216:219]
M v[216:219], a[148:151], a[164:167], v[216:219]
 s_waitcnt lgkmcnt(2)
M v[220:223], a[156:159], a[164:167], v[220:223]
 s_waitcnt vmcnt(17) lgkmcnt(0)
M v[220:223], a[152:155], a[160:163], v[220:223]
 s_barrier
M v[224:227], a[96:99], a[168:171], v[224:227]
 ds_read_b128 a[160:163], v5 offset:0
 ds_read_b128 a[164:167], v6 offset:0
M v[224:227], a[100:103], a[172:175], v[224:227]
M v[228:231], a[108:111], a[172:175], v[228:231]
M v[228:231], a[104:107], a[168:171], v[228:231]
M v[232:235], a[112:115], a[168:171], v[232:235]
M v[232:235], a[116:119], a[172:175], v[232:235]
M v[236:239], a[124:127], a[172:175], v[236:239]
M v[236:239], a[120:123], a[168:171], v[236:239]
M v[240:243], a[128:131], a[168:171], v[240:243]
M v[240:243], a[132:135], a[172:175], v[240:243]
M v[244:247], a[140:143], a[172:175], v[244:247]
M v[244:247], a[136:139], a[168:171], v[244:247]
M v[248:251], a[144:147], a[168:171], v[248:251]
M v[248:251], a[148:151], a[172:175], v[248:251]
 s_waitcnt lgkmcnt(0)
M v[252:255], a[156:159], a[172:175], v[252:255]
M v[252:255], a[152:155], a[168:171], v[252:255]
M a[0:3], a[32:35], a[160:163], a[0:3]
 ds_read_b128 a[168:171], v5 offset:2048
 ds_read_b128 a[172:175], v6 offset:2048
M a[0:3], a[36:39], a[164:167], a[0:3]
 ds_read_b64_tr_b16 a[96:97], v1 offset:32768
 ds_read_b64_tr_b16 a[98:99], v1 offset:33792
M a[4:7], a[44:47], a[164:167], a[4:7]
 s_add_u32 m0, s24, 49152
 v_lshrrev_b32 v28, 2, v0
M a[4:7], a[40:43], a[160:163], a[4:7]
 buffer_load_dwordx4 v12, s[48:51], s22 offen offset:0   lds
M a[8:11], a[48:51], a[160:163], a[8:11]
 v_mul_u32_u24 v28, 896, v28
M a[8:11], a[52:55], a[164:167], a[8:11]
M a[12:15], a[60:63], a[164:167], a[12:15]
 ds_read_b64_tr_b16 a[100:101], v1 offset:40960
 ds_read_b64_tr_b16 a[102:103], v1 offset:41984
M a[12:15], a[56:59], a[160:163], a[12:15]
 v_and_b32 v29, 3, v0
M a[16:19], a[64:67], a[160:163], a[16:19]
 buffer_load_dwordx4 v13, s[48:51], s22 offen offset:1024   lds
M a[16:19], a[68:71], a[164:167], a[16:19]
 v_lshl_add_u32 v28, v29, 4, v28
M a[20:23], a[76:79], a[164:167], a[20:23]
M a[20:23], a[72:75], a[160:163], a[20:23]
 s_lshr_b32 s64, s20, 1
 ds_read_b64_tr_b16 a[104:105], v2 offset:32768
 ds_read_b64_tr_b16 a[106:107], v2 offset:33792
M a[24:27], a[80:83], a[160:163], a[24:27]
 s_lshl_b32 s64, s64, 6
 s_and_b32 s72, s20, 1
 s_lshl_b32 s72, s72, 3
M a[24:27], a[84:87], a[164:167], a[24:27]
 s_waitcnt lgkmcnt(6)
 s_add_u32 s64, s64, s72
 s_add_u32 s64, s64, 131072
M a[28:31], a[92:95], a[164:167], a[28:31]
 buffer_load_dwordx4 v14, s[48:51], s22 offen offset:2048   lds
M a[28:31], a[88:91], a[160:163], a[28:31]
 v_add_u32 v28, s64, v28
M v[32:35], a[32:35], a[168:171], v[32:35]
 ds_read_b128 a[160:163], v5 offset:4096
 ds_read_b128 a[164:167], v6 offset:4096
M v[32:35], a[36:39], a[172:175], v[32:35]
 s_lshl_b32 s94, s41, 18
 ds_read_b64_tr_b16 a[108:109], v2 offset:40960
 ds_read_b64_tr_b16 a[110:111], v2 offset:41984
M v[36:39], a[44:47], a[172:175], v[36:39]
 buffer_load_dwordx4 v15, s[48:51], s22 offen offset:3072   lds
M v[36:39], a[40:43], a[168:171], v[36:39]
 s_sub_u32 s22, s22, 2097024
 s_and_b32 s64, s42, 7
M v[40:43], a[48:51], a[168:171], v[40:43]
 s_lshl_b32 s64, s64, 10
M v[40:43], a[52:55], a[172:175], v[40:43]
 s_add_u32 s94, s94, s64
 ds_read_b64_tr_b16 a[112:113], v3 offset:32768
 ds_read_b64_tr_b16 a[114:115], v3 offset:33792
M v[44:47], a[60:63], a[172:175], v[44:47]
 s_add_u32 m0, s23, 16384
 s_lshl_b32 s64, s20, 13
 s_add_u32 s94, s94, s64
M v[44:47], a[56:59], a[168:171], v[44:47]
 buffer_load_dwordx4 v8, s[16:19], s21 offen offset:0  nt lds
M v[48:51], a[64:67], a[168:171], v[48:51]
 s_add_u32 s94, s94, 100663296
 ds_read_b64_tr_b16 a[192:193], v28 offset:0
M v[48:51], a[68:71], a[172:175], v[48:51]
M v[52:55], a[76:79], a[172:175], v[52:55]
 ds_read_b64_tr_b16 a[116:117], v3 offset:40960
 ds_read_b64_tr_b16 a[118:119], v3 offset:41984
M v[52:55], a[72:75], a[168:171], v[52:55]
 ds_read_b64_tr_b16 a[194:195], v28 offset:14336
M v[56:59], a[80:83], a[168:171], v[56:59]
 buffer_load_dwordx4 v9, s[16:19], s21 offen offset:1024  nt lds
M v[56:59], a[84:87], a[172:175], v[56:59]
 s_waitcnt lgkmcnt(8)
 ds_read_b64_tr_b16 a[196:197], v28 offset:128
M v[60:63], a[92:95], a[172:175], v[60:63]
M v[60:63], a[88:91], a[168:171], v[60:63]
 ds_read_b64_tr_b16 a[120:121], v4 offset:32768
 ds_read_b64_tr_b16 a[122:123], v4 offset:33792
M v[64:67], a[32:35], a[160:163], v[64:67]
 ds_read_b128 a[168:171], v5 offset:6144
 ds_read_b128 a[172:175], v6 offset:6144
M v[64:67], a[36:39], a[164:167], v[64:67]
 buffer_load_dwordx4 v10, s[16:19], s21 offen offset:2048  nt lds
M v[68:71], a[44:47], a[164:167], v[68:71]
 ds_read_b64_tr_b16 a[198:199], v28 offset:14464
M v[68:71], a[40:43], a[160:163], v[68:71]
M v[72:75], a[48:51], a[160:163], v[72:75]
 ds_read_b64_tr_b16 a[124:125], v4 offset:40960
 ds_read_b64_tr_b16 a[126:127], v4 offset:41984
M v[72:75], a[52:55], a[164:167], v[72:75]
 ds_read_b64_tr_b16 a[200:201], v28 offset:256
M v[76:79], a[60:63], a[164:167], v[76:79]
 buffer_load_dwordx4 v11, s[16:19], s21 offen offset:3072  nt lds
M v[76:79], a[56:59], a[160:163], v[76:79]
 s_add_u32 s21, s21, 524160
 ds_read_b64_tr_b16 a[202:203], v28 offset:14592
M v[80:83], a[64:67], a[160:163], v[80:83]
M v[80:83], a[68:71], a[164:167], v[80:83]
 ds_read_b64_tr_b16 a[204:205], v28 offset:384
M v[84:87], a[76:79], a[164:167], v[84:87]
M v[84:87], a[72:75], a[160:163], v[84:87]
 ds_read_b64_tr_b16 a[206:207], v28 offset:14720
M v[88:91], a[80:83], a[160:163], v[88:91]
M v[88:91], a[84:87], a[164:167], v[88:91]
 s_waitcnt lgkmcnt(7)
 ds_read_b64_tr_b16 a[208:209], v28 offset:512
M v[92:95], a[92:95], a[164:167], v[92:95]
 s_waitcnt vmcnt(16) lgkmcnt(0)
M v[92:95], a[88:91], a[160:163], v[92:95]
 s_barrier
M v[96:99], a[32:35], a[168:171], v[96:99]
 ds_read_b128 a[160:163], v5 offset:16384
 ds_read_b128 a[164:167], v6 offset:16384
M v[96:99], a[36:39], a[172:175], v[96:99]
 ds_read_b64_tr_b16 a[210:211], v28 offset:14848
M v[100:103], a[44:47], a[172:175], v[100:103]
 s_add_u32 m0, s24, 0
 ds_read_b64_tr_b16 a[128:129], v1 offset:49152
 ds_read_b64_tr_b16 a[130:131], v1 offset:50176
M v[100:103], a[40:43], a[168:171], v[100:103]
 buffer_load_dwordx4 v12, s[48:51], s22 offen offset:0   lds
M v[104:107], a[48:51], a[168:171], v[104:107]
 ds_read_b64_tr_b16 a[212:213], v28 offset:640
M v[104:107], a[52:55], a[172:175], v[104:107]
M v[108:111], a[60:63], a[172:175], v[108:111]
 ds_read_b64_tr_b16 a[214:215], v28 offset:14976
M v[108:111], a[56:59], a[168:171], v[108:111]
M v[112:115], a[64:67], a[168:171], v[112:115]
 ds_read_b64_tr_b16 a[216:217], v28 offset:768
M v[112:115], a[68:71], a[172:175], v[112:115]
 ds_read_b64_tr_b16 a[132:133], v1 offset:57344
 ds_read_b64_tr_b16 a[134:135], v1 offset:58368
M v[116:119], a[76:79], a[172:175], v[116:119]
 buffer_load_dwordx4 v13, s[48:51], s22 offen offset:1024   lds
M v[116:119], a[72:75], a[168:171], v[116:119]
 ds_read_b64_tr_b16 a[218:219], v28 offset:15104
M v[120:123], a[80:83], a[168:171], v[120:123]
M v[120:123], a[84:87], a[172:175], v[120:123]
 s_waitcnt lgkmcnt(9)
M v[124:127], a[92:95], a[172:175], v[124:127]
M v[124:127], a[88:91], a[168:171], v[124:127]
M v[128:131], a[32:35], a[160:163], v[128:131]
 ds_read_b128 a[168:171], v5 offset:18432
 ds_read_b128 a[172:175], v6 offset:18432
M v[128:131], a[36:39], a[164:167], v[128:131]
 ds_read_b64_tr_b16 a[136:137], v2 offset:49152
 ds_read_b64_tr_b16 a[138:139], v2 offset:50176
M v[132:135], a[44:47], a[164:167], v[132:135]
 buffer_load_dwordx4 v14, s[48:51], s22 offen offset:2048   lds
M v[132:135], a[40:43], a[160:163], v[132:135]
M v[136:139], a[48:51], a[160:163], v[136:139]
M v[136:139], a[52:55], a[164:167], v[136:139]
M v[140:143], a[60:63], a[164:167], v[140:143]
M v[140:143], a[56:59], a[160:163], v[140:143]
 ds_read_b64_tr_b16 a[140:141], v2 offset:57344
 ds_read_b64_tr_b16 a[142:143], v2 offset:58368
M v[144:147], a[64:67], a[160:163], v[144:147]
 buffer_load_dwordx4 v15, s[48:51], s22 offen offset:3072   lds
M v[144:147], a[68:71], a[164:167], v[144:147]
 s_add_u32 s22, s22, 2097152
M v[148:151], a[76:79], a[164:167], v[148:151]
M v[148:151], a[72:75], a[160:163], v[148:151]
M v[152:155], a[80:83], a[160:163], v[152:155]
M v[152:155], a[84:87], a[164:167], v[152:155]
 s_waitcnt lgkmcnt(4)
M v[156:159], a[92:95], a[164:167], v[156:159]
 s_add_u32 m0, s23, 32768
 ds_read_b64_tr_b16 a[144:145], v3 offset:49152
 ds_read_b64_tr_b16 a[146:147], v3 offset:50176
M v[156:159], a[88:91], a[160:163], v[156:159]
 buffer_load_dwordx4 v8, s[16:19], s21 offen offset:0  nt lds
M v[160:163], a[32:35], a[168:171], v[160:163]
 ds_read_b128 a[160:163], v5 offset:20480
 ds_read_b128 a[164:167], v6 offset:20480
M v[160:163], a[36:39], a[172:175], v[160:163]
M v[164:167], a[44:47], a[172:175], v[164:167]
M v[164:167], a[40:43], a[168:171], v[164:167]
M v[168:171], a[48:51], a[168:171], v[168:171]
M v[168:171], a[52:55], a[172:175], v[168:171]
 ds_read_b64_tr_b16 a[148:149], v3 offset:57344
 ds_read_b64_tr_b16 a[150:151], v3 offset:58368
M v[172:175], a[60:63], a[172:175], v[172:175]
 buffer_load_dwordx4 v9, s[16:19], s21 offen offset:1024  nt lds
M v[172:175], a[56:59], a[168:171], v[172:175]
M v[176:179], a[64:67], a[168:171], v[176:179]
M v[176:179], a[68:71], a[172:175], v[176:179]
M v[180:183], a[76:79], a[172:175], v[180:183]
M v[180:183], a[72:75], a[168:171], v[180:183]
M v[184:187], a[80:83], a[168:171], v[184:187]
 ds_read_b64_tr_b16 a[152:153], v4 offset:49152
 ds_read_b64_tr_b16 a[154:155], v4 offset:50176
M v[184:187], a[84:87], a[172:175], v[184:187]
 s_waitcnt lgkmcnt(4)
M v[188:191], a[92:95], a[172:175], v[188:191]
 buffer_load_dwordx4 v10, s[16:19], s21 offen offset:2048  nt lds
M v[188:191], a[88:91], a[168:171], v[188:191]
M v[192:195], a[32:35], a[160:163], v[192:195]
 ds_read_b128 a[168:171], v5 offset:22528
 ds_read_b128 a[172:175], v6 offset:22528
M v[192:195], a[36:39], a[164:167], v[192:195]
M v[196:199], a[44:47], a[164:167], v[196:199]
M v[196:199], a[40:43], a[160:163], v[196:199]
 ds_read_b64_tr_b16 a[156:157], v4 offset:57344
 ds_read_b64_tr_b16 a[158:159], v4 offset:58368
M v[200:203], a[48:51], a[160:163], v[200:203]
 buffer_load_dwordx4 v11, s[16:19], s21 offen offset:3072  nt lds
M v[200:203], a[52:55], a[164:167], v[200:203]
 s_add_u32 s21, s21, 128
M v[204:207], a[60:63], a[164:167], v[204:207]
M v[204:207], a[56:59], a[160:163], v[204:207]
M v[208:211], a[64:67], a[160:163], v[208:211]
M v[208:211], a[68:71], a[164:167], v[208:211]
M v[212:215], a[76:79], a[164:167], v[212:215]
M v[212:215], a[72:75], a[160:163], v[212:215]
M v[216:219], a[80:83], a[160:163], v[216:219]
M v[216:219], a[84:87], a[164:167], v[216:219]
 s_waitcnt lgkmcnt(2)
M v[220:223], a[92:95], a[164:167], v[220:223]
 s_waitcnt vmcnt(16) lgkmcnt(0)
M v[220:223], a[88:91], a[160:163], v[220:223]
 s_barrier
M v[224:227], a[32:35], a[168:171], v[224:227]
 ds_read_b128 a[160:163], v5 offset:32768
 ds_read_b128 a[164:167], v6 offset:32768
M v[224:227], a[36:39], a[172:175], v[224:227]
 buffer_load_dword a240, v24, s[32:35], 0 offen offset:1536
M v[228:231], a[44:47], a[172:175], v[228:231]
M v[228:231], a[40:43], a[168:171], v[228:231]
M v[232:235], a[48:51], a[168:171], v[232:235]
M v[232:235], a[52:55], a[172:175], v[232:235]
M v[236:239], a[60:63], a[172:175], v[236:239]
M v[236:239], a[56:59], a[168:171], v[236:239]
M v[240:243], a[64:67], a[168:171], v[240:243]
M v[240:243], a[68:71], a[172:175], v[240:243]
M v[244:247], a[76:79], a[172:175], v[244:247]
M v[244:247], a[72:75], a[168:171], v[244:247]
M v[248:251], a[80:83], a[168:171], v[248:251]
M v[248:251], a[84:87], a[172:175], v[248:251]
 s_waitcnt lgkmcnt(0)
M v[252:255], a[92:95], a[172:175], v[252:255]
M v[252:255], a[88:91], a[168:171], v[252:255]
M a[0:3], a[96:99], a[160:163], a[0:3]
 ds_read_b128 a[168:171], v5 offset:34816
 ds_read_b128 a[172:175], v6 offset:34816
M a[0:3], a[100:103], a[164:167], a[0:3]
 ds_read_b64_tr_b16 a[32:33], v1 offset:0
 ds_read_b64_tr_b16 a[34:35], v1 offset:1024
M a[4:7], a[108:111], a[164:167], a[4:7]
 s_add_u32 m0, s24, 16384
M a[4:7], a[104:107], a[160:163], a[4:7]
 buffer_load_dwordx4 v12, s[48:51], s22 offen offset:0   lds
M a[8:11], a[112:115], a[160:163], a[8:11]
M a[8:11], a[116:119], a[164:167], a[8:11]
M a[12:15], a[124:127], a[164:167], a[12:15]
 ds_read_b64_tr_b16 a[36:37], v1 offset:8192
 ds_read_b64_tr_b16 a[38:39], v1 offset:9216
M a[12:15], a[120:123], a[160:163], a[12:15]
M a[16:19], a[128:131], a[160:163], a[16:19]
 buffer_load_dwordx4 v13, s[48:51], s22 offen offset:1024   lds
M a[16:19], a[132:135], a[164:167], a[16:19]
M a[20:23], a[140:143], a[164:167], a[20:23]
M a[20:23], a[136:139], a[160:163], a[20:23]
 ds_read_b64_tr_b16 a[40:41], v2 offset:0
 ds_read_b64_tr_b16 a[42:43], v2 offset:1024
M a[24:27], a[144:147], a[160:163], a[24:27]
M a[24:27], a[148:151], a[164:167], a[24:27]
 s_waitcnt lgkmcnt(6)
M a[28:31], a[156:159], a[164:167], a[28:31]
 buffer_load_dwordx4 v14, s[48:51], s22 offen offset:2048   lds
M a[28:31], a[152:155], a[160:163], a[28:31]
M v[32:35], a[96:99], a[168:171], v[32:35]
 ds_read_b128 a[160:163], v5 offset:36864
 ds_read_b128 a[164:167], v6 offset:36864
M v[32:35], a[100:103], a[172:175], v[32:35]
 ds_read_b64_tr_b16 a[44:45], v2 offset:8192
 ds_read_b64_tr_b16 a[46:47], v2 offset:9216
M v[36:39], a[108:111], a[172:175], v[36:39]
 buffer_load_dwordx4 v15, s[48:51], s22 offen offset:3072   lds
M v[36:39], a[104:107], a[168:171], v[36:39]
 s_sub_u32 s22, s22, 2097024
M v[40:43], a[112:115], a[168:171], v[40:43]
M v[40:43], a[116:119], a[172:175], v[40:43]
 ds_read_b64_tr_b16 a[48:49], v3 offset:0
 ds_read_b64_tr_b16 a[50:51], v3 offset:1024
M v[44:47], a[124:127], a[172:175], v[44:47]
 s_add_u32 m0, s23, 49152
M v[44:47], a[120:123], a[168:171], v[44:47]
 buffer_load_dwordx4 v8, s[16:19], s21 offen offset:0  nt lds
M v[48:51], a[128:131], a[168:171], v[48:51]
M v[48:51], a[132:135], a[172:175], v[48:51]
M v[52:55], a[140:143], a[172:175], v[52:55]
 ds_read_b64_tr_b16 a[52:53], v3 offset:8192
 ds_read_b64_tr_b16 a[54:55], v3 offset:9216
M v[52:55], a[136:139], a[168:171], v[52:55]
M v[56:59], a[144:147], a[168:171], v[56:59]
 buffer_load_dwordx4 v9, s[16:19], s21 offen offset:1024  nt lds
M v[56:59], a[148:151], a[172:175], v[56:59]
 s_waitcnt lgkmcnt(6)
M v[60:63], a[156:159], a[172:175], v[60:63]
M v[60:63], a[152:155], a[168:171], v[60:63]
 ds_read_b64_tr_b16 a[56:57], v4 offset:0
 ds_read_b64_tr_b16 a[58:59], v4 offset:1024
M v[64:67], a[96:99], a[160:163], v[64:67]
 ds_read_b128 a[168:171], v5 offset:38912
 ds_read_b128 a[172:175], v6 offset:38912
M v[64:67], a[100:103], a[164:167], v[64:67]
 buffer_load_dwordx4 v10, s[16:19], s21 offen offset:2048  nt lds
M v[68:71], a[108:111], a[164:167], v[68:71]
M v[68:71], a[104:107], a[160:163], v[68:71]
M v[72:75], a[112:115], a[160:163], v[72:75]
 ds_read_b64_tr_b16 a[60:61], v4 offset:8192
 ds_read_b64_tr_b16 a[62:63], v4 offset:9216
M v[72:75], a[116:119], a[164:167], v[72:75]
M v[76:79], a[124:127], a[164:167], v[76:79]
 buffer_load_dwordx4 v11, s[16:19], s21 offen offset:3072  nt lds
M v[76:79], a[120:123], a[160:163], v[76:79]
 s_add_u32 s21, s21, 524160
M v[80:83], a[128:131], a[160:163], v[80:83]
M v[80:83], a[132:135], a[164:167], v[80:83]
M v[84:87], a[140:143], a[164:167], v[84:87]
M v[84:87], a[136:139], a[160:163], v[84:87]
M v[88:91], a[144:147], a[160:163], v[88:91]
M v[88:91], a[148:151], a[164:167], v[88:91]
 s_waitcnt lgkmcnt(2)
M v[92:95], a[156:159], a[164:167], v[92:95]
 s_waitcnt vmcnt(17) lgkmcnt(0)
M v[92:95], a[152:155], a[160:163], v[92:95]
 s_barrier
M v[96:99], a[96:99], a[168:171], v[96:99]
 ds_read_b128 a[160:163], v5 offset:49152
 ds_read_b128 a[164:167], v6 offset:49152
M v[96:99], a[100:103], a[172:175], v[96:99]
M v[100:103], a[108:111], a[172:175], v[100:103]
 s_add_u32 m0, s24, 32768
 ds_read_b64_tr_b16 a[64:65], v1 offset:16384
 ds_read_b64_tr_b16 a[66:67], v1 offset:17408
M v[100:103], a[104:107], a[168:171], v[100:103]
 buffer_load_dwordx4 v12, s[48:51], s22 offen offset:0   lds
M v[104:107], a[112:115], a[168:171], v[104:107]
M v[104:107], a[116:119], a[172:175], v[104:107]
M v[108:111], a[124:127], a[172:175], v[108:111]
M v[108:111], a[120:123], a[168:171], v[108:111]
M v[112:115], a[128:131], a[168:171], v[112:115]
M v[112:115], a[132:135], a[172:175], v[112:115]
 ds_read_b64_tr_b16 a[68:69], v1 offset:24576
 ds_read_b64_tr_b16 a[70:71], v1 offset:25600
M v[116:119], a[140:143], a[172:175], v[116:119]
 buffer_load_dwordx4 v13, s[48:51], s22 offen offset:1024   lds
M v[116:119], a[136:139], a[168:171], v[116:119]
M v[120:123], a[144:147], a[168:171], v[120:123]
 s_and_b32 s64, s42, 7
 s_lshl_b32 s64, s64, 2
M v[120:123], a[148:151], a[172:175], v[120:123]
 s_waitcnt lgkmcnt(4)
 s_add_u32 s64, s64, s20
M v[124:127], a[156:159], a[172:175], v[124:127]
 s_mul_i32 s64, s64, 114688
 v_bfe_u32 v28, v0, 2, 2
 v_and_b32 v29, 3, v0
M v[124:127], a[152:155], a[168:171], v[124:127]
 v_lshlrev_b32 v29, 7, v29
 v_lshl_add_u32 v28, v28, 13, v29
M v[128:131], a[96:99], a[160:163], v[128:131]
 ds_read_b128 a[168:171], v5 offset:51200
 ds_read_b128 a[172:175], v6 offset:51200
M v[128:131], a[100:103], a[164:167], v[128:131]
 ds_read_b64_tr_b16 a[72:73], v2 offset:16384
 ds_read_b64_tr_b16 a[74:75], v2 offset:17408
M v[132:135], a[108:111], a[164:167], v[132:135]
 buffer_load_dwordx4 v14, s[48:51], s22 offen offset:2048   lds
M v[132:135], a[104:107], a[160:163], v[132:135]
 v_add_u32 v23, s64, v28
 v_and_b32 v28, 48, v0
M v[136:139], a[112:115], a[160:163], v[136:139]
 v_lshl_add_u32 v23, v28, 24, v23
M v[136:139], a[116:119], a[164:167], v[136:139]
M v[140:143], a[124:127], a[164:167], v[140:143]
M v[140:143], a[120:123], a[160:163], v[140:143]
 ds_read_b64_tr_b16 a[76:77], v2 offset:24576
 ds_read_b64_tr_b16 a[78:79], v2 offset:25600
M v[144:147], a[128:131], a[160:163], v[144:147]
 buffer_load_dwordx4 v15, s[48:51], s22 offen offset:3072   lds
M v[144:147], a[132:135], a[164:167], v[144:147]
 s_add_u32 s22, s22, 2097152
M v[148:151], a[140:143], a[164:167], v[148:151]
M v[148:151], a[136:139], a[160:163], v[148:151]
M v[152:155], a[144:147], a[160:163], v[152:155]
M v[152:155], a[148:151], a[164:167], v[152:155]
 s_waitcnt lgkmcnt(4)
M v[156:159], a[156:159], a[164:167], v[156:159]
 s_add_u32 m0, s23, 0
 ds_read_b64_tr_b16 a[80:81], v3 offset:16384
 ds_read_b64_tr_b16 a[82:83], v3 offset:17408
M v[156:159], a[152:155], a[160:163], v[156:159]
 buffer_load_dwordx4 v8, s[16:19], s21 offen offset:0  nt lds
M v[160:163], a[96:99], a[168:171], v[160:163]
 ds_read_b128 a[160:163], v5 offset:53248
 ds_read_b128 a[164:167], v6 offset:53248
M v[160:163], a[100:103], a[172:175], v[160:163]
M v[164:167], a[108:111], a[172:175], v[164:167]
M v[164:167], a[104:107], a[168:171], v[164:167]
M v[168:171], a[112:115], a[168:171], v[168:171]
M v[168:171], a[116:119], a[172:175], v[168:171]
 ds_read_b64_tr_b16 a[84:85], v3 offset:24576
 ds_read_b64_tr_b16 a[86:87], v3 offset:25600
M v[172:175], a[124:127], a[172:175], v[172:175]
 buffer_load_dwordx4 v9, s[16:19], s21 offen offset:1024  nt lds
M v[172:175], a[120:123], a[168:171], v[172:175]
M v[176:179], a[128:131], a[168:171], v[176:179]
M v[176:179], a[132:135], a[172:175], v[176:179]
M v[180:183], a[140:143], a[172:175], v[180:183]
M v[180:183], a[136:139], a[168:171], v[180:183]
M v[184:187], a[144:147], a[168:171], v[184:187]
 ds_read_b64_tr_b16 a[88:89], v4 offset:16384
 ds_read_b64_tr_b16 a[90:91], v4 offset:17408
M v[184:187], a[148:151], a[172:175], v[184:187]
 s_waitcnt lgkmcnt(4)
M v[188:191], a[156:159], a[172:175], v[188:191]
 buffer_load_dwordx4 v10, s[16:19], s21 offen offset:2048  nt lds
M v[188:191], a[152:155], a[168:171], v[188:191]
M v[192:195], a[96:99], a[160:163], v[192:195]
 ds_read_b128 a[168:171], v5 offset:55296
 ds_read_b128 a[172:175], v6 offset:55296
M v[192:195], a[100:103], a[164:167], v[192:195]
M v[196:199], a[108:111], a[164:167], v[196:199]
M v[196:199], a[104:107], a[160:163], v[196:199]
 ds_read_b64_tr_b16 a[92:93], v4 offset:24576
 ds_read_b64_tr_b16 a[94:95], v4 offset:25600
M v[200:203], a[112:115], a[160:163], v[200:203]
 buffer_load_dwordx4 v11, s[16:19], s21 offen offset:3072  nt lds
M v[200:203], a[116:119], a[164:167], v[200:203]
 s_add_u32 s21, s21, 128
M v[204:207], a[124:127], a[164:167], v[204:207]
M v[204:207], a[120:123], a[160:163], v[204:207]
M v[208:211], a[128:131], a[160:163], v[208:211]
M v[208:211], a[132:135], a[164:167], v[208:211]
M v[212:215], a[140:143], a[164:167], v[212:215]
M v[212:215], a[136:139], a[160:163], v[212:215]
M v[216:219], a[144:147], a[160:163], v[216:219]
M v[216:219], a[148:151], a[164:167], v[216:219]
 s_waitcnt lgkmcnt(2)
M v[220:223], a[156:159], a[164:167], v[220:223]
 s_waitcnt vmcnt(17) lgkmcnt(0)
M v[220:223], a[152:155], a[160:163], v[220:223]
 s_barrier
M v[224:227], a[96:99], a[168:171], v[224:227]
 ds_read_b128 a[160:163], v5 offset:0
 ds_read_b128 a[164:167], v6 offset:0
M v[224:227], a[100:103], a[172:175], v[224:227]
 buffer_load_dword a240, v23, s[52:55], 0 offen offset:0
M v[228:231], a[108:111], a[172:175], v[228:231]
 v_add_u32 v23, 32768, v23
M v[228:231], a[104:107], a[168:171], v[228:231]
M v[232:235], a[112:115], a[168:171], v[232:235]
M v[232:235], a[116:119], a[172:175], v[232:235]
M v[236:239], a[124:127], a[172:175], v[236:239]
M v[236:239], a[120:123], a[168:171], v[236:239]
M v[240:243], a[128:131], a[168:171], v[240:243]
M v[240:243], a[132:135], a[172:175], v[240:243]
M v[244:247], a[140:143], a[172:175], v[244:247]
M v[244:247], a[136:139], a[168:171], v[244:247]
M v[248:251], a[144:147], a[168:171], v[248:251]
M v[248:251], a[148:151], a[172:175], v[248:251]
 s_waitcnt lgkmcnt(0)
M v[252:255], a[156:159], a[172:175], v[252:255]
M v[252:255], a[152:155], a[168:171], v[252:255]
M a[0:3], a[32:35], a[160:163], a[0:3]
 ds_read_b128 a[168:171], v5 offset:2048
 ds_read_b128 a[172:175], v6 offset:2048
M a[0:3], a[36:39], a[164:167], a[0:3]
 ds_read_b64_tr_b16 a[96:97], v1 offset:32768
 ds_read_b64_tr_b16 a[98:99], v1 offset:33792
M a[4:7], a[44:47], a[164:167], a[4:7]
 s_add_u32 m0, s24, 49152
M a[4:7], a[40:43], a[160:163], a[4:7]
 buffer_load_dwordx4 v12, s[48:51], s22 offen offset:0   lds
M a[8:11], a[48:51], a[160:163], a[8:11]
M a[8:11], a[52:55], a[164:167], a[8:11]
M a[12:15], a[60:63], a[164:167], a[12:15]
 ds_read_b64_tr_b16 a[100:101], v1 offset:40960
 ds_read_b64_tr_b16 a[102:103], v1 offset:41984
M a[12:15], a[56:59], a[160:163], a[12:15]
M a[16:19], a[64:67], a[160:163], a[16:19]
 buffer_load_dwordx4 v13, s[48:51], s22 offen offset:1024   lds
M a[16:19], a[68:71], a[164:167], a[16:19]
M a[20:23], a[76:79], a[164:167], a[20:23]
M a[20:23], a[72:75], a[160:163], a[20:23]
 ds_read_b64_tr_b16 a[104:105], v2 offset:32768
 ds_read_b64_tr_b16 a[106:107], v2 offset:33792
M a[24:27], a[80:83], a[160:163], a[24:27]
M a[24:27], a[84:87], a[164:167], a[24:27]
 s_waitcnt lgkmcnt(6)
M a[28:31], a[92:95], a[164:167], a[28:31]
 buffer_load_dwordx4 v14, s[48:51], s22 offen offset:2048   lds
M a[28:31], a[88:91], a[160:163], a[28:31]
M v[32:35], a[32:35], a[168:171], v[32:35]
 ds_read_b128 a[160:163], v5 offset:4096
 ds_read_b128 a[164:167], v6 offset:4096
M v[32:35], a[36:39], a[172:175], v[32:35]
 ds_read_b64_tr_b16 a[108:109], v2 offset:40960
 ds_read_b64_tr_b16 a[110:111], v2 offset:41984
M v[36:39], a[44:47], a[172:175], v[36:39]
 buffer_load_dwordx4 v15, s[48:51], s22 offen offset:3072   lds
M v[36:39], a[40:43], a[168:171], v[36:39]
 s_sub_u32 s22, s22, 2097024
M v[40:43], a[48:51], a[168:171], v[40:43]
M v[40:43], a[52:55], a[172:175], v[40:43]
 ds_read_b64_tr_b16 a[112:113], v3 offset:32768
 ds_read_b64_tr_b16 a[114:115], v3 offset:33792
M v[44:47], a[60:63], a[172:175], v[44:47]
 s_add_u32 m0, s23, 16384
M v[44:47], a[56:59], a[168:171], v[44:47]
 buffer_load_dwordx4 v8, s[16:19], s21 offen offset:0  nt lds
M v[48:51], a[64:67], a[168:171], v[48:51]
M v[48:51], a[68:71], a[172:175], v[48:51]
M v[52:55], a[76:79], a[172:175], v[52:55]
 ds_read_b64_tr_b16 a[116:117], v3 offset:40960
 ds_read_b64_tr_b16 a[118:119], v3 offset:41984
M v[52:55], a[72:75], a[168:171], v[52:55]
M v[56:59], a[80:83], a[168:171], v[56:59]
 buffer_load_dwordx4 v9, s[16:19], s21 offen offset:1024  nt lds
M v[56:59], a[84:87], a[172:175], v[56:59]
 s_waitcnt lgkmcnt(6)
M v[60:63], a[92:95], a[172:175], v[60:63]
M v[60:63], a[88:91], a[168:171], v[60:63]
 ds_read_b64_tr_b16 a[120:121], v4 offset:32768
 ds_read_b64_tr_b16 a[122:123], v4 offset:33792
M v[64:67], a[32:35], a[160:163], v[64:67]
 ds_read_b128 a[168:171], v5 offset:6144
 ds_read_b128 a[172:175], v6 offset:6144
M v[64:67], a[36:39], a[164:167], v[64:67]
 buffer_load_dwordx4 v10, s[16:19], s21 offen offset:2048  nt lds
M v[68:71], a[44:47], a[164:167], v[68:71]
M v[68:71], a[40:43], a[160:163], v[68:71]
M v[72:75], a[48:51], a[160:163], v[72:75]
 ds_read_b64_tr_b16 a[124:125], v4 offset:40960
 ds_read_b64_tr_b16 a[126:127], v4 offset:41984
M v[72:75], a[52:55], a[164:167], v[72:75]
M v[76:79], a[60:63], a[164:167], v[76:79]
 buffer_load_dwordx4 v11, s[16:19], s21 offen offset:3072  nt lds
M v[76:79], a[56:59], a[160:163], v[76:79]
 s_add_u32 s21, s21, 524160
M v[80:83], a[64:67], a[160:163], v[80:83]
M v[80:83], a[68:71], a[164:167], v[80:83]
M v[84:87], a[76:79], a[164:167], v[84:87]
M v[84:87], a[72:75], a[160:163], v[84:87]
M v[88:91], a[80:83], a[160:163], v[88:91]
M v[88:91], a[84:87], a[164:167], v[88:91]
 s_waitcnt lgkmcnt(2)
M v[92:95], a[92:95], a[164:167], v[92:95]
 s_waitcnt vmcnt(17) lgkmcnt(0)
M v[92:95], a[88:91], a[160:163], v[92:95]
 s_barrier
M v[96:99], a[32:35], a[168:171], v[96:99]
 ds_read_b128 a[160:163], v5 offset:16384
 ds_read_b128 a[164:167], v6 offset:16384
M v[96:99], a[36:39], a[172:175], v[96:99]
M v[100:103], a[44:47], a[172:175], v[100:103]
 s_add_u32 m0, s24, 0
 ds_read_b64_tr_b16 a[128:129], v1 offset:49152
 ds_read_b64_tr_b16 a[130:131], v1 offset:50176
M v[100:103], a[40:43], a[168:171], v[100:103]
 buffer_load_dwordx4 v12, s[48:51], s22 offen offset:0   lds
M v[104:107], a[48:51], a[168:171], v[104:107]
M v[104:107], a[52:55], a[172:175], v[104:107]
M v[108:111], a[60:63], a[172:175], v[108:111]
M v[108:111], a[56:59], a[168:171], v[108:111]
M v[112:115], a[64:67], a[168:171], v[112:115]
M v[112:115], a[68:71], a[172:175], v[112:115]
 ds_read_b64_tr_b16 a[132:133], v1 offset:57344
 ds_read_b64_tr_b16 a[134:135], v1 offset:58368
M v[116:119], a[76:79], a[172:175], v[116:119]
 buffer_load_dwordx4 v13, s[48:51], s22 offen offset:1024   lds
M v[116:119], a[72:75], a[168:171], v[116:119]
M v[120:123], a[80:83], a[168:171], v[120:123]
M v[120:123], a[84:87], a[172:175], v[120:123]
 s_waitcnt lgkmcnt(4)
M v[124:127], a[92:95], a[172:175], v[124:127]
M v[124:127], a[88:91], a[168:171], v[124:127]
M v[128:131], a[32:35], a[160:163], v[128:131]
 ds_read_b128 a[168:171], v5 offset:18432
 ds_read_b128 a[172:175], v6 offset:18432
M v[128:131], a[36:39], a[164:167], v[128:131]
 ds_read_b64_tr_b16 a[136:137], v2 offset:49152
 ds_read_b64_tr_b16 a[138:139], v2 offset:50176
M v[132:135], a[44:47], a[164:167], v[132:135]
 buffer_load_dwordx4 v14, s[48:51], s22 offen offset:2048   lds
M v[132:135], a[40:43], a[160:163], v[132:135]
M v[136:139], a[48:51], a[160:163], v[136:139]
M v[136:139], a[52:55], a[164:167], v[136:139]
M v[140:143], a[60:63], a[164:167], v[140:143]
M v[140:143], a[56:59], a[160:163], v[140:143]
 ds_read_b64_tr_b16 a[140:141], v2 offset:57344
 ds_read_b64_tr_b16 a[142:143], v2 offset:58368
M v[144:147], a[64:67], a[160:163], v[144:147]
 buffer_load_dwordx4 v15, s[48:51], s22 offen offset:3072   lds
M v[144:147], a[68:71], a[164:167], v[144:147]
 s_add_u32 s22, s22, 2097152
M v[148:151], a[76:79], a[164:167], v[148:151]
M v[148:151], a[72:75], a[160:163], v[148:151]
M v[152:155], a[80:83], a[160:163], v[152:155]
M v[152:155], a[84:87], a[164:167], v[152:155]
 s_waitcnt lgkmcnt(4)
M v[156:159], a[92:95], a[164:167], v[156:159]
 s_add_u32 m0, s23, 32768
 ds_read_b64_tr_b16 a[144:145], v3 offset:49152
 ds_read_b64_tr_b16 a[146:147], v3 offset:50176
M v[156:159], a[88:91], a[160:163], v[156:159]
 buffer_load_dwordx4 v8, s[16:19], s21 offen offset:0  nt lds
M v[160:163], a[32:35], a[168:171], v[160:163]
 ds_read_b128 a[160:163], v5 offset:20480
 ds_read_b128 a[164:167], v6 offset:20480
M v[160:163], a[36:39], a[172:175], v[160:163]
M v[164:167], a[44:47], a[172:175], v[164:167]
M v[164:167], a[40:43], a[168:171], v[164:167]
M v[168:171], a[48:51], a[168:171], v[168:171]
M v[168:171], a[52:55], a[172:175], v[168:171]
 ds_read_b64_tr_b16 a[148:149], v3 offset:57344
 ds_read_b64_tr_b16 a[150:151], v3 offset:58368
M v[172:175], a[60:63], a[172:175], v[172:175]
 buffer_load_dwordx4 v9, s[16:19], s21 offen offset:1024  nt lds
M v[172:175], a[56:59], a[168:171], v[172:175]
M v[176:179], a[64:67], a[168:171], v[176:179]
M v[176:179], a[68:71], a[172:175], v[176:179]
M v[180:183], a[76:79], a[172:175], v[180:183]
M v[180:183], a[72:75], a[168:171], v[180:183]
M v[184:187], a[80:83], a[168:171], v[184:187]
 ds_read_b64_tr_b16 a[152:153], v4 offset:49152
 ds_read_b64_tr_b16 a[154:155], v4 offset:50176
M v[184:187], a[84:87], a[172:175], v[184:187]
 s_waitcnt lgkmcnt(4)
M v[188:191], a[92:95], a[172:175], v[188:191]
 buffer_load_dwordx4 v10, s[16:19], s21 offen offset:2048  nt lds
M v[188:191], a[88:91], a[168:171], v[188:191]
M v[192:195], a[32:35], a[160:163], v[192:195]
 ds_read_b128 a[168:171], v5 offset:22528
 ds_read_b128 a[172:175], v6 offset:22528
M v[192:195], a[36:39], a[164:167], v[192:195]
M v[196:199], a[44:47], a[164:167], v[196:199]
M v[196:199], a[40:43], a[160:163], v[196:199]
 ds_read_b64_tr_b16 a[156:157], v4 offset:57344
 ds_read_b64_tr_b16 a[158:159], v4 offset:58368
M v[200:203], a[48:51], a[160:163], v[200:203]
 buffer_load_dwordx4 v11, s[16:19], s21 offen offset:3072  nt lds
M v[200:203], a[52:55], a[164:167], v[200:203]
 s_add_u32 s21, s21, 128
M v[204:207], a[60:63], a[164:167], v[204:207]
M v[204:207], a[56:59], a[160:163], v[204:207]
M v[208:211], a[64:67], a[160:163], v[208:211]
M v[208:211], a[68:71], a[164:167], v[208:211]
M v[212:215], a[76:79], a[164:167], v[212:215]
M v[212:215], a[72:75], a[160:163], v[212:215]
M v[216:219], a[80:83], a[160:163], v[216:219]
M v[216:219], a[84:87], a[164:167], v[216:219]
 s_waitcnt lgkmcnt(2)
M v[220:223], a[92:95], a[164:167], v[220:223]
 s_waitcnt vmcnt(17) lgkmcnt(0)
M v[220:223], a[88:91], a[160:163], v[220:223]
 s_barrier
M v[224:227], a[32:35], a[168:171], v[224:227]
 ds_read_b128 a[160:163], v5 offset:32768
 ds_read_b128 a[164:167], v6 offset:32768
M v[224:227], a[36:39], a[172:175], v[224:227]
 buffer_load_dword a240, v23, s[52:55], 0 offen offset:0
M v[228:231], a[44:47], a[172:175], v[228:231]
 v_add_u32 v23, 32768, v23
M v[228:231], a[40:43], a[168:171], v[228:231]
M v[232:235], a[48:51], a[168:171], v[232:235]
M v[232:235], a[52:55], a[172:175], v[232:235]
M v[236:239], a[60:63], a[172:175], v[236:239]
M v[236:239], a[56:59], a[168:171], v[236:239]
M v[240:243], a[64:67], a[168:171], v[240:243]
M v[240:243], a[68:71], a[172:175], v[240:243]
M v[244:247], a[76:79], a[172:175], v[244:247]
M v[244:247], a[72:75], a[168:171], v[244:247]
M v[248:251], a[80:83], a[168:171], v[248:251]
M v[248:251], a[84:87], a[172:175], v[248:251]
 s_waitcnt lgkmcnt(0)
M v[252:255], a[92:95], a[172:175], v[252:255]
M v[252:255], a[88:91], a[168:171], v[252:255]
M a[0:3], a[96:99], a[160:163], a[0:3]
 ds_read_b128 a[168:171], v5 offset:34816
 ds_read_b128 a[172:175], v6 offset:34816
M a[0:3], a[100:103], a[164:167], a[0:3]
 ds_read_b64_tr_b16 a[32:33], v1 offset:0
 ds_read_b64_tr_b16 a[34:35], v1 offset:1024
M a[4:7], a[108:111], a[164:167], a[4:7]
 s_add_u32 m0, s24, 16384
M a[4:7], a[104:107], a[160:163], a[4:7]
 buffer_load_dwordx4 v12, s[48:51], s22 offen offset:0   lds
M a[8:11], a[112:115], a[160:163], a[8:11]
M a[8:11], a[116:119], a[164:167], a[8:11]
M a[12:15], a[124:127], a[164:167], a[12:15]
 ds_read_b64_tr_b16 a[36:37], v1 offset:8192
 ds_read_b64_tr_b16 a[38:39], v1 offset:9216
M a[12:15], a[120:123], a[160:163], a[12:15]
M a[16:19], a[128:131], a[160:163], a[16:19]
 buffer_load_dwordx4 v13, s[48:51], s22 offen offset:1024   lds
M a[16:19], a[132:135], a[164:167], a[16:19]
M a[20:23], a[140:143], a[164:167], a[20:23]
M a[20:23], a[136:139], a[160:163], a[20:23]
 ds_read_b64_tr_b16 a[40:41], v2 offset:0
 ds_read_b64_tr_b16 a[42:43], v2 offset:1024
M a[24:27], a[144:147], a[160:163], a[24:27]
M a[24:27], a[148:151], a[164:167], a[24:27]
 s_waitcnt lgkmcnt(6)
M a[28:31], a[156:159], a[164:167], a[28:31]
 buffer_load_dwordx4 v14, s[48:51], s22 offen offset:2048   lds
M a[28:31], a[152:155], a[160:163], a[28:31]
M v[32:35], a[96:99], a[168:171], v[32:35]
 ds_read_b128 a[160:163], v5 offset:36864
 ds_read_b128 a[164:167], v6 offset:36864
M v[32:35], a[100:103], a[172:175], v[32:35]
 ds_read_b64_tr_b16 a[44:45], v2 offset:8192
 ds_read_b64_tr_b16 a[46:47], v2 offset:9216
M v[36:39], a[108:111], a[172:175], v[36:39]
 buffer_load_dwordx4 v15, s[48:51], s22 offen offset:3072   lds
M v[36:39], a[104:107], a[168:171], v[36:39]
 s_sub_u32 s22, s22, 2097024
M v[40:43], a[112:115], a[168:171], v[40:43]
M v[40:43], a[116:119], a[172:175], v[40:43]
 ds_read_b64_tr_b16 a[48:49], v3 offset:0
 ds_read_b64_tr_b16 a[50:51], v3 offset:1024
M v[44:47], a[124:127], a[172:175], v[44:47]
 s_add_u32 m0, s23, 49152
M v[44:47], a[120:123], a[168:171], v[44:47]
 buffer_load_dwordx4 v8, s[16:19], s21 offen offset:0  nt lds
M v[48:51], a[128:131], a[168:171], v[48:51]
M v[48:51], a[132:135], a[172:175], v[48:51]
M v[52:55], a[140:143], a[172:175], v[52:55]
 ds_read_b64_tr_b16 a[52:53], v3 offset:8192
 ds_read_b64_tr_b16 a[54:55], v3 offset:9216
M v[52:55], a[136:139], a[168:171], v[52:55]
M v[56:59], a[144:147], a[168:171], v[56:59]
 buffer_load_dwordx4 v9, s[16:19], s21 offen offset:1024  nt lds
M v[56:59], a[148:151], a[172:175], v[56:59]
 s_waitcnt lgkmcnt(6)
M v[60:63], a[156:159], a[172:175], v[60:63]
M v[60:63], a[152:155], a[168:171], v[60:63]
 ds_read_b64_tr_b16 a[56:57], v4 offset:0
 ds_read_b64_tr_b16 a[58:59], v4 offset:1024
M v[64:67], a[96:99], a[160:163], v[64:67]
 ds_read_b128 a[168:171], v5 offset:38912
 ds_read_b128 a[172:175], v6 offset:38912
M v[64:67], a[100:103], a[164:167], v[64:67]
 buffer_load_dwordx4 v10, s[16:19], s21 offen offset:2048  nt lds
M v[68:71], a[108:111], a[164:167], v[68:71]
M v[68:71], a[104:107], a[160:163], v[68:71]
M v[72:75], a[112:115], a[160:163], v[72:75]
 ds_read_b64_tr_b16 a[60:61], v4 offset:8192
 ds_read_b64_tr_b16 a[62:63], v4 offset:9216
M v[72:75], a[116:119], a[164:167], v[72:75]
M v[76:79], a[124:127], a[164:167], v[76:79]
 buffer_load_dwordx4 v11, s[16:19], s21 offen offset:3072  nt lds
M v[76:79], a[120:123], a[160:163], v[76:79]
 s_add_u32 s21, s21, 524160
M v[80:83], a[128:131], a[160:163], v[80:83]
M v[80:83], a[132:135], a[164:167], v[80:83]
M v[84:87], a[140:143], a[164:167], v[84:87]
M v[84:87], a[136:139], a[160:163], v[84:87]
M v[88:91], a[144:147], a[160:163], v[88:91]
M v[88:91], a[148:151], a[164:167], v[88:91]
 s_waitcnt lgkmcnt(2)
M v[92:95], a[156:159], a[164:167], v[92:95]
 s_waitcnt vmcnt(17) lgkmcnt(0)
M v[92:95], a[152:155], a[160:163], v[92:95]
 s_barrier
M v[96:99], a[96:99], a[168:171], v[96:99]
 ds_read_b128 a[160:163], v5 offset:49152
 ds_read_b128 a[164:167], v6 offset:49152
M v[96:99], a[100:103], a[172:175], v[96:99]
M v[100:103], a[108:111], a[172:175], v[100:103]
 s_add_u32 m0, s24, 32768
 ds_read_b64_tr_b16 a[64:65], v1 offset:16384
 ds_read_b64_tr_b16 a[66:67], v1 offset:17408
M v[100:103], a[104:107], a[168:171], v[100:103]
 buffer_load_dwordx4 v12, s[48:51], s22 offen offset:0   lds
M v[104:107], a[112:115], a[168:171], v[104:107]
M v[104:107], a[116:119], a[172:175], v[104:107]
M v[108:111], a[124:127], a[172:175], v[108:111]
M v[108:111], a[120:123], a[168:171], v[108:111]
M v[112:115], a[128:131], a[168:171], v[112:115]
M v[112:115], a[132:135], a[172:175], v[112:115]
 ds_read_b64_tr_b16 a[68:69], v1 offset:24576
 ds_read_b64_tr_b16 a[70:71], v1 offset:25600
M v[116:119], a[140:143], a[172:175], v[116:119]
 buffer_load_dwordx4 v13, s[48:51], s22 offen offset:1024   lds
M v[116:119], a[136:139], a[168:171], v[116:119]
M v[120:123], a[144:147], a[168:171], v[120:123]
M v[120:123], a[148:151], a[172:175], v[120:123]
 s_waitcnt lgkmcnt(4)
M v[124:127], a[156:159], a[172:175], v[124:127]
M v[124:127], a[152:155], a[168:171], v[124:127]
M v[128:131], a[96:99], a[160:163], v[128:131]
 ds_read_b128 a[168:171], v5 offset:51200
 ds_read_b128 a[172:175], v6 offset:51200
M v[128:131], a[100:103], a[164:167], v[128:131]
 ds_read_b64_tr_b16 a[72:73], v2 offset:16384
 ds_read_b64_tr_b16 a[74:75], v2 offset:17408
M v[132:135], a[108:111], a[164:167], v[132:135]
 buffer_load_dwordx4 v14, s[48:51], s22 offen offset:2048   lds
M v[132:135], a[104:107], a[160:163], v[132:135]
M v[136:139], a[112:115], a[160:163], v[136:139]
M v[136:139], a[116:119], a[164:167], v[136:139]
M v[140:143], a[124:127], a[164:167], v[140:143]
M v[140:143], a[120:123], a[160:163], v[140:143]
 ds_read_b64_tr_b16 a[76:77], v2 offset:24576
 ds_read_b64_tr_b16 a[78:79], v2 offset:25600
M v[144:147], a[128:131], a[160:163], v[144:147]
 buffer_load_dwordx4 v15, s[48:51], s22 offen offset:3072   lds
M v[144:147], a[132:135], a[164:167], v[144:147]
 s_add_u32 s22, s22, 2097152
M v[148:151], a[140:143], a[164:167], v[148:151]
M v[148:151], a[136:139], a[160:163], v[148:151]
M v[152:155], a[144:147], a[160:163], v[152:155]
M v[152:155], a[148:151], a[164:167], v[152:155]
 s_waitcnt lgkmcnt(4)
M v[156:159], a[156:159], a[164:167], v[156:159]
 s_add_u32 m0, s23, 0
 ds_read_b64_tr_b16 a[80:81], v3 offset:16384
 ds_read_b64_tr_b16 a[82:83], v3 offset:17408
M v[156:159], a[152:155], a[160:163], v[156:159]
 buffer_load_dwordx4 v8, s[16:19], s21 offen offset:0  nt lds
M v[160:163], a[96:99], a[168:171], v[160:163]
 ds_read_b128 a[160:163], v5 offset:53248
 ds_read_b128 a[164:167], v6 offset:53248
M v[160:163], a[100:103], a[172:175], v[160:163]
M v[164:167], a[108:111], a[172:175], v[164:167]
M v[164:167], a[104:107], a[168:171], v[164:167]
M v[168:171], a[112:115], a[168:171], v[168:171]
M v[168:171], a[116:119], a[172:175], v[168:171]
 ds_read_b64_tr_b16 a[84:85], v3 offset:24576
 ds_read_b64_tr_b16 a[86:87], v3 offset:25600
M v[172:175], a[124:127], a[172:175], v[172:175]
 buffer_load_dwordx4 v9, s[16:19], s21 offen offset:1024  nt lds
M v[172:175], a[120:123], a[168:171], v[172:175]
M v[176:179], a[128:131], a[168:171], v[176:179]
M v[176:179], a[132:135], a[172:175], v[176:179]
M v[180:183], a[140:143], a[172:175], v[180:183]
M v[180:183], a[136:139], a[168:171], v[180:183]
M v[184:187], a[144:147], a[168:171], v[184:187]
 ds_read_b64_tr_b16 a[88:89], v4 offset:16384
 ds_read_b64_tr_b16 a[90:91], v4 offset:17408
M v[184:187], a[148:151], a[172:175], v[184:187]
 s_waitcnt lgkmcnt(4)
M v[188:191], a[156:159], a[172:175], v[188:191]
 buffer_load_dwordx4 v10, s[16:19], s21 offen offset:2048  nt lds
M v[188:191], a[152:155], a[168:171], v[188:191]
M v[192:195], a[96:99], a[160:163], v[192:195]
 ds_read_b128 a[168:171], v5 offset:55296
 ds_read_b128 a[172:175], v6 offset:55296
M v[192:195], a[100:103], a[164:167], v[192:195]
M v[196:199], a[108:111], a[164:167], v[196:199]
M v[196:199], a[104:107], a[160:163], v[196:199]
 ds_read_b64_tr_b16 a[92:93], v4 offset:24576
 ds_read_b64_tr_b16 a[94:95], v4 offset:25600
M v[200:203], a[112:115], a[160:163], v[200:203]
 buffer_load_dwordx4 v11, s[16:19], s21 offen offset:3072  nt lds
M v[200:203], a[116:119], a[164:167], v[200:203]
 s_add_u32 s21, s21, 128
M v[204:207], a[124:127], a[164:167], v[204:207]
M v[204:207], a[120:123], a[160:163], v[204:207]
M v[208:211], a[128:131], a[160:163], v[208:211]
M v[208:211], a[132:135], a[164:167], v[208:211]
M v[212:215], a[140:143], a[164:167], v[212:215]
M v[212:215], a[136:139], a[160:163], v[212:215]
M v[216:219], a[144:147], a[160:163], v[216:219]
M v[216:219], a[148:151], a[164:167], v[216:219]
 s_waitcnt lgkmcnt(2)
M v[220:223], a[156:159], a[164:167], v[220:223]
 s_waitcnt vmcnt(17) lgkmcnt(0)
M v[220:223], a[152:155], a[160:163], v[220:223]
 s_barrier
M v[224:227], a[96:99], a[168:171], v[224:227]
 ds_read_b128 a[160:163], v5 offset:0
 ds_read_b128 a[164:167], v6 offset:0
M v[224:227], a[100:103], a[172:175], v[224:227]
 buffer_load_dword a240, v23, s[52:55], 0 offen offset:0
M v[228:231], a[108:111], a[172:175], v[228:231]
 v_add_u32 v23, 16384, v23
M v[228:231], a[104:107], a[168:171], v[228:231]
M v[232:235], a[112:115], a[168:171], v[232:235]
M v[232:235], a[116:119], a[172:175], v[232:235]
M v[236:239], a[124:127], a[172:175], v[236:239]
M v[236:239], a[120:123], a[168:171], v[236:239]
M v[240:243], a[128:131], a[168:171], v[240:243]
M v[240:243], a[132:135], a[172:175], v[240:243]
M v[244:247], a[140:143], a[172:175], v[244:247]
M v[244:247], a[136:139], a[168:171], v[244:247]
M v[248:251], a[144:147], a[168:171], v[248:251]
M v[248:251], a[148:151], a[172:175], v[248:251]
 s_waitcnt lgkmcnt(0)
M v[252:255], a[156:159], a[172:175], v[252:255]
M v[252:255], a[152:155], a[168:171], v[252:255]
M a[0:3], a[32:35], a[160:163], a[0:3]
 ds_read_b128 a[168:171], v5 offset:2048
 ds_read_b128 a[172:175], v6 offset:2048
M a[0:3], a[36:39], a[164:167], a[0:3]
 ds_read_b64_tr_b16 a[96:97], v1 offset:32768
 ds_read_b64_tr_b16 a[98:99], v1 offset:33792
M a[4:7], a[44:47], a[164:167], a[4:7]
 s_add_u32 m0, s24, 49152
 v_accvgpr_read_b32 v27, a241
M a[4:7], a[40:43], a[160:163], a[4:7]
 buffer_load_dwordx4 v12, s[48:51], s22 offen offset:0   lds
M a[8:11], a[48:51], a[160:163], a[8:11]
M a[8:11], a[52:55], a[164:167], a[8:11]
M a[12:15], a[60:63], a[164:167], a[12:15]
 ds_read_b64_tr_b16 a[100:101], v1 offset:40960
 ds_read_b64_tr_b16 a[102:103], v1 offset:41984
M a[12:15], a[56:59], a[160:163], a[12:15]
M a[16:19], a[64:67], a[160:163], a[16:19]
 buffer_load_dwordx4 v13, s[48:51], s22 offen offset:1024   lds
M a[16:19], a[68:71], a[164:167], a[16:19]
M a[20:23], a[76:79], a[164:167], a[20:23]
M a[20:23], a[72:75], a[160:163], a[20:23]
 ds_read_b64_tr_b16 a[104:105], v2 offset:32768
 ds_read_b64_tr_b16 a[106:107], v2 offset:33792
M a[24:27], a[80:83], a[160:163], a[24:27]
M a[24:27], a[84:87], a[164:167], a[24:27]
 s_waitcnt lgkmcnt(6)
M a[28:31], a[92:95], a[164:167], a[28:31]
 buffer_load_dwordx4 v14, s[48:51], s22 offen offset:2048   lds
M a[28:31], a[88:91], a[160:163], a[28:31]
M v[32:35], a[32:35], a[168:171], v[32:35]
 ds_read_b128 a[160:163], v5 offset:4096
 ds_read_b128 a[164:167], v6 offset:4096
M v[32:35], a[36:39], a[172:175], v[32:35]
 ds_read_b64_tr_b16 a[108:109], v2 offset:40960
 ds_read_b64_tr_b16 a[110:111], v2 offset:41984
M v[36:39], a[44:47], a[172:175], v[36:39]
 buffer_load_dwordx4 v15, s[48:51], s22 offen offset:3072   lds
M v[36:39], a[40:43], a[168:171], v[36:39]
 s_sub_u32 s22, s22, 2097024
M v[40:43], a[48:51], a[168:171], v[40:43]
M v[40:43], a[52:55], a[172:175], v[40:43]
 ds_read_b64_tr_b16 a[112:113], v3 offset:32768
 ds_read_b64_tr_b16 a[114:115], v3 offset:33792
M v[44:47], a[60:63], a[172:175], v[44:47]
 s_add_u32 m0, s23, 16384
M v[44:47], a[56:59], a[168:171], v[44:47]
 buffer_load_dwordx4 v8, s[16:19], s21 offen offset:0  nt lds
M v[48:51], a[64:67], a[168:171], v[48:51]
M v[48:51], a[68:71], a[172:175], v[48:51]
M v[52:55], a[76:79], a[172:175], v[52:55]
 ds_read_b64_tr_b16 a[116:117], v3 offset:40960
 ds_read_b64_tr_b16 a[118:119], v3 offset:41984
M v[52:55], a[72:75], a[168:171], v[52:55]
M v[56:59], a[80:83], a[168:171], v[56:59]
 buffer_load_dwordx4 v9, s[16:19], s21 offen offset:1024  nt lds
M v[56:59], a[84:87], a[172:175], v[56:59]
 s_waitcnt lgkmcnt(6)
M v[60:63], a[92:95], a[172:175], v[60:63]
M v[60:63], a[88:91], a[168:171], v[60:63]
 ds_read_b64_tr_b16 a[120:121], v4 offset:32768
 ds_read_b64_tr_b16 a[122:123], v4 offset:33792
M v[64:67], a[32:35], a[160:163], v[64:67]
 ds_read_b128 a[168:171], v5 offset:6144
 ds_read_b128 a[172:175], v6 offset:6144
M v[64:67], a[36:39], a[164:167], v[64:67]
 buffer_load_dwordx4 v10, s[16:19], s21 offen offset:2048  nt lds
M v[68:71], a[44:47], a[164:167], v[68:71]
M v[68:71], a[40:43], a[160:163], v[68:71]
M v[72:75], a[48:51], a[160:163], v[72:75]
 ds_read_b64_tr_b16 a[124:125], v4 offset:40960
 ds_read_b64_tr_b16 a[126:127], v4 offset:41984
M v[72:75], a[52:55], a[164:167], v[72:75]
 v_sub_f32 v48, v48, v27
 v_sub_f32 v49, v49, v27
M v[76:79], a[60:63], a[164:167], v[76:79]
 buffer_load_dwordx4 v11, s[16:19], s21 offen offset:3072  nt lds
M v[76:79], a[56:59], a[160:163], v[76:79]
 s_add_u32 s21, s21, 524160
 v_sub_f32 v50, v50, v27
 v_sub_f32 v51, v51, v27
M v[80:83], a[64:67], a[160:163], v[80:83]
 v_sub_f32 v52, v52, v27
 v_sub_f32 v53, v53, v27
M v[80:83], a[68:71], a[164:167], v[80:83]
 v_sub_f32 v54, v54, v27
 v_sub_f32 v55, v55, v27
M v[84:87], a[76:79], a[164:167], v[84:87]
 v_sub_f32 v56, v56, v27
 v_sub_f32 v57, v57, v27
M v[84:87], a[72:75], a[160:163], v[84:87]
 v_sub_f32 v58, v58, v27
 v_sub_f32 v59, v59, v27
M v[88:91], a[80:83], a[160:163], v[88:91]
 v_sub_f32 v60, v60, v27
 v_sub_f32 v61, v61, v27
M v[88:91], a[84:87], a[164:167], v[88:91]
 s_waitcnt lgkmcnt(2)
 v_sub_f32 v62, v62, v27
 v_sub_f32 v63, v63, v27
M v[92:95], a[92:95], a[164:167], v[92:95]
 s_waitcnt vmcnt(17) lgkmcnt(0)
M v[92:95], a[88:91], a[160:163], v[92:95]
 s_barrier
M v[96:99], a[32:35], a[168:171], v[96:99]
 ds_read_b128 a[160:163], v5 offset:16384
 ds_read_b128 a[164:167], v6 offset:16384
M v[96:99], a[36:39], a[172:175], v[96:99]
M v[100:103], a[44:47], a[172:175], v[100:103]
 s_add_u32 m0, s24, 0
 ds_read_b64_tr_b16 a[128:129], v1 offset:49152
 ds_read_b64_tr_b16 a[130:131], v1 offset:50176
M v[100:103], a[40:43], a[168:171], v[100:103]
 buffer_load_dwordx4 v12, s[48:51], s22 offen offset:0   lds
M v[104:107], a[48:51], a[168:171], v[104:107]
 v_sub_f32 v80, v80, v27
 v_sub_f32 v81, v81, v27
M v[104:107], a[52:55], a[172:175], v[104:107]
 v_sub_f32 v82, v82, v27
 v_sub_f32 v83, v83, v27
M v[108:111], a[60:63], a[172:175], v[108:111]
 v_sub_f32 v84, v84, v27
 v_sub_f32 v85, v85, v27
M v[108:111], a[56:59], a[168:171], v[108:111]
 v_sub_f32 v86, v86, v27
 v_sub_f32 v87, v87, v27
M v[112:115], a[64:67], a[168:171], v[112:115]
 v_sub_f32 v88, v88, v27
 v_sub_f32 v89, v89, v27
M v[112:115], a[68:71], a[172:175], v[112:115]
 ds_read_b64_tr_b16 a[132:133], v1 offset:57344
 ds_read_b64_tr_b16 a[134:135], v1 offset:58368
M v[116:119], a[76:79], a[172:175], v[116:119]
 buffer_load_dwordx4 v13, s[48:51], s22 offen offset:1024   lds
M v[116:119], a[72:75], a[168:171], v[116:119]
 v_sub_f32 v90, v90, v27
 v_sub_f32 v91, v91, v27
M v[120:123], a[80:83], a[168:171], v[120:123]
 v_sub_f32 v92, v92, v27
 v_sub_f32 v93, v93, v27
M v[120:123], a[84:87], a[172:175], v[120:123]
 s_waitcnt lgkmcnt(4)
 v_sub_f32 v94, v94, v27
 v_sub_f32 v95, v95, v27
M v[124:127], a[92:95], a[172:175], v[124:127]
M v[124:127], a[88:91], a[168:171], v[124:127]
M v[128:131], a[32:35], a[160:163], v[128:131]
 ds_read_b128 a[168:171], v5 offset:18432
 ds_read_b128 a[172:175], v6 offset:18432
M v[128:131], a[36:39], a[164:167], v[128:131]
 ds_read_b64_tr_b16 a[136:137], v2 offset:49152
 ds_read_b64_tr_b16 a[138:139], v2 offset:50176
M v[132:135], a[44:47], a[164:167], v[132:135]
 buffer_load_dwordx4 v14, s[48:51], s22 offen offset:2048   lds
M v[132:135], a[40:43], a[160:163], v[132:135]
M v[136:139], a[48:51], a[160:163], v[136:139]
 v_sub_f32 v112, v112, v27
 v_sub_f32 v113, v113, v27
M v[136:139], a[52:55], a[164:167], v[136:139]
 v_sub_f32 v114, v114, v27
 v_sub_f32 v115, v115, v27
M v[140:143], a[60:63], a[164:167], v[140:143]
 v_sub_f32 v116, v116, v27
 v_sub_f32 v117, v117, v27
M v[140:143], a[56:59], a[160:163], v[140:143]
 ds_read_b64_tr_b16 a[140:141], v2 offset:57344
 ds_read_b64_tr_b16 a[142:143], v2 offset:58368
M v[144:147], a[64:67], a[160:163], v[144:147]
 buffer_load_dwordx4 v15, s[48:51], s22 offen offset:3072   lds
M v[144:147], a[68:71], a[164:167], v[144:147]
 s_add_u32 s22, s22, 2097152
 v_sub_f32 v118, v118, v27
 v_sub_f32 v119, v119, v27
M v[148:151], a[76:79], a[164:167], v[148:151]
 v_sub_f32 v120, v120, v27
 v_sub_f32 v121, v121, v27
M v[148:151], a[72:75], a[160:163], v[148:151]
 v_sub_f32 v122, v122, v27
 v_sub_f32 v123, v123, v27
M v[152:155], a[80:83], a[160:163], v[152:155]
 v_sub_f32 v124, v124, v27
 v_sub_f32 v125, v125, v27
M v[152:155], a[84:87], a[164:167], v[152:155]
 s_waitcnt lgkmcnt(4)
 v_sub_f32 v126, v126, v27
 v_sub_f32 v127, v127, v27
M v[156:159], a[92:95], a[164:167], v[156:159]
 s_add_u32 m0, s23, 32768
 ds_read_b64_tr_b16 a[144:145], v3 offset:49152
 ds_read_b64_tr_b16 a[146:147], v3 offset:50176
M v[156:159], a[88:91], a[160:163], v[156:159]
 buffer_load_dwordx4 v8, s[16:19], s21 offen offset:0  nt lds
M v[160:163], a[32:35], a[168:171], v[160:163]
 ds_read_b128 a[160:163], v5 offset:20480
 ds_read_b128 a[164:167], v6 offset:20480
M v[160:163], a[36:39], a[172:175], v[160:163]
M v[164:167], a[44:47], a[172:175], v[164:167]
M v[164:167], a[40:43], a[168:171], v[164:167]
M v[168:171], a[48:51], a[168:171], v[168:171]
 v_sub_f32 v128, v128, v27
 v_sub_f32 v129, v129, v27
M v[168:171], a[52:55], a[172:175], v[168:171]
 ds_read_b64_tr_b16 a[148:149], v3 offset:57344
 ds_read_b64_tr_b16 a[150:151], v3 offset:58368
M v[172:175], a[60:63], a[172:175], v[172:175]
 buffer_load_dwordx4 v9, s[16:19], s21 offen offset:1024  nt lds
M v[172:175], a[56:59], a[168:171], v[172:175]
 v_sub_f32 v130, v130, v27
 v_sub_f32 v131, v131, v27
M v[176:179], a[64:67], a[168:171], v[176:179]
 v_sub_f32 v132, v132, v27
 v_sub_f32 v133, v133, v27
M v[176:179], a[68:71], a[172:175], v[176:179]
 v_sub_f32 v134, v134, v27
 v_sub_f32 v135, v135, v27
M v[180:183], a[76:79], a[172:175], v[180:183]
 v_sub_f32 v136, v136, v27
 v_sub_f32 v137, v137, v27
M v[180:183], a[72:75], a[168:171], v[180:183]
 v_sub_f32 v138, v138, v27
 v_sub_f32 v139, v139, v27
M v[184:187], a[80:83], a[168:171], v[184:187]
 ds_read_b64_tr_b16 a[152:153], v4 offset:49152
 ds_read_b64_tr_b16 a[154:155], v4 offset:50176
M v[184:187], a[84:87], a[172:175], v[184:187]
 s_waitcnt lgkmcnt(4)
 v_sub_f32 v140, v140, v27
 v_sub_f32 v141, v141, v27
M v[188:191], a[92:95], a[172:175], v[188:191]
 buffer_load_dwordx4 v10, s[16:19], s21 offen offset:2048  nt lds
M v[188:191], a[88:91], a[168:171], v[188:191]
 v_sub_f32 v142, v142, v27
 v_sub_f32 v143, v143, v27
M v[192:195], a[32:35], a[160:163], v[192:195]
 ds_read_b128 a[168:171], v5 offset:22528
 ds_read_b128 a[172:175], v6 offset:22528
M v[192:195], a[36:39], a[164:167], v[192:195]
 v_sub_f32 v144, v144, v27
 v_sub_f32 v145, v145, v27
M v[196:199], a[44:47], a[164:167], v[196:199]
 v_sub_f32 v146, v146, v27
 v_sub_f32 v147, v147, v27
M v[196:199], a[40:43], a[160:163], v[196:199]
 ds_read_b64_tr_b16 a[156:157], v4 offset:57344
 ds_read_b64_tr_b16 a[158:159], v4 offset:58368
M v[200:203], a[48:51], a[160:163], v[200:203]
 buffer_load_dwordx4 v11, s[16:19], s21 offen offset:3072  nt lds
M v[200:203], a[52:55], a[164:167], v[200:203]
 s_add_u32 s21, s21, 128
 v_sub_f32 v148, v148, v27
 v_sub_f32 v149, v149, v27
M v[204:207], a[60:63], a[164:167], v[204:207]
 v_sub_f32 v150, v150, v27
 v_sub_f32 v151, v151, v27
M v[204:207], a[56:59], a[160:163], v[204:207]
 v_sub_f32 v152, v152, v27
 v_sub_f32 v153, v153, v27
M v[208:211], a[64:67], a[160:163], v[208:211]
 v_sub_f32 v154, v154, v27
 v_sub_f32 v155, v155, v27
M v[208:211], a[68:71], a[164:167], v[208:211]
 v_sub_f32 v156, v156, v27
 v_sub_f32 v157, v157, v27
M v[212:215], a[76:79], a[164:167], v[212:215]
 v_sub_f32 v158, v158, v27
 v_sub_f32 v159, v159, v27
M v[212:215], a[72:75], a[160:163], v[212:215]
M v[216:219], a[80:83], a[160:163], v[216:219]
M v[216:219], a[84:87], a[164:167], v[216:219]
 s_waitcnt lgkmcnt(2)
M v[220:223], a[92:95], a[164:167], v[220:223]
 s_waitcnt vmcnt(17) lgkmcnt(0)
M v[220:223], a[88:91], a[160:163], v[220:223]
 s_barrier
M v[224:227], a[32:35], a[168:171], v[224:227]
 ds_read_b128 a[160:163], v5 offset:32768
 ds_read_b128 a[164:167], v6 offset:32768
M v[224:227], a[36:39], a[172:175], v[224:227]
 buffer_load_dword a240, v23, s[52:55], 0 offen offset:0
M v[228:231], a[44:47], a[172:175], v[228:231]
 v_add_u32 v23, 16384, v23
M v[228:231], a[40:43], a[168:171], v[228:231]
M v[232:235], a[48:51], a[168:171], v[232:235]
M v[232:235], a[52:55], a[172:175], v[232:235]
M v[236:239], a[60:63], a[172:175], v[236:239]
M v[236:239], a[56:59], a[168:171], v[236:239]
M v[240:243], a[64:67], a[168:171], v[240:243]
M v[240:243], a[68:71], a[172:175], v[240:243]
M v[244:247], a[76:79], a[172:175], v[244:247]
M v[244:247], a[72:75], a[168:171], v[244:247]
M v[248:251], a[80:83], a[168:171], v[248:251]
M v[248:251], a[84:87], a[172:175], v[248:251]
 s_waitcnt lgkmcnt(0)
M v[252:255], a[92:95], a[172:175], v[252:255]
M v[252:255], a[88:91], a[168:171], v[252:255]
M a[0:3], a[96:99], a[160:163], a[0:3]
 ds_read_b128 a[168:171], v5 offset:34816
 ds_read_b128 a[172:175], v6 offset:34816
M a[0:3], a[100:103], a[164:167], a[0:3]
 ds_read_b64_tr_b16 a[32:33], v1 offset:0
 ds_read_b64_tr_b16 a[34:35], v1 offset:1024
M a[4:7], a[108:111], a[164:167], a[4:7]
 s_add_u32 m0, s24, 16384
M a[4:7], a[104:107], a[160:163], a[4:7]
 buffer_load_dwordx4 v12, s[48:51], s22 offen offset:0   lds
M a[8:11], a[112:115], a[160:163], a[8:11]
M a[8:11], a[116:119], a[164:167], a[8:11]
M a[12:15], a[124:127], a[164:167], a[12:15]
 ds_read_b64_tr_b16 a[36:37], v1 offset:8192
 ds_read_b64_tr_b16 a[38:39], v1 offset:9216
M a[12:15], a[120:123], a[160:163], a[12:15]
M a[16:19], a[128:131], a[160:163], a[16:19]
 buffer_load_dwordx4 v13, s[48:51], s22 offen offset:1024   lds
M a[16:19], a[132:135], a[164:167], a[16:19]
M a[20:23], a[140:143], a[164:167], a[20:23]
M a[20:23], a[136:139], a[160:163], a[20:23]
 ds_read_b64_tr_b16 a[40:41], v2 offset:0
 ds_read_b64_tr_b16 a[42:43], v2 offset:1024
M a[24:27], a[144:147], a[160:163], a[24:27]
M a[24:27], a[148:151], a[164:167], a[24:27]
 s_waitcnt lgkmcnt(6)
M a[28:31], a[156:159], a[164:167], a[28:31]
 buffer_load_dwordx4 v14, s[48:51], s22 offen offset:2048   lds
M a[28:31], a[152:155], a[160:163], a[28:31]
M v[32:35], a[96:99], a[168:171], v[32:35]
 ds_read_b128 a[160:163], v5 offset:36864
 ds_read_b128 a[164:167], v6 offset:36864
M v[32:35], a[100:103], a[172:175], v[32:35]
 ds_read_b64_tr_b16 a[44:45], v2 offset:8192
 ds_read_b64_tr_b16 a[46:47], v2 offset:9216
M v[36:39], a[108:111], a[172:175], v[36:39]
 buffer_load_dwordx4 v15, s[48:51], s22 offen offset:3072   lds
M v[36:39], a[104:107], a[168:171], v[36:39]
 s_sub_u32 s22, s22, 2097024
M v[40:43], a[112:115], a[168:171], v[40:43]
M v[40:43], a[116:119], a[172:175], v[40:43]
 ds_read_b64_tr_b16 a[48:49], v3 offset:0
 ds_read_b64_tr_b16 a[50:51], v3 offset:1024
M v[44:47], a[124:127], a[172:175], v[44:47]
 s_add_u32 m0, s23, 49152
M v[44:47], a[120:123], a[168:171], v[44:47]
 buffer_load_dwordx4 v8, s[16:19], s21 offen offset:0  nt lds
M v[48:51], a[128:131], a[168:171], v[48:51]
M v[48:51], a[132:135], a[172:175], v[48:51]
M v[52:55], a[140:143], a[172:175], v[52:55]
 ds_read_b64_tr_b16 a[52:53], v3 offset:8192
 ds_read_b64_tr_b16 a[54:55], v3 offset:9216
M v[52:55], a[136:139], a[168:171], v[52:55]
M v[56:59], a[144:147], a[168:171], v[56:59]
 buffer_load_dwordx4 v9, s[16:19], s21 offen offset:1024  nt lds
M v[56:59], a[148:151], a[172:175], v[56:59]
 s_waitcnt lgkmcnt(6)
M v[60:63], a[156:159], a[172:175], v[60:63]
M v[60:63], a[152:155], a[168:171], v[60:63]
 ds_read_b64_tr_b16 a[56:57], v4 offset:0
 ds_read_b64_tr_b16 a[58:59], v4 offset:1024
M v[64:67], a[96:99], a[160:163], v[64:67]
 ds_read_b128 a[168:171], v5 offset:38912
 ds_read_b128 a[172:175], v6 offset:38912
M v[64:67], a[100:103], a[164:167], v[64:67]
 buffer_load_dwordx4 v10, s[16:19], s21 offen offset:2048  nt lds
M v[68:71], a[108:111], a[164:167], v[68:71]
M v[68:71], a[104:107], a[160:163], v[68:71]
M v[72:75], a[112:115], a[160:163], v[72:75]
 ds_read_b64_tr_b16 a[60:61], v4 offset:8192
 ds_read_b64_tr_b16 a[62:63], v4 offset:9216
M v[72:75], a[116:119], a[164:167], v[72:75]
M v[76:79], a[124:127], a[164:167], v[76:79]
 buffer_load_dwordx4 v11, s[16:19], s21 offen offset:3072  nt lds
M v[76:79], a[120:123], a[160:163], v[76:79]
 s_add_u32 s21, s21, 524160
M v[80:83], a[128:131], a[160:163], v[80:83]
M v[80:83], a[132:135], a[164:167], v[80:83]
M v[84:87], a[140:143], a[164:167], v[84:87]
M v[84:87], a[136:139], a[160:163], v[84:87]
M v[88:91], a[144:147], a[160:163], v[88:91]
M v[88:91], a[148:151], a[164:167], v[88:91]
 s_waitcnt lgkmcnt(2)
M v[92:95], a[156:159], a[164:167], v[92:95]
 s_waitcnt vmcnt(17) lgkmcnt(0)
M v[92:95], a[152:155], a[160:163], v[92:95]
 s_barrier
M v[96:99], a[96:99], a[168:171], v[96:99]
 ds_read_b128 a[160:163], v5 offset:49152
 ds_read_b128 a[164:167], v6 offset:49152
M v[96:99], a[100:103], a[172:175], v[96:99]
M v[100:103], a[108:111], a[172:175], v[100:103]
 s_add_u32 m0, s24, 32768
 ds_read_b64_tr_b16 a[64:65], v1 offset:16384
 ds_read_b64_tr_b16 a[66:67], v1 offset:17408
M v[100:103], a[104:107], a[168:171], v[100:103]
 buffer_load_dwordx4 v12, s[48:51], s22 offen offset:0   lds
M v[104:107], a[112:115], a[168:171], v[104:107]
M v[104:107], a[116:119], a[172:175], v[104:107]
M v[108:111], a[124:127], a[172:175], v[108:111]
M v[108:111], a[120:123], a[168:171], v[108:111]
M v[112:115], a[128:131], a[168:171], v[112:115]
M v[112:115], a[132:135], a[172:175], v[112:115]
 ds_read_b64_tr_b16 a[68:69], v1 offset:24576
 ds_read_b64_tr_b16 a[70:71], v1 offset:25600
M v[116:119], a[140:143], a[172:175], v[116:119]
 buffer_load_dwordx4 v13, s[48:51], s22 offen offset:1024   lds
M v[116:119], a[136:139], a[168:171], v[116:119]
M v[120:123], a[144:147], a[168:171], v[120:123]
M v[120:123], a[148:151], a[172:175], v[120:123]
 s_waitcnt lgkmcnt(4)
M v[124:127], a[156:159], a[172:175], v[124:127]
M v[124:127], a[152:155], a[168:171], v[124:127]
M v[128:131], a[96:99], a[160:163], v[128:131]
 ds_read_b128 a[168:171], v5 offset:51200
 ds_read_b128 a[172:175], v6 offset:51200
M v[128:131], a[100:103], a[164:167], v[128:131]
 ds_read_b64_tr_b16 a[72:73], v2 offset:16384
 ds_read_b64_tr_b16 a[74:75], v2 offset:17408
M v[132:135], a[108:111], a[164:167], v[132:135]
 buffer_load_dwordx4 v14, s[48:51], s22 offen offset:2048   lds
M v[132:135], a[104:107], a[160:163], v[132:135]
M v[136:139], a[112:115], a[160:163], v[136:139]
M v[136:139], a[116:119], a[164:167], v[136:139]
M v[140:143], a[124:127], a[164:167], v[140:143]
M v[140:143], a[120:123], a[160:163], v[140:143]
 ds_read_b64_tr_b16 a[76:77], v2 offset:24576
 ds_read_b64_tr_b16 a[78:79], v2 offset:25600
M v[144:147], a[128:131], a[160:163], v[144:147]
 buffer_load_dwordx4 v15, s[48:51], s22 offen offset:3072   lds
M v[144:147], a[132:135], a[164:167], v[144:147]
 s_add_u32 s22, s22, 2097152
M v[148:151], a[140:143], a[164:167], v[148:151]
M v[148:151], a[136:139], a[160:163], v[148:151]
M v[152:155], a[144:147], a[160:163], v[152:155]
M v[152:155], a[148:151], a[164:167], v[152:155]
 s_waitcnt lgkmcnt(4)
M v[156:159], a[156:159], a[164:167], v[156:159]
 s_add_u32 m0, s23, 0
 ds_read_b64_tr_b16 a[80:81], v3 offset:16384
 ds_read_b64_tr_b16 a[82:83], v3 offset:17408
M v[156:159], a[152:155], a[160:163], v[156:159]
 buffer_load_dwordx4 v8, s[52:55], s28 offen offset:0   lds
M v[160:163], a[96:99], a[168:171], v[160:163]
 ds_read_b128 a[160:163], v5 offset:53248
 ds_read_b128 a[164:167], v6 offset:53248
M v[160:163], a[100:103], a[172:175], v[160:163]
M v[164:167], a[108:111], a[172:175], v[164:167]
M v[164:167], a[104:107], a[168:171], v[164:167]
M v[168:171], a[112:115], a[168:171], v[168:171]
M v[168:171], a[116:119], a[172:175], v[168:171]
 ds_read_b64_tr_b16 a[84:85], v3 offset:24576
 ds_read_b64_tr_b16 a[86:87], v3 offset:25600
M v[172:175], a[124:127], a[172:175], v[172:175]
 buffer_load_dwordx4 v9, s[52:55], s28 offen offset:1024   lds
M v[172:175], a[120:123], a[168:171], v[172:175]
M v[176:179], a[128:131], a[168:171], v[176:179]
M v[176:179], a[132:135], a[172:175], v[176:179]
M v[180:183], a[140:143], a[172:175], v[180:183]
M v[180:183], a[136:139], a[168:171], v[180:183]
M v[184:187], a[144:147], a[168:171], v[184:187]
 ds_read_b64_tr_b16 a[88:89], v4 offset:16384
 ds_read_b64_tr_b16 a[90:91], v4 offset:17408
M v[184:187], a[148:151], a[172:175], v[184:187]
 s_waitcnt lgkmcnt(4)
M v[188:191], a[156:159], a[172:175], v[188:191]
 buffer_load_dwordx4 v10, s[52:55], s28 offen offset:2048   lds
M v[188:191], a[152:155], a[168:171], v[188:191]
M v[192:195], a[96:99], a[160:163], v[192:195]
 ds_read_b128 a[168:171], v5 offset:55296
 ds_read_b128 a[172:175], v6 offset:55296
M v[192:195], a[100:103], a[164:167], v[192:195]
M v[196:199], a[108:111], a[164:167], v[196:199]
M v[196:199], a[104:107], a[160:163], v[196:199]
 ds_read_b64_tr_b16 a[92:93], v4 offset:24576
 ds_read_b64_tr_b16 a[94:95], v4 offset:25600
M v[200:203], a[112:115], a[160:163], v[200:203]
 buffer_load_dwordx4 v11, s[52:55], s28 offen offset:3072   lds
M v[200:203], a[116:119], a[164:167], v[200:203]
 s_add_u32 s28, s28, 128
 v_sub_f32 v160, v160, v27
 v_sub_f32 v161, v161, v27
M v[204:207], a[124:127], a[164:167], v[204:207]
 v_sub_f32 v162, v162, v27
 v_sub_f32 v163, v163, v27
M v[204:207], a[120:123], a[160:163], v[204:207]
 v_sub_f32 v164, v164, v27
 v_sub_f32 v165, v165, v27
M v[208:211], a[128:131], a[160:163], v[208:211]
 v_sub_f32 v166, v166, v27
 v_sub_f32 v167, v167, v27
M v[208:211], a[132:135], a[164:167], v[208:211]
 v_sub_f32 v168, v168, v27
 v_sub_f32 v169, v169, v27
M v[212:215], a[140:143], a[164:167], v[212:215]
 v_sub_f32 v170, v170, v27
 v_sub_f32 v171, v171, v27
M v[212:215], a[136:139], a[160:163], v[212:215]
 v_sub_f32 v172, v172, v27
 v_sub_f32 v173, v173, v27
M v[216:219], a[144:147], a[160:163], v[216:219]
 v_sub_f32 v174, v174, v27
 v_sub_f32 v175, v175, v27
M v[216:219], a[148:151], a[164:167], v[216:219]
 s_waitcnt lgkmcnt(2)
 v_sub_f32 v176, v176, v27
 v_sub_f32 v177, v177, v27
M v[220:223], a[156:159], a[164:167], v[220:223]
 s_waitcnt vmcnt(17) lgkmcnt(0)
 v_sub_f32 v178, v178, v27
 v_sub_f32 v179, v179, v27
M v[220:223], a[152:155], a[160:163], v[220:223]
 s_barrier
M v[224:227], a[96:99], a[168:171], v[224:227]
 ds_read_b128 a[160:163], v5 offset:0
 ds_read_b128 a[164:167], v6 offset:0
M v[224:227], a[100:103], a[172:175], v[224:227]
 v_and_b32 v26, 48, v0
 v_lshlrev_b32 v26, 17, v26
M v[228:231], a[108:111], a[172:175], v[228:231]
 v_or_b32 v26, v26, v0
 v_lshl_add_u32 v26, v26, 7, s95
M v[228:231], a[104:107], a[168:171], v[228:231]
 buffer_load_dword a240, v26, s[76:79], 0 offen offset:0
M v[232:235], a[112:115], a[168:171], v[232:235]
 v_sub_f32 v180, v180, v27
 v_sub_f32 v181, v181, v27
M v[232:235], a[116:119], a[172:175], v[232:235]
 v_sub_f32 v182, v182, v27
 v_sub_f32 v183, v183, v27
M v[236:239], a[124:127], a[172:175], v[236:239]
 v_sub_f32 v184, v184, v27
 v_sub_f32 v185, v185, v27
M v[236:239], a[120:123], a[168:171], v[236:239]
 v_sub_f32 v186, v186, v27
 v_sub_f32 v187, v187, v27
M v[240:243], a[128:131], a[168:171], v[240:243]
 v_sub_f32 v188, v188, v27
 v_sub_f32 v189, v189, v27
M v[240:243], a[132:135], a[172:175], v[240:243]
 v_sub_f32 v190, v190, v27
 v_sub_f32 v191, v191, v27
M v[244:247], a[140:143], a[172:175], v[244:247]
 v_sub_f32 v192, v192, v27
 v_sub_f32 v193, v193, v27
M v[244:247], a[136:139], a[168:171], v[244:247]
 v_sub_f32 v194, v194, v27
 v_sub_f32 v195, v195, v27
M v[248:251], a[144:147], a[168:171], v[248:251]
 v_sub_f32 v196, v196, v27
 v_sub_f32 v197, v197, v27
M v[248:251], a[148:151], a[172:175], v[248:251]
 s_waitcnt lgkmcnt(0)
 v_sub_f32 v198, v198, v27
 v_sub_f32 v199, v199, v27
M v[252:255], a[156:159], a[172:175], v[252:255]
 v_sub_f32 v200, v200, v27
 v_sub_f32 v201, v201, v27
M v[252:255], a[152:155], a[168:171], v[252:255]
 v_sub_f32 v202, v202, v27
 v_sub_f32 v203, v203, v27
M a[0:3], a[32:35], a[160:163], a[0:3]
 ds_read_b128 a[168:171], v5 offset:2048
 ds_read_b128 a[172:175], v6 offset:2048
M a[0:3], a[36:39], a[164:167], a[0:3]
 ds_read_b64_tr_b16 a[96:97], v1 offset:32768
 ds_read_b64_tr_b16 a[98:99], v1 offset:33792
M a[4:7], a[44:47], a[164:167], a[4:7]
 s_add_u32 m0, s24, 49152
 v_lshrrev_b32 v28, 4, v0
 v_add_u32 v28, 0, v28
M a[4:7], a[40:43], a[160:163], a[4:7]
 buffer_load_dwordx4 v12, s[48:51], s22 offen offset:0   lds
M a[8:11], a[48:51], a[160:163], a[8:11]
 v_and_b32 v29, 7, v0
 v_xor_b32 v28, v28, v29
M a[8:11], a[52:55], a[164:167], a[8:11]
 v_lshlrev_b32 v28, 4, v28
 v_lshrrev_b32 v29, 3, v0
M a[12:15], a[60:63], a[164:167], a[12:15]
 ds_read_b64_tr_b16 a[100:101], v1 offset:40960
 ds_read_b64_tr_b16 a[102:103], v1 offset:41984
M a[12:15], a[56:59], a[160:163], a[12:15]
 buffer_load_dwordx4 v13, s[48:51], s22 offen offset:1024   lds
M a[16:19], a[64:67], a[160:163], a[16:19]
 v_mul_u32_u24 v29, 896, v29
 s_mul_i32 s64, s20, 28672
M a[16:19], a[68:71], a[164:167], a[16:19]
 buffer_load_dwordx4 v14, s[48:51], s22 offen offset:2048   lds
M a[20:23], a[76:79], a[164:167], a[20:23]
 s_add_u32 s64, s64, 0
 v_add3_u32 v16, v29, v28, s64
M a[20:23], a[72:75], a[160:163], a[20:23]
 ds_read_b64_tr_b16 a[104:105], v2 offset:32768
 ds_read_b64_tr_b16 a[106:107], v2 offset:33792
M a[24:27], a[80:83], a[160:163], a[24:27]
 v_add_u32 v18, 12288, v16
 v_lshrrev_b32 v28, 4, v0
M a[24:27], a[84:87], a[164:167], a[24:27]
 s_waitcnt lgkmcnt(6)
 v_add_u32 v28, 4, v28
 v_and_b32 v29, 7, v0
M a[28:31], a[92:95], a[164:167], a[28:31]
 buffer_load_dwordx4 v15, s[48:51], s22 offen offset:3072   lds
M a[28:31], a[88:91], a[160:163], a[28:31]
 s_sub_u32 s22, s22, 2097024
 v_xor_b32 v28, v28, v29
 v_lshlrev_b32 v28, 4, v28
M v[32:35], a[32:35], a[168:171], v[32:35]
 s_add_u32 m0, s23, 16384
 ds_read_b128 a[160:163], v5 offset:4096
 ds_read_b128 a[164:167], v6 offset:4096
M v[32:35], a[36:39], a[172:175], v[32:35]
 ds_read_b64_tr_b16 a[108:109], v2 offset:40960
 ds_read_b64_tr_b16 a[110:111], v2 offset:41984
M v[36:39], a[44:47], a[172:175], v[36:39]
 buffer_load_dwordx4 v8, s[52:55], s28 offen offset:0   lds
M v[36:39], a[40:43], a[168:171], v[36:39]
 v_lshrrev_b32 v29, 3, v0
 v_mul_u32_u24 v29, 896, v29
M v[40:43], a[48:51], a[168:171], v[40:43]
 buffer_load_dwordx4 v9, s[52:55], s28 offen offset:1024   lds
M v[40:43], a[52:55], a[172:175], v[40:43]
 ds_read_b64_tr_b16 a[112:113], v3 offset:32768
 ds_read_b64_tr_b16 a[114:115], v3 offset:33792
M v[44:47], a[60:63], a[172:175], v[44:47]
 s_mul_i32 s64, s20, 28672
 s_add_u32 s64, s64, 6144
M v[44:47], a[56:59], a[168:171], v[44:47]
 buffer_load_dwordx4 v10, s[52:55], s28 offen offset:2048   lds
M v[48:51], a[64:67], a[168:171], v[48:51]
 v_add3_u32 v17, v29, v28, s64
 v_add_u32 v19, 12288, v17
M v[48:51], a[68:71], a[172:175], v[48:51]
 v_add_u32 v20, 0x20000, v1
 v_add_u32 v21, 0x20000, v2
M v[52:55], a[76:79], a[172:175], v[52:55]
 ds_read_b64_tr_b16 a[116:117], v3 offset:40960
 ds_read_b64_tr_b16 a[118:119], v3 offset:41984
M v[52:55], a[72:75], a[168:171], v[52:55]
 buffer_load_dwordx4 v11, s[52:55], s28 offen offset:3072   lds
M v[56:59], a[80:83], a[168:171], v[56:59]
 s_add_u32 s28, s28, 1048448
 v_add_u32 v22, 0x20000, v3
 v_add_u32 v23, 0x20000, v4
M v[56:59], a[84:87], a[172:175], v[56:59]
 s_waitcnt lgkmcnt(6)
 v_sub_f32 v204, v204, v27
 v_sub_f32 v205, v205, v27
M v[60:63], a[92:95], a[172:175], v[60:63]
 s_add_u32 m0, s23, 131072
 v_sub_f32 v206, v206, v27
 v_sub_f32 v207, v207, v27
M v[60:63], a[88:91], a[168:171], v[60:63]
 ds_read_b64_tr_b16 a[120:121], v4 offset:32768
 ds_read_b64_tr_b16 a[122:123], v4 offset:33792
M v[64:67], a[32:35], a[160:163], v[64:67]
 ds_read_b128 a[168:171], v5 offset:6144
 ds_read_b128 a[172:175], v6 offset:6144
M v[64:67], a[36:39], a[164:167], v[64:67]
 buffer_load_dwordx4 v8, s[52:55], s28 offen offset:0   lds
M v[68:71], a[44:47], a[164:167], v[68:71]
 buffer_load_dwordx4 v9, s[52:55], s28 offen offset:1024   lds
M v[68:71], a[40:43], a[160:163], v[68:71]
 v_sub_f32 v208, v208, v27
 v_sub_f32 v209, v209, v27
M v[72:75], a[48:51], a[160:163], v[72:75]
 ds_read_b64_tr_b16 a[124:125], v4 offset:40960
 ds_read_b64_tr_b16 a[126:127], v4 offset:41984
M v[72:75], a[52:55], a[164:167], v[72:75]
 buffer_load_dwordx4 v10, s[52:55], s28 offen offset:2048   lds
M v[76:79], a[60:63], a[164:167], v[76:79]
 v_sub_f32 v210, v210, v27
 v_sub_f32 v211, v211, v27
M v[76:79], a[56:59], a[160:163], v[76:79]
 v_sub_f32 v212, v212, v27
 v_sub_f32 v213, v213, v27
M v[80:83], a[64:67], a[160:163], v[80:83]
 buffer_load_dwordx4 v11, s[52:55], s28 offen offset:3072   lds
M v[80:83], a[68:71], a[164:167], v[80:83]
 s_sub_u32 s28, s28, 524288
 v_sub_f32 v214, v214, v27
 v_sub_f32 v215, v215, v27
M v[84:87], a[76:79], a[164:167], v[84:87]
 v_sub_f32 v216, v216, v27
 v_sub_f32 v217, v217, v27
M v[84:87], a[72:75], a[160:163], v[84:87]
 v_sub_f32 v218, v218, v27
 v_sub_f32 v219, v219, v27
M v[88:91], a[80:83], a[160:163], v[88:91]
 v_sub_f32 v220, v220, v27
 v_sub_f32 v221, v221, v27
M v[88:91], a[84:87], a[164:167], v[88:91]
 s_waitcnt lgkmcnt(2)
 v_sub_f32 v222, v222, v27
 v_sub_f32 v223, v223, v27
M v[92:95], a[92:95], a[164:167], v[92:95]
 s_waitcnt vmcnt(21) lgkmcnt(0)
 v_sub_f32 v224, v224, v27
 v_sub_f32 v225, v225, v27
M v[92:95], a[88:91], a[160:163], v[92:95]
 s_barrier
M v[96:99], a[32:35], a[168:171], v[96:99]
 ds_read_b128 a[160:163], v5 offset:16384
 ds_read_b128 a[164:167], v6 offset:16384
M v[96:99], a[36:39], a[172:175], v[96:99]
 v_sub_f32 v226, v226, v27
 v_sub_f32 v227, v227, v27
M v[100:103], a[44:47], a[172:175], v[100:103]
 s_add_u32 m0, s24, 0
 ds_read_b64_tr_b16 a[128:129], v1 offset:49152
 ds_read_b64_tr_b16 a[130:131], v1 offset:50176
M v[100:103], a[40:43], a[168:171], v[100:103]
 buffer_load_dwordx4 v16, s[56:59], s29 offen offset:0   lds
M v[104:107], a[48:51], a[168:171], v[104:107]
 s_mul_i32 s72, s41, 4352
 v_sub_f32 v228, v228, v27
M v[104:107], a[52:55], a[172:175], v[104:107]
 s_add_u32 s46, s72, 104923136
 v_sub_f32 v229, v229, v27
 v_sub_f32 v230, v230, v27
M v[108:111], a[60:63], a[172:175], v[108:111]
 s_lshl_b32 s45, s42, 7
 s_add_u32 s45, s45, s46
 s_sub_u32 s66, 15, s42
M v[108:111], a[56:59], a[168:171], v[108:111]
 buffer_load_dwordx4 v17, s[56:59], s29 offen offset:1024   lds
M v[112:115], a[64:67], a[168:171], v[112:115]
 s_min_u32 s66, s66, s42
 v_sub_f32 v231, v231, v27
M v[112:115], a[68:71], a[172:175], v[112:115]
 s_lshl_b32 s47, s66, 7
 ds_read_b64_tr_b16 a[132:133], v1 offset:57344
 ds_read_b64_tr_b16 a[134:135], v1 offset:58368
M v[116:119], a[76:79], a[172:175], v[116:119]
 s_add_u32 s47, s47, s46
 v_sub_f32 v232, v232, v27
 v_sub_f32 v233, v233, v27
M v[116:119], a[72:75], a[168:171], v[116:119]
 s_add_u32 s47, s47, 2048
 s_lshl_b32 s65, s41, 3
 s_add_u32 s65, s65, s66
M v[120:123], a[80:83], a[168:171], v[120:123]
 buffer_load_dwordx4 v18, s[56:59], s29 offen offset:2048   lds
M v[120:123], a[84:87], a[172:175], v[120:123]
 s_waitcnt lgkmcnt(4)
 s_mul_i32 s34, s65, 73728
 v_sub_f32 v234, v234, v27
M v[124:127], a[92:95], a[172:175], v[124:127]
 s_add_u32 s34, s34, 50331648
 v_sub_f32 v235, v235, v27
 v_sub_f32 v236, v236, v27
M v[124:127], a[88:91], a[168:171], v[124:127]
 s_lshl_b32 s65, s42, 4
 v_sub_f32 v237, v237, v27
 v_sub_f32 v238, v238, v27
M v[128:131], a[32:35], a[160:163], v[128:131]
 s_add_u32 s65, s65, s41
 ds_read_b128 a[168:171], v5 offset:18432
 ds_read_b128 a[172:175], v6 offset:18432
M v[128:131], a[36:39], a[164:167], v[128:131]
 s_mul_i32 s33, s65, 114688
 ds_read_b64_tr_b16 a[136:137], v2 offset:49152
 ds_read_b64_tr_b16 a[138:139], v2 offset:50176
M v[132:135], a[44:47], a[164:167], v[132:135]
 buffer_load_dwordx4 v19, s[56:59], s29 offen offset:3072   lds
M v[132:135], a[40:43], a[160:163], v[132:135]
 s_add_u32 s29, s29, 128
 s_mul_i32 s65, s20, 28672
 v_sub_f32 v239, v239, v27
M v[136:139], a[48:51], a[160:163], v[136:139]
 s_add_u32 s33, s33, s65
 s_add_u32 s33, s33, 67108864
 s_sub_u32 s65, 15, s66
M v[136:139], a[52:55], a[164:167], v[136:139]
 s_add_u32 m0, s23, 32768
 s_lshl_b32 s65, s65, 16
 s_lshl_b32 s64, s41, 20
M v[140:143], a[60:63], a[164:167], v[140:143]
 buffer_load_dwordx4 v8, s[52:55], s28 offen offset:0   lds
M v[140:143], a[56:59], a[160:163], v[140:143]
 ds_read_b64_tr_b16 a[140:141], v2 offset:57344
 ds_read_b64_tr_b16 a[142:143], v2 offset:58368
M v[144:147], a[64:67], a[160:163], v[144:147]
 s_add_u32 s32, s64, s65
 v_sub_f32 v240, v240, v27
M v[144:147], a[68:71], a[164:167], v[144:147]
 s_lshl_b32 s65, s20, 14
 s_add_u32 s32, s32, s65
 s_add_u32 s32, s32, 33554432
M v[148:151], a[76:79], a[164:167], v[148:151]
 buffer_load_dwordx4 v9, s[52:55], s28 offen offset:1024   lds
M v[148:151], a[72:75], a[160:163], v[148:151]
 s_mov_b32 s31, 0x53800000
 v_sub_f32 v241, v241, v27
M v[152:155], a[80:83], a[160:163], v[152:155]
 s_mov_b32 s40, 1
 s_sub_u32 s64, s42, 10
 s_and_b32 s35, s64, 536870912
M v[152:155], a[84:87], a[164:167], v[152:155]
 s_waitcnt lgkmcnt(4)
 v_sub_f32 v242, v242, v27
 v_sub_f32 v243, v243, v27
M v[156:159], a[92:95], a[164:167], v[156:159]
 ds_read_b64_tr_b16 a[144:145], v3 offset:49152
 ds_read_b64_tr_b16 a[146:147], v3 offset:50176
M v[156:159], a[88:91], a[160:163], v[156:159]
 buffer_load_dwordx4 v10, s[52:55], s28 offen offset:2048   lds
M v[160:163], a[32:35], a[168:171], v[160:163]
 ds_read_b128 a[160:163], v5 offset:20480
 ds_read_b128 a[164:167], v6 offset:20480
M v[160:163], a[36:39], a[172:175], v[160:163]
 v_sub_f32 v244, v244, v27
 v_sub_f32 v245, v245, v27
M v[164:167], a[44:47], a[172:175], v[164:167]
 v_sub_f32 v246, v246, v27
 v_sub_f32 v247, v247, v27
M v[164:167], a[40:43], a[168:171], v[164:167]
 v_sub_f32 v248, v248, v27
 v_sub_f32 v249, v249, v27
M v[168:171], a[48:51], a[168:171], v[168:171]
 buffer_load_dwordx4 v11, s[52:55], s28 offen offset:3072   lds
M v[168:171], a[52:55], a[172:175], v[168:171]
 s_add_u32 s28, s28, 524416
 ds_read_b64_tr_b16 a[148:149], v3 offset:57344
 ds_read_b64_tr_b16 a[150:151], v3 offset:58368
M v[172:175], a[60:63], a[172:175], v[172:175]
 v_sub_f32 v250, v250, v27
 v_sub_f32 v251, v251, v27
M v[172:175], a[56:59], a[168:171], v[172:175]
 v_sub_f32 v252, v252, v27
 v_sub_f32 v253, v253, v27
M v[176:179], a[64:67], a[168:171], v[176:179]
 s_add_u32 m0, s23, 147456
 v_sub_f32 v254, v254, v27
 v_sub_f32 v255, v255, v27
M v[176:179], a[68:71], a[172:175], v[176:179]
 buffer_load_dwordx4 v8, s[52:55], s28 offen offset:0   lds
M v[180:183], a[76:79], a[172:175], v[180:183]
M v[180:183], a[72:75], a[168:171], v[180:183]
M v[184:187], a[80:83], a[168:171], v[184:187]
 ds_read_b64_tr_b16 a[152:153], v4 offset:49152
 ds_read_b64_tr_b16 a[154:155], v4 offset:50176
M v[184:187], a[84:87], a[172:175], v[184:187]
 s_waitcnt lgkmcnt(4)
M v[188:191], a[92:95], a[172:175], v[188:191]
 buffer_load_dwordx4 v9, s[52:55], s28 offen offset:1024   lds
M v[188:191], a[88:91], a[168:171], v[188:191]
M v[192:195], a[32:35], a[160:163], v[192:195]
 ds_read_b128 a[168:171], v5 offset:22528
 ds_read_b128 a[172:175], v6 offset:22528
M v[192:195], a[36:39], a[164:167], v[192:195]
M v[196:199], a[44:47], a[164:167], v[196:199]
 buffer_load_dwordx4 v10, s[52:55], s28 offen offset:2048   lds
M v[196:199], a[40:43], a[160:163], v[196:199]
 ds_read_b64_tr_b16 a[156:157], v4 offset:57344
 ds_read_b64_tr_b16 a[158:159], v4 offset:58368
M v[200:203], a[48:51], a[160:163], v[200:203]
M v[200:203], a[52:55], a[164:167], v[200:203]
M v[204:207], a[60:63], a[164:167], v[204:207]
M v[204:207], a[56:59], a[160:163], v[204:207]
 buffer_load_dwordx4 v11, s[52:55], s28 offen offset:3072   lds
M v[208:211], a[64:67], a[160:163], v[208:211]
 s_sub_u32 s28, s28, 524288
M v[208:211], a[68:71], a[164:167], v[208:211]
M v[212:215], a[76:79], a[164:167], v[212:215]
M v[212:215], a[72:75], a[160:163], v[212:215]
M v[216:219], a[80:83], a[160:163], v[216:219]
M v[216:219], a[84:87], a[164:167], v[216:219]
 s_waitcnt lgkmcnt(2)
M v[220:223], a[92:95], a[164:167], v[220:223]
 s_waitcnt vmcnt(25) lgkmcnt(0)
M v[220:223], a[88:91], a[160:163], v[220:223]
 s_barrier
M v[224:227], a[32:35], a[168:171], v[224:227]
 ds_read_b128 a[160:163], v5 offset:32768
 ds_read_b128 a[164:167], v6 offset:32768
M v[224:227], a[36:39], a[172:175], v[224:227]
M v[228:231], a[44:47], a[172:175], v[228:231]
M v[228:231], a[40:43], a[168:171], v[228:231]
M v[232:235], a[48:51], a[168:171], v[232:235]
M v[232:235], a[52:55], a[172:175], v[232:235]
M v[236:239], a[60:63], a[172:175], v[236:239]
M v[236:239], a[56:59], a[168:171], v[236:239]
M v[240:243], a[64:67], a[168:171], v[240:243]
M v[240:243], a[68:71], a[172:175], v[240:243]
M v[244:247], a[76:79], a[172:175], v[244:247]
M v[244:247], a[72:75], a[168:171], v[244:247]
M v[248:251], a[80:83], a[168:171], v[248:251]
M v[248:251], a[84:87], a[172:175], v[248:251]
 s_waitcnt lgkmcnt(0)
M v[252:255], a[92:95], a[172:175], v[252:255]
M v[252:255], a[88:91], a[168:171], v[252:255]
M a[0:3], a[96:99], a[160:163], a[0:3]
 ds_read_b128 a[168:171], v5 offset:34816
 ds_read_b128 a[172:175], v6 offset:34816
M a[0:3], a[100:103], a[164:167], a[0:3]
 ds_read_b64_tr_b16 a[32:33], v1 offset:0
 ds_read_b64_tr_b16 a[34:35], v1 offset:1024
M a[4:7], a[108:111], a[164:167], a[4:7]
 s_add_u32 m0, s24, 16384
M a[4:7], a[104:107], a[160:163], a[4:7]
 buffer_load_dwordx4 v16, s[56:59], s29 offen offset:0   lds
M a[8:11], a[112:115], a[160:163], a[8:11]
M a[8:11], a[116:119], a[164:167], a[8:11]
M a[12:15], a[124:127], a[164:167], a[12:15]
 ds_read_b64_tr_b16 a[36:37], v1 offset:8192
 ds_read_b64_tr_b16 a[38:39], v1 offset:9216
M a[12:15], a[120:123], a[160:163], a[12:15]
M a[16:19], a[128:131], a[160:163], a[16:19]
 buffer_load_dwordx4 v17, s[56:59], s29 offen offset:1024   lds
M a[16:19], a[132:135], a[164:167], a[16:19]
 v_accvgpr_read_b32 v24, a0
 v_accvgpr_read_b32 v25, a1
M a[20:23], a[140:143], a[164:167], a[20:23]
 v_accvgpr_read_b32 v26, a2
 v_accvgpr_read_b32 v27, a3
M a[20:23], a[136:139], a[160:163], a[20:23]
 ds_read_b64_tr_b16 a[40:41], v2 offset:0
 ds_read_b64_tr_b16 a[42:43], v2 offset:1024
M a[24:27], a[144:147], a[160:163], a[24:27]
 v_accvgpr_read_b32 v28, a4
 v_accvgpr_read_b32 v29, a5
M a[24:27], a[148:151], a[164:167], a[24:27]
 s_waitcnt lgkmcnt(6)
 buffer_load_dwordx4 v18, s[56:59], s29 offen offset:2048   lds
M a[28:31], a[156:159], a[164:167], a[28:31]
 v_accvgpr_read_b32 v30, a6
 v_accvgpr_read_b32 v31, a7
M a[28:31], a[152:155], a[160:163], a[28:31]
 v_cvt_pk_bf16_f32 v24, v24, v25
 v_cvt_pk_bf16_f32 v25, v26, v27
M v[32:35], a[96:99], a[168:171], v[32:35]
 ds_read_b128 a[160:163], v5 offset:36864
 ds_read_b128 a[164:167], v6 offset:36864
M v[32:35], a[100:103], a[172:175], v[32:35]
 ds_read_b64_tr_b16 a[44:45], v2 offset:8192
 ds_read_b64_tr_b16 a[46:47], v2 offset:9216
M v[36:39], a[108:111], a[172:175], v[36:39]
 buffer_load_dwordx4 v19, s[56:59], s29 offen offset:3072   lds
M v[36:39], a[104:107], a[168:171], v[36:39]
 s_add_u32 s29, s29, 128
 v_cvt_pk_bf16_f32 v26, v28, v29
 v_cvt_pk_bf16_f32 v27, v30, v31
M v[40:43], a[112:115], a[168:171], v[40:43]
 s_add_u32 s3, s93, 0
 buffer_store_dwordx4 v[24:27], v7, s[8:11], s3 offen offset:0 sc1
M v[40:43], a[116:119], a[172:175], v[40:43]
 ds_read_b64_tr_b16 a[48:49], v3 offset:0
 ds_read_b64_tr_b16 a[50:51], v3 offset:1024
M v[44:47], a[124:127], a[172:175], v[44:47]
 s_add_u32 m0, s23, 49152
 v_accvgpr_read_b32 v24, a8
 v_accvgpr_read_b32 v25, a9
M v[44:47], a[120:123], a[168:171], v[44:47]
 buffer_load_dwordx4 v8, s[52:55], s28 offen offset:0   lds
M v[48:51], a[128:131], a[168:171], v[48:51]
 v_accvgpr_read_b32 v26, a10
 v_accvgpr_read_b32 v27, a11
M v[48:51], a[132:135], a[172:175], v[48:51]
 v_accvgpr_read_b32 v28, a12
 v_accvgpr_read_b32 v29, a13
M v[52:55], a[140:143], a[172:175], v[52:55]
 ds_read_b64_tr_b16 a[52:53], v3 offset:8192
 ds_read_b64_tr_b16 a[54:55], v3 offset:9216
M v[52:55], a[136:139], a[168:171], v[52:55]
 v_accvgpr_read_b32 v30, a14
 v_accvgpr_read_b32 v31, a15
M v[56:59], a[144:147], a[168:171], v[56:59]
 buffer_load_dwordx4 v9, s[52:55], s28 offen offset:1024   lds
M v[56:59], a[148:151], a[172:175], v[56:59]
 s_waitcnt lgkmcnt(6)
 v_cvt_pk_bf16_f32 v24, v24, v25
 v_cvt_pk_bf16_f32 v25, v26, v27
M v[60:63], a[156:159], a[172:175], v[60:63]
 v_cvt_pk_bf16_f32 v26, v28, v29
 v_cvt_pk_bf16_f32 v27, v30, v31
M v[60:63], a[152:155], a[168:171], v[60:63]
 ds_read_b64_tr_b16 a[56:57], v4 offset:0
 ds_read_b64_tr_b16 a[58:59], v4 offset:1024
M v[64:67], a[96:99], a[160:163], v[64:67]
 ds_read_b128 a[168:171], v5 offset:38912
 ds_read_b128 a[172:175], v6 offset:38912
M v[64:67], a[100:103], a[164:167], v[64:67]
 buffer_load_dwordx4 v10, s[52:55], s28 offen offset:2048   lds
M v[68:71], a[108:111], a[164:167], v[68:71]
M v[68:71], a[104:107], a[160:163], v[68:71]
 buffer_store_dwordx4 v[24:27], v7, s[8:11], s3 offen offset:1024 sc1
M v[72:75], a[112:115], a[160:163], v[72:75]
 ds_read_b64_tr_b16 a[60:61], v4 offset:8192
 ds_read_b64_tr_b16 a[62:63], v4 offset:9216
M v[72:75], a[116:119], a[164:167], v[72:75]
 v_accvgpr_read_b32 v24, a16
 v_accvgpr_read_b32 v25, a17
M v[76:79], a[124:127], a[164:167], v[76:79]
 buffer_load_dwordx4 v11, s[52:55], s28 offen offset:3072   lds
M v[76:79], a[120:123], a[160:163], v[76:79]
 s_add_u32 s28, s28, 1048448
 v_accvgpr_read_b32 v26, a18
 v_accvgpr_read_b32 v27, a19
M v[80:83], a[128:131], a[160:163], v[80:83]
 v_accvgpr_read_b32 v28, a20
 v_accvgpr_read_b32 v29, a21
M v[80:83], a[132:135], a[164:167], v[80:83]
 v_accvgpr_read_b32 v30, a22
 v_accvgpr_read_b32 v31, a23
M v[84:87], a[140:143], a[164:167], v[84:87]
 v_cvt_pk_bf16_f32 v24, v24, v25
 v_cvt_pk_bf16_f32 v25, v26, v27
M v[84:87], a[136:139], a[160:163], v[84:87]
 v_cvt_pk_bf16_f32 v26, v28, v29
 v_cvt_pk_bf16_f32 v27, v30, v31
M v[88:91], a[144:147], a[160:163], v[88:91]
 buffer_store_dwordx4 v[24:27], v7, s[8:11], s3 offen offset:2048 sc1
M v[88:91], a[148:151], a[164:167], v[88:91]
 s_waitcnt lgkmcnt(2)
 v_accvgpr_read_b32 v24, a24
 v_accvgpr_read_b32 v25, a25
M v[92:95], a[156:159], a[164:167], v[92:95]
 s_waitcnt vmcnt(27) lgkmcnt(0)
 v_accvgpr_read_b32 v26, a26
 v_accvgpr_read_b32 v27, a27
M v[92:95], a[152:155], a[160:163], v[92:95]
 s_barrier
M v[96:99], a[96:99], a[168:171], v[96:99]
 ds_read_b128 a[160:163], v5 offset:49152
 ds_read_b128 a[164:167], v6 offset:49152
M v[96:99], a[100:103], a[172:175], v[96:99]
 v_accvgpr_read_b32 v28, a28
 v_accvgpr_read_b32 v29, a29
M v[100:103], a[108:111], a[172:175], v[100:103]
 s_add_u32 m0, s24, 32768
 ds_read_b64_tr_b16 a[64:65], v1 offset:16384
 ds_read_b64_tr_b16 a[66:67], v1 offset:17408
M v[100:103], a[104:107], a[168:171], v[100:103]
 buffer_load_dwordx4 v16, s[56:59], s29 offen offset:0   lds
M v[104:107], a[112:115], a[168:171], v[104:107]
 v_accvgpr_read_b32 v30, a30
 v_accvgpr_read_b32 v31, a31
M v[104:107], a[116:119], a[172:175], v[104:107]
 v_cvt_pk_bf16_f32 v24, v24, v25
 v_cvt_pk_bf16_f32 v25, v26, v27
M v[108:111], a[124:127], a[172:175], v[108:111]
 v_cvt_pk_bf16_f32 v26, v28, v29
 v_cvt_pk_bf16_f32 v27, v30, v31
M v[108:111], a[120:123], a[168:171], v[108:111]
 buffer_store_dwordx4 v[24:27], v7, s[8:11], s3 offen offset:3072 sc1
M v[112:115], a[128:131], a[168:171], v[112:115]
 v_cvt_pk_bf16_f32 v32, v32, v33
 v_cvt_pk_bf16_f32 v33, v34, v35
M v[112:115], a[132:135], a[172:175], v[112:115]
 ds_read_b64_tr_b16 a[68:69], v1 offset:24576
 ds_read_b64_tr_b16 a[70:71], v1 offset:25600
M v[116:119], a[140:143], a[172:175], v[116:119]
 buffer_load_dwordx4 v17, s[56:59], s29 offen offset:1024   lds
M v[116:119], a[136:139], a[168:171], v[116:119]
 v_cvt_pk_bf16_f32 v34, v36, v37
 v_cvt_pk_bf16_f32 v35, v38, v39
M v[120:123], a[144:147], a[168:171], v[120:123]
 v_accvgpr_write_b32 a4, v32
 v_accvgpr_write_b32 a5, v33
M v[120:123], a[148:151], a[172:175], v[120:123]
 s_waitcnt lgkmcnt(4)
 v_accvgpr_write_b32 a6, v34
 v_accvgpr_write_b32 a7, v35
M v[124:127], a[156:159], a[172:175], v[124:127]
 v_cvt_pk_bf16_f32 v40, v40, v41
 v_cvt_pk_bf16_f32 v41, v42, v43
M v[124:127], a[152:155], a[168:171], v[124:127]
 v_cvt_pk_bf16_f32 v42, v44, v45
 v_cvt_pk_bf16_f32 v43, v46, v47
M v[128:131], a[96:99], a[160:163], v[128:131]
 ds_read_b128 a[168:171], v5 offset:51200
 ds_read_b128 a[172:175], v6 offset:51200
M v[128:131], a[100:103], a[164:167], v[128:131]
 ds_read_b64_tr_b16 a[72:73], v2 offset:16384
 ds_read_b64_tr_b16 a[74:75], v2 offset:17408
M v[132:135], a[108:111], a[164:167], v[132:135]
 buffer_load_dwordx4 v18, s[56:59], s29 offen offset:2048   lds
M v[132:135], a[104:107], a[160:163], v[132:135]
 v_accvgpr_write_b32 a12, v40
 v_accvgpr_write_b32 a13, v41
M v[136:139], a[112:115], a[160:163], v[136:139]
 v_accvgpr_write_b32 a14, v42
 v_accvgpr_write_b32 a15, v43
M v[136:139], a[116:119], a[164:167], v[136:139]
 v_cvt_pk_bf16_f32 v48, v48, v49
 v_cvt_pk_bf16_f32 v49, v50, v51
M v[140:143], a[124:127], a[164:167], v[140:143]
 v_cvt_pk_bf16_f32 v50, v52, v53
 v_cvt_pk_bf16_f32 v51, v54, v55
M v[140:143], a[120:123], a[160:163], v[140:143]
 ds_read_b64_tr_b16 a[76:77], v2 offset:24576
 ds_read_b64_tr_b16 a[78:79], v2 offset:25600
M v[144:147], a[128:131], a[160:163], v[144:147]
 buffer_load_dwordx4 v19, s[56:59], s29 offen offset:3072   lds
M v[144:147], a[132:135], a[164:167], v[144:147]
 s_add_u32 s29, s29, 128
 v_accvgpr_write_b32 a20, v48
 v_accvgpr_write_b32 a21, v49
M v[148:151], a[140:143], a[164:167], v[148:151]
 v_accvgpr_write_b32 a22, v50
 v_accvgpr_write_b32 a23, v51
M v[148:151], a[136:139], a[160:163], v[148:151]
 v_cvt_pk_bf16_f32 v56, v56, v57
 v_cvt_pk_bf16_f32 v57, v58, v59
M v[152:155], a[144:147], a[160:163], v[152:155]
 v_cvt_pk_bf16_f32 v58, v60, v61
 v_cvt_pk_bf16_f32 v59, v62, v63
M v[152:155], a[148:151], a[164:167], v[152:155]
 s_waitcnt lgkmcnt(4)
 v_accvgpr_write_b32 a28, v56
 v_accvgpr_write_b32 a29, v57
M v[156:159], a[156:159], a[164:167], v[156:159]
 s_add_u32 m0, s23, 0
 ds_read_b64_tr_b16 a[80:81], v3 offset:16384
 ds_read_b64_tr_b16 a[82:83], v3 offset:17408
M v[156:159], a[152:155], a[160:163], v[156:159]
 buffer_load_dwordx4 v8, s[52:55], s28 offen offset:0   lds
M v[160:163], a[96:99], a[168:171], v[160:163]
 ds_read_b128 a[160:163], v5 offset:53248
 ds_read_b128 a[164:167], v6 offset:53248
M v[160:163], a[100:103], a[172:175], v[160:163]
 v_accvgpr_write_b32 a30, v58
 v_accvgpr_write_b32 a31, v59
M v[164:167], a[108:111], a[172:175], v[164:167]
 v_cvt_pk_bf16_f32 v64, v64, v65
 v_cvt_pk_bf16_f32 v65, v66, v67
M v[164:167], a[104:107], a[168:171], v[164:167]
 v_cvt_pk_bf16_f32 v66, v68, v69
 v_cvt_pk_bf16_f32 v67, v70, v71
M v[168:171], a[112:115], a[168:171], v[168:171]
 v_cvt_pk_bf16_f32 v72, v72, v73
 v_cvt_pk_bf16_f32 v73, v74, v75
M v[168:171], a[116:119], a[172:175], v[168:171]
 ds_read_b64_tr_b16 a[84:85], v3 offset:24576
 ds_read_b64_tr_b16 a[86:87], v3 offset:25600
M v[172:175], a[124:127], a[172:175], v[172:175]
 buffer_load_dwordx4 v9, s[52:55], s28 offen offset:1024   lds
M v[172:175], a[120:123], a[168:171], v[172:175]
 v_cvt_pk_bf16_f32 v74, v76, v77
 v_cvt_pk_bf16_f32 v75, v78, v79
M v[176:179], a[128:131], a[168:171], v[176:179]
 v_cvt_pk_bf16_f32 v80, v80, v81
 v_cvt_pk_bf16_f32 v81, v82, v83
M v[176:179], a[132:135], a[172:175], v[176:179]
 v_cvt_pk_bf16_f32 v82, v84, v85
 v_cvt_pk_bf16_f32 v83, v86, v87
M v[180:183], a[140:143], a[172:175], v[180:183]
 v_cvt_pk_bf16_f32 v88, v88, v89
 v_cvt_pk_bf16_f32 v89, v90, v91
M v[180:183], a[136:139], a[168:171], v[180:183]
 v_cvt_pk_bf16_f32 v90, v92, v93
 v_cvt_pk_bf16_f32 v91, v94, v95
M v[184:187], a[144:147], a[168:171], v[184:187]
 ds_read_b64_tr_b16 a[88:89], v4 offset:16384
 ds_read_b64_tr_b16 a[90:91], v4 offset:17408
M v[184:187], a[148:151], a[172:175], v[184:187]
 s_waitcnt lgkmcnt(4)
 buffer_load_dwordx4 v10, s[52:55], s28 offen offset:2048   lds
M v[188:191], a[156:159], a[172:175], v[188:191]
 v_cvt_pk_bf16_f32 v96, v96, v97
 v_cvt_pk_bf16_f32 v97, v98, v99
M v[188:191], a[152:155], a[168:171], v[188:191]
 v_cvt_pk_bf16_f32 v98, v100, v101
 v_cvt_pk_bf16_f32 v99, v102, v103
M v[192:195], a[96:99], a[160:163], v[192:195]
 ds_read_b128 a[168:171], v5 offset:55296
 ds_read_b128 a[172:175], v6 offset:55296
M v[192:195], a[100:103], a[164:167], v[192:195]
 v_cvt_pk_bf16_f32 v104, v104, v105
 v_cvt_pk_bf16_f32 v105, v106, v107
M v[196:199], a[108:111], a[164:167], v[196:199]
 v_cvt_pk_bf16_f32 v106, v108, v109
 v_cvt_pk_bf16_f32 v107, v110, v111
M v[196:199], a[104:107], a[160:163], v[196:199]
 ds_read_b64_tr_b16 a[92:93], v4 offset:24576
 ds_read_b64_tr_b16 a[94:95], v4 offset:25600
M v[200:203], a[112:115], a[160:163], v[200:203]
 buffer_load_dwordx4 v11, s[52:55], s28 offen offset:3072   lds
M v[200:203], a[116:119], a[164:167], v[200:203]
 s_add_u32 s28, s28, 128
 v_cvt_pk_bf16_f32 v112, v112, v113
 v_cvt_pk_bf16_f32 v113, v114, v115
M v[204:207], a[124:127], a[164:167], v[204:207]
 v_cvt_pk_bf16_f32 v114, v116, v117
 v_cvt_pk_bf16_f32 v115, v118, v119
M v[204:207], a[120:123], a[160:163], v[204:207]
 v_cvt_pk_bf16_f32 v120, v120, v121
 v_cvt_pk_bf16_f32 v121, v122, v123
M v[208:211], a[128:131], a[160:163], v[208:211]
 v_cvt_pk_bf16_f32 v122, v124, v125
 v_cvt_pk_bf16_f32 v123, v126, v127
M v[208:211], a[132:135], a[164:167], v[208:211]
 v_cvt_pk_bf16_f32 v128, v128, v129
 v_cvt_pk_bf16_f32 v129, v130, v131
M v[212:215], a[140:143], a[164:167], v[212:215]
 v_cvt_pk_bf16_f32 v130, v132, v133
 v_cvt_pk_bf16_f32 v131, v134, v135
M v[212:215], a[136:139], a[160:163], v[212:215]
 v_cvt_pk_bf16_f32 v136, v136, v137
 v_cvt_pk_bf16_f32 v137, v138, v139
M v[216:219], a[144:147], a[160:163], v[216:219]
 v_cvt_pk_bf16_f32 v138, v140, v141
 v_cvt_pk_bf16_f32 v139, v142, v143
M v[216:219], a[148:151], a[164:167], v[216:219]
 s_waitcnt lgkmcnt(2)
 v_cvt_pk_bf16_f32 v144, v144, v145
 v_cvt_pk_bf16_f32 v145, v146, v147
M v[220:223], a[156:159], a[164:167], v[220:223]
 s_waitcnt vmcnt(24) lgkmcnt(0)
 v_cvt_pk_bf16_f32 v146, v148, v149
 v_cvt_pk_bf16_f32 v147, v150, v151
M v[220:223], a[152:155], a[160:163], v[220:223]
 s_barrier
M v[224:227], a[96:99], a[168:171], v[224:227]
 ds_read_b128 a[160:163], v5 offset:0
 ds_read_b128 a[164:167], v6 offset:0
M v[224:227], a[100:103], a[172:175], v[224:227]
 v_cvt_pk_bf16_f32 v152, v152, v153
 v_cvt_pk_bf16_f32 v153, v154, v155
M v[228:231], a[108:111], a[172:175], v[228:231]
 v_cvt_pk_bf16_f32 v154, v156, v157
 v_cvt_pk_bf16_f32 v155, v158, v159
M v[228:231], a[104:107], a[168:171], v[228:231]
 v_cvt_pk_bf16_f32 v160, v160, v161
 v_cvt_pk_bf16_f32 v161, v162, v163
M v[232:235], a[112:115], a[168:171], v[232:235]
 v_cvt_pk_bf16_f32 v162, v164, v165
 v_cvt_pk_bf16_f32 v163, v166, v167
M v[232:235], a[116:119], a[172:175], v[232:235]
 v_cvt_pk_bf16_f32 v168, v168, v169
 v_cvt_pk_bf16_f32 v169, v170, v171
M v[236:239], a[124:127], a[172:175], v[236:239]
 v_cvt_pk_bf16_f32 v170, v172, v173
 v_cvt_pk_bf16_f32 v171, v174, v175
M v[236:239], a[120:123], a[168:171], v[236:239]
 v_cvt_pk_bf16_f32 v176, v176, v177
 v_cvt_pk_bf16_f32 v177, v178, v179
M v[240:243], a[128:131], a[168:171], v[240:243]
 v_cvt_pk_bf16_f32 v178, v180, v181
 v_cvt_pk_bf16_f32 v179, v182, v183
M v[240:243], a[132:135], a[172:175], v[240:243]
 v_cvt_pk_bf16_f32 v184, v184, v185
 v_cvt_pk_bf16_f32 v185, v186, v187
M v[244:247], a[140:143], a[172:175], v[244:247]
 v_cvt_pk_bf16_f32 v186, v188, v189
 v_cvt_pk_bf16_f32 v187, v190, v191
M v[244:247], a[136:139], a[168:171], v[244:247]
 v_cvt_pk_bf16_f32 v192, v192, v193
 v_cvt_pk_bf16_f32 v193, v194, v195
M v[248:251], a[144:147], a[168:171], v[248:251]
 v_cvt_pk_bf16_f32 v194, v196, v197
 v_cvt_pk_bf16_f32 v195, v198, v199
M v[248:251], a[148:151], a[172:175], v[248:251]
 s_waitcnt lgkmcnt(0)
 v_cvt_pk_bf16_f32 v200, v200, v201
 v_cvt_pk_bf16_f32 v201, v202, v203
M v[252:255], a[156:159], a[172:175], v[252:255]
 v_cvt_pk_bf16_f32 v202, v204, v205
 v_cvt_pk_bf16_f32 v203, v206, v207
M v[252:255], a[152:155], a[168:171], v[252:255]
 v_cvt_pk_bf16_f32 v208, v208, v209
 v_cvt_pk_bf16_f32 v209, v210, v211
M v[32:35], a[32:35], a[160:163], 0
 s_add_u32 m0, s23, 16384
 ds_read_b128 a[168:171], v5 offset:2048
 ds_read_b128 a[172:175], v6 offset:2048
M v[32:35], a[36:39], a[164:167], v[32:35]
 ds_read_b64_tr_b16 a[96:97], v1 offset:32768
 ds_read_b64_tr_b16 a[98:99], v1 offset:33792
M v[36:39], a[44:47], a[164:167], 0
 buffer_load_dwordx4 v8, s[52:55], s28 offen offset:0   lds
M v[36:39], a[40:43], a[160:163], v[36:39]
 v_cvt_pk_bf16_f32 v210, v212, v213
 v_cvt_pk_bf16_f32 v211, v214, v215
M v[40:43], a[48:51], a[160:163], 0
 ds_read_b64_tr_b16 a[100:101], v1 offset:40960
 ds_read_b64_tr_b16 a[102:103], v1 offset:41984
M v[40:43], a[52:55], a[164:167], v[40:43]
 buffer_load_dwordx4 v9, s[52:55], s28 offen offset:1024   lds
M v[44:47], a[60:63], a[164:167], 0
 v_cvt_pk_bf16_f32 v216, v216, v217
 v_cvt_pk_bf16_f32 v217, v218, v219
M v[44:47], a[56:59], a[160:163], v[44:47]
 ds_read_b64_tr_b16 a[104:105], v2 offset:32768
 ds_read_b64_tr_b16 a[106:107], v2 offset:33792
M v[48:51], a[64:67], a[160:163], 0
 v_cvt_pk_bf16_f32 v218, v220, v221
 v_cvt_pk_bf16_f32 v219, v222, v223
M v[48:51], a[68:71], a[164:167], v[48:51]
 v_cvt_pk_bf16_f32 v224, v224, v225
 v_cvt_pk_bf16_f32 v225, v226, v227
M v[52:55], a[76:79], a[164:167], 0
 ds_read_b64_tr_b16 a[108:109], v2 offset:40960
 ds_read_b64_tr_b16 a[110:111], v2 offset:41984
M v[52:55], a[72:75], a[160:163], v[52:55]
 buffer_load_dwordx4 v10, s[52:55], s28 offen offset:2048   lds
M v[56:59], a[80:83], a[160:163], 0
 v_cvt_pk_bf16_f32 v226, v228, v229
 v_cvt_pk_bf16_f32 v227, v230, v231
M v[56:59], a[84:87], a[164:167], v[56:59]
 s_waitcnt lgkmcnt(8)
 ds_read_b64_tr_b16 a[112:113], v3 offset:32768
 ds_read_b64_tr_b16 a[114:115], v3 offset:33792
M v[60:63], a[92:95], a[164:167], 0
 v_cvt_pk_bf16_f32 v232, v232, v233
 v_cvt_pk_bf16_f32 v233, v234, v235
M v[60:63], a[88:91], a[160:163], v[60:63]
 buffer_load_dwordx4 v11, s[52:55], s28 offen offset:3072   lds
M v[68:71], a[32:35], a[168:171], 0
 s_add_u32 s28, s28, 524160
 ds_read_b128 a[160:163], v5 offset:4096
 ds_read_b128 a[164:167], v6 offset:4096
M v[68:71], a[36:39], a[172:175], v[68:71]
 ds_read_b64_tr_b16 a[116:117], v3 offset:40960
 ds_read_b64_tr_b16 a[118:119], v3 offset:41984
M v[76:79], a[44:47], a[172:175], 0
 v_cvt_pk_bf16_f32 v234, v236, v237
 v_cvt_pk_bf16_f32 v235, v238, v239
M v[76:79], a[40:43], a[168:171], v[76:79]
 s_add_u32 m0, s24, 49152
 ds_read_b64_tr_b16 a[120:121], v4 offset:32768
 ds_read_b64_tr_b16 a[122:123], v4 offset:33792
M v[84:87], a[48:51], a[168:171], 0
 buffer_load_dwordx4 v16, s[56:59], s29 offen offset:0   lds
M v[84:87], a[52:55], a[172:175], v[84:87]
 v_cvt_pk_bf16_f32 v240, v240, v241
 v_cvt_pk_bf16_f32 v241, v242, v243
M v[92:95], a[60:63], a[172:175], 0
 ds_read_b64_tr_b16 a[124:125], v4 offset:40960
 ds_read_b64_tr_b16 a[126:127], v4 offset:41984
M v[92:95], a[56:59], a[168:171], v[92:95]
 v_cvt_pk_bf16_f32 v242, v244, v245
 v_cvt_pk_bf16_f32 v243, v246, v247
M v[100:103], a[64:67], a[168:171], 0
 v_cvt_pk_bf16_f32 v248, v248, v249
 v_cvt_pk_bf16_f32 v249, v250, v251
M v[100:103], a[68:71], a[172:175], v[100:103]
 buffer_load_dwordx4 v17, s[56:59], s29 offen offset:1024   lds
M v[108:111], a[76:79], a[172:175], 0
 v_cvt_pk_bf16_f32 v250, v252, v253
 v_cvt_pk_bf16_f32 v251, v254, v255
M v[108:111], a[72:75], a[168:171], v[108:111]
 s_add_u32 s3, s93, 8192
 v_mov_b32 v12, 1
 v_or_b32 v15, s20, v0
M v[116:119], a[80:83], a[168:171], 0
 v_min_u32 v15, 1, v15
 v_lshlrev_b32 v15, 29, v15
M v[116:119], a[84:87], a[172:175], v[116:119]
 s_waitcnt lgkmcnt(6)
 buffer_store_dwordx4 a[4:7], v7, s[8:11], s3 offen offset:0 sc1
M v[124:127], a[92:95], a[172:175], 0
 s_waitcnt vmcnt(17) lgkmcnt(0)
 buffer_load_dwordx4 v18, s[56:59], s29 offen offset:2048   lds
M v[124:127], a[88:91], a[168:171], v[124:127]
 s_barrier
M v[132:135], a[32:35], a[160:163], 0
 ds_read_b128 a[168:171], v5 offset:6144
 ds_read_b128 a[172:175], v6 offset:6144
M v[132:135], a[36:39], a[164:167], v[132:135]
 ds_read_b64_tr_b16 a[128:129], v1 offset:49152
 ds_read_b64_tr_b16 a[130:131], v1 offset:50176
M v[140:143], a[44:47], a[164:167], 0
M v[140:143], a[40:43], a[160:163], v[140:143]
 buffer_load_dwordx4 v19, s[56:59], s29 offen offset:3072   lds
M v[148:151], a[48:51], a[160:163], 0
 s_add_u32 s29, s29, 128
 ds_read_b64_tr_b16 a[132:133], v1 offset:57344
 ds_read_b64_tr_b16 a[134:135], v1 offset:58368
M v[148:151], a[52:55], a[164:167], v[148:151]
 buffer_store_dwordx4 a[12:15], v7, s[8:11], s3 offen offset:1024 sc1
M v[156:159], a[60:63], a[164:167], 0
M v[156:159], a[56:59], a[160:163], v[156:159]
 s_add_u32 m0, s23, 32768
 ds_read_b64_tr_b16 a[136:137], v2 offset:49152
 ds_read_b64_tr_b16 a[138:139], v2 offset:50176
M v[164:167], a[64:67], a[160:163], 0
 buffer_load_dwordx4 v8, s[52:55], s28 offen offset:0   lds
M v[164:167], a[68:71], a[164:167], v[164:167]
M v[172:175], a[76:79], a[164:167], 0
 ds_read_b64_tr_b16 a[140:141], v2 offset:57344
 ds_read_b64_tr_b16 a[142:143], v2 offset:58368
M v[172:175], a[72:75], a[160:163], v[172:175]
M v[180:183], a[80:83], a[160:163], 0
M v[180:183], a[84:87], a[164:167], v[180:183]
 s_waitcnt lgkmcnt(8)
 ds_read_b64_tr_b16 a[144:145], v3 offset:49152
 ds_read_b64_tr_b16 a[146:147], v3 offset:50176
M v[188:191], a[92:95], a[164:167], 0
 buffer_load_dwordx4 v9, s[52:55], s28 offen offset:1024   lds
M v[188:191], a[88:91], a[160:163], v[188:191]
M v[196:199], a[32:35], a[168:171], 0
 ds_read_b128 a[160:163], v5 offset:16384
 ds_read_b128 a[164:167], v6 offset:16384
M v[196:199], a[36:39], a[172:175], v[196:199]
 ds_read_b64_tr_b16 a[148:149], v3 offset:57344
 ds_read_b64_tr_b16 a[150:151], v3 offset:58368
M v[204:207], a[44:47], a[172:175], 0
 buffer_load_dwordx4 v10, s[52:55], s28 offen offset:2048   lds
M v[204:207], a[40:43], a[168:171], v[204:207]
 ds_read_b64_tr_b16 a[152:153], v4 offset:49152
 ds_read_b64_tr_b16 a[154:155], v4 offset:50176
M v[212:215], a[48:51], a[168:171], 0
M v[212:215], a[52:55], a[172:175], v[212:215]
M v[220:223], a[60:63], a[172:175], 0
 ds_read_b64_tr_b16 a[156:157], v4 offset:57344
 ds_read_b64_tr_b16 a[158:159], v4 offset:58368
M v[220:223], a[56:59], a[168:171], v[220:223]
 buffer_load_dwordx4 v11, s[52:55], s28 offen offset:3072   lds
M v[228:231], a[64:67], a[168:171], 0
 s_add_u32 s28, s28, 128
M v[228:231], a[68:71], a[172:175], v[228:231]
M v[236:239], a[76:79], a[172:175], 0
M v[236:239], a[72:75], a[168:171], v[236:239]
M v[244:247], a[80:83], a[168:171], 0
M v[244:247], a[84:87], a[172:175], v[244:247]
 s_waitcnt lgkmcnt(6)
M v[252:255], a[92:95], a[172:175], 0
 s_waitcnt lgkmcnt(0)
M v[252:255], a[88:91], a[168:171], v[252:255]
 s_barrier
M v[32:35], a[96:99], a[160:163], v[32:35]
 s_add_u32 m0, s23, 49152
 ds_read_b128 a[168:171], v5 offset:18432
 ds_read_b128 a[172:175], v6 offset:18432
M v[32:35], a[100:103], a[164:167], v[32:35]
 ds_read_b64_tr_b16 a[32:33], v20 offset:0
 ds_read_b64_tr_b16 a[34:35], v20 offset:1024
M v[36:39], a[108:111], a[164:167], v[36:39]
 s_mov_b32 s39, 16387
 buffer_load_dwordx4 v8, s[52:55], s28 offen offset:0   lds
M v[36:39], a[104:107], a[160:163], v[36:39]
 s_lshl_b32 s64, s20, 14
M v[40:43], a[112:115], a[160:163], v[40:43]
 s_add_u32 s12, s64, s34
 ds_read_b64_tr_b16 a[36:37], v20 offset:8192
 ds_read_b64_tr_b16 a[38:39], v20 offset:9216
M v[40:43], a[116:119], a[164:167], v[40:43]
 s_add_u32 s13, s12, 4096
 buffer_load_dwordx4 v9, s[52:55], s28 offen offset:1024   lds
M v[44:47], a[124:127], a[164:167], v[44:47]
 s_add_u32 s14, s12, 8192
M v[44:47], a[120:123], a[160:163], v[44:47]
 s_add_u32 s15, s12, 12288
 ds_read_b64_tr_b16 a[40:41], v21 offset:0
 ds_read_b64_tr_b16 a[42:43], v21 offset:1024
M v[48:51], a[128:131], a[160:163], v[48:51]
 buffer_store_dwordx4 a[20:23], v7, s[8:11], s3 offen offset:2048 sc1
M v[48:51], a[132:135], a[164:167], v[48:51]
M v[52:55], a[140:143], a[164:167], v[52:55]
 ds_read_b64_tr_b16 a[44:45], v21 offset:8192
 ds_read_b64_tr_b16 a[46:47], v21 offset:9216
M v[52:55], a[136:139], a[160:163], v[52:55]
 buffer_load_dwordx4 v10, s[52:55], s28 offen offset:2048   lds
M v[56:59], a[144:147], a[160:163], v[56:59]
M v[56:59], a[148:151], a[164:167], v[56:59]
 s_waitcnt lgkmcnt(8)
 ds_read_b64_tr_b16 a[48:49], v22 offset:0
 ds_read_b64_tr_b16 a[50:51], v22 offset:1024
M v[60:63], a[156:159], a[164:167], v[60:63]
M v[60:63], a[152:155], a[160:163], v[60:63]
 buffer_load_dwordx4 v11, s[52:55], s28 offen offset:3072   lds
M v[68:71], a[96:99], a[168:171], v[68:71]
 s_add_u32 s28, s28, 524160
 ds_read_b128 a[160:163], v5 offset:20480
 ds_read_b128 a[164:167], v6 offset:20480
M v[68:71], a[100:103], a[172:175], v[68:71]
 ds_read_b64_tr_b16 a[52:53], v22 offset:8192
 ds_read_b64_tr_b16 a[54:55], v22 offset:9216
M v[76:79], a[108:111], a[172:175], v[76:79]
M v[76:79], a[104:107], a[168:171], v[76:79]
 s_add_u32 m0, s24, 0
 ds_read_b64_tr_b16 a[56:57], v23 offset:0
 ds_read_b64_tr_b16 a[58:59], v23 offset:1024
M v[84:87], a[112:115], a[168:171], v[84:87]
 buffer_load_dwordx4 v16, s[56:59], s29 offen offset:0   lds
M v[84:87], a[116:119], a[172:175], v[84:87]
M v[92:95], a[124:127], a[172:175], v[92:95]
 ds_read_b64_tr_b16 a[60:61], v23 offset:8192
 ds_read_b64_tr_b16 a[62:63], v23 offset:9216
M v[92:95], a[120:123], a[168:171], v[92:95]
M v[100:103], a[128:131], a[168:171], v[100:103]
M v[100:103], a[132:135], a[172:175], v[100:103]
 buffer_load_dwordx4 v17, s[56:59], s29 offen offset:1024   lds
M v[108:111], a[140:143], a[172:175], v[108:111]
M v[108:111], a[136:139], a[168:171], v[108:111]
M v[116:119], a[144:147], a[168:171], v[116:119]
M v[116:119], a[148:151], a[172:175], v[116:119]
 s_waitcnt lgkmcnt(6)
M v[124:127], a[156:159], a[172:175], v[124:127]
 s_waitcnt vmcnt(25) lgkmcnt(0)
 buffer_load_dwordx4 v18, s[56:59], s29 offen offset:2048   lds
M v[124:127], a[152:155], a[168:171], v[124:127]
 s_barrier
M v[132:135], a[96:99], a[160:163], v[132:135]
 ds_read_b128 a[168:171], v5 offset:22528
 ds_read_b128 a[172:175], v6 offset:22528
M v[132:135], a[100:103], a[164:167], v[132:135]
 ds_read_b64_tr_b16 a[64:65], v20 offset:16384
 ds_read_b64_tr_b16 a[66:67], v20 offset:17408
M v[140:143], a[108:111], a[164:167], v[140:143]
M v[140:143], a[104:107], a[160:163], v[140:143]
 buffer_load_dwordx4 v19, s[56:59], s29 offen offset:3072   lds
M v[148:151], a[112:115], a[160:163], v[148:151]
 s_add_u32 s29, s29, 128
 ds_read_b64_tr_b16 a[68:69], v20 offset:24576
 ds_read_b64_tr_b16 a[70:71], v20 offset:25600
M v[148:151], a[116:119], a[164:167], v[148:151]
 buffer_store_dwordx4 a[28:31], v7, s[8:11], s3 offen offset:3072 sc1
M v[156:159], a[124:127], a[164:167], v[156:159]
M v[156:159], a[120:123], a[160:163], v[156:159]
 s_add_u32 m0, s23, 131072
 ds_read_b64_tr_b16 a[72:73], v21 offset:16384
 ds_read_b64_tr_b16 a[74:75], v21 offset:17408
M v[164:167], a[128:131], a[160:163], v[164:167]
 buffer_load_dwordx4 v8, s[52:55], s28 offen offset:0   lds
M v[164:167], a[132:135], a[164:167], v[164:167]
M v[172:175], a[140:143], a[164:167], v[172:175]
 ds_read_b64_tr_b16 a[76:77], v21 offset:24576
 ds_read_b64_tr_b16 a[78:79], v21 offset:25600
M v[172:175], a[136:139], a[160:163], v[172:175]
M v[180:183], a[144:147], a[160:163], v[180:183]
M v[180:183], a[148:151], a[164:167], v[180:183]
 s_waitcnt lgkmcnt(8)
 ds_read_b64_tr_b16 a[80:81], v22 offset:16384
 ds_read_b64_tr_b16 a[82:83], v22 offset:17408
M v[188:191], a[156:159], a[164:167], v[188:191]
 buffer_load_dwordx4 v9, s[52:55], s28 offen offset:1024   lds
M v[188:191], a[152:155], a[160:163], v[188:191]
M v[196:199], a[96:99], a[168:171], v[196:199]
 ds_read_b128 a[160:163], v5 offset:32768
 ds_read_b128 a[164:167], v6 offset:32768
M v[196:199], a[100:103], a[172:175], v[196:199]
 ds_read_b64_tr_b16 a[84:85], v22 offset:24576
 ds_read_b64_tr_b16 a[86:87], v22 offset:25600
M v[204:207], a[108:111], a[172:175], v[204:207]
 buffer_load_dwordx4 v10, s[52:55], s28 offen offset:2048   lds
M v[204:207], a[104:107], a[168:171], v[204:207]
 ds_read_b64_tr_b16 a[88:89], v23 offset:16384
 ds_read_b64_tr_b16 a[90:91], v23 offset:17408
M v[212:215], a[112:115], a[168:171], v[212:215]
M v[212:215], a[116:119], a[172:175], v[212:215]
M v[220:223], a[124:127], a[172:175], v[220:223]
 ds_read_b64_tr_b16 a[92:93], v23 offset:24576
 ds_read_b64_tr_b16 a[94:95], v23 offset:25600
M v[220:223], a[120:123], a[168:171], v[220:223]
 buffer_load_dwordx4 v11, s[52:55], s28 offen offset:3072   lds
M v[228:231], a[128:131], a[168:171], v[228:231]
 s_add_u32 s28, s28, 128
M v[228:231], a[132:135], a[172:175], v[228:231]
M v[236:239], a[140:143], a[172:175], v[236:239]
M v[236:239], a[136:139], a[168:171], v[236:239]
M v[244:247], a[144:147], a[168:171], v[244:247]
M v[244:247], a[148:151], a[172:175], v[244:247]
 s_waitcnt lgkmcnt(6)
M v[252:255], a[156:159], a[172:175], v[252:255]
 s_waitcnt vmcnt(28) lgkmcnt(0)
M v[252:255], a[152:155], a[168:171], v[252:255]
 s_barrier
M v[32:35], a[32:35], a[160:163], v[32:35]
 s_add_u32 m0, s23, 147456
 ds_read_b128 a[168:171], v5 offset:34816
 ds_read_b128 a[172:175], v6 offset:34816
M v[32:35], a[36:39], a[164:167], v[32:35]
 ds_read_b64_tr_b16 a[96:97], v1 offset:0
 ds_read_b64_tr_b16 a[98:99], v1 offset:1024
M v[36:39], a[44:47], a[164:167], v[36:39]
 buffer_load_dwordx4 v8, s[52:55], s28 offen offset:0   lds
M v[36:39], a[40:43], a[160:163], v[36:39]
M v[40:43], a[48:51], a[160:163], v[40:43]
 ds_read_b64_tr_b16 a[100:101], v1 offset:8192
 ds_read_b64_tr_b16 a[102:103], v1 offset:9216
M v[40:43], a[52:55], a[164:167], v[40:43]
 buffer_load_dwordx4 v9, s[52:55], s28 offen offset:1024   lds
M v[44:47], a[60:63], a[164:167], v[44:47]
M v[44:47], a[56:59], a[160:163], v[44:47]
 ds_read_b64_tr_b16 a[104:105], v2 offset:0
 ds_read_b64_tr_b16 a[106:107], v2 offset:1024
M v[48:51], a[64:67], a[160:163], v[48:51]
M v[48:51], a[68:71], a[164:167], v[48:51]
M v[52:55], a[76:79], a[164:167], v[52:55]
 ds_read_b64_tr_b16 a[108:109], v2 offset:8192
 ds_read_b64_tr_b16 a[110:111], v2 offset:9216
M v[52:55], a[72:75], a[160:163], v[52:55]
 buffer_load_dwordx4 v10, s[52:55], s28 offen offset:2048   lds
M v[56:59], a[80:83], a[160:163], v[56:59]
M v[56:59], a[84:87], a[164:167], v[56:59]
 s_waitcnt lgkmcnt(8)
 ds_read_b64_tr_b16 a[112:113], v3 offset:0
 ds_read_b64_tr_b16 a[114:115], v3 offset:1024
M v[60:63], a[92:95], a[164:167], v[60:63]
M v[60:63], a[88:91], a[160:163], v[60:63]
 buffer_load_dwordx4 v11, s[52:55], s28 offen offset:3072   lds
M v[68:71], a[32:35], a[168:171], v[68:71]
 s_add_u32 s28, s28, 524160
 ds_read_b128 a[160:163], v5 offset:36864
 ds_read_b128 a[164:167], v6 offset:36864
M v[68:71], a[36:39], a[172:175], v[68:71]
 ds_read_b64_tr_b16 a[116:117], v3 offset:8192
 ds_read_b64_tr_b16 a[118:119], v3 offset:9216
M v[76:79], a[44:47], a[172:175], v[76:79]
M v[76:79], a[40:43], a[168:171], v[76:79]
 s_add_u32 m0, s24, 16384
 ds_read_b64_tr_b16 a[120:121], v4 offset:0
 ds_read_b64_tr_b16 a[122:123], v4 offset:1024
M v[84:87], a[48:51], a[168:171], v[84:87]
 buffer_load_dwordx4 v16, s[56:59], s29 offen offset:0   lds
M v[84:87], a[52:55], a[172:175], v[84:87]
M v[92:95], a[60:63], a[172:175], v[92:95]
 ds_read_b64_tr_b16 a[124:125], v4 offset:8192
 ds_read_b64_tr_b16 a[126:127], v4 offset:9216
M v[92:95], a[56:59], a[168:171], v[92:95]
M v[100:103], a[64:67], a[168:171], v[100:103]
M v[100:103], a[68:71], a[172:175], v[100:103]
 buffer_load_dwordx4 v17, s[56:59], s29 offen offset:1024   lds
M v[108:111], a[76:79], a[172:175], v[108:111]
M v[108:111], a[72:75], a[168:171], v[108:111]
M v[116:119], a[80:83], a[168:171], v[116:119]
M v[116:119], a[84:87], a[172:175], v[116:119]
 s_waitcnt lgkmcnt(6)
M v[124:127], a[92:95], a[172:175], v[124:127]
 s_waitcnt vmcnt(25) lgkmcnt(0)
 buffer_load_dwordx4 v18, s[56:59], s29 offen offset:2048   lds
M v[124:127], a[88:91], a[168:171], v[124:127]
 s_barrier
M v[132:135], a[32:35], a[160:163], v[132:135]
 ds_read_b128 a[168:171], v5 offset:38912
 ds_read_b128 a[172:175], v6 offset:38912
M v[132:135], a[36:39], a[164:167], v[132:135]
 ds_read_b64_tr_b16 a[128:129], v1 offset:16384
 ds_read_b64_tr_b16 a[130:131], v1 offset:17408
M v[140:143], a[44:47], a[164:167], v[140:143]
M v[140:143], a[40:43], a[160:163], v[140:143]
 buffer_load_dwordx4 v19, s[56:59], s29 offen offset:3072   lds
M v[148:151], a[48:51], a[160:163], v[148:151]
 s_add_u32 s29, s29, 128
 ds_read_b64_tr_b16 a[132:133], v1 offset:24576
 ds_read_b64_tr_b16 a[134:135], v1 offset:25600
M v[148:151], a[52:55], a[164:167], v[148:151]
M v[156:159], a[60:63], a[164:167], v[156:159]
M v[156:159], a[56:59], a[160:163], v[156:159]
 s_add_u32 m0, s23, 0
 ds_read_b64_tr_b16 a[136:137], v2 offset:16384
 ds_read_b64_tr_b16 a[138:139], v2 offset:17408
M v[164:167], a[64:67], a[160:163], v[164:167]
 buffer_load_dwordx4 v8, s[52:55], s28 offen offset:0   lds
M v[164:167], a[68:71], a[164:167], v[164:167]
M v[172:175], a[76:79], a[164:167], v[172:175]
 ds_read_b64_tr_b16 a[140:141], v2 offset:24576
 ds_read_b64_tr_b16 a[142:143], v2 offset:25600
M v[172:175], a[72:75], a[160:163], v[172:175]
M v[180:183], a[80:83], a[160:163], v[180:183]
M v[180:183], a[84:87], a[164:167], v[180:183]
 s_waitcnt lgkmcnt(8)
 ds_read_b64_tr_b16 a[144:145], v3 offset:16384
 ds_read_b64_tr_b16 a[146:147], v3 offset:17408
M v[188:191], a[92:95], a[164:167], v[188:191]
 buffer_load_dwordx4 v9, s[52:55], s28 offen offset:1024   lds
M v[188:191], a[88:91], a[160:163], v[188:191]
M v[196:199], a[32:35], a[168:171], v[196:199]
 ds_read_b128 a[160:163], v5 offset:49152
 ds_read_b128 a[164:167], v6 offset:49152
M v[196:199], a[36:39], a[172:175], v[196:199]
 ds_read_b64_tr_b16 a[148:149], v3 offset:24576
 ds_read_b64_tr_b16 a[150:151], v3 offset:25600
M v[204:207], a[44:47], a[172:175], v[204:207]
 buffer_load_dwordx4 v10, s[52:55], s28 offen offset:2048   lds
M v[204:207], a[40:43], a[168:171], v[204:207]
 ds_read_b64_tr_b16 a[152:153], v4 offset:16384
 ds_read_b64_tr_b16 a[154:155], v4 offset:17408
M v[212:215], a[48:51], a[168:171], v[212:215]
M v[212:215], a[52:55], a[172:175], v[212:215]
M v[220:223], a[60:63], a[172:175], v[220:223]
 ds_read_b64_tr_b16 a[156:157], v4 offset:24576
 ds_read_b64_tr_b16 a[158:159], v4 offset:25600
M v[220:223], a[56:59], a[168:171], v[220:223]
 buffer_load_dwordx4 v11, s[52:55], s28 offen offset:3072   lds
M v[228:231], a[64:67], a[168:171], v[228:231]
 s_add_u32 s28, s28, 128
M v[228:231], a[68:71], a[172:175], v[228:231]
M v[236:239], a[76:79], a[172:175], v[236:239]
M v[236:239], a[72:75], a[168:171], v[236:239]
M v[244:247], a[80:83], a[168:171], v[244:247]
M v[244:247], a[84:87], a[172:175], v[244:247]
 s_waitcnt lgkmcnt(6)
M v[252:255], a[92:95], a[172:175], v[252:255]
 s_waitcnt vmcnt(16) lgkmcnt(0)
M v[252:255], a[88:91], a[168:171], v[252:255]
 s_barrier
M v[32:35], a[96:99], a[160:163], v[32:35]
 s_add_u32 m0, s23, 16384
 ds_read_b128 a[168:171], v5 offset:51200
 ds_read_b128 a[172:175], v6 offset:51200
M v[32:35], a[100:103], a[164:167], v[32:35]
 ds_read_b64_tr_b16 a[32:33], v1 offset:32768
 ds_read_b64_tr_b16 a[34:35], v1 offset:33792
M v[36:39], a[108:111], a[164:167], v[36:39]
 buffer_load_dwordx4 v8, s[52:55], s28 offen offset:0   lds
M v[36:39], a[104:107], a[160:163], v[36:39]
 buffer_store_dword v12, v15, s[8:11], s45 offen sc1
M v[40:43], a[112:115], a[160:163], v[40:43]
 s_add_u32 s3, s93, 262144
 ds_read_b64_tr_b16 a[36:37], v1 offset:40960
 ds_read_b64_tr_b16 a[38:39], v1 offset:41984
M v[40:43], a[116:119], a[164:167], v[40:43]
 v_min_u32 v25, 15, v0
 v_lshlrev_b32 v25, 7, v25
M v[44:47], a[124:127], a[164:167], v[44:47]
 v_max_u32 v13, 1024, v25
M v[44:47], a[120:123], a[160:163], v[44:47]
 ds_read_b64_tr_b16 a[40:41], v2 offset:32768
 ds_read_b64_tr_b16 a[42:43], v2 offset:33792
M v[48:51], a[128:131], a[160:163], v[48:51]
 buffer_load_dwordx4 v9, s[52:55], s28 offen offset:1024   lds
M v[48:51], a[132:135], a[164:167], v[48:51]
 buffer_store_dwordx4 v[64:67], v7, s[8:11], s3 offen offset:0 sc1
M v[52:55], a[140:143], a[164:167], v[52:55]
 ds_read_b64_tr_b16 a[44:45], v2 offset:40960
 ds_read_b64_tr_b16 a[46:47], v2 offset:41984
M v[52:55], a[136:139], a[160:163], v[52:55]
M v[56:59], a[144:147], a[160:163], v[56:59]
M v[56:59], a[148:151], a[164:167], v[56:59]
 s_waitcnt lgkmcnt(8)
 ds_read_b64_tr_b16 a[48:49], v3 offset:32768
 ds_read_b64_tr_b16 a[50:51], v3 offset:33792
M v[60:63], a[156:159], a[164:167], v[60:63]
 buffer_load_dwordx4 v10, s[52:55], s28 offen offset:2048   lds
M v[60:63], a[152:155], a[160:163], v[60:63]
M v[68:71], a[96:99], a[168:171], v[68:71]
 ds_read_b128 a[160:163], v5 offset:53248
 ds_read_b128 a[164:167], v6 offset:53248
M v[68:71], a[100:103], a[172:175], v[68:71]
 ds_read_b64_tr_b16 a[52:53], v3 offset:40960
 ds_read_b64_tr_b16 a[54:55], v3 offset:41984
M v[76:79], a[108:111], a[172:175], v[76:79]
 buffer_store_dwordx4 v[72:75], v7, s[8:11], s3 offen offset:1024 sc1
M v[76:79], a[104:107], a[168:171], v[76:79]
 ds_read_b64_tr_b16 a[56:57], v4 offset:32768
 ds_read_b64_tr_b16 a[58:59], v4 offset:33792
M v[84:87], a[112:115], a[168:171], v[84:87]
M v[84:87], a[116:119], a[172:175], v[84:87]
 buffer_load_dwordx4 v11, s[52:55], s28 offen offset:3072   lds
M v[92:95], a[124:127], a[172:175], v[92:95]
 s_add_u32 s28, s28, 524160
 ds_read_b64_tr_b16 a[60:61], v4 offset:40960
 ds_read_b64_tr_b16 a[62:63], v4 offset:41984
M v[92:95], a[120:123], a[168:171], v[92:95]
M v[100:103], a[128:131], a[168:171], v[100:103]
M v[100:103], a[132:135], a[172:175], v[100:103]
M v[108:111], a[140:143], a[172:175], v[108:111]
M v[108:111], a[136:139], a[168:171], v[108:111]
M v[116:119], a[144:147], a[168:171], v[116:119]
M v[116:119], a[148:151], a[172:175], v[116:119]
 s_waitcnt lgkmcnt(6)
M v[124:127], a[156:159], a[172:175], v[124:127]
 s_waitcnt lgkmcnt(0)
M v[124:127], a[152:155], a[168:171], v[124:127]
 s_barrier
M v[132:135], a[96:99], a[160:163], v[132:135]
 ds_read_b128 a[168:171], v5 offset:55296
 ds_read_b128 a[172:175], v6 offset:55296
M v[132:135], a[100:103], a[164:167], v[132:135]
 ds_read_b64_tr_b16 a[64:65], v1 offset:49152
 ds_read_b64_tr_b16 a[66:67], v1 offset:50176
M v[140:143], a[108:111], a[164:167], v[140:143]
 buffer_store_dwordx4 v[80:83], v7, s[8:11], s3 offen offset:2048 sc1
M v[140:143], a[104:107], a[160:163], v[140:143]
M v[148:151], a[112:115], a[160:163], v[148:151]
 ds_read_b64_tr_b16 a[68:69], v1 offset:57344
 ds_read_b64_tr_b16 a[70:71], v1 offset:58368
M v[148:151], a[116:119], a[164:167], v[148:151]
M v[156:159], a[124:127], a[164:167], v[156:159]
M v[156:159], a[120:123], a[160:163], v[156:159]
 ds_read_b64_tr_b16 a[72:73], v2 offset:49152
 ds_read_b64_tr_b16 a[74:75], v2 offset:50176
M v[164:167], a[128:131], a[160:163], v[164:167]
M v[164:167], a[132:135], a[164:167], v[164:167]
M v[172:175], a[140:143], a[164:167], v[172:175]
 ds_read_b64_tr_b16 a[76:77], v2 offset:57344
 ds_read_b64_tr_b16 a[78:79], v2 offset:58368
M v[172:175], a[136:139], a[160:163], v[172:175]
M v[180:183], a[144:147], a[160:163], v[180:183]
M v[180:183], a[148:151], a[164:167], v[180:183]
 s_waitcnt lgkmcnt(8)
 ds_read_b64_tr_b16 a[80:81], v3 offset:49152
 ds_read_b64_tr_b16 a[82:83], v3 offset:50176
M v[188:191], a[156:159], a[164:167], v[188:191]
 buffer_store_dwordx4 v[88:91], v7, s[8:11], s3 offen offset:3072 sc1
M v[188:191], a[152:155], a[160:163], v[188:191]
M v[196:199], a[96:99], a[168:171], v[196:199]
 ds_read_b128 a[160:163], v5 offset:0
 ds_read_b128 a[164:167], v6 offset:0
M v[196:199], a[100:103], a[172:175], v[196:199]
 ds_read_b64_tr_b16 a[84:85], v3 offset:57344
 ds_read_b64_tr_b16 a[86:87], v3 offset:58368
M v[204:207], a[108:111], a[172:175], v[204:207]
M v[204:207], a[104:107], a[168:171], v[204:207]
 ds_read_b64_tr_b16 a[88:89], v4 offset:49152
 ds_read_b64_tr_b16 a[90:91], v4 offset:50176
M v[212:215], a[112:115], a[168:171], v[212:215]
M v[212:215], a[116:119], a[172:175], v[212:215]
M v[220:223], a[124:127], a[172:175], v[220:223]
 ds_read_b64_tr_b16 a[92:93], v4 offset:57344
 ds_read_b64_tr_b16 a[94:95], v4 offset:58368
M v[220:223], a[120:123], a[168:171], v[220:223]
M v[228:231], a[128:131], a[168:171], v[228:231]
M v[228:231], a[132:135], a[172:175], v[228:231]
M v[236:239], a[140:143], a[172:175], v[236:239]
M v[236:239], a[136:139], a[168:171], v[236:239]
M v[244:247], a[144:147], a[168:171], v[244:247]
M v[244:247], a[148:151], a[172:175], v[244:247]
 s_waitcnt lgkmcnt(6)
M v[252:255], a[156:159], a[172:175], v[252:255]
 s_waitcnt vmcnt(21) lgkmcnt(0)
M v[252:255], a[152:155], a[168:171], v[252:255]
 s_barrier
M v[32:35], a[32:35], a[160:163], v[32:35]
 s_add_u32 m0, s23, 32768
 ds_read_b128 a[168:171], v5 offset:2048
 ds_read_b128 a[172:175], v6 offset:2048
M v[32:35], a[36:39], a[164:167], v[32:35]
 ds_read_b64_tr_b16 a[96:97], v20 offset:0
 ds_read_b64_tr_b16 a[98:99], v20 offset:1024
M v[36:39], a[44:47], a[164:167], v[36:39]
 buffer_load_dwordx4 v16, s[56:59], s29 offen offset:0   lds
M v[36:39], a[40:43], a[160:163], v[36:39]
M v[40:43], a[48:51], a[160:163], v[40:43]
 s_add_u32 s3, s93, 270336
 ds_read_b64_tr_b16 a[100:101], v20 offset:8192
 ds_read_b64_tr_b16 a[102:103], v20 offset:9216
M v[40:43], a[52:55], a[164:167], v[40:43]
 buffer_load_dwordx4 v17, s[56:59], s29 offen offset:1024   lds
M v[44:47], a[60:63], a[164:167], v[44:47]
 buffer_store_dwordx4 v[96:99], v7, s[8:11], s3 offen offset:0 sc1
M v[44:47], a[56:59], a[160:163], v[44:47]
 ds_read_b64_tr_b16 a[104:105], v21 offset:0
 ds_read_b64_tr_b16 a[106:107], v21 offset:1024
M v[48:51], a[64:67], a[160:163], v[48:51]
M v[48:51], a[68:71], a[164:167], v[48:51]
 buffer_load_dwordx4 v18, s[56:59], s29 offen offset:2048   lds
M v[52:55], a[76:79], a[164:167], v[52:55]
 ds_read_b64_tr_b16 a[108:109], v21 offset:8192
 ds_read_b64_tr_b16 a[110:111], v21 offset:9216
M v[52:55], a[72:75], a[160:163], v[52:55]
M v[56:59], a[80:83], a[160:163], v[56:59]
M v[56:59], a[84:87], a[164:167], v[56:59]
 s_waitcnt lgkmcnt(8)
 ds_read_b64_tr_b16 a[112:113], v22 offset:0
 ds_read_b64_tr_b16 a[114:115], v22 offset:1024
M v[60:63], a[92:95], a[164:167], v[60:63]
 buffer_load_dwordx4 v19, s[56:59], s29 offen offset:3072   lds
M v[60:63], a[88:91], a[160:163], v[60:63]
 s_add_u32 s29, s29, 128
M v[68:71], a[32:35], a[168:171], v[68:71]
 ds_read_b128 a[160:163], v5 offset:4096
 ds_read_b128 a[164:167], v6 offset:4096
M v[68:71], a[36:39], a[172:175], v[68:71]
 ds_read_b64_tr_b16 a[116:117], v22 offset:8192
 ds_read_b64_tr_b16 a[118:119], v22 offset:9216
M v[76:79], a[44:47], a[172:175], v[76:79]
 s_lshl_b32 s28, s20, 13
 buffer_store_dwordx4 v[104:107], v7, s[8:11], s3 offen offset:1024 sc1
M v[76:79], a[40:43], a[168:171], v[76:79]
 s_lshl_b32 s21, s41, 20
 ds_read_b64_tr_b16 a[120:121], v23 offset:0
 ds_read_b64_tr_b16 a[122:123], v23 offset:1024
M v[84:87], a[48:51], a[168:171], v[84:87]
 s_mov_b32 s22, 0
M v[84:87], a[52:55], a[172:175], v[84:87]
 s_lshl_b32 s7, s41, 18
M v[92:95], a[60:63], a[172:175], v[92:95]
 s_add_u32 s7, s7, 100663296
 ds_read_b64_tr_b16 a[124:125], v23 offset:8192
 ds_read_b64_tr_b16 a[126:127], v23 offset:9216
M v[92:95], a[56:59], a[168:171], v[92:95]
 s_add_u32 s38, s7, 65536
M v[100:103], a[64:67], a[168:171], v[100:103]
 s_add_u32 s64, s42, 1
M v[100:103], a[68:71], a[172:175], v[100:103]
 s_min_u32 s64, s64, 10
M v[108:111], a[76:79], a[172:175], v[108:111]
 s_sub_u32 s27, s64, 2
 buffer_load_dword v24, v13, s[8:11], s46 offen sc1
M v[108:111], a[72:75], a[168:171], v[108:111]
 s_lshl_b32 s6, s64, 1
M v[116:119], a[80:83], a[168:171], v[116:119]
 s_sub_u32 s43, s6, 2
 s_lshl_b32 s64, s42, 16
 s_add_u32 s4, s21, s64
M v[116:119], a[84:87], a[172:175], v[116:119]
 s_waitcnt lgkmcnt(6)
 s_sub_u32 s26, 1114112, s64
 s_add_u32 s26, s26, s21
M v[124:127], a[92:95], a[172:175], v[124:127]
 s_waitcnt vmcnt(20) lgkmcnt(0)
 s_lshl_b32 s64, s42, 1
 s_sub_u32 s64, 32, s64
M v[124:127], a[88:91], a[168:171], v[124:127]
 s_barrier
M v[132:135], a[32:35], a[160:163], v[132:135]
 s_cmp_ge_u32 s42, 10
 ds_read_b128 a[168:171], v5 offset:6144
 ds_read_b128 a[172:175], v6 offset:6144
M v[132:135], a[36:39], a[164:167], v[132:135]
 s_cselect_b32 s25, s64, 32767
 ds_read_b64_tr_b16 a[128:129], v20 offset:16384
 ds_read_b64_tr_b16 a[130:131], v20 offset:17408
M v[140:143], a[44:47], a[164:167], v[140:143]
 s_mov_b32 s23, 0
 buffer_store_dwordx4 v[112:115], v7, s[8:11], s3 offen offset:2048 sc1
M v[140:143], a[40:43], a[160:163], v[140:143]
M v[148:151], a[48:51], a[160:163], v[148:151]
 ds_read_b64_tr_b16 a[132:133], v20 offset:24576
 ds_read_b64_tr_b16 a[134:135], v20 offset:25600
M v[148:151], a[52:55], a[164:167], v[148:151]
M v[156:159], a[60:63], a[164:167], v[156:159]
M v[156:159], a[56:59], a[160:163], v[156:159]
 ds_read_b64_tr_b16 a[136:137], v21 offset:16384
 ds_read_b64_tr_b16 a[138:139], v21 offset:17408
M v[164:167], a[64:67], a[160:163], v[164:167]
M v[164:167], a[68:71], a[164:167], v[164:167]
M v[172:175], a[76:79], a[164:167], v[172:175]
 ds_read_b64_tr_b16 a[140:141], v21 offset:24576
 ds_read_b64_tr_b16 a[142:143], v21 offset:25600
M v[172:175], a[72:75], a[160:163], v[172:175]
M v[180:183], a[80:83], a[160:163], v[180:183]
M v[180:183], a[84:87], a[164:167], v[180:183]
 s_waitcnt lgkmcnt(8)
 ds_read_b64_tr_b16 a[144:145], v22 offset:16384
 ds_read_b64_tr_b16 a[146:147], v22 offset:17408
M v[188:191], a[92:95], a[164:167], v[188:191]
 buffer_store_dwordx4 v[120:123], v7, s[8:11], s3 offen offset:3072 sc1
M v[188:191], a[88:91], a[160:163], v[188:191]
M v[196:199], a[32:35], a[168:171], v[196:199]
 ds_read_b128 a[160:163], v5 offset:16384
 ds_read_b128 a[164:167], v6 offset:16384
M v[196:199], a[36:39], a[172:175], v[196:199]
 ds_read_b64_tr_b16 a[148:149], v22 offset:24576
 ds_read_b64_tr_b16 a[150:151], v22 offset:25600
M v[204:207], a[44:47], a[172:175], v[204:207]
M v[204:207], a[40:43], a[168:171], v[204:207]
 ds_read_b64_tr_b16 a[152:153], v23 offset:16384
 ds_read_b64_tr_b16 a[154:155], v23 offset:17408
M v[212:215], a[48:51], a[168:171], v[212:215]
M v[212:215], a[52:55], a[172:175], v[212:215]
M v[220:223], a[60:63], a[172:175], v[220:223]
 ds_read_b64_tr_b16 a[156:157], v23 offset:24576
 ds_read_b64_tr_b16 a[158:159], v23 offset:25600
M v[220:223], a[56:59], a[168:171], v[220:223]
M v[228:231], a[64:67], a[168:171], v[228:231]
M v[228:231], a[68:71], a[172:175], v[228:231]
M v[236:239], a[76:79], a[172:175], v[236:239]
M v[236:239], a[72:75], a[168:171], v[236:239]
M v[244:247], a[80:83], a[168:171], v[244:247]
M v[244:247], a[84:87], a[172:175], v[244:247]
 s_waitcnt lgkmcnt(6)
M v[252:255], a[92:95], a[172:175], v[252:255]
 s_waitcnt vmcnt(18) lgkmcnt(0)
M v[252:255], a[88:91], a[168:171], v[252:255]
 s_barrier
M v[32:35], a[96:99], a[160:163], v[32:35]
 ds_read_b128 a[168:171], v5 offset:18432
 ds_read_b128 a[172:175], v6 offset:18432
M v[32:35], a[100:103], a[164:167], v[32:35]
 ds_read_b64_tr_b16 a[32:33], v1 offset:0
 ds_read_b64_tr_b16 a[34:35], v1 offset:1024
M v[36:39], a[108:111], a[164:167], v[36:39]
 v_add_u32 v10, s28, v7
 v_add_u32 v11, 0x1000, v10
M v[36:39], a[104:107], a[160:163], v[36:39]
 s_waitcnt vmcnt(2)
 v_cmp_eq_u32 vcc, 0, v24
 s_add_u32 s3, s93, 524288
M v[40:43], a[112:115], a[160:163], v[40:43]
 s_lshl_b32 s64, s20, 10
 ds_read_b64_tr_b16 a[36:37], v1 offset:8192
 ds_read_b64_tr_b16 a[38:39], v1 offset:9216
M v[40:43], a[116:119], a[164:167], v[40:43]
 s_cbranch_vccnz L_f1s14
L_f1r14:
M v[44:47], a[124:127], a[164:167], v[44:47]
 s_add_u32 m0, s28, 98304
 s_nop 0
 buffer_load_dwordx4 v10, s[8:11], s21 offen offset:0 sc1 lds
M v[44:47], a[120:123], a[160:163], v[44:47]
 ds_read_b64_tr_b16 a[40:41], v2 offset:0
 ds_read_b64_tr_b16 a[42:43], v2 offset:1024
M v[48:51], a[128:131], a[160:163], v[48:51]
 buffer_store_dwordx4 v[128:131], v7, s[8:11], s3 offen offset:0 sc1
M v[48:51], a[132:135], a[164:167], v[48:51]
M v[52:55], a[140:143], a[164:167], v[52:55]
 ds_read_b64_tr_b16 a[44:45], v2 offset:8192
 ds_read_b64_tr_b16 a[46:47], v2 offset:9216
M v[52:55], a[136:139], a[160:163], v[52:55]
 buffer_load_dwordx4 v10, s[8:11], s21 offen offset:1024 sc1 lds
M v[56:59], a[144:147], a[160:163], v[56:59]
M v[56:59], a[148:151], a[164:167], v[56:59]
 s_waitcnt lgkmcnt(8)
 ds_read_b64_tr_b16 a[48:49], v3 offset:0
 ds_read_b64_tr_b16 a[50:51], v3 offset:1024
M v[60:63], a[156:159], a[164:167], v[60:63]
M v[60:63], a[152:155], a[160:163], v[60:63]
 buffer_load_dwordx4 v10, s[8:11], s21 offen offset:2048 sc1 lds
M v[68:71], a[96:99], a[168:171], v[68:71]
 ds_read_b128 a[160:163], v5 offset:20480
 ds_read_b128 a[164:167], v6 offset:20480
M v[68:71], a[100:103], a[172:175], v[68:71]
 ds_read_b64_tr_b16 a[52:53], v3 offset:8192
 ds_read_b64_tr_b16 a[54:55], v3 offset:9216
M v[76:79], a[108:111], a[172:175], v[76:79]
 buffer_store_dwordx4 v[136:139], v7, s[8:11], s3 offen offset:1024 sc1
M v[76:79], a[104:107], a[168:171], v[76:79]
 ds_read_b64_tr_b16 a[56:57], v4 offset:0
 ds_read_b64_tr_b16 a[58:59], v4 offset:1024
M v[84:87], a[112:115], a[168:171], v[84:87]
 buffer_load_dwordx4 v10, s[8:11], s21 offen offset:3072 sc1 lds
M v[84:87], a[116:119], a[172:175], v[84:87]
 s_add_u32 m0, s28, 102400
M v[92:95], a[124:127], a[172:175], v[92:95]
 ds_read_b64_tr_b16 a[60:61], v4 offset:8192
 ds_read_b64_tr_b16 a[62:63], v4 offset:9216
M v[92:95], a[120:123], a[168:171], v[92:95]
M v[100:103], a[128:131], a[168:171], v[100:103]
 buffer_load_dwordx4 v11, s[8:11], s21 offen offset:0 sc1 lds
M v[100:103], a[132:135], a[172:175], v[100:103]
M v[108:111], a[140:143], a[172:175], v[108:111]
M v[108:111], a[136:139], a[168:171], v[108:111]
M v[116:119], a[144:147], a[168:171], v[116:119]
 buffer_load_dwordx4 v11, s[8:11], s21 offen offset:1024 sc1 lds
M v[116:119], a[148:151], a[172:175], v[116:119]
 s_waitcnt lgkmcnt(6)
M v[124:127], a[156:159], a[172:175], v[124:127]
 s_waitcnt lgkmcnt(0)
 buffer_load_dwordx4 v11, s[8:11], s21 offen offset:2048 sc1 lds
M v[124:127], a[152:155], a[168:171], v[124:127]
 s_barrier
M v[132:135], a[96:99], a[160:163], v[132:135]
 ds_read_b128 a[168:171], v5 offset:22528
 ds_read_b128 a[172:175], v6 offset:22528
M v[132:135], a[100:103], a[164:167], v[132:135]
 ds_read_b64_tr_b16 a[64:65], v1 offset:16384
 ds_read_b64_tr_b16 a[66:67], v1 offset:17408
M v[140:143], a[108:111], a[164:167], v[140:143]
 buffer_load_dwordx4 v11, s[8:11], s21 offen offset:3072 sc1 lds
M v[140:143], a[104:107], a[160:163], v[140:143]
 s_add_u32 s24, s23, 16777216
 buffer_store_dwordx4 v[144:147], v7, s[8:11], s3 offen offset:2048 sc1
M v[148:151], a[112:115], a[160:163], v[148:151]
 s_mov_b32 s23, s21
 ds_read_b64_tr_b16 a[68:69], v1 offset:24576
 ds_read_b64_tr_b16 a[70:71], v1 offset:25600
M v[148:151], a[116:119], a[164:167], v[148:151]
 s_add_u32 s21, s21, 32768
M v[156:159], a[124:127], a[164:167], v[156:159]
 s_add_u32 s22, s22, 1
M v[156:159], a[120:123], a[160:163], v[156:159]
 s_cmp_eq_u32 s22, s25
 ds_read_b64_tr_b16 a[72:73], v2 offset:16384
 ds_read_b64_tr_b16 a[74:75], v2 offset:17408
M v[164:167], a[128:131], a[160:163], v[164:167]
 s_cselect_b32 s21, s26, s21
 v_subrev_u32 v5, 0x10000, v5
 v_subrev_u32 v6, 0x10000, v6
M v[164:167], a[132:135], a[164:167], v[164:167]
 s_cmp_eq_u32 s22, s43
M v[172:175], a[140:143], a[164:167], v[172:175]
 s_cselect_b32 s21, s4, s21
 ds_read_b64_tr_b16 a[76:77], v2 offset:24576
 ds_read_b64_tr_b16 a[78:79], v2 offset:25600
M v[172:175], a[136:139], a[160:163], v[172:175]
 s_cmp_eq_u32 s22, s6
M v[180:183], a[144:147], a[160:163], v[180:183]
 s_cselect_b32 s21, s7, s21
 v_mov_b32 v9, v25
 v_lshrrev_b32 v24, 4, v0
M v[180:183], a[148:151], a[164:167], v[180:183]
 s_waitcnt lgkmcnt(8)
 ds_read_b64_tr_b16 a[80:81], v3 offset:16384
 ds_read_b64_tr_b16 a[82:83], v3 offset:17408
M v[188:191], a[156:159], a[164:167], v[188:191]
 v_lshlrev_b32 v24, 2, v24
 v_and_b32 v25, 15, v0
M v[188:191], a[152:155], a[160:163], v[188:191]
 v_sub_u32 v24, v24, v25
M v[196:199], a[96:99], a[168:171], v[196:199]
 s_add_u32 s64, s64, s34
 ds_read_b128 a[160:163], v5 offset:32768
 ds_read_b128 a[164:167], v6 offset:32768
M v[196:199], a[100:103], a[172:175], v[196:199]
 s_add_u32 s52, s64, 65536
 ds_read_b64_tr_b16 a[84:85], v3 offset:24576
 ds_read_b64_tr_b16 a[86:87], v3 offset:25600
M v[204:207], a[108:111], a[172:175], v[204:207]
 s_mov_b32 s55, 0x21800000
 buffer_store_dwordx4 v[152:155], v7, s[8:11], s3 offen offset:3072 sc1
M v[204:207], a[104:107], a[168:171], v[204:207]
 s_cmp_eq_u32 s20, 0
 ds_read_b64_tr_b16 a[88:89], v4 offset:16384
 ds_read_b64_tr_b16 a[90:91], v4 offset:17408
M v[212:215], a[112:115], a[168:171], v[212:215]
 s_cselect_b32 s54, s39, 0
M v[212:215], a[116:119], a[172:175], v[212:215]
 s_lshr_b32 s64, s20, 1
M v[220:223], a[124:127], a[172:175], v[220:223]
 s_lshl_b32 s64, s64, 17
 ds_read_b64_tr_b16 a[92:93], v4 offset:24576
 ds_read_b64_tr_b16 a[94:95], v4 offset:25600
M v[220:223], a[120:123], a[168:171], v[220:223]
 s_and_b32 s65, s20, 1
M v[228:231], a[128:131], a[168:171], v[228:231]
 s_lshl_b32 s65, s65, 12
M v[228:231], a[132:135], a[172:175], v[228:231]
 s_add_u32 s64, s64, s65
 v_add_u32 v14, s64, v7
 v_mov_b32 v8, 0xff800000
M v[236:239], a[140:143], a[172:175], v[236:239]
 v_cmp_lt_i32 s[16:17], 0, v24
 v_cmp_lt_i32 s[18:19], -1, v24
M v[236:239], a[136:139], a[168:171], v[236:239]
 v_cmp_lt_i32 s[48:49], -2, v24
 v_cmp_lt_i32 s[50:51], -3, v24
M v[244:247], a[144:147], a[168:171], v[244:247]
M v[244:247], a[148:151], a[172:175], v[244:247]
 s_waitcnt lgkmcnt(6)
M v[252:255], a[156:159], a[172:175], v[252:255]
 s_waitcnt lgkmcnt(0)
M v[252:255], a[152:155], a[168:171], v[252:255]
 s_barrier
M v[32:35], a[32:35], a[160:163], v[32:35]
 ds_read_b128 a[168:171], v5 offset:34816
 ds_read_b128 a[172:175], v6 offset:34816
M v[32:35], a[36:39], a[164:167], v[32:35]
 buffer_load_dword v24, v9, s[8:11], s46 offen sc1
M v[36:39], a[44:47], a[164:167], v[36:39]
 v_mov_b32 v1, v15
 v_add_u32 v2, 0x10000, v7
M v[36:39], a[40:43], a[160:163], v[36:39]
 v_mov_b32 v3, v10
 v_mov_b32 v4, v11
M v[40:43], a[48:51], a[160:163], v[40:43]
 s_mov_b64 s[60:61], s[76:77]
M v[40:43], a[52:55], a[164:167], v[40:43]
 s_mov_b32 s62, s78
M v[44:47], a[60:63], a[164:167], v[44:47]
 s_mov_b32 s63, 0x20000
 v_lshl_add_u32 v10, v0, 7, s95
 v_and_b32 v0, 48, v0
M v[44:47], a[56:59], a[160:163], v[44:47]
 v_lshl_add_u32 v0, v0, 24, v10
 v_mul_f32 v32, s5, v32
M v[48:51], a[64:67], a[160:163], v[48:51]
 v_mul_f32 v33, s5, v33
 v_mul_f32 v34, s5, v34
M v[48:51], a[68:71], a[164:167], v[48:51]
 v_mul_f32 v35, s5, v35
 v_mul_f32 v36, s5, v36
M v[52:55], a[76:79], a[164:167], v[52:55]
 v_mul_f32 v37, s5, v37
 v_mul_f32 v38, s5, v38
M v[52:55], a[72:75], a[160:163], v[52:55]
 v_mul_f32 v39, s5, v39
 v_cvt_pk_bf16_f32 v32, v32, v33
M v[56:59], a[80:83], a[160:163], v[56:59]
 v_cvt_pk_bf16_f32 v33, v34, v35
 v_cvt_pk_bf16_f32 v34, v36, v37
M v[56:59], a[84:87], a[164:167], v[56:59]
 s_waitcnt lgkmcnt(0)
 v_cvt_pk_bf16_f32 v35, v38, v39
 ds_write_b128 v14, v[32:35] offset:0
M v[60:63], a[92:95], a[164:167], v[60:63]
 s_add_u32 s3, s93, 532480
 buffer_store_dwordx4 v[160:163], v7, s[8:11], s3 offen offset:0 sc1
M v[60:63], a[88:91], a[160:163], v[60:63]
 v_mul_f32 v40, s5, v40
 v_mul_f32 v41, s5, v41
M v[68:71], a[32:35], a[168:171], v[68:71]
 ds_read_b128 a[160:163], v5 offset:36864
 ds_read_b128 a[164:167], v6 offset:36864
M v[68:71], a[36:39], a[172:175], v[68:71]
 v_mul_f32 v42, s5, v42
 v_mul_f32 v43, s5, v43
M v[76:79], a[44:47], a[172:175], v[76:79]
 v_mul_f32 v44, s5, v44
 v_mul_f32 v45, s5, v45
M v[76:79], a[40:43], a[168:171], v[76:79]
 v_mul_f32 v46, s5, v46
 v_mul_f32 v47, s5, v47
M v[84:87], a[48:51], a[168:171], v[84:87]
 v_cvt_pk_bf16_f32 v40, v40, v41
 v_cvt_pk_bf16_f32 v41, v42, v43
M v[84:87], a[52:55], a[172:175], v[84:87]
 v_cvt_pk_bf16_f32 v42, v44, v45
 v_cvt_pk_bf16_f32 v43, v46, v47
M v[92:95], a[60:63], a[172:175], v[92:95]
 ds_write_b128 v14, v[40:43] offset:1024
M v[92:95], a[56:59], a[168:171], v[92:95]
 buffer_store_dwordx4 v[168:171], v7, s[8:11], s3 offen offset:1024 sc1
M v[100:103], a[64:67], a[168:171], v[100:103]
 v_mul_f32 v48, s5, v48
 v_mul_f32 v49, s5, v49
M v[100:103], a[68:71], a[172:175], v[100:103]
 v_mul_f32 v50, s5, v50
 v_mul_f32 v51, s5, v51
M v[108:111], a[76:79], a[172:175], v[108:111]
 v_mul_f32 v52, s5, v52
 v_mul_f32 v53, s5, v53
M v[108:111], a[72:75], a[168:171], v[108:111]
 v_mul_f32 v54, s5, v54
 v_mul_f32 v55, s5, v55
M v[116:119], a[80:83], a[168:171], v[116:119]
 v_cvt_pk_bf16_f32 v48, v48, v49
 v_cvt_pk_bf16_f32 v49, v50, v51
M v[116:119], a[84:87], a[172:175], v[116:119]
 s_waitcnt lgkmcnt(1)
 v_cvt_pk_bf16_f32 v50, v52, v53
 v_cvt_pk_bf16_f32 v51, v54, v55
M v[124:127], a[92:95], a[172:175], v[124:127]
 ds_write_b128 v14, v[48:51] offset:2048
M v[124:127], a[88:91], a[168:171], v[124:127]
 buffer_store_dwordx4 v[176:179], v7, s[8:11], s3 offen offset:2048 sc1
M v[132:135], a[32:35], a[160:163], v[132:135]
 ds_read_b128 a[168:171], v5 offset:38912
 ds_read_b128 a[172:175], v6 offset:38912
M v[132:135], a[36:39], a[164:167], v[132:135]
 v_mul_f32 v56, s5, v56
 v_mul_f32 v57, s5, v57
M v[140:143], a[44:47], a[164:167], v[140:143]
 v_mul_f32 v58, s5, v58
 v_mul_f32 v59, s5, v59
M v[140:143], a[40:43], a[160:163], v[140:143]
 v_mul_f32 v60, s5, v60
 v_mul_f32 v61, s5, v61
M v[148:151], a[48:51], a[160:163], v[148:151]
 v_mul_f32 v62, s5, v62
 v_mul_f32 v63, s5, v63
M v[148:151], a[52:55], a[164:167], v[148:151]
 v_cvt_pk_bf16_f32 v56, v56, v57
 v_cvt_pk_bf16_f32 v57, v58, v59
M v[156:159], a[60:63], a[164:167], v[156:159]
 v_cvt_pk_bf16_f32 v58, v60, v61
 v_cvt_pk_bf16_f32 v59, v62, v63
M v[156:159], a[56:59], a[160:163], v[156:159]
 s_waitcnt lgkmcnt(0)
 ds_write_b128 v14, v[56:59] offset:3072
M v[164:167], a[64:67], a[160:163], v[164:167]
 s_barrier
M v[164:167], a[68:71], a[164:167], v[164:167]
M v[172:175], a[76:79], a[164:167], v[172:175]
 s_add_u32 m0, s28, 32768
 s_nop 0
 buffer_load_dwordx4 v3, s[8:11], s21 offen offset:0 sc1 lds
M v[172:175], a[72:75], a[160:163], v[172:175]
M v[180:183], a[80:83], a[160:163], v[180:183]
 buffer_store_dwordx4 v[184:187], v7, s[8:11], s3 offen offset:3072 sc1
M v[180:183], a[84:87], a[164:167], v[180:183]
 v_mul_f32 v68, s5, v68
 v_mul_f32 v69, s5, v69
M v[188:191], a[92:95], a[164:167], v[188:191]
 buffer_load_dwordx4 v3, s[8:11], s21 offen offset:1024 sc1 lds
M v[188:191], a[88:91], a[160:163], v[188:191]
 v_mul_f32 v70, s5, v70
 v_mul_f32 v71, s5, v71
M v[196:199], a[32:35], a[168:171], v[196:199]
 v_mul_f32 v76, s5, v76
 v_mul_f32 v77, s5, v77
M v[196:199], a[36:39], a[172:175], v[196:199]
 v_mul_f32 v78, s5, v78
 v_mul_f32 v79, s5, v79
M v[204:207], a[44:47], a[172:175], v[204:207]
 buffer_load_dwordx4 v3, s[8:11], s21 offen offset:2048 sc1 lds
M v[204:207], a[40:43], a[168:171], v[204:207]
 v_cvt_pk_bf16_f32 v68, v68, v69
 v_cvt_pk_bf16_f32 v69, v70, v71
M v[212:215], a[48:51], a[168:171], v[212:215]
 v_cvt_pk_bf16_f32 v70, v76, v77
 v_cvt_pk_bf16_f32 v71, v78, v79
M v[212:215], a[52:55], a[172:175], v[212:215]
 ds_write_b128 v14, v[68:71] offset:8192
 v_mul_f32 v84, s5, v84
M v[220:223], a[60:63], a[172:175], v[220:223]
 buffer_load_dwordx4 v3, s[8:11], s21 offen offset:3072 sc1 lds
M v[220:223], a[56:59], a[168:171], v[220:223]
 s_add_u32 m0, s28, 36864
 v_mul_f32 v85, s5, v85
 v_mul_f32 v86, s5, v86
M v[228:231], a[64:67], a[168:171], v[228:231]
 v_mul_f32 v87, s5, v87
 v_mul_f32 v92, s5, v92
M v[228:231], a[68:71], a[172:175], v[228:231]
 v_mul_f32 v93, s5, v93
 v_mul_f32 v94, s5, v94
M v[236:239], a[76:79], a[172:175], v[236:239]
 buffer_load_dwordx4 v4, s[8:11], s21 offen offset:0 sc1 lds
M v[236:239], a[72:75], a[168:171], v[236:239]
 v_mul_f32 v95, s5, v95
 v_cvt_pk_bf16_f32 v84, v84, v85
M v[244:247], a[80:83], a[168:171], v[244:247]
 v_cvt_pk_bf16_f32 v85, v86, v87
 v_cvt_pk_bf16_f32 v86, v92, v93
M v[244:247], a[84:87], a[172:175], v[244:247]
 v_cvt_pk_bf16_f32 v87, v94, v95
 ds_write_b128 v14, v[84:87] offset:9216
M v[252:255], a[92:95], a[172:175], v[252:255]
 buffer_load_dwordx4 v4, s[8:11], s21 offen offset:1024 sc1 lds
M v[252:255], a[88:91], a[168:171], v[252:255]
 buffer_load_dwordx4 v4, s[8:11], s21 offen offset:2048 sc1 lds
 buffer_load_dwordx4 v4, s[8:11], s21 offen offset:3072 sc1 lds
 s_add_u32 s24, s23, 16777216
 s_mov_b32 s23, s21
 s_add_u32 s21, s21, 32768
 s_add_u32 s22, s22, 1
 s_cmp_eq_u32 s22, s25
 s_cselect_b32 s21, s26, s21
 s_cmp_eq_u32 s22, s43
 s_cselect_b32 s21, s4, s21
 s_cmp_eq_u32 s22, s6
 s_cselect_b32 s21, s7, s21
 v_mul_f32 v100, s5, v100
 v_mul_f32 v101, s5, v101
 v_mul_f32 v102, s5, v102
 v_mul_f32 v103, s5, v103
 v_mul_f32 v108, s5, v108
 v_mul_f32 v109, s5, v109
 v_mul_f32 v110, s5, v110
 v_mul_f32 v111, s5, v111
 v_cvt_pk_bf16_f32 v100, v100, v101
 v_cvt_pk_bf16_f32 v101, v102, v103
 v_cvt_pk_bf16_f32 v102, v108, v109
 v_cvt_pk_bf16_f32 v103, v110, v111
 ds_write_b128 v14, v[100:103] offset:10240
 v_pk_mul_f32 v[116:117], v[116:117], s[4:5] op_sel:[0,1] op_sel_hi:[1,1]
 v_pk_mul_f32 v[118:119], v[118:119], s[4:5] op_sel:[0,1] op_sel_hi:[1,1]
 v_pk_mul_f32 v[124:125], v[124:125], s[4:5] op_sel:[0,1] op_sel_hi:[1,1]
 v_pk_mul_f32 v[126:127], v[126:127], s[4:5] op_sel:[0,1] op_sel_hi:[1,1]
 v_cvt_pk_bf16_f32 v116, v116, v117
 v_cvt_pk_bf16_f32 v117, v118, v119
 v_cvt_pk_bf16_f32 v118, v124, v125
 v_cvt_pk_bf16_f32 v119, v126, v127
 ds_write_b128 v14, v[116:119] offset:11264
 v_pk_mul_f32 v[132:133], v[132:133], s[4:5] op_sel:[0,1] op_sel_hi:[1,1]
 v_pk_mul_f32 v[134:135], v[134:135], s[4:5] op_sel:[0,1] op_sel_hi:[1,1]
 v_pk_mul_f32 v[140:141], v[140:141], s[4:5] op_sel:[0,1] op_sel_hi:[1,1]
 v_pk_mul_f32 v[142:143], v[142:143], s[4:5] op_sel:[0,1] op_sel_hi:[1,1]
 v_cvt_pk_bf16_f32 v132, v132, v133
 v_cvt_pk_bf16_f32 v133, v134, v135
 v_cvt_pk_bf16_f32 v134, v140, v141
 v_cvt_pk_bf16_f32 v135, v142, v143
 ds_write_b128 v14, v[132:135] offset:16384
 v_pk_mul_f32 v[148:149], v[148:149], s[4:5] op_sel:[0,1] op_sel_hi:[1,1]
 v_pk_mul_f32 v[150:151], v[150:151], s[4:5] op_sel:[0,1] op_sel_hi:[1,1]
 v_pk_mul_f32 v[156:157], v[156:157], s[4:5] op_sel:[0,1] op_sel_hi:[1,1]
 v_pk_mul_f32 v[158:159], v[158:159], s[4:5] op_sel:[0,1] op_sel_hi:[1,1]
 v_cvt_pk_bf16_f32 v148, v148, v149
 v_cvt_pk_bf16_f32 v149, v150, v151
 v_cvt_pk_bf16_f32 v150, v156, v157
 v_cvt_pk_bf16_f32 v151, v158, v159
 ds_write_b128 v14, v[148:151] offset:17408
 v_pk_mul_f32 v[164:165], v[164:165], s[4:5] op_sel:[0,1] op_sel_hi:[1,1]
 v_pk_mul_f32 v[166:167], v[166:167], s[4:5] op_sel:[0,1] op_sel_hi:[1,1]
 v_pk_mul_f32 v[172:173], v[172:173], s[4:5] op_sel:[0,1] op_sel_hi:[1,1]
 v_pk_mul_f32 v[174:175], v[174:175], s[4:5] op_sel:[0,1] op_sel_hi:[1,1]
 v_cvt_pk_bf16_f32 v164, v164, v165
 v_cvt_pk_bf16_f32 v165, v166, v167
 v_cvt_pk_bf16_f32 v166, v172, v173
 v_cvt_pk_bf16_f32 v167, v174, v175
 ds_write_b128 v14, v[164:167] offset:18432
 v_pk_mul_f32 v[180:181], v[180:181], s[4:5] op_sel:[0,1] op_sel_hi:[1,1]
 v_pk_mul_f32 v[182:183], v[182:183], s[4:5] op_sel:[0,1] op_sel_hi:[1,1]
 v_pk_mul_f32 v[188:189], v[188:189], s[4:5] op_sel:[0,1] op_sel_hi:[1,1]
 v_pk_mul_f32 v[190:191], v[190:191], s[4:5] op_sel:[0,1] op_sel_hi:[1,1]
 v_cvt_pk_bf16_f32 v180, v180, v181
 v_cvt_pk_bf16_f32 v181, v182, v183
 v_cvt_pk_bf16_f32 v182, v188, v189
 v_cvt_pk_bf16_f32 v183, v190, v191
 ds_write_b128 v14, v[180:183] offset:19456
 v_pk_mul_f32 v[196:197], v[196:197], s[4:5] op_sel:[0,1] op_sel_hi:[1,1]
 v_pk_mul_f32 v[198:199], v[198:199], s[4:5] op_sel:[0,1] op_sel_hi:[1,1]
 v_pk_mul_f32 v[204:205], v[204:205], s[4:5] op_sel:[0,1] op_sel_hi:[1,1]
 v_pk_mul_f32 v[206:207], v[206:207], s[4:5] op_sel:[0,1] op_sel_hi:[1,1]
 v_cvt_pk_bf16_f32 v196, v196, v197
 v_cvt_pk_bf16_f32 v197, v198, v199
 v_cvt_pk_bf16_f32 v198, v204, v205
 v_cvt_pk_bf16_f32 v199, v206, v207
 ds_write_b128 v14, v[196:199] offset:24576
 v_pk_mul_f32 v[212:213], v[212:213], s[4:5] op_sel:[0,1] op_sel_hi:[1,1]
 v_pk_mul_f32 v[214:215], v[214:215], s[4:5] op_sel:[0,1] op_sel_hi:[1,1]
 v_pk_mul_f32 v[220:221], v[220:221], s[4:5] op_sel:[0,1] op_sel_hi:[1,1]
 v_pk_mul_f32 v[222:223], v[222:223], s[4:5] op_sel:[0,1] op_sel_hi:[1,1]
 v_cvt_pk_bf16_f32 v212, v212, v213
 v_cvt_pk_bf16_f32 v213, v214, v215
 v_cvt_pk_bf16_f32 v214, v220, v221
 v_cvt_pk_bf16_f32 v215, v222, v223
 ds_write_b128 v14, v[212:215] offset:25600
 v_pk_mul_f32 v[228:229], v[228:229], s[4:5] op_sel:[0,1] op_sel_hi:[1,1]
 v_pk_mul_f32 v[230:231], v[230:231], s[4:5] op_sel:[0,1] op_sel_hi:[1,1]
 v_pk_mul_f32 v[236:237], v[236:237], s[4:5] op_sel:[0,1] op_sel_hi:[1,1]
 v_pk_mul_f32 v[238:239], v[238:239], s[4:5] op_sel:[0,1] op_sel_hi:[1,1]
 v_cvt_pk_bf16_f32 v228, v228, v229
 v_cvt_pk_bf16_f32 v229, v230, v231
 v_cvt_pk_bf16_f32 v230, v236, v237
 v_cvt_pk_bf16_f32 v231, v238, v239
 ds_write_b128 v14, v[228:231] offset:26624
 v_pk_mul_f32 v[244:245], v[244:245], s[4:5] op_sel:[0,1] op_sel_hi:[1,1]
 v_pk_mul_f32 v[246:247], v[246:247], s[4:5] op_sel:[0,1] op_sel_hi:[1,1]
 v_pk_mul_f32 v[252:253], v[252:253], s[4:5] op_sel:[0,1] op_sel_hi:[1,1]
 v_pk_mul_f32 v[254:255], v[254:255], s[4:5] op_sel:[0,1] op_sel_hi:[1,1]
 v_cvt_pk_bf16_f32 v244, v244, v245
 v_cvt_pk_bf16_f32 v245, v246, v247
 v_cvt_pk_bf16_f32 v246, v252, v253
 v_cvt_pk_bf16_f32 v247, v254, v255
 ds_write_b128 v14, v[244:247] offset:27648
 s_waitcnt vmcnt(15) lgkmcnt(0)
 s_barrier
 ds_read_b128 a[64:67], v2 offset:32768
 ds_read_b128 a[68:71], v2 offset:33792
 ds_read_b128 a[72:75], v2 offset:34816
 ds_read_b128 a[76:79], v2 offset:35840
 ds_read_b128 a[80:83], v2 offset:36864
 ds_read_b128 a[84:87], v2 offset:37888
 ds_read_b128 a[88:91], v2 offset:38912
 ds_read_b128 a[92:95], v2 offset:39936
 s_lshl_b32 s64, s20, 13
 s_sub_u32 s65, 155648, s64
 v_add_u32 v10, s64, v7
 v_add_u32 v11, s65, v7
 ds_read_b128 a[0:3], v10 offset:0
 ds_read_b128 a[4:7], v10 offset:1024
 ds_read_b128 a[8:11], v10 offset:2048
 ds_read_b128 a[12:15], v10 offset:3072
 ds_read_b128 a[16:19], v10 offset:4096
 ds_read_b128 a[20:23], v10 offset:5120
 ds_read_b128 a[24:27], v10 offset:6144
 ds_read_b128 a[28:31], v10 offset:7168
 ds_read_b128 a[32:35], v11 offset:0
 ds_read_b128 a[36:39], v11 offset:1024
 ds_read_b128 a[40:43], v11 offset:2048
 ds_read_b128 a[44:47], v11 offset:3072
 ds_read_b128 a[48:51], v11 offset:4096
 ds_read_b128 a[52:55], v11 offset:5120
 ds_read_b128 a[56:59], v11 offset:6144
 ds_read_b128 a[60:63], v11 offset:7168
 s_waitcnt vmcnt(12)
 v_cmp_eq_u32 vcc, 0, v24
 v_mov_b32 v17, 3
 v_or_b32 v6, s35, v7
 s_cbranch_vccnz L_f1s15
L_f1r15:
 s_mov_b32 s30, s93
 s_mov_b32 s29, s94
 s_cmp_eq_u32 s20, 0
 s_cselect_b32 s5, 4, 0
 v_mov_b32 v32, 0xc1800000
 v_mov_b32 v33, 0xc1800000
 v_mov_b32 v34, 0xc1800000
 v_mov_b32 v35, 0xc1800000
 v_mov_b32 v36, 0xc1800000
 v_mov_b32 v37, 0xc1800000
 v_mov_b32 v38, 0xc1800000
 v_mov_b32 v39, 0xc1800000
 s_waitcnt lgkmcnt(0)
M v[64:67], a[64:67], a[0:3], v[32:35]
 ds_read_b128 a[96:99], v2 offset:40960
 v_mov_b32 v30, 0
M v[64:67], a[68:71], a[4:7], v[64:67]
 s_add_u32 m0, s28, 65536
 ds_read_b128 a[100:103], v2 offset:41984
 v_mov_b32 v31, 0
M v[64:67], a[72:75], a[8:11], v[64:67]
 buffer_load_dwordx4 v3, s[8:11], s24 offen offset:0 sc1 lds
M v[64:67], a[76:79], a[12:15], v[64:67]
 ds_read_b128 a[104:107], v2 offset:43008
 v_accvgpr_write_b32 a128, v192
M v[64:67], a[80:83], a[16:19], v[64:67]
 ds_read_b128 a[108:111], v2 offset:44032
 v_accvgpr_write_b32 a129, v193
M v[64:67], a[84:87], a[20:23], v[64:67]
 buffer_load_dwordx4 v3, s[8:11], s24 offen offset:1024 sc1 lds
M v[64:67], a[88:91], a[24:27], v[64:67]
 ds_read_b128 a[112:115], v2 offset:45056
 v_accvgpr_write_b32 a130, v194
M v[64:67], a[92:95], a[28:31], v[64:67]
 ds_read_b128 a[116:119], v2 offset:46080
 v_accvgpr_write_b32 a131, v195
M v[68:71], a[92:95], a[60:63], v[36:39]
 v_accvgpr_write_b32 a132, v200
 v_accvgpr_write_b32 a133, v201
M v[68:71], a[88:91], a[56:59], v[68:71]
 ds_read_b128 a[120:123], v2 offset:47104
 v_accvgpr_write_b32 a134, v202
M v[68:71], a[84:87], a[52:55], v[68:71]
 ds_read_b128 a[124:127], v2 offset:48128
 v_accvgpr_write_b32 a135, v203
M v[68:71], a[80:83], a[48:51], v[68:71]
 buffer_load_dwordx4 v3, s[8:11], s24 offen offset:2048 sc1 lds
M v[68:71], a[76:79], a[44:47], v[68:71]
 v_accvgpr_write_b32 a136, v208
 v_accvgpr_write_b32 a137, v209
M v[68:71], a[72:75], a[40:43], v[68:71]
 v_accvgpr_write_b32 a138, v210
 v_accvgpr_write_b32 a139, v211
M v[68:71], a[68:71], a[36:39], v[68:71]
 v_exp_f32 v18, v64
M v[68:71], a[64:67], a[32:35], v[68:71]
 s_waitcnt lgkmcnt(0)
 v_exp_f32 v19, v65
M v[72:75], a[96:99], a[0:3], v[32:35]
 ds_read_b128 a[64:67], v2 offset:49152
 v_add_f32 v26, v18, v19
M v[72:75], a[100:103], a[4:7], v[72:75]
 ds_read_b128 a[68:71], v2 offset:50176
 v_cvt_pk_bf16_f32 v40, v18, v19
M v[72:75], a[104:107], a[8:11], v[72:75]
 buffer_load_dwordx4 v3, s[8:11], s24 offen offset:3072 sc1 lds
M v[72:75], a[108:111], a[12:15], v[72:75]
 ds_read_b128 a[72:75], v2 offset:51200
 v_accvgpr_write_b32 a140, v216
M v[72:75], a[112:115], a[16:19], v[72:75]
 s_add_u32 m0, s28, 69632
 ds_read_b128 a[76:79], v2 offset:52224
 v_accvgpr_write_b32 a141, v217
M v[72:75], a[116:119], a[20:23], v[72:75]
 buffer_load_dwordx4 v4, s[8:11], s24 offen offset:0 sc1 lds
M v[72:75], a[120:123], a[24:27], v[72:75]
 ds_read_b128 a[80:83], v2 offset:53248
 v_accvgpr_write_b32 a142, v218
M v[72:75], a[124:127], a[28:31], v[72:75]
 s_add_u32 s3, s32, 0
 ds_read_b128 a[84:87], v2 offset:54272
 v_accvgpr_write_b32 a143, v219
M v[76:79], a[124:127], a[60:63], v[36:39]
 buffer_store_dwordx4 a[0:3], v6, s[8:11], s3 offen offset:0 sc1
M v[76:79], a[120:123], a[56:59], v[76:79]
 ds_read_b128 a[88:91], v2 offset:55296
 v_accvgpr_write_b32 a144, v224
M v[76:79], a[116:119], a[52:55], v[76:79]
 ds_read_b128 a[92:95], v2 offset:56320
 v_accvgpr_write_b32 a145, v225
M v[76:79], a[112:115], a[48:51], v[76:79]
 buffer_load_dwordx4 v4, s[8:11], s24 offen offset:1024 sc1 lds
M v[76:79], a[108:111], a[44:47], v[76:79]
 v_exp_f32 v20, v66
M v[76:79], a[104:107], a[40:43], v[76:79]
 buffer_store_dwordx4 a[4:7], v6, s[8:11], s3 offen offset:1024 sc1
M v[76:79], a[100:103], a[36:39], v[76:79]
 v_exp_f32 v21, v67
M v[76:79], a[96:99], a[32:35], v[76:79]
 s_waitcnt lgkmcnt(0)
 v_exp_f32 v22, v68
M v[80:83], a[64:67], a[0:3], v[32:35]
 ds_read_b128 a[96:99], v2 offset:57344
 v_add_f32 v26, v20, v26
M v[80:83], a[68:71], a[4:7], v[80:83]
 ds_read_b128 a[100:103], v2 offset:58368
 v_cvt_pk_bf16_f32 v41, v20, v21
M v[80:83], a[72:75], a[8:11], v[80:83]
 buffer_load_dwordx4 v4, s[8:11], s24 offen offset:2048 sc1 lds
M v[80:83], a[76:79], a[12:15], v[80:83]
 ds_read_b128 a[104:107], v2 offset:59392
 v_add_f32 v26, v21, v26
M v[80:83], a[80:83], a[16:19], v[80:83]
 ds_read_b128 a[108:111], v2 offset:60416
 v_accvgpr_write_b32 a146, v226
M v[80:83], a[84:87], a[20:23], v[80:83]
 buffer_store_dwordx4 a[8:11], v6, s[8:11], s3 offen offset:2048 sc1
M v[80:83], a[88:91], a[24:27], v[80:83]
 ds_read_b128 a[112:115], v2 offset:61440
 v_accvgpr_write_b32 a147, v227
M v[80:83], a[92:95], a[28:31], v[80:83]
 ds_read_b128 a[116:119], v2 offset:62464
 v_accvgpr_write_b32 a148, v232
M v[84:87], a[92:95], a[60:63], v[36:39]
 buffer_load_dwordx4 v4, s[8:11], s24 offen offset:3072 sc1 lds
M v[84:87], a[88:91], a[56:59], v[84:87]
 ds_read_b128 a[120:123], v2 offset:63488
 v_accvgpr_write_b32 a149, v233
M v[84:87], a[84:87], a[52:55], v[84:87]
 ds_read_b128 a[124:127], v2 offset:64512
 v_accvgpr_write_b32 a150, v234
M v[84:87], a[80:83], a[48:51], v[84:87]
 buffer_store_dwordx4 a[12:15], v6, s[8:11], s3 offen offset:3072 sc1
M v[84:87], a[76:79], a[44:47], v[84:87]
 s_add_u32 s3, s32, 4096
 v_exp_f32 v23, v69
M v[84:87], a[72:75], a[40:43], v[84:87]
 buffer_store_dwordx4 a[16:19], v6, s[8:11], s3 offen offset:0 sc1
M v[84:87], a[68:71], a[36:39], v[84:87]
 s_waitcnt vmcnt(13) lgkmcnt(0)
 v_exp_f32 v24, v70
M v[84:87], a[64:67], a[32:35], v[84:87]
 s_barrier
M v[88:91], a[96:99], a[0:3], v[32:35]
 ds_read_b128 a[64:67], v7 offset:32768
 v_add_f32 v27, v22, v23
M v[88:91], a[100:103], a[4:7], v[88:91]
 ds_read_b128 a[68:71], v7 offset:33792
 v_cvt_pk_bf16_f32 v44, v22, v23
M v[88:91], a[104:107], a[8:11], v[88:91]
 buffer_store_dword v17, v1, s[8:11], s45 offen sc1
M v[88:91], a[108:111], a[12:15], v[88:91]
 ds_read_b128 a[72:75], v7 offset:34816
 v_accvgpr_write_b32 a151, v235
M v[88:91], a[112:115], a[16:19], v[88:91]
 ds_read_b128 a[76:79], v7 offset:35840
 v_accvgpr_write_b32 a152, v240
M v[88:91], a[116:119], a[20:23], v[88:91]
 buffer_store_dwordx4 a[20:23], v6, s[8:11], s3 offen offset:1024 sc1
M v[88:91], a[120:123], a[24:27], v[88:91]
 ds_read_b128 a[80:83], v7 offset:36864
 v_accvgpr_write_b32 a153, v241
M v[88:91], a[124:127], a[28:31], v[88:91]
 ds_read_b128 a[84:87], v7 offset:37888
 v_accvgpr_write_b32 a154, v242
M v[92:95], a[124:127], a[60:63], v[36:39]
 buffer_store_dwordx4 a[24:27], v6, s[8:11], s3 offen offset:2048 sc1
M v[92:95], a[120:123], a[56:59], v[92:95]
 ds_read_b128 a[88:91], v7 offset:38912
 v_accvgpr_write_b32 a155, v243
M v[92:95], a[116:119], a[52:55], v[92:95]
 ds_read_b128 a[92:95], v7 offset:39936
 v_accvgpr_write_b32 a156, v248
M v[92:95], a[112:115], a[48:51], v[92:95]
 buffer_store_dwordx4 a[28:31], v6, s[8:11], s3 offen offset:3072 sc1
M v[92:95], a[108:111], a[44:47], v[92:95]
 v_exp_f32 v25, v71
M v[92:95], a[104:107], a[40:43], v[92:95]
 v_exp_f32 v18, v72
M v[92:95], a[100:103], a[36:39], v[92:95]
 s_waitcnt lgkmcnt(0)
 v_exp_f32 v19, v73
M v[92:95], a[96:99], a[32:35], v[92:95]
 v_exp_f32 v20, v74
M v[96:99], a[64:67], a[0:3], v[32:35]
 s_add_u32 m0, s28, 98304
 ds_read_b128 a[96:99], v7 offset:40960
 ds_read_b128 a[100:103], v7 offset:41984
M v[96:99], a[68:71], a[4:7], v[96:99]
 buffer_load_dwordx4 v3, s[8:11], s21 offen offset:0 sc1 lds
M v[96:99], a[72:75], a[8:11], v[96:99]
 v_exp_f32 v21, v75
M v[96:99], a[76:79], a[12:15], v[96:99]
 s_add_u32 s3, s32, 8192
 ds_read_b128 a[104:107], v7 offset:43008
 ds_read_b128 a[108:111], v7 offset:44032
M v[96:99], a[80:83], a[16:19], v[96:99]
 buffer_store_dwordx4 a[32:35], v6, s[8:11], s3 offen offset:0 sc1
M v[96:99], a[84:87], a[20:23], v[96:99]
 v_exp_f32 v22, v76
M v[96:99], a[88:91], a[24:27], v[96:99]
 ds_read_b128 a[112:115], v7 offset:45056
 ds_read_b128 a[116:119], v7 offset:46080
M v[96:99], a[92:95], a[28:31], v[96:99]
 buffer_load_dwordx4 v3, s[8:11], s21 offen offset:1024 sc1 lds
M v[100:103], a[92:95], a[60:63], v[36:39]
 v_exp_f32 v23, v77
M v[100:103], a[88:91], a[56:59], v[100:103]
 ds_read_b128 a[120:123], v7 offset:47104
 ds_read_b128 a[124:127], v7 offset:48128
M v[100:103], a[84:87], a[52:55], v[100:103]
 buffer_store_dwordx4 a[36:39], v6, s[8:11], s3 offen offset:1024 sc1
M v[100:103], a[80:83], a[48:51], v[100:103]
 v_add_f32 v27, v24, v27
 v_cvt_pk_bf16_f32 v45, v24, v25
M v[100:103], a[76:79], a[44:47], v[100:103]
 buffer_load_dwordx4 v3, s[8:11], s21 offen offset:2048 sc1 lds
M v[100:103], a[72:75], a[40:43], v[100:103]
 v_add_f32 v27, v25, v27
 v_add_f32 v26, v18, v26
M v[100:103], a[68:71], a[36:39], v[100:103]
 v_exp_f32 v24, v78
M v[100:103], a[64:67], a[32:35], v[100:103]
 s_waitcnt lgkmcnt(0)
 v_exp_f32 v25, v79
M v[104:107], a[96:99], a[0:3], v[32:35]
 ds_read_b128 a[64:67], v7 offset:49152
 ds_read_b128 a[68:71], v7 offset:50176
M v[104:107], a[100:103], a[4:7], v[104:107]
 buffer_load_dwordx4 v3, s[8:11], s21 offen offset:3072 sc1 lds
M v[104:107], a[104:107], a[8:11], v[104:107]
 v_cvt_pk_bf16_f32 v42, v18, v19
 v_add_f32 v26, v19, v26
M v[104:107], a[108:111], a[12:15], v[104:107]
 ds_read_b128 a[72:75], v7 offset:51200
 ds_read_b128 a[76:79], v7 offset:52224
M v[104:107], a[112:115], a[16:19], v[104:107]
 buffer_store_dwordx4 a[40:43], v6, s[8:11], s3 offen offset:2048 sc1
M v[104:107], a[116:119], a[20:23], v[104:107]
 v_exp_f32 v18, v80
M v[104:107], a[120:123], a[24:27], v[104:107]
 s_add_u32 m0, s28, 102400
 ds_read_b128 a[80:83], v7 offset:53248
 ds_read_b128 a[84:87], v7 offset:54272
M v[104:107], a[124:127], a[28:31], v[104:107]
 buffer_load_dwordx4 v4, s[8:11], s21 offen offset:0 sc1 lds
M v[108:111], a[124:127], a[60:63], v[36:39]
 v_exp_f32 v19, v81
M v[108:111], a[120:123], a[56:59], v[108:111]
 ds_read_b128 a[88:91], v7 offset:55296
 ds_read_b128 a[92:95], v7 offset:56320
M v[108:111], a[116:119], a[52:55], v[108:111]
 buffer_store_dwordx4 a[44:47], v6, s[8:11], s3 offen offset:3072 sc1
M v[108:111], a[112:115], a[48:51], v[108:111]
 v_add_f32 v26, v20, v26
 v_cvt_pk_bf16_f32 v43, v20, v21
M v[108:111], a[108:111], a[44:47], v[108:111]
 buffer_load_dwordx4 v4, s[8:11], s21 offen offset:1024 sc1 lds
M v[108:111], a[104:107], a[40:43], v[108:111]
 s_add_u32 s3, s32, 12288
 v_add_f32 v26, v21, v26
 v_add_f32 v27, v22, v27
M v[108:111], a[100:103], a[36:39], v[108:111]
 buffer_store_dwordx4 a[48:51], v6, s[8:11], s3 offen offset:0 sc1
M v[108:111], a[96:99], a[32:35], v[108:111]
 s_waitcnt lgkmcnt(0)
 v_exp_f32 v20, v82
M v[112:115], a[64:67], a[0:3], v[32:35]
 ds_read_b128 a[96:99], v7 offset:57344
 ds_read_b128 a[100:103], v7 offset:58368
M v[112:115], a[68:71], a[4:7], v[112:115]
 buffer_load_dwordx4 v4, s[8:11], s21 offen offset:2048 sc1 lds
M v[112:115], a[72:75], a[8:11], v[112:115]
 v_exp_f32 v21, v83
M v[112:115], a[76:79], a[12:15], v[112:115]
 ds_read_b128 a[104:107], v7 offset:59392
 ds_read_b128 a[108:111], v7 offset:60416
M v[112:115], a[80:83], a[16:19], v[112:115]
 buffer_load_dwordx4 v4, s[8:11], s21 offen offset:3072 sc1 lds
M v[112:115], a[84:87], a[20:23], v[112:115]
 s_add_u32 s24, s23, 16777216
 v_cvt_pk_bf16_f32 v46, v22, v23
 v_add_f32 v27, v23, v27
M v[112:115], a[88:91], a[24:27], v[112:115]
 s_mov_b32 s23, s21
 ds_read_b128 a[112:115], v7 offset:61440
 ds_read_b128 a[116:119], v7 offset:62464
M v[112:115], a[92:95], a[28:31], v[112:115]
 buffer_store_dwordx4 a[52:55], v6, s[8:11], s3 offen offset:1024 sc1
M v[116:119], a[92:95], a[60:63], v[36:39]
 s_add_u32 s21, s21, 32768
 v_add_f32 v27, v24, v27
M v[116:119], a[88:91], a[56:59], v[116:119]
 s_add_u32 s22, s22, 1
 ds_read_b128 a[120:123], v7 offset:63488
 ds_read_b128 a[124:127], v7 offset:64512
M v[116:119], a[84:87], a[52:55], v[116:119]
 s_cmp_eq_u32 s22, s25
 v_exp_f32 v22, v88
M v[116:119], a[80:83], a[48:51], v[116:119]
 s_cselect_b32 s21, s26, s21
 v_exp_f32 v23, v89
M v[116:119], a[76:79], a[44:47], v[116:119]
 buffer_store_dwordx4 a[56:59], v6, s[8:11], s3 offen offset:2048 sc1
M v[116:119], a[72:75], a[40:43], v[116:119]
 s_cmp_eq_u32 s22, s43
 v_cvt_pk_bf16_f32 v47, v24, v25
 v_add_f32 v27, v25, v27
M v[116:119], a[68:71], a[36:39], v[116:119]
 s_waitcnt vmcnt(21) lgkmcnt(0)
 v_exp_f32 v24, v90
M v[116:119], a[64:67], a[32:35], v[116:119]
 s_barrier
M v[120:123], a[96:99], a[0:3], v[32:35]
 s_cselect_b32 s21, s4, s21
 ds_read_b128 a[64:67], v2 offset:0
 ds_read_b128 a[68:71], v2 offset:1024
M v[120:123], a[100:103], a[4:7], v[120:123]
 s_cmp_eq_u32 s22, s6
 v_exp_f32 v25, v91
M v[120:123], a[104:107], a[8:11], v[120:123]
 s_cselect_b32 s21, s7, s21
 v_add_f32 v26, v18, v26
 v_cvt_pk_bf16_f32 v56, v18, v19
M v[120:123], a[108:111], a[12:15], v[120:123]
 ds_read_b128 a[72:75], v2 offset:2048
 ds_read_b128 a[76:79], v2 offset:3072
M v[120:123], a[112:115], a[16:19], v[120:123]
 buffer_store_dwordx4 a[60:63], v6, s[8:11], s3 offen offset:3072 sc1
M v[120:123], a[116:119], a[20:23], v[120:123]
 v_add_f32 v26, v19, v26
 v_add_f32 v26, v20, v26
M v[120:123], a[120:123], a[24:27], v[120:123]
 ds_read_b128 a[80:83], v2 offset:4096
 ds_read_b128 a[84:87], v2 offset:5120
M v[120:123], a[124:127], a[28:31], v[120:123]
 v_exp_f32 v18, v84
M v[124:127], a[124:127], a[60:63], v[36:39]
 v_exp_f32 v19, v85
M v[124:127], a[120:123], a[56:59], v[124:127]
 ds_read_b128 a[88:91], v2 offset:6144
 ds_read_b128 a[92:95], v2 offset:7168
M v[124:127], a[116:119], a[52:55], v[124:127]
 v_cvt_pk_bf16_f32 v57, v20, v21
 v_add_f32 v26, v21, v26
M v[124:127], a[112:115], a[48:51], v[124:127]
 v_exp_f32 v20, v86
M v[124:127], a[108:111], a[44:47], v[124:127]
 v_exp_f32 v21, v87
M v[124:127], a[104:107], a[40:43], v[124:127]
 v_add_f32 v26, v22, v26
 v_cvt_pk_bf16_f32 v58, v22, v23
M v[124:127], a[100:103], a[36:39], v[124:127]
 s_waitcnt lgkmcnt(0)
 v_add_f32 v26, v23, v26
 v_add_f32 v26, v24, v26
M v[124:127], a[96:99], a[32:35], v[124:127]
 v_exp_f32 v22, v92
 v_cvt_pk_bf16_f32 v59, v24, v25
 v_add_f32 v26, v25, v26
 v_add_f32 v27, v18, v27
 v_cvt_pk_bf16_f32 v60, v18, v19
 v_add_f32 v27, v19, v27
 v_exp_f32 v23, v93
 v_add_f32 v27, v20, v27
 v_cvt_pk_bf16_f32 v61, v20, v21
 v_add_f32 v27, v21, v27
 v_exp_f32 v24, v94
 v_add_f32 v27, v22, v27
 v_cvt_pk_bf16_f32 v62, v22, v23
 v_exp_f32 v25, v95
 v_add_f32 v27, v23, v27
 v_add_f32 v27, v24, v27
 v_cvt_pk_bf16_f32 v63, v24, v25
 v_add_f32 v27, v25, v27
 v_max_f32 v10, v26, v27
 v_min_f32 v11, v26, v27
 v_cmp_lt_f32 s[36:37], s31, v10
 v_cmp_gt_f32 vcc, s55, v11
 s_nop 0
 s_or_b64 vcc, vcc, s[36:37]
 s_cbranch_vccnz L_st8
L_rt8:
M v[128:131], a[64:67], v[40:43], 0
 s_add_u32 m0, s28, 0
 ds_read_b128 a[96:99], v2 offset:8192
 ds_read_b128 a[100:103], v2 offset:9216
M v[128:131], a[68:71], v[56:59], v[128:131]
 buffer_load_dwordx4 v3, s[8:11], s24 offen offset:0 sc1 lds
M v[132:135], a[68:71], v[60:63], 0
 v_accvgpr_write_b32 a157, v249
 v_accvgpr_write_b32 a158, v250
M v[132:135], a[64:67], v[44:47], v[132:135]
 ds_read_b128 a[104:107], v2 offset:10240
 ds_read_b128 a[108:111], v2 offset:11264
M v[136:139], a[72:75], v[40:43], 0
 buffer_load_dwordx4 v3, s[8:11], s24 offen offset:1024 sc1 lds
M v[136:139], a[76:79], v[56:59], v[136:139]
 v_accvgpr_write_b32 a159, v251
 v_add_f32 v30, v26, v30
M v[140:143], a[76:79], v[60:63], 0
 ds_read_b128 a[112:115], v2 offset:12288
 ds_read_b128 a[116:119], v2 offset:13312
M v[140:143], a[72:75], v[44:47], v[140:143]
 buffer_load_dwordx4 v3, s[8:11], s24 offen offset:2048 sc1 lds
M v[144:147], a[80:83], v[40:43], 0
 v_exp_f32 v18, v96
M v[144:147], a[84:87], v[56:59], v[144:147]
 ds_read_b128 a[120:123], v2 offset:14336
 ds_read_b128 a[124:127], v2 offset:15360
M v[148:151], a[84:87], v[60:63], 0
 buffer_load_dwordx4 v3, s[8:11], s24 offen offset:3072 sc1 lds
M v[148:151], a[80:83], v[44:47], v[148:151]
 s_add_u32 m0, s28, 4096
 v_exp_f32 v19, v97
M v[152:155], a[88:91], v[40:43], 0
 buffer_load_dwordx4 v4, s[8:11], s24 offen offset:0 sc1 lds
M v[152:155], a[92:95], v[56:59], v[152:155]
 v_exp_f32 v20, v98
M v[156:159], a[92:95], v[60:63], 0
 v_exp_f32 v21, v99
M v[156:159], a[88:91], v[44:47], v[156:159]
 s_waitcnt lgkmcnt(0)
 v_exp_f32 v22, v104
M v[160:163], a[96:99], v[40:43], 0
 ds_read_b128 a[64:67], v2 offset:16384
 ds_read_b128 a[68:71], v2 offset:17408
M v[160:163], a[100:103], v[56:59], v[160:163]
 buffer_load_dwordx4 v4, s[8:11], s24 offen offset:1024 sc1 lds
M v[164:167], a[100:103], v[60:63], 0
 v_exp_f32 v23, v105
M v[164:167], a[96:99], v[44:47], v[164:167]
 ds_read_b128 a[72:75], v2 offset:18432
 ds_read_b128 a[76:79], v2 offset:19456
M v[168:171], a[104:107], v[40:43], 0
 buffer_load_dwordx4 v4, s[8:11], s24 offen offset:2048 sc1 lds
M v[168:171], a[108:111], v[56:59], v[168:171]
 v_add_f32 v31, v27, v31
 v_add_f32 v28, v18, v19
M v[172:175], a[108:111], v[60:63], 0
 ds_read_b128 a[80:83], v2 offset:20480
 ds_read_b128 a[84:87], v2 offset:21504
M v[172:175], a[104:107], v[44:47], v[172:175]
 buffer_load_dwordx4 v4, s[8:11], s24 offen offset:3072 sc1 lds
M v[176:179], a[112:115], v[40:43], 0
 v_exp_f32 v24, v106
M v[176:179], a[116:119], v[56:59], v[176:179]
 s_add_u32 m0, s28, 32768
 ds_read_b128 a[88:91], v2 offset:22528
 ds_read_b128 a[92:95], v2 offset:23552
M v[180:183], a[116:119], v[60:63], 0
 buffer_load_dwordx4 v3, s[8:11], s21 offen offset:0 sc1 lds
M v[180:183], a[112:115], v[44:47], v[180:183]
 v_exp_f32 v25, v107
M v[184:187], a[120:123], v[40:43], 0
 buffer_load_dwordx4 v3, s[8:11], s21 offen offset:1024 sc1 lds
M v[184:187], a[124:127], v[56:59], v[184:187]
 v_cvt_pk_bf16_f32 v48, v18, v19
 v_add_f32 v28, v20, v28
M v[188:191], a[124:127], v[60:63], 0
 buffer_load_dwordx4 v3, s[8:11], s21 offen offset:2048 sc1 lds
M v[188:191], a[120:123], v[44:47], v[188:191]
 s_waitcnt lgkmcnt(0)
 v_exp_f32 v18, v100
M v[192:195], a[64:67], v[40:43], 0
 ds_read_b128 a[96:99], v2 offset:24576
 ds_read_b128 a[100:103], v2 offset:25600
M v[192:195], a[68:71], v[56:59], v[192:195]
 buffer_load_dwordx4 v3, s[8:11], s21 offen offset:3072 sc1 lds
M v[196:199], a[68:71], v[60:63], 0
 v_exp_f32 v19, v101
M v[196:199], a[64:67], v[44:47], v[196:199]
 s_add_u32 m0, s28, 36864
 ds_read_b128 a[104:107], v2 offset:26624
 ds_read_b128 a[108:111], v2 offset:27648
M v[200:203], a[72:75], v[40:43], 0
 buffer_load_dwordx4 v4, s[8:11], s21 offen offset:0 sc1 lds
M v[200:203], a[76:79], v[56:59], v[200:203]
 v_cvt_pk_bf16_f32 v49, v20, v21
 v_add_f32 v28, v21, v28
M v[204:207], a[76:79], v[60:63], 0
 ds_read_b128 a[112:115], v2 offset:28672
 ds_read_b128 a[116:119], v2 offset:29696
M v[204:207], a[72:75], v[44:47], v[204:207]
 buffer_load_dwordx4 v4, s[8:11], s21 offen offset:1024 sc1 lds
M v[208:211], a[80:83], v[40:43], 0
 v_exp_f32 v20, v102
M v[208:211], a[84:87], v[56:59], v[208:211]
 ds_read_b128 a[120:123], v2 offset:30720
 ds_read_b128 a[124:127], v2 offset:31744
M v[212:215], a[84:87], v[60:63], 0
 buffer_load_dwordx4 v4, s[8:11], s21 offen offset:2048 sc1 lds
M v[212:215], a[80:83], v[44:47], v[212:215]
 v_exp_f32 v21, v103
M v[216:219], a[88:91], v[40:43], 0
 v_add_f32 v28, v22, v28
 v_cvt_pk_bf16_f32 v50, v22, v23
M v[216:219], a[92:95], v[56:59], v[216:219]
 buffer_load_dwordx4 v4, s[8:11], s21 offen offset:3072 sc1 lds
M v[220:223], a[92:95], v[60:63], 0
 s_waitcnt vmcnt(16) lgkmcnt(0)
 s_add_u32 s24, s23, 16777216
 s_mov_b32 s23, s21
M v[220:223], a[88:91], v[44:47], v[220:223]
 s_barrier
M v[224:227], a[96:99], v[40:43], 0
 ds_read_b128 a[64:67], v2 offset:32768
 ds_read_b128 a[68:71], v2 offset:33792
M v[224:227], a[100:103], v[56:59], v[224:227]
 s_xor_b32 s3, s47, 64
 v_mov_b32 v15, 1
M v[228:231], a[100:103], v[60:63], 0
 v_or_b32 v16, s35, v1
 s_add_u32 s21, s21, 32768
M v[228:231], a[96:99], v[44:47], v[228:231]
 s_add_u32 s22, s22, 1
 ds_read_b128 a[72:75], v2 offset:34816
 ds_read_b128 a[76:79], v2 offset:35840
M v[232:235], a[104:107], v[40:43], 0
 buffer_store_dword v15, v16, s[8:11], s3 offen sc1
M v[232:235], a[108:111], v[56:59], v[232:235]
 s_cmp_eq_u32 s22, s25
 v_add_f32 v28, v23, v28
 v_add_f32 v28, v24, v28
M v[236:239], a[108:111], v[60:63], 0
 s_cselect_b32 s21, s26, s21
 ds_read_b128 a[80:83], v2 offset:36864
 ds_read_b128 a[84:87], v2 offset:37888
M v[236:239], a[104:107], v[44:47], v[236:239]
 s_cmp_eq_u32 s22, s43
 v_exp_f32 v22, v108
M v[240:243], a[112:115], v[40:43], 0
 s_cselect_b32 s21, s4, s21
 v_exp_f32 v23, v109
M v[240:243], a[116:119], v[56:59], v[240:243]
 s_cmp_eq_u32 s22, s6
 ds_read_b128 a[88:91], v2 offset:38912
 ds_read_b128 a[92:95], v2 offset:39936
M v[244:247], a[116:119], v[60:63], 0
 s_cselect_b32 s21, s7, s21
 v_cvt_pk_bf16_f32 v51, v24, v25
 v_add_f32 v28, v25, v28
M v[244:247], a[112:115], v[44:47], v[244:247]
 v_exp_f32 v24, v110
M v[248:251], a[120:123], v[40:43], 0
 v_exp_f32 v25, v111
M v[248:251], a[124:127], v[56:59], v[248:251]
 v_add_f32 v29, v18, v19
 v_cvt_pk_bf16_f32 v52, v18, v19
M v[252:255], a[124:127], v[60:63], 0
 s_waitcnt lgkmcnt(0)
 v_add_f32 v29, v20, v29
 v_cvt_pk_bf16_f32 v53, v20, v21
M v[252:255], a[120:123], v[44:47], v[252:255]
 v_add_f32 v29, v21, v29
 v_add_f32 v29, v22, v29
 v_cvt_pk_bf16_f32 v54, v22, v23
 v_add_f32 v29, v23, v29
 v_add_f32 v29, v24, v29
 v_cvt_pk_bf16_f32 v55, v24, v25
 v_add_f32 v29, v25, v29
M v[64:67], a[64:67], a[0:3], v[32:35]
 s_add_u32 m0, s28, 65536
 ds_read_b128 a[96:99], v2 offset:40960
 ds_read_b128 a[100:103], v2 offset:41984
M v[64:67], a[68:71], a[4:7], v[64:67]
 buffer_load_dwordx4 v3, s[8:11], s24 offen offset:0 sc1 lds
M v[64:67], a[72:75], a[8:11], v[64:67]
 v_exp_f32 v18, v112
M v[64:67], a[76:79], a[12:15], v[64:67]
 s_add_u32 s3, s30, 786432
 ds_read_b128 a[104:107], v2 offset:43008
 ds_read_b128 a[108:111], v2 offset:44032
M v[64:67], a[80:83], a[16:19], v[64:67]
 buffer_store_dwordx4 a[128:131], v7, s[8:11], s3 offen offset:0 sc1
M v[64:67], a[84:87], a[20:23], v[64:67]
 s_cmp_eq_u32 s20, 0
 v_exp_f32 v19, v113
M v[64:67], a[88:91], a[24:27], v[64:67]
 s_cselect_b64 s[64:65], s[16:17], 0
 ds_read_b128 a[112:115], v2 offset:45056
 ds_read_b128 a[116:119], v2 offset:46080
M v[64:67], a[92:95], a[28:31], v[64:67]
 buffer_load_dwordx4 v3, s[8:11], s24 offen offset:1024 sc1 lds
M v[68:71], a[92:95], a[60:63], v[36:39]
 s_cselect_b64 s[66:67], s[18:19], 0
 v_exp_f32 v20, v114
M v[68:71], a[88:91], a[56:59], v[68:71]
 s_cselect_b64 s[68:69], s[48:49], 0
 ds_read_b128 a[120:123], v2 offset:47104
 ds_read_b128 a[124:127], v2 offset:48128
M v[68:71], a[84:87], a[52:55], v[68:71]
 buffer_store_dwordx4 a[132:135], v7, s[8:11], s3 offen offset:1024 sc1
M v[68:71], a[80:83], a[48:51], v[68:71]
 s_cselect_b64 s[70:71], s[50:51], 0
 v_exp_f32 v21, v115
M v[68:71], a[76:79], a[44:47], v[68:71]
 s_cmp_lt_u32 s20, 1
 v_add_f32 v28, v18, v28
 v_cvt_pk_bf16_f32 v56, v18, v19
M v[68:71], a[72:75], a[40:43], v[68:71]
 buffer_load_dwordx4 v3, s[8:11], s24 offen offset:2048 sc1 lds
M v[68:71], a[68:71], a[36:39], v[68:71]
 s_cselect_b64 s[78:79], -1, 0
 v_exp_f32 v22, v120
M v[68:71], a[64:67], a[32:35], v[68:71]
 s_waitcnt lgkmcnt(0)
 v_add_f32 v28, v19, v28
 v_add_f32 v28, v20, v28
M v[72:75], a[96:99], a[0:3], v[32:35]
 s_cmp_eq_u32 s20, 1
 ds_read_b128 a[64:67], v2 offset:49152
 ds_read_b128 a[68:71], v2 offset:50176
M v[72:75], a[100:103], a[4:7], v[72:75]
 buffer_store_dwordx4 a[136:139], v7, s[8:11], s3 offen offset:2048 sc1
M v[72:75], a[104:107], a[8:11], v[72:75]
 s_cselect_b64 s[72:73], s[16:17], s[78:79]
 v_exp_f32 v23, v121
M v[72:75], a[108:111], a[12:15], v[72:75]
 s_cselect_b64 s[74:75], s[18:19], s[78:79]
 ds_read_b128 a[72:75], v2 offset:51200
 ds_read_b128 a[76:79], v2 offset:52224
M v[72:75], a[112:115], a[16:19], v[72:75]
 buffer_load_dwordx4 v3, s[8:11], s24 offen offset:3072 sc1 lds
M v[72:75], a[116:119], a[20:23], v[72:75]
 s_cselect_b64 s[76:77], s[48:49], s[78:79]
 v_exp_f32 v24, v122
M v[72:75], a[120:123], a[24:27], v[72:75]
 s_cselect_b64 s[78:79], s[50:51], s[78:79]
 ds_read_b128 a[80:83], v2 offset:53248
 ds_read_b128 a[84:87], v2 offset:54272
M v[72:75], a[124:127], a[28:31], v[72:75]
 buffer_store_dwordx4 a[140:143], v7, s[8:11], s3 offen offset:3072 sc1
M v[76:79], a[124:127], a[60:63], v[36:39]
 v_exp_f32 v25, v123
M v[76:79], a[120:123], a[56:59], v[76:79]
 s_add_u32 m0, s28, 69632
 ds_read_b128 a[88:91], v2 offset:55296
 ds_read_b128 a[92:95], v2 offset:56320
M v[76:79], a[116:119], a[52:55], v[76:79]
 buffer_load_dwordx4 v4, s[8:11], s24 offen offset:0 sc1 lds
M v[76:79], a[112:115], a[48:51], v[76:79]
 v_cvt_pk_bf16_f32 v57, v20, v21
 v_add_f32 v28, v21, v28
M v[76:79], a[108:111], a[44:47], v[76:79]
 v_exp_f32 v18, v116
M v[76:79], a[104:107], a[40:43], v[76:79]
 v_add_f32 v28, v22, v28
 v_cvt_pk_bf16_f32 v58, v22, v23
M v[76:79], a[100:103], a[36:39], v[76:79]
 v_add_f32 v28, v23, v28
 v_add_f32 v28, v24, v28
M v[76:79], a[96:99], a[32:35], v[76:79]
 s_waitcnt lgkmcnt(0)
 v_exp_f32 v19, v117
M v[80:83], a[64:67], a[0:3], v[32:35]
 s_add_u32 s3, s30, 794624
 ds_read_b128 a[96:99], v2 offset:57344
 ds_read_b128 a[100:103], v2 offset:58368
M v[80:83], a[68:71], a[4:7], v[80:83]
 buffer_store_dwordx4 a[144:147], v7, s[8:11], s3 offen offset:0 sc1
M v[80:83], a[72:75], a[8:11], v[80:83]
 v_cvt_pk_bf16_f32 v59, v24, v25
 v_add_f32 v28, v25, v28
M v[80:83], a[76:79], a[12:15], v[80:83]
 ds_read_b128 a[104:107], v2 offset:59392
 ds_read_b128 a[108:111], v2 offset:60416
M v[80:83], a[80:83], a[16:19], v[80:83]
 buffer_load_dwordx4 v4, s[8:11], s24 offen offset:1024 sc1 lds
M v[80:83], a[84:87], a[20:23], v[80:83]
 v_exp_f32 v20, v118
M v[80:83], a[88:91], a[24:27], v[80:83]
 ds_read_b128 a[112:115], v2 offset:61440
 ds_read_b128 a[116:119], v2 offset:62464
M v[80:83], a[92:95], a[28:31], v[80:83]
 buffer_load_dwordx4 v4, s[8:11], s24 offen offset:2048 sc1 lds
M v[84:87], a[92:95], a[60:63], v[36:39]
 v_exp_f32 v21, v119
M v[84:87], a[88:91], a[56:59], v[84:87]
 ds_read_b128 a[120:123], v2 offset:63488
 ds_read_b128 a[124:127], v2 offset:64512
M v[84:87], a[84:87], a[52:55], v[84:87]
 buffer_store_dwordx4 a[148:151], v7, s[8:11], s3 offen offset:1024 sc1
M v[84:87], a[80:83], a[48:51], v[84:87]
 v_exp_f32 v22, v124
M v[84:87], a[76:79], a[44:47], v[84:87]
 buffer_load_dwordx4 v4, s[8:11], s24 offen offset:3072 sc1 lds
M v[84:87], a[72:75], a[40:43], v[84:87]
 v_exp_f32 v23, v125
M v[84:87], a[68:71], a[36:39], v[84:87]
 s_waitcnt vmcnt(23) lgkmcnt(0)
 v_add_f32 v29, v18, v29
 v_cvt_pk_bf16_f32 v60, v18, v19
M v[84:87], a[64:67], a[32:35], v[84:87]
 s_barrier
M v[88:91], a[96:99], a[0:3], v[32:35]
 ds_read_b128 a[64:67], v7 offset:0
 ds_read_b128 a[68:71], v7 offset:1024
M v[88:91], a[100:103], a[4:7], v[88:91]
 buffer_store_dwordx4 a[152:155], v7, s[8:11], s3 offen offset:2048 sc1
M v[88:91], a[104:107], a[8:11], v[88:91]
 v_exp_f32 v24, v126
M v[88:91], a[108:111], a[12:15], v[88:91]
 ds_read_b128 a[72:75], v7 offset:2048
 ds_read_b128 a[76:79], v7 offset:3072
M v[88:91], a[112:115], a[16:19], v[88:91]
 buffer_store_dwordx4 a[156:159], v7, s[8:11], s3 offen offset:3072 sc1
M v[88:91], a[116:119], a[20:23], v[88:91]
 v_exp_f32 v25, v127
M v[88:91], a[120:123], a[24:27], v[88:91]
 ds_read_b128 a[80:83], v7 offset:4096
 ds_read_b128 a[84:87], v7 offset:5120
M v[88:91], a[124:127], a[28:31], v[88:91]
 v_add_f32 v29, v19, v29
 v_add_f32 v29, v20, v29
M v[92:95], a[124:127], a[60:63], v[36:39]
 v_cvt_pk_bf16_f32 v61, v20, v21
 v_add_f32 v29, v21, v29
M v[92:95], a[120:123], a[56:59], v[92:95]
 ds_read_b128 a[88:91], v7 offset:6144
 ds_read_b128 a[92:95], v7 offset:7168
M v[92:95], a[116:119], a[52:55], v[92:95]
 v_add_f32 v29, v22, v29
 v_cvt_pk_bf16_f32 v62, v22, v23
M v[92:95], a[112:115], a[48:51], v[92:95]
 v_add_f32 v29, v23, v29
 v_add_f32 v29, v24, v29
M v[92:95], a[108:111], a[44:47], v[92:95]
 v_cvt_pk_bf16_f32 v63, v24, v25
 v_add_f32 v29, v25, v29
M v[92:95], a[104:107], a[40:43], v[92:95]
M v[92:95], a[100:103], a[36:39], v[92:95]
 s_waitcnt lgkmcnt(0)
M v[92:95], a[96:99], a[32:35], v[92:95]
 v_max_f32 v10, v28, v29
 v_cmp_lt_f32 vcc, s31, v10
 s_nop 0
 s_cbranch_vccnz L_st9
L_rt9:
M v[128:131], a[64:67], v[48:51], v[128:131]
 s_add_u32 s3, s29, 0
 ds_read_b128 a[96:99], v7 offset:8192
 ds_read_b128 a[100:103], v7 offset:9216
M v[128:131], a[68:71], v[56:59], v[128:131]
 buffer_store_dwordx4 a[192:195], v7, s[8:11], s3 offen sc1
M v[132:135], a[68:71], v[60:63], v[132:135]
 s_cmp_eq_u32 s20, 3
 v_exp_f32 v18, v64
M v[132:135], a[64:67], v[52:55], v[132:135]
 s_cselect_b64 s[88:89], s[16:17], -1
 ds_read_b128 a[104:107], v7 offset:10240
 ds_read_b128 a[108:111], v7 offset:11264
M v[136:139], a[72:75], v[48:51], v[136:139]
 s_cselect_b64 s[90:91], s[18:19], -1
 v_exp_f32 v19, v65
M v[136:139], a[76:79], v[56:59], v[136:139]
 s_cselect_b64 s[92:93], s[48:49], -1
 v_add_f32 v30, v28, v30
 v_add_f32 v31, v29, v31
M v[140:143], a[76:79], v[60:63], v[140:143]
 s_cselect_b64 s[94:95], s[50:51], -1
 ds_read_b128 a[112:115], v7 offset:12288
 ds_read_b128 a[116:119], v7 offset:13312
M v[140:143], a[72:75], v[52:55], v[140:143]
 s_add_u32 m0, s28, 98304
 v_exp_f32 v20, v66
M v[144:147], a[80:83], v[48:51], v[144:147]
 buffer_load_dwordx4 v3, s[8:11], s21 offen offset:0 sc1 lds
M v[144:147], a[84:87], v[56:59], v[144:147]
 s_add_u32 s3, s29, 32768
 ds_read_b128 a[120:123], v7 offset:14336
 ds_read_b128 a[124:127], v7 offset:15360
M v[148:151], a[84:87], v[60:63], v[148:151]
 buffer_store_dwordx4 a[196:199], v7, s[8:11], s3 offen sc1
M v[148:151], a[80:83], v[52:55], v[148:151]
 v_exp_f32 v21, v67
M v[152:155], a[88:91], v[48:51], v[152:155]
 buffer_load_dwordx4 v3, s[8:11], s21 offen offset:1024 sc1 lds
M v[152:155], a[92:95], v[56:59], v[152:155]
 s_add_u32 s3, s29, 65536
 v_add_f32 v26, v18, v19
 v_cvt_pk_bf16_f32 v40, v18, v19
M v[156:159], a[92:95], v[60:63], v[156:159]
 buffer_store_dwordx4 a[200:203], v7, s[8:11], s3 offen sc1
M v[156:159], a[88:91], v[52:55], v[156:159]
 s_waitcnt lgkmcnt(0)
 v_exp_f32 v22, v72
M v[160:163], a[96:99], v[48:51], v[160:163]
 ds_read_b128 a[64:67], v7 offset:16384
 ds_read_b128 a[68:71], v7 offset:17408
M v[160:163], a[100:103], v[56:59], v[160:163]
 buffer_load_dwordx4 v3, s[8:11], s21 offen offset:2048 sc1 lds
M v[164:167], a[100:103], v[60:63], v[164:167]
 v_exp_f32 v23, v73
M v[164:167], a[96:99], v[52:55], v[164:167]
 s_add_u32 s3, s29, 98304
 ds_read_b128 a[72:75], v7 offset:18432
 ds_read_b128 a[76:79], v7 offset:19456
M v[168:171], a[104:107], v[48:51], v[168:171]
 buffer_store_dwordx4 a[204:207], v7, s[8:11], s3 offen sc1
M v[168:171], a[108:111], v[56:59], v[168:171]
 v_add_f32 v26, v20, v26
 v_cvt_pk_bf16_f32 v41, v20, v21
M v[172:175], a[108:111], v[60:63], v[172:175]
 ds_read_b128 a[80:83], v7 offset:20480
 ds_read_b128 a[84:87], v7 offset:21504
M v[172:175], a[104:107], v[52:55], v[172:175]
 buffer_load_dwordx4 v3, s[8:11], s21 offen offset:3072 sc1 lds
M v[176:179], a[112:115], v[48:51], v[176:179]
 v_exp_f32 v24, v74
M v[176:179], a[116:119], v[56:59], v[176:179]
 s_add_u32 s3, s29, 131072
 ds_read_b128 a[88:91], v7 offset:22528
 ds_read_b128 a[92:95], v7 offset:23552
M v[180:183], a[116:119], v[60:63], v[180:183]
 buffer_store_dwordx4 a[208:211], v7, s[8:11], s3 offen sc1
M v[180:183], a[112:115], v[52:55], v[180:183]
 s_add_u32 m0, s28, 102400
 v_exp_f32 v25, v75
M v[184:187], a[120:123], v[48:51], v[184:187]
 buffer_load_dwordx4 v4, s[8:11], s21 offen offset:0 sc1 lds
M v[184:187], a[124:127], v[56:59], v[184:187]
 s_add_u32 s3, s29, 163840
 v_exp_f32 v18, v68
M v[188:191], a[124:127], v[60:63], v[188:191]
 buffer_store_dwordx4 a[212:215], v7, s[8:11], s3 offen sc1
M v[188:191], a[120:123], v[52:55], v[188:191]
 s_waitcnt lgkmcnt(0)
 v_add_f32 v26, v21, v26
 v_add_f32 v26, v22, v26
M v[192:195], a[64:67], v[48:51], v[192:195]
 s_add_u32 s3, s29, 196608
 ds_read_b128 a[96:99], v7 offset:24576
 ds_read_b128 a[100:103], v7 offset:25600
M v[192:195], a[68:71], v[56:59], v[192:195]
 buffer_store_dwordx4 a[216:219], v7, s[8:11], s3 offen sc1
M v[196:199], a[68:71], v[60:63], v[196:199]
 v_exp_f32 v19, v69
M v[196:199], a[64:67], v[52:55], v[196:199]
 ds_read_b128 a[104:107], v7 offset:26624
 ds_read_b128 a[108:111], v7 offset:27648
M v[200:203], a[72:75], v[48:51], v[200:203]
 buffer_load_dwordx4 v4, s[8:11], s21 offen offset:1024 sc1 lds
M v[200:203], a[76:79], v[56:59], v[200:203]
 v_exp_f32 v20, v70
M v[204:207], a[76:79], v[60:63], v[204:207]
 ds_read_b128 a[112:115], v7 offset:28672
 ds_read_b128 a[116:119], v7 offset:29696
M v[204:207], a[72:75], v[52:55], v[204:207]
 buffer_load_dwordx4 v4, s[8:11], s21 offen offset:2048 sc1 lds
M v[208:211], a[80:83], v[48:51], v[208:211]
 v_exp_f32 v21, v71
M v[208:211], a[84:87], v[56:59], v[208:211]
 ds_read_b128 a[120:123], v7 offset:30720
 ds_read_b128 a[124:127], v7 offset:31744
M v[212:215], a[84:87], v[60:63], v[212:215]
 buffer_load_dwordx4 v4, s[8:11], s21 offen offset:3072 sc1 lds
M v[212:215], a[80:83], v[52:55], v[212:215]
 s_add_u32 s24, s23, 16777216
 v_cvt_pk_bf16_f32 v42, v22, v23
 v_add_f32 v26, v23, v26
M v[216:219], a[88:91], v[48:51], v[216:219]
 s_mov_b32 s23, s21
 v_exp_f32 v22, v76
M v[216:219], a[92:95], v[56:59], v[216:219]
 s_add_u32 s21, s21, 32768
 s_add_u32 s22, s22, 1
 v_add_f32 v26, v24, v26
M v[220:223], a[92:95], v[60:63], v[220:223]
 s_waitcnt vmcnt(32) lgkmcnt(0)
 v_cvt_pk_bf16_f32 v43, v24, v25
 v_add_f32 v26, v25, v26
M v[220:223], a[88:91], v[52:55], v[220:223]
 s_barrier
M v[224:227], a[96:99], v[48:51], v[224:227]
 s_cmp_eq_u32 s22, s25
 ds_read_b128 a[64:67], v7 offset:32768
 ds_read_b128 a[68:71], v7 offset:33792
M v[224:227], a[100:103], v[56:59], v[224:227]
 s_cselect_b32 s21, s26, s21
 v_exp_f32 v23, v77
M v[228:231], a[100:103], v[60:63], v[228:231]
 s_cmp_eq_u32 s22, s43
 v_add_f32 v27, v18, v19
 v_cvt_pk_bf16_f32 v44, v18, v19
M v[228:231], a[96:99], v[52:55], v[228:231]
 s_cselect_b32 s21, s4, s21
 ds_read_b128 a[72:75], v7 offset:34816
 ds_read_b128 a[76:79], v7 offset:35840
M v[232:235], a[104:107], v[48:51], v[232:235]
 s_cmp_eq_u32 s22, s6
 v_exp_f32 v24, v78
M v[232:235], a[108:111], v[56:59], v[232:235]
 s_cselect_b32 s21, s7, s21
 v_add_f32 v27, v20, v27
 v_cvt_pk_bf16_f32 v45, v20, v21
M v[236:239], a[108:111], v[60:63], v[236:239]
 ds_read_b128 a[80:83], v7 offset:36864
 ds_read_b128 a[84:87], v7 offset:37888
M v[236:239], a[104:107], v[52:55], v[236:239]
 v_exp_f32 v25, v79
M v[240:243], a[112:115], v[48:51], v[240:243]
 v_add_f32 v27, v21, v27
 v_add_f32 v27, v22, v27
M v[240:243], a[116:119], v[56:59], v[240:243]
 ds_read_b128 a[88:91], v7 offset:38912
 ds_read_b128 a[92:95], v7 offset:39936
M v[244:247], a[116:119], v[60:63], v[244:247]
 v_cvt_pk_bf16_f32 v46, v22, v23
 v_add_f32 v27, v23, v27
M v[244:247], a[112:115], v[52:55], v[244:247]
 v_add_f32 v27, v24, v27
 v_cvt_pk_bf16_f32 v47, v24, v25
M v[248:251], a[120:123], v[48:51], v[248:251]
 v_add_f32 v27, v25, v27
M v[248:251], a[124:127], v[56:59], v[248:251]
M v[252:255], a[124:127], v[60:63], v[252:255]
 s_waitcnt lgkmcnt(0)
M v[252:255], a[120:123], v[52:55], v[252:255]
 s_cmp_lt_u32 s20, 2
 s_cselect_b64 s[86:87], -1, 0
 s_cmp_eq_u32 s20, 2
 s_cselect_b64 s[80:81], s[16:17], s[86:87]
 s_cselect_b64 s[82:83], s[18:19], s[86:87]
 s_cselect_b64 s[84:85], s[48:49], s[86:87]
 s_cselect_b64 s[86:87], s[50:51], s[86:87]
 s_branch L_loop_mid
L_zs0:
 s_mov_b32 s64, 65536
L_zs0_l:
 s_sleep 2
 buffer_load_dword v17, v16, s[12:15], 0 offen offset:64 sc1
 s_sub_u32 s64, s64, 1
 s_cbranch_scc1 L_zs0_x
 s_waitcnt vmcnt(0)
 v_cmp_ne_u32 vcc, 1, v17
 s_nop 0
 s_cbranch_vccnz L_zs0_l
L_zs0_x:
 s_waitcnt vmcnt(0)
 s_branch L_zr0
L_zs1:
 s_mov_b32 s64, 65536
L_zs1_l:
 s_sleep 2
 buffer_load_dword v17, v16, s[12:15], 0 offen offset:64 sc1
 s_sub_u32 s64, s64, 1
 s_cbranch_scc1 L_zs1_x
 s_waitcnt vmcnt(0)
 v_cmp_ne_u32 vcc, 1, v17
 s_nop 0
 s_cbranch_vccnz L_zs1_l
L_zs1_x:
 s_waitcnt vmcnt(0)
 s_branch L_zr1
L_hs:
 s_mov_b32 s91, 65536
L_hs_l:
 buffer_load_dwordx4 v[16:19], v7, s[8:11], s67 offen offset:0 sc1
 buffer_load_dwordx4 v[20:23], v7, s[8:11], s67 offen offset:1024 sc1
 s_waitcnt vmcnt(0)
 s_sub_u32 s91, s91, 1
 s_cbranch_scc1 L_hr
 v_min3_u32 v28, v16, v17, v18
 v_min3_u32 v28, v28, v19, v20
 v_min3_u32 v28, v28, v21, v22
 v_min_u32 v28, v28, v23
 v_cmp_eq_u32 vcc, 0, v28
 s_nop 0
 s_cbranch_vccnz L_hs_l
 s_branch L_hr
L_f1s04:
 s_mov_b32 s91, 65536
L_f1s04_l:
 s_sleep 2
 buffer_load_dword v24, v13, s[8:11], s46 offen sc1
 s_sub_u32 s91, s91, 1
 s_cbranch_scc1 L_f1s04_x
 s_waitcnt vmcnt(0)
 v_cmp_eq_u32 vcc, 0, v24
 s_nop 0
 s_cbranch_vccnz L_f1s04_l
L_f1s04_x:
 s_waitcnt vmcnt(0)
 s_branch L_f1r04
L_f1s05:
 s_mov_b32 s91, 65536
L_f1s05_l:
 s_sleep 2
 buffer_load_dword v24, v9, s[8:11], s46 offen sc1
 s_sub_u32 s91, s91, 1
 s_cbranch_scc1 L_f1s05_x
 s_waitcnt vmcnt(0)
 v_cmp_eq_u32 vcc, 0, v24
 s_nop 0
 s_cbranch_vccnz L_f1s05_l
L_f1s05_x:
 s_waitcnt vmcnt(0)
 s_branch L_f1r05
L_f1s14:
 s_mov_b32 s91, 65536
L_f1s14_l:
 s_sleep 2
 buffer_load_dword v24, v13, s[8:11], s46 offen sc1
 s_sub_u32 s91, s91, 1
 s_cbranch_scc1 L_f1s14_x
 s_waitcnt vmcnt(0)
 v_cmp_eq_u32 vcc, 0, v24
 s_nop 0
 s_cbranch_vccnz L_f1s14_l
L_f1s14_x:
 s_waitcnt vmcnt(0)
 s_branch L_f1r14
L_f1s15:
 s_mov_b32 s91, 65536
L_f1s15_l:
 s_sleep 2
 buffer_load_dword v24, v9, s[8:11], s46 offen sc1
 s_sub_u32 s91, s91, 1
 s_cbranch_scc1 L_f1s15_x
 s_waitcnt vmcnt(0)
 v_cmp_eq_u32 vcc, 0, v24
 s_nop 0
 s_cbranch_vccnz L_f1s15_l
L_f1s15_x:
 s_waitcnt vmcnt(0)
 s_branch L_f1r15
.p2align 6
L_loop_top:
M v[64:67], a[64:67], a[0:3], v[32:35]
 s_add_u32 m0, s28, 65536
 ds_read_b128 a[96:99], v2 offset:40960
M v[64:67], a[68:71], a[4:7], v[64:67]
 ds_read_b128 a[100:103], v2 offset:41984
M v[64:67], a[72:75], a[8:11], v[64:67]
 buffer_load_dword a240, v0, s[60:63], 0 offen offset:0
M v[64:67], a[76:79], a[12:15], v[64:67]
 ds_read_b128 a[104:107], v2 offset:43008
M v[64:67], a[80:83], a[16:19], v[64:67]
 ds_read_b128 a[108:111], v2 offset:44032
M v[64:67], a[84:87], a[20:23], v[64:67]
 buffer_load_dwordx4 v3, s[8:11], s24 offen offset:0 sc1 lds
M v[64:67], a[88:91], a[24:27], v[64:67]
 ds_read_b128 a[112:115], v2 offset:45056
M v[64:67], a[92:95], a[28:31], v[64:67]
 ds_read_b128 a[116:119], v2 offset:46080
M v[68:71], a[92:95], a[60:63], v[36:39]
 buffer_load_dwordx4 v3, s[8:11], s24 offen offset:1024 sc1 lds
M v[68:71], a[88:91], a[56:59], v[68:71]
 ds_read_b128 a[120:123], v2 offset:47104
M v[68:71], a[84:87], a[52:55], v[68:71]
 ds_read_b128 a[124:127], v2 offset:48128
M v[68:71], a[80:83], a[48:51], v[68:71]
 v_exp_f32 v18, v112
M v[68:71], a[76:79], a[44:47], v[68:71]
 buffer_load_dwordx4 v3, s[8:11], s24 offen offset:2048 sc1 lds
M v[68:71], a[72:75], a[40:43], v[68:71]
 v_exp_f32 v19, v113
M v[68:71], a[68:71], a[36:39], v[68:71]
 v_exp_f32 v20, v114
M v[68:71], a[64:67], a[32:35], v[68:71]
 s_waitcnt lgkmcnt(0)
 v_exp_f32 v21, v115
M v[72:75], a[96:99], a[0:3], v[32:35]
 ds_read_b128 a[64:67], v2 offset:49152
 v_add_f32 v28, v18, v28
M v[72:75], a[100:103], a[4:7], v[72:75]
 ds_read_b128 a[68:71], v2 offset:50176
 v_cvt_pk_bf16_f32 v56, v18, v19
M v[72:75], a[104:107], a[8:11], v[72:75]
 buffer_load_dwordx4 v3, s[8:11], s24 offen offset:3072 sc1 lds
M v[72:75], a[108:111], a[12:15], v[72:75]
 ds_read_b128 a[72:75], v2 offset:51200
 v_add_f32 v28, v19, v28
M v[72:75], a[112:115], a[16:19], v[72:75]
 ds_read_b128 a[76:79], v2 offset:52224
 v_add_f32 v28, v20, v28
M v[72:75], a[116:119], a[20:23], v[72:75]
 v_exp_f32 v22, v120
M v[72:75], a[120:123], a[24:27], v[72:75]
 s_add_u32 m0, s28, 69632
 ds_read_b128 a[80:83], v2 offset:53248
 v_cvt_pk_bf16_f32 v57, v20, v21
M v[72:75], a[124:127], a[28:31], v[72:75]
 ds_read_b128 a[84:87], v2 offset:54272
 v_add_f32 v28, v21, v28
M v[76:79], a[124:127], a[60:63], v[36:39]
 buffer_load_dwordx4 v4, s[8:11], s24 offen offset:0 sc1 lds
M v[76:79], a[120:123], a[56:59], v[76:79]
 ds_read_b128 a[88:91], v2 offset:55296
M v[76:79], a[116:119], a[52:55], v[76:79]
 ds_read_b128 a[92:95], v2 offset:56320
M v[76:79], a[112:115], a[48:51], v[76:79]
 v_exp_f32 v23, v121
M v[76:79], a[108:111], a[44:47], v[76:79]
 buffer_load_dwordx4 v4, s[8:11], s24 offen offset:1024 sc1 lds
M v[76:79], a[104:107], a[40:43], v[76:79]
 v_exp_f32 v24, v122
M v[76:79], a[100:103], a[36:39], v[76:79]
 v_exp_f32 v25, v123
M v[76:79], a[96:99], a[32:35], v[76:79]
 s_waitcnt lgkmcnt(0)
 v_exp_f32 v18, v116
M v[80:83], a[64:67], a[0:3], v[32:35]
 ds_read_b128 a[96:99], v2 offset:57344
 v_add_f32 v28, v22, v28
M v[80:83], a[68:71], a[4:7], v[80:83]
 ds_read_b128 a[100:103], v2 offset:58368
 v_cvt_pk_bf16_f32 v58, v22, v23
M v[80:83], a[72:75], a[8:11], v[80:83]
 buffer_load_dwordx4 v4, s[8:11], s24 offen offset:2048 sc1 lds
M v[80:83], a[76:79], a[12:15], v[80:83]
 ds_read_b128 a[104:107], v2 offset:59392
 v_add_f32 v28, v23, v28
M v[80:83], a[80:83], a[16:19], v[80:83]
 ds_read_b128 a[108:111], v2 offset:60416
 v_add_f32 v28, v24, v28
M v[80:83], a[84:87], a[20:23], v[80:83]
 v_exp_f32 v19, v117
M v[80:83], a[88:91], a[24:27], v[80:83]
 ds_read_b128 a[112:115], v2 offset:61440
 v_cvt_pk_bf16_f32 v59, v24, v25
M v[80:83], a[92:95], a[28:31], v[80:83]
 ds_read_b128 a[116:119], v2 offset:62464
 v_add_f32 v28, v25, v28
M v[84:87], a[92:95], a[60:63], v[36:39]
 buffer_load_dwordx4 v4, s[8:11], s24 offen offset:3072 sc1 lds
M v[84:87], a[88:91], a[56:59], v[84:87]
 ds_read_b128 a[120:123], v2 offset:63488
 v_add_f32 v29, v18, v29
M v[84:87], a[84:87], a[52:55], v[84:87]
 ds_read_b128 a[124:127], v2 offset:64512
 v_cvt_pk_bf16_f32 v60, v18, v19
M v[84:87], a[80:83], a[48:51], v[84:87]
 v_exp_f32 v20, v118
M v[84:87], a[76:79], a[44:47], v[84:87]
 v_exp_f32 v21, v119
M v[84:87], a[72:75], a[40:43], v[84:87]
 v_exp_f32 v22, v124
M v[84:87], a[68:71], a[36:39], v[84:87]
 s_waitcnt vmcnt(17) lgkmcnt(0)
 v_exp_f32 v23, v125
M v[84:87], a[64:67], a[32:35], v[84:87]
 s_barrier
M v[88:91], a[96:99], a[0:3], v[32:35]
 ds_read_b128 a[64:67], v7 offset:0
 v_add_f32 v29, v19, v29
M v[88:91], a[100:103], a[4:7], v[88:91]
 ds_read_b128 a[68:71], v7 offset:1024
 v_add_f32 v29, v20, v29
M v[88:91], a[104:107], a[8:11], v[88:91]
 v_exp_f32 v24, v126
M v[88:91], a[108:111], a[12:15], v[88:91]
 ds_read_b128 a[72:75], v7 offset:2048
 v_cvt_pk_bf16_f32 v61, v20, v21
M v[88:91], a[112:115], a[16:19], v[88:91]
 ds_read_b128 a[76:79], v7 offset:3072
 v_add_f32 v29, v21, v29
M v[88:91], a[116:119], a[20:23], v[88:91]
 v_exp_f32 v25, v127
M v[88:91], a[120:123], a[24:27], v[88:91]
 ds_read_b128 a[80:83], v7 offset:4096
 v_add_f32 v29, v22, v29
M v[88:91], a[124:127], a[28:31], v[88:91]
 ds_read_b128 a[84:87], v7 offset:5120
 v_cvt_pk_bf16_f32 v62, v22, v23
M v[92:95], a[124:127], a[60:63], v[36:39]
 v_add_f32 v29, v23, v29
 v_add_f32 v29, v24, v29
M v[92:95], a[120:123], a[56:59], v[92:95]
 ds_read_b128 a[88:91], v7 offset:6144
 v_cvt_pk_bf16_f32 v63, v24, v25
M v[92:95], a[116:119], a[52:55], v[92:95]
 ds_read_b128 a[92:95], v7 offset:7168
 v_add_f32 v29, v25, v29
M v[92:95], a[112:115], a[48:51], v[92:95]
 v_max_f32 v10, v28, v29
M v[92:95], a[108:111], a[44:47], v[92:95]
 v_cmp_lt_f32 vcc, s31, v10
M v[92:95], a[104:107], a[40:43], v[92:95]
M v[92:95], a[100:103], a[36:39], v[92:95]
 s_waitcnt lgkmcnt(0)
M v[92:95], a[96:99], a[32:35], v[92:95]
 s_cbranch_vccnz L_st1
L_rt1:
M v[128:131], a[64:67], v[48:51], v[128:131]
 s_add_u32 m0, s28, 98304
 ds_read_b128 a[96:99], v7 offset:8192
 v_add_f32 v30, v28, v30
M v[128:131], a[68:71], v[56:59], v[128:131]
 ds_read_b128 a[100:103], v7 offset:9216
 v_add_f32 v31, v29, v31
M v[132:135], a[68:71], v[60:63], v[132:135]
 buffer_load_dwordx4 v3, s[8:11], s21 offen offset:0 sc1 lds
M v[132:135], a[64:67], v[52:55], v[132:135]
 ds_read_b128 a[104:107], v7 offset:10240
M v[136:139], a[72:75], v[48:51], v[136:139]
 ds_read_b128 a[108:111], v7 offset:11264
M v[136:139], a[76:79], v[56:59], v[136:139]
 buffer_load_dwordx4 v3, s[8:11], s21 offen offset:1024 sc1 lds
M v[140:143], a[76:79], v[60:63], v[140:143]
 ds_read_b128 a[112:115], v7 offset:12288
M v[140:143], a[72:75], v[52:55], v[140:143]
 ds_read_b128 a[116:119], v7 offset:13312
M v[144:147], a[80:83], v[48:51], v[144:147]
 v_exp_f32 v18, v64
M v[144:147], a[84:87], v[56:59], v[144:147]
 ds_read_b128 a[120:123], v7 offset:14336
M v[148:151], a[84:87], v[60:63], v[148:151]
 ds_read_b128 a[124:127], v7 offset:15360
M v[148:151], a[80:83], v[52:55], v[148:151]
 buffer_load_dwordx4 v3, s[8:11], s21 offen offset:2048 sc1 lds
M v[152:155], a[88:91], v[48:51], v[152:155]
 v_exp_f32 v19, v65
M v[152:155], a[92:95], v[56:59], v[152:155]
 v_exp_f32 v20, v66
M v[156:159], a[92:95], v[60:63], v[156:159]
 buffer_load_dwordx4 v3, s[8:11], s21 offen offset:3072 sc1 lds
M v[156:159], a[88:91], v[52:55], v[156:159]
 s_waitcnt lgkmcnt(0)
 v_exp_f32 v21, v67
M v[160:163], a[96:99], v[48:51], v[160:163]
 ds_read_b128 a[64:67], v7 offset:16384
 v_add_f32 v26, v18, v19
M v[160:163], a[100:103], v[56:59], v[160:163]
 s_add_u32 m0, s28, 102400
 ds_read_b128 a[68:71], v7 offset:17408
 v_cvt_pk_bf16_f32 v40, v18, v19
M v[164:167], a[100:103], v[60:63], v[164:167]
 buffer_load_dwordx4 v4, s[8:11], s21 offen offset:0 sc1 lds
M v[164:167], a[96:99], v[52:55], v[164:167]
 ds_read_b128 a[72:75], v7 offset:18432
 v_add_f32 v26, v20, v26
M v[168:171], a[104:107], v[48:51], v[168:171]
 ds_read_b128 a[76:79], v7 offset:19456
 v_cvt_pk_bf16_f32 v41, v20, v21
M v[168:171], a[108:111], v[56:59], v[168:171]
 v_exp_f32 v22, v72
M v[172:175], a[108:111], v[60:63], v[172:175]
 ds_read_b128 a[80:83], v7 offset:20480
 v_add_f32 v26, v21, v26
M v[172:175], a[104:107], v[52:55], v[172:175]
 ds_read_b128 a[84:87], v7 offset:21504
M v[176:179], a[112:115], v[48:51], v[176:179]
 buffer_load_dwordx4 v4, s[8:11], s21 offen offset:1024 sc1 lds
M v[176:179], a[116:119], v[56:59], v[176:179]
 ds_read_b128 a[88:91], v7 offset:22528
M v[180:183], a[116:119], v[60:63], v[180:183]
 ds_read_b128 a[92:95], v7 offset:23552
M v[180:183], a[112:115], v[52:55], v[180:183]
 buffer_load_dwordx4 v4, s[8:11], s21 offen offset:2048 sc1 lds
M v[184:187], a[120:123], v[48:51], v[184:187]
 v_exp_f32 v23, v73
M v[184:187], a[124:127], v[56:59], v[184:187]
 v_exp_f32 v24, v74
M v[188:191], a[124:127], v[60:63], v[188:191]
 v_exp_f32 v25, v75
M v[188:191], a[120:123], v[52:55], v[188:191]
 s_waitcnt lgkmcnt(0)
 v_exp_f32 v18, v68
M v[192:195], a[64:67], v[48:51], v[192:195]
 ds_read_b128 a[96:99], v7 offset:24576
 v_add_f32 v26, v22, v26
M v[192:195], a[68:71], v[56:59], v[192:195]
 ds_read_b128 a[100:103], v7 offset:25600
 v_cvt_pk_bf16_f32 v42, v22, v23
M v[196:199], a[68:71], v[60:63], v[196:199]
 buffer_load_dwordx4 v4, s[8:11], s21 offen offset:3072 sc1 lds
M v[196:199], a[64:67], v[52:55], v[196:199]
 s_add_u32 s24, s23, 16777216
 ds_read_b128 a[104:107], v7 offset:26624
 v_add_f32 v26, v23, v26
M v[200:203], a[72:75], v[48:51], v[200:203]
 s_mov_b32 s23, s21
 ds_read_b128 a[108:111], v7 offset:27648
 v_add_f32 v26, v24, v26
M v[200:203], a[76:79], v[56:59], v[200:203]
 s_add_u32 s21, s21, 32768
 v_exp_f32 v19, v69
M v[204:207], a[76:79], v[60:63], v[204:207]
 s_add_u32 s22, s22, 1
 ds_read_b128 a[112:115], v7 offset:28672
 v_cvt_pk_bf16_f32 v43, v24, v25
M v[204:207], a[72:75], v[52:55], v[204:207]
 s_cmp_eq_u32 s22, s25
 ds_read_b128 a[116:119], v7 offset:29696
 v_add_f32 v26, v25, v26
M v[208:211], a[80:83], v[48:51], v[208:211]
 s_cselect_b32 s21, s26, s21
 v_exp_f32 v20, v70
M v[208:211], a[84:87], v[56:59], v[208:211]
 s_cmp_eq_u32 s22, s43
 ds_read_b128 a[120:123], v7 offset:30720
 v_add_f32 v27, v18, v19
M v[212:215], a[84:87], v[60:63], v[212:215]
 s_cselect_b32 s21, s4, s21
 ds_read_b128 a[124:127], v7 offset:31744
 v_cvt_pk_bf16_f32 v44, v18, v19
M v[212:215], a[80:83], v[52:55], v[212:215]
 s_cmp_eq_u32 s22, s6
 v_exp_f32 v21, v71
M v[216:219], a[88:91], v[48:51], v[216:219]
 s_cselect_b32 s21, s7, s21
 v_exp_f32 v22, v76
M v[216:219], a[92:95], v[56:59], v[216:219]
 v_add_f32 v27, v20, v27
 v_cvt_pk_bf16_f32 v45, v20, v21
M v[220:223], a[92:95], v[60:63], v[220:223]
 s_waitcnt vmcnt(17) lgkmcnt(0)
 v_add_f32 v27, v21, v27
M v[220:223], a[88:91], v[52:55], v[220:223]
 s_barrier
M v[224:227], a[96:99], v[48:51], v[224:227]
 ds_read_b128 a[64:67], v7 offset:32768
M v[224:227], a[100:103], v[56:59], v[224:227]
 ds_read_b128 a[68:71], v7 offset:33792
M v[228:231], a[100:103], v[60:63], v[228:231]
 v_exp_f32 v23, v77
M v[228:231], a[96:99], v[52:55], v[228:231]
 ds_read_b128 a[72:75], v7 offset:34816
 v_add_f32 v27, v22, v27
M v[232:235], a[104:107], v[48:51], v[232:235]
 ds_read_b128 a[76:79], v7 offset:35840
 v_cvt_pk_bf16_f32 v46, v22, v23
M v[232:235], a[108:111], v[56:59], v[232:235]
 v_exp_f32 v24, v78
M v[236:239], a[108:111], v[60:63], v[236:239]
 ds_read_b128 a[80:83], v7 offset:36864
 v_add_f32 v27, v23, v27
M v[236:239], a[104:107], v[52:55], v[236:239]
 ds_read_b128 a[84:87], v7 offset:37888
M v[240:243], a[112:115], v[48:51], v[240:243]
 v_exp_f32 v25, v79
M v[240:243], a[116:119], v[56:59], v[240:243]
 ds_read_b128 a[88:91], v7 offset:38912
 v_add_f32 v27, v24, v27
M v[244:247], a[116:119], v[60:63], v[244:247]
 ds_read_b128 a[92:95], v7 offset:39936
 v_cvt_pk_bf16_f32 v47, v24, v25
M v[244:247], a[112:115], v[52:55], v[244:247]
 v_add_f32 v27, v25, v27
M v[248:251], a[120:123], v[48:51], v[248:251]
M v[248:251], a[124:127], v[56:59], v[248:251]
M v[252:255], a[124:127], v[60:63], v[252:255]
 s_waitcnt lgkmcnt(0)
M v[252:255], a[120:123], v[52:55], v[252:255]
L_loop_mid:
M v[96:99], a[64:67], a[0:3], v[32:35]
 s_and_b32 s39, s54, 15
 ds_read_b128 a[96:99], v7 offset:40960
M v[96:99], a[68:71], a[4:7], v[96:99]
 s_cbranch_scc1 L_fll
L_fllr:
 ds_read_b128 a[100:103], v7 offset:41984
M v[96:99], a[72:75], a[8:11], v[96:99]
 s_lshr_b32 s54, s54, 4
 v_exp_f32 v18, v80
M v[96:99], a[76:79], a[12:15], v[96:99]
 s_add_u32 m0, s28, 0
 ds_read_b128 a[104:107], v7 offset:43008
M v[96:99], a[80:83], a[16:19], v[96:99]
 ds_read_b128 a[108:111], v7 offset:44032
M v[96:99], a[84:87], a[20:23], v[96:99]
 buffer_load_dwordx4 v3, s[8:11], s24 offen offset:0 sc1 lds
M v[96:99], a[88:91], a[24:27], v[96:99]
 ds_read_b128 a[112:115], v7 offset:45056
M v[96:99], a[92:95], a[28:31], v[96:99]
 ds_read_b128 a[116:119], v7 offset:46080
M v[100:103], a[92:95], a[60:63], v[36:39]
 v_exp_f32 v19, v81
M v[100:103], a[88:91], a[56:59], v[100:103]
 ds_read_b128 a[120:123], v7 offset:47104
 v_add_f32 v26, v18, v26
M v[100:103], a[84:87], a[52:55], v[100:103]
 ds_read_b128 a[124:127], v7 offset:48128
 v_cvt_pk_bf16_f32 v56, v18, v19
M v[100:103], a[80:83], a[48:51], v[100:103]
 buffer_load_dwordx4 v3, s[8:11], s24 offen offset:1024 sc1 lds
M v[100:103], a[76:79], a[44:47], v[100:103]
 v_exp_f32 v20, v82
M v[100:103], a[72:75], a[40:43], v[100:103]
 v_exp_f32 v21, v83
M v[100:103], a[68:71], a[36:39], v[100:103]
 buffer_load_dwordx4 v3, s[8:11], s24 offen offset:2048 sc1 lds
M v[100:103], a[64:67], a[32:35], v[100:103]
 s_waitcnt lgkmcnt(0)
 v_exp_f32 v22, v88
M v[104:107], a[96:99], a[0:3], v[32:35]
 ds_read_b128 a[64:67], v7 offset:49152
 v_add_f32 v26, v19, v26
M v[104:107], a[100:103], a[4:7], v[104:107]
 ds_read_b128 a[68:71], v7 offset:50176
 v_add_f32 v26, v20, v26
M v[104:107], a[104:107], a[8:11], v[104:107]
 v_exp_f32 v23, v89
M v[104:107], a[108:111], a[12:15], v[104:107]
 ds_read_b128 a[72:75], v7 offset:51200
 v_cvt_pk_bf16_f32 v57, v20, v21
M v[104:107], a[112:115], a[16:19], v[104:107]
 ds_read_b128 a[76:79], v7 offset:52224
 v_add_f32 v26, v21, v26
M v[104:107], a[116:119], a[20:23], v[104:107]
 buffer_load_dwordx4 v3, s[8:11], s24 offen offset:3072 sc1 lds
M v[104:107], a[120:123], a[24:27], v[104:107]
 ds_read_b128 a[80:83], v7 offset:53248
 v_add_f32 v26, v22, v26
M v[104:107], a[124:127], a[28:31], v[104:107]
 s_add_u32 m0, s28, 4096
 ds_read_b128 a[84:87], v7 offset:54272
 v_cvt_pk_bf16_f32 v58, v22, v23
M v[108:111], a[124:127], a[60:63], v[36:39]
 buffer_load_dwordx4 v4, s[8:11], s24 offen offset:0 sc1 lds
M v[108:111], a[120:123], a[56:59], v[108:111]
 ds_read_b128 a[88:91], v7 offset:55296
 v_add_f32 v26, v23, v26
M v[108:111], a[116:119], a[52:55], v[108:111]
 ds_read_b128 a[92:95], v7 offset:56320
M v[108:111], a[112:115], a[48:51], v[108:111]
 v_exp_f32 v24, v90
M v[108:111], a[108:111], a[44:47], v[108:111]
 v_exp_f32 v25, v91
M v[108:111], a[104:107], a[40:43], v[108:111]
 buffer_load_dwordx4 v4, s[8:11], s24 offen offset:1024 sc1 lds
M v[108:111], a[100:103], a[36:39], v[108:111]
 v_exp_f32 v18, v84
M v[108:111], a[96:99], a[32:35], v[108:111]
 s_waitcnt lgkmcnt(0)
 v_exp_f32 v19, v85
M v[112:115], a[64:67], a[0:3], v[32:35]
 ds_read_b128 a[96:99], v7 offset:57344
 v_add_f32 v26, v24, v26
M v[112:115], a[68:71], a[4:7], v[112:115]
 ds_read_b128 a[100:103], v7 offset:58368
 v_cvt_pk_bf16_f32 v59, v24, v25
M v[112:115], a[72:75], a[8:11], v[112:115]
 buffer_load_dwordx4 v4, s[8:11], s24 offen offset:2048 sc1 lds
M v[112:115], a[76:79], a[12:15], v[112:115]
 ds_read_b128 a[104:107], v7 offset:59392
 v_add_f32 v26, v25, v26
M v[112:115], a[80:83], a[16:19], v[112:115]
 ds_read_b128 a[108:111], v7 offset:60416
 v_add_f32 v27, v18, v27
M v[112:115], a[84:87], a[20:23], v[112:115]
 v_exp_f32 v20, v86
M v[112:115], a[88:91], a[24:27], v[112:115]
 ds_read_b128 a[112:115], v7 offset:61440
 v_cvt_pk_bf16_f32 v60, v18, v19
M v[112:115], a[92:95], a[28:31], v[112:115]
 ds_read_b128 a[116:119], v7 offset:62464
 v_add_f32 v27, v19, v27
M v[116:119], a[92:95], a[60:63], v[36:39]
 buffer_load_dwordx4 v4, s[8:11], s24 offen offset:3072 sc1 lds
M v[116:119], a[88:91], a[56:59], v[116:119]
 ds_read_b128 a[120:123], v7 offset:63488
M v[116:119], a[84:87], a[52:55], v[116:119]
 ds_read_b128 a[124:127], v7 offset:64512
M v[116:119], a[80:83], a[48:51], v[116:119]
 v_exp_f32 v21, v87
M v[116:119], a[76:79], a[44:47], v[116:119]
 v_exp_f32 v22, v92
M v[116:119], a[72:75], a[40:43], v[116:119]
 v_exp_f32 v23, v93
M v[116:119], a[68:71], a[36:39], v[116:119]
 s_waitcnt vmcnt(16) lgkmcnt(0)
 v_add_f32 v27, v20, v27
 v_cvt_pk_bf16_f32 v61, v20, v21
M v[116:119], a[64:67], a[32:35], v[116:119]
 s_barrier
M v[120:123], a[96:99], a[0:3], v[32:35]
 ds_read_b128 a[64:67], v2 offset:0
 v_add_f32 v27, v21, v27
M v[120:123], a[100:103], a[4:7], v[120:123]
 ds_read_b128 a[68:71], v2 offset:1024
 v_add_f32 v27, v22, v27
M v[120:123], a[104:107], a[8:11], v[120:123]
 v_exp_f32 v24, v94
M v[120:123], a[108:111], a[12:15], v[120:123]
 ds_read_b128 a[72:75], v2 offset:2048
 v_cvt_pk_bf16_f32 v62, v22, v23
M v[120:123], a[112:115], a[16:19], v[120:123]
 ds_read_b128 a[76:79], v2 offset:3072
 v_add_f32 v27, v23, v27
M v[120:123], a[116:119], a[20:23], v[120:123]
 v_exp_f32 v25, v95
M v[120:123], a[120:123], a[24:27], v[120:123]
 ds_read_b128 a[80:83], v2 offset:4096
 v_add_f32 v27, v24, v27
M v[120:123], a[124:127], a[28:31], v[120:123]
 ds_read_b128 a[84:87], v2 offset:5120
 v_cvt_pk_bf16_f32 v63, v24, v25
M v[124:127], a[124:127], a[60:63], v[36:39]
 v_add_f32 v27, v25, v27
M v[124:127], a[120:123], a[56:59], v[124:127]
 ds_read_b128 a[88:91], v2 offset:6144
M v[124:127], a[116:119], a[52:55], v[124:127]
 ds_read_b128 a[92:95], v2 offset:7168
 v_max_f32 v10, v26, v27
M v[124:127], a[112:115], a[48:51], v[124:127]
 v_cmp_lt_f32 vcc, s31, v10
M v[124:127], a[108:111], a[44:47], v[124:127]
M v[124:127], a[104:107], a[40:43], v[124:127]
M v[124:127], a[100:103], a[36:39], v[124:127]
 s_waitcnt lgkmcnt(0)
M v[124:127], a[96:99], a[32:35], v[124:127]
 s_cbranch_vccnz L_st0
L_rt0:
M v[128:131], a[64:67], v[40:43], v[128:131]
 s_add_u32 m0, s28, 32768
 ds_read_b128 a[96:99], v2 offset:8192
 v_add_f32 v30, v26, v30
M v[128:131], a[68:71], v[56:59], v[128:131]
 ds_read_b128 a[100:103], v2 offset:9216
 v_add_f32 v31, v27, v31
M v[132:135], a[68:71], v[60:63], v[132:135]
 buffer_load_dwordx4 v3, s[8:11], s21 offen offset:0 sc1 lds
M v[132:135], a[64:67], v[44:47], v[132:135]
 ds_read_b128 a[104:107], v2 offset:10240
M v[136:139], a[72:75], v[40:43], v[136:139]
 ds_read_b128 a[108:111], v2 offset:11264
M v[136:139], a[76:79], v[56:59], v[136:139]
 buffer_load_dwordx4 v3, s[8:11], s21 offen offset:1024 sc1 lds
M v[140:143], a[76:79], v[60:63], v[140:143]
 ds_read_b128 a[112:115], v2 offset:12288
M v[140:143], a[72:75], v[44:47], v[140:143]
 ds_read_b128 a[116:119], v2 offset:13312
M v[144:147], a[80:83], v[40:43], v[144:147]
 v_exp_f32 v18, v96
M v[144:147], a[84:87], v[56:59], v[144:147]
 ds_read_b128 a[120:123], v2 offset:14336
M v[148:151], a[84:87], v[60:63], v[148:151]
 ds_read_b128 a[124:127], v2 offset:15360
M v[148:151], a[80:83], v[44:47], v[148:151]
 buffer_load_dwordx4 v3, s[8:11], s21 offen offset:2048 sc1 lds
M v[152:155], a[88:91], v[40:43], v[152:155]
 v_exp_f32 v19, v97
M v[152:155], a[92:95], v[56:59], v[152:155]
 v_exp_f32 v20, v98
M v[156:159], a[92:95], v[60:63], v[156:159]
 buffer_load_dwordx4 v3, s[8:11], s21 offen offset:3072 sc1 lds
M v[156:159], a[88:91], v[44:47], v[156:159]
 s_waitcnt lgkmcnt(0)
 v_exp_f32 v21, v99
M v[160:163], a[96:99], v[40:43], v[160:163]
 ds_read_b128 a[64:67], v2 offset:16384
 v_add_f32 v28, v18, v19
M v[160:163], a[100:103], v[56:59], v[160:163]
 s_add_u32 m0, s28, 36864
 ds_read_b128 a[68:71], v2 offset:17408
 v_cvt_pk_bf16_f32 v48, v18, v19
M v[164:167], a[100:103], v[60:63], v[164:167]
 buffer_load_dwordx4 v4, s[8:11], s21 offen offset:0 sc1 lds
M v[164:167], a[96:99], v[44:47], v[164:167]
 ds_read_b128 a[72:75], v2 offset:18432
 v_add_f32 v28, v20, v28
M v[168:171], a[104:107], v[40:43], v[168:171]
 ds_read_b128 a[76:79], v2 offset:19456
 v_cvt_pk_bf16_f32 v49, v20, v21
M v[168:171], a[108:111], v[56:59], v[168:171]
 v_exp_f32 v22, v104
M v[172:175], a[108:111], v[60:63], v[172:175]
 ds_read_b128 a[80:83], v2 offset:20480
 v_add_f32 v28, v21, v28
M v[172:175], a[104:107], v[44:47], v[172:175]
 ds_read_b128 a[84:87], v2 offset:21504
M v[176:179], a[112:115], v[40:43], v[176:179]
 buffer_load_dwordx4 v4, s[8:11], s21 offen offset:1024 sc1 lds
M v[176:179], a[116:119], v[56:59], v[176:179]
 ds_read_b128 a[88:91], v2 offset:22528
M v[180:183], a[116:119], v[60:63], v[180:183]
 ds_read_b128 a[92:95], v2 offset:23552
M v[180:183], a[112:115], v[44:47], v[180:183]
 buffer_load_dwordx4 v4, s[8:11], s21 offen offset:2048 sc1 lds
M v[184:187], a[120:123], v[40:43], v[184:187]
 v_exp_f32 v23, v105
M v[184:187], a[124:127], v[56:59], v[184:187]
 v_exp_f32 v24, v106
M v[188:191], a[124:127], v[60:63], v[188:191]
 v_exp_f32 v25, v107
M v[188:191], a[120:123], v[44:47], v[188:191]
 s_waitcnt lgkmcnt(0)
 v_exp_f32 v18, v100
M v[192:195], a[64:67], v[40:43], v[192:195]
 ds_read_b128 a[96:99], v2 offset:24576
 v_add_f32 v28, v22, v28
M v[192:195], a[68:71], v[56:59], v[192:195]
 ds_read_b128 a[100:103], v2 offset:25600
 v_cvt_pk_bf16_f32 v50, v22, v23
M v[196:199], a[68:71], v[60:63], v[196:199]
 buffer_load_dwordx4 v4, s[8:11], s21 offen offset:3072 sc1 lds
M v[196:199], a[64:67], v[44:47], v[196:199]
 s_add_u32 s24, s23, 16777216
 ds_read_b128 a[104:107], v2 offset:26624
 v_add_f32 v28, v23, v28
M v[200:203], a[72:75], v[40:43], v[200:203]
 s_mov_b32 s23, s21
 ds_read_b128 a[108:111], v2 offset:27648
 v_add_f32 v28, v24, v28
M v[200:203], a[76:79], v[56:59], v[200:203]
 s_add_u32 s21, s21, 32768
 v_exp_f32 v19, v101
M v[204:207], a[76:79], v[60:63], v[204:207]
 s_add_u32 s22, s22, 1
 ds_read_b128 a[112:115], v2 offset:28672
 v_cvt_pk_bf16_f32 v51, v24, v25
M v[204:207], a[72:75], v[44:47], v[204:207]
 s_cmp_eq_u32 s22, s25
 ds_read_b128 a[116:119], v2 offset:29696
 v_add_f32 v28, v25, v28
M v[208:211], a[80:83], v[40:43], v[208:211]
 s_cselect_b32 s21, s26, s21
 v_exp_f32 v20, v102
M v[208:211], a[84:87], v[56:59], v[208:211]
 s_cmp_eq_u32 s22, s43
 ds_read_b128 a[120:123], v2 offset:30720
 v_add_f32 v29, v18, v19
M v[212:215], a[84:87], v[60:63], v[212:215]
 s_cselect_b32 s21, s4, s21
 ds_read_b128 a[124:127], v2 offset:31744
 v_cvt_pk_bf16_f32 v52, v18, v19
M v[212:215], a[80:83], v[44:47], v[212:215]
 s_cmp_eq_u32 s22, s6
 v_exp_f32 v21, v103
M v[216:219], a[88:91], v[40:43], v[216:219]
 s_cselect_b32 s21, s7, s21
 v_exp_f32 v22, v108
M v[216:219], a[92:95], v[56:59], v[216:219]
 v_add_f32 v29, v20, v29
 v_cvt_pk_bf16_f32 v53, v20, v21
M v[220:223], a[92:95], v[60:63], v[220:223]
 s_waitcnt vmcnt(16) lgkmcnt(0)
 v_exp_f32 v23, v109
M v[220:223], a[88:91], v[44:47], v[220:223]
 s_barrier
M v[224:227], a[96:99], v[40:43], v[224:227]
 ds_read_b128 a[64:67], v2 offset:32768
 v_add_f32 v29, v21, v29
M v[224:227], a[100:103], v[56:59], v[224:227]
 ds_read_b128 a[68:71], v2 offset:33792
 v_add_f32 v29, v22, v29
M v[228:231], a[100:103], v[60:63], v[228:231]
 v_cmp_gt_u32 vcc, s39, v6
 v_cvt_pk_bf16_f32 v54, v22, v23
M v[228:231], a[96:99], v[44:47], v[228:231]
 ds_read_b128 a[72:75], v2 offset:34816
 v_add_f32 v29, v23, v29
M v[232:235], a[104:107], v[40:43], v[232:235]
 ds_read_b128 a[76:79], v2 offset:35840
M v[232:235], a[108:111], v[56:59], v[232:235]
 s_cbranch_vccnz L_fls0
L_flr0:
 v_exp_f32 v24, v110
M v[236:239], a[108:111], v[60:63], v[236:239]
 s_and_b32 s3, s5, 15
 ds_read_b128 a[80:83], v2 offset:36864
M v[236:239], a[104:107], v[44:47], v[236:239]
 s_cbranch_scc1 L_pub3
L_pub3r:
 ds_read_b128 a[84:87], v2 offset:37888
M v[240:243], a[112:115], v[40:43], v[240:243]
 s_lshr_b32 s5, s5, 4
 v_exp_f32 v25, v111
M v[240:243], a[116:119], v[56:59], v[240:243]
 ds_read_b128 a[88:91], v2 offset:38912
 v_add_f32 v29, v24, v29
M v[244:247], a[116:119], v[60:63], v[244:247]
 ds_read_b128 a[92:95], v2 offset:39936
 v_cvt_pk_bf16_f32 v55, v24, v25
M v[244:247], a[112:115], v[44:47], v[244:247]
 v_add_f32 v29, v25, v29
M v[248:251], a[120:123], v[40:43], v[248:251]
 s_sub_u32 s27, s27, 1
M v[248:251], a[124:127], v[56:59], v[248:251]
 s_cmp_lg_u32 s27, 0
M v[252:255], a[124:127], v[60:63], v[252:255]
 s_waitcnt lgkmcnt(0)
M v[252:255], a[120:123], v[44:47], v[252:255]
 s_cbranch_scc1 L_loop_top
L_p1:
 s_cmp_eq_u32 s40, 0
 s_cbranch_scc1 L_final_h
 v_cndmask_b32 v64, v32, v8, s[64:65]
 v_cndmask_b32 v65, v32, v8, s[66:67]
 v_cndmask_b32 v66, v32, v8, s[68:69]
 v_cndmask_b32 v67, v32, v8, s[70:71]
 s_nop 1
M v[64:67], a[64:67], a[0:3], v[64:67]
 s_add_u32 m0, s28, 65536
 ds_read_b128 a[96:99], v2 offset:40960
 v_cndmask_b32 v72, v32, v8, s[72:73]
M v[64:67], a[68:71], a[4:7], v[64:67]
 ds_read_b128 a[100:103], v2 offset:41984
 v_cndmask_b32 v73, v32, v8, s[74:75]
M v[64:67], a[72:75], a[8:11], v[64:67]
 buffer_load_dwordx4 v3, s[8:11], s24 offen offset:0 sc1 lds
M v[64:67], a[76:79], a[12:15], v[64:67]
 ds_read_b128 a[104:107], v2 offset:43008
 v_cndmask_b32 v74, v32, v8, s[76:77]
M v[64:67], a[80:83], a[16:19], v[64:67]
 ds_read_b128 a[108:111], v2 offset:44032
 v_cndmask_b32 v75, v32, v8, s[78:79]
M v[64:67], a[84:87], a[20:23], v[64:67]
 v_exp_f32 v18, v112
M v[64:67], a[88:91], a[24:27], v[64:67]
 ds_read_b128 a[112:115], v2 offset:45056
M v[64:67], a[92:95], a[28:31], v[64:67]
 ds_read_b128 a[116:119], v2 offset:46080
M v[68:71], a[92:95], a[60:63], v[36:39]
 buffer_load_dwordx4 v3, s[8:11], s24 offen offset:1024 sc1 lds
M v[68:71], a[88:91], a[56:59], v[68:71]
 ds_read_b128 a[120:123], v2 offset:47104
M v[68:71], a[84:87], a[52:55], v[68:71]
 ds_read_b128 a[124:127], v2 offset:48128
M v[68:71], a[80:83], a[48:51], v[68:71]
 v_exp_f32 v19, v113
M v[68:71], a[76:79], a[44:47], v[68:71]
 buffer_load_dwordx4 v3, s[8:11], s24 offen offset:2048 sc1 lds
M v[68:71], a[72:75], a[40:43], v[68:71]
 v_exp_f32 v20, v114
M v[68:71], a[68:71], a[36:39], v[68:71]
 v_exp_f32 v21, v115
M v[68:71], a[64:67], a[32:35], v[68:71]
 s_waitcnt lgkmcnt(0)
 v_exp_f32 v22, v120
M v[72:75], a[96:99], a[0:3], v[72:75]
 ds_read_b128 a[64:67], v2 offset:49152
 v_cndmask_b32 v80, v32, v8, s[80:81]
M v[72:75], a[100:103], a[4:7], v[72:75]
 ds_read_b128 a[68:71], v2 offset:50176
 v_cndmask_b32 v81, v32, v8, s[82:83]
M v[72:75], a[104:107], a[8:11], v[72:75]
 buffer_load_dwordx4 v3, s[8:11], s24 offen offset:3072 sc1 lds
M v[72:75], a[108:111], a[12:15], v[72:75]
 ds_read_b128 a[72:75], v2 offset:51200
 v_cndmask_b32 v82, v32, v8, s[84:85]
M v[72:75], a[112:115], a[16:19], v[72:75]
 ds_read_b128 a[76:79], v2 offset:52224
 v_cndmask_b32 v83, v32, v8, s[86:87]
M v[72:75], a[116:119], a[20:23], v[72:75]
 v_exp_f32 v23, v121
M v[72:75], a[120:123], a[24:27], v[72:75]
 s_add_u32 m0, s28, 69632
 ds_read_b128 a[80:83], v2 offset:53248
 v_add_f32 v28, v18, v28
M v[72:75], a[124:127], a[28:31], v[72:75]
 ds_read_b128 a[84:87], v2 offset:54272
 v_cvt_pk_bf16_f32 v56, v18, v19
M v[76:79], a[124:127], a[60:63], v[36:39]
 buffer_load_dwordx4 v4, s[8:11], s24 offen offset:0 sc1 lds
M v[76:79], a[120:123], a[56:59], v[76:79]
 ds_read_b128 a[88:91], v2 offset:55296
 v_add_f32 v28, v19, v28
M v[76:79], a[116:119], a[52:55], v[76:79]
 ds_read_b128 a[92:95], v2 offset:56320
 v_add_f32 v28, v20, v28
M v[76:79], a[112:115], a[48:51], v[76:79]
 v_exp_f32 v24, v122
M v[76:79], a[108:111], a[44:47], v[76:79]
 buffer_load_dwordx4 v4, s[8:11], s24 offen offset:1024 sc1 lds
M v[76:79], a[104:107], a[40:43], v[76:79]
 v_exp_f32 v25, v123
M v[76:79], a[100:103], a[36:39], v[76:79]
 v_exp_f32 v18, v116
M v[76:79], a[96:99], a[32:35], v[76:79]
 s_waitcnt lgkmcnt(0)
 v_exp_f32 v19, v117
M v[80:83], a[64:67], a[0:3], v[80:83]
 ds_read_b128 a[96:99], v2 offset:57344
 v_cndmask_b32 v88, v32, v8, s[88:89]
M v[80:83], a[68:71], a[4:7], v[80:83]
 ds_read_b128 a[100:103], v2 offset:58368
 v_cndmask_b32 v89, v32, v8, s[90:91]
M v[80:83], a[72:75], a[8:11], v[80:83]
 buffer_load_dwordx4 v4, s[8:11], s24 offen offset:2048 sc1 lds
M v[80:83], a[76:79], a[12:15], v[80:83]
 ds_read_b128 a[104:107], v2 offset:59392
 v_cndmask_b32 v90, v32, v8, s[92:93]
M v[80:83], a[80:83], a[16:19], v[80:83]
 ds_read_b128 a[108:111], v2 offset:60416
 v_cndmask_b32 v91, v32, v8, s[94:95]
M v[80:83], a[84:87], a[20:23], v[80:83]
 v_cvt_pk_bf16_f32 v57, v20, v21
 v_add_f32 v28, v21, v28
M v[80:83], a[88:91], a[24:27], v[80:83]
 ds_read_b128 a[112:115], v2 offset:61440
 v_add_f32 v28, v22, v28
M v[80:83], a[92:95], a[28:31], v[80:83]
 ds_read_b128 a[116:119], v2 offset:62464
 v_cvt_pk_bf16_f32 v58, v22, v23
M v[84:87], a[92:95], a[60:63], v[36:39]
 buffer_load_dwordx4 v4, s[8:11], s24 offen offset:3072 sc1 lds
M v[84:87], a[88:91], a[56:59], v[84:87]
 ds_read_b128 a[120:123], v2 offset:63488
 v_add_f32 v28, v23, v28
M v[84:87], a[84:87], a[52:55], v[84:87]
 ds_read_b128 a[124:127], v2 offset:64512
 v_add_f32 v28, v24, v28
M v[84:87], a[80:83], a[48:51], v[84:87]
 v_exp_f32 v20, v118
M v[84:87], a[76:79], a[44:47], v[84:87]
 v_exp_f32 v21, v119
M v[84:87], a[72:75], a[40:43], v[84:87]
 v_exp_f32 v22, v124
M v[84:87], a[68:71], a[36:39], v[84:87]
 s_waitcnt vmcnt(16) lgkmcnt(0)
 v_exp_f32 v23, v125
M v[84:87], a[64:67], a[32:35], v[84:87]
 s_barrier
M v[88:91], a[96:99], a[0:3], v[88:91]
 ds_read_b128 a[64:67], v7 offset:0
 v_cvt_pk_bf16_f32 v59, v24, v25
M v[88:91], a[100:103], a[4:7], v[88:91]
 ds_read_b128 a[68:71], v7 offset:1024
 v_add_f32 v28, v25, v28
M v[88:91], a[104:107], a[8:11], v[88:91]
 v_exp_f32 v24, v126
M v[88:91], a[108:111], a[12:15], v[88:91]
 ds_read_b128 a[72:75], v7 offset:2048
 v_add_f32 v29, v18, v29
M v[88:91], a[112:115], a[16:19], v[88:91]
 ds_read_b128 a[76:79], v7 offset:3072
 v_cvt_pk_bf16_f32 v60, v18, v19
M v[88:91], a[116:119], a[20:23], v[88:91]
 v_exp_f32 v25, v127
M v[88:91], a[120:123], a[24:27], v[88:91]
 ds_read_b128 a[80:83], v7 offset:4096
 v_add_f32 v29, v19, v29
M v[88:91], a[124:127], a[28:31], v[88:91]
 ds_read_b128 a[84:87], v7 offset:5120
 v_add_f32 v29, v20, v29
M v[92:95], a[124:127], a[60:63], v[36:39]
 v_cvt_pk_bf16_f32 v61, v20, v21
 v_add_f32 v29, v21, v29
M v[92:95], a[120:123], a[56:59], v[92:95]
 ds_read_b128 a[88:91], v7 offset:6144
 v_add_f32 v29, v22, v29
M v[92:95], a[116:119], a[52:55], v[92:95]
 ds_read_b128 a[92:95], v7 offset:7168
 v_cvt_pk_bf16_f32 v62, v22, v23
M v[92:95], a[112:115], a[48:51], v[92:95]
 v_add_f32 v29, v23, v29
 v_add_f32 v29, v24, v29
M v[92:95], a[108:111], a[44:47], v[92:95]
 v_cvt_pk_bf16_f32 v63, v24, v25
 v_add_f32 v29, v25, v29
M v[92:95], a[104:107], a[40:43], v[92:95]
M v[92:95], a[100:103], a[36:39], v[92:95]
 s_waitcnt lgkmcnt(0)
M v[92:95], a[96:99], a[32:35], v[92:95]
 v_max_f32 v10, v28, v29
 v_cmp_lt_f32 vcc, s31, v10
 s_nop 0
 s_cbranch_vccnz L_st5
L_rt5:
M v[128:131], a[64:67], v[48:51], v[128:131]
 s_add_u32 m0, s28, 98304
 ds_read_b128 a[96:99], v7 offset:8192
 v_add_f32 v30, v28, v30
M v[128:131], a[68:71], v[56:59], v[128:131]
 ds_read_b128 a[100:103], v7 offset:9216
 v_add_f32 v31, v29, v31
M v[132:135], a[68:71], v[60:63], v[132:135]
 buffer_load_dwordx4 v3, s[8:11], s21 offen offset:0 sc1 lds
M v[132:135], a[64:67], v[52:55], v[132:135]
 s_cmp_eq_u32 s20, 3
 ds_read_b128 a[104:107], v7 offset:10240
M v[136:139], a[72:75], v[48:51], v[136:139]
 s_cselect_b64 s[64:65], s[16:17], 0
 ds_read_b128 a[108:111], v7 offset:11264
M v[136:139], a[76:79], v[56:59], v[136:139]
 buffer_load_dwordx4 v3, s[8:11], s21 offen offset:1024 sc1 lds
M v[140:143], a[76:79], v[60:63], v[140:143]
 s_cselect_b64 s[66:67], s[18:19], 0
 ds_read_b128 a[112:115], v7 offset:12288
M v[140:143], a[72:75], v[52:55], v[140:143]
 s_cselect_b64 s[68:69], s[48:49], 0
 ds_read_b128 a[116:119], v7 offset:13312
M v[144:147], a[80:83], v[48:51], v[144:147]
 s_cselect_b64 s[70:71], s[50:51], 0
 v_exp_f32 v18, v64
M v[144:147], a[84:87], v[56:59], v[144:147]
 s_cmp_gt_u32 s20, 2
 ds_read_b128 a[120:123], v7 offset:14336
M v[148:151], a[84:87], v[60:63], v[148:151]
 s_cselect_b64 s[78:79], -1, 0
 ds_read_b128 a[124:127], v7 offset:15360
M v[148:151], a[80:83], v[52:55], v[148:151]
 buffer_load_dwordx4 v3, s[8:11], s21 offen offset:2048 sc1 lds
M v[152:155], a[88:91], v[48:51], v[152:155]
 v_exp_f32 v19, v65
M v[152:155], a[92:95], v[56:59], v[152:155]
 v_exp_f32 v20, v66
M v[156:159], a[92:95], v[60:63], v[156:159]
 buffer_load_dwordx4 v3, s[8:11], s21 offen offset:3072 sc1 lds
M v[156:159], a[88:91], v[52:55], v[156:159]
 s_waitcnt lgkmcnt(0)
 v_exp_f32 v21, v67
M v[160:163], a[96:99], v[48:51], v[160:163]
 ds_read_b128 a[64:67], v7 offset:16384
 v_add_f32 v26, v18, v19
M v[160:163], a[100:103], v[56:59], v[160:163]
 s_add_u32 m0, s28, 102400
 ds_read_b128 a[68:71], v7 offset:17408
 v_cvt_pk_bf16_f32 v40, v18, v19
M v[164:167], a[100:103], v[60:63], v[164:167]
 buffer_load_dwordx4 v4, s[8:11], s21 offen offset:0 sc1 lds
M v[164:167], a[96:99], v[52:55], v[164:167]
 s_cmp_eq_u32 s20, 2
 ds_read_b128 a[72:75], v7 offset:18432
 v_add_f32 v26, v20, v26
M v[168:171], a[104:107], v[48:51], v[168:171]
 s_cselect_b64 s[72:73], s[16:17], s[78:79]
 ds_read_b128 a[76:79], v7 offset:19456
 v_cvt_pk_bf16_f32 v41, v20, v21
M v[168:171], a[108:111], v[56:59], v[168:171]
 s_cselect_b64 s[74:75], s[18:19], s[78:79]
 v_exp_f32 v22, v72
M v[172:175], a[108:111], v[60:63], v[172:175]
 s_cselect_b64 s[76:77], s[48:49], s[78:79]
 ds_read_b128 a[80:83], v7 offset:20480
 v_add_f32 v26, v21, v26
M v[172:175], a[104:107], v[52:55], v[172:175]
 s_cselect_b64 s[78:79], s[50:51], s[78:79]
 ds_read_b128 a[84:87], v7 offset:21504
M v[176:179], a[112:115], v[48:51], v[176:179]
 buffer_load_dwordx4 v4, s[8:11], s21 offen offset:1024 sc1 lds
M v[176:179], a[116:119], v[56:59], v[176:179]
 s_cmp_gt_u32 s20, 1
 ds_read_b128 a[88:91], v7 offset:22528
M v[180:183], a[116:119], v[60:63], v[180:183]
 s_cselect_b64 s[86:87], -1, 0
 ds_read_b128 a[92:95], v7 offset:23552
M v[180:183], a[112:115], v[52:55], v[180:183]
 buffer_load_dwordx4 v4, s[8:11], s21 offen offset:2048 sc1 lds
M v[184:187], a[120:123], v[48:51], v[184:187]
 s_cmp_eq_u32 s20, 1
 v_exp_f32 v23, v73
M v[184:187], a[124:127], v[56:59], v[184:187]
 s_cselect_b64 s[80:81], s[16:17], s[86:87]
 v_exp_f32 v24, v74
M v[188:191], a[124:127], v[60:63], v[188:191]
 s_cselect_b64 s[82:83], s[18:19], s[86:87]
 v_exp_f32 v25, v75
M v[188:191], a[120:123], v[52:55], v[188:191]
 s_waitcnt lgkmcnt(0)
 v_exp_f32 v18, v68
M v[192:195], a[64:67], v[48:51], v[192:195]
 s_cselect_b64 s[84:85], s[48:49], s[86:87]
 ds_read_b128 a[96:99], v7 offset:24576
 v_add_f32 v26, v22, v26
M v[192:195], a[68:71], v[56:59], v[192:195]
 s_cselect_b64 s[86:87], s[50:51], s[86:87]
 ds_read_b128 a[100:103], v7 offset:25600
 v_cvt_pk_bf16_f32 v42, v22, v23
M v[196:199], a[68:71], v[60:63], v[196:199]
 buffer_load_dwordx4 v4, s[8:11], s21 offen offset:3072 sc1 lds
M v[196:199], a[64:67], v[52:55], v[196:199]
 s_add_u32 s24, s23, 16777216
 ds_read_b128 a[104:107], v7 offset:26624
 v_add_f32 v26, v23, v26
M v[200:203], a[72:75], v[48:51], v[200:203]
 s_mov_b32 s23, s21
 ds_read_b128 a[108:111], v7 offset:27648
 v_add_f32 v26, v24, v26
M v[200:203], a[76:79], v[56:59], v[200:203]
 s_add_u32 s21, s21, 32768
 v_exp_f32 v19, v69
M v[204:207], a[76:79], v[60:63], v[204:207]
 s_add_u32 s22, s22, 1
 ds_read_b128 a[112:115], v7 offset:28672
 v_cvt_pk_bf16_f32 v43, v24, v25
M v[204:207], a[72:75], v[52:55], v[204:207]
 s_cmp_eq_u32 s22, s25
 ds_read_b128 a[116:119], v7 offset:29696
 v_add_f32 v26, v25, v26
M v[208:211], a[80:83], v[48:51], v[208:211]
 s_cselect_b32 s21, s26, s21
 v_exp_f32 v20, v70
M v[208:211], a[84:87], v[56:59], v[208:211]
 s_cmp_eq_u32 s22, s43
 ds_read_b128 a[120:123], v7 offset:30720
 v_add_f32 v27, v18, v19
M v[212:215], a[84:87], v[60:63], v[212:215]
 s_cselect_b32 s21, s4, s21
 ds_read_b128 a[124:127], v7 offset:31744
 v_cvt_pk_bf16_f32 v44, v18, v19
M v[212:215], a[80:83], v[52:55], v[212:215]
 s_cmp_eq_u32 s22, s6
 v_exp_f32 v21, v71
M v[216:219], a[88:91], v[48:51], v[216:219]
 s_cselect_b32 s21, s7, s21
 v_exp_f32 v22, v76
M v[216:219], a[92:95], v[56:59], v[216:219]
 s_cmp_eq_u32 s20, 0
 v_exp_f32 v23, v77
M v[220:223], a[92:95], v[60:63], v[220:223]
 s_waitcnt vmcnt(16) lgkmcnt(0)
 v_exp_f32 v24, v78
M v[220:223], a[88:91], v[52:55], v[220:223]
 s_barrier
M v[224:227], a[96:99], v[48:51], v[224:227]
 s_cselect_b64 s[88:89], s[16:17], -1
 ds_read_b128 a[64:67], v7 offset:32768
 v_add_f32 v27, v20, v27
M v[224:227], a[100:103], v[56:59], v[224:227]
 s_cselect_b64 s[90:91], s[18:19], -1
 ds_read_b128 a[68:71], v7 offset:33792
 v_cvt_pk_bf16_f32 v45, v20, v21
M v[228:231], a[100:103], v[60:63], v[228:231]
 buffer_load_dword v5, off, s[8:11], s47 sc1
M v[228:231], a[96:99], v[52:55], v[228:231]
 s_cselect_b64 s[92:93], s[48:49], -1
 ds_read_b128 a[72:75], v7 offset:34816
 v_add_f32 v27, v21, v27
M v[232:235], a[104:107], v[48:51], v[232:235]
 s_cselect_b64 s[94:95], s[50:51], -1
 ds_read_b128 a[76:79], v7 offset:35840
 v_add_f32 v27, v22, v27
M v[232:235], a[108:111], v[56:59], v[232:235]
 v_cndmask_b32 v100, v36, v8, s[64:65]
 v_cndmask_b32 v101, v36, v8, s[66:67]
M v[236:239], a[108:111], v[60:63], v[236:239]
 ds_read_b128 a[80:83], v7 offset:36864
 v_cndmask_b32 v102, v36, v8, s[68:69]
M v[236:239], a[104:107], v[52:55], v[236:239]
 ds_read_b128 a[84:87], v7 offset:37888
 v_cndmask_b32 v103, v36, v8, s[70:71]
M v[240:243], a[112:115], v[48:51], v[240:243]
 v_cndmask_b32 v108, v36, v8, s[72:73]
 v_cndmask_b32 v109, v36, v8, s[74:75]
M v[240:243], a[116:119], v[56:59], v[240:243]
 ds_read_b128 a[88:91], v7 offset:38912
 v_cndmask_b32 v110, v36, v8, s[76:77]
M v[244:247], a[116:119], v[60:63], v[244:247]
 ds_read_b128 a[92:95], v7 offset:39936
 v_cndmask_b32 v111, v36, v8, s[78:79]
M v[244:247], a[112:115], v[52:55], v[244:247]
 v_cndmask_b32 v116, v36, v8, s[80:81]
 v_cndmask_b32 v117, v36, v8, s[82:83]
M v[248:251], a[120:123], v[48:51], v[248:251]
 v_cndmask_b32 v118, v36, v8, s[84:85]
 v_cndmask_b32 v119, v36, v8, s[86:87]
M v[248:251], a[124:127], v[56:59], v[248:251]
 v_cndmask_b32 v124, v36, v8, s[88:89]
 v_cndmask_b32 v125, v36, v8, s[90:91]
M v[252:255], a[124:127], v[60:63], v[252:255]
 s_waitcnt lgkmcnt(0)
 v_cndmask_b32 v126, v36, v8, s[92:93]
 v_cndmask_b32 v127, v36, v8, s[94:95]
M v[252:255], a[120:123], v[52:55], v[252:255]
 v_exp_f32 v25, v79
 v_cvt_pk_bf16_f32 v46, v22, v23
 v_add_f32 v27, v23, v27
 v_add_f32 v27, v24, v27
 v_cvt_pk_bf16_f32 v47, v24, v25
 v_add_f32 v27, v25, v27
L_p2:
M v[100:103], a[64:67], a[32:35], v[100:103]
 ds_read_b128 a[96:99], v7 offset:40960
 ds_read_b128 a[100:103], v7 offset:41984
 v_exp_f32 v18, v80
M v[100:103], a[68:71], a[36:39], v[100:103]
 ds_read_b128 a[104:107], v7 offset:43008
 v_exp_f32 v19, v81
M v[100:103], a[72:75], a[40:43], v[100:103]
 ds_read_b128 a[108:111], v7 offset:44032
 ds_read_b128 a[112:115], v7 offset:45056
 v_exp_f32 v20, v82
 v_add_f32 v26, v18, v26
M v[100:103], a[76:79], a[44:47], v[100:103]
 ds_read_b128 a[116:119], v7 offset:46080
 v_cvt_pk_bf16_f32 v56, v18, v19
 v_exp_f32 v21, v83
M v[100:103], a[80:83], a[48:51], v[100:103]
 s_add_u32 m0, s28, 0
 ds_read_b128 a[120:123], v7 offset:47104
 ds_read_b128 a[124:127], v7 offset:48128
 v_add_f32 v26, v19, v26
M v[100:103], a[84:87], a[52:55], v[100:103]
 buffer_load_dwordx4 v3, s[8:11], s24 offen offset:0 sc1 lds
M v[100:103], a[88:91], a[56:59], v[100:103]
 ds_read_b128 a[128:131], v7 offset:49152
 ds_read_b128 a[132:135], v7 offset:50176
 v_exp_f32 v22, v88
 v_add_f32 v26, v20, v26
 v_cvt_pk_bf16_f32 v57, v20, v21
M v[100:103], a[92:95], a[60:63], v[100:103]
 s_waitcnt lgkmcnt(2)
 ds_read_b128 a[136:139], v7 offset:51200
 v_exp_f32 v23, v89
 v_add_f32 v26, v21, v26
M v[108:111], a[124:127], a[60:63], v[108:111]
 ds_read_b128 a[140:143], v7 offset:52224
 ds_read_b128 a[144:147], v7 offset:53248
 v_exp_f32 v24, v90
M v[108:111], a[120:123], a[56:59], v[108:111]
 buffer_load_dwordx4 v3, s[8:11], s24 offen offset:1024 sc1 lds
M v[108:111], a[116:119], a[52:55], v[108:111]
 ds_read_b128 a[148:151], v7 offset:54272
 ds_read_b128 a[152:155], v7 offset:55296
 v_add_f32 v26, v22, v26
 v_cvt_pk_bf16_f32 v58, v22, v23
M v[108:111], a[112:115], a[48:51], v[108:111]
 ds_read_b128 a[156:159], v7 offset:56320
 v_exp_f32 v25, v91
 v_add_f32 v26, v23, v26
M v[108:111], a[108:111], a[44:47], v[108:111]
 ds_read_b128 a[160:163], v7 offset:57344
 ds_read_b128 a[164:167], v7 offset:58368
 v_exp_f32 v18, v84
M v[108:111], a[104:107], a[40:43], v[108:111]
 buffer_load_dwordx4 v3, s[8:11], s24 offen offset:2048 sc1 lds
M v[108:111], a[100:103], a[36:39], v[108:111]
 ds_read_b128 a[168:171], v7 offset:59392
 ds_read_b128 a[172:175], v7 offset:60416
 v_add_f32 v26, v24, v26
 v_cvt_pk_bf16_f32 v59, v24, v25
M v[108:111], a[96:99], a[32:35], v[108:111]
 s_waitcnt lgkmcnt(4)
 ds_read_b128 a[176:179], v7 offset:61440
 v_exp_f32 v19, v85
 v_add_f32 v26, v25, v26
M v[116:119], a[128:131], a[32:35], v[116:119]
 ds_read_b128 a[180:183], v7 offset:62464
 ds_read_b128 a[184:187], v7 offset:63488
 v_exp_f32 v20, v86
M v[116:119], a[132:135], a[36:39], v[116:119]
 ds_read_b128 a[188:191], v7 offset:64512
 v_add_f32 v27, v18, v27
 v_cvt_pk_bf16_f32 v60, v18, v19
M v[116:119], a[136:139], a[40:43], v[116:119]
 buffer_load_dwordx4 v3, s[8:11], s24 offen offset:3072 sc1 lds
M v[116:119], a[140:143], a[44:47], v[116:119]
 s_add_u32 m0, s28, 4096
 v_exp_f32 v21, v87
 v_add_f32 v27, v19, v27
 v_exp_f32 v22, v92
M v[116:119], a[144:147], a[48:51], v[116:119]
 buffer_load_dwordx4 v4, s[8:11], s24 offen offset:0 sc1 lds
M v[116:119], a[148:151], a[52:55], v[116:119]
 s_waitcnt vmcnt(14) lgkmcnt(0)
 v_add_f32 v27, v20, v27
 v_cvt_pk_bf16_f32 v61, v20, v21
 v_exp_f32 v23, v93
 v_add_f32 v27, v21, v27
M v[116:119], a[152:155], a[56:59], v[116:119]
 s_barrier
M v[116:119], a[156:159], a[60:63], v[116:119]
 ds_read_b128 a[64:67], v2 offset:0
 ds_read_b128 a[68:71], v2 offset:1024
 v_exp_f32 v24, v94
M v[124:127], a[188:191], a[60:63], v[124:127]
 ds_read_b128 a[72:75], v2 offset:2048
 v_add_f32 v27, v22, v27
 v_cvt_pk_bf16_f32 v62, v22, v23
M v[124:127], a[184:187], a[56:59], v[124:127]
 ds_read_b128 a[76:79], v2 offset:3072
 ds_read_b128 a[80:83], v2 offset:4096
 v_exp_f32 v25, v95
 v_add_f32 v27, v23, v27
M v[124:127], a[180:183], a[52:55], v[124:127]
 ds_read_b128 a[84:87], v2 offset:5120
 v_add_f32 v27, v24, v27
 v_cvt_pk_bf16_f32 v63, v24, v25
 v_add_f32 v27, v25, v27
M v[124:127], a[176:179], a[48:51], v[124:127]
 ds_read_b128 a[88:91], v2 offset:6144
 ds_read_b128 a[92:95], v2 offset:7168
 v_max_f32 v10, v26, v27
 v_cmp_lt_f32 vcc, s31, v10
M v[124:127], a[172:175], a[44:47], v[124:127]
 buffer_load_dwordx4 v4, s[8:11], s24 offen offset:1024 sc1 lds
M v[124:127], a[168:171], a[40:43], v[124:127]
 buffer_load_dwordx4 v4, s[8:11], s24 offen offset:2048 sc1 lds
M v[124:127], a[164:167], a[36:39], v[124:127]
 buffer_load_dwordx4 v4, s[8:11], s24 offen offset:3072 sc1 lds
M v[124:127], a[160:163], a[32:35], v[124:127]
 s_waitcnt lgkmcnt(0)
 s_cbranch_vccnz L_st6
L_rt6:
 s_cmp_le_u32 s42, 5
 s_cbranch_scc1 L_p3k
 s_cmp_ge_u32 s42, 10
 s_cbranch_scc1 L_p3c
M v[128:131], a[64:67], v[40:43], v[128:131]
 s_add_u32 m0, s28, 32768
 ds_read_b128 a[96:99], v2 offset:8192
 v_add_f32 v30, v26, v30
M v[128:131], a[68:71], v[56:59], v[128:131]
 ds_read_b128 a[100:103], v2 offset:9216
 v_add_f32 v31, v27, v31
M v[132:135], a[68:71], v[60:63], v[132:135]
 buffer_load_dwordx4 v3, s[8:11], s21 offen offset:0 sc1 lds
M v[132:135], a[64:67], v[44:47], v[132:135]
 ds_read_b128 a[104:107], v2 offset:10240
M v[136:139], a[72:75], v[40:43], v[136:139]
 ds_read_b128 a[108:111], v2 offset:11264
M v[136:139], a[76:79], v[56:59], v[136:139]
 buffer_load_dwordx4 v3, s[8:11], s21 offen offset:1024 sc1 lds
M v[140:143], a[76:79], v[60:63], v[140:143]
 ds_read_b128 a[112:115], v2 offset:12288
M v[140:143], a[72:75], v[44:47], v[140:143]
 ds_read_b128 a[116:119], v2 offset:13312
M v[144:147], a[80:83], v[40:43], v[144:147]
 v_exp_f32 v18, v100
M v[144:147], a[84:87], v[56:59], v[144:147]
 ds_read_b128 a[120:123], v2 offset:14336
M v[148:151], a[84:87], v[60:63], v[148:151]
 ds_read_b128 a[124:127], v2 offset:15360
M v[148:151], a[80:83], v[44:47], v[148:151]
 buffer_load_dwordx4 v3, s[8:11], s21 offen offset:2048 sc1 lds
M v[152:155], a[88:91], v[40:43], v[152:155]
 v_exp_f32 v19, v101
M v[152:155], a[92:95], v[56:59], v[152:155]
 v_exp_f32 v20, v102
M v[156:159], a[92:95], v[60:63], v[156:159]
 buffer_load_dwordx4 v3, s[8:11], s21 offen offset:3072 sc1 lds
M v[156:159], a[88:91], v[44:47], v[156:159]
 s_waitcnt lgkmcnt(0)
 v_exp_f32 v21, v103
M v[160:163], a[96:99], v[40:43], v[160:163]
 ds_read_b128 a[64:67], v2 offset:16384
 v_add_f32 v29, v18, v19
M v[160:163], a[100:103], v[56:59], v[160:163]
 s_add_u32 m0, s28, 36864
 ds_read_b128 a[68:71], v2 offset:17408
 v_cvt_pk_bf16_f32 v52, v18, v19
M v[164:167], a[100:103], v[60:63], v[164:167]
 buffer_load_dwordx4 v4, s[8:11], s21 offen offset:0 sc1 lds
M v[164:167], a[96:99], v[44:47], v[164:167]
 ds_read_b128 a[72:75], v2 offset:18432
 v_add_f32 v29, v20, v29
M v[168:171], a[104:107], v[40:43], v[168:171]
 ds_read_b128 a[76:79], v2 offset:19456
 v_cvt_pk_bf16_f32 v53, v20, v21
M v[168:171], a[108:111], v[56:59], v[168:171]
 v_exp_f32 v22, v108
M v[172:175], a[108:111], v[60:63], v[172:175]
 ds_read_b128 a[80:83], v2 offset:20480
 v_add_f32 v29, v21, v29
M v[172:175], a[104:107], v[44:47], v[172:175]
 ds_read_b128 a[84:87], v2 offset:21504
M v[176:179], a[112:115], v[40:43], v[176:179]
 buffer_load_dwordx4 v4, s[8:11], s21 offen offset:1024 sc1 lds
M v[176:179], a[116:119], v[56:59], v[176:179]
 ds_read_b128 a[88:91], v2 offset:22528
M v[180:183], a[116:119], v[60:63], v[180:183]
 ds_read_b128 a[92:95], v2 offset:23552
M v[180:183], a[112:115], v[44:47], v[180:183]
 buffer_load_dwordx4 v4, s[8:11], s21 offen offset:2048 sc1 lds
M v[184:187], a[120:123], v[40:43], v[184:187]
 v_exp_f32 v23, v109
M v[184:187], a[124:127], v[56:59], v[184:187]
 v_exp_f32 v24, v110
M v[188:191], a[124:127], v[60:63], v[188:191]
 v_exp_f32 v25, v111
M v[188:191], a[120:123], v[44:47], v[188:191]
 s_waitcnt lgkmcnt(0)
 v_exp_f32 v18, v116
M v[192:195], a[64:67], v[40:43], v[192:195]
 ds_read_b128 a[96:99], v2 offset:24576
 v_add_f32 v29, v22, v29
M v[192:195], a[68:71], v[56:59], v[192:195]
 ds_read_b128 a[100:103], v2 offset:25600
 v_cvt_pk_bf16_f32 v54, v22, v23
M v[196:199], a[68:71], v[60:63], v[196:199]
 buffer_load_dwordx4 v4, s[8:11], s21 offen offset:3072 sc1 lds
M v[196:199], a[64:67], v[44:47], v[196:199]
 s_add_u32 s24, s23, 16777216
 ds_read_b128 a[104:107], v2 offset:26624
 v_add_f32 v29, v23, v29
M v[200:203], a[72:75], v[40:43], v[200:203]
 s_mov_b32 s23, s21
 ds_read_b128 a[108:111], v2 offset:27648
 v_add_f32 v29, v24, v29
M v[200:203], a[76:79], v[56:59], v[200:203]
 s_add_u32 s21, s21, 32768
 v_exp_f32 v19, v117
M v[204:207], a[76:79], v[60:63], v[204:207]
 s_add_u32 s22, s22, 1
 ds_read_b128 a[112:115], v2 offset:28672
 v_cvt_pk_bf16_f32 v55, v24, v25
M v[204:207], a[72:75], v[44:47], v[204:207]
 s_cmp_eq_u32 s22, s25
 ds_read_b128 a[116:119], v2 offset:29696
 v_add_f32 v29, v25, v29
M v[208:211], a[80:83], v[40:43], v[208:211]
 s_cselect_b32 s21, s26, s21
 v_exp_f32 v20, v118
M v[208:211], a[84:87], v[56:59], v[208:211]
 s_cmp_eq_u32 s22, s43
 ds_read_b128 a[120:123], v2 offset:30720
 v_add_f32 v29, v18, v29
M v[212:215], a[84:87], v[60:63], v[212:215]
 s_cselect_b32 s21, s4, s21
 ds_read_b128 a[124:127], v2 offset:31744
 v_cvt_pk_bf16_f32 v48, v18, v19
M v[212:215], a[80:83], v[44:47], v[212:215]
 s_cmp_eq_u32 s22, s6
 v_exp_f32 v21, v119
M v[216:219], a[88:91], v[40:43], v[216:219]
 s_cselect_b32 s21, s7, s21
 v_exp_f32 v22, v124
M v[216:219], a[92:95], v[56:59], v[216:219]
 v_exp_f32 v23, v125
M v[220:223], a[92:95], v[60:63], v[220:223]
 s_waitcnt vmcnt(8) lgkmcnt(0)
 v_add_f32 v29, v19, v29
 v_add_f32 v29, v20, v29
M v[220:223], a[88:91], v[44:47], v[220:223]
 s_barrier
M v[224:227], a[96:99], v[40:43], v[224:227]
 ds_read_b128 a[64:67], v7 offset:0
 v_cvt_pk_bf16_f32 v49, v20, v21
M v[224:227], a[100:103], v[56:59], v[224:227]
 ds_read_b128 a[68:71], v7 offset:1024
 v_add_f32 v29, v21, v29
M v[228:231], a[100:103], v[60:63], v[228:231]
 v_exp_f32 v24, v126
M v[228:231], a[96:99], v[44:47], v[228:231]
 ds_read_b128 a[72:75], v7 offset:2048
 v_add_f32 v29, v22, v29
M v[232:235], a[104:107], v[40:43], v[232:235]
 ds_read_b128 a[76:79], v7 offset:3072
 v_cvt_pk_bf16_f32 v50, v22, v23
M v[232:235], a[108:111], v[56:59], v[232:235]
 v_exp_f32 v25, v127
M v[236:239], a[108:111], v[60:63], v[236:239]
 ds_read_b128 a[80:83], v7 offset:4096
 v_add_f32 v29, v23, v29
M v[236:239], a[104:107], v[44:47], v[236:239]
 ds_read_b128 a[84:87], v7 offset:5120
 v_add_f32 v29, v24, v29
M v[240:243], a[112:115], v[40:43], v[240:243]
 v_cvt_pk_bf16_f32 v51, v24, v25
 v_add_f32 v29, v25, v29
M v[240:243], a[116:119], v[56:59], v[240:243]
 ds_read_b128 a[88:91], v7 offset:6144
M v[244:247], a[116:119], v[60:63], v[244:247]
 ds_read_b128 a[92:95], v7 offset:7168
M v[244:247], a[112:115], v[44:47], v[244:247]
 v_cmp_lt_f32 vcc, s31, v29
M v[248:251], a[120:123], v[40:43], v[248:251]
M v[248:251], a[124:127], v[56:59], v[248:251]
M v[252:255], a[124:127], v[60:63], v[252:255]
 s_waitcnt lgkmcnt(0)
M v[252:255], a[120:123], v[44:47], v[252:255]
 s_cbranch_vccnz L_st2
L_rt2:
L_pBo:
M v[132:135], a[64:67], v[52:55], v[132:135]
 ds_read_b128 a[96:99], v7 offset:8192
 ds_read_b128 a[100:103], v7 offset:9216
M v[132:135], a[68:71], v[48:51], v[132:135]
 ds_read_b128 a[104:107], v7 offset:10240
 v_cvt_pk_bf16_f32 v128, v128, v129
 v_cvt_pk_bf16_f32 v129, v130, v131
M v[140:143], a[76:79], v[48:51], v[140:143]
 ds_read_b128 a[108:111], v7 offset:11264
 ds_read_b128 a[112:115], v7 offset:12288
 v_cvt_pk_bf16_f32 v130, v136, v137
M v[140:143], a[72:75], v[52:55], v[140:143]
 ds_read_b128 a[116:119], v7 offset:13312
 v_cvt_pk_bf16_f32 v131, v138, v139
 v_cvt_pk_bf16_f32 v144, v144, v145
M v[148:151], a[80:83], v[52:55], v[148:151]
 s_add_u32 m0, s28, 65536
 ds_read_b128 a[120:123], v7 offset:14336
 ds_read_b128 a[124:127], v7 offset:15360
M v[148:151], a[84:87], v[48:51], v[148:151]
 buffer_load_dwordx4 v3, s[8:11], s38 offen offset:0 sc1 lds
M v[156:159], a[92:95], v[48:51], v[156:159]
 ds_read_b128 a[128:131], v7 offset:16384
 ds_read_b128 a[132:135], v7 offset:17408
 v_cvt_pk_bf16_f32 v145, v146, v147
M v[156:159], a[88:91], v[52:55], v[156:159]
 s_waitcnt lgkmcnt(2)
 ds_read_b128 a[136:139], v7 offset:18432
 v_cvt_pk_bf16_f32 v146, v152, v153
 v_cvt_pk_bf16_f32 v147, v154, v155
M v[164:167], a[96:99], v[52:55], v[164:167]
 ds_read_b128 a[140:143], v7 offset:19456
 ds_read_b128 a[144:147], v7 offset:20480
 v_cvt_pk_bf16_f32 v160, v160, v161
M v[164:167], a[100:103], v[48:51], v[164:167]
 buffer_load_dwordx4 v3, s[8:11], s38 offen offset:1024 sc1 lds
M v[172:175], a[108:111], v[48:51], v[172:175]
 ds_read_b128 a[148:151], v7 offset:21504
 ds_read_b128 a[152:155], v7 offset:22528
 v_cvt_pk_bf16_f32 v161, v162, v163
M v[172:175], a[104:107], v[52:55], v[172:175]
 ds_read_b128 a[156:159], v7 offset:23552
 v_cvt_pk_bf16_f32 v162, v168, v169
 v_cvt_pk_bf16_f32 v163, v170, v171
M v[180:183], a[112:115], v[52:55], v[180:183]
 ds_read_b128 a[160:163], v7 offset:24576
 ds_read_b128 a[164:167], v7 offset:25600
 v_cvt_pk_bf16_f32 v176, v176, v177
M v[180:183], a[116:119], v[48:51], v[180:183]
 buffer_load_dwordx4 v3, s[8:11], s38 offen offset:2048 sc1 lds
M v[188:191], a[124:127], v[48:51], v[188:191]
 ds_read_b128 a[168:171], v7 offset:26624
 ds_read_b128 a[172:175], v7 offset:27648
 v_cvt_pk_bf16_f32 v177, v178, v179
M v[188:191], a[120:123], v[52:55], v[188:191]
 s_waitcnt lgkmcnt(4)
 ds_read_b128 a[176:179], v7 offset:28672
 v_cvt_pk_bf16_f32 v178, v184, v185
M v[196:199], a[128:131], v[52:55], v[196:199]
 ds_read_b128 a[180:183], v7 offset:29696
 ds_read_b128 a[184:187], v7 offset:30720
 v_cvt_pk_bf16_f32 v179, v186, v187
M v[196:199], a[132:135], v[48:51], v[196:199]
 ds_read_b128 a[188:191], v7 offset:31744
 v_cvt_pk_bf16_f32 v192, v192, v193
 v_cvt_pk_bf16_f32 v193, v194, v195
M v[204:207], a[140:143], v[48:51], v[204:207]
 buffer_load_dwordx4 v3, s[8:11], s38 offen offset:3072 sc1 lds
M v[204:207], a[136:139], v[52:55], v[204:207]
 s_add_u32 m0, s28, 69632
 v_cvt_pk_bf16_f32 v194, v200, v201
 v_cvt_pk_bf16_f32 v195, v202, v203
 v_cvt_pk_bf16_f32 v208, v208, v209
M v[212:215], a[144:147], v[52:55], v[212:215]
 buffer_load_dwordx4 v4, s[8:11], s38 offen offset:0 sc1 lds
M v[212:215], a[148:151], v[48:51], v[212:215]
 s_waitcnt lgkmcnt(0)
 v_cvt_pk_bf16_f32 v209, v210, v211
 v_cvt_pk_bf16_f32 v210, v216, v217
 v_cvt_pk_bf16_f32 v211, v218, v219
M v[220:223], a[156:159], v[48:51], v[220:223]
 s_barrier
M v[220:223], a[152:155], v[52:55], v[220:223]
 ds_read_b128 a[64:67], v2 offset:32768
 ds_read_b128 a[68:71], v2 offset:33792
 v_cvt_pk_bf16_f32 v224, v224, v225
M v[228:231], a[160:163], v[52:55], v[228:231]
 ds_read_b128 a[72:75], v2 offset:34816
 v_cvt_pk_bf16_f32 v225, v226, v227
 v_cvt_pk_bf16_f32 v226, v232, v233
M v[228:231], a[164:167], v[48:51], v[228:231]
 ds_read_b128 a[76:79], v2 offset:35840
 ds_read_b128 a[80:83], v2 offset:36864
M v[236:239], a[172:175], v[48:51], v[236:239]
 ds_read_b128 a[84:87], v2 offset:37888
 v_cvt_pk_bf16_f32 v227, v234, v235
 v_cvt_pk_bf16_f32 v240, v240, v241
M v[236:239], a[168:171], v[52:55], v[236:239]
 ds_read_b128 a[88:91], v2 offset:38912
 ds_read_b128 a[92:95], v2 offset:39936
 v_cvt_pk_bf16_f32 v241, v242, v243
M v[244:247], a[176:179], v[52:55], v[244:247]
 buffer_load_dwordx4 v4, s[8:11], s38 offen offset:1024 sc1 lds
M v[244:247], a[180:183], v[48:51], v[244:247]
 buffer_load_dwordx4 v4, s[8:11], s38 offen offset:2048 sc1 lds
M v[252:255], a[188:191], v[48:51], v[252:255]
 buffer_load_dwordx4 v4, s[8:11], s38 offen offset:3072 sc1 lds
M v[252:255], a[184:187], v[52:55], v[252:255]
 s_waitcnt lgkmcnt(0)
 s_add_u32 s38, s38, 32768
 v_cvt_pk_bf16_f32 v242, v248, v249
 v_cvt_pk_bf16_f32 v243, v250, v251
 s_branch L_op1
L_p3c:
 s_waitcnt vmcnt(8)
 v_cmp_ne_u32 vcc, 1, v5
 s_nop 0
 s_cbranch_vccnz L_fps0
L_fpr0:
M v[128:131], a[64:67], v[40:43], v[128:131]
 ds_read_b128 a[96:99], v2 offset:8192
 ds_read_b128 a[100:103], v2 offset:9216
M v[128:131], a[68:71], v[56:59], v[128:131]
 buffer_load_dwordx4 v[14:17], v7, s[8:11], s52 offen sc1
M v[132:135], a[68:71], v[60:63], v[132:135]
 v_exp_f32 v18, v100
M v[132:135], a[64:67], v[44:47], v[132:135]
 ds_read_b128 a[104:107], v2 offset:10240
 ds_read_b128 a[108:111], v2 offset:11264
M v[136:139], a[72:75], v[40:43], v[136:139]
 buffer_load_dwordx4 a[128:131], v7, s[8:11], s12 offen offset:0 sc1
M v[136:139], a[76:79], v[56:59], v[136:139]
 v_exp_f32 v19, v101
M v[140:143], a[76:79], v[60:63], v[140:143]
 ds_read_b128 a[112:115], v2 offset:12288
 ds_read_b128 a[116:119], v2 offset:13312
M v[140:143], a[72:75], v[44:47], v[140:143]
 buffer_load_dwordx4 a[132:135], v7, s[8:11], s12 offen offset:1024 sc1
M v[144:147], a[80:83], v[40:43], v[144:147]
 v_exp_f32 v20, v102
M v[144:147], a[84:87], v[56:59], v[144:147]
 ds_read_b128 a[120:123], v2 offset:14336
 ds_read_b128 a[124:127], v2 offset:15360
M v[148:151], a[84:87], v[60:63], v[148:151]
 buffer_load_dwordx4 a[136:139], v7, s[8:11], s12 offen offset:2048 sc1
M v[148:151], a[80:83], v[44:47], v[148:151]
 v_exp_f32 v21, v103
M v[152:155], a[88:91], v[40:43], v[152:155]
 v_add_f32 v30, v26, v30
 v_add_f32 v31, v27, v31
M v[152:155], a[92:95], v[56:59], v[152:155]
 v_add_f32 v29, v18, v19
 v_cvt_pk_bf16_f32 v52, v18, v19
M v[156:159], a[92:95], v[60:63], v[156:159]
 buffer_load_dwordx4 a[140:143], v7, s[8:11], s12 offen offset:3072 sc1
M v[156:159], a[88:91], v[44:47], v[156:159]
 s_waitcnt lgkmcnt(0)
 v_exp_f32 v22, v108
M v[160:163], a[96:99], v[40:43], v[160:163]
 ds_read_b128 a[64:67], v2 offset:16384
 ds_read_b128 a[68:71], v2 offset:17408
M v[160:163], a[100:103], v[56:59], v[160:163]
 buffer_load_dwordx4 a[144:147], v7, s[8:11], s13 offen offset:0 sc1
M v[164:167], a[100:103], v[60:63], v[164:167]
 v_exp_f32 v23, v109
M v[164:167], a[96:99], v[44:47], v[164:167]
 ds_read_b128 a[72:75], v2 offset:18432
 ds_read_b128 a[76:79], v2 offset:19456
M v[168:171], a[104:107], v[40:43], v[168:171]
 v_add_f32 v29, v20, v29
 v_cvt_pk_bf16_f32 v53, v20, v21
M v[168:171], a[108:111], v[56:59], v[168:171]
 buffer_load_dwordx4 a[148:151], v7, s[8:11], s13 offen offset:1024 sc1
M v[172:175], a[108:111], v[60:63], v[172:175]
 ds_read_b128 a[80:83], v2 offset:20480
 ds_read_b128 a[84:87], v2 offset:21504
M v[172:175], a[104:107], v[44:47], v[172:175]
 v_exp_f32 v24, v110
M v[176:179], a[112:115], v[40:43], v[176:179]
 buffer_load_dwordx4 a[152:155], v7, s[8:11], s13 offen offset:2048 sc1
M v[176:179], a[116:119], v[56:59], v[176:179]
 ds_read_b128 a[88:91], v2 offset:22528
 ds_read_b128 a[92:95], v2 offset:23552
M v[180:183], a[116:119], v[60:63], v[180:183]
 v_exp_f32 v25, v111
M v[180:183], a[112:115], v[44:47], v[180:183]
 v_add_f32 v29, v21, v29
 v_add_f32 v29, v22, v29
M v[184:187], a[120:123], v[40:43], v[184:187]
 buffer_load_dwordx4 a[156:159], v7, s[8:11], s13 offen offset:3072 sc1
M v[184:187], a[124:127], v[56:59], v[184:187]
 v_exp_f32 v18, v116
M v[188:191], a[124:127], v[60:63], v[188:191]
 v_cvt_pk_bf16_f32 v54, v22, v23
 v_add_f32 v29, v23, v29
M v[188:191], a[120:123], v[44:47], v[188:191]
 s_waitcnt lgkmcnt(0)
 v_exp_f32 v19, v117
M v[192:195], a[64:67], v[40:43], v[192:195]
 ds_read_b128 a[96:99], v2 offset:24576
 ds_read_b128 a[100:103], v2 offset:25600
M v[192:195], a[68:71], v[56:59], v[192:195]
 buffer_load_dwordx4 a[160:163], v7, s[8:11], s14 offen offset:0 sc1
M v[196:199], a[68:71], v[60:63], v[196:199]
 v_add_f32 v29, v24, v29
 v_cvt_pk_bf16_f32 v55, v24, v25
M v[196:199], a[64:67], v[44:47], v[196:199]
 ds_read_b128 a[104:107], v2 offset:26624
 ds_read_b128 a[108:111], v2 offset:27648
M v[200:203], a[72:75], v[40:43], v[200:203]
 buffer_load_dwordx4 a[164:167], v7, s[8:11], s14 offen offset:1024 sc1
M v[200:203], a[76:79], v[56:59], v[200:203]
 v_exp_f32 v20, v118
M v[204:207], a[76:79], v[60:63], v[204:207]
 ds_read_b128 a[112:115], v2 offset:28672
 ds_read_b128 a[116:119], v2 offset:29696
M v[204:207], a[72:75], v[44:47], v[204:207]
 buffer_load_dwordx4 a[168:171], v7, s[8:11], s14 offen offset:2048 sc1
M v[208:211], a[80:83], v[40:43], v[208:211]
 v_exp_f32 v21, v119
M v[208:211], a[84:87], v[56:59], v[208:211]
 ds_read_b128 a[120:123], v2 offset:30720
 ds_read_b128 a[124:127], v2 offset:31744
M v[212:215], a[84:87], v[60:63], v[212:215]
 buffer_load_dwordx4 a[172:175], v7, s[8:11], s14 offen offset:3072 sc1
M v[212:215], a[80:83], v[44:47], v[212:215]
 v_exp_f32 v22, v124
M v[216:219], a[88:91], v[40:43], v[216:219]
 v_add_f32 v29, v25, v29
 v_add_f32 v29, v18, v29
M v[216:219], a[92:95], v[56:59], v[216:219]
 buffer_load_dwordx4 a[176:179], v7, s[8:11], s15 offen offset:0 sc1
M v[220:223], a[92:95], v[60:63], v[220:223]
 s_waitcnt vmcnt(14) lgkmcnt(0)
 v_exp_f32 v23, v125
M v[220:223], a[88:91], v[44:47], v[220:223]
 s_barrier
M v[224:227], a[96:99], v[40:43], v[224:227]
 ds_read_b128 a[64:67], v7 offset:0
 ds_read_b128 a[68:71], v7 offset:1024
M v[224:227], a[100:103], v[56:59], v[224:227]
 buffer_load_dwordx4 a[180:183], v7, s[8:11], s15 offen offset:1024 sc1
M v[228:231], a[100:103], v[60:63], v[228:231]
 v_exp_f32 v24, v126
M v[228:231], a[96:99], v[44:47], v[228:231]
 ds_read_b128 a[72:75], v7 offset:2048
 ds_read_b128 a[76:79], v7 offset:3072
M v[232:235], a[104:107], v[40:43], v[232:235]
 buffer_load_dwordx4 a[184:187], v7, s[8:11], s15 offen offset:2048 sc1
M v[232:235], a[108:111], v[56:59], v[232:235]
 v_exp_f32 v25, v127
M v[236:239], a[108:111], v[60:63], v[236:239]
 ds_read_b128 a[80:83], v7 offset:4096
 ds_read_b128 a[84:87], v7 offset:5120
M v[236:239], a[104:107], v[44:47], v[236:239]
 v_cvt_pk_bf16_f32 v48, v18, v19
 v_add_f32 v29, v19, v29
M v[240:243], a[112:115], v[40:43], v[240:243]
 buffer_load_dwordx4 a[188:191], v7, s[8:11], s15 offen offset:3072 sc1
M v[240:243], a[116:119], v[56:59], v[240:243]
 ds_read_b128 a[88:91], v7 offset:6144
 ds_read_b128 a[92:95], v7 offset:7168
M v[244:247], a[116:119], v[60:63], v[244:247]
 v_add_f32 v29, v20, v29
 v_cvt_pk_bf16_f32 v49, v20, v21
M v[244:247], a[112:115], v[44:47], v[244:247]
 v_add_f32 v29, v21, v29
 v_add_f32 v29, v22, v29
M v[248:251], a[120:123], v[40:43], v[248:251]
 v_cvt_pk_bf16_f32 v50, v22, v23
 v_add_f32 v29, v23, v29
M v[248:251], a[124:127], v[56:59], v[248:251]
 v_add_f32 v29, v24, v29
 v_cvt_pk_bf16_f32 v51, v24, v25
M v[252:255], a[124:127], v[60:63], v[252:255]
 s_waitcnt lgkmcnt(0)
 v_add_f32 v29, v25, v29
M v[252:255], a[120:123], v[44:47], v[252:255]
 v_cmp_lt_f32 vcc, s31, v29
 s_nop 0
 s_cbranch_vccnz L_st3
L_rt3:
 s_waitcnt vmcnt(16)
 v_cmp_neq_f32 vcc, v32, v14
 v_cmp_neq_f32 s[64:65], v36, v15
 v_add_f32 v16, v16, v30
 v_add_f32 v17, v17, v31
 s_or_b64 vcc, vcc, s[64:65]
 s_cbranch_vccnz L_comb
M v[132:135], a[64:67], v[52:55], v[132:135]
 s_add_u32 m0, s28, 32768
 ds_read_b128 a[96:99], v7 offset:8192
 ds_read_b128 a[100:103], v7 offset:9216
M v[132:135], a[68:71], v[48:51], v[132:135]
 buffer_load_dwordx4 v3, s[8:11], s21 offen offset:0 sc1 lds
M v[140:143], a[76:79], v[48:51], v[140:143]
 ds_read_b128 a[104:107], v7 offset:10240
 ds_read_b128 a[108:111], v7 offset:11264
M v[140:143], a[72:75], v[52:55], v[140:143]
 v_mov_b32 v30, v16
 v_mov_b32 v31, v17
M v[148:151], a[80:83], v[52:55], v[148:151]
 ds_read_b128 a[112:115], v7 offset:12288
 ds_read_b128 a[116:119], v7 offset:13312
M v[148:151], a[84:87], v[48:51], v[148:151]
 ds_read_b128 a[120:123], v7 offset:14336
M v[156:159], a[92:95], v[48:51], v[156:159]
 ds_read_b128 a[124:127], v7 offset:15360
 ds_read_b128 a[192:195], v7 offset:16384
M v[156:159], a[88:91], v[52:55], v[156:159]
 s_waitcnt lgkmcnt(5)
M v[164:167], a[96:99], v[52:55], v[164:167]
 ds_read_b128 a[196:199], v7 offset:17408
 ds_read_b128 a[200:203], v7 offset:18432
M v[164:167], a[100:103], v[48:51], v[164:167]
 buffer_load_dwordx4 v3, s[8:11], s21 offen offset:1024 sc1 lds
M v[172:175], a[108:111], v[48:51], v[172:175]
 ds_read_b128 a[204:207], v7 offset:19456
 ds_read_b128 a[208:211], v7 offset:20480
M v[172:175], a[104:107], v[52:55], v[172:175]
 s_waitcnt lgkmcnt(5)
M v[180:183], a[112:115], v[52:55], v[180:183]
 ds_read_b128 a[212:215], v7 offset:21504
 ds_read_b128 a[216:219], v7 offset:22528
M v[180:183], a[116:119], v[48:51], v[180:183]
 buffer_load_dwordx4 v3, s[8:11], s21 offen offset:2048 sc1 lds
M v[188:191], a[124:127], v[48:51], v[188:191]
 ds_read_b128 a[220:223], v7 offset:23552
M v[188:191], a[120:123], v[52:55], v[188:191]
 s_waitcnt lgkmcnt(4)
M v[196:199], a[192:195], v[52:55], v[196:199]
 ds_read_b128 a[96:99], v7 offset:24576
 ds_read_b128 a[100:103], v7 offset:25600
M v[196:199], a[196:199], v[48:51], v[196:199]
 ds_read_b128 a[104:107], v7 offset:26624
M v[204:207], a[204:207], v[48:51], v[204:207]
 ds_read_b128 a[108:111], v7 offset:27648
 ds_read_b128 a[112:115], v7 offset:28672
M v[204:207], a[200:203], v[52:55], v[204:207]
 s_waitcnt lgkmcnt(5)
 ds_read_b128 a[116:119], v7 offset:29696
M v[212:215], a[208:211], v[52:55], v[212:215]
 ds_read_b128 a[120:123], v7 offset:30720
 ds_read_b128 a[124:127], v7 offset:31744
M v[212:215], a[212:215], v[48:51], v[212:215]
 buffer_load_dwordx4 v3, s[8:11], s21 offen offset:3072 sc1 lds
M v[220:223], a[220:223], v[48:51], v[220:223]
 s_add_u32 m0, s28, 36864
M v[220:223], a[216:219], v[52:55], v[220:223]
 s_waitcnt lgkmcnt(0)
M v[228:231], a[96:99], v[52:55], v[228:231]
 buffer_load_dwordx4 v4, s[8:11], s21 offen offset:0 sc1 lds
M v[228:231], a[100:103], v[48:51], v[228:231]
M v[236:239], a[108:111], v[48:51], v[236:239]
 buffer_load_dwordx4 v4, s[8:11], s21 offen offset:1024 sc1 lds
M v[236:239], a[104:107], v[52:55], v[236:239]
M v[244:247], a[112:115], v[52:55], v[244:247]
 buffer_load_dwordx4 v4, s[8:11], s21 offen offset:2048 sc1 lds
M v[244:247], a[116:119], v[48:51], v[244:247]
M v[252:255], a[124:127], v[48:51], v[252:255]
 buffer_load_dwordx4 v4, s[8:11], s21 offen offset:3072 sc1 lds
M v[252:255], a[120:123], v[52:55], v[252:255]
 s_waitcnt vmcnt(16)
M v[128:131], a[246:249], a[128:131], v[128:131]
 s_add_u32 m0, s28, 65536
M v[136:139], a[244:247], a[128:131], v[136:139]
 buffer_load_dwordx4 v3, s[8:11], s38 offen offset:0 sc1 lds
M v[144:147], a[246:249], a[132:135], v[144:147]
M v[152:155], a[244:247], a[132:135], v[152:155]
 s_barrier
M v[160:163], a[246:249], a[136:139], v[160:163]
 buffer_load_dwordx4 v3, s[8:11], s38 offen offset:1024 sc1 lds
M v[168:171], a[244:247], a[136:139], v[168:171]
 v_cvt_pk_bf16_f32 v128, v128, v129
 v_cvt_pk_bf16_f32 v129, v130, v131
M v[176:179], a[246:249], a[140:143], v[176:179]
 buffer_load_dwordx4 v3, s[8:11], s38 offen offset:2048 sc1 lds
M v[184:187], a[244:247], a[140:143], v[184:187]
 v_cvt_pk_bf16_f32 v130, v136, v137
 v_cvt_pk_bf16_f32 v131, v138, v139
M v[192:195], a[246:249], a[144:147], v[192:195]
 v_cvt_pk_bf16_f32 v144, v144, v145
 v_cvt_pk_bf16_f32 v145, v146, v147
M v[200:203], a[244:247], a[144:147], v[200:203]
 v_cvt_pk_bf16_f32 v146, v152, v153
 v_cvt_pk_bf16_f32 v147, v154, v155
M v[208:211], a[246:249], a[148:151], v[208:211]
 buffer_load_dwordx4 v3, s[8:11], s38 offen offset:3072 sc1 lds
M v[216:219], a[244:247], a[148:151], v[216:219]
 v_cvt_pk_bf16_f32 v160, v160, v161
 v_cvt_pk_bf16_f32 v161, v162, v163
M v[224:227], a[246:249], a[152:155], v[224:227]
 ds_read_b128 a[64:67], v2 offset:32768
 v_cvt_pk_bf16_f32 v162, v168, v169
M v[232:235], a[244:247], a[152:155], v[232:235]
 s_add_u32 m0, s28, 69632
 ds_read_b128 a[68:71], v2 offset:33792
 v_cvt_pk_bf16_f32 v163, v170, v171
M v[240:243], a[246:249], a[156:159], v[240:243]
 buffer_load_dwordx4 v4, s[8:11], s38 offen offset:0 sc1 lds
M v[248:251], a[244:247], a[156:159], v[248:251]
 s_waitcnt vmcnt(17)
 ds_read_b128 a[72:75], v2 offset:34816
 v_cvt_pk_bf16_f32 v176, v176, v177
M v[132:135], a[246:249], a[160:163], v[132:135]
 ds_read_b128 a[76:79], v2 offset:35840
 v_cvt_pk_bf16_f32 v177, v178, v179
M v[140:143], a[244:247], a[160:163], v[140:143]
 buffer_load_dwordx4 v4, s[8:11], s38 offen offset:1024 sc1 lds
M v[148:151], a[246:249], a[164:167], v[148:151]
 ds_read_b128 a[80:83], v2 offset:36864
 v_cvt_pk_bf16_f32 v178, v184, v185
M v[156:159], a[244:247], a[164:167], v[156:159]
 ds_read_b128 a[84:87], v2 offset:37888
 v_cvt_pk_bf16_f32 v179, v186, v187
M v[164:167], a[246:249], a[168:171], v[164:167]
 v_cvt_pk_bf16_f32 v192, v192, v193
 v_cvt_pk_bf16_f32 v193, v194, v195
M v[172:175], a[244:247], a[168:171], v[172:175]
 ds_read_b128 a[88:91], v2 offset:38912
 v_cvt_pk_bf16_f32 v194, v200, v201
M v[180:183], a[246:249], a[172:175], v[180:183]
 ds_read_b128 a[92:95], v2 offset:39936
 v_cvt_pk_bf16_f32 v195, v202, v203
M v[188:191], a[244:247], a[172:175], v[188:191]
 s_waitcnt vmcnt(14)
 v_cvt_pk_bf16_f32 v208, v208, v209
 v_cvt_pk_bf16_f32 v209, v210, v211
M v[196:199], a[246:249], a[176:179], v[196:199]
 buffer_load_dwordx4 v4, s[8:11], s38 offen offset:2048 sc1 lds
M v[204:207], a[244:247], a[176:179], v[204:207]
 v_cvt_pk_bf16_f32 v210, v216, v217
 v_cvt_pk_bf16_f32 v211, v218, v219
M v[212:215], a[246:249], a[180:183], v[212:215]
 buffer_load_dwordx4 v4, s[8:11], s38 offen offset:3072 sc1 lds
M v[220:223], a[244:247], a[180:183], v[220:223]
 s_add_u32 s38, s38, 32768
 v_cvt_pk_bf16_f32 v224, v224, v225
 v_cvt_pk_bf16_f32 v225, v226, v227
M v[228:231], a[246:249], a[184:187], v[228:231]
 v_cvt_pk_bf16_f32 v226, v232, v233
 v_cvt_pk_bf16_f32 v227, v234, v235
M v[236:239], a[244:247], a[184:187], v[236:239]
 v_cvt_pk_bf16_f32 v240, v240, v241
 v_cvt_pk_bf16_f32 v241, v242, v243
M v[244:247], a[246:249], a[188:191], v[244:247]
 s_waitcnt lgkmcnt(0)
 v_cvt_pk_bf16_f32 v242, v248, v249
 v_cvt_pk_bf16_f32 v243, v250, v251
M v[252:255], a[244:247], a[188:191], v[252:255]
L_op1:
M v[64:67], a[64:67], v[128:131], 0
 ds_read_b128 a[96:99], v2 offset:40960
 ds_read_b128 a[100:103], v2 offset:41984
M v[64:67], a[68:71], v[144:147], v[64:67]
 ds_read_b128 a[104:107], v2 offset:43008
 v_cvt_pk_bf16_f32 v132, v132, v133
M v[64:67], a[72:75], v[160:163], v[64:67]
 ds_read_b128 a[108:111], v2 offset:44032
 ds_read_b128 a[112:115], v2 offset:45056
M v[64:67], a[76:79], v[176:179], v[64:67]
 ds_read_b128 a[116:119], v2 offset:46080
 v_cvt_pk_bf16_f32 v133, v134, v135
M v[64:67], a[80:83], v[192:195], v[64:67]
 ds_read_b128 a[120:123], v2 offset:47104
 ds_read_b128 a[124:127], v2 offset:48128
M v[64:67], a[84:87], v[208:211], v[64:67]
 v_cvt_pk_bf16_f32 v134, v140, v141
 v_cvt_pk_bf16_f32 v135, v142, v143
M v[64:67], a[88:91], v[224:227], v[64:67]
 ds_read_b128 a[128:131], v2 offset:49152
 ds_read_b128 a[132:135], v2 offset:50176
M v[64:67], a[92:95], v[240:243], v[64:67]
 s_waitcnt lgkmcnt(2)
 ds_read_b128 a[136:139], v2 offset:51200
 v_cvt_pk_bf16_f32 v148, v148, v149
M v[72:75], a[96:99], v[128:131], 0
 ds_read_b128 a[140:143], v2 offset:52224
 ds_read_b128 a[144:147], v2 offset:53248
M v[72:75], a[100:103], v[144:147], v[72:75]
 v_cvt_pk_bf16_f32 v149, v150, v151
 v_cvt_pk_bf16_f32 v150, v156, v157
M v[72:75], a[104:107], v[160:163], v[72:75]
 ds_read_b128 a[148:151], v2 offset:54272
 ds_read_b128 a[152:155], v2 offset:55296
M v[72:75], a[108:111], v[176:179], v[72:75]
 ds_read_b128 a[156:159], v2 offset:56320
 v_cvt_pk_bf16_f32 v151, v158, v159
M v[72:75], a[112:115], v[192:195], v[72:75]
 ds_read_b128 a[160:163], v2 offset:57344
 ds_read_b128 a[164:167], v2 offset:58368
M v[72:75], a[116:119], v[208:211], v[72:75]
 v_cvt_pk_bf16_f32 v164, v164, v165
 v_cvt_pk_bf16_f32 v165, v166, v167
M v[72:75], a[120:123], v[224:227], v[72:75]
 ds_read_b128 a[168:171], v2 offset:59392
 ds_read_b128 a[172:175], v2 offset:60416
M v[72:75], a[124:127], v[240:243], v[72:75]
 s_waitcnt lgkmcnt(4)
 ds_read_b128 a[176:179], v2 offset:61440
 v_cvt_pk_bf16_f32 v166, v172, v173
M v[80:83], a[128:131], v[128:131], 0
 ds_read_b128 a[180:183], v2 offset:62464
 ds_read_b128 a[184:187], v2 offset:63488
M v[80:83], a[132:135], v[144:147], v[80:83]
 ds_read_b128 a[188:191], v2 offset:64512
 v_cvt_pk_bf16_f32 v167, v174, v175
M v[80:83], a[136:139], v[160:163], v[80:83]
 v_cvt_pk_bf16_f32 v180, v180, v181
 v_cvt_pk_bf16_f32 v181, v182, v183
M v[80:83], a[140:143], v[176:179], v[80:83]
 v_cvt_pk_bf16_f32 v182, v188, v189
 v_cvt_pk_bf16_f32 v183, v190, v191
M v[80:83], a[144:147], v[192:195], v[80:83]
 v_cvt_pk_bf16_f32 v196, v196, v197
 v_cvt_pk_bf16_f32 v197, v198, v199
M v[80:83], a[148:151], v[208:211], v[80:83]
 v_cvt_pk_bf16_f32 v198, v204, v205
 v_cvt_pk_bf16_f32 v199, v206, v207
M v[80:83], a[152:155], v[224:227], v[80:83]
 v_cvt_pk_bf16_f32 v212, v212, v213
 v_cvt_pk_bf16_f32 v213, v214, v215
M v[80:83], a[156:159], v[240:243], v[80:83]
 s_waitcnt lgkmcnt(0)
 v_cvt_pk_bf16_f32 v214, v220, v221
 v_cvt_pk_bf16_f32 v215, v222, v223
M v[88:91], a[160:163], v[128:131], 0
 v_cvt_pk_bf16_f32 v228, v228, v229
 v_cvt_pk_bf16_f32 v229, v230, v231
M v[88:91], a[164:167], v[144:147], v[88:91]
 v_cvt_pk_bf16_f32 v230, v236, v237
 v_cvt_pk_bf16_f32 v231, v238, v239
M v[88:91], a[168:171], v[160:163], v[88:91]
 s_add_u32 m0, s28, 0
 v_cvt_pk_bf16_f32 v244, v244, v245
 v_cvt_pk_bf16_f32 v245, v246, v247
M v[88:91], a[172:175], v[176:179], v[88:91]
 v_cvt_pk_bf16_f32 v246, v252, v253
 v_cvt_pk_bf16_f32 v247, v254, v255
M v[88:91], a[176:179], v[192:195], v[88:91]
 buffer_load_dwordx4 v3, s[8:11], s38 offen offset:0 sc1 lds
M v[88:91], a[180:183], v[208:211], v[88:91]
 v_add_f32 v31, v29, v31
 v_mov_b32 v10, v30
M v[88:91], a[184:187], v[224:227], v[88:91]
 v_mov_b32 v11, v31
 v_permlane16_swap_b32 v10, v30
M v[88:91], a[188:191], v[240:243], v[88:91]
 buffer_load_dwordx4 v3, s[8:11], s38 offen offset:1024 sc1 lds
M v[68:71], a[64:67], v[132:135], 0
 v_permlane16_swap_b32 v11, v31
 v_add_f32 v30, v10, v30
M v[68:71], a[68:71], v[148:151], v[68:71]
 v_add_f32 v31, v11, v31
 v_mov_b32 v10, v30
M v[68:71], a[72:75], v[164:167], v[68:71]
 v_mov_b32 v11, v31
 v_permlane32_swap_b32 v10, v30
M v[68:71], a[76:79], v[180:183], v[68:71]
 buffer_load_dwordx4 v3, s[8:11], s38 offen offset:2048 sc1 lds
M v[68:71], a[80:83], v[196:199], v[68:71]
 v_permlane32_swap_b32 v11, v31
 v_add_f32 v30, v10, v30
M v[68:71], a[84:87], v[212:215], v[68:71]
 v_add_f32 v31, v11, v31
M v[68:71], a[88:91], v[228:231], v[68:71]
 v_rcp_f32 v5, v30
M v[68:71], a[92:95], v[244:247], v[68:71]
 buffer_load_dwordx4 v3, s[8:11], s38 offen offset:3072 sc1 lds
M v[76:79], a[96:99], v[132:135], 0
 v_rcp_f32 v6, v31
M v[76:79], a[100:103], v[148:151], v[76:79]
M v[76:79], a[104:107], v[164:167], v[76:79]
 s_add_u32 m0, s28, 4096
M v[76:79], a[108:111], v[180:183], v[76:79]
 buffer_load_dwordx4 v4, s[8:11], s38 offen offset:0 sc1 lds
M v[76:79], a[112:115], v[196:199], v[76:79]
M v[76:79], a[116:119], v[212:215], v[76:79]
M v[76:79], a[120:123], v[228:231], v[76:79]
 s_waitcnt vmcnt(13)
M v[76:79], a[124:127], v[244:247], v[76:79]
 s_barrier
M v[84:87], a[128:131], v[132:135], 0
 ds_read_b128 a[64:67], v7 offset:32768
M v[84:87], a[132:135], v[148:151], v[84:87]
 ds_read_b128 a[68:71], v7 offset:33792
M v[84:87], a[136:139], v[164:167], v[84:87]
 buffer_load_dwordx4 v4, s[8:11], s38 offen offset:1024 sc1 lds
M v[84:87], a[140:143], v[180:183], v[84:87]
 ds_read_b128 a[72:75], v7 offset:34816
M v[84:87], a[144:147], v[196:199], v[84:87]
 ds_read_b128 a[76:79], v7 offset:35840
M v[84:87], a[148:151], v[212:215], v[84:87]
 buffer_load_dwordx4 v4, s[8:11], s38 offen offset:2048 sc1 lds
M v[84:87], a[152:155], v[228:231], v[84:87]
 ds_read_b128 a[80:83], v7 offset:36864
M v[84:87], a[156:159], v[244:247], v[84:87]
 ds_read_b128 a[84:87], v7 offset:37888
M v[92:95], a[160:163], v[132:135], 0
 buffer_load_dwordx4 v4, s[8:11], s38 offen offset:3072 sc1 lds
M v[92:95], a[164:167], v[148:151], v[92:95]
 s_add_u32 s38, s38, 32768
 ds_read_b128 a[88:91], v7 offset:38912
M v[92:95], a[168:171], v[164:167], v[92:95]
 ds_read_b128 a[92:95], v7 offset:39936
M v[92:95], a[172:175], v[180:183], v[92:95]
M v[92:95], a[176:179], v[196:199], v[92:95]
M v[92:95], a[180:183], v[212:215], v[92:95]
M v[92:95], a[184:187], v[228:231], v[92:95]
 s_waitcnt lgkmcnt(0)
 s_cmp_eq_u32 s42, 6
M v[92:95], a[188:191], v[244:247], v[92:95]
 s_cbranch_scc1 L_y1
L_y1r:
M v[96:99], a[64:67], v[128:131], 0
 s_add_u32 m0, s28, 98304
 ds_read_b128 a[96:99], v7 offset:40960
M v[96:99], a[68:71], v[144:147], v[96:99]
 ds_read_b128 a[100:103], v7 offset:41984
M v[96:99], a[72:75], v[160:163], v[96:99]
 buffer_load_dwordx4 v3, s[8:11], s38 offen offset:0 sc1 lds
M v[96:99], a[76:79], v[176:179], v[96:99]
 ds_read_b128 a[104:107], v7 offset:43008
 s_add_u32 s29, s33, 0
M v[96:99], a[80:83], v[192:195], v[96:99]
 ds_read_b128 a[108:111], v7 offset:44032
 s_add_u32 s30, s33, 14336
M v[96:99], a[84:87], v[208:211], v[96:99]
 v_max3_f32 v32, |v64|, |v65|, |v66|
 v_max3_f32 v32, |v67|, |v72|, v32
M v[96:99], a[88:91], v[224:227], v[96:99]
 ds_read_b128 a[112:115], v7 offset:45056
 v_max3_f32 v32, |v73|, |v74|, v32
M v[96:99], a[92:95], v[240:243], v[96:99]
 ds_read_b128 a[116:119], v7 offset:46080
 v_mul_f32 v32, 2.0, v32
M v[100:103], a[92:95], v[244:247], 0
 buffer_load_dwordx4 v3, s[8:11], s38 offen offset:1024 sc1 lds
M v[100:103], a[88:91], v[228:231], v[100:103]
 ds_read_b128 a[120:123], v7 offset:47104
 v_mov_b32 v33, v32
M v[100:103], a[84:87], v[212:215], v[100:103]
 ds_read_b128 a[124:127], v7 offset:48128
 v_mov_b32 v34, v32
M v[100:103], a[80:83], v[196:199], v[100:103]
 v_mov_b32 v35, v32
 v_mul_f32 v28, -v32, v5
M v[100:103], a[76:79], v[180:183], v[100:103]
 buffer_load_dwordx4 v3, s[8:11], s38 offen offset:2048 sc1 lds
M v[100:103], a[72:75], v[164:167], v[100:103]
 v_mul_f32 v64, v5, v64
 v_mul_f32 v65, v5, v65
M v[100:103], a[68:71], v[148:151], v[100:103]
 v_mul_f32 v66, v5, v66
 v_mul_f32 v67, v5, v67
M v[100:103], a[64:67], v[132:135], v[100:103]
 s_waitcnt lgkmcnt(0)
 v_mul_f32 v72, v5, v72
 v_mul_f32 v73, v5, v73
M v[104:107], a[96:99], v[128:131], 0
 ds_read_b128 a[64:67], v7 offset:49152
 v_mul_f32 v74, v5, v74
M v[104:107], a[100:103], v[144:147], v[104:107]
 ds_read_b128 a[68:71], v7 offset:50176
 v_mul_f32 v75, v5, v75
M v[104:107], a[104:107], v[160:163], v[104:107]
 buffer_load_dwordx4 v3, s[8:11], s38 offen offset:3072 sc1 lds
M v[104:107], a[108:111], v[176:179], v[104:107]
 ds_read_b128 a[72:75], v7 offset:51200
 v_cvt_pk_bf16_f32 v64, v64, v65
M v[104:107], a[112:115], v[192:195], v[104:107]
 ds_read_b128 a[76:79], v7 offset:52224
 v_cvt_pk_bf16_f32 v65, v66, v67
M v[104:107], a[116:119], v[208:211], v[104:107]
 v_cvt_pk_bf16_f32 v66, v72, v73
 v_cvt_pk_bf16_f32 v67, v74, v75
M v[104:107], a[120:123], v[224:227], v[104:107]
 s_add_u32 m0, s28, 102400
 ds_read_b128 a[80:83], v7 offset:53248
M v[104:107], a[124:127], v[240:243], v[104:107]
 ds_read_b128 a[84:87], v7 offset:54272
M v[108:111], a[124:127], v[244:247], 0
 buffer_load_dwordx4 v4, s[8:11], s38 offen offset:0 sc1 lds
M v[108:111], a[120:123], v[228:231], v[108:111]
 ds_read_b128 a[88:91], v7 offset:55296
M v[108:111], a[116:119], v[212:215], v[108:111]
 ds_read_b128 a[92:95], v7 offset:56320
M v[108:111], a[112:115], v[196:199], v[108:111]
 buffer_store_dwordx4 v[64:67], v7, s[8:11], s29 offen offset:0 sc1
M v[108:111], a[108:111], v[180:183], v[108:111]
 buffer_load_dwordx4 v4, s[8:11], s38 offen offset:1024 sc1 lds
M v[108:111], a[104:107], v[164:167], v[108:111]
 v_max3_f32 v36, |v68|, |v69|, |v70|
 v_max3_f32 v36, |v71|, |v76|, v36
M v[108:111], a[100:103], v[148:151], v[108:111]
 v_max3_f32 v36, |v77|, |v78|, v36
 v_mul_f32 v36, 2.0, v36
M v[108:111], a[96:99], v[132:135], v[108:111]
 s_waitcnt lgkmcnt(0)
 v_mov_b32 v37, v36
 v_mov_b32 v38, v36
M v[112:115], a[64:67], v[128:131], 0
 ds_read_b128 a[96:99], v7 offset:57344
 v_mov_b32 v39, v36
M v[112:115], a[68:71], v[144:147], v[112:115]
 ds_read_b128 a[100:103], v7 offset:58368
 v_mul_f32 v29, -v36, v6
M v[112:115], a[72:75], v[160:163], v[112:115]
 buffer_load_dwordx4 v4, s[8:11], s38 offen offset:2048 sc1 lds
M v[112:115], a[76:79], v[176:179], v[112:115]
 ds_read_b128 a[104:107], v7 offset:59392
 v_mul_f32 v68, v6, v68
M v[112:115], a[80:83], v[192:195], v[112:115]
 ds_read_b128 a[108:111], v7 offset:60416
 v_mul_f32 v69, v6, v69
M v[112:115], a[84:87], v[208:211], v[112:115]
 v_mul_f32 v70, v6, v70
 v_mul_f32 v71, v6, v71
M v[112:115], a[88:91], v[224:227], v[112:115]
 ds_read_b128 a[112:115], v7 offset:61440
 v_mul_f32 v76, v6, v76
M v[112:115], a[92:95], v[240:243], v[112:115]
 ds_read_b128 a[116:119], v7 offset:62464
 v_mul_f32 v77, v6, v77
M v[116:119], a[92:95], v[244:247], 0
 buffer_load_dwordx4 v4, s[8:11], s38 offen offset:3072 sc1 lds
M v[116:119], a[88:91], v[228:231], v[116:119]
 s_add_u32 s38, s38, 32768
 ds_read_b128 a[120:123], v7 offset:63488
 v_mul_f32 v78, v6, v78
M v[116:119], a[84:87], v[212:215], v[116:119]
 ds_read_b128 a[124:127], v7 offset:64512
 v_mul_f32 v79, v6, v79
M v[116:119], a[80:83], v[196:199], v[116:119]
 v_cvt_pk_bf16_f32 v68, v68, v69
 v_cvt_pk_bf16_f32 v69, v70, v71
M v[116:119], a[76:79], v[180:183], v[116:119]
 v_cvt_pk_bf16_f32 v70, v76, v77
 v_cvt_pk_bf16_f32 v71, v78, v79
M v[116:119], a[72:75], v[164:167], v[116:119]
 buffer_store_dwordx4 v[68:71], v7, s[8:11], s30 offen offset:0 sc1
M v[116:119], a[68:71], v[148:151], v[116:119]
 s_waitcnt vmcnt(18) lgkmcnt(0)
 v_mul_f32 v80, v5, v80
 v_mul_f32 v81, v5, v81
M v[116:119], a[64:67], v[132:135], v[116:119]
 s_barrier
M v[120:123], a[96:99], v[128:131], 0
 ds_read_b128 a[64:67], v2 offset:0
 v_mul_f32 v82, v5, v82
M v[120:123], a[100:103], v[144:147], v[120:123]
 ds_read_b128 a[68:71], v2 offset:1024
 v_mul_f32 v83, v5, v83
M v[120:123], a[104:107], v[160:163], v[120:123]
 v_mul_f32 v88, v5, v88
 v_mul_f32 v89, v5, v89
M v[120:123], a[108:111], v[176:179], v[120:123]
 ds_read_b128 a[72:75], v2 offset:2048
 v_mul_f32 v90, v5, v90
M v[120:123], a[112:115], v[192:195], v[120:123]
 ds_read_b128 a[76:79], v2 offset:3072
 v_mul_f32 v91, v5, v91
M v[120:123], a[116:119], v[208:211], v[120:123]
 v_cvt_pk_bf16_f32 v80, v80, v81
 v_cvt_pk_bf16_f32 v81, v82, v83
M v[120:123], a[120:123], v[224:227], v[120:123]
 ds_read_b128 a[80:83], v2 offset:4096
 v_cvt_pk_bf16_f32 v82, v88, v89
M v[120:123], a[124:127], v[240:243], v[120:123]
 ds_read_b128 a[84:87], v2 offset:5120
 v_cvt_pk_bf16_f32 v83, v90, v91
M v[124:127], a[124:127], v[244:247], 0
 buffer_store_dwordx4 v[80:83], v7, s[8:11], s29 offen offset:1024 sc1
M v[124:127], a[120:123], v[228:231], v[124:127]
 ds_read_b128 a[88:91], v2 offset:6144
 v_mul_f32 v84, v6, v84
M v[124:127], a[116:119], v[212:215], v[124:127]
 ds_read_b128 a[92:95], v2 offset:7168
 v_mul_f32 v85, v6, v85
M v[124:127], a[112:115], v[196:199], v[124:127]
 v_mul_f32 v86, v6, v86
 v_mul_f32 v87, v6, v87
M v[124:127], a[108:111], v[180:183], v[124:127]
 v_mul_f32 v92, v6, v92
 v_mul_f32 v93, v6, v93
M v[124:127], a[104:107], v[164:167], v[124:127]
 v_mul_f32 v94, v6, v94
 v_mul_f32 v95, v6, v95
M v[124:127], a[100:103], v[148:151], v[124:127]
 s_waitcnt lgkmcnt(0)
 v_cvt_pk_bf16_f32 v84, v84, v85
 v_cvt_pk_bf16_f32 v85, v86, v87
M v[124:127], a[96:99], v[132:135], v[124:127]
 v_cvt_pk_bf16_f32 v86, v92, v93
 v_cvt_pk_bf16_f32 v87, v94, v95
 buffer_store_dwordx4 v[84:87], v7, s[8:11], s30 offen offset:1024 sc1
M v[64:67], a[64:67], v[128:131], v[32:35]
 s_add_u32 m0, s28, 32768
 ds_read_b128 a[96:99], v2 offset:8192
M v[64:67], a[68:71], v[144:147], v[64:67]
 ds_read_b128 a[100:103], v2 offset:9216
 s_mov_b32 s79, 104923136
M v[64:67], a[72:75], v[160:163], v[64:67]
 buffer_load_dwordx4 v3, s[8:11], s38 offen offset:0 sc1 lds
M v[64:67], a[76:79], v[176:179], v[64:67]
 ds_read_b128 a[104:107], v2 offset:10240
 s_add_u32 s29, s33, 2048
M v[64:67], a[80:83], v[192:195], v[64:67]
 ds_read_b128 a[108:111], v2 offset:11264
 s_add_u32 s30, s33, 16384
M v[64:67], a[84:87], v[208:211], v[64:67]
 buffer_load_dword v24, off, s[8:11], s79 sc1
M v[64:67], a[88:91], v[224:227], v[64:67]
 ds_read_b128 a[112:115], v2 offset:12288
 v_lshrrev_b32 v0, 4, v7
M v[64:67], a[92:95], v[240:243], v[64:67]
 ds_read_b128 a[116:119], v2 offset:13312
 v_and_b32 v14, 15, v0
M v[68:71], a[92:95], v[244:247], v[36:39]
 buffer_load_dwordx4 v3, s[8:11], s38 offen offset:1024 sc1 lds
M v[68:71], a[88:91], v[228:231], v[68:71]
 ds_read_b128 a[120:123], v2 offset:14336
 v_lshlrev_b32 v14, 2, v14
M v[68:71], a[84:87], v[212:215], v[68:71]
 ds_read_b128 a[124:127], v2 offset:15360
 v_lshrrev_b32 v11, 4, v0
M v[68:71], a[80:83], v[196:199], v[68:71]
 s_mov_b32 s52, s96
 s_and_b32 s53, s97, 0xffff
 s_mov_b32 s54, 1835008
M v[68:71], a[76:79], v[180:183], v[68:71]
 buffer_load_dwordx4 v3, s[8:11], s38 offen offset:2048 sc1 lds
M v[68:71], a[72:75], v[164:167], v[68:71]
 s_mov_b32 s55, 0x20000
 v_mul_f32 v96, v5, v96
M v[68:71], a[68:71], v[148:151], v[68:71]
 s_lshr_b32 s74, s41, 3
 s_xor_b32 s74, s74, 0
 s_mul_i32 s67, s74, -2
M v[68:71], a[64:67], v[132:135], v[68:71]
 s_waitcnt lgkmcnt(0)
 s_mul_i32 s74, s74, 8
 v_mul_f32 v97, v5, v97
M v[72:75], a[96:99], v[128:131], v[32:35]
 s_add_u32 s74, s74, s20
 ds_read_b128 a[64:67], v2 offset:16384
 v_mul_f32 v98, v5, v98
M v[72:75], a[100:103], v[144:147], v[72:75]
 s_lshl_b32 s75, s74, 6
 ds_read_b128 a[68:71], v2 offset:17408
 s_add_u32 s76, s75, 256
M v[72:75], a[104:107], v[160:163], v[72:75]
 buffer_load_dwordx4 v3, s[8:11], s38 offen offset:3072 sc1 lds
M v[72:75], a[108:111], v[176:179], v[72:75]
 ds_read_b128 a[72:75], v2 offset:18432
 s_add_u32 s67, s67, 3
M v[72:75], a[112:115], v[192:195], v[72:75]
 s_sub_u32 s67, s67, s20
 ds_read_b128 a[76:79], v2 offset:19456
 v_mul_f32 v99, v5, v99
M v[72:75], a[116:119], v[208:211], v[72:75]
 s_and_b32 s67, s67, 536870912
 s_or_b32 s76, s76, s67
 v_or_b32 v27, s67, v7
M v[72:75], a[120:123], v[224:227], v[72:75]
 s_add_u32 m0, s28, 36864
 ds_read_b128 a[80:83], v2 offset:20480
 v_add_u32 v27, 4096, v27
M v[72:75], a[124:127], v[240:243], v[72:75]
 ds_read_b128 a[84:87], v2 offset:21504
 v_mul_f32 v104, v5, v104
M v[76:79], a[124:127], v[244:247], v[36:39]
 buffer_load_dwordx4 v4, s[8:11], s38 offen offset:0 sc1 lds
M v[76:79], a[120:123], v[228:231], v[76:79]
 ds_read_b128 a[88:91], v2 offset:22528
 v_mul_f32 v105, v5, v105
M v[76:79], a[116:119], v[212:215], v[76:79]
 ds_read_b128 a[92:95], v2 offset:23552
 v_mul_f32 v106, v5, v106
M v[76:79], a[112:115], v[196:199], v[76:79]
 v_mul_f32 v107, v5, v107
 v_cvt_pk_bf16_f32 v96, v96, v97
M v[76:79], a[108:111], v[180:183], v[76:79]
 buffer_load_dwordx4 v4, s[8:11], s38 offen offset:1024 sc1 lds
M v[76:79], a[104:107], v[164:167], v[76:79]
 v_cvt_pk_bf16_f32 v97, v98, v99
 v_cvt_pk_bf16_f32 v98, v104, v105
M v[76:79], a[100:103], v[148:151], v[76:79]
 v_cvt_pk_bf16_f32 v99, v106, v107
M v[76:79], a[96:99], v[132:135], v[76:79]
 s_waitcnt lgkmcnt(0)
M v[80:83], a[64:67], v[128:131], v[32:35]
 ds_read_b128 a[96:99], v2 offset:24576
M v[80:83], a[68:71], v[144:147], v[80:83]
 ds_read_b128 a[100:103], v2 offset:25600
M v[80:83], a[72:75], v[160:163], v[80:83]
 buffer_load_dwordx4 v4, s[8:11], s38 offen offset:2048 sc1 lds
M v[80:83], a[76:79], v[176:179], v[80:83]
 ds_read_b128 a[104:107], v2 offset:26624
M v[80:83], a[80:83], v[192:195], v[80:83]
 ds_read_b128 a[108:111], v2 offset:27648
M v[80:83], a[84:87], v[208:211], v[80:83]
 buffer_store_dwordx4 v[96:99], v7, s[8:11], s29 offen offset:0 sc1
M v[80:83], a[88:91], v[224:227], v[80:83]
 ds_read_b128 a[112:115], v2 offset:28672
 v_mul_f32 v100, v6, v100
M v[80:83], a[92:95], v[240:243], v[80:83]
 ds_read_b128 a[116:119], v2 offset:29696
 v_mul_f32 v101, v6, v101
M v[84:87], a[92:95], v[244:247], v[36:39]
 buffer_load_dwordx4 v4, s[8:11], s38 offen offset:3072 sc1 lds
M v[84:87], a[88:91], v[228:231], v[84:87]
 s_add_u32 s38, s38, 32768
 ds_read_b128 a[120:123], v2 offset:30720
 v_mul_f32 v102, v6, v102
M v[84:87], a[84:87], v[212:215], v[84:87]
 ds_read_b128 a[124:127], v2 offset:31744
 v_mul_f32 v103, v6, v103
M v[84:87], a[80:83], v[196:199], v[84:87]
 v_mul_f32 v108, v6, v108
 v_mul_f32 v109, v6, v109
M v[84:87], a[76:79], v[180:183], v[84:87]
 v_mul_f32 v110, v6, v110
 v_mul_f32 v111, v6, v111
M v[84:87], a[72:75], v[164:167], v[84:87]
 v_cvt_pk_bf16_f32 v100, v100, v101
 v_cvt_pk_bf16_f32 v101, v102, v103
M v[84:87], a[68:71], v[148:151], v[84:87]
 s_waitcnt vmcnt(22) lgkmcnt(0)
 v_cvt_pk_bf16_f32 v102, v108, v109
 v_cvt_pk_bf16_f32 v103, v110, v111
M v[84:87], a[64:67], v[132:135], v[84:87]
 s_barrier
M v[88:91], a[96:99], v[128:131], v[32:35]
 ds_read_b128 a[64:67], v7 offset:0
M v[88:91], a[100:103], v[144:147], v[88:91]
 ds_read_b128 a[68:71], v7 offset:1024
M v[88:91], a[104:107], v[160:163], v[88:91]
 buffer_store_dwordx4 v[100:103], v7, s[8:11], s30 offen offset:0 sc1
M v[88:91], a[108:111], v[176:179], v[88:91]
 ds_read_b128 a[72:75], v7 offset:2048
 v_mul_f32 v112, v5, v112
M v[88:91], a[112:115], v[192:195], v[88:91]
 ds_read_b128 a[76:79], v7 offset:3072
 v_mul_f32 v113, v5, v113
M v[88:91], a[116:119], v[208:211], v[88:91]
 v_mul_f32 v114, v5, v114
 v_mul_f32 v115, v5, v115
M v[88:91], a[120:123], v[224:227], v[88:91]
 ds_read_b128 a[80:83], v7 offset:4096
 v_mul_f32 v120, v5, v120
M v[88:91], a[124:127], v[240:243], v[88:91]
 ds_read_b128 a[84:87], v7 offset:5120
 v_mul_f32 v121, v5, v121
M v[92:95], a[124:127], v[244:247], v[36:39]
 v_mul_f32 v122, v5, v122
 v_mul_f32 v123, v5, v123
M v[92:95], a[120:123], v[228:231], v[92:95]
 ds_read_b128 a[88:91], v7 offset:6144
 v_cvt_pk_bf16_f32 v112, v112, v113
M v[92:95], a[116:119], v[212:215], v[92:95]
 ds_read_b128 a[92:95], v7 offset:7168
 v_cvt_pk_bf16_f32 v113, v114, v115
M v[92:95], a[112:115], v[196:199], v[92:95]
 v_cvt_pk_bf16_f32 v114, v120, v121
 v_cvt_pk_bf16_f32 v115, v122, v123
M v[92:95], a[108:111], v[180:183], v[92:95]
 buffer_store_dwordx4 v[112:115], v7, s[8:11], s29 offen offset:1024 sc1
M v[92:95], a[104:107], v[164:167], v[92:95]
 v_mul_f32 v116, v6, v116
 v_mul_f32 v117, v6, v117
M v[92:95], a[100:103], v[148:151], v[92:95]
 s_waitcnt lgkmcnt(0)
 v_mul_f32 v118, v6, v118
 v_mul_f32 v119, v6, v119
M v[92:95], a[96:99], v[132:135], v[92:95]
 v_mul_f32 v124, v6, v124
 v_mul_f32 v125, v6, v125
 v_mul_f32 v126, v6, v126
 v_mul_f32 v127, v6, v127
 v_cvt_pk_bf16_f32 v116, v116, v117
 v_cvt_pk_bf16_f32 v117, v118, v119
 v_cvt_pk_bf16_f32 v118, v124, v125
 v_cvt_pk_bf16_f32 v119, v126, v127
 buffer_store_dwordx4 v[116:119], v7, s[8:11], s30 offen offset:1024 sc1
M v[96:99], a[64:67], v[128:131], v[32:35]
 s_add_u32 m0, s28, 65536
 ds_read_b128 a[96:99], v7 offset:8192
M v[96:99], a[68:71], v[144:147], v[96:99]
 ds_read_b128 a[100:103], v7 offset:9216
 s_sub_u32 s64, 15, s42
M v[96:99], a[72:75], v[160:163], v[96:99]
 buffer_load_dwordx4 v3, s[8:11], s38 offen offset:0 sc1 lds
M v[96:99], a[76:79], v[176:179], v[96:99]
 ds_read_b128 a[104:107], v7 offset:10240
 s_min_u32 s64, s64, s42
M v[96:99], a[80:83], v[192:195], v[96:99]
 s_mul_i32 s45, s64, 8704
 ds_read_b128 a[108:111], v7 offset:11264
 s_add_u32 s29, s33, 4096
M v[96:99], a[84:87], v[208:211], v[96:99]
 s_lshl_b32 s64, s20, 6
 s_add_u32 s30, s33, 18432
 v_fma_f32 v64, v64, v5, v28
M v[96:99], a[88:91], v[224:227], v[96:99]
 s_add_u32 s64, s64, s41
 ds_read_b128 a[112:115], v7 offset:12288
 v_fma_f32 v65, v65, v5, v28
M v[96:99], a[92:95], v[240:243], v[96:99]
 s_lshl2_add_u32 s45, s64, s45
 ds_read_b128 a[116:119], v7 offset:13312
 s_add_u32 s45, s45, 104992768
M v[100:103], a[92:95], v[244:247], v[36:39]
 buffer_load_dwordx4 v3, s[8:11], s38 offen offset:1024 sc1 lds
M v[100:103], a[88:91], v[228:231], v[100:103]
 ds_read_b128 a[120:123], v7 offset:14336
 s_movk_i32 s65, 1024
M v[100:103], a[84:87], v[212:215], v[100:103]
 s_cmp_lt_u32 s42, 8
 ds_read_b128 a[124:127], v7 offset:15360
 v_fma_f32 v66, v66, v5, v28
M v[100:103], a[80:83], v[196:199], v[100:103]
 s_cselect_b32 s64, 4352, s65
 v_fma_f32 v67, v67, v5, v28
 v_fma_f32 v72, v72, v5, v28
M v[100:103], a[76:79], v[180:183], v[100:103]
 buffer_load_dwordx4 v3, s[8:11], s38 offen offset:2048 sc1 lds
M v[100:103], a[72:75], v[164:167], v[100:103]
 s_cselect_b32 s65, 0, 64
 v_fma_f32 v73, v73, v5, v28
 v_fma_f32 v74, v74, v5, v28
M v[100:103], a[68:71], v[148:151], v[100:103]
 s_cselect_b32 s66, 32, 64
 s_add_u32 s3, s45, s64
 s_add_u32 s45, s45, s65
M v[100:103], a[64:67], v[132:135], v[100:103]
 s_waitcnt lgkmcnt(0)
 v_lshrrev_b32 v17, 5, v7
 v_mul_u32_u24 v17, 4352, v17
M v[104:107], a[96:99], v[128:131], v[32:35]
 ds_read_b128 a[64:67], v7 offset:16384
 v_and_b32 v16, 16, v7
M v[104:107], a[100:103], v[144:147], v[104:107]
 ds_read_b128 a[68:71], v7 offset:17408
 v_lshl_add_u32 v16, v16, 3, v17
M v[104:107], a[104:107], v[160:163], v[104:107]
 buffer_load_dwordx4 v3, s[8:11], s38 offen offset:3072 sc1 lds
M v[104:107], a[108:111], v[176:179], v[104:107]
 ds_read_b128 a[72:75], v7 offset:18432
 v_mov_b32 v17, 536870912
M v[104:107], a[112:115], v[192:195], v[104:107]
 ds_read_b128 a[76:79], v7 offset:19456
 v_cmp_gt_u32 vcc, s66, v7
M v[104:107], a[116:119], v[208:211], v[104:107]
 v_mov_b32 v15, 1
 s_nop 0
M v[104:107], a[120:123], v[224:227], v[104:107]
 s_add_u32 m0, s28, 69632
 ds_read_b128 a[80:83], v7 offset:20480
 v_cndmask_b32 v16, v17, v16, vcc
M v[104:107], a[124:127], v[240:243], v[104:107]
 ds_read_b128 a[84:87], v7 offset:21504
 v_fma_f32 v75, v75, v5, v28
M v[108:111], a[124:127], v[244:247], v[36:39]
 buffer_load_dwordx4 v4, s[8:11], s38 offen offset:0 sc1 lds
M v[108:111], a[120:123], v[228:231], v[108:111]
 ds_read_b128 a[88:91], v7 offset:22528
 v_cvt_pk_bf16_f32 v64, v64, v65
M v[108:111], a[116:119], v[212:215], v[108:111]
 ds_read_b128 a[92:95], v7 offset:23552
 v_cvt_pk_bf16_f32 v65, v66, v67
M v[108:111], a[112:115], v[196:199], v[108:111]
 v_cvt_pk_bf16_f32 v66, v72, v73
 v_cvt_pk_bf16_f32 v67, v74, v75
M v[108:111], a[108:111], v[180:183], v[108:111]
 buffer_load_dwordx4 v4, s[8:11], s38 offen offset:1024 sc1 lds
M v[108:111], a[104:107], v[164:167], v[108:111]
M v[108:111], a[100:103], v[148:151], v[108:111]
 buffer_store_dwordx4 v[64:67], v7, s[8:11], s29 offen offset:0 sc1
M v[108:111], a[96:99], v[132:135], v[108:111]
 s_waitcnt lgkmcnt(0)
 v_fma_f32 v68, v68, v6, v29
 v_fma_f32 v69, v69, v6, v29
M v[112:115], a[64:67], v[128:131], v[32:35]
 ds_read_b128 a[96:99], v7 offset:24576
 v_fma_f32 v70, v70, v6, v29
M v[112:115], a[68:71], v[144:147], v[112:115]
 ds_read_b128 a[100:103], v7 offset:25600
 v_fma_f32 v71, v71, v6, v29
M v[112:115], a[72:75], v[160:163], v[112:115]
 buffer_load_dwordx4 v4, s[8:11], s38 offen offset:2048 sc1 lds
M v[112:115], a[76:79], v[176:179], v[112:115]
 ds_read_b128 a[104:107], v7 offset:26624
 v_fma_f32 v76, v76, v6, v29
M v[112:115], a[80:83], v[192:195], v[112:115]
 ds_read_b128 a[108:111], v7 offset:27648
 v_fma_f32 v77, v77, v6, v29
M v[112:115], a[84:87], v[208:211], v[112:115]
 v_fma_f32 v78, v78, v6, v29
 v_fma_f32 v79, v79, v6, v29
M v[112:115], a[88:91], v[224:227], v[112:115]
 ds_read_b128 a[112:115], v7 offset:28672
 v_cvt_pk_bf16_f32 v68, v68, v69
M v[112:115], a[92:95], v[240:243], v[112:115]
 ds_read_b128 a[116:119], v7 offset:29696
 v_cvt_pk_bf16_f32 v69, v70, v71
M v[116:119], a[92:95], v[244:247], v[36:39]
 buffer_load_dwordx4 v4, s[8:11], s38 offen offset:3072 sc1 lds
M v[116:119], a[88:91], v[228:231], v[116:119]
 s_add_u32 s38, s38, 32768
 ds_read_b128 a[120:123], v7 offset:30720
 v_cvt_pk_bf16_f32 v70, v76, v77
M v[116:119], a[84:87], v[212:215], v[116:119]
 ds_read_b128 a[124:127], v7 offset:31744
 v_cvt_pk_bf16_f32 v71, v78, v79
M v[116:119], a[80:83], v[196:199], v[116:119]
M v[116:119], a[76:79], v[180:183], v[116:119]
 buffer_store_dwordx4 v[68:71], v7, s[8:11], s30 offen offset:0 sc1
M v[116:119], a[72:75], v[164:167], v[116:119]
 v_fma_f32 v80, v80, v5, v28
 v_fma_f32 v81, v81, v5, v28
M v[116:119], a[68:71], v[148:151], v[116:119]
 s_waitcnt vmcnt(26) lgkmcnt(0)
 v_fma_f32 v82, v82, v5, v28
 v_fma_f32 v83, v83, v5, v28
M v[116:119], a[64:67], v[132:135], v[116:119]
 s_barrier
M v[120:123], a[96:99], v[128:131], v[32:35]
 ds_read_b128 a[64:67], v2 offset:32768
 v_fma_f32 v88, v88, v5, v28
M v[120:123], a[100:103], v[144:147], v[120:123]
 ds_read_b128 a[68:71], v2 offset:33792
 v_fma_f32 v89, v89, v5, v28
M v[120:123], a[104:107], v[160:163], v[120:123]
 v_fma_f32 v90, v90, v5, v28
 v_fma_f32 v91, v91, v5, v28
M v[120:123], a[108:111], v[176:179], v[120:123]
 ds_read_b128 a[72:75], v2 offset:34816
 v_cvt_pk_bf16_f32 v80, v80, v81
M v[120:123], a[112:115], v[192:195], v[120:123]
 ds_read_b128 a[76:79], v2 offset:35840
 v_cvt_pk_bf16_f32 v81, v82, v83
M v[120:123], a[116:119], v[208:211], v[120:123]
 v_cvt_pk_bf16_f32 v82, v88, v89
 v_cvt_pk_bf16_f32 v83, v90, v91
M v[120:123], a[120:123], v[224:227], v[120:123]
 ds_read_b128 a[80:83], v2 offset:36864
M v[120:123], a[124:127], v[240:243], v[120:123]
 ds_read_b128 a[84:87], v2 offset:37888
M v[124:127], a[124:127], v[244:247], v[36:39]
 buffer_store_dwordx4 v[80:83], v7, s[8:11], s29 offen offset:1024 sc1
M v[124:127], a[120:123], v[228:231], v[124:127]
 ds_read_b128 a[88:91], v2 offset:38912
 v_fma_f32 v84, v84, v6, v29
M v[124:127], a[116:119], v[212:215], v[124:127]
 ds_read_b128 a[92:95], v2 offset:39936
 v_fma_f32 v85, v85, v6, v29
M v[124:127], a[112:115], v[196:199], v[124:127]
 v_fma_f32 v86, v86, v6, v29
 v_fma_f32 v87, v87, v6, v29
M v[124:127], a[108:111], v[180:183], v[124:127]
 v_fma_f32 v92, v92, v6, v29
 v_fma_f32 v93, v93, v6, v29
M v[124:127], a[104:107], v[164:167], v[124:127]
 v_fma_f32 v94, v94, v6, v29
 v_fma_f32 v95, v95, v6, v29
M v[124:127], a[100:103], v[148:151], v[124:127]
 s_waitcnt lgkmcnt(0)
 s_cmp_eq_u32 s42, 6
 v_cvt_pk_bf16_f32 v84, v84, v85
 v_cvt_pk_bf16_f32 v85, v86, v87
M v[124:127], a[96:99], v[132:135], v[124:127]
 v_cvt_pk_bf16_f32 v86, v92, v93
 v_cvt_pk_bf16_f32 v87, v94, v95
 buffer_store_dwordx4 v[84:87], v7, s[8:11], s30 offen offset:1024 sc1
 s_cbranch_scc1 L_y2
L_y2r:
M v[64:67], a[64:67], v[128:131], v[32:35]
 ds_read_b128 a[96:99], v2 offset:40960
M v[64:67], a[68:71], v[144:147], v[64:67]
 ds_read_b128 a[100:103], v2 offset:41984
M v[64:67], a[72:75], v[160:163], v[64:67]
 s_waitcnt vmcnt(23)
 v_cmp_gt_u32 vcc, 1, v24
M v[64:67], a[76:79], v[176:179], v[64:67]
 s_mov_b32 s65, 104890368
 ds_read_b128 a[104:107], v2 offset:43008
 s_add_u32 s29, s33, 6144
M v[64:67], a[80:83], v[192:195], v[64:67]
 s_cbranch_vccnz L_fhs1
L_fhr1:
 ds_read_b128 a[108:111], v2 offset:44032
 s_add_u32 s30, s33, 20480
M v[64:67], a[84:87], v[208:211], v[64:67]
 buffer_load_dword v25, v14, s[8:11], s65 offen sc1
M v[64:67], a[88:91], v[224:227], v[64:67]
 ds_read_b128 a[112:115], v2 offset:45056
 v_fma_f32 v96, v96, v5, v28
M v[64:67], a[92:95], v[240:243], v[64:67]
 ds_read_b128 a[116:119], v2 offset:46080
 v_fma_f32 v97, v97, v5, v28
M v[68:71], a[92:95], v[244:247], v[36:39]
 v_fma_f32 v98, v98, v5, v28
 v_fma_f32 v99, v99, v5, v28
M v[68:71], a[88:91], v[228:231], v[68:71]
 ds_read_b128 a[120:123], v2 offset:47104
 v_fma_f32 v104, v104, v5, v28
M v[68:71], a[84:87], v[212:215], v[68:71]
 ds_read_b128 a[124:127], v2 offset:48128
 v_fma_f32 v105, v105, v5, v28
M v[68:71], a[80:83], v[196:199], v[68:71]
 v_fma_f32 v106, v106, v5, v28
 v_fma_f32 v107, v107, v5, v28
M v[68:71], a[76:79], v[180:183], v[68:71]
 v_cvt_pk_bf16_f32 v96, v96, v97
M v[68:71], a[72:75], v[164:167], v[68:71]
 v_cvt_pk_bf16_f32 v97, v98, v99
M v[68:71], a[68:71], v[148:151], v[68:71]
 v_cvt_pk_bf16_f32 v98, v104, v105
M v[68:71], a[64:67], v[132:135], v[68:71]
 s_waitcnt lgkmcnt(0)
 v_cvt_pk_bf16_f32 v99, v106, v107
M v[72:75], a[96:99], v[128:131], v[32:35]
 ds_read_b128 a[64:67], v2 offset:49152
M v[72:75], a[100:103], v[144:147], v[72:75]
 ds_read_b128 a[68:71], v2 offset:50176
M v[72:75], a[104:107], v[160:163], v[72:75]
 buffer_store_dwordx4 v[96:99], v7, s[8:11], s29 offen offset:0 sc1
M v[72:75], a[108:111], v[176:179], v[72:75]
 ds_read_b128 a[72:75], v2 offset:51200
 v_fma_f32 v100, v100, v6, v29
M v[72:75], a[112:115], v[192:195], v[72:75]
 ds_read_b128 a[76:79], v2 offset:52224
 v_fma_f32 v101, v101, v6, v29
M v[72:75], a[116:119], v[208:211], v[72:75]
 v_fma_f32 v102, v102, v6, v29
 v_fma_f32 v103, v103, v6, v29
M v[72:75], a[120:123], v[224:227], v[72:75]
 ds_read_b128 a[80:83], v2 offset:53248
 v_fma_f32 v108, v108, v6, v29
M v[72:75], a[124:127], v[240:243], v[72:75]
 ds_read_b128 a[84:87], v2 offset:54272
 v_fma_f32 v109, v109, v6, v29
M v[76:79], a[124:127], v[244:247], v[36:39]
 v_fma_f32 v110, v110, v6, v29
 v_fma_f32 v111, v111, v6, v29
M v[76:79], a[120:123], v[228:231], v[76:79]
 ds_read_b128 a[88:91], v2 offset:55296
 v_cvt_pk_bf16_f32 v100, v100, v101
M v[76:79], a[116:119], v[212:215], v[76:79]
 ds_read_b128 a[92:95], v2 offset:56320
 v_cvt_pk_bf16_f32 v101, v102, v103
M v[76:79], a[112:115], v[196:199], v[76:79]
 v_cvt_pk_bf16_f32 v102, v108, v109
M v[76:79], a[108:111], v[180:183], v[76:79]
 v_cvt_pk_bf16_f32 v103, v110, v111
M v[76:79], a[104:107], v[164:167], v[76:79]
 buffer_store_dwordx4 v[100:103], v7, s[8:11], s30 offen offset:0 sc1
M v[76:79], a[100:103], v[148:151], v[76:79]
M v[76:79], a[96:99], v[132:135], v[76:79]
 s_waitcnt lgkmcnt(0)
 v_fma_f32 v112, v112, v5, v28
M v[80:83], a[64:67], v[128:131], v[32:35]
 ds_read_b128 a[96:99], v2 offset:57344
 v_fma_f32 v113, v113, v5, v28
M v[80:83], a[68:71], v[144:147], v[80:83]
 ds_read_b128 a[100:103], v2 offset:58368
 v_fma_f32 v114, v114, v5, v28
M v[80:83], a[72:75], v[160:163], v[80:83]
 v_fma_f32 v115, v115, v5, v28
M v[80:83], a[76:79], v[176:179], v[80:83]
 ds_read_b128 a[104:107], v2 offset:59392
 v_fma_f32 v120, v120, v5, v28
M v[80:83], a[80:83], v[192:195], v[80:83]
 ds_read_b128 a[108:111], v2 offset:60416
 v_fma_f32 v121, v121, v5, v28
M v[80:83], a[84:87], v[208:211], v[80:83]
 v_fma_f32 v122, v122, v5, v28
M v[80:83], a[88:91], v[224:227], v[80:83]
 ds_read_b128 a[112:115], v2 offset:61440
 v_fma_f32 v123, v123, v5, v28
M v[80:83], a[92:95], v[240:243], v[80:83]
 ds_read_b128 a[116:119], v2 offset:62464
 v_cvt_pk_bf16_f32 v112, v112, v113
M v[84:87], a[92:95], v[244:247], v[36:39]
 v_cvt_pk_bf16_f32 v113, v114, v115
 v_cvt_pk_bf16_f32 v114, v120, v121
M v[84:87], a[88:91], v[228:231], v[84:87]
 ds_read_b128 a[120:123], v2 offset:63488
 v_cvt_pk_bf16_f32 v115, v122, v123
M v[84:87], a[84:87], v[212:215], v[84:87]
 ds_read_b128 a[124:127], v2 offset:64512
M v[84:87], a[80:83], v[196:199], v[84:87]
 buffer_store_dwordx4 v[112:115], v7, s[8:11], s29 offen offset:1024 sc1
M v[84:87], a[76:79], v[180:183], v[84:87]
 v_fma_f32 v116, v116, v6, v29
M v[84:87], a[72:75], v[164:167], v[84:87]
 v_fma_f32 v117, v117, v6, v29
M v[84:87], a[68:71], v[148:151], v[84:87]
 s_waitcnt vmcnt(19) lgkmcnt(0)
 v_fma_f32 v118, v118, v6, v29
M v[84:87], a[64:67], v[132:135], v[84:87]
 s_barrier
M v[88:91], a[96:99], v[128:131], v[32:35]
 ds_read_b128 a[64:67], v7 offset:32768
 v_fma_f32 v119, v119, v6, v29
M v[88:91], a[100:103], v[144:147], v[88:91]
 ds_read_b128 a[68:71], v7 offset:33792
 v_fma_f32 v124, v124, v6, v29
M v[88:91], a[104:107], v[160:163], v[88:91]
 v_fma_f32 v125, v125, v6, v29
 v_fma_f32 v126, v126, v6, v29
M v[88:91], a[108:111], v[176:179], v[88:91]
 ds_read_b128 a[72:75], v7 offset:34816
 v_fma_f32 v127, v127, v6, v29
M v[88:91], a[112:115], v[192:195], v[88:91]
 ds_read_b128 a[76:79], v7 offset:35840
 v_cvt_pk_bf16_f32 v116, v116, v117
M v[88:91], a[116:119], v[208:211], v[88:91]
 v_cvt_pk_bf16_f32 v117, v118, v119
M v[88:91], a[120:123], v[224:227], v[88:91]
 ds_read_b128 a[80:83], v7 offset:36864
 v_cvt_pk_bf16_f32 v118, v124, v125
M v[88:91], a[124:127], v[240:243], v[88:91]
 ds_read_b128 a[84:87], v7 offset:37888
 v_cvt_pk_bf16_f32 v119, v126, v127
M v[92:95], a[124:127], v[244:247], v[36:39]
 buffer_store_dwordx4 v[116:119], v7, s[8:11], s30 offen offset:1024 sc1
M v[92:95], a[120:123], v[228:231], v[92:95]
 ds_read_b128 a[88:91], v7 offset:38912
M v[92:95], a[116:119], v[212:215], v[92:95]
 ds_read_b128 a[92:95], v7 offset:39936
M v[92:95], a[112:115], v[196:199], v[92:95]
M v[92:95], a[108:111], v[180:183], v[92:95]
M v[92:95], a[104:107], v[164:167], v[92:95]
M v[92:95], a[100:103], v[148:151], v[92:95]
 s_waitcnt lgkmcnt(0)
M v[92:95], a[96:99], v[132:135], v[92:95]
M v[96:99], a[64:67], v[128:131], v[32:35]
 ds_read_b128 a[96:99], v7 offset:40960
M v[96:99], a[68:71], v[144:147], v[96:99]
 ds_read_b128 a[100:103], v7 offset:41984
M v[96:99], a[72:75], v[160:163], v[96:99]
M v[96:99], a[76:79], v[176:179], v[96:99]
 ds_read_b128 a[104:107], v7 offset:43008
 s_add_u32 s29, s33, 8192
M v[96:99], a[80:83], v[192:195], v[96:99]
 ds_read_b128 a[108:111], v7 offset:44032
 s_add_u32 s30, s33, 22528
M v[96:99], a[84:87], v[208:211], v[96:99]
 v_fma_f32 v64, v64, v5, v28
 v_fma_f32 v65, v65, v5, v28
M v[96:99], a[88:91], v[224:227], v[96:99]
 ds_read_b128 a[112:115], v7 offset:45056
 v_fma_f32 v66, v66, v5, v28
M v[96:99], a[92:95], v[240:243], v[96:99]
 ds_read_b128 a[116:119], v7 offset:46080
 v_fma_f32 v67, v67, v5, v28
M v[100:103], a[92:95], v[244:247], v[36:39]
 v_fma_f32 v72, v72, v5, v28
M v[100:103], a[88:91], v[228:231], v[100:103]
 ds_read_b128 a[120:123], v7 offset:47104
 v_fma_f32 v73, v73, v5, v28
M v[100:103], a[84:87], v[212:215], v[100:103]
 ds_read_b128 a[124:127], v7 offset:48128
 v_fma_f32 v74, v74, v5, v28
M v[100:103], a[80:83], v[196:199], v[100:103]
 v_fma_f32 v75, v75, v5, v28
M v[100:103], a[76:79], v[180:183], v[100:103]
 v_cvt_pk_bf16_f32 v64, v64, v65
M v[100:103], a[72:75], v[164:167], v[100:103]
 v_cvt_pk_bf16_f32 v65, v66, v67
M v[100:103], a[68:71], v[148:151], v[100:103]
 v_cvt_pk_bf16_f32 v66, v72, v73
M v[100:103], a[64:67], v[132:135], v[100:103]
 s_waitcnt lgkmcnt(0)
 v_cvt_pk_bf16_f32 v67, v74, v75
M v[104:107], a[96:99], v[128:131], v[32:35]
 ds_read_b128 a[64:67], v7 offset:49152
M v[104:107], a[100:103], v[144:147], v[104:107]
 ds_read_b128 a[68:71], v7 offset:50176
M v[104:107], a[104:107], v[160:163], v[104:107]
 buffer_store_dwordx4 v[64:67], v7, s[8:11], s29 offen offset:0 sc1
M v[104:107], a[108:111], v[176:179], v[104:107]
 ds_read_b128 a[72:75], v7 offset:51200
 v_fma_f32 v68, v68, v6, v29
M v[104:107], a[112:115], v[192:195], v[104:107]
 ds_read_b128 a[76:79], v7 offset:52224
 v_fma_f32 v69, v69, v6, v29
M v[104:107], a[116:119], v[208:211], v[104:107]
 v_fma_f32 v70, v70, v6, v29
 v_fma_f32 v71, v71, v6, v29
M v[104:107], a[120:123], v[224:227], v[104:107]
 ds_read_b128 a[80:83], v7 offset:53248
 v_fma_f32 v76, v76, v6, v29
M v[104:107], a[124:127], v[240:243], v[104:107]
 ds_read_b128 a[84:87], v7 offset:54272
 v_fma_f32 v77, v77, v6, v29
M v[108:111], a[124:127], v[244:247], v[36:39]
 v_fma_f32 v78, v78, v6, v29
 v_fma_f32 v79, v79, v6, v29
M v[108:111], a[120:123], v[228:231], v[108:111]
 ds_read_b128 a[88:91], v7 offset:55296
 v_cvt_pk_bf16_f32 v68, v68, v69
M v[108:111], a[116:119], v[212:215], v[108:111]
 ds_read_b128 a[92:95], v7 offset:56320
 v_cvt_pk_bf16_f32 v69, v70, v71
M v[108:111], a[112:115], v[196:199], v[108:111]
 v_cvt_pk_bf16_f32 v70, v76, v77
M v[108:111], a[108:111], v[180:183], v[108:111]
 v_cvt_pk_bf16_f32 v71, v78, v79
M v[108:111], a[104:107], v[164:167], v[108:111]
 buffer_store_dwordx4 v[68:71], v7, s[8:11], s30 offen offset:0 sc1
M v[108:111], a[100:103], v[148:151], v[108:111]
M v[108:111], a[96:99], v[132:135], v[108:111]
 s_waitcnt lgkmcnt(0)
 v_fma_f32 v80, v80, v5, v28
M v[112:115], a[64:67], v[128:131], v[32:35]
 ds_read_b128 a[96:99], v7 offset:57344
 v_fma_f32 v81, v81, v5, v28
M v[112:115], a[68:71], v[144:147], v[112:115]
 ds_read_b128 a[100:103], v7 offset:58368
 v_fma_f32 v82, v82, v5, v28
M v[112:115], a[72:75], v[160:163], v[112:115]
 v_fma_f32 v83, v83, v5, v28
M v[112:115], a[76:79], v[176:179], v[112:115]
 ds_read_b128 a[104:107], v7 offset:59392
 v_fma_f32 v88, v88, v5, v28
M v[112:115], a[80:83], v[192:195], v[112:115]
 ds_read_b128 a[108:111], v7 offset:60416
 v_fma_f32 v89, v89, v5, v28
M v[112:115], a[84:87], v[208:211], v[112:115]
 v_fma_f32 v90, v90, v5, v28
M v[112:115], a[88:91], v[224:227], v[112:115]
 ds_read_b128 a[112:115], v7 offset:61440
 v_fma_f32 v91, v91, v5, v28
M v[112:115], a[92:95], v[240:243], v[112:115]
 ds_read_b128 a[116:119], v7 offset:62464
 v_cvt_pk_bf16_f32 v80, v80, v81
M v[116:119], a[92:95], v[244:247], v[36:39]
 s_waitcnt vmcnt(6)
 v_readlane_b32 s84, v25, 0
 v_readlane_b32 s85, v25, 1
M v[116:119], a[88:91], v[228:231], v[116:119]
 ds_read_b128 a[120:123], v7 offset:63488
 v_mov_b32 v24, 0x3f80
M v[116:119], a[84:87], v[212:215], v[116:119]
 ds_read_b128 a[124:127], v7 offset:64512
 v_mov_b32 v25, 0x3f800000
M v[116:119], a[80:83], v[196:199], v[116:119]
 v_cvt_pk_bf16_f32 v81, v82, v83
 v_cvt_pk_bf16_f32 v82, v88, v89
M v[116:119], a[76:79], v[180:183], v[116:119]
 v_cvt_pk_bf16_f32 v83, v90, v91
M v[116:119], a[72:75], v[164:167], v[116:119]
 buffer_store_dwordx4 v[80:83], v7, s[8:11], s29 offen offset:1024 sc1
M v[116:119], a[68:71], v[148:151], v[116:119]
 s_waitcnt lgkmcnt(0)
 v_fma_f32 v84, v84, v6, v29
 v_fma_f32 v85, v85, v6, v29
M v[116:119], a[64:67], v[132:135], v[116:119]
 s_barrier
M v[120:123], a[96:99], v[128:131], v[32:35]
 ds_read_b128 a[64:67], v2 offset:0
 v_fma_f32 v86, v86, v6, v29
M v[120:123], a[100:103], v[144:147], v[120:123]
 ds_read_b128 a[68:71], v2 offset:1024
 v_fma_f32 v87, v87, v6, v29
M v[120:123], a[104:107], v[160:163], v[120:123]
 v_fma_f32 v92, v92, v6, v29
 v_fma_f32 v93, v93, v6, v29
M v[120:123], a[108:111], v[176:179], v[120:123]
 ds_read_b128 a[72:75], v2 offset:2048
 v_fma_f32 v94, v94, v6, v29
M v[120:123], a[112:115], v[192:195], v[120:123]
 ds_read_b128 a[76:79], v2 offset:3072
 v_fma_f32 v95, v95, v6, v29
M v[120:123], a[116:119], v[208:211], v[120:123]
 s_waitcnt vmcnt(3)
 v_cvt_pk_bf16_f32 v84, v84, v85
 v_cvt_pk_bf16_f32 v85, v86, v87
M v[120:123], a[120:123], v[224:227], v[120:123]
 ds_read_b128 a[80:83], v2 offset:4096
 v_cvt_pk_bf16_f32 v86, v92, v93
M v[120:123], a[124:127], v[240:243], v[120:123]
 ds_read_b128 a[84:87], v2 offset:5120
 v_cvt_pk_bf16_f32 v87, v94, v95
M v[124:127], a[124:127], v[244:247], v[36:39]
 buffer_store_dword v15, v16, s[8:11], s45 offen sc1
M v[124:127], a[120:123], v[228:231], v[124:127]
 ds_read_b128 a[88:91], v2 offset:6144
M v[124:127], a[116:119], v[212:215], v[124:127]
 ds_read_b128 a[92:95], v2 offset:7168
M v[124:127], a[112:115], v[196:199], v[124:127]
 buffer_store_dwordx4 v[84:87], v7, s[8:11], s30 offen offset:1024 sc1
M v[124:127], a[108:111], v[180:183], v[124:127]
M v[124:127], a[104:107], v[164:167], v[124:127]
M v[124:127], a[100:103], v[148:151], v[124:127]
 s_waitcnt lgkmcnt(0)
 s_cmp_eq_u32 s42, 6
M v[124:127], a[96:99], v[132:135], v[124:127]
 s_cbranch_scc1 L_y3
L_y3r:
M v[64:67], a[64:67], v[128:131], v[32:35]
 ds_read_b128 a[96:99], v2 offset:8192
M v[64:67], a[68:71], v[144:147], v[64:67]
 ds_read_b128 a[100:103], v2 offset:9216
M v[64:67], a[72:75], v[160:163], v[64:67]
M v[64:67], a[76:79], v[176:179], v[64:67]
 ds_read_b128 a[104:107], v2 offset:10240
 s_add_u32 s29, s33, 10240
M v[64:67], a[80:83], v[192:195], v[64:67]
 ds_read_b128 a[108:111], v2 offset:11264
 s_add_u32 s30, s33, 24576
M v[64:67], a[84:87], v[208:211], v[64:67]
 v_fma_f32 v96, v96, v5, v28
 v_fma_f32 v97, v97, v5, v28
M v[64:67], a[88:91], v[224:227], v[64:67]
 ds_read_b128 a[112:115], v2 offset:12288
 v_fma_f32 v98, v98, v5, v28
M v[64:67], a[92:95], v[240:243], v[64:67]
 ds_read_b128 a[116:119], v2 offset:13312
 v_fma_f32 v99, v99, v5, v28
M v[68:71], a[92:95], v[244:247], v[36:39]
 v_fma_f32 v104, v104, v5, v28
 v_fma_f32 v105, v105, v5, v28
M v[68:71], a[88:91], v[228:231], v[68:71]
 ds_read_b128 a[120:123], v2 offset:14336
 v_fma_f32 v106, v106, v5, v28
M v[68:71], a[84:87], v[212:215], v[68:71]
 ds_read_b128 a[124:127], v2 offset:15360
 v_fma_f32 v107, v107, v5, v28
M v[68:71], a[80:83], v[196:199], v[68:71]
 v_cvt_pk_bf16_f32 v96, v96, v97
 v_cvt_pk_bf16_f32 v97, v98, v99
M v[68:71], a[76:79], v[180:183], v[68:71]
 v_cvt_pk_bf16_f32 v98, v104, v105
 v_cvt_pk_bf16_f32 v99, v106, v107
M v[68:71], a[72:75], v[164:167], v[68:71]
 buffer_store_dwordx4 v[96:99], v7, s[8:11], s29 offen offset:0 sc1
M v[68:71], a[68:71], v[148:151], v[68:71]
 v_fma_f32 v100, v100, v6, v29
 v_fma_f32 v101, v101, v6, v29
M v[68:71], a[64:67], v[132:135], v[68:71]
 s_waitcnt lgkmcnt(0)
 v_fma_f32 v102, v102, v6, v29
 v_fma_f32 v103, v103, v6, v29
M v[72:75], a[96:99], v[128:131], v[32:35]
 ds_read_b128 a[64:67], v2 offset:16384
 v_fma_f32 v108, v108, v6, v29
M v[72:75], a[100:103], v[144:147], v[72:75]
 ds_read_b128 a[68:71], v2 offset:17408
 v_fma_f32 v109, v109, v6, v29
M v[72:75], a[104:107], v[160:163], v[72:75]
 v_fma_f32 v110, v110, v6, v29
 v_fma_f32 v111, v111, v6, v29
M v[72:75], a[108:111], v[176:179], v[72:75]
 ds_read_b128 a[72:75], v2 offset:18432
 v_cvt_pk_bf16_f32 v100, v100, v101
M v[72:75], a[112:115], v[192:195], v[72:75]
 ds_read_b128 a[76:79], v2 offset:19456
 v_cvt_pk_bf16_f32 v101, v102, v103
M v[72:75], a[116:119], v[208:211], v[72:75]
 v_cvt_pk_bf16_f32 v102, v108, v109
 v_cvt_pk_bf16_f32 v103, v110, v111
M v[72:75], a[120:123], v[224:227], v[72:75]
 ds_read_b128 a[80:83], v2 offset:20480
M v[72:75], a[124:127], v[240:243], v[72:75]
 ds_read_b128 a[84:87], v2 offset:21504
M v[76:79], a[124:127], v[244:247], v[36:39]
 buffer_store_dwordx4 v[100:103], v7, s[8:11], s30 offen offset:0 sc1
M v[76:79], a[120:123], v[228:231], v[76:79]
 ds_read_b128 a[88:91], v2 offset:22528
 v_fma_f32 v112, v112, v5, v28
M v[76:79], a[116:119], v[212:215], v[76:79]
 ds_read_b128 a[92:95], v2 offset:23552
 v_fma_f32 v113, v113, v5, v28
M v[76:79], a[112:115], v[196:199], v[76:79]
 v_fma_f32 v114, v114, v5, v28
 v_fma_f32 v115, v115, v5, v28
M v[76:79], a[108:111], v[180:183], v[76:79]
 v_fma_f32 v120, v120, v5, v28
 v_fma_f32 v121, v121, v5, v28
M v[76:79], a[104:107], v[164:167], v[76:79]
 v_fma_f32 v122, v122, v5, v28
 v_fma_f32 v123, v123, v5, v28
M v[76:79], a[100:103], v[148:151], v[76:79]
 v_cvt_pk_bf16_f32 v112, v112, v113
 v_cvt_pk_bf16_f32 v113, v114, v115
M v[76:79], a[96:99], v[132:135], v[76:79]
 s_waitcnt lgkmcnt(0)
 v_cvt_pk_bf16_f32 v114, v120, v121
 v_cvt_pk_bf16_f32 v115, v122, v123
M v[80:83], a[64:67], v[128:131], v[32:35]
 ds_read_b128 a[96:99], v2 offset:24576
M v[80:83], a[68:71], v[144:147], v[80:83]
 ds_read_b128 a[100:103], v2 offset:25600
M v[80:83], a[72:75], v[160:163], v[80:83]
 buffer_store_dwordx4 v[112:115], v7, s[8:11], s29 offen offset:1024 sc1
M v[80:83], a[76:79], v[176:179], v[80:83]
 ds_read_b128 a[104:107], v2 offset:26624
 v_fma_f32 v116, v116, v6, v29
M v[80:83], a[80:83], v[192:195], v[80:83]
 ds_read_b128 a[108:111], v2 offset:27648
 v_fma_f32 v117, v117, v6, v29
M v[80:83], a[84:87], v[208:211], v[80:83]
 v_fma_f32 v118, v118, v6, v29
 v_fma_f32 v119, v119, v6, v29
M v[80:83], a[88:91], v[224:227], v[80:83]
 ds_read_b128 a[112:115], v2 offset:28672
 v_fma_f32 v124, v124, v6, v29
M v[80:83], a[92:95], v[240:243], v[80:83]
 ds_read_b128 a[116:119], v2 offset:29696
 v_fma_f32 v125, v125, v6, v29
M v[84:87], a[92:95], v[244:247], v[36:39]
 v_fma_f32 v126, v126, v6, v29
 v_fma_f32 v127, v127, v6, v29
M v[84:87], a[88:91], v[228:231], v[84:87]
 ds_read_b128 a[120:123], v2 offset:30720
 v_cvt_pk_bf16_f32 v116, v116, v117
M v[84:87], a[84:87], v[212:215], v[84:87]
 ds_read_b128 a[124:127], v2 offset:31744
 v_cvt_pk_bf16_f32 v117, v118, v119
M v[84:87], a[80:83], v[196:199], v[84:87]
 v_cvt_pk_bf16_f32 v118, v124, v125
 v_cvt_pk_bf16_f32 v119, v126, v127
M v[84:87], a[76:79], v[180:183], v[84:87]
 buffer_store_dwordx4 v[116:119], v7, s[8:11], s30 offen offset:1024 sc1
M v[84:87], a[72:75], v[164:167], v[84:87]
 s_add_u32 s29, s33, 12288
M v[84:87], a[68:71], v[148:151], v[84:87]
 s_add_u32 s30, s33, 26624
 v_fma_f32 v64, v64, v5, v28
 v_fma_f32 v65, v65, v5, v28
M v[84:87], a[64:67], v[132:135], v[84:87]
 s_waitcnt lgkmcnt(0)
 v_fma_f32 v66, v66, v5, v28
 v_fma_f32 v67, v67, v5, v28
M v[88:91], a[96:99], v[128:131], v[32:35]
 v_fma_f32 v72, v72, v5, v28
 v_fma_f32 v73, v73, v5, v28
M v[88:91], a[100:103], v[144:147], v[88:91]
 v_fma_f32 v74, v74, v5, v28
 v_fma_f32 v75, v75, v5, v28
M v[88:91], a[104:107], v[160:163], v[88:91]
 v_cvt_pk_bf16_f32 v64, v64, v65
 v_cvt_pk_bf16_f32 v65, v66, v67
M v[88:91], a[108:111], v[176:179], v[88:91]
 v_cvt_pk_bf16_f32 v66, v72, v73
 v_cvt_pk_bf16_f32 v67, v74, v75
M v[88:91], a[112:115], v[192:195], v[88:91]
 buffer_store_dwordx4 v[64:67], v7, s[8:11], s29 offen offset:0 sc1
M v[88:91], a[116:119], v[208:211], v[88:91]
 v_fma_f32 v68, v68, v6, v29
 v_fma_f32 v69, v69, v6, v29
M v[88:91], a[120:123], v[224:227], v[88:91]
 v_fma_f32 v70, v70, v6, v29
 v_fma_f32 v71, v71, v6, v29
M v[88:91], a[124:127], v[240:243], v[88:91]
 v_fma_f32 v76, v76, v6, v29
 v_fma_f32 v77, v77, v6, v29
M v[92:95], a[124:127], v[244:247], v[36:39]
 v_fma_f32 v78, v78, v6, v29
 v_fma_f32 v79, v79, v6, v29
M v[92:95], a[120:123], v[228:231], v[92:95]
 v_cvt_pk_bf16_f32 v68, v68, v69
 v_cvt_pk_bf16_f32 v69, v70, v71
M v[92:95], a[116:119], v[212:215], v[92:95]
 v_cvt_pk_bf16_f32 v70, v76, v77
 v_cvt_pk_bf16_f32 v71, v78, v79
M v[92:95], a[112:115], v[196:199], v[92:95]
 buffer_store_dwordx4 v[68:71], v7, s[8:11], s30 offen offset:0 sc1
M v[92:95], a[108:111], v[180:183], v[92:95]
M v[92:95], a[104:107], v[164:167], v[92:95]
M v[92:95], a[100:103], v[148:151], v[92:95]
M v[92:95], a[96:99], v[132:135], v[92:95]
 v_fma_f32 v80, v80, v5, v28
 v_fma_f32 v81, v81, v5, v28
 v_fma_f32 v82, v82, v5, v28
 v_fma_f32 v83, v83, v5, v28
 v_fma_f32 v88, v88, v5, v28
 v_fma_f32 v89, v89, v5, v28
 v_fma_f32 v90, v90, v5, v28
 v_fma_f32 v91, v91, v5, v28
 v_cvt_pk_bf16_f32 v80, v80, v81
 v_cvt_pk_bf16_f32 v81, v82, v83
 v_cvt_pk_bf16_f32 v82, v88, v89
 v_cvt_pk_bf16_f32 v83, v90, v91
 buffer_store_dwordx4 v[80:83], v7, s[8:11], s29 offen offset:1024 sc1
 v_fma_f32 v84, v84, v6, v29
 v_fma_f32 v85, v85, v6, v29
 v_fma_f32 v86, v86, v6, v29
 v_fma_f32 v87, v87, v6, v29
 v_fma_f32 v92, v92, v6, v29
 v_fma_f32 v93, v93, v6, v29
 v_fma_f32 v94, v94, v6, v29
 v_fma_f32 v95, v95, v6, v29
 v_cvt_pk_bf16_f32 v84, v84, v85
 v_cvt_pk_bf16_f32 v85, v86, v87
 v_cvt_pk_bf16_f32 v86, v92, v93
 v_cvt_pk_bf16_f32 v87, v94, v95
 buffer_store_dwordx4 v[84:87], v7, s[8:11], s30 offen offset:1024 sc1
 s_waitcnt vmcnt(0)
 buffer_store_dword v15, v16, s[8:11], s3 offen sc1
 s_cmp_lt_u32 s42, 8
 s_cbranch_scc1 L_red
 s_cmp_eq_u32 s20, 3
 s_cbranch_scc1 L_vend
 s_sub_u32 s64, 15, s42
 s_lshl_b32 s64, s64, 1
 s_lshr_b32 s65, s41, 3
 s_add_u32 s46, s64, s65
 s_mul_i32 s46, s46, 4352
 s_and_b32 s72, s41, 7
 s_lshl_b32 s66, s72, 7
 s_add_u32 s46, s46, s66
 s_add_u32 s46, s46, 104993792
 v_and_b32 v14, 15, v0
 v_lshlrev_b32 v14, 2, v14
 buffer_load_dword v9, v14, s[8:11], s46 offen sc1
 s_mul_i32 s86, s65, 3
 s_add_u32 s86, s86, s20
 s_add_u32 s86, s86, 8
 s_mul_i32 s77, s42, 1835008
 s_mul_i32 s78, s72, 14336
 s_add_u32 s77, s77, s78
 s_add_u32 s77, s77, 67108864
 s_lshl_b32 s78, s86, 10
 s_add_u32 s77, s77, s78
 s_lshl_b32 s86, s86, 6
 s_lshr_b32 s73, s72, 1
 s_sub_u32 s65, 7, s73
 s_bitcmp1_b32 s72, 0
 s_cselect_b32 s73, s65, s73
 s_lshl_b32 s73, s73, 4
 s_lshl_b32 s65, s42, 7
 s_add_u32 s73, s73, s65
 v_and_b32 v10, 15, v0
 v_add_u32 v10, s73, v10
 s_mov_b32 s64, 104857664
 v_mul_u32_u24 v12, 896, v10
 v_lshl_add_u32 v12, v11, 4, v12
 v_lshrrev_b32 v13, 4, v10
 v_lshlrev_b32 v13, 5, v13
 v_and_b32 v104, 15, v10
 v_add_lshl_u32 v13, v13, v104, 2
 buffer_load_dword v15, v13, s[8:11], s64 offen sc1
 buffer_load_dwordx4 v[16:19], v12, s[56:59], s86 offen
 v_mov_b32 v48, 0
 v_mov_b32 v49, 0
 v_mov_b32 v50, 0
 v_mov_b32 v51, 0
 v_mov_b32 v52, 0
 v_mov_b32 v53, 0
 v_mov_b32 v54, 0
 v_mov_b32 v55, 0
 s_waitcnt vmcnt(2)
 v_cmp_eq_u32 vcc, 1, v9
 s_mov_b32 s91, 65536
 s_mov_b32 s69, 0
 s_and_b32 s70, vcc_lo, 0xffff
 s_or_b32 s68, s70, 0xffff0000
 s_cmp_lg_u32 s70, 0
 s_cbranch_scc1 L_vk0
 s_call_b64 s[36:37], L_rpoll
L_vk0:
 s_ff1_i32_b32 s71, s70
 s_bitset0_b32 s70, s71
 s_mul_i32 s71, s71, 114688
 s_add_u32 s71, s71, s77
 buffer_load_dwordx4 v[128:131], v7, s[8:11], s71 offen sc1
 s_cmp_lg_u32 s70, 0
 s_cbranch_scc1 L_vk1
 s_call_b64 s[36:37], L_rpoll
L_vk1:
 s_ff1_i32_b32 s71, s70
 s_bitset0_b32 s70, s71
 s_mul_i32 s71, s71, 114688
 s_add_u32 s71, s71, s77
 buffer_load_dwordx4 v[132:135], v7, s[8:11], s71 offen sc1
 s_waitcnt vmcnt(2)
 v_lshlrev_b32 v32, 16, v16
 v_and_b32 v33, 0xffff0000, v16
 v_lshlrev_b32 v34, 16, v17
 v_and_b32 v35, 0xffff0000, v17
 v_lshlrev_b32 v36, 16, v18
 v_and_b32 v37, 0xffff0000, v18
 v_lshlrev_b32 v38, 16, v19
 v_and_b32 v39, 0xffff0000, v19
 v_sub_f32 v13, 1.0, v15
 v_cmp_eq_u32 s[80:81], s84, v10
 v_cmp_eq_u32 s[82:83], s85, v10
 s_nop 0
 s_or_b64 vcc, s[80:81], s[82:83]
 s_cbranch_vccnz L_moe2
L_moe_ret2:
 v_mul_f32 v32, v13, v32
 v_mul_f32 v33, v13, v33
 v_mul_f32 v34, v13, v34
 v_mul_f32 v35, v13, v35
 v_mul_f32 v36, v13, v36
 v_mul_f32 v37, v13, v37
 v_mul_f32 v38, v13, v38
 v_mul_f32 v39, v13, v39
 s_cmp_lg_u32 s70, 0
 s_cbranch_scc1 L_vk2
 s_call_b64 s[36:37], L_rpoll
L_vk2:
 s_ff1_i32_b32 s71, s70
 s_bitset0_b32 s70, s71
 s_mul_i32 s71, s71, 114688
 s_add_u32 s71, s71, s77
 buffer_load_dwordx4 v[136:139], v7, s[8:11], s71 offen sc1
 s_cmp_lg_u32 s70, 0
 s_cbranch_scc1 L_vk3
 s_call_b64 s[36:37], L_rpoll
L_vk3:
 s_ff1_i32_b32 s71, s70
 s_bitset0_b32 s70, s71
 s_mul_i32 s71, s71, 114688
 s_add_u32 s71, s71, s77
 buffer_load_dwordx4 v[140:143], v7, s[8:11], s71 offen sc1
 s_cmp_lg_u32 s70, 0
 s_cbranch_scc1 L_vk4
 s_call_b64 s[36:37], L_rpoll
L_vk4:
 s_ff1_i32_b32 s71, s70
 s_bitset0_b32 s70, s71
 s_mul_i32 s71, s71, 114688
 s_add_u32 s71, s71, s77
 buffer_load_dwordx4 v[144:147], v7, s[8:11], s71 offen sc1
 s_cmp_lg_u32 s70, 0
 s_cbranch_scc1 L_vk5
 s_call_b64 s[36:37], L_rpoll
L_vk5:
 s_ff1_i32_b32 s71, s70
 s_bitset0_b32 s70, s71
 s_mul_i32 s71, s71, 114688
 s_add_u32 s71, s71, s77
 buffer_load_dwordx4 v[148:151], v7, s[8:11], s71 offen sc1
 s_cmp_lg_u32 s70, 0
 s_cbranch_scc1 L_vk6
 s_call_b64 s[36:37], L_rpoll
L_vk6:
 s_ff1_i32_b32 s71, s70
 s_bitset0_b32 s70, s71
 s_mul_i32 s71, s71, 114688
 s_add_u32 s71, s71, s77
 buffer_load_dwordx4 v[152:155], v7, s[8:11], s71 offen sc1
 s_cmp_lg_u32 s70, 0
 s_cbranch_scc1 L_vk7
 s_call_b64 s[36:37], L_rpoll
L_vk7:
 s_ff1_i32_b32 s71, s70
 s_bitset0_b32 s70, s71
 s_mul_i32 s71, s71, 114688
 s_add_u32 s71, s71, s77
 buffer_load_dwordx4 v[156:159], v7, s[8:11], s71 offen sc1
 s_cmp_lg_u32 s70, 0
 s_cbranch_scc1 L_vk8
 s_call_b64 s[36:37], L_rpoll
L_vk8:
 s_ff1_i32_b32 s71, s70
 s_bitset0_b32 s70, s71
 s_mul_i32 s71, s71, 114688
 s_add_u32 s71, s71, s77
 buffer_load_dwordx4 v[160:163], v7, s[8:11], s71 offen sc1
 s_cmp_lg_u32 s70, 0
 s_cbranch_scc1 L_vk9
 s_call_b64 s[36:37], L_rpoll
L_vk9:
 s_ff1_i32_b32 s71, s70
 s_bitset0_b32 s70, s71
 s_mul_i32 s71, s71, 114688
 s_add_u32 s71, s71, s77
 buffer_load_dwordx4 v[164:167], v7, s[8:11], s71 offen sc1
 s_cmp_lg_u32 s70, 0
 s_cbranch_scc1 L_vk10
 s_call_b64 s[36:37], L_rpoll
L_vk10:
 s_ff1_i32_b32 s71, s70
 s_bitset0_b32 s70, s71
 s_mul_i32 s71, s71, 114688
 s_add_u32 s71, s71, s77
 buffer_load_dwordx4 v[168:171], v7, s[8:11], s71 offen sc1
 s_cmp_lg_u32 s70, 0
 s_cbranch_scc1 L_vk11
 s_call_b64 s[36:37], L_rpoll
L_vk11:
 s_ff1_i32_b32 s71, s70
 s_bitset0_b32 s70, s71
 s_mul_i32 s71, s71, 114688
 s_add_u32 s71, s71, s77
 buffer_load_dwordx4 v[172:175], v7, s[8:11], s71 offen sc1
 s_cmp_lg_u32 s70, 0
 s_cbranch_scc1 L_vk12
 s_call_b64 s[36:37], L_rpoll
L_vk12:
 s_ff1_i32_b32 s71, s70
 s_bitset0_b32 s70, s71
 s_mul_i32 s71, s71, 114688
 s_add_u32 s71, s71, s77
 buffer_load_dwordx4 v[176:179], v7, s[8:11], s71 offen sc1
 s_cmp_lg_u32 s70, 0
 s_cbranch_scc1 L_vk13
 s_call_b64 s[36:37], L_rpoll
L_vk13:
 s_ff1_i32_b32 s71, s70
 s_bitset0_b32 s70, s71
 s_mul_i32 s71, s71, 114688
 s_add_u32 s71, s71, s77
 buffer_load_dwordx4 v[180:183], v7, s[8:11], s71 offen sc1
 s_cmp_lg_u32 s70, 0
 s_cbranch_scc1 L_vk14
 s_call_b64 s[36:37], L_rpoll
L_vk14:
 s_ff1_i32_b32 s71, s70
 s_bitset0_b32 s70, s71
 s_mul_i32 s71, s71, 114688
 s_add_u32 s71, s71, s77
 buffer_load_dwordx4 v[184:187], v7, s[8:11], s71 offen sc1
 s_cmp_lg_u32 s70, 0
 s_cbranch_scc1 L_vk15
 s_call_b64 s[36:37], L_rpoll
L_vk15:
 s_ff1_i32_b32 s71, s70
 s_bitset0_b32 s70, s71
 s_mul_i32 s71, s71, 114688
 s_add_u32 s71, s71, s77
 buffer_load_dwordx4 v[188:191], v7, s[8:11], s71 offen sc1
 s_waitcnt vmcnt(15)
 v_dot2c_f32_bf16 v48, v128, v24
 v_dot2c_f32_bf16 v49, v128, v25
 v_dot2c_f32_bf16 v50, v129, v24
 v_dot2c_f32_bf16 v51, v129, v25
 v_dot2c_f32_bf16 v52, v130, v24
 v_dot2c_f32_bf16 v53, v130, v25
 v_dot2c_f32_bf16 v54, v131, v24
 v_dot2c_f32_bf16 v55, v131, v25
 s_waitcnt vmcnt(14)
 v_dot2c_f32_bf16 v48, v132, v24
 v_dot2c_f32_bf16 v49, v132, v25
 v_dot2c_f32_bf16 v50, v133, v24
 v_dot2c_f32_bf16 v51, v133, v25
 v_dot2c_f32_bf16 v52, v134, v24
 v_dot2c_f32_bf16 v53, v134, v25
 v_dot2c_f32_bf16 v54, v135, v24
 v_dot2c_f32_bf16 v55, v135, v25
 s_waitcnt vmcnt(13)
 v_dot2c_f32_bf16 v48, v136, v24
 v_dot2c_f32_bf16 v49, v136, v25
 v_dot2c_f32_bf16 v50, v137, v24
 v_dot2c_f32_bf16 v51, v137, v25
 v_dot2c_f32_bf16 v52, v138, v24
 v_dot2c_f32_bf16 v53, v138, v25
 v_dot2c_f32_bf16 v54, v139, v24
 v_dot2c_f32_bf16 v55, v139, v25
 s_waitcnt vmcnt(12)
 v_dot2c_f32_bf16 v48, v140, v24
 v_dot2c_f32_bf16 v49, v140, v25
 v_dot2c_f32_bf16 v50, v141, v24
 v_dot2c_f32_bf16 v51, v141, v25
 v_dot2c_f32_bf16 v52, v142, v24
 v_dot2c_f32_bf16 v53, v142, v25
 v_dot2c_f32_bf16 v54, v143, v24
 v_dot2c_f32_bf16 v55, v143, v25
 s_waitcnt vmcnt(11)
 v_dot2c_f32_bf16 v48, v144, v24
 v_dot2c_f32_bf16 v49, v144, v25
 v_dot2c_f32_bf16 v50, v145, v24
 v_dot2c_f32_bf16 v51, v145, v25
 v_dot2c_f32_bf16 v52, v146, v24
 v_dot2c_f32_bf16 v53, v146, v25
 v_dot2c_f32_bf16 v54, v147, v24
 v_dot2c_f32_bf16 v55, v147, v25
 s_waitcnt vmcnt(10)
 v_dot2c_f32_bf16 v48, v148, v24
 v_dot2c_f32_bf16 v49, v148, v25
 v_dot2c_f32_bf16 v50, v149, v24
 v_dot2c_f32_bf16 v51, v149, v25
 v_dot2c_f32_bf16 v52, v150, v24
 v_dot2c_f32_bf16 v53, v150, v25
 v_dot2c_f32_bf16 v54, v151, v24
 v_dot2c_f32_bf16 v55, v151, v25
 s_waitcnt vmcnt(9)
 v_dot2c_f32_bf16 v48, v152, v24
 v_dot2c_f32_bf16 v49, v152, v25
 v_dot2c_f32_bf16 v50, v153, v24
 v_dot2c_f32_bf16 v51, v153, v25
 v_dot2c_f32_bf16 v52, v154, v24
 v_dot2c_f32_bf16 v53, v154, v25
 v_dot2c_f32_bf16 v54, v155, v24
 v_dot2c_f32_bf16 v55, v155, v25
 s_waitcnt vmcnt(8)
 v_dot2c_f32_bf16 v48, v156, v24
 v_dot2c_f32_bf16 v49, v156, v25
 v_dot2c_f32_bf16 v50, v157, v24
 v_dot2c_f32_bf16 v51, v157, v25
 v_dot2c_f32_bf16 v52, v158, v24
 v_dot2c_f32_bf16 v53, v158, v25
 v_dot2c_f32_bf16 v54, v159, v24
 v_dot2c_f32_bf16 v55, v159, v25
 s_waitcnt vmcnt(7)
 v_dot2c_f32_bf16 v48, v160, v24
 v_dot2c_f32_bf16 v49, v160, v25
 v_dot2c_f32_bf16 v50, v161, v24
 v_dot2c_f32_bf16 v51, v161, v25
 v_dot2c_f32_bf16 v52, v162, v24
 v_dot2c_f32_bf16 v53, v162, v25
 v_dot2c_f32_bf16 v54, v163, v24
 v_dot2c_f32_bf16 v55, v163, v25
 s_waitcnt vmcnt(6)
 v_dot2c_f32_bf16 v48, v164, v24
 v_dot2c_f32_bf16 v49, v164, v25
 v_dot2c_f32_bf16 v50, v165, v24
 v_dot2c_f32_bf16 v51, v165, v25
 v_dot2c_f32_bf16 v52, v166, v24
 v_dot2c_f32_bf16 v53, v166, v25
 v_dot2c_f32_bf16 v54, v167, v24
 v_dot2c_f32_bf16 v55, v167, v25
 s_waitcnt vmcnt(5)
 v_dot2c_f32_bf16 v48, v168, v24
 v_dot2c_f32_bf16 v49, v168, v25
 v_dot2c_f32_bf16 v50, v169, v24
 v_dot2c_f32_bf16 v51, v169, v25
 v_dot2c_f32_bf16 v52, v170, v24
 v_dot2c_f32_bf16 v53, v170, v25
 v_dot2c_f32_bf16 v54, v171, v24
 v_dot2c_f32_bf16 v55, v171, v25
 s_waitcnt vmcnt(4)
 v_dot2c_f32_bf16 v48, v172, v24
 v_dot2c_f32_bf16 v49, v172, v25
 v_dot2c_f32_bf16 v50, v173, v24
 v_dot2c_f32_bf16 v51, v173, v25
 v_dot2c_f32_bf16 v52, v174, v24
 v_dot2c_f32_bf16 v53, v174, v25
 v_dot2c_f32_bf16 v54, v175, v24
 v_dot2c_f32_bf16 v55, v175, v25
 s_waitcnt vmcnt(3)
 v_dot2c_f32_bf16 v48, v176, v24
 v_dot2c_f32_bf16 v49, v176, v25
 v_dot2c_f32_bf16 v50, v177, v24
 v_dot2c_f32_bf16 v51, v177, v25
 v_dot2c_f32_bf16 v52, v178, v24
 v_dot2c_f32_bf16 v53, v178, v25
 v_dot2c_f32_bf16 v54, v179, v24
 v_dot2c_f32_bf16 v55, v179, v25
 s_waitcnt vmcnt(2)
 v_dot2c_f32_bf16 v48, v180, v24
 v_dot2c_f32_bf16 v49, v180, v25
 v_dot2c_f32_bf16 v50, v181, v24
 v_dot2c_f32_bf16 v51, v181, v25
 v_dot2c_f32_bf16 v52, v182, v24
 v_dot2c_f32_bf16 v53, v182, v25
 v_dot2c_f32_bf16 v54, v183, v24
 v_dot2c_f32_bf16 v55, v183, v25
 s_waitcnt vmcnt(1)
 v_dot2c_f32_bf16 v48, v184, v24
 v_dot2c_f32_bf16 v49, v184, v25
 v_dot2c_f32_bf16 v50, v185, v24
 v_dot2c_f32_bf16 v51, v185, v25
 v_dot2c_f32_bf16 v52, v186, v24
 v_dot2c_f32_bf16 v53, v186, v25
 v_dot2c_f32_bf16 v54, v187, v24
 v_dot2c_f32_bf16 v55, v187, v25
 s_waitcnt vmcnt(0)
 v_dot2c_f32_bf16 v48, v188, v24
 v_dot2c_f32_bf16 v49, v188, v25
 v_dot2c_f32_bf16 v50, v189, v24
 v_dot2c_f32_bf16 v51, v189, v25
 v_dot2c_f32_bf16 v52, v190, v24
 v_dot2c_f32_bf16 v53, v190, v25
 v_dot2c_f32_bf16 v54, v191, v24
 v_dot2c_f32_bf16 v55, v191, v25
 s_nop 1
 v_fmac_f32 v32, v15, v48
 v_fmac_f32 v33, v15, v49
 v_fmac_f32 v34, v15, v50
 v_fmac_f32 v35, v15, v51
 v_fmac_f32 v36, v15, v52
 v_fmac_f32 v37, v15, v53
 v_fmac_f32 v38, v15, v54
 v_fmac_f32 v39, v15, v55
 v_cvt_pk_bf16_f32 v16, v32, v33
 v_cvt_pk_bf16_f32 v17, v34, v35
 v_cvt_pk_bf16_f32 v18, v36, v37
 v_cvt_pk_bf16_f32 v19, v38, v39
 buffer_store_dwordx4 v[16:19], v12, s[52:55], s86 offen sc1
L_vend:
 s_endpgm
L_p3k:
 s_mov_b32 s72, s32
 s_add_u32 s73, s72, 4096
 s_add_u32 s74, s72, 8192
 s_add_u32 s75, s72, 12288
 s_waitcnt vmcnt(8)
 v_cmp_ne_u32 vcc, 1, v5
 s_nop 0
 s_cbranch_vccnz L_fps1
L_fpr1:
M v[128:131], a[64:67], v[40:43], v[128:131]
 ds_read_b128 a[96:99], v2 offset:8192
 ds_read_b128 a[100:103], v2 offset:9216
M v[128:131], a[68:71], v[56:59], v[128:131]
 buffer_load_dwordx4 a[0:3], v7, s[8:11], s72 offen offset:0 sc1
M v[132:135], a[68:71], v[60:63], v[132:135]
 v_exp_f32 v18, v100
M v[132:135], a[64:67], v[44:47], v[132:135]
 ds_read_b128 a[104:107], v2 offset:10240
 ds_read_b128 a[108:111], v2 offset:11264
M v[136:139], a[72:75], v[40:43], v[136:139]
 buffer_load_dwordx4 a[4:7], v7, s[8:11], s72 offen offset:1024 sc1
M v[136:139], a[76:79], v[56:59], v[136:139]
 v_exp_f32 v19, v101
M v[140:143], a[76:79], v[60:63], v[140:143]
 ds_read_b128 a[112:115], v2 offset:12288
 ds_read_b128 a[116:119], v2 offset:13312
M v[140:143], a[72:75], v[44:47], v[140:143]
 buffer_load_dwordx4 a[8:11], v7, s[8:11], s72 offen offset:2048 sc1
M v[144:147], a[80:83], v[40:43], v[144:147]
 v_exp_f32 v20, v102
M v[144:147], a[84:87], v[56:59], v[144:147]
 ds_read_b128 a[120:123], v2 offset:14336
 ds_read_b128 a[124:127], v2 offset:15360
M v[148:151], a[84:87], v[60:63], v[148:151]
 v_exp_f32 v21, v103
M v[148:151], a[80:83], v[44:47], v[148:151]
 buffer_load_dwordx4 a[12:15], v7, s[8:11], s72 offen offset:3072 sc1
M v[152:155], a[88:91], v[40:43], v[152:155]
 v_add_f32 v30, v26, v30
 v_add_f32 v31, v27, v31
M v[152:155], a[92:95], v[56:59], v[152:155]
 v_add_f32 v29, v18, v19
 v_cvt_pk_bf16_f32 v52, v18, v19
M v[156:159], a[92:95], v[60:63], v[156:159]
 v_exp_f32 v22, v108
M v[156:159], a[88:91], v[44:47], v[156:159]
 s_waitcnt lgkmcnt(0)
 v_add_f32 v29, v20, v29
 v_cvt_pk_bf16_f32 v53, v20, v21
M v[160:163], a[96:99], v[40:43], v[160:163]
 ds_read_b128 a[64:67], v2 offset:16384
 ds_read_b128 a[68:71], v2 offset:17408
M v[160:163], a[100:103], v[56:59], v[160:163]
 buffer_load_dwordx4 a[16:19], v7, s[8:11], s73 offen offset:0 sc1
M v[164:167], a[100:103], v[60:63], v[164:167]
 v_exp_f32 v23, v109
M v[164:167], a[96:99], v[44:47], v[164:167]
 ds_read_b128 a[72:75], v2 offset:18432
 ds_read_b128 a[76:79], v2 offset:19456
M v[168:171], a[104:107], v[40:43], v[168:171]
 buffer_load_dwordx4 a[20:23], v7, s[8:11], s73 offen offset:1024 sc1
M v[168:171], a[108:111], v[56:59], v[168:171]
 v_exp_f32 v24, v110
M v[172:175], a[108:111], v[60:63], v[172:175]
 ds_read_b128 a[80:83], v2 offset:20480
 ds_read_b128 a[84:87], v2 offset:21504
M v[172:175], a[104:107], v[44:47], v[172:175]
 buffer_load_dwordx4 a[24:27], v7, s[8:11], s73 offen offset:2048 sc1
M v[176:179], a[112:115], v[40:43], v[176:179]
 v_exp_f32 v25, v111
M v[176:179], a[116:119], v[56:59], v[176:179]
 ds_read_b128 a[88:91], v2 offset:22528
 ds_read_b128 a[92:95], v2 offset:23552
M v[180:183], a[116:119], v[60:63], v[180:183]
 buffer_load_dwordx4 a[28:31], v7, s[8:11], s73 offen offset:3072 sc1
M v[180:183], a[112:115], v[44:47], v[180:183]
 v_add_f32 v29, v21, v29
 v_add_f32 v29, v22, v29
M v[184:187], a[120:123], v[40:43], v[184:187]
 v_exp_f32 v18, v116
M v[184:187], a[124:127], v[56:59], v[184:187]
 v_cvt_pk_bf16_f32 v54, v22, v23
 v_add_f32 v29, v23, v29
M v[188:191], a[124:127], v[60:63], v[188:191]
 buffer_load_dwordx4 a[32:35], v7, s[8:11], s74 offen offset:0 sc1
M v[188:191], a[120:123], v[44:47], v[188:191]
 s_waitcnt lgkmcnt(0)
 v_exp_f32 v19, v117
M v[192:195], a[64:67], v[40:43], v[192:195]
 ds_read_b128 a[96:99], v2 offset:24576
 ds_read_b128 a[100:103], v2 offset:25600
M v[192:195], a[68:71], v[56:59], v[192:195]
 buffer_load_dwordx4 a[36:39], v7, s[8:11], s74 offen offset:1024 sc1
M v[196:199], a[68:71], v[60:63], v[196:199]
 v_add_f32 v29, v24, v29
 v_cvt_pk_bf16_f32 v55, v24, v25
M v[196:199], a[64:67], v[44:47], v[196:199]
 ds_read_b128 a[104:107], v2 offset:26624
 ds_read_b128 a[108:111], v2 offset:27648
M v[200:203], a[72:75], v[40:43], v[200:203]
 v_exp_f32 v20, v118
M v[200:203], a[76:79], v[56:59], v[200:203]
 buffer_load_dwordx4 a[40:43], v7, s[8:11], s74 offen offset:2048 sc1
M v[204:207], a[76:79], v[60:63], v[204:207]
 ds_read_b128 a[112:115], v2 offset:28672
 ds_read_b128 a[116:119], v2 offset:29696
M v[204:207], a[72:75], v[44:47], v[204:207]
 v_exp_f32 v21, v119
M v[208:211], a[80:83], v[40:43], v[208:211]
 v_add_f32 v29, v25, v29
 v_add_f32 v29, v18, v29
M v[208:211], a[84:87], v[56:59], v[208:211]
 ds_read_b128 a[120:123], v2 offset:30720
 ds_read_b128 a[124:127], v2 offset:31744
M v[212:215], a[84:87], v[60:63], v[212:215]
 buffer_load_dwordx4 a[44:47], v7, s[8:11], s74 offen offset:3072 sc1
M v[212:215], a[80:83], v[44:47], v[212:215]
 v_exp_f32 v22, v124
M v[216:219], a[88:91], v[40:43], v[216:219]
 v_cvt_pk_bf16_f32 v48, v18, v19
 v_add_f32 v29, v19, v29
M v[216:219], a[92:95], v[56:59], v[216:219]
 buffer_load_dwordx4 a[48:51], v7, s[8:11], s75 offen offset:0 sc1
M v[220:223], a[92:95], v[60:63], v[220:223]
 s_waitcnt vmcnt(13) lgkmcnt(0)
 v_exp_f32 v23, v125
M v[220:223], a[88:91], v[44:47], v[220:223]
 s_barrier
M v[224:227], a[96:99], v[40:43], v[224:227]
 ds_read_b128 a[64:67], v7 offset:0
 ds_read_b128 a[68:71], v7 offset:1024
M v[224:227], a[100:103], v[56:59], v[224:227]
 buffer_load_dwordx4 a[52:55], v7, s[8:11], s75 offen offset:1024 sc1
M v[228:231], a[100:103], v[60:63], v[228:231]
 v_exp_f32 v24, v126
M v[228:231], a[96:99], v[44:47], v[228:231]
 ds_read_b128 a[72:75], v7 offset:2048
 ds_read_b128 a[76:79], v7 offset:3072
M v[232:235], a[104:107], v[40:43], v[232:235]
 buffer_load_dwordx4 a[56:59], v7, s[8:11], s75 offen offset:2048 sc1
M v[232:235], a[108:111], v[56:59], v[232:235]
 v_exp_f32 v25, v127
M v[236:239], a[108:111], v[60:63], v[236:239]
 ds_read_b128 a[80:83], v7 offset:4096
 ds_read_b128 a[84:87], v7 offset:5120
M v[236:239], a[104:107], v[44:47], v[236:239]
 v_add_f32 v29, v20, v29
 v_cvt_pk_bf16_f32 v49, v20, v21
M v[240:243], a[112:115], v[40:43], v[240:243]
 buffer_load_dwordx4 a[60:63], v7, s[8:11], s75 offen offset:3072 sc1
M v[240:243], a[116:119], v[56:59], v[240:243]
 ds_read_b128 a[88:91], v7 offset:6144
 ds_read_b128 a[92:95], v7 offset:7168
M v[244:247], a[116:119], v[60:63], v[244:247]
 v_add_f32 v29, v21, v29
 v_add_f32 v29, v22, v29
M v[244:247], a[112:115], v[44:47], v[244:247]
 v_cvt_pk_bf16_f32 v50, v22, v23
 v_add_f32 v29, v23, v29
M v[248:251], a[120:123], v[40:43], v[248:251]
 v_add_f32 v29, v24, v29
 v_cvt_pk_bf16_f32 v51, v24, v25
M v[248:251], a[124:127], v[56:59], v[248:251]
 v_add_f32 v29, v25, v29
M v[252:255], a[124:127], v[60:63], v[252:255]
 s_waitcnt lgkmcnt(0)
M v[252:255], a[120:123], v[44:47], v[252:255]
 v_cmp_lt_f32 vcc, s31, v29
 s_nop 0
 s_cbranch_vccnz L_st7
L_rt7:
M v[132:135], a[64:67], v[52:55], v[132:135]
 ds_read_b128 a[96:99], v7 offset:8192
 ds_read_b128 a[100:103], v7 offset:9216
M v[132:135], a[68:71], v[48:51], v[132:135]
 ds_read_b128 a[104:107], v7 offset:10240
 v_add_f32 v31, v29, v31
M v[140:143], a[76:79], v[48:51], v[140:143]
 s_sub_u32 s27, 5, s42
 ds_read_b128 a[108:111], v7 offset:11264
 ds_read_b128 a[112:115], v7 offset:12288
M v[140:143], a[72:75], v[52:55], v[140:143]
 s_mov_b32 s40, 0
 ds_read_b128 a[116:119], v7 offset:13312
 v_mov_b32 v10, v30
M v[148:151], a[80:83], v[52:55], v[148:151]
 s_add_u32 m0, s28, 32768
 ds_read_b128 a[120:123], v7 offset:14336
 ds_read_b128 a[124:127], v7 offset:15360
M v[148:151], a[84:87], v[48:51], v[148:151]
 buffer_load_dwordx4 v3, s[8:11], s21 offen offset:0 sc1 lds
M v[156:159], a[92:95], v[48:51], v[156:159]
 ds_read_b128 a[128:131], v7 offset:16384
 ds_read_b128 a[132:135], v7 offset:17408
M v[156:159], a[88:91], v[52:55], v[156:159]
 s_waitcnt lgkmcnt(2)
 ds_read_b128 a[136:139], v7 offset:18432
 v_mov_b32 v11, v31
M v[164:167], a[96:99], v[52:55], v[164:167]
 ds_read_b128 a[140:143], v7 offset:19456
 ds_read_b128 a[144:147], v7 offset:20480
M v[164:167], a[100:103], v[48:51], v[164:167]
 buffer_load_dwordx4 v3, s[8:11], s21 offen offset:1024 sc1 lds
M v[172:175], a[108:111], v[48:51], v[172:175]
 ds_read_b128 a[148:151], v7 offset:21504
 ds_read_b128 a[152:155], v7 offset:22528
M v[172:175], a[104:107], v[52:55], v[172:175]
 ds_read_b128 a[156:159], v7 offset:23552
 v_permlane16_swap_b32 v10, v30
M v[180:183], a[112:115], v[52:55], v[180:183]
 ds_read_b128 a[160:163], v7 offset:24576
 ds_read_b128 a[164:167], v7 offset:25600
M v[180:183], a[116:119], v[48:51], v[180:183]
 buffer_load_dwordx4 v3, s[8:11], s21 offen offset:2048 sc1 lds
M v[188:191], a[124:127], v[48:51], v[188:191]
 ds_read_b128 a[168:171], v7 offset:26624
 ds_read_b128 a[172:175], v7 offset:27648
M v[188:191], a[120:123], v[52:55], v[188:191]
 s_waitcnt lgkmcnt(4)
 ds_read_b128 a[176:179], v7 offset:28672
 v_permlane16_swap_b32 v11, v31
M v[196:199], a[128:131], v[52:55], v[196:199]
 ds_read_b128 a[180:183], v7 offset:29696
 ds_read_b128 a[184:187], v7 offset:30720
M v[196:199], a[132:135], v[48:51], v[196:199]
 ds_read_b128 a[188:191], v7 offset:31744
 v_add_f32 v30, v10, v30
M v[204:207], a[140:143], v[48:51], v[204:207]
 buffer_load_dwordx4 v3, s[8:11], s21 offen offset:3072 sc1 lds
M v[204:207], a[136:139], v[52:55], v[204:207]
 s_add_u32 m0, s28, 36864
 v_add_f32 v31, v11, v31
 v_mov_b32 v10, v30
M v[212:215], a[144:147], v[52:55], v[212:215]
 buffer_load_dwordx4 v4, s[8:11], s21 offen offset:0 sc1 lds
M v[212:215], a[148:151], v[48:51], v[212:215]
 s_waitcnt lgkmcnt(0)
 v_mov_b32 v11, v31
 v_permlane32_swap_b32 v10, v30
M v[220:223], a[156:159], v[48:51], v[220:223]
 s_barrier
M v[220:223], a[152:155], v[52:55], v[220:223]
 ds_read_b128 a[64:67], v2 offset:32768
 ds_read_b128 a[68:71], v2 offset:33792
M v[228:231], a[160:163], v[52:55], v[228:231]
 ds_read_b128 a[72:75], v2 offset:34816
 v_permlane32_swap_b32 v11, v31
M v[228:231], a[164:167], v[48:51], v[228:231]
 ds_read_b128 a[76:79], v2 offset:35840
 ds_read_b128 a[80:83], v2 offset:36864
M v[236:239], a[172:175], v[48:51], v[236:239]
 ds_read_b128 a[84:87], v2 offset:37888
 v_add_f32 v30, v10, v30
M v[236:239], a[168:171], v[52:55], v[236:239]
 ds_read_b128 a[88:91], v2 offset:38912
 ds_read_b128 a[92:95], v2 offset:39936
M v[244:247], a[176:179], v[52:55], v[244:247]
 buffer_load_dwordx4 v4, s[8:11], s21 offen offset:1024 sc1 lds
M v[244:247], a[180:183], v[48:51], v[244:247]
 buffer_load_dwordx4 v4, s[8:11], s21 offen offset:2048 sc1 lds
M v[252:255], a[188:191], v[48:51], v[252:255]
 buffer_load_dwordx4 v4, s[8:11], s21 offen offset:3072 sc1 lds
M v[252:255], a[184:187], v[52:55], v[252:255]
 s_waitcnt lgkmcnt(0)
 s_add_u32 s24, s23, 16777216
 s_mov_b32 s23, s21
 s_add_u32 s21, s21, 32768
 s_add_u32 s22, s22, 1
 s_cmp_eq_u32 s22, s25
 s_cselect_b32 s21, s26, s21
 s_cmp_eq_u32 s22, s43
 s_cselect_b32 s21, s4, s21
 s_cmp_eq_u32 s22, s6
 s_cselect_b32 s21, s7, s21
 v_add_f32 v31, v11, v31
 v_rcp_f32 v5, v30
 v_rcp_f32 v6, v31
 v_accvgpr_write_b32 a192, v5
 v_accvgpr_write_b32 a193, v6
 v_mov_b32 v30, 0
 v_mov_b32 v31, 0
 v_mov_b32 v32, 0xc1800000
 v_mov_b32 v33, 0xc1800000
 v_mov_b32 v34, 0xc1800000
 v_mov_b32 v35, 0xc1800000
 v_mov_b32 v36, 0xc1800000
 v_mov_b32 v37, 0xc1800000
 v_mov_b32 v38, 0xc1800000
 v_mov_b32 v39, 0xc1800000
 s_waitcnt vmcnt(8)
M v[64:67], a[64:67], a[0:3], v[32:35]
 ds_read_b128 a[96:99], v2 offset:40960
 v_cvt_pk_bf16_f32 v128, v128, v129
M v[64:67], a[68:71], a[4:7], v[64:67]
 ds_read_b128 a[100:103], v2 offset:41984
 v_cvt_pk_bf16_f32 v129, v130, v131
M v[64:67], a[72:75], a[8:11], v[64:67]
 buffer_load_dword v6, v9, s[8:11], s46 offen sc1
M v[64:67], a[76:79], a[12:15], v[64:67]
 ds_read_b128 a[104:107], v2 offset:43008
 v_cvt_pk_bf16_f32 v130, v136, v137
M v[64:67], a[80:83], a[16:19], v[64:67]
 s_add_u32 m0, s28, 65536
 ds_read_b128 a[108:111], v2 offset:44032
 v_cvt_pk_bf16_f32 v131, v138, v139
M v[64:67], a[84:87], a[20:23], v[64:67]
 buffer_load_dwordx4 v3, s[8:11], s24 offen offset:0 sc1 lds
M v[64:67], a[88:91], a[24:27], v[64:67]
 ds_read_b128 a[112:115], v2 offset:45056
 v_accvgpr_write_b32 a128, v128
M v[64:67], a[92:95], a[28:31], v[64:67]
 ds_read_b128 a[116:119], v2 offset:46080
 v_accvgpr_write_b32 a129, v129
M v[68:71], a[92:95], a[60:63], v[36:39]
 buffer_load_dwordx4 v3, s[8:11], s24 offen offset:1024 sc1 lds
M v[68:71], a[88:91], a[56:59], v[68:71]
 ds_read_b128 a[120:123], v2 offset:47104
 v_accvgpr_write_b32 a130, v130
M v[68:71], a[84:87], a[52:55], v[68:71]
 ds_read_b128 a[124:127], v2 offset:48128
 v_accvgpr_write_b32 a131, v131
M v[68:71], a[80:83], a[48:51], v[68:71]
 v_exp_f32 v18, v64
M v[68:71], a[76:79], a[44:47], v[68:71]
 v_exp_f32 v19, v65
M v[68:71], a[72:75], a[40:43], v[68:71]
 buffer_load_dwordx4 v3, s[8:11], s24 offen offset:2048 sc1 lds
M v[68:71], a[68:71], a[36:39], v[68:71]
 v_exp_f32 v20, v66
M v[68:71], a[64:67], a[32:35], v[68:71]
 s_waitcnt lgkmcnt(0)
 v_exp_f32 v21, v67
M v[72:75], a[96:99], a[0:3], v[32:35]
 ds_read_b128 a[64:67], v2 offset:49152
 v_add_f32 v26, v18, v19
M v[72:75], a[100:103], a[4:7], v[72:75]
 ds_read_b128 a[68:71], v2 offset:50176
 v_cvt_pk_bf16_f32 v40, v18, v19
M v[72:75], a[104:107], a[8:11], v[72:75]
 buffer_load_dwordx4 v3, s[8:11], s24 offen offset:3072 sc1 lds
M v[72:75], a[108:111], a[12:15], v[72:75]
 ds_read_b128 a[72:75], v2 offset:51200
 v_add_f32 v26, v20, v26
M v[72:75], a[112:115], a[16:19], v[72:75]
 ds_read_b128 a[76:79], v2 offset:52224
 v_cvt_pk_bf16_f32 v41, v20, v21
M v[72:75], a[116:119], a[20:23], v[72:75]
 v_exp_f32 v22, v68
M v[72:75], a[120:123], a[24:27], v[72:75]
 ds_read_b128 a[80:83], v2 offset:53248
 v_add_f32 v26, v21, v26
M v[72:75], a[124:127], a[28:31], v[72:75]
 s_add_u32 m0, s28, 69632
 ds_read_b128 a[84:87], v2 offset:54272
 v_cvt_pk_bf16_f32 v132, v132, v133
M v[76:79], a[124:127], a[60:63], v[36:39]
 buffer_load_dwordx4 v4, s[8:11], s24 offen offset:0 sc1 lds
M v[76:79], a[120:123], a[56:59], v[76:79]
 ds_read_b128 a[88:91], v2 offset:55296
 v_cvt_pk_bf16_f32 v133, v134, v135
M v[76:79], a[116:119], a[52:55], v[76:79]
 ds_read_b128 a[92:95], v2 offset:56320
 v_cvt_pk_bf16_f32 v134, v140, v141
M v[76:79], a[112:115], a[48:51], v[76:79]
 v_exp_f32 v23, v69
M v[76:79], a[108:111], a[44:47], v[76:79]
 buffer_load_dwordx4 v4, s[8:11], s24 offen offset:1024 sc1 lds
M v[76:79], a[104:107], a[40:43], v[76:79]
 v_exp_f32 v24, v70
M v[76:79], a[100:103], a[36:39], v[76:79]
 v_exp_f32 v25, v71
M v[76:79], a[96:99], a[32:35], v[76:79]
 s_waitcnt lgkmcnt(0)
 v_exp_f32 v18, v72
M v[80:83], a[64:67], a[0:3], v[32:35]
 ds_read_b128 a[96:99], v2 offset:57344
 v_add_f32 v27, v22, v23
M v[80:83], a[68:71], a[4:7], v[80:83]
 ds_read_b128 a[100:103], v2 offset:58368
 v_cvt_pk_bf16_f32 v44, v22, v23
M v[80:83], a[72:75], a[8:11], v[80:83]
 buffer_load_dwordx4 v4, s[8:11], s24 offen offset:2048 sc1 lds
M v[80:83], a[76:79], a[12:15], v[80:83]
 ds_read_b128 a[104:107], v2 offset:59392
 v_add_f32 v27, v24, v27
M v[80:83], a[80:83], a[16:19], v[80:83]
 ds_read_b128 a[108:111], v2 offset:60416
 v_cvt_pk_bf16_f32 v45, v24, v25
M v[80:83], a[84:87], a[20:23], v[80:83]
 v_exp_f32 v19, v73
M v[80:83], a[88:91], a[24:27], v[80:83]
 ds_read_b128 a[112:115], v2 offset:61440
 v_add_f32 v27, v25, v27
M v[80:83], a[92:95], a[28:31], v[80:83]
 ds_read_b128 a[116:119], v2 offset:62464
 v_add_f32 v26, v18, v26
M v[84:87], a[92:95], a[60:63], v[36:39]
 s_waitcnt vmcnt(7)
 v_cmp_gt_u32 vcc, 3, v6
 v_cvt_pk_bf16_f32 v42, v18, v19
M v[84:87], a[88:91], a[56:59], v[84:87]
 ds_read_b128 a[120:123], v2 offset:63488
 v_add_f32 v26, v19, v26
M v[84:87], a[84:87], a[52:55], v[84:87]
 ds_read_b128 a[124:127], v2 offset:64512
 v_cvt_pk_bf16_f32 v135, v142, v143
M v[84:87], a[80:83], a[48:51], v[84:87]
 s_cbranch_vccnz L_f2s
L_f2r:
 v_exp_f32 v20, v74
M v[84:87], a[76:79], a[44:47], v[84:87]
 buffer_load_dwordx4 v4, s[8:11], s24 offen offset:3072 sc1 lds
M v[84:87], a[72:75], a[40:43], v[84:87]
 v_exp_f32 v21, v75
M v[84:87], a[68:71], a[36:39], v[84:87]
 s_waitcnt lgkmcnt(0)
 v_exp_f32 v22, v76
M v[84:87], a[64:67], a[32:35], v[84:87]
 s_barrier
M v[88:91], a[96:99], a[0:3], v[32:35]
 ds_read_b128 a[64:67], v7 offset:32768
 v_add_f32 v26, v20, v26
M v[88:91], a[100:103], a[4:7], v[88:91]
 ds_read_b128 a[68:71], v7 offset:33792
 v_cvt_pk_bf16_f32 v43, v20, v21
M v[88:91], a[104:107], a[8:11], v[88:91]
 v_exp_f32 v23, v77
M v[88:91], a[108:111], a[12:15], v[88:91]
 ds_read_b128 a[72:75], v7 offset:34816
 v_add_f32 v26, v21, v26
M v[88:91], a[112:115], a[16:19], v[88:91]
 ds_read_b128 a[76:79], v7 offset:35840
 v_add_f32 v27, v22, v27
M v[88:91], a[116:119], a[20:23], v[88:91]
 v_exp_f32 v24, v78
M v[88:91], a[120:123], a[24:27], v[88:91]
 ds_read_b128 a[80:83], v7 offset:36864
 v_cvt_pk_bf16_f32 v46, v22, v23
M v[88:91], a[124:127], a[28:31], v[88:91]
 ds_read_b128 a[84:87], v7 offset:37888
 v_add_f32 v27, v23, v27
M v[92:95], a[124:127], a[60:63], v[36:39]
 v_exp_f32 v25, v79
M v[92:95], a[120:123], a[56:59], v[92:95]
 ds_read_b128 a[88:91], v7 offset:38912
 v_add_f32 v27, v24, v27
M v[92:95], a[116:119], a[52:55], v[92:95]
 ds_read_b128 a[92:95], v7 offset:39936
 v_cvt_pk_bf16_f32 v47, v24, v25
M v[92:95], a[112:115], a[48:51], v[92:95]
 v_add_f32 v27, v25, v27
 v_accvgpr_write_b32 a160, v132
M v[92:95], a[108:111], a[44:47], v[92:95]
 v_accvgpr_write_b32 a161, v133
 v_accvgpr_write_b32 a162, v134
M v[92:95], a[104:107], a[40:43], v[92:95]
 v_accvgpr_write_b32 a163, v135
 v_cvt_pk_bf16_f32 v144, v144, v145
M v[92:95], a[100:103], a[36:39], v[92:95]
 s_waitcnt lgkmcnt(0)
 v_cvt_pk_bf16_f32 v145, v146, v147
 v_cvt_pk_bf16_f32 v146, v152, v153
M v[92:95], a[96:99], a[32:35], v[92:95]
 v_cvt_pk_bf16_f32 v147, v154, v155
 v_accvgpr_write_b32 a132, v144
M v[96:99], a[64:67], a[0:3], v[32:35]
 s_add_u32 m0, s28, 98304
 ds_read_b128 a[96:99], v7 offset:40960
 v_accvgpr_write_b32 a133, v145
M v[96:99], a[68:71], a[4:7], v[96:99]
 ds_read_b128 a[100:103], v7 offset:41984
 v_accvgpr_write_b32 a134, v146
M v[96:99], a[72:75], a[8:11], v[96:99]
 buffer_load_dwordx4 v3, s[8:11], s21 offen offset:0 sc1 lds
M v[96:99], a[76:79], a[12:15], v[96:99]
 ds_read_b128 a[104:107], v7 offset:43008
 v_accvgpr_write_b32 a135, v147
M v[96:99], a[80:83], a[16:19], v[96:99]
 ds_read_b128 a[108:111], v7 offset:44032
 v_cvt_pk_bf16_f32 v148, v148, v149
M v[96:99], a[84:87], a[20:23], v[96:99]
 buffer_load_dwordx4 v3, s[8:11], s21 offen offset:1024 sc1 lds
M v[96:99], a[88:91], a[24:27], v[96:99]
 ds_read_b128 a[112:115], v7 offset:45056
 v_cvt_pk_bf16_f32 v149, v150, v151
M v[96:99], a[92:95], a[28:31], v[96:99]
 ds_read_b128 a[116:119], v7 offset:46080
 v_cvt_pk_bf16_f32 v150, v156, v157
M v[100:103], a[92:95], a[60:63], v[36:39]
 v_exp_f32 v18, v80
M v[100:103], a[88:91], a[56:59], v[100:103]
 ds_read_b128 a[120:123], v7 offset:47104
 v_cvt_pk_bf16_f32 v151, v158, v159
M v[100:103], a[84:87], a[52:55], v[100:103]
 ds_read_b128 a[124:127], v7 offset:48128
 v_accvgpr_write_b32 a164, v148
M v[100:103], a[80:83], a[48:51], v[100:103]
 buffer_load_dwordx4 v3, s[8:11], s21 offen offset:2048 sc1 lds
M v[100:103], a[76:79], a[44:47], v[100:103]
 v_exp_f32 v19, v81
M v[100:103], a[72:75], a[40:43], v[100:103]
 v_exp_f32 v20, v82
M v[100:103], a[68:71], a[36:39], v[100:103]
 v_exp_f32 v21, v83
M v[100:103], a[64:67], a[32:35], v[100:103]
 s_waitcnt lgkmcnt(0)
 v_exp_f32 v22, v88
M v[104:107], a[96:99], a[0:3], v[32:35]
 ds_read_b128 a[64:67], v7 offset:49152
 v_add_f32 v26, v18, v26
M v[104:107], a[100:103], a[4:7], v[104:107]
 ds_read_b128 a[68:71], v7 offset:50176
 v_cvt_pk_bf16_f32 v56, v18, v19
M v[104:107], a[104:107], a[8:11], v[104:107]
 buffer_load_dwordx4 v3, s[8:11], s21 offen offset:3072 sc1 lds
M v[104:107], a[108:111], a[12:15], v[104:107]
 s_add_u32 m0, s28, 102400
 ds_read_b128 a[72:75], v7 offset:51200
 v_add_f32 v26, v19, v26
M v[104:107], a[112:115], a[16:19], v[104:107]
 ds_read_b128 a[76:79], v7 offset:52224
 v_add_f32 v26, v20, v26
M v[104:107], a[116:119], a[20:23], v[104:107]
 buffer_load_dwordx4 v4, s[8:11], s21 offen offset:0 sc1 lds
M v[104:107], a[120:123], a[24:27], v[104:107]
 ds_read_b128 a[80:83], v7 offset:53248
 v_cvt_pk_bf16_f32 v57, v20, v21
M v[104:107], a[124:127], a[28:31], v[104:107]
 ds_read_b128 a[84:87], v7 offset:54272
 v_add_f32 v26, v21, v26
M v[108:111], a[124:127], a[60:63], v[36:39]
 v_exp_f32 v23, v89
M v[108:111], a[120:123], a[56:59], v[108:111]
 ds_read_b128 a[88:91], v7 offset:55296
 v_add_f32 v26, v22, v26
M v[108:111], a[116:119], a[52:55], v[108:111]
 ds_read_b128 a[92:95], v7 offset:56320
 v_cvt_pk_bf16_f32 v58, v22, v23
M v[108:111], a[112:115], a[48:51], v[108:111]
 buffer_load_dwordx4 v4, s[8:11], s21 offen offset:1024 sc1 lds
M v[108:111], a[108:111], a[44:47], v[108:111]
 v_exp_f32 v24, v90
M v[108:111], a[104:107], a[40:43], v[108:111]
 v_exp_f32 v25, v91
M v[108:111], a[100:103], a[36:39], v[108:111]
 buffer_load_dwordx4 v4, s[8:11], s21 offen offset:2048 sc1 lds
M v[108:111], a[96:99], a[32:35], v[108:111]
 s_waitcnt lgkmcnt(0)
 v_exp_f32 v18, v84
M v[112:115], a[64:67], a[0:3], v[32:35]
 ds_read_b128 a[96:99], v7 offset:57344
 v_add_f32 v26, v23, v26
M v[112:115], a[68:71], a[4:7], v[112:115]
 ds_read_b128 a[100:103], v7 offset:58368
 v_add_f32 v26, v24, v26
M v[112:115], a[72:75], a[8:11], v[112:115]
 v_exp_f32 v19, v85
M v[112:115], a[76:79], a[12:15], v[112:115]
 ds_read_b128 a[104:107], v7 offset:59392
 v_cvt_pk_bf16_f32 v59, v24, v25
M v[112:115], a[80:83], a[16:19], v[112:115]
 ds_read_b128 a[108:111], v7 offset:60416
 v_add_f32 v26, v25, v26
M v[112:115], a[84:87], a[20:23], v[112:115]
 buffer_load_dwordx4 v4, s[8:11], s21 offen offset:3072 sc1 lds
M v[112:115], a[88:91], a[24:27], v[112:115]
 s_add_u32 s24, s23, 16777216
 ds_read_b128 a[112:115], v7 offset:61440
 v_add_f32 v27, v18, v27
M v[112:115], a[92:95], a[28:31], v[112:115]
 s_mov_b32 s23, s21
 ds_read_b128 a[116:119], v7 offset:62464
 v_cvt_pk_bf16_f32 v60, v18, v19
M v[116:119], a[92:95], a[60:63], v[36:39]
 s_add_u32 s21, s21, 32768
 v_exp_f32 v20, v86
M v[116:119], a[88:91], a[56:59], v[116:119]
 s_add_u32 s22, s22, 1
 ds_read_b128 a[120:123], v7 offset:63488
 v_add_f32 v27, v19, v27
M v[116:119], a[84:87], a[52:55], v[116:119]
 s_cmp_eq_u32 s22, s25
 ds_read_b128 a[124:127], v7 offset:64512
 v_accvgpr_write_b32 a165, v149
M v[116:119], a[80:83], a[48:51], v[116:119]
 s_cselect_b32 s21, s26, s21
 v_exp_f32 v21, v87
M v[116:119], a[76:79], a[44:47], v[116:119]
 s_cmp_eq_u32 s22, s43
 v_exp_f32 v22, v92
M v[116:119], a[72:75], a[40:43], v[116:119]
 s_cselect_b32 s21, s4, s21
 v_exp_f32 v23, v93
M v[116:119], a[68:71], a[36:39], v[116:119]
 s_waitcnt vmcnt(8) lgkmcnt(0)
 v_add_f32 v27, v20, v27
 v_cvt_pk_bf16_f32 v61, v20, v21
M v[116:119], a[64:67], a[32:35], v[116:119]
 s_barrier
M v[120:123], a[96:99], a[0:3], v[32:35]
 s_cmp_eq_u32 s22, s6
 ds_read_b128 a[64:67], v2 offset:0
 v_add_f32 v27, v21, v27
M v[120:123], a[100:103], a[4:7], v[120:123]
 s_cselect_b32 s21, s7, s21
 ds_read_b128 a[68:71], v2 offset:1024
 v_add_f32 v27, v22, v27
M v[120:123], a[104:107], a[8:11], v[120:123]
 v_exp_f32 v24, v94
M v[120:123], a[108:111], a[12:15], v[120:123]
 ds_read_b128 a[72:75], v2 offset:2048
 v_cvt_pk_bf16_f32 v62, v22, v23
M v[120:123], a[112:115], a[16:19], v[120:123]
 ds_read_b128 a[76:79], v2 offset:3072
 v_add_f32 v27, v23, v27
M v[120:123], a[116:119], a[20:23], v[120:123]
 v_exp_f32 v25, v95
M v[120:123], a[120:123], a[24:27], v[120:123]
 ds_read_b128 a[80:83], v2 offset:4096
 v_add_f32 v27, v24, v27
M v[120:123], a[124:127], a[28:31], v[120:123]
 ds_read_b128 a[84:87], v2 offset:5120
 v_cvt_pk_bf16_f32 v63, v24, v25
M v[124:127], a[124:127], a[60:63], v[36:39]
 v_add_f32 v27, v25, v27
 v_accvgpr_write_b32 a166, v150
M v[124:127], a[120:123], a[56:59], v[124:127]
 ds_read_b128 a[88:91], v2 offset:6144
 v_max_f32 v10, v26, v27
M v[124:127], a[116:119], a[52:55], v[124:127]
 ds_read_b128 a[92:95], v2 offset:7168
 v_min_f32 v11, v26, v27
M v[124:127], a[112:115], a[48:51], v[124:127]
 v_cmp_lt_f32 s[36:37], s31, v10
 v_accvgpr_write_b32 a167, v151
M v[124:127], a[108:111], a[44:47], v[124:127]
 v_cmp_gt_f32 vcc, s55, v11
 v_cvt_pk_bf16_f32 v160, v160, v161
M v[124:127], a[104:107], a[40:43], v[124:127]
 v_cvt_pk_bf16_f32 v161, v162, v163
 v_cvt_pk_bf16_f32 v162, v168, v169
M v[124:127], a[100:103], a[36:39], v[124:127]
 s_waitcnt lgkmcnt(0)
 s_or_b64 vcc, vcc, s[36:37]
M v[124:127], a[96:99], a[32:35], v[124:127]
 s_cbranch_vccnz L_st11
L_rt11:
 v_cvt_pk_bf16_f32 v163, v170, v171
 v_accvgpr_write_b32 a136, v160
 v_accvgpr_write_b32 a137, v161
 v_accvgpr_write_b32 a138, v162
 v_accvgpr_write_b32 a139, v163
 v_cvt_pk_bf16_f32 v164, v164, v165
 v_cvt_pk_bf16_f32 v165, v166, v167
 v_cvt_pk_bf16_f32 v166, v172, v173
 v_cvt_pk_bf16_f32 v167, v174, v175
 v_accvgpr_write_b32 a168, v164
 v_accvgpr_write_b32 a169, v165
 v_accvgpr_write_b32 a170, v166
 v_accvgpr_write_b32 a171, v167
 v_cvt_pk_bf16_f32 v176, v176, v177
 v_cvt_pk_bf16_f32 v177, v178, v179
 v_cvt_pk_bf16_f32 v178, v184, v185
 v_cvt_pk_bf16_f32 v179, v186, v187
 v_accvgpr_write_b32 a140, v176
 v_accvgpr_write_b32 a141, v177
 v_accvgpr_write_b32 a142, v178
 v_accvgpr_write_b32 a143, v179
 v_cvt_pk_bf16_f32 v180, v180, v181
 v_cvt_pk_bf16_f32 v181, v182, v183
 v_cvt_pk_bf16_f32 v182, v188, v189
 v_cvt_pk_bf16_f32 v183, v190, v191
 v_accvgpr_write_b32 a172, v180
 v_accvgpr_write_b32 a173, v181
 v_accvgpr_write_b32 a174, v182
 v_accvgpr_write_b32 a175, v183
 v_cvt_pk_bf16_f32 v192, v192, v193
 v_cvt_pk_bf16_f32 v193, v194, v195
 v_cvt_pk_bf16_f32 v194, v200, v201
 v_cvt_pk_bf16_f32 v195, v202, v203
 v_accvgpr_write_b32 a144, v192
 v_accvgpr_write_b32 a145, v193
 v_accvgpr_write_b32 a146, v194
 v_accvgpr_write_b32 a147, v195
 v_cvt_pk_bf16_f32 v196, v196, v197
 v_cvt_pk_bf16_f32 v197, v198, v199
 v_cvt_pk_bf16_f32 v198, v204, v205
 v_cvt_pk_bf16_f32 v199, v206, v207
 v_accvgpr_write_b32 a176, v196
 v_accvgpr_write_b32 a177, v197
 v_accvgpr_write_b32 a178, v198
 v_accvgpr_write_b32 a179, v199
 v_cvt_pk_bf16_f32 v208, v208, v209
 v_cvt_pk_bf16_f32 v209, v210, v211
 v_cvt_pk_bf16_f32 v210, v216, v217
 v_cvt_pk_bf16_f32 v211, v218, v219
 v_accvgpr_write_b32 a148, v208
 v_accvgpr_write_b32 a149, v209
 v_accvgpr_write_b32 a150, v210
 v_accvgpr_write_b32 a151, v211
 v_cvt_pk_bf16_f32 v212, v212, v213
 v_cvt_pk_bf16_f32 v213, v214, v215
 v_cvt_pk_bf16_f32 v214, v220, v221
 v_cvt_pk_bf16_f32 v215, v222, v223
 v_accvgpr_write_b32 a180, v212
 v_accvgpr_write_b32 a181, v213
 v_accvgpr_write_b32 a182, v214
 v_accvgpr_write_b32 a183, v215
 v_cvt_pk_bf16_f32 v224, v224, v225
 v_cvt_pk_bf16_f32 v225, v226, v227
 v_cvt_pk_bf16_f32 v226, v232, v233
 v_cvt_pk_bf16_f32 v227, v234, v235
 v_accvgpr_write_b32 a152, v224
 v_accvgpr_write_b32 a153, v225
 v_accvgpr_write_b32 a154, v226
 v_accvgpr_write_b32 a155, v227
 v_cvt_pk_bf16_f32 v228, v228, v229
 v_cvt_pk_bf16_f32 v229, v230, v231
 v_cvt_pk_bf16_f32 v230, v236, v237
 v_cvt_pk_bf16_f32 v231, v238, v239
 v_accvgpr_write_b32 a184, v228
 v_accvgpr_write_b32 a185, v229
 v_accvgpr_write_b32 a186, v230
 v_accvgpr_write_b32 a187, v231
M v[128:131], a[64:67], v[40:43], 0
 s_add_u32 m0, s28, 0
 ds_read_b128 a[96:99], v2 offset:8192
 ds_read_b128 a[100:103], v2 offset:9216
M v[128:131], a[68:71], v[56:59], v[128:131]
 buffer_load_dwordx4 v3, s[8:11], s24 offen offset:0 sc1 lds
M v[132:135], a[68:71], v[60:63], 0
 v_cvt_pk_bf16_f32 v240, v240, v241
 v_cvt_pk_bf16_f32 v241, v242, v243
M v[132:135], a[64:67], v[44:47], v[132:135]
 ds_read_b128 a[104:107], v2 offset:10240
 ds_read_b128 a[108:111], v2 offset:11264
M v[136:139], a[72:75], v[40:43], 0
 buffer_load_dwordx4 v3, s[8:11], s24 offen offset:1024 sc1 lds
M v[136:139], a[76:79], v[56:59], v[136:139]
 v_cvt_pk_bf16_f32 v242, v248, v249
 v_cvt_pk_bf16_f32 v243, v250, v251
M v[140:143], a[76:79], v[60:63], 0
 ds_read_b128 a[112:115], v2 offset:12288
 ds_read_b128 a[116:119], v2 offset:13312
M v[140:143], a[72:75], v[44:47], v[140:143]
 buffer_load_dwordx4 v3, s[8:11], s24 offen offset:2048 sc1 lds
M v[144:147], a[80:83], v[40:43], 0
 v_accvgpr_write_b32 a156, v240
 v_accvgpr_write_b32 a157, v241
M v[144:147], a[84:87], v[56:59], v[144:147]
 ds_read_b128 a[120:123], v2 offset:14336
 ds_read_b128 a[124:127], v2 offset:15360
M v[148:151], a[84:87], v[60:63], 0
 buffer_load_dwordx4 v3, s[8:11], s24 offen offset:3072 sc1 lds
M v[148:151], a[80:83], v[44:47], v[148:151]
 s_add_u32 m0, s28, 4096
 v_accvgpr_write_b32 a158, v242
 v_accvgpr_write_b32 a159, v243
M v[152:155], a[88:91], v[40:43], 0
 buffer_load_dwordx4 v4, s[8:11], s24 offen offset:0 sc1 lds
M v[152:155], a[92:95], v[56:59], v[152:155]
 v_cvt_pk_bf16_f32 v244, v244, v245
 v_cvt_pk_bf16_f32 v245, v246, v247
M v[156:159], a[92:95], v[60:63], 0
 v_cvt_pk_bf16_f32 v246, v252, v253
 v_cvt_pk_bf16_f32 v247, v254, v255
M v[156:159], a[88:91], v[44:47], v[156:159]
 s_waitcnt lgkmcnt(0)
 v_accvgpr_write_b32 a188, v244
 v_accvgpr_write_b32 a189, v245
M v[160:163], a[96:99], v[40:43], 0
 ds_read_b128 a[64:67], v2 offset:16384
 ds_read_b128 a[68:71], v2 offset:17408
M v[160:163], a[100:103], v[56:59], v[160:163]
 buffer_load_dwordx4 v4, s[8:11], s24 offen offset:1024 sc1 lds
M v[164:167], a[100:103], v[60:63], 0
 v_accvgpr_write_b32 a190, v246
 v_accvgpr_write_b32 a191, v247
M v[164:167], a[96:99], v[44:47], v[164:167]
 ds_read_b128 a[72:75], v2 offset:18432
 ds_read_b128 a[76:79], v2 offset:19456
M v[168:171], a[104:107], v[40:43], 0
 buffer_load_dwordx4 v4, s[8:11], s24 offen offset:2048 sc1 lds
M v[168:171], a[108:111], v[56:59], v[168:171]
 v_exp_f32 v18, v96
M v[172:175], a[108:111], v[60:63], 0
 ds_read_b128 a[80:83], v2 offset:20480
 ds_read_b128 a[84:87], v2 offset:21504
M v[172:175], a[104:107], v[44:47], v[172:175]
 buffer_load_dwordx4 v4, s[8:11], s24 offen offset:3072 sc1 lds
M v[176:179], a[112:115], v[40:43], 0
 v_exp_f32 v19, v97
M v[176:179], a[116:119], v[56:59], v[176:179]
 s_add_u32 m0, s28, 32768
 ds_read_b128 a[88:91], v2 offset:22528
 ds_read_b128 a[92:95], v2 offset:23552
M v[180:183], a[116:119], v[60:63], 0
 buffer_load_dwordx4 v3, s[8:11], s21 offen offset:0 sc1 lds
M v[180:183], a[112:115], v[44:47], v[180:183]
 v_exp_f32 v20, v98
M v[184:187], a[120:123], v[40:43], 0
 buffer_load_dwordx4 v3, s[8:11], s21 offen offset:1024 sc1 lds
M v[184:187], a[124:127], v[56:59], v[184:187]
 v_exp_f32 v21, v99
M v[188:191], a[124:127], v[60:63], 0
 buffer_load_dwordx4 v3, s[8:11], s21 offen offset:2048 sc1 lds
M v[188:191], a[120:123], v[44:47], v[188:191]
 s_waitcnt lgkmcnt(0)
 v_exp_f32 v22, v104
M v[192:195], a[64:67], v[40:43], 0
 ds_read_b128 a[96:99], v2 offset:24576
 ds_read_b128 a[100:103], v2 offset:25600
M v[192:195], a[68:71], v[56:59], v[192:195]
 buffer_load_dwordx4 v3, s[8:11], s21 offen offset:3072 sc1 lds
M v[196:199], a[68:71], v[60:63], 0
 v_exp_f32 v23, v105
M v[196:199], a[64:67], v[44:47], v[196:199]
 s_add_u32 m0, s28, 36864
 ds_read_b128 a[104:107], v2 offset:26624
 ds_read_b128 a[108:111], v2 offset:27648
M v[200:203], a[72:75], v[40:43], 0
 buffer_load_dwordx4 v4, s[8:11], s21 offen offset:0 sc1 lds
M v[200:203], a[76:79], v[56:59], v[200:203]
 v_add_f32 v30, v26, v30
 v_add_f32 v31, v27, v31
M v[204:207], a[76:79], v[60:63], 0
 ds_read_b128 a[112:115], v2 offset:28672
 ds_read_b128 a[116:119], v2 offset:29696
M v[204:207], a[72:75], v[44:47], v[204:207]
 buffer_load_dwordx4 v4, s[8:11], s21 offen offset:1024 sc1 lds
M v[208:211], a[80:83], v[40:43], 0
 v_exp_f32 v24, v106
M v[208:211], a[84:87], v[56:59], v[208:211]
 ds_read_b128 a[120:123], v2 offset:30720
 ds_read_b128 a[124:127], v2 offset:31744
M v[212:215], a[84:87], v[60:63], 0
 buffer_load_dwordx4 v4, s[8:11], s21 offen offset:2048 sc1 lds
M v[212:215], a[80:83], v[44:47], v[212:215]
 v_exp_f32 v25, v107
M v[216:219], a[88:91], v[40:43], 0
 v_add_f32 v28, v18, v19
 v_cvt_pk_bf16_f32 v48, v18, v19
M v[216:219], a[92:95], v[56:59], v[216:219]
 buffer_load_dwordx4 v4, s[8:11], s21 offen offset:3072 sc1 lds
M v[220:223], a[92:95], v[60:63], 0
 s_waitcnt vmcnt(16) lgkmcnt(0)
 s_add_u32 s24, s23, 16777216
 s_mov_b32 s23, s21
M v[220:223], a[88:91], v[44:47], v[220:223]
 s_barrier
M v[224:227], a[96:99], v[40:43], 0
 ds_read_b128 a[64:67], v2 offset:32768
 ds_read_b128 a[68:71], v2 offset:33792
M v[224:227], a[100:103], v[56:59], v[224:227]
 s_add_u32 s21, s21, 32768
 v_add_f32 v28, v20, v28
M v[228:231], a[100:103], v[60:63], 0
 s_add_u32 s22, s22, 1
 v_exp_f32 v18, v100
M v[228:231], a[96:99], v[44:47], v[228:231]
 s_cmp_eq_u32 s22, s25
 ds_read_b128 a[72:75], v2 offset:34816
 ds_read_b128 a[76:79], v2 offset:35840
M v[232:235], a[104:107], v[40:43], 0
 s_cselect_b32 s21, s26, s21
 v_exp_f32 v19, v101
M v[232:235], a[108:111], v[56:59], v[232:235]
 s_cmp_eq_u32 s22, s43
 v_cvt_pk_bf16_f32 v49, v20, v21
 v_add_f32 v28, v21, v28
M v[236:239], a[108:111], v[60:63], 0
 s_cselect_b32 s21, s4, s21
 ds_read_b128 a[80:83], v2 offset:36864
 ds_read_b128 a[84:87], v2 offset:37888
M v[236:239], a[104:107], v[44:47], v[236:239]
 s_cmp_eq_u32 s22, s6
 v_exp_f32 v20, v102
M v[240:243], a[112:115], v[40:43], 0
 s_cselect_b32 s21, s7, s21
 v_exp_f32 v21, v103
M v[240:243], a[116:119], v[56:59], v[240:243]
 ds_read_b128 a[88:91], v2 offset:38912
 ds_read_b128 a[92:95], v2 offset:39936
M v[244:247], a[116:119], v[60:63], 0
 v_add_f32 v28, v22, v28
 v_cvt_pk_bf16_f32 v50, v22, v23
M v[244:247], a[112:115], v[44:47], v[244:247]
 v_add_f32 v28, v23, v28
 v_add_f32 v28, v24, v28
M v[248:251], a[120:123], v[40:43], 0
 v_exp_f32 v22, v108
M v[248:251], a[124:127], v[56:59], v[248:251]
 s_cmp_lg_u32 s27, 0
 v_exp_f32 v23, v109
M v[252:255], a[124:127], v[60:63], 0
 s_waitcnt lgkmcnt(0)
 v_cvt_pk_bf16_f32 v51, v24, v25
 v_add_f32 v28, v25, v28
M v[252:255], a[120:123], v[44:47], v[252:255]
 v_exp_f32 v24, v110
 v_add_f32 v29, v18, v19
 v_cvt_pk_bf16_f32 v52, v18, v19
 v_add_f32 v29, v20, v29
 v_cvt_pk_bf16_f32 v53, v20, v21
 v_add_f32 v29, v21, v29
 v_exp_f32 v25, v111
 v_add_f32 v29, v22, v29
 v_cvt_pk_bf16_f32 v54, v22, v23
 v_add_f32 v29, v23, v29
 v_add_f32 v29, v24, v29
 v_cvt_pk_bf16_f32 v55, v24, v25
 v_add_f32 v29, v25, v29
 s_cbranch_scc1 L_loop_top
L_final_h:
 s_waitcnt vmcnt(8)
 s_barrier
 ds_read_b128 a[64:67], v7 offset:0
 ds_read_b128 a[68:71], v7 offset:1024
 ds_read_b128 a[72:75], v7 offset:2048
 ds_read_b128 a[76:79], v7 offset:3072
 ds_read_b128 a[80:83], v7 offset:4096
 ds_read_b128 a[84:87], v7 offset:5120
 ds_read_b128 a[88:91], v7 offset:6144
 ds_read_b128 a[92:95], v7 offset:7168
 s_add_u32 m0, s28, 65536
 v_exp_f32 v18, v112
 buffer_load_dwordx4 v3, s[8:11], s38 offen offset:0 sc1 lds
 v_exp_f32 v19, v113
 v_exp_f32 v20, v114
 v_add_f32 v28, v18, v28
 v_cvt_pk_bf16_f32 v56, v18, v19
 buffer_load_dwordx4 v3, s[8:11], s38 offen offset:1024 sc1 lds
 v_exp_f32 v21, v115
 v_add_f32 v28, v19, v28
 v_exp_f32 v22, v120
 v_add_f32 v28, v20, v28
 v_cvt_pk_bf16_f32 v57, v20, v21
 buffer_load_dwordx4 v3, s[8:11], s38 offen offset:2048 sc1 lds
 v_exp_f32 v23, v121
 v_add_f32 v28, v21, v28
 v_exp_f32 v24, v122
 v_add_f32 v28, v22, v28
 v_cvt_pk_bf16_f32 v58, v22, v23
 buffer_load_dwordx4 v3, s[8:11], s38 offen offset:3072 sc1 lds
 v_exp_f32 v25, v123
 v_add_f32 v28, v23, v28
 v_exp_f32 v18, v116
 v_add_f32 v28, v24, v28
 s_add_u32 m0, s28, 69632
 v_cvt_pk_bf16_f32 v59, v24, v25
 buffer_load_dwordx4 v4, s[8:11], s38 offen offset:0 sc1 lds
 v_exp_f32 v19, v117
 v_add_f32 v28, v25, v28
 v_exp_f32 v20, v118
 v_add_f32 v29, v18, v29
 v_cvt_pk_bf16_f32 v60, v18, v19
 buffer_load_dwordx4 v4, s[8:11], s38 offen offset:1024 sc1 lds
 v_exp_f32 v21, v119
 v_add_f32 v29, v19, v29
 v_exp_f32 v22, v124
 v_add_f32 v29, v20, v29
 v_cvt_pk_bf16_f32 v61, v20, v21
 buffer_load_dwordx4 v4, s[8:11], s38 offen offset:2048 sc1 lds
 v_exp_f32 v23, v125
 v_add_f32 v29, v21, v29
 v_exp_f32 v24, v126
 v_add_f32 v29, v22, v29
 v_cvt_pk_bf16_f32 v62, v22, v23
 buffer_load_dwordx4 v4, s[8:11], s38 offen offset:3072 sc1 lds
 s_add_u32 s38, s38, 32768
 v_exp_f32 v25, v127
 v_add_f32 v29, v23, v29
 v_add_f32 v29, v24, v29
 v_cvt_pk_bf16_f32 v63, v24, v25
 v_add_f32 v29, v25, v29
 v_max_f32 v10, v28, v29
 v_cmp_lt_f32 vcc, s31, v10
 s_nop 0
 s_cbranch_vccnz L_st4
L_rt4:
 v_add_f32 v30, v28, v30
 v_add_f32 v31, v29, v31
 v_mov_b32 v12, v32
 v_mov_b32 v13, v36
 v_mov_b32 v14, v30
 v_mov_b32 v15, v31
 buffer_store_dwordx4 v[12:15], v7, s[8:11], s52 offen sc1
 s_waitcnt lgkmcnt(0)
M v[128:131], a[64:67], v[48:51], v[128:131]
 ds_read_b128 a[96:99], v7 offset:8192
M v[128:131], a[68:71], v[56:59], v[128:131]
 ds_read_b128 a[100:103], v7 offset:9216
M v[132:135], a[68:71], v[60:63], v[132:135]
M v[132:135], a[64:67], v[52:55], v[132:135]
 ds_read_b128 a[104:107], v7 offset:10240
M v[136:139], a[72:75], v[48:51], v[136:139]
 ds_read_b128 a[108:111], v7 offset:11264
M v[136:139], a[76:79], v[56:59], v[136:139]
M v[140:143], a[76:79], v[60:63], v[140:143]
 ds_read_b128 a[112:115], v7 offset:12288
M v[140:143], a[72:75], v[52:55], v[140:143]
 ds_read_b128 a[116:119], v7 offset:13312
M v[144:147], a[80:83], v[48:51], v[144:147]
M v[144:147], a[84:87], v[56:59], v[144:147]
 ds_read_b128 a[120:123], v7 offset:14336
 v_cvt_pk_bf16_f32 v128, v128, v129
M v[148:151], a[84:87], v[60:63], v[148:151]
 ds_read_b128 a[124:127], v7 offset:15360
 v_cvt_pk_bf16_f32 v129, v130, v131
M v[148:151], a[80:83], v[52:55], v[148:151]
 v_cvt_pk_bf16_f32 v130, v136, v137
 v_cvt_pk_bf16_f32 v131, v138, v139
M v[152:155], a[88:91], v[48:51], v[152:155]
 buffer_store_dwordx4 v[128:131], v7, s[8:11], s12 offen offset:0 sc1
M v[152:155], a[92:95], v[56:59], v[152:155]
 v_cvt_pk_bf16_f32 v132, v132, v133
 v_cvt_pk_bf16_f32 v133, v134, v135
M v[156:159], a[92:95], v[60:63], v[156:159]
 v_cvt_pk_bf16_f32 v134, v140, v141
 v_cvt_pk_bf16_f32 v135, v142, v143
M v[156:159], a[88:91], v[52:55], v[156:159]
 s_waitcnt lgkmcnt(0)
M v[160:163], a[96:99], v[48:51], v[160:163]
 ds_read_b128 a[64:67], v7 offset:16384
M v[160:163], a[100:103], v[56:59], v[160:163]
 ds_read_b128 a[68:71], v7 offset:17408
M v[164:167], a[100:103], v[60:63], v[164:167]
 buffer_store_dwordx4 v[132:135], v7, s[8:11], s14 offen offset:0 sc1
M v[164:167], a[96:99], v[52:55], v[164:167]
 ds_read_b128 a[72:75], v7 offset:18432
 v_cvt_pk_bf16_f32 v144, v144, v145
M v[168:171], a[104:107], v[48:51], v[168:171]
 ds_read_b128 a[76:79], v7 offset:19456
 v_cvt_pk_bf16_f32 v145, v146, v147
M v[168:171], a[108:111], v[56:59], v[168:171]
 v_cvt_pk_bf16_f32 v146, v152, v153
 v_cvt_pk_bf16_f32 v147, v154, v155
M v[172:175], a[108:111], v[60:63], v[172:175]
 ds_read_b128 a[80:83], v7 offset:20480
M v[172:175], a[104:107], v[52:55], v[172:175]
 ds_read_b128 a[84:87], v7 offset:21504
M v[176:179], a[112:115], v[48:51], v[176:179]
 buffer_store_dwordx4 v[144:147], v7, s[8:11], s12 offen offset:1024 sc1
M v[176:179], a[116:119], v[56:59], v[176:179]
 ds_read_b128 a[88:91], v7 offset:22528
 v_cvt_pk_bf16_f32 v148, v148, v149
M v[180:183], a[116:119], v[60:63], v[180:183]
 ds_read_b128 a[92:95], v7 offset:23552
 v_cvt_pk_bf16_f32 v149, v150, v151
M v[180:183], a[112:115], v[52:55], v[180:183]
 v_cvt_pk_bf16_f32 v150, v156, v157
 v_cvt_pk_bf16_f32 v151, v158, v159
M v[184:187], a[120:123], v[48:51], v[184:187]
 buffer_store_dwordx4 v[148:151], v7, s[8:11], s14 offen offset:1024 sc1
M v[184:187], a[124:127], v[56:59], v[184:187]
 v_cvt_pk_bf16_f32 v160, v160, v161
 v_cvt_pk_bf16_f32 v161, v162, v163
M v[188:191], a[124:127], v[60:63], v[188:191]
 v_cvt_pk_bf16_f32 v162, v168, v169
 v_cvt_pk_bf16_f32 v163, v170, v171
M v[188:191], a[120:123], v[52:55], v[188:191]
 s_waitcnt lgkmcnt(0)
M v[192:195], a[64:67], v[48:51], v[192:195]
 ds_read_b128 a[96:99], v7 offset:24576
M v[192:195], a[68:71], v[56:59], v[192:195]
 ds_read_b128 a[100:103], v7 offset:25600
M v[196:199], a[68:71], v[60:63], v[196:199]
 buffer_store_dwordx4 v[160:163], v7, s[8:11], s12 offen offset:2048 sc1
M v[196:199], a[64:67], v[52:55], v[196:199]
 ds_read_b128 a[104:107], v7 offset:26624
 v_cvt_pk_bf16_f32 v164, v164, v165
M v[200:203], a[72:75], v[48:51], v[200:203]
 ds_read_b128 a[108:111], v7 offset:27648
 v_cvt_pk_bf16_f32 v165, v166, v167
M v[200:203], a[76:79], v[56:59], v[200:203]
 v_cvt_pk_bf16_f32 v166, v172, v173
 v_cvt_pk_bf16_f32 v167, v174, v175
M v[204:207], a[76:79], v[60:63], v[204:207]
 ds_read_b128 a[112:115], v7 offset:28672
M v[204:207], a[72:75], v[52:55], v[204:207]
 ds_read_b128 a[116:119], v7 offset:29696
M v[208:211], a[80:83], v[48:51], v[208:211]
 buffer_store_dwordx4 v[164:167], v7, s[8:11], s14 offen offset:2048 sc1
M v[208:211], a[84:87], v[56:59], v[208:211]
 ds_read_b128 a[120:123], v7 offset:30720
 v_cvt_pk_bf16_f32 v176, v176, v177
M v[212:215], a[84:87], v[60:63], v[212:215]
 ds_read_b128 a[124:127], v7 offset:31744
 v_cvt_pk_bf16_f32 v177, v178, v179
M v[212:215], a[80:83], v[52:55], v[212:215]
 v_cvt_pk_bf16_f32 v178, v184, v185
 v_cvt_pk_bf16_f32 v179, v186, v187
M v[216:219], a[88:91], v[48:51], v[216:219]
 buffer_store_dwordx4 v[176:179], v7, s[8:11], s12 offen offset:3072 sc1
M v[216:219], a[92:95], v[56:59], v[216:219]
 v_cvt_pk_bf16_f32 v180, v180, v181
 v_cvt_pk_bf16_f32 v181, v182, v183
M v[220:223], a[92:95], v[60:63], v[220:223]
 s_waitcnt lgkmcnt(0)
 v_cvt_pk_bf16_f32 v182, v188, v189
 v_cvt_pk_bf16_f32 v183, v190, v191
M v[220:223], a[88:91], v[52:55], v[220:223]
 s_barrier
M v[224:227], a[96:99], v[48:51], v[224:227]
 ds_read_b128 a[64:67], v2 offset:32768
M v[224:227], a[100:103], v[56:59], v[224:227]
 ds_read_b128 a[68:71], v2 offset:33792
M v[228:231], a[100:103], v[60:63], v[228:231]
 buffer_store_dwordx4 v[180:183], v7, s[8:11], s14 offen offset:3072 sc1
M v[228:231], a[96:99], v[52:55], v[228:231]
 ds_read_b128 a[72:75], v2 offset:34816
 v_cvt_pk_bf16_f32 v192, v192, v193
M v[232:235], a[104:107], v[48:51], v[232:235]
 ds_read_b128 a[76:79], v2 offset:35840
 v_cvt_pk_bf16_f32 v193, v194, v195
M v[232:235], a[108:111], v[56:59], v[232:235]
 v_cvt_pk_bf16_f32 v194, v200, v201
 v_cvt_pk_bf16_f32 v195, v202, v203
M v[236:239], a[108:111], v[60:63], v[236:239]
 ds_read_b128 a[80:83], v2 offset:36864
M v[236:239], a[104:107], v[52:55], v[236:239]
 ds_read_b128 a[84:87], v2 offset:37888
M v[240:243], a[112:115], v[48:51], v[240:243]
 buffer_store_dwordx4 v[192:195], v7, s[8:11], s13 offen offset:0 sc1
M v[240:243], a[116:119], v[56:59], v[240:243]
 ds_read_b128 a[88:91], v2 offset:38912
 v_cvt_pk_bf16_f32 v196, v196, v197
M v[244:247], a[116:119], v[60:63], v[244:247]
 ds_read_b128 a[92:95], v2 offset:39936
 v_cvt_pk_bf16_f32 v197, v198, v199
M v[244:247], a[112:115], v[52:55], v[244:247]
 v_cvt_pk_bf16_f32 v198, v204, v205
 v_cvt_pk_bf16_f32 v199, v206, v207
M v[248:251], a[120:123], v[48:51], v[248:251]
 buffer_store_dwordx4 v[196:199], v7, s[8:11], s15 offen offset:0 sc1
M v[248:251], a[124:127], v[56:59], v[248:251]
 v_cvt_pk_bf16_f32 v208, v208, v209
 v_cvt_pk_bf16_f32 v209, v210, v211
M v[252:255], a[124:127], v[60:63], v[252:255]
 s_waitcnt lgkmcnt(0)
 v_cvt_pk_bf16_f32 v210, v216, v217
 v_cvt_pk_bf16_f32 v211, v218, v219
M v[252:255], a[120:123], v[52:55], v[252:255]
 buffer_store_dwordx4 v[208:211], v7, s[8:11], s13 offen offset:1024 sc1
 v_cvt_pk_bf16_f32 v212, v212, v213
 v_cvt_pk_bf16_f32 v213, v214, v215
 v_cvt_pk_bf16_f32 v214, v220, v221
 v_cvt_pk_bf16_f32 v215, v222, v223
 buffer_store_dwordx4 v[212:215], v7, s[8:11], s15 offen offset:1024 sc1
 v_cvt_pk_bf16_f32 v224, v224, v225
 v_cvt_pk_bf16_f32 v225, v226, v227
 v_cvt_pk_bf16_f32 v226, v232, v233
 v_cvt_pk_bf16_f32 v227, v234, v235
 buffer_store_dwordx4 v[224:227], v7, s[8:11], s13 offen offset:2048 sc1
 v_cvt_pk_bf16_f32 v228, v228, v229
 v_cvt_pk_bf16_f32 v229, v230, v231
 v_cvt_pk_bf16_f32 v230, v236, v237
 v_cvt_pk_bf16_f32 v231, v238, v239
 buffer_store_dwordx4 v[228:231], v7, s[8:11], s15 offen offset:2048 sc1
 v_cvt_pk_bf16_f32 v240, v240, v241
 v_cvt_pk_bf16_f32 v241, v242, v243
 v_cvt_pk_bf16_f32 v242, v248, v249
 v_cvt_pk_bf16_f32 v243, v250, v251
 buffer_store_dwordx4 v[240:243], v7, s[8:11], s13 offen offset:3072 sc1
 v_cvt_pk_bf16_f32 v244, v244, v245
 v_cvt_pk_bf16_f32 v245, v246, v247
 v_cvt_pk_bf16_f32 v246, v252, v253
 v_cvt_pk_bf16_f32 v247, v254, v255
 buffer_store_dwordx4 v[244:247], v7, s[8:11], s15 offen offset:3072 sc1
M v[64:67], a[64:67], a[128:131], 0
 ds_read_b128 a[96:99], v2 offset:40960
M v[64:67], a[68:71], a[132:135], v[64:67]
 s_add_u32 m0, s28, 0
 ds_read_b128 a[100:103], v2 offset:41984
M v[64:67], a[72:75], a[136:139], v[64:67]
 buffer_load_dwordx4 v3, s[8:11], s38 offen offset:0 sc1 lds
M v[64:67], a[76:79], a[140:143], v[64:67]
 ds_read_b128 a[104:107], v2 offset:43008
 v_accvgpr_read_b32 v5, a192
M v[64:67], a[80:83], a[144:147], v[64:67]
 ds_read_b128 a[108:111], v2 offset:44032
 v_accvgpr_read_b32 v6, a193
M v[64:67], a[84:87], a[148:151], v[64:67]
 s_sub_u32 s64, 15, s42
M v[64:67], a[88:91], a[152:155], v[64:67]
 s_min_u32 s64, s64, s42
 ds_read_b128 a[112:115], v2 offset:45056
M v[64:67], a[92:95], a[156:159], v[64:67]
 s_mul_i32 s45, s64, 8704
 ds_read_b128 a[116:119], v2 offset:46080
M v[68:71], a[92:95], a[188:191], 0
 s_lshl_b32 s64, s20, 6
M v[68:71], a[88:91], a[184:187], v[68:71]
 s_add_u32 s64, s64, s41
 ds_read_b128 a[120:123], v2 offset:47104
M v[68:71], a[84:87], a[180:183], v[68:71]
 s_lshl2_add_u32 s45, s64, s45
 ds_read_b128 a[124:127], v2 offset:48128
 s_add_u32 s45, s45, 104992768
M v[68:71], a[80:83], a[176:179], v[68:71]
 buffer_load_dwordx4 v3, s[8:11], s38 offen offset:1024 sc1 lds
M v[68:71], a[76:79], a[172:175], v[68:71]
 s_movk_i32 s65, 1024
M v[68:71], a[72:75], a[168:171], v[68:71]
 s_cmp_lt_u32 s42, 8
M v[68:71], a[68:71], a[164:167], v[68:71]
 s_cselect_b32 s64, 4352, s65
M v[68:71], a[64:67], a[160:163], v[68:71]
 s_waitcnt lgkmcnt(0)
M v[72:75], a[96:99], a[128:131], 0
 s_cselect_b32 s65, 0, 64
 ds_read_b128 a[64:67], v2 offset:49152
M v[72:75], a[100:103], a[132:135], v[72:75]
 s_cselect_b32 s66, 32, 64
 ds_read_b128 a[68:71], v2 offset:50176
 s_add_u32 s3, s45, s64
M v[72:75], a[104:107], a[136:139], v[72:75]
 buffer_load_dwordx4 v3, s[8:11], s38 offen offset:2048 sc1 lds
M v[72:75], a[108:111], a[140:143], v[72:75]
 ds_read_b128 a[72:75], v2 offset:51200
 s_add_u32 s45, s45, s65
M v[72:75], a[112:115], a[144:147], v[72:75]
 ds_read_b128 a[76:79], v2 offset:52224
 v_lshrrev_b32 v17, 5, v7
M v[72:75], a[116:119], a[148:151], v[72:75]
 v_mul_u32_u24 v17, 4352, v17
 v_and_b32 v16, 16, v7
M v[72:75], a[120:123], a[152:155], v[72:75]
 ds_read_b128 a[80:83], v2 offset:53248
 v_lshl_add_u32 v16, v16, 3, v17
M v[72:75], a[124:127], a[156:159], v[72:75]
 ds_read_b128 a[84:87], v2 offset:54272
 v_mov_b32 v17, 536870912
M v[76:79], a[124:127], a[188:191], 0
 buffer_load_dwordx4 v3, s[8:11], s38 offen offset:3072 sc1 lds
M v[76:79], a[120:123], a[184:187], v[76:79]
 ds_read_b128 a[88:91], v2 offset:55296
 v_cmp_gt_u32 vcc, s66, v7
M v[76:79], a[116:119], a[180:183], v[76:79]
 ds_read_b128 a[92:95], v2 offset:56320
 v_mov_b32 v15, 1
M v[76:79], a[112:115], a[176:179], v[76:79]
 s_nop 0
 v_cndmask_b32 v16, v17, v16, vcc
M v[76:79], a[108:111], a[172:175], v[76:79]
M v[76:79], a[104:107], a[168:171], v[76:79]
M v[76:79], a[100:103], a[164:167], v[76:79]
 s_add_u32 m0, s28, 4096
M v[76:79], a[96:99], a[160:163], v[76:79]
 s_waitcnt lgkmcnt(0)
M v[80:83], a[64:67], a[128:131], 0
 ds_read_b128 a[96:99], v2 offset:57344
M v[80:83], a[68:71], a[132:135], v[80:83]
 ds_read_b128 a[100:103], v2 offset:58368
M v[80:83], a[72:75], a[136:139], v[80:83]
 buffer_load_dwordx4 v4, s[8:11], s38 offen offset:0 sc1 lds
M v[80:83], a[76:79], a[140:143], v[80:83]
 ds_read_b128 a[104:107], v2 offset:59392
M v[80:83], a[80:83], a[144:147], v[80:83]
 ds_read_b128 a[108:111], v2 offset:60416
M v[80:83], a[84:87], a[148:151], v[80:83]
M v[80:83], a[88:91], a[152:155], v[80:83]
 ds_read_b128 a[112:115], v2 offset:61440
M v[80:83], a[92:95], a[156:159], v[80:83]
 ds_read_b128 a[116:119], v2 offset:62464
M v[84:87], a[92:95], a[188:191], 0
 buffer_load_dwordx4 v4, s[8:11], s38 offen offset:1024 sc1 lds
M v[84:87], a[88:91], a[184:187], v[84:87]
 ds_read_b128 a[120:123], v2 offset:63488
M v[84:87], a[84:87], a[180:183], v[84:87]
 ds_read_b128 a[124:127], v2 offset:64512
M v[84:87], a[80:83], a[176:179], v[84:87]
M v[84:87], a[76:79], a[172:175], v[84:87]
M v[84:87], a[72:75], a[168:171], v[84:87]
 buffer_load_dwordx4 v4, s[8:11], s38 offen offset:2048 sc1 lds
M v[84:87], a[68:71], a[164:167], v[84:87]
 s_waitcnt vmcnt(7) lgkmcnt(0)
M v[84:87], a[64:67], a[160:163], v[84:87]
 s_barrier
M v[88:91], a[96:99], a[128:131], 0
 s_xor_b32 s47, s47, 64
 ds_read_b128 a[64:67], v7 offset:32768
M v[88:91], a[100:103], a[132:135], v[88:91]
 ds_read_b128 a[68:71], v7 offset:33792
 v_mov_b32 v18, 1
M v[88:91], a[104:107], a[136:139], v[88:91]
 buffer_store_dword v18, v1, s[8:11], s47 offen sc1
M v[88:91], a[108:111], a[140:143], v[88:91]
 ds_read_b128 a[72:75], v7 offset:34816
M v[88:91], a[112:115], a[144:147], v[88:91]
 ds_read_b128 a[76:79], v7 offset:35840
M v[88:91], a[116:119], a[148:151], v[88:91]
 buffer_load_dwordx4 v4, s[8:11], s38 offen offset:3072 sc1 lds
M v[88:91], a[120:123], a[152:155], v[88:91]
 s_add_u32 s38, s38, 32768
 ds_read_b128 a[80:83], v7 offset:36864
M v[88:91], a[124:127], a[156:159], v[88:91]
 ds_read_b128 a[84:87], v7 offset:37888
M v[92:95], a[124:127], a[188:191], 0
M v[92:95], a[120:123], a[184:187], v[92:95]
 ds_read_b128 a[88:91], v7 offset:38912
M v[92:95], a[116:119], a[180:183], v[92:95]
 ds_read_b128 a[92:95], v7 offset:39936
M v[92:95], a[112:115], a[176:179], v[92:95]
M v[92:95], a[108:111], a[172:175], v[92:95]
M v[92:95], a[104:107], a[168:171], v[92:95]
M v[92:95], a[100:103], a[164:167], v[92:95]
 s_waitcnt lgkmcnt(0)
M v[92:95], a[96:99], a[160:163], v[92:95]
M v[96:99], a[64:67], a[128:131], 0
 s_add_u32 m0, s28, 98304
 ds_read_b128 a[96:99], v7 offset:40960
M v[96:99], a[68:71], a[132:135], v[96:99]
 ds_read_b128 a[100:103], v7 offset:41984
M v[96:99], a[72:75], a[136:139], v[96:99]
 buffer_load_dwordx4 v3, s[8:11], s38 offen offset:0 sc1 lds
M v[96:99], a[76:79], a[140:143], v[96:99]
 ds_read_b128 a[104:107], v7 offset:43008
 s_add_u32 s29, s33, 0
M v[96:99], a[80:83], a[144:147], v[96:99]
 ds_read_b128 a[108:111], v7 offset:44032
 s_add_u32 s30, s33, 14336
M v[96:99], a[84:87], a[148:151], v[96:99]
 v_max3_f32 v32, |v64|, |v65|, |v66|
 v_max3_f32 v32, |v67|, |v72|, v32
M v[96:99], a[88:91], a[152:155], v[96:99]
 ds_read_b128 a[112:115], v7 offset:45056
 v_max3_f32 v32, |v73|, |v74|, v32
M v[96:99], a[92:95], a[156:159], v[96:99]
 ds_read_b128 a[116:119], v7 offset:46080
 v_mul_f32 v32, 2.0, v32
M v[100:103], a[92:95], a[188:191], 0
 buffer_load_dwordx4 v3, s[8:11], s38 offen offset:1024 sc1 lds
M v[100:103], a[88:91], a[184:187], v[100:103]
 ds_read_b128 a[120:123], v7 offset:47104
 v_mov_b32 v33, v32
M v[100:103], a[84:87], a[180:183], v[100:103]
 ds_read_b128 a[124:127], v7 offset:48128
 v_mov_b32 v34, v32
M v[100:103], a[80:83], a[176:179], v[100:103]
 v_mov_b32 v35, v32
 v_mul_f32 v28, -v32, v5
M v[100:103], a[76:79], a[172:175], v[100:103]
 buffer_load_dwordx4 v3, s[8:11], s38 offen offset:2048 sc1 lds
M v[100:103], a[72:75], a[168:171], v[100:103]
 v_mul_f32 v64, v5, v64
 v_mul_f32 v65, v5, v65
M v[100:103], a[68:71], a[164:167], v[100:103]
 v_mul_f32 v66, v5, v66
 v_mul_f32 v67, v5, v67
M v[100:103], a[64:67], a[160:163], v[100:103]
 s_waitcnt lgkmcnt(0)
 v_mul_f32 v72, v5, v72
 v_mul_f32 v73, v5, v73
M v[104:107], a[96:99], a[128:131], 0
 ds_read_b128 a[64:67], v7 offset:49152
 v_mul_f32 v74, v5, v74
M v[104:107], a[100:103], a[132:135], v[104:107]
 ds_read_b128 a[68:71], v7 offset:50176
 v_mul_f32 v75, v5, v75
M v[104:107], a[104:107], a[136:139], v[104:107]
 buffer_load_dwordx4 v3, s[8:11], s38 offen offset:3072 sc1 lds
M v[104:107], a[108:111], a[140:143], v[104:107]
 ds_read_b128 a[72:75], v7 offset:51200
 v_cvt_pk_bf16_f32 v64, v64, v65
M v[104:107], a[112:115], a[144:147], v[104:107]
 ds_read_b128 a[76:79], v7 offset:52224
 v_cvt_pk_bf16_f32 v65, v66, v67
M v[104:107], a[116:119], a[148:151], v[104:107]
 v_cvt_pk_bf16_f32 v66, v72, v73
 v_cvt_pk_bf16_f32 v67, v74, v75
M v[104:107], a[120:123], a[152:155], v[104:107]
 s_add_u32 m0, s28, 102400
 ds_read_b128 a[80:83], v7 offset:53248
M v[104:107], a[124:127], a[156:159], v[104:107]
 ds_read_b128 a[84:87], v7 offset:54272
M v[108:111], a[124:127], a[188:191], 0
 buffer_load_dwordx4 v4, s[8:11], s38 offen offset:0 sc1 lds
M v[108:111], a[120:123], a[184:187], v[108:111]
 ds_read_b128 a[88:91], v7 offset:55296
M v[108:111], a[116:119], a[180:183], v[108:111]
 ds_read_b128 a[92:95], v7 offset:56320
M v[108:111], a[112:115], a[176:179], v[108:111]
 buffer_store_dwordx4 v[64:67], v7, s[8:11], s29 offen offset:0 sc1
M v[108:111], a[108:111], a[172:175], v[108:111]
 buffer_load_dwordx4 v4, s[8:11], s38 offen offset:1024 sc1 lds
M v[108:111], a[104:107], a[168:171], v[108:111]
 v_max3_f32 v36, |v68|, |v69|, |v70|
 v_max3_f32 v36, |v71|, |v76|, v36
M v[108:111], a[100:103], a[164:167], v[108:111]
 v_max3_f32 v36, |v77|, |v78|, v36
 v_mul_f32 v36, 2.0, v36
M v[108:111], a[96:99], a[160:163], v[108:111]
 s_waitcnt lgkmcnt(0)
 v_mov_b32 v37, v36
 v_mov_b32 v38, v36
M v[112:115], a[64:67], a[128:131], 0
 ds_read_b128 a[96:99], v7 offset:57344
 v_mov_b32 v39, v36
M v[112:115], a[68:71], a[132:135], v[112:115]
 ds_read_b128 a[100:103], v7 offset:58368
 v_mul_f32 v29, -v36, v6
M v[112:115], a[72:75], a[136:139], v[112:115]
 buffer_load_dwordx4 v4, s[8:11], s38 offen offset:2048 sc1 lds
M v[112:115], a[76:79], a[140:143], v[112:115]
 ds_read_b128 a[104:107], v7 offset:59392
 v_mul_f32 v68, v6, v68
M v[112:115], a[80:83], a[144:147], v[112:115]
 ds_read_b128 a[108:111], v7 offset:60416
 v_mul_f32 v69, v6, v69
M v[112:115], a[84:87], a[148:151], v[112:115]
 v_mul_f32 v70, v6, v70
 v_mul_f32 v71, v6, v71
M v[112:115], a[88:91], a[152:155], v[112:115]
 ds_read_b128 a[112:115], v7 offset:61440
 v_mul_f32 v76, v6, v76
M v[112:115], a[92:95], a[156:159], v[112:115]
 ds_read_b128 a[116:119], v7 offset:62464
 v_mul_f32 v77, v6, v77
M v[116:119], a[92:95], a[188:191], 0
 buffer_load_dwordx4 v4, s[8:11], s38 offen offset:3072 sc1 lds
M v[116:119], a[88:91], a[184:187], v[116:119]
 s_add_u32 s38, s38, 32768
 ds_read_b128 a[120:123], v7 offset:63488
 v_mul_f32 v78, v6, v78
M v[116:119], a[84:87], a[180:183], v[116:119]
 ds_read_b128 a[124:127], v7 offset:64512
 v_mul_f32 v79, v6, v79
M v[116:119], a[80:83], a[176:179], v[116:119]
 v_cvt_pk_bf16_f32 v68, v68, v69
 v_cvt_pk_bf16_f32 v69, v70, v71
M v[116:119], a[76:79], a[172:175], v[116:119]
 v_cvt_pk_bf16_f32 v70, v76, v77
 v_cvt_pk_bf16_f32 v71, v78, v79
M v[116:119], a[72:75], a[168:171], v[116:119]
 buffer_store_dwordx4 v[68:71], v7, s[8:11], s30 offen offset:0 sc1
M v[116:119], a[68:71], a[164:167], v[116:119]
 s_waitcnt lgkmcnt(0)
 v_mul_f32 v80, v5, v80
 v_mul_f32 v81, v5, v81
M v[116:119], a[64:67], a[160:163], v[116:119]
 s_barrier
M v[120:123], a[96:99], a[128:131], 0
 ds_read_b128 a[64:67], v2 offset:0
 v_mul_f32 v82, v5, v82
M v[120:123], a[100:103], a[132:135], v[120:123]
 ds_read_b128 a[68:71], v2 offset:1024
 v_mul_f32 v83, v5, v83
M v[120:123], a[104:107], a[136:139], v[120:123]
 v_mul_f32 v88, v5, v88
 v_mul_f32 v89, v5, v89
M v[120:123], a[108:111], a[140:143], v[120:123]
 ds_read_b128 a[72:75], v2 offset:2048
 v_mul_f32 v90, v5, v90
M v[120:123], a[112:115], a[144:147], v[120:123]
 ds_read_b128 a[76:79], v2 offset:3072
 v_mul_f32 v91, v5, v91
M v[120:123], a[116:119], a[148:151], v[120:123]
 v_cvt_pk_bf16_f32 v80, v80, v81
 v_cvt_pk_bf16_f32 v81, v82, v83
M v[120:123], a[120:123], a[152:155], v[120:123]
 ds_read_b128 a[80:83], v2 offset:4096
 v_cvt_pk_bf16_f32 v82, v88, v89
M v[120:123], a[124:127], a[156:159], v[120:123]
 ds_read_b128 a[84:87], v2 offset:5120
 v_cvt_pk_bf16_f32 v83, v90, v91
M v[124:127], a[124:127], a[188:191], 0
 buffer_store_dwordx4 v[80:83], v7, s[8:11], s29 offen offset:1024 sc1
M v[124:127], a[120:123], a[184:187], v[124:127]
 ds_read_b128 a[88:91], v2 offset:6144
 v_mul_f32 v84, v6, v84
M v[124:127], a[116:119], a[180:183], v[124:127]
 ds_read_b128 a[92:95], v2 offset:7168
 v_mul_f32 v85, v6, v85
M v[124:127], a[112:115], a[176:179], v[124:127]
 v_mul_f32 v86, v6, v86
 v_mul_f32 v87, v6, v87
M v[124:127], a[108:111], a[172:175], v[124:127]
 v_mul_f32 v92, v6, v92
 v_mul_f32 v93, v6, v93
M v[124:127], a[104:107], a[168:171], v[124:127]
 v_mul_f32 v94, v6, v94
 v_mul_f32 v95, v6, v95
M v[124:127], a[100:103], a[164:167], v[124:127]
 s_waitcnt lgkmcnt(0)
 v_cvt_pk_bf16_f32 v84, v84, v85
 v_cvt_pk_bf16_f32 v85, v86, v87
M v[124:127], a[96:99], a[160:163], v[124:127]
 v_cvt_pk_bf16_f32 v86, v92, v93
 v_cvt_pk_bf16_f32 v87, v94, v95
 buffer_store_dwordx4 v[84:87], v7, s[8:11], s30 offen offset:1024 sc1
M v[64:67], a[64:67], a[128:131], v[32:35]
 s_add_u32 m0, s28, 32768
 ds_read_b128 a[96:99], v2 offset:8192
M v[64:67], a[68:71], a[132:135], v[64:67]
 ds_read_b128 a[100:103], v2 offset:9216
 s_mov_b32 s79, 104923136
M v[64:67], a[72:75], a[136:139], v[64:67]
 buffer_load_dwordx4 v3, s[8:11], s38 offen offset:0 sc1 lds
M v[64:67], a[76:79], a[140:143], v[64:67]
 ds_read_b128 a[104:107], v2 offset:10240
 s_add_u32 s29, s33, 2048
M v[64:67], a[80:83], a[144:147], v[64:67]
 ds_read_b128 a[108:111], v2 offset:11264
 s_add_u32 s30, s33, 16384
M v[64:67], a[84:87], a[148:151], v[64:67]
 buffer_load_dword v24, off, s[8:11], s79 sc1
M v[64:67], a[88:91], a[152:155], v[64:67]
 ds_read_b128 a[112:115], v2 offset:12288
 v_lshrrev_b32 v0, 4, v7
M v[64:67], a[92:95], a[156:159], v[64:67]
 ds_read_b128 a[116:119], v2 offset:13312
 v_and_b32 v14, 15, v0
M v[68:71], a[92:95], a[188:191], v[36:39]
 buffer_load_dwordx4 v3, s[8:11], s38 offen offset:1024 sc1 lds
M v[68:71], a[88:91], a[184:187], v[68:71]
 ds_read_b128 a[120:123], v2 offset:14336
 v_lshlrev_b32 v14, 2, v14
M v[68:71], a[84:87], a[180:183], v[68:71]
 ds_read_b128 a[124:127], v2 offset:15360
 v_lshrrev_b32 v11, 4, v0
M v[68:71], a[80:83], a[176:179], v[68:71]
 s_mov_b32 s52, s96
 s_and_b32 s53, s97, 0xffff
 s_mov_b32 s54, 1835008
M v[68:71], a[76:79], a[172:175], v[68:71]
 buffer_load_dwordx4 v3, s[8:11], s38 offen offset:2048 sc1 lds
M v[68:71], a[72:75], a[168:171], v[68:71]
 s_mov_b32 s55, 0x20000
 v_mul_f32 v96, v5, v96
M v[68:71], a[68:71], a[164:167], v[68:71]
 s_lshr_b32 s74, s41, 3
 s_xor_b32 s74, s74, 0
 s_mul_i32 s67, s74, -2
M v[68:71], a[64:67], a[160:163], v[68:71]
 s_waitcnt lgkmcnt(0)
 s_mul_i32 s74, s74, 8
 v_mul_f32 v97, v5, v97
M v[72:75], a[96:99], a[128:131], v[32:35]
 s_add_u32 s74, s74, s20
 ds_read_b128 a[64:67], v2 offset:16384
 v_mul_f32 v98, v5, v98
M v[72:75], a[100:103], a[132:135], v[72:75]
 s_lshl_b32 s75, s74, 6
 ds_read_b128 a[68:71], v2 offset:17408
 s_add_u32 s76, s75, 256
M v[72:75], a[104:107], a[136:139], v[72:75]
 buffer_load_dwordx4 v3, s[8:11], s38 offen offset:3072 sc1 lds
M v[72:75], a[108:111], a[140:143], v[72:75]
 ds_read_b128 a[72:75], v2 offset:18432
 s_add_u32 s67, s67, 3
M v[72:75], a[112:115], a[144:147], v[72:75]
 s_sub_u32 s67, s67, s20
 ds_read_b128 a[76:79], v2 offset:19456
 v_mul_f32 v99, v5, v99
M v[72:75], a[116:119], a[148:151], v[72:75]
 s_and_b32 s67, s67, 536870912
 s_or_b32 s76, s76, s67
 v_or_b32 v27, s67, v7
M v[72:75], a[120:123], a[152:155], v[72:75]
 s_add_u32 m0, s28, 36864
 ds_read_b128 a[80:83], v2 offset:20480
 v_add_u32 v27, 4096, v27
M v[72:75], a[124:127], a[156:159], v[72:75]
 ds_read_b128 a[84:87], v2 offset:21504
 v_mul_f32 v104, v5, v104
M v[76:79], a[124:127], a[188:191], v[36:39]
 buffer_load_dwordx4 v4, s[8:11], s38 offen offset:0 sc1 lds
M v[76:79], a[120:123], a[184:187], v[76:79]
 ds_read_b128 a[88:91], v2 offset:22528
 v_mul_f32 v105, v5, v105
M v[76:79], a[116:119], a[180:183], v[76:79]
 ds_read_b128 a[92:95], v2 offset:23552
 v_mul_f32 v106, v5, v106
M v[76:79], a[112:115], a[176:179], v[76:79]
 v_mul_f32 v107, v5, v107
 v_cvt_pk_bf16_f32 v96, v96, v97
M v[76:79], a[108:111], a[172:175], v[76:79]
 buffer_load_dwordx4 v4, s[8:11], s38 offen offset:1024 sc1 lds
M v[76:79], a[104:107], a[168:171], v[76:79]
 v_cvt_pk_bf16_f32 v97, v98, v99
 v_cvt_pk_bf16_f32 v98, v104, v105
M v[76:79], a[100:103], a[164:167], v[76:79]
 v_cvt_pk_bf16_f32 v99, v106, v107
M v[76:79], a[96:99], a[160:163], v[76:79]
 s_waitcnt lgkmcnt(0)
M v[80:83], a[64:67], a[128:131], v[32:35]
 ds_read_b128 a[96:99], v2 offset:24576
M v[80:83], a[68:71], a[132:135], v[80:83]
 ds_read_b128 a[100:103], v2 offset:25600
M v[80:83], a[72:75], a[136:139], v[80:83]
 buffer_load_dwordx4 v4, s[8:11], s38 offen offset:2048 sc1 lds
M v[80:83], a[76:79], a[140:143], v[80:83]
 ds_read_b128 a[104:107], v2 offset:26624
M v[80:83], a[80:83], a[144:147], v[80:83]
 ds_read_b128 a[108:111], v2 offset:27648
M v[80:83], a[84:87], a[148:151], v[80:83]
 buffer_store_dwordx4 v[96:99], v7, s[8:11], s29 offen offset:0 sc1
M v[80:83], a[88:91], a[152:155], v[80:83]
 ds_read_b128 a[112:115], v2 offset:28672
 v_mul_f32 v100, v6, v100
M v[80:83], a[92:95], a[156:159], v[80:83]
 ds_read_b128 a[116:119], v2 offset:29696
 v_mul_f32 v101, v6, v101
M v[84:87], a[92:95], a[188:191], v[36:39]
 buffer_load_dwordx4 v4, s[8:11], s38 offen offset:3072 sc1 lds
M v[84:87], a[88:91], a[184:187], v[84:87]
 s_add_u32 s38, s38, 32768
 ds_read_b128 a[120:123], v2 offset:30720
 v_mul_f32 v102, v6, v102
M v[84:87], a[84:87], a[180:183], v[84:87]
 ds_read_b128 a[124:127], v2 offset:31744
 v_mul_f32 v103, v6, v103
M v[84:87], a[80:83], a[176:179], v[84:87]
 v_mul_f32 v108, v6, v108
 v_mul_f32 v109, v6, v109
M v[84:87], a[76:79], a[172:175], v[84:87]
 v_mul_f32 v110, v6, v110
 v_mul_f32 v111, v6, v111
M v[84:87], a[72:75], a[168:171], v[84:87]
 v_cvt_pk_bf16_f32 v100, v100, v101
 v_cvt_pk_bf16_f32 v101, v102, v103
M v[84:87], a[68:71], a[164:167], v[84:87]
 s_waitcnt vmcnt(22) lgkmcnt(0)
 v_cvt_pk_bf16_f32 v102, v108, v109
 v_cvt_pk_bf16_f32 v103, v110, v111
M v[84:87], a[64:67], a[160:163], v[84:87]
 s_barrier
M v[88:91], a[96:99], a[128:131], v[32:35]
 ds_read_b128 a[64:67], v7 offset:0
M v[88:91], a[100:103], a[132:135], v[88:91]
 ds_read_b128 a[68:71], v7 offset:1024
M v[88:91], a[104:107], a[136:139], v[88:91]
 buffer_store_dwordx4 v[100:103], v7, s[8:11], s30 offen offset:0 sc1
M v[88:91], a[108:111], a[140:143], v[88:91]
 ds_read_b128 a[72:75], v7 offset:2048
 v_mul_f32 v112, v5, v112
M v[88:91], a[112:115], a[144:147], v[88:91]
 ds_read_b128 a[76:79], v7 offset:3072
 v_mul_f32 v113, v5, v113
M v[88:91], a[116:119], a[148:151], v[88:91]
 v_mul_f32 v114, v5, v114
 v_mul_f32 v115, v5, v115
M v[88:91], a[120:123], a[152:155], v[88:91]
 ds_read_b128 a[80:83], v7 offset:4096
 v_mul_f32 v120, v5, v120
M v[88:91], a[124:127], a[156:159], v[88:91]
 ds_read_b128 a[84:87], v7 offset:5120
 v_mul_f32 v121, v5, v121
M v[92:95], a[124:127], a[188:191], v[36:39]
 v_mul_f32 v122, v5, v122
 v_mul_f32 v123, v5, v123
M v[92:95], a[120:123], a[184:187], v[92:95]
 ds_read_b128 a[88:91], v7 offset:6144
 v_cvt_pk_bf16_f32 v112, v112, v113
M v[92:95], a[116:119], a[180:183], v[92:95]
 ds_read_b128 a[92:95], v7 offset:7168
 v_cvt_pk_bf16_f32 v113, v114, v115
M v[92:95], a[112:115], a[176:179], v[92:95]
 v_cvt_pk_bf16_f32 v114, v120, v121
 v_cvt_pk_bf16_f32 v115, v122, v123
M v[92:95], a[108:111], a[172:175], v[92:95]
 buffer_store_dwordx4 v[112:115], v7, s[8:11], s29 offen offset:1024 sc1
M v[92:95], a[104:107], a[168:171], v[92:95]
 v_mul_f32 v116, v6, v116
 v_mul_f32 v117, v6, v117
M v[92:95], a[100:103], a[164:167], v[92:95]
 s_waitcnt lgkmcnt(0)
 v_mul_f32 v118, v6, v118
 v_mul_f32 v119, v6, v119
M v[92:95], a[96:99], a[160:163], v[92:95]
 v_mul_f32 v124, v6, v124
 v_mul_f32 v125, v6, v125
 v_mul_f32 v126, v6, v126
 v_mul_f32 v127, v6, v127
 v_cvt_pk_bf16_f32 v116, v116, v117
 v_cvt_pk_bf16_f32 v117, v118, v119
 v_cvt_pk_bf16_f32 v118, v124, v125
 v_cvt_pk_bf16_f32 v119, v126, v127
 buffer_store_dwordx4 v[116:119], v7, s[8:11], s30 offen offset:1024 sc1
M v[96:99], a[64:67], a[128:131], v[32:35]
 s_add_u32 m0, s28, 65536
 ds_read_b128 a[96:99], v7 offset:8192
M v[96:99], a[68:71], a[132:135], v[96:99]
 ds_read_b128 a[100:103], v7 offset:9216
M v[96:99], a[72:75], a[136:139], v[96:99]
 buffer_load_dwordx4 v3, s[8:11], s38 offen offset:0 sc1 lds
M v[96:99], a[76:79], a[140:143], v[96:99]
 ds_read_b128 a[104:107], v7 offset:10240
 s_add_u32 s29, s33, 4096
M v[96:99], a[80:83], a[144:147], v[96:99]
 ds_read_b128 a[108:111], v7 offset:11264
 s_add_u32 s30, s33, 18432
M v[96:99], a[84:87], a[148:151], v[96:99]
 v_fma_f32 v64, v64, v5, v28
 v_fma_f32 v65, v65, v5, v28
M v[96:99], a[88:91], a[152:155], v[96:99]
 ds_read_b128 a[112:115], v7 offset:12288
 v_fma_f32 v66, v66, v5, v28
M v[96:99], a[92:95], a[156:159], v[96:99]
 ds_read_b128 a[116:119], v7 offset:13312
 v_fma_f32 v67, v67, v5, v28
M v[100:103], a[92:95], a[188:191], v[36:39]
 buffer_load_dwordx4 v3, s[8:11], s38 offen offset:1024 sc1 lds
M v[100:103], a[88:91], a[184:187], v[100:103]
 ds_read_b128 a[120:123], v7 offset:14336
 v_fma_f32 v72, v72, v5, v28
M v[100:103], a[84:87], a[180:183], v[100:103]
 ds_read_b128 a[124:127], v7 offset:15360
 v_fma_f32 v73, v73, v5, v28
M v[100:103], a[80:83], a[176:179], v[100:103]
 v_fma_f32 v74, v74, v5, v28
 v_fma_f32 v75, v75, v5, v28
M v[100:103], a[76:79], a[172:175], v[100:103]
 buffer_load_dwordx4 v3, s[8:11], s38 offen offset:2048 sc1 lds
M v[100:103], a[72:75], a[168:171], v[100:103]
 v_cvt_pk_bf16_f32 v64, v64, v65
 v_cvt_pk_bf16_f32 v65, v66, v67
M v[100:103], a[68:71], a[164:167], v[100:103]
 v_cvt_pk_bf16_f32 v66, v72, v73
M v[100:103], a[64:67], a[160:163], v[100:103]
 s_waitcnt lgkmcnt(0)
 v_cvt_pk_bf16_f32 v67, v74, v75
M v[104:107], a[96:99], a[128:131], v[32:35]
 ds_read_b128 a[64:67], v7 offset:16384
M v[104:107], a[100:103], a[132:135], v[104:107]
 ds_read_b128 a[68:71], v7 offset:17408
M v[104:107], a[104:107], a[136:139], v[104:107]
 buffer_load_dwordx4 v3, s[8:11], s38 offen offset:3072 sc1 lds
M v[104:107], a[108:111], a[140:143], v[104:107]
 ds_read_b128 a[72:75], v7 offset:18432
M v[104:107], a[112:115], a[144:147], v[104:107]
 ds_read_b128 a[76:79], v7 offset:19456
M v[104:107], a[116:119], a[148:151], v[104:107]
 buffer_store_dwordx4 v[64:67], v7, s[8:11], s29 offen offset:0 sc1
M v[104:107], a[120:123], a[152:155], v[104:107]
 s_add_u32 m0, s28, 69632
 ds_read_b128 a[80:83], v7 offset:20480
 v_fma_f32 v68, v68, v6, v29
M v[104:107], a[124:127], a[156:159], v[104:107]
 ds_read_b128 a[84:87], v7 offset:21504
 v_fma_f32 v69, v69, v6, v29
M v[108:111], a[124:127], a[188:191], v[36:39]
 buffer_load_dwordx4 v4, s[8:11], s38 offen offset:0 sc1 lds
M v[108:111], a[120:123], a[184:187], v[108:111]
 ds_read_b128 a[88:91], v7 offset:22528
 v_fma_f32 v70, v70, v6, v29
M v[108:111], a[116:119], a[180:183], v[108:111]
 ds_read_b128 a[92:95], v7 offset:23552
 v_fma_f32 v71, v71, v6, v29
M v[108:111], a[112:115], a[176:179], v[108:111]
 v_fma_f32 v76, v76, v6, v29
 v_fma_f32 v77, v77, v6, v29
M v[108:111], a[108:111], a[172:175], v[108:111]
 buffer_load_dwordx4 v4, s[8:11], s38 offen offset:1024 sc1 lds
M v[108:111], a[104:107], a[168:171], v[108:111]
 v_fma_f32 v78, v78, v6, v29
 v_fma_f32 v79, v79, v6, v29
M v[108:111], a[100:103], a[164:167], v[108:111]
 v_cvt_pk_bf16_f32 v68, v68, v69
 v_cvt_pk_bf16_f32 v69, v70, v71
M v[108:111], a[96:99], a[160:163], v[108:111]
 s_waitcnt lgkmcnt(0)
 v_cvt_pk_bf16_f32 v70, v76, v77
 v_cvt_pk_bf16_f32 v71, v78, v79
M v[112:115], a[64:67], a[128:131], v[32:35]
 ds_read_b128 a[96:99], v7 offset:24576
M v[112:115], a[68:71], a[132:135], v[112:115]
 ds_read_b128 a[100:103], v7 offset:25600
M v[112:115], a[72:75], a[136:139], v[112:115]
 buffer_load_dwordx4 v4, s[8:11], s38 offen offset:2048 sc1 lds
M v[112:115], a[76:79], a[140:143], v[112:115]
 ds_read_b128 a[104:107], v7 offset:26624
M v[112:115], a[80:83], a[144:147], v[112:115]
 ds_read_b128 a[108:111], v7 offset:27648
M v[112:115], a[84:87], a[148:151], v[112:115]
 buffer_store_dwordx4 v[68:71], v7, s[8:11], s30 offen offset:0 sc1
M v[112:115], a[88:91], a[152:155], v[112:115]
 ds_read_b128 a[112:115], v7 offset:28672
 v_fma_f32 v80, v80, v5, v28
M v[112:115], a[92:95], a[156:159], v[112:115]
 ds_read_b128 a[116:119], v7 offset:29696
 v_fma_f32 v81, v81, v5, v28
M v[116:119], a[92:95], a[188:191], v[36:39]
 buffer_load_dwordx4 v4, s[8:11], s38 offen offset:3072 sc1 lds
M v[116:119], a[88:91], a[184:187], v[116:119]
 s_add_u32 s38, s38, 32768
 ds_read_b128 a[120:123], v7 offset:30720
 v_fma_f32 v82, v82, v5, v28
M v[116:119], a[84:87], a[180:183], v[116:119]
 ds_read_b128 a[124:127], v7 offset:31744
 v_fma_f32 v83, v83, v5, v28
M v[116:119], a[80:83], a[176:179], v[116:119]
 v_fma_f32 v88, v88, v5, v28
 v_fma_f32 v89, v89, v5, v28
M v[116:119], a[76:79], a[172:175], v[116:119]
 v_fma_f32 v90, v90, v5, v28
 v_fma_f32 v91, v91, v5, v28
M v[116:119], a[72:75], a[168:171], v[116:119]
 v_cvt_pk_bf16_f32 v80, v80, v81
 v_cvt_pk_bf16_f32 v81, v82, v83
M v[116:119], a[68:71], a[164:167], v[116:119]
 s_waitcnt vmcnt(26) lgkmcnt(0)
 v_cvt_pk_bf16_f32 v82, v88, v89
 v_cvt_pk_bf16_f32 v83, v90, v91
M v[116:119], a[64:67], a[160:163], v[116:119]
 s_barrier
M v[120:123], a[96:99], a[128:131], v[32:35]
 ds_read_b128 a[64:67], v2 offset:32768
M v[120:123], a[100:103], a[132:135], v[120:123]
 ds_read_b128 a[68:71], v2 offset:33792
M v[120:123], a[104:107], a[136:139], v[120:123]
 buffer_store_dwordx4 v[80:83], v7, s[8:11], s29 offen offset:1024 sc1
M v[120:123], a[108:111], a[140:143], v[120:123]
 ds_read_b128 a[72:75], v2 offset:34816
 v_fma_f32 v84, v84, v6, v29
M v[120:123], a[112:115], a[144:147], v[120:123]
 ds_read_b128 a[76:79], v2 offset:35840
 v_fma_f32 v85, v85, v6, v29
M v[120:123], a[116:119], a[148:151], v[120:123]
 v_fma_f32 v86, v86, v6, v29
 v_fma_f32 v87, v87, v6, v29
M v[120:123], a[120:123], a[152:155], v[120:123]
 ds_read_b128 a[80:83], v2 offset:36864
 v_fma_f32 v92, v92, v6, v29
M v[120:123], a[124:127], a[156:159], v[120:123]
 ds_read_b128 a[84:87], v2 offset:37888
 v_fma_f32 v93, v93, v6, v29
M v[124:127], a[124:127], a[188:191], v[36:39]
 v_fma_f32 v94, v94, v6, v29
 v_fma_f32 v95, v95, v6, v29
M v[124:127], a[120:123], a[184:187], v[124:127]
 ds_read_b128 a[88:91], v2 offset:38912
 v_cvt_pk_bf16_f32 v84, v84, v85
M v[124:127], a[116:119], a[180:183], v[124:127]
 ds_read_b128 a[92:95], v2 offset:39936
 v_cvt_pk_bf16_f32 v85, v86, v87
M v[124:127], a[112:115], a[176:179], v[124:127]
 v_cvt_pk_bf16_f32 v86, v92, v93
 v_cvt_pk_bf16_f32 v87, v94, v95
M v[124:127], a[108:111], a[172:175], v[124:127]
 buffer_store_dwordx4 v[84:87], v7, s[8:11], s30 offen offset:1024 sc1
M v[124:127], a[104:107], a[168:171], v[124:127]
M v[124:127], a[100:103], a[164:167], v[124:127]
 s_waitcnt lgkmcnt(0)
M v[124:127], a[96:99], a[160:163], v[124:127]
M v[64:67], a[64:67], a[128:131], v[32:35]
 ds_read_b128 a[96:99], v2 offset:40960
M v[64:67], a[68:71], a[132:135], v[64:67]
 ds_read_b128 a[100:103], v2 offset:41984
M v[64:67], a[72:75], a[136:139], v[64:67]
 s_waitcnt vmcnt(23)
 v_cmp_gt_u32 vcc, 1, v24
M v[64:67], a[76:79], a[140:143], v[64:67]
 s_mov_b32 s65, 104890368
 ds_read_b128 a[104:107], v2 offset:43008
 s_add_u32 s29, s33, 6144
M v[64:67], a[80:83], a[144:147], v[64:67]
 s_cbranch_vccnz L_fhs0
L_fhr0:
 ds_read_b128 a[108:111], v2 offset:44032
 s_add_u32 s30, s33, 20480
M v[64:67], a[84:87], a[148:151], v[64:67]
 buffer_load_dword v25, v14, s[8:11], s65 offen sc1
M v[64:67], a[88:91], a[152:155], v[64:67]
 ds_read_b128 a[112:115], v2 offset:45056
 v_fma_f32 v96, v96, v5, v28
M v[64:67], a[92:95], a[156:159], v[64:67]
 ds_read_b128 a[116:119], v2 offset:46080
 v_fma_f32 v97, v97, v5, v28
M v[68:71], a[92:95], a[188:191], v[36:39]
 v_fma_f32 v98, v98, v5, v28
 v_fma_f32 v99, v99, v5, v28
M v[68:71], a[88:91], a[184:187], v[68:71]
 ds_read_b128 a[120:123], v2 offset:47104
 v_fma_f32 v104, v104, v5, v28
M v[68:71], a[84:87], a[180:183], v[68:71]
 ds_read_b128 a[124:127], v2 offset:48128
 v_fma_f32 v105, v105, v5, v28
M v[68:71], a[80:83], a[176:179], v[68:71]
 v_fma_f32 v106, v106, v5, v28
 v_fma_f32 v107, v107, v5, v28
M v[68:71], a[76:79], a[172:175], v[68:71]
 v_cvt_pk_bf16_f32 v96, v96, v97
M v[68:71], a[72:75], a[168:171], v[68:71]
 v_cvt_pk_bf16_f32 v97, v98, v99
M v[68:71], a[68:71], a[164:167], v[68:71]
 v_cvt_pk_bf16_f32 v98, v104, v105
M v[68:71], a[64:67], a[160:163], v[68:71]
 s_waitcnt lgkmcnt(0)
 v_cvt_pk_bf16_f32 v99, v106, v107
M v[72:75], a[96:99], a[128:131], v[32:35]
 ds_read_b128 a[64:67], v2 offset:49152
M v[72:75], a[100:103], a[132:135], v[72:75]
 ds_read_b128 a[68:71], v2 offset:50176
M v[72:75], a[104:107], a[136:139], v[72:75]
 buffer_store_dwordx4 v[96:99], v7, s[8:11], s29 offen offset:0 sc1
M v[72:75], a[108:111], a[140:143], v[72:75]
 ds_read_b128 a[72:75], v2 offset:51200
 v_fma_f32 v100, v100, v6, v29
M v[72:75], a[112:115], a[144:147], v[72:75]
 ds_read_b128 a[76:79], v2 offset:52224
 v_fma_f32 v101, v101, v6, v29
M v[72:75], a[116:119], a[148:151], v[72:75]
 v_fma_f32 v102, v102, v6, v29
 v_fma_f32 v103, v103, v6, v29
M v[72:75], a[120:123], a[152:155], v[72:75]
 ds_read_b128 a[80:83], v2 offset:53248
 v_fma_f32 v108, v108, v6, v29
M v[72:75], a[124:127], a[156:159], v[72:75]
 ds_read_b128 a[84:87], v2 offset:54272
 v_fma_f32 v109, v109, v6, v29
M v[76:79], a[124:127], a[188:191], v[36:39]
 v_fma_f32 v110, v110, v6, v29
 v_fma_f32 v111, v111, v6, v29
M v[76:79], a[120:123], a[184:187], v[76:79]
 ds_read_b128 a[88:91], v2 offset:55296
 v_cvt_pk_bf16_f32 v100, v100, v101
M v[76:79], a[116:119], a[180:183], v[76:79]
 ds_read_b128 a[92:95], v2 offset:56320
 v_cvt_pk_bf16_f32 v101, v102, v103
M v[76:79], a[112:115], a[176:179], v[76:79]
 v_cvt_pk_bf16_f32 v102, v108, v109
M v[76:79], a[108:111], a[172:175], v[76:79]
 v_cvt_pk_bf16_f32 v103, v110, v111
M v[76:79], a[104:107], a[168:171], v[76:79]
 buffer_store_dwordx4 v[100:103], v7, s[8:11], s30 offen offset:0 sc1
M v[76:79], a[100:103], a[164:167], v[76:79]
M v[76:79], a[96:99], a[160:163], v[76:79]
 s_waitcnt lgkmcnt(0)
 v_fma_f32 v112, v112, v5, v28
M v[80:83], a[64:67], a[128:131], v[32:35]
 ds_read_b128 a[96:99], v2 offset:57344
 v_fma_f32 v113, v113, v5, v28
M v[80:83], a[68:71], a[132:135], v[80:83]
 ds_read_b128 a[100:103], v2 offset:58368
 v_fma_f32 v114, v114, v5, v28
M v[80:83], a[72:75], a[136:139], v[80:83]
 v_fma_f32 v115, v115, v5, v28
M v[80:83], a[76:79], a[140:143], v[80:83]
 ds_read_b128 a[104:107], v2 offset:59392
 v_fma_f32 v120, v120, v5, v28
M v[80:83], a[80:83], a[144:147], v[80:83]
 ds_read_b128 a[108:111], v2 offset:60416
 v_fma_f32 v121, v121, v5, v28
M v[80:83], a[84:87], a[148:151], v[80:83]
 v_fma_f32 v122, v122, v5, v28
M v[80:83], a[88:91], a[152:155], v[80:83]
 ds_read_b128 a[112:115], v2 offset:61440
 v_fma_f32 v123, v123, v5, v28
M v[80:83], a[92:95], a[156:159], v[80:83]
 ds_read_b128 a[116:119], v2 offset:62464
 v_cvt_pk_bf16_f32 v112, v112, v113
M v[84:87], a[92:95], a[188:191], v[36:39]
 v_cvt_pk_bf16_f32 v113, v114, v115
 v_cvt_pk_bf16_f32 v114, v120, v121
M v[84:87], a[88:91], a[184:187], v[84:87]
 ds_read_b128 a[120:123], v2 offset:63488
 v_cvt_pk_bf16_f32 v115, v122, v123
M v[84:87], a[84:87], a[180:183], v[84:87]
 ds_read_b128 a[124:127], v2 offset:64512
M v[84:87], a[80:83], a[176:179], v[84:87]
 buffer_store_dwordx4 v[112:115], v7, s[8:11], s29 offen offset:1024 sc1
M v[84:87], a[76:79], a[172:175], v[84:87]
 v_fma_f32 v116, v116, v6, v29
M v[84:87], a[72:75], a[168:171], v[84:87]
 v_fma_f32 v117, v117, v6, v29
M v[84:87], a[68:71], a[164:167], v[84:87]
 s_waitcnt vmcnt(19) lgkmcnt(0)
 v_fma_f32 v118, v118, v6, v29
M v[84:87], a[64:67], a[160:163], v[84:87]
 s_barrier
M v[88:91], a[96:99], a[128:131], v[32:35]
 ds_read_b128 a[64:67], v7 offset:32768
 v_fma_f32 v119, v119, v6, v29
M v[88:91], a[100:103], a[132:135], v[88:91]
 ds_read_b128 a[68:71], v7 offset:33792
 v_fma_f32 v124, v124, v6, v29
M v[88:91], a[104:107], a[136:139], v[88:91]
 v_fma_f32 v125, v125, v6, v29
 v_fma_f32 v126, v126, v6, v29
M v[88:91], a[108:111], a[140:143], v[88:91]
 ds_read_b128 a[72:75], v7 offset:34816
 v_fma_f32 v127, v127, v6, v29
M v[88:91], a[112:115], a[144:147], v[88:91]
 ds_read_b128 a[76:79], v7 offset:35840
 v_cvt_pk_bf16_f32 v116, v116, v117
M v[88:91], a[116:119], a[148:151], v[88:91]
 v_cvt_pk_bf16_f32 v117, v118, v119
M v[88:91], a[120:123], a[152:155], v[88:91]
 ds_read_b128 a[80:83], v7 offset:36864
 v_cvt_pk_bf16_f32 v118, v124, v125
M v[88:91], a[124:127], a[156:159], v[88:91]
 ds_read_b128 a[84:87], v7 offset:37888
 v_cvt_pk_bf16_f32 v119, v126, v127
M v[92:95], a[124:127], a[188:191], v[36:39]
 buffer_store_dwordx4 v[116:119], v7, s[8:11], s30 offen offset:1024 sc1
M v[92:95], a[120:123], a[184:187], v[92:95]
 ds_read_b128 a[88:91], v7 offset:38912
M v[92:95], a[116:119], a[180:183], v[92:95]
 ds_read_b128 a[92:95], v7 offset:39936
M v[92:95], a[112:115], a[176:179], v[92:95]
M v[92:95], a[108:111], a[172:175], v[92:95]
M v[92:95], a[104:107], a[168:171], v[92:95]
M v[92:95], a[100:103], a[164:167], v[92:95]
 s_waitcnt lgkmcnt(0)
M v[92:95], a[96:99], a[160:163], v[92:95]
M v[96:99], a[64:67], a[128:131], v[32:35]
 ds_read_b128 a[96:99], v7 offset:40960
M v[96:99], a[68:71], a[132:135], v[96:99]
 ds_read_b128 a[100:103], v7 offset:41984
M v[96:99], a[72:75], a[136:139], v[96:99]
M v[96:99], a[76:79], a[140:143], v[96:99]
 ds_read_b128 a[104:107], v7 offset:43008
 s_add_u32 s29, s33, 8192
M v[96:99], a[80:83], a[144:147], v[96:99]
 ds_read_b128 a[108:111], v7 offset:44032
 s_add_u32 s30, s33, 22528
M v[96:99], a[84:87], a[148:151], v[96:99]
 v_fma_f32 v64, v64, v5, v28
 v_fma_f32 v65, v65, v5, v28
M v[96:99], a[88:91], a[152:155], v[96:99]
 ds_read_b128 a[112:115], v7 offset:45056
 v_fma_f32 v66, v66, v5, v28
M v[96:99], a[92:95], a[156:159], v[96:99]
 ds_read_b128 a[116:119], v7 offset:46080
 v_fma_f32 v67, v67, v5, v28
M v[100:103], a[92:95], a[188:191], v[36:39]
 v_fma_f32 v72, v72, v5, v28
M v[100:103], a[88:91], a[184:187], v[100:103]
 ds_read_b128 a[120:123], v7 offset:47104
 v_fma_f32 v73, v73, v5, v28
M v[100:103], a[84:87], a[180:183], v[100:103]
 ds_read_b128 a[124:127], v7 offset:48128
 v_fma_f32 v74, v74, v5, v28
M v[100:103], a[80:83], a[176:179], v[100:103]
 v_fma_f32 v75, v75, v5, v28
M v[100:103], a[76:79], a[172:175], v[100:103]
 v_cvt_pk_bf16_f32 v64, v64, v65
M v[100:103], a[72:75], a[168:171], v[100:103]
 v_cvt_pk_bf16_f32 v65, v66, v67
M v[100:103], a[68:71], a[164:167], v[100:103]
 v_cvt_pk_bf16_f32 v66, v72, v73
M v[100:103], a[64:67], a[160:163], v[100:103]
 s_waitcnt lgkmcnt(0)
 v_cvt_pk_bf16_f32 v67, v74, v75
M v[104:107], a[96:99], a[128:131], v[32:35]
 ds_read_b128 a[64:67], v7 offset:49152
M v[104:107], a[100:103], a[132:135], v[104:107]
 ds_read_b128 a[68:71], v7 offset:50176
M v[104:107], a[104:107], a[136:139], v[104:107]
 buffer_store_dwordx4 v[64:67], v7, s[8:11], s29 offen offset:0 sc1
M v[104:107], a[108:111], a[140:143], v[104:107]
 ds_read_b128 a[72:75], v7 offset:51200
 v_fma_f32 v68, v68, v6, v29
M v[104:107], a[112:115], a[144:147], v[104:107]
 ds_read_b128 a[76:79], v7 offset:52224
 v_fma_f32 v69, v69, v6, v29
M v[104:107], a[116:119], a[148:151], v[104:107]
 v_fma_f32 v70, v70, v6, v29
 v_fma_f32 v71, v71, v6, v29
M v[104:107], a[120:123], a[152:155], v[104:107]
 ds_read_b128 a[80:83], v7 offset:53248
 v_fma_f32 v76, v76, v6, v29
M v[104:107], a[124:127], a[156:159], v[104:107]
 ds_read_b128 a[84:87], v7 offset:54272
 v_fma_f32 v77, v77, v6, v29
M v[108:111], a[124:127], a[188:191], v[36:39]
 v_fma_f32 v78, v78, v6, v29
 v_fma_f32 v79, v79, v6, v29
M v[108:111], a[120:123], a[184:187], v[108:111]
 ds_read_b128 a[88:91], v7 offset:55296
 v_cvt_pk_bf16_f32 v68, v68, v69
M v[108:111], a[116:119], a[180:183], v[108:111]
 ds_read_b128 a[92:95], v7 offset:56320
 v_cvt_pk_bf16_f32 v69, v70, v71
M v[108:111], a[112:115], a[176:179], v[108:111]
 v_cvt_pk_bf16_f32 v70, v76, v77
M v[108:111], a[108:111], a[172:175], v[108:111]
 v_cvt_pk_bf16_f32 v71, v78, v79
M v[108:111], a[104:107], a[168:171], v[108:111]
 buffer_store_dwordx4 v[68:71], v7, s[8:11], s30 offen offset:0 sc1
M v[108:111], a[100:103], a[164:167], v[108:111]
M v[108:111], a[96:99], a[160:163], v[108:111]
 s_waitcnt lgkmcnt(0)
 v_fma_f32 v80, v80, v5, v28
M v[112:115], a[64:67], a[128:131], v[32:35]
 ds_read_b128 a[96:99], v7 offset:57344
 v_fma_f32 v81, v81, v5, v28
M v[112:115], a[68:71], a[132:135], v[112:115]
 ds_read_b128 a[100:103], v7 offset:58368
 v_fma_f32 v82, v82, v5, v28
M v[112:115], a[72:75], a[136:139], v[112:115]
 v_fma_f32 v83, v83, v5, v28
M v[112:115], a[76:79], a[140:143], v[112:115]
 ds_read_b128 a[104:107], v7 offset:59392
 v_fma_f32 v88, v88, v5, v28
M v[112:115], a[80:83], a[144:147], v[112:115]
 ds_read_b128 a[108:111], v7 offset:60416
 v_fma_f32 v89, v89, v5, v28
M v[112:115], a[84:87], a[148:151], v[112:115]
 v_fma_f32 v90, v90, v5, v28
M v[112:115], a[88:91], a[152:155], v[112:115]
 ds_read_b128 a[112:115], v7 offset:61440
 v_fma_f32 v91, v91, v5, v28
M v[112:115], a[92:95], a[156:159], v[112:115]
 ds_read_b128 a[116:119], v7 offset:62464
 v_cvt_pk_bf16_f32 v80, v80, v81
M v[116:119], a[92:95], a[188:191], v[36:39]
 s_waitcnt vmcnt(6)
 v_readlane_b32 s84, v25, 0
 v_readlane_b32 s85, v25, 1
M v[116:119], a[88:91], a[184:187], v[116:119]
 ds_read_b128 a[120:123], v7 offset:63488
 v_mov_b32 v24, 0x3f80
M v[116:119], a[84:87], a[180:183], v[116:119]
 ds_read_b128 a[124:127], v7 offset:64512
 v_mov_b32 v25, 0x3f800000
M v[116:119], a[80:83], a[176:179], v[116:119]
 v_cvt_pk_bf16_f32 v81, v82, v83
 v_cvt_pk_bf16_f32 v82, v88, v89
M v[116:119], a[76:79], a[172:175], v[116:119]
 v_cvt_pk_bf16_f32 v83, v90, v91
M v[116:119], a[72:75], a[168:171], v[116:119]
 buffer_store_dwordx4 v[80:83], v7, s[8:11], s29 offen offset:1024 sc1
M v[116:119], a[68:71], a[164:167], v[116:119]
 s_waitcnt lgkmcnt(0)
 v_fma_f32 v84, v84, v6, v29
 v_fma_f32 v85, v85, v6, v29
M v[116:119], a[64:67], a[160:163], v[116:119]
 s_barrier
M v[120:123], a[96:99], a[128:131], v[32:35]
 ds_read_b128 a[64:67], v2 offset:0
 v_fma_f32 v86, v86, v6, v29
M v[120:123], a[100:103], a[132:135], v[120:123]
 ds_read_b128 a[68:71], v2 offset:1024
 v_fma_f32 v87, v87, v6, v29
M v[120:123], a[104:107], a[136:139], v[120:123]
 v_fma_f32 v92, v92, v6, v29
 v_fma_f32 v93, v93, v6, v29
M v[120:123], a[108:111], a[140:143], v[120:123]
 ds_read_b128 a[72:75], v2 offset:2048
 v_fma_f32 v94, v94, v6, v29
M v[120:123], a[112:115], a[144:147], v[120:123]
 ds_read_b128 a[76:79], v2 offset:3072
 v_fma_f32 v95, v95, v6, v29
M v[120:123], a[116:119], a[148:151], v[120:123]
 s_waitcnt vmcnt(3)
 v_cvt_pk_bf16_f32 v84, v84, v85
 v_cvt_pk_bf16_f32 v85, v86, v87
M v[120:123], a[120:123], a[152:155], v[120:123]
 ds_read_b128 a[80:83], v2 offset:4096
 v_cvt_pk_bf16_f32 v86, v92, v93
M v[120:123], a[124:127], a[156:159], v[120:123]
 ds_read_b128 a[84:87], v2 offset:5120
 v_cvt_pk_bf16_f32 v87, v94, v95
M v[124:127], a[124:127], a[188:191], v[36:39]
 buffer_store_dword v15, v16, s[8:11], s45 offen sc1
M v[124:127], a[120:123], a[184:187], v[124:127]
 ds_read_b128 a[88:91], v2 offset:6144
M v[124:127], a[116:119], a[180:183], v[124:127]
 ds_read_b128 a[92:95], v2 offset:7168
M v[124:127], a[112:115], a[176:179], v[124:127]
 buffer_store_dwordx4 v[84:87], v7, s[8:11], s30 offen offset:1024 sc1
M v[124:127], a[108:111], a[172:175], v[124:127]
M v[124:127], a[104:107], a[168:171], v[124:127]
M v[124:127], a[100:103], a[164:167], v[124:127]
 s_waitcnt lgkmcnt(0)
M v[124:127], a[96:99], a[160:163], v[124:127]
M v[64:67], a[64:67], a[128:131], v[32:35]
 ds_read_b128 a[96:99], v2 offset:8192
M v[64:67], a[68:71], a[132:135], v[64:67]
 ds_read_b128 a[100:103], v2 offset:9216
M v[64:67], a[72:75], a[136:139], v[64:67]
M v[64:67], a[76:79], a[140:143], v[64:67]
 ds_read_b128 a[104:107], v2 offset:10240
 s_add_u32 s29, s33, 10240
M v[64:67], a[80:83], a[144:147], v[64:67]
 ds_read_b128 a[108:111], v2 offset:11264
 s_add_u32 s30, s33, 24576
M v[64:67], a[84:87], a[148:151], v[64:67]
 v_fma_f32 v96, v96, v5, v28
 v_fma_f32 v97, v97, v5, v28
M v[64:67], a[88:91], a[152:155], v[64:67]
 ds_read_b128 a[112:115], v2 offset:12288
 v_fma_f32 v98, v98, v5, v28
M v[64:67], a[92:95], a[156:159], v[64:67]
 ds_read_b128 a[116:119], v2 offset:13312
 v_fma_f32 v99, v99, v5, v28
M v[68:71], a[92:95], a[188:191], v[36:39]
 v_fma_f32 v104, v104, v5, v28
 v_fma_f32 v105, v105, v5, v28
M v[68:71], a[88:91], a[184:187], v[68:71]
 ds_read_b128 a[120:123], v2 offset:14336
 v_fma_f32 v106, v106, v5, v28
M v[68:71], a[84:87], a[180:183], v[68:71]
 ds_read_b128 a[124:127], v2 offset:15360
 v_fma_f32 v107, v107, v5, v28
M v[68:71], a[80:83], a[176:179], v[68:71]
 v_cvt_pk_bf16_f32 v96, v96, v97
 v_cvt_pk_bf16_f32 v97, v98, v99
M v[68:71], a[76:79], a[172:175], v[68:71]
 v_cvt_pk_bf16_f32 v98, v104, v105
 v_cvt_pk_bf16_f32 v99, v106, v107
M v[68:71], a[72:75], a[168:171], v[68:71]
 buffer_store_dwordx4 v[96:99], v7, s[8:11], s29 offen offset:0 sc1
M v[68:71], a[68:71], a[164:167], v[68:71]
 v_fma_f32 v100, v100, v6, v29
 v_fma_f32 v101, v101, v6, v29
M v[68:71], a[64:67], a[160:163], v[68:71]
 s_waitcnt lgkmcnt(0)
 v_fma_f32 v102, v102, v6, v29
 v_fma_f32 v103, v103, v6, v29
M v[72:75], a[96:99], a[128:131], v[32:35]
 ds_read_b128 a[64:67], v2 offset:16384
 v_fma_f32 v108, v108, v6, v29
M v[72:75], a[100:103], a[132:135], v[72:75]
 ds_read_b128 a[68:71], v2 offset:17408
 v_fma_f32 v109, v109, v6, v29
M v[72:75], a[104:107], a[136:139], v[72:75]
 v_fma_f32 v110, v110, v6, v29
 v_fma_f32 v111, v111, v6, v29
M v[72:75], a[108:111], a[140:143], v[72:75]
 ds_read_b128 a[72:75], v2 offset:18432
 v_cvt_pk_bf16_f32 v100, v100, v101
M v[72:75], a[112:115], a[144:147], v[72:75]
 ds_read_b128 a[76:79], v2 offset:19456
 v_cvt_pk_bf16_f32 v101, v102, v103
M v[72:75], a[116:119], a[148:151], v[72:75]
 v_cvt_pk_bf16_f32 v102, v108, v109
 v_cvt_pk_bf16_f32 v103, v110, v111
M v[72:75], a[120:123], a[152:155], v[72:75]
 ds_read_b128 a[80:83], v2 offset:20480
M v[72:75], a[124:127], a[156:159], v[72:75]
 ds_read_b128 a[84:87], v2 offset:21504
M v[76:79], a[124:127], a[188:191], v[36:39]
 buffer_store_dwordx4 v[100:103], v7, s[8:11], s30 offen offset:0 sc1
M v[76:79], a[120:123], a[184:187], v[76:79]
 ds_read_b128 a[88:91], v2 offset:22528
 v_fma_f32 v112, v112, v5, v28
M v[76:79], a[116:119], a[180:183], v[76:79]
 ds_read_b128 a[92:95], v2 offset:23552
 v_fma_f32 v113, v113, v5, v28
M v[76:79], a[112:115], a[176:179], v[76:79]
 v_fma_f32 v114, v114, v5, v28
 v_fma_f32 v115, v115, v5, v28
M v[76:79], a[108:111], a[172:175], v[76:79]
 v_fma_f32 v120, v120, v5, v28
 v_fma_f32 v121, v121, v5, v28
M v[76:79], a[104:107], a[168:171], v[76:79]
 v_fma_f32 v122, v122, v5, v28
 v_fma_f32 v123, v123, v5, v28
M v[76:79], a[100:103], a[164:167], v[76:79]
 v_cvt_pk_bf16_f32 v112, v112, v113
 v_cvt_pk_bf16_f32 v113, v114, v115
M v[76:79], a[96:99], a[160:163], v[76:79]
 s_waitcnt lgkmcnt(0)
 v_cvt_pk_bf16_f32 v114, v120, v121
 v_cvt_pk_bf16_f32 v115, v122, v123
M v[80:83], a[64:67], a[128:131], v[32:35]
 ds_read_b128 a[96:99], v2 offset:24576
M v[80:83], a[68:71], a[132:135], v[80:83]
 ds_read_b128 a[100:103], v2 offset:25600
M v[80:83], a[72:75], a[136:139], v[80:83]
 buffer_store_dwordx4 v[112:115], v7, s[8:11], s29 offen offset:1024 sc1
M v[80:83], a[76:79], a[140:143], v[80:83]
 ds_read_b128 a[104:107], v2 offset:26624
 v_fma_f32 v116, v116, v6, v29
M v[80:83], a[80:83], a[144:147], v[80:83]
 ds_read_b128 a[108:111], v2 offset:27648
 v_fma_f32 v117, v117, v6, v29
M v[80:83], a[84:87], a[148:151], v[80:83]
 v_fma_f32 v118, v118, v6, v29
 v_fma_f32 v119, v119, v6, v29
M v[80:83], a[88:91], a[152:155], v[80:83]
 ds_read_b128 a[112:115], v2 offset:28672
 v_fma_f32 v124, v124, v6, v29
M v[80:83], a[92:95], a[156:159], v[80:83]
 ds_read_b128 a[116:119], v2 offset:29696
 v_fma_f32 v125, v125, v6, v29
M v[84:87], a[92:95], a[188:191], v[36:39]
 v_fma_f32 v126, v126, v6, v29
 v_fma_f32 v127, v127, v6, v29
M v[84:87], a[88:91], a[184:187], v[84:87]
 ds_read_b128 a[120:123], v2 offset:30720
 v_cvt_pk_bf16_f32 v116, v116, v117
M v[84:87], a[84:87], a[180:183], v[84:87]
 ds_read_b128 a[124:127], v2 offset:31744
 v_cvt_pk_bf16_f32 v117, v118, v119
M v[84:87], a[80:83], a[176:179], v[84:87]
 v_cvt_pk_bf16_f32 v118, v124, v125
 v_cvt_pk_bf16_f32 v119, v126, v127
M v[84:87], a[76:79], a[172:175], v[84:87]
 buffer_store_dwordx4 v[116:119], v7, s[8:11], s30 offen offset:1024 sc1
M v[84:87], a[72:75], a[168:171], v[84:87]
 s_add_u32 s29, s33, 12288
M v[84:87], a[68:71], a[164:167], v[84:87]
 s_add_u32 s30, s33, 26624
 v_fma_f32 v64, v64, v5, v28
 v_fma_f32 v65, v65, v5, v28
M v[84:87], a[64:67], a[160:163], v[84:87]
 s_waitcnt lgkmcnt(0)
 v_fma_f32 v66, v66, v5, v28
 v_fma_f32 v67, v67, v5, v28
M v[88:91], a[96:99], a[128:131], v[32:35]
 v_fma_f32 v72, v72, v5, v28
 v_fma_f32 v73, v73, v5, v28
M v[88:91], a[100:103], a[132:135], v[88:91]
 v_fma_f32 v74, v74, v5, v28
 v_fma_f32 v75, v75, v5, v28
M v[88:91], a[104:107], a[136:139], v[88:91]
 v_cvt_pk_bf16_f32 v64, v64, v65
 v_cvt_pk_bf16_f32 v65, v66, v67
M v[88:91], a[108:111], a[140:143], v[88:91]
 v_cvt_pk_bf16_f32 v66, v72, v73
 v_cvt_pk_bf16_f32 v67, v74, v75
M v[88:91], a[112:115], a[144:147], v[88:91]
 buffer_store_dwordx4 v[64:67], v7, s[8:11], s29 offen offset:0 sc1
M v[88:91], a[116:119], a[148:151], v[88:91]
 v_fma_f32 v68, v68, v6, v29
 v_fma_f32 v69, v69, v6, v29
M v[88:91], a[120:123], a[152:155], v[88:91]
 v_fma_f32 v70, v70, v6, v29
 v_fma_f32 v71, v71, v6, v29
M v[88:91], a[124:127], a[156:159], v[88:91]
 v_fma_f32 v76, v76, v6, v29
 v_fma_f32 v77, v77, v6, v29
M v[92:95], a[124:127], a[188:191], v[36:39]
 v_fma_f32 v78, v78, v6, v29
 v_fma_f32 v79, v79, v6, v29
M v[92:95], a[120:123], a[184:187], v[92:95]
 v_cvt_pk_bf16_f32 v68, v68, v69
 v_cvt_pk_bf16_f32 v69, v70, v71
M v[92:95], a[116:119], a[180:183], v[92:95]
 v_cvt_pk_bf16_f32 v70, v76, v77
 v_cvt_pk_bf16_f32 v71, v78, v79
M v[92:95], a[112:115], a[176:179], v[92:95]
 buffer_store_dwordx4 v[68:71], v7, s[8:11], s30 offen offset:0 sc1
M v[92:95], a[108:111], a[172:175], v[92:95]
M v[92:95], a[104:107], a[168:171], v[92:95]
M v[92:95], a[100:103], a[164:167], v[92:95]
M v[92:95], a[96:99], a[160:163], v[92:95]
 v_fma_f32 v80, v80, v5, v28
 v_fma_f32 v81, v81, v5, v28
 v_fma_f32 v82, v82, v5, v28
 v_fma_f32 v83, v83, v5, v28
 v_fma_f32 v88, v88, v5, v28
 v_fma_f32 v89, v89, v5, v28
 v_fma_f32 v90, v90, v5, v28
 v_fma_f32 v91, v91, v5, v28
 v_cvt_pk_bf16_f32 v80, v80, v81
 v_cvt_pk_bf16_f32 v81, v82, v83
 v_cvt_pk_bf16_f32 v82, v88, v89
 v_cvt_pk_bf16_f32 v83, v90, v91
 buffer_store_dwordx4 v[80:83], v7, s[8:11], s29 offen offset:1024 sc1
 v_fma_f32 v84, v84, v6, v29
 v_fma_f32 v85, v85, v6, v29
 v_fma_f32 v86, v86, v6, v29
 v_fma_f32 v87, v87, v6, v29
 v_fma_f32 v92, v92, v6, v29
 v_fma_f32 v93, v93, v6, v29
 v_fma_f32 v94, v94, v6, v29
 v_fma_f32 v95, v95, v6, v29
 v_cvt_pk_bf16_f32 v84, v84, v85
 v_cvt_pk_bf16_f32 v85, v86, v87
 v_cvt_pk_bf16_f32 v86, v92, v93
 v_cvt_pk_bf16_f32 v87, v94, v95
 buffer_store_dwordx4 v[84:87], v7, s[8:11], s30 offen offset:1024 sc1
 s_waitcnt vmcnt(0)
 buffer_store_dword v15, v16, s[8:11], s3 offen sc1
L_red:
 s_lshl_b32 s64, s42, 1
 s_lshr_b32 s65, s41, 3
 s_add_u32 s46, s64, s65
 s_mul_i32 s46, s46, 4352
 s_and_b32 s72, s41, 7
 s_lshl_b32 s66, s72, 7
 s_add_u32 s46, s46, s66
 s_add_u32 s46, s46, 104992768
 v_and_b32 v14, 31, v0
 v_lshlrev_b32 v14, 2, v14
 buffer_load_dword v9, v14, s[8:11], s46 offen sc1
 s_mul_i32 s86, s65, 4
 s_add_u32 s86, s86, s20
 s_mul_i32 s77, s42, 1835008
 s_mul_i32 s78, s72, 14336
 s_add_u32 s77, s77, s78
 s_add_u32 s77, s77, 67108864
 s_sub_u32 s64, 15, s64
 s_sub_u32 s78, s64, 1
 s_mul_i32 s78, s78, 1835008
 s_add_u32 s78, s78, s77
 s_lshl_b32 s66, s86, 10
 s_add_u32 s78, s78, s66
 s_lshl_b32 s66, s74, 10
 s_add_u32 s77, s77, s66
 s_lshl_b32 s66, s64, 7
 s_lshl_b32 s86, s86, 6
 s_lshr_b32 s73, s72, 1
 s_sub_u32 s65, 7, s73
 s_bitcmp1_b32 s72, 0
 s_cselect_b32 s73, s65, s73
 s_lshl_b32 s73, s73, 4
 s_lshl_b32 s65, s42, 7
 s_add_u32 s73, s73, s65
 v_and_b32 v10, 15, v0
 v_add_u32 v10, s73, v10
 v_add_u32 v29, s66, v10
 s_mov_b32 s64, 104857664
 v_mul_u32_u24 v12, 896, v10
 v_lshl_add_u32 v12, v11, 4, v12
 v_lshrrev_b32 v13, 4, v10
 v_lshlrev_b32 v13, 5, v13
 v_and_b32 v104, 15, v10
 v_add_lshl_u32 v13, v13, v104, 2
 buffer_load_dword v15, v13, s[8:11], s64 offen sc1
 buffer_load_dwordx4 v[16:19], v12, s[56:59], s75 offen
 buffer_load_dwordx4 v[20:23], v12, s[56:59], s76 offen
 v_mov_b32 v48, 0
 v_mov_b32 v49, 0
 v_mov_b32 v50, 0
 v_mov_b32 v51, 0
 v_mov_b32 v52, 0
 v_mov_b32 v53, 0
 v_mov_b32 v54, 0
 v_mov_b32 v55, 0
 v_mov_b32 v56, 0
 v_mov_b32 v57, 0
 v_mov_b32 v58, 0
 v_mov_b32 v59, 0
 v_mov_b32 v60, 0
 v_mov_b32 v61, 0
 v_mov_b32 v62, 0
 v_mov_b32 v63, 0
 v_mul_u32_u24 v28, 896, v29
 v_lshl_add_u32 v28, v11, 4, v28
 v_lshrrev_b32 v13, 4, v29
 v_lshlrev_b32 v13, 5, v13
 v_and_b32 v104, 15, v29
 v_add_lshl_u32 v13, v13, v104, 2
 buffer_load_dword v26, v13, s[8:11], s64 offen sc1
 buffer_load_dwordx4 v[96:99], v28, s[56:59], s86 offen
 v_mov_b32 v64, 0
 v_mov_b32 v65, 0
 v_mov_b32 v66, 0
 v_mov_b32 v67, 0
 v_mov_b32 v68, 0
 v_mov_b32 v69, 0
 v_mov_b32 v70, 0
 v_mov_b32 v71, 0
 s_waitcnt vmcnt(5)
 v_cmp_eq_u32 vcc, 1, v9
 s_mov_b32 s91, 65536
 s_mov_b32 s69, 0
 s_mov_b32 s70, vcc_lo
 s_mov_b32 s68, vcc_lo
 s_cmp_lg_u32 s70, 0
 s_cbranch_scc1 L_rk0
 s_call_b64 s[36:37], L_rpoll
L_rk0:
 s_ff1_i32_b32 s71, s70
 s_bitset0_b32 s70, s71
 s_cmp_ge_u32 s71, 16
 s_cselect_b32 s72, s78, s77
 s_cselect_b32 s73, 0x1, 0
 s_cselect_b32 s87, 536870912, 0
 s_mul_i32 s71, s71, 114688
 s_add_u32 s71, s71, s72
 buffer_load_dwordx4 v[128:131], v7, s[8:11], s71 offen sc1
 s_or_b32 s69, s69, s73
 s_or_b32 s71, s71, s87
 buffer_load_dwordx4 v[132:135], v27, s[8:11], s71 offen sc1
 s_cmp_lg_u32 s70, 0
 s_cbranch_scc1 L_rk1
 s_call_b64 s[36:37], L_rpoll
L_rk1:
 s_ff1_i32_b32 s71, s70
 s_bitset0_b32 s70, s71
 s_cmp_ge_u32 s71, 16
 s_cselect_b32 s72, s78, s77
 s_cselect_b32 s73, 0x2, 0
 s_cselect_b32 s87, 536870912, 0
 s_mul_i32 s71, s71, 114688
 s_add_u32 s71, s71, s72
 buffer_load_dwordx4 v[136:139], v7, s[8:11], s71 offen sc1
 s_or_b32 s69, s69, s73
 s_or_b32 s71, s71, s87
 buffer_load_dwordx4 v[140:143], v27, s[8:11], s71 offen sc1
 s_waitcnt vmcnt(7)
 v_lshlrev_b32 v32, 16, v16
 v_and_b32 v33, 0xffff0000, v16
 v_lshlrev_b32 v34, 16, v17
 v_and_b32 v35, 0xffff0000, v17
 v_lshlrev_b32 v36, 16, v18
 v_and_b32 v37, 0xffff0000, v18
 v_lshlrev_b32 v38, 16, v19
 v_and_b32 v39, 0xffff0000, v19
 s_waitcnt vmcnt(6)
 v_lshlrev_b32 v40, 16, v20
 v_and_b32 v41, 0xffff0000, v20
 v_lshlrev_b32 v42, 16, v21
 v_and_b32 v43, 0xffff0000, v21
 v_lshlrev_b32 v44, 16, v22
 v_and_b32 v45, 0xffff0000, v22
 v_lshlrev_b32 v46, 16, v23
 v_and_b32 v47, 0xffff0000, v23
 v_sub_f32 v13, 1.0, v15
 v_cmp_eq_u32 s[80:81], s84, v10
 v_cmp_eq_u32 s[82:83], s85, v10
 s_nop 0
 s_or_b64 vcc, s[80:81], s[82:83]
 s_cbranch_vccnz L_moe0
L_moe_ret0:
 v_mul_f32 v32, v13, v32
 v_mul_f32 v33, v13, v33
 v_mul_f32 v34, v13, v34
 v_mul_f32 v35, v13, v35
 v_mul_f32 v36, v13, v36
 v_mul_f32 v37, v13, v37
 v_mul_f32 v38, v13, v38
 v_mul_f32 v39, v13, v39
 v_mul_f32 v40, v13, v40
 v_mul_f32 v41, v13, v41
 v_mul_f32 v42, v13, v42
 v_mul_f32 v43, v13, v43
 v_mul_f32 v44, v13, v44
 v_mul_f32 v45, v13, v45
 v_mul_f32 v46, v13, v46
 v_mul_f32 v47, v13, v47
 s_cmp_lg_u32 s70, 0
 s_cbranch_scc1 L_rk2
 s_call_b64 s[36:37], L_rpoll
L_rk2:
 s_ff1_i32_b32 s71, s70
 s_bitset0_b32 s70, s71
 s_cmp_ge_u32 s71, 16
 s_cselect_b32 s72, s78, s77
 s_cselect_b32 s73, 0x4, 0
 s_cselect_b32 s87, 536870912, 0
 s_mul_i32 s71, s71, 114688
 s_add_u32 s71, s71, s72
 buffer_load_dwordx4 v[144:147], v7, s[8:11], s71 offen sc1
 s_or_b32 s69, s69, s73
 s_or_b32 s71, s71, s87
 buffer_load_dwordx4 v[148:151], v27, s[8:11], s71 offen sc1
 s_waitcnt vmcnt(6)
 v_lshlrev_b32 v80, 16, v96
 v_and_b32 v81, 0xffff0000, v96
 v_lshlrev_b32 v82, 16, v97
 v_and_b32 v83, 0xffff0000, v97
 v_lshlrev_b32 v84, 16, v98
 v_and_b32 v85, 0xffff0000, v98
 v_lshlrev_b32 v86, 16, v99
 v_and_b32 v87, 0xffff0000, v99
 v_sub_f32 v13, 1.0, v26
 v_cmp_eq_u32 s[80:81], s84, v29
 v_cmp_eq_u32 s[82:83], s85, v29
 s_nop 0
 s_or_b64 vcc, s[80:81], s[82:83]
 s_cbranch_vccnz L_moe1
L_moe_ret1:
 v_mul_f32 v80, v13, v80
 v_mul_f32 v81, v13, v81
 v_mul_f32 v82, v13, v82
 v_mul_f32 v83, v13, v83
 v_mul_f32 v84, v13, v84
 v_mul_f32 v85, v13, v85
 v_mul_f32 v86, v13, v86
 v_mul_f32 v87, v13, v87
 s_cmp_lg_u32 s70, 0
 s_cbranch_scc1 L_rk3
 s_call_b64 s[36:37], L_rpoll
L_rk3:
 s_ff1_i32_b32 s71, s70
 s_bitset0_b32 s70, s71
 s_cmp_ge_u32 s71, 16
 s_cselect_b32 s72, s78, s77
 s_cselect_b32 s73, 0x8, 0
 s_cselect_b32 s87, 536870912, 0
 s_mul_i32 s71, s71, 114688
 s_add_u32 s71, s71, s72
 buffer_load_dwordx4 v[152:155], v7, s[8:11], s71 offen sc1
 s_or_b32 s69, s69, s73
 s_or_b32 s71, s71, s87
 buffer_load_dwordx4 v[156:159], v27, s[8:11], s71 offen sc1
 s_cmp_lg_u32 s70, 0
 s_cbranch_scc1 L_rk4
 s_call_b64 s[36:37], L_rpoll
L_rk4:
 s_ff1_i32_b32 s71, s70
 s_bitset0_b32 s70, s71
 s_cmp_ge_u32 s71, 16
 s_cselect_b32 s72, s78, s77
 s_cselect_b32 s73, 0x10, 0
 s_cselect_b32 s87, 536870912, 0
 s_mul_i32 s71, s71, 114688
 s_add_u32 s71, s71, s72
 buffer_load_dwordx4 v[160:163], v7, s[8:11], s71 offen sc1
 s_or_b32 s69, s69, s73
 s_or_b32 s71, s71, s87
 buffer_load_dwordx4 v[164:167], v27, s[8:11], s71 offen sc1
 s_cmp_lg_u32 s70, 0
 s_cbranch_scc1 L_rk5
 s_call_b64 s[36:37], L_rpoll
L_rk5:
 s_ff1_i32_b32 s71, s70
 s_bitset0_b32 s70, s71
 s_cmp_ge_u32 s71, 16
 s_cselect_b32 s72, s78, s77
 s_cselect_b32 s73, 0x20, 0
 s_cselect_b32 s87, 536870912, 0
 s_mul_i32 s71, s71, 114688
 s_add_u32 s71, s71, s72
 buffer_load_dwordx4 v[168:171], v7, s[8:11], s71 offen sc1
 s_or_b32 s69, s69, s73
 s_or_b32 s71, s71, s87
 buffer_load_dwordx4 v[172:175], v27, s[8:11], s71 offen sc1
 s_cmp_lg_u32 s70, 0
 s_cbranch_scc1 L_rk6
 s_call_b64 s[36:37], L_rpoll
L_rk6:
 s_ff1_i32_b32 s71, s70
 s_bitset0_b32 s70, s71
 s_cmp_ge_u32 s71, 16
 s_cselect_b32 s72, s78, s77
 s_cselect_b32 s73, 0x40, 0
 s_cselect_b32 s87, 536870912, 0
 s_mul_i32 s71, s71, 114688
 s_add_u32 s71, s71, s72
 buffer_load_dwordx4 v[176:179], v7, s[8:11], s71 offen sc1
 s_or_b32 s69, s69, s73
 s_or_b32 s71, s71, s87
 buffer_load_dwordx4 v[180:183], v27, s[8:11], s71 offen sc1
 s_waitcnt vmcnt(12)
 s_bitcmp1_b32 s69, 0
 s_cbranch_scc1 L_rx0
 v_dot2c_f32_bf16 v48, v128, v24
 v_dot2c_f32_bf16 v49, v128, v25
 v_dot2c_f32_bf16 v50, v129, v24
 v_dot2c_f32_bf16 v51, v129, v25
 v_dot2c_f32_bf16 v52, v130, v24
 v_dot2c_f32_bf16 v53, v130, v25
 v_dot2c_f32_bf16 v54, v131, v24
 v_dot2c_f32_bf16 v55, v131, v25
 v_dot2c_f32_bf16 v56, v132, v24
 v_dot2c_f32_bf16 v57, v132, v25
 v_dot2c_f32_bf16 v58, v133, v24
 v_dot2c_f32_bf16 v59, v133, v25
 v_dot2c_f32_bf16 v60, v134, v24
 v_dot2c_f32_bf16 v61, v134, v25
 v_dot2c_f32_bf16 v62, v135, v24
 v_dot2c_f32_bf16 v63, v135, v25
L_ry0:
 s_cmp_lg_u32 s70, 0
 s_cbranch_scc1 L_rk7
 s_call_b64 s[36:37], L_rpoll
L_rk7:
 s_ff1_i32_b32 s71, s70
 s_bitset0_b32 s70, s71
 s_cmp_ge_u32 s71, 16
 s_cselect_b32 s72, s78, s77
 s_cselect_b32 s73, 0x80, 0
 s_cselect_b32 s87, 536870912, 0
 s_mul_i32 s71, s71, 114688
 s_add_u32 s71, s71, s72
 buffer_load_dwordx4 v[184:187], v7, s[8:11], s71 offen sc1
 s_or_b32 s69, s69, s73
 s_or_b32 s71, s71, s87
 buffer_load_dwordx4 v[188:191], v27, s[8:11], s71 offen sc1
 s_waitcnt vmcnt(12)
 s_bitcmp1_b32 s69, 1
 s_cbranch_scc1 L_rx1
 v_dot2c_f32_bf16 v48, v136, v24
 v_dot2c_f32_bf16 v49, v136, v25
 v_dot2c_f32_bf16 v50, v137, v24
 v_dot2c_f32_bf16 v51, v137, v25
 v_dot2c_f32_bf16 v52, v138, v24
 v_dot2c_f32_bf16 v53, v138, v25
 v_dot2c_f32_bf16 v54, v139, v24
 v_dot2c_f32_bf16 v55, v139, v25
 v_dot2c_f32_bf16 v56, v140, v24
 v_dot2c_f32_bf16 v57, v140, v25
 v_dot2c_f32_bf16 v58, v141, v24
 v_dot2c_f32_bf16 v59, v141, v25
 v_dot2c_f32_bf16 v60, v142, v24
 v_dot2c_f32_bf16 v61, v142, v25
 v_dot2c_f32_bf16 v62, v143, v24
 v_dot2c_f32_bf16 v63, v143, v25
L_ry1:
 s_cmp_lg_u32 s70, 0
 s_cbranch_scc1 L_rk8
 s_call_b64 s[36:37], L_rpoll
L_rk8:
 s_ff1_i32_b32 s71, s70
 s_bitset0_b32 s70, s71
 s_cmp_ge_u32 s71, 16
 s_cselect_b32 s72, s78, s77
 s_cselect_b32 s73, 0x100, 0
 s_cselect_b32 s87, 536870912, 0
 s_mul_i32 s71, s71, 114688
 s_add_u32 s71, s71, s72
 buffer_load_dwordx4 v[192:195], v7, s[8:11], s71 offen sc1
 s_or_b32 s69, s69, s73
 s_or_b32 s71, s71, s87
 buffer_load_dwordx4 v[196:199], v27, s[8:11], s71 offen sc1
 s_waitcnt vmcnt(12)
 s_bitcmp1_b32 s69, 2
 s_cbranch_scc1 L_rx2
 v_dot2c_f32_bf16 v48, v144, v24
 v_dot2c_f32_bf16 v49, v144, v25
 v_dot2c_f32_bf16 v50, v145, v24
 v_dot2c_f32_bf16 v51, v145, v25
 v_dot2c_f32_bf16 v52, v146, v24
 v_dot2c_f32_bf16 v53, v146, v25
 v_dot2c_f32_bf16 v54, v147, v24
 v_dot2c_f32_bf16 v55, v147, v25
 v_dot2c_f32_bf16 v56, v148, v24
 v_dot2c_f32_bf16 v57, v148, v25
 v_dot2c_f32_bf16 v58, v149, v24
 v_dot2c_f32_bf16 v59, v149, v25
 v_dot2c_f32_bf16 v60, v150, v24
 v_dot2c_f32_bf16 v61, v150, v25
 v_dot2c_f32_bf16 v62, v151, v24
 v_dot2c_f32_bf16 v63, v151, v25
L_ry2:
 s_cmp_lg_u32 s70, 0
 s_cbranch_scc1 L_rk9
 s_call_b64 s[36:37], L_rpoll
L_rk9:
 s_ff1_i32_b32 s71, s70
 s_bitset0_b32 s70, s71
 s_cmp_ge_u32 s71, 16
 s_cselect_b32 s72, s78, s77
 s_cselect_b32 s73, 0x200, 0
 s_cselect_b32 s87, 536870912, 0
 s_mul_i32 s71, s71, 114688
 s_add_u32 s71, s71, s72
 buffer_load_dwordx4 v[200:203], v7, s[8:11], s71 offen sc1
 s_or_b32 s69, s69, s73
 s_or_b32 s71, s71, s87
 buffer_load_dwordx4 v[204:207], v27, s[8:11], s71 offen sc1
 s_waitcnt vmcnt(12)
 s_bitcmp1_b32 s69, 3
 s_cbranch_scc1 L_rx3
 v_dot2c_f32_bf16 v48, v152, v24
 v_dot2c_f32_bf16 v49, v152, v25
 v_dot2c_f32_bf16 v50, v153, v24
 v_dot2c_f32_bf16 v51, v153, v25
 v_dot2c_f32_bf16 v52, v154, v24
 v_dot2c_f32_bf16 v53, v154, v25
 v_dot2c_f32_bf16 v54, v155, v24
 v_dot2c_f32_bf16 v55, v155, v25
 v_dot2c_f32_bf16 v56, v156, v24
 v_dot2c_f32_bf16 v57, v156, v25
 v_dot2c_f32_bf16 v58, v157, v24
 v_dot2c_f32_bf16 v59, v157, v25
 v_dot2c_f32_bf16 v60, v158, v24
 v_dot2c_f32_bf16 v61, v158, v25
 v_dot2c_f32_bf16 v62, v159, v24
 v_dot2c_f32_bf16 v63, v159, v25
L_ry3:
 s_cmp_lg_u32 s70, 0
 s_cbranch_scc1 L_rk10
 s_call_b64 s[36:37], L_rpoll
L_rk10:
 s_ff1_i32_b32 s71, s70
 s_bitset0_b32 s70, s71
 s_cmp_ge_u32 s71, 16
 s_cselect_b32 s72, s78, s77
 s_cselect_b32 s73, 0x400, 0
 s_cselect_b32 s87, 536870912, 0
 s_mul_i32 s71, s71, 114688
 s_add_u32 s71, s71, s72
 buffer_load_dwordx4 v[208:211], v7, s[8:11], s71 offen sc1
 s_or_b32 s69, s69, s73
 s_or_b32 s71, s71, s87
 buffer_load_dwordx4 v[212:215], v27, s[8:11], s71 offen sc1
 s_waitcnt vmcnt(12)
 s_bitcmp1_b32 s69, 4
 s_cbranch_scc1 L_rx4
 v_dot2c_f32_bf16 v48, v160, v24
 v_dot2c_f32_bf16 v49, v160, v25
 v_dot2c_f32_bf16 v50, v161, v24
 v_dot2c_f32_bf16 v51, v161, v25
 v_dot2c_f32_bf16 v52, v162, v24
 v_dot2c_f32_bf16 v53, v162, v25
 v_dot2c_f32_bf16 v54, v163, v24
 v_dot2c_f32_bf16 v55, v163, v25
 v_dot2c_f32_bf16 v56, v164, v24
 v_dot2c_f32_bf16 v57, v164, v25
 v_dot2c_f32_bf16 v58, v165, v24
 v_dot2c_f32_bf16 v59, v165, v25
 v_dot2c_f32_bf16 v60, v166, v24
 v_dot2c_f32_bf16 v61, v166, v25
 v_dot2c_f32_bf16 v62, v167, v24
 v_dot2c_f32_bf16 v63, v167, v25
L_ry4:
 s_cmp_lg_u32 s70, 0
 s_cbranch_scc1 L_rk11
 s_call_b64 s[36:37], L_rpoll
L_rk11:
 s_ff1_i32_b32 s71, s70
 s_bitset0_b32 s70, s71
 s_cmp_ge_u32 s71, 16
 s_cselect_b32 s72, s78, s77
 s_cselect_b32 s73, 0x800, 0
 s_cselect_b32 s87, 536870912, 0
 s_mul_i32 s71, s71, 114688
 s_add_u32 s71, s71, s72
 buffer_load_dwordx4 v[216:219], v7, s[8:11], s71 offen sc1
 s_or_b32 s69, s69, s73
 s_or_b32 s71, s71, s87
 buffer_load_dwordx4 v[220:223], v27, s[8:11], s71 offen sc1
 s_waitcnt vmcnt(12)
 s_bitcmp1_b32 s69, 5
 s_cbranch_scc1 L_rx5
 v_dot2c_f32_bf16 v48, v168, v24
 v_dot2c_f32_bf16 v49, v168, v25
 v_dot2c_f32_bf16 v50, v169, v24
 v_dot2c_f32_bf16 v51, v169, v25
 v_dot2c_f32_bf16 v52, v170, v24
 v_dot2c_f32_bf16 v53, v170, v25
 v_dot2c_f32_bf16 v54, v171, v24
 v_dot2c_f32_bf16 v55, v171, v25
 v_dot2c_f32_bf16 v56, v172, v24
 v_dot2c_f32_bf16 v57, v172, v25
 v_dot2c_f32_bf16 v58, v173, v24
 v_dot2c_f32_bf16 v59, v173, v25
 v_dot2c_f32_bf16 v60, v174, v24
 v_dot2c_f32_bf16 v61, v174, v25
 v_dot2c_f32_bf16 v62, v175, v24
 v_dot2c_f32_bf16 v63, v175, v25
L_ry5:
 s_cmp_lg_u32 s70, 0
 s_cbranch_scc1 L_rk12
 s_call_b64 s[36:37], L_rpoll
L_rk12:
 s_ff1_i32_b32 s71, s70
 s_bitset0_b32 s70, s71
 s_cmp_ge_u32 s71, 16
 s_cselect_b32 s72, s78, s77
 s_cselect_b32 s73, 0x1000, 0
 s_cselect_b32 s87, 536870912, 0
 s_mul_i32 s71, s71, 114688
 s_add_u32 s71, s71, s72
 buffer_load_dwordx4 v[224:227], v7, s[8:11], s71 offen sc1
 s_or_b32 s69, s69, s73
 s_or_b32 s71, s71, s87
 buffer_load_dwordx4 v[228:231], v27, s[8:11], s71 offen sc1
 s_waitcnt vmcnt(12)
 s_bitcmp1_b32 s69, 6
 s_cbranch_scc1 L_rx6
 v_dot2c_f32_bf16 v48, v176, v24
 v_dot2c_f32_bf16 v49, v176, v25
 v_dot2c_f32_bf16 v50, v177, v24
 v_dot2c_f32_bf16 v51, v177, v25
 v_dot2c_f32_bf16 v52, v178, v24
 v_dot2c_f32_bf16 v53, v178, v25
 v_dot2c_f32_bf16 v54, v179, v24
 v_dot2c_f32_bf16 v55, v179, v25
 v_dot2c_f32_bf16 v56, v180, v24
 v_dot2c_f32_bf16 v57, v180, v25
 v_dot2c_f32_bf16 v58, v181, v24
 v_dot2c_f32_bf16 v59, v181, v25
 v_dot2c_f32_bf16 v60, v182, v24
 v_dot2c_f32_bf16 v61, v182, v25
 v_dot2c_f32_bf16 v62, v183, v24
 v_dot2c_f32_bf16 v63, v183, v25
L_ry6:
 s_cmp_lg_u32 s70, 0
 s_cbranch_scc1 L_rk13
 s_call_b64 s[36:37], L_rpoll
L_rk13:
 s_ff1_i32_b32 s71, s70
 s_bitset0_b32 s70, s71
 s_cmp_ge_u32 s71, 16
 s_cselect_b32 s72, s78, s77
 s_cselect_b32 s73, 0x2000, 0
 s_cselect_b32 s87, 536870912, 0
 s_mul_i32 s71, s71, 114688
 s_add_u32 s71, s71, s72
 buffer_load_dwordx4 v[232:235], v7, s[8:11], s71 offen sc1
 s_or_b32 s69, s69, s73
 s_or_b32 s71, s71, s87
 buffer_load_dwordx4 v[236:239], v27, s[8:11], s71 offen sc1
 s_waitcnt vmcnt(12)
 s_bitcmp1_b32 s69, 7
 s_cbranch_scc1 L_rx7
 v_dot2c_f32_bf16 v48, v184, v24
 v_dot2c_f32_bf16 v49, v184, v25
 v_dot2c_f32_bf16 v50, v185, v24
 v_dot2c_f32_bf16 v51, v185, v25
 v_dot2c_f32_bf16 v52, v186, v24
 v_dot2c_f32_bf16 v53, v186, v25
 v_dot2c_f32_bf16 v54, v187, v24
 v_dot2c_f32_bf16 v55, v187, v25
 v_dot2c_f32_bf16 v56, v188, v24
 v_dot2c_f32_bf16 v57, v188, v25
 v_dot2c_f32_bf16 v58, v189, v24
 v_dot2c_f32_bf16 v59, v189, v25
 v_dot2c_f32_bf16 v60, v190, v24
 v_dot2c_f32_bf16 v61, v190, v25
 v_dot2c_f32_bf16 v62, v191, v24
 v_dot2c_f32_bf16 v63, v191, v25
L_ry7:
 s_cmp_lg_u32 s70, 0
 s_cbranch_scc1 L_rk14
 s_call_b64 s[36:37], L_rpoll
L_rk14:
 s_ff1_i32_b32 s71, s70
 s_bitset0_b32 s70, s71
 s_cmp_ge_u32 s71, 16
 s_cselect_b32 s72, s78, s77
 s_cselect_b32 s73, 0x4000, 0
 s_cselect_b32 s87, 536870912, 0
 s_mul_i32 s71, s71, 114688
 s_add_u32 s71, s71, s72
 buffer_load_dwordx4 v[240:243], v7, s[8:11], s71 offen sc1
 s_or_b32 s69, s69, s73
 s_or_b32 s71, s71, s87
 buffer_load_dwordx4 v[244:247], v27, s[8:11], s71 offen sc1
 s_waitcnt vmcnt(12)
 s_bitcmp1_b32 s69, 8
 s_cbranch_scc1 L_rx8
 v_dot2c_f32_bf16 v48, v192, v24
 v_dot2c_f32_bf16 v49, v192, v25
 v_dot2c_f32_bf16 v50, v193, v24
 v_dot2c_f32_bf16 v51, v193, v25
 v_dot2c_f32_bf16 v52, v194, v24
 v_dot2c_f32_bf16 v53, v194, v25
 v_dot2c_f32_bf16 v54, v195, v24
 v_dot2c_f32_bf16 v55, v195, v25
 v_dot2c_f32_bf16 v56, v196, v24
 v_dot2c_f32_bf16 v57, v196, v25
 v_dot2c_f32_bf16 v58, v197, v24
 v_dot2c_f32_bf16 v59, v197, v25
 v_dot2c_f32_bf16 v60, v198, v24
 v_dot2c_f32_bf16 v61, v198, v25
 v_dot2c_f32_bf16 v62, v199, v24
 v_dot2c_f32_bf16 v63, v199, v25
L_ry8:
 s_cmp_lg_u32 s70, 0
 s_cbranch_scc1 L_rk15
 s_call_b64 s[36:37], L_rpoll
L_rk15:
 s_ff1_i32_b32 s71, s70
 s_bitset0_b32 s70, s71
 s_cmp_ge_u32 s71, 16
 s_cselect_b32 s72, s78, s77
 s_cselect_b32 s73, 0x8000, 0
 s_cselect_b32 s87, 536870912, 0
 s_mul_i32 s71, s71, 114688
 s_add_u32 s71, s71, s72
 buffer_load_dwordx4 v[248:251], v7, s[8:11], s71 offen sc1
 s_or_b32 s69, s69, s73
 s_or_b32 s71, s71, s87
 buffer_load_dwordx4 v[252:255], v27, s[8:11], s71 offen sc1
 s_waitcnt vmcnt(12)
 s_bitcmp1_b32 s69, 9
 s_cbranch_scc1 L_rx9
 v_dot2c_f32_bf16 v48, v200, v24
 v_dot2c_f32_bf16 v49, v200, v25
 v_dot2c_f32_bf16 v50, v201, v24
 v_dot2c_f32_bf16 v51, v201, v25
 v_dot2c_f32_bf16 v52, v202, v24
 v_dot2c_f32_bf16 v53, v202, v25
 v_dot2c_f32_bf16 v54, v203, v24
 v_dot2c_f32_bf16 v55, v203, v25
 v_dot2c_f32_bf16 v56, v204, v24
 v_dot2c_f32_bf16 v57, v204, v25
 v_dot2c_f32_bf16 v58, v205, v24
 v_dot2c_f32_bf16 v59, v205, v25
 v_dot2c_f32_bf16 v60, v206, v24
 v_dot2c_f32_bf16 v61, v206, v25
 v_dot2c_f32_bf16 v62, v207, v24
 v_dot2c_f32_bf16 v63, v207, v25
L_ry9:
 s_cmp_lg_u32 s70, 0
 s_cbranch_scc1 L_rk16
 s_call_b64 s[36:37], L_rpoll
L_rk16:
 s_ff1_i32_b32 s71, s70
 s_bitset0_b32 s70, s71
 s_cmp_ge_u32 s71, 16
 s_cselect_b32 s72, s78, s77
 s_cselect_b32 s73, 0x10000, 0
 s_cselect_b32 s87, 536870912, 0
 s_mul_i32 s71, s71, 114688
 s_add_u32 s71, s71, s72
 buffer_load_dwordx4 v[128:131], v7, s[8:11], s71 offen sc1
 s_or_b32 s69, s69, s73
 s_or_b32 s71, s71, s87
 buffer_load_dwordx4 v[132:135], v27, s[8:11], s71 offen sc1
 s_waitcnt vmcnt(12)
 s_bitcmp1_b32 s69, 10
 s_cbranch_scc1 L_rx10
 v_dot2c_f32_bf16 v48, v208, v24
 v_dot2c_f32_bf16 v49, v208, v25
 v_dot2c_f32_bf16 v50, v209, v24
 v_dot2c_f32_bf16 v51, v209, v25
 v_dot2c_f32_bf16 v52, v210, v24
 v_dot2c_f32_bf16 v53, v210, v25
 v_dot2c_f32_bf16 v54, v211, v24
 v_dot2c_f32_bf16 v55, v211, v25
 v_dot2c_f32_bf16 v56, v212, v24
 v_dot2c_f32_bf16 v57, v212, v25
 v_dot2c_f32_bf16 v58, v213, v24
 v_dot2c_f32_bf16 v59, v213, v25
 v_dot2c_f32_bf16 v60, v214, v24
 v_dot2c_f32_bf16 v61, v214, v25
 v_dot2c_f32_bf16 v62, v215, v24
 v_dot2c_f32_bf16 v63, v215, v25
L_ry10:
 s_cmp_lg_u32 s70, 0
 s_cbranch_scc1 L_rk17
 s_call_b64 s[36:37], L_rpoll
L_rk17:
 s_ff1_i32_b32 s71, s70
 s_bitset0_b32 s70, s71
 s_cmp_ge_u32 s71, 16
 s_cselect_b32 s72, s78, s77
 s_cselect_b32 s73, 0x20000, 0
 s_cselect_b32 s87, 536870912, 0
 s_mul_i32 s71, s71, 114688
 s_add_u32 s71, s71, s72
 buffer_load_dwordx4 v[136:139], v7, s[8:11], s71 offen sc1
 s_or_b32 s69, s69, s73
 s_or_b32 s71, s71, s87
 buffer_load_dwordx4 v[140:143], v27, s[8:11], s71 offen sc1
 s_waitcnt vmcnt(12)
 s_bitcmp1_b32 s69, 11
 s_cbranch_scc1 L_rx11
 v_dot2c_f32_bf16 v48, v216, v24
 v_dot2c_f32_bf16 v49, v216, v25
 v_dot2c_f32_bf16 v50, v217, v24
 v_dot2c_f32_bf16 v51, v217, v25
 v_dot2c_f32_bf16 v52, v218, v24
 v_dot2c_f32_bf16 v53, v218, v25
 v_dot2c_f32_bf16 v54, v219, v24
 v_dot2c_f32_bf16 v55, v219, v25
 v_dot2c_f32_bf16 v56, v220, v24
 v_dot2c_f32_bf16 v57, v220, v25
 v_dot2c_f32_bf16 v58, v221, v24
 v_dot2c_f32_bf16 v59, v221, v25
 v_dot2c_f32_bf16 v60, v222, v24
 v_dot2c_f32_bf16 v61, v222, v25
 v_dot2c_f32_bf16 v62, v223, v24
 v_dot2c_f32_bf16 v63, v223, v25
L_ry11:
 s_cmp_lg_u32 s70, 0
 s_cbranch_scc1 L_rk18
 s_call_b64 s[36:37], L_rpoll
L_rk18:
 s_ff1_i32_b32 s71, s70
 s_bitset0_b32 s70, s71
 s_cmp_ge_u32 s71, 16
 s_cselect_b32 s72, s78, s77
 s_cselect_b32 s73, 0x40000, 0
 s_cselect_b32 s87, 536870912, 0
 s_mul_i32 s71, s71, 114688
 s_add_u32 s71, s71, s72
 buffer_load_dwordx4 v[144:147], v7, s[8:11], s71 offen sc1
 s_or_b32 s69, s69, s73
 s_or_b32 s71, s71, s87
 buffer_load_dwordx4 v[148:151], v27, s[8:11], s71 offen sc1
 s_waitcnt vmcnt(12)
 s_bitcmp1_b32 s69, 12
 s_cbranch_scc1 L_rx12
 v_dot2c_f32_bf16 v48, v224, v24
 v_dot2c_f32_bf16 v49, v224, v25
 v_dot2c_f32_bf16 v50, v225, v24
 v_dot2c_f32_bf16 v51, v225, v25
 v_dot2c_f32_bf16 v52, v226, v24
 v_dot2c_f32_bf16 v53, v226, v25
 v_dot2c_f32_bf16 v54, v227, v24
 v_dot2c_f32_bf16 v55, v227, v25
 v_dot2c_f32_bf16 v56, v228, v24
 v_dot2c_f32_bf16 v57, v228, v25
 v_dot2c_f32_bf16 v58, v229, v24
 v_dot2c_f32_bf16 v59, v229, v25
 v_dot2c_f32_bf16 v60, v230, v24
 v_dot2c_f32_bf16 v61, v230, v25
 v_dot2c_f32_bf16 v62, v231, v24
 v_dot2c_f32_bf16 v63, v231, v25
L_ry12:
 s_cmp_lg_u32 s70, 0
 s_cbranch_scc1 L_rk19
 s_call_b64 s[36:37], L_rpoll
L_rk19:
 s_ff1_i32_b32 s71, s70
 s_bitset0_b32 s70, s71
 s_cmp_ge_u32 s71, 16
 s_cselect_b32 s72, s78, s77
 s_cselect_b32 s73, 0x80000, 0
 s_cselect_b32 s87, 536870912, 0
 s_mul_i32 s71, s71, 114688
 s_add_u32 s71, s71, s72
 buffer_load_dwordx4 v[152:155], v7, s[8:11], s71 offen sc1
 s_or_b32 s69, s69, s73
 s_or_b32 s71, s71, s87
 buffer_load_dwordx4 v[156:159], v27, s[8:11], s71 offen sc1
 s_waitcnt vmcnt(12)
 s_bitcmp1_b32 s69, 13
 s_cbranch_scc1 L_rx13
 v_dot2c_f32_bf16 v48, v232, v24
 v_dot2c_f32_bf16 v49, v232, v25
 v_dot2c_f32_bf16 v50, v233, v24
 v_dot2c_f32_bf16 v51, v233, v25
 v_dot2c_f32_bf16 v52, v234, v24
 v_dot2c_f32_bf16 v53, v234, v25
 v_dot2c_f32_bf16 v54, v235, v24
 v_dot2c_f32_bf16 v55, v235, v25
 v_dot2c_f32_bf16 v56, v236, v24
 v_dot2c_f32_bf16 v57, v236, v25
 v_dot2c_f32_bf16 v58, v237, v24
 v_dot2c_f32_bf16 v59, v237, v25
 v_dot2c_f32_bf16 v60, v238, v24
 v_dot2c_f32_bf16 v61, v238, v25
 v_dot2c_f32_bf16 v62, v239, v24
 v_dot2c_f32_bf16 v63, v239, v25
L_ry13:
 s_cmp_lg_u32 s70, 0
 s_cbranch_scc1 L_rk20
 s_call_b64 s[36:37], L_rpoll
L_rk20:
 s_ff1_i32_b32 s71, s70
 s_bitset0_b32 s70, s71
 s_cmp_ge_u32 s71, 16
 s_cselect_b32 s72, s78, s77
 s_cselect_b32 s73, 0x100000, 0
 s_cselect_b32 s87, 536870912, 0
 s_mul_i32 s71, s71, 114688
 s_add_u32 s71, s71, s72
 buffer_load_dwordx4 v[160:163], v7, s[8:11], s71 offen sc1
 s_or_b32 s69, s69, s73
 s_or_b32 s71, s71, s87
 buffer_load_dwordx4 v[164:167], v27, s[8:11], s71 offen sc1
 s_waitcnt vmcnt(12)
 s_bitcmp1_b32 s69, 14
 s_cbranch_scc1 L_rx14
 v_dot2c_f32_bf16 v48, v240, v24
 v_dot2c_f32_bf16 v49, v240, v25
 v_dot2c_f32_bf16 v50, v241, v24
 v_dot2c_f32_bf16 v51, v241, v25
 v_dot2c_f32_bf16 v52, v242, v24
 v_dot2c_f32_bf16 v53, v242, v25
 v_dot2c_f32_bf16 v54, v243, v24
 v_dot2c_f32_bf16 v55, v243, v25
 v_dot2c_f32_bf16 v56, v244, v24
 v_dot2c_f32_bf16 v57, v244, v25
 v_dot2c_f32_bf16 v58, v245, v24
 v_dot2c_f32_bf16 v59, v245, v25
 v_dot2c_f32_bf16 v60, v246, v24
 v_dot2c_f32_bf16 v61, v246, v25
 v_dot2c_f32_bf16 v62, v247, v24
 v_dot2c_f32_bf16 v63, v247, v25
L_ry14:
 s_cmp_lg_u32 s70, 0
 s_cbranch_scc1 L_rk21
 s_call_b64 s[36:37], L_rpoll
L_rk21:
 s_ff1_i32_b32 s71, s70
 s_bitset0_b32 s70, s71
 s_cmp_ge_u32 s71, 16
 s_cselect_b32 s72, s78, s77
 s_cselect_b32 s73, 0x200000, 0
 s_cselect_b32 s87, 536870912, 0
 s_mul_i32 s71, s71, 114688
 s_add_u32 s71, s71, s72
 buffer_load_dwordx4 v[168:171], v7, s[8:11], s71 offen sc1
 s_or_b32 s69, s69, s73
 s_or_b32 s71, s71, s87
 buffer_load_dwordx4 v[172:175], v27, s[8:11], s71 offen sc1
 s_waitcnt vmcnt(12)
 s_bitcmp1_b32 s69, 15
 s_cbranch_scc1 L_rx15
 v_dot2c_f32_bf16 v48, v248, v24
 v_dot2c_f32_bf16 v49, v248, v25
 v_dot2c_f32_bf16 v50, v249, v24
 v_dot2c_f32_bf16 v51, v249, v25
 v_dot2c_f32_bf16 v52, v250, v24
 v_dot2c_f32_bf16 v53, v250, v25
 v_dot2c_f32_bf16 v54, v251, v24
 v_dot2c_f32_bf16 v55, v251, v25
 v_dot2c_f32_bf16 v56, v252, v24
 v_dot2c_f32_bf16 v57, v252, v25
 v_dot2c_f32_bf16 v58, v253, v24
 v_dot2c_f32_bf16 v59, v253, v25
 v_dot2c_f32_bf16 v60, v254, v24
 v_dot2c_f32_bf16 v61, v254, v25
 v_dot2c_f32_bf16 v62, v255, v24
 v_dot2c_f32_bf16 v63, v255, v25
L_ry15:
 s_cmp_lg_u32 s70, 0
 s_cbranch_scc1 L_rk22
 s_call_b64 s[36:37], L_rpoll
L_rk22:
 s_ff1_i32_b32 s71, s70
 s_bitset0_b32 s70, s71
 s_cmp_ge_u32 s71, 16
 s_cselect_b32 s72, s78, s77
 s_cselect_b32 s73, 0x400000, 0
 s_cselect_b32 s87, 536870912, 0
 s_mul_i32 s71, s71, 114688
 s_add_u32 s71, s71, s72
 buffer_load_dwordx4 v[176:179], v7, s[8:11], s71 offen sc1
 s_or_b32 s69, s69, s73
 s_or_b32 s71, s71, s87
 buffer_load_dwordx4 v[180:183], v27, s[8:11], s71 offen sc1
 s_waitcnt vmcnt(12)
 s_bitcmp0_b32 s69, 16
 s_cbranch_scc1 L_rx16
 v_dot2c_f32_bf16 v64, v128, v24
 v_dot2c_f32_bf16 v65, v128, v25
 v_dot2c_f32_bf16 v66, v129, v24
 v_dot2c_f32_bf16 v67, v129, v25
 v_dot2c_f32_bf16 v68, v130, v24
 v_dot2c_f32_bf16 v69, v130, v25
 v_dot2c_f32_bf16 v70, v131, v24
 v_dot2c_f32_bf16 v71, v131, v25
L_ry16:
 s_cmp_lg_u32 s70, 0
 s_cbranch_scc1 L_rk23
 s_call_b64 s[36:37], L_rpoll
L_rk23:
 s_ff1_i32_b32 s71, s70
 s_bitset0_b32 s70, s71
 s_cmp_ge_u32 s71, 16
 s_cselect_b32 s72, s78, s77
 s_cselect_b32 s73, 0x800000, 0
 s_cselect_b32 s87, 536870912, 0
 s_mul_i32 s71, s71, 114688
 s_add_u32 s71, s71, s72
 buffer_load_dwordx4 v[184:187], v7, s[8:11], s71 offen sc1
 s_or_b32 s69, s69, s73
 s_or_b32 s71, s71, s87
 buffer_load_dwordx4 v[188:191], v27, s[8:11], s71 offen sc1
 s_waitcnt vmcnt(12)
 s_bitcmp0_b32 s69, 17
 s_cbranch_scc1 L_rx17
 v_dot2c_f32_bf16 v64, v136, v24
 v_dot2c_f32_bf16 v65, v136, v25
 v_dot2c_f32_bf16 v66, v137, v24
 v_dot2c_f32_bf16 v67, v137, v25
 v_dot2c_f32_bf16 v68, v138, v24
 v_dot2c_f32_bf16 v69, v138, v25
 v_dot2c_f32_bf16 v70, v139, v24
 v_dot2c_f32_bf16 v71, v139, v25
L_ry17:
 s_cmp_lg_u32 s70, 0
 s_cbranch_scc1 L_rk24
 s_call_b64 s[36:37], L_rpoll
L_rk24:
 s_ff1_i32_b32 s71, s70
 s_bitset0_b32 s70, s71
 s_cmp_ge_u32 s71, 16
 s_cselect_b32 s72, s78, s77
 s_cselect_b32 s73, 0x1000000, 0
 s_cselect_b32 s87, 536870912, 0
 s_mul_i32 s71, s71, 114688
 s_add_u32 s71, s71, s72
 buffer_load_dwordx4 v[192:195], v7, s[8:11], s71 offen sc1
 s_or_b32 s69, s69, s73
 s_or_b32 s71, s71, s87
 buffer_load_dwordx4 v[196:199], v27, s[8:11], s71 offen sc1
 s_waitcnt vmcnt(12)
 s_bitcmp0_b32 s69, 18
 s_cbranch_scc1 L_rx18
 v_dot2c_f32_bf16 v64, v144, v24
 v_dot2c_f32_bf16 v65, v144, v25
 v_dot2c_f32_bf16 v66, v145, v24
 v_dot2c_f32_bf16 v67, v145, v25
 v_dot2c_f32_bf16 v68, v146, v24
 v_dot2c_f32_bf16 v69, v146, v25
 v_dot2c_f32_bf16 v70, v147, v24
 v_dot2c_f32_bf16 v71, v147, v25
L_ry18:
 s_cmp_lg_u32 s70, 0
 s_cbranch_scc1 L_rk25
 s_call_b64 s[36:37], L_rpoll
L_rk25:
 s_ff1_i32_b32 s71, s70
 s_bitset0_b32 s70, s71
 s_cmp_ge_u32 s71, 16
 s_cselect_b32 s72, s78, s77
 s_cselect_b32 s73, 0x2000000, 0
 s_cselect_b32 s87, 536870912, 0
 s_mul_i32 s71, s71, 114688
 s_add_u32 s71, s71, s72
 buffer_load_dwordx4 v[200:203], v7, s[8:11], s71 offen sc1
 s_or_b32 s69, s69, s73
 s_or_b32 s71, s71, s87
 buffer_load_dwordx4 v[204:207], v27, s[8:11], s71 offen sc1
 s_waitcnt vmcnt(12)
 s_bitcmp0_b32 s69, 19
 s_cbranch_scc1 L_rx19
 v_dot2c_f32_bf16 v64, v152, v24
 v_dot2c_f32_bf16 v65, v152, v25
 v_dot2c_f32_bf16 v66, v153, v24
 v_dot2c_f32_bf16 v67, v153, v25
 v_dot2c_f32_bf16 v68, v154, v24
 v_dot2c_f32_bf16 v69, v154, v25
 v_dot2c_f32_bf16 v70, v155, v24
 v_dot2c_f32_bf16 v71, v155, v25
L_ry19:
 s_cmp_lg_u32 s70, 0
 s_cbranch_scc1 L_rk26
 s_call_b64 s[36:37], L_rpoll
L_rk26:
 s_ff1_i32_b32 s71, s70
 s_bitset0_b32 s70, s71
 s_cmp_ge_u32 s71, 16
 s_cselect_b32 s72, s78, s77
 s_cselect_b32 s73, 0x4000000, 0
 s_cselect_b32 s87, 536870912, 0
 s_mul_i32 s71, s71, 114688
 s_add_u32 s71, s71, s72
 buffer_load_dwordx4 v[208:211], v7, s[8:11], s71 offen sc1
 s_or_b32 s69, s69, s73
 s_or_b32 s71, s71, s87
 buffer_load_dwordx4 v[212:215], v27, s[8:11], s71 offen sc1
 s_waitcnt vmcnt(12)
 s_bitcmp0_b32 s69, 20
 s_cbranch_scc1 L_rx20
 v_dot2c_f32_bf16 v64, v160, v24
 v_dot2c_f32_bf16 v65, v160, v25
 v_dot2c_f32_bf16 v66, v161, v24
 v_dot2c_f32_bf16 v67, v161, v25
 v_dot2c_f32_bf16 v68, v162, v24
 v_dot2c_f32_bf16 v69, v162, v25
 v_dot2c_f32_bf16 v70, v163, v24
 v_dot2c_f32_bf16 v71, v163, v25
L_ry20:
 s_cmp_lg_u32 s70, 0
 s_cbranch_scc1 L_rk27
 s_call_b64 s[36:37], L_rpoll
L_rk27:
 s_ff1_i32_b32 s71, s70
 s_bitset0_b32 s70, s71
 s_cmp_ge_u32 s71, 16
 s_cselect_b32 s72, s78, s77
 s_cselect_b32 s73, 0x8000000, 0
 s_cselect_b32 s87, 536870912, 0
 s_mul_i32 s71, s71, 114688
 s_add_u32 s71, s71, s72
 buffer_load_dwordx4 v[216:219], v7, s[8:11], s71 offen sc1
 s_or_b32 s69, s69, s73
 s_or_b32 s71, s71, s87
 buffer_load_dwordx4 v[220:223], v27, s[8:11], s71 offen sc1
 s_waitcnt vmcnt(12)
 s_bitcmp0_b32 s69, 21
 s_cbranch_scc1 L_rx21
 v_dot2c_f32_bf16 v64, v168, v24
 v_dot2c_f32_bf16 v65, v168, v25
 v_dot2c_f32_bf16 v66, v169, v24
 v_dot2c_f32_bf16 v67, v169, v25
 v_dot2c_f32_bf16 v68, v170, v24
 v_dot2c_f32_bf16 v69, v170, v25
 v_dot2c_f32_bf16 v70, v171, v24
 v_dot2c_f32_bf16 v71, v171, v25
L_ry21:
 s_and_b32 s71, s69, 0x3fffff
 s_bcnt1_i32_b32 s71, s71
 s_cmp_eq_u32 s71, 6
 s_cselect_b32 s66, 1, 0
 s_cbranch_scc0 L_rne
 v_fmac_f32 v32, v15, v48
 v_fmac_f32 v33, v15, v49
 v_fmac_f32 v34, v15, v50
 v_fmac_f32 v35, v15, v51
 v_fmac_f32 v36, v15, v52
 v_fmac_f32 v37, v15, v53
 v_fmac_f32 v38, v15, v54
 v_fmac_f32 v39, v15, v55
 v_cvt_pk_bf16_f32 v16, v32, v33
 v_cvt_pk_bf16_f32 v17, v34, v35
 v_cvt_pk_bf16_f32 v18, v36, v37
 v_cvt_pk_bf16_f32 v19, v38, v39
 buffer_store_dwordx4 v[16:19], v12, s[52:55], s75 offen sc1
 v_fmac_f32 v40, v15, v56
 v_fmac_f32 v41, v15, v57
 v_fmac_f32 v42, v15, v58
 v_fmac_f32 v43, v15, v59
 v_fmac_f32 v44, v15, v60
 v_fmac_f32 v45, v15, v61
 v_fmac_f32 v46, v15, v62
 v_fmac_f32 v47, v15, v63
 v_cvt_pk_bf16_f32 v20, v40, v41
 v_cvt_pk_bf16_f32 v21, v42, v43
 v_cvt_pk_bf16_f32 v22, v44, v45
 v_cvt_pk_bf16_f32 v23, v46, v47
 buffer_store_dwordx4 v[20:23], v12, s[52:55], s76 offen sc1
L_rne:
 s_cmp_lg_u32 s70, 0
 s_cbranch_scc1 L_rk28
 s_call_b64 s[36:37], L_rpoll
L_rk28:
 s_ff1_i32_b32 s71, s70
 s_bitset0_b32 s70, s71
 s_cmp_ge_u32 s71, 16
 s_cselect_b32 s72, s78, s77
 s_cselect_b32 s73, 0x10000000, 0
 s_cselect_b32 s87, 536870912, 0
 s_mul_i32 s71, s71, 114688
 s_add_u32 s71, s71, s72
 buffer_load_dwordx4 v[224:227], v7, s[8:11], s71 offen sc1
 s_or_b32 s69, s69, s73
 s_or_b32 s71, s71, s87
 buffer_load_dwordx4 v[228:231], v27, s[8:11], s71 offen sc1
 s_waitcnt vmcnt(12)
 s_bitcmp0_b32 s69, 22
 s_cbranch_scc1 L_rx22
 v_dot2c_f32_bf16 v64, v176, v24
 v_dot2c_f32_bf16 v65, v176, v25
 v_dot2c_f32_bf16 v66, v177, v24
 v_dot2c_f32_bf16 v67, v177, v25
 v_dot2c_f32_bf16 v68, v178, v24
 v_dot2c_f32_bf16 v69, v178, v25
 v_dot2c_f32_bf16 v70, v179, v24
 v_dot2c_f32_bf16 v71, v179, v25
L_ry22:
 s_cmp_lg_u32 s70, 0
 s_cbranch_scc1 L_rk29
 s_call_b64 s[36:37], L_rpoll
L_rk29:
 s_ff1_i32_b32 s71, s70
 s_bitset0_b32 s70, s71
 s_cmp_ge_u32 s71, 16
 s_cselect_b32 s72, s78, s77
 s_cselect_b32 s73, 0x20000000, 0
 s_cselect_b32 s87, 536870912, 0
 s_mul_i32 s71, s71, 114688
 s_add_u32 s71, s71, s72
 buffer_load_dwordx4 v[232:235], v7, s[8:11], s71 offen sc1
 s_or_b32 s69, s69, s73
 s_or_b32 s71, s71, s87
 buffer_load_dwordx4 v[236:239], v27, s[8:11], s71 offen sc1
 s_waitcnt vmcnt(12)
 s_bitcmp0_b32 s69, 23
 s_cbranch_scc1 L_rx23
 v_dot2c_f32_bf16 v64, v184, v24
 v_dot2c_f32_bf16 v65, v184, v25
 v_dot2c_f32_bf16 v66, v185, v24
 v_dot2c_f32_bf16 v67, v185, v25
 v_dot2c_f32_bf16 v68, v186, v24
 v_dot2c_f32_bf16 v69, v186, v25
 v_dot2c_f32_bf16 v70, v187, v24
 v_dot2c_f32_bf16 v71, v187, v25
L_ry23:
 s_cmp_lg_u32 s70, 0
 s_cbranch_scc1 L_rk30
 s_call_b64 s[36:37], L_rpoll
L_rk30:
 s_ff1_i32_b32 s71, s70
 s_bitset0_b32 s70, s71
 s_cmp_ge_u32 s71, 16
 s_cselect_b32 s72, s78, s77
 s_cselect_b32 s73, 0x40000000, 0
 s_cselect_b32 s87, 536870912, 0
 s_mul_i32 s71, s71, 114688
 s_add_u32 s71, s71, s72
 buffer_load_dwordx4 v[240:243], v7, s[8:11], s71 offen sc1
 s_or_b32 s69, s69, s73
 s_or_b32 s71, s71, s87
 buffer_load_dwordx4 v[244:247], v27, s[8:11], s71 offen sc1
 s_waitcnt vmcnt(12)
 s_bitcmp0_b32 s69, 24
 s_cbranch_scc1 L_rx24
 v_dot2c_f32_bf16 v64, v192, v24
 v_dot2c_f32_bf16 v65, v192, v25
 v_dot2c_f32_bf16 v66, v193, v24
 v_dot2c_f32_bf16 v67, v193, v25
 v_dot2c_f32_bf16 v68, v194, v24
 v_dot2c_f32_bf16 v69, v194, v25
 v_dot2c_f32_bf16 v70, v195, v24
 v_dot2c_f32_bf16 v71, v195, v25
L_ry24:
 s_cmp_lg_u32 s70, 0
 s_cbranch_scc1 L_rk31
 s_call_b64 s[36:37], L_rpoll
L_rk31:
 s_ff1_i32_b32 s71, s70
 s_bitset0_b32 s70, s71
 s_cmp_ge_u32 s71, 16
 s_cselect_b32 s72, s78, s77
 s_cselect_b32 s73, 0x80000000, 0
 s_cselect_b32 s87, 536870912, 0
 s_mul_i32 s71, s71, 114688
 s_add_u32 s71, s71, s72
 buffer_load_dwordx4 v[248:251], v7, s[8:11], s71 offen sc1
 s_or_b32 s69, s69, s73
 s_or_b32 s71, s71, s87
 buffer_load_dwordx4 v[252:255], v27, s[8:11], s71 offen sc1
 s_waitcnt vmcnt(12)
 s_bitcmp0_b32 s69, 25
 s_cbranch_scc1 L_rx25
 v_dot2c_f32_bf16 v64, v200, v24
 v_dot2c_f32_bf16 v65, v200, v25
 v_dot2c_f32_bf16 v66, v201, v24
 v_dot2c_f32_bf16 v67, v201, v25
 v_dot2c_f32_bf16 v68, v202, v24
 v_dot2c_f32_bf16 v69, v202, v25
 v_dot2c_f32_bf16 v70, v203, v24
 v_dot2c_f32_bf16 v71, v203, v25
L_ry25:
 s_waitcnt vmcnt(10)
 s_bitcmp0_b32 s69, 26
 s_cbranch_scc1 L_rx26
 v_dot2c_f32_bf16 v64, v208, v24
 v_dot2c_f32_bf16 v65, v208, v25
 v_dot2c_f32_bf16 v66, v209, v24
 v_dot2c_f32_bf16 v67, v209, v25
 v_dot2c_f32_bf16 v68, v210, v24
 v_dot2c_f32_bf16 v69, v210, v25
 v_dot2c_f32_bf16 v70, v211, v24
 v_dot2c_f32_bf16 v71, v211, v25
L_ry26:
 s_waitcnt vmcnt(8)
 s_bitcmp0_b32 s69, 27
 s_cbranch_scc1 L_rx27
 v_dot2c_f32_bf16 v64, v216, v24
 v_dot2c_f32_bf16 v65, v216, v25
 v_dot2c_f32_bf16 v66, v217, v24
 v_dot2c_f32_bf16 v67, v217, v25
 v_dot2c_f32_bf16 v68, v218, v24
 v_dot2c_f32_bf16 v69, v218, v25
 v_dot2c_f32_bf16 v70, v219, v24
 v_dot2c_f32_bf16 v71, v219, v25
L_ry27:
 s_waitcnt vmcnt(6)
 s_bitcmp0_b32 s69, 28
 s_cbranch_scc1 L_rx28
 v_dot2c_f32_bf16 v64, v224, v24
 v_dot2c_f32_bf16 v65, v224, v25
 v_dot2c_f32_bf16 v66, v225, v24
 v_dot2c_f32_bf16 v67, v225, v25
 v_dot2c_f32_bf16 v68, v226, v24
 v_dot2c_f32_bf16 v69, v226, v25
 v_dot2c_f32_bf16 v70, v227, v24
 v_dot2c_f32_bf16 v71, v227, v25
L_ry28:
 s_waitcnt vmcnt(4)
 s_bitcmp0_b32 s69, 29
 s_cbranch_scc1 L_rx29
 v_dot2c_f32_bf16 v64, v232, v24
 v_dot2c_f32_bf16 v65, v232, v25
 v_dot2c_f32_bf16 v66, v233, v24
 v_dot2c_f32_bf16 v67, v233, v25
 v_dot2c_f32_bf16 v68, v234, v24
 v_dot2c_f32_bf16 v69, v234, v25
 v_dot2c_f32_bf16 v70, v235, v24
 v_dot2c_f32_bf16 v71, v235, v25
L_ry29:
 s_waitcnt vmcnt(2)
 s_bitcmp0_b32 s69, 30
 s_cbranch_scc1 L_rx30
 v_dot2c_f32_bf16 v64, v240, v24
 v_dot2c_f32_bf16 v65, v240, v25
 v_dot2c_f32_bf16 v66, v241, v24
 v_dot2c_f32_bf16 v67, v241, v25
 v_dot2c_f32_bf16 v68, v242, v24
 v_dot2c_f32_bf16 v69, v242, v25
 v_dot2c_f32_bf16 v70, v243, v24
 v_dot2c_f32_bf16 v71, v243, v25
L_ry30:
 s_waitcnt vmcnt(0)
 s_bitcmp0_b32 s69, 31
 s_cbranch_scc1 L_rx31
 v_dot2c_f32_bf16 v64, v248, v24
 v_dot2c_f32_bf16 v65, v248, v25
 v_dot2c_f32_bf16 v66, v249, v24
 v_dot2c_f32_bf16 v67, v249, v25
 v_dot2c_f32_bf16 v68, v250, v24
 v_dot2c_f32_bf16 v69, v250, v25
 v_dot2c_f32_bf16 v70, v251, v24
 v_dot2c_f32_bf16 v71, v251, v25
L_ry31:
 s_nop 1
 v_fmac_f32 v80, v26, v64
 v_fmac_f32 v81, v26, v65
 v_fmac_f32 v82, v26, v66
 v_fmac_f32 v83, v26, v67
 v_fmac_f32 v84, v26, v68
 v_fmac_f32 v85, v26, v69
 v_fmac_f32 v86, v26, v70
 v_fmac_f32 v87, v26, v71
 v_cvt_pk_bf16_f32 v96, v80, v81
 v_cvt_pk_bf16_f32 v97, v82, v83
 v_cvt_pk_bf16_f32 v98, v84, v85
 v_cvt_pk_bf16_f32 v99, v86, v87
 buffer_store_dwordx4 v[96:99], v28, s[52:55], s86 offen sc1
 s_cmp_eq_u32 s66, 1
 s_cbranch_scc1 L_rdone
 v_fmac_f32 v32, v15, v48
 v_fmac_f32 v33, v15, v49
 v_fmac_f32 v34, v15, v50
 v_fmac_f32 v35, v15, v51
 v_fmac_f32 v36, v15, v52
 v_fmac_f32 v37, v15, v53
 v_fmac_f32 v38, v15, v54
 v_fmac_f32 v39, v15, v55
 v_cvt_pk_bf16_f32 v16, v32, v33
 v_cvt_pk_bf16_f32 v17, v34, v35
 v_cvt_pk_bf16_f32 v18, v36, v37
 v_cvt_pk_bf16_f32 v19, v38, v39
 buffer_store_dwordx4 v[16:19], v12, s[52:55], s75 offen sc1
 v_fmac_f32 v40, v15, v56
 v_fmac_f32 v41, v15, v57
 v_fmac_f32 v42, v15, v58
 v_fmac_f32 v43, v15, v59
 v_fmac_f32 v44, v15, v60
 v_fmac_f32 v45, v15, v61
 v_fmac_f32 v46, v15, v62
 v_fmac_f32 v47, v15, v63
 v_cvt_pk_bf16_f32 v20, v40, v41
 v_cvt_pk_bf16_f32 v21, v42, v43
 v_cvt_pk_bf16_f32 v22, v44, v45
 v_cvt_pk_bf16_f32 v23, v46, v47
 buffer_store_dwordx4 v[20:23], v12, s[52:55], s76 offen sc1
L_rdone:
 s_endpgm
L_rx0:
 v_dot2c_f32_bf16 v64, v128, v24
 v_dot2c_f32_bf16 v65, v128, v25
 v_dot2c_f32_bf16 v66, v129, v24
 v_dot2c_f32_bf16 v67, v129, v25
 v_dot2c_f32_bf16 v68, v130, v24
 v_dot2c_f32_bf16 v69, v130, v25
 v_dot2c_f32_bf16 v70, v131, v24
 v_dot2c_f32_bf16 v71, v131, v25
 s_branch L_ry0
L_rx1:
 v_dot2c_f32_bf16 v64, v136, v24
 v_dot2c_f32_bf16 v65, v136, v25
 v_dot2c_f32_bf16 v66, v137, v24
 v_dot2c_f32_bf16 v67, v137, v25
 v_dot2c_f32_bf16 v68, v138, v24
 v_dot2c_f32_bf16 v69, v138, v25
 v_dot2c_f32_bf16 v70, v139, v24
 v_dot2c_f32_bf16 v71, v139, v25
 s_branch L_ry1
L_rx2:
 v_dot2c_f32_bf16 v64, v144, v24
 v_dot2c_f32_bf16 v65, v144, v25
 v_dot2c_f32_bf16 v66, v145, v24
 v_dot2c_f32_bf16 v67, v145, v25
 v_dot2c_f32_bf16 v68, v146, v24
 v_dot2c_f32_bf16 v69, v146, v25
 v_dot2c_f32_bf16 v70, v147, v24
 v_dot2c_f32_bf16 v71, v147, v25
 s_branch L_ry2
L_rx3:
 v_dot2c_f32_bf16 v64, v152, v24
 v_dot2c_f32_bf16 v65, v152, v25
 v_dot2c_f32_bf16 v66, v153, v24
 v_dot2c_f32_bf16 v67, v153, v25
 v_dot2c_f32_bf16 v68, v154, v24
 v_dot2c_f32_bf16 v69, v154, v25
 v_dot2c_f32_bf16 v70, v155, v24
 v_dot2c_f32_bf16 v71, v155, v25
 s_branch L_ry3
L_rx4:
 v_dot2c_f32_bf16 v64, v160, v24
 v_dot2c_f32_bf16 v65, v160, v25
 v_dot2c_f32_bf16 v66, v161, v24
 v_dot2c_f32_bf16 v67, v161, v25
 v_dot2c_f32_bf16 v68, v162, v24
 v_dot2c_f32_bf16 v69, v162, v25
 v_dot2c_f32_bf16 v70, v163, v24
 v_dot2c_f32_bf16 v71, v163, v25
 s_branch L_ry4
L_rx5:
 v_dot2c_f32_bf16 v64, v168, v24
 v_dot2c_f32_bf16 v65, v168, v25
 v_dot2c_f32_bf16 v66, v169, v24
 v_dot2c_f32_bf16 v67, v169, v25
 v_dot2c_f32_bf16 v68, v170, v24
 v_dot2c_f32_bf16 v69, v170, v25
 v_dot2c_f32_bf16 v70, v171, v24
 v_dot2c_f32_bf16 v71, v171, v25
 s_branch L_ry5
L_rx6:
 v_dot2c_f32_bf16 v64, v176, v24
 v_dot2c_f32_bf16 v65, v176, v25
 v_dot2c_f32_bf16 v66, v177, v24
 v_dot2c_f32_bf16 v67, v177, v25
 v_dot2c_f32_bf16 v68, v178, v24
 v_dot2c_f32_bf16 v69, v178, v25
 v_dot2c_f32_bf16 v70, v179, v24
 v_dot2c_f32_bf16 v71, v179, v25
 s_branch L_ry6
L_rx7:
 v_dot2c_f32_bf16 v64, v184, v24
 v_dot2c_f32_bf16 v65, v184, v25
 v_dot2c_f32_bf16 v66, v185, v24
 v_dot2c_f32_bf16 v67, v185, v25
 v_dot2c_f32_bf16 v68, v186, v24
 v_dot2c_f32_bf16 v69, v186, v25
 v_dot2c_f32_bf16 v70, v187, v24
 v_dot2c_f32_bf16 v71, v187, v25
 s_branch L_ry7
L_rx8:
 v_dot2c_f32_bf16 v64, v192, v24
 v_dot2c_f32_bf16 v65, v192, v25
 v_dot2c_f32_bf16 v66, v193, v24
 v_dot2c_f32_bf16 v67, v193, v25
 v_dot2c_f32_bf16 v68, v194, v24
 v_dot2c_f32_bf16 v69, v194, v25
 v_dot2c_f32_bf16 v70, v195, v24
 v_dot2c_f32_bf16 v71, v195, v25
 s_branch L_ry8
L_rx9:
 v_dot2c_f32_bf16 v64, v200, v24
 v_dot2c_f32_bf16 v65, v200, v25
 v_dot2c_f32_bf16 v66, v201, v24
 v_dot2c_f32_bf16 v67, v201, v25
 v_dot2c_f32_bf16 v68, v202, v24
 v_dot2c_f32_bf16 v69, v202, v25
 v_dot2c_f32_bf16 v70, v203, v24
 v_dot2c_f32_bf16 v71, v203, v25
 s_branch L_ry9
L_rx10:
 v_dot2c_f32_bf16 v64, v208, v24
 v_dot2c_f32_bf16 v65, v208, v25
 v_dot2c_f32_bf16 v66, v209, v24
 v_dot2c_f32_bf16 v67, v209, v25
 v_dot2c_f32_bf16 v68, v210, v24
 v_dot2c_f32_bf16 v69, v210, v25
 v_dot2c_f32_bf16 v70, v211, v24
 v_dot2c_f32_bf16 v71, v211, v25
 s_branch L_ry10
L_rx11:
 v_dot2c_f32_bf16 v64, v216, v24
 v_dot2c_f32_bf16 v65, v216, v25
 v_dot2c_f32_bf16 v66, v217, v24
 v_dot2c_f32_bf16 v67, v217, v25
 v_dot2c_f32_bf16 v68, v218, v24
 v_dot2c_f32_bf16 v69, v218, v25
 v_dot2c_f32_bf16 v70, v219, v24
 v_dot2c_f32_bf16 v71, v219, v25
 s_branch L_ry11
L_rx12:
 v_dot2c_f32_bf16 v64, v224, v24
 v_dot2c_f32_bf16 v65, v224, v25
 v_dot2c_f32_bf16 v66, v225, v24
 v_dot2c_f32_bf16 v67, v225, v25
 v_dot2c_f32_bf16 v68, v226, v24
 v_dot2c_f32_bf16 v69, v226, v25
 v_dot2c_f32_bf16 v70, v227, v24
 v_dot2c_f32_bf16 v71, v227, v25
 s_branch L_ry12
L_rx13:
 v_dot2c_f32_bf16 v64, v232, v24
 v_dot2c_f32_bf16 v65, v232, v25
 v_dot2c_f32_bf16 v66, v233, v24
 v_dot2c_f32_bf16 v67, v233, v25
 v_dot2c_f32_bf16 v68, v234, v24
 v_dot2c_f32_bf16 v69, v234, v25
 v_dot2c_f32_bf16 v70, v235, v24
 v_dot2c_f32_bf16 v71, v235, v25
 s_branch L_ry13
L_rx14:
 v_dot2c_f32_bf16 v64, v240, v24
 v_dot2c_f32_bf16 v65, v240, v25
 v_dot2c_f32_bf16 v66, v241, v24
 v_dot2c_f32_bf16 v67, v241, v25
 v_dot2c_f32_bf16 v68, v242, v24
 v_dot2c_f32_bf16 v69, v242, v25
 v_dot2c_f32_bf16 v70, v243, v24
 v_dot2c_f32_bf16 v71, v243, v25
 s_branch L_ry14
L_rx15:
 v_dot2c_f32_bf16 v64, v248, v24
 v_dot2c_f32_bf16 v65, v248, v25
 v_dot2c_f32_bf16 v66, v249, v24
 v_dot2c_f32_bf16 v67, v249, v25
 v_dot2c_f32_bf16 v68, v250, v24
 v_dot2c_f32_bf16 v69, v250, v25
 v_dot2c_f32_bf16 v70, v251, v24
 v_dot2c_f32_bf16 v71, v251, v25
 s_branch L_ry15
L_rx16:
 v_dot2c_f32_bf16 v48, v128, v24
 v_dot2c_f32_bf16 v49, v128, v25
 v_dot2c_f32_bf16 v50, v129, v24
 v_dot2c_f32_bf16 v51, v129, v25
 v_dot2c_f32_bf16 v52, v130, v24
 v_dot2c_f32_bf16 v53, v130, v25
 v_dot2c_f32_bf16 v54, v131, v24
 v_dot2c_f32_bf16 v55, v131, v25
 v_dot2c_f32_bf16 v56, v132, v24
 v_dot2c_f32_bf16 v57, v132, v25
 v_dot2c_f32_bf16 v58, v133, v24
 v_dot2c_f32_bf16 v59, v133, v25
 v_dot2c_f32_bf16 v60, v134, v24
 v_dot2c_f32_bf16 v61, v134, v25
 v_dot2c_f32_bf16 v62, v135, v24
 v_dot2c_f32_bf16 v63, v135, v25
 s_branch L_ry16
L_rx17:
 v_dot2c_f32_bf16 v48, v136, v24
 v_dot2c_f32_bf16 v49, v136, v25
 v_dot2c_f32_bf16 v50, v137, v24
 v_dot2c_f32_bf16 v51, v137, v25
 v_dot2c_f32_bf16 v52, v138, v24
 v_dot2c_f32_bf16 v53, v138, v25
 v_dot2c_f32_bf16 v54, v139, v24
 v_dot2c_f32_bf16 v55, v139, v25
 v_dot2c_f32_bf16 v56, v140, v24
 v_dot2c_f32_bf16 v57, v140, v25
 v_dot2c_f32_bf16 v58, v141, v24
 v_dot2c_f32_bf16 v59, v141, v25
 v_dot2c_f32_bf16 v60, v142, v24
 v_dot2c_f32_bf16 v61, v142, v25
 v_dot2c_f32_bf16 v62, v143, v24
 v_dot2c_f32_bf16 v63, v143, v25
 s_branch L_ry17
L_rx18:
 v_dot2c_f32_bf16 v48, v144, v24
 v_dot2c_f32_bf16 v49, v144, v25
 v_dot2c_f32_bf16 v50, v145, v24
 v_dot2c_f32_bf16 v51, v145, v25
 v_dot2c_f32_bf16 v52, v146, v24
 v_dot2c_f32_bf16 v53, v146, v25
 v_dot2c_f32_bf16 v54, v147, v24
 v_dot2c_f32_bf16 v55, v147, v25
 v_dot2c_f32_bf16 v56, v148, v24
 v_dot2c_f32_bf16 v57, v148, v25
 v_dot2c_f32_bf16 v58, v149, v24
 v_dot2c_f32_bf16 v59, v149, v25
 v_dot2c_f32_bf16 v60, v150, v24
 v_dot2c_f32_bf16 v61, v150, v25
 v_dot2c_f32_bf16 v62, v151, v24
 v_dot2c_f32_bf16 v63, v151, v25
 s_branch L_ry18
L_rx19:
 v_dot2c_f32_bf16 v48, v152, v24
 v_dot2c_f32_bf16 v49, v152, v25
 v_dot2c_f32_bf16 v50, v153, v24
 v_dot2c_f32_bf16 v51, v153, v25
 v_dot2c_f32_bf16 v52, v154, v24
 v_dot2c_f32_bf16 v53, v154, v25
 v_dot2c_f32_bf16 v54, v155, v24
 v_dot2c_f32_bf16 v55, v155, v25
 v_dot2c_f32_bf16 v56, v156, v24
 v_dot2c_f32_bf16 v57, v156, v25
 v_dot2c_f32_bf16 v58, v157, v24
 v_dot2c_f32_bf16 v59, v157, v25
 v_dot2c_f32_bf16 v60, v158, v24
 v_dot2c_f32_bf16 v61, v158, v25
 v_dot2c_f32_bf16 v62, v159, v24
 v_dot2c_f32_bf16 v63, v159, v25
 s_branch L_ry19
L_rx20:
 v_dot2c_f32_bf16 v48, v160, v24
 v_dot2c_f32_bf16 v49, v160, v25
 v_dot2c_f32_bf16 v50, v161, v24
 v_dot2c_f32_bf16 v51, v161, v25
 v_dot2c_f32_bf16 v52, v162, v24
 v_dot2c_f32_bf16 v53, v162, v25
 v_dot2c_f32_bf16 v54, v163, v24
 v_dot2c_f32_bf16 v55, v163, v25
 v_dot2c_f32_bf16 v56, v164, v24
 v_dot2c_f32_bf16 v57, v164, v25
 v_dot2c_f32_bf16 v58, v165, v24
 v_dot2c_f32_bf16 v59, v165, v25
 v_dot2c_f32_bf16 v60, v166, v24
 v_dot2c_f32_bf16 v61, v166, v25
 v_dot2c_f32_bf16 v62, v167, v24
 v_dot2c_f32_bf16 v63, v167, v25
 s_branch L_ry20
L_rx21:
 v_dot2c_f32_bf16 v48, v168, v24
 v_dot2c_f32_bf16 v49, v168, v25
 v_dot2c_f32_bf16 v50, v169, v24
 v_dot2c_f32_bf16 v51, v169, v25
 v_dot2c_f32_bf16 v52, v170, v24
 v_dot2c_f32_bf16 v53, v170, v25
 v_dot2c_f32_bf16 v54, v171, v24
 v_dot2c_f32_bf16 v55, v171, v25
 v_dot2c_f32_bf16 v56, v172, v24
 v_dot2c_f32_bf16 v57, v172, v25
 v_dot2c_f32_bf16 v58, v173, v24
 v_dot2c_f32_bf16 v59, v173, v25
 v_dot2c_f32_bf16 v60, v174, v24
 v_dot2c_f32_bf16 v61, v174, v25
 v_dot2c_f32_bf16 v62, v175, v24
 v_dot2c_f32_bf16 v63, v175, v25
 s_branch L_ry21
L_rx22:
 v_dot2c_f32_bf16 v48, v176, v24
 v_dot2c_f32_bf16 v49, v176, v25
 v_dot2c_f32_bf16 v50, v177, v24
 v_dot2c_f32_bf16 v51, v177, v25
 v_dot2c_f32_bf16 v52, v178, v24
 v_dot2c_f32_bf16 v53, v178, v25
 v_dot2c_f32_bf16 v54, v179, v24
 v_dot2c_f32_bf16 v55, v179, v25
 v_dot2c_f32_bf16 v56, v180, v24
 v_dot2c_f32_bf16 v57, v180, v25
 v_dot2c_f32_bf16 v58, v181, v24
 v_dot2c_f32_bf16 v59, v181, v25
 v_dot2c_f32_bf16 v60, v182, v24
 v_dot2c_f32_bf16 v61, v182, v25
 v_dot2c_f32_bf16 v62, v183, v24
 v_dot2c_f32_bf16 v63, v183, v25
 s_branch L_ry22
L_rx23:
 v_dot2c_f32_bf16 v48, v184, v24
 v_dot2c_f32_bf16 v49, v184, v25
 v_dot2c_f32_bf16 v50, v185, v24
 v_dot2c_f32_bf16 v51, v185, v25
 v_dot2c_f32_bf16 v52, v186, v24
 v_dot2c_f32_bf16 v53, v186, v25
 v_dot2c_f32_bf16 v54, v187, v24
 v_dot2c_f32_bf16 v55, v187, v25
 v_dot2c_f32_bf16 v56, v188, v24
 v_dot2c_f32_bf16 v57, v188, v25
 v_dot2c_f32_bf16 v58, v189, v24
 v_dot2c_f32_bf16 v59, v189, v25
 v_dot2c_f32_bf16 v60, v190, v24
 v_dot2c_f32_bf16 v61, v190, v25
 v_dot2c_f32_bf16 v62, v191, v24
 v_dot2c_f32_bf16 v63, v191, v25
 s_branch L_ry23
L_rx24:
 v_dot2c_f32_bf16 v48, v192, v24
 v_dot2c_f32_bf16 v49, v192, v25
 v_dot2c_f32_bf16 v50, v193, v24
 v_dot2c_f32_bf16 v51, v193, v25
 v_dot2c_f32_bf16 v52, v194, v24
 v_dot2c_f32_bf16 v53, v194, v25
 v_dot2c_f32_bf16 v54, v195, v24
 v_dot2c_f32_bf16 v55, v195, v25
 v_dot2c_f32_bf16 v56, v196, v24
 v_dot2c_f32_bf16 v57, v196, v25
 v_dot2c_f32_bf16 v58, v197, v24
 v_dot2c_f32_bf16 v59, v197, v25
 v_dot2c_f32_bf16 v60, v198, v24
 v_dot2c_f32_bf16 v61, v198, v25
 v_dot2c_f32_bf16 v62, v199, v24
 v_dot2c_f32_bf16 v63, v199, v25
 s_branch L_ry24
L_rx25:
 v_dot2c_f32_bf16 v48, v200, v24
 v_dot2c_f32_bf16 v49, v200, v25
 v_dot2c_f32_bf16 v50, v201, v24
 v_dot2c_f32_bf16 v51, v201, v25
 v_dot2c_f32_bf16 v52, v202, v24
 v_dot2c_f32_bf16 v53, v202, v25
 v_dot2c_f32_bf16 v54, v203, v24
 v_dot2c_f32_bf16 v55, v203, v25
 v_dot2c_f32_bf16 v56, v204, v24
 v_dot2c_f32_bf16 v57, v204, v25
 v_dot2c_f32_bf16 v58, v205, v24
 v_dot2c_f32_bf16 v59, v205, v25
 v_dot2c_f32_bf16 v60, v206, v24
 v_dot2c_f32_bf16 v61, v206, v25
 v_dot2c_f32_bf16 v62, v207, v24
 v_dot2c_f32_bf16 v63, v207, v25
 s_branch L_ry25
L_rx26:
 v_dot2c_f32_bf16 v48, v208, v24
 v_dot2c_f32_bf16 v49, v208, v25
 v_dot2c_f32_bf16 v50, v209, v24
 v_dot2c_f32_bf16 v51, v209, v25
 v_dot2c_f32_bf16 v52, v210, v24
 v_dot2c_f32_bf16 v53, v210, v25
 v_dot2c_f32_bf16 v54, v211, v24
 v_dot2c_f32_bf16 v55, v211, v25
 v_dot2c_f32_bf16 v56, v212, v24
 v_dot2c_f32_bf16 v57, v212, v25
 v_dot2c_f32_bf16 v58, v213, v24
 v_dot2c_f32_bf16 v59, v213, v25
 v_dot2c_f32_bf16 v60, v214, v24
 v_dot2c_f32_bf16 v61, v214, v25
 v_dot2c_f32_bf16 v62, v215, v24
 v_dot2c_f32_bf16 v63, v215, v25
 s_branch L_ry26
L_rx27:
 v_dot2c_f32_bf16 v48, v216, v24
 v_dot2c_f32_bf16 v49, v216, v25
 v_dot2c_f32_bf16 v50, v217, v24
 v_dot2c_f32_bf16 v51, v217, v25
 v_dot2c_f32_bf16 v52, v218, v24
 v_dot2c_f32_bf16 v53, v218, v25
 v_dot2c_f32_bf16 v54, v219, v24
 v_dot2c_f32_bf16 v55, v219, v25
 v_dot2c_f32_bf16 v56, v220, v24
 v_dot2c_f32_bf16 v57, v220, v25
 v_dot2c_f32_bf16 v58, v221, v24
 v_dot2c_f32_bf16 v59, v221, v25
 v_dot2c_f32_bf16 v60, v222, v24
 v_dot2c_f32_bf16 v61, v222, v25
 v_dot2c_f32_bf16 v62, v223, v24
 v_dot2c_f32_bf16 v63, v223, v25
 s_branch L_ry27
L_rx28:
 v_dot2c_f32_bf16 v48, v224, v24
 v_dot2c_f32_bf16 v49, v224, v25
 v_dot2c_f32_bf16 v50, v225, v24
 v_dot2c_f32_bf16 v51, v225, v25
 v_dot2c_f32_bf16 v52, v226, v24
 v_dot2c_f32_bf16 v53, v226, v25
 v_dot2c_f32_bf16 v54, v227, v24
 v_dot2c_f32_bf16 v55, v227, v25
 v_dot2c_f32_bf16 v56, v228, v24
 v_dot2c_f32_bf16 v57, v228, v25
 v_dot2c_f32_bf16 v58, v229, v24
 v_dot2c_f32_bf16 v59, v229, v25
 v_dot2c_f32_bf16 v60, v230, v24
 v_dot2c_f32_bf16 v61, v230, v25
 v_dot2c_f32_bf16 v62, v231, v24
 v_dot2c_f32_bf16 v63, v231, v25
 s_branch L_ry28
L_rx29:
 v_dot2c_f32_bf16 v48, v232, v24
 v_dot2c_f32_bf16 v49, v232, v25
 v_dot2c_f32_bf16 v50, v233, v24
 v_dot2c_f32_bf16 v51, v233, v25
 v_dot2c_f32_bf16 v52, v234, v24
 v_dot2c_f32_bf16 v53, v234, v25
 v_dot2c_f32_bf16 v54, v235, v24
 v_dot2c_f32_bf16 v55, v235, v25
 v_dot2c_f32_bf16 v56, v236, v24
 v_dot2c_f32_bf16 v57, v236, v25
 v_dot2c_f32_bf16 v58, v237, v24
 v_dot2c_f32_bf16 v59, v237, v25
 v_dot2c_f32_bf16 v60, v238, v24
 v_dot2c_f32_bf16 v61, v238, v25
 v_dot2c_f32_bf16 v62, v239, v24
 v_dot2c_f32_bf16 v63, v239, v25
 s_branch L_ry29
L_rx30:
 v_dot2c_f32_bf16 v48, v240, v24
 v_dot2c_f32_bf16 v49, v240, v25
 v_dot2c_f32_bf16 v50, v241, v24
 v_dot2c_f32_bf16 v51, v241, v25
 v_dot2c_f32_bf16 v52, v242, v24
 v_dot2c_f32_bf16 v53, v242, v25
 v_dot2c_f32_bf16 v54, v243, v24
 v_dot2c_f32_bf16 v55, v243, v25
 v_dot2c_f32_bf16 v56, v244, v24
 v_dot2c_f32_bf16 v57, v244, v25
 v_dot2c_f32_bf16 v58, v245, v24
 v_dot2c_f32_bf16 v59, v245, v25
 v_dot2c_f32_bf16 v60, v246, v24
 v_dot2c_f32_bf16 v61, v246, v25
 v_dot2c_f32_bf16 v62, v247, v24
 v_dot2c_f32_bf16 v63, v247, v25
 s_branch L_ry30
L_rx31:
 v_dot2c_f32_bf16 v48, v248, v24
 v_dot2c_f32_bf16 v49, v248, v25
 v_dot2c_f32_bf16 v50, v249, v24
 v_dot2c_f32_bf16 v51, v249, v25
 v_dot2c_f32_bf16 v52, v250, v24
 v_dot2c_f32_bf16 v53, v250, v25
 v_dot2c_f32_bf16 v54, v251, v24
 v_dot2c_f32_bf16 v55, v251, v25
 v_dot2c_f32_bf16 v56, v252, v24
 v_dot2c_f32_bf16 v57, v252, v25
 v_dot2c_f32_bf16 v58, v253, v24
 v_dot2c_f32_bf16 v59, v253, v25
 v_dot2c_f32_bf16 v60, v254, v24
 v_dot2c_f32_bf16 v61, v254, v25
 v_dot2c_f32_bf16 v62, v255, v24
 v_dot2c_f32_bf16 v63, v255, v25
 s_branch L_ry31
L_rpoll0:
 s_sleep 1
L_rpoll:
 buffer_load_dword v9, v14, s[8:11], s46 offen sc1
 s_waitcnt vmcnt(0)
 v_cmp_eq_u32 vcc, 1, v9
 s_sub_u32 s91, s91, 1
 s_cselect_b32 s70, -1, 0
 s_or_b32 s70, s70, vcc_lo
 s_andn2_b32 s70, s70, s68
 s_cbranch_scc0 L_rpoll0
 s_or_b32 s68, s68, s70
 s_setpc_b64 s[36:37]
L_comb:
 buffer_load_dwordx4 v[14:17], v7, s[8:11], s52 offen sc1
 s_waitcnt vmcnt(0)
 s_add_u32 m0, s28, 32768
 s_nop 0
 buffer_load_dwordx4 v3, s[8:11], s21 offen offset:0 sc1 lds
 buffer_load_dwordx4 v3, s[8:11], s21 offen offset:1024 sc1 lds
 buffer_load_dwordx4 v3, s[8:11], s21 offen offset:2048 sc1 lds
 buffer_load_dwordx4 v3, s[8:11], s21 offen offset:3072 sc1 lds
 s_add_u32 m0, s28, 36864
 s_nop 0
 buffer_load_dwordx4 v4, s[8:11], s21 offen offset:0 sc1 lds
 buffer_load_dwordx4 v4, s[8:11], s21 offen offset:1024 sc1 lds
 buffer_load_dwordx4 v4, s[8:11], s21 offen offset:2048 sc1 lds
 buffer_load_dwordx4 v4, s[8:11], s21 offen offset:3072 sc1 lds
 s_nop 7
 v_sub_f32 v10, v32, v14
 v_sub_f32 v11, v36, v15
 v_max_f32 v10, 0, v10
 v_max_f32 v11, 0, v11
 v_sub_f32 v100, v100, v11
 v_sub_f32 v101, v101, v11
 v_sub_f32 v102, v102, v11
 v_sub_f32 v103, v103, v11
 v_sub_f32 v108, v108, v11
 v_sub_f32 v109, v109, v11
 v_sub_f32 v110, v110, v11
 v_sub_f32 v111, v111, v11
 v_sub_f32 v116, v116, v11
 v_sub_f32 v117, v117, v11
 v_sub_f32 v118, v118, v11
 v_sub_f32 v119, v119, v11
 v_sub_f32 v124, v124, v11
 v_sub_f32 v125, v125, v11
 v_sub_f32 v126, v126, v11
 v_sub_f32 v127, v127, v11
 v_sub_f32 v32, v32, v10
 v_sub_f32 v33, v33, v10
 v_sub_f32 v34, v34, v10
 v_sub_f32 v35, v35, v10
 v_sub_f32 v36, v36, v11
 v_sub_f32 v37, v37, v11
 v_sub_f32 v38, v38, v11
 v_sub_f32 v39, v39, v11
 v_exp_f32 v12, -v10
 v_exp_f32 v13, -v11
 v_mul_f32 v30, v12, v30
 v_mul_f32 v31, v13, v31
 v_mul_f32 v128, v12, v128
 v_mul_f32 v129, v12, v129
 v_mul_f32 v130, v12, v130
 v_mul_f32 v131, v12, v131
 v_mul_f32 v132, v13, v132
 v_mul_f32 v133, v13, v133
 v_mul_f32 v134, v13, v134
 v_mul_f32 v135, v13, v135
 v_mul_f32 v136, v12, v136
 v_mul_f32 v137, v12, v137
 v_mul_f32 v138, v12, v138
 v_mul_f32 v139, v12, v139
 v_mul_f32 v140, v13, v140
 v_mul_f32 v141, v13, v141
 v_mul_f32 v142, v13, v142
 v_mul_f32 v143, v13, v143
 v_mul_f32 v144, v12, v144
 v_mul_f32 v145, v12, v145
 v_mul_f32 v146, v12, v146
 v_mul_f32 v147, v12, v147
 v_mul_f32 v148, v13, v148
 v_mul_f32 v149, v13, v149
 v_mul_f32 v150, v13, v150
 v_mul_f32 v151, v13, v151
 v_mul_f32 v152, v12, v152
 v_mul_f32 v153, v12, v153
 v_mul_f32 v154, v12, v154
 v_mul_f32 v155, v12, v155
 v_mul_f32 v156, v13, v156
 v_mul_f32 v157, v13, v157
 v_mul_f32 v158, v13, v158
 v_mul_f32 v159, v13, v159
 v_mul_f32 v160, v12, v160
 v_mul_f32 v161, v12, v161
 v_mul_f32 v162, v12, v162
 v_mul_f32 v163, v12, v163
 v_mul_f32 v164, v13, v164
 v_mul_f32 v165, v13, v165
 v_mul_f32 v166, v13, v166
 v_mul_f32 v167, v13, v167
 v_mul_f32 v168, v12, v168
 v_mul_f32 v169, v12, v169
 v_mul_f32 v170, v12, v170
 v_mul_f32 v171, v12, v171
 v_mul_f32 v172, v13, v172
 v_mul_f32 v173, v13, v173
 v_mul_f32 v174, v13, v174
 v_mul_f32 v175, v13, v175
 v_mul_f32 v176, v12, v176
 v_mul_f32 v177, v12, v177
 v_mul_f32 v178, v12, v178
 v_mul_f32 v179, v12, v179
 v_mul_f32 v180, v13, v180
 v_mul_f32 v181, v13, v181
 v_mul_f32 v182, v13, v182
 v_mul_f32 v183, v13, v183
 v_mul_f32 v184, v12, v184
 v_mul_f32 v185, v12, v185
 v_mul_f32 v186, v12, v186
 v_mul_f32 v187, v12, v187
 v_mul_f32 v188, v13, v188
 v_mul_f32 v189, v13, v189
 v_mul_f32 v190, v13, v190
 v_mul_f32 v191, v13, v191
 v_mul_f32 v192, v12, v192
 v_mul_f32 v193, v12, v193
 v_mul_f32 v194, v12, v194
 v_mul_f32 v195, v12, v195
 v_mul_f32 v196, v13, v196
 v_mul_f32 v197, v13, v197
 v_mul_f32 v198, v13, v198
 v_mul_f32 v199, v13, v199
 v_mul_f32 v200, v12, v200
 v_mul_f32 v201, v12, v201
 v_mul_f32 v202, v12, v202
 v_mul_f32 v203, v12, v203
 v_mul_f32 v204, v13, v204
 v_mul_f32 v205, v13, v205
 v_mul_f32 v206, v13, v206
 v_mul_f32 v207, v13, v207
 v_mul_f32 v208, v12, v208
 v_mul_f32 v209, v12, v209
 v_mul_f32 v210, v12, v210
 v_mul_f32 v211, v12, v211
 v_mul_f32 v212, v13, v212
 v_mul_f32 v213, v13, v213
 v_mul_f32 v214, v13, v214
 v_mul_f32 v215, v13, v215
 v_mul_f32 v216, v12, v216
 v_mul_f32 v217, v12, v217
 v_mul_f32 v218, v12, v218
 v_mul_f32 v219, v12, v219
 v_mul_f32 v220, v13, v220
 v_mul_f32 v221, v13, v221
 v_mul_f32 v222, v13, v222
 v_mul_f32 v223, v13, v223
 v_mul_f32 v224, v12, v224
 v_mul_f32 v225, v12, v225
 v_mul_f32 v226, v12, v226
 v_mul_f32 v227, v12, v227
 v_mul_f32 v228, v13, v228
 v_mul_f32 v229, v13, v229
 v_mul_f32 v230, v13, v230
 v_mul_f32 v231, v13, v231
 v_mul_f32 v232, v12, v232
 v_mul_f32 v233, v12, v233
 v_mul_f32 v234, v12, v234
 v_mul_f32 v235, v12, v235
 v_mul_f32 v236, v13, v236
 v_mul_f32 v237, v13, v237
 v_mul_f32 v238, v13, v238
 v_mul_f32 v239, v13, v239
 v_mul_f32 v240, v12, v240
 v_mul_f32 v241, v12, v241
 v_mul_f32 v242, v12, v242
 v_mul_f32 v243, v12, v243
 v_mul_f32 v244, v13, v244
 v_mul_f32 v245, v13, v245
 v_mul_f32 v246, v13, v246
 v_mul_f32 v247, v13, v247
 v_mul_f32 v248, v12, v248
 v_mul_f32 v249, v12, v249
 v_mul_f32 v250, v12, v250
 v_mul_f32 v251, v12, v251
 v_mul_f32 v252, v13, v252
 v_mul_f32 v253, v13, v253
 v_mul_f32 v254, v13, v254
 v_mul_f32 v255, v13, v255
 v_exp_f32 v18, v100
 v_exp_f32 v19, v101
 v_exp_f32 v20, v102
 v_add_f32 v29, v18, v19
 v_cvt_pk_bf16_f32 v52, v18, v19
 v_exp_f32 v21, v103
 v_exp_f32 v22, v108
 v_add_f32 v29, v20, v29
 v_cvt_pk_bf16_f32 v53, v20, v21
 v_exp_f32 v23, v109
 v_add_f32 v29, v21, v29
 v_exp_f32 v24, v110
 v_add_f32 v29, v22, v29
 v_cvt_pk_bf16_f32 v54, v22, v23
 v_exp_f32 v25, v111
 v_add_f32 v29, v23, v29
 v_exp_f32 v18, v116
 v_add_f32 v29, v24, v29
 v_cvt_pk_bf16_f32 v55, v24, v25
 v_exp_f32 v19, v117
 v_add_f32 v29, v25, v29
 v_exp_f32 v20, v118
 v_add_f32 v29, v18, v29
 v_cvt_pk_bf16_f32 v48, v18, v19
 v_exp_f32 v21, v119
 v_add_f32 v29, v19, v29
 v_exp_f32 v22, v124
 v_add_f32 v29, v20, v29
 v_cvt_pk_bf16_f32 v49, v20, v21
 v_exp_f32 v23, v125
 v_add_f32 v29, v21, v29
 v_exp_f32 v24, v126
 v_add_f32 v29, v22, v29
 v_cvt_pk_bf16_f32 v50, v22, v23
 v_exp_f32 v25, v127
 v_add_f32 v29, v23, v29
 v_add_f32 v29, v24, v29
 v_cvt_pk_bf16_f32 v51, v24, v25
 v_add_f32 v29, v25, v29
 v_sub_f32 v10, v32, v14
 v_sub_f32 v11, v36, v15
 v_cvt_i32_f32 v10, v10
 v_cvt_i32_f32 v11, v11
 v_ldexp_f32 v10, 1.0, v10
 v_ldexp_f32 v11, 1.0, v11
 v_and_b32 v10, 0xffff0000, v10
 v_and_b32 v11, 0xffff0000, v11
 v_fmac_f32 v30, v10, v16
 v_fmac_f32 v31, v11, v17
 v_lshrrev_b32 v12, 16, v10
 v_lshrrev_b32 v13, 16, v11
 v_accvgpr_read_b32 v18, a128
 v_dot2c_f32_bf16 v128, v18, v12
 v_dot2c_f32_bf16 v129, v18, v10
 v_accvgpr_read_b32 v19, a129
 v_dot2c_f32_bf16 v130, v19, v12
 v_dot2c_f32_bf16 v131, v19, v10
 v_accvgpr_read_b32 v20, a130
 v_dot2c_f32_bf16 v136, v20, v12
 v_dot2c_f32_bf16 v137, v20, v10
 v_accvgpr_read_b32 v21, a131
 v_dot2c_f32_bf16 v138, v21, v12
 v_dot2c_f32_bf16 v139, v21, v10
 v_accvgpr_read_b32 v22, a132
 v_dot2c_f32_bf16 v144, v22, v12
 v_dot2c_f32_bf16 v145, v22, v10
 v_accvgpr_read_b32 v23, a133
 v_dot2c_f32_bf16 v146, v23, v12
 v_dot2c_f32_bf16 v147, v23, v10
 v_accvgpr_read_b32 v24, a134
 v_dot2c_f32_bf16 v152, v24, v12
 v_dot2c_f32_bf16 v153, v24, v10
 v_accvgpr_read_b32 v25, a135
 v_dot2c_f32_bf16 v154, v25, v12
 v_dot2c_f32_bf16 v155, v25, v10
 v_accvgpr_read_b32 v18, a136
 v_dot2c_f32_bf16 v160, v18, v12
 v_dot2c_f32_bf16 v161, v18, v10
 v_accvgpr_read_b32 v19, a137
 v_dot2c_f32_bf16 v162, v19, v12
 v_dot2c_f32_bf16 v163, v19, v10
 v_accvgpr_read_b32 v20, a138
 v_dot2c_f32_bf16 v168, v20, v12
 v_dot2c_f32_bf16 v169, v20, v10
 v_accvgpr_read_b32 v21, a139
 v_dot2c_f32_bf16 v170, v21, v12
 v_dot2c_f32_bf16 v171, v21, v10
 v_accvgpr_read_b32 v22, a140
 v_dot2c_f32_bf16 v176, v22, v12
 v_dot2c_f32_bf16 v177, v22, v10
 v_accvgpr_read_b32 v23, a141
 v_dot2c_f32_bf16 v178, v23, v12
 v_dot2c_f32_bf16 v179, v23, v10
 v_accvgpr_read_b32 v24, a142
 v_dot2c_f32_bf16 v184, v24, v12
 v_dot2c_f32_bf16 v185, v24, v10
 v_accvgpr_read_b32 v25, a143
 v_dot2c_f32_bf16 v186, v25, v12
 v_dot2c_f32_bf16 v187, v25, v10
 v_accvgpr_read_b32 v18, a144
 v_dot2c_f32_bf16 v192, v18, v12
 v_dot2c_f32_bf16 v193, v18, v10
 v_accvgpr_read_b32 v19, a145
 v_dot2c_f32_bf16 v194, v19, v12
 v_dot2c_f32_bf16 v195, v19, v10
 v_accvgpr_read_b32 v20, a146
 v_dot2c_f32_bf16 v200, v20, v12
 v_dot2c_f32_bf16 v201, v20, v10
 v_accvgpr_read_b32 v21, a147
 v_dot2c_f32_bf16 v202, v21, v12
 v_dot2c_f32_bf16 v203, v21, v10
 v_accvgpr_read_b32 v22, a148
 v_dot2c_f32_bf16 v208, v22, v12
 v_dot2c_f32_bf16 v209, v22, v10
 v_accvgpr_read_b32 v23, a149
 v_dot2c_f32_bf16 v210, v23, v12
 v_dot2c_f32_bf16 v211, v23, v10
 v_accvgpr_read_b32 v24, a150
 v_dot2c_f32_bf16 v216, v24, v12
 v_dot2c_f32_bf16 v217, v24, v10
 v_accvgpr_read_b32 v25, a151
 v_dot2c_f32_bf16 v218, v25, v12
 v_dot2c_f32_bf16 v219, v25, v10
 v_accvgpr_read_b32 v18, a152
 v_dot2c_f32_bf16 v224, v18, v12
 v_dot2c_f32_bf16 v225, v18, v10
 v_accvgpr_read_b32 v19, a153
 v_dot2c_f32_bf16 v226, v19, v12
 v_dot2c_f32_bf16 v227, v19, v10
 v_accvgpr_read_b32 v20, a154
 v_dot2c_f32_bf16 v232, v20, v12
 v_dot2c_f32_bf16 v233, v20, v10
 v_accvgpr_read_b32 v21, a155
 v_dot2c_f32_bf16 v234, v21, v12
 v_dot2c_f32_bf16 v235, v21, v10
 v_accvgpr_read_b32 v22, a156
 v_dot2c_f32_bf16 v240, v22, v12
 v_dot2c_f32_bf16 v241, v22, v10
 v_accvgpr_read_b32 v23, a157
 v_dot2c_f32_bf16 v242, v23, v12
 v_dot2c_f32_bf16 v243, v23, v10
 v_accvgpr_read_b32 v24, a158
 v_dot2c_f32_bf16 v248, v24, v12
 v_dot2c_f32_bf16 v249, v24, v10
 v_accvgpr_read_b32 v25, a159
 v_dot2c_f32_bf16 v250, v25, v12
 v_dot2c_f32_bf16 v251, v25, v10
 v_accvgpr_read_b32 v18, a160
 v_dot2c_f32_bf16 v132, v18, v13
 v_dot2c_f32_bf16 v133, v18, v11
 v_accvgpr_read_b32 v19, a161
 v_dot2c_f32_bf16 v134, v19, v13
 v_dot2c_f32_bf16 v135, v19, v11
 v_accvgpr_read_b32 v20, a162
 v_dot2c_f32_bf16 v140, v20, v13
 v_dot2c_f32_bf16 v141, v20, v11
 v_accvgpr_read_b32 v21, a163
 v_dot2c_f32_bf16 v142, v21, v13
 v_dot2c_f32_bf16 v143, v21, v11
 v_accvgpr_read_b32 v22, a164
 v_dot2c_f32_bf16 v148, v22, v13
 v_dot2c_f32_bf16 v149, v22, v11
 v_accvgpr_read_b32 v23, a165
 v_dot2c_f32_bf16 v150, v23, v13
 v_dot2c_f32_bf16 v151, v23, v11
 v_accvgpr_read_b32 v24, a166
 v_dot2c_f32_bf16 v156, v24, v13
 v_dot2c_f32_bf16 v157, v24, v11
 v_accvgpr_read_b32 v25, a167
 v_dot2c_f32_bf16 v158, v25, v13
 v_dot2c_f32_bf16 v159, v25, v11
 v_accvgpr_read_b32 v18, a168
 v_dot2c_f32_bf16 v164, v18, v13
 v_dot2c_f32_bf16 v165, v18, v11
 v_accvgpr_read_b32 v19, a169
 v_dot2c_f32_bf16 v166, v19, v13
 v_dot2c_f32_bf16 v167, v19, v11
 v_accvgpr_read_b32 v20, a170
 v_dot2c_f32_bf16 v172, v20, v13
 v_dot2c_f32_bf16 v173, v20, v11
 v_accvgpr_read_b32 v21, a171
 v_dot2c_f32_bf16 v174, v21, v13
 v_dot2c_f32_bf16 v175, v21, v11
 v_accvgpr_read_b32 v22, a172
 v_dot2c_f32_bf16 v180, v22, v13
 v_dot2c_f32_bf16 v181, v22, v11
 v_accvgpr_read_b32 v23, a173
 v_dot2c_f32_bf16 v182, v23, v13
 v_dot2c_f32_bf16 v183, v23, v11
 v_accvgpr_read_b32 v24, a174
 v_dot2c_f32_bf16 v188, v24, v13
 v_dot2c_f32_bf16 v189, v24, v11
 v_accvgpr_read_b32 v25, a175
 v_dot2c_f32_bf16 v190, v25, v13
 v_dot2c_f32_bf16 v191, v25, v11
 v_accvgpr_read_b32 v18, a176
 v_dot2c_f32_bf16 v196, v18, v13
 v_dot2c_f32_bf16 v197, v18, v11
 v_accvgpr_read_b32 v19, a177
 v_dot2c_f32_bf16 v198, v19, v13
 v_dot2c_f32_bf16 v199, v19, v11
 v_accvgpr_read_b32 v20, a178
 v_dot2c_f32_bf16 v204, v20, v13
 v_dot2c_f32_bf16 v205, v20, v11
 v_accvgpr_read_b32 v21, a179
 v_dot2c_f32_bf16 v206, v21, v13
 v_dot2c_f32_bf16 v207, v21, v11
 v_accvgpr_read_b32 v22, a180
 v_dot2c_f32_bf16 v212, v22, v13
 v_dot2c_f32_bf16 v213, v22, v11
 v_accvgpr_read_b32 v23, a181
 v_dot2c_f32_bf16 v214, v23, v13
 v_dot2c_f32_bf16 v215, v23, v11
 v_accvgpr_read_b32 v24, a182
 v_dot2c_f32_bf16 v220, v24, v13
 v_dot2c_f32_bf16 v221, v24, v11
 v_accvgpr_read_b32 v25, a183
 v_dot2c_f32_bf16 v222, v25, v13
 v_dot2c_f32_bf16 v223, v25, v11
 v_accvgpr_read_b32 v18, a184
 v_dot2c_f32_bf16 v228, v18, v13
 v_dot2c_f32_bf16 v229, v18, v11
 v_accvgpr_read_b32 v19, a185
 v_dot2c_f32_bf16 v230, v19, v13
 v_dot2c_f32_bf16 v231, v19, v11
 v_accvgpr_read_b32 v20, a186
 v_dot2c_f32_bf16 v236, v20, v13
 v_dot2c_f32_bf16 v237, v20, v11
 v_accvgpr_read_b32 v21, a187
 v_dot2c_f32_bf16 v238, v21, v13
 v_dot2c_f32_bf16 v239, v21, v11
 v_accvgpr_read_b32 v22, a188
 v_dot2c_f32_bf16 v244, v22, v13
 v_dot2c_f32_bf16 v245, v22, v11
 v_accvgpr_read_b32 v23, a189
 v_dot2c_f32_bf16 v246, v23, v13
 v_dot2c_f32_bf16 v247, v23, v11
 v_accvgpr_read_b32 v24, a190
 v_dot2c_f32_bf16 v252, v24, v13
 v_dot2c_f32_bf16 v253, v24, v11
 v_accvgpr_read_b32 v25, a191
 v_dot2c_f32_bf16 v254, v25, v13
 v_dot2c_f32_bf16 v255, v25, v11
 s_nop 3
 s_branch L_pBo
L_st0:
 s_call_b64 s[36:37], L_slow0
 s_branch L_rt0
L_st1:
 s_call_b64 s[36:37], L_slow1
 s_branch L_rt1
L_st2:
 s_call_b64 s[36:37], L_slowB
 s_branch L_rt2
L_st3:
 s_call_b64 s[36:37], L_slowB
 s_branch L_rt3
L_st4:
 s_call_b64 s[36:37], L_slow1n
 s_branch L_rt4
L_st5:
 s_call_b64 s[36:37], L_slow1
 s_branch L_rt5
L_st6:
 s_call_b64 s[36:37], L_slow0B
 s_branch L_rt6
L_st7:
 s_call_b64 s[36:37], L_slowB
 s_branch L_rt7
L_st8:
 s_call_b64 s[36:37], L_slowf
 s_branch L_rt8
L_st9:
 s_call_b64 s[36:37], L_slow1
 s_branch L_rt9
L_st10:
 s_call_b64 s[36:37], L_slowf
 s_branch L_rt10
L_st11:
 s_call_b64 s[36:37], L_slowf
 s_branch L_rt11
L_slow0:
 s_nop 7
 s_nop 3
 v_max3_f32 v10, v64, v65, v66
 v_max3_f32 v10, v67, v72, v10
 v_max3_f32 v10, v73, v74, v10
 v_max3_f32 v10, v75, v80, v10
 v_max3_f32 v10, v81, v82, v10
 v_max3_f32 v10, v83, v88, v10
 v_max3_f32 v10, v89, v90, v10
 v_max_f32 v10, v91, v10
 v_max3_f32 v11, v68, v69, v70
 v_max3_f32 v11, v71, v76, v11
 v_max3_f32 v11, v77, v78, v11
 v_max3_f32 v11, v79, v84, v11
 v_max3_f32 v11, v85, v86, v11
 v_max3_f32 v11, v87, v92, v11
 v_max3_f32 v11, v93, v94, v11
 v_max_f32 v11, v95, v11
 v_mov_b32 v12, v10
 v_mov_b32 v13, v11
 s_nop 0
 v_permlane16_swap_b32 v12, v10
 v_permlane16_swap_b32 v13, v11
 v_max_f32 v10, v12, v10
 v_max_f32 v11, v13, v11
 v_mov_b32 v12, v10
 v_mov_b32 v13, v11
 s_nop 0
 v_permlane32_swap_b32 v12, v10
 v_permlane32_swap_b32 v13, v11
 v_max_f32 v10, v12, v10
 v_max_f32 v11, v13, v11
 v_ceil_f32 v10, v10
 v_ceil_f32 v11, v11
 v_max_f32 v10, 0, v10
 v_max_f32 v11, 0, v11
 v_sub_f32 v64, v64, v10
 v_sub_f32 v65, v65, v10
 v_sub_f32 v66, v66, v10
 v_sub_f32 v67, v67, v10
 v_sub_f32 v68, v68, v11
 v_sub_f32 v69, v69, v11
 v_sub_f32 v70, v70, v11
 v_sub_f32 v71, v71, v11
 v_sub_f32 v72, v72, v10
 v_sub_f32 v73, v73, v10
 v_sub_f32 v74, v74, v10
 v_sub_f32 v75, v75, v10
 v_sub_f32 v76, v76, v11
 v_sub_f32 v77, v77, v11
 v_sub_f32 v78, v78, v11
 v_sub_f32 v79, v79, v11
 v_sub_f32 v80, v80, v10
 v_sub_f32 v81, v81, v10
 v_sub_f32 v82, v82, v10
 v_sub_f32 v83, v83, v10
 v_sub_f32 v84, v84, v11
 v_sub_f32 v85, v85, v11
 v_sub_f32 v86, v86, v11
 v_sub_f32 v87, v87, v11
 v_sub_f32 v88, v88, v10
 v_sub_f32 v89, v89, v10
 v_sub_f32 v90, v90, v10
 v_sub_f32 v91, v91, v10
 v_sub_f32 v92, v92, v11
 v_sub_f32 v93, v93, v11
 v_sub_f32 v94, v94, v11
 v_sub_f32 v95, v95, v11
 v_sub_f32 v96, v96, v10
 v_sub_f32 v97, v97, v10
 v_sub_f32 v98, v98, v10
 v_sub_f32 v99, v99, v10
 v_sub_f32 v100, v100, v11
 v_sub_f32 v101, v101, v11
 v_sub_f32 v102, v102, v11
 v_sub_f32 v103, v103, v11
 v_sub_f32 v104, v104, v10
 v_sub_f32 v105, v105, v10
 v_sub_f32 v106, v106, v10
 v_sub_f32 v107, v107, v10
 v_sub_f32 v108, v108, v11
 v_sub_f32 v109, v109, v11
 v_sub_f32 v110, v110, v11
 v_sub_f32 v111, v111, v11
 v_sub_f32 v112, v112, v10
 v_sub_f32 v113, v113, v10
 v_sub_f32 v114, v114, v10
 v_sub_f32 v115, v115, v10
 v_sub_f32 v116, v116, v11
 v_sub_f32 v117, v117, v11
 v_sub_f32 v118, v118, v11
 v_sub_f32 v119, v119, v11
 v_sub_f32 v120, v120, v10
 v_sub_f32 v121, v121, v10
 v_sub_f32 v122, v122, v10
 v_sub_f32 v123, v123, v10
 v_sub_f32 v124, v124, v11
 v_sub_f32 v125, v125, v11
 v_sub_f32 v126, v126, v11
 v_sub_f32 v127, v127, v11
 v_sub_f32 v32, v32, v10
 v_sub_f32 v33, v33, v10
 v_sub_f32 v34, v34, v10
 v_sub_f32 v35, v35, v10
 v_sub_f32 v36, v36, v11
 v_sub_f32 v37, v37, v11
 v_sub_f32 v38, v38, v11
 v_sub_f32 v39, v39, v11
 v_exp_f32 v12, -v10
 v_exp_f32 v13, -v11
 v_mul_f32 v30, v12, v30
 v_mul_f32 v31, v13, v31
 v_mul_f32 v128, v12, v128
 v_mul_f32 v129, v12, v129
 v_mul_f32 v130, v12, v130
 v_mul_f32 v131, v12, v131
 v_mul_f32 v132, v13, v132
 v_mul_f32 v133, v13, v133
 v_mul_f32 v134, v13, v134
 v_mul_f32 v135, v13, v135
 v_mul_f32 v136, v12, v136
 v_mul_f32 v137, v12, v137
 v_mul_f32 v138, v12, v138
 v_mul_f32 v139, v12, v139
 v_mul_f32 v140, v13, v140
 v_mul_f32 v141, v13, v141
 v_mul_f32 v142, v13, v142
 v_mul_f32 v143, v13, v143
 v_mul_f32 v144, v12, v144
 v_mul_f32 v145, v12, v145
 v_mul_f32 v146, v12, v146
 v_mul_f32 v147, v12, v147
 v_mul_f32 v148, v13, v148
 v_mul_f32 v149, v13, v149
 v_mul_f32 v150, v13, v150
 v_mul_f32 v151, v13, v151
 v_mul_f32 v152, v12, v152
 v_mul_f32 v153, v12, v153
 v_mul_f32 v154, v12, v154
 v_mul_f32 v155, v12, v155
 v_mul_f32 v156, v13, v156
 v_mul_f32 v157, v13, v157
 v_mul_f32 v158, v13, v158
 v_mul_f32 v159, v13, v159
 v_mul_f32 v160, v12, v160
 v_mul_f32 v161, v12, v161
 v_mul_f32 v162, v12, v162
 v_mul_f32 v163, v12, v163
 v_mul_f32 v164, v13, v164
 v_mul_f32 v165, v13, v165
 v_mul_f32 v166, v13, v166
 v_mul_f32 v167, v13, v167
 v_mul_f32 v168, v12, v168
 v_mul_f32 v169, v12, v169
 v_mul_f32 v170, v12, v170
 v_mul_f32 v171, v12, v171
 v_mul_f32 v172, v13, v172
 v_mul_f32 v173, v13, v173
 v_mul_f32 v174, v13, v174
 v_mul_f32 v175, v13, v175
 v_mul_f32 v176, v12, v176
 v_mul_f32 v177, v12, v177
 v_mul_f32 v178, v12, v178
 v_mul_f32 v179, v12, v179
 v_mul_f32 v180, v13, v180
 v_mul_f32 v181, v13, v181
 v_mul_f32 v182, v13, v182
 v_mul_f32 v183, v13, v183
 v_mul_f32 v184, v12, v184
 v_mul_f32 v185, v12, v185
 v_mul_f32 v186, v12, v186
 v_mul_f32 v187, v12, v187
 v_mul_f32 v188, v13, v188
 v_mul_f32 v189, v13, v189
 v_mul_f32 v190, v13, v190
 v_mul_f32 v191, v13, v191
 v_mul_f32 v192, v12, v192
 v_mul_f32 v193, v12, v193
 v_mul_f32 v194, v12, v194
 v_mul_f32 v195, v12, v195
 v_mul_f32 v196, v13, v196
 v_mul_f32 v197, v13, v197
 v_mul_f32 v198, v13, v198
 v_mul_f32 v199, v13, v199
 v_mul_f32 v200, v12, v200
 v_mul_f32 v201, v12, v201
 v_mul_f32 v202, v12, v202
 v_mul_f32 v203, v12, v203
 v_mul_f32 v204, v13, v204
 v_mul_f32 v205, v13, v205
 v_mul_f32 v206, v13, v206
 v_mul_f32 v207, v13, v207
 v_mul_f32 v208, v12, v208
 v_mul_f32 v209, v12, v209
 v_mul_f32 v210, v12, v210
 v_mul_f32 v211, v12, v211
 v_mul_f32 v212, v13, v212
 v_mul_f32 v213, v13, v213
 v_mul_f32 v214, v13, v214
 v_mul_f32 v215, v13, v215
 v_mul_f32 v216, v12, v216
 v_mul_f32 v217, v12, v217
 v_mul_f32 v218, v12, v218
 v_mul_f32 v219, v12, v219
 v_mul_f32 v220, v13, v220
 v_mul_f32 v221, v13, v221
 v_mul_f32 v222, v13, v222
 v_mul_f32 v223, v13, v223
 v_mul_f32 v224, v12, v224
 v_mul_f32 v225, v12, v225
 v_mul_f32 v226, v12, v226
 v_mul_f32 v227, v12, v227
 v_mul_f32 v228, v13, v228
 v_mul_f32 v229, v13, v229
 v_mul_f32 v230, v13, v230
 v_mul_f32 v231, v13, v231
 v_mul_f32 v232, v12, v232
 v_mul_f32 v233, v12, v233
 v_mul_f32 v234, v12, v234
 v_mul_f32 v235, v12, v235
 v_mul_f32 v236, v13, v236
 v_mul_f32 v237, v13, v237
 v_mul_f32 v238, v13, v238
 v_mul_f32 v239, v13, v239
 v_mul_f32 v240, v12, v240
 v_mul_f32 v241, v12, v241
 v_mul_f32 v242, v12, v242
 v_mul_f32 v243, v12, v243
 v_mul_f32 v244, v13, v244
 v_mul_f32 v245, v13, v245
 v_mul_f32 v246, v13, v246
 v_mul_f32 v247, v13, v247
 v_mul_f32 v248, v12, v248
 v_mul_f32 v249, v12, v249
 v_mul_f32 v250, v12, v250
 v_mul_f32 v251, v12, v251
 v_mul_f32 v252, v13, v252
 v_mul_f32 v253, v13, v253
 v_mul_f32 v254, v13, v254
 v_mul_f32 v255, v13, v255
 v_exp_f32 v18, v64
 v_exp_f32 v19, v65
 v_exp_f32 v20, v66
 v_add_f32 v26, v18, v19
 v_cvt_pk_bf16_f32 v40, v18, v19
 v_exp_f32 v21, v67
 v_exp_f32 v22, v72
 v_add_f32 v26, v20, v26
 v_cvt_pk_bf16_f32 v41, v20, v21
 v_exp_f32 v23, v73
 v_add_f32 v26, v21, v26
 v_exp_f32 v24, v74
 v_add_f32 v26, v22, v26
 v_cvt_pk_bf16_f32 v42, v22, v23
 v_exp_f32 v25, v75
 v_add_f32 v26, v23, v26
 v_exp_f32 v18, v68
 v_add_f32 v26, v24, v26
 v_cvt_pk_bf16_f32 v43, v24, v25
 v_exp_f32 v19, v69
 v_add_f32 v26, v25, v26
 v_exp_f32 v20, v70
 v_add_f32 v27, v18, v19
 v_cvt_pk_bf16_f32 v44, v18, v19
 v_exp_f32 v21, v71
 v_exp_f32 v22, v76
 v_add_f32 v27, v20, v27
 v_cvt_pk_bf16_f32 v45, v20, v21
 v_exp_f32 v23, v77
 v_add_f32 v27, v21, v27
 v_exp_f32 v24, v78
 v_add_f32 v27, v22, v27
 v_cvt_pk_bf16_f32 v46, v22, v23
 v_exp_f32 v25, v79
 v_add_f32 v27, v23, v27
 v_add_f32 v27, v24, v27
 v_cvt_pk_bf16_f32 v47, v24, v25
 v_add_f32 v27, v25, v27
 v_exp_f32 v18, v80
 v_exp_f32 v19, v81
 v_exp_f32 v20, v82
 v_add_f32 v26, v18, v26
 v_cvt_pk_bf16_f32 v56, v18, v19
 v_exp_f32 v21, v83
 v_add_f32 v26, v19, v26
 v_exp_f32 v22, v88
 v_add_f32 v26, v20, v26
 v_cvt_pk_bf16_f32 v57, v20, v21
 v_exp_f32 v23, v89
 v_add_f32 v26, v21, v26
 v_exp_f32 v24, v90
 v_add_f32 v26, v22, v26
 v_cvt_pk_bf16_f32 v58, v22, v23
 v_exp_f32 v25, v91
 v_add_f32 v26, v23, v26
 v_exp_f32 v18, v84
 v_add_f32 v26, v24, v26
 v_cvt_pk_bf16_f32 v59, v24, v25
 v_exp_f32 v19, v85
 v_add_f32 v26, v25, v26
 v_exp_f32 v20, v86
 v_add_f32 v27, v18, v27
 v_cvt_pk_bf16_f32 v60, v18, v19
 v_exp_f32 v21, v87
 v_add_f32 v27, v19, v27
 v_exp_f32 v22, v92
 v_add_f32 v27, v20, v27
 v_cvt_pk_bf16_f32 v61, v20, v21
 v_exp_f32 v23, v93
 v_add_f32 v27, v21, v27
 v_exp_f32 v24, v94
 v_add_f32 v27, v22, v27
 v_cvt_pk_bf16_f32 v62, v22, v23
 v_exp_f32 v25, v95
 v_add_f32 v27, v23, v27
 v_add_f32 v27, v24, v27
 v_cvt_pk_bf16_f32 v63, v24, v25
 v_add_f32 v27, v25, v27
 s_nop 3
 s_setpc_b64 s[36:37]
L_slow1:
 s_nop 7
 s_nop 3
 v_max3_f32 v10, v96, v97, v98
 v_max3_f32 v10, v99, v104, v10
 v_max3_f32 v10, v105, v106, v10
 v_max3_f32 v10, v107, v112, v10
 v_max3_f32 v10, v113, v114, v10
 v_max3_f32 v10, v115, v120, v10
 v_max3_f32 v10, v121, v122, v10
 v_max_f32 v10, v123, v10
 v_max3_f32 v11, v100, v101, v102
 v_max3_f32 v11, v103, v108, v11
 v_max3_f32 v11, v109, v110, v11
 v_max3_f32 v11, v111, v116, v11
 v_max3_f32 v11, v117, v118, v11
 v_max3_f32 v11, v119, v124, v11
 v_max3_f32 v11, v125, v126, v11
 v_max_f32 v11, v127, v11
 v_mov_b32 v12, v10
 v_mov_b32 v13, v11
 s_nop 0
 v_permlane16_swap_b32 v12, v10
 v_permlane16_swap_b32 v13, v11
 v_max_f32 v10, v12, v10
 v_max_f32 v11, v13, v11
 v_mov_b32 v12, v10
 v_mov_b32 v13, v11
 s_nop 0
 v_permlane32_swap_b32 v12, v10
 v_permlane32_swap_b32 v13, v11
 v_max_f32 v10, v12, v10
 v_max_f32 v11, v13, v11
 v_ceil_f32 v10, v10
 v_ceil_f32 v11, v11
 v_max_f32 v10, 0, v10
 v_max_f32 v11, 0, v11
 v_sub_f32 v96, v96, v10
 v_sub_f32 v97, v97, v10
 v_sub_f32 v98, v98, v10
 v_sub_f32 v99, v99, v10
 v_sub_f32 v100, v100, v11
 v_sub_f32 v101, v101, v11
 v_sub_f32 v102, v102, v11
 v_sub_f32 v103, v103, v11
 v_sub_f32 v104, v104, v10
 v_sub_f32 v105, v105, v10
 v_sub_f32 v106, v106, v10
 v_sub_f32 v107, v107, v10
 v_sub_f32 v108, v108, v11
 v_sub_f32 v109, v109, v11
 v_sub_f32 v110, v110, v11
 v_sub_f32 v111, v111, v11
 v_sub_f32 v112, v112, v10
 v_sub_f32 v113, v113, v10
 v_sub_f32 v114, v114, v10
 v_sub_f32 v115, v115, v10
 v_sub_f32 v116, v116, v11
 v_sub_f32 v117, v117, v11
 v_sub_f32 v118, v118, v11
 v_sub_f32 v119, v119, v11
 v_sub_f32 v120, v120, v10
 v_sub_f32 v121, v121, v10
 v_sub_f32 v122, v122, v10
 v_sub_f32 v123, v123, v10
 v_sub_f32 v124, v124, v11
 v_sub_f32 v125, v125, v11
 v_sub_f32 v126, v126, v11
 v_sub_f32 v127, v127, v11
 v_sub_f32 v64, v64, v10
 v_sub_f32 v65, v65, v10
 v_sub_f32 v66, v66, v10
 v_sub_f32 v67, v67, v10
 v_sub_f32 v68, v68, v11
 v_sub_f32 v69, v69, v11
 v_sub_f32 v70, v70, v11
 v_sub_f32 v71, v71, v11
 v_sub_f32 v72, v72, v10
 v_sub_f32 v73, v73, v10
 v_sub_f32 v74, v74, v10
 v_sub_f32 v75, v75, v10
 v_sub_f32 v76, v76, v11
 v_sub_f32 v77, v77, v11
 v_sub_f32 v78, v78, v11
 v_sub_f32 v79, v79, v11
 v_sub_f32 v80, v80, v10
 v_sub_f32 v81, v81, v10
 v_sub_f32 v82, v82, v10
 v_sub_f32 v83, v83, v10
 v_sub_f32 v84, v84, v11
 v_sub_f32 v85, v85, v11
 v_sub_f32 v86, v86, v11
 v_sub_f32 v87, v87, v11
 v_sub_f32 v88, v88, v10
 v_sub_f32 v89, v89, v10
 v_sub_f32 v90, v90, v10
 v_sub_f32 v91, v91, v10
 v_sub_f32 v92, v92, v11
 v_sub_f32 v93, v93, v11
 v_sub_f32 v94, v94, v11
 v_sub_f32 v95, v95, v11
 v_sub_f32 v32, v32, v10
 v_sub_f32 v33, v33, v10
 v_sub_f32 v34, v34, v10
 v_sub_f32 v35, v35, v10
 v_sub_f32 v36, v36, v11
 v_sub_f32 v37, v37, v11
 v_sub_f32 v38, v38, v11
 v_sub_f32 v39, v39, v11
 v_exp_f32 v12, -v10
 v_exp_f32 v13, -v11
 v_mul_f32 v30, v12, v30
 v_mul_f32 v31, v13, v31
 v_mul_f32 v128, v12, v128
 v_mul_f32 v129, v12, v129
 v_mul_f32 v130, v12, v130
 v_mul_f32 v131, v12, v131
 v_mul_f32 v132, v13, v132
 v_mul_f32 v133, v13, v133
 v_mul_f32 v134, v13, v134
 v_mul_f32 v135, v13, v135
 v_mul_f32 v136, v12, v136
 v_mul_f32 v137, v12, v137
 v_mul_f32 v138, v12, v138
 v_mul_f32 v139, v12, v139
 v_mul_f32 v140, v13, v140
 v_mul_f32 v141, v13, v141
 v_mul_f32 v142, v13, v142
 v_mul_f32 v143, v13, v143
 v_mul_f32 v144, v12, v144
 v_mul_f32 v145, v12, v145
 v_mul_f32 v146, v12, v146
 v_mul_f32 v147, v12, v147
 v_mul_f32 v148, v13, v148
 v_mul_f32 v149, v13, v149
 v_mul_f32 v150, v13, v150
 v_mul_f32 v151, v13, v151
 v_mul_f32 v152, v12, v152
 v_mul_f32 v153, v12, v153
 v_mul_f32 v154, v12, v154
 v_mul_f32 v155, v12, v155
 v_mul_f32 v156, v13, v156
 v_mul_f32 v157, v13, v157
 v_mul_f32 v158, v13, v158
 v_mul_f32 v159, v13, v159
 v_mul_f32 v160, v12, v160
 v_mul_f32 v161, v12, v161
 v_mul_f32 v162, v12, v162
 v_mul_f32 v163, v12, v163
 v_mul_f32 v164, v13, v164
 v_mul_f32 v165, v13, v165
 v_mul_f32 v166, v13, v166
 v_mul_f32 v167, v13, v167
 v_mul_f32 v168, v12, v168
 v_mul_f32 v169, v12, v169
 v_mul_f32 v170, v12, v170
 v_mul_f32 v171, v12, v171
 v_mul_f32 v172, v13, v172
 v_mul_f32 v173, v13, v173
 v_mul_f32 v174, v13, v174
 v_mul_f32 v175, v13, v175
 v_mul_f32 v176, v12, v176
 v_mul_f32 v177, v12, v177
 v_mul_f32 v178, v12, v178
 v_mul_f32 v179, v12, v179
 v_mul_f32 v180, v13, v180
 v_mul_f32 v181, v13, v181
 v_mul_f32 v182, v13, v182
 v_mul_f32 v183, v13, v183
 v_mul_f32 v184, v12, v184
 v_mul_f32 v185, v12, v185
 v_mul_f32 v186, v12, v186
 v_mul_f32 v187, v12, v187
 v_mul_f32 v188, v13, v188
 v_mul_f32 v189, v13, v189
 v_mul_f32 v190, v13, v190
 v_mul_f32 v191, v13, v191
 v_mul_f32 v192, v12, v192
 v_mul_f32 v193, v12, v193
 v_mul_f32 v194, v12, v194
 v_mul_f32 v195, v12, v195
 v_mul_f32 v196, v13, v196
 v_mul_f32 v197, v13, v197
 v_mul_f32 v198, v13, v198
 v_mul_f32 v199, v13, v199
 v_mul_f32 v200, v12, v200
 v_mul_f32 v201, v12, v201
 v_mul_f32 v202, v12, v202
 v_mul_f32 v203, v12, v203
 v_mul_f32 v204, v13, v204
 v_mul_f32 v205, v13, v205
 v_mul_f32 v206, v13, v206
 v_mul_f32 v207, v13, v207
 v_mul_f32 v208, v12, v208
 v_mul_f32 v209, v12, v209
 v_mul_f32 v210, v12, v210
 v_mul_f32 v211, v12, v211
 v_mul_f32 v212, v13, v212
 v_mul_f32 v213, v13, v213
 v_mul_f32 v214, v13, v214
 v_mul_f32 v215, v13, v215
 v_mul_f32 v216, v12, v216
 v_mul_f32 v217, v12, v217
 v_mul_f32 v218, v12, v218
 v_mul_f32 v219, v12, v219
 v_mul_f32 v220, v13, v220
 v_mul_f32 v221, v13, v221
 v_mul_f32 v222, v13, v222
 v_mul_f32 v223, v13, v223
 v_mul_f32 v224, v12, v224
 v_mul_f32 v225, v12, v225
 v_mul_f32 v226, v12, v226
 v_mul_f32 v227, v12, v227
 v_mul_f32 v228, v13, v228
 v_mul_f32 v229, v13, v229
 v_mul_f32 v230, v13, v230
 v_mul_f32 v231, v13, v231
 v_mul_f32 v232, v12, v232
 v_mul_f32 v233, v12, v233
 v_mul_f32 v234, v12, v234
 v_mul_f32 v235, v12, v235
 v_mul_f32 v236, v13, v236
 v_mul_f32 v237, v13, v237
 v_mul_f32 v238, v13, v238
 v_mul_f32 v239, v13, v239
 v_mul_f32 v240, v12, v240
 v_mul_f32 v241, v12, v241
 v_mul_f32 v242, v12, v242
 v_mul_f32 v243, v12, v243
 v_mul_f32 v244, v13, v244
 v_mul_f32 v245, v13, v245
 v_mul_f32 v246, v13, v246
 v_mul_f32 v247, v13, v247
 v_mul_f32 v248, v12, v248
 v_mul_f32 v249, v12, v249
 v_mul_f32 v250, v12, v250
 v_mul_f32 v251, v12, v251
 v_mul_f32 v252, v13, v252
 v_mul_f32 v253, v13, v253
 v_mul_f32 v254, v13, v254
 v_mul_f32 v255, v13, v255
 v_exp_f32 v18, v96
 v_exp_f32 v19, v97
 v_exp_f32 v20, v98
 v_add_f32 v28, v18, v19
 v_cvt_pk_bf16_f32 v48, v18, v19
 v_exp_f32 v21, v99
 v_exp_f32 v22, v104
 v_add_f32 v28, v20, v28
 v_cvt_pk_bf16_f32 v49, v20, v21
 v_exp_f32 v23, v105
 v_add_f32 v28, v21, v28
 v_exp_f32 v24, v106
 v_add_f32 v28, v22, v28
 v_cvt_pk_bf16_f32 v50, v22, v23
 v_exp_f32 v25, v107
 v_add_f32 v28, v23, v28
 v_exp_f32 v18, v100
 v_add_f32 v28, v24, v28
 v_cvt_pk_bf16_f32 v51, v24, v25
 v_exp_f32 v19, v101
 v_add_f32 v28, v25, v28
 v_exp_f32 v20, v102
 v_add_f32 v29, v18, v19
 v_cvt_pk_bf16_f32 v52, v18, v19
 v_exp_f32 v21, v103
 v_exp_f32 v22, v108
 v_add_f32 v29, v20, v29
 v_cvt_pk_bf16_f32 v53, v20, v21
 v_exp_f32 v23, v109
 v_add_f32 v29, v21, v29
 v_exp_f32 v24, v110
 v_add_f32 v29, v22, v29
 v_cvt_pk_bf16_f32 v54, v22, v23
 v_exp_f32 v25, v111
 v_add_f32 v29, v23, v29
 v_add_f32 v29, v24, v29
 v_cvt_pk_bf16_f32 v55, v24, v25
 v_add_f32 v29, v25, v29
 v_exp_f32 v18, v112
 v_exp_f32 v19, v113
 v_exp_f32 v20, v114
 v_add_f32 v28, v18, v28
 v_cvt_pk_bf16_f32 v56, v18, v19
 v_exp_f32 v21, v115
 v_add_f32 v28, v19, v28
 v_exp_f32 v22, v120
 v_add_f32 v28, v20, v28
 v_cvt_pk_bf16_f32 v57, v20, v21
 v_exp_f32 v23, v121
 v_add_f32 v28, v21, v28
 v_exp_f32 v24, v122
 v_add_f32 v28, v22, v28
 v_cvt_pk_bf16_f32 v58, v22, v23
 v_exp_f32 v25, v123
 v_add_f32 v28, v23, v28
 v_exp_f32 v18, v116
 v_add_f32 v28, v24, v28
 v_cvt_pk_bf16_f32 v59, v24, v25
 v_exp_f32 v19, v117
 v_add_f32 v28, v25, v28
 v_exp_f32 v20, v118
 v_add_f32 v29, v18, v29
 v_cvt_pk_bf16_f32 v60, v18, v19
 v_exp_f32 v21, v119
 v_add_f32 v29, v19, v29
 v_exp_f32 v22, v124
 v_add_f32 v29, v20, v29
 v_cvt_pk_bf16_f32 v61, v20, v21
 v_exp_f32 v23, v125
 v_add_f32 v29, v21, v29
 v_exp_f32 v24, v126
 v_add_f32 v29, v22, v29
 v_cvt_pk_bf16_f32 v62, v22, v23
 v_exp_f32 v25, v127
 v_add_f32 v29, v23, v29
 v_add_f32 v29, v24, v29
 v_cvt_pk_bf16_f32 v63, v24, v25
 v_add_f32 v29, v25, v29
 s_nop 3
 s_setpc_b64 s[36:37]
L_slow1n:
 s_nop 7
 s_nop 3
 v_max3_f32 v10, v96, v97, v98
 v_max3_f32 v10, v99, v104, v10
 v_max3_f32 v10, v105, v106, v10
 v_max3_f32 v10, v107, v112, v10
 v_max3_f32 v10, v113, v114, v10
 v_max3_f32 v10, v115, v120, v10
 v_max3_f32 v10, v121, v122, v10
 v_max_f32 v10, v123, v10
 v_max3_f32 v11, v100, v101, v102
 v_max3_f32 v11, v103, v108, v11
 v_max3_f32 v11, v109, v110, v11
 v_max3_f32 v11, v111, v116, v11
 v_max3_f32 v11, v117, v118, v11
 v_max3_f32 v11, v119, v124, v11
 v_max3_f32 v11, v125, v126, v11
 v_max_f32 v11, v127, v11
 v_mov_b32 v12, v10
 v_mov_b32 v13, v11
 s_nop 0
 v_permlane16_swap_b32 v12, v10
 v_permlane16_swap_b32 v13, v11
 v_max_f32 v10, v12, v10
 v_max_f32 v11, v13, v11
 v_mov_b32 v12, v10
 v_mov_b32 v13, v11
 s_nop 0
 v_permlane32_swap_b32 v12, v10
 v_permlane32_swap_b32 v13, v11
 v_max_f32 v10, v12, v10
 v_max_f32 v11, v13, v11
 v_ceil_f32 v10, v10
 v_ceil_f32 v11, v11
 v_max_f32 v10, 0, v10
 v_max_f32 v11, 0, v11
 v_sub_f32 v96, v96, v10
 v_sub_f32 v97, v97, v10
 v_sub_f32 v98, v98, v10
 v_sub_f32 v99, v99, v10
 v_sub_f32 v100, v100, v11
 v_sub_f32 v101, v101, v11
 v_sub_f32 v102, v102, v11
 v_sub_f32 v103, v103, v11
 v_sub_f32 v104, v104, v10
 v_sub_f32 v105, v105, v10
 v_sub_f32 v106, v106, v10
 v_sub_f32 v107, v107, v10
 v_sub_f32 v108, v108, v11
 v_sub_f32 v109, v109, v11
 v_sub_f32 v110, v110, v11
 v_sub_f32 v111, v111, v11
 v_sub_f32 v112, v112, v10
 v_sub_f32 v113, v113, v10
 v_sub_f32 v114, v114, v10
 v_sub_f32 v115, v115, v10
 v_sub_f32 v116, v116, v11
 v_sub_f32 v117, v117, v11
 v_sub_f32 v118, v118, v11
 v_sub_f32 v119, v119, v11
 v_sub_f32 v120, v120, v10
 v_sub_f32 v121, v121, v10
 v_sub_f32 v122, v122, v10
 v_sub_f32 v123, v123, v10
 v_sub_f32 v124, v124, v11
 v_sub_f32 v125, v125, v11
 v_sub_f32 v126, v126, v11
 v_sub_f32 v127, v127, v11
 v_sub_f32 v32, v32, v10
 v_sub_f32 v33, v33, v10
 v_sub_f32 v34, v34, v10
 v_sub_f32 v35, v35, v10
 v_sub_f32 v36, v36, v11
 v_sub_f32 v37, v37, v11
 v_sub_f32 v38, v38, v11
 v_sub_f32 v39, v39, v11
 v_exp_f32 v12, -v10
 v_exp_f32 v13, -v11
 v_mul_f32 v30, v12, v30
 v_mul_f32 v31, v13, v31
 v_mul_f32 v128, v12, v128
 v_mul_f32 v129, v12, v129
 v_mul_f32 v130, v12, v130
 v_mul_f32 v131, v12, v131
 v_mul_f32 v132, v13, v132
 v_mul_f32 v133, v13, v133
 v_mul_f32 v134, v13, v134
 v_mul_f32 v135, v13, v135
 v_mul_f32 v136, v12, v136
 v_mul_f32 v137, v12, v137
 v_mul_f32 v138, v12, v138
 v_mul_f32 v139, v12, v139
 v_mul_f32 v140, v13, v140
 v_mul_f32 v141, v13, v141
 v_mul_f32 v142, v13, v142
 v_mul_f32 v143, v13, v143
 v_mul_f32 v144, v12, v144
 v_mul_f32 v145, v12, v145
 v_mul_f32 v146, v12, v146
 v_mul_f32 v147, v12, v147
 v_mul_f32 v148, v13, v148
 v_mul_f32 v149, v13, v149
 v_mul_f32 v150, v13, v150
 v_mul_f32 v151, v13, v151
 v_mul_f32 v152, v12, v152
 v_mul_f32 v153, v12, v153
 v_mul_f32 v154, v12, v154
 v_mul_f32 v155, v12, v155
 v_mul_f32 v156, v13, v156
 v_mul_f32 v157, v13, v157
 v_mul_f32 v158, v13, v158
 v_mul_f32 v159, v13, v159
 v_mul_f32 v160, v12, v160
 v_mul_f32 v161, v12, v161
 v_mul_f32 v162, v12, v162
 v_mul_f32 v163, v12, v163
 v_mul_f32 v164, v13, v164
 v_mul_f32 v165, v13, v165
 v_mul_f32 v166, v13, v166
 v_mul_f32 v167, v13, v167
 v_mul_f32 v168, v12, v168
 v_mul_f32 v169, v12, v169
 v_mul_f32 v170, v12, v170
 v_mul_f32 v171, v12, v171
 v_mul_f32 v172, v13, v172
 v_mul_f32 v173, v13, v173
 v_mul_f32 v174, v13, v174
 v_mul_f32 v175, v13, v175
 v_mul_f32 v176, v12, v176
 v_mul_f32 v177, v12, v177
 v_mul_f32 v178, v12, v178
 v_mul_f32 v179, v12, v179
 v_mul_f32 v180, v13, v180
 v_mul_f32 v181, v13, v181
 v_mul_f32 v182, v13, v182
 v_mul_f32 v183, v13, v183
 v_mul_f32 v184, v12, v184
 v_mul_f32 v185, v12, v185
 v_mul_f32 v186, v12, v186
 v_mul_f32 v187, v12, v187
 v_mul_f32 v188, v13, v188
 v_mul_f32 v189, v13, v189
 v_mul_f32 v190, v13, v190
 v_mul_f32 v191, v13, v191
 v_mul_f32 v192, v12, v192
 v_mul_f32 v193, v12, v193
 v_mul_f32 v194, v12, v194
 v_mul_f32 v195, v12, v195
 v_mul_f32 v196, v13, v196
 v_mul_f32 v197, v13, v197
 v_mul_f32 v198, v13, v198
 v_mul_f32 v199, v13, v199
 v_mul_f32 v200, v12, v200
 v_mul_f32 v201, v12, v201
 v_mul_f32 v202, v12, v202
 v_mul_f32 v203, v12, v203
 v_mul_f32 v204, v13, v204
 v_mul_f32 v205, v13, v205
 v_mul_f32 v206, v13, v206
 v_mul_f32 v207, v13, v207
 v_mul_f32 v208, v12, v208
 v_mul_f32 v209, v12, v209
 v_mul_f32 v210, v12, v210
 v_mul_f32 v211, v12, v211
 v_mul_f32 v212, v13, v212
 v_mul_f32 v213, v13, v213
 v_mul_f32 v214, v13, v214
 v_mul_f32 v215, v13, v215
 v_mul_f32 v216, v12, v216
 v_mul_f32 v217, v12, v217
 v_mul_f32 v218, v12, v218
 v_mul_f32 v219, v12, v219
 v_mul_f32 v220, v13, v220
 v_mul_f32 v221, v13, v221
 v_mul_f32 v222, v13, v222
 v_mul_f32 v223, v13, v223
 v_mul_f32 v224, v12, v224
 v_mul_f32 v225, v12, v225
 v_mul_f32 v226, v12, v226
 v_mul_f32 v227, v12, v227
 v_mul_f32 v228, v13, v228
 v_mul_f32 v229, v13, v229
 v_mul_f32 v230, v13, v230
 v_mul_f32 v231, v13, v231
 v_mul_f32 v232, v12, v232
 v_mul_f32 v233, v12, v233
 v_mul_f32 v234, v12, v234
 v_mul_f32 v235, v12, v235
 v_mul_f32 v236, v13, v236
 v_mul_f32 v237, v13, v237
 v_mul_f32 v238, v13, v238
 v_mul_f32 v239, v13, v239
 v_mul_f32 v240, v12, v240
 v_mul_f32 v241, v12, v241
 v_mul_f32 v242, v12, v242
 v_mul_f32 v243, v12, v243
 v_mul_f32 v244, v13, v244
 v_mul_f32 v245, v13, v245
 v_mul_f32 v246, v13, v246
 v_mul_f32 v247, v13, v247
 v_mul_f32 v248, v12, v248
 v_mul_f32 v249, v12, v249
 v_mul_f32 v250, v12, v250
 v_mul_f32 v251, v12, v251
 v_mul_f32 v252, v13, v252
 v_mul_f32 v253, v13, v253
 v_mul_f32 v254, v13, v254
 v_mul_f32 v255, v13, v255
 v_exp_f32 v18, v96
 v_exp_f32 v19, v97
 v_exp_f32 v20, v98
 v_add_f32 v28, v18, v19
 v_cvt_pk_bf16_f32 v48, v18, v19
 v_exp_f32 v21, v99
 v_exp_f32 v22, v104
 v_add_f32 v28, v20, v28
 v_cvt_pk_bf16_f32 v49, v20, v21
 v_exp_f32 v23, v105
 v_add_f32 v28, v21, v28
 v_exp_f32 v24, v106
 v_add_f32 v28, v22, v28
 v_cvt_pk_bf16_f32 v50, v22, v23
 v_exp_f32 v25, v107
 v_add_f32 v28, v23, v28
 v_exp_f32 v18, v100
 v_add_f32 v28, v24, v28
 v_cvt_pk_bf16_f32 v51, v24, v25
 v_exp_f32 v19, v101
 v_add_f32 v28, v25, v28
 v_exp_f32 v20, v102
 v_add_f32 v29, v18, v19
 v_cvt_pk_bf16_f32 v52, v18, v19
 v_exp_f32 v21, v103
 v_exp_f32 v22, v108
 v_add_f32 v29, v20, v29
 v_cvt_pk_bf16_f32 v53, v20, v21
 v_exp_f32 v23, v109
 v_add_f32 v29, v21, v29
 v_exp_f32 v24, v110
 v_add_f32 v29, v22, v29
 v_cvt_pk_bf16_f32 v54, v22, v23
 v_exp_f32 v25, v111
 v_add_f32 v29, v23, v29
 v_add_f32 v29, v24, v29
 v_cvt_pk_bf16_f32 v55, v24, v25
 v_add_f32 v29, v25, v29
 v_exp_f32 v18, v112
 v_exp_f32 v19, v113
 v_exp_f32 v20, v114
 v_add_f32 v28, v18, v28
 v_cvt_pk_bf16_f32 v56, v18, v19
 v_exp_f32 v21, v115
 v_add_f32 v28, v19, v28
 v_exp_f32 v22, v120
 v_add_f32 v28, v20, v28
 v_cvt_pk_bf16_f32 v57, v20, v21
 v_exp_f32 v23, v121
 v_add_f32 v28, v21, v28
 v_exp_f32 v24, v122
 v_add_f32 v28, v22, v28
 v_cvt_pk_bf16_f32 v58, v22, v23
 v_exp_f32 v25, v123
 v_add_f32 v28, v23, v28
 v_exp_f32 v18, v116
 v_add_f32 v28, v24, v28
 v_cvt_pk_bf16_f32 v59, v24, v25
 v_exp_f32 v19, v117
 v_add_f32 v28, v25, v28
 v_exp_f32 v20, v118
 v_add_f32 v29, v18, v29
 v_cvt_pk_bf16_f32 v60, v18, v19
 v_exp_f32 v21, v119
 v_add_f32 v29, v19, v29
 v_exp_f32 v22, v124
 v_add_f32 v29, v20, v29
 v_cvt_pk_bf16_f32 v61, v20, v21
 v_exp_f32 v23, v125
 v_add_f32 v29, v21, v29
 v_exp_f32 v24, v126
 v_add_f32 v29, v22, v29
 v_cvt_pk_bf16_f32 v62, v22, v23
 v_exp_f32 v25, v127
 v_add_f32 v29, v23, v29
 v_add_f32 v29, v24, v29
 v_cvt_pk_bf16_f32 v63, v24, v25
 v_add_f32 v29, v25, v29
 s_nop 3
 s_setpc_b64 s[36:37]
L_slow0B:
 s_nop 7
 s_nop 3
 v_max3_f32 v10, v64, v65, v66
 v_max3_f32 v10, v67, v72, v10
 v_max3_f32 v10, v73, v74, v10
 v_max3_f32 v10, v75, v80, v10
 v_max3_f32 v10, v81, v82, v10
 v_max3_f32 v10, v83, v88, v10
 v_max3_f32 v10, v89, v90, v10
 v_max_f32 v10, v91, v10
 v_max3_f32 v11, v68, v69, v70
 v_max3_f32 v11, v71, v76, v11
 v_max3_f32 v11, v77, v78, v11
 v_max3_f32 v11, v79, v84, v11
 v_max3_f32 v11, v85, v86, v11
 v_max3_f32 v11, v87, v92, v11
 v_max3_f32 v11, v93, v94, v11
 v_max_f32 v11, v95, v11
 v_mov_b32 v12, v10
 v_mov_b32 v13, v11
 s_nop 0
 v_permlane16_swap_b32 v12, v10
 v_permlane16_swap_b32 v13, v11
 v_max_f32 v10, v12, v10
 v_max_f32 v11, v13, v11
 v_mov_b32 v12, v10
 v_mov_b32 v13, v11
 s_nop 0
 v_permlane32_swap_b32 v12, v10
 v_permlane32_swap_b32 v13, v11
 v_max_f32 v10, v12, v10
 v_max_f32 v11, v13, v11
 v_ceil_f32 v10, v10
 v_ceil_f32 v11, v11
 v_max_f32 v10, 0, v10
 v_max_f32 v11, 0, v11
 v_sub_f32 v64, v64, v10
 v_sub_f32 v65, v65, v10
 v_sub_f32 v66, v66, v10
 v_sub_f32 v67, v67, v10
 v_sub_f32 v68, v68, v11
 v_sub_f32 v69, v69, v11
 v_sub_f32 v70, v70, v11
 v_sub_f32 v71, v71, v11
 v_sub_f32 v72, v72, v10
 v_sub_f32 v73, v73, v10
 v_sub_f32 v74, v74, v10
 v_sub_f32 v75, v75, v10
 v_sub_f32 v76, v76, v11
 v_sub_f32 v77, v77, v11
 v_sub_f32 v78, v78, v11
 v_sub_f32 v79, v79, v11
 v_sub_f32 v80, v80, v10
 v_sub_f32 v81, v81, v10
 v_sub_f32 v82, v82, v10
 v_sub_f32 v83, v83, v10
 v_sub_f32 v84, v84, v11
 v_sub_f32 v85, v85, v11
 v_sub_f32 v86, v86, v11
 v_sub_f32 v87, v87, v11
 v_sub_f32 v88, v88, v10
 v_sub_f32 v89, v89, v10
 v_sub_f32 v90, v90, v10
 v_sub_f32 v91, v91, v10
 v_sub_f32 v92, v92, v11
 v_sub_f32 v93, v93, v11
 v_sub_f32 v94, v94, v11
 v_sub_f32 v95, v95, v11
 v_sub_f32 v100, v100, v11
 v_sub_f32 v101, v101, v11
 v_sub_f32 v102, v102, v11
 v_sub_f32 v103, v103, v11
 v_sub_f32 v108, v108, v11
 v_sub_f32 v109, v109, v11
 v_sub_f32 v110, v110, v11
 v_sub_f32 v111, v111, v11
 v_sub_f32 v116, v116, v11
 v_sub_f32 v117, v117, v11
 v_sub_f32 v118, v118, v11
 v_sub_f32 v119, v119, v11
 v_sub_f32 v124, v124, v11
 v_sub_f32 v125, v125, v11
 v_sub_f32 v126, v126, v11
 v_sub_f32 v127, v127, v11
 v_sub_f32 v32, v32, v10
 v_sub_f32 v33, v33, v10
 v_sub_f32 v34, v34, v10
 v_sub_f32 v35, v35, v10
 v_sub_f32 v36, v36, v11
 v_sub_f32 v37, v37, v11
 v_sub_f32 v38, v38, v11
 v_sub_f32 v39, v39, v11
 v_exp_f32 v12, -v10
 v_exp_f32 v13, -v11
 v_mul_f32 v30, v12, v30
 v_mul_f32 v31, v13, v31
 v_mul_f32 v128, v12, v128
 v_mul_f32 v129, v12, v129
 v_mul_f32 v130, v12, v130
 v_mul_f32 v131, v12, v131
 v_mul_f32 v132, v13, v132
 v_mul_f32 v133, v13, v133
 v_mul_f32 v134, v13, v134
 v_mul_f32 v135, v13, v135
 v_mul_f32 v136, v12, v136
 v_mul_f32 v137, v12, v137
 v_mul_f32 v138, v12, v138
 v_mul_f32 v139, v12, v139
 v_mul_f32 v140, v13, v140
 v_mul_f32 v141, v13, v141
 v_mul_f32 v142, v13, v142
 v_mul_f32 v143, v13, v143
 v_mul_f32 v144, v12, v144
 v_mul_f32 v145, v12, v145
 v_mul_f32 v146, v12, v146
 v_mul_f32 v147, v12, v147
 v_mul_f32 v148, v13, v148
 v_mul_f32 v149, v13, v149
 v_mul_f32 v150, v13, v150
 v_mul_f32 v151, v13, v151
 v_mul_f32 v152, v12, v152
 v_mul_f32 v153, v12, v153
 v_mul_f32 v154, v12, v154
 v_mul_f32 v155, v12, v155
 v_mul_f32 v156, v13, v156
 v_mul_f32 v157, v13, v157
 v_mul_f32 v158, v13, v158
 v_mul_f32 v159, v13, v159
 v_mul_f32 v160, v12, v160
 v_mul_f32 v161, v12, v161
 v_mul_f32 v162, v12, v162
 v_mul_f32 v163, v12, v163
 v_mul_f32 v164, v13, v164
 v_mul_f32 v165, v13, v165
 v_mul_f32 v166, v13, v166
 v_mul_f32 v167, v13, v167
 v_mul_f32 v168, v12, v168
 v_mul_f32 v169, v12, v169
 v_mul_f32 v170, v12, v170
 v_mul_f32 v171, v12, v171
 v_mul_f32 v172, v13, v172
 v_mul_f32 v173, v13, v173
 v_mul_f32 v174, v13, v174
 v_mul_f32 v175, v13, v175
 v_mul_f32 v176, v12, v176
 v_mul_f32 v177, v12, v177
 v_mul_f32 v178, v12, v178
 v_mul_f32 v179, v12, v179
 v_mul_f32 v180, v13, v180
 v_mul_f32 v181, v13, v181
 v_mul_f32 v182, v13, v182
 v_mul_f32 v183, v13, v183
 v_mul_f32 v184, v12, v184
 v_mul_f32 v185, v12, v185
 v_mul_f32 v186, v12, v186
 v_mul_f32 v187, v12, v187
 v_mul_f32 v188, v13, v188
 v_mul_f32 v189, v13, v189
 v_mul_f32 v190, v13, v190
 v_mul_f32 v191, v13, v191
 v_mul_f32 v192, v12, v192
 v_mul_f32 v193, v12, v193
 v_mul_f32 v194, v12, v194
 v_mul_f32 v195, v12, v195
 v_mul_f32 v196, v13, v196
 v_mul_f32 v197, v13, v197
 v_mul_f32 v198, v13, v198
 v_mul_f32 v199, v13, v199
 v_mul_f32 v200, v12, v200
 v_mul_f32 v201, v12, v201
 v_mul_f32 v202, v12, v202
 v_mul_f32 v203, v12, v203
 v_mul_f32 v204, v13, v204
 v_mul_f32 v205, v13, v205
 v_mul_f32 v206, v13, v206
 v_mul_f32 v207, v13, v207
 v_mul_f32 v208, v12, v208
 v_mul_f32 v209, v12, v209
 v_mul_f32 v210, v12, v210
 v_mul_f32 v211, v12, v211
 v_mul_f32 v212, v13, v212
 v_mul_f32 v213, v13, v213
 v_mul_f32 v214, v13, v214
 v_mul_f32 v215, v13, v215
 v_mul_f32 v216, v12, v216
 v_mul_f32 v217, v12, v217
 v_mul_f32 v218, v12, v218
 v_mul_f32 v219, v12, v219
 v_mul_f32 v220, v13, v220
 v_mul_f32 v221, v13, v221
 v_mul_f32 v222, v13, v222
 v_mul_f32 v223, v13, v223
 v_mul_f32 v224, v12, v224
 v_mul_f32 v225, v12, v225
 v_mul_f32 v226, v12, v226
 v_mul_f32 v227, v12, v227
 v_mul_f32 v228, v13, v228
 v_mul_f32 v229, v13, v229
 v_mul_f32 v230, v13, v230
 v_mul_f32 v231, v13, v231
 v_mul_f32 v232, v12, v232
 v_mul_f32 v233, v12, v233
 v_mul_f32 v234, v12, v234
 v_mul_f32 v235, v12, v235
 v_mul_f32 v236, v13, v236
 v_mul_f32 v237, v13, v237
 v_mul_f32 v238, v13, v238
 v_mul_f32 v239, v13, v239
 v_mul_f32 v240, v12, v240
 v_mul_f32 v241, v12, v241
 v_mul_f32 v242, v12, v242
 v_mul_f32 v243, v12, v243
 v_mul_f32 v244, v13, v244
 v_mul_f32 v245, v13, v245
 v_mul_f32 v246, v13, v246
 v_mul_f32 v247, v13, v247
 v_mul_f32 v248, v12, v248
 v_mul_f32 v249, v12, v249
 v_mul_f32 v250, v12, v250
 v_mul_f32 v251, v12, v251
 v_mul_f32 v252, v13, v252
 v_mul_f32 v253, v13, v253
 v_mul_f32 v254, v13, v254
 v_mul_f32 v255, v13, v255
 v_exp_f32 v18, v64
 v_exp_f32 v19, v65
 v_exp_f32 v20, v66
 v_add_f32 v26, v18, v19
 v_cvt_pk_bf16_f32 v40, v18, v19
 v_exp_f32 v21, v67
 v_exp_f32 v22, v72
 v_add_f32 v26, v20, v26
 v_cvt_pk_bf16_f32 v41, v20, v21
 v_exp_f32 v23, v73
 v_add_f32 v26, v21, v26
 v_exp_f32 v24, v74
 v_add_f32 v26, v22, v26
 v_cvt_pk_bf16_f32 v42, v22, v23
 v_exp_f32 v25, v75
 v_add_f32 v26, v23, v26
 v_exp_f32 v18, v68
 v_add_f32 v26, v24, v26
 v_cvt_pk_bf16_f32 v43, v24, v25
 v_exp_f32 v19, v69
 v_add_f32 v26, v25, v26
 v_exp_f32 v20, v70
 v_add_f32 v27, v18, v19
 v_cvt_pk_bf16_f32 v44, v18, v19
 v_exp_f32 v21, v71
 v_exp_f32 v22, v76
 v_add_f32 v27, v20, v27
 v_cvt_pk_bf16_f32 v45, v20, v21
 v_exp_f32 v23, v77
 v_add_f32 v27, v21, v27
 v_exp_f32 v24, v78
 v_add_f32 v27, v22, v27
 v_cvt_pk_bf16_f32 v46, v22, v23
 v_exp_f32 v25, v79
 v_add_f32 v27, v23, v27
 v_add_f32 v27, v24, v27
 v_cvt_pk_bf16_f32 v47, v24, v25
 v_add_f32 v27, v25, v27
 v_exp_f32 v18, v80
 v_exp_f32 v19, v81
 v_exp_f32 v20, v82
 v_add_f32 v26, v18, v26
 v_cvt_pk_bf16_f32 v56, v18, v19
 v_exp_f32 v21, v83
 v_add_f32 v26, v19, v26
 v_exp_f32 v22, v88
 v_add_f32 v26, v20, v26
 v_cvt_pk_bf16_f32 v57, v20, v21
 v_exp_f32 v23, v89
 v_add_f32 v26, v21, v26
 v_exp_f32 v24, v90
 v_add_f32 v26, v22, v26
 v_cvt_pk_bf16_f32 v58, v22, v23
 v_exp_f32 v25, v91
 v_add_f32 v26, v23, v26
 v_exp_f32 v18, v84
 v_add_f32 v26, v24, v26
 v_cvt_pk_bf16_f32 v59, v24, v25
 v_exp_f32 v19, v85
 v_add_f32 v26, v25, v26
 v_exp_f32 v20, v86
 v_add_f32 v27, v18, v27
 v_cvt_pk_bf16_f32 v60, v18, v19
 v_exp_f32 v21, v87
 v_add_f32 v27, v19, v27
 v_exp_f32 v22, v92
 v_add_f32 v27, v20, v27
 v_cvt_pk_bf16_f32 v61, v20, v21
 v_exp_f32 v23, v93
 v_add_f32 v27, v21, v27
 v_exp_f32 v24, v94
 v_add_f32 v27, v22, v27
 v_cvt_pk_bf16_f32 v62, v22, v23
 v_exp_f32 v25, v95
 v_add_f32 v27, v23, v27
 v_add_f32 v27, v24, v27
 v_cvt_pk_bf16_f32 v63, v24, v25
 v_add_f32 v27, v25, v27
 s_nop 3
 s_setpc_b64 s[36:37]
L_slowB:
 s_nop 7
 s_nop 3
 v_max3_f32 v11, v100, v101, v102
 v_max3_f32 v11, v103, v108, v11
 v_max3_f32 v11, v109, v110, v11
 v_max3_f32 v11, v111, v116, v11
 v_max3_f32 v11, v117, v118, v11
 v_max3_f32 v11, v119, v124, v11
 v_max3_f32 v11, v125, v126, v11
 v_max_f32 v11, v127, v11
 v_mov_b32 v13, v11
 s_nop 1
 v_permlane16_swap_b32 v13, v11
 v_max_f32 v11, v13, v11
 v_mov_b32 v13, v11
 s_nop 1
 v_permlane32_swap_b32 v13, v11
 v_max_f32 v11, v13, v11
 v_ceil_f32 v11, v11
 v_max_f32 v11, 0, v11
 v_sub_f32 v100, v100, v11
 v_sub_f32 v101, v101, v11
 v_sub_f32 v102, v102, v11
 v_sub_f32 v103, v103, v11
 v_sub_f32 v108, v108, v11
 v_sub_f32 v109, v109, v11
 v_sub_f32 v110, v110, v11
 v_sub_f32 v111, v111, v11
 v_sub_f32 v116, v116, v11
 v_sub_f32 v117, v117, v11
 v_sub_f32 v118, v118, v11
 v_sub_f32 v119, v119, v11
 v_sub_f32 v124, v124, v11
 v_sub_f32 v125, v125, v11
 v_sub_f32 v126, v126, v11
 v_sub_f32 v127, v127, v11
 v_sub_f32 v36, v36, v11
 v_sub_f32 v37, v37, v11
 v_sub_f32 v38, v38, v11
 v_sub_f32 v39, v39, v11
 v_exp_f32 v13, -v11
 s_nop 0
 v_mul_f32 v31, v13, v31
 v_mul_f32 v132, v13, v132
 v_mul_f32 v133, v13, v133
 v_mul_f32 v134, v13, v134
 v_mul_f32 v135, v13, v135
 v_mul_f32 v140, v13, v140
 v_mul_f32 v141, v13, v141
 v_mul_f32 v142, v13, v142
 v_mul_f32 v143, v13, v143
 v_mul_f32 v148, v13, v148
 v_mul_f32 v149, v13, v149
 v_mul_f32 v150, v13, v150
 v_mul_f32 v151, v13, v151
 v_mul_f32 v156, v13, v156
 v_mul_f32 v157, v13, v157
 v_mul_f32 v158, v13, v158
 v_mul_f32 v159, v13, v159
 v_mul_f32 v164, v13, v164
 v_mul_f32 v165, v13, v165
 v_mul_f32 v166, v13, v166
 v_mul_f32 v167, v13, v167
 v_mul_f32 v172, v13, v172
 v_mul_f32 v173, v13, v173
 v_mul_f32 v174, v13, v174
 v_mul_f32 v175, v13, v175
 v_mul_f32 v180, v13, v180
 v_mul_f32 v181, v13, v181
 v_mul_f32 v182, v13, v182
 v_mul_f32 v183, v13, v183
 v_mul_f32 v188, v13, v188
 v_mul_f32 v189, v13, v189
 v_mul_f32 v190, v13, v190
 v_mul_f32 v191, v13, v191
 v_mul_f32 v196, v13, v196
 v_mul_f32 v197, v13, v197
 v_mul_f32 v198, v13, v198
 v_mul_f32 v199, v13, v199
 v_mul_f32 v204, v13, v204
 v_mul_f32 v205, v13, v205
 v_mul_f32 v206, v13, v206
 v_mul_f32 v207, v13, v207
 v_mul_f32 v212, v13, v212
 v_mul_f32 v213, v13, v213
 v_mul_f32 v214, v13, v214
 v_mul_f32 v215, v13, v215
 v_mul_f32 v220, v13, v220
 v_mul_f32 v221, v13, v221
 v_mul_f32 v222, v13, v222
 v_mul_f32 v223, v13, v223
 v_mul_f32 v228, v13, v228
 v_mul_f32 v229, v13, v229
 v_mul_f32 v230, v13, v230
 v_mul_f32 v231, v13, v231
 v_mul_f32 v236, v13, v236
 v_mul_f32 v237, v13, v237
 v_mul_f32 v238, v13, v238
 v_mul_f32 v239, v13, v239
 v_mul_f32 v244, v13, v244
 v_mul_f32 v245, v13, v245
 v_mul_f32 v246, v13, v246
 v_mul_f32 v247, v13, v247
 v_mul_f32 v252, v13, v252
 v_mul_f32 v253, v13, v253
 v_mul_f32 v254, v13, v254
 v_mul_f32 v255, v13, v255
 v_exp_f32 v18, v100
 v_exp_f32 v19, v101
 v_exp_f32 v20, v102
 v_add_f32 v29, v18, v19
 v_cvt_pk_bf16_f32 v52, v18, v19
 v_exp_f32 v21, v103
 v_exp_f32 v22, v108
 v_add_f32 v29, v20, v29
 v_cvt_pk_bf16_f32 v53, v20, v21
 v_exp_f32 v23, v109
 v_add_f32 v29, v21, v29
 v_exp_f32 v24, v110
 v_add_f32 v29, v22, v29
 v_cvt_pk_bf16_f32 v54, v22, v23
 v_exp_f32 v25, v111
 v_add_f32 v29, v23, v29
 v_exp_f32 v18, v116
 v_add_f32 v29, v24, v29
 v_cvt_pk_bf16_f32 v55, v24, v25
 v_exp_f32 v19, v117
 v_add_f32 v29, v25, v29
 v_exp_f32 v20, v118
 v_add_f32 v29, v18, v29
 v_cvt_pk_bf16_f32 v48, v18, v19
 v_exp_f32 v21, v119
 v_add_f32 v29, v19, v29
 v_exp_f32 v22, v124
 v_add_f32 v29, v20, v29
 v_cvt_pk_bf16_f32 v49, v20, v21
 v_exp_f32 v23, v125
 v_add_f32 v29, v21, v29
 v_exp_f32 v24, v126
 v_add_f32 v29, v22, v29
 v_cvt_pk_bf16_f32 v50, v22, v23
 v_exp_f32 v25, v127
 v_add_f32 v29, v23, v29
 v_add_f32 v29, v24, v29
 v_cvt_pk_bf16_f32 v51, v24, v25
 v_add_f32 v29, v25, v29
 s_nop 3
 s_setpc_b64 s[36:37]
L_slowf:
 s_nop 7
 s_nop 3
 v_max3_f32 v10, v64, v65, v66
 v_max3_f32 v10, v67, v72, v10
 v_max3_f32 v10, v73, v74, v10
 v_max3_f32 v10, v75, v80, v10
 v_max3_f32 v10, v81, v82, v10
 v_max3_f32 v10, v83, v88, v10
 v_max3_f32 v10, v89, v90, v10
 v_max_f32 v10, v91, v10
 v_max3_f32 v11, v68, v69, v70
 v_max3_f32 v11, v71, v76, v11
 v_max3_f32 v11, v77, v78, v11
 v_max3_f32 v11, v79, v84, v11
 v_max3_f32 v11, v85, v86, v11
 v_max3_f32 v11, v87, v92, v11
 v_max3_f32 v11, v93, v94, v11
 v_max_f32 v11, v95, v11
 v_mov_b32 v12, v10
 v_mov_b32 v13, v11
 s_nop 0
 v_permlane16_swap_b32 v12, v10
 v_permlane16_swap_b32 v13, v11
 v_max_f32 v10, v12, v10
 v_max_f32 v11, v13, v11
 v_mov_b32 v12, v10
 v_mov_b32 v13, v11
 s_nop 0
 v_permlane32_swap_b32 v12, v10
 v_permlane32_swap_b32 v13, v11
 v_max_f32 v10, v12, v10
 v_max_f32 v11, v13, v11
 v_ceil_f32 v10, v10
 v_ceil_f32 v11, v11
 v_sub_f32 v64, v64, v10
 v_sub_f32 v65, v65, v10
 v_sub_f32 v66, v66, v10
 v_sub_f32 v67, v67, v10
 v_sub_f32 v68, v68, v11
 v_sub_f32 v69, v69, v11
 v_sub_f32 v70, v70, v11
 v_sub_f32 v71, v71, v11
 v_sub_f32 v72, v72, v10
 v_sub_f32 v73, v73, v10
 v_sub_f32 v74, v74, v10
 v_sub_f32 v75, v75, v10
 v_sub_f32 v76, v76, v11
 v_sub_f32 v77, v77, v11
 v_sub_f32 v78, v78, v11
 v_sub_f32 v79, v79, v11
 v_sub_f32 v80, v80, v10
 v_sub_f32 v81, v81, v10
 v_sub_f32 v82, v82, v10
 v_sub_f32 v83, v83, v10
 v_sub_f32 v84, v84, v11
 v_sub_f32 v85, v85, v11
 v_sub_f32 v86, v86, v11
 v_sub_f32 v87, v87, v11
 v_sub_f32 v88, v88, v10
 v_sub_f32 v89, v89, v10
 v_sub_f32 v90, v90, v10
 v_sub_f32 v91, v91, v10
 v_sub_f32 v92, v92, v11
 v_sub_f32 v93, v93, v11
 v_sub_f32 v94, v94, v11
 v_sub_f32 v95, v95, v11
 v_sub_f32 v96, v96, v10
 v_sub_f32 v97, v97, v10
 v_sub_f32 v98, v98, v10
 v_sub_f32 v99, v99, v10
 v_sub_f32 v100, v100, v11
 v_sub_f32 v101, v101, v11
 v_sub_f32 v102, v102, v11
 v_sub_f32 v103, v103, v11
 v_sub_f32 v104, v104, v10
 v_sub_f32 v105, v105, v10
 v_sub_f32 v106, v106, v10
 v_sub_f32 v107, v107, v10
 v_sub_f32 v108, v108, v11
 v_sub_f32 v109, v109, v11
 v_sub_f32 v110, v110, v11
 v_sub_f32 v111, v111, v11
 v_sub_f32 v112, v112, v10
 v_sub_f32 v113, v113, v10
 v_sub_f32 v114, v114, v10
 v_sub_f32 v115, v115, v10
 v_sub_f32 v116, v116, v11
 v_sub_f32 v117, v117, v11
 v_sub_f32 v118, v118, v11
 v_sub_f32 v119, v119, v11
 v_sub_f32 v120, v120, v10
 v_sub_f32 v121, v121, v10
 v_sub_f32 v122, v122, v10
 v_sub_f32 v123, v123, v10
 v_sub_f32 v124, v124, v11
 v_sub_f32 v125, v125, v11
 v_sub_f32 v126, v126, v11
 v_sub_f32 v127, v127, v11
 v_sub_f32 v32, v32, v10
 v_sub_f32 v33, v33, v10
 v_sub_f32 v34, v34, v10
 v_sub_f32 v35, v35, v10
 v_sub_f32 v36, v36, v11
 v_sub_f32 v37, v37, v11
 v_sub_f32 v38, v38, v11
 v_sub_f32 v39, v39, v11
 v_exp_f32 v18, v64
 v_exp_f32 v19, v65
 v_exp_f32 v20, v66
 v_add_f32 v26, v18, v19
 v_cvt_pk_bf16_f32 v40, v18, v19
 v_exp_f32 v21, v67
 v_exp_f32 v22, v72
 v_add_f32 v26, v20, v26
 v_cvt_pk_bf16_f32 v41, v20, v21
 v_exp_f32 v23, v73
 v_add_f32 v26, v21, v26
 v_exp_f32 v24, v74
 v_add_f32 v26, v22, v26
 v_cvt_pk_bf16_f32 v42, v22, v23
 v_exp_f32 v25, v75
 v_add_f32 v26, v23, v26
 v_exp_f32 v18, v68
 v_add_f32 v26, v24, v26
 v_cvt_pk_bf16_f32 v43, v24, v25
 v_exp_f32 v19, v69
 v_add_f32 v26, v25, v26
 v_exp_f32 v20, v70
 v_add_f32 v27, v18, v19
 v_cvt_pk_bf16_f32 v44, v18, v19
 v_exp_f32 v21, v71
 v_exp_f32 v22, v76
 v_add_f32 v27, v20, v27
 v_cvt_pk_bf16_f32 v45, v20, v21
 v_exp_f32 v23, v77
 v_add_f32 v27, v21, v27
 v_exp_f32 v24, v78
 v_add_f32 v27, v22, v27
 v_cvt_pk_bf16_f32 v46, v22, v23
 v_exp_f32 v25, v79
 v_add_f32 v27, v23, v27
 v_add_f32 v27, v24, v27
 v_cvt_pk_bf16_f32 v47, v24, v25
 v_add_f32 v27, v25, v27
 v_exp_f32 v18, v80
 v_exp_f32 v19, v81
 v_exp_f32 v20, v82
 v_add_f32 v26, v18, v26
 v_cvt_pk_bf16_f32 v56, v18, v19
 v_exp_f32 v21, v83
 v_add_f32 v26, v19, v26
 v_exp_f32 v22, v88
 v_add_f32 v26, v20, v26
 v_cvt_pk_bf16_f32 v57, v20, v21
 v_exp_f32 v23, v89
 v_add_f32 v26, v21, v26
 v_exp_f32 v24, v90
 v_add_f32 v26, v22, v26
 v_cvt_pk_bf16_f32 v58, v22, v23
 v_exp_f32 v25, v91
 v_add_f32 v26, v23, v26
 v_exp_f32 v18, v84
 v_add_f32 v26, v24, v26
 v_cvt_pk_bf16_f32 v59, v24, v25
 v_exp_f32 v19, v85
 v_add_f32 v26, v25, v26
 v_exp_f32 v20, v86
 v_add_f32 v27, v18, v27
 v_cvt_pk_bf16_f32 v60, v18, v19
 v_exp_f32 v21, v87
 v_add_f32 v27, v19, v27
 v_exp_f32 v22, v92
 v_add_f32 v27, v20, v27
 v_cvt_pk_bf16_f32 v61, v20, v21
 v_exp_f32 v23, v93
 v_add_f32 v27, v21, v27
 v_exp_f32 v24, v94
 v_add_f32 v27, v22, v27
 v_cvt_pk_bf16_f32 v62, v22, v23
 v_exp_f32 v25, v95
 v_add_f32 v27, v23, v27
 v_add_f32 v27, v24, v27
 v_cvt_pk_bf16_f32 v63, v24, v25
 v_add_f32 v27, v25, v27
 s_nop 3
 s_setpc_b64 s[36:37]
L_moe0:
 s_lshl_b32 s88, s75, 1
 s_call_b64 s[36:37], L_moe
 v_add_f32 v32, v108, v32
 v_add_f32 v33, v109, v33
 v_add_f32 v34, v110, v34
 v_add_f32 v35, v111, v35
 v_add_f32 v36, v112, v36
 v_add_f32 v37, v113, v37
 v_add_f32 v38, v114, v38
 v_add_f32 v39, v115, v39
 v_add_f32 v40, v116, v40
 v_add_f32 v41, v117, v41
 v_add_f32 v42, v118, v42
 v_add_f32 v43, v119, v43
 v_add_f32 v44, v120, v44
 v_add_f32 v45, v121, v45
 v_add_f32 v46, v122, v46
 v_add_f32 v47, v123, v47
 s_mov_b64 exec, -1
 s_branch L_moe_ret0
L_moe1:
 s_lshl_b32 s88, s86, 1
 s_call_b64 s[36:37], L_moe
 v_add_f32 v80, v108, v80
 v_add_f32 v81, v109, v81
 v_add_f32 v82, v110, v82
 v_add_f32 v83, v111, v83
 v_add_f32 v84, v112, v84
 v_add_f32 v85, v113, v85
 v_add_f32 v86, v114, v86
 v_add_f32 v87, v115, v87
 s_mov_b64 exec, -1
 s_branch L_moe_ret1
L_moe2:
 s_lshl_b32 s88, s86, 1
 s_call_b64 s[36:37], L_moe
 v_add_f32 v32, v108, v32
 v_add_f32 v33, v109, v33
 v_add_f32 v34, v110, v34
 v_add_f32 v35, v111, v35
 v_add_f32 v36, v112, v36
 v_add_f32 v37, v113, v37
 v_add_f32 v38, v114, v38
 v_add_f32 v39, v115, v39
 s_mov_b64 exec, -1
 s_branch L_moe_ret2
L_moe:
 v_min_u32 v104, 27, v0
 v_lshlrev_b32 v104, 2, v104
 s_mov_b32 s64, 105062912
 s_mov_b32 s65, 65536
 s_mov_b32 exec_lo, 0xffffffff
 s_mov_b32 exec_hi, 0xffffffff
L_pfy:
 buffer_load_dword v105, v104, s[8:11], s64 offen sc1
 s_sub_u32 s65, s65, 1
 s_cbranch_scc1 L_pfy_x
 s_waitcnt vmcnt(0)
 v_cmp_ne_u32 vcc, 1, v105
 s_nop 0
 s_cbranch_vccz L_pfy_x
 s_sleep 2
 s_branch L_pfy
L_pfy_x:
 s_waitcnt vmcnt(0)
 s_mov_b64 exec, -1
 s_or_b64 exec, s[80:81], s[82:83]
 v_mov_b32 v104, 1792
 v_cndmask_b32 v104, v104, 0, s[80:81]
 v_lshl_add_u32 v104, v11, 5, v104
 s_add_u32 s88, s88, 104898560
 buffer_load_dwordx4 v[108:111], v104, s[8:11], s88 offen sc1
 buffer_load_dwordx4 v[112:115], v104, s[8:11], s88 offen offset:16 sc1
 buffer_load_dwordx4 v[116:119], v104, s[8:11], s88 offen offset:512 sc1
 buffer_load_dwordx4 v[120:123], v104, s[8:11], s88 offen offset:528 sc1
 s_waitcnt vmcnt(0)
 s_setpc_b64 s[36:37]
L_y1:
 s_lshl_b32 s89, s41, 1
 s_add_u32 s89, s89, s20
 s_cmp_ge_u32 s20, 2
 s_cselect_b32 s89, 28, s89
 s_cmp_ge_u32 s89, 28
 s_cbranch_scc1 L_y1r
 v_lshrrev_b32 v50, 4, v7
 v_lshrrev_b32 v51, 3, v50
 v_mul_u32_u24 v51, 4352, v51
 v_and_b32 v52, 7, v50
 v_lshl_add_u32 v51, v52, 7, v51
 s_mov_b32 s90, 104923136
 s_mov_b32 s88, 104957952
 s_mov_b32 s91, 65536
L_yp:
 buffer_load_dword v52, v51, s[8:11], s90 offen sc1
 buffer_load_dword v53, v51, s[8:11], s88 offen sc1
 s_waitcnt vmcnt(0)
 v_min_u32 v52, v52, v53
 v_cmp_gt_u32 vcc, 4, v52
 s_sub_u32 s91, s91, 1
 s_cbranch_scc1 L_ypx
 s_cbranch_vccnz L_yp
L_ypx:
 s_cmp_lt_u32 s89, 14
 s_cselect_b32 s90, 8, 12
 s_add_u32 s90, s90, 104890368
 buffer_load_dword v53, off, s[8:11], s90 sc1
 v_lshrrev_b32 v51, 3, v50
 v_mul_u32_u24 v51, 3584, v51
 v_and_b32 v52, 7, v50
 v_lshl_add_u32 v51, v52, 4, v51
 s_lshl_b32 s88, s89, 7
 s_add_u32 s90, s88, 104898560
 s_add_u32 s88, s88, 105906176
 buffer_load_dwordx4 v[136:139], v51, s[8:11], s88 offen sc1
 s_add_u32 s88, s88, 28672
 buffer_load_dwordx4 v[140:143], v51, s[8:11], s88 offen sc1
 s_add_u32 s88, s88, 28672
 buffer_load_dwordx4 v[152:155], v51, s[8:11], s88 offen sc1
 s_add_u32 s88, s88, 28672
 buffer_load_dwordx4 v[156:159], v51, s[8:11], s88 offen sc1
 s_add_u32 s88, s88, 28672
 buffer_load_dwordx4 v[168:171], v51, s[8:11], s88 offen sc1
 s_add_u32 s88, s88, 28672
 buffer_load_dwordx4 v[172:175], v51, s[8:11], s88 offen sc1
 s_add_u32 s88, s88, 28672
 buffer_load_dwordx4 v[184:187], v51, s[8:11], s88 offen sc1
 s_add_u32 s88, s88, 28672
 buffer_load_dwordx4 v[188:191], v51, s[8:11], s88 offen sc1
 s_add_u32 s88, s88, 28672
 buffer_load_dwordx4 v[200:203], v51, s[8:11], s88 offen sc1
 s_add_u32 s88, s88, 28672
 buffer_load_dwordx4 v[204:207], v51, s[8:11], s88 offen sc1
 s_add_u32 s88, s88, 28672
 buffer_load_dwordx4 v[216:219], v51, s[8:11], s88 offen sc1
 s_add_u32 s88, s88, 28672
 buffer_load_dwordx4 v[220:223], v51, s[8:11], s88 offen sc1
 s_add_u32 s88, s88, 28672
 buffer_load_dwordx4 v[232:235], v51, s[8:11], s88 offen sc1
 s_add_u32 s88, s88, 28672
 buffer_load_dwordx4 v[236:239], v51, s[8:11], s88 offen sc1
 s_add_u32 s88, s88, 28672
 s_branch L_y1r
L_y2:
 s_cmp_ge_u32 s89, 28
 s_cbranch_scc1 L_y2r
 s_waitcnt vmcnt(24)
 s_waitcnt vmcnt(12)
 v_add_f32 v136, v140, v136
 v_add_f32 v137, v141, v137
 v_add_f32 v138, v142, v138
 v_add_f32 v139, v143, v139
 s_waitcnt vmcnt(11)
 v_add_f32 v136, v152, v136
 v_add_f32 v137, v153, v137
 v_add_f32 v138, v154, v138
 v_add_f32 v139, v155, v139
 s_waitcnt vmcnt(10)
 v_add_f32 v136, v156, v136
 v_add_f32 v137, v157, v137
 v_add_f32 v138, v158, v138
 v_add_f32 v139, v159, v139
 s_waitcnt vmcnt(9)
 v_add_f32 v136, v168, v136
 v_add_f32 v137, v169, v137
 v_add_f32 v138, v170, v138
 v_add_f32 v139, v171, v139
 s_waitcnt vmcnt(8)
 v_add_f32 v136, v172, v136
 v_add_f32 v137, v173, v137
 v_add_f32 v138, v174, v138
 v_add_f32 v139, v175, v139
 s_waitcnt vmcnt(7)
 v_add_f32 v136, v184, v136
 v_add_f32 v137, v185, v137
 v_add_f32 v138, v186, v138
 v_add_f32 v139, v187, v139
 s_waitcnt vmcnt(6)
 v_add_f32 v136, v188, v136
 v_add_f32 v137, v189, v137
 v_add_f32 v138, v190, v138
 v_add_f32 v139, v191, v139
 s_waitcnt vmcnt(5)
 v_add_f32 v136, v200, v136
 v_add_f32 v137, v201, v137
 v_add_f32 v138, v202, v138
 v_add_f32 v139, v203, v139
 s_waitcnt vmcnt(4)
 v_add_f32 v136, v204, v136
 v_add_f32 v137, v205, v137
 v_add_f32 v138, v206, v138
 v_add_f32 v139, v207, v139
 s_waitcnt vmcnt(3)
 v_add_f32 v136, v216, v136
 v_add_f32 v137, v217, v137
 v_add_f32 v138, v218, v138
 v_add_f32 v139, v219, v139
 s_waitcnt vmcnt(2)
 v_add_f32 v136, v220, v136
 v_add_f32 v137, v221, v137
 v_add_f32 v138, v222, v138
 v_add_f32 v139, v223, v139
 s_waitcnt vmcnt(1)
 v_add_f32 v136, v232, v136
 v_add_f32 v137, v233, v137
 v_add_f32 v138, v234, v138
 v_add_f32 v139, v235, v139
 s_waitcnt vmcnt(0)
 v_add_f32 v136, v236, v136
 v_add_f32 v137, v237, v137
 v_add_f32 v138, v238, v138
 v_add_f32 v139, v239, v139
 v_add_f32 v136, v136, v136 row_ror:8 row_mask:0xf bank_mask:0xf
 v_add_f32 v137, v137, v137 row_ror:8 row_mask:0xf bank_mask:0xf
 v_add_f32 v138, v138, v138 row_ror:8 row_mask:0xf bank_mask:0xf
 v_add_f32 v139, v139, v139 row_ror:8 row_mask:0xf bank_mask:0xf
 v_mov_b32 v140, v136
 v_mov_b32 v141, v137
 v_mov_b32 v142, v138
 v_mov_b32 v143, v139
 v_permlane16_swap_b32 v140, v136
 v_permlane16_swap_b32 v141, v137
 v_permlane16_swap_b32 v142, v138
 v_permlane16_swap_b32 v143, v139
 v_add_f32 v136, v140, v136
 v_add_f32 v137, v141, v137
 v_add_f32 v138, v142, v138
 v_add_f32 v139, v143, v139
 v_mov_b32 v140, v136
 v_mov_b32 v141, v137
 v_mov_b32 v142, v138
 v_mov_b32 v143, v139
 v_permlane32_swap_b32 v140, v136
 v_permlane32_swap_b32 v141, v137
 v_permlane32_swap_b32 v142, v138
 v_permlane32_swap_b32 v143, v139
 v_add_f32 v136, v140, v136
 v_add_f32 v137, v141, v137
 v_add_f32 v138, v142, v138
 v_add_f32 v139, v143, v139
 v_cvt_pk_bf16_f32 v51, v136, v137
 v_lshlrev_b32 v136, 16, v51
 v_and_b32 v137, 0xffff0000, v51
 v_cvt_pk_bf16_f32 v51, v138, v139
 v_lshlrev_b32 v138, 16, v51
 v_and_b32 v139, 0xffff0000, v51
 v_mul_f32 v136, v53, v136
 v_mul_f32 v137, v53, v137
 v_mul_f32 v138, v53, v138
 v_mul_f32 v139, v53, v139
 v_cvt_pk_bf16_f32 v51, v136, v137
 v_lshlrev_b32 v136, 16, v51
 v_and_b32 v137, 0xffff0000, v51
 v_cvt_pk_bf16_f32 v51, v138, v139
 v_lshlrev_b32 v138, 16, v51
 v_and_b32 v139, 0xffff0000, v51
 s_mov_b64 exec, 0xff
 buffer_store_dwordx4 v[136:139], v7, s[8:11], s90 offen sc1
 s_mov_b64 exec, -1
 s_branch L_y2r
L_y3:
 s_cmp_ge_u32 s89, 28
 s_cbranch_scc1 L_y3r
 v_mov_b32 v52, 1
 s_lshl_b32 s89, s89, 2
 s_add_u32 s89, s89, 105062912
 s_mov_b64 exec, 1
 s_waitcnt vmcnt(5)
 buffer_store_dword v52, off, s[8:11], s89 sc1
 s_mov_b64 exec, -1
 s_branch L_y3r
L_fll:
 buffer_load_dword v6, v9, s[8:11], s46 offen sc1
 s_branch L_fllr
L_pub3:
 v_mov_b32 v17, s3
 buffer_store_dword v17, v1, s[8:11], s45 offen sc1
 s_branch L_pub3r
L_fhs0:
 s_mov_b32 s91, 65536
L_fhs0_l:
 s_sleep 2
 buffer_load_dword v24, off, s[8:11], s79 sc1
 s_sub_u32 s91, s91, 1
 s_cbranch_scc1 L_fhs0_x
 s_waitcnt vmcnt(0)
 v_cmp_gt_u32 vcc, 1, v24
 s_nop 0
 s_cbranch_vccnz L_fhs0_l
L_fhs0_x:
 s_waitcnt vmcnt(0)
 s_branch L_fhr0
L_fhs1:
 s_mov_b32 s91, 65536
L_fhs1_l:
 s_sleep 2
 buffer_load_dword v24, off, s[8:11], s79 sc1
 s_sub_u32 s91, s91, 1
 s_cbranch_scc1 L_fhs1_x
 s_waitcnt vmcnt(0)
 v_cmp_gt_u32 vcc, 1, v24
 s_nop 0
 s_cbranch_vccnz L_fhs1_l
L_fhs1_x:
 s_waitcnt vmcnt(0)
 s_branch L_fhr1
L_fps0:
 s_mov_b32 s53, 65536
L_fps0_l:
 s_sleep 2
 buffer_load_dword v5, off, s[8:11], s47 sc1
 s_sub_u32 s53, s53, 1
 s_cbranch_scc1 L_fps0_x
 s_waitcnt vmcnt(0)
 v_cmp_ne_u32 vcc, 1, v5
 s_nop 0
 s_cbranch_vccnz L_fps0_l
L_fps0_x:
 s_waitcnt vmcnt(0)
 s_branch L_fpr0
L_fps1:
 s_mov_b32 s53, 65536
L_fps1_l:
 s_sleep 2
 buffer_load_dword v5, off, s[8:11], s47 sc1
 s_sub_u32 s53, s53, 1
 s_cbranch_scc1 L_fps1_x
 s_waitcnt vmcnt(0)
 v_cmp_ne_u32 vcc, 1, v5
 s_nop 0
 s_cbranch_vccnz L_fps1_l
L_fps1_x:
 s_waitcnt vmcnt(0)
 s_branch L_fpr1
L_f2s:
 s_mov_b32 s53, 65536
L_f2s_l:
 s_sleep 2
 buffer_load_dword v6, v9, s[8:11], s46 offen sc1
 s_sub_u32 s53, s53, 1
 s_cbranch_scc1 L_f2s_x
 s_waitcnt vmcnt(0)
 v_cmp_gt_u32 vcc, 3, v6
 s_nop 0
 s_cbranch_vccnz L_f2s_l
L_f2s_x:
 s_waitcnt vmcnt(0)
 s_branch L_f2r
L_fls0:
 s_mov_b32 s53, 65536
L_fls0_l:
 s_sleep 2
 buffer_load_dword v6, v9, s[8:11], s46 offen sc1
 s_sub_u32 s53, s53, 1
 s_cbranch_scc1 L_fls0_x
 s_waitcnt vmcnt(0)
 v_cmp_gt_u32 vcc, s39, v6
 s_nop 0
 s_cbranch_vccnz L_fls0_l
L_fls0_x:
 s_waitcnt vmcnt(0)
 s_branch L_flr0
L_code_end:
.section .rodata,"a"
.p2align 6
.amdhsa_kernel gated_mix__compressed_kv_cla__moe_arch_mod__prompt_kernel
  .amdhsa_next_free_vgpr 512
  .amdhsa_next_free_sgpr 102
  .amdhsa_accum_offset 256
  .amdhsa_group_segment_fixed_size 0
  .amdhsa_kernarg_size 120
  .amdhsa_user_sgpr_count 2
  .amdhsa_user_sgpr_kernarg_segment_ptr 1
  .amdhsa_system_sgpr_workgroup_id_x 1
  .amdhsa_float_denorm_mode_32 3
.end_amdhsa_kernel
```

```asm
; @launch grid=(256,1,1) block=(256,1,1) lds=163840
.amdgcn_target "amdgcn-amd-amdhsa--gfx950"
.text
.macro M d, a, b, c
v_mfma_f32_16x16x32_bf16 \d, \a, \b, \c
.endm
.globl gated_mix__compressed_kv_cla__moe_arch_mod__prompt_kernel
.p2align 8
.type gated_mix__compressed_kv_cla__moe_arch_mod__prompt_kernel,@function
gated_mix__compressed_kv_cla__moe_arch_mod__prompt_kernel:
 s_cmp_lt_u32 s2, 256
 s_cbranch_scc1 L_go
 s_endpgm
L_go:
 s_load_dwordx8 s[80:87], s[0:1], 0
 s_load_dwordx4 s[88:91], s[0:1], 32
 s_load_dwordx2 s[92:93], s[0:1], 56
 s_load_dwordx2 s[30:31], s[0:1], 88
 s_load_dwordx4 s[4:7], s[0:1], 104
 v_lshrrev_b32 v24, 6, v0
 v_and_b32 v0, 63, v0
 v_readfirstlane_b32 s20, v24
 s_getpc_b64 s[76:77]
L_pc0:
 s_and_b32 s77, s77, 0xffff
 s_mov_b32 s78, L_code_end-L_pc0
 s_mov_b32 s79, 0x20000
 s_lshr_b32 s64, s2, 3
 s_lshl_b32 s64, s64, 2
 s_add_u32 s64, s64, s20
 s_lshl_b32 s95, s64, 11
 v_lshl_add_u32 v29, v0, 7, s95
 v_and_b32 v28, 48, v0
 v_lshl_add_u32 v28, v28, 24, v29
 buffer_load_dword a240, v28, s[76:79], 0 offen offset:0
 s_and_b32 s41, s2, 7
 s_lshr_b32 s42, s2, 3
 s_lshr_b32 s64, s42, 4
 s_lshl_b32 s64, s64, 3
 s_add_u32 s41, s41, s64
 s_and_b32 s42, s42, 15
 s_lshr_b32 s45, s42, 3
 s_xor_b32 s45, s45, 1
 s_mov_b32 s44, 0
 v_accvgpr_write_b32 a250, 0
 v_accvgpr_write_b32 a251, 0
 v_and_b32 v24, 15, v0
 v_lshrrev_b32 v25, 4, v0
 v_lshlrev_b32 v7, 4, v0
 s_and_b32 s65, s20, 1
 s_lshr_b32 s66, s20, 1
 v_or_b32 v28, 0, v25
 v_lshlrev_b32 v28, 1, v28
 v_xor_b32 v28, v28, v24
 v_lshrrev_b32 v29, 3, v28
 v_lshlrev_b32 v29, 8, v29
 v_and_b32 v28, 7, v28
 v_lshl_add_u32 v28, v28, 4, v29
 v_lshl_add_u32 v28, v25, 13, v28
 s_lshl_b32 s64, s20, 17
 s_add_u32 s64, s64, 0
 v_add_u32 v8, s64, v28
 v_add_u32 v9, 31744, v8
 v_or_b32 v28, 4, v25
 v_lshlrev_b32 v28, 1, v28
 v_xor_b32 v28, v28, v24
 v_lshrrev_b32 v29, 3, v28
 v_lshlrev_b32 v29, 8, v29
 v_and_b32 v28, 7, v28
 v_lshl_add_u32 v28, v28, 4, v29
 v_lshl_add_u32 v28, v25, 13, v28
 s_lshl_b32 s64, s20, 17
 s_add_u32 s64, s64, 63488
 v_add_u32 v10, s64, v28
 v_add_u32 v11, 31744, v10
 v_add_u32 v28, 0, v25
 v_and_b32 v29, 7, v0
 v_xor_b32 v28, v28, v29
 v_lshlrev_b32 v28, 4, v28
 v_lshrrev_b32 v29, 3, v0
 v_lshl_add_u32 v30, v29, 11, v28
 s_lshl_b32 s64, s66, 19
 s_lshl_b32 s67, s65, 20
 s_add_u32 s64, s64, s67
 s_add_u32 s64, s64, 0
 v_add_u32 v12, s64, v30
 v_add_u32 v14, 30720, v12
 v_add_u32 v28, 4, v25
 v_and_b32 v29, 7, v0
 v_xor_b32 v28, v28, v29
 v_lshlrev_b32 v28, 4, v28
 v_lshrrev_b32 v29, 3, v0
 v_lshl_add_u32 v30, v29, 11, v28
 s_lshl_b32 s64, s66, 19
 s_lshl_b32 s67, s65, 20
 s_add_u32 s64, s64, s67
 s_add_u32 s64, s64, 15360
 v_add_u32 v13, s64, v30
 v_add_u32 v15, 30720, v13
 s_mov_b32 s21, 0
 s_mov_b32 s22, 0
 s_lshl_b32 s23, s20, 12
 s_add_u32 s24, s23, 65536
 s_lshl_b32 s74, s41, 9
 s_sub_u32 s18, 8388608, s74
 s_mov_b32 s19, 0x20000
 s_and_b32 s75, s42, 7
 s_lshl_b32 s75, s75, 16
 s_sub_u32 s50, 4194304, s75
 s_mov_b32 s51, 0x20000
 s_mov_b32 m0, s23
 s_cmp_eq_u32 s45, 0
 s_waitcnt lgkmcnt(0)
 s_cselect_b64 s[72:73], s[86:87], s[88:89]
 s_add_u32 s16, s72, s74
 s_addc_u32 s17, s73, 0
 s_and_b32 s17, s17, 0xffff
 buffer_load_dwordx4 v8, s[16:19], s21 offen offset:0  nt lds
 buffer_load_dwordx4 v9, s[16:19], s21 offen offset:1024  nt lds
 buffer_load_dwordx4 v10, s[16:19], s21 offen offset:2048  nt lds
 buffer_load_dwordx4 v11, s[16:19], s21 offen offset:3072  nt lds
 s_add_u32 s21, s21, 128
 s_add_u32 s48, s82, s75
 s_addc_u32 s49, s83, 0
 s_and_b32 s49, s49, 0xffff
 s_add_u32 m0, s24, 0
 s_nop 0
 buffer_load_dwordx4 v12, s[48:51], s22 offen offset:0   lds
 buffer_load_dwordx4 v13, s[48:51], s22 offen offset:1024   lds
 buffer_load_dwordx4 v14, s[48:51], s22 offen offset:2048   lds
 buffer_load_dwordx4 v15, s[48:51], s22 offen offset:3072   lds
 s_add_u32 s22, s22, 2097152
 s_add_u32 m0, s23, 16384
 s_nop 0
 buffer_load_dwordx4 v8, s[16:19], s21 offen offset:0  nt lds
 buffer_load_dwordx4 v9, s[16:19], s21 offen offset:1024  nt lds
 buffer_load_dwordx4 v10, s[16:19], s21 offen offset:2048  nt lds
 buffer_load_dwordx4 v11, s[16:19], s21 offen offset:3072  nt lds
 s_add_u32 s21, s21, 524160
 v_lshrrev_b32 v26, 2, v24
 v_and_b32 v28, 1, v25
 v_lshl_or_b32 v28, v28, 2, v26
 v_lshl_add_u32 v29, v25, 3, v26
 v_lshlrev_b32 v29, 8, v29
 v_and_b32 v30, 3, v0
 v_lshl_add_u32 v29, v30, 3, v29
 s_lshl_b32 s64, s65, 2
 s_add_u32 s64, s64, 0
 v_xor_b32 v30, s64, v28
 v_lshl_add_u32 v1, v30, 5, v29
 s_lshl_b32 s64, s65, 2
 s_add_u32 s64, s64, 1
 v_xor_b32 v30, s64, v28
 v_lshl_add_u32 v2, v30, 5, v29
 s_lshl_b32 s64, s65, 2
 s_add_u32 s64, s64, 2
 v_xor_b32 v30, s64, v28
 v_lshl_add_u32 v3, v30, 5, v29
 s_lshl_b32 s64, s65, 2
 s_add_u32 s64, s64, 3
 v_xor_b32 v30, s64, v28
 v_lshl_add_u32 v4, v30, 5, v29
 v_add_u32 v28, 0, v25
 v_lshrrev_b32 v29, 1, v24
 v_xor_b32 v28, v28, v29
 v_lshlrev_b32 v28, 4, v28
 v_lshl_add_u32 v28, v24, 7, v28
 s_lshl_b32 s64, s66, 13
 s_add_u32 s64, s64, 65536
 v_add_u32 v5, s64, v28
 v_add_u32 v28, 4, v25
 v_lshrrev_b32 v29, 1, v24
 v_xor_b32 v28, v28, v29
 v_lshlrev_b32 v28, 4, v28
 v_lshl_add_u32 v28, v24, 7, v28
 s_lshl_b32 s64, s66, 13
 s_add_u32 s64, s64, 65536
 v_add_u32 v6, s64, v28
 s_lshl_b32 s64, s2, 2
 s_add_u32 s64, s64, s20
 s_lshl_b32 s64, s64, 12
 v_lshrrev_b32 v28, 2, v0
 v_and_b32 v29, 3, v0
 v_lshlrev_b32 v29, 7, v29
 v_lshl_add_u32 v28, v28, 11, v29
 v_add_u32 v24, s64, v28
 v_and_b32 v28, 56, v0
 v_lshl_add_u32 v24, v28, 24, v24
 s_mov_b32 s32, s82
 s_and_b32 s33, s83, 0xffff
 s_mov_b32 s34, 4194304
 s_mov_b32 s35, 0x20000
 s_mov_b32 s56, s80
 s_and_b32 s57, s81, 0xffff
 s_mov_b32 s58, 1835008
 s_mov_b32 s59, 0x20000
 s_mov_b32 s60, s92
 s_and_b32 s61, s93, 0xffff
 s_mov_b32 s62, 896
 s_mov_b32 s63, 0x20000
 s_mov_b32 s68, s30
 s_and_b32 s69, s31, 0xffff
 s_mov_b32 s70, 896
 s_mov_b32 s71, 0x20000
 s_mov_b32 s8, s6
 s_and_b32 s9, s7, 0xffff
 s_mov_b32 s10, 268435456
 s_mov_b32 s11, 0x20000
 s_mov_b32 s12, s4
 s_and_b32 s13, s5, 0xffff
 s_mov_b32 s14, 256
 s_mov_b32 s15, 0x20000
 s_add_u32 s72, s84, s74
 s_addc_u32 s73, s85, 0
 s_sub_u32 s75, 3670016, s74
 s_mov_b32 s52, s72
 s_and_b32 s53, s73, 0xffff
 s_mov_b32 s54, s75
 s_mov_b32 s55, 0x20000
 s_mov_b32 s5, 0x3db8aa3b
 s_mov_b32 s28, 0
 s_mul_i32 s29, s42, 114688
 s_lshl_b32 s72, s45, 24
 s_lshl_b32 s73, s41, 20
 s_add_u32 s72, s72, s73
 s_bfe_u32 s64, s42, 0x20001
 s_lshl_b32 s64, s64, 15
 s_add_u32 s72, s72, s64
 s_lshl_b32 s64, s66, 17
 s_add_u32 s72, s72, s64
 s_and_b32 s67, s42, 1
 s_cmp_eq_u32 s45, 0
 s_cselect_b32 s64, 12, 14
 s_cselect_b32 s75, 14, 10
 s_lshl_b32 s67, s67, s75
 s_add_u32 s72, s72, s67
 s_lshl_b32 s64, s65, s64
 s_add_u32 s93, s72, s64
 s_load_dwordx4 s[80:83], s[0:1], 64
 s_load_dwordx2 s[84:85], s[0:1], 80
 s_load_dwordx2 s[96:97], s[0:1], 96
 s_cmp_lt_u32 s42, 8
 s_cbranch_scc0 L_kv1
L_kv0:
 s_lshl_b32 s64, s42, 4
 s_add_u32 s64, s64, s41
 s_lshl_b32 s64, s64, 2
 s_add_u32 s64, s64, s20
 s_cmp_lt_u32 s64, 41
 s_cselect_b32 s39, 0, 536870912
 s_min_u32 s64, s64, 41
 s_lshl_b32 s38, s64, 2
 s_max_u32 s67, s64, 8
 s_sub_u32 s67, s67, 8
 s_mul_i32 s67, s67, 3328
 s_lshl_b32 s64, s64, 10
 s_add_u32 s64, s64, s67
 s_add_u32 s73, s64, 104914944
 v_or_b32 v64, s39, v7
 v_mov_b32 v68, 0
 v_mov_b32 v69, 0
 v_mov_b32 v70, 0
 v_mov_b32 v71, 0
 s_lshl_b32 s30, s41, 3
 s_add_u32 s30, s30, s42
 s_lshl_b32 s64, s30, 2
 s_add_u32 s64, s64, s20
 s_mul_i32 s72, s64, 3584
 v_mov_b32 v32, 536870912
 v_cmp_gt_u32 vcc, 56, v0
 s_lshl_b32 s67, s64, 2
 s_nop 0
 v_cndmask_b32 v32, v32, v7, vcc
 buffer_load_dwordx4 v[40:43], v32, s[56:59], s72 offen offset:0
 buffer_load_dwordx4 v[44:47], v32, s[56:59], s72 offen offset:896
 buffer_load_dwordx4 v[48:51], v32, s[56:59], s72 offen offset:1792
 buffer_load_dwordx4 v[52:55], v32, s[56:59], s72 offen offset:2688
 buffer_load_dwordx4 v[56:59], v32, s[60:63], 0 offen
 buffer_load_dwordx4 v[60:63], v32, s[68:71], 0 offen
 buffer_store_dwordx4 v[68:71], v64, s[8:11], s73 offen offset:0 sc1
 buffer_store_dwordx4 v[68:71], v64, s[8:11], s73 offen offset:1024 sc1
 buffer_store_dwordx4 v[68:71], v64, s[8:11], s73 offen offset:2048 sc1
 s_waitcnt vmcnt(13) lgkmcnt(0)
 s_barrier
 ds_read_b128 a[160:163], v5 offset:0
 ds_read_b128 a[164:167], v6 offset:0
 ds_read_b64_tr_b16 a[32:33], v1 offset:0
 ds_read_b64_tr_b16 a[34:35], v1 offset:1024
 ds_read_b64_tr_b16 a[36:37], v1 offset:8192
 ds_read_b64_tr_b16 a[38:39], v1 offset:9216
 ds_read_b64_tr_b16 a[40:41], v2 offset:0
 ds_read_b64_tr_b16 a[42:43], v2 offset:1024
 ds_read_b64_tr_b16 a[44:45], v2 offset:8192
 ds_read_b64_tr_b16 a[46:47], v2 offset:9216
 ds_read_b128 a[168:171], v5 offset:2048
 ds_read_b128 a[172:175], v6 offset:2048
 ds_read_b64_tr_b16 a[48:49], v3 offset:0
 ds_read_b64_tr_b16 a[50:51], v3 offset:1024
 ds_read_b64_tr_b16 a[52:53], v3 offset:8192
 ds_read_b64_tr_b16 a[54:55], v3 offset:9216
 ds_read_b64_tr_b16 a[56:57], v4 offset:0
 ds_read_b64_tr_b16 a[58:59], v4 offset:1024
 ds_read_b64_tr_b16 a[60:61], v4 offset:8192
 ds_read_b64_tr_b16 a[62:63], v4 offset:9216
 ds_read_b128 a[176:179], v5 offset:4096
 ds_read_b128 a[180:183], v6 offset:4096
 ds_read_b128 a[184:187], v5 offset:6144
 ds_read_b128 a[188:191], v6 offset:6144
 s_add_u32 m0, s24, 16384
 s_nop 0
 buffer_load_dwordx4 v12, s[48:51], s22 offen offset:0   lds
 buffer_load_dwordx4 v13, s[48:51], s22 offen offset:1024   lds
 buffer_load_dwordx4 v14, s[48:51], s22 offen offset:2048   lds
 buffer_load_dwordx4 v15, s[48:51], s22 offen offset:3072   lds
 s_sub_u32 s22, s22, 2097024
 s_add_u32 m0, s23, 32768
 s_nop 0
 buffer_load_dwordx4 v8, s[16:19], s21 offen offset:0  nt lds
 buffer_load_dwordx4 v9, s[16:19], s21 offen offset:1024  nt lds
 buffer_load_dwordx4 v10, s[16:19], s21 offen offset:2048  nt lds
 buffer_load_dwordx4 v11, s[16:19], s21 offen offset:3072  nt lds
 s_add_u32 s21, s21, 128
 v_mov_b32 v72, 0
 v_mov_b32 v73, 0
 v_mov_b32 v74, 0
 v_mov_b32 v75, 0
 v_mov_b32 v76, 0
 v_mov_b32 v77, 0
 v_mov_b32 v78, 0
 v_mov_b32 v79, 0
 s_waitcnt vmcnt(12)
 v_dot2c_f32_bf16 v72, v40, v56
 v_dot2c_f32_bf16 v73, v44, v56
 v_dot2c_f32_bf16 v74, v48, v56
 v_dot2c_f32_bf16 v75, v52, v56
 s_waitcnt vmcnt(11)
 v_dot2c_f32_bf16 v76, v40, v60
 v_dot2c_f32_bf16 v77, v44, v60
 v_dot2c_f32_bf16 v78, v48, v60
 v_dot2c_f32_bf16 v79, v52, v60
 v_dot2c_f32_bf16 v72, v41, v57
 v_dot2c_f32_bf16 v73, v45, v57
 v_dot2c_f32_bf16 v74, v49, v57
 v_dot2c_f32_bf16 v75, v53, v57
 v_dot2c_f32_bf16 v76, v41, v61
 v_dot2c_f32_bf16 v77, v45, v61
 v_dot2c_f32_bf16 v78, v49, v61
 v_dot2c_f32_bf16 v79, v53, v61
 v_dot2c_f32_bf16 v72, v42, v58
 v_dot2c_f32_bf16 v73, v46, v58
 v_dot2c_f32_bf16 v74, v50, v58
 v_dot2c_f32_bf16 v75, v54, v58
 v_dot2c_f32_bf16 v76, v42, v62
 v_dot2c_f32_bf16 v77, v46, v62
 v_dot2c_f32_bf16 v78, v50, v62
 v_dot2c_f32_bf16 v79, v54, v62
 v_dot2c_f32_bf16 v72, v43, v59
 v_dot2c_f32_bf16 v73, v47, v59
 v_dot2c_f32_bf16 v74, v51, v59
 v_dot2c_f32_bf16 v75, v55, v59
 v_dot2c_f32_bf16 v76, v43, v63
 v_dot2c_f32_bf16 v77, v47, v63
 v_dot2c_f32_bf16 v78, v51, v63
 v_dot2c_f32_bf16 v79, v55, v63
 v_permlane32_swap_b32 v72, v74
 v_permlane32_swap_b32 v73, v75
 v_permlane32_swap_b32 v76, v78
 v_permlane32_swap_b32 v77, v79
 v_add_f32 v72, v72, v74
 v_add_f32 v73, v73, v75
 v_add_f32 v76, v76, v78
 v_add_f32 v77, v77, v79
 v_lshrrev_b32 v80, 4, v0
 v_permlane16_swap_b32 v72, v73
 v_permlane16_swap_b32 v76, v77
 v_add_f32 v72, v72, v73
 v_add_f32 v76, v76, v77
 v_add_u32 v81, s67, v80
 v_add_f32 v72, v72, v72 row_ror:8 row_mask:0xf bank_mask:0xf
 v_add_f32 v76, v76, v76 row_ror:8 row_mask:0xf bank_mask:0xf
 s_nop 0
 v_add_f32 v72, v72, v72 row_ror:4 row_mask:0xf bank_mask:0xf
 v_add_f32 v76, v76, v76 row_ror:4 row_mask:0xf bank_mask:0xf
 s_nop 0
 v_add_f32 v72, v72, v72 row_ror:2 row_mask:0xf bank_mask:0xf
 v_add_f32 v76, v76, v76 row_ror:2 row_mask:0xf bank_mask:0xf
 s_nop 0
 v_add_f32 v72, v72, v72 row_ror:1 row_mask:0xf bank_mask:0xf
 v_add_f32 v76, v76, v76 row_ror:1 row_mask:0xf bank_mask:0xf
 v_ashrrev_i32 v82, 31, v72
 v_or_b32 v82, 0x80000000, v82
 v_xor_b32 v82, v82, v72
 v_and_b32 v82, 0xfffff800, v82
 v_sub_u32 v81, 2047, v81
 v_or_b32 v82, v82, v81
 v_max_u32 v82, 1, v82
 v_mul_f32 v77, 0xbfb8aa3b, v76
 v_exp_f32 v77, v77
 s_nop 0
 v_add_f32 v77, 1.0, v77
 v_rcp_f32 v76, v77
 s_lshl_b32 s72, s20, 4
 s_add_u32 s72, s72, 163584
 v_lshl_add_u32 v80, v80, 2, s72
 ds_write_b32 v80, v82
 ds_write_b32 v80, v72 offset:64
 ds_write_b32 v80, v76 offset:128
 s_waitcnt lgkmcnt(15)
M a[0:3], a[160:163], a[32:35], 0
M a[0:3], a[164:167], a[36:39], a[0:3]
M a[4:7], a[164:167], a[44:47], 0
M a[4:7], a[160:163], a[40:43], a[4:7]
 s_waitcnt lgkmcnt(11)
M a[8:11], a[160:163], a[48:51], 0
M a[8:11], a[164:167], a[52:55], a[8:11]
 s_waitcnt lgkmcnt(7)
M a[12:15], a[164:167], a[60:63], 0
 s_add_u32 m0, s23, 49152
M a[12:15], a[160:163], a[56:59], a[12:15]
 buffer_load_dwordx4 v8, s[16:19], s21 offen offset:0  nt lds
M v[32:35], a[168:171], a[32:35], 0
 buffer_load_dwordx4 v9, s[16:19], s21 offen offset:1024  nt lds
M v[32:35], a[172:175], a[36:39], v[32:35]
M v[36:39], a[172:175], a[44:47], 0
 buffer_load_dwordx4 v10, s[16:19], s21 offen offset:2048  nt lds
M v[36:39], a[168:171], a[40:43], v[36:39]
M v[40:43], a[168:171], a[48:51], 0
 buffer_load_dwordx4 v11, s[16:19], s21 offen offset:3072  nt lds
M v[40:43], a[172:175], a[52:55], v[40:43]
 s_add_u32 s21, s21, 524160
M v[44:47], a[172:175], a[60:63], 0
 s_waitcnt lgkmcnt(0)
M v[44:47], a[168:171], a[56:59], v[44:47]
 s_barrier
M v[64:67], a[176:179], a[32:35], 0
 s_add_u32 m0, s24, 32768
 ds_read_b64_tr_b16 a[64:65], v1 offset:16384
 ds_read_b64_tr_b16 a[66:67], v1 offset:17408
M v[64:67], a[180:183], a[36:39], v[64:67]
 ds_read_b64_tr_b16 a[68:69], v1 offset:24576
 ds_read_b64_tr_b16 a[70:71], v1 offset:25600
M v[68:71], a[180:183], a[44:47], 0
 buffer_load_dwordx4 v12, s[48:51], s22 offen offset:0   lds
M v[68:71], a[176:179], a[40:43], v[68:71]
 ds_read_b64_tr_b16 a[72:73], v2 offset:16384
 ds_read_b64_tr_b16 a[74:75], v2 offset:17408
M v[72:75], a[176:179], a[48:51], 0
 ds_read_b64_tr_b16 a[76:77], v2 offset:24576
 ds_read_b64_tr_b16 a[78:79], v2 offset:25600
M v[72:75], a[180:183], a[52:55], v[72:75]
 buffer_load_dwordx4 v13, s[48:51], s22 offen offset:1024   lds
M v[76:79], a[180:183], a[60:63], 0
 ds_read_b64_tr_b16 a[80:81], v3 offset:16384
 ds_read_b64_tr_b16 a[82:83], v3 offset:17408
M v[76:79], a[176:179], a[56:59], v[76:79]
 ds_read_b64_tr_b16 a[84:85], v3 offset:24576
 ds_read_b64_tr_b16 a[86:87], v3 offset:25600
M v[96:99], a[184:187], a[32:35], 0
 buffer_load_dwordx4 v14, s[48:51], s22 offen offset:2048   lds
M v[96:99], a[188:191], a[36:39], v[96:99]
 ds_read_b64_tr_b16 a[88:89], v4 offset:16384
 ds_read_b64_tr_b16 a[90:91], v4 offset:17408
M v[100:103], a[188:191], a[44:47], 0
 ds_read_b64_tr_b16 a[92:93], v4 offset:24576
 ds_read_b64_tr_b16 a[94:95], v4 offset:25600
M v[100:103], a[184:187], a[40:43], v[100:103]
 buffer_load_dwordx4 v15, s[48:51], s22 offen offset:3072   lds
M v[104:107], a[184:187], a[48:51], 0
 s_add_u32 s22, s22, 2097152
 v_max3_f32 v20, |v32|, |v33|, |v34|
 v_max3_f32 v20, |v35|, |v36|, v20
M v[104:107], a[188:191], a[52:55], v[104:107]
 v_max3_f32 v20, |v37|, |v38|, v20
 v_max3_f32 v21, |v64|, |v65|, |v66|
M v[108:111], a[188:191], a[60:63], 0
 s_add_u32 m0, s23, 0
 v_max3_f32 v21, |v67|, |v68|, v21
 v_max3_f32 v21, |v69|, |v70|, v21
M v[108:111], a[184:187], a[56:59], v[108:111]
 s_waitcnt lgkmcnt(0)
 v_min_f32 v20, v20, v21
 v_mul_f32 v20, 0x41000000, v20
M a[16:19], a[160:163], a[64:67], 0
 buffer_load_dwordx4 v8, s[16:19], s21 offen offset:0  nt lds
M a[16:19], a[164:167], a[68:71], a[16:19]
 v_mov_b32 v21, v20
 v_mov_b32 v22, v20
M a[20:23], a[164:167], a[76:79], 0
 buffer_load_dwordx4 v9, s[16:19], s21 offen offset:1024  nt lds
M a[20:23], a[160:163], a[72:75], a[20:23]
 v_mov_b32 v23, v20
 v_accvgpr_write_b32 a241, v20
M a[24:27], a[160:163], a[80:83], 0
M a[24:27], a[164:167], a[84:87], a[24:27]
M a[28:31], a[164:167], a[92:95], 0
 buffer_load_dwordx4 v10, s[16:19], s21 offen offset:2048  nt lds
M a[28:31], a[160:163], a[88:91], a[28:31]
M v[48:51], a[168:171], a[64:67], v[20:23]
M v[48:51], a[172:175], a[68:71], v[48:51]
 buffer_load_dwordx4 v11, s[16:19], s21 offen offset:3072  nt lds
M v[52:55], a[172:175], a[76:79], v[20:23]
 s_add_u32 s21, s21, 128
M v[52:55], a[168:171], a[72:75], v[52:55]
M v[56:59], a[168:171], a[80:83], v[20:23]
M v[56:59], a[172:175], a[84:87], v[56:59]
M v[60:63], a[172:175], a[92:95], v[20:23]
 s_waitcnt vmcnt(12)
M v[60:63], a[168:171], a[88:91], v[60:63]
 s_barrier
M v[80:83], a[176:179], a[64:67], v[20:23]
 s_add_u32 m0, s24, 49152
 ds_read_b128 a[160:163], v5 offset:16384
 ds_read_b128 a[164:167], v6 offset:16384
M v[80:83], a[180:183], a[68:71], v[80:83]
 buffer_load_dwordx4 v12, s[48:51], s22 offen offset:0   lds
M v[84:87], a[180:183], a[76:79], v[20:23]
 ds_read_b64_tr_b16 a[96:97], v1 offset:32768
 ds_read_b64_tr_b16 a[98:99], v1 offset:33792
M v[84:87], a[176:179], a[72:75], v[84:87]
M v[88:91], a[176:179], a[80:83], v[20:23]
 buffer_load_dwordx4 v13, s[48:51], s22 offen offset:1024   lds
M v[88:91], a[180:183], a[84:87], v[88:91]
 ds_read_b64_tr_b16 a[100:101], v1 offset:40960
 ds_read_b64_tr_b16 a[102:103], v1 offset:41984
M v[92:95], a[180:183], a[92:95], v[20:23]
M v[92:95], a[176:179], a[88:91], v[92:95]
M v[112:115], a[184:187], a[64:67], v[20:23]
 ds_read_b64_tr_b16 a[104:105], v2 offset:32768
 ds_read_b64_tr_b16 a[106:107], v2 offset:33792
M v[112:115], a[188:191], a[68:71], v[112:115]
 buffer_load_dwordx4 v14, s[48:51], s22 offen offset:2048   lds
M v[116:119], a[188:191], a[76:79], v[20:23]
M v[116:119], a[184:187], a[72:75], v[116:119]
 ds_read_b64_tr_b16 a[108:109], v2 offset:40960
 ds_read_b64_tr_b16 a[110:111], v2 offset:41984
M v[120:123], a[184:187], a[80:83], v[20:23]
 buffer_load_dwordx4 v15, s[48:51], s22 offen offset:3072   lds
M v[120:123], a[188:191], a[84:87], v[120:123]
 s_waitcnt lgkmcnt(8)
M v[124:127], a[188:191], a[92:95], v[20:23]
 s_sub_u32 s22, s22, 2097024
M v[124:127], a[184:187], a[88:91], v[124:127]
 s_add_u32 m0, s23, 16384
 ds_read_b64_tr_b16 a[112:113], v3 offset:32768
 ds_read_b64_tr_b16 a[114:115], v3 offset:33792
M v[128:131], a[160:163], a[32:35], v[20:23]
 ds_read_b128 a[168:171], v5 offset:18432
 ds_read_b128 a[172:175], v6 offset:18432
M v[128:131], a[164:167], a[36:39], v[128:131]
 buffer_load_dwordx4 v8, s[16:19], s21 offen offset:0  nt lds
M v[132:135], a[164:167], a[44:47], v[20:23]
 ds_read_b64_tr_b16 a[116:117], v3 offset:40960
 ds_read_b64_tr_b16 a[118:119], v3 offset:41984
M v[132:135], a[160:163], a[40:43], v[132:135]
 buffer_load_dwordx4 v9, s[16:19], s21 offen offset:1024  nt lds
M v[136:139], a[160:163], a[48:51], v[20:23]
M v[136:139], a[164:167], a[52:55], v[136:139]
 ds_read_b64_tr_b16 a[120:121], v4 offset:32768
 ds_read_b64_tr_b16 a[122:123], v4 offset:33792
M v[140:143], a[164:167], a[60:63], v[20:23]
 buffer_load_dwordx4 v10, s[16:19], s21 offen offset:2048  nt lds
M v[140:143], a[160:163], a[56:59], v[140:143]
M v[144:147], a[160:163], a[64:67], v[20:23]
 ds_read_b64_tr_b16 a[124:125], v4 offset:40960
 ds_read_b64_tr_b16 a[126:127], v4 offset:41984
M v[144:147], a[164:167], a[68:71], v[144:147]
 buffer_load_dwordx4 v11, s[16:19], s21 offen offset:3072  nt lds
M v[148:151], a[164:167], a[76:79], v[20:23]
 s_add_u32 s21, s21, 524160
M v[148:151], a[160:163], a[72:75], v[148:151]
M v[152:155], a[160:163], a[80:83], v[20:23]
M v[152:155], a[164:167], a[84:87], v[152:155]
 s_waitcnt lgkmcnt(6)
M v[156:159], a[164:167], a[92:95], v[20:23]
 s_waitcnt vmcnt(16) lgkmcnt(0)
M v[156:159], a[160:163], a[88:91], v[156:159]
 s_barrier
M v[160:163], a[168:171], a[32:35], v[20:23]
 s_add_u32 m0, s24, 0
 ds_read_b128 a[160:163], v5 offset:20480
 ds_read_b128 a[164:167], v6 offset:20480
M v[160:163], a[172:175], a[36:39], v[160:163]
 buffer_load_dwordx4 v12, s[48:51], s22 offen offset:0   lds
M v[164:167], a[172:175], a[44:47], v[20:23]
 ds_read_b64_tr_b16 a[128:129], v1 offset:49152
 ds_read_b64_tr_b16 a[130:131], v1 offset:50176
M v[164:167], a[168:171], a[40:43], v[164:167]
M v[168:171], a[168:171], a[48:51], v[20:23]
 buffer_load_dwordx4 v13, s[48:51], s22 offen offset:1024   lds
M v[168:171], a[172:175], a[52:55], v[168:171]
 ds_read_b64_tr_b16 a[132:133], v1 offset:57344
 ds_read_b64_tr_b16 a[134:135], v1 offset:58368
M v[172:175], a[172:175], a[60:63], v[20:23]
M v[172:175], a[168:171], a[56:59], v[172:175]
M v[176:179], a[168:171], a[64:67], v[20:23]
 ds_read_b64_tr_b16 a[136:137], v2 offset:49152
 ds_read_b64_tr_b16 a[138:139], v2 offset:50176
M v[176:179], a[172:175], a[68:71], v[176:179]
 buffer_load_dwordx4 v14, s[48:51], s22 offen offset:2048   lds
M v[180:183], a[172:175], a[76:79], v[20:23]
M v[180:183], a[168:171], a[72:75], v[180:183]
 ds_read_b64_tr_b16 a[140:141], v2 offset:57344
 ds_read_b64_tr_b16 a[142:143], v2 offset:58368
M v[184:187], a[168:171], a[80:83], v[20:23]
 buffer_load_dwordx4 v15, s[48:51], s22 offen offset:3072   lds
M v[184:187], a[172:175], a[84:87], v[184:187]
 s_waitcnt lgkmcnt(8)
M v[188:191], a[172:175], a[92:95], v[20:23]
 s_add_u32 s22, s22, 2097152
M v[188:191], a[168:171], a[88:91], v[188:191]
 s_add_u32 m0, s23, 32768
 ds_read_b64_tr_b16 a[144:145], v3 offset:49152
 ds_read_b64_tr_b16 a[146:147], v3 offset:50176
M v[192:195], a[160:163], a[32:35], v[20:23]
 ds_read_b128 a[168:171], v5 offset:22528
 ds_read_b128 a[172:175], v6 offset:22528
M v[192:195], a[164:167], a[36:39], v[192:195]
 buffer_load_dwordx4 v8, s[16:19], s21 offen offset:0  nt lds
M v[196:199], a[164:167], a[44:47], v[20:23]
 ds_read_b64_tr_b16 a[148:149], v3 offset:57344
 ds_read_b64_tr_b16 a[150:151], v3 offset:58368
M v[196:199], a[160:163], a[40:43], v[196:199]
 buffer_load_dwordx4 v9, s[16:19], s21 offen offset:1024  nt lds
M v[200:203], a[160:163], a[48:51], v[20:23]
M v[200:203], a[164:167], a[52:55], v[200:203]
 ds_read_b64_tr_b16 a[152:153], v4 offset:49152
 ds_read_b64_tr_b16 a[154:155], v4 offset:50176
M v[204:207], a[164:167], a[60:63], v[20:23]
 buffer_load_dwordx4 v10, s[16:19], s21 offen offset:2048  nt lds
M v[204:207], a[160:163], a[56:59], v[204:207]
M v[208:211], a[160:163], a[64:67], v[20:23]
 ds_read_b64_tr_b16 a[156:157], v4 offset:57344
 ds_read_b64_tr_b16 a[158:159], v4 offset:58368
M v[208:211], a[164:167], a[68:71], v[208:211]
 buffer_load_dwordx4 v11, s[16:19], s21 offen offset:3072  nt lds
M v[212:215], a[164:167], a[76:79], v[20:23]
 s_add_u32 s21, s21, 128
M v[212:215], a[160:163], a[72:75], v[212:215]
M v[216:219], a[160:163], a[80:83], v[20:23]
M v[216:219], a[164:167], a[84:87], v[216:219]
 s_waitcnt lgkmcnt(6)
M v[220:223], a[164:167], a[92:95], v[20:23]
 s_waitcnt vmcnt(16) lgkmcnt(0)
M v[220:223], a[160:163], a[88:91], v[220:223]
 s_barrier
M v[224:227], a[168:171], a[32:35], v[20:23]
 ds_read_b128 a[160:163], v5 offset:32768
 ds_read_b128 a[164:167], v6 offset:32768
M v[224:227], a[172:175], a[36:39], v[224:227]
 buffer_load_dword a240, v24, s[32:35], 0 offen offset:512
M v[228:231], a[172:175], a[44:47], v[20:23]
M v[228:231], a[168:171], a[40:43], v[228:231]
M v[232:235], a[168:171], a[48:51], v[20:23]
M v[232:235], a[172:175], a[52:55], v[232:235]
M v[236:239], a[172:175], a[60:63], v[20:23]
M v[236:239], a[168:171], a[56:59], v[236:239]
M v[240:243], a[168:171], a[64:67], v[20:23]
M v[240:243], a[172:175], a[68:71], v[240:243]
M v[244:247], a[172:175], a[76:79], v[20:23]
M v[244:247], a[168:171], a[72:75], v[244:247]
M v[248:251], a[168:171], a[80:83], v[20:23]
M v[248:251], a[172:175], a[84:87], v[248:251]
 s_waitcnt lgkmcnt(0)
M v[252:255], a[172:175], a[92:95], v[20:23]
M v[252:255], a[168:171], a[88:91], v[252:255]
M a[0:3], a[160:163], a[96:99], a[0:3]
 ds_read_b128 a[168:171], v5 offset:34816
 ds_read_b128 a[172:175], v6 offset:34816
M a[0:3], a[164:167], a[100:103], a[0:3]
 ds_read_b64_tr_b16 a[32:33], v1 offset:0
 ds_read_b64_tr_b16 a[34:35], v1 offset:1024
M a[4:7], a[164:167], a[108:111], a[4:7]
 s_add_u32 m0, s24, 16384
M a[4:7], a[160:163], a[104:107], a[4:7]
 buffer_load_dwordx4 v12, s[48:51], s22 offen offset:0   lds
M a[8:11], a[160:163], a[112:115], a[8:11]
M a[8:11], a[164:167], a[116:119], a[8:11]
M a[12:15], a[164:167], a[124:127], a[12:15]
 ds_read_b64_tr_b16 a[36:37], v1 offset:8192
 ds_read_b64_tr_b16 a[38:39], v1 offset:9216
M a[12:15], a[160:163], a[120:123], a[12:15]
M a[16:19], a[160:163], a[128:131], a[16:19]
 buffer_load_dwordx4 v13, s[48:51], s22 offen offset:1024   lds
M a[16:19], a[164:167], a[132:135], a[16:19]
M a[20:23], a[164:167], a[140:143], a[20:23]
M a[20:23], a[160:163], a[136:139], a[20:23]
 ds_read_b64_tr_b16 a[40:41], v2 offset:0
 ds_read_b64_tr_b16 a[42:43], v2 offset:1024
M a[24:27], a[160:163], a[144:147], a[24:27]
M a[24:27], a[164:167], a[148:151], a[24:27]
 s_waitcnt lgkmcnt(6)
M a[28:31], a[164:167], a[156:159], a[28:31]
 buffer_load_dwordx4 v14, s[48:51], s22 offen offset:2048   lds
M a[28:31], a[160:163], a[152:155], a[28:31]
M v[32:35], a[168:171], a[96:99], v[32:35]
 ds_read_b128 a[160:163], v5 offset:36864
 ds_read_b128 a[164:167], v6 offset:36864
M v[32:35], a[172:175], a[100:103], v[32:35]
 ds_read_b64_tr_b16 a[44:45], v2 offset:8192
 ds_read_b64_tr_b16 a[46:47], v2 offset:9216
M v[36:39], a[172:175], a[108:111], v[36:39]
 buffer_load_dwordx4 v15, s[48:51], s22 offen offset:3072   lds
M v[36:39], a[168:171], a[104:107], v[36:39]
 s_sub_u32 s22, s22, 2097024
M v[40:43], a[168:171], a[112:115], v[40:43]
M v[40:43], a[172:175], a[116:119], v[40:43]
 ds_read_b64_tr_b16 a[48:49], v3 offset:0
 ds_read_b64_tr_b16 a[50:51], v3 offset:1024
M v[44:47], a[172:175], a[124:127], v[44:47]
 s_add_u32 m0, s23, 49152
M v[44:47], a[168:171], a[120:123], v[44:47]
 buffer_load_dwordx4 v8, s[16:19], s21 offen offset:0  nt lds
M v[48:51], a[168:171], a[128:131], v[48:51]
M v[48:51], a[172:175], a[132:135], v[48:51]
M v[52:55], a[172:175], a[140:143], v[52:55]
 ds_read_b64_tr_b16 a[52:53], v3 offset:8192
 ds_read_b64_tr_b16 a[54:55], v3 offset:9216
M v[52:55], a[168:171], a[136:139], v[52:55]
M v[56:59], a[168:171], a[144:147], v[56:59]
 buffer_load_dwordx4 v9, s[16:19], s21 offen offset:1024  nt lds
M v[56:59], a[172:175], a[148:151], v[56:59]
 s_waitcnt lgkmcnt(6)
M v[60:63], a[172:175], a[156:159], v[60:63]
M v[60:63], a[168:171], a[152:155], v[60:63]
 ds_read_b64_tr_b16 a[56:57], v4 offset:0
 ds_read_b64_tr_b16 a[58:59], v4 offset:1024
M v[64:67], a[160:163], a[96:99], v[64:67]
 ds_read_b128 a[168:171], v5 offset:38912
 ds_read_b128 a[172:175], v6 offset:38912
M v[64:67], a[164:167], a[100:103], v[64:67]
 buffer_load_dwordx4 v10, s[16:19], s21 offen offset:2048  nt lds
M v[68:71], a[164:167], a[108:111], v[68:71]
M v[68:71], a[160:163], a[104:107], v[68:71]
M v[72:75], a[160:163], a[112:115], v[72:75]
 ds_read_b64_tr_b16 a[60:61], v4 offset:8192
 ds_read_b64_tr_b16 a[62:63], v4 offset:9216
M v[72:75], a[164:167], a[116:119], v[72:75]
M v[76:79], a[164:167], a[124:127], v[76:79]
 buffer_load_dwordx4 v11, s[16:19], s21 offen offset:3072  nt lds
M v[76:79], a[160:163], a[120:123], v[76:79]
 s_add_u32 s21, s21, 524160
M v[80:83], a[160:163], a[128:131], v[80:83]
M v[80:83], a[164:167], a[132:135], v[80:83]
M v[84:87], a[164:167], a[140:143], v[84:87]
M v[84:87], a[160:163], a[136:139], v[84:87]
M v[88:91], a[160:163], a[144:147], v[88:91]
M v[88:91], a[164:167], a[148:151], v[88:91]
 s_waitcnt lgkmcnt(2)
M v[92:95], a[164:167], a[156:159], v[92:95]
 s_waitcnt vmcnt(17) lgkmcnt(0)
M v[92:95], a[160:163], a[152:155], v[92:95]
 s_barrier
M v[96:99], a[168:171], a[96:99], v[96:99]
 ds_read_b128 a[160:163], v5 offset:49152
 ds_read_b128 a[164:167], v6 offset:49152
M v[96:99], a[172:175], a[100:103], v[96:99]
M v[100:103], a[172:175], a[108:111], v[100:103]
 s_add_u32 m0, s24, 32768
 ds_read_b64_tr_b16 a[64:65], v1 offset:16384
 ds_read_b64_tr_b16 a[66:67], v1 offset:17408
M v[100:103], a[168:171], a[104:107], v[100:103]
 buffer_load_dwordx4 v12, s[48:51], s22 offen offset:0   lds
M v[104:107], a[168:171], a[112:115], v[104:107]
M v[104:107], a[172:175], a[116:119], v[104:107]
M v[108:111], a[172:175], a[124:127], v[108:111]
M v[108:111], a[168:171], a[120:123], v[108:111]
M v[112:115], a[168:171], a[128:131], v[112:115]
M v[112:115], a[172:175], a[132:135], v[112:115]
 ds_read_b64_tr_b16 a[68:69], v1 offset:24576
 ds_read_b64_tr_b16 a[70:71], v1 offset:25600
M v[116:119], a[172:175], a[140:143], v[116:119]
 buffer_load_dwordx4 v13, s[48:51], s22 offen offset:1024   lds
M v[116:119], a[168:171], a[136:139], v[116:119]
M v[120:123], a[168:171], a[144:147], v[120:123]
M v[120:123], a[172:175], a[148:151], v[120:123]
 s_waitcnt lgkmcnt(4)
M v[124:127], a[172:175], a[156:159], v[124:127]
M v[124:127], a[168:171], a[152:155], v[124:127]
M v[128:131], a[160:163], a[96:99], v[128:131]
 ds_read_b128 a[168:171], v5 offset:51200
 ds_read_b128 a[172:175], v6 offset:51200
M v[128:131], a[164:167], a[100:103], v[128:131]
 ds_read_b64_tr_b16 a[72:73], v2 offset:16384
 ds_read_b64_tr_b16 a[74:75], v2 offset:17408
M v[132:135], a[164:167], a[108:111], v[132:135]
 buffer_load_dwordx4 v14, s[48:51], s22 offen offset:2048   lds
M v[132:135], a[160:163], a[104:107], v[132:135]
M v[136:139], a[160:163], a[112:115], v[136:139]
M v[136:139], a[164:167], a[116:119], v[136:139]
M v[140:143], a[164:167], a[124:127], v[140:143]
M v[140:143], a[160:163], a[120:123], v[140:143]
 ds_read_b64_tr_b16 a[76:77], v2 offset:24576
 ds_read_b64_tr_b16 a[78:79], v2 offset:25600
M v[144:147], a[160:163], a[128:131], v[144:147]
 buffer_load_dwordx4 v15, s[48:51], s22 offen offset:3072   lds
M v[144:147], a[164:167], a[132:135], v[144:147]
 s_add_u32 s22, s22, 2097152
M v[148:151], a[164:167], a[140:143], v[148:151]
M v[148:151], a[160:163], a[136:139], v[148:151]
M v[152:155], a[160:163], a[144:147], v[152:155]
M v[152:155], a[164:167], a[148:151], v[152:155]
 s_waitcnt lgkmcnt(4)
M v[156:159], a[164:167], a[156:159], v[156:159]
 s_add_u32 m0, s23, 0
 ds_read_b64_tr_b16 a[80:81], v3 offset:16384
 ds_read_b64_tr_b16 a[82:83], v3 offset:17408
M v[156:159], a[160:163], a[152:155], v[156:159]
 buffer_load_dwordx4 v8, s[16:19], s21 offen offset:0  nt lds
M v[160:163], a[168:171], a[96:99], v[160:163]
 ds_read_b128 a[160:163], v5 offset:53248
 ds_read_b128 a[164:167], v6 offset:53248
M v[160:163], a[172:175], a[100:103], v[160:163]
M v[164:167], a[172:175], a[108:111], v[164:167]
M v[164:167], a[168:171], a[104:107], v[164:167]
M v[168:171], a[168:171], a[112:115], v[168:171]
M v[168:171], a[172:175], a[116:119], v[168:171]
 ds_read_b64_tr_b16 a[84:85], v3 offset:24576
 ds_read_b64_tr_b16 a[86:87], v3 offset:25600
M v[172:175], a[172:175], a[124:127], v[172:175]
 buffer_load_dwordx4 v9, s[16:19], s21 offen offset:1024  nt lds
M v[172:175], a[168:171], a[120:123], v[172:175]
M v[176:179], a[168:171], a[128:131], v[176:179]
M v[176:179], a[172:175], a[132:135], v[176:179]
M v[180:183], a[172:175], a[140:143], v[180:183]
M v[180:183], a[168:171], a[136:139], v[180:183]
M v[184:187], a[168:171], a[144:147], v[184:187]
 ds_read_b64_tr_b16 a[88:89], v4 offset:16384
 ds_read_b64_tr_b16 a[90:91], v4 offset:17408
M v[184:187], a[172:175], a[148:151], v[184:187]
 s_waitcnt lgkmcnt(4)
M v[188:191], a[172:175], a[156:159], v[188:191]
 buffer_load_dwordx4 v10, s[16:19], s21 offen offset:2048  nt lds
M v[188:191], a[168:171], a[152:155], v[188:191]
M v[192:195], a[160:163], a[96:99], v[192:195]
 ds_read_b128 a[168:171], v5 offset:55296
 ds_read_b128 a[172:175], v6 offset:55296
M v[192:195], a[164:167], a[100:103], v[192:195]
M v[196:199], a[164:167], a[108:111], v[196:199]
M v[196:199], a[160:163], a[104:107], v[196:199]
 ds_read_b64_tr_b16 a[92:93], v4 offset:24576
 ds_read_b64_tr_b16 a[94:95], v4 offset:25600
M v[200:203], a[160:163], a[112:115], v[200:203]
 buffer_load_dwordx4 v11, s[16:19], s21 offen offset:3072  nt lds
M v[200:203], a[164:167], a[116:119], v[200:203]
 s_add_u32 s21, s21, 128
M v[204:207], a[164:167], a[124:127], v[204:207]
M v[204:207], a[160:163], a[120:123], v[204:207]
M v[208:211], a[160:163], a[128:131], v[208:211]
M v[208:211], a[164:167], a[132:135], v[208:211]
M v[212:215], a[164:167], a[140:143], v[212:215]
M v[212:215], a[160:163], a[136:139], v[212:215]
M v[216:219], a[160:163], a[144:147], v[216:219]
M v[216:219], a[164:167], a[148:151], v[216:219]
 s_waitcnt lgkmcnt(2)
M v[220:223], a[164:167], a[156:159], v[220:223]
 s_waitcnt vmcnt(17) lgkmcnt(0)
M v[220:223], a[160:163], a[152:155], v[220:223]
 s_barrier
M v[224:227], a[168:171], a[96:99], v[224:227]
 ds_read_b128 a[160:163], v5 offset:0
 ds_read_b128 a[164:167], v6 offset:0
M v[224:227], a[172:175], a[100:103], v[224:227]
 v_min_u32 v16, 1, v0
 v_lshlrev_b32 v16, 29, v16
M v[228:231], a[172:175], a[108:111], v[228:231]
 v_or_b32 v16, s39, v16
 v_mov_b32 v17, 1
M v[228:231], a[168:171], a[104:107], v[228:231]
M v[232:235], a[168:171], a[112:115], v[232:235]
 buffer_store_dword v17, v16, s[12:15], s38 offen offset:64 sc1
M v[232:235], a[172:175], a[116:119], v[232:235]
M v[236:239], a[172:175], a[124:127], v[236:239]
M v[236:239], a[168:171], a[120:123], v[236:239]
M v[240:243], a[168:171], a[128:131], v[240:243]
M v[240:243], a[172:175], a[132:135], v[240:243]
M v[244:247], a[172:175], a[140:143], v[244:247]
M v[244:247], a[168:171], a[136:139], v[244:247]
M v[248:251], a[168:171], a[144:147], v[248:251]
M v[248:251], a[172:175], a[148:151], v[248:251]
 s_waitcnt lgkmcnt(0)
M v[252:255], a[172:175], a[156:159], v[252:255]
M v[252:255], a[168:171], a[152:155], v[252:255]
M a[0:3], a[160:163], a[32:35], a[0:3]
 ds_read_b128 a[168:171], v5 offset:2048
 ds_read_b128 a[172:175], v6 offset:2048
M a[0:3], a[164:167], a[36:39], a[0:3]
 ds_read_b64_tr_b16 a[96:97], v1 offset:32768
 ds_read_b64_tr_b16 a[98:99], v1 offset:33792
M a[4:7], a[164:167], a[44:47], a[4:7]
 s_add_u32 m0, s24, 49152
M a[4:7], a[160:163], a[40:43], a[4:7]
 buffer_load_dwordx4 v12, s[48:51], s22 offen offset:0   lds
M a[8:11], a[160:163], a[48:51], a[8:11]
 v_and_b32 v20, 31, v0
M a[8:11], a[164:167], a[52:55], a[8:11]
 v_lshlrev_b32 v20, 2, v20
M a[12:15], a[164:167], a[60:63], a[12:15]
 ds_read_b64_tr_b16 a[100:101], v1 offset:40960
 ds_read_b64_tr_b16 a[102:103], v1 offset:41984
M a[12:15], a[160:163], a[56:59], a[12:15]
 v_add_u32 v21, 163584, v20
M a[16:19], a[160:163], a[64:67], a[16:19]
 buffer_load_dwordx4 v13, s[48:51], s22 offen offset:1024   lds
M a[16:19], a[164:167], a[68:71], a[16:19]
 ds_read_b32 v19, v21
M a[20:23], a[164:167], a[76:79], a[20:23]
 ds_read_b32 v21, v21 offset:64
M a[20:23], a[160:163], a[72:75], a[20:23]
 s_min_u32 s64, s20, 1
 ds_read_b64_tr_b16 a[104:105], v2 offset:32768
 ds_read_b64_tr_b16 a[106:107], v2 offset:33792
M a[24:27], a[160:163], a[80:83], a[24:27]
 s_lshl_b32 s64, s64, 29
 v_and_b32 v22, 32, v0
M a[24:27], a[164:167], a[84:87], a[24:27]
 s_waitcnt lgkmcnt(8)
 v_lshl_or_b32 v20, v22, 24, v20
M a[28:31], a[164:167], a[92:95], a[28:31]
 buffer_load_dwordx4 v14, s[48:51], s22 offen offset:2048   lds
M a[28:31], a[160:163], a[88:91], a[28:31]
 v_or_b32 v20, s64, v20
M v[32:35], a[168:171], a[32:35], v[32:35]
 ds_read_b128 a[160:163], v5 offset:4096
 ds_read_b128 a[164:167], v6 offset:4096
M v[32:35], a[172:175], a[36:39], v[32:35]
 ds_read_b64_tr_b16 a[108:109], v2 offset:40960
 ds_read_b64_tr_b16 a[110:111], v2 offset:41984
M v[36:39], a[172:175], a[44:47], v[36:39]
 buffer_load_dwordx4 v15, s[48:51], s22 offen offset:3072   lds
M v[36:39], a[168:171], a[40:43], v[36:39]
 s_sub_u32 s22, s22, 2097024
 v_and_b32 v22, 16, v0
M v[40:43], a[168:171], a[48:51], v[40:43]
 v_lshl_or_b32 v18, v22, 25, v20
M v[40:43], a[172:175], a[52:55], v[40:43]
 s_lshl_b32 s72, s30, 7
 ds_read_b64_tr_b16 a[112:113], v3 offset:32768
 ds_read_b64_tr_b16 a[114:115], v3 offset:33792
M v[44:47], a[172:175], a[60:63], v[44:47]
 s_add_u32 m0, s23, 16384
 s_add_u32 s72, s72, 104857600
M v[44:47], a[168:171], a[56:59], v[44:47]
 buffer_load_dwordx4 v8, s[16:19], s21 offen offset:0  nt lds
M v[48:51], a[168:171], a[64:67], v[48:51]
M v[48:51], a[172:175], a[68:71], v[48:51]
M v[52:55], a[172:175], a[76:79], v[52:55]
 ds_read_b64_tr_b16 a[116:117], v3 offset:40960
 ds_read_b64_tr_b16 a[118:119], v3 offset:41984
M v[52:55], a[168:171], a[72:75], v[52:55]
M v[56:59], a[168:171], a[80:83], v[56:59]
 buffer_load_dwordx4 v9, s[16:19], s21 offen offset:1024  nt lds
M v[56:59], a[172:175], a[84:87], v[56:59]
 s_waitcnt lgkmcnt(6)
M v[60:63], a[172:175], a[92:95], v[60:63]
 buffer_store_dword v21, v20, s[8:11], s72 offen sc1
M v[60:63], a[168:171], a[88:91], v[60:63]
 ds_read_b64_tr_b16 a[120:121], v4 offset:32768
 ds_read_b64_tr_b16 a[122:123], v4 offset:33792
M v[64:67], a[160:163], a[32:35], v[64:67]
 ds_read_b128 a[168:171], v5 offset:6144
 ds_read_b128 a[172:175], v6 offset:6144
M v[64:67], a[164:167], a[36:39], v[64:67]
 buffer_load_dwordx4 v10, s[16:19], s21 offen offset:2048  nt lds
M v[68:71], a[164:167], a[44:47], v[68:71]
M v[68:71], a[160:163], a[40:43], v[68:71]
M v[72:75], a[160:163], a[48:51], v[72:75]
 ds_read_b64_tr_b16 a[124:125], v4 offset:40960
 ds_read_b64_tr_b16 a[126:127], v4 offset:41984
M v[72:75], a[164:167], a[52:55], v[72:75]
M v[76:79], a[164:167], a[60:63], v[76:79]
 buffer_load_dwordx4 v11, s[16:19], s21 offen offset:3072  nt lds
M v[76:79], a[160:163], a[56:59], v[76:79]
 s_add_u32 s21, s21, 524160
M v[80:83], a[160:163], a[64:67], v[80:83]
M v[80:83], a[164:167], a[68:71], v[80:83]
M v[84:87], a[164:167], a[76:79], v[84:87]
M v[84:87], a[160:163], a[72:75], v[84:87]
 s_and_b32 s86, s41, 7
M v[88:91], a[160:163], a[80:83], v[88:91]
 s_mul_i32 s86, s86, 14
 s_lshr_b32 s64, s41, 3
 s_mul_i32 s64, s64, 7
M v[88:91], a[164:167], a[84:87], v[88:91]
 s_waitcnt lgkmcnt(2)
 s_add_u32 s86, s86, s64
 s_min_u32 s64, s42, 6
M v[92:95], a[164:167], a[92:95], v[92:95]
 s_waitcnt vmcnt(18) lgkmcnt(0)
 s_add_u32 s86, s86, s64
 s_sub_u32 s64, 6, s42
M v[92:95], a[160:163], a[88:91], v[92:95]
 s_barrier
M v[96:99], a[168:171], a[32:35], v[96:99]
 ds_read_b128 a[160:163], v5 offset:16384
 ds_read_b128 a[164:167], v6 offset:16384
M v[96:99], a[172:175], a[36:39], v[96:99]
 s_and_b32 s88, s64, 536870912
 s_mul_i32 s87, s20, 7168
M v[100:103], a[172:175], a[44:47], v[100:103]
 s_add_u32 m0, s24, 0
 ds_read_b64_tr_b16 a[128:129], v1 offset:49152
 ds_read_b64_tr_b16 a[130:131], v1 offset:50176
M v[100:103], a[168:171], a[40:43], v[100:103]
 buffer_load_dwordx4 v12, s[48:51], s22 offen offset:0   lds
M v[104:107], a[168:171], a[48:51], v[104:107]
 s_add_u32 s87, s87, 131072
M v[104:107], a[172:175], a[52:55], v[104:107]
 s_cmp_lt_u32 s20, 2
M v[108:111], a[172:175], a[60:63], v[108:111]
 s_cselect_b64 s[72:73], s[80:81], s[82:83]
M v[108:111], a[168:171], a[56:59], v[108:111]
 s_mov_b32 s60, s72
M v[112:115], a[168:171], a[64:67], v[112:115]
 s_and_b32 s61, s73, 0xffff
M v[112:115], a[172:175], a[68:71], v[112:115]
 s_mov_b32 s62, 1605632
 ds_read_b64_tr_b16 a[132:133], v1 offset:57344
 ds_read_b64_tr_b16 a[134:135], v1 offset:58368
M v[116:119], a[172:175], a[76:79], v[116:119]
 buffer_load_dwordx4 v13, s[48:51], s22 offen offset:1024   lds
M v[116:119], a[168:171], a[72:75], v[116:119]
 s_mov_b32 s63, 0x20000
M v[120:123], a[168:171], a[80:83], v[120:123]
 s_mov_b32 s68, s84
 s_and_b32 s69, s85, 0xffff
 s_mov_b32 s70, 1605632
M v[120:123], a[172:175], a[84:87], v[120:123]
 s_waitcnt lgkmcnt(4)
 s_mov_b32 s71, 0x20000
M v[124:127], a[172:175], a[92:95], v[124:127]
 s_lshl_b32 s89, s86, 5
 s_and_b32 s64, s20, 1
 s_mul_i32 s64, s64, 802816
M v[124:127], a[168:171], a[88:91], v[124:127]
 buffer_load_dwordx4 v14, s[48:51], s22 offen offset:2048   lds
M v[128:131], a[160:163], a[32:35], v[128:131]
 ds_read_b128 a[168:171], v5 offset:18432
 ds_read_b128 a[172:175], v6 offset:18432
M v[128:131], a[164:167], a[36:39], v[128:131]
 ds_read_b64_tr_b16 a[136:137], v2 offset:49152
 ds_read_b64_tr_b16 a[138:139], v2 offset:50176
M v[132:135], a[164:167], a[44:47], v[132:135]
 s_add_u32 s89, s89, s64
 v_lshrrev_b32 v28, 1, v0
M v[132:135], a[160:163], a[40:43], v[132:135]
 v_mul_u32_u24 v28, 3584, v28
 v_and_b32 v29, 1, v0
M v[136:139], a[160:163], a[48:51], v[136:139]
 v_lshl_add_u32 v25, v29, 4, v28
 v_or_b32 v25, s88, v25
M v[136:139], a[164:167], a[52:55], v[136:139]
M v[140:143], a[164:167], a[60:63], v[140:143]
 buffer_load_dwordx4 v15, s[48:51], s22 offen offset:3072   lds
M v[140:143], a[160:163], a[56:59], v[140:143]
 s_add_u32 s22, s22, 2097152
 ds_read_b64_tr_b16 a[140:141], v2 offset:57344
 ds_read_b64_tr_b16 a[142:143], v2 offset:58368
M v[144:147], a[160:163], a[64:67], v[144:147]
M v[144:147], a[164:167], a[68:71], v[144:147]
M v[148:151], a[164:167], a[76:79], v[148:151]
M v[148:151], a[160:163], a[72:75], v[148:151]
 s_add_u32 m0, s23, 32768
M v[152:155], a[160:163], a[80:83], v[152:155]
 buffer_load_dwordx4 v8, s[16:19], s21 offen offset:0  nt lds
M v[152:155], a[164:167], a[84:87], v[152:155]
 s_waitcnt lgkmcnt(4)
M v[156:159], a[164:167], a[92:95], v[156:159]
 ds_read_b64_tr_b16 a[144:145], v3 offset:49152
 ds_read_b64_tr_b16 a[146:147], v3 offset:50176
M v[156:159], a[160:163], a[88:91], v[156:159]
M v[160:163], a[168:171], a[32:35], v[160:163]
 ds_read_b128 a[160:163], v5 offset:20480
 ds_read_b128 a[164:167], v6 offset:20480
M v[160:163], a[172:175], a[36:39], v[160:163]
M v[164:167], a[172:175], a[44:47], v[164:167]
 buffer_load_dwordx4 v9, s[16:19], s21 offen offset:1024  nt lds
M v[164:167], a[168:171], a[40:43], v[164:167]
M v[168:171], a[168:171], a[48:51], v[168:171]
M v[168:171], a[172:175], a[52:55], v[168:171]
 ds_read_b64_tr_b16 a[148:149], v3 offset:57344
 ds_read_b64_tr_b16 a[150:151], v3 offset:58368
M v[172:175], a[172:175], a[60:63], v[172:175]
M v[172:175], a[168:171], a[56:59], v[172:175]
M v[176:179], a[168:171], a[64:67], v[176:179]
M v[176:179], a[172:175], a[68:71], v[176:179]
 buffer_load_dwordx4 v10, s[16:19], s21 offen offset:2048  nt lds
M v[180:183], a[172:175], a[76:79], v[180:183]
M v[180:183], a[168:171], a[72:75], v[180:183]
M v[184:187], a[168:171], a[80:83], v[184:187]
 ds_read_b64_tr_b16 a[152:153], v4 offset:49152
 ds_read_b64_tr_b16 a[154:155], v4 offset:50176
M v[184:187], a[172:175], a[84:87], v[184:187]
 s_waitcnt lgkmcnt(4)
M v[188:191], a[172:175], a[92:95], v[188:191]
M v[188:191], a[168:171], a[88:91], v[188:191]
 buffer_load_dwordx4 v11, s[16:19], s21 offen offset:3072  nt lds
M v[192:195], a[160:163], a[32:35], v[192:195]
 s_add_u32 s21, s21, 128
 ds_read_b128 a[168:171], v5 offset:22528
 ds_read_b128 a[172:175], v6 offset:22528
M v[192:195], a[164:167], a[36:39], v[192:195]
M v[196:199], a[164:167], a[44:47], v[196:199]
M v[196:199], a[160:163], a[40:43], v[196:199]
 ds_read_b64_tr_b16 a[156:157], v4 offset:57344
 ds_read_b64_tr_b16 a[158:159], v4 offset:58368
M v[200:203], a[160:163], a[48:51], v[200:203]
 s_add_u32 m0, s87, 0
M v[200:203], a[164:167], a[52:55], v[200:203]
 buffer_load_dwordx4 v25, s[60:63], s89 offen offset:0 nt lds
M v[204:207], a[164:167], a[60:63], v[204:207]
 s_add_u32 s89, s89, 114688
M v[204:207], a[160:163], a[56:59], v[204:207]
M v[208:211], a[160:163], a[64:67], v[208:211]
M v[208:211], a[164:167], a[68:71], v[208:211]
M v[212:215], a[164:167], a[76:79], v[212:215]
M v[212:215], a[160:163], a[72:75], v[212:215]
M v[216:219], a[160:163], a[80:83], v[216:219]
M v[216:219], a[164:167], a[84:87], v[216:219]
 s_waitcnt lgkmcnt(2)
M v[220:223], a[164:167], a[92:95], v[220:223]
 s_waitcnt vmcnt(19) lgkmcnt(0)
M v[220:223], a[160:163], a[88:91], v[220:223]
 s_barrier
M v[224:227], a[168:171], a[32:35], v[224:227]
 ds_read_b128 a[160:163], v5 offset:32768
 ds_read_b128 a[164:167], v6 offset:32768
M v[224:227], a[172:175], a[36:39], v[224:227]
M v[228:231], a[172:175], a[44:47], v[228:231]
M v[228:231], a[168:171], a[40:43], v[228:231]
M v[232:235], a[168:171], a[48:51], v[232:235]
M v[232:235], a[172:175], a[52:55], v[232:235]
M v[236:239], a[172:175], a[60:63], v[236:239]
M v[236:239], a[168:171], a[56:59], v[236:239]
M v[240:243], a[168:171], a[64:67], v[240:243]
M v[240:243], a[172:175], a[68:71], v[240:243]
M v[244:247], a[172:175], a[76:79], v[244:247]
M v[244:247], a[168:171], a[72:75], v[244:247]
M v[248:251], a[168:171], a[80:83], v[248:251]
M v[248:251], a[172:175], a[84:87], v[248:251]
 s_waitcnt lgkmcnt(0)
M v[252:255], a[172:175], a[92:95], v[252:255]
M v[252:255], a[168:171], a[88:91], v[252:255]
M a[0:3], a[160:163], a[96:99], a[0:3]
 ds_read_b128 a[168:171], v5 offset:34816
 ds_read_b128 a[172:175], v6 offset:34816
M a[0:3], a[164:167], a[100:103], a[0:3]
 ds_read_b64_tr_b16 a[32:33], v1 offset:0
 ds_read_b64_tr_b16 a[34:35], v1 offset:1024
M a[4:7], a[164:167], a[108:111], a[4:7]
 s_add_u32 m0, s24, 16384
M a[4:7], a[160:163], a[104:107], a[4:7]
 buffer_load_dwordx4 v12, s[48:51], s22 offen offset:0   lds
M a[8:11], a[160:163], a[112:115], a[8:11]
M a[8:11], a[164:167], a[116:119], a[8:11]
M a[12:15], a[164:167], a[124:127], a[12:15]
 ds_read_b64_tr_b16 a[36:37], v1 offset:8192
 ds_read_b64_tr_b16 a[38:39], v1 offset:9216
M a[12:15], a[160:163], a[120:123], a[12:15]
M a[16:19], a[160:163], a[128:131], a[16:19]
 buffer_load_dwordx4 v13, s[48:51], s22 offen offset:1024   lds
M a[16:19], a[164:167], a[132:135], a[16:19]
M a[20:23], a[164:167], a[140:143], a[20:23]
M a[20:23], a[160:163], a[136:139], a[20:23]
 ds_read_b64_tr_b16 a[40:41], v2 offset:0
 ds_read_b64_tr_b16 a[42:43], v2 offset:1024
M a[24:27], a[160:163], a[144:147], a[24:27]
M a[24:27], a[164:167], a[148:151], a[24:27]
 s_waitcnt lgkmcnt(6)
M a[28:31], a[164:167], a[156:159], a[28:31]
 buffer_load_dwordx4 v14, s[48:51], s22 offen offset:2048   lds
M a[28:31], a[160:163], a[152:155], a[28:31]
M v[32:35], a[168:171], a[96:99], v[32:35]
 ds_read_b128 a[160:163], v5 offset:36864
 ds_read_b128 a[164:167], v6 offset:36864
M v[32:35], a[172:175], a[100:103], v[32:35]
 ds_read_b64_tr_b16 a[44:45], v2 offset:8192
 ds_read_b64_tr_b16 a[46:47], v2 offset:9216
M v[36:39], a[172:175], a[108:111], v[36:39]
 buffer_load_dwordx4 v15, s[48:51], s22 offen offset:3072   lds
M v[36:39], a[168:171], a[104:107], v[36:39]
 s_sub_u32 s22, s22, 2097024
M v[40:43], a[168:171], a[112:115], v[40:43]
M v[40:43], a[172:175], a[116:119], v[40:43]
 ds_read_b64_tr_b16 a[48:49], v3 offset:0
 ds_read_b64_tr_b16 a[50:51], v3 offset:1024
M v[44:47], a[172:175], a[124:127], v[44:47]
 s_add_u32 m0, s23, 49152
M v[44:47], a[168:171], a[120:123], v[44:47]
 buffer_load_dwordx4 v8, s[16:19], s21 offen offset:0  nt lds
M v[48:51], a[168:171], a[128:131], v[48:51]
M v[48:51], a[172:175], a[132:135], v[48:51]
M v[52:55], a[172:175], a[140:143], v[52:55]
 ds_read_b64_tr_b16 a[52:53], v3 offset:8192
 ds_read_b64_tr_b16 a[54:55], v3 offset:9216
M v[52:55], a[168:171], a[136:139], v[52:55]
M v[56:59], a[168:171], a[144:147], v[56:59]
 buffer_load_dwordx4 v9, s[16:19], s21 offen offset:1024  nt lds
M v[56:59], a[172:175], a[148:151], v[56:59]
 s_waitcnt lgkmcnt(6)
M v[60:63], a[172:175], a[156:159], v[60:63]
M v[60:63], a[168:171], a[152:155], v[60:63]
 ds_read_b64_tr_b16 a[56:57], v4 offset:0
 ds_read_b64_tr_b16 a[58:59], v4 offset:1024
M v[64:67], a[160:163], a[96:99], v[64:67]
 ds_read_b128 a[168:171], v5 offset:38912
 ds_read_b128 a[172:175], v6 offset:38912
M v[64:67], a[164:167], a[100:103], v[64:67]
 buffer_load_dwordx4 v10, s[16:19], s21 offen offset:2048  nt lds
M v[68:71], a[164:167], a[108:111], v[68:71]
M v[68:71], a[160:163], a[104:107], v[68:71]
M v[72:75], a[160:163], a[112:115], v[72:75]
 ds_read_b64_tr_b16 a[60:61], v4 offset:8192
 ds_read_b64_tr_b16 a[62:63], v4 offset:9216
M v[72:75], a[164:167], a[116:119], v[72:75]
M v[76:79], a[164:167], a[124:127], v[76:79]
 buffer_load_dwordx4 v11, s[16:19], s21 offen offset:3072  nt lds
M v[76:79], a[160:163], a[120:123], v[76:79]
 s_add_u32 s21, s21, 524160
M v[80:83], a[160:163], a[128:131], v[80:83]
M v[80:83], a[164:167], a[132:135], v[80:83]
M v[84:87], a[164:167], a[140:143], v[84:87]
M v[84:87], a[160:163], a[136:139], v[84:87]
M v[88:91], a[160:163], a[144:147], v[88:91]
M v[88:91], a[164:167], a[148:151], v[88:91]
 s_waitcnt lgkmcnt(2)
M v[92:95], a[164:167], a[156:159], v[92:95]
 s_waitcnt vmcnt(17) lgkmcnt(0)
M v[92:95], a[160:163], a[152:155], v[92:95]
 s_barrier
M v[96:99], a[168:171], a[96:99], v[96:99]
 ds_read_b128 a[160:163], v5 offset:49152
 ds_read_b128 a[164:167], v6 offset:49152
M v[96:99], a[172:175], a[100:103], v[96:99]
M v[100:103], a[172:175], a[108:111], v[100:103]
 s_add_u32 m0, s24, 32768
 ds_read_b64_tr_b16 a[64:65], v1 offset:16384
 ds_read_b64_tr_b16 a[66:67], v1 offset:17408
M v[100:103], a[168:171], a[104:107], v[100:103]
 buffer_load_dwordx4 v12, s[48:51], s22 offen offset:0   lds
M v[104:107], a[168:171], a[112:115], v[104:107]
 v_min_u32 v16, 40, v0
 v_lshlrev_b32 v16, 2, v16
M v[104:107], a[172:175], a[116:119], v[104:107]
 buffer_load_dword v17, v16, s[12:15], 0 offen offset:64 sc1
M v[108:111], a[172:175], a[124:127], v[108:111]
M v[108:111], a[168:171], a[120:123], v[108:111]
M v[112:115], a[168:171], a[128:131], v[112:115]
M v[112:115], a[172:175], a[132:135], v[112:115]
 ds_read_b64_tr_b16 a[68:69], v1 offset:24576
 ds_read_b64_tr_b16 a[70:71], v1 offset:25600
M v[116:119], a[172:175], a[140:143], v[116:119]
 buffer_load_dwordx4 v13, s[48:51], s22 offen offset:1024   lds
M v[116:119], a[168:171], a[136:139], v[116:119]
M v[120:123], a[168:171], a[144:147], v[120:123]
M v[120:123], a[172:175], a[148:151], v[120:123]
 s_waitcnt lgkmcnt(4)
M v[124:127], a[172:175], a[156:159], v[124:127]
M v[124:127], a[168:171], a[152:155], v[124:127]
 buffer_load_dwordx4 v14, s[48:51], s22 offen offset:2048   lds
M v[128:131], a[160:163], a[96:99], v[128:131]
 ds_read_b128 a[168:171], v5 offset:51200
 ds_read_b128 a[172:175], v6 offset:51200
M v[128:131], a[164:167], a[100:103], v[128:131]
 ds_read_b64_tr_b16 a[72:73], v2 offset:16384
 ds_read_b64_tr_b16 a[74:75], v2 offset:17408
M v[132:135], a[164:167], a[108:111], v[132:135]
M v[132:135], a[160:163], a[104:107], v[132:135]
M v[136:139], a[160:163], a[112:115], v[136:139]
M v[136:139], a[164:167], a[116:119], v[136:139]
M v[140:143], a[164:167], a[124:127], v[140:143]
 buffer_load_dwordx4 v15, s[48:51], s22 offen offset:3072   lds
M v[140:143], a[160:163], a[120:123], v[140:143]
 s_add_u32 s22, s22, 2097152
 ds_read_b64_tr_b16 a[76:77], v2 offset:24576
 ds_read_b64_tr_b16 a[78:79], v2 offset:25600
M v[144:147], a[160:163], a[128:131], v[144:147]
M v[144:147], a[164:167], a[132:135], v[144:147]
M v[148:151], a[164:167], a[140:143], v[148:151]
M v[148:151], a[160:163], a[136:139], v[148:151]
 s_add_u32 m0, s23, 0
M v[152:155], a[160:163], a[144:147], v[152:155]
 buffer_load_dwordx4 v8, s[16:19], s21 offen offset:0  nt lds
M v[152:155], a[164:167], a[148:151], v[152:155]
 s_waitcnt lgkmcnt(4)
M v[156:159], a[164:167], a[156:159], v[156:159]
 ds_read_b64_tr_b16 a[80:81], v3 offset:16384
 ds_read_b64_tr_b16 a[82:83], v3 offset:17408
M v[156:159], a[160:163], a[152:155], v[156:159]
M v[160:163], a[168:171], a[96:99], v[160:163]
 ds_read_b128 a[160:163], v5 offset:53248
 ds_read_b128 a[164:167], v6 offset:53248
M v[160:163], a[172:175], a[100:103], v[160:163]
M v[164:167], a[172:175], a[108:111], v[164:167]
 buffer_load_dwordx4 v9, s[16:19], s21 offen offset:1024  nt lds
M v[164:167], a[168:171], a[104:107], v[164:167]
M v[168:171], a[168:171], a[112:115], v[168:171]
M v[168:171], a[172:175], a[116:119], v[168:171]
 ds_read_b64_tr_b16 a[84:85], v3 offset:24576
 ds_read_b64_tr_b16 a[86:87], v3 offset:25600
M v[172:175], a[172:175], a[124:127], v[172:175]
M v[172:175], a[168:171], a[120:123], v[172:175]
M v[176:179], a[168:171], a[128:131], v[176:179]
M v[176:179], a[172:175], a[132:135], v[176:179]
 buffer_load_dwordx4 v10, s[16:19], s21 offen offset:2048  nt lds
M v[180:183], a[172:175], a[140:143], v[180:183]
M v[180:183], a[168:171], a[136:139], v[180:183]
M v[184:187], a[168:171], a[144:147], v[184:187]
 ds_read_b64_tr_b16 a[88:89], v4 offset:16384
 ds_read_b64_tr_b16 a[90:91], v4 offset:17408
M v[184:187], a[172:175], a[148:151], v[184:187]
 s_waitcnt lgkmcnt(4)
M v[188:191], a[172:175], a[156:159], v[188:191]
M v[188:191], a[168:171], a[152:155], v[188:191]
 buffer_load_dwordx4 v11, s[16:19], s21 offen offset:3072  nt lds
M v[192:195], a[160:163], a[96:99], v[192:195]
 s_add_u32 s21, s21, 128
 ds_read_b128 a[168:171], v5 offset:55296
 ds_read_b128 a[172:175], v6 offset:55296
M v[192:195], a[164:167], a[100:103], v[192:195]
M v[196:199], a[164:167], a[108:111], v[196:199]
M v[196:199], a[160:163], a[104:107], v[196:199]
 ds_read_b64_tr_b16 a[92:93], v4 offset:24576
 ds_read_b64_tr_b16 a[94:95], v4 offset:25600
M v[200:203], a[160:163], a[112:115], v[200:203]
 s_add_u32 m0, s87, 1024
M v[200:203], a[164:167], a[116:119], v[200:203]
 buffer_load_dwordx4 v25, s[60:63], s89 offen offset:0 nt lds
M v[204:207], a[164:167], a[124:127], v[204:207]
 s_add_u32 s89, s89, 114688
M v[204:207], a[160:163], a[120:123], v[204:207]
M v[208:211], a[160:163], a[128:131], v[208:211]
M v[208:211], a[164:167], a[132:135], v[208:211]
M v[212:215], a[164:167], a[140:143], v[212:215]
M v[212:215], a[160:163], a[136:139], v[212:215]
M v[216:219], a[160:163], a[144:147], v[216:219]
M v[216:219], a[164:167], a[148:151], v[216:219]
 s_waitcnt lgkmcnt(2)
M v[220:223], a[164:167], a[156:159], v[220:223]
 s_waitcnt vmcnt(19) lgkmcnt(0)
M v[220:223], a[160:163], a[152:155], v[220:223]
 s_barrier
M v[224:227], a[168:171], a[96:99], v[224:227]
 ds_read_b128 a[160:163], v5 offset:0
 ds_read_b128 a[164:167], v6 offset:0
M v[224:227], a[172:175], a[100:103], v[224:227]
M v[228:231], a[172:175], a[108:111], v[228:231]
M v[228:231], a[168:171], a[104:107], v[228:231]
M v[232:235], a[168:171], a[112:115], v[232:235]
M v[232:235], a[172:175], a[116:119], v[232:235]
M v[236:239], a[172:175], a[124:127], v[236:239]
M v[236:239], a[168:171], a[120:123], v[236:239]
M v[240:243], a[168:171], a[128:131], v[240:243]
M v[240:243], a[172:175], a[132:135], v[240:243]
M v[244:247], a[172:175], a[140:143], v[244:247]
M v[244:247], a[168:171], a[136:139], v[244:247]
M v[248:251], a[168:171], a[144:147], v[248:251]
M v[248:251], a[172:175], a[148:151], v[248:251]
 s_waitcnt lgkmcnt(0)
M v[252:255], a[172:175], a[156:159], v[252:255]
M v[252:255], a[168:171], a[152:155], v[252:255]
M a[0:3], a[160:163], a[32:35], a[0:3]
 ds_read_b128 a[168:171], v5 offset:2048
 ds_read_b128 a[172:175], v6 offset:2048
M a[0:3], a[164:167], a[36:39], a[0:3]
 ds_read_b64_tr_b16 a[96:97], v1 offset:32768
 ds_read_b64_tr_b16 a[98:99], v1 offset:33792
M a[4:7], a[164:167], a[44:47], a[4:7]
 s_add_u32 m0, s24, 49152
M a[4:7], a[160:163], a[40:43], a[4:7]
 buffer_load_dwordx4 v12, s[48:51], s22 offen offset:0   lds
M a[8:11], a[160:163], a[48:51], a[8:11]
M a[8:11], a[164:167], a[52:55], a[8:11]
M a[12:15], a[164:167], a[60:63], a[12:15]
 ds_read_b64_tr_b16 a[100:101], v1 offset:40960
 ds_read_b64_tr_b16 a[102:103], v1 offset:41984
M a[12:15], a[160:163], a[56:59], a[12:15]
M a[16:19], a[160:163], a[64:67], a[16:19]
 buffer_load_dwordx4 v13, s[48:51], s22 offen offset:1024   lds
M a[16:19], a[164:167], a[68:71], a[16:19]
M a[20:23], a[164:167], a[76:79], a[20:23]
M a[20:23], a[160:163], a[72:75], a[20:23]
 ds_read_b64_tr_b16 a[104:105], v2 offset:32768
 ds_read_b64_tr_b16 a[106:107], v2 offset:33792
M a[24:27], a[160:163], a[80:83], a[24:27]
M a[24:27], a[164:167], a[84:87], a[24:27]
 s_waitcnt lgkmcnt(6)
M a[28:31], a[164:167], a[92:95], a[28:31]
 buffer_load_dwordx4 v14, s[48:51], s22 offen offset:2048   lds
M a[28:31], a[160:163], a[88:91], a[28:31]
M v[32:35], a[168:171], a[32:35], v[32:35]
 ds_read_b128 a[160:163], v5 offset:4096
 ds_read_b128 a[164:167], v6 offset:4096
M v[32:35], a[172:175], a[36:39], v[32:35]
 ds_read_b64_tr_b16 a[108:109], v2 offset:40960
 ds_read_b64_tr_b16 a[110:111], v2 offset:41984
M v[36:39], a[172:175], a[44:47], v[36:39]
 buffer_load_dwordx4 v15, s[48:51], s22 offen offset:3072   lds
M v[36:39], a[168:171], a[40:43], v[36:39]
 s_sub_u32 s22, s22, 2097024
M v[40:43], a[168:171], a[48:51], v[40:43]
M v[40:43], a[172:175], a[52:55], v[40:43]
 ds_read_b64_tr_b16 a[112:113], v3 offset:32768
 ds_read_b64_tr_b16 a[114:115], v3 offset:33792
M v[44:47], a[172:175], a[60:63], v[44:47]
 s_add_u32 m0, s23, 16384
M v[44:47], a[168:171], a[56:59], v[44:47]
 buffer_load_dwordx4 v8, s[16:19], s21 offen offset:0  nt lds
M v[48:51], a[168:171], a[64:67], v[48:51]
M v[48:51], a[172:175], a[68:71], v[48:51]
M v[52:55], a[172:175], a[76:79], v[52:55]
 ds_read_b64_tr_b16 a[116:117], v3 offset:40960
 ds_read_b64_tr_b16 a[118:119], v3 offset:41984
M v[52:55], a[168:171], a[72:75], v[52:55]
M v[56:59], a[168:171], a[80:83], v[56:59]
 buffer_load_dwordx4 v9, s[16:19], s21 offen offset:1024  nt lds
M v[56:59], a[172:175], a[84:87], v[56:59]
 s_waitcnt lgkmcnt(6)
M v[60:63], a[172:175], a[92:95], v[60:63]
M v[60:63], a[168:171], a[88:91], v[60:63]
 ds_read_b64_tr_b16 a[120:121], v4 offset:32768
 ds_read_b64_tr_b16 a[122:123], v4 offset:33792
M v[64:67], a[160:163], a[32:35], v[64:67]
 ds_read_b128 a[168:171], v5 offset:6144
 ds_read_b128 a[172:175], v6 offset:6144
M v[64:67], a[164:167], a[36:39], v[64:67]
 buffer_load_dwordx4 v10, s[16:19], s21 offen offset:2048  nt lds
M v[68:71], a[164:167], a[44:47], v[68:71]
M v[68:71], a[160:163], a[40:43], v[68:71]
M v[72:75], a[160:163], a[48:51], v[72:75]
 ds_read_b64_tr_b16 a[124:125], v4 offset:40960
 ds_read_b64_tr_b16 a[126:127], v4 offset:41984
M v[72:75], a[164:167], a[52:55], v[72:75]
M v[76:79], a[164:167], a[60:63], v[76:79]
 buffer_load_dwordx4 v11, s[16:19], s21 offen offset:3072  nt lds
M v[76:79], a[160:163], a[56:59], v[76:79]
 s_add_u32 s21, s21, 524160
M v[80:83], a[160:163], a[64:67], v[80:83]
M v[80:83], a[164:167], a[68:71], v[80:83]
M v[84:87], a[164:167], a[76:79], v[84:87]
M v[84:87], a[160:163], a[72:75], v[84:87]
M v[88:91], a[160:163], a[80:83], v[88:91]
M v[88:91], a[164:167], a[84:87], v[88:91]
 s_waitcnt lgkmcnt(2)
M v[92:95], a[164:167], a[92:95], v[92:95]
 s_waitcnt vmcnt(18) lgkmcnt(0)
M v[92:95], a[160:163], a[88:91], v[92:95]
 s_barrier
M v[96:99], a[168:171], a[32:35], v[96:99]
 ds_read_b128 a[160:163], v5 offset:16384
 ds_read_b128 a[164:167], v6 offset:16384
M v[96:99], a[172:175], a[36:39], v[96:99]
M v[100:103], a[172:175], a[44:47], v[100:103]
 s_add_u32 m0, s24, 0
 ds_read_b64_tr_b16 a[128:129], v1 offset:49152
 ds_read_b64_tr_b16 a[130:131], v1 offset:50176
M v[100:103], a[168:171], a[40:43], v[100:103]
 buffer_load_dwordx4 v12, s[48:51], s22 offen offset:0   lds
M v[104:107], a[168:171], a[48:51], v[104:107]
M v[104:107], a[172:175], a[52:55], v[104:107]
M v[108:111], a[172:175], a[60:63], v[108:111]
M v[108:111], a[168:171], a[56:59], v[108:111]
M v[112:115], a[168:171], a[64:67], v[112:115]
M v[112:115], a[172:175], a[68:71], v[112:115]
 ds_read_b64_tr_b16 a[132:133], v1 offset:57344
 ds_read_b64_tr_b16 a[134:135], v1 offset:58368
M v[116:119], a[172:175], a[76:79], v[116:119]
 buffer_load_dwordx4 v13, s[48:51], s22 offen offset:1024   lds
M v[116:119], a[168:171], a[72:75], v[116:119]
M v[120:123], a[168:171], a[80:83], v[120:123]
M v[120:123], a[172:175], a[84:87], v[120:123]
 s_waitcnt lgkmcnt(4)
M v[124:127], a[172:175], a[92:95], v[124:127]
M v[124:127], a[168:171], a[88:91], v[124:127]
 buffer_load_dwordx4 v14, s[48:51], s22 offen offset:2048   lds
M v[128:131], a[160:163], a[32:35], v[128:131]
 ds_read_b128 a[168:171], v5 offset:18432
 ds_read_b128 a[172:175], v6 offset:18432
M v[128:131], a[164:167], a[36:39], v[128:131]
 ds_read_b64_tr_b16 a[136:137], v2 offset:49152
 ds_read_b64_tr_b16 a[138:139], v2 offset:50176
M v[132:135], a[164:167], a[44:47], v[132:135]
M v[132:135], a[160:163], a[40:43], v[132:135]
M v[136:139], a[160:163], a[48:51], v[136:139]
M v[136:139], a[164:167], a[52:55], v[136:139]
M v[140:143], a[164:167], a[60:63], v[140:143]
 buffer_load_dwordx4 v15, s[48:51], s22 offen offset:3072   lds
M v[140:143], a[160:163], a[56:59], v[140:143]
 s_add_u32 s22, s22, 2097152
 ds_read_b64_tr_b16 a[140:141], v2 offset:57344
 ds_read_b64_tr_b16 a[142:143], v2 offset:58368
M v[144:147], a[160:163], a[64:67], v[144:147]
M v[144:147], a[164:167], a[68:71], v[144:147]
M v[148:151], a[164:167], a[76:79], v[148:151]
M v[148:151], a[160:163], a[72:75], v[148:151]
 s_add_u32 m0, s23, 32768
M v[152:155], a[160:163], a[80:83], v[152:155]
 buffer_load_dwordx4 v8, s[16:19], s21 offen offset:0  nt lds
M v[152:155], a[164:167], a[84:87], v[152:155]
 s_waitcnt lgkmcnt(4)
M v[156:159], a[164:167], a[92:95], v[156:159]
 ds_read_b64_tr_b16 a[144:145], v3 offset:49152
 ds_read_b64_tr_b16 a[146:147], v3 offset:50176
M v[156:159], a[160:163], a[88:91], v[156:159]
M v[160:163], a[168:171], a[32:35], v[160:163]
 ds_read_b128 a[160:163], v5 offset:20480
 ds_read_b128 a[164:167], v6 offset:20480
M v[160:163], a[172:175], a[36:39], v[160:163]
M v[164:167], a[172:175], a[44:47], v[164:167]
 buffer_load_dwordx4 v9, s[16:19], s21 offen offset:1024  nt lds
M v[164:167], a[168:171], a[40:43], v[164:167]
M v[168:171], a[168:171], a[48:51], v[168:171]
M v[168:171], a[172:175], a[52:55], v[168:171]
 ds_read_b64_tr_b16 a[148:149], v3 offset:57344
 ds_read_b64_tr_b16 a[150:151], v3 offset:58368
M v[172:175], a[172:175], a[60:63], v[172:175]
M v[172:175], a[168:171], a[56:59], v[172:175]
M v[176:179], a[168:171], a[64:67], v[176:179]
M v[176:179], a[172:175], a[68:71], v[176:179]
 buffer_load_dwordx4 v10, s[16:19], s21 offen offset:2048  nt lds
M v[180:183], a[172:175], a[76:79], v[180:183]
M v[180:183], a[168:171], a[72:75], v[180:183]
M v[184:187], a[168:171], a[80:83], v[184:187]
 ds_read_b64_tr_b16 a[152:153], v4 offset:49152
 ds_read_b64_tr_b16 a[154:155], v4 offset:50176
M v[184:187], a[172:175], a[84:87], v[184:187]
 s_waitcnt lgkmcnt(4)
M v[188:191], a[172:175], a[92:95], v[188:191]
M v[188:191], a[168:171], a[88:91], v[188:191]
 buffer_load_dwordx4 v11, s[16:19], s21 offen offset:3072  nt lds
M v[192:195], a[160:163], a[32:35], v[192:195]
 s_add_u32 s21, s21, 128
 ds_read_b128 a[168:171], v5 offset:22528
 ds_read_b128 a[172:175], v6 offset:22528
M v[192:195], a[164:167], a[36:39], v[192:195]
M v[196:199], a[164:167], a[44:47], v[196:199]
M v[196:199], a[160:163], a[40:43], v[196:199]
 ds_read_b64_tr_b16 a[156:157], v4 offset:57344
 ds_read_b64_tr_b16 a[158:159], v4 offset:58368
M v[200:203], a[160:163], a[48:51], v[200:203]
 s_add_u32 m0, s87, 2048
M v[200:203], a[164:167], a[52:55], v[200:203]
 buffer_load_dwordx4 v25, s[60:63], s89 offen offset:0 nt lds
M v[204:207], a[164:167], a[60:63], v[204:207]
 s_add_u32 s89, s89, 114688
M v[204:207], a[160:163], a[56:59], v[204:207]
M v[208:211], a[160:163], a[64:67], v[208:211]
M v[208:211], a[164:167], a[68:71], v[208:211]
M v[212:215], a[164:167], a[76:79], v[212:215]
M v[212:215], a[160:163], a[72:75], v[212:215]
M v[216:219], a[160:163], a[80:83], v[216:219]
M v[216:219], a[164:167], a[84:87], v[216:219]
 s_waitcnt lgkmcnt(2)
M v[220:223], a[164:167], a[92:95], v[220:223]
 s_waitcnt vmcnt(18) lgkmcnt(0)
M v[220:223], a[160:163], a[88:91], v[220:223]
 s_barrier
M v[224:227], a[168:171], a[32:35], v[224:227]
 ds_read_b128 a[160:163], v5 offset:32768
 ds_read_b128 a[164:167], v6 offset:32768
M v[224:227], a[172:175], a[36:39], v[224:227]
 v_cmp_ne_u32 vcc, 1, v17
M v[228:231], a[172:175], a[44:47], v[228:231]
 s_nop 0
M v[228:231], a[168:171], a[40:43], v[228:231]
 s_cbranch_vccnz L_zs0
L_zr0:
M v[232:235], a[168:171], a[48:51], v[232:235]
 buffer_load_dword a240, v24, s[32:35], 0 offen offset:1024
M v[232:235], a[172:175], a[52:55], v[232:235]
 s_lshl_b32 s72, s30, 6
M v[236:239], a[172:175], a[60:63], v[236:239]
 s_add_u32 s72, s72, 104914944
M v[236:239], a[168:171], a[56:59], v[236:239]
M v[240:243], a[168:171], a[64:67], v[240:243]
 buffer_store_dword v19, v18, s[8:11], s72 offen sc1
M v[240:243], a[172:175], a[68:71], v[240:243]
M v[244:247], a[172:175], a[76:79], v[244:247]
M v[244:247], a[168:171], a[72:75], v[244:247]
M v[248:251], a[168:171], a[80:83], v[248:251]
M v[248:251], a[172:175], a[84:87], v[248:251]
 s_waitcnt lgkmcnt(0)
M v[252:255], a[172:175], a[92:95], v[252:255]
M v[252:255], a[168:171], a[88:91], v[252:255]
M a[0:3], a[160:163], a[96:99], a[0:3]
 ds_read_b128 a[168:171], v5 offset:34816
 ds_read_b128 a[172:175], v6 offset:34816
M a[0:3], a[164:167], a[100:103], a[0:3]
 ds_read_b64_tr_b16 a[32:33], v1 offset:0
 ds_read_b64_tr_b16 a[34:35], v1 offset:1024
M a[4:7], a[164:167], a[108:111], a[4:7]
 s_add_u32 m0, s24, 16384
M a[4:7], a[160:163], a[104:107], a[4:7]
 buffer_load_dwordx4 v12, s[48:51], s22 offen offset:0   lds
M a[8:11], a[160:163], a[112:115], a[8:11]
M a[8:11], a[164:167], a[116:119], a[8:11]
M a[12:15], a[164:167], a[124:127], a[12:15]
 ds_read_b64_tr_b16 a[36:37], v1 offset:8192
 ds_read_b64_tr_b16 a[38:39], v1 offset:9216
M a[12:15], a[160:163], a[120:123], a[12:15]
M a[16:19], a[160:163], a[128:131], a[16:19]
 buffer_load_dwordx4 v13, s[48:51], s22 offen offset:1024   lds
M a[16:19], a[164:167], a[132:135], a[16:19]
M a[20:23], a[164:167], a[140:143], a[20:23]
M a[20:23], a[160:163], a[136:139], a[20:23]
 ds_read_b64_tr_b16 a[40:41], v2 offset:0
 ds_read_b64_tr_b16 a[42:43], v2 offset:1024
M a[24:27], a[160:163], a[144:147], a[24:27]
M a[24:27], a[164:167], a[148:151], a[24:27]
 s_waitcnt lgkmcnt(6)
M a[28:31], a[164:167], a[156:159], a[28:31]
 buffer_load_dwordx4 v14, s[48:51], s22 offen offset:2048   lds
M a[28:31], a[160:163], a[152:155], a[28:31]
M v[32:35], a[168:171], a[96:99], v[32:35]
 ds_read_b128 a[160:163], v5 offset:36864
 ds_read_b128 a[164:167], v6 offset:36864
M v[32:35], a[172:175], a[100:103], v[32:35]
 ds_read_b64_tr_b16 a[44:45], v2 offset:8192
 ds_read_b64_tr_b16 a[46:47], v2 offset:9216
M v[36:39], a[172:175], a[108:111], v[36:39]
 buffer_load_dwordx4 v15, s[48:51], s22 offen offset:3072   lds
M v[36:39], a[168:171], a[104:107], v[36:39]
 s_sub_u32 s22, s22, 2097024
M v[40:43], a[168:171], a[112:115], v[40:43]
M v[40:43], a[172:175], a[116:119], v[40:43]
 ds_read_b64_tr_b16 a[48:49], v3 offset:0
 ds_read_b64_tr_b16 a[50:51], v3 offset:1024
M v[44:47], a[172:175], a[124:127], v[44:47]
 s_add_u32 m0, s23, 49152
M v[44:47], a[168:171], a[120:123], v[44:47]
 buffer_load_dwordx4 v8, s[16:19], s21 offen offset:0  nt lds
M v[48:51], a[168:171], a[128:131], v[48:51]
M v[48:51], a[172:175], a[132:135], v[48:51]
M v[52:55], a[172:175], a[140:143], v[52:55]
 ds_read_b64_tr_b16 a[52:53], v3 offset:8192
 ds_read_b64_tr_b16 a[54:55], v3 offset:9216
M v[52:55], a[168:171], a[136:139], v[52:55]
M v[56:59], a[168:171], a[144:147], v[56:59]
 buffer_load_dwordx4 v9, s[16:19], s21 offen offset:1024  nt lds
M v[56:59], a[172:175], a[148:151], v[56:59]
 s_waitcnt lgkmcnt(6)
M v[60:63], a[172:175], a[156:159], v[60:63]
M v[60:63], a[168:171], a[152:155], v[60:63]
 ds_read_b64_tr_b16 a[56:57], v4 offset:0
 ds_read_b64_tr_b16 a[58:59], v4 offset:1024
M v[64:67], a[160:163], a[96:99], v[64:67]
 ds_read_b128 a[168:171], v5 offset:38912
 ds_read_b128 a[172:175], v6 offset:38912
M v[64:67], a[164:167], a[100:103], v[64:67]
 buffer_load_dwordx4 v10, s[16:19], s21 offen offset:2048  nt lds
M v[68:71], a[164:167], a[108:111], v[68:71]
M v[68:71], a[160:163], a[104:107], v[68:71]
M v[72:75], a[160:163], a[112:115], v[72:75]
 ds_read_b64_tr_b16 a[60:61], v4 offset:8192
 ds_read_b64_tr_b16 a[62:63], v4 offset:9216
M v[72:75], a[164:167], a[116:119], v[72:75]
M v[76:79], a[164:167], a[124:127], v[76:79]
 buffer_load_dwordx4 v11, s[16:19], s21 offen offset:3072  nt lds
M v[76:79], a[160:163], a[120:123], v[76:79]
 s_add_u32 s21, s21, 524160
M v[80:83], a[160:163], a[128:131], v[80:83]
M v[80:83], a[164:167], a[132:135], v[80:83]
M v[84:87], a[164:167], a[140:143], v[84:87]
M v[84:87], a[160:163], a[136:139], v[84:87]
M v[88:91], a[160:163], a[144:147], v[88:91]
M v[88:91], a[164:167], a[148:151], v[88:91]
 s_waitcnt lgkmcnt(2)
M v[92:95], a[164:167], a[156:159], v[92:95]
 s_waitcnt vmcnt(19) lgkmcnt(0)
M v[92:95], a[160:163], a[152:155], v[92:95]
 s_barrier
M v[96:99], a[168:171], a[96:99], v[96:99]
 ds_read_b128 a[160:163], v5 offset:49152
 ds_read_b128 a[164:167], v6 offset:49152
M v[96:99], a[172:175], a[100:103], v[96:99]
M v[100:103], a[172:175], a[108:111], v[100:103]
 s_add_u32 m0, s24, 32768
 ds_read_b64_tr_b16 a[64:65], v1 offset:16384
 ds_read_b64_tr_b16 a[66:67], v1 offset:17408
M v[100:103], a[168:171], a[104:107], v[100:103]
 buffer_load_dwordx4 v12, s[48:51], s22 offen offset:0   lds
M v[104:107], a[168:171], a[112:115], v[104:107]
M v[104:107], a[172:175], a[116:119], v[104:107]
M v[108:111], a[172:175], a[124:127], v[108:111]
M v[108:111], a[168:171], a[120:123], v[108:111]
M v[112:115], a[168:171], a[128:131], v[112:115]
M v[112:115], a[172:175], a[132:135], v[112:115]
 ds_read_b64_tr_b16 a[68:69], v1 offset:24576
 ds_read_b64_tr_b16 a[70:71], v1 offset:25600
M v[116:119], a[172:175], a[140:143], v[116:119]
 buffer_load_dwordx4 v13, s[48:51], s22 offen offset:1024   lds
M v[116:119], a[168:171], a[136:139], v[116:119]
M v[120:123], a[168:171], a[144:147], v[120:123]
M v[120:123], a[172:175], a[148:151], v[120:123]
 s_waitcnt lgkmcnt(4)
M v[124:127], a[172:175], a[156:159], v[124:127]
M v[124:127], a[168:171], a[152:155], v[124:127]
 buffer_load_dwordx4 v14, s[48:51], s22 offen offset:2048   lds
M v[128:131], a[160:163], a[96:99], v[128:131]
 ds_read_b128 a[168:171], v5 offset:51200
 ds_read_b128 a[172:175], v6 offset:51200
M v[128:131], a[164:167], a[100:103], v[128:131]
 ds_read_b64_tr_b16 a[72:73], v2 offset:16384
 ds_read_b64_tr_b16 a[74:75], v2 offset:17408
M v[132:135], a[164:167], a[108:111], v[132:135]
M v[132:135], a[160:163], a[104:107], v[132:135]
M v[136:139], a[160:163], a[112:115], v[136:139]
M v[136:139], a[164:167], a[116:119], v[136:139]
M v[140:143], a[164:167], a[124:127], v[140:143]
 buffer_load_dwordx4 v15, s[48:51], s22 offen offset:3072   lds
M v[140:143], a[160:163], a[120:123], v[140:143]
 s_add_u32 s22, s22, 2097152
 ds_read_b64_tr_b16 a[76:77], v2 offset:24576
 ds_read_b64_tr_b16 a[78:79], v2 offset:25600
M v[144:147], a[160:163], a[128:131], v[144:147]
M v[144:147], a[164:167], a[132:135], v[144:147]
M v[148:151], a[164:167], a[140:143], v[148:151]
M v[148:151], a[160:163], a[136:139], v[148:151]
 s_add_u32 m0, s23, 0
M v[152:155], a[160:163], a[144:147], v[152:155]
 buffer_load_dwordx4 v8, s[16:19], s21 offen offset:0  nt lds
M v[152:155], a[164:167], a[148:151], v[152:155]
 s_waitcnt lgkmcnt(4)
M v[156:159], a[164:167], a[156:159], v[156:159]
 ds_read_b64_tr_b16 a[80:81], v3 offset:16384
 ds_read_b64_tr_b16 a[82:83], v3 offset:17408
M v[156:159], a[160:163], a[152:155], v[156:159]
M v[160:163], a[168:171], a[96:99], v[160:163]
 ds_read_b128 a[160:163], v5 offset:53248
 ds_read_b128 a[164:167], v6 offset:53248
M v[160:163], a[172:175], a[100:103], v[160:163]
M v[164:167], a[172:175], a[108:111], v[164:167]
 buffer_load_dwordx4 v9, s[16:19], s21 offen offset:1024  nt lds
M v[164:167], a[168:171], a[104:107], v[164:167]
M v[168:171], a[168:171], a[112:115], v[168:171]
M v[168:171], a[172:175], a[116:119], v[168:171]
 ds_read_b64_tr_b16 a[84:85], v3 offset:24576
 ds_read_b64_tr_b16 a[86:87], v3 offset:25600
M v[172:175], a[172:175], a[124:127], v[172:175]
M v[172:175], a[168:171], a[120:123], v[172:175]
M v[176:179], a[168:171], a[128:131], v[176:179]
M v[176:179], a[172:175], a[132:135], v[176:179]
 buffer_load_dwordx4 v10, s[16:19], s21 offen offset:2048  nt lds
M v[180:183], a[172:175], a[140:143], v[180:183]
M v[180:183], a[168:171], a[136:139], v[180:183]
M v[184:187], a[168:171], a[144:147], v[184:187]
 ds_read_b64_tr_b16 a[88:89], v4 offset:16384
 ds_read_b64_tr_b16 a[90:91], v4 offset:17408
M v[184:187], a[172:175], a[148:151], v[184:187]
 s_waitcnt lgkmcnt(4)
M v[188:191], a[172:175], a[156:159], v[188:191]
M v[188:191], a[168:171], a[152:155], v[188:191]
 buffer_load_dwordx4 v11, s[16:19], s21 offen offset:3072  nt lds
M v[192:195], a[160:163], a[96:99], v[192:195]
 s_add_u32 s21, s21, 128
 ds_read_b128 a[168:171], v5 offset:55296
 ds_read_b128 a[172:175], v6 offset:55296
M v[192:195], a[164:167], a[100:103], v[192:195]
M v[196:199], a[164:167], a[108:111], v[196:199]
M v[196:199], a[160:163], a[104:107], v[196:199]
 ds_read_b64_tr_b16 a[92:93], v4 offset:24576
 ds_read_b64_tr_b16 a[94:95], v4 offset:25600
M v[200:203], a[160:163], a[112:115], v[200:203]
 s_add_u32 m0, s87, 3072
M v[200:203], a[164:167], a[116:119], v[200:203]
 buffer_load_dwordx4 v25, s[60:63], s89 offen offset:0 nt lds
M v[204:207], a[164:167], a[124:127], v[204:207]
 s_add_u32 s89, s89, 114688
M v[204:207], a[160:163], a[120:123], v[204:207]
M v[208:211], a[160:163], a[128:131], v[208:211]
M v[208:211], a[164:167], a[132:135], v[208:211]
M v[212:215], a[164:167], a[140:143], v[212:215]
M v[212:215], a[160:163], a[136:139], v[212:215]
M v[216:219], a[160:163], a[144:147], v[216:219]
M v[216:219], a[164:167], a[148:151], v[216:219]
 s_waitcnt lgkmcnt(2)
M v[220:223], a[164:167], a[156:159], v[220:223]
 s_waitcnt vmcnt(20) lgkmcnt(0)
M v[220:223], a[160:163], a[152:155], v[220:223]
 s_barrier
M v[224:227], a[168:171], a[96:99], v[224:227]
 ds_read_b128 a[160:163], v5 offset:0
 ds_read_b128 a[164:167], v6 offset:0
M v[224:227], a[172:175], a[100:103], v[224:227]
M v[228:231], a[172:175], a[108:111], v[228:231]
M v[228:231], a[168:171], a[104:107], v[228:231]
M v[232:235], a[168:171], a[112:115], v[232:235]
M v[232:235], a[172:175], a[116:119], v[232:235]
M v[236:239], a[172:175], a[124:127], v[236:239]
M v[236:239], a[168:171], a[120:123], v[236:239]
M v[240:243], a[168:171], a[128:131], v[240:243]
M v[240:243], a[172:175], a[132:135], v[240:243]
M v[244:247], a[172:175], a[140:143], v[244:247]
M v[244:247], a[168:171], a[136:139], v[244:247]
M v[248:251], a[168:171], a[144:147], v[248:251]
M v[248:251], a[172:175], a[148:151], v[248:251]
 s_waitcnt lgkmcnt(0)
M v[252:255], a[172:175], a[156:159], v[252:255]
M v[252:255], a[168:171], a[152:155], v[252:255]
M a[0:3], a[160:163], a[32:35], a[0:3]
 ds_read_b128 a[168:171], v5 offset:2048
 ds_read_b128 a[172:175], v6 offset:2048
M a[0:3], a[164:167], a[36:39], a[0:3]
 ds_read_b64_tr_b16 a[96:97], v1 offset:32768
 ds_read_b64_tr_b16 a[98:99], v1 offset:33792
M a[4:7], a[164:167], a[44:47], a[4:7]
 s_add_u32 m0, s24, 49152
M a[4:7], a[160:163], a[40:43], a[4:7]
 buffer_load_dwordx4 v12, s[48:51], s22 offen offset:0   lds
M a[8:11], a[160:163], a[48:51], a[8:11]
M a[8:11], a[164:167], a[52:55], a[8:11]
M a[12:15], a[164:167], a[60:63], a[12:15]
 ds_read_b64_tr_b16 a[100:101], v1 offset:40960
 ds_read_b64_tr_b16 a[102:103], v1 offset:41984
M a[12:15], a[160:163], a[56:59], a[12:15]
M a[16:19], a[160:163], a[64:67], a[16:19]
 buffer_load_dwordx4 v13, s[48:51], s22 offen offset:1024   lds
M a[16:19], a[164:167], a[68:71], a[16:19]
M a[20:23], a[164:167], a[76:79], a[20:23]
M a[20:23], a[160:163], a[72:75], a[20:23]
 ds_read_b64_tr_b16 a[104:105], v2 offset:32768
 ds_read_b64_tr_b16 a[106:107], v2 offset:33792
M a[24:27], a[160:163], a[80:83], a[24:27]
M a[24:27], a[164:167], a[84:87], a[24:27]
 s_waitcnt lgkmcnt(6)
M a[28:31], a[164:167], a[92:95], a[28:31]
 buffer_load_dwordx4 v14, s[48:51], s22 offen offset:2048   lds
M a[28:31], a[160:163], a[88:91], a[28:31]
M v[32:35], a[168:171], a[32:35], v[32:35]
 ds_read_b128 a[160:163], v5 offset:4096
 ds_read_b128 a[164:167], v6 offset:4096
M v[32:35], a[172:175], a[36:39], v[32:35]
 ds_read_b64_tr_b16 a[108:109], v2 offset:40960
 ds_read_b64_tr_b16 a[110:111], v2 offset:41984
M v[36:39], a[172:175], a[44:47], v[36:39]
 buffer_load_dwordx4 v15, s[48:51], s22 offen offset:3072   lds
M v[36:39], a[168:171], a[40:43], v[36:39]
 s_sub_u32 s22, s22, 2097024
M v[40:43], a[168:171], a[48:51], v[40:43]
M v[40:43], a[172:175], a[52:55], v[40:43]
 ds_read_b64_tr_b16 a[112:113], v3 offset:32768
 ds_read_b64_tr_b16 a[114:115], v3 offset:33792
M v[44:47], a[172:175], a[60:63], v[44:47]
 s_add_u32 m0, s23, 16384
M v[44:47], a[168:171], a[56:59], v[44:47]
 buffer_load_dwordx4 v8, s[16:19], s21 offen offset:0  nt lds
M v[48:51], a[168:171], a[64:67], v[48:51]
M v[48:51], a[172:175], a[68:71], v[48:51]
M v[52:55], a[172:175], a[76:79], v[52:55]
 ds_read_b64_tr_b16 a[116:117], v3 offset:40960
 ds_read_b64_tr_b16 a[118:119], v3 offset:41984
M v[52:55], a[168:171], a[72:75], v[52:55]
M v[56:59], a[168:171], a[80:83], v[56:59]
 buffer_load_dwordx4 v9, s[16:19], s21 offen offset:1024  nt lds
M v[56:59], a[172:175], a[84:87], v[56:59]
 s_waitcnt lgkmcnt(6)
M v[60:63], a[172:175], a[92:95], v[60:63]
M v[60:63], a[168:171], a[88:91], v[60:63]
 ds_read_b64_tr_b16 a[120:121], v4 offset:32768
 ds_read_b64_tr_b16 a[122:123], v4 offset:33792
M v[64:67], a[160:163], a[32:35], v[64:67]
 ds_read_b128 a[168:171], v5 offset:6144
 ds_read_b128 a[172:175], v6 offset:6144
M v[64:67], a[164:167], a[36:39], v[64:67]
 buffer_load_dwordx4 v10, s[16:19], s21 offen offset:2048  nt lds
M v[68:71], a[164:167], a[44:47], v[68:71]
M v[68:71], a[160:163], a[40:43], v[68:71]
M v[72:75], a[160:163], a[48:51], v[72:75]
 ds_read_b64_tr_b16 a[124:125], v4 offset:40960
 ds_read_b64_tr_b16 a[126:127], v4 offset:41984
M v[72:75], a[164:167], a[52:55], v[72:75]
M v[76:79], a[164:167], a[60:63], v[76:79]
 buffer_load_dwordx4 v11, s[16:19], s21 offen offset:3072  nt lds
M v[76:79], a[160:163], a[56:59], v[76:79]
 s_add_u32 s21, s21, 524160
M v[80:83], a[160:163], a[64:67], v[80:83]
M v[80:83], a[164:167], a[68:71], v[80:83]
M v[84:87], a[164:167], a[76:79], v[84:87]
M v[84:87], a[160:163], a[72:75], v[84:87]
M v[88:91], a[160:163], a[80:83], v[88:91]
M v[88:91], a[164:167], a[84:87], v[88:91]
 s_waitcnt lgkmcnt(2)
M v[92:95], a[164:167], a[92:95], v[92:95]
 s_waitcnt vmcnt(17) lgkmcnt(0)
M v[92:95], a[160:163], a[88:91], v[92:95]
 s_barrier
M v[96:99], a[168:171], a[32:35], v[96:99]
 ds_read_b128 a[160:163], v5 offset:16384
 ds_read_b128 a[164:167], v6 offset:16384
M v[96:99], a[172:175], a[36:39], v[96:99]
M v[100:103], a[172:175], a[44:47], v[100:103]
 s_add_u32 m0, s24, 0
 ds_read_b64_tr_b16 a[128:129], v1 offset:49152
 ds_read_b64_tr_b16 a[130:131], v1 offset:50176
M v[100:103], a[168:171], a[40:43], v[100:103]
 buffer_load_dwordx4 v12, s[48:51], s22 offen offset:0   lds
M v[104:107], a[168:171], a[48:51], v[104:107]
M v[104:107], a[172:175], a[52:55], v[104:107]
M v[108:111], a[172:175], a[60:63], v[108:111]
M v[108:111], a[168:171], a[56:59], v[108:111]
M v[112:115], a[168:171], a[64:67], v[112:115]
M v[112:115], a[172:175], a[68:71], v[112:115]
 ds_read_b64_tr_b16 a[132:133], v1 offset:57344
 ds_read_b64_tr_b16 a[134:135], v1 offset:58368
M v[116:119], a[172:175], a[76:79], v[116:119]
 buffer_load_dwordx4 v13, s[48:51], s22 offen offset:1024   lds
M v[116:119], a[168:171], a[72:75], v[116:119]
M v[120:123], a[168:171], a[80:83], v[120:123]
M v[120:123], a[172:175], a[84:87], v[120:123]
 s_waitcnt lgkmcnt(4)
M v[124:127], a[172:175], a[92:95], v[124:127]
M v[124:127], a[168:171], a[88:91], v[124:127]
 buffer_load_dwordx4 v14, s[48:51], s22 offen offset:2048   lds
M v[128:131], a[160:163], a[32:35], v[128:131]
 ds_read_b128 a[168:171], v5 offset:18432
 ds_read_b128 a[172:175], v6 offset:18432
M v[128:131], a[164:167], a[36:39], v[128:131]
 ds_read_b64_tr_b16 a[136:137], v2 offset:49152
 ds_read_b64_tr_b16 a[138:139], v2 offset:50176
M v[132:135], a[164:167], a[44:47], v[132:135]
M v[132:135], a[160:163], a[40:43], v[132:135]
M v[136:139], a[160:163], a[48:51], v[136:139]
M v[136:139], a[164:167], a[52:55], v[136:139]
M v[140:143], a[164:167], a[60:63], v[140:143]
 buffer_load_dwordx4 v15, s[48:51], s22 offen offset:3072   lds
M v[140:143], a[160:163], a[56:59], v[140:143]
 s_add_u32 s22, s22, 2097152
 ds_read_b64_tr_b16 a[140:141], v2 offset:57344
 ds_read_b64_tr_b16 a[142:143], v2 offset:58368
M v[144:147], a[160:163], a[64:67], v[144:147]
M v[144:147], a[164:167], a[68:71], v[144:147]
M v[148:151], a[164:167], a[76:79], v[148:151]
M v[148:151], a[160:163], a[72:75], v[148:151]
 s_add_u32 m0, s23, 32768
M v[152:155], a[160:163], a[80:83], v[152:155]
 buffer_load_dwordx4 v8, s[16:19], s21 offen offset:0  nt lds
M v[152:155], a[164:167], a[84:87], v[152:155]
 s_waitcnt lgkmcnt(4)
M v[156:159], a[164:167], a[92:95], v[156:159]
 ds_read_b64_tr_b16 a[144:145], v3 offset:49152
 ds_read_b64_tr_b16 a[146:147], v3 offset:50176
M v[156:159], a[160:163], a[88:91], v[156:159]
M v[160:163], a[168:171], a[32:35], v[160:163]
 ds_read_b128 a[160:163], v5 offset:20480
 ds_read_b128 a[164:167], v6 offset:20480
M v[160:163], a[172:175], a[36:39], v[160:163]
M v[164:167], a[172:175], a[44:47], v[164:167]
 buffer_load_dwordx4 v9, s[16:19], s21 offen offset:1024  nt lds
M v[164:167], a[168:171], a[40:43], v[164:167]
M v[168:171], a[168:171], a[48:51], v[168:171]
M v[168:171], a[172:175], a[52:55], v[168:171]
 ds_read_b64_tr_b16 a[148:149], v3 offset:57344
 ds_read_b64_tr_b16 a[150:151], v3 offset:58368
M v[172:175], a[172:175], a[60:63], v[172:175]
M v[172:175], a[168:171], a[56:59], v[172:175]
M v[176:179], a[168:171], a[64:67], v[176:179]
M v[176:179], a[172:175], a[68:71], v[176:179]
 buffer_load_dwordx4 v10, s[16:19], s21 offen offset:2048  nt lds
M v[180:183], a[172:175], a[76:79], v[180:183]
M v[180:183], a[168:171], a[72:75], v[180:183]
M v[184:187], a[168:171], a[80:83], v[184:187]
 ds_read_b64_tr_b16 a[152:153], v4 offset:49152
 ds_read_b64_tr_b16 a[154:155], v4 offset:50176
M v[184:187], a[172:175], a[84:87], v[184:187]
 s_waitcnt lgkmcnt(4)
M v[188:191], a[172:175], a[92:95], v[188:191]
M v[188:191], a[168:171], a[88:91], v[188:191]
 buffer_load_dwordx4 v11, s[16:19], s21 offen offset:3072  nt lds
M v[192:195], a[160:163], a[32:35], v[192:195]
 s_add_u32 s21, s21, 128
 ds_read_b128 a[168:171], v5 offset:22528
 ds_read_b128 a[172:175], v6 offset:22528
M v[192:195], a[164:167], a[36:39], v[192:195]
M v[196:199], a[164:167], a[44:47], v[196:199]
M v[196:199], a[160:163], a[40:43], v[196:199]
 ds_read_b64_tr_b16 a[156:157], v4 offset:57344
 ds_read_b64_tr_b16 a[158:159], v4 offset:58368
M v[200:203], a[160:163], a[48:51], v[200:203]
 s_add_u32 m0, s87, 4096
M v[200:203], a[164:167], a[52:55], v[200:203]
 buffer_load_dwordx4 v25, s[60:63], s89 offen offset:0 nt lds
M v[204:207], a[164:167], a[60:63], v[204:207]
 s_add_u32 s89, s89, 114688
M v[204:207], a[160:163], a[56:59], v[204:207]
M v[208:211], a[160:163], a[64:67], v[208:211]
M v[208:211], a[164:167], a[68:71], v[208:211]
M v[212:215], a[164:167], a[76:79], v[212:215]
M v[212:215], a[160:163], a[72:75], v[212:215]
M v[216:219], a[160:163], a[80:83], v[216:219]
M v[216:219], a[164:167], a[84:87], v[216:219]
 s_waitcnt lgkmcnt(2)
M v[220:223], a[164:167], a[92:95], v[220:223]
 s_waitcnt vmcnt(18) lgkmcnt(0)
M v[220:223], a[160:163], a[88:91], v[220:223]
 s_barrier
M v[224:227], a[168:171], a[32:35], v[224:227]
 ds_read_b128 a[160:163], v5 offset:32768
 ds_read_b128 a[164:167], v6 offset:32768
M v[224:227], a[172:175], a[36:39], v[224:227]
 v_and_b32 v26, 48, v0
 v_lshlrev_b32 v26, 17, v26
M v[228:231], a[172:175], a[44:47], v[228:231]
 v_or_b32 v26, v26, v0
 v_lshl_add_u32 v26, v26, 7, s95
M v[228:231], a[168:171], a[40:43], v[228:231]
 buffer_load_dword a240, v26, s[76:79], 0 offen offset:0
M v[232:235], a[168:171], a[48:51], v[232:235]
M v[232:235], a[172:175], a[52:55], v[232:235]
M v[236:239], a[172:175], a[60:63], v[236:239]
M v[236:239], a[168:171], a[56:59], v[236:239]
M v[240:243], a[168:171], a[64:67], v[240:243]
M v[240:243], a[172:175], a[68:71], v[240:243]
M v[244:247], a[172:175], a[76:79], v[244:247]
M v[244:247], a[168:171], a[72:75], v[244:247]
M v[248:251], a[168:171], a[80:83], v[248:251]
M v[248:251], a[172:175], a[84:87], v[248:251]
 s_waitcnt lgkmcnt(0)
M v[252:255], a[172:175], a[92:95], v[252:255]
M v[252:255], a[168:171], a[88:91], v[252:255]
M a[0:3], a[160:163], a[96:99], a[0:3]
 ds_read_b128 a[168:171], v5 offset:34816
 ds_read_b128 a[172:175], v6 offset:34816
M a[0:3], a[164:167], a[100:103], a[0:3]
 ds_read_b64_tr_b16 a[32:33], v1 offset:0
 ds_read_b64_tr_b16 a[34:35], v1 offset:1024
M a[4:7], a[164:167], a[108:111], a[4:7]
 s_add_u32 m0, s24, 16384
M a[4:7], a[160:163], a[104:107], a[4:7]
 buffer_load_dwordx4 v12, s[48:51], s22 offen offset:0   lds
M a[8:11], a[160:163], a[112:115], a[8:11]
M a[8:11], a[164:167], a[116:119], a[8:11]
 s_lshl_b32 s67, s20, 11
M a[12:15], a[164:167], a[124:127], a[12:15]
 s_add_u32 s67, s67, 104914944
 ds_read_b64_tr_b16 a[36:37], v1 offset:8192
 ds_read_b64_tr_b16 a[38:39], v1 offset:9216
M a[12:15], a[160:163], a[120:123], a[12:15]
M a[16:19], a[160:163], a[128:131], a[16:19]
 buffer_load_dwordx4 v13, s[48:51], s22 offen offset:1024   lds
M a[16:19], a[164:167], a[132:135], a[16:19]
M a[20:23], a[164:167], a[140:143], a[20:23]
 buffer_load_dwordx4 v[16:19], v7, s[8:11], s67 offen offset:0 sc1
M a[20:23], a[160:163], a[136:139], a[20:23]
 ds_read_b64_tr_b16 a[40:41], v2 offset:0
 ds_read_b64_tr_b16 a[42:43], v2 offset:1024
M a[24:27], a[160:163], a[144:147], a[24:27]
 buffer_load_dwordx4 v[20:23], v7, s[8:11], s67 offen offset:1024 sc1
M a[24:27], a[164:167], a[148:151], a[24:27]
 s_waitcnt lgkmcnt(6)
M a[28:31], a[164:167], a[156:159], a[28:31]
 buffer_load_dwordx4 v14, s[48:51], s22 offen offset:2048   lds
M a[28:31], a[160:163], a[152:155], a[28:31]
M v[32:35], a[168:171], a[96:99], v[32:35]
 ds_read_b128 a[160:163], v5 offset:36864
 ds_read_b128 a[164:167], v6 offset:36864
M v[32:35], a[172:175], a[100:103], v[32:35]
 ds_read_b64_tr_b16 a[44:45], v2 offset:8192
 ds_read_b64_tr_b16 a[46:47], v2 offset:9216
M v[36:39], a[172:175], a[108:111], v[36:39]
 buffer_load_dwordx4 v15, s[48:51], s22 offen offset:3072   lds
M v[36:39], a[168:171], a[104:107], v[36:39]
 s_sub_u32 s22, s22, 2097024
M v[40:43], a[168:171], a[112:115], v[40:43]
M v[40:43], a[172:175], a[116:119], v[40:43]
 ds_read_b64_tr_b16 a[48:49], v3 offset:0
 ds_read_b64_tr_b16 a[50:51], v3 offset:1024
M v[44:47], a[172:175], a[124:127], v[44:47]
 s_add_u32 m0, s23, 49152
M v[44:47], a[168:171], a[120:123], v[44:47]
 buffer_load_dwordx4 v8, s[16:19], s21 offen offset:0  nt lds
M v[48:51], a[168:171], a[128:131], v[48:51]
M v[48:51], a[172:175], a[132:135], v[48:51]
M v[52:55], a[172:175], a[140:143], v[52:55]
 ds_read_b64_tr_b16 a[52:53], v3 offset:8192
 ds_read_b64_tr_b16 a[54:55], v3 offset:9216
M v[52:55], a[168:171], a[136:139], v[52:55]
M v[56:59], a[168:171], a[144:147], v[56:59]
 buffer_load_dwordx4 v9, s[16:19], s21 offen offset:1024  nt lds
M v[56:59], a[172:175], a[148:151], v[56:59]
 s_waitcnt lgkmcnt(6)
M v[60:63], a[172:175], a[156:159], v[60:63]
M v[60:63], a[168:171], a[152:155], v[60:63]
 ds_read_b64_tr_b16 a[56:57], v4 offset:0
 ds_read_b64_tr_b16 a[58:59], v4 offset:1024
M v[64:67], a[160:163], a[96:99], v[64:67]
 ds_read_b128 a[168:171], v5 offset:38912
 ds_read_b128 a[172:175], v6 offset:38912
M v[64:67], a[164:167], a[100:103], v[64:67]
 buffer_load_dwordx4 v10, s[16:19], s21 offen offset:2048  nt lds
M v[68:71], a[164:167], a[108:111], v[68:71]
M v[68:71], a[160:163], a[104:107], v[68:71]
M v[72:75], a[160:163], a[112:115], v[72:75]
 ds_read_b64_tr_b16 a[60:61], v4 offset:8192
 ds_read_b64_tr_b16 a[62:63], v4 offset:9216
M v[72:75], a[164:167], a[116:119], v[72:75]
M v[76:79], a[164:167], a[124:127], v[76:79]
 buffer_load_dwordx4 v11, s[16:19], s21 offen offset:3072  nt lds
M v[76:79], a[160:163], a[120:123], v[76:79]
 s_add_u32 s21, s21, 524160
M v[80:83], a[160:163], a[128:131], v[80:83]
M v[80:83], a[164:167], a[132:135], v[80:83]
M v[84:87], a[164:167], a[140:143], v[84:87]
M v[84:87], a[160:163], a[136:139], v[84:87]
M v[88:91], a[160:163], a[144:147], v[88:91]
M v[88:91], a[164:167], a[148:151], v[88:91]
 s_waitcnt lgkmcnt(2)
M v[92:95], a[164:167], a[156:159], v[92:95]
 s_waitcnt vmcnt(20) lgkmcnt(0)
M v[92:95], a[160:163], a[152:155], v[92:95]
 s_barrier
M v[96:99], a[168:171], a[96:99], v[96:99]
 ds_read_b128 a[160:163], v5 offset:49152
 ds_read_b128 a[164:167], v6 offset:49152
M v[96:99], a[172:175], a[100:103], v[96:99]
M v[100:103], a[172:175], a[108:111], v[100:103]
 s_add_u32 m0, s24, 32768
 ds_read_b64_tr_b16 a[64:65], v1 offset:16384
 ds_read_b64_tr_b16 a[66:67], v1 offset:17408
M v[100:103], a[168:171], a[104:107], v[100:103]
 buffer_load_dwordx4 v12, s[48:51], s22 offen offset:0   lds
M v[104:107], a[168:171], a[112:115], v[104:107]
M v[104:107], a[172:175], a[116:119], v[104:107]
M v[108:111], a[172:175], a[124:127], v[108:111]
M v[108:111], a[168:171], a[120:123], v[108:111]
M v[112:115], a[168:171], a[128:131], v[112:115]
M v[112:115], a[172:175], a[132:135], v[112:115]
 ds_read_b64_tr_b16 a[68:69], v1 offset:24576
 ds_read_b64_tr_b16 a[70:71], v1 offset:25600
M v[116:119], a[172:175], a[140:143], v[116:119]
 buffer_load_dwordx4 v13, s[48:51], s22 offen offset:1024   lds
M v[116:119], a[168:171], a[136:139], v[116:119]
M v[120:123], a[168:171], a[144:147], v[120:123]
M v[120:123], a[172:175], a[148:151], v[120:123]
 s_waitcnt lgkmcnt(4)
M v[124:127], a[172:175], a[156:159], v[124:127]
M v[124:127], a[168:171], a[152:155], v[124:127]
 buffer_load_dwordx4 v14, s[48:51], s22 offen offset:2048   lds
M v[128:131], a[160:163], a[96:99], v[128:131]
 ds_read_b128 a[168:171], v5 offset:51200
 ds_read_b128 a[172:175], v6 offset:51200
M v[128:131], a[164:167], a[100:103], v[128:131]
 ds_read_b64_tr_b16 a[72:73], v2 offset:16384
 ds_read_b64_tr_b16 a[74:75], v2 offset:17408
M v[132:135], a[164:167], a[108:111], v[132:135]
M v[132:135], a[160:163], a[104:107], v[132:135]
M v[136:139], a[160:163], a[112:115], v[136:139]
M v[136:139], a[164:167], a[116:119], v[136:139]
M v[140:143], a[164:167], a[124:127], v[140:143]
 buffer_load_dwordx4 v15, s[48:51], s22 offen offset:3072   lds
M v[140:143], a[160:163], a[120:123], v[140:143]
 s_add_u32 s22, s22, 2097152
 ds_read_b64_tr_b16 a[76:77], v2 offset:24576
 ds_read_b64_tr_b16 a[78:79], v2 offset:25600
M v[144:147], a[160:163], a[128:131], v[144:147]
M v[144:147], a[164:167], a[132:135], v[144:147]
M v[148:151], a[164:167], a[140:143], v[148:151]
M v[148:151], a[160:163], a[136:139], v[148:151]
 s_add_u32 m0, s23, 0
M v[152:155], a[160:163], a[144:147], v[152:155]
 buffer_load_dwordx4 v8, s[16:19], s21 offen offset:0  nt lds
M v[152:155], a[164:167], a[148:151], v[152:155]
 s_waitcnt lgkmcnt(4)
M v[156:159], a[164:167], a[156:159], v[156:159]
 ds_read_b64_tr_b16 a[80:81], v3 offset:16384
 ds_read_b64_tr_b16 a[82:83], v3 offset:17408
M v[156:159], a[160:163], a[152:155], v[156:159]
M v[160:163], a[168:171], a[96:99], v[160:163]
 ds_read_b128 a[160:163], v5 offset:53248
 ds_read_b128 a[164:167], v6 offset:53248
M v[160:163], a[172:175], a[100:103], v[160:163]
M v[164:167], a[172:175], a[108:111], v[164:167]
 buffer_load_dwordx4 v9, s[16:19], s21 offen offset:1024  nt lds
M v[164:167], a[168:171], a[104:107], v[164:167]
M v[168:171], a[168:171], a[112:115], v[168:171]
M v[168:171], a[172:175], a[116:119], v[168:171]
 ds_read_b64_tr_b16 a[84:85], v3 offset:24576
 ds_read_b64_tr_b16 a[86:87], v3 offset:25600
M v[172:175], a[172:175], a[124:127], v[172:175]
M v[172:175], a[168:171], a[120:123], v[172:175]
M v[176:179], a[168:171], a[128:131], v[176:179]
M v[176:179], a[172:175], a[132:135], v[176:179]
 buffer_load_dwordx4 v10, s[16:19], s21 offen offset:2048  nt lds
M v[180:183], a[172:175], a[140:143], v[180:183]
M v[180:183], a[168:171], a[136:139], v[180:183]
M v[184:187], a[168:171], a[144:147], v[184:187]
 ds_read_b64_tr_b16 a[88:89], v4 offset:16384
 ds_read_b64_tr_b16 a[90:91], v4 offset:17408
M v[184:187], a[172:175], a[148:151], v[184:187]
 s_waitcnt lgkmcnt(4)
M v[188:191], a[172:175], a[156:159], v[188:191]
M v[188:191], a[168:171], a[152:155], v[188:191]
 buffer_load_dwordx4 v11, s[16:19], s21 offen offset:3072  nt lds
M v[192:195], a[160:163], a[96:99], v[192:195]
 s_add_u32 s21, s21, 128
 ds_read_b128 a[168:171], v5 offset:55296
 ds_read_b128 a[172:175], v6 offset:55296
M v[192:195], a[164:167], a[100:103], v[192:195]
M v[196:199], a[164:167], a[108:111], v[196:199]
M v[196:199], a[160:163], a[104:107], v[196:199]
 ds_read_b64_tr_b16 a[92:93], v4 offset:24576
 ds_read_b64_tr_b16 a[94:95], v4 offset:25600
M v[200:203], a[160:163], a[112:115], v[200:203]
 s_add_u32 m0, s87, 5120
M v[200:203], a[164:167], a[116:119], v[200:203]
 buffer_load_dwordx4 v25, s[60:63], s89 offen offset:0 nt lds
M v[204:207], a[164:167], a[124:127], v[204:207]
 s_add_u32 s89, s89, 114688
M v[204:207], a[160:163], a[120:123], v[204:207]
M v[208:211], a[160:163], a[128:131], v[208:211]
M v[208:211], a[164:167], a[132:135], v[208:211]
M v[212:215], a[164:167], a[140:143], v[212:215]
M v[212:215], a[160:163], a[136:139], v[212:215]
M v[216:219], a[160:163], a[144:147], v[216:219]
M v[216:219], a[164:167], a[148:151], v[216:219]
 s_waitcnt lgkmcnt(2)
M v[220:223], a[164:167], a[156:159], v[220:223]
 s_waitcnt vmcnt(21) lgkmcnt(0)
M v[220:223], a[160:163], a[152:155], v[220:223]
 s_barrier
M v[224:227], a[168:171], a[96:99], v[224:227]
 ds_read_b128 a[160:163], v5 offset:0
 ds_read_b128 a[164:167], v6 offset:0
M v[224:227], a[172:175], a[100:103], v[224:227]
M v[228:231], a[172:175], a[108:111], v[228:231]
M v[228:231], a[168:171], a[104:107], v[228:231]
M v[232:235], a[168:171], a[112:115], v[232:235]
M v[232:235], a[172:175], a[116:119], v[232:235]
M v[236:239], a[172:175], a[124:127], v[236:239]
M v[236:239], a[168:171], a[120:123], v[236:239]
M v[240:243], a[168:171], a[128:131], v[240:243]
M v[240:243], a[172:175], a[132:135], v[240:243]
M v[244:247], a[172:175], a[140:143], v[244:247]
M v[244:247], a[168:171], a[136:139], v[244:247]
M v[248:251], a[168:171], a[144:147], v[248:251]
M v[248:251], a[172:175], a[148:151], v[248:251]
 s_waitcnt lgkmcnt(0)
M v[252:255], a[172:175], a[156:159], v[252:255]
M v[252:255], a[168:171], a[152:155], v[252:255]
M a[0:3], a[160:163], a[32:35], a[0:3]
 ds_read_b128 a[168:171], v5 offset:2048
 ds_read_b128 a[172:175], v6 offset:2048
M a[0:3], a[164:167], a[36:39], a[0:3]
 ds_read_b64_tr_b16 a[96:97], v1 offset:32768
 ds_read_b64_tr_b16 a[98:99], v1 offset:33792
M a[4:7], a[164:167], a[44:47], a[4:7]
 s_add_u32 m0, s24, 49152
M a[4:7], a[160:163], a[40:43], a[4:7]
 buffer_load_dwordx4 v12, s[48:51], s22 offen offset:0   lds
M a[8:11], a[160:163], a[48:51], a[8:11]
M a[8:11], a[164:167], a[52:55], a[8:11]
M a[12:15], a[164:167], a[60:63], a[12:15]
 ds_read_b64_tr_b16 a[100:101], v1 offset:40960
 ds_read_b64_tr_b16 a[102:103], v1 offset:41984
M a[12:15], a[160:163], a[56:59], a[12:15]
M a[16:19], a[160:163], a[64:67], a[16:19]
 buffer_load_dwordx4 v13, s[48:51], s22 offen offset:1024   lds
M a[16:19], a[164:167], a[68:71], a[16:19]
M a[20:23], a[164:167], a[76:79], a[20:23]
 s_waitcnt vmcnt(18)
 v_min3_u32 v28, v16, v17, v18
M a[20:23], a[160:163], a[72:75], a[20:23]
 ds_read_b64_tr_b16 a[104:105], v2 offset:32768
 ds_read_b64_tr_b16 a[106:107], v2 offset:33792
M a[24:27], a[160:163], a[80:83], a[24:27]
 s_waitcnt vmcnt(17)
 v_min3_u32 v28, v28, v19, v20
M a[24:27], a[164:167], a[84:87], a[24:27]
 s_waitcnt lgkmcnt(6)
 v_min3_u32 v28, v28, v21, v22
M a[28:31], a[164:167], a[92:95], a[28:31]
 buffer_load_dwordx4 v14, s[48:51], s22 offen offset:2048   lds
M a[28:31], a[160:163], a[88:91], a[28:31]
 v_min_u32 v28, v28, v23
M v[32:35], a[168:171], a[32:35], v[32:35]
 ds_read_b128 a[160:163], v5 offset:4096
 ds_read_b128 a[164:167], v6 offset:4096
M v[32:35], a[172:175], a[36:39], v[32:35]
 ds_read_b64_tr_b16 a[108:109], v2 offset:40960
 ds_read_b64_tr_b16 a[110:111], v2 offset:41984
M v[36:39], a[172:175], a[44:47], v[36:39]
 buffer_load_dwordx4 v15, s[48:51], s22 offen offset:3072   lds
M v[36:39], a[168:171], a[40:43], v[36:39]
 s_sub_u32 s22, s22, 2097024
 v_cmp_eq_u32 vcc, 0, v28
M v[40:43], a[168:171], a[48:51], v[40:43]
 s_nop 0
M v[40:43], a[172:175], a[52:55], v[40:43]
 s_cbranch_vccnz L_hs
L_hr:
 ds_read_b64_tr_b16 a[112:113], v3 offset:32768
 ds_read_b64_tr_b16 a[114:115], v3 offset:33792
M v[44:47], a[172:175], a[60:63], v[44:47]
 s_add_u32 m0, s23, 16384
 v_max_u32 v28, v16, v17
M v[44:47], a[168:171], a[56:59], v[44:47]
 buffer_load_dwordx4 v8, s[16:19], s21 offen offset:0  nt lds
M v[48:51], a[168:171], a[64:67], v[48:51]
 v_min_u32 v29, v16, v17
M v[48:51], a[172:175], a[68:71], v[48:51]
 v_med3_u32 v29, v28, v29, v18
M v[52:55], a[172:175], a[76:79], v[52:55]
 ds_read_b64_tr_b16 a[116:117], v3 offset:40960
 ds_read_b64_tr_b16 a[118:119], v3 offset:41984
M v[52:55], a[168:171], a[72:75], v[52:55]
 v_max_u32 v28, v28, v18
M v[56:59], a[168:171], a[80:83], v[56:59]
 buffer_load_dwordx4 v9, s[16:19], s21 offen offset:1024  nt lds
M v[56:59], a[172:175], a[84:87], v[56:59]
 s_waitcnt lgkmcnt(6)
 v_med3_u32 v29, v28, v29, v19
M v[60:63], a[172:175], a[92:95], v[60:63]
 v_max_u32 v28, v28, v19
M v[60:63], a[168:171], a[88:91], v[60:63]
 ds_read_b64_tr_b16 a[120:121], v4 offset:32768
 ds_read_b64_tr_b16 a[122:123], v4 offset:33792
M v[64:67], a[160:163], a[32:35], v[64:67]
 ds_read_b128 a[168:171], v5 offset:6144
 ds_read_b128 a[172:175], v6 offset:6144
M v[64:67], a[164:167], a[36:39], v[64:67]
 buffer_load_dwordx4 v10, s[16:19], s21 offen offset:2048  nt lds
M v[68:71], a[164:167], a[44:47], v[68:71]
 v_med3_u32 v29, v28, v29, v20
M v[68:71], a[160:163], a[40:43], v[68:71]
 v_max_u32 v28, v28, v20
M v[72:75], a[160:163], a[48:51], v[72:75]
 ds_read_b64_tr_b16 a[124:125], v4 offset:40960
 ds_read_b64_tr_b16 a[126:127], v4 offset:41984
M v[72:75], a[164:167], a[52:55], v[72:75]
 v_med3_u32 v29, v28, v29, v21
M v[76:79], a[164:167], a[60:63], v[76:79]
 buffer_load_dwordx4 v11, s[16:19], s21 offen offset:3072  nt lds
M v[76:79], a[160:163], a[56:59], v[76:79]
 s_add_u32 s21, s21, 524160
 v_max_u32 v28, v28, v21
M v[80:83], a[160:163], a[64:67], v[80:83]
 v_med3_u32 v29, v28, v29, v22
M v[80:83], a[164:167], a[68:71], v[80:83]
 v_max_u32 v28, v28, v22
M v[84:87], a[164:167], a[76:79], v[84:87]
 v_med3_u32 v29, v28, v29, v23
M v[84:87], a[160:163], a[72:75], v[84:87]
 v_max_u32 v28, v28, v23
M v[88:91], a[160:163], a[80:83], v[88:91]
 s_nop 0
 v_mov_b32 v30, v28 row_ror:8 row_mask:0xf bank_mask:0xf
M v[88:91], a[164:167], a[84:87], v[88:91]
 s_waitcnt lgkmcnt(2)
 v_mov_b32 v31, v29 row_ror:8 row_mask:0xf bank_mask:0xf
M v[92:95], a[164:167], a[92:95], v[92:95]
 s_waitcnt vmcnt(17) lgkmcnt(0)
 v_min_u32 v16, v28, v30
M v[92:95], a[160:163], a[88:91], v[92:95]
 s_barrier
M v[96:99], a[168:171], a[32:35], v[96:99]
 ds_read_b128 a[160:163], v5 offset:16384
 ds_read_b128 a[164:167], v6 offset:16384
M v[96:99], a[172:175], a[36:39], v[96:99]
 v_max_u32 v28, v28, v30
M v[100:103], a[172:175], a[44:47], v[100:103]
 s_add_u32 m0, s24, 0
 ds_read_b64_tr_b16 a[128:129], v1 offset:49152
 ds_read_b64_tr_b16 a[130:131], v1 offset:50176
M v[100:103], a[168:171], a[40:43], v[100:103]
 buffer_load_dwordx4 v12, s[48:51], s22 offen offset:0   lds
M v[104:107], a[168:171], a[48:51], v[104:107]
 v_max3_u32 v29, v29, v31, v16
M v[104:107], a[172:175], a[52:55], v[104:107]
 v_mov_b32 v30, v28 row_ror:4 row_mask:0xf bank_mask:0xf
M v[108:111], a[172:175], a[60:63], v[108:111]
 v_mov_b32 v31, v29 row_ror:4 row_mask:0xf bank_mask:0xf
M v[108:111], a[168:171], a[56:59], v[108:111]
 v_min_u32 v16, v28, v30
M v[112:115], a[168:171], a[64:67], v[112:115]
 v_max_u32 v28, v28, v30
M v[112:115], a[172:175], a[68:71], v[112:115]
 ds_read_b64_tr_b16 a[132:133], v1 offset:57344
 ds_read_b64_tr_b16 a[134:135], v1 offset:58368
M v[116:119], a[172:175], a[76:79], v[116:119]
 buffer_load_dwordx4 v13, s[48:51], s22 offen offset:1024   lds
M v[116:119], a[168:171], a[72:75], v[116:119]
 v_max3_u32 v29, v29, v31, v16
M v[120:123], a[168:171], a[80:83], v[120:123]
 v_mov_b32 v30, v28 row_ror:2 row_mask:0xf bank_mask:0xf
M v[120:123], a[172:175], a[84:87], v[120:123]
 s_waitcnt lgkmcnt(4)
 v_mov_b32 v31, v29 row_ror:2 row_mask:0xf bank_mask:0xf
M v[124:127], a[172:175], a[92:95], v[124:127]
 v_min_u32 v16, v28, v30
M v[124:127], a[168:171], a[88:91], v[124:127]
 buffer_load_dwordx4 v14, s[48:51], s22 offen offset:2048   lds
M v[128:131], a[160:163], a[32:35], v[128:131]
 ds_read_b128 a[168:171], v5 offset:18432
 ds_read_b128 a[172:175], v6 offset:18432
M v[128:131], a[164:167], a[36:39], v[128:131]
 ds_read_b64_tr_b16 a[136:137], v2 offset:49152
 ds_read_b64_tr_b16 a[138:139], v2 offset:50176
M v[132:135], a[164:167], a[44:47], v[132:135]
 v_max_u32 v28, v28, v30
M v[132:135], a[160:163], a[40:43], v[132:135]
 v_max3_u32 v29, v29, v31, v16
M v[136:139], a[160:163], a[48:51], v[136:139]
 v_mov_b32 v30, v28 row_ror:1 row_mask:0xf bank_mask:0xf
M v[136:139], a[164:167], a[52:55], v[136:139]
 v_mov_b32 v31, v29 row_ror:1 row_mask:0xf bank_mask:0xf
M v[140:143], a[164:167], a[60:63], v[140:143]
 buffer_load_dwordx4 v15, s[48:51], s22 offen offset:3072   lds
M v[140:143], a[160:163], a[56:59], v[140:143]
 s_add_u32 s22, s22, 2097152
 ds_read_b64_tr_b16 a[140:141], v2 offset:57344
 ds_read_b64_tr_b16 a[142:143], v2 offset:58368
M v[144:147], a[160:163], a[64:67], v[144:147]
 v_min_u32 v16, v28, v30
M v[144:147], a[164:167], a[68:71], v[144:147]
 v_max_u32 v28, v28, v30
M v[148:151], a[164:167], a[76:79], v[148:151]
 v_max3_u32 v29, v29, v31, v16
M v[148:151], a[160:163], a[72:75], v[148:151]
 s_add_u32 m0, s23, 32768
 v_mov_b32 v30, v28
M v[152:155], a[160:163], a[80:83], v[152:155]
 buffer_load_dwordx4 v8, s[16:19], s21 offen offset:0  nt lds
M v[152:155], a[164:167], a[84:87], v[152:155]
 s_waitcnt lgkmcnt(4)
 v_mov_b32 v31, v29
M v[156:159], a[164:167], a[92:95], v[156:159]
 ds_read_b64_tr_b16 a[144:145], v3 offset:49152
 ds_read_b64_tr_b16 a[146:147], v3 offset:50176
M v[156:159], a[160:163], a[88:91], v[156:159]
 v_permlane16_swap_b32 v30, v28
M v[160:163], a[168:171], a[32:35], v[160:163]
 ds_read_b128 a[160:163], v5 offset:20480
 ds_read_b128 a[164:167], v6 offset:20480
M v[160:163], a[172:175], a[36:39], v[160:163]
 v_permlane16_swap_b32 v31, v29
M v[164:167], a[172:175], a[44:47], v[164:167]
 buffer_load_dwordx4 v9, s[16:19], s21 offen offset:1024  nt lds
M v[164:167], a[168:171], a[40:43], v[164:167]
 v_min_u32 v16, v28, v30
M v[168:171], a[168:171], a[48:51], v[168:171]
 v_max_u32 v28, v28, v30
M v[168:171], a[172:175], a[52:55], v[168:171]
 ds_read_b64_tr_b16 a[148:149], v3 offset:57344
 ds_read_b64_tr_b16 a[150:151], v3 offset:58368
M v[172:175], a[172:175], a[60:63], v[172:175]
 v_max3_u32 v29, v29, v31, v16
M v[172:175], a[168:171], a[56:59], v[172:175]
 v_mov_b32 v30, v28
M v[176:179], a[168:171], a[64:67], v[176:179]
 v_mov_b32 v31, v29
M v[176:179], a[172:175], a[68:71], v[176:179]
 buffer_load_dwordx4 v10, s[16:19], s21 offen offset:2048  nt lds
M v[180:183], a[172:175], a[76:79], v[180:183]
 v_permlane32_swap_b32 v30, v28
M v[180:183], a[168:171], a[72:75], v[180:183]
 v_permlane32_swap_b32 v31, v29
M v[184:187], a[168:171], a[80:83], v[184:187]
 ds_read_b64_tr_b16 a[152:153], v4 offset:49152
 ds_read_b64_tr_b16 a[154:155], v4 offset:50176
M v[184:187], a[172:175], a[84:87], v[184:187]
 s_waitcnt lgkmcnt(4)
 v_min_u32 v16, v28, v30
M v[188:191], a[172:175], a[92:95], v[188:191]
 v_max_u32 v28, v28, v30
M v[188:191], a[168:171], a[88:91], v[188:191]
 buffer_load_dwordx4 v11, s[16:19], s21 offen offset:3072  nt lds
M v[192:195], a[160:163], a[32:35], v[192:195]
 s_add_u32 s21, s21, 128
 ds_read_b128 a[168:171], v5 offset:22528
 ds_read_b128 a[172:175], v6 offset:22528
M v[192:195], a[164:167], a[36:39], v[192:195]
 v_max3_u32 v29, v29, v31, v16
M v[196:199], a[164:167], a[44:47], v[196:199]
 s_lshl_b32 s64, s20, 3
M v[196:199], a[160:163], a[40:43], v[196:199]
 s_add_u32 s64, s64, 159744
 ds_read_b64_tr_b16 a[156:157], v4 offset:57344
 ds_read_b64_tr_b16 a[158:159], v4 offset:58368
M v[200:203], a[160:163], a[48:51], v[200:203]
 s_add_u32 m0, s87, 6144
 v_mov_b32 v16, s64
M v[200:203], a[164:167], a[52:55], v[200:203]
 buffer_load_dwordx4 v25, s[60:63], s89 offen offset:0 nt lds
M v[204:207], a[164:167], a[60:63], v[204:207]
 s_add_u32 s89, s89, 114688
 ds_write_b64 v16, v[28:29]
M v[204:207], a[160:163], a[56:59], v[204:207]
M v[208:211], a[160:163], a[64:67], v[208:211]
M v[208:211], a[164:167], a[68:71], v[208:211]
M v[212:215], a[164:167], a[76:79], v[212:215]
M v[212:215], a[160:163], a[72:75], v[212:215]
M v[216:219], a[160:163], a[80:83], v[216:219]
M v[216:219], a[164:167], a[84:87], v[216:219]
 s_waitcnt lgkmcnt(3)
M v[220:223], a[164:167], a[92:95], v[220:223]
 s_waitcnt vmcnt(18) lgkmcnt(0)
M v[220:223], a[160:163], a[88:91], v[220:223]
 s_barrier
M v[224:227], a[168:171], a[32:35], v[224:227]
 ds_read_b128 a[160:163], v5 offset:32768
 ds_read_b128 a[164:167], v6 offset:32768
M v[224:227], a[172:175], a[36:39], v[224:227]
 buffer_load_dword a240, v24, s[32:35], 0 offen offset:1536
M v[228:231], a[172:175], a[44:47], v[228:231]
M v[228:231], a[168:171], a[40:43], v[228:231]
M v[232:235], a[168:171], a[48:51], v[232:235]
M v[232:235], a[172:175], a[52:55], v[232:235]
M v[236:239], a[172:175], a[60:63], v[236:239]
M v[236:239], a[168:171], a[56:59], v[236:239]
M v[240:243], a[168:171], a[64:67], v[240:243]
M v[240:243], a[172:175], a[68:71], v[240:243]
M v[244:247], a[172:175], a[76:79], v[244:247]
M v[244:247], a[168:171], a[72:75], v[244:247]
M v[248:251], a[168:171], a[80:83], v[248:251]
M v[248:251], a[172:175], a[84:87], v[248:251]
 s_waitcnt lgkmcnt(0)
M v[252:255], a[172:175], a[92:95], v[252:255]
M v[252:255], a[168:171], a[88:91], v[252:255]
M a[0:3], a[160:163], a[96:99], a[0:3]
 ds_read_b128 a[168:171], v5 offset:34816
 ds_read_b128 a[172:175], v6 offset:34816
M a[0:3], a[164:167], a[100:103], a[0:3]
 ds_read_b64_tr_b16 a[32:33], v1 offset:0
 ds_read_b64_tr_b16 a[34:35], v1 offset:1024
M a[4:7], a[164:167], a[108:111], a[4:7]
 s_add_u32 m0, s24, 16384
M a[4:7], a[160:163], a[104:107], a[4:7]
 buffer_load_dwordx4 v12, s[48:51], s22 offen offset:0   lds
M a[8:11], a[160:163], a[112:115], a[8:11]
 v_mov_b32 v28, 159744
M a[8:11], a[164:167], a[116:119], a[8:11]
 ds_read_b128 v[16:19], v28
M a[12:15], a[164:167], a[124:127], a[12:15]
 ds_read_b64_tr_b16 a[36:37], v1 offset:8192
 ds_read_b64_tr_b16 a[38:39], v1 offset:9216
M a[12:15], a[160:163], a[120:123], a[12:15]
 ds_read_b128 v[20:23], v28 offset:16
M a[16:19], a[160:163], a[128:131], a[16:19]
 buffer_load_dwordx4 v13, s[48:51], s22 offen offset:1024   lds
M a[16:19], a[164:167], a[132:135], a[16:19]
M a[20:23], a[164:167], a[140:143], a[20:23]
M a[20:23], a[160:163], a[136:139], a[20:23]
 ds_read_b64_tr_b16 a[40:41], v2 offset:0
 ds_read_b64_tr_b16 a[42:43], v2 offset:1024
M a[24:27], a[160:163], a[144:147], a[24:27]
M a[24:27], a[164:167], a[148:151], a[24:27]
 s_waitcnt lgkmcnt(8)
M a[28:31], a[164:167], a[156:159], a[28:31]
 buffer_load_dwordx4 v14, s[48:51], s22 offen offset:2048   lds
M a[28:31], a[160:163], a[152:155], a[28:31]
M v[32:35], a[168:171], a[96:99], v[32:35]
 ds_read_b128 a[160:163], v5 offset:36864
 ds_read_b128 a[164:167], v6 offset:36864
M v[32:35], a[172:175], a[100:103], v[32:35]
 ds_read_b64_tr_b16 a[44:45], v2 offset:8192
 ds_read_b64_tr_b16 a[46:47], v2 offset:9216
M v[36:39], a[172:175], a[108:111], v[36:39]
 buffer_load_dwordx4 v15, s[48:51], s22 offen offset:3072   lds
M v[36:39], a[168:171], a[104:107], v[36:39]
 s_sub_u32 s22, s22, 2097024
 s_waitcnt lgkmcnt(9)
 v_min_u32 v28, v16, v18
M v[40:43], a[168:171], a[112:115], v[40:43]
 v_max_u32 v16, v16, v18
M v[40:43], a[172:175], a[116:119], v[40:43]
 ds_read_b64_tr_b16 a[48:49], v3 offset:0
 ds_read_b64_tr_b16 a[50:51], v3 offset:1024
M v[44:47], a[172:175], a[124:127], v[44:47]
 s_add_u32 m0, s23, 49152
 v_max3_u32 v17, v17, v19, v28
M v[44:47], a[168:171], a[120:123], v[44:47]
 buffer_load_dwordx4 v8, s[16:19], s21 offen offset:0  nt lds
M v[48:51], a[168:171], a[128:131], v[48:51]
 s_waitcnt lgkmcnt(8)
 v_min_u32 v29, v20, v22
M v[48:51], a[172:175], a[132:135], v[48:51]
 v_max_u32 v20, v20, v22
M v[52:55], a[172:175], a[140:143], v[52:55]
 ds_read_b64_tr_b16 a[52:53], v3 offset:8192
 ds_read_b64_tr_b16 a[54:55], v3 offset:9216
M v[52:55], a[168:171], a[136:139], v[52:55]
 v_max3_u32 v21, v21, v23, v29
M v[56:59], a[168:171], a[144:147], v[56:59]
 buffer_load_dwordx4 v9, s[16:19], s21 offen offset:1024  nt lds
M v[56:59], a[172:175], a[148:151], v[56:59]
 s_waitcnt lgkmcnt(6)
 v_min_u32 v28, v16, v20
M v[60:63], a[172:175], a[156:159], v[60:63]
 v_max_u32 v16, v16, v20
M v[60:63], a[168:171], a[152:155], v[60:63]
 ds_read_b64_tr_b16 a[56:57], v4 offset:0
 ds_read_b64_tr_b16 a[58:59], v4 offset:1024
M v[64:67], a[160:163], a[96:99], v[64:67]
 ds_read_b128 a[168:171], v5 offset:38912
 ds_read_b128 a[172:175], v6 offset:38912
M v[64:67], a[164:167], a[100:103], v[64:67]
 buffer_load_dwordx4 v10, s[16:19], s21 offen offset:2048  nt lds
M v[68:71], a[164:167], a[108:111], v[68:71]
 v_max3_u32 v17, v17, v21, v28
M v[68:71], a[160:163], a[104:107], v[68:71]
 v_and_b32 v28, 1, v0
M v[72:75], a[160:163], a[112:115], v[72:75]
 ds_read_b64_tr_b16 a[60:61], v4 offset:8192
 ds_read_b64_tr_b16 a[62:63], v4 offset:9216
M v[72:75], a[164:167], a[116:119], v[72:75]
 v_cmp_eq_u32 vcc, 0, v28
M v[76:79], a[164:167], a[124:127], v[76:79]
 buffer_load_dwordx4 v11, s[16:19], s21 offen offset:3072  nt lds
M v[76:79], a[160:163], a[120:123], v[76:79]
 s_add_u32 s21, s21, 524160
 s_and_b32 s64, s20, 1
M v[80:83], a[160:163], a[128:131], v[80:83]
 s_mul_i32 s64, s64, 448
 v_cndmask_b32 v24, v17, v16, vcc
M v[80:83], a[164:167], a[132:135], v[80:83]
 v_and_b32 v24, 0x7ff, v24
M v[84:87], a[164:167], a[140:143], v[84:87]
 v_sub_u32 v24, 2047, v24
M v[84:87], a[160:163], a[136:139], v[84:87]
 v_mul_u32_u24 v28, 896, v24
M v[88:91], a[160:163], a[144:147], v[88:91]
 v_lshrrev_b32 v29, 4, v0
M v[88:91], a[164:167], a[148:151], v[88:91]
 s_waitcnt lgkmcnt(2)
 v_lshl_add_u32 v28, v29, 4, v28
M v[92:95], a[164:167], a[156:159], v[92:95]
 s_waitcnt vmcnt(18) lgkmcnt(0)
 v_bfe_u32 v30, v0, 1, 3
M v[92:95], a[160:163], a[152:155], v[92:95]
 s_barrier
M v[96:99], a[168:171], a[96:99], v[96:99]
 ds_read_b128 a[160:163], v5 offset:49152
 ds_read_b128 a[164:167], v6 offset:49152
M v[96:99], a[172:175], a[100:103], v[96:99]
 v_lshl_or_b32 v28, v30, 26, v28
M v[100:103], a[172:175], a[108:111], v[100:103]
 s_add_u32 m0, s24, 32768
 ds_read_b64_tr_b16 a[64:65], v1 offset:16384
 ds_read_b64_tr_b16 a[66:67], v1 offset:17408
M v[100:103], a[168:171], a[104:107], v[100:103]
 buffer_load_dwordx4 v12, s[48:51], s22 offen offset:0   lds
M v[104:107], a[168:171], a[112:115], v[104:107]
M v[104:107], a[172:175], a[116:119], v[104:107]
M v[108:111], a[172:175], a[124:127], v[108:111]
 buffer_load_dwordx4 a[208:211], v28, s[56:59], s64 offen offset:0
M v[108:111], a[168:171], a[120:123], v[108:111]
M v[112:115], a[168:171], a[128:131], v[112:115]
 buffer_load_dwordx4 a[212:215], v28, s[56:59], s64 offen offset:64
M v[112:115], a[172:175], a[132:135], v[112:115]
 ds_read_b64_tr_b16 a[68:69], v1 offset:24576
 ds_read_b64_tr_b16 a[70:71], v1 offset:25600
M v[116:119], a[172:175], a[140:143], v[116:119]
 buffer_load_dwordx4 v13, s[48:51], s22 offen offset:1024   lds
M v[116:119], a[168:171], a[136:139], v[116:119]
M v[120:123], a[168:171], a[144:147], v[120:123]
M v[120:123], a[172:175], a[148:151], v[120:123]
 s_waitcnt lgkmcnt(4)
M v[124:127], a[172:175], a[156:159], v[124:127]
 buffer_load_dwordx4 a[216:219], v28, s[56:59], s64 offen offset:128
M v[124:127], a[168:171], a[152:155], v[124:127]
M v[128:131], a[160:163], a[96:99], v[128:131]
 ds_read_b128 a[168:171], v5 offset:51200
 ds_read_b128 a[172:175], v6 offset:51200
M v[128:131], a[164:167], a[100:103], v[128:131]
 ds_read_b64_tr_b16 a[72:73], v2 offset:16384
 ds_read_b64_tr_b16 a[74:75], v2 offset:17408
M v[132:135], a[164:167], a[108:111], v[132:135]
 buffer_load_dwordx4 v14, s[48:51], s22 offen offset:2048   lds
M v[132:135], a[160:163], a[104:107], v[132:135]
M v[136:139], a[160:163], a[112:115], v[136:139]
 buffer_load_dwordx4 a[220:223], v28, s[56:59], s64 offen offset:192
M v[136:139], a[164:167], a[116:119], v[136:139]
M v[140:143], a[164:167], a[124:127], v[140:143]
 buffer_load_dwordx4 a[224:227], v28, s[56:59], s64 offen offset:256
M v[140:143], a[160:163], a[120:123], v[140:143]
 ds_read_b64_tr_b16 a[76:77], v2 offset:24576
 ds_read_b64_tr_b16 a[78:79], v2 offset:25600
M v[144:147], a[160:163], a[128:131], v[144:147]
 buffer_load_dwordx4 v15, s[48:51], s22 offen offset:3072   lds
M v[144:147], a[164:167], a[132:135], v[144:147]
 s_add_u32 s22, s22, 2097152
M v[148:151], a[164:167], a[140:143], v[148:151]
M v[148:151], a[160:163], a[136:139], v[148:151]
 buffer_load_dwordx4 a[228:231], v28, s[56:59], s64 offen offset:320
M v[152:155], a[160:163], a[144:147], v[152:155]
M v[152:155], a[164:167], a[148:151], v[152:155]
 s_waitcnt lgkmcnt(4)
M v[156:159], a[164:167], a[156:159], v[156:159]
 s_add_u32 m0, s23, 0
 ds_read_b64_tr_b16 a[80:81], v3 offset:16384
 ds_read_b64_tr_b16 a[82:83], v3 offset:17408
M v[156:159], a[160:163], a[152:155], v[156:159]
 buffer_load_dwordx4 v8, s[16:19], s21 offen offset:0  nt lds
M v[160:163], a[168:171], a[96:99], v[160:163]
 ds_read_b128 a[160:163], v5 offset:53248
 ds_read_b128 a[164:167], v6 offset:53248
M v[160:163], a[172:175], a[100:103], v[160:163]
 buffer_load_dwordx4 a[232:235], v28, s[56:59], s64 offen offset:384
M v[164:167], a[172:175], a[108:111], v[164:167]
 v_lshrrev_b32 v28, 4, v24
M v[164:167], a[168:171], a[104:107], v[164:167]
 v_lshlrev_b32 v28, 5, v28
M v[168:171], a[168:171], a[112:115], v[168:171]
 v_and_b32 v30, 15, v24
M v[168:171], a[172:175], a[116:119], v[168:171]
 ds_read_b64_tr_b16 a[84:85], v3 offset:24576
 ds_read_b64_tr_b16 a[86:87], v3 offset:25600
M v[172:175], a[172:175], a[124:127], v[172:175]
 buffer_load_dwordx4 v9, s[16:19], s21 offen offset:1024  nt lds
M v[172:175], a[168:171], a[120:123], v[172:175]
 v_add_lshl_u32 v28, v28, v30, 2
M v[176:179], a[168:171], a[128:131], v[176:179]
 v_lshrrev_b32 v30, 1, v0
M v[176:179], a[172:175], a[132:135], v[176:179]
 v_min_u32 v30, 1, v30
M v[180:183], a[172:175], a[140:143], v[180:183]
 v_lshl_or_b32 v28, v30, 29, v28
M v[180:183], a[168:171], a[136:139], v[180:183]
 s_mov_b32 s64, 104857600
M v[184:187], a[168:171], a[144:147], v[184:187]
 ds_read_b64_tr_b16 a[88:89], v4 offset:16384
 ds_read_b64_tr_b16 a[90:91], v4 offset:17408
M v[184:187], a[172:175], a[148:151], v[184:187]
 s_waitcnt lgkmcnt(4)
M v[188:191], a[172:175], a[156:159], v[188:191]
 buffer_load_dwordx4 v10, s[16:19], s21 offen offset:2048  nt lds
M v[188:191], a[168:171], a[152:155], v[188:191]
 buffer_load_dword v23, v28, s[8:11], s64 offen sc1
M v[192:195], a[160:163], a[96:99], v[192:195]
 ds_read_b128 a[168:171], v5 offset:55296
 ds_read_b128 a[172:175], v6 offset:55296
M v[192:195], a[164:167], a[100:103], v[192:195]
 v_bfe_u32 v28, v0, 2, 2
M v[196:199], a[164:167], a[108:111], v[196:199]
 v_lshl_add_u32 v28, v29, 3, v28
M v[196:199], a[160:163], a[104:107], v[196:199]
 ds_read_b64_tr_b16 a[92:93], v4 offset:24576
 ds_read_b64_tr_b16 a[94:95], v4 offset:25600
M v[200:203], a[160:163], a[112:115], v[200:203]
 buffer_load_dwordx4 v11, s[16:19], s21 offen offset:3072  nt lds
M v[200:203], a[164:167], a[116:119], v[200:203]
 s_add_u32 s21, s21, 128
 v_lshlrev_b32 v28, 5, v28
M v[204:207], a[164:167], a[124:127], v[204:207]
 v_and_b32 v30, 3, v0
M v[204:207], a[160:163], a[120:123], v[204:207]
 v_lshl_add_u32 v28, v30, 3, v28
M v[208:211], a[160:163], a[128:131], v[208:211]
 v_add_u32 v22, s87, v28
M v[208:211], a[164:167], a[132:135], v[208:211]
M v[212:215], a[164:167], a[140:143], v[212:215]
M v[212:215], a[160:163], a[136:139], v[212:215]
M v[216:219], a[160:163], a[144:147], v[216:219]
M v[216:219], a[164:167], a[148:151], v[216:219]
 s_waitcnt lgkmcnt(2)
M v[220:223], a[164:167], a[156:159], v[220:223]
 s_waitcnt vmcnt(26) lgkmcnt(0)
M v[220:223], a[160:163], a[152:155], v[220:223]
 s_barrier
M v[224:227], a[168:171], a[96:99], v[224:227]
 ds_read_b128 a[160:163], v5 offset:0
 ds_read_b128 a[164:167], v6 offset:0
M v[224:227], a[172:175], a[100:103], v[224:227]
M v[228:231], a[172:175], a[108:111], v[228:231]
M v[228:231], a[168:171], a[104:107], v[228:231]
M v[232:235], a[168:171], a[112:115], v[232:235]
M v[232:235], a[172:175], a[116:119], v[232:235]
M v[236:239], a[172:175], a[124:127], v[236:239]
M v[236:239], a[168:171], a[120:123], v[236:239]
M v[240:243], a[168:171], a[128:131], v[240:243]
M v[240:243], a[172:175], a[132:135], v[240:243]
M v[244:247], a[172:175], a[140:143], v[244:247]
M v[244:247], a[168:171], a[136:139], v[244:247]
M v[248:251], a[168:171], a[144:147], v[248:251]
M v[248:251], a[172:175], a[148:151], v[248:251]
 s_waitcnt lgkmcnt(0)
M v[252:255], a[172:175], a[156:159], v[252:255]
M v[252:255], a[168:171], a[152:155], v[252:255]
M a[0:3], a[160:163], a[32:35], a[0:3]
 ds_read_b128 a[168:171], v5 offset:2048
 ds_read_b128 a[172:175], v6 offset:2048
M a[0:3], a[164:167], a[36:39], a[0:3]
 ds_read_b64_tr_b16 a[96:97], v1 offset:32768
 ds_read_b64_tr_b16 a[98:99], v1 offset:33792
M a[4:7], a[164:167], a[44:47], a[4:7]
 s_add_u32 m0, s24, 49152
M a[4:7], a[160:163], a[40:43], a[4:7]
 buffer_load_dwordx4 v12, s[48:51], s22 offen offset:0   lds
M a[8:11], a[160:163], a[48:51], a[8:11]
M a[8:11], a[164:167], a[52:55], a[8:11]
M a[12:15], a[164:167], a[60:63], a[12:15]
 ds_read_b64_tr_b16 a[100:101], v1 offset:40960
 ds_read_b64_tr_b16 a[102:103], v1 offset:41984
M a[12:15], a[160:163], a[56:59], a[12:15]
M a[16:19], a[160:163], a[64:67], a[16:19]
 buffer_load_dwordx4 v13, s[48:51], s22 offen offset:1024   lds
M a[16:19], a[164:167], a[68:71], a[16:19]
M a[20:23], a[164:167], a[76:79], a[20:23]
M a[20:23], a[160:163], a[72:75], a[20:23]
 ds_read_b64_tr_b16 a[104:105], v2 offset:32768
 ds_read_b64_tr_b16 a[106:107], v2 offset:33792
M a[24:27], a[160:163], a[80:83], a[24:27]
M a[24:27], a[164:167], a[84:87], a[24:27]
 s_waitcnt lgkmcnt(6)
M a[28:31], a[164:167], a[92:95], a[28:31]
 buffer_load_dwordx4 v14, s[48:51], s22 offen offset:2048   lds
M a[28:31], a[160:163], a[88:91], a[28:31]
M v[32:35], a[168:171], a[32:35], v[32:35]
 ds_read_b128 a[160:163], v5 offset:4096
 ds_read_b128 a[164:167], v6 offset:4096
M v[32:35], a[172:175], a[36:39], v[32:35]
 ds_read_b64_tr_b16 a[108:109], v2 offset:40960
 ds_read_b64_tr_b16 a[110:111], v2 offset:41984
M v[36:39], a[172:175], a[44:47], v[36:39]
 buffer_load_dwordx4 v15, s[48:51], s22 offen offset:3072   lds
M v[36:39], a[168:171], a[40:43], v[36:39]
 s_sub_u32 s22, s22, 2097024
M v[40:43], a[168:171], a[48:51], v[40:43]
M v[40:43], a[172:175], a[52:55], v[40:43]
 ds_read_b64_tr_b16 a[112:113], v3 offset:32768
 ds_read_b64_tr_b16 a[114:115], v3 offset:33792
M v[44:47], a[172:175], a[60:63], v[44:47]
 s_add_u32 m0, s23, 16384
M v[44:47], a[168:171], a[56:59], v[44:47]
 buffer_load_dwordx4 v8, s[16:19], s21 offen offset:0  nt lds
M v[48:51], a[168:171], a[64:67], v[48:51]
M v[48:51], a[172:175], a[68:71], v[48:51]
M v[52:55], a[172:175], a[76:79], v[52:55]
 ds_read_b64_tr_b16 a[116:117], v3 offset:40960
 ds_read_b64_tr_b16 a[118:119], v3 offset:41984
M v[52:55], a[168:171], a[72:75], v[52:55]
M v[56:59], a[168:171], a[80:83], v[56:59]
 buffer_load_dwordx4 v9, s[16:19], s21 offen offset:1024  nt lds
M v[56:59], a[172:175], a[84:87], v[56:59]
 s_waitcnt lgkmcnt(6)
M v[60:63], a[172:175], a[92:95], v[60:63]
M v[60:63], a[168:171], a[88:91], v[60:63]
 ds_read_b64_tr_b16 a[120:121], v4 offset:32768
 ds_read_b64_tr_b16 a[122:123], v4 offset:33792
M v[64:67], a[160:163], a[32:35], v[64:67]
 ds_read_b128 a[168:171], v5 offset:6144
 ds_read_b128 a[172:175], v6 offset:6144
M v[64:67], a[164:167], a[36:39], v[64:67]
 buffer_load_dwordx4 v10, s[16:19], s21 offen offset:2048  nt lds
M v[68:71], a[164:167], a[44:47], v[68:71]
M v[68:71], a[160:163], a[40:43], v[68:71]
M v[72:75], a[160:163], a[48:51], v[72:75]
 ds_read_b64_tr_b16 a[124:125], v4 offset:40960
 ds_read_b64_tr_b16 a[126:127], v4 offset:41984
M v[72:75], a[164:167], a[52:55], v[72:75]
M v[76:79], a[164:167], a[60:63], v[76:79]
 buffer_load_dwordx4 v11, s[16:19], s21 offen offset:3072  nt lds
M v[76:79], a[160:163], a[56:59], v[76:79]
 s_add_u32 s21, s21, 524160
M v[80:83], a[160:163], a[64:67], v[80:83]
M v[80:83], a[164:167], a[68:71], v[80:83]
M v[84:87], a[164:167], a[76:79], v[84:87]
M v[84:87], a[160:163], a[72:75], v[84:87]
M v[88:91], a[160:163], a[80:83], v[88:91]
M v[88:91], a[164:167], a[84:87], v[88:91]
 s_waitcnt lgkmcnt(2)
M v[92:95], a[164:167], a[92:95], v[92:95]
 s_waitcnt vmcnt(24) lgkmcnt(0)
M v[92:95], a[160:163], a[88:91], v[92:95]
 s_barrier
M v[96:99], a[168:171], a[32:35], v[96:99]
 ds_read_b128 a[160:163], v5 offset:16384
 ds_read_b128 a[164:167], v6 offset:16384
M v[96:99], a[172:175], a[36:39], v[96:99]
M v[100:103], a[172:175], a[44:47], v[100:103]
 s_add_u32 m0, s24, 0
 ds_read_b64_tr_b16 a[128:129], v1 offset:49152
 ds_read_b64_tr_b16 a[130:131], v1 offset:50176
M v[100:103], a[168:171], a[40:43], v[100:103]
 buffer_load_dwordx4 v12, s[48:51], s22 offen offset:0   lds
M v[104:107], a[168:171], a[48:51], v[104:107]
 ds_read_b64_tr_b16 a[176:177], v22 offset:0
M v[104:107], a[172:175], a[52:55], v[104:107]
 ds_read_b64_tr_b16 a[178:179], v22 offset:128
 ds_read_b64_tr_b16 a[180:181], v22 offset:1024
M v[108:111], a[172:175], a[60:63], v[108:111]
 ds_read_b64_tr_b16 a[182:183], v22 offset:1152
M v[108:111], a[168:171], a[56:59], v[108:111]
 ds_read_b64_tr_b16 a[184:185], v22 offset:2048
 ds_read_b64_tr_b16 a[186:187], v22 offset:2176
M v[112:115], a[168:171], a[64:67], v[112:115]
 ds_read_b64_tr_b16 a[188:189], v22 offset:3072
M v[112:115], a[172:175], a[68:71], v[112:115]
 ds_read_b64_tr_b16 a[132:133], v1 offset:57344
 ds_read_b64_tr_b16 a[134:135], v1 offset:58368
M v[116:119], a[172:175], a[76:79], v[116:119]
 buffer_load_dwordx4 v13, s[48:51], s22 offen offset:1024   lds
M v[116:119], a[168:171], a[72:75], v[116:119]
 ds_read_b64_tr_b16 a[190:191], v22 offset:3200
M v[120:123], a[168:171], a[80:83], v[120:123]
M v[120:123], a[172:175], a[84:87], v[120:123]
 s_waitcnt lgkmcnt(12)
M v[124:127], a[172:175], a[92:95], v[124:127]
M v[124:127], a[168:171], a[88:91], v[124:127]
M v[128:131], a[160:163], a[32:35], v[128:131]
 ds_read_b128 a[168:171], v5 offset:18432
 ds_read_b128 a[172:175], v6 offset:18432
M v[128:131], a[164:167], a[36:39], v[128:131]
 ds_read_b64_tr_b16 a[136:137], v2 offset:49152
 ds_read_b64_tr_b16 a[138:139], v2 offset:50176
M v[132:135], a[164:167], a[44:47], v[132:135]
 buffer_load_dwordx4 v14, s[48:51], s22 offen offset:2048   lds
M v[132:135], a[160:163], a[40:43], v[132:135]
M v[136:139], a[160:163], a[48:51], v[136:139]
M v[136:139], a[164:167], a[52:55], v[136:139]
M v[140:143], a[164:167], a[60:63], v[140:143]
M v[140:143], a[160:163], a[56:59], v[140:143]
 ds_read_b64_tr_b16 a[140:141], v2 offset:57344
 ds_read_b64_tr_b16 a[142:143], v2 offset:58368
M v[144:147], a[160:163], a[64:67], v[144:147]
 buffer_load_dwordx4 v15, s[48:51], s22 offen offset:3072   lds
M v[144:147], a[164:167], a[68:71], v[144:147]
 s_add_u32 s22, s22, 2097152
M v[148:151], a[164:167], a[76:79], v[148:151]
M v[148:151], a[160:163], a[72:75], v[148:151]
M v[152:155], a[160:163], a[80:83], v[152:155]
M v[152:155], a[164:167], a[84:87], v[152:155]
 s_waitcnt lgkmcnt(4)
M v[156:159], a[164:167], a[92:95], v[156:159]
 s_add_u32 m0, s23, 32768
 ds_read_b64_tr_b16 a[144:145], v3 offset:49152
 ds_read_b64_tr_b16 a[146:147], v3 offset:50176
M v[156:159], a[160:163], a[88:91], v[156:159]
 buffer_load_dwordx4 v8, s[16:19], s21 offen offset:0  nt lds
 s_waitcnt vmcnt(27)
M v[16:19], a[176:179], a[208:211], 0
 s_waitcnt vmcnt(26)
M v[16:19], a[180:183], a[212:215], v[16:19]
 s_waitcnt vmcnt(24)
M v[16:19], a[184:187], a[216:219], v[16:19]
 s_waitcnt vmcnt(22)
M v[16:19], a[188:191], a[220:223], v[16:19]
M v[160:163], a[168:171], a[32:35], v[160:163]
 ds_read_b128 a[160:163], v5 offset:20480
 ds_read_b128 a[164:167], v6 offset:20480
M v[160:163], a[172:175], a[36:39], v[160:163]
 ds_read_b64_tr_b16 a[176:177], v22 offset:4096
M v[164:167], a[172:175], a[44:47], v[164:167]
 ds_read_b64_tr_b16 a[178:179], v22 offset:4224
 ds_read_b64_tr_b16 a[180:181], v22 offset:5120
M v[164:167], a[168:171], a[40:43], v[164:167]
 ds_read_b64_tr_b16 a[182:183], v22 offset:5248
M v[168:171], a[168:171], a[48:51], v[168:171]
 ds_read_b64_tr_b16 a[184:185], v22 offset:6144
M v[168:171], a[172:175], a[52:55], v[168:171]
 ds_read_b64_tr_b16 a[148:149], v3 offset:57344
 ds_read_b64_tr_b16 a[150:151], v3 offset:58368
M v[172:175], a[172:175], a[60:63], v[172:175]
 buffer_load_dwordx4 v9, s[16:19], s21 offen offset:1024  nt lds
M v[172:175], a[168:171], a[56:59], v[172:175]
 ds_read_b64_tr_b16 a[186:187], v22 offset:6272
M v[176:179], a[168:171], a[64:67], v[176:179]
M v[176:179], a[172:175], a[68:71], v[176:179]
M v[180:183], a[172:175], a[76:79], v[180:183]
M v[180:183], a[168:171], a[72:75], v[180:183]
M v[184:187], a[168:171], a[80:83], v[184:187]
 ds_read_b64_tr_b16 a[152:153], v4 offset:49152
 ds_read_b64_tr_b16 a[154:155], v4 offset:50176
M v[184:187], a[172:175], a[84:87], v[184:187]
 s_waitcnt lgkmcnt(10)
M v[188:191], a[172:175], a[92:95], v[188:191]
 buffer_load_dwordx4 v10, s[16:19], s21 offen offset:2048  nt lds
M v[188:191], a[168:171], a[88:91], v[188:191]
M v[192:195], a[160:163], a[32:35], v[192:195]
 ds_read_b128 a[168:171], v5 offset:22528
 ds_read_b128 a[172:175], v6 offset:22528
M v[192:195], a[164:167], a[36:39], v[192:195]
M v[196:199], a[164:167], a[44:47], v[196:199]
M v[196:199], a[160:163], a[40:43], v[196:199]
 ds_read_b64_tr_b16 a[156:157], v4 offset:57344
 ds_read_b64_tr_b16 a[158:159], v4 offset:58368
M v[200:203], a[160:163], a[48:51], v[200:203]
 buffer_load_dwordx4 v11, s[16:19], s21 offen offset:3072  nt lds
M v[200:203], a[164:167], a[52:55], v[200:203]
 s_add_u32 s21, s21, 128
M v[204:207], a[164:167], a[60:63], v[204:207]
M v[204:207], a[160:163], a[56:59], v[204:207]
M v[208:211], a[160:163], a[64:67], v[208:211]
M v[208:211], a[164:167], a[68:71], v[208:211]
M v[212:215], a[164:167], a[76:79], v[212:215]
M v[212:215], a[160:163], a[72:75], v[212:215]
M v[216:219], a[160:163], a[80:83], v[216:219]
M v[216:219], a[164:167], a[84:87], v[216:219]
 s_waitcnt lgkmcnt(2)
M v[220:223], a[164:167], a[92:95], v[220:223]
 s_waitcnt vmcnt(16) lgkmcnt(0)
M v[220:223], a[160:163], a[88:91], v[220:223]
 s_barrier
M v[16:19], a[176:179], a[224:227], v[16:19]
M v[16:19], a[180:183], a[228:231], v[16:19]
M v[16:19], a[184:187], a[232:235], v[16:19]
M v[224:227], a[168:171], a[32:35], v[224:227]
 ds_read_b128 a[160:163], v5 offset:32768
 ds_read_b128 a[164:167], v6 offset:32768
M v[224:227], a[172:175], a[36:39], v[224:227]
M v[228:231], a[172:175], a[44:47], v[228:231]
M v[228:231], a[168:171], a[40:43], v[228:231]
M v[232:235], a[168:171], a[48:51], v[232:235]
M v[232:235], a[172:175], a[52:55], v[232:235]
M v[236:239], a[172:175], a[60:63], v[236:239]
M v[236:239], a[168:171], a[56:59], v[236:239]
M v[240:243], a[168:171], a[64:67], v[240:243]
M v[240:243], a[172:175], a[68:71], v[240:243]
M v[244:247], a[172:175], a[76:79], v[244:247]
M v[244:247], a[168:171], a[72:75], v[244:247]
M v[248:251], a[168:171], a[80:83], v[248:251]
M v[248:251], a[172:175], a[84:87], v[248:251]
 s_waitcnt lgkmcnt(0)
M v[252:255], a[172:175], a[92:95], v[252:255]
M v[252:255], a[168:171], a[88:91], v[252:255]
M a[0:3], a[160:163], a[96:99], a[0:3]
 ds_read_b128 a[168:171], v5 offset:34816
 ds_read_b128 a[172:175], v6 offset:34816
M a[0:3], a[164:167], a[100:103], a[0:3]
 ds_read_b64_tr_b16 a[32:33], v1 offset:0
 ds_read_b64_tr_b16 a[34:35], v1 offset:1024
M a[4:7], a[164:167], a[108:111], a[4:7]
 s_add_u32 m0, s24, 16384
M a[4:7], a[160:163], a[104:107], a[4:7]
 buffer_load_dwordx4 v12, s[48:51], s22 offen offset:0   lds
M a[8:11], a[160:163], a[112:115], a[8:11]
M a[8:11], a[164:167], a[116:119], a[8:11]
 s_lshl_b32 s64, s20, 10
M a[12:15], a[164:167], a[124:127], a[12:15]
 s_add_u32 s64, s64, 159744
 ds_read_b64_tr_b16 a[36:37], v1 offset:8192
 ds_read_b64_tr_b16 a[38:39], v1 offset:9216
M a[12:15], a[160:163], a[120:123], a[12:15]
 v_add_u32 v21, s64, v7
 ds_write_b128 v21, v[16:19]
M a[16:19], a[160:163], a[128:131], a[16:19]
 buffer_load_dwordx4 v13, s[48:51], s22 offen offset:1024   lds
M a[16:19], a[164:167], a[132:135], a[16:19]
 s_mul_i32 s67, s86, 14336
M a[20:23], a[164:167], a[140:143], a[20:23]
 s_mul_i32 s64, s20, 224
M a[20:23], a[160:163], a[136:139], a[20:23]
 s_add_u32 s67, s67, s64
 ds_read_b64_tr_b16 a[40:41], v2 offset:0
 ds_read_b64_tr_b16 a[42:43], v2 offset:1024
M a[24:27], a[160:163], a[144:147], a[24:27]
 v_lshrrev_b32 v28, 4, v0
 v_mul_u32_u24 v28, 896, v28
M a[24:27], a[164:167], a[148:151], a[24:27]
 s_waitcnt lgkmcnt(7)
 v_and_b32 v29, 15, v0
 v_lshl_add_u32 v28, v29, 4, v28
M a[28:31], a[164:167], a[156:159], a[28:31]
 buffer_load_dwordx4 v14, s[48:51], s22 offen offset:2048   lds
M a[28:31], a[160:163], a[152:155], a[28:31]
 v_mov_b32 v30, 536870912
 v_cmp_gt_u32 vcc, 14, v29
M v[32:35], a[168:171], a[96:99], v[32:35]
 s_nop 0
 ds_read_b128 a[160:163], v5 offset:36864
 ds_read_b128 a[164:167], v6 offset:36864
M v[32:35], a[172:175], a[100:103], v[32:35]
 s_nop 0
 ds_read_b64_tr_b16 a[44:45], v2 offset:8192
 ds_read_b64_tr_b16 a[46:47], v2 offset:9216
M v[36:39], a[172:175], a[108:111], v[36:39]
 buffer_load_dwordx4 v15, s[48:51], s22 offen offset:3072   lds
M v[36:39], a[168:171], a[104:107], v[36:39]
 s_sub_u32 s22, s22, 2097024
 v_cndmask_b32 v28, v30, v28, vcc
 v_add_u32 v29, 2560, v28
M v[40:43], a[168:171], a[112:115], v[40:43]
 v_add_u32 v30, 5120, v28
 v_add_u32 v31, 7680, v28
M v[40:43], a[172:175], a[116:119], v[40:43]
 ds_read_b64_tr_b16 a[48:49], v3 offset:0
 ds_read_b64_tr_b16 a[50:51], v3 offset:1024
M v[44:47], a[172:175], a[124:127], v[44:47]
 s_add_u32 m0, s23, 49152
M v[44:47], a[168:171], a[120:123], v[44:47]
 buffer_load_dwordx4 v8, s[16:19], s21 offen offset:0  nt lds
M v[48:51], a[168:171], a[128:131], v[48:51]
M v[48:51], a[172:175], a[132:135], v[48:51]
M v[52:55], a[172:175], a[140:143], v[52:55]
 ds_read_b64_tr_b16 a[52:53], v3 offset:8192
 ds_read_b64_tr_b16 a[54:55], v3 offset:9216
M v[52:55], a[168:171], a[136:139], v[52:55]
M v[56:59], a[168:171], a[144:147], v[56:59]
 buffer_load_dwordx4 v9, s[16:19], s21 offen offset:1024  nt lds
M v[56:59], a[172:175], a[148:151], v[56:59]
 s_waitcnt lgkmcnt(6)
M v[60:63], a[172:175], a[156:159], v[60:63]
M v[60:63], a[168:171], a[152:155], v[60:63]
 ds_read_b64_tr_b16 a[56:57], v4 offset:0
 ds_read_b64_tr_b16 a[58:59], v4 offset:1024
M v[64:67], a[160:163], a[96:99], v[64:67]
 ds_read_b128 a[168:171], v5 offset:38912
 ds_read_b128 a[172:175], v6 offset:38912
M v[64:67], a[164:167], a[100:103], v[64:67]
 buffer_load_dwordx4 v10, s[16:19], s21 offen offset:2048  nt lds
M v[68:71], a[164:167], a[108:111], v[68:71]
M v[68:71], a[160:163], a[104:107], v[68:71]
M v[72:75], a[160:163], a[112:115], v[72:75]
 ds_read_b64_tr_b16 a[60:61], v4 offset:8192
 ds_read_b64_tr_b16 a[62:63], v4 offset:9216
M v[72:75], a[164:167], a[116:119], v[72:75]
M v[76:79], a[164:167], a[124:127], v[76:79]
 buffer_load_dwordx4 v11, s[16:19], s21 offen offset:3072  nt lds
M v[76:79], a[160:163], a[120:123], v[76:79]
 s_add_u32 s21, s21, 524160
M v[80:83], a[160:163], a[128:131], v[80:83]
M v[80:83], a[164:167], a[132:135], v[80:83]
M v[84:87], a[164:167], a[140:143], v[84:87]
M v[84:87], a[160:163], a[136:139], v[84:87]
M v[88:91], a[160:163], a[144:147], v[88:91]
M v[88:91], a[164:167], a[148:151], v[88:91]
 s_waitcnt lgkmcnt(2)
M v[92:95], a[164:167], a[156:159], v[92:95]
 s_waitcnt vmcnt(16) lgkmcnt(0)
M v[92:95], a[160:163], a[152:155], v[92:95]
 s_barrier
M v[96:99], a[168:171], a[96:99], v[96:99]
 ds_read_b128 a[160:163], v5 offset:49152
 ds_read_b128 a[164:167], v6 offset:49152
M v[96:99], a[172:175], a[100:103], v[96:99]
M v[100:103], a[172:175], a[108:111], v[100:103]
 s_add_u32 m0, s24, 32768
 ds_read_b64_tr_b16 a[64:65], v1 offset:16384
 ds_read_b64_tr_b16 a[66:67], v1 offset:17408
M v[100:103], a[168:171], a[104:107], v[100:103]
 buffer_load_dwordx4 v12, s[48:51], s22 offen offset:0   lds
M v[104:107], a[168:171], a[112:115], v[104:107]
M v[104:107], a[172:175], a[116:119], v[104:107]
M v[108:111], a[172:175], a[124:127], v[108:111]
M v[108:111], a[168:171], a[120:123], v[108:111]
 buffer_load_dwordx4 v13, s[48:51], s22 offen offset:1024   lds
M v[112:115], a[168:171], a[128:131], v[112:115]
M v[112:115], a[172:175], a[132:135], v[112:115]
 ds_read_b64_tr_b16 a[68:69], v1 offset:24576
 ds_read_b64_tr_b16 a[70:71], v1 offset:25600
M v[116:119], a[172:175], a[140:143], v[116:119]
M v[116:119], a[168:171], a[136:139], v[116:119]
M v[120:123], a[168:171], a[144:147], v[120:123]
 buffer_load_dwordx4 v14, s[48:51], s22 offen offset:2048   lds
M v[120:123], a[172:175], a[148:151], v[120:123]
 s_waitcnt lgkmcnt(4)
M v[124:127], a[172:175], a[156:159], v[124:127]
M v[124:127], a[168:171], a[152:155], v[124:127]
M v[128:131], a[160:163], a[96:99], v[128:131]
 ds_read_b128 a[168:171], v5 offset:51200
 ds_read_b128 a[172:175], v6 offset:51200
M v[128:131], a[164:167], a[100:103], v[128:131]
 ds_read_b64_tr_b16 a[72:73], v2 offset:16384
 ds_read_b64_tr_b16 a[74:75], v2 offset:17408
M v[132:135], a[164:167], a[108:111], v[132:135]
 buffer_load_dwordx4 v15, s[48:51], s22 offen offset:3072   lds
M v[132:135], a[160:163], a[104:107], v[132:135]
 s_add_u32 s22, s22, 2097152
M v[136:139], a[160:163], a[112:115], v[136:139]
M v[136:139], a[164:167], a[116:119], v[136:139]
 s_add_u32 m0, s23, 0
M v[140:143], a[164:167], a[124:127], v[140:143]
 buffer_load_dwordx4 v8, s[16:19], s21 offen offset:0  nt lds
M v[140:143], a[160:163], a[120:123], v[140:143]
 ds_read_b64_tr_b16 a[76:77], v2 offset:24576
 ds_read_b64_tr_b16 a[78:79], v2 offset:25600
M v[144:147], a[160:163], a[128:131], v[144:147]
M v[144:147], a[164:167], a[132:135], v[144:147]
M v[148:151], a[164:167], a[140:143], v[148:151]
 buffer_load_dwordx4 v9, s[16:19], s21 offen offset:1024  nt lds
M v[148:151], a[160:163], a[136:139], v[148:151]
M v[152:155], a[160:163], a[144:147], v[152:155]
M v[152:155], a[164:167], a[148:151], v[152:155]
 s_waitcnt lgkmcnt(4)
M v[156:159], a[164:167], a[156:159], v[156:159]
 ds_read_b64_tr_b16 a[80:81], v3 offset:16384
 ds_read_b64_tr_b16 a[82:83], v3 offset:17408
M v[156:159], a[160:163], a[152:155], v[156:159]
 buffer_load_dwordx4 v10, s[16:19], s21 offen offset:2048  nt lds
M v[160:163], a[168:171], a[96:99], v[160:163]
 ds_read_b128 a[160:163], v5 offset:53248
 ds_read_b128 a[164:167], v6 offset:53248
M v[160:163], a[172:175], a[100:103], v[160:163]
M v[164:167], a[172:175], a[108:111], v[164:167]
M v[164:167], a[168:171], a[104:107], v[164:167]
M v[168:171], a[168:171], a[112:115], v[168:171]
 buffer_load_dwordx4 v11, s[16:19], s21 offen offset:3072  nt lds
M v[168:171], a[172:175], a[116:119], v[168:171]
 s_add_u32 s21, s21, 128
 ds_read_b64_tr_b16 a[84:85], v3 offset:24576
 ds_read_b64_tr_b16 a[86:87], v3 offset:25600
M v[172:175], a[172:175], a[124:127], v[172:175]
M v[172:175], a[168:171], a[120:123], v[172:175]
M v[176:179], a[168:171], a[128:131], v[176:179]
 s_add_u32 m0, s87, 0
M v[176:179], a[172:175], a[132:135], v[176:179]
 buffer_load_dwordx4 v28, s[68:71], s67 offen offset:0 nt lds
M v[180:183], a[172:175], a[140:143], v[180:183]
M v[180:183], a[168:171], a[136:139], v[180:183]
M v[184:187], a[168:171], a[144:147], v[184:187]
 ds_read_b64_tr_b16 a[88:89], v4 offset:16384
 ds_read_b64_tr_b16 a[90:91], v4 offset:17408
M v[184:187], a[172:175], a[148:151], v[184:187]
 s_waitcnt lgkmcnt(4)
M v[188:191], a[172:175], a[156:159], v[188:191]
 buffer_load_dwordx4 v29, s[68:71], s67 offen offset:1024 nt lds
M v[188:191], a[168:171], a[152:155], v[188:191]
M v[192:195], a[160:163], a[96:99], v[192:195]
 ds_read_b128 a[168:171], v5 offset:55296
 ds_read_b128 a[172:175], v6 offset:55296
M v[192:195], a[164:167], a[100:103], v[192:195]
M v[196:199], a[164:167], a[108:111], v[196:199]
 buffer_load_dwordx4 v30, s[68:71], s67 offen offset:2048 nt lds
M v[196:199], a[160:163], a[104:107], v[196:199]
 ds_read_b64_tr_b16 a[92:93], v4 offset:24576
 ds_read_b64_tr_b16 a[94:95], v4 offset:25600
M v[200:203], a[160:163], a[112:115], v[200:203]
M v[200:203], a[164:167], a[116:119], v[200:203]
M v[204:207], a[164:167], a[124:127], v[204:207]
M v[204:207], a[160:163], a[120:123], v[204:207]
 buffer_load_dwordx4 v31, s[68:71], s67 offen offset:3072 nt lds
M v[208:211], a[160:163], a[128:131], v[208:211]
 s_add_u32 s67, s67, 0
M v[208:211], a[164:167], a[132:135], v[208:211]
M v[212:215], a[164:167], a[140:143], v[212:215]
M v[212:215], a[160:163], a[136:139], v[212:215]
M v[216:219], a[160:163], a[144:147], v[216:219]
M v[216:219], a[164:167], a[148:151], v[216:219]
 s_waitcnt lgkmcnt(2)
M v[220:223], a[164:167], a[156:159], v[220:223]
 s_waitcnt vmcnt(20) lgkmcnt(0)
M v[220:223], a[160:163], a[152:155], v[220:223]
 s_barrier
M v[224:227], a[168:171], a[96:99], v[224:227]
 ds_read_b128 a[160:163], v5 offset:0
 ds_read_b128 a[164:167], v6 offset:0
M v[224:227], a[172:175], a[100:103], v[224:227]
M v[228:231], a[172:175], a[108:111], v[228:231]
M v[228:231], a[168:171], a[104:107], v[228:231]
M v[232:235], a[168:171], a[112:115], v[232:235]
M v[232:235], a[172:175], a[116:119], v[232:235]
M v[236:239], a[172:175], a[124:127], v[236:239]
M v[236:239], a[168:171], a[120:123], v[236:239]
M v[240:243], a[168:171], a[128:131], v[240:243]
M v[240:243], a[172:175], a[132:135], v[240:243]
M v[244:247], a[172:175], a[140:143], v[244:247]
M v[244:247], a[168:171], a[136:139], v[244:247]
M v[248:251], a[168:171], a[144:147], v[248:251]
M v[248:251], a[172:175], a[148:151], v[248:251]
 s_waitcnt lgkmcnt(0)
M v[252:255], a[172:175], a[156:159], v[252:255]
M v[252:255], a[168:171], a[152:155], v[252:255]
M a[0:3], a[160:163], a[32:35], a[0:3]
 ds_read_b128 a[168:171], v5 offset:2048
 ds_read_b128 a[172:175], v6 offset:2048
M a[0:3], a[164:167], a[36:39], a[0:3]
 ds_read_b64_tr_b16 a[96:97], v1 offset:32768
 ds_read_b64_tr_b16 a[98:99], v1 offset:33792
M a[4:7], a[164:167], a[44:47], a[4:7]
 s_add_u32 m0, s24, 49152
 v_cvt_pk_bf16_f32 v23, v23, v23
 v_accvgpr_read_b32 v27, a241
M a[4:7], a[160:163], a[40:43], a[4:7]
 buffer_load_dwordx4 v12, s[48:51], s22 offen offset:0   lds
M a[8:11], a[160:163], a[48:51], a[8:11]
 v_and_b32 v23, 0xffff0000, v23
M a[8:11], a[164:167], a[52:55], a[8:11]
 v_mul_f32 v22, 0xbfb8aa3b, v23
M a[12:15], a[164:167], a[60:63], a[12:15]
 ds_read_b64_tr_b16 a[100:101], v1 offset:40960
 ds_read_b64_tr_b16 a[102:103], v1 offset:41984
M a[12:15], a[160:163], a[56:59], a[12:15]
 v_exp_f32 v22, v22
M a[16:19], a[160:163], a[64:67], a[16:19]
 buffer_load_dwordx4 v13, s[48:51], s22 offen offset:1024   lds
M a[16:19], a[164:167], a[68:71], a[16:19]
 v_add_f32 v22, 1.0, v22
M a[20:23], a[164:167], a[76:79], a[20:23]
 v_rcp_f32 v23, v22
M a[20:23], a[160:163], a[72:75], a[20:23]
 s_or_b32 s64, s86, s20
 ds_read_b64_tr_b16 a[104:105], v2 offset:32768
 ds_read_b64_tr_b16 a[106:107], v2 offset:33792
M a[24:27], a[160:163], a[80:83], a[24:27]
 s_min_u32 s64, s64, 1
 s_lshl_b32 s64, s64, 29
 v_lshrrev_b32 v22, 1, v0
M a[24:27], a[164:167], a[84:87], a[24:27]
 s_waitcnt lgkmcnt(6)
 v_min_u32 v22, 1, v22
M a[28:31], a[164:167], a[92:95], a[28:31]
 buffer_load_dwordx4 v14, s[48:51], s22 offen offset:2048   lds
M a[28:31], a[160:163], a[88:91], a[28:31]
 v_lshlrev_b32 v22, 29, v22
M v[32:35], a[168:171], a[32:35], v[32:35]
 ds_read_b128 a[160:163], v5 offset:4096
 ds_read_b128 a[164:167], v6 offset:4096
M v[32:35], a[172:175], a[36:39], v[32:35]
 ds_read_b64_tr_b16 a[108:109], v2 offset:40960
 ds_read_b64_tr_b16 a[110:111], v2 offset:41984
M v[36:39], a[172:175], a[44:47], v[36:39]
 buffer_load_dwordx4 v15, s[48:51], s22 offen offset:3072   lds
M v[36:39], a[168:171], a[40:43], v[36:39]
 s_sub_u32 s22, s22, 2097024
 v_lshl_or_b32 v22, v0, 2, v22
M v[40:43], a[168:171], a[48:51], v[40:43]
 v_or_b32 v22, s64, v22
M v[40:43], a[172:175], a[52:55], v[40:43]
 ds_read_b64_tr_b16 a[112:113], v3 offset:32768
 ds_read_b64_tr_b16 a[114:115], v3 offset:33792
M v[44:47], a[172:175], a[60:63], v[44:47]
 s_add_u32 m0, s23, 16384
 v_cvt_pk_bf16_f32 v23, v23, v23
M v[44:47], a[168:171], a[56:59], v[44:47]
 buffer_load_dwordx4 v8, s[16:19], s21 offen offset:0  nt lds
M v[48:51], a[168:171], a[64:67], v[48:51]
 v_and_b32 v23, 0xffff0000, v23
M v[48:51], a[172:175], a[68:71], v[48:51]
 s_mov_b32 s64, 104890368
M v[52:55], a[172:175], a[76:79], v[52:55]
 ds_read_b64_tr_b16 a[116:117], v3 offset:40960
 ds_read_b64_tr_b16 a[118:119], v3 offset:41984
M v[52:55], a[168:171], a[72:75], v[52:55]
 buffer_store_dword v24, v22, s[8:11], s64 offen sc1
M v[56:59], a[168:171], a[80:83], v[56:59]
 buffer_load_dwordx4 v9, s[16:19], s21 offen offset:1024  nt lds
M v[56:59], a[172:175], a[84:87], v[56:59]
 s_waitcnt lgkmcnt(6)
M v[60:63], a[172:175], a[92:95], v[60:63]
 buffer_store_dword v23, v22, s[8:11], s64 offen offset:8 sc1
M v[60:63], a[168:171], a[88:91], v[60:63]
 ds_read_b64_tr_b16 a[120:121], v4 offset:32768
 ds_read_b64_tr_b16 a[122:123], v4 offset:33792
M v[64:67], a[160:163], a[32:35], v[64:67]
 ds_read_b128 a[168:171], v5 offset:6144
 ds_read_b128 a[172:175], v6 offset:6144
M v[64:67], a[164:167], a[36:39], v[64:67]
 buffer_load_dwordx4 v10, s[16:19], s21 offen offset:2048  nt lds
M v[68:71], a[164:167], a[44:47], v[68:71]
 v_add_u32 v25, 159744, v7
M v[68:71], a[160:163], a[40:43], v[68:71]
 ds_read_b128 v[16:19], v25
M v[72:75], a[160:163], a[48:51], v[72:75]
 ds_read_b64_tr_b16 a[124:125], v4 offset:40960
 ds_read_b64_tr_b16 a[126:127], v4 offset:41984
M v[72:75], a[164:167], a[52:55], v[72:75]
 ds_read_b128 v[28:31], v25 offset:1024
 v_sub_f32 v48, v48, v27
M v[76:79], a[164:167], a[60:63], v[76:79]
 buffer_load_dwordx4 v11, s[16:19], s21 offen offset:3072  nt lds
M v[76:79], a[160:163], a[56:59], v[76:79]
 s_add_u32 s21, s21, 524160
 ds_read_b128 v[20:23], v25 offset:2048
 v_sub_f32 v49, v49, v27
M v[80:83], a[160:163], a[64:67], v[80:83]
 v_sub_f32 v50, v50, v27
 v_sub_f32 v51, v51, v27
M v[80:83], a[164:167], a[68:71], v[80:83]
 v_sub_f32 v52, v52, v27
 v_sub_f32 v53, v53, v27
M v[84:87], a[164:167], a[76:79], v[84:87]
 v_sub_f32 v54, v54, v27
 v_sub_f32 v55, v55, v27
M v[84:87], a[160:163], a[72:75], v[84:87]
 v_sub_f32 v56, v56, v27
 v_sub_f32 v57, v57, v27
M v[88:91], a[160:163], a[80:83], v[88:91]
 v_sub_f32 v58, v58, v27
 v_sub_f32 v59, v59, v27
M v[88:91], a[164:167], a[84:87], v[88:91]
 s_waitcnt lgkmcnt(5)
 v_sub_f32 v60, v60, v27
 v_sub_f32 v61, v61, v27
M v[92:95], a[164:167], a[92:95], v[92:95]
 s_waitcnt vmcnt(22) lgkmcnt(0)
 v_sub_f32 v62, v62, v27
 v_sub_f32 v63, v63, v27
M v[92:95], a[160:163], a[88:91], v[92:95]
 s_barrier
M v[96:99], a[168:171], a[32:35], v[96:99]
 ds_read_b128 a[160:163], v5 offset:16384
 ds_read_b128 a[164:167], v6 offset:16384
M v[96:99], a[172:175], a[36:39], v[96:99]
 v_add_f32 v16, v28, v16
M v[100:103], a[172:175], a[44:47], v[100:103]
 s_add_u32 m0, s24, 0
 ds_read_b64_tr_b16 a[128:129], v1 offset:49152
 ds_read_b64_tr_b16 a[130:131], v1 offset:50176
M v[100:103], a[168:171], a[40:43], v[100:103]
 buffer_load_dwordx4 v12, s[48:51], s22 offen offset:0   lds
M v[104:107], a[168:171], a[48:51], v[104:107]
 v_add_f32 v17, v29, v17
 v_sub_f32 v80, v80, v27
M v[104:107], a[172:175], a[52:55], v[104:107]
 v_add_f32 v18, v30, v18
 v_sub_f32 v81, v81, v27
M v[108:111], a[172:175], a[60:63], v[108:111]
 v_add_f32 v19, v31, v19
 v_sub_f32 v82, v82, v27
M v[108:111], a[168:171], a[56:59], v[108:111]
 ds_read_b128 v[28:31], v25 offset:3072
 v_sub_f32 v83, v83, v27
M v[112:115], a[168:171], a[64:67], v[112:115]
 v_cvt_pk_bf16_f32 v25, v16, v17
 v_sub_f32 v84, v84, v27
M v[112:115], a[172:175], a[68:71], v[112:115]
 ds_read_b64_tr_b16 a[132:133], v1 offset:57344
 ds_read_b64_tr_b16 a[134:135], v1 offset:58368
M v[116:119], a[172:175], a[76:79], v[116:119]
 buffer_load_dwordx4 v13, s[48:51], s22 offen offset:1024   lds
M v[116:119], a[168:171], a[72:75], v[116:119]
 v_lshlrev_b32 v16, 16, v25
 v_sub_f32 v85, v85, v27
M v[120:123], a[168:171], a[80:83], v[120:123]
 v_and_b32 v17, 0xffff0000, v25
 v_sub_f32 v86, v86, v27
M v[120:123], a[172:175], a[84:87], v[120:123]
 s_waitcnt lgkmcnt(5)
 v_cvt_pk_bf16_f32 v25, v18, v19
 v_sub_f32 v87, v87, v27
M v[124:127], a[172:175], a[92:95], v[124:127]
 v_lshlrev_b32 v18, 16, v25
 v_sub_f32 v88, v88, v27
M v[124:127], a[168:171], a[88:91], v[124:127]
 v_and_b32 v19, 0xffff0000, v25
 v_sub_f32 v89, v89, v27
M v[128:131], a[160:163], a[32:35], v[128:131]
 ds_read_b128 a[168:171], v5 offset:18432
 ds_read_b128 a[172:175], v6 offset:18432
M v[128:131], a[164:167], a[36:39], v[128:131]
 ds_read_b64_tr_b16 a[136:137], v2 offset:49152
 ds_read_b64_tr_b16 a[138:139], v2 offset:50176
M v[132:135], a[164:167], a[44:47], v[132:135]
 buffer_load_dwordx4 v14, s[48:51], s22 offen offset:2048   lds
M v[132:135], a[160:163], a[40:43], v[132:135]
 s_waitcnt lgkmcnt(6)
 v_add_f32 v20, v28, v20
 v_sub_f32 v90, v90, v27
M v[136:139], a[160:163], a[48:51], v[136:139]
 v_add_f32 v21, v29, v21
 v_sub_f32 v91, v91, v27
M v[136:139], a[164:167], a[52:55], v[136:139]
 v_add_f32 v22, v30, v22
 v_sub_f32 v92, v92, v27
M v[140:143], a[164:167], a[60:63], v[140:143]
 v_add_f32 v23, v31, v23
 v_sub_f32 v93, v93, v27
M v[140:143], a[160:163], a[56:59], v[140:143]
 ds_read_b64_tr_b16 a[140:141], v2 offset:57344
 ds_read_b64_tr_b16 a[142:143], v2 offset:58368
M v[144:147], a[160:163], a[64:67], v[144:147]
 buffer_load_dwordx4 v15, s[48:51], s22 offen offset:3072   lds
M v[144:147], a[164:167], a[68:71], v[144:147]
 s_add_u32 s22, s22, 2097152
 v_mul_f32 v28, 0xbfb8aa3b, v16
 v_sub_f32 v94, v94, v27
M v[148:151], a[164:167], a[76:79], v[148:151]
 v_mul_f32 v29, 0xbfb8aa3b, v17
 v_sub_f32 v95, v95, v27
M v[148:151], a[160:163], a[72:75], v[148:151]
 v_mul_f32 v30, 0xbfb8aa3b, v18
 v_sub_f32 v112, v112, v27
M v[152:155], a[160:163], a[80:83], v[152:155]
 v_mul_f32 v31, 0xbfb8aa3b, v19
 v_sub_f32 v113, v113, v27
M v[152:155], a[164:167], a[84:87], v[152:155]
 s_waitcnt lgkmcnt(4)
 v_exp_f32 v28, v28
M v[156:159], a[164:167], a[92:95], v[156:159]
 s_add_u32 m0, s23, 32768
 ds_read_b64_tr_b16 a[144:145], v3 offset:49152
 ds_read_b64_tr_b16 a[146:147], v3 offset:50176
M v[156:159], a[160:163], a[88:91], v[156:159]
 buffer_load_dwordx4 v8, s[16:19], s21 offen offset:0  nt lds
M v[160:163], a[168:171], a[32:35], v[160:163]
 ds_read_b128 a[160:163], v5 offset:20480
 ds_read_b128 a[164:167], v6 offset:20480
M v[160:163], a[172:175], a[36:39], v[160:163]
 v_exp_f32 v29, v29
M v[164:167], a[172:175], a[44:47], v[164:167]
 v_exp_f32 v30, v30
M v[164:167], a[168:171], a[40:43], v[164:167]
 v_exp_f32 v31, v31
M v[168:171], a[168:171], a[48:51], v[168:171]
 v_cvt_pk_bf16_f32 v25, v20, v21
 v_sub_f32 v114, v114, v27
M v[168:171], a[172:175], a[52:55], v[168:171]
 ds_read_b64_tr_b16 a[148:149], v3 offset:57344
 ds_read_b64_tr_b16 a[150:151], v3 offset:58368
M v[172:175], a[172:175], a[60:63], v[172:175]
 buffer_load_dwordx4 v9, s[16:19], s21 offen offset:1024  nt lds
M v[172:175], a[168:171], a[56:59], v[172:175]
 v_lshlrev_b32 v20, 16, v25
 v_sub_f32 v115, v115, v27
M v[176:179], a[168:171], a[64:67], v[176:179]
 v_and_b32 v21, 0xffff0000, v25
 v_sub_f32 v116, v116, v27
M v[176:179], a[172:175], a[68:71], v[176:179]
 v_cvt_pk_bf16_f32 v25, v22, v23
 v_sub_f32 v117, v117, v27
M v[180:183], a[172:175], a[76:79], v[180:183]
 v_lshlrev_b32 v22, 16, v25
 v_sub_f32 v118, v118, v27
M v[180:183], a[168:171], a[72:75], v[180:183]
 v_and_b32 v23, 0xffff0000, v25
 v_sub_f32 v119, v119, v27
M v[184:187], a[168:171], a[80:83], v[184:187]
 ds_read_b64_tr_b16 a[152:153], v4 offset:49152
 ds_read_b64_tr_b16 a[154:155], v4 offset:50176
M v[184:187], a[172:175], a[84:87], v[184:187]
 s_waitcnt lgkmcnt(4)
 v_add_f32 v28, 1.0, v28
 v_sub_f32 v120, v120, v27
M v[188:191], a[172:175], a[92:95], v[188:191]
 buffer_load_dwordx4 v10, s[16:19], s21 offen offset:2048  nt lds
M v[188:191], a[168:171], a[88:91], v[188:191]
 v_add_f32 v29, 1.0, v29
 v_sub_f32 v121, v121, v27
M v[192:195], a[160:163], a[32:35], v[192:195]
 ds_read_b128 a[168:171], v5 offset:22528
 ds_read_b128 a[172:175], v6 offset:22528
M v[192:195], a[164:167], a[36:39], v[192:195]
 v_add_f32 v30, 1.0, v30
 v_sub_f32 v122, v122, v27
M v[196:199], a[164:167], a[44:47], v[196:199]
 v_add_f32 v31, 1.0, v31
 v_sub_f32 v123, v123, v27
M v[196:199], a[160:163], a[40:43], v[196:199]
 ds_read_b64_tr_b16 a[156:157], v4 offset:57344
 ds_read_b64_tr_b16 a[158:159], v4 offset:58368
M v[200:203], a[160:163], a[48:51], v[200:203]
 buffer_load_dwordx4 v11, s[16:19], s21 offen offset:3072  nt lds
M v[200:203], a[164:167], a[52:55], v[200:203]
 s_add_u32 s21, s21, 128
 v_rcp_f32 v28, v28
M v[204:207], a[164:167], a[60:63], v[204:207]
 v_rcp_f32 v29, v29
M v[204:207], a[160:163], a[56:59], v[204:207]
 v_rcp_f32 v30, v30
M v[208:211], a[160:163], a[64:67], v[208:211]
 v_rcp_f32 v31, v31
M v[208:211], a[164:167], a[68:71], v[208:211]
 v_mul_f32 v16, v28, v16
 v_sub_f32 v124, v124, v27
M v[212:215], a[164:167], a[76:79], v[212:215]
 v_mul_f32 v17, v29, v17
 v_sub_f32 v125, v125, v27
M v[212:215], a[160:163], a[72:75], v[212:215]
 v_mul_f32 v18, v30, v18
 v_sub_f32 v126, v126, v27
M v[216:219], a[160:163], a[80:83], v[216:219]
 v_mul_f32 v19, v31, v19
 v_sub_f32 v127, v127, v27
M v[216:219], a[164:167], a[84:87], v[216:219]
 s_waitcnt lgkmcnt(2)
 v_cvt_pk_bf16_f32 v25, v16, v17
 v_sub_f32 v128, v128, v27
M v[220:223], a[164:167], a[92:95], v[220:223]
 s_waitcnt vmcnt(22) lgkmcnt(0)
 v_lshlrev_b32 v16, 16, v25
 v_sub_f32 v129, v129, v27
M v[220:223], a[160:163], a[88:91], v[220:223]
 s_barrier
M v[224:227], a[168:171], a[32:35], v[224:227]
 ds_read_b128 a[160:163], v5 offset:32768
 ds_read_b128 a[164:167], v6 offset:32768
M v[224:227], a[172:175], a[36:39], v[224:227]
 v_and_b32 v17, 0xffff0000, v25
 v_sub_f32 v130, v130, v27
M v[228:231], a[172:175], a[44:47], v[228:231]
 v_cvt_pk_bf16_f32 v25, v18, v19
 v_sub_f32 v131, v131, v27
M v[228:231], a[168:171], a[40:43], v[228:231]
 v_lshlrev_b32 v18, 16, v25
 v_sub_f32 v132, v132, v27
M v[232:235], a[168:171], a[48:51], v[232:235]
 v_and_b32 v19, 0xffff0000, v25
 v_sub_f32 v133, v133, v27
M v[232:235], a[172:175], a[52:55], v[232:235]
 v_mul_f32 v16, v20, v16
 v_sub_f32 v134, v134, v27
M v[236:239], a[172:175], a[60:63], v[236:239]
 v_mul_f32 v17, v21, v17
 v_sub_f32 v135, v135, v27
M v[236:239], a[168:171], a[56:59], v[236:239]
 v_mul_f32 v18, v22, v18
 v_sub_f32 v136, v136, v27
M v[240:243], a[168:171], a[64:67], v[240:243]
 v_mul_f32 v19, v23, v19
 v_sub_f32 v137, v137, v27
M v[240:243], a[172:175], a[68:71], v[240:243]
 v_cvt_pk_bf16_f32 v16, v16, v17
 v_sub_f32 v138, v138, v27
M v[244:247], a[172:175], a[76:79], v[244:247]
 v_cvt_pk_bf16_f32 v17, v18, v19
 v_sub_f32 v139, v139, v27
M v[244:247], a[168:171], a[72:75], v[244:247]
 v_sub_f32 v140, v140, v27
 v_sub_f32 v141, v141, v27
M v[248:251], a[168:171], a[80:83], v[248:251]
 v_sub_f32 v142, v142, v27
 v_sub_f32 v143, v143, v27
M v[248:251], a[172:175], a[84:87], v[248:251]
 s_waitcnt lgkmcnt(0)
 v_sub_f32 v144, v144, v27
 v_sub_f32 v145, v145, v27
M v[252:255], a[172:175], a[92:95], v[252:255]
 v_sub_f32 v146, v146, v27
 v_sub_f32 v147, v147, v27
M v[252:255], a[168:171], a[88:91], v[252:255]
 v_sub_f32 v148, v148, v27
 v_sub_f32 v149, v149, v27
M a[0:3], a[160:163], a[96:99], a[0:3]
 ds_read_b128 a[168:171], v5 offset:34816
 ds_read_b128 a[172:175], v6 offset:34816
M a[0:3], a[164:167], a[100:103], a[0:3]
 ds_read_b64_tr_b16 a[32:33], v1 offset:0
 ds_read_b64_tr_b16 a[34:35], v1 offset:1024
M a[4:7], a[164:167], a[108:111], a[4:7]
 s_add_u32 m0, s24, 16384
 v_lshrrev_b32 v28, 2, v0
 v_lshlrev_b32 v28, 8, v28
M a[4:7], a[160:163], a[104:107], a[4:7]
 buffer_load_dwordx4 v12, s[48:51], s22 offen offset:0   lds
M a[8:11], a[160:163], a[112:115], a[8:11]
 v_and_b32 v29, 3, v0
 v_lshl_add_u32 v28, v29, 3, v28
M a[8:11], a[164:167], a[116:119], a[8:11]
 v_add_u32 v28, s87, v28
 v_sub_f32 v150, v150, v27
M a[12:15], a[164:167], a[124:127], a[12:15]
 s_waitcnt vmcnt(19)
 ds_read_b64_tr_b16 a[36:37], v1 offset:8192
 ds_read_b64_tr_b16 a[38:39], v1 offset:9216
M a[12:15], a[160:163], a[120:123], a[12:15]
 ds_read_b64_tr_b16 a[176:177], v28 offset:0
 v_sub_f32 v151, v151, v27
M a[16:19], a[160:163], a[128:131], a[16:19]
 buffer_load_dwordx4 v13, s[48:51], s22 offen offset:1024   lds
M a[16:19], a[164:167], a[132:135], a[16:19]
 ds_read_b64_tr_b16 a[178:179], v28 offset:32
 ds_read_b64_tr_b16 a[180:181], v28 offset:64
M a[20:23], a[164:167], a[140:143], a[20:23]
 ds_read_b64_tr_b16 a[182:183], v28 offset:96
 v_sub_f32 v152, v152, v27
M a[20:23], a[160:163], a[136:139], a[20:23]
 ds_read_b64_tr_b16 a[40:41], v2 offset:0
 ds_read_b64_tr_b16 a[42:43], v2 offset:1024
M a[24:27], a[160:163], a[144:147], a[24:27]
 ds_read_b64_tr_b16 a[184:185], v28 offset:128
 v_sub_f32 v153, v153, v27
M a[24:27], a[164:167], a[148:151], a[24:27]
 s_waitcnt lgkmcnt(11)
 ds_read_b64_tr_b16 a[186:187], v28 offset:160
 ds_read_b64_tr_b16 a[188:189], v28 offset:192
M a[28:31], a[164:167], a[156:159], a[28:31]
 buffer_load_dwordx4 v14, s[48:51], s22 offen offset:2048   lds
M a[28:31], a[160:163], a[152:155], a[28:31]
 v_sub_f32 v154, v154, v27
 v_sub_f32 v155, v155, v27
M v[32:35], a[168:171], a[96:99], v[32:35]
 ds_read_b128 a[160:163], v5 offset:36864
 ds_read_b128 a[164:167], v6 offset:36864
M v[32:35], a[172:175], a[100:103], v[32:35]
 ds_read_b64_tr_b16 a[44:45], v2 offset:8192
 ds_read_b64_tr_b16 a[46:47], v2 offset:9216
M v[36:39], a[172:175], a[108:111], v[36:39]
 buffer_load_dwordx4 v15, s[48:51], s22 offen offset:3072   lds
M v[36:39], a[168:171], a[104:107], v[36:39]
 s_sub_u32 s22, s22, 2097024
 v_sub_f32 v156, v156, v27
 v_sub_f32 v157, v157, v27
M v[40:43], a[168:171], a[112:115], v[40:43]
 v_sub_f32 v158, v158, v27
 v_sub_f32 v159, v159, v27
M v[40:43], a[172:175], a[116:119], v[40:43]
 ds_read_b64_tr_b16 a[48:49], v3 offset:0
 ds_read_b64_tr_b16 a[50:51], v3 offset:1024
M v[44:47], a[172:175], a[124:127], v[44:47]
 s_add_u32 m0, s23, 49152
M v[44:47], a[168:171], a[120:123], v[44:47]
 buffer_load_dwordx4 v8, s[16:19], s21 offen offset:0  nt lds
M v[48:51], a[168:171], a[128:131], v[48:51]
M v[48:51], a[172:175], a[132:135], v[48:51]
M v[52:55], a[172:175], a[140:143], v[52:55]
 ds_read_b64_tr_b16 a[52:53], v3 offset:8192
 ds_read_b64_tr_b16 a[54:55], v3 offset:9216
M v[52:55], a[168:171], a[136:139], v[52:55]
M v[56:59], a[168:171], a[144:147], v[56:59]
 buffer_load_dwordx4 v9, s[16:19], s21 offen offset:1024  nt lds
M v[56:59], a[172:175], a[148:151], v[56:59]
 s_waitcnt lgkmcnt(6)
M v[60:63], a[172:175], a[156:159], v[60:63]
M v[60:63], a[168:171], a[152:155], v[60:63]
 ds_read_b64_tr_b16 a[56:57], v4 offset:0
 ds_read_b64_tr_b16 a[58:59], v4 offset:1024
M v[64:67], a[160:163], a[96:99], v[64:67]
 ds_read_b128 a[168:171], v5 offset:38912
 ds_read_b128 a[172:175], v6 offset:38912
M v[64:67], a[164:167], a[100:103], v[64:67]
 buffer_load_dwordx4 v10, s[16:19], s21 offen offset:2048  nt lds
M v[68:71], a[164:167], a[108:111], v[68:71]
M v[68:71], a[160:163], a[104:107], v[68:71]
M v[72:75], a[160:163], a[112:115], v[72:75]
 ds_read_b64_tr_b16 a[60:61], v4 offset:8192
 ds_read_b64_tr_b16 a[62:63], v4 offset:9216
M v[72:75], a[164:167], a[116:119], v[72:75]
M v[76:79], a[164:167], a[124:127], v[76:79]
 buffer_load_dwordx4 v11, s[16:19], s21 offen offset:3072  nt lds
M v[76:79], a[160:163], a[120:123], v[76:79]
 s_add_u32 s21, s21, 524160
M v[80:83], a[160:163], a[128:131], v[80:83]
M v[80:83], a[164:167], a[132:135], v[80:83]
M v[84:87], a[164:167], a[140:143], v[84:87]
M v[84:87], a[160:163], a[136:139], v[84:87]
M v[88:91], a[160:163], a[144:147], v[88:91]
M v[88:91], a[164:167], a[148:151], v[88:91]
 s_waitcnt lgkmcnt(2)
M v[92:95], a[164:167], a[156:159], v[92:95]
 s_waitcnt vmcnt(16) lgkmcnt(0)
M v[92:95], a[160:163], a[152:155], v[92:95]
 s_barrier
 v_mfma_f32_16x16x16_bf16 a[208:211], a[176:177], v[16:17], 0
 v_mfma_f32_16x16x16_bf16 a[212:215], a[178:179], v[16:17], 0
 v_mfma_f32_16x16x16_bf16 a[216:219], a[180:181], v[16:17], 0
 v_mfma_f32_16x16x16_bf16 a[220:223], a[182:183], v[16:17], 0
 v_mfma_f32_16x16x16_bf16 a[224:227], a[184:185], v[16:17], 0
 v_mfma_f32_16x16x16_bf16 a[228:231], a[186:187], v[16:17], 0
 v_mfma_f32_16x16x16_bf16 a[232:235], a[188:189], v[16:17], 0
M v[96:99], a[168:171], a[96:99], v[96:99]
 ds_read_b128 a[160:163], v5 offset:49152
 ds_read_b128 a[164:167], v6 offset:49152
M v[96:99], a[172:175], a[100:103], v[96:99]
M v[100:103], a[172:175], a[108:111], v[100:103]
 s_add_u32 m0, s24, 32768
 ds_read_b64_tr_b16 a[64:65], v1 offset:16384
 ds_read_b64_tr_b16 a[66:67], v1 offset:17408
M v[100:103], a[168:171], a[104:107], v[100:103]
 buffer_load_dwordx4 v12, s[48:51], s22 offen offset:0   lds
M v[104:107], a[168:171], a[112:115], v[104:107]
M v[104:107], a[172:175], a[116:119], v[104:107]
M v[108:111], a[172:175], a[124:127], v[108:111]
M v[108:111], a[168:171], a[120:123], v[108:111]
M v[112:115], a[168:171], a[128:131], v[112:115]
M v[112:115], a[172:175], a[132:135], v[112:115]
 ds_read_b64_tr_b16 a[68:69], v1 offset:24576
 ds_read_b64_tr_b16 a[70:71], v1 offset:25600
M v[116:119], a[172:175], a[140:143], v[116:119]
 buffer_load_dwordx4 v13, s[48:51], s22 offen offset:1024   lds
M v[116:119], a[168:171], a[136:139], v[116:119]
M v[120:123], a[168:171], a[144:147], v[120:123]
M v[120:123], a[172:175], a[148:151], v[120:123]
 s_waitcnt lgkmcnt(4)
M v[124:127], a[172:175], a[156:159], v[124:127]
M v[124:127], a[168:171], a[152:155], v[124:127]
M v[128:131], a[160:163], a[96:99], v[128:131]
 ds_read_b128 a[168:171], v5 offset:51200
 ds_read_b128 a[172:175], v6 offset:51200
M v[128:131], a[164:167], a[100:103], v[128:131]
 ds_read_b64_tr_b16 a[72:73], v2 offset:16384
 ds_read_b64_tr_b16 a[74:75], v2 offset:17408
M v[132:135], a[164:167], a[108:111], v[132:135]
 buffer_load_dwordx4 v14, s[48:51], s22 offen offset:2048   lds
M v[132:135], a[160:163], a[104:107], v[132:135]
M v[136:139], a[160:163], a[112:115], v[136:139]
M v[136:139], a[164:167], a[116:119], v[136:139]
M v[140:143], a[164:167], a[124:127], v[140:143]
M v[140:143], a[160:163], a[120:123], v[140:143]
 ds_read_b64_tr_b16 a[76:77], v2 offset:24576
 ds_read_b64_tr_b16 a[78:79], v2 offset:25600
M v[144:147], a[160:163], a[128:131], v[144:147]
 buffer_load_dwordx4 v15, s[48:51], s22 offen offset:3072   lds
M v[144:147], a[164:167], a[132:135], v[144:147]
 s_add_u32 s22, s22, 2097152
M v[148:151], a[164:167], a[140:143], v[148:151]
M v[148:151], a[160:163], a[136:139], v[148:151]
M v[152:155], a[160:163], a[144:147], v[152:155]
M v[152:155], a[164:167], a[148:151], v[152:155]
 s_waitcnt lgkmcnt(4)
M v[156:159], a[164:167], a[156:159], v[156:159]
 s_add_u32 m0, s23, 0
 ds_read_b64_tr_b16 a[80:81], v3 offset:16384
 ds_read_b64_tr_b16 a[82:83], v3 offset:17408
M v[156:159], a[160:163], a[152:155], v[156:159]
 buffer_load_dwordx4 v8, s[52:55], s28 offen offset:0   lds
M v[160:163], a[168:171], a[96:99], v[160:163]
 ds_read_b128 a[160:163], v5 offset:53248
 ds_read_b128 a[164:167], v6 offset:53248
M v[160:163], a[172:175], a[100:103], v[160:163]
M v[164:167], a[172:175], a[108:111], v[164:167]
M v[164:167], a[168:171], a[104:107], v[164:167]
M v[168:171], a[168:171], a[112:115], v[168:171]
M v[168:171], a[172:175], a[116:119], v[168:171]
 ds_read_b64_tr_b16 a[84:85], v3 offset:24576
 ds_read_b64_tr_b16 a[86:87], v3 offset:25600
M v[172:175], a[172:175], a[124:127], v[172:175]
 buffer_load_dwordx4 v9, s[52:55], s28 offen offset:1024   lds
M v[172:175], a[168:171], a[120:123], v[172:175]
M v[176:179], a[168:171], a[128:131], v[176:179]
M v[176:179], a[172:175], a[132:135], v[176:179]
M v[180:183], a[172:175], a[140:143], v[180:183]
M v[180:183], a[168:171], a[136:139], v[180:183]
M v[184:187], a[168:171], a[144:147], v[184:187]
 ds_read_b64_tr_b16 a[88:89], v4 offset:16384
 ds_read_b64_tr_b16 a[90:91], v4 offset:17408
M v[184:187], a[172:175], a[148:151], v[184:187]
 s_waitcnt lgkmcnt(4)
M v[188:191], a[172:175], a[156:159], v[188:191]
 buffer_load_dwordx4 v10, s[52:55], s28 offen offset:2048   lds
M v[188:191], a[168:171], a[152:155], v[188:191]
M v[192:195], a[160:163], a[96:99], v[192:195]
 ds_read_b128 a[168:171], v5 offset:55296
 ds_read_b128 a[172:175], v6 offset:55296
M v[192:195], a[164:167], a[100:103], v[192:195]
M v[196:199], a[164:167], a[108:111], v[196:199]
M v[196:199], a[160:163], a[104:107], v[196:199]
 ds_read_b64_tr_b16 a[92:93], v4 offset:24576
 ds_read_b64_tr_b16 a[94:95], v4 offset:25600
M v[200:203], a[160:163], a[112:115], v[200:203]
 buffer_load_dwordx4 v11, s[52:55], s28 offen offset:3072   lds
M v[200:203], a[164:167], a[116:119], v[200:203]
 s_add_u32 s28, s28, 128
 v_sub_f32 v160, v160, v27
 v_sub_f32 v161, v161, v27
M v[204:207], a[164:167], a[124:127], v[204:207]
 v_sub_f32 v162, v162, v27
 v_sub_f32 v163, v163, v27
M v[204:207], a[160:163], a[120:123], v[204:207]
 v_sub_f32 v164, v164, v27
 v_sub_f32 v165, v165, v27
M v[208:211], a[160:163], a[128:131], v[208:211]
 v_sub_f32 v166, v166, v27
 v_sub_f32 v167, v167, v27
M v[208:211], a[164:167], a[132:135], v[208:211]
 v_sub_f32 v168, v168, v27
 v_sub_f32 v169, v169, v27
M v[212:215], a[164:167], a[140:143], v[212:215]
 v_sub_f32 v170, v170, v27
 v_sub_f32 v171, v171, v27
M v[212:215], a[160:163], a[136:139], v[212:215]
 v_sub_f32 v172, v172, v27
 v_sub_f32 v173, v173, v27
M v[216:219], a[160:163], a[144:147], v[216:219]
 v_sub_f32 v174, v174, v27
 v_sub_f32 v175, v175, v27
M v[216:219], a[164:167], a[148:151], v[216:219]
 s_waitcnt lgkmcnt(2)
 v_sub_f32 v176, v176, v27
 v_sub_f32 v177, v177, v27
M v[220:223], a[164:167], a[156:159], v[220:223]
 s_waitcnt vmcnt(16) lgkmcnt(0)
 v_sub_f32 v178, v178, v27
 v_sub_f32 v179, v179, v27
M v[220:223], a[160:163], a[152:155], v[220:223]
 s_barrier
M v[224:227], a[168:171], a[96:99], v[224:227]
 ds_read_b128 a[160:163], v5 offset:0
 ds_read_b128 a[164:167], v6 offset:0
M v[224:227], a[172:175], a[100:103], v[224:227]
 v_and_b32 v26, 48, v0
 v_lshlrev_b32 v26, 17, v26
M v[228:231], a[172:175], a[108:111], v[228:231]
 v_or_b32 v26, v26, v0
 v_lshl_add_u32 v26, v26, 7, s95
M v[228:231], a[168:171], a[104:107], v[228:231]
 buffer_load_dword a240, v26, s[76:79], 0 offen offset:0
M v[232:235], a[168:171], a[112:115], v[232:235]
 v_sub_f32 v180, v180, v27
 v_sub_f32 v181, v181, v27
M v[232:235], a[172:175], a[116:119], v[232:235]
 v_sub_f32 v182, v182, v27
 v_sub_f32 v183, v183, v27
M v[236:239], a[172:175], a[124:127], v[236:239]
 v_sub_f32 v184, v184, v27
 v_sub_f32 v185, v185, v27
M v[236:239], a[168:171], a[120:123], v[236:239]
 v_sub_f32 v186, v186, v27
 v_sub_f32 v187, v187, v27
M v[240:243], a[168:171], a[128:131], v[240:243]
 v_sub_f32 v188, v188, v27
 v_sub_f32 v189, v189, v27
M v[240:243], a[172:175], a[132:135], v[240:243]
 v_sub_f32 v190, v190, v27
 v_sub_f32 v191, v191, v27
M v[244:247], a[172:175], a[140:143], v[244:247]
 v_sub_f32 v192, v192, v27
 v_sub_f32 v193, v193, v27
M v[244:247], a[168:171], a[136:139], v[244:247]
 v_sub_f32 v194, v194, v27
 v_sub_f32 v195, v195, v27
M v[248:251], a[168:171], a[144:147], v[248:251]
 v_sub_f32 v196, v196, v27
 v_sub_f32 v197, v197, v27
M v[248:251], a[172:175], a[148:151], v[248:251]
 s_waitcnt lgkmcnt(0)
 v_sub_f32 v198, v198, v27
 v_sub_f32 v199, v199, v27
M v[252:255], a[172:175], a[156:159], v[252:255]
 v_sub_f32 v200, v200, v27
 v_sub_f32 v201, v201, v27
M v[252:255], a[168:171], a[152:155], v[252:255]
 v_sub_f32 v202, v202, v27
 v_sub_f32 v203, v203, v27
M a[0:3], a[160:163], a[32:35], a[0:3]
 ds_read_b128 a[168:171], v5 offset:2048
 ds_read_b128 a[172:175], v6 offset:2048
M a[0:3], a[164:167], a[36:39], a[0:3]
 ds_read_b64_tr_b16 a[96:97], v1 offset:32768
 ds_read_b64_tr_b16 a[98:99], v1 offset:33792
M a[4:7], a[164:167], a[44:47], a[4:7]
 s_add_u32 m0, s24, 49152
 v_lshrrev_b32 v28, 4, v0
 v_add_u32 v28, 0, v28
M a[4:7], a[160:163], a[40:43], a[4:7]
 buffer_load_dwordx4 v12, s[48:51], s22 offen offset:0   lds
M a[8:11], a[160:163], a[48:51], a[8:11]
 v_and_b32 v29, 7, v0
 v_xor_b32 v28, v28, v29
M a[8:11], a[164:167], a[52:55], a[8:11]
 v_lshlrev_b32 v28, 4, v28
 v_lshrrev_b32 v29, 3, v0
M a[12:15], a[164:167], a[60:63], a[12:15]
 ds_read_b64_tr_b16 a[100:101], v1 offset:40960
 ds_read_b64_tr_b16 a[102:103], v1 offset:41984
M a[12:15], a[160:163], a[56:59], a[12:15]
 buffer_load_dwordx4 v13, s[48:51], s22 offen offset:1024   lds
M a[16:19], a[160:163], a[64:67], a[16:19]
 v_mul_u32_u24 v29, 896, v29
 s_mul_i32 s64, s20, 28672
M a[16:19], a[164:167], a[68:71], a[16:19]
 buffer_load_dwordx4 v14, s[48:51], s22 offen offset:2048   lds
M a[20:23], a[164:167], a[76:79], a[20:23]
 s_add_u32 s64, s64, 0
 v_add3_u32 v16, v29, v28, s64
M a[20:23], a[160:163], a[72:75], a[20:23]
 ds_read_b64_tr_b16 a[104:105], v2 offset:32768
 ds_read_b64_tr_b16 a[106:107], v2 offset:33792
M a[24:27], a[160:163], a[80:83], a[24:27]
 v_add_u32 v18, 12288, v16
 v_lshrrev_b32 v28, 4, v0
M a[24:27], a[164:167], a[84:87], a[24:27]
 s_waitcnt lgkmcnt(6)
 v_add_u32 v28, 4, v28
 v_and_b32 v29, 7, v0
M a[28:31], a[164:167], a[92:95], a[28:31]
 buffer_load_dwordx4 v15, s[48:51], s22 offen offset:3072   lds
M a[28:31], a[160:163], a[88:91], a[28:31]
 s_sub_u32 s22, s22, 2097024
 v_xor_b32 v28, v28, v29
 v_lshlrev_b32 v28, 4, v28
M v[32:35], a[168:171], a[32:35], v[32:35]
 s_add_u32 m0, s23, 16384
 ds_read_b128 a[160:163], v5 offset:4096
 ds_read_b128 a[164:167], v6 offset:4096
M v[32:35], a[172:175], a[36:39], v[32:35]
 ds_read_b64_tr_b16 a[108:109], v2 offset:40960
 ds_read_b64_tr_b16 a[110:111], v2 offset:41984
M v[36:39], a[172:175], a[44:47], v[36:39]
 buffer_load_dwordx4 v8, s[52:55], s28 offen offset:0   lds
M v[36:39], a[168:171], a[40:43], v[36:39]
 v_lshrrev_b32 v29, 3, v0
 v_mul_u32_u24 v29, 896, v29
M v[40:43], a[168:171], a[48:51], v[40:43]
 buffer_load_dwordx4 v9, s[52:55], s28 offen offset:1024   lds
M v[40:43], a[172:175], a[52:55], v[40:43]
 ds_read_b64_tr_b16 a[112:113], v3 offset:32768
 ds_read_b64_tr_b16 a[114:115], v3 offset:33792
M v[44:47], a[172:175], a[60:63], v[44:47]
 s_mul_i32 s64, s20, 28672
 s_add_u32 s64, s64, 6144
M v[44:47], a[168:171], a[56:59], v[44:47]
 buffer_load_dwordx4 v10, s[52:55], s28 offen offset:2048   lds
M v[48:51], a[168:171], a[64:67], v[48:51]
 v_add3_u32 v17, v29, v28, s64
 v_add_u32 v19, 12288, v17
M v[48:51], a[172:175], a[68:71], v[48:51]
 v_add_u32 v20, 0x20000, v1
 v_add_u32 v21, 0x20000, v2
M v[52:55], a[172:175], a[76:79], v[52:55]
 ds_read_b64_tr_b16 a[116:117], v3 offset:40960
 ds_read_b64_tr_b16 a[118:119], v3 offset:41984
M v[52:55], a[168:171], a[72:75], v[52:55]
 buffer_load_dwordx4 v11, s[52:55], s28 offen offset:3072   lds
M v[56:59], a[168:171], a[80:83], v[56:59]
 s_add_u32 s28, s28, 1048448
 v_add_u32 v22, 0x20000, v3
 v_add_u32 v23, 0x20000, v4
M v[56:59], a[172:175], a[84:87], v[56:59]
 s_waitcnt lgkmcnt(6)
 v_sub_f32 v204, v204, v27
 v_sub_f32 v205, v205, v27
M v[60:63], a[172:175], a[92:95], v[60:63]
 s_add_u32 m0, s23, 131072
 v_sub_f32 v206, v206, v27
 v_sub_f32 v207, v207, v27
M v[60:63], a[168:171], a[88:91], v[60:63]
 ds_read_b64_tr_b16 a[120:121], v4 offset:32768
 ds_read_b64_tr_b16 a[122:123], v4 offset:33792
M v[64:67], a[160:163], a[32:35], v[64:67]
 ds_read_b128 a[168:171], v5 offset:6144
 ds_read_b128 a[172:175], v6 offset:6144
M v[64:67], a[164:167], a[36:39], v[64:67]
 buffer_load_dwordx4 v8, s[52:55], s28 offen offset:0   lds
M v[68:71], a[164:167], a[44:47], v[68:71]
 buffer_load_dwordx4 v9, s[52:55], s28 offen offset:1024   lds
M v[68:71], a[160:163], a[40:43], v[68:71]
 v_sub_f32 v208, v208, v27
 v_sub_f32 v209, v209, v27
M v[72:75], a[160:163], a[48:51], v[72:75]
 ds_read_b64_tr_b16 a[124:125], v4 offset:40960
 ds_read_b64_tr_b16 a[126:127], v4 offset:41984
M v[72:75], a[164:167], a[52:55], v[72:75]
 buffer_load_dwordx4 v10, s[52:55], s28 offen offset:2048   lds
M v[76:79], a[164:167], a[60:63], v[76:79]
 v_sub_f32 v210, v210, v27
 v_sub_f32 v211, v211, v27
M v[76:79], a[160:163], a[56:59], v[76:79]
 v_sub_f32 v212, v212, v27
 v_sub_f32 v213, v213, v27
M v[80:83], a[160:163], a[64:67], v[80:83]
 buffer_load_dwordx4 v11, s[52:55], s28 offen offset:3072   lds
M v[80:83], a[164:167], a[68:71], v[80:83]
 s_sub_u32 s28, s28, 524288
 v_sub_f32 v214, v214, v27
 v_sub_f32 v215, v215, v27
M v[84:87], a[164:167], a[76:79], v[84:87]
 v_sub_f32 v216, v216, v27
 v_sub_f32 v217, v217, v27
M v[84:87], a[160:163], a[72:75], v[84:87]
 v_sub_f32 v218, v218, v27
 v_sub_f32 v219, v219, v27
M v[88:91], a[160:163], a[80:83], v[88:91]
 v_sub_f32 v220, v220, v27
 v_sub_f32 v221, v221, v27
M v[88:91], a[164:167], a[84:87], v[88:91]
 s_waitcnt lgkmcnt(2)
 v_sub_f32 v222, v222, v27
 v_sub_f32 v223, v223, v27
M v[92:95], a[164:167], a[92:95], v[92:95]
 s_waitcnt vmcnt(21) lgkmcnt(0)
 v_sub_f32 v224, v224, v27
 v_sub_f32 v225, v225, v27
M v[92:95], a[160:163], a[88:91], v[92:95]
 s_barrier
M v[96:99], a[168:171], a[32:35], v[96:99]
 ds_read_b128 a[160:163], v5 offset:16384
 ds_read_b128 a[164:167], v6 offset:16384
M v[96:99], a[172:175], a[36:39], v[96:99]
 v_sub_f32 v226, v226, v27
 v_sub_f32 v227, v227, v27
M v[100:103], a[172:175], a[44:47], v[100:103]
 s_add_u32 m0, s24, 0
 ds_read_b64_tr_b16 a[128:129], v1 offset:49152
 ds_read_b64_tr_b16 a[130:131], v1 offset:50176
M v[100:103], a[168:171], a[40:43], v[100:103]
 buffer_load_dwordx4 v16, s[56:59], s29 offen offset:0   lds
M v[104:107], a[168:171], a[48:51], v[104:107]
 s_mul_i32 s72, s41, 4352
 v_sub_f32 v228, v228, v27
M v[104:107], a[172:175], a[52:55], v[104:107]
 s_add_u32 s46, s72, 104923136
 v_sub_f32 v229, v229, v27
 v_sub_f32 v230, v230, v27
M v[108:111], a[172:175], a[60:63], v[108:111]
 s_lshl_b32 s45, s42, 7
 s_add_u32 s45, s45, s46
 s_sub_u32 s66, 15, s42
M v[108:111], a[168:171], a[56:59], v[108:111]
 buffer_load_dwordx4 v17, s[56:59], s29 offen offset:1024   lds
M v[112:115], a[168:171], a[64:67], v[112:115]
 s_min_u32 s66, s66, s42
 v_sub_f32 v231, v231, v27
M v[112:115], a[172:175], a[68:71], v[112:115]
 s_lshl_b32 s47, s66, 7
 ds_read_b64_tr_b16 a[132:133], v1 offset:57344
 ds_read_b64_tr_b16 a[134:135], v1 offset:58368
M v[116:119], a[172:175], a[76:79], v[116:119]
 s_add_u32 s47, s47, s46
 v_sub_f32 v232, v232, v27
 v_sub_f32 v233, v233, v27
M v[116:119], a[168:171], a[72:75], v[116:119]
 s_add_u32 s47, s47, 2112
 s_lshl_b32 s65, s41, 3
 s_add_u32 s65, s65, s66
M v[120:123], a[168:171], a[80:83], v[120:123]
 buffer_load_dwordx4 v18, s[56:59], s29 offen offset:2048   lds
M v[120:123], a[172:175], a[84:87], v[120:123]
 s_waitcnt lgkmcnt(4)
 s_mul_i32 s34, s65, 73728
 v_sub_f32 v234, v234, v27
M v[124:127], a[172:175], a[92:95], v[124:127]
 s_add_u32 s34, s34, 50331648
 v_sub_f32 v235, v235, v27
 v_sub_f32 v236, v236, v27
M v[124:127], a[168:171], a[88:91], v[124:127]
 s_lshl_b32 s65, s42, 4
 v_sub_f32 v237, v237, v27
 v_sub_f32 v238, v238, v27
M v[128:131], a[160:163], a[32:35], v[128:131]
 s_add_u32 s65, s65, s41
 ds_read_b128 a[168:171], v5 offset:18432
 ds_read_b128 a[172:175], v6 offset:18432
M v[128:131], a[164:167], a[36:39], v[128:131]
 s_mul_i32 s33, s65, 114688
 ds_read_b64_tr_b16 a[136:137], v2 offset:49152
 ds_read_b64_tr_b16 a[138:139], v2 offset:50176
M v[132:135], a[164:167], a[44:47], v[132:135]
 buffer_load_dwordx4 v19, s[56:59], s29 offen offset:3072   lds
M v[132:135], a[160:163], a[40:43], v[132:135]
 s_add_u32 s29, s29, 128
 s_mul_i32 s65, s20, 28672
 v_sub_f32 v239, v239, v27
M v[136:139], a[160:163], a[48:51], v[136:139]
 s_add_u32 s33, s33, s65
 s_add_u32 s33, s33, 67108864
 s_sub_u32 s65, 15, s66
M v[136:139], a[164:167], a[52:55], v[136:139]
 s_add_u32 m0, s23, 32768
 s_lshl_b32 s65, s65, 16
 s_lshl_b32 s64, s41, 20
M v[140:143], a[164:167], a[60:63], v[140:143]
 buffer_load_dwordx4 v8, s[52:55], s28 offen offset:0   lds
M v[140:143], a[160:163], a[56:59], v[140:143]
 ds_read_b64_tr_b16 a[140:141], v2 offset:57344
 ds_read_b64_tr_b16 a[142:143], v2 offset:58368
M v[144:147], a[160:163], a[64:67], v[144:147]
 s_add_u32 s32, s64, s65
 v_sub_f32 v240, v240, v27
M v[144:147], a[164:167], a[68:71], v[144:147]
 s_lshl_b32 s65, s20, 14
 s_add_u32 s32, s32, s65
 s_add_u32 s32, s32, 33554432
M v[148:151], a[164:167], a[76:79], v[148:151]
 buffer_load_dwordx4 v9, s[52:55], s28 offen offset:1024   lds
M v[148:151], a[160:163], a[72:75], v[148:151]
 s_mov_b32 s31, 0x53800000
 v_sub_f32 v241, v241, v27
M v[152:155], a[160:163], a[80:83], v[152:155]
 s_mov_b32 s40, 1
 s_sub_u32 s64, s42, 10
 s_and_b32 s35, s64, 536870912
M v[152:155], a[164:167], a[84:87], v[152:155]
 s_waitcnt lgkmcnt(4)
 v_sub_f32 v242, v242, v27
 v_sub_f32 v243, v243, v27
M v[156:159], a[164:167], a[92:95], v[156:159]
 ds_read_b64_tr_b16 a[144:145], v3 offset:49152
 ds_read_b64_tr_b16 a[146:147], v3 offset:50176
M v[156:159], a[160:163], a[88:91], v[156:159]
 buffer_load_dwordx4 v10, s[52:55], s28 offen offset:2048   lds
M v[160:163], a[168:171], a[32:35], v[160:163]
 ds_read_b128 a[160:163], v5 offset:20480
 ds_read_b128 a[164:167], v6 offset:20480
M v[160:163], a[172:175], a[36:39], v[160:163]
 v_sub_f32 v244, v244, v27
 v_sub_f32 v245, v245, v27
M v[164:167], a[172:175], a[44:47], v[164:167]
 v_sub_f32 v246, v246, v27
 v_sub_f32 v247, v247, v27
M v[164:167], a[168:171], a[40:43], v[164:167]
 v_sub_f32 v248, v248, v27
 v_sub_f32 v249, v249, v27
M v[168:171], a[168:171], a[48:51], v[168:171]
 buffer_load_dwordx4 v11, s[52:55], s28 offen offset:3072   lds
M v[168:171], a[172:175], a[52:55], v[168:171]
 s_add_u32 s28, s28, 524416
 ds_read_b64_tr_b16 a[148:149], v3 offset:57344
 ds_read_b64_tr_b16 a[150:151], v3 offset:58368
M v[172:175], a[172:175], a[60:63], v[172:175]
 v_sub_f32 v250, v250, v27
 v_sub_f32 v251, v251, v27
M v[172:175], a[168:171], a[56:59], v[172:175]
 v_sub_f32 v252, v252, v27
 v_sub_f32 v253, v253, v27
M v[176:179], a[168:171], a[64:67], v[176:179]
 s_add_u32 m0, s23, 147456
 v_sub_f32 v254, v254, v27
 v_sub_f32 v255, v255, v27
M v[176:179], a[172:175], a[68:71], v[176:179]
 buffer_load_dwordx4 v8, s[52:55], s28 offen offset:0   lds
M v[180:183], a[172:175], a[76:79], v[180:183]
M v[180:183], a[168:171], a[72:75], v[180:183]
M v[184:187], a[168:171], a[80:83], v[184:187]
 ds_read_b64_tr_b16 a[152:153], v4 offset:49152
 ds_read_b64_tr_b16 a[154:155], v4 offset:50176
M v[184:187], a[172:175], a[84:87], v[184:187]
 s_waitcnt lgkmcnt(4)
M v[188:191], a[172:175], a[92:95], v[188:191]
 buffer_load_dwordx4 v9, s[52:55], s28 offen offset:1024   lds
M v[188:191], a[168:171], a[88:91], v[188:191]
M v[192:195], a[160:163], a[32:35], v[192:195]
 ds_read_b128 a[168:171], v5 offset:22528
 ds_read_b128 a[172:175], v6 offset:22528
M v[192:195], a[164:167], a[36:39], v[192:195]
M v[196:199], a[164:167], a[44:47], v[196:199]
 buffer_load_dwordx4 v10, s[52:55], s28 offen offset:2048   lds
M v[196:199], a[160:163], a[40:43], v[196:199]
 ds_read_b64_tr_b16 a[156:157], v4 offset:57344
 ds_read_b64_tr_b16 a[158:159], v4 offset:58368
M v[200:203], a[160:163], a[48:51], v[200:203]
M v[200:203], a[164:167], a[52:55], v[200:203]
M v[204:207], a[164:167], a[60:63], v[204:207]
M v[204:207], a[160:163], a[56:59], v[204:207]
 buffer_load_dwordx4 v11, s[52:55], s28 offen offset:3072   lds
M v[208:211], a[160:163], a[64:67], v[208:211]
 s_sub_u32 s28, s28, 524288
M v[208:211], a[164:167], a[68:71], v[208:211]
M v[212:215], a[164:167], a[76:79], v[212:215]
M v[212:215], a[160:163], a[72:75], v[212:215]
M v[216:219], a[160:163], a[80:83], v[216:219]
M v[216:219], a[164:167], a[84:87], v[216:219]
 s_waitcnt lgkmcnt(2)
M v[220:223], a[164:167], a[92:95], v[220:223]
 s_waitcnt vmcnt(25) lgkmcnt(0)
M v[220:223], a[160:163], a[88:91], v[220:223]
 s_barrier
M v[224:227], a[168:171], a[32:35], v[224:227]
 ds_read_b128 a[160:163], v5 offset:32768
 ds_read_b128 a[164:167], v6 offset:32768
M v[224:227], a[172:175], a[36:39], v[224:227]
M v[228:231], a[172:175], a[44:47], v[228:231]
M v[228:231], a[168:171], a[40:43], v[228:231]
M v[232:235], a[168:171], a[48:51], v[232:235]
M v[232:235], a[172:175], a[52:55], v[232:235]
M v[236:239], a[172:175], a[60:63], v[236:239]
M v[236:239], a[168:171], a[56:59], v[236:239]
M v[240:243], a[168:171], a[64:67], v[240:243]
M v[240:243], a[172:175], a[68:71], v[240:243]
M v[244:247], a[172:175], a[76:79], v[244:247]
M v[244:247], a[168:171], a[72:75], v[244:247]
M v[248:251], a[168:171], a[80:83], v[248:251]
M v[248:251], a[172:175], a[84:87], v[248:251]
 s_waitcnt lgkmcnt(0)
M v[252:255], a[172:175], a[92:95], v[252:255]
M v[252:255], a[168:171], a[88:91], v[252:255]
M a[0:3], a[160:163], a[96:99], a[0:3]
 ds_read_b128 a[168:171], v5 offset:34816
 ds_read_b128 a[172:175], v6 offset:34816
M a[0:3], a[164:167], a[100:103], a[0:3]
 ds_read_b64_tr_b16 a[32:33], v1 offset:0
 ds_read_b64_tr_b16 a[34:35], v1 offset:1024
M a[4:7], a[164:167], a[108:111], a[4:7]
 s_add_u32 m0, s24, 16384
M a[4:7], a[160:163], a[104:107], a[4:7]
 buffer_load_dwordx4 v16, s[56:59], s29 offen offset:0   lds
M a[8:11], a[160:163], a[112:115], a[8:11]
M a[8:11], a[164:167], a[116:119], a[8:11]
M a[12:15], a[164:167], a[124:127], a[12:15]
 ds_read_b64_tr_b16 a[36:37], v1 offset:8192
 ds_read_b64_tr_b16 a[38:39], v1 offset:9216
M a[12:15], a[160:163], a[120:123], a[12:15]
M a[16:19], a[160:163], a[128:131], a[16:19]
 buffer_load_dwordx4 v17, s[56:59], s29 offen offset:1024   lds
M a[16:19], a[164:167], a[132:135], a[16:19]
M a[20:23], a[164:167], a[140:143], a[20:23]
M a[20:23], a[160:163], a[136:139], a[20:23]
 ds_read_b64_tr_b16 a[40:41], v2 offset:0
 ds_read_b64_tr_b16 a[42:43], v2 offset:1024
M a[24:27], a[160:163], a[144:147], a[24:27]
M a[24:27], a[164:167], a[148:151], a[24:27]
 s_waitcnt lgkmcnt(6)
 buffer_load_dwordx4 v18, s[56:59], s29 offen offset:2048   lds
M a[28:31], a[164:167], a[156:159], a[28:31]
M a[28:31], a[160:163], a[152:155], a[28:31]
M v[32:35], a[168:171], a[96:99], v[32:35]
 ds_read_b128 a[160:163], v5 offset:36864
 ds_read_b128 a[164:167], v6 offset:36864
M v[32:35], a[172:175], a[100:103], v[32:35]
 ds_read_b64_tr_b16 a[44:45], v2 offset:8192
 ds_read_b64_tr_b16 a[46:47], v2 offset:9216
M v[36:39], a[172:175], a[108:111], v[36:39]
 buffer_load_dwordx4 v19, s[56:59], s29 offen offset:3072   lds
M v[36:39], a[168:171], a[104:107], v[36:39]
 s_add_u32 s29, s29, 128
M v[40:43], a[168:171], a[112:115], v[40:43]
M v[40:43], a[172:175], a[116:119], v[40:43]
 ds_read_b64_tr_b16 a[48:49], v3 offset:0
 ds_read_b64_tr_b16 a[50:51], v3 offset:1024
M v[44:47], a[172:175], a[124:127], v[44:47]
 s_add_u32 m0, s23, 49152
 v_accvgpr_read_b32 v24, a0
 v_accvgpr_read_b32 v25, a1
M v[44:47], a[168:171], a[120:123], v[44:47]
 buffer_load_dwordx4 v8, s[52:55], s28 offen offset:0   lds
M v[48:51], a[168:171], a[128:131], v[48:51]
 v_accvgpr_read_b32 v26, a2
 v_accvgpr_read_b32 v27, a3
M v[48:51], a[172:175], a[132:135], v[48:51]
 v_cvt_pk_bf16_f32 v24, v24, v25
 v_cvt_pk_bf16_f32 v25, v26, v27
M v[52:55], a[172:175], a[140:143], v[52:55]
 ds_read_b64_tr_b16 a[52:53], v3 offset:8192
 ds_read_b64_tr_b16 a[54:55], v3 offset:9216
M v[52:55], a[168:171], a[136:139], v[52:55]
 v_cvt_pk_bf16_f32 v26, v32, v33
 v_cvt_pk_bf16_f32 v27, v34, v35
M v[56:59], a[168:171], a[144:147], v[56:59]
 s_add_u32 s3, s93, 0
 buffer_load_dwordx4 v9, s[52:55], s28 offen offset:1024   lds
M v[56:59], a[172:175], a[148:151], v[56:59]
 s_waitcnt lgkmcnt(6)
M v[60:63], a[172:175], a[156:159], v[60:63]
 buffer_store_dwordx4 v[24:27], v7, s[8:11], s3 offen offset:0 sc1
M v[60:63], a[168:171], a[152:155], v[60:63]
 ds_read_b64_tr_b16 a[56:57], v4 offset:0
 ds_read_b64_tr_b16 a[58:59], v4 offset:1024
M v[64:67], a[160:163], a[96:99], v[64:67]
 ds_read_b128 a[168:171], v5 offset:38912
 ds_read_b128 a[172:175], v6 offset:38912
M v[64:67], a[164:167], a[100:103], v[64:67]
 buffer_load_dwordx4 v10, s[52:55], s28 offen offset:2048   lds
M v[68:71], a[164:167], a[108:111], v[68:71]
 v_accvgpr_read_b32 v24, a4
 v_accvgpr_read_b32 v25, a5
M v[68:71], a[160:163], a[104:107], v[68:71]
 v_accvgpr_read_b32 v26, a6
 v_accvgpr_read_b32 v27, a7
M v[72:75], a[160:163], a[112:115], v[72:75]
 ds_read_b64_tr_b16 a[60:61], v4 offset:8192
 ds_read_b64_tr_b16 a[62:63], v4 offset:9216
M v[72:75], a[164:167], a[116:119], v[72:75]
 v_cvt_pk_bf16_f32 v24, v24, v25
 v_cvt_pk_bf16_f32 v25, v26, v27
M v[76:79], a[164:167], a[124:127], v[76:79]
 buffer_load_dwordx4 v11, s[52:55], s28 offen offset:3072   lds
M v[76:79], a[160:163], a[120:123], v[76:79]
 s_add_u32 s28, s28, 1048448
 v_cvt_pk_bf16_f32 v26, v36, v37
 v_cvt_pk_bf16_f32 v27, v38, v39
M v[80:83], a[160:163], a[128:131], v[80:83]
M v[80:83], a[164:167], a[132:135], v[80:83]
M v[84:87], a[164:167], a[140:143], v[84:87]
 buffer_store_dwordx4 v[24:27], v7, s[8:11], s3 offen offset:2048 sc1
M v[84:87], a[160:163], a[136:139], v[84:87]
M v[88:91], a[160:163], a[144:147], v[88:91]
M v[88:91], a[164:167], a[148:151], v[88:91]
 s_waitcnt lgkmcnt(2)
M v[92:95], a[164:167], a[156:159], v[92:95]
 s_waitcnt vmcnt(26) lgkmcnt(0)
 v_accvgpr_read_b32 v24, a8
 v_accvgpr_read_b32 v25, a9
M v[92:95], a[160:163], a[152:155], v[92:95]
 s_barrier
M v[96:99], a[168:171], a[96:99], v[96:99]
 ds_read_b128 a[160:163], v5 offset:49152
 ds_read_b128 a[164:167], v6 offset:49152
M v[96:99], a[172:175], a[100:103], v[96:99]
 v_accvgpr_read_b32 v26, a10
 v_accvgpr_read_b32 v27, a11
M v[100:103], a[172:175], a[108:111], v[100:103]
 s_add_u32 m0, s24, 32768
 ds_read_b64_tr_b16 a[64:65], v1 offset:16384
 ds_read_b64_tr_b16 a[66:67], v1 offset:17408
M v[100:103], a[168:171], a[104:107], v[100:103]
 buffer_load_dwordx4 v16, s[56:59], s29 offen offset:0   lds
M v[104:107], a[168:171], a[112:115], v[104:107]
 v_cvt_pk_bf16_f32 v24, v24, v25
 v_cvt_pk_bf16_f32 v25, v26, v27
M v[104:107], a[172:175], a[116:119], v[104:107]
 v_cvt_pk_bf16_f32 v26, v40, v41
 v_cvt_pk_bf16_f32 v27, v42, v43
M v[108:111], a[172:175], a[124:127], v[108:111]
 s_add_u32 s3, s93, 4096
 buffer_store_dwordx4 v[24:27], v7, s[8:11], s3 offen offset:0 sc1
M v[108:111], a[168:171], a[120:123], v[108:111]
 v_cvt_pk_bf16_f32 v64, v64, v65
 v_cvt_pk_bf16_f32 v65, v66, v67
M v[112:115], a[168:171], a[128:131], v[112:115]
 v_cvt_pk_bf16_f32 v66, v96, v97
 v_cvt_pk_bf16_f32 v67, v98, v99
M v[112:115], a[172:175], a[132:135], v[112:115]
 ds_read_b64_tr_b16 a[68:69], v1 offset:24576
 ds_read_b64_tr_b16 a[70:71], v1 offset:25600
M v[116:119], a[172:175], a[140:143], v[116:119]
 buffer_load_dwordx4 v17, s[56:59], s29 offen offset:1024   lds
M v[116:119], a[168:171], a[136:139], v[116:119]
 v_accvgpr_read_b32 v24, a12
 v_accvgpr_read_b32 v25, a13
M v[120:123], a[168:171], a[144:147], v[120:123]
 v_accvgpr_read_b32 v26, a14
 v_accvgpr_read_b32 v27, a15
M v[120:123], a[172:175], a[148:151], v[120:123]
 s_waitcnt lgkmcnt(4)
 v_cvt_pk_bf16_f32 v24, v24, v25
 v_cvt_pk_bf16_f32 v25, v26, v27
M v[124:127], a[172:175], a[156:159], v[124:127]
 v_cvt_pk_bf16_f32 v26, v44, v45
 v_cvt_pk_bf16_f32 v27, v46, v47
M v[124:127], a[168:171], a[152:155], v[124:127]
 buffer_store_dwordx4 v[24:27], v7, s[8:11], s3 offen offset:2048 sc1
M v[128:131], a[160:163], a[96:99], v[128:131]
 ds_read_b128 a[168:171], v5 offset:51200
 ds_read_b128 a[172:175], v6 offset:51200
M v[128:131], a[164:167], a[100:103], v[128:131]
 ds_read_b64_tr_b16 a[72:73], v2 offset:16384
 ds_read_b64_tr_b16 a[74:75], v2 offset:17408
M v[132:135], a[164:167], a[108:111], v[132:135]
 buffer_load_dwordx4 v18, s[56:59], s29 offen offset:2048   lds
M v[132:135], a[160:163], a[104:107], v[132:135]
 v_cvt_pk_bf16_f32 v68, v68, v69
 v_cvt_pk_bf16_f32 v69, v70, v71
M v[136:139], a[160:163], a[112:115], v[136:139]
 v_cvt_pk_bf16_f32 v70, v100, v101
 v_cvt_pk_bf16_f32 v71, v102, v103
M v[136:139], a[164:167], a[116:119], v[136:139]
 v_cvt_pk_bf16_f32 v72, v72, v73
 v_cvt_pk_bf16_f32 v73, v74, v75
M v[140:143], a[164:167], a[124:127], v[140:143]
 v_accvgpr_read_b32 v24, a16
 v_accvgpr_read_b32 v25, a17
M v[140:143], a[160:163], a[120:123], v[140:143]
 ds_read_b64_tr_b16 a[76:77], v2 offset:24576
 ds_read_b64_tr_b16 a[78:79], v2 offset:25600
M v[144:147], a[160:163], a[128:131], v[144:147]
 buffer_load_dwordx4 v19, s[56:59], s29 offen offset:3072   lds
M v[144:147], a[164:167], a[132:135], v[144:147]
 s_add_u32 s29, s29, 128
 v_accvgpr_read_b32 v26, a18
 v_accvgpr_read_b32 v27, a19
M v[148:151], a[164:167], a[140:143], v[148:151]
 v_cvt_pk_bf16_f32 v24, v24, v25
 v_cvt_pk_bf16_f32 v25, v26, v27
M v[148:151], a[160:163], a[136:139], v[148:151]
 v_cvt_pk_bf16_f32 v26, v48, v49
 v_cvt_pk_bf16_f32 v27, v50, v51
M v[152:155], a[160:163], a[144:147], v[152:155]
 s_add_u32 s3, s93, 8192
 buffer_store_dwordx4 v[24:27], v7, s[8:11], s3 offen offset:0 sc1
M v[152:155], a[164:167], a[148:151], v[152:155]
 s_waitcnt lgkmcnt(4)
 v_cvt_pk_bf16_f32 v74, v104, v105
 v_cvt_pk_bf16_f32 v75, v106, v107
M v[156:159], a[164:167], a[156:159], v[156:159]
 s_add_u32 m0, s23, 0
 ds_read_b64_tr_b16 a[80:81], v3 offset:16384
 ds_read_b64_tr_b16 a[82:83], v3 offset:17408
M v[156:159], a[160:163], a[152:155], v[156:159]
 buffer_load_dwordx4 v8, s[52:55], s28 offen offset:0   lds
M v[160:163], a[168:171], a[96:99], v[160:163]
 ds_read_b128 a[160:163], v5 offset:53248
 ds_read_b128 a[164:167], v6 offset:53248
M v[160:163], a[172:175], a[100:103], v[160:163]
 v_cvt_pk_bf16_f32 v76, v76, v77
 v_cvt_pk_bf16_f32 v77, v78, v79
M v[164:167], a[172:175], a[108:111], v[164:167]
 v_accvgpr_read_b32 v24, a20
 v_accvgpr_read_b32 v25, a21
M v[164:167], a[168:171], a[104:107], v[164:167]
 v_accvgpr_read_b32 v26, a22
 v_accvgpr_read_b32 v27, a23
M v[168:171], a[168:171], a[112:115], v[168:171]
 v_cvt_pk_bf16_f32 v24, v24, v25
 v_cvt_pk_bf16_f32 v25, v26, v27
M v[168:171], a[172:175], a[116:119], v[168:171]
 ds_read_b64_tr_b16 a[84:85], v3 offset:24576
 ds_read_b64_tr_b16 a[86:87], v3 offset:25600
M v[172:175], a[172:175], a[124:127], v[172:175]
 buffer_load_dwordx4 v9, s[52:55], s28 offen offset:1024   lds
M v[172:175], a[168:171], a[120:123], v[172:175]
 v_cvt_pk_bf16_f32 v26, v52, v53
 v_cvt_pk_bf16_f32 v27, v54, v55
M v[176:179], a[168:171], a[128:131], v[176:179]
 v_cvt_pk_bf16_f32 v78, v108, v109
 v_cvt_pk_bf16_f32 v79, v110, v111
M v[176:179], a[172:175], a[132:135], v[176:179]
 buffer_store_dwordx4 v[24:27], v7, s[8:11], s3 offen offset:2048 sc1
M v[180:183], a[172:175], a[140:143], v[180:183]
 v_cvt_pk_bf16_f32 v80, v80, v81
 v_cvt_pk_bf16_f32 v81, v82, v83
M v[180:183], a[168:171], a[136:139], v[180:183]
 v_cvt_pk_bf16_f32 v82, v112, v113
 v_cvt_pk_bf16_f32 v83, v114, v115
M v[184:187], a[168:171], a[144:147], v[184:187]
 ds_read_b64_tr_b16 a[88:89], v4 offset:16384
 ds_read_b64_tr_b16 a[90:91], v4 offset:17408
M v[184:187], a[172:175], a[148:151], v[184:187]
 s_waitcnt lgkmcnt(4)
 buffer_load_dwordx4 v10, s[52:55], s28 offen offset:2048   lds
M v[188:191], a[172:175], a[156:159], v[188:191]
 v_accvgpr_read_b32 v24, a24
 v_accvgpr_read_b32 v25, a25
M v[188:191], a[168:171], a[152:155], v[188:191]
 v_accvgpr_read_b32 v26, a26
 v_accvgpr_read_b32 v27, a27
M v[192:195], a[160:163], a[96:99], v[192:195]
 ds_read_b128 a[168:171], v5 offset:55296
 ds_read_b128 a[172:175], v6 offset:55296
M v[192:195], a[164:167], a[100:103], v[192:195]
 v_cvt_pk_bf16_f32 v24, v24, v25
 v_cvt_pk_bf16_f32 v25, v26, v27
M v[196:199], a[164:167], a[108:111], v[196:199]
 v_cvt_pk_bf16_f32 v26, v56, v57
 v_cvt_pk_bf16_f32 v27, v58, v59
M v[196:199], a[160:163], a[104:107], v[196:199]
 s_add_u32 s3, s93, 12288
 ds_read_b64_tr_b16 a[92:93], v4 offset:24576
 ds_read_b64_tr_b16 a[94:95], v4 offset:25600
M v[200:203], a[160:163], a[112:115], v[200:203]
 buffer_load_dwordx4 v11, s[52:55], s28 offen offset:3072   lds
M v[200:203], a[164:167], a[116:119], v[200:203]
 s_add_u32 s28, s28, 128
 v_cvt_pk_bf16_f32 v84, v84, v85
 v_cvt_pk_bf16_f32 v85, v86, v87
M v[204:207], a[164:167], a[124:127], v[204:207]
 v_cvt_pk_bf16_f32 v86, v116, v117
 v_cvt_pk_bf16_f32 v87, v118, v119
M v[204:207], a[160:163], a[120:123], v[204:207]
 v_cvt_pk_bf16_f32 v88, v88, v89
 v_cvt_pk_bf16_f32 v89, v90, v91
M v[208:211], a[160:163], a[128:131], v[208:211]
 buffer_store_dwordx4 v[24:27], v7, s[8:11], s3 offen offset:0 sc1
M v[208:211], a[164:167], a[132:135], v[208:211]
 v_cvt_pk_bf16_f32 v90, v120, v121
 v_cvt_pk_bf16_f32 v91, v122, v123
M v[212:215], a[164:167], a[140:143], v[212:215]
 v_accvgpr_read_b32 v24, a28
 v_accvgpr_read_b32 v25, a29
M v[212:215], a[160:163], a[136:139], v[212:215]
 v_accvgpr_read_b32 v26, a30
 v_accvgpr_read_b32 v27, a31
M v[216:219], a[160:163], a[144:147], v[216:219]
 v_cvt_pk_bf16_f32 v24, v24, v25
 v_cvt_pk_bf16_f32 v25, v26, v27
M v[216:219], a[164:167], a[148:151], v[216:219]
 s_waitcnt lgkmcnt(2)
 v_cvt_pk_bf16_f32 v26, v60, v61
 v_cvt_pk_bf16_f32 v27, v62, v63
M v[220:223], a[164:167], a[156:159], v[220:223]
 s_waitcnt vmcnt(27) lgkmcnt(0)
 buffer_store_dwordx4 v[24:27], v7, s[8:11], s3 offen offset:2048 sc1
M v[220:223], a[160:163], a[152:155], v[220:223]
 s_barrier
M v[224:227], a[168:171], a[96:99], v[224:227]
 ds_read_b128 a[160:163], v5 offset:0
 ds_read_b128 a[164:167], v6 offset:0
M v[224:227], a[172:175], a[100:103], v[224:227]
 v_cvt_pk_bf16_f32 v92, v92, v93
 v_cvt_pk_bf16_f32 v93, v94, v95
M v[228:231], a[172:175], a[108:111], v[228:231]
 v_cvt_pk_bf16_f32 v94, v124, v125
 v_cvt_pk_bf16_f32 v95, v126, v127
M v[228:231], a[168:171], a[104:107], v[228:231]
 v_cvt_pk_bf16_f32 v128, v128, v129
 v_cvt_pk_bf16_f32 v129, v130, v131
M v[232:235], a[168:171], a[112:115], v[232:235]
 v_cvt_pk_bf16_f32 v130, v160, v161
 v_cvt_pk_bf16_f32 v131, v162, v163
M v[232:235], a[172:175], a[116:119], v[232:235]
 v_cvt_pk_bf16_f32 v132, v132, v133
 v_cvt_pk_bf16_f32 v133, v134, v135
M v[236:239], a[172:175], a[124:127], v[236:239]
 v_cvt_pk_bf16_f32 v134, v164, v165
 v_cvt_pk_bf16_f32 v135, v166, v167
M v[236:239], a[168:171], a[120:123], v[236:239]
 v_cvt_pk_bf16_f32 v136, v136, v137
 v_cvt_pk_bf16_f32 v137, v138, v139
M v[240:243], a[168:171], a[128:131], v[240:243]
 v_cvt_pk_bf16_f32 v138, v168, v169
 v_cvt_pk_bf16_f32 v139, v170, v171
M v[240:243], a[172:175], a[132:135], v[240:243]
 v_cvt_pk_bf16_f32 v140, v140, v141
 v_cvt_pk_bf16_f32 v141, v142, v143
M v[244:247], a[172:175], a[140:143], v[244:247]
 v_cvt_pk_bf16_f32 v142, v172, v173
 v_cvt_pk_bf16_f32 v143, v174, v175
M v[244:247], a[168:171], a[136:139], v[244:247]
 v_cvt_pk_bf16_f32 v144, v144, v145
 v_cvt_pk_bf16_f32 v145, v146, v147
M v[248:251], a[168:171], a[144:147], v[248:251]
 v_cvt_pk_bf16_f32 v146, v176, v177
 v_cvt_pk_bf16_f32 v147, v178, v179
M v[248:251], a[172:175], a[148:151], v[248:251]
 s_waitcnt lgkmcnt(0)
 v_cvt_pk_bf16_f32 v148, v148, v149
 v_cvt_pk_bf16_f32 v149, v150, v151
M v[252:255], a[172:175], a[156:159], v[252:255]
 v_cvt_pk_bf16_f32 v150, v180, v181
 v_cvt_pk_bf16_f32 v151, v182, v183
M v[252:255], a[168:171], a[152:155], v[252:255]
 v_cvt_pk_bf16_f32 v152, v152, v153
 v_cvt_pk_bf16_f32 v153, v154, v155
M v[32:35], a[32:35], a[160:163], 0
 s_add_u32 m0, s23, 16384
 ds_read_b128 a[168:171], v5 offset:2048
 ds_read_b128 a[172:175], v6 offset:2048
M v[32:35], a[36:39], a[164:167], v[32:35]
 ds_read_b64_tr_b16 a[96:97], v1 offset:32768
 ds_read_b64_tr_b16 a[98:99], v1 offset:33792
M v[36:39], a[44:47], a[164:167], 0
 buffer_load_dwordx4 v8, s[52:55], s28 offen offset:0   lds
M v[36:39], a[40:43], a[160:163], v[36:39]
 v_cvt_pk_bf16_f32 v154, v184, v185
 v_cvt_pk_bf16_f32 v155, v186, v187
M v[40:43], a[48:51], a[160:163], 0
 ds_read_b64_tr_b16 a[100:101], v1 offset:40960
 ds_read_b64_tr_b16 a[102:103], v1 offset:41984
M v[40:43], a[52:55], a[164:167], v[40:43]
 buffer_load_dwordx4 v9, s[52:55], s28 offen offset:1024   lds
M v[44:47], a[60:63], a[164:167], 0
 v_cvt_pk_bf16_f32 v156, v156, v157
 v_cvt_pk_bf16_f32 v157, v158, v159
M v[44:47], a[56:59], a[160:163], v[44:47]
 ds_read_b64_tr_b16 a[104:105], v2 offset:32768
 ds_read_b64_tr_b16 a[106:107], v2 offset:33792
M v[48:51], a[64:67], a[160:163], 0
 v_cvt_pk_bf16_f32 v158, v188, v189
 v_cvt_pk_bf16_f32 v159, v190, v191
M v[48:51], a[68:71], a[164:167], v[48:51]
 v_cvt_pk_bf16_f32 v192, v192, v193
 v_cvt_pk_bf16_f32 v193, v194, v195
M v[52:55], a[76:79], a[164:167], 0
 ds_read_b64_tr_b16 a[108:109], v2 offset:40960
 ds_read_b64_tr_b16 a[110:111], v2 offset:41984
M v[52:55], a[72:75], a[160:163], v[52:55]
 buffer_load_dwordx4 v10, s[52:55], s28 offen offset:2048   lds
M v[56:59], a[80:83], a[160:163], 0
 v_cvt_pk_bf16_f32 v194, v224, v225
 v_cvt_pk_bf16_f32 v195, v226, v227
M v[56:59], a[84:87], a[164:167], v[56:59]
 s_waitcnt lgkmcnt(8)
 ds_read_b64_tr_b16 a[112:113], v3 offset:32768
 ds_read_b64_tr_b16 a[114:115], v3 offset:33792
M v[60:63], a[92:95], a[164:167], 0
 v_cvt_pk_bf16_f32 v196, v196, v197
 v_cvt_pk_bf16_f32 v197, v198, v199
M v[60:63], a[88:91], a[160:163], v[60:63]
 buffer_load_dwordx4 v11, s[52:55], s28 offen offset:3072   lds
M v[96:99], a[32:35], a[168:171], 0
 s_add_u32 s28, s28, 524160
 ds_read_b128 a[160:163], v5 offset:4096
 ds_read_b128 a[164:167], v6 offset:4096
M v[96:99], a[36:39], a[172:175], v[96:99]
 ds_read_b64_tr_b16 a[116:117], v3 offset:40960
 ds_read_b64_tr_b16 a[118:119], v3 offset:41984
M v[100:103], a[44:47], a[172:175], 0
 v_cvt_pk_bf16_f32 v198, v228, v229
 v_cvt_pk_bf16_f32 v199, v230, v231
M v[100:103], a[40:43], a[168:171], v[100:103]
 s_add_u32 m0, s24, 49152
 ds_read_b64_tr_b16 a[120:121], v4 offset:32768
 ds_read_b64_tr_b16 a[122:123], v4 offset:33792
M v[104:107], a[48:51], a[168:171], 0
 buffer_load_dwordx4 v16, s[56:59], s29 offen offset:0   lds
M v[104:107], a[52:55], a[172:175], v[104:107]
 v_cvt_pk_bf16_f32 v200, v200, v201
 v_cvt_pk_bf16_f32 v201, v202, v203
M v[108:111], a[60:63], a[172:175], 0
 ds_read_b64_tr_b16 a[124:125], v4 offset:40960
 ds_read_b64_tr_b16 a[126:127], v4 offset:41984
M v[108:111], a[56:59], a[168:171], v[108:111]
 v_cvt_pk_bf16_f32 v202, v232, v233
 v_cvt_pk_bf16_f32 v203, v234, v235
M v[112:115], a[64:67], a[168:171], 0
 v_cvt_pk_bf16_f32 v204, v204, v205
 v_cvt_pk_bf16_f32 v205, v206, v207
M v[112:115], a[68:71], a[172:175], v[112:115]
 buffer_load_dwordx4 v17, s[56:59], s29 offen offset:1024   lds
M v[116:119], a[76:79], a[172:175], 0
 v_cvt_pk_bf16_f32 v206, v236, v237
 v_cvt_pk_bf16_f32 v207, v238, v239
M v[116:119], a[72:75], a[168:171], v[116:119]
 v_cvt_pk_bf16_f32 v208, v208, v209
 v_cvt_pk_bf16_f32 v209, v210, v211
M v[120:123], a[80:83], a[168:171], 0
 v_cvt_pk_bf16_f32 v210, v240, v241
 v_cvt_pk_bf16_f32 v211, v242, v243
M v[120:123], a[84:87], a[172:175], v[120:123]
 s_waitcnt lgkmcnt(6)
 v_cvt_pk_bf16_f32 v212, v212, v213
 v_cvt_pk_bf16_f32 v213, v214, v215
M v[124:127], a[92:95], a[172:175], 0
 s_waitcnt vmcnt(21) lgkmcnt(0)
 buffer_load_dwordx4 v18, s[56:59], s29 offen offset:2048   lds
M v[124:127], a[88:91], a[168:171], v[124:127]
 s_barrier
M v[160:163], a[32:35], a[160:163], 0
 ds_read_b128 a[168:171], v5 offset:6144
 ds_read_b128 a[172:175], v6 offset:6144
M v[160:163], a[36:39], a[164:167], v[160:163]
 ds_read_b64_tr_b16 a[128:129], v1 offset:49152
 ds_read_b64_tr_b16 a[130:131], v1 offset:50176
M v[164:167], a[44:47], a[164:167], 0
 v_cvt_pk_bf16_f32 v214, v244, v245
 v_cvt_pk_bf16_f32 v215, v246, v247
M v[164:167], a[40:43], a[160:163], v[164:167]
 buffer_load_dwordx4 v19, s[56:59], s29 offen offset:3072   lds
M v[168:171], a[48:51], a[160:163], 0
 s_add_u32 s29, s29, 128
 ds_read_b64_tr_b16 a[132:133], v1 offset:57344
 ds_read_b64_tr_b16 a[134:135], v1 offset:58368
M v[168:171], a[52:55], a[164:167], v[168:171]
 v_cvt_pk_bf16_f32 v216, v216, v217
 v_cvt_pk_bf16_f32 v217, v218, v219
M v[172:175], a[60:63], a[164:167], 0
 v_cvt_pk_bf16_f32 v218, v248, v249
 v_cvt_pk_bf16_f32 v219, v250, v251
M v[172:175], a[56:59], a[160:163], v[172:175]
 s_add_u32 m0, s23, 32768
 ds_read_b64_tr_b16 a[136:137], v2 offset:49152
 ds_read_b64_tr_b16 a[138:139], v2 offset:50176
M v[176:179], a[64:67], a[160:163], 0
 buffer_load_dwordx4 v8, s[52:55], s28 offen offset:0   lds
M v[176:179], a[68:71], a[164:167], v[176:179]
 v_cvt_pk_bf16_f32 v220, v220, v221
 v_cvt_pk_bf16_f32 v221, v222, v223
M v[180:183], a[76:79], a[164:167], 0
 ds_read_b64_tr_b16 a[140:141], v2 offset:57344
 ds_read_b64_tr_b16 a[142:143], v2 offset:58368
M v[180:183], a[72:75], a[160:163], v[180:183]
 v_cvt_pk_bf16_f32 v222, v252, v253
 v_cvt_pk_bf16_f32 v223, v254, v255
M v[184:187], a[80:83], a[160:163], 0
 s_add_u32 s3, s93, 262144
 v_mov_b32 v12, 1
 v_or_b32 v15, s20, v0
M v[184:187], a[84:87], a[164:167], v[184:187]
 s_waitcnt lgkmcnt(8)
 ds_read_b64_tr_b16 a[144:145], v3 offset:49152
 ds_read_b64_tr_b16 a[146:147], v3 offset:50176
M v[188:191], a[92:95], a[164:167], 0
 buffer_load_dwordx4 v9, s[52:55], s28 offen offset:1024   lds
M v[188:191], a[88:91], a[160:163], v[188:191]
 v_min_u32 v15, 1, v15
 v_lshlrev_b32 v15, 29, v15
M v[224:227], a[32:35], a[168:171], 0
 ds_read_b128 a[160:163], v5 offset:16384
 ds_read_b128 a[164:167], v6 offset:16384
M v[224:227], a[36:39], a[172:175], v[224:227]
 ds_read_b64_tr_b16 a[148:149], v3 offset:57344
 ds_read_b64_tr_b16 a[150:151], v3 offset:58368
M v[228:231], a[44:47], a[172:175], 0
 buffer_load_dwordx4 v10, s[52:55], s28 offen offset:2048   lds
M v[228:231], a[40:43], a[168:171], v[228:231]
 ds_read_b64_tr_b16 a[152:153], v4 offset:49152
 ds_read_b64_tr_b16 a[154:155], v4 offset:50176
M v[232:235], a[48:51], a[168:171], 0
 buffer_store_dwordx4 v[64:67], v7, s[8:11], s3 offen offset:0 sc1
M v[232:235], a[52:55], a[172:175], v[232:235]
M v[236:239], a[60:63], a[172:175], 0
 ds_read_b64_tr_b16 a[156:157], v4 offset:57344
 ds_read_b64_tr_b16 a[158:159], v4 offset:58368
M v[236:239], a[56:59], a[168:171], v[236:239]
 buffer_load_dwordx4 v11, s[52:55], s28 offen offset:3072   lds
M v[240:243], a[64:67], a[168:171], 0
 s_add_u32 s28, s28, 128
M v[240:243], a[68:71], a[172:175], v[240:243]
 buffer_store_dwordx4 v[68:71], v7, s[8:11], s3 offen offset:2048 sc1
M v[244:247], a[76:79], a[172:175], 0
M v[244:247], a[72:75], a[168:171], v[244:247]
M v[248:251], a[80:83], a[168:171], 0
M v[248:251], a[84:87], a[172:175], v[248:251]
 s_waitcnt lgkmcnt(6)
M v[252:255], a[92:95], a[172:175], 0
 s_waitcnt vmcnt(14) lgkmcnt(0)
M v[252:255], a[88:91], a[168:171], v[252:255]
 s_barrier
M v[32:35], a[96:99], a[160:163], v[32:35]
 s_add_u32 m0, s23, 49152
 ds_read_b128 a[168:171], v5 offset:18432
 ds_read_b128 a[172:175], v6 offset:18432
M v[32:35], a[100:103], a[164:167], v[32:35]
 ds_read_b64_tr_b16 a[32:33], v20 offset:0
 ds_read_b64_tr_b16 a[34:35], v20 offset:1024
M v[36:39], a[108:111], a[164:167], v[36:39]
 s_mov_b32 s39, 1347
 buffer_load_dwordx4 v8, s[52:55], s28 offen offset:0   lds
M v[36:39], a[104:107], a[160:163], v[36:39]
 s_cmp_lt_u32 s42, 2
 buffer_store_dword v12, v15, s[8:11], s45 offen sc1
M v[40:43], a[112:115], a[160:163], v[40:43]
 s_cselect_b32 s39, 1284, s39
 ds_read_b64_tr_b16 a[36:37], v20 offset:8192
 ds_read_b64_tr_b16 a[38:39], v20 offset:9216
M v[40:43], a[116:119], a[164:167], v[40:43]
 s_lshl_b32 s64, s20, 14
 buffer_load_dwordx4 v9, s[52:55], s28 offen offset:1024   lds
M v[44:47], a[124:127], a[164:167], v[44:47]
 s_add_u32 s12, s64, s34
 s_add_u32 s3, s93, 266240
M v[44:47], a[120:123], a[160:163], v[44:47]
 s_add_u32 s13, s12, 4096
 ds_read_b64_tr_b16 a[40:41], v21 offset:0
 ds_read_b64_tr_b16 a[42:43], v21 offset:1024
M v[48:51], a[128:131], a[160:163], v[48:51]
 s_add_u32 s14, s12, 8192
 buffer_store_dwordx4 v[72:75], v7, s[8:11], s3 offen offset:0 sc1
M v[48:51], a[132:135], a[164:167], v[48:51]
 s_add_u32 s15, s12, 12288
M v[52:55], a[140:143], a[164:167], v[52:55]
 ds_read_b64_tr_b16 a[44:45], v21 offset:8192
 ds_read_b64_tr_b16 a[46:47], v21 offset:9216
M v[52:55], a[136:139], a[160:163], v[52:55]
 buffer_load_dwordx4 v10, s[52:55], s28 offen offset:2048   lds
M v[56:59], a[144:147], a[160:163], v[56:59]
M v[56:59], a[148:151], a[164:167], v[56:59]
 s_waitcnt lgkmcnt(8)
 ds_read_b64_tr_b16 a[48:49], v22 offset:0
 ds_read_b64_tr_b16 a[50:51], v22 offset:1024
M v[60:63], a[156:159], a[164:167], v[60:63]
M v[60:63], a[152:155], a[160:163], v[60:63]
 buffer_load_dwordx4 v11, s[52:55], s28 offen offset:3072   lds
M v[96:99], a[96:99], a[168:171], v[96:99]
 s_add_u32 s28, s28, 524160
 ds_read_b128 a[160:163], v5 offset:20480
 ds_read_b128 a[164:167], v6 offset:20480
M v[96:99], a[100:103], a[172:175], v[96:99]
 ds_read_b64_tr_b16 a[52:53], v22 offset:8192
 ds_read_b64_tr_b16 a[54:55], v22 offset:9216
M v[100:103], a[108:111], a[172:175], v[100:103]
M v[100:103], a[104:107], a[168:171], v[100:103]
 s_add_u32 m0, s24, 0
 ds_read_b64_tr_b16 a[56:57], v23 offset:0
 ds_read_b64_tr_b16 a[58:59], v23 offset:1024
M v[104:107], a[112:115], a[168:171], v[104:107]
 buffer_load_dwordx4 v16, s[56:59], s29 offen offset:0   lds
M v[104:107], a[116:119], a[172:175], v[104:107]
M v[108:111], a[124:127], a[172:175], v[108:111]
 ds_read_b64_tr_b16 a[60:61], v23 offset:8192
 ds_read_b64_tr_b16 a[62:63], v23 offset:9216
M v[108:111], a[120:123], a[168:171], v[108:111]
M v[112:115], a[128:131], a[168:171], v[112:115]
M v[112:115], a[132:135], a[172:175], v[112:115]
 buffer_load_dwordx4 v17, s[56:59], s29 offen offset:1024   lds
M v[116:119], a[140:143], a[172:175], v[116:119]
M v[116:119], a[136:139], a[168:171], v[116:119]
M v[120:123], a[144:147], a[168:171], v[120:123]
M v[120:123], a[148:151], a[172:175], v[120:123]
 s_waitcnt lgkmcnt(6)
M v[124:127], a[156:159], a[172:175], v[124:127]
 s_waitcnt lgkmcnt(0)
 buffer_load_dwordx4 v18, s[56:59], s29 offen offset:2048   lds
M v[124:127], a[152:155], a[168:171], v[124:127]
 s_barrier
M v[160:163], a[96:99], a[160:163], v[160:163]
 ds_read_b128 a[168:171], v5 offset:22528
 ds_read_b128 a[172:175], v6 offset:22528
M v[160:163], a[100:103], a[164:167], v[160:163]
 ds_read_b64_tr_b16 a[64:65], v20 offset:16384
 ds_read_b64_tr_b16 a[66:67], v20 offset:17408
M v[164:167], a[108:111], a[164:167], v[164:167]
M v[164:167], a[104:107], a[160:163], v[164:167]
 buffer_load_dwordx4 v19, s[56:59], s29 offen offset:3072   lds
M v[168:171], a[112:115], a[160:163], v[168:171]
 s_add_u32 s29, s29, 128
 ds_read_b64_tr_b16 a[68:69], v20 offset:24576
 ds_read_b64_tr_b16 a[70:71], v20 offset:25600
M v[168:171], a[116:119], a[164:167], v[168:171]
 buffer_store_dwordx4 v[76:79], v7, s[8:11], s3 offen offset:2048 sc1
M v[172:175], a[124:127], a[164:167], v[172:175]
M v[172:175], a[120:123], a[160:163], v[172:175]
 s_add_u32 m0, s23, 131072
 ds_read_b64_tr_b16 a[72:73], v21 offset:16384
 ds_read_b64_tr_b16 a[74:75], v21 offset:17408
M v[176:179], a[128:131], a[160:163], v[176:179]
 buffer_load_dwordx4 v8, s[52:55], s28 offen offset:0   lds
M v[176:179], a[132:135], a[164:167], v[176:179]
M v[180:183], a[140:143], a[164:167], v[180:183]
 ds_read_b64_tr_b16 a[76:77], v21 offset:24576
 ds_read_b64_tr_b16 a[78:79], v21 offset:25600
M v[180:183], a[136:139], a[160:163], v[180:183]
M v[184:187], a[144:147], a[160:163], v[184:187]
M v[184:187], a[148:151], a[164:167], v[184:187]
 s_waitcnt lgkmcnt(8)
 ds_read_b64_tr_b16 a[80:81], v22 offset:16384
 ds_read_b64_tr_b16 a[82:83], v22 offset:17408
M v[188:191], a[156:159], a[164:167], v[188:191]
 buffer_load_dwordx4 v9, s[52:55], s28 offen offset:1024   lds
M v[188:191], a[152:155], a[160:163], v[188:191]
M v[224:227], a[96:99], a[168:171], v[224:227]
 ds_read_b128 a[160:163], v5 offset:32768
 ds_read_b128 a[164:167], v6 offset:32768
M v[224:227], a[100:103], a[172:175], v[224:227]
 ds_read_b64_tr_b16 a[84:85], v22 offset:24576
 ds_read_b64_tr_b16 a[86:87], v22 offset:25600
M v[228:231], a[108:111], a[172:175], v[228:231]
 buffer_load_dwordx4 v10, s[52:55], s28 offen offset:2048   lds
M v[228:231], a[104:107], a[168:171], v[228:231]
 ds_read_b64_tr_b16 a[88:89], v23 offset:16384
 ds_read_b64_tr_b16 a[90:91], v23 offset:17408
M v[232:235], a[112:115], a[168:171], v[232:235]
M v[232:235], a[116:119], a[172:175], v[232:235]
M v[236:239], a[124:127], a[172:175], v[236:239]
 ds_read_b64_tr_b16 a[92:93], v23 offset:24576
 ds_read_b64_tr_b16 a[94:95], v23 offset:25600
M v[236:239], a[120:123], a[168:171], v[236:239]
 buffer_load_dwordx4 v11, s[52:55], s28 offen offset:3072   lds
M v[240:243], a[128:131], a[168:171], v[240:243]
 s_add_u32 s28, s28, 128
M v[240:243], a[132:135], a[172:175], v[240:243]
M v[244:247], a[140:143], a[172:175], v[244:247]
M v[244:247], a[136:139], a[168:171], v[244:247]
M v[248:251], a[144:147], a[168:171], v[248:251]
M v[248:251], a[148:151], a[172:175], v[248:251]
 s_waitcnt lgkmcnt(6)
M v[252:255], a[156:159], a[172:175], v[252:255]
 s_waitcnt lgkmcnt(0)
M v[252:255], a[152:155], a[168:171], v[252:255]
 s_barrier
M v[32:35], a[32:35], a[160:163], v[32:35]
 s_add_u32 m0, s23, 147456
 ds_read_b128 a[168:171], v5 offset:34816
 ds_read_b128 a[172:175], v6 offset:34816
M v[32:35], a[36:39], a[164:167], v[32:35]
 ds_read_b64_tr_b16 a[96:97], v1 offset:0
 ds_read_b64_tr_b16 a[98:99], v1 offset:1024
M v[36:39], a[44:47], a[164:167], v[36:39]
 buffer_load_dwordx4 v8, s[52:55], s28 offen offset:0   lds
M v[36:39], a[40:43], a[160:163], v[36:39]
 v_and_b32 v29, 15, v0
 v_mul_u32_u24 v30, 1792, v29
M v[40:43], a[48:51], a[160:163], v[40:43]
 s_add_u32 s3, s93, 270336
 ds_read_b64_tr_b16 a[100:101], v1 offset:8192
 ds_read_b64_tr_b16 a[102:103], v1 offset:9216
M v[40:43], a[52:55], a[164:167], v[40:43]
 buffer_load_dwordx4 v9, s[52:55], s28 offen offset:1024   lds
M v[44:47], a[60:63], a[164:167], v[44:47]
 v_lshrrev_b32 v31, 4, v0
 v_lshl_add_u32 v30, v31, 4, v30
M v[44:47], a[56:59], a[160:163], v[44:47]
 ds_read_b64_tr_b16 a[104:105], v2 offset:0
 ds_read_b64_tr_b16 a[106:107], v2 offset:1024
M v[48:51], a[64:67], a[160:163], v[48:51]
 v_lshrrev_b32 v29, 1, v29
 v_min_u32 v29, 1, v29
M v[48:51], a[68:71], a[164:167], v[48:51]
 v_lshl_or_b32 v30, v29, 29, v30
 v_or_b32 v30, s88, v30
M v[52:55], a[76:79], a[164:167], v[52:55]
 s_mul_i32 s89, s86, 3584
 ds_read_b64_tr_b16 a[108:109], v2 offset:8192
 ds_read_b64_tr_b16 a[110:111], v2 offset:9216
M v[52:55], a[72:75], a[160:163], v[52:55]
 s_mul_i32 s64, s20, 448
 buffer_load_dwordx4 v10, s[52:55], s28 offen offset:2048   lds
M v[56:59], a[80:83], a[160:163], v[56:59]
 s_add_u32 s89, s89, s64
 s_add_u32 s89, s89, 105906176
M v[56:59], a[84:87], a[164:167], v[56:59]
 s_waitcnt lgkmcnt(8)
 ds_read_b64_tr_b16 a[112:113], v3 offset:0
 ds_read_b64_tr_b16 a[114:115], v3 offset:1024
M v[60:63], a[92:95], a[164:167], v[60:63]
 buffer_store_dwordx4 v[80:83], v7, s[8:11], s3 offen offset:0 sc1
M v[60:63], a[88:91], a[160:163], v[60:63]
 buffer_load_dwordx4 v11, s[52:55], s28 offen offset:3072   lds
M v[96:99], a[32:35], a[168:171], v[96:99]
 s_add_u32 s28, s28, 524160
 ds_read_b128 a[160:163], v5 offset:36864
 ds_read_b128 a[164:167], v6 offset:36864
M v[96:99], a[36:39], a[172:175], v[96:99]
 ds_read_b64_tr_b16 a[116:117], v3 offset:8192
 ds_read_b64_tr_b16 a[118:119], v3 offset:9216
M v[100:103], a[44:47], a[172:175], v[100:103]
M v[100:103], a[40:43], a[168:171], v[100:103]
 s_add_u32 m0, s24, 16384
 ds_read_b64_tr_b16 a[120:121], v4 offset:0
 ds_read_b64_tr_b16 a[122:123], v4 offset:1024
M v[104:107], a[48:51], a[168:171], v[104:107]
 buffer_load_dwordx4 v16, s[56:59], s29 offen offset:0   lds
M v[104:107], a[52:55], a[172:175], v[104:107]
M v[108:111], a[60:63], a[172:175], v[108:111]
 ds_read_b64_tr_b16 a[124:125], v4 offset:8192
 ds_read_b64_tr_b16 a[126:127], v4 offset:9216
M v[108:111], a[56:59], a[168:171], v[108:111]
M v[112:115], a[64:67], a[168:171], v[112:115]
M v[112:115], a[68:71], a[172:175], v[112:115]
 buffer_load_dwordx4 v17, s[56:59], s29 offen offset:1024   lds
M v[116:119], a[76:79], a[172:175], v[116:119]
M v[116:119], a[72:75], a[168:171], v[116:119]
M v[120:123], a[80:83], a[168:171], v[120:123]
M v[120:123], a[84:87], a[172:175], v[120:123]
 s_waitcnt lgkmcnt(6)
M v[124:127], a[92:95], a[172:175], v[124:127]
 s_waitcnt vmcnt(28) lgkmcnt(0)
 buffer_load_dwordx4 v18, s[56:59], s29 offen offset:2048   lds
M v[124:127], a[88:91], a[168:171], v[124:127]
 s_barrier
M v[160:163], a[32:35], a[160:163], v[160:163]
 ds_read_b128 a[168:171], v5 offset:38912
 ds_read_b128 a[172:175], v6 offset:38912
M v[160:163], a[36:39], a[164:167], v[160:163]
 ds_read_b64_tr_b16 a[128:129], v1 offset:16384
 ds_read_b64_tr_b16 a[130:131], v1 offset:17408
M v[164:167], a[44:47], a[164:167], v[164:167]
M v[164:167], a[40:43], a[160:163], v[164:167]
 buffer_load_dwordx4 v19, s[56:59], s29 offen offset:3072   lds
M v[168:171], a[48:51], a[160:163], v[168:171]
 s_add_u32 s29, s29, 128
 ds_read_b64_tr_b16 a[132:133], v1 offset:24576
 ds_read_b64_tr_b16 a[134:135], v1 offset:25600
M v[168:171], a[52:55], a[164:167], v[168:171]
 buffer_store_dwordx4 v[84:87], v7, s[8:11], s3 offen offset:2048 sc1
M v[172:175], a[60:63], a[164:167], v[172:175]
M v[172:175], a[56:59], a[160:163], v[172:175]
 s_add_u32 m0, s23, 0
 ds_read_b64_tr_b16 a[136:137], v2 offset:16384
 ds_read_b64_tr_b16 a[138:139], v2 offset:17408
M v[176:179], a[64:67], a[160:163], v[176:179]
 buffer_load_dwordx4 v8, s[52:55], s28 offen offset:0   lds
M v[176:179], a[68:71], a[164:167], v[176:179]
M v[180:183], a[76:79], a[164:167], v[180:183]
 ds_read_b64_tr_b16 a[140:141], v2 offset:24576
 ds_read_b64_tr_b16 a[142:143], v2 offset:25600
M v[180:183], a[72:75], a[160:163], v[180:183]
M v[184:187], a[80:83], a[160:163], v[184:187]
M v[184:187], a[84:87], a[164:167], v[184:187]
 s_waitcnt lgkmcnt(8)
 ds_read_b64_tr_b16 a[144:145], v3 offset:16384
 ds_read_b64_tr_b16 a[146:147], v3 offset:17408
M v[188:191], a[92:95], a[164:167], v[188:191]
 buffer_load_dwordx4 v9, s[52:55], s28 offen offset:1024   lds
M v[188:191], a[88:91], a[160:163], v[188:191]
M v[224:227], a[32:35], a[168:171], v[224:227]
 ds_read_b128 a[160:163], v5 offset:49152
 ds_read_b128 a[164:167], v6 offset:49152
M v[224:227], a[36:39], a[172:175], v[224:227]
 ds_read_b64_tr_b16 a[148:149], v3 offset:24576
 ds_read_b64_tr_b16 a[150:151], v3 offset:25600
M v[228:231], a[44:47], a[172:175], v[228:231]
 buffer_load_dwordx4 v10, s[52:55], s28 offen offset:2048   lds
M v[228:231], a[40:43], a[168:171], v[228:231]
 ds_read_b64_tr_b16 a[152:153], v4 offset:16384
 ds_read_b64_tr_b16 a[154:155], v4 offset:17408
M v[232:235], a[48:51], a[168:171], v[232:235]
M v[232:235], a[52:55], a[172:175], v[232:235]
M v[236:239], a[60:63], a[172:175], v[236:239]
 ds_read_b64_tr_b16 a[156:157], v4 offset:24576
 ds_read_b64_tr_b16 a[158:159], v4 offset:25600
M v[236:239], a[56:59], a[168:171], v[236:239]
 buffer_load_dwordx4 v11, s[52:55], s28 offen offset:3072   lds
M v[240:243], a[64:67], a[168:171], v[240:243]
 s_add_u32 s28, s28, 128
M v[240:243], a[68:71], a[172:175], v[240:243]
M v[244:247], a[76:79], a[172:175], v[244:247]
M v[244:247], a[72:75], a[168:171], v[244:247]
M v[248:251], a[80:83], a[168:171], v[248:251]
M v[248:251], a[84:87], a[172:175], v[248:251]
 s_waitcnt lgkmcnt(6)
M v[252:255], a[92:95], a[172:175], v[252:255]
 s_waitcnt vmcnt(30) lgkmcnt(0)
M v[252:255], a[88:91], a[168:171], v[252:255]
 s_barrier
M v[32:35], a[96:99], a[160:163], v[32:35]
 s_add_u32 m0, s23, 16384
 ds_read_b128 a[168:171], v5 offset:51200
 ds_read_b128 a[172:175], v6 offset:51200
M v[32:35], a[100:103], a[164:167], v[32:35]
 ds_read_b64_tr_b16 a[32:33], v1 offset:32768
 ds_read_b64_tr_b16 a[34:35], v1 offset:33792
M v[36:39], a[108:111], a[164:167], v[36:39]
 buffer_load_dwordx4 v8, s[52:55], s28 offen offset:0   lds
M v[36:39], a[104:107], a[160:163], v[36:39]
 v_min_u32 v25, 15, v0
 v_lshlrev_b32 v25, 7, v25
M v[40:43], a[112:115], a[160:163], v[40:43]
 s_add_u32 s3, s93, 274432
 ds_read_b64_tr_b16 a[36:37], v1 offset:40960
 ds_read_b64_tr_b16 a[38:39], v1 offset:41984
M v[40:43], a[116:119], a[164:167], v[40:43]
 v_max_u32 v13, 1024, v25
M v[44:47], a[124:127], a[164:167], v[44:47]
 buffer_store_dwordx4 v[88:91], v7, s[8:11], s3 offen offset:0 sc1
M v[44:47], a[120:123], a[160:163], v[44:47]
 ds_read_b64_tr_b16 a[40:41], v2 offset:32768
 ds_read_b64_tr_b16 a[42:43], v2 offset:33792
M v[48:51], a[128:131], a[160:163], v[48:51]
 buffer_load_dwordx4 v9, s[52:55], s28 offen offset:1024   lds
M v[48:51], a[132:135], a[164:167], v[48:51]
M v[52:55], a[140:143], a[164:167], v[52:55]
 ds_read_b64_tr_b16 a[44:45], v2 offset:40960
 ds_read_b64_tr_b16 a[46:47], v2 offset:41984
M v[52:55], a[136:139], a[160:163], v[52:55]
M v[56:59], a[144:147], a[160:163], v[56:59]
M v[56:59], a[148:151], a[164:167], v[56:59]
 s_waitcnt lgkmcnt(8)
 ds_read_b64_tr_b16 a[48:49], v3 offset:32768
 ds_read_b64_tr_b16 a[50:51], v3 offset:33792
M v[60:63], a[156:159], a[164:167], v[60:63]
 buffer_load_dwordx4 v10, s[52:55], s28 offen offset:2048   lds
M v[60:63], a[152:155], a[160:163], v[60:63]
M v[96:99], a[96:99], a[168:171], v[96:99]
 ds_read_b128 a[160:163], v5 offset:53248
 ds_read_b128 a[164:167], v6 offset:53248
M v[96:99], a[100:103], a[172:175], v[96:99]
 ds_read_b64_tr_b16 a[52:53], v3 offset:40960
 ds_read_b64_tr_b16 a[54:55], v3 offset:41984
M v[100:103], a[108:111], a[172:175], v[100:103]
 buffer_store_dwordx4 v[92:95], v7, s[8:11], s3 offen offset:2048 sc1
M v[100:103], a[104:107], a[168:171], v[100:103]
 ds_read_b64_tr_b16 a[56:57], v4 offset:32768
 ds_read_b64_tr_b16 a[58:59], v4 offset:33792
M v[104:107], a[112:115], a[168:171], v[104:107]
M v[104:107], a[116:119], a[172:175], v[104:107]
 buffer_load_dwordx4 v11, s[52:55], s28 offen offset:3072   lds
M v[108:111], a[124:127], a[172:175], v[108:111]
 s_add_u32 s28, s28, 524160
 ds_read_b64_tr_b16 a[60:61], v4 offset:40960
 ds_read_b64_tr_b16 a[62:63], v4 offset:41984
M v[108:111], a[120:123], a[168:171], v[108:111]
M v[112:115], a[128:131], a[168:171], v[112:115]
M v[112:115], a[132:135], a[172:175], v[112:115]
M v[116:119], a[140:143], a[172:175], v[116:119]
M v[116:119], a[136:139], a[168:171], v[116:119]
M v[120:123], a[144:147], a[168:171], v[120:123]
M v[120:123], a[148:151], a[172:175], v[120:123]
 s_waitcnt lgkmcnt(6)
M v[124:127], a[156:159], a[172:175], v[124:127]
 s_waitcnt vmcnt(25) lgkmcnt(0)
M v[124:127], a[152:155], a[168:171], v[124:127]
 s_barrier
M v[160:163], a[96:99], a[160:163], v[160:163]
 ds_read_b128 a[168:171], v5 offset:55296
 ds_read_b128 a[172:175], v6 offset:55296
M v[160:163], a[100:103], a[164:167], v[160:163]
 ds_read_b64_tr_b16 a[64:65], v1 offset:49152
 ds_read_b64_tr_b16 a[66:67], v1 offset:50176
M v[164:167], a[108:111], a[164:167], v[164:167]
 buffer_store_dwordx4 a[208:211], v30, s[8:11], s89 offen offset:0 sc1
M v[164:167], a[104:107], a[160:163], v[164:167]
M v[168:171], a[112:115], a[160:163], v[168:171]
 ds_read_b64_tr_b16 a[68:69], v1 offset:57344
 ds_read_b64_tr_b16 a[70:71], v1 offset:58368
M v[168:171], a[116:119], a[164:167], v[168:171]
M v[172:175], a[124:127], a[164:167], v[172:175]
M v[172:175], a[120:123], a[160:163], v[172:175]
 ds_read_b64_tr_b16 a[72:73], v2 offset:49152
 ds_read_b64_tr_b16 a[74:75], v2 offset:50176
M v[176:179], a[128:131], a[160:163], v[176:179]
M v[176:179], a[132:135], a[164:167], v[176:179]
M v[180:183], a[140:143], a[164:167], v[180:183]
 ds_read_b64_tr_b16 a[76:77], v2 offset:57344
 ds_read_b64_tr_b16 a[78:79], v2 offset:58368
M v[180:183], a[136:139], a[160:163], v[180:183]
M v[184:187], a[144:147], a[160:163], v[184:187]
M v[184:187], a[148:151], a[164:167], v[184:187]
 s_waitcnt lgkmcnt(8)
 ds_read_b64_tr_b16 a[80:81], v3 offset:49152
 ds_read_b64_tr_b16 a[82:83], v3 offset:50176
M v[188:191], a[156:159], a[164:167], v[188:191]
 buffer_store_dwordx4 a[212:215], v30, s[8:11], s89 offen offset:64 sc1
M v[188:191], a[152:155], a[160:163], v[188:191]
M v[224:227], a[96:99], a[168:171], v[224:227]
 ds_read_b128 a[160:163], v5 offset:0
 ds_read_b128 a[164:167], v6 offset:0
M v[224:227], a[100:103], a[172:175], v[224:227]
 ds_read_b64_tr_b16 a[84:85], v3 offset:57344
 ds_read_b64_tr_b16 a[86:87], v3 offset:58368
M v[228:231], a[108:111], a[172:175], v[228:231]
M v[228:231], a[104:107], a[168:171], v[228:231]
 ds_read_b64_tr_b16 a[88:89], v4 offset:49152
 ds_read_b64_tr_b16 a[90:91], v4 offset:50176
M v[232:235], a[112:115], a[168:171], v[232:235]
M v[232:235], a[116:119], a[172:175], v[232:235]
M v[236:239], a[124:127], a[172:175], v[236:239]
 ds_read_b64_tr_b16 a[92:93], v4 offset:57344
 ds_read_b64_tr_b16 a[94:95], v4 offset:58368
M v[236:239], a[120:123], a[168:171], v[236:239]
M v[240:243], a[128:131], a[168:171], v[240:243]
M v[240:243], a[132:135], a[172:175], v[240:243]
M v[244:247], a[140:143], a[172:175], v[244:247]
M v[244:247], a[136:139], a[168:171], v[244:247]
M v[248:251], a[144:147], a[168:171], v[248:251]
M v[248:251], a[148:151], a[172:175], v[248:251]
 s_waitcnt lgkmcnt(6)
M v[252:255], a[156:159], a[172:175], v[252:255]
 s_waitcnt vmcnt(22) lgkmcnt(0)
M v[252:255], a[152:155], a[168:171], v[252:255]
 s_barrier
M v[32:35], a[32:35], a[160:163], v[32:35]
 s_add_u32 m0, s23, 32768
 ds_read_b128 a[168:171], v5 offset:2048
 ds_read_b128 a[172:175], v6 offset:2048
M v[32:35], a[36:39], a[164:167], v[32:35]
 ds_read_b64_tr_b16 a[96:97], v20 offset:0
 ds_read_b64_tr_b16 a[98:99], v20 offset:1024
M v[36:39], a[44:47], a[164:167], v[36:39]
 buffer_load_dwordx4 v16, s[56:59], s29 offen offset:0   lds
M v[36:39], a[40:43], a[160:163], v[36:39]
 buffer_store_dwordx4 a[216:219], v30, s[8:11], s89 offen offset:128 sc1
M v[40:43], a[48:51], a[160:163], v[40:43]
 ds_read_b64_tr_b16 a[100:101], v20 offset:8192
 ds_read_b64_tr_b16 a[102:103], v20 offset:9216
M v[40:43], a[52:55], a[164:167], v[40:43]
 buffer_load_dwordx4 v17, s[56:59], s29 offen offset:1024   lds
M v[44:47], a[60:63], a[164:167], v[44:47]
M v[44:47], a[56:59], a[160:163], v[44:47]
 ds_read_b64_tr_b16 a[104:105], v21 offset:0
 ds_read_b64_tr_b16 a[106:107], v21 offset:1024
M v[48:51], a[64:67], a[160:163], v[48:51]
M v[48:51], a[68:71], a[164:167], v[48:51]
 buffer_load_dwordx4 v18, s[56:59], s29 offen offset:2048   lds
M v[52:55], a[76:79], a[164:167], v[52:55]
 ds_read_b64_tr_b16 a[108:109], v21 offset:8192
 ds_read_b64_tr_b16 a[110:111], v21 offset:9216
M v[52:55], a[72:75], a[160:163], v[52:55]
 buffer_store_dwordx4 a[220:223], v30, s[8:11], s89 offen offset:192 sc1
M v[56:59], a[80:83], a[160:163], v[56:59]
M v[56:59], a[84:87], a[164:167], v[56:59]
 s_waitcnt lgkmcnt(8)
 ds_read_b64_tr_b16 a[112:113], v22 offset:0
 ds_read_b64_tr_b16 a[114:115], v22 offset:1024
M v[60:63], a[92:95], a[164:167], v[60:63]
 buffer_load_dwordx4 v19, s[56:59], s29 offen offset:3072   lds
M v[60:63], a[88:91], a[160:163], v[60:63]
 s_add_u32 s29, s29, 128
M v[96:99], a[32:35], a[168:171], v[96:99]
 ds_read_b128 a[160:163], v5 offset:4096
 ds_read_b128 a[164:167], v6 offset:4096
M v[96:99], a[36:39], a[172:175], v[96:99]
 ds_read_b64_tr_b16 a[116:117], v22 offset:8192
 ds_read_b64_tr_b16 a[118:119], v22 offset:9216
M v[100:103], a[44:47], a[172:175], v[100:103]
 s_lshl_b32 s28, s20, 13
 buffer_store_dwordx4 a[224:227], v30, s[8:11], s89 offen offset:256 sc1
M v[100:103], a[40:43], a[168:171], v[100:103]
 s_lshl_b32 s21, s41, 20
 ds_read_b64_tr_b16 a[120:121], v23 offset:0
 ds_read_b64_tr_b16 a[122:123], v23 offset:1024
M v[104:107], a[48:51], a[168:171], v[104:107]
 s_mov_b32 s22, 0
M v[104:107], a[52:55], a[172:175], v[104:107]
 s_lshl_b32 s7, s41, 18
M v[108:111], a[60:63], a[172:175], v[108:111]
 s_add_u32 s7, s7, 100663296
 ds_read_b64_tr_b16 a[124:125], v23 offset:8192
 ds_read_b64_tr_b16 a[126:127], v23 offset:9216
M v[108:111], a[56:59], a[168:171], v[108:111]
 s_add_u32 s38, s7, 65536
 buffer_store_dwordx4 a[228:231], v30, s[8:11], s89 offen offset:320 sc1
M v[112:115], a[64:67], a[168:171], v[112:115]
 s_sub_u32 s27, s42, 1
M v[112:115], a[68:71], a[172:175], v[112:115]
 s_mov_b32 s43, 32767
M v[116:119], a[76:79], a[172:175], v[116:119]
 s_mov_b32 s4, 0
 buffer_load_dword v24, v13, s[8:11], s46 offen sc1
M v[116:119], a[72:75], a[168:171], v[116:119]
 s_add_u32 s26, s21, 655360
 buffer_store_dwordx4 a[232:235], v30, s[8:11], s89 offen offset:384 sc1
M v[120:123], a[80:83], a[168:171], v[120:123]
 s_lshl_b32 s64, s42, 1
 s_add_u32 s65, s64, 4
 s_add_u32 s64, s64, 2
M v[120:123], a[84:87], a[172:175], v[120:123]
 s_waitcnt lgkmcnt(6)
 s_add_u32 s3, s93, 524288
M v[124:127], a[92:95], a[172:175], v[124:127]
 s_waitcnt vmcnt(23) lgkmcnt(0)
M v[124:127], a[88:91], a[168:171], v[124:127]
 s_barrier
M v[160:163], a[32:35], a[160:163], v[160:163]
 s_cmp_le_u32 s42, 5
 ds_read_b128 a[168:171], v5 offset:6144
 ds_read_b128 a[172:175], v6 offset:6144
M v[160:163], a[36:39], a[164:167], v[160:163]
 s_cselect_b32 s25, s65, 32767
 ds_read_b64_tr_b16 a[128:129], v20 offset:16384
 ds_read_b64_tr_b16 a[130:131], v20 offset:17408
M v[164:167], a[44:47], a[164:167], v[164:167]
 s_cselect_b32 s6, 14, s64
 buffer_store_dwordx4 v[128:131], v7, s[8:11], s3 offen offset:0 sc1
M v[164:167], a[40:43], a[160:163], v[164:167]
 s_mov_b32 s23, 0
M v[168:171], a[48:51], a[160:163], v[168:171]
 ds_read_b64_tr_b16 a[132:133], v20 offset:24576
 ds_read_b64_tr_b16 a[134:135], v20 offset:25600
M v[168:171], a[52:55], a[164:167], v[168:171]
M v[172:175], a[60:63], a[164:167], v[172:175]
 buffer_store_dwordx4 v[132:135], v7, s[8:11], s3 offen offset:2048 sc1
M v[172:175], a[56:59], a[160:163], v[172:175]
 s_add_u32 s3, s93, 528384
 ds_read_b64_tr_b16 a[136:137], v21 offset:16384
 ds_read_b64_tr_b16 a[138:139], v21 offset:17408
M v[176:179], a[64:67], a[160:163], v[176:179]
M v[176:179], a[68:71], a[164:167], v[176:179]
M v[180:183], a[76:79], a[164:167], v[180:183]
 ds_read_b64_tr_b16 a[140:141], v21 offset:24576
 ds_read_b64_tr_b16 a[142:143], v21 offset:25600
M v[180:183], a[72:75], a[160:163], v[180:183]
 buffer_store_dwordx4 v[136:139], v7, s[8:11], s3 offen offset:0 sc1
M v[184:187], a[80:83], a[160:163], v[184:187]
M v[184:187], a[84:87], a[164:167], v[184:187]
 s_waitcnt lgkmcnt(8)
 ds_read_b64_tr_b16 a[144:145], v22 offset:16384
 ds_read_b64_tr_b16 a[146:147], v22 offset:17408
M v[188:191], a[92:95], a[164:167], v[188:191]
M v[188:191], a[88:91], a[160:163], v[188:191]
 buffer_store_dwordx4 v[140:143], v7, s[8:11], s3 offen offset:2048 sc1
M v[224:227], a[32:35], a[168:171], v[224:227]
 ds_read_b128 a[160:163], v5 offset:16384
 ds_read_b128 a[164:167], v6 offset:16384
M v[224:227], a[36:39], a[172:175], v[224:227]
 s_add_u32 s3, s93, 532480
 ds_read_b64_tr_b16 a[148:149], v22 offset:24576
 ds_read_b64_tr_b16 a[150:151], v22 offset:25600
M v[228:231], a[44:47], a[172:175], v[228:231]
M v[228:231], a[40:43], a[168:171], v[228:231]
 ds_read_b64_tr_b16 a[152:153], v23 offset:16384
 ds_read_b64_tr_b16 a[154:155], v23 offset:17408
M v[232:235], a[48:51], a[168:171], v[232:235]
 buffer_store_dwordx4 v[144:147], v7, s[8:11], s3 offen offset:0 sc1
M v[232:235], a[52:55], a[172:175], v[232:235]
M v[236:239], a[60:63], a[172:175], v[236:239]
 ds_read_b64_tr_b16 a[156:157], v23 offset:24576
 ds_read_b64_tr_b16 a[158:159], v23 offset:25600
M v[236:239], a[56:59], a[168:171], v[236:239]
M v[240:243], a[64:67], a[168:171], v[240:243]
M v[240:243], a[68:71], a[172:175], v[240:243]
M v[244:247], a[76:79], a[172:175], v[244:247]
M v[244:247], a[72:75], a[168:171], v[244:247]
M v[248:251], a[80:83], a[168:171], v[248:251]
M v[248:251], a[84:87], a[172:175], v[248:251]
 s_waitcnt lgkmcnt(6)
M v[252:255], a[92:95], a[172:175], v[252:255]
 s_waitcnt vmcnt(23) lgkmcnt(0)
M v[252:255], a[88:91], a[168:171], v[252:255]
 s_barrier
M v[32:35], a[96:99], a[160:163], v[32:35]
 ds_read_b128 a[168:171], v5 offset:18432
 ds_read_b128 a[172:175], v6 offset:18432
M v[32:35], a[100:103], a[164:167], v[32:35]
 ds_read_b64_tr_b16 a[32:33], v1 offset:0
 ds_read_b64_tr_b16 a[34:35], v1 offset:1024
M v[36:39], a[108:111], a[164:167], v[36:39]
 v_add_u32 v10, s28, v7
 v_add_u32 v11, 0x1000, v10
M v[36:39], a[104:107], a[160:163], v[36:39]
 s_waitcnt vmcnt(6)
 v_cmp_eq_u32 vcc, 0, v24
M v[40:43], a[112:115], a[160:163], v[40:43]
 s_lshl_b32 s64, s20, 10
 ds_read_b64_tr_b16 a[36:37], v1 offset:8192
 ds_read_b64_tr_b16 a[38:39], v1 offset:9216
M v[40:43], a[116:119], a[164:167], v[40:43]
 s_cbranch_vccnz L_f1s04
L_f1r04:
M v[44:47], a[124:127], a[164:167], v[44:47]
 s_add_u32 m0, s28, 98304
 s_nop 0
 buffer_load_dwordx4 v10, s[8:11], s21 offen offset:0 sc1 lds
M v[44:47], a[120:123], a[160:163], v[44:47]
 ds_read_b64_tr_b16 a[40:41], v2 offset:0
 ds_read_b64_tr_b16 a[42:43], v2 offset:1024
M v[48:51], a[128:131], a[160:163], v[48:51]
 buffer_store_dwordx4 v[148:151], v7, s[8:11], s3 offen offset:2048 sc1
M v[48:51], a[132:135], a[164:167], v[48:51]
M v[52:55], a[140:143], a[164:167], v[52:55]
 ds_read_b64_tr_b16 a[44:45], v2 offset:8192
 ds_read_b64_tr_b16 a[46:47], v2 offset:9216
M v[52:55], a[136:139], a[160:163], v[52:55]
 buffer_load_dwordx4 v10, s[8:11], s21 offen offset:1024 sc1 lds
M v[56:59], a[144:147], a[160:163], v[56:59]
M v[56:59], a[148:151], a[164:167], v[56:59]
 s_waitcnt lgkmcnt(8)
 ds_read_b64_tr_b16 a[48:49], v3 offset:0
 ds_read_b64_tr_b16 a[50:51], v3 offset:1024
M v[60:63], a[156:159], a[164:167], v[60:63]
M v[60:63], a[152:155], a[160:163], v[60:63]
 s_add_u32 s3, s93, 536576
 buffer_load_dwordx4 v10, s[8:11], s21 offen offset:2048 sc1 lds
M v[96:99], a[96:99], a[168:171], v[96:99]
 ds_read_b128 a[160:163], v5 offset:20480
 ds_read_b128 a[164:167], v6 offset:20480
M v[96:99], a[100:103], a[172:175], v[96:99]
 ds_read_b64_tr_b16 a[52:53], v3 offset:8192
 ds_read_b64_tr_b16 a[54:55], v3 offset:9216
M v[100:103], a[108:111], a[172:175], v[100:103]
 buffer_store_dwordx4 v[152:155], v7, s[8:11], s3 offen offset:0 sc1
M v[100:103], a[104:107], a[168:171], v[100:103]
 ds_read_b64_tr_b16 a[56:57], v4 offset:0
 ds_read_b64_tr_b16 a[58:59], v4 offset:1024
M v[104:107], a[112:115], a[168:171], v[104:107]
 buffer_load_dwordx4 v10, s[8:11], s21 offen offset:3072 sc1 lds
M v[104:107], a[116:119], a[172:175], v[104:107]
 s_add_u32 m0, s28, 102400
M v[108:111], a[124:127], a[172:175], v[108:111]
 ds_read_b64_tr_b16 a[60:61], v4 offset:8192
 ds_read_b64_tr_b16 a[62:63], v4 offset:9216
M v[108:111], a[120:123], a[168:171], v[108:111]
M v[112:115], a[128:131], a[168:171], v[112:115]
 buffer_load_dwordx4 v11, s[8:11], s21 offen offset:0 sc1 lds
M v[112:115], a[132:135], a[172:175], v[112:115]
M v[116:119], a[140:143], a[172:175], v[116:119]
 buffer_store_dwordx4 v[156:159], v7, s[8:11], s3 offen offset:2048 sc1
M v[116:119], a[136:139], a[168:171], v[116:119]
M v[120:123], a[144:147], a[168:171], v[120:123]
 buffer_load_dwordx4 v11, s[8:11], s21 offen offset:1024 sc1 lds
M v[120:123], a[148:151], a[172:175], v[120:123]
 s_waitcnt lgkmcnt(6)
M v[124:127], a[156:159], a[172:175], v[124:127]
 s_waitcnt lgkmcnt(0)
 buffer_load_dwordx4 v11, s[8:11], s21 offen offset:2048 sc1 lds
M v[124:127], a[152:155], a[168:171], v[124:127]
 s_barrier
M v[160:163], a[96:99], a[160:163], v[160:163]
 ds_read_b128 a[168:171], v5 offset:22528
 ds_read_b128 a[172:175], v6 offset:22528
M v[160:163], a[100:103], a[164:167], v[160:163]
 ds_read_b64_tr_b16 a[64:65], v1 offset:16384
 ds_read_b64_tr_b16 a[66:67], v1 offset:17408
M v[164:167], a[108:111], a[164:167], v[164:167]
 buffer_load_dwordx4 v11, s[8:11], s21 offen offset:3072 sc1 lds
M v[164:167], a[104:107], a[160:163], v[164:167]
 s_add_u32 s24, s23, 16777216
M v[168:171], a[112:115], a[160:163], v[168:171]
 s_mov_b32 s23, s21
 ds_read_b64_tr_b16 a[68:69], v1 offset:24576
 ds_read_b64_tr_b16 a[70:71], v1 offset:25600
M v[168:171], a[116:119], a[164:167], v[168:171]
 s_add_u32 s21, s21, 32768
 s_add_u32 s3, s93, 786432
M v[172:175], a[124:127], a[164:167], v[172:175]
 s_add_u32 s22, s22, 1
 buffer_store_dwordx4 v[192:195], v7, s[8:11], s3 offen offset:0 sc1
M v[172:175], a[120:123], a[160:163], v[172:175]
 s_cmp_eq_u32 s22, s25
 ds_read_b64_tr_b16 a[72:73], v2 offset:16384
 ds_read_b64_tr_b16 a[74:75], v2 offset:17408
M v[176:179], a[128:131], a[160:163], v[176:179]
 s_cselect_b32 s21, s26, s21
 v_subrev_u32 v5, 0x10000, v5
 v_subrev_u32 v6, 0x10000, v6
M v[176:179], a[132:135], a[164:167], v[176:179]
 s_cmp_eq_u32 s22, s43
M v[180:183], a[140:143], a[164:167], v[180:183]
 s_cselect_b32 s21, s4, s21
 ds_read_b64_tr_b16 a[76:77], v2 offset:24576
 ds_read_b64_tr_b16 a[78:79], v2 offset:25600
M v[180:183], a[136:139], a[160:163], v[180:183]
 s_cmp_eq_u32 s22, s6
M v[184:187], a[144:147], a[160:163], v[184:187]
 s_cselect_b32 s21, s7, s21
 v_mov_b32 v9, v25
 v_lshrrev_b32 v24, 4, v0
M v[184:187], a[148:151], a[164:167], v[184:187]
 s_waitcnt lgkmcnt(8)
 ds_read_b64_tr_b16 a[80:81], v3 offset:16384
 ds_read_b64_tr_b16 a[82:83], v3 offset:17408
M v[188:191], a[156:159], a[164:167], v[188:191]
 v_lshlrev_b32 v24, 2, v24
 v_and_b32 v25, 15, v0
M v[188:191], a[152:155], a[160:163], v[188:191]
 v_sub_u32 v24, v24, v25
M v[224:227], a[96:99], a[168:171], v[224:227]
 s_add_u32 s64, s64, s34
 ds_read_b128 a[160:163], v5 offset:32768
 ds_read_b128 a[164:167], v6 offset:32768
M v[224:227], a[100:103], a[172:175], v[224:227]
 s_add_u32 s52, s64, 65536
 ds_read_b64_tr_b16 a[84:85], v3 offset:24576
 ds_read_b64_tr_b16 a[86:87], v3 offset:25600
M v[228:231], a[108:111], a[172:175], v[228:231]
 s_mov_b32 s55, 0x21800000
 buffer_store_dwordx4 v[196:199], v7, s[8:11], s3 offen offset:2048 sc1
M v[228:231], a[104:107], a[168:171], v[228:231]
 s_cmp_eq_u32 s20, 0
 ds_read_b64_tr_b16 a[88:89], v4 offset:16384
 ds_read_b64_tr_b16 a[90:91], v4 offset:17408
M v[232:235], a[112:115], a[168:171], v[232:235]
 s_cselect_b32 s54, s39, 0
M v[232:235], a[116:119], a[172:175], v[232:235]
 s_lshr_b32 s64, s20, 1
M v[236:239], a[124:127], a[172:175], v[236:239]
 s_lshl_b32 s64, s64, 17
 ds_read_b64_tr_b16 a[92:93], v4 offset:24576
 ds_read_b64_tr_b16 a[94:95], v4 offset:25600
M v[236:239], a[120:123], a[168:171], v[236:239]
 s_and_b32 s65, s20, 1
M v[240:243], a[128:131], a[168:171], v[240:243]
 s_lshl_b32 s65, s65, 12
M v[240:243], a[132:135], a[172:175], v[240:243]
 s_add_u32 s64, s64, s65
 v_add_u32 v14, s64, v7
 v_mov_b32 v8, 0xff800000
M v[244:247], a[140:143], a[172:175], v[244:247]
 v_cmp_lt_i32 s[16:17], 0, v24
 v_cmp_lt_i32 s[18:19], -1, v24
M v[244:247], a[136:139], a[168:171], v[244:247]
 v_cmp_lt_i32 s[48:49], -2, v24
 v_cmp_lt_i32 s[50:51], -3, v24
M v[248:251], a[144:147], a[168:171], v[248:251]
M v[248:251], a[148:151], a[172:175], v[248:251]
 s_waitcnt lgkmcnt(6)
M v[252:255], a[156:159], a[172:175], v[252:255]
 s_waitcnt lgkmcnt(0)
M v[252:255], a[152:155], a[168:171], v[252:255]
 s_barrier
M v[32:35], a[32:35], a[160:163], v[32:35]
 ds_read_b128 a[168:171], v5 offset:34816
 ds_read_b128 a[172:175], v6 offset:34816
M v[32:35], a[36:39], a[164:167], v[32:35]
 buffer_load_dword v24, v9, s[8:11], s46 offen sc1
M v[36:39], a[44:47], a[164:167], v[36:39]
 v_mov_b32 v1, v15
 v_add_u32 v2, 0x10000, v7
M v[36:39], a[40:43], a[160:163], v[36:39]
 v_mov_b32 v3, v10
 v_mov_b32 v4, v11
M v[40:43], a[48:51], a[160:163], v[40:43]
 s_mov_b64 s[60:61], s[76:77]
M v[40:43], a[52:55], a[164:167], v[40:43]
 s_mov_b32 s62, s78
M v[44:47], a[60:63], a[164:167], v[44:47]
 s_mov_b32 s63, 0x20000
 v_lshl_add_u32 v10, v0, 7, s95
 v_and_b32 v0, 48, v0
M v[44:47], a[56:59], a[160:163], v[44:47]
 v_lshl_add_u32 v0, v0, 24, v10
 v_mul_f32 v32, s5, v32
M v[48:51], a[64:67], a[160:163], v[48:51]
 v_mul_f32 v33, s5, v33
 v_mul_f32 v34, s5, v34
M v[48:51], a[68:71], a[164:167], v[48:51]
 v_mul_f32 v35, s5, v35
 v_mul_f32 v36, s5, v36
M v[52:55], a[76:79], a[164:167], v[52:55]
 v_mul_f32 v37, s5, v37
 v_mul_f32 v38, s5, v38
M v[52:55], a[72:75], a[160:163], v[52:55]
 v_mul_f32 v39, s5, v39
 v_cvt_pk_bf16_f32 v32, v32, v33
M v[56:59], a[80:83], a[160:163], v[56:59]
 v_cvt_pk_bf16_f32 v33, v34, v35
 v_cvt_pk_bf16_f32 v34, v36, v37
M v[56:59], a[84:87], a[164:167], v[56:59]
 s_waitcnt lgkmcnt(0)
 v_cvt_pk_bf16_f32 v35, v38, v39
 ds_write_b128 v14, v[32:35] offset:0
M v[60:63], a[92:95], a[164:167], v[60:63]
 s_add_u32 s3, s93, 790528
 buffer_store_dwordx4 v[200:203], v7, s[8:11], s3 offen offset:0 sc1
M v[60:63], a[88:91], a[160:163], v[60:63]
 v_mul_f32 v40, s5, v40
 v_mul_f32 v41, s5, v41
M v[96:99], a[32:35], a[168:171], v[96:99]
 ds_read_b128 a[160:163], v5 offset:36864
 ds_read_b128 a[164:167], v6 offset:36864
M v[96:99], a[36:39], a[172:175], v[96:99]
 v_mul_f32 v42, s5, v42
 v_mul_f32 v43, s5, v43
M v[100:103], a[44:47], a[172:175], v[100:103]
 v_mul_f32 v44, s5, v44
 v_mul_f32 v45, s5, v45
M v[100:103], a[40:43], a[168:171], v[100:103]
 v_mul_f32 v46, s5, v46
 v_mul_f32 v47, s5, v47
M v[104:107], a[48:51], a[168:171], v[104:107]
 v_cvt_pk_bf16_f32 v40, v40, v41
 v_cvt_pk_bf16_f32 v41, v42, v43
M v[104:107], a[52:55], a[172:175], v[104:107]
 v_cvt_pk_bf16_f32 v42, v44, v45
 v_cvt_pk_bf16_f32 v43, v46, v47
M v[108:111], a[60:63], a[172:175], v[108:111]
 ds_write_b128 v14, v[40:43] offset:1024
M v[108:111], a[56:59], a[168:171], v[108:111]
 buffer_store_dwordx4 v[204:207], v7, s[8:11], s3 offen offset:2048 sc1
M v[112:115], a[64:67], a[168:171], v[112:115]
 v_mul_f32 v48, s5, v48
 v_mul_f32 v49, s5, v49
M v[112:115], a[68:71], a[172:175], v[112:115]
 v_mul_f32 v50, s5, v50
 v_mul_f32 v51, s5, v51
M v[116:119], a[76:79], a[172:175], v[116:119]
 v_mul_f32 v52, s5, v52
 v_mul_f32 v53, s5, v53
M v[116:119], a[72:75], a[168:171], v[116:119]
 v_mul_f32 v54, s5, v54
 v_mul_f32 v55, s5, v55
M v[120:123], a[80:83], a[168:171], v[120:123]
 v_cvt_pk_bf16_f32 v48, v48, v49
 v_cvt_pk_bf16_f32 v49, v50, v51
M v[120:123], a[84:87], a[172:175], v[120:123]
 s_waitcnt lgkmcnt(1)
 v_cvt_pk_bf16_f32 v50, v52, v53
 v_cvt_pk_bf16_f32 v51, v54, v55
M v[124:127], a[92:95], a[172:175], v[124:127]
 ds_write_b128 v14, v[48:51] offset:2048
M v[124:127], a[88:91], a[168:171], v[124:127]
 s_add_u32 s3, s93, 794624
 buffer_store_dwordx4 v[208:211], v7, s[8:11], s3 offen offset:0 sc1
M v[160:163], a[32:35], a[160:163], v[160:163]
 ds_read_b128 a[168:171], v5 offset:38912
 ds_read_b128 a[172:175], v6 offset:38912
M v[160:163], a[36:39], a[164:167], v[160:163]
 v_mul_f32 v56, s5, v56
 v_mul_f32 v57, s5, v57
M v[164:167], a[44:47], a[164:167], v[164:167]
 v_mul_f32 v58, s5, v58
 v_mul_f32 v59, s5, v59
M v[164:167], a[40:43], a[160:163], v[164:167]
 v_mul_f32 v60, s5, v60
 v_mul_f32 v61, s5, v61
M v[168:171], a[48:51], a[160:163], v[168:171]
 v_mul_f32 v62, s5, v62
 v_mul_f32 v63, s5, v63
M v[168:171], a[52:55], a[164:167], v[168:171]
 v_cvt_pk_bf16_f32 v56, v56, v57
 v_cvt_pk_bf16_f32 v57, v58, v59
M v[172:175], a[60:63], a[164:167], v[172:175]
 v_cvt_pk_bf16_f32 v58, v60, v61
 v_cvt_pk_bf16_f32 v59, v62, v63
M v[172:175], a[56:59], a[160:163], v[172:175]
 s_waitcnt lgkmcnt(0)
 ds_write_b128 v14, v[56:59] offset:3072
M v[176:179], a[64:67], a[160:163], v[176:179]
 s_barrier
M v[176:179], a[68:71], a[164:167], v[176:179]
M v[180:183], a[76:79], a[164:167], v[180:183]
 s_add_u32 m0, s28, 32768
 s_nop 0
 buffer_load_dwordx4 v3, s[8:11], s21 offen offset:0 sc1 lds
M v[180:183], a[72:75], a[160:163], v[180:183]
M v[184:187], a[80:83], a[160:163], v[184:187]
 buffer_store_dwordx4 v[212:215], v7, s[8:11], s3 offen offset:2048 sc1
M v[184:187], a[84:87], a[164:167], v[184:187]
 v_mul_f32 v96, s5, v96
 v_mul_f32 v97, s5, v97
M v[188:191], a[92:95], a[164:167], v[188:191]
 buffer_load_dwordx4 v3, s[8:11], s21 offen offset:1024 sc1 lds
M v[188:191], a[88:91], a[160:163], v[188:191]
 v_mul_f32 v98, s5, v98
 v_mul_f32 v99, s5, v99
M v[224:227], a[32:35], a[168:171], v[224:227]
 v_mul_f32 v100, s5, v100
 v_mul_f32 v101, s5, v101
M v[224:227], a[36:39], a[172:175], v[224:227]
 v_mul_f32 v102, s5, v102
 v_mul_f32 v103, s5, v103
M v[228:231], a[44:47], a[172:175], v[228:231]
 buffer_load_dwordx4 v3, s[8:11], s21 offen offset:2048 sc1 lds
M v[228:231], a[40:43], a[168:171], v[228:231]
 v_cvt_pk_bf16_f32 v96, v96, v97
 v_cvt_pk_bf16_f32 v97, v98, v99
M v[232:235], a[48:51], a[168:171], v[232:235]
 v_cvt_pk_bf16_f32 v98, v100, v101
 v_cvt_pk_bf16_f32 v99, v102, v103
M v[232:235], a[52:55], a[172:175], v[232:235]
 ds_write_b128 v14, v[96:99] offset:8192
M v[236:239], a[60:63], a[172:175], v[236:239]
 s_add_u32 s3, s93, 798720
 buffer_load_dwordx4 v3, s[8:11], s21 offen offset:3072 sc1 lds
M v[236:239], a[56:59], a[168:171], v[236:239]
 s_add_u32 m0, s28, 36864
M v[240:243], a[64:67], a[168:171], v[240:243]
 buffer_store_dwordx4 v[216:219], v7, s[8:11], s3 offen offset:0 sc1
M v[240:243], a[68:71], a[172:175], v[240:243]
 v_mul_f32 v104, s5, v104
 v_mul_f32 v105, s5, v105
M v[244:247], a[76:79], a[172:175], v[244:247]
 buffer_load_dwordx4 v4, s[8:11], s21 offen offset:0 sc1 lds
M v[244:247], a[72:75], a[168:171], v[244:247]
 v_mul_f32 v106, s5, v106
 v_mul_f32 v107, s5, v107
M v[248:251], a[80:83], a[168:171], v[248:251]
 v_mul_f32 v108, s5, v108
 v_mul_f32 v109, s5, v109
M v[248:251], a[84:87], a[172:175], v[248:251]
 v_mul_f32 v110, s5, v110
 v_mul_f32 v111, s5, v111
M v[252:255], a[92:95], a[172:175], v[252:255]
 buffer_load_dwordx4 v4, s[8:11], s21 offen offset:1024 sc1 lds
M v[252:255], a[88:91], a[168:171], v[252:255]
 buffer_load_dwordx4 v4, s[8:11], s21 offen offset:2048 sc1 lds
 buffer_load_dwordx4 v4, s[8:11], s21 offen offset:3072 sc1 lds
 s_add_u32 s24, s23, 16777216
 s_mov_b32 s23, s21
 s_add_u32 s21, s21, 32768
 s_add_u32 s22, s22, 1
 s_cmp_eq_u32 s22, s25
 s_cselect_b32 s21, s26, s21
 s_cmp_eq_u32 s22, s43
 s_cselect_b32 s21, s4, s21
 s_cmp_eq_u32 s22, s6
 s_cselect_b32 s21, s7, s21
 v_cvt_pk_bf16_f32 v104, v104, v105
 v_cvt_pk_bf16_f32 v105, v106, v107
 v_cvt_pk_bf16_f32 v106, v108, v109
 v_cvt_pk_bf16_f32 v107, v110, v111
 ds_write_b128 v14, v[104:107] offset:9216
 buffer_store_dwordx4 v[220:223], v7, s[8:11], s3 offen offset:2048 sc1
 v_pk_mul_f32 v[112:113], v[112:113], s[4:5] op_sel:[0,1] op_sel_hi:[1,1]
 v_pk_mul_f32 v[114:115], v[114:115], s[4:5] op_sel:[0,1] op_sel_hi:[1,1]
 v_pk_mul_f32 v[116:117], v[116:117], s[4:5] op_sel:[0,1] op_sel_hi:[1,1]
 v_pk_mul_f32 v[118:119], v[118:119], s[4:5] op_sel:[0,1] op_sel_hi:[1,1]
 v_cvt_pk_bf16_f32 v112, v112, v113
 v_cvt_pk_bf16_f32 v113, v114, v115
 v_cvt_pk_bf16_f32 v114, v116, v117
 v_cvt_pk_bf16_f32 v115, v118, v119
 ds_write_b128 v14, v[112:115] offset:10240
 v_pk_mul_f32 v[120:121], v[120:121], s[4:5] op_sel:[0,1] op_sel_hi:[1,1]
 v_pk_mul_f32 v[122:123], v[122:123], s[4:5] op_sel:[0,1] op_sel_hi:[1,1]
 v_pk_mul_f32 v[124:125], v[124:125], s[4:5] op_sel:[0,1] op_sel_hi:[1,1]
 v_pk_mul_f32 v[126:127], v[126:127], s[4:5] op_sel:[0,1] op_sel_hi:[1,1]
 v_cvt_pk_bf16_f32 v120, v120, v121
 v_cvt_pk_bf16_f32 v121, v122, v123
 v_cvt_pk_bf16_f32 v122, v124, v125
 v_cvt_pk_bf16_f32 v123, v126, v127
 ds_write_b128 v14, v[120:123] offset:11264
 v_pk_mul_f32 v[160:161], v[160:161], s[4:5] op_sel:[0,1] op_sel_hi:[1,1]
 v_pk_mul_f32 v[162:163], v[162:163], s[4:5] op_sel:[0,1] op_sel_hi:[1,1]
 v_pk_mul_f32 v[164:165], v[164:165], s[4:5] op_sel:[0,1] op_sel_hi:[1,1]
 v_pk_mul_f32 v[166:167], v[166:167], s[4:5] op_sel:[0,1] op_sel_hi:[1,1]
 v_cvt_pk_bf16_f32 v160, v160, v161
 v_cvt_pk_bf16_f32 v161, v162, v163
 v_cvt_pk_bf16_f32 v162, v164, v165
 v_cvt_pk_bf16_f32 v163, v166, v167
 ds_write_b128 v14, v[160:163] offset:16384
 v_pk_mul_f32 v[168:169], v[168:169], s[4:5] op_sel:[0,1] op_sel_hi:[1,1]
 v_pk_mul_f32 v[170:171], v[170:171], s[4:5] op_sel:[0,1] op_sel_hi:[1,1]
 v_pk_mul_f32 v[172:173], v[172:173], s[4:5] op_sel:[0,1] op_sel_hi:[1,1]
 v_pk_mul_f32 v[174:175], v[174:175], s[4:5] op_sel:[0,1] op_sel_hi:[1,1]
 v_cvt_pk_bf16_f32 v168, v168, v169
 v_cvt_pk_bf16_f32 v169, v170, v171
 v_cvt_pk_bf16_f32 v170, v172, v173
 v_cvt_pk_bf16_f32 v171, v174, v175
 ds_write_b128 v14, v[168:171] offset:17408
 v_pk_mul_f32 v[176:177], v[176:177], s[4:5] op_sel:[0,1] op_sel_hi:[1,1]
 v_pk_mul_f32 v[178:179], v[178:179], s[4:5] op_sel:[0,1] op_sel_hi:[1,1]
 v_pk_mul_f32 v[180:181], v[180:181], s[4:5] op_sel:[0,1] op_sel_hi:[1,1]
 v_pk_mul_f32 v[182:183], v[182:183], s[4:5] op_sel:[0,1] op_sel_hi:[1,1]
 v_cvt_pk_bf16_f32 v176, v176, v177
 v_cvt_pk_bf16_f32 v177, v178, v179
 v_cvt_pk_bf16_f32 v178, v180, v181
 v_cvt_pk_bf16_f32 v179, v182, v183
 ds_write_b128 v14, v[176:179] offset:18432
 v_pk_mul_f32 v[184:185], v[184:185], s[4:5] op_sel:[0,1] op_sel_hi:[1,1]
 v_pk_mul_f32 v[186:187], v[186:187], s[4:5] op_sel:[0,1] op_sel_hi:[1,1]
 v_pk_mul_f32 v[188:189], v[188:189], s[4:5] op_sel:[0,1] op_sel_hi:[1,1]
 v_pk_mul_f32 v[190:191], v[190:191], s[4:5] op_sel:[0,1] op_sel_hi:[1,1]
 v_cvt_pk_bf16_f32 v184, v184, v185
 v_cvt_pk_bf16_f32 v185, v186, v187
 v_cvt_pk_bf16_f32 v186, v188, v189
 v_cvt_pk_bf16_f32 v187, v190, v191
 ds_write_b128 v14, v[184:187] offset:19456
 v_pk_mul_f32 v[224:225], v[224:225], s[4:5] op_sel:[0,1] op_sel_hi:[1,1]
 v_pk_mul_f32 v[226:227], v[226:227], s[4:5] op_sel:[0,1] op_sel_hi:[1,1]
 v_pk_mul_f32 v[228:229], v[228:229], s[4:5] op_sel:[0,1] op_sel_hi:[1,1]
 v_pk_mul_f32 v[230:231], v[230:231], s[4:5] op_sel:[0,1] op_sel_hi:[1,1]
 v_cvt_pk_bf16_f32 v224, v224, v225
 v_cvt_pk_bf16_f32 v225, v226, v227
 v_cvt_pk_bf16_f32 v226, v228, v229
 v_cvt_pk_bf16_f32 v227, v230, v231
 ds_write_b128 v14, v[224:227] offset:24576
 v_pk_mul_f32 v[232:233], v[232:233], s[4:5] op_sel:[0,1] op_sel_hi:[1,1]
 v_pk_mul_f32 v[234:235], v[234:235], s[4:5] op_sel:[0,1] op_sel_hi:[1,1]
 v_pk_mul_f32 v[236:237], v[236:237], s[4:5] op_sel:[0,1] op_sel_hi:[1,1]
 v_pk_mul_f32 v[238:239], v[238:239], s[4:5] op_sel:[0,1] op_sel_hi:[1,1]
 v_cvt_pk_bf16_f32 v232, v232, v233
 v_cvt_pk_bf16_f32 v233, v234, v235
 v_cvt_pk_bf16_f32 v234, v236, v237
 v_cvt_pk_bf16_f32 v235, v238, v239
 ds_write_b128 v14, v[232:235] offset:25600
 v_pk_mul_f32 v[240:241], v[240:241], s[4:5] op_sel:[0,1] op_sel_hi:[1,1]
 v_pk_mul_f32 v[242:243], v[242:243], s[4:5] op_sel:[0,1] op_sel_hi:[1,1]
 v_pk_mul_f32 v[244:245], v[244:245], s[4:5] op_sel:[0,1] op_sel_hi:[1,1]
 v_pk_mul_f32 v[246:247], v[246:247], s[4:5] op_sel:[0,1] op_sel_hi:[1,1]
 v_cvt_pk_bf16_f32 v240, v240, v241
 v_cvt_pk_bf16_f32 v241, v242, v243
 v_cvt_pk_bf16_f32 v242, v244, v245
 v_cvt_pk_bf16_f32 v243, v246, v247
 ds_write_b128 v14, v[240:243] offset:26624
 v_pk_mul_f32 v[248:249], v[248:249], s[4:5] op_sel:[0,1] op_sel_hi:[1,1]
 v_pk_mul_f32 v[250:251], v[250:251], s[4:5] op_sel:[0,1] op_sel_hi:[1,1]
 v_pk_mul_f32 v[252:253], v[252:253], s[4:5] op_sel:[0,1] op_sel_hi:[1,1]
 v_pk_mul_f32 v[254:255], v[254:255], s[4:5] op_sel:[0,1] op_sel_hi:[1,1]
 v_cvt_pk_bf16_f32 v248, v248, v249
 v_cvt_pk_bf16_f32 v249, v250, v251
 v_cvt_pk_bf16_f32 v250, v252, v253
 v_cvt_pk_bf16_f32 v251, v254, v255
 ds_write_b128 v14, v[248:251] offset:27648
 s_waitcnt vmcnt(17) lgkmcnt(0)
 s_barrier
 ds_read_b128 a[64:67], v2 offset:32768
 ds_read_b128 a[68:71], v2 offset:33792
 ds_read_b128 a[72:75], v2 offset:34816
 ds_read_b128 a[76:79], v2 offset:35840
 ds_read_b128 a[80:83], v2 offset:36864
 ds_read_b128 a[84:87], v2 offset:37888
 ds_read_b128 a[88:91], v2 offset:38912
 ds_read_b128 a[92:95], v2 offset:39936
 s_lshl_b32 s64, s20, 13
 s_sub_u32 s65, 155648, s64
 v_add_u32 v10, s64, v7
 v_add_u32 v11, s65, v7
 ds_read_b128 a[0:3], v10 offset:0
 ds_read_b128 a[4:7], v10 offset:1024
 ds_read_b128 a[8:11], v10 offset:2048
 ds_read_b128 a[12:15], v10 offset:3072
 ds_read_b128 a[16:19], v10 offset:4096
 ds_read_b128 a[20:23], v10 offset:5120
 ds_read_b128 a[24:27], v10 offset:6144
 ds_read_b128 a[28:31], v10 offset:7168
 ds_read_b128 a[32:35], v11 offset:0
 ds_read_b128 a[36:39], v11 offset:1024
 ds_read_b128 a[40:43], v11 offset:2048
 ds_read_b128 a[44:47], v11 offset:3072
 ds_read_b128 a[48:51], v11 offset:4096
 ds_read_b128 a[52:55], v11 offset:5120
 ds_read_b128 a[56:59], v11 offset:6144
 ds_read_b128 a[60:63], v11 offset:7168
 s_waitcnt vmcnt(14)
 v_cmp_eq_u32 vcc, 0, v24
 v_mov_b32 v17, 5
 v_or_b32 v6, s35, v7
 s_cbranch_vccnz L_f1s05
L_f1r05:
 s_mov_b32 s30, s93
 s_mov_b32 s29, s94
 s_cmp_eq_u32 s20, 0
 s_cselect_b32 s5, 0, 0
 v_mov_b32 v32, 0xc1800000
 v_mov_b32 v33, 0xc1800000
 v_mov_b32 v34, 0xc1800000
 v_mov_b32 v35, 0xc1800000
 v_mov_b32 v36, 0xc1800000
 v_mov_b32 v37, 0xc1800000
 v_mov_b32 v38, 0xc1800000
 v_mov_b32 v39, 0xc1800000
 s_waitcnt lgkmcnt(0)
M v[64:67], a[64:67], a[0:3], v[32:35]
 ds_read_b128 a[96:99], v2 offset:40960
 v_mov_b32 v30, 0
M v[64:67], a[68:71], a[4:7], v[64:67]
 s_add_u32 m0, s28, 65536
 ds_read_b128 a[100:103], v2 offset:41984
 v_mov_b32 v31, 0
M v[64:67], a[72:75], a[8:11], v[64:67]
 buffer_load_dwordx4 v3, s[8:11], s24 offen offset:0 sc1 lds
M v[64:67], a[76:79], a[12:15], v[64:67]
 ds_read_b128 a[104:107], v2 offset:43008
M v[64:67], a[80:83], a[16:19], v[64:67]
 ds_read_b128 a[108:111], v2 offset:44032
M v[64:67], a[84:87], a[20:23], v[64:67]
 buffer_load_dwordx4 v3, s[8:11], s24 offen offset:1024 sc1 lds
M v[64:67], a[88:91], a[24:27], v[64:67]
 ds_read_b128 a[112:115], v2 offset:45056
M v[64:67], a[92:95], a[28:31], v[64:67]
 ds_read_b128 a[116:119], v2 offset:46080
M v[68:71], a[92:95], a[60:63], v[36:39]
M v[68:71], a[88:91], a[56:59], v[68:71]
 ds_read_b128 a[120:123], v2 offset:47104
M v[68:71], a[84:87], a[52:55], v[68:71]
 ds_read_b128 a[124:127], v2 offset:48128
M v[68:71], a[80:83], a[48:51], v[68:71]
 buffer_load_dwordx4 v3, s[8:11], s24 offen offset:2048 sc1 lds
M v[68:71], a[76:79], a[44:47], v[68:71]
 v_exp_f32 v18, v64
M v[68:71], a[72:75], a[40:43], v[68:71]
 v_exp_f32 v19, v65
M v[68:71], a[68:71], a[36:39], v[68:71]
 v_exp_f32 v20, v66
M v[68:71], a[64:67], a[32:35], v[68:71]
 s_waitcnt lgkmcnt(0)
 v_exp_f32 v21, v67
M v[72:75], a[96:99], a[0:3], v[32:35]
 ds_read_b128 a[64:67], v2 offset:49152
 v_add_f32 v26, v18, v19
M v[72:75], a[100:103], a[4:7], v[72:75]
 ds_read_b128 a[68:71], v2 offset:50176
 v_cvt_pk_bf16_f32 v40, v18, v19
M v[72:75], a[104:107], a[8:11], v[72:75]
 buffer_load_dwordx4 v3, s[8:11], s24 offen offset:3072 sc1 lds
M v[72:75], a[108:111], a[12:15], v[72:75]
 ds_read_b128 a[72:75], v2 offset:51200
 v_add_f32 v26, v20, v26
M v[72:75], a[112:115], a[16:19], v[72:75]
 s_add_u32 m0, s28, 69632
 ds_read_b128 a[76:79], v2 offset:52224
 v_cvt_pk_bf16_f32 v41, v20, v21
M v[72:75], a[116:119], a[20:23], v[72:75]
 buffer_load_dwordx4 v4, s[8:11], s24 offen offset:0 sc1 lds
M v[72:75], a[120:123], a[24:27], v[72:75]
 ds_read_b128 a[80:83], v2 offset:53248
 v_add_f32 v26, v21, v26
M v[72:75], a[124:127], a[28:31], v[72:75]
 ds_read_b128 a[84:87], v2 offset:54272
M v[76:79], a[124:127], a[60:63], v[36:39]
 v_exp_f32 v22, v68
M v[76:79], a[120:123], a[56:59], v[76:79]
 ds_read_b128 a[88:91], v2 offset:55296
M v[76:79], a[116:119], a[52:55], v[76:79]
 ds_read_b128 a[92:95], v2 offset:56320
M v[76:79], a[112:115], a[48:51], v[76:79]
 buffer_load_dwordx4 v4, s[8:11], s24 offen offset:1024 sc1 lds
M v[76:79], a[108:111], a[44:47], v[76:79]
 v_exp_f32 v23, v69
M v[76:79], a[104:107], a[40:43], v[76:79]
 v_exp_f32 v24, v70
M v[76:79], a[100:103], a[36:39], v[76:79]
 buffer_load_dwordx4 v4, s[8:11], s24 offen offset:2048 sc1 lds
M v[76:79], a[96:99], a[32:35], v[76:79]
 s_waitcnt lgkmcnt(0)
 v_exp_f32 v25, v71
M v[80:83], a[64:67], a[0:3], v[32:35]
 ds_read_b128 a[96:99], v2 offset:57344
 v_add_f32 v27, v22, v23
M v[80:83], a[68:71], a[4:7], v[80:83]
 ds_read_b128 a[100:103], v2 offset:58368
 v_cvt_pk_bf16_f32 v44, v22, v23
M v[80:83], a[72:75], a[8:11], v[80:83]
 v_exp_f32 v18, v72
M v[80:83], a[76:79], a[12:15], v[80:83]
 ds_read_b128 a[104:107], v2 offset:59392
 v_add_f32 v27, v24, v27
M v[80:83], a[80:83], a[16:19], v[80:83]
 ds_read_b128 a[108:111], v2 offset:60416
 v_cvt_pk_bf16_f32 v45, v24, v25
M v[80:83], a[84:87], a[20:23], v[80:83]
 buffer_load_dwordx4 v4, s[8:11], s24 offen offset:3072 sc1 lds
M v[80:83], a[88:91], a[24:27], v[80:83]
 ds_read_b128 a[112:115], v2 offset:61440
 v_add_f32 v27, v25, v27
M v[80:83], a[92:95], a[28:31], v[80:83]
 ds_read_b128 a[116:119], v2 offset:62464
M v[84:87], a[92:95], a[60:63], v[36:39]
 v_exp_f32 v19, v73
M v[84:87], a[88:91], a[56:59], v[84:87]
 ds_read_b128 a[120:123], v2 offset:63488
 v_add_f32 v26, v18, v26
M v[84:87], a[84:87], a[52:55], v[84:87]
 ds_read_b128 a[124:127], v2 offset:64512
 v_cvt_pk_bf16_f32 v42, v18, v19
M v[84:87], a[80:83], a[48:51], v[84:87]
 v_exp_f32 v20, v74
M v[84:87], a[76:79], a[44:47], v[84:87]
 v_exp_f32 v21, v75
M v[84:87], a[72:75], a[40:43], v[84:87]
 v_exp_f32 v22, v76
M v[84:87], a[68:71], a[36:39], v[84:87]
 s_waitcnt vmcnt(8) lgkmcnt(0)
 v_exp_f32 v23, v77
M v[84:87], a[64:67], a[32:35], v[84:87]
 s_barrier
M v[88:91], a[96:99], a[0:3], v[32:35]
 ds_read_b128 a[64:67], v7 offset:32768
 v_add_f32 v26, v19, v26
M v[88:91], a[100:103], a[4:7], v[88:91]
 ds_read_b128 a[68:71], v7 offset:33792
 v_add_f32 v26, v20, v26
M v[88:91], a[104:107], a[8:11], v[88:91]
 buffer_store_dword v17, v1, s[8:11], s45 offen sc1
M v[88:91], a[108:111], a[12:15], v[88:91]
 ds_read_b128 a[72:75], v7 offset:34816
 v_cvt_pk_bf16_f32 v43, v20, v21
M v[88:91], a[112:115], a[16:19], v[88:91]
 ds_read_b128 a[76:79], v7 offset:35840
 v_add_f32 v26, v21, v26
M v[88:91], a[116:119], a[20:23], v[88:91]
 v_exp_f32 v24, v78
M v[88:91], a[120:123], a[24:27], v[88:91]
 ds_read_b128 a[80:83], v7 offset:36864
 v_add_f32 v27, v22, v27
M v[88:91], a[124:127], a[28:31], v[88:91]
 ds_read_b128 a[84:87], v7 offset:37888
 v_cvt_pk_bf16_f32 v46, v22, v23
M v[92:95], a[124:127], a[60:63], v[36:39]
 v_exp_f32 v25, v79
M v[92:95], a[120:123], a[56:59], v[92:95]
 ds_read_b128 a[88:91], v7 offset:38912
 v_add_f32 v27, v23, v27
M v[92:95], a[116:119], a[52:55], v[92:95]
 ds_read_b128 a[92:95], v7 offset:39936
 v_add_f32 v27, v24, v27
M v[92:95], a[112:115], a[48:51], v[92:95]
 v_cvt_pk_bf16_f32 v47, v24, v25
 v_add_f32 v27, v25, v27
M v[92:95], a[108:111], a[44:47], v[92:95]
M v[92:95], a[104:107], a[40:43], v[92:95]
M v[92:95], a[100:103], a[36:39], v[92:95]
 s_waitcnt lgkmcnt(0)
M v[92:95], a[96:99], a[32:35], v[92:95]
 s_cmp_eq_u32 s42, 0
 s_cbranch_scc1 L_j0
M v[96:99], a[64:67], a[0:3], v[32:35]
 s_add_u32 m0, s28, 98304
 ds_read_b128 a[96:99], v7 offset:40960
M v[96:99], a[68:71], a[4:7], v[96:99]
 ds_read_b128 a[100:103], v7 offset:41984
M v[96:99], a[72:75], a[8:11], v[96:99]
 buffer_load_dwordx4 v3, s[8:11], s21 offen offset:0 sc1 lds
M v[96:99], a[76:79], a[12:15], v[96:99]
 s_cmp_eq_u32 s20, 0
 ds_read_b128 a[104:107], v7 offset:43008
M v[96:99], a[80:83], a[16:19], v[96:99]
 s_cselect_b64 s[64:65], s[16:17], 0
 ds_read_b128 a[108:111], v7 offset:44032
M v[96:99], a[84:87], a[20:23], v[96:99]
 buffer_load_dwordx4 v3, s[8:11], s21 offen offset:1024 sc1 lds
M v[96:99], a[88:91], a[24:27], v[96:99]
 s_cselect_b64 s[66:67], s[18:19], 0
 ds_read_b128 a[112:115], v7 offset:45056
M v[96:99], a[92:95], a[28:31], v[96:99]
 s_cselect_b64 s[68:69], s[48:49], 0
 ds_read_b128 a[116:119], v7 offset:46080
M v[100:103], a[92:95], a[60:63], v[36:39]
 s_cselect_b64 s[70:71], s[50:51], 0
 v_exp_f32 v18, v80
M v[100:103], a[88:91], a[56:59], v[100:103]
 s_cmp_lt_u32 s20, 1
 ds_read_b128 a[120:123], v7 offset:47104
M v[100:103], a[84:87], a[52:55], v[100:103]
 s_cselect_b64 s[78:79], -1, 0
 ds_read_b128 a[124:127], v7 offset:48128
M v[100:103], a[80:83], a[48:51], v[100:103]
 buffer_load_dwordx4 v3, s[8:11], s21 offen offset:2048 sc1 lds
M v[100:103], a[76:79], a[44:47], v[100:103]
 s_cmp_eq_u32 s20, 1
 v_exp_f32 v19, v81
M v[100:103], a[72:75], a[40:43], v[100:103]
 s_cselect_b64 s[72:73], s[16:17], s[78:79]
 v_exp_f32 v20, v82
M v[100:103], a[68:71], a[36:39], v[100:103]
 s_cselect_b64 s[74:75], s[18:19], s[78:79]
 v_exp_f32 v21, v83
M v[100:103], a[64:67], a[32:35], v[100:103]
 s_waitcnt lgkmcnt(0)
 v_exp_f32 v22, v88
M v[104:107], a[96:99], a[0:3], v[32:35]
 s_cselect_b64 s[76:77], s[48:49], s[78:79]
 ds_read_b128 a[64:67], v7 offset:49152
 v_add_f32 v26, v18, v26
M v[104:107], a[100:103], a[4:7], v[104:107]
 s_cselect_b64 s[78:79], s[50:51], s[78:79]
 ds_read_b128 a[68:71], v7 offset:50176
 v_cvt_pk_bf16_f32 v56, v18, v19
M v[104:107], a[104:107], a[8:11], v[104:107]
 buffer_load_dwordx4 v3, s[8:11], s21 offen offset:3072 sc1 lds
M v[104:107], a[108:111], a[12:15], v[104:107]
 s_add_u32 m0, s28, 102400
 ds_read_b128 a[72:75], v7 offset:51200
 v_add_f32 v26, v19, v26
M v[104:107], a[112:115], a[16:19], v[104:107]
 s_cmp_lt_u32 s20, 2
 ds_read_b128 a[76:79], v7 offset:52224
 v_add_f32 v26, v20, v26
M v[104:107], a[116:119], a[20:23], v[104:107]
 buffer_load_dwordx4 v4, s[8:11], s21 offen offset:0 sc1 lds
M v[104:107], a[120:123], a[24:27], v[104:107]
 s_cselect_b64 s[86:87], -1, 0
 ds_read_b128 a[80:83], v7 offset:53248
 v_cvt_pk_bf16_f32 v57, v20, v21
M v[104:107], a[124:127], a[28:31], v[104:107]
 s_cmp_eq_u32 s20, 2
 ds_read_b128 a[84:87], v7 offset:54272
 v_add_f32 v26, v21, v26
M v[108:111], a[124:127], a[60:63], v[36:39]
 s_cselect_b64 s[80:81], s[16:17], s[86:87]
 v_exp_f32 v23, v89
M v[108:111], a[120:123], a[56:59], v[108:111]
 s_cselect_b64 s[82:83], s[18:19], s[86:87]
 ds_read_b128 a[88:91], v7 offset:55296
 v_add_f32 v26, v22, v26
M v[108:111], a[116:119], a[52:55], v[108:111]
 s_cselect_b64 s[84:85], s[48:49], s[86:87]
 ds_read_b128 a[92:95], v7 offset:56320
 v_cvt_pk_bf16_f32 v58, v22, v23
M v[108:111], a[112:115], a[48:51], v[108:111]
 buffer_load_dwordx4 v4, s[8:11], s21 offen offset:1024 sc1 lds
M v[108:111], a[108:111], a[44:47], v[108:111]
 s_cselect_b64 s[86:87], s[50:51], s[86:87]
 v_exp_f32 v24, v90
M v[108:111], a[104:107], a[40:43], v[108:111]
 s_cmp_eq_u32 s20, 3
 v_exp_f32 v25, v91
M v[108:111], a[100:103], a[36:39], v[108:111]
 buffer_load_dwordx4 v4, s[8:11], s21 offen offset:2048 sc1 lds
M v[108:111], a[96:99], a[32:35], v[108:111]
 s_waitcnt lgkmcnt(0)
 v_exp_f32 v18, v84
M v[112:115], a[64:67], a[0:3], v[32:35]
 s_cselect_b64 s[88:89], s[16:17], -1
 ds_read_b128 a[96:99], v7 offset:57344
 v_add_f32 v26, v23, v26
M v[112:115], a[68:71], a[4:7], v[112:115]
 s_cselect_b64 s[90:91], s[18:19], -1
 ds_read_b128 a[100:103], v7 offset:58368
 v_add_f32 v26, v24, v26
M v[112:115], a[72:75], a[8:11], v[112:115]
 s_cselect_b64 s[92:93], s[48:49], -1
 v_exp_f32 v19, v85
M v[112:115], a[76:79], a[12:15], v[112:115]
 s_cselect_b64 s[94:95], s[50:51], -1
 ds_read_b128 a[104:107], v7 offset:59392
 v_cvt_pk_bf16_f32 v59, v24, v25
M v[112:115], a[80:83], a[16:19], v[112:115]
 ds_read_b128 a[108:111], v7 offset:60416
 v_add_f32 v26, v25, v26
M v[112:115], a[84:87], a[20:23], v[112:115]
 buffer_load_dwordx4 v4, s[8:11], s21 offen offset:3072 sc1 lds
M v[112:115], a[88:91], a[24:27], v[112:115]
 s_add_u32 s24, s23, 16777216
 ds_read_b128 a[112:115], v7 offset:61440
 v_add_f32 v27, v18, v27
M v[112:115], a[92:95], a[28:31], v[112:115]
 s_mov_b32 s23, s21
 ds_read_b128 a[116:119], v7 offset:62464
 v_cvt_pk_bf16_f32 v60, v18, v19
M v[116:119], a[92:95], a[60:63], v[36:39]
 s_add_u32 s21, s21, 32768
 v_exp_f32 v20, v86
M v[116:119], a[88:91], a[56:59], v[116:119]
 s_add_u32 s22, s22, 1
 ds_read_b128 a[120:123], v7 offset:63488
 v_add_f32 v27, v19, v27
M v[116:119], a[84:87], a[52:55], v[116:119]
 s_cmp_eq_u32 s22, s25
 ds_read_b128 a[124:127], v7 offset:64512
M v[116:119], a[80:83], a[48:51], v[116:119]
 s_cselect_b32 s21, s26, s21
 v_exp_f32 v21, v87
M v[116:119], a[76:79], a[44:47], v[116:119]
 s_cmp_eq_u32 s22, s43
 v_exp_f32 v22, v92
M v[116:119], a[72:75], a[40:43], v[116:119]
 s_cselect_b32 s21, s4, s21
 v_exp_f32 v23, v93
M v[116:119], a[68:71], a[36:39], v[116:119]
 s_waitcnt vmcnt(9) lgkmcnt(0)
 v_add_f32 v27, v20, v27
 v_cvt_pk_bf16_f32 v61, v20, v21
M v[116:119], a[64:67], a[32:35], v[116:119]
 s_barrier
M v[120:123], a[96:99], a[0:3], v[32:35]
 s_cmp_eq_u32 s22, s6
 ds_read_b128 a[64:67], v2 offset:0
 v_add_f32 v27, v21, v27
M v[120:123], a[100:103], a[4:7], v[120:123]
 s_cselect_b32 s21, s7, s21
 ds_read_b128 a[68:71], v2 offset:1024
 v_add_f32 v27, v22, v27
M v[120:123], a[104:107], a[8:11], v[120:123]
 v_exp_f32 v24, v94
M v[120:123], a[108:111], a[12:15], v[120:123]
 ds_read_b128 a[72:75], v2 offset:2048
 v_cvt_pk_bf16_f32 v62, v22, v23
M v[120:123], a[112:115], a[16:19], v[120:123]
 ds_read_b128 a[76:79], v2 offset:3072
 v_add_f32 v27, v23, v27
M v[120:123], a[116:119], a[20:23], v[120:123]
 v_exp_f32 v25, v95
M v[120:123], a[120:123], a[24:27], v[120:123]
 ds_read_b128 a[80:83], v2 offset:4096
 v_add_f32 v27, v24, v27
M v[120:123], a[124:127], a[28:31], v[120:123]
 ds_read_b128 a[84:87], v2 offset:5120
 v_cvt_pk_bf16_f32 v63, v24, v25
M v[124:127], a[124:127], a[60:63], v[36:39]
 v_add_f32 v27, v25, v27
M v[124:127], a[120:123], a[56:59], v[124:127]
 ds_read_b128 a[88:91], v2 offset:6144
 v_max_f32 v10, v26, v27
M v[124:127], a[116:119], a[52:55], v[124:127]
 ds_read_b128 a[92:95], v2 offset:7168
 v_min_f32 v11, v26, v27
M v[124:127], a[112:115], a[48:51], v[124:127]
 v_cmp_lt_f32 s[36:37], s31, v10
M v[124:127], a[108:111], a[44:47], v[124:127]
 v_cmp_gt_f32 vcc, s55, v11
M v[124:127], a[104:107], a[40:43], v[124:127]
M v[124:127], a[100:103], a[36:39], v[124:127]
 s_waitcnt lgkmcnt(0)
 s_or_b64 vcc, vcc, s[36:37]
M v[124:127], a[96:99], a[32:35], v[124:127]
 s_cbranch_vccnz L_st10
L_rt10:
M v[128:131], a[64:67], v[40:43], 0
 s_add_u32 m0, s28, 0
 ds_read_b128 a[96:99], v2 offset:8192
 ds_read_b128 a[100:103], v2 offset:9216
M v[128:131], a[68:71], v[56:59], v[128:131]
 buffer_load_dwordx4 v3, s[8:11], s24 offen offset:0 sc1 lds
M v[132:135], a[68:71], v[60:63], 0
 v_exp_f32 v18, v96
M v[132:135], a[64:67], v[44:47], v[132:135]
 ds_read_b128 a[104:107], v2 offset:10240
 ds_read_b128 a[108:111], v2 offset:11264
M v[136:139], a[72:75], v[40:43], 0
 buffer_load_dwordx4 v3, s[8:11], s24 offen offset:1024 sc1 lds
M v[136:139], a[76:79], v[56:59], v[136:139]
 v_exp_f32 v19, v97
M v[140:143], a[76:79], v[60:63], 0
 ds_read_b128 a[112:115], v2 offset:12288
 ds_read_b128 a[116:119], v2 offset:13312
M v[140:143], a[72:75], v[44:47], v[140:143]
 buffer_load_dwordx4 v3, s[8:11], s24 offen offset:2048 sc1 lds
M v[144:147], a[80:83], v[40:43], 0
 v_exp_f32 v20, v98
M v[144:147], a[84:87], v[56:59], v[144:147]
 ds_read_b128 a[120:123], v2 offset:14336
 ds_read_b128 a[124:127], v2 offset:15360
M v[148:151], a[84:87], v[60:63], 0
 buffer_load_dwordx4 v3, s[8:11], s24 offen offset:3072 sc1 lds
M v[148:151], a[80:83], v[44:47], v[148:151]
 s_add_u32 m0, s28, 4096
 v_exp_f32 v21, v99
M v[152:155], a[88:91], v[40:43], 0
 buffer_load_dwordx4 v4, s[8:11], s24 offen offset:0 sc1 lds
M v[152:155], a[92:95], v[56:59], v[152:155]
 v_add_f32 v30, v26, v30
 v_add_f32 v31, v27, v31
M v[156:159], a[92:95], v[60:63], 0
 v_exp_f32 v22, v104
M v[156:159], a[88:91], v[44:47], v[156:159]
 s_waitcnt lgkmcnt(0)
 v_add_f32 v28, v18, v19
 v_cvt_pk_bf16_f32 v48, v18, v19
M v[160:163], a[96:99], v[40:43], 0
 ds_read_b128 a[64:67], v2 offset:16384
 ds_read_b128 a[68:71], v2 offset:17408
M v[160:163], a[100:103], v[56:59], v[160:163]
 buffer_load_dwordx4 v4, s[8:11], s24 offen offset:1024 sc1 lds
M v[164:167], a[100:103], v[60:63], 0
 v_exp_f32 v23, v105
M v[164:167], a[96:99], v[44:47], v[164:167]
 ds_read_b128 a[72:75], v2 offset:18432
 ds_read_b128 a[76:79], v2 offset:19456
M v[168:171], a[104:107], v[40:43], 0
 buffer_load_dwordx4 v4, s[8:11], s24 offen offset:2048 sc1 lds
M v[168:171], a[108:111], v[56:59], v[168:171]
 v_add_f32 v28, v20, v28
 v_cvt_pk_bf16_f32 v49, v20, v21
M v[172:175], a[108:111], v[60:63], 0
 ds_read_b128 a[80:83], v2 offset:20480
 ds_read_b128 a[84:87], v2 offset:21504
M v[172:175], a[104:107], v[44:47], v[172:175]
 buffer_load_dwordx4 v4, s[8:11], s24 offen offset:3072 sc1 lds
M v[176:179], a[112:115], v[40:43], 0
 v_exp_f32 v24, v106
M v[176:179], a[116:119], v[56:59], v[176:179]
 s_add_u32 m0, s28, 32768
 ds_read_b128 a[88:91], v2 offset:22528
 ds_read_b128 a[92:95], v2 offset:23552
M v[180:183], a[116:119], v[60:63], 0
 buffer_load_dwordx4 v3, s[8:11], s21 offen offset:0 sc1 lds
M v[180:183], a[112:115], v[44:47], v[180:183]
 v_exp_f32 v25, v107
M v[184:187], a[120:123], v[40:43], 0
 buffer_load_dwordx4 v3, s[8:11], s21 offen offset:1024 sc1 lds
M v[184:187], a[124:127], v[56:59], v[184:187]
 v_exp_f32 v18, v100
M v[188:191], a[124:127], v[60:63], 0
 buffer_load_dwordx4 v3, s[8:11], s21 offen offset:2048 sc1 lds
M v[188:191], a[120:123], v[44:47], v[188:191]
 s_waitcnt lgkmcnt(0)
 v_add_f32 v28, v21, v28
 v_add_f32 v28, v22, v28
M v[192:195], a[64:67], v[40:43], 0
 ds_read_b128 a[96:99], v2 offset:24576
 ds_read_b128 a[100:103], v2 offset:25600
M v[192:195], a[68:71], v[56:59], v[192:195]
 buffer_load_dwordx4 v3, s[8:11], s21 offen offset:3072 sc1 lds
M v[196:199], a[68:71], v[60:63], 0
 v_exp_f32 v19, v101
M v[196:199], a[64:67], v[44:47], v[196:199]
 s_add_u32 m0, s28, 36864
 ds_read_b128 a[104:107], v2 offset:26624
 ds_read_b128 a[108:111], v2 offset:27648
M v[200:203], a[72:75], v[40:43], 0
 buffer_load_dwordx4 v4, s[8:11], s21 offen offset:0 sc1 lds
M v[200:203], a[76:79], v[56:59], v[200:203]
 v_exp_f32 v20, v102
M v[204:207], a[76:79], v[60:63], 0
 ds_read_b128 a[112:115], v2 offset:28672
 ds_read_b128 a[116:119], v2 offset:29696
M v[204:207], a[72:75], v[44:47], v[204:207]
 buffer_load_dwordx4 v4, s[8:11], s21 offen offset:1024 sc1 lds
M v[208:211], a[80:83], v[40:43], 0
 v_exp_f32 v21, v103
M v[208:211], a[84:87], v[56:59], v[208:211]
 ds_read_b128 a[120:123], v2 offset:30720
 ds_read_b128 a[124:127], v2 offset:31744
M v[212:215], a[84:87], v[60:63], 0
 buffer_load_dwordx4 v4, s[8:11], s21 offen offset:2048 sc1 lds
M v[212:215], a[80:83], v[44:47], v[212:215]
 v_cvt_pk_bf16_f32 v50, v22, v23
 v_add_f32 v28, v23, v28
M v[216:219], a[88:91], v[40:43], 0
 v_exp_f32 v22, v108
M v[216:219], a[92:95], v[56:59], v[216:219]
 buffer_load_dwordx4 v4, s[8:11], s21 offen offset:3072 sc1 lds
M v[220:223], a[92:95], v[60:63], 0
 s_waitcnt vmcnt(16) lgkmcnt(0)
 s_add_u32 s24, s23, 16777216
 s_mov_b32 s23, s21
M v[220:223], a[88:91], v[44:47], v[220:223]
 s_barrier
M v[224:227], a[96:99], v[40:43], 0
 ds_read_b128 a[64:67], v2 offset:32768
 ds_read_b128 a[68:71], v2 offset:33792
M v[224:227], a[100:103], v[56:59], v[224:227]
 s_add_u32 s21, s21, 32768
 v_add_f32 v28, v24, v28
M v[228:231], a[100:103], v[60:63], 0
 s_add_u32 s22, s22, 1
 v_exp_f32 v23, v109
M v[228:231], a[96:99], v[44:47], v[228:231]
 s_cmp_eq_u32 s22, s25
 ds_read_b128 a[72:75], v2 offset:34816
 ds_read_b128 a[76:79], v2 offset:35840
M v[232:235], a[104:107], v[40:43], 0
 s_cselect_b32 s21, s26, s21
 v_cvt_pk_bf16_f32 v51, v24, v25
 v_add_f32 v28, v25, v28
M v[232:235], a[108:111], v[56:59], v[232:235]
 s_cmp_eq_u32 s22, s43
 v_exp_f32 v24, v110
M v[236:239], a[108:111], v[60:63], 0
 s_cselect_b32 s21, s4, s21
 ds_read_b128 a[80:83], v2 offset:36864
 ds_read_b128 a[84:87], v2 offset:37888
M v[236:239], a[104:107], v[44:47], v[236:239]
 s_cmp_eq_u32 s22, s6
 v_exp_f32 v25, v111
M v[240:243], a[112:115], v[40:43], 0
 s_cselect_b32 s21, s7, s21
 v_add_f32 v29, v18, v19
 v_cvt_pk_bf16_f32 v52, v18, v19
M v[240:243], a[116:119], v[56:59], v[240:243]
 ds_read_b128 a[88:91], v2 offset:38912
 ds_read_b128 a[92:95], v2 offset:39936
M v[244:247], a[116:119], v[60:63], 0
 v_add_f32 v29, v20, v29
 v_cvt_pk_bf16_f32 v53, v20, v21
M v[244:247], a[112:115], v[44:47], v[244:247]
 v_add_f32 v29, v21, v29
 v_add_f32 v29, v22, v29
M v[248:251], a[120:123], v[40:43], 0
 v_cvt_pk_bf16_f32 v54, v22, v23
 v_add_f32 v29, v23, v29
M v[248:251], a[124:127], v[56:59], v[248:251]
 s_cmp_lg_u32 s27, 0
 v_add_f32 v29, v24, v29
 v_cvt_pk_bf16_f32 v55, v24, v25
M v[252:255], a[124:127], v[60:63], 0
 s_waitcnt lgkmcnt(0)
 v_add_f32 v29, v25, v29
M v[252:255], a[120:123], v[44:47], v[252:255]
 s_cbranch_scc1 L_loop_top
 s_branch L_p1
L_j0:
 s_cmp_eq_u32 s20, 0
 s_cselect_b64 s[64:65], s[16:17], 0
 s_cselect_b64 s[66:67], s[18:19], 0
 s_cselect_b64 s[68:69], s[48:49], 0
 s_cselect_b64 s[70:71], s[50:51], 0
 s_cmp_lt_u32 s20, 1
 s_cselect_b64 s[78:79], -1, 0
 s_cmp_eq_u32 s20, 1
 s_cselect_b64 s[72:73], s[16:17], s[78:79]
 s_cselect_b64 s[74:75], s[18:19], s[78:79]
 s_cselect_b64 s[76:77], s[48:49], s[78:79]
 s_cselect_b64 s[78:79], s[50:51], s[78:79]
 s_cmp_lt_u32 s20, 2
 s_cselect_b64 s[86:87], -1, 0
 s_cmp_eq_u32 s20, 2
 s_cselect_b64 s[80:81], s[16:17], s[86:87]
 s_cselect_b64 s[82:83], s[18:19], s[86:87]
 s_cselect_b64 s[84:85], s[48:49], s[86:87]
 s_cselect_b64 s[86:87], s[50:51], s[86:87]
 s_cmp_eq_u32 s20, 3
 s_cselect_b64 s[88:89], s[16:17], -1
 s_cselect_b64 s[90:91], s[18:19], -1
 s_cselect_b64 s[92:93], s[48:49], -1
 s_cselect_b64 s[94:95], s[50:51], -1
 v_mov_b32 v56, 0
 v_mov_b32 v57, 0
 v_mov_b32 v58, 0
 v_mov_b32 v59, 0
 v_accvgpr_write_b32 a242, 0
 v_accvgpr_write_b32 a243, 0
 v_cndmask_b32 v64, v64, v8, s[64:65]
 v_cndmask_b32 v65, v65, v8, s[66:67]
 v_cndmask_b32 v66, v66, v8, s[68:69]
 v_cndmask_b32 v67, v67, v8, s[70:71]
 v_cndmask_b32 v72, v72, v8, s[72:73]
 v_cndmask_b32 v73, v73, v8, s[74:75]
 v_cndmask_b32 v74, v74, v8, s[76:77]
 v_cndmask_b32 v75, v75, v8, s[78:79]
 v_cndmask_b32 v80, v80, v8, s[80:81]
 v_cndmask_b32 v81, v81, v8, s[82:83]
 v_cndmask_b32 v82, v82, v8, s[84:85]
 v_cndmask_b32 v83, v83, v8, s[86:87]
 v_cndmask_b32 v88, v88, v8, s[88:89]
 v_cndmask_b32 v89, v89, v8, s[90:91]
 v_cndmask_b32 v90, v90, v8, s[92:93]
 v_cndmask_b32 v91, v91, v8, s[94:95]
 s_cmp_eq_u32 s20, 3
 s_cselect_b64 s[64:65], s[16:17], 0
 s_cselect_b64 s[66:67], s[18:19], 0
 s_cselect_b64 s[68:69], s[48:49], 0
 s_cselect_b64 s[70:71], s[50:51], 0
 s_cmp_gt_u32 s20, 2
 s_cselect_b64 s[78:79], -1, 0
 s_cmp_eq_u32 s20, 2
 s_cselect_b64 s[72:73], s[16:17], s[78:79]
 s_cselect_b64 s[74:75], s[18:19], s[78:79]
 s_cselect_b64 s[76:77], s[48:49], s[78:79]
 s_cselect_b64 s[78:79], s[50:51], s[78:79]
 s_cmp_gt_u32 s20, 1
 s_cselect_b64 s[86:87], -1, 0
 s_cmp_eq_u32 s20, 1
 s_cselect_b64 s[80:81], s[16:17], s[86:87]
 s_cselect_b64 s[82:83], s[18:19], s[86:87]
 s_cselect_b64 s[84:85], s[48:49], s[86:87]
 s_cselect_b64 s[86:87], s[50:51], s[86:87]
 s_cmp_eq_u32 s20, 0
 s_cselect_b64 s[88:89], s[16:17], -1
 s_cselect_b64 s[90:91], s[18:19], -1
 s_cselect_b64 s[92:93], s[48:49], -1
 s_cselect_b64 s[94:95], s[50:51], -1
 s_add_u32 m0, s28, 98304
 v_max3_f32 v10, v64, v65, v66
 buffer_load_dwordx4 v3, s[8:11], s21 offen offset:0 sc1 lds
 v_max3_f32 v10, v67, v72, v10
 v_max3_f32 v10, v73, v74, v10
 v_max3_f32 v10, v75, v80, v10
 v_max3_f32 v10, v81, v82, v10
 v_max3_f32 v10, v83, v88, v10
 v_max3_f32 v10, v89, v90, v10
 v_max_f32 v10, v91, v10
 v_max3_f32 v11, v68, v69, v70
 v_max3_f32 v11, v71, v76, v11
 v_max3_f32 v11, v77, v78, v11
 v_max3_f32 v11, v79, v84, v11
 v_mfma_f32_32x32x16_bf16 v[128:143], v[56:59], v[56:59], 0
 buffer_load_dwordx4 v3, s[8:11], s21 offen offset:1024 sc1 lds
 v_max3_f32 v11, v85, v86, v11
 v_max3_f32 v11, v87, v92, v11
 v_max3_f32 v11, v93, v94, v11
 v_max_f32 v11, v95, v11
 v_mov_b32 v12, v10
 v_mov_b32 v13, v11
 s_nop 0
 v_permlane16_swap_b32 v12, v10
 v_permlane16_swap_b32 v13, v11
 v_max_f32 v10, v12, v10
 v_max_f32 v11, v13, v11
 v_mov_b32 v12, v10
 buffer_load_dwordx4 v3, s[8:11], s21 offen offset:2048 sc1 lds
 v_mov_b32 v13, v11
 v_mfma_f32_32x32x16_bf16 v[144:159], v[56:59], v[56:59], 0
 v_permlane32_swap_b32 v12, v10
 v_permlane32_swap_b32 v13, v11
 v_max_f32 v10, v12, v10
 v_max_f32 v11, v13, v11
 v_ceil_f32 v10, v10
 v_ceil_f32 v11, v11
 v_sub_f32 v32, v32, v10
 v_sub_f32 v33, v33, v10
 v_sub_f32 v34, v34, v10
 v_sub_f32 v35, v35, v10
 buffer_load_dwordx4 v3, s[8:11], s21 offen offset:3072 sc1 lds
 v_sub_f32 v36, v36, v11
 v_sub_f32 v37, v37, v11
 v_sub_f32 v38, v38, v11
 v_mfma_f32_32x32x16_bf16 v[160:175], v[56:59], v[56:59], 0
 v_sub_f32 v39, v39, v11
 v_sub_f32 v64, v64, v10
 v_sub_f32 v65, v65, v10
 v_sub_f32 v66, v66, v10
 v_sub_f32 v67, v67, v10
 v_sub_f32 v68, v68, v11
 v_sub_f32 v69, v69, v11
 s_add_u32 m0, s28, 102400
 v_sub_f32 v70, v70, v11
 buffer_load_dwordx4 v4, s[8:11], s21 offen offset:0 sc1 lds
 v_sub_f32 v71, v71, v11
 v_sub_f32 v72, v72, v10
 v_sub_f32 v73, v73, v10
 v_sub_f32 v74, v74, v10
 v_mfma_f32_32x32x16_bf16 v[176:191], v[56:59], v[56:59], 0
 v_sub_f32 v75, v75, v10
 v_sub_f32 v76, v76, v11
 v_sub_f32 v77, v77, v11
 v_sub_f32 v78, v78, v11
 v_sub_f32 v79, v79, v11
 v_sub_f32 v80, v80, v10
 v_sub_f32 v81, v81, v10
 buffer_load_dwordx4 v4, s[8:11], s21 offen offset:1024 sc1 lds
 v_sub_f32 v82, v82, v10
 v_sub_f32 v83, v83, v10
 v_sub_f32 v84, v84, v11
 v_sub_f32 v85, v85, v11
 v_sub_f32 v86, v86, v11
 v_sub_f32 v87, v87, v11
 v_mfma_f32_32x32x16_bf16 v[192:207], v[56:59], v[56:59], 0
 v_sub_f32 v88, v88, v10
 v_sub_f32 v89, v89, v10
 v_sub_f32 v90, v90, v10
 v_sub_f32 v91, v91, v10
 v_sub_f32 v92, v92, v11
 buffer_load_dwordx4 v4, s[8:11], s21 offen offset:2048 sc1 lds
 v_sub_f32 v93, v93, v11
 v_sub_f32 v94, v94, v11
 v_sub_f32 v95, v95, v11
 v_exp_f32 v18, v64
 v_exp_f32 v19, v65
 v_exp_f32 v20, v66
 v_add_f32 v26, v18, v19
 v_cvt_pk_bf16_f32 v40, v18, v19
 v_mfma_f32_32x32x16_bf16 v[208:223], v[56:59], v[56:59], 0
 v_exp_f32 v21, v67
 v_exp_f32 v22, v72
 v_add_f32 v26, v20, v26
 buffer_load_dwordx4 v4, s[8:11], s21 offen offset:3072 sc1 lds
 v_cvt_pk_bf16_f32 v41, v20, v21
 v_exp_f32 v23, v73
 v_add_f32 v26, v21, v26
 v_exp_f32 v24, v74
 v_add_f32 v26, v22, v26
 v_cvt_pk_bf16_f32 v42, v22, v23
 v_exp_f32 v25, v75
 v_add_f32 v26, v23, v26
 v_exp_f32 v18, v68
 v_add_f32 v26, v24, v26
 v_mfma_f32_32x32x16_bf16 v[224:239], v[56:59], v[56:59], 0
 s_add_u32 s24, s23, 16777216
 s_mov_b32 s23, s21
 s_add_u32 s21, s21, 32768
 s_add_u32 s22, s22, 1
 s_cmp_eq_u32 s22, s25
 s_cselect_b32 s21, s26, s21
 s_cmp_eq_u32 s22, s43
 s_cselect_b32 s21, s4, s21
 s_cmp_eq_u32 s22, s6
 s_cselect_b32 s21, s7, s21
 v_cvt_pk_bf16_f32 v43, v24, v25
 buffer_load_dword v5, off, s[8:11], s47 sc1
 v_exp_f32 v19, v69
 v_add_f32 v26, v25, v26
 v_mfma_f32_32x32x16_bf16 v[240:255], v[56:59], v[56:59], 0
 v_exp_f32 v20, v70
 v_add_f32 v27, v18, v19
 v_cvt_pk_bf16_f32 v44, v18, v19
 v_exp_f32 v21, v71
 v_exp_f32 v22, v76
 v_add_f32 v27, v20, v27
 v_cvt_pk_bf16_f32 v45, v20, v21
 v_exp_f32 v23, v77
 v_add_f32 v27, v21, v27
 v_exp_f32 v24, v78
 v_add_f32 v27, v22, v27
 v_cvt_pk_bf16_f32 v46, v22, v23
 v_exp_f32 v25, v79
 v_add_f32 v27, v23, v27
 v_add_f32 v27, v24, v27
 v_cvt_pk_bf16_f32 v47, v24, v25
 v_add_f32 v27, v25, v27
 v_cndmask_b32 v100, v36, v8, s[64:65]
 v_cndmask_b32 v101, v36, v8, s[66:67]
 v_cndmask_b32 v102, v36, v8, s[68:69]
 v_cndmask_b32 v103, v36, v8, s[70:71]
 v_cndmask_b32 v108, v36, v8, s[72:73]
 v_cndmask_b32 v109, v36, v8, s[74:75]
 v_cndmask_b32 v110, v36, v8, s[76:77]
 v_cndmask_b32 v111, v36, v8, s[78:79]
 v_cndmask_b32 v116, v36, v8, s[80:81]
 v_cndmask_b32 v117, v36, v8, s[82:83]
 v_cndmask_b32 v118, v36, v8, s[84:85]
 v_cndmask_b32 v119, v36, v8, s[86:87]
 v_cndmask_b32 v124, v36, v8, s[88:89]
 v_cndmask_b32 v125, v36, v8, s[90:91]
 v_cndmask_b32 v126, v36, v8, s[92:93]
 v_cndmask_b32 v127, v36, v8, s[94:95]
 s_branch L_p2
L_kv1:
 s_mov_b32 s60, s90
 s_and_b32 s61, s91, 0xffff
 s_mov_b32 s62, 3670016
 s_mov_b32 s63, 0x20000
 s_waitcnt vmcnt(4) lgkmcnt(0)
 s_barrier
 ds_read_b128 a[160:163], v5 offset:0
 ds_read_b128 a[164:167], v6 offset:0
 ds_read_b64_tr_b16 a[32:33], v1 offset:0
 ds_read_b64_tr_b16 a[34:35], v1 offset:1024
 ds_read_b64_tr_b16 a[36:37], v1 offset:8192
 ds_read_b64_tr_b16 a[38:39], v1 offset:9216
 ds_read_b64_tr_b16 a[40:41], v2 offset:0
 ds_read_b64_tr_b16 a[42:43], v2 offset:1024
 ds_read_b64_tr_b16 a[44:45], v2 offset:8192
 ds_read_b64_tr_b16 a[46:47], v2 offset:9216
 ds_read_b128 a[168:171], v5 offset:2048
 ds_read_b128 a[172:175], v6 offset:2048
 ds_read_b64_tr_b16 a[48:49], v3 offset:0
 ds_read_b64_tr_b16 a[50:51], v3 offset:1024
 ds_read_b64_tr_b16 a[52:53], v3 offset:8192
 ds_read_b64_tr_b16 a[54:55], v3 offset:9216
 ds_read_b64_tr_b16 a[56:57], v4 offset:0
 ds_read_b64_tr_b16 a[58:59], v4 offset:1024
 ds_read_b64_tr_b16 a[60:61], v4 offset:8192
 ds_read_b64_tr_b16 a[62:63], v4 offset:9216
 ds_read_b128 a[176:179], v5 offset:4096
 ds_read_b128 a[180:183], v6 offset:4096
 ds_read_b128 a[184:187], v5 offset:6144
 ds_read_b128 a[188:191], v6 offset:6144
 s_add_u32 m0, s24, 16384
 s_nop 0
 buffer_load_dwordx4 v12, s[48:51], s22 offen offset:0   lds
 buffer_load_dwordx4 v13, s[48:51], s22 offen offset:1024   lds
 buffer_load_dwordx4 v14, s[48:51], s22 offen offset:2048   lds
 buffer_load_dwordx4 v15, s[48:51], s22 offen offset:3072   lds
 s_sub_u32 s22, s22, 2097024
 s_add_u32 m0, s23, 32768
 s_nop 0
 buffer_load_dwordx4 v8, s[16:19], s21 offen offset:0  nt lds
 buffer_load_dwordx4 v9, s[16:19], s21 offen offset:1024  nt lds
 buffer_load_dwordx4 v10, s[16:19], s21 offen offset:2048  nt lds
 buffer_load_dwordx4 v11, s[16:19], s21 offen offset:3072  nt lds
 s_add_u32 s21, s21, 128
 s_waitcnt lgkmcnt(15)
M a[0:3], a[32:35], a[160:163], 0
M a[0:3], a[36:39], a[164:167], a[0:3]
 s_waitcnt lgkmcnt(14)
M a[4:7], a[44:47], a[164:167], 0
M a[4:7], a[40:43], a[160:163], a[4:7]
 s_waitcnt lgkmcnt(8)
M a[8:11], a[48:51], a[160:163], 0
M a[8:11], a[52:55], a[164:167], a[8:11]
 s_waitcnt lgkmcnt(4)
M a[12:15], a[60:63], a[164:167], 0
 s_add_u32 m0, s23, 49152
M a[12:15], a[56:59], a[160:163], a[12:15]
 buffer_load_dwordx4 v8, s[16:19], s21 offen offset:0  nt lds
M v[32:35], a[32:35], a[168:171], 0
 buffer_load_dwordx4 v9, s[16:19], s21 offen offset:1024  nt lds
M v[32:35], a[36:39], a[172:175], v[32:35]
M v[36:39], a[44:47], a[172:175], 0
 buffer_load_dwordx4 v10, s[16:19], s21 offen offset:2048  nt lds
M v[36:39], a[40:43], a[168:171], v[36:39]
M v[40:43], a[48:51], a[168:171], 0
 buffer_load_dwordx4 v11, s[16:19], s21 offen offset:3072  nt lds
M v[40:43], a[52:55], a[172:175], v[40:43]
 s_add_u32 s21, s21, 524160
M v[44:47], a[60:63], a[172:175], 0
 s_waitcnt vmcnt(12) lgkmcnt(0)
M v[44:47], a[56:59], a[168:171], v[44:47]
 s_barrier
M v[64:67], a[32:35], a[176:179], 0
 s_add_u32 m0, s24, 32768
 ds_read_b64_tr_b16 a[64:65], v1 offset:16384
 ds_read_b64_tr_b16 a[66:67], v1 offset:17408
M v[64:67], a[36:39], a[180:183], v[64:67]
 ds_read_b64_tr_b16 a[68:69], v1 offset:24576
 ds_read_b64_tr_b16 a[70:71], v1 offset:25600
M v[68:71], a[44:47], a[180:183], 0
 buffer_load_dwordx4 v12, s[48:51], s22 offen offset:0   lds
M v[68:71], a[40:43], a[176:179], v[68:71]
 ds_read_b64_tr_b16 a[72:73], v2 offset:16384
 ds_read_b64_tr_b16 a[74:75], v2 offset:17408
M v[72:75], a[48:51], a[176:179], 0
 ds_read_b64_tr_b16 a[76:77], v2 offset:24576
 ds_read_b64_tr_b16 a[78:79], v2 offset:25600
M v[72:75], a[52:55], a[180:183], v[72:75]
 buffer_load_dwordx4 v13, s[48:51], s22 offen offset:1024   lds
M v[76:79], a[60:63], a[180:183], 0
 ds_read_b64_tr_b16 a[80:81], v3 offset:16384
 ds_read_b64_tr_b16 a[82:83], v3 offset:17408
M v[76:79], a[56:59], a[176:179], v[76:79]
 ds_read_b64_tr_b16 a[84:85], v3 offset:24576
 ds_read_b64_tr_b16 a[86:87], v3 offset:25600
M v[96:99], a[32:35], a[184:187], 0
 buffer_load_dwordx4 v14, s[48:51], s22 offen offset:2048   lds
M v[96:99], a[36:39], a[188:191], v[96:99]
 ds_read_b64_tr_b16 a[88:89], v4 offset:16384
 ds_read_b64_tr_b16 a[90:91], v4 offset:17408
M v[100:103], a[44:47], a[188:191], 0
 ds_read_b64_tr_b16 a[92:93], v4 offset:24576
 ds_read_b64_tr_b16 a[94:95], v4 offset:25600
M v[100:103], a[40:43], a[184:187], v[100:103]
 buffer_load_dwordx4 v15, s[48:51], s22 offen offset:3072   lds
M v[104:107], a[48:51], a[184:187], 0
 s_add_u32 s22, s22, 2097152
 v_max3_f32 v20, |v32|, |v33|, |v34|
 v_max3_f32 v20, |v35|, |v36|, v20
M v[104:107], a[52:55], a[188:191], v[104:107]
 v_max3_f32 v20, |v37|, |v38|, v20
 v_max3_f32 v21, |v64|, |v65|, |v66|
M v[108:111], a[60:63], a[188:191], 0
 s_add_u32 m0, s23, 0
 v_max3_f32 v21, |v67|, |v68|, v21
 v_max3_f32 v21, |v69|, |v70|, v21
M v[108:111], a[56:59], a[184:187], v[108:111]
 s_waitcnt lgkmcnt(0)
 v_min_f32 v20, v20, v21
 v_mul_f32 v20, 0x41000000, v20
M a[16:19], a[64:67], a[160:163], 0
 buffer_load_dwordx4 v8, s[16:19], s21 offen offset:0  nt lds
M a[16:19], a[68:71], a[164:167], a[16:19]
 v_mov_b32 v21, v20
 v_mov_b32 v22, v20
M a[20:23], a[76:79], a[164:167], 0
 buffer_load_dwordx4 v9, s[16:19], s21 offen offset:1024  nt lds
M a[20:23], a[72:75], a[160:163], a[20:23]
 v_mov_b32 v23, v20
 v_accvgpr_write_b32 a241, v20
M a[24:27], a[80:83], a[160:163], 0
M a[24:27], a[84:87], a[164:167], a[24:27]
M a[28:31], a[92:95], a[164:167], 0
 buffer_load_dwordx4 v10, s[16:19], s21 offen offset:2048  nt lds
M a[28:31], a[88:91], a[160:163], a[28:31]
M v[48:51], a[64:67], a[168:171], v[20:23]
M v[48:51], a[68:71], a[172:175], v[48:51]
 buffer_load_dwordx4 v11, s[16:19], s21 offen offset:3072  nt lds
M v[52:55], a[76:79], a[172:175], v[20:23]
 s_add_u32 s21, s21, 128
M v[52:55], a[72:75], a[168:171], v[52:55]
M v[56:59], a[80:83], a[168:171], v[20:23]
M v[56:59], a[84:87], a[172:175], v[56:59]
M v[60:63], a[92:95], a[172:175], v[20:23]
 s_waitcnt vmcnt(12)
M v[60:63], a[88:91], a[168:171], v[60:63]
 s_barrier
M v[80:83], a[64:67], a[176:179], v[20:23]
 s_add_u32 m0, s24, 49152
 ds_read_b128 a[160:163], v5 offset:16384
 ds_read_b128 a[164:167], v6 offset:16384
M v[80:83], a[68:71], a[180:183], v[80:83]
 buffer_load_dwordx4 v12, s[48:51], s22 offen offset:0   lds
M v[84:87], a[76:79], a[180:183], v[20:23]
 ds_read_b64_tr_b16 a[96:97], v1 offset:32768
 ds_read_b64_tr_b16 a[98:99], v1 offset:33792
M v[84:87], a[72:75], a[176:179], v[84:87]
M v[88:91], a[80:83], a[176:179], v[20:23]
 buffer_load_dwordx4 v13, s[48:51], s22 offen offset:1024   lds
M v[88:91], a[84:87], a[180:183], v[88:91]
 ds_read_b64_tr_b16 a[100:101], v1 offset:40960
 ds_read_b64_tr_b16 a[102:103], v1 offset:41984
M v[92:95], a[92:95], a[180:183], v[20:23]
M v[92:95], a[88:91], a[176:179], v[92:95]
M v[112:115], a[64:67], a[184:187], v[20:23]
 ds_read_b64_tr_b16 a[104:105], v2 offset:32768
 ds_read_b64_tr_b16 a[106:107], v2 offset:33792
M v[112:115], a[68:71], a[188:191], v[112:115]
 buffer_load_dwordx4 v14, s[48:51], s22 offen offset:2048   lds
M v[116:119], a[76:79], a[188:191], v[20:23]
M v[116:119], a[72:75], a[184:187], v[116:119]
 ds_read_b64_tr_b16 a[108:109], v2 offset:40960
 ds_read_b64_tr_b16 a[110:111], v2 offset:41984
M v[120:123], a[80:83], a[184:187], v[20:23]
 buffer_load_dwordx4 v15, s[48:51], s22 offen offset:3072   lds
M v[120:123], a[84:87], a[188:191], v[120:123]
 s_waitcnt lgkmcnt(8)
M v[124:127], a[92:95], a[188:191], v[20:23]
 s_sub_u32 s22, s22, 2097024
M v[124:127], a[88:91], a[184:187], v[124:127]
 s_add_u32 m0, s23, 16384
 ds_read_b64_tr_b16 a[112:113], v3 offset:32768
 ds_read_b64_tr_b16 a[114:115], v3 offset:33792
M v[128:131], a[32:35], a[160:163], v[20:23]
 ds_read_b128 a[168:171], v5 offset:18432
 ds_read_b128 a[172:175], v6 offset:18432
M v[128:131], a[36:39], a[164:167], v[128:131]
 buffer_load_dwordx4 v8, s[16:19], s21 offen offset:0  nt lds
M v[132:135], a[44:47], a[164:167], v[20:23]
 ds_read_b64_tr_b16 a[116:117], v3 offset:40960
 ds_read_b64_tr_b16 a[118:119], v3 offset:41984
M v[132:135], a[40:43], a[160:163], v[132:135]
 buffer_load_dwordx4 v9, s[16:19], s21 offen offset:1024  nt lds
M v[136:139], a[48:51], a[160:163], v[20:23]
M v[136:139], a[52:55], a[164:167], v[136:139]
 ds_read_b64_tr_b16 a[120:121], v4 offset:32768
 ds_read_b64_tr_b16 a[122:123], v4 offset:33792
M v[140:143], a[60:63], a[164:167], v[20:23]
 buffer_load_dwordx4 v10, s[16:19], s21 offen offset:2048  nt lds
M v[140:143], a[56:59], a[160:163], v[140:143]
M v[144:147], a[64:67], a[160:163], v[20:23]
 ds_read_b64_tr_b16 a[124:125], v4 offset:40960
 ds_read_b64_tr_b16 a[126:127], v4 offset:41984
M v[144:147], a[68:71], a[164:167], v[144:147]
 buffer_load_dwordx4 v11, s[16:19], s21 offen offset:3072  nt lds
M v[148:151], a[76:79], a[164:167], v[20:23]
 s_add_u32 s21, s21, 524160
M v[148:151], a[72:75], a[160:163], v[148:151]
M v[152:155], a[80:83], a[160:163], v[20:23]
M v[152:155], a[84:87], a[164:167], v[152:155]
 s_waitcnt lgkmcnt(6)
M v[156:159], a[92:95], a[164:167], v[20:23]
 s_waitcnt vmcnt(16) lgkmcnt(0)
M v[156:159], a[88:91], a[160:163], v[156:159]
 s_barrier
M v[160:163], a[32:35], a[168:171], v[20:23]
 s_add_u32 m0, s24, 0
 ds_read_b128 a[160:163], v5 offset:20480
 ds_read_b128 a[164:167], v6 offset:20480
M v[160:163], a[36:39], a[172:175], v[160:163]
 buffer_load_dwordx4 v12, s[48:51], s22 offen offset:0   lds
M v[164:167], a[44:47], a[172:175], v[20:23]
 ds_read_b64_tr_b16 a[128:129], v1 offset:49152
 ds_read_b64_tr_b16 a[130:131], v1 offset:50176
M v[164:167], a[40:43], a[168:171], v[164:167]
M v[168:171], a[48:51], a[168:171], v[20:23]
 buffer_load_dwordx4 v13, s[48:51], s22 offen offset:1024   lds
M v[168:171], a[52:55], a[172:175], v[168:171]
 ds_read_b64_tr_b16 a[132:133], v1 offset:57344
 ds_read_b64_tr_b16 a[134:135], v1 offset:58368
M v[172:175], a[60:63], a[172:175], v[20:23]
M v[172:175], a[56:59], a[168:171], v[172:175]
M v[176:179], a[64:67], a[168:171], v[20:23]
 ds_read_b64_tr_b16 a[136:137], v2 offset:49152
 ds_read_b64_tr_b16 a[138:139], v2 offset:50176
M v[176:179], a[68:71], a[172:175], v[176:179]
 buffer_load_dwordx4 v14, s[48:51], s22 offen offset:2048   lds
M v[180:183], a[76:79], a[172:175], v[20:23]
M v[180:183], a[72:75], a[168:171], v[180:183]
 ds_read_b64_tr_b16 a[140:141], v2 offset:57344
 ds_read_b64_tr_b16 a[142:143], v2 offset:58368
M v[184:187], a[80:83], a[168:171], v[20:23]
 buffer_load_dwordx4 v15, s[48:51], s22 offen offset:3072   lds
M v[184:187], a[84:87], a[172:175], v[184:187]
 s_waitcnt lgkmcnt(8)
M v[188:191], a[92:95], a[172:175], v[20:23]
 s_add_u32 s22, s22, 2097152
M v[188:191], a[88:91], a[168:171], v[188:191]
 s_add_u32 m0, s23, 32768
 ds_read_b64_tr_b16 a[144:145], v3 offset:49152
 ds_read_b64_tr_b16 a[146:147], v3 offset:50176
M v[192:195], a[32:35], a[160:163], v[20:23]
 ds_read_b128 a[168:171], v5 offset:22528
 ds_read_b128 a[172:175], v6 offset:22528
M v[192:195], a[36:39], a[164:167], v[192:195]
 buffer_load_dwordx4 v8, s[16:19], s21 offen offset:0  nt lds
M v[196:199], a[44:47], a[164:167], v[20:23]
 ds_read_b64_tr_b16 a[148:149], v3 offset:57344
 ds_read_b64_tr_b16 a[150:151], v3 offset:58368
M v[196:199], a[40:43], a[160:163], v[196:199]
 buffer_load_dwordx4 v9, s[16:19], s21 offen offset:1024  nt lds
M v[200:203], a[48:51], a[160:163], v[20:23]
M v[200:203], a[52:55], a[164:167], v[200:203]
 ds_read_b64_tr_b16 a[152:153], v4 offset:49152
 ds_read_b64_tr_b16 a[154:155], v4 offset:50176
M v[204:207], a[60:63], a[164:167], v[20:23]
 buffer_load_dwordx4 v10, s[16:19], s21 offen offset:2048  nt lds
M v[204:207], a[56:59], a[160:163], v[204:207]
M v[208:211], a[64:67], a[160:163], v[20:23]
 ds_read_b64_tr_b16 a[156:157], v4 offset:57344
 ds_read_b64_tr_b16 a[158:159], v4 offset:58368
M v[208:211], a[68:71], a[164:167], v[208:211]
 buffer_load_dwordx4 v11, s[16:19], s21 offen offset:3072  nt lds
M v[212:215], a[76:79], a[164:167], v[20:23]
 s_add_u32 s21, s21, 128
M v[212:215], a[72:75], a[160:163], v[212:215]
M v[216:219], a[80:83], a[160:163], v[20:23]
M v[216:219], a[84:87], a[164:167], v[216:219]
 s_waitcnt lgkmcnt(6)
M v[220:223], a[92:95], a[164:167], v[20:23]
 s_waitcnt vmcnt(16) lgkmcnt(0)
M v[220:223], a[88:91], a[160:163], v[220:223]
 s_barrier
M v[224:227], a[32:35], a[168:171], v[20:23]
 ds_read_b128 a[160:163], v5 offset:32768
 ds_read_b128 a[164:167], v6 offset:32768
M v[224:227], a[36:39], a[172:175], v[224:227]
 buffer_load_dword a240, v24, s[32:35], 0 offen offset:512
M v[228:231], a[44:47], a[172:175], v[20:23]
M v[228:231], a[40:43], a[168:171], v[228:231]
M v[232:235], a[48:51], a[168:171], v[20:23]
M v[232:235], a[52:55], a[172:175], v[232:235]
M v[236:239], a[60:63], a[172:175], v[20:23]
M v[236:239], a[56:59], a[168:171], v[236:239]
M v[240:243], a[64:67], a[168:171], v[20:23]
M v[240:243], a[68:71], a[172:175], v[240:243]
M v[244:247], a[76:79], a[172:175], v[20:23]
M v[244:247], a[72:75], a[168:171], v[244:247]
M v[248:251], a[80:83], a[168:171], v[20:23]
M v[248:251], a[84:87], a[172:175], v[248:251]
 s_waitcnt lgkmcnt(0)
M v[252:255], a[92:95], a[172:175], v[20:23]
M v[252:255], a[88:91], a[168:171], v[252:255]
M a[0:3], a[96:99], a[160:163], a[0:3]
 ds_read_b128 a[168:171], v5 offset:34816
 ds_read_b128 a[172:175], v6 offset:34816
M a[0:3], a[100:103], a[164:167], a[0:3]
 ds_read_b64_tr_b16 a[32:33], v1 offset:0
 ds_read_b64_tr_b16 a[34:35], v1 offset:1024
M a[4:7], a[108:111], a[164:167], a[4:7]
 s_add_u32 m0, s24, 16384
M a[4:7], a[104:107], a[160:163], a[4:7]
 buffer_load_dwordx4 v12, s[48:51], s22 offen offset:0   lds
M a[8:11], a[112:115], a[160:163], a[8:11]
M a[8:11], a[116:119], a[164:167], a[8:11]
M a[12:15], a[124:127], a[164:167], a[12:15]
 ds_read_b64_tr_b16 a[36:37], v1 offset:8192
 ds_read_b64_tr_b16 a[38:39], v1 offset:9216
M a[12:15], a[120:123], a[160:163], a[12:15]
M a[16:19], a[128:131], a[160:163], a[16:19]
 buffer_load_dwordx4 v13, s[48:51], s22 offen offset:1024   lds
M a[16:19], a[132:135], a[164:167], a[16:19]
M a[20:23], a[140:143], a[164:167], a[20:23]
M a[20:23], a[136:139], a[160:163], a[20:23]
 ds_read_b64_tr_b16 a[40:41], v2 offset:0
 ds_read_b64_tr_b16 a[42:43], v2 offset:1024
M a[24:27], a[144:147], a[160:163], a[24:27]
M a[24:27], a[148:151], a[164:167], a[24:27]
 s_waitcnt lgkmcnt(6)
M a[28:31], a[156:159], a[164:167], a[28:31]
 buffer_load_dwordx4 v14, s[48:51], s22 offen offset:2048   lds
M a[28:31], a[152:155], a[160:163], a[28:31]
M v[32:35], a[96:99], a[168:171], v[32:35]
 ds_read_b128 a[160:163], v5 offset:36864
 ds_read_b128 a[164:167], v6 offset:36864
M v[32:35], a[100:103], a[172:175], v[32:35]
 ds_read_b64_tr_b16 a[44:45], v2 offset:8192
 ds_read_b64_tr_b16 a[46:47], v2 offset:9216
M v[36:39], a[108:111], a[172:175], v[36:39]
 buffer_load_dwordx4 v15, s[48:51], s22 offen offset:3072   lds
M v[36:39], a[104:107], a[168:171], v[36:39]
 s_sub_u32 s22, s22, 2097024
M v[40:43], a[112:115], a[168:171], v[40:43]
M v[40:43], a[116:119], a[172:175], v[40:43]
 ds_read_b64_tr_b16 a[48:49], v3 offset:0
 ds_read_b64_tr_b16 a[50:51], v3 offset:1024
M v[44:47], a[124:127], a[172:175], v[44:47]
 s_add_u32 m0, s23, 49152
M v[44:47], a[120:123], a[168:171], v[44:47]
 buffer_load_dwordx4 v8, s[16:19], s21 offen offset:0  nt lds
M v[48:51], a[128:131], a[168:171], v[48:51]
M v[48:51], a[132:135], a[172:175], v[48:51]
M v[52:55], a[140:143], a[172:175], v[52:55]
 ds_read_b64_tr_b16 a[52:53], v3 offset:8192
 ds_read_b64_tr_b16 a[54:55], v3 offset:9216
M v[52:55], a[136:139], a[168:171], v[52:55]
M v[56:59], a[144:147], a[168:171], v[56:59]
 buffer_load_dwordx4 v9, s[16:19], s21 offen offset:1024  nt lds
M v[56:59], a[148:151], a[172:175], v[56:59]
 s_waitcnt lgkmcnt(6)
M v[60:63], a[156:159], a[172:175], v[60:63]
M v[60:63], a[152:155], a[168:171], v[60:63]
 ds_read_b64_tr_b16 a[56:57], v4 offset:0
 ds_read_b64_tr_b16 a[58:59], v4 offset:1024
M v[64:67], a[96:99], a[160:163], v[64:67]
 ds_read_b128 a[168:171], v5 offset:38912
 ds_read_b128 a[172:175], v6 offset:38912
M v[64:67], a[100:103], a[164:167], v[64:67]
 buffer_load_dwordx4 v10, s[16:19], s21 offen offset:2048  nt lds
M v[68:71], a[108:111], a[164:167], v[68:71]
M v[68:71], a[104:107], a[160:163], v[68:71]
M v[72:75], a[112:115], a[160:163], v[72:75]
 ds_read_b64_tr_b16 a[60:61], v4 offset:8192
 ds_read_b64_tr_b16 a[62:63], v4 offset:9216
M v[72:75], a[116:119], a[164:167], v[72:75]
M v[76:79], a[124:127], a[164:167], v[76:79]
 buffer_load_dwordx4 v11, s[16:19], s21 offen offset:3072  nt lds
M v[76:79], a[120:123], a[160:163], v[76:79]
 s_add_u32 s21, s21, 524160
M v[80:83], a[128:131], a[160:163], v[80:83]
M v[80:83], a[132:135], a[164:167], v[80:83]
M v[84:87], a[140:143], a[164:167], v[84:87]
M v[84:87], a[136:139], a[160:163], v[84:87]
M v[88:91], a[144:147], a[160:163], v[88:91]
M v[88:91], a[148:151], a[164:167], v[88:91]
 s_waitcnt lgkmcnt(2)
M v[92:95], a[156:159], a[164:167], v[92:95]
 s_waitcnt vmcnt(17) lgkmcnt(0)
M v[92:95], a[152:155], a[160:163], v[92:95]
 s_barrier
M v[96:99], a[96:99], a[168:171], v[96:99]
 ds_read_b128 a[160:163], v5 offset:49152
 ds_read_b128 a[164:167], v6 offset:49152
M v[96:99], a[100:103], a[172:175], v[96:99]
M v[100:103], a[108:111], a[172:175], v[100:103]
 s_add_u32 m0, s24, 32768
 ds_read_b64_tr_b16 a[64:65], v1 offset:16384
 ds_read_b64_tr_b16 a[66:67], v1 offset:17408
M v[100:103], a[104:107], a[168:171], v[100:103]
 buffer_load_dwordx4 v12, s[48:51], s22 offen offset:0   lds
M v[104:107], a[112:115], a[168:171], v[104:107]
M v[104:107], a[116:119], a[172:175], v[104:107]
M v[108:111], a[124:127], a[172:175], v[108:111]
M v[108:111], a[120:123], a[168:171], v[108:111]
M v[112:115], a[128:131], a[168:171], v[112:115]
M v[112:115], a[132:135], a[172:175], v[112:115]
 ds_read_b64_tr_b16 a[68:69], v1 offset:24576
 ds_read_b64_tr_b16 a[70:71], v1 offset:25600
M v[116:119], a[140:143], a[172:175], v[116:119]
 buffer_load_dwordx4 v13, s[48:51], s22 offen offset:1024   lds
M v[116:119], a[136:139], a[168:171], v[116:119]
M v[120:123], a[144:147], a[168:171], v[120:123]
M v[120:123], a[148:151], a[172:175], v[120:123]
 s_waitcnt lgkmcnt(4)
M v[124:127], a[156:159], a[172:175], v[124:127]
M v[124:127], a[152:155], a[168:171], v[124:127]
M v[128:131], a[96:99], a[160:163], v[128:131]
 ds_read_b128 a[168:171], v5 offset:51200
 ds_read_b128 a[172:175], v6 offset:51200
M v[128:131], a[100:103], a[164:167], v[128:131]
 ds_read_b64_tr_b16 a[72:73], v2 offset:16384
 ds_read_b64_tr_b16 a[74:75], v2 offset:17408
M v[132:135], a[108:111], a[164:167], v[132:135]
 buffer_load_dwordx4 v14, s[48:51], s22 offen offset:2048   lds
M v[132:135], a[104:107], a[160:163], v[132:135]
M v[136:139], a[112:115], a[160:163], v[136:139]
M v[136:139], a[116:119], a[164:167], v[136:139]
M v[140:143], a[124:127], a[164:167], v[140:143]
M v[140:143], a[120:123], a[160:163], v[140:143]
 ds_read_b64_tr_b16 a[76:77], v2 offset:24576
 ds_read_b64_tr_b16 a[78:79], v2 offset:25600
M v[144:147], a[128:131], a[160:163], v[144:147]
 buffer_load_dwordx4 v15, s[48:51], s22 offen offset:3072   lds
M v[144:147], a[132:135], a[164:167], v[144:147]
 s_add_u32 s22, s22, 2097152
M v[148:151], a[140:143], a[164:167], v[148:151]
M v[148:151], a[136:139], a[160:163], v[148:151]
M v[152:155], a[144:147], a[160:163], v[152:155]
M v[152:155], a[148:151], a[164:167], v[152:155]
 s_waitcnt lgkmcnt(4)
M v[156:159], a[156:159], a[164:167], v[156:159]
 s_add_u32 m0, s23, 0
 ds_read_b64_tr_b16 a[80:81], v3 offset:16384
 ds_read_b64_tr_b16 a[82:83], v3 offset:17408
M v[156:159], a[152:155], a[160:163], v[156:159]
 buffer_load_dwordx4 v8, s[16:19], s21 offen offset:0  nt lds
M v[160:163], a[96:99], a[168:171], v[160:163]
 ds_read_b128 a[160:163], v5 offset:53248
 ds_read_b128 a[164:167], v6 offset:53248
M v[160:163], a[100:103], a[172:175], v[160:163]
M v[164:167], a[108:111], a[172:175], v[164:167]
M v[164:167], a[104:107], a[168:171], v[164:167]
M v[168:171], a[112:115], a[168:171], v[168:171]
M v[168:171], a[116:119], a[172:175], v[168:171]
 ds_read_b64_tr_b16 a[84:85], v3 offset:24576
 ds_read_b64_tr_b16 a[86:87], v3 offset:25600
M v[172:175], a[124:127], a[172:175], v[172:175]
 buffer_load_dwordx4 v9, s[16:19], s21 offen offset:1024  nt lds
M v[172:175], a[120:123], a[168:171], v[172:175]
M v[176:179], a[128:131], a[168:171], v[176:179]
M v[176:179], a[132:135], a[172:175], v[176:179]
M v[180:183], a[140:143], a[172:175], v[180:183]
M v[180:183], a[136:139], a[168:171], v[180:183]
M v[184:187], a[144:147], a[168:171], v[184:187]
 ds_read_b64_tr_b16 a[88:89], v4 offset:16384
 ds_read_b64_tr_b16 a[90:91], v4 offset:17408
M v[184:187], a[148:151], a[172:175], v[184:187]
 s_waitcnt lgkmcnt(4)
M v[188:191], a[156:159], a[172:175], v[188:191]
 buffer_load_dwordx4 v10, s[16:19], s21 offen offset:2048  nt lds
M v[188:191], a[152:155], a[168:171], v[188:191]
M v[192:195], a[96:99], a[160:163], v[192:195]
 ds_read_b128 a[168:171], v5 offset:55296
 ds_read_b128 a[172:175], v6 offset:55296
M v[192:195], a[100:103], a[164:167], v[192:195]
M v[196:199], a[108:111], a[164:167], v[196:199]
M v[196:199], a[104:107], a[160:163], v[196:199]
 ds_read_b64_tr_b16 a[92:93], v4 offset:24576
 ds_read_b64_tr_b16 a[94:95], v4 offset:25600
M v[200:203], a[112:115], a[160:163], v[200:203]
 buffer_load_dwordx4 v11, s[16:19], s21 offen offset:3072  nt lds
M v[200:203], a[116:119], a[164:167], v[200:203]
 s_add_u32 s21, s21, 128
M v[204:207], a[124:127], a[164:167], v[204:207]
M v[204:207], a[120:123], a[160:163], v[204:207]
M v[208:211], a[128:131], a[160:163], v[208:211]
M v[208:211], a[132:135], a[164:167], v[208:211]
M v[212:215], a[140:143], a[164:167], v[212:215]
M v[212:215], a[136:139], a[160:163], v[212:215]
M v[216:219], a[144:147], a[160:163], v[216:219]
M v[216:219], a[148:151], a[164:167], v[216:219]
 s_waitcnt lgkmcnt(2)
M v[220:223], a[156:159], a[164:167], v[220:223]
 s_waitcnt vmcnt(17) lgkmcnt(0)
M v[220:223], a[152:155], a[160:163], v[220:223]
 s_barrier
M v[224:227], a[96:99], a[168:171], v[224:227]
 ds_read_b128 a[160:163], v5 offset:0
 ds_read_b128 a[164:167], v6 offset:0
M v[224:227], a[100:103], a[172:175], v[224:227]
M v[228:231], a[108:111], a[172:175], v[228:231]
M v[228:231], a[104:107], a[168:171], v[228:231]
M v[232:235], a[112:115], a[168:171], v[232:235]
M v[232:235], a[116:119], a[172:175], v[232:235]
M v[236:239], a[124:127], a[172:175], v[236:239]
M v[236:239], a[120:123], a[168:171], v[236:239]
M v[240:243], a[128:131], a[168:171], v[240:243]
M v[240:243], a[132:135], a[172:175], v[240:243]
M v[244:247], a[140:143], a[172:175], v[244:247]
M v[244:247], a[136:139], a[168:171], v[244:247]
M v[248:251], a[144:147], a[168:171], v[248:251]
M v[248:251], a[148:151], a[172:175], v[248:251]
 s_waitcnt lgkmcnt(0)
M v[252:255], a[156:159], a[172:175], v[252:255]
M v[252:255], a[152:155], a[168:171], v[252:255]
M a[0:3], a[32:35], a[160:163], a[0:3]
 ds_read_b128 a[168:171], v5 offset:2048
 ds_read_b128 a[172:175], v6 offset:2048
M a[0:3], a[36:39], a[164:167], a[0:3]
 ds_read_b64_tr_b16 a[96:97], v1 offset:32768
 ds_read_b64_tr_b16 a[98:99], v1 offset:33792
M a[4:7], a[44:47], a[164:167], a[4:7]
 s_add_u32 m0, s24, 49152
M a[4:7], a[40:43], a[160:163], a[4:7]
 buffer_load_dwordx4 v12, s[48:51], s22 offen offset:0   lds
M a[8:11], a[48:51], a[160:163], a[8:11]
M a[8:11], a[52:55], a[164:167], a[8:11]
M a[12:15], a[60:63], a[164:167], a[12:15]
 ds_read_b64_tr_b16 a[100:101], v1 offset:40960
 ds_read_b64_tr_b16 a[102:103], v1 offset:41984
M a[12:15], a[56:59], a[160:163], a[12:15]
M a[16:19], a[64:67], a[160:163], a[16:19]
 buffer_load_dwordx4 v13, s[48:51], s22 offen offset:1024   lds
M a[16:19], a[68:71], a[164:167], a[16:19]
M a[20:23], a[76:79], a[164:167], a[20:23]
 v_mov_b32 v16, 0x3f80
M a[20:23], a[72:75], a[160:163], a[20:23]
 ds_read_b64_tr_b16 a[104:105], v2 offset:32768
 ds_read_b64_tr_b16 a[106:107], v2 offset:33792
M a[24:27], a[80:83], a[160:163], a[24:27]
 v_lshrrev_b32 v17, 8, v7
M a[24:27], a[84:87], a[164:167], a[24:27]
 s_waitcnt lgkmcnt(6)
 v_bfe_u32 v18, v7, 6, 2
M a[28:31], a[92:95], a[164:167], a[28:31]
 buffer_load_dwordx4 v14, s[48:51], s22 offen offset:2048   lds
M a[28:31], a[88:91], a[160:163], a[28:31]
 v_and_b32 v19, 16, v7
M v[32:35], a[32:35], a[168:171], v[32:35]
 ds_read_b128 a[160:163], v5 offset:4096
 ds_read_b128 a[164:167], v6 offset:4096
M v[32:35], a[36:39], a[172:175], v[32:35]
 ds_read_b64_tr_b16 a[108:109], v2 offset:40960
 ds_read_b64_tr_b16 a[110:111], v2 offset:41984
M v[36:39], a[44:47], a[172:175], v[36:39]
 buffer_load_dwordx4 v15, s[48:51], s22 offen offset:3072   lds
M v[36:39], a[40:43], a[168:171], v[36:39]
 s_sub_u32 s22, s22, 2097024
 v_lshlrev_b32 v19, v19, v16
M v[40:43], a[48:51], a[168:171], v[40:43]
 v_cmp_eq_u32 vcc, v17, v18
M v[40:43], a[52:55], a[172:175], v[40:43]
 ds_read_b64_tr_b16 a[112:113], v3 offset:32768
 ds_read_b64_tr_b16 a[114:115], v3 offset:33792
M v[44:47], a[60:63], a[172:175], v[44:47]
 s_add_u32 m0, s23, 16384
 v_and_b32 v16, 32, v7
M v[44:47], a[56:59], a[168:171], v[44:47]
 buffer_load_dwordx4 v8, s[16:19], s21 offen offset:0  nt lds
M v[48:51], a[64:67], a[168:171], v[48:51]
 v_accvgpr_write_b32 a244, 0
M v[48:51], a[68:71], a[172:175], v[48:51]
 v_accvgpr_write_b32 a245, 0
M v[52:55], a[76:79], a[172:175], v[52:55]
 ds_read_b64_tr_b16 a[116:117], v3 offset:40960
 ds_read_b64_tr_b16 a[118:119], v3 offset:41984
M v[52:55], a[72:75], a[168:171], v[52:55]
 v_cndmask_b32 v19, 0, v19, vcc
M v[56:59], a[80:83], a[168:171], v[56:59]
 buffer_load_dwordx4 v9, s[16:19], s21 offen offset:1024  nt lds
M v[56:59], a[84:87], a[172:175], v[56:59]
 s_waitcnt lgkmcnt(6)
 v_cmp_eq_u32 vcc, 0, v16
M v[60:63], a[92:95], a[172:175], v[60:63]
 v_accvgpr_write_b32 a248, 0
M v[60:63], a[88:91], a[168:171], v[60:63]
 ds_read_b64_tr_b16 a[120:121], v4 offset:32768
 ds_read_b64_tr_b16 a[122:123], v4 offset:33792
M v[64:67], a[32:35], a[160:163], v[64:67]
 ds_read_b128 a[168:171], v5 offset:6144
 ds_read_b128 a[172:175], v6 offset:6144
M v[64:67], a[36:39], a[164:167], v[64:67]
 buffer_load_dwordx4 v10, s[16:19], s21 offen offset:2048  nt lds
M v[68:71], a[44:47], a[164:167], v[68:71]
 v_accvgpr_write_b32 a249, 0
M v[68:71], a[40:43], a[160:163], v[68:71]
 v_cndmask_b32 v17, 0, v19, vcc
M v[72:75], a[48:51], a[160:163], v[72:75]
 ds_read_b64_tr_b16 a[124:125], v4 offset:40960
 ds_read_b64_tr_b16 a[126:127], v4 offset:41984
M v[72:75], a[52:55], a[164:167], v[72:75]
 v_sub_u32 v18, v19, v17
M v[76:79], a[60:63], a[164:167], v[76:79]
 buffer_load_dwordx4 v11, s[16:19], s21 offen offset:3072  nt lds
M v[76:79], a[56:59], a[160:163], v[76:79]
 s_add_u32 s21, s21, 524160
 v_accvgpr_write_b32 a246, v17
M v[80:83], a[64:67], a[160:163], v[80:83]
 v_accvgpr_write_b32 a247, v18
M v[80:83], a[68:71], a[164:167], v[80:83]
M v[84:87], a[76:79], a[164:167], v[84:87]
M v[84:87], a[72:75], a[160:163], v[84:87]
M v[88:91], a[80:83], a[160:163], v[88:91]
M v[88:91], a[84:87], a[164:167], v[88:91]
 s_waitcnt lgkmcnt(2)
M v[92:95], a[92:95], a[164:167], v[92:95]
 s_waitcnt vmcnt(16) lgkmcnt(0)
M v[92:95], a[88:91], a[160:163], v[92:95]
 s_barrier
M v[96:99], a[32:35], a[168:171], v[96:99]
 ds_read_b128 a[160:163], v5 offset:16384
 ds_read_b128 a[164:167], v6 offset:16384
M v[96:99], a[36:39], a[172:175], v[96:99]
M v[100:103], a[44:47], a[172:175], v[100:103]
 s_add_u32 m0, s24, 0
 ds_read_b64_tr_b16 a[128:129], v1 offset:49152
 ds_read_b64_tr_b16 a[130:131], v1 offset:50176
M v[100:103], a[40:43], a[168:171], v[100:103]
 buffer_load_dwordx4 v12, s[48:51], s22 offen offset:0   lds
M v[104:107], a[48:51], a[168:171], v[104:107]
M v[104:107], a[52:55], a[172:175], v[104:107]
M v[108:111], a[60:63], a[172:175], v[108:111]
M v[108:111], a[56:59], a[168:171], v[108:111]
M v[112:115], a[64:67], a[168:171], v[112:115]
M v[112:115], a[68:71], a[172:175], v[112:115]
 ds_read_b64_tr_b16 a[132:133], v1 offset:57344
 ds_read_b64_tr_b16 a[134:135], v1 offset:58368
M v[116:119], a[76:79], a[172:175], v[116:119]
 buffer_load_dwordx4 v13, s[48:51], s22 offen offset:1024   lds
M v[116:119], a[72:75], a[168:171], v[116:119]
M v[120:123], a[80:83], a[168:171], v[120:123]
M v[120:123], a[84:87], a[172:175], v[120:123]
 s_waitcnt lgkmcnt(4)
M v[124:127], a[92:95], a[172:175], v[124:127]
M v[124:127], a[88:91], a[168:171], v[124:127]
M v[128:131], a[32:35], a[160:163], v[128:131]
 ds_read_b128 a[168:171], v5 offset:18432
 ds_read_b128 a[172:175], v6 offset:18432
M v[128:131], a[36:39], a[164:167], v[128:131]
 ds_read_b64_tr_b16 a[136:137], v2 offset:49152
 ds_read_b64_tr_b16 a[138:139], v2 offset:50176
M v[132:135], a[44:47], a[164:167], v[132:135]
 buffer_load_dwordx4 v14, s[48:51], s22 offen offset:2048   lds
M v[132:135], a[40:43], a[160:163], v[132:135]
M v[136:139], a[48:51], a[160:163], v[136:139]
M v[136:139], a[52:55], a[164:167], v[136:139]
M v[140:143], a[60:63], a[164:167], v[140:143]
M v[140:143], a[56:59], a[160:163], v[140:143]
 ds_read_b64_tr_b16 a[140:141], v2 offset:57344
 ds_read_b64_tr_b16 a[142:143], v2 offset:58368
M v[144:147], a[64:67], a[160:163], v[144:147]
 buffer_load_dwordx4 v15, s[48:51], s22 offen offset:3072   lds
M v[144:147], a[68:71], a[164:167], v[144:147]
 s_add_u32 s22, s22, 2097152
M v[148:151], a[76:79], a[164:167], v[148:151]
M v[148:151], a[72:75], a[160:163], v[148:151]
M v[152:155], a[80:83], a[160:163], v[152:155]
M v[152:155], a[84:87], a[164:167], v[152:155]
 s_waitcnt lgkmcnt(4)
M v[156:159], a[92:95], a[164:167], v[156:159]
 s_add_u32 m0, s23, 32768
 ds_read_b64_tr_b16 a[144:145], v3 offset:49152
 ds_read_b64_tr_b16 a[146:147], v3 offset:50176
M v[156:159], a[88:91], a[160:163], v[156:159]
 buffer_load_dwordx4 v8, s[16:19], s21 offen offset:0  nt lds
M v[160:163], a[32:35], a[168:171], v[160:163]
 ds_read_b128 a[160:163], v5 offset:20480
 ds_read_b128 a[164:167], v6 offset:20480
M v[160:163], a[36:39], a[172:175], v[160:163]
M v[164:167], a[44:47], a[172:175], v[164:167]
M v[164:167], a[40:43], a[168:171], v[164:167]
M v[168:171], a[48:51], a[168:171], v[168:171]
M v[168:171], a[52:55], a[172:175], v[168:171]
 ds_read_b64_tr_b16 a[148:149], v3 offset:57344
 ds_read_b64_tr_b16 a[150:151], v3 offset:58368
M v[172:175], a[60:63], a[172:175], v[172:175]
 buffer_load_dwordx4 v9, s[16:19], s21 offen offset:1024  nt lds
M v[172:175], a[56:59], a[168:171], v[172:175]
M v[176:179], a[64:67], a[168:171], v[176:179]
M v[176:179], a[68:71], a[172:175], v[176:179]
M v[180:183], a[76:79], a[172:175], v[180:183]
M v[180:183], a[72:75], a[168:171], v[180:183]
M v[184:187], a[80:83], a[168:171], v[184:187]
 ds_read_b64_tr_b16 a[152:153], v4 offset:49152
 ds_read_b64_tr_b16 a[154:155], v4 offset:50176
M v[184:187], a[84:87], a[172:175], v[184:187]
 s_waitcnt lgkmcnt(4)
M v[188:191], a[92:95], a[172:175], v[188:191]
 buffer_load_dwordx4 v10, s[16:19], s21 offen offset:2048  nt lds
M v[188:191], a[88:91], a[168:171], v[188:191]
M v[192:195], a[32:35], a[160:163], v[192:195]
 ds_read_b128 a[168:171], v5 offset:22528
 ds_read_b128 a[172:175], v6 offset:22528
M v[192:195], a[36:39], a[164:167], v[192:195]
M v[196:199], a[44:47], a[164:167], v[196:199]
M v[196:199], a[40:43], a[160:163], v[196:199]
 ds_read_b64_tr_b16 a[156:157], v4 offset:57344
 ds_read_b64_tr_b16 a[158:159], v4 offset:58368
M v[200:203], a[48:51], a[160:163], v[200:203]
 buffer_load_dwordx4 v11, s[16:19], s21 offen offset:3072  nt lds
M v[200:203], a[52:55], a[164:167], v[200:203]
 s_add_u32 s21, s21, 128
M v[204:207], a[60:63], a[164:167], v[204:207]
M v[204:207], a[56:59], a[160:163], v[204:207]
M v[208:211], a[64:67], a[160:163], v[208:211]
M v[208:211], a[68:71], a[164:167], v[208:211]
M v[212:215], a[76:79], a[164:167], v[212:215]
M v[212:215], a[72:75], a[160:163], v[212:215]
M v[216:219], a[80:83], a[160:163], v[216:219]
M v[216:219], a[84:87], a[164:167], v[216:219]
 s_waitcnt lgkmcnt(2)
M v[220:223], a[92:95], a[164:167], v[220:223]
 s_waitcnt vmcnt(16) lgkmcnt(0)
M v[220:223], a[88:91], a[160:163], v[220:223]
 s_barrier
M v[224:227], a[32:35], a[168:171], v[224:227]
 ds_read_b128 a[160:163], v5 offset:32768
 ds_read_b128 a[164:167], v6 offset:32768
M v[224:227], a[36:39], a[172:175], v[224:227]
M v[228:231], a[44:47], a[172:175], v[228:231]
M v[228:231], a[40:43], a[168:171], v[228:231]
M v[232:235], a[48:51], a[168:171], v[232:235]
M v[232:235], a[52:55], a[172:175], v[232:235]
M v[236:239], a[60:63], a[172:175], v[236:239]
M v[236:239], a[56:59], a[168:171], v[236:239]
M v[240:243], a[64:67], a[168:171], v[240:243]
M v[240:243], a[68:71], a[172:175], v[240:243]
M v[244:247], a[76:79], a[172:175], v[244:247]
M v[244:247], a[72:75], a[168:171], v[244:247]
M v[248:251], a[80:83], a[168:171], v[248:251]
M v[248:251], a[84:87], a[172:175], v[248:251]
 s_waitcnt lgkmcnt(0)
M v[252:255], a[92:95], a[172:175], v[252:255]
M v[252:255], a[88:91], a[168:171], v[252:255]
M a[0:3], a[96:99], a[160:163], a[0:3]
 ds_read_b128 a[168:171], v5 offset:34816
 ds_read_b128 a[172:175], v6 offset:34816
M a[0:3], a[100:103], a[164:167], a[0:3]
 ds_read_b64_tr_b16 a[32:33], v1 offset:0
 ds_read_b64_tr_b16 a[34:35], v1 offset:1024
M a[4:7], a[108:111], a[164:167], a[4:7]
 s_add_u32 m0, s24, 16384
M a[4:7], a[104:107], a[160:163], a[4:7]
 buffer_load_dwordx4 v12, s[48:51], s22 offen offset:0   lds
M a[8:11], a[112:115], a[160:163], a[8:11]
M a[8:11], a[116:119], a[164:167], a[8:11]
M a[12:15], a[124:127], a[164:167], a[12:15]
 ds_read_b64_tr_b16 a[36:37], v1 offset:8192
 ds_read_b64_tr_b16 a[38:39], v1 offset:9216
M a[12:15], a[120:123], a[160:163], a[12:15]
M a[16:19], a[128:131], a[160:163], a[16:19]
 buffer_load_dwordx4 v13, s[48:51], s22 offen offset:1024   lds
M a[16:19], a[132:135], a[164:167], a[16:19]
M a[20:23], a[140:143], a[164:167], a[20:23]
M a[20:23], a[136:139], a[160:163], a[20:23]
 ds_read_b64_tr_b16 a[40:41], v2 offset:0
 ds_read_b64_tr_b16 a[42:43], v2 offset:1024
M a[24:27], a[144:147], a[160:163], a[24:27]
M a[24:27], a[148:151], a[164:167], a[24:27]
 s_waitcnt lgkmcnt(6)
M a[28:31], a[156:159], a[164:167], a[28:31]
 buffer_load_dwordx4 v14, s[48:51], s22 offen offset:2048   lds
M a[28:31], a[152:155], a[160:163], a[28:31]
M v[32:35], a[96:99], a[168:171], v[32:35]
 ds_read_b128 a[160:163], v5 offset:36864
 ds_read_b128 a[164:167], v6 offset:36864
M v[32:35], a[100:103], a[172:175], v[32:35]
 ds_read_b64_tr_b16 a[44:45], v2 offset:8192
 ds_read_b64_tr_b16 a[46:47], v2 offset:9216
M v[36:39], a[108:111], a[172:175], v[36:39]
 buffer_load_dwordx4 v15, s[48:51], s22 offen offset:3072   lds
M v[36:39], a[104:107], a[168:171], v[36:39]
 s_sub_u32 s22, s22, 2097024
M v[40:43], a[112:115], a[168:171], v[40:43]
M v[40:43], a[116:119], a[172:175], v[40:43]
 ds_read_b64_tr_b16 a[48:49], v3 offset:0
 ds_read_b64_tr_b16 a[50:51], v3 offset:1024
M v[44:47], a[124:127], a[172:175], v[44:47]
 s_add_u32 m0, s23, 49152
M v[44:47], a[120:123], a[168:171], v[44:47]
 buffer_load_dwordx4 v8, s[16:19], s21 offen offset:0  nt lds
M v[48:51], a[128:131], a[168:171], v[48:51]
M v[48:51], a[132:135], a[172:175], v[48:51]
M v[52:55], a[140:143], a[172:175], v[52:55]
 ds_read_b64_tr_b16 a[52:53], v3 offset:8192
 ds_read_b64_tr_b16 a[54:55], v3 offset:9216
M v[52:55], a[136:139], a[168:171], v[52:55]
M v[56:59], a[144:147], a[168:171], v[56:59]
 buffer_load_dwordx4 v9, s[16:19], s21 offen offset:1024  nt lds
M v[56:59], a[148:151], a[172:175], v[56:59]
 s_waitcnt lgkmcnt(6)
M v[60:63], a[156:159], a[172:175], v[60:63]
M v[60:63], a[152:155], a[168:171], v[60:63]
 ds_read_b64_tr_b16 a[56:57], v4 offset:0
 ds_read_b64_tr_b16 a[58:59], v4 offset:1024
M v[64:67], a[96:99], a[160:163], v[64:67]
 ds_read_b128 a[168:171], v5 offset:38912
 ds_read_b128 a[172:175], v6 offset:38912
M v[64:67], a[100:103], a[164:167], v[64:67]
 buffer_load_dwordx4 v10, s[16:19], s21 offen offset:2048  nt lds
M v[68:71], a[108:111], a[164:167], v[68:71]
M v[68:71], a[104:107], a[160:163], v[68:71]
M v[72:75], a[112:115], a[160:163], v[72:75]
 ds_read_b64_tr_b16 a[60:61], v4 offset:8192
 ds_read_b64_tr_b16 a[62:63], v4 offset:9216
M v[72:75], a[116:119], a[164:167], v[72:75]
M v[76:79], a[124:127], a[164:167], v[76:79]
 buffer_load_dwordx4 v11, s[16:19], s21 offen offset:3072  nt lds
M v[76:79], a[120:123], a[160:163], v[76:79]
 s_add_u32 s21, s21, 524160
M v[80:83], a[128:131], a[160:163], v[80:83]
M v[80:83], a[132:135], a[164:167], v[80:83]
M v[84:87], a[140:143], a[164:167], v[84:87]
M v[84:87], a[136:139], a[160:163], v[84:87]
M v[88:91], a[144:147], a[160:163], v[88:91]
M v[88:91], a[148:151], a[164:167], v[88:91]
 s_waitcnt lgkmcnt(2)
M v[92:95], a[156:159], a[164:167], v[92:95]
 s_waitcnt vmcnt(16) lgkmcnt(0)
M v[92:95], a[152:155], a[160:163], v[92:95]
 s_barrier
M v[96:99], a[96:99], a[168:171], v[96:99]
 ds_read_b128 a[160:163], v5 offset:49152
 ds_read_b128 a[164:167], v6 offset:49152
M v[96:99], a[100:103], a[172:175], v[96:99]
M v[100:103], a[108:111], a[172:175], v[100:103]
 s_add_u32 m0, s24, 32768
 ds_read_b64_tr_b16 a[64:65], v1 offset:16384
 ds_read_b64_tr_b16 a[66:67], v1 offset:17408
M v[100:103], a[104:107], a[168:171], v[100:103]
 buffer_load_dwordx4 v12, s[48:51], s22 offen offset:0   lds
M v[104:107], a[112:115], a[168:171], v[104:107]
 v_min_u32 v16, 40, v0
 v_lshlrev_b32 v16, 2, v16
M v[104:107], a[116:119], a[172:175], v[104:107]
 buffer_load_dword v17, v16, s[12:15], 0 offen offset:64 sc1
M v[108:111], a[124:127], a[172:175], v[108:111]
M v[108:111], a[120:123], a[168:171], v[108:111]
M v[112:115], a[128:131], a[168:171], v[112:115]
M v[112:115], a[132:135], a[172:175], v[112:115]
 ds_read_b64_tr_b16 a[68:69], v1 offset:24576
 ds_read_b64_tr_b16 a[70:71], v1 offset:25600
M v[116:119], a[140:143], a[172:175], v[116:119]
 buffer_load_dwordx4 v13, s[48:51], s22 offen offset:1024   lds
M v[116:119], a[136:139], a[168:171], v[116:119]
M v[120:123], a[144:147], a[168:171], v[120:123]
M v[120:123], a[148:151], a[172:175], v[120:123]
 s_waitcnt lgkmcnt(4)
M v[124:127], a[156:159], a[172:175], v[124:127]
M v[124:127], a[152:155], a[168:171], v[124:127]
M v[128:131], a[96:99], a[160:163], v[128:131]
 ds_read_b128 a[168:171], v5 offset:51200
 ds_read_b128 a[172:175], v6 offset:51200
M v[128:131], a[100:103], a[164:167], v[128:131]
 ds_read_b64_tr_b16 a[72:73], v2 offset:16384
 ds_read_b64_tr_b16 a[74:75], v2 offset:17408
M v[132:135], a[108:111], a[164:167], v[132:135]
 buffer_load_dwordx4 v14, s[48:51], s22 offen offset:2048   lds
M v[132:135], a[104:107], a[160:163], v[132:135]
M v[136:139], a[112:115], a[160:163], v[136:139]
M v[136:139], a[116:119], a[164:167], v[136:139]
M v[140:143], a[124:127], a[164:167], v[140:143]
M v[140:143], a[120:123], a[160:163], v[140:143]
 ds_read_b64_tr_b16 a[76:77], v2 offset:24576
 ds_read_b64_tr_b16 a[78:79], v2 offset:25600
M v[144:147], a[128:131], a[160:163], v[144:147]
 buffer_load_dwordx4 v15, s[48:51], s22 offen offset:3072   lds
M v[144:147], a[132:135], a[164:167], v[144:147]
 s_add_u32 s22, s22, 2097152
M v[148:151], a[140:143], a[164:167], v[148:151]
M v[148:151], a[136:139], a[160:163], v[148:151]
M v[152:155], a[144:147], a[160:163], v[152:155]
M v[152:155], a[148:151], a[164:167], v[152:155]
 s_waitcnt lgkmcnt(4)
M v[156:159], a[156:159], a[164:167], v[156:159]
 s_add_u32 m0, s23, 0
 ds_read_b64_tr_b16 a[80:81], v3 offset:16384
 ds_read_b64_tr_b16 a[82:83], v3 offset:17408
M v[156:159], a[152:155], a[160:163], v[156:159]
 buffer_load_dwordx4 v8, s[16:19], s21 offen offset:0  nt lds
M v[160:163], a[96:99], a[168:171], v[160:163]
 ds_read_b128 a[160:163], v5 offset:53248
 ds_read_b128 a[164:167], v6 offset:53248
M v[160:163], a[100:103], a[172:175], v[160:163]
M v[164:167], a[108:111], a[172:175], v[164:167]
M v[164:167], a[104:107], a[168:171], v[164:167]
M v[168:171], a[112:115], a[168:171], v[168:171]
M v[168:171], a[116:119], a[172:175], v[168:171]
 ds_read_b64_tr_b16 a[84:85], v3 offset:24576
 ds_read_b64_tr_b16 a[86:87], v3 offset:25600
M v[172:175], a[124:127], a[172:175], v[172:175]
 buffer_load_dwordx4 v9, s[16:19], s21 offen offset:1024  nt lds
M v[172:175], a[120:123], a[168:171], v[172:175]
M v[176:179], a[128:131], a[168:171], v[176:179]
M v[176:179], a[132:135], a[172:175], v[176:179]
M v[180:183], a[140:143], a[172:175], v[180:183]
M v[180:183], a[136:139], a[168:171], v[180:183]
M v[184:187], a[144:147], a[168:171], v[184:187]
 ds_read_b64_tr_b16 a[88:89], v4 offset:16384
 ds_read_b64_tr_b16 a[90:91], v4 offset:17408
M v[184:187], a[148:151], a[172:175], v[184:187]
 s_waitcnt lgkmcnt(4)
M v[188:191], a[156:159], a[172:175], v[188:191]
 buffer_load_dwordx4 v10, s[16:19], s21 offen offset:2048  nt lds
M v[188:191], a[152:155], a[168:171], v[188:191]
M v[192:195], a[96:99], a[160:163], v[192:195]
 ds_read_b128 a[168:171], v5 offset:55296
 ds_read_b128 a[172:175], v6 offset:55296
M v[192:195], a[100:103], a[164:167], v[192:195]
M v[196:199], a[108:111], a[164:167], v[196:199]
M v[196:199], a[104:107], a[160:163], v[196:199]
 ds_read_b64_tr_b16 a[92:93], v4 offset:24576
 ds_read_b64_tr_b16 a[94:95], v4 offset:25600
M v[200:203], a[112:115], a[160:163], v[200:203]
 buffer_load_dwordx4 v11, s[16:19], s21 offen offset:3072  nt lds
M v[200:203], a[116:119], a[164:167], v[200:203]
 s_add_u32 s21, s21, 128
M v[204:207], a[124:127], a[164:167], v[204:207]
M v[204:207], a[120:123], a[160:163], v[204:207]
M v[208:211], a[128:131], a[160:163], v[208:211]
M v[208:211], a[132:135], a[164:167], v[208:211]
M v[212:215], a[140:143], a[164:167], v[212:215]
M v[212:215], a[136:139], a[160:163], v[212:215]
M v[216:219], a[144:147], a[160:163], v[216:219]
M v[216:219], a[148:151], a[164:167], v[216:219]
 s_waitcnt lgkmcnt(2)
M v[220:223], a[156:159], a[164:167], v[220:223]
 s_waitcnt vmcnt(17) lgkmcnt(0)
M v[220:223], a[152:155], a[160:163], v[220:223]
 s_barrier
M v[224:227], a[96:99], a[168:171], v[224:227]
 ds_read_b128 a[160:163], v5 offset:0
 ds_read_b128 a[164:167], v6 offset:0
M v[224:227], a[100:103], a[172:175], v[224:227]
M v[228:231], a[108:111], a[172:175], v[228:231]
M v[228:231], a[104:107], a[168:171], v[228:231]
M v[232:235], a[112:115], a[168:171], v[232:235]
M v[232:235], a[116:119], a[172:175], v[232:235]
M v[236:239], a[124:127], a[172:175], v[236:239]
M v[236:239], a[120:123], a[168:171], v[236:239]
M v[240:243], a[128:131], a[168:171], v[240:243]
M v[240:243], a[132:135], a[172:175], v[240:243]
M v[244:247], a[140:143], a[172:175], v[244:247]
M v[244:247], a[136:139], a[168:171], v[244:247]
M v[248:251], a[144:147], a[168:171], v[248:251]
M v[248:251], a[148:151], a[172:175], v[248:251]
 s_waitcnt lgkmcnt(0)
M v[252:255], a[156:159], a[172:175], v[252:255]
M v[252:255], a[152:155], a[168:171], v[252:255]
M a[0:3], a[32:35], a[160:163], a[0:3]
 ds_read_b128 a[168:171], v5 offset:2048
 ds_read_b128 a[172:175], v6 offset:2048
M a[0:3], a[36:39], a[164:167], a[0:3]
 ds_read_b64_tr_b16 a[96:97], v1 offset:32768
 ds_read_b64_tr_b16 a[98:99], v1 offset:33792
M a[4:7], a[44:47], a[164:167], a[4:7]
 s_add_u32 m0, s24, 49152
M a[4:7], a[40:43], a[160:163], a[4:7]
 buffer_load_dwordx4 v12, s[48:51], s22 offen offset:0   lds
M a[8:11], a[48:51], a[160:163], a[8:11]
M a[8:11], a[52:55], a[164:167], a[8:11]
M a[12:15], a[60:63], a[164:167], a[12:15]
 ds_read_b64_tr_b16 a[100:101], v1 offset:40960
 ds_read_b64_tr_b16 a[102:103], v1 offset:41984
M a[12:15], a[56:59], a[160:163], a[12:15]
M a[16:19], a[64:67], a[160:163], a[16:19]
 buffer_load_dwordx4 v13, s[48:51], s22 offen offset:1024   lds
M a[16:19], a[68:71], a[164:167], a[16:19]
M a[20:23], a[76:79], a[164:167], a[20:23]
M a[20:23], a[72:75], a[160:163], a[20:23]
 ds_read_b64_tr_b16 a[104:105], v2 offset:32768
 ds_read_b64_tr_b16 a[106:107], v2 offset:33792
M a[24:27], a[80:83], a[160:163], a[24:27]
M a[24:27], a[84:87], a[164:167], a[24:27]
 s_waitcnt lgkmcnt(6)
M a[28:31], a[92:95], a[164:167], a[28:31]
 buffer_load_dwordx4 v14, s[48:51], s22 offen offset:2048   lds
M a[28:31], a[88:91], a[160:163], a[28:31]
M v[32:35], a[32:35], a[168:171], v[32:35]
 ds_read_b128 a[160:163], v5 offset:4096
 ds_read_b128 a[164:167], v6 offset:4096
M v[32:35], a[36:39], a[172:175], v[32:35]
 ds_read_b64_tr_b16 a[108:109], v2 offset:40960
 ds_read_b64_tr_b16 a[110:111], v2 offset:41984
M v[36:39], a[44:47], a[172:175], v[36:39]
 buffer_load_dwordx4 v15, s[48:51], s22 offen offset:3072   lds
M v[36:39], a[40:43], a[168:171], v[36:39]
 s_sub_u32 s22, s22, 2097024
M v[40:43], a[48:51], a[168:171], v[40:43]
M v[40:43], a[52:55], a[172:175], v[40:43]
 ds_read_b64_tr_b16 a[112:113], v3 offset:32768
 ds_read_b64_tr_b16 a[114:115], v3 offset:33792
M v[44:47], a[60:63], a[172:175], v[44:47]
 s_add_u32 m0, s23, 16384
M v[44:47], a[56:59], a[168:171], v[44:47]
 buffer_load_dwordx4 v8, s[16:19], s21 offen offset:0  nt lds
M v[48:51], a[64:67], a[168:171], v[48:51]
M v[48:51], a[68:71], a[172:175], v[48:51]
M v[52:55], a[76:79], a[172:175], v[52:55]
 ds_read_b64_tr_b16 a[116:117], v3 offset:40960
 ds_read_b64_tr_b16 a[118:119], v3 offset:41984
M v[52:55], a[72:75], a[168:171], v[52:55]
M v[56:59], a[80:83], a[168:171], v[56:59]
 buffer_load_dwordx4 v9, s[16:19], s21 offen offset:1024  nt lds
M v[56:59], a[84:87], a[172:175], v[56:59]
 s_waitcnt lgkmcnt(6)
M v[60:63], a[92:95], a[172:175], v[60:63]
M v[60:63], a[88:91], a[168:171], v[60:63]
 ds_read_b64_tr_b16 a[120:121], v4 offset:32768
 ds_read_b64_tr_b16 a[122:123], v4 offset:33792
M v[64:67], a[32:35], a[160:163], v[64:67]
 ds_read_b128 a[168:171], v5 offset:6144
 ds_read_b128 a[172:175], v6 offset:6144
M v[64:67], a[36:39], a[164:167], v[64:67]
 buffer_load_dwordx4 v10, s[16:19], s21 offen offset:2048  nt lds
M v[68:71], a[44:47], a[164:167], v[68:71]
M v[68:71], a[40:43], a[160:163], v[68:71]
M v[72:75], a[48:51], a[160:163], v[72:75]
 ds_read_b64_tr_b16 a[124:125], v4 offset:40960
 ds_read_b64_tr_b16 a[126:127], v4 offset:41984
M v[72:75], a[52:55], a[164:167], v[72:75]
M v[76:79], a[60:63], a[164:167], v[76:79]
 buffer_load_dwordx4 v11, s[16:19], s21 offen offset:3072  nt lds
M v[76:79], a[56:59], a[160:163], v[76:79]
 s_add_u32 s21, s21, 524160
M v[80:83], a[64:67], a[160:163], v[80:83]
M v[80:83], a[68:71], a[164:167], v[80:83]
M v[84:87], a[76:79], a[164:167], v[84:87]
M v[84:87], a[72:75], a[160:163], v[84:87]
M v[88:91], a[80:83], a[160:163], v[88:91]
M v[88:91], a[84:87], a[164:167], v[88:91]
 s_waitcnt lgkmcnt(2)
M v[92:95], a[92:95], a[164:167], v[92:95]
 s_waitcnt vmcnt(17) lgkmcnt(0)
M v[92:95], a[88:91], a[160:163], v[92:95]
 s_barrier
M v[96:99], a[32:35], a[168:171], v[96:99]
 ds_read_b128 a[160:163], v5 offset:16384
 ds_read_b128 a[164:167], v6 offset:16384
M v[96:99], a[36:39], a[172:175], v[96:99]
M v[100:103], a[44:47], a[172:175], v[100:103]
 s_add_u32 m0, s24, 0
 ds_read_b64_tr_b16 a[128:129], v1 offset:49152
 ds_read_b64_tr_b16 a[130:131], v1 offset:50176
M v[100:103], a[40:43], a[168:171], v[100:103]
 buffer_load_dwordx4 v12, s[48:51], s22 offen offset:0   lds
M v[104:107], a[48:51], a[168:171], v[104:107]
M v[104:107], a[52:55], a[172:175], v[104:107]
M v[108:111], a[60:63], a[172:175], v[108:111]
M v[108:111], a[56:59], a[168:171], v[108:111]
M v[112:115], a[64:67], a[168:171], v[112:115]
M v[112:115], a[68:71], a[172:175], v[112:115]
 ds_read_b64_tr_b16 a[132:133], v1 offset:57344
 ds_read_b64_tr_b16 a[134:135], v1 offset:58368
M v[116:119], a[76:79], a[172:175], v[116:119]
 buffer_load_dwordx4 v13, s[48:51], s22 offen offset:1024   lds
M v[116:119], a[72:75], a[168:171], v[116:119]
M v[120:123], a[80:83], a[168:171], v[120:123]
M v[120:123], a[84:87], a[172:175], v[120:123]
 s_waitcnt lgkmcnt(4)
M v[124:127], a[92:95], a[172:175], v[124:127]
M v[124:127], a[88:91], a[168:171], v[124:127]
M v[128:131], a[32:35], a[160:163], v[128:131]
 ds_read_b128 a[168:171], v5 offset:18432
 ds_read_b128 a[172:175], v6 offset:18432
M v[128:131], a[36:39], a[164:167], v[128:131]
 ds_read_b64_tr_b16 a[136:137], v2 offset:49152
 ds_read_b64_tr_b16 a[138:139], v2 offset:50176
M v[132:135], a[44:47], a[164:167], v[132:135]
 buffer_load_dwordx4 v14, s[48:51], s22 offen offset:2048   lds
M v[132:135], a[40:43], a[160:163], v[132:135]
M v[136:139], a[48:51], a[160:163], v[136:139]
M v[136:139], a[52:55], a[164:167], v[136:139]
M v[140:143], a[60:63], a[164:167], v[140:143]
M v[140:143], a[56:59], a[160:163], v[140:143]
 ds_read_b64_tr_b16 a[140:141], v2 offset:57344
 ds_read_b64_tr_b16 a[142:143], v2 offset:58368
M v[144:147], a[64:67], a[160:163], v[144:147]
 buffer_load_dwordx4 v15, s[48:51], s22 offen offset:3072   lds
M v[144:147], a[68:71], a[164:167], v[144:147]
 s_add_u32 s22, s22, 2097152
M v[148:151], a[76:79], a[164:167], v[148:151]
M v[148:151], a[72:75], a[160:163], v[148:151]
M v[152:155], a[80:83], a[160:163], v[152:155]
M v[152:155], a[84:87], a[164:167], v[152:155]
 s_waitcnt lgkmcnt(4)
M v[156:159], a[92:95], a[164:167], v[156:159]
 s_add_u32 m0, s23, 32768
 ds_read_b64_tr_b16 a[144:145], v3 offset:49152
 ds_read_b64_tr_b16 a[146:147], v3 offset:50176
M v[156:159], a[88:91], a[160:163], v[156:159]
 buffer_load_dwordx4 v8, s[16:19], s21 offen offset:0  nt lds
M v[160:163], a[32:35], a[168:171], v[160:163]
 ds_read_b128 a[160:163], v5 offset:20480
 ds_read_b128 a[164:167], v6 offset:20480
M v[160:163], a[36:39], a[172:175], v[160:163]
M v[164:167], a[44:47], a[172:175], v[164:167]
M v[164:167], a[40:43], a[168:171], v[164:167]
M v[168:171], a[48:51], a[168:171], v[168:171]
M v[168:171], a[52:55], a[172:175], v[168:171]
 ds_read_b64_tr_b16 a[148:149], v3 offset:57344
 ds_read_b64_tr_b16 a[150:151], v3 offset:58368
M v[172:175], a[60:63], a[172:175], v[172:175]
 buffer_load_dwordx4 v9, s[16:19], s21 offen offset:1024  nt lds
M v[172:175], a[56:59], a[168:171], v[172:175]
M v[176:179], a[64:67], a[168:171], v[176:179]
M v[176:179], a[68:71], a[172:175], v[176:179]
M v[180:183], a[76:79], a[172:175], v[180:183]
M v[180:183], a[72:75], a[168:171], v[180:183]
M v[184:187], a[80:83], a[168:171], v[184:187]
 ds_read_b64_tr_b16 a[152:153], v4 offset:49152
 ds_read_b64_tr_b16 a[154:155], v4 offset:50176
M v[184:187], a[84:87], a[172:175], v[184:187]
 s_waitcnt lgkmcnt(4)
M v[188:191], a[92:95], a[172:175], v[188:191]
 buffer_load_dwordx4 v10, s[16:19], s21 offen offset:2048  nt lds
M v[188:191], a[88:91], a[168:171], v[188:191]
M v[192:195], a[32:35], a[160:163], v[192:195]
 ds_read_b128 a[168:171], v5 offset:22528
 ds_read_b128 a[172:175], v6 offset:22528
M v[192:195], a[36:39], a[164:167], v[192:195]
M v[196:199], a[44:47], a[164:167], v[196:199]
M v[196:199], a[40:43], a[160:163], v[196:199]
 ds_read_b64_tr_b16 a[156:157], v4 offset:57344
 ds_read_b64_tr_b16 a[158:159], v4 offset:58368
M v[200:203], a[48:51], a[160:163], v[200:203]
 buffer_load_dwordx4 v11, s[16:19], s21 offen offset:3072  nt lds
M v[200:203], a[52:55], a[164:167], v[200:203]
 s_add_u32 s21, s21, 128
M v[204:207], a[60:63], a[164:167], v[204:207]
M v[204:207], a[56:59], a[160:163], v[204:207]
M v[208:211], a[64:67], a[160:163], v[208:211]
M v[208:211], a[68:71], a[164:167], v[208:211]
M v[212:215], a[76:79], a[164:167], v[212:215]
M v[212:215], a[72:75], a[160:163], v[212:215]
M v[216:219], a[80:83], a[160:163], v[216:219]
M v[216:219], a[84:87], a[164:167], v[216:219]
 s_waitcnt lgkmcnt(2)
M v[220:223], a[92:95], a[164:167], v[220:223]
 s_waitcnt vmcnt(16) lgkmcnt(0)
M v[220:223], a[88:91], a[160:163], v[220:223]
 s_barrier
M v[224:227], a[32:35], a[168:171], v[224:227]
 ds_read_b128 a[160:163], v5 offset:32768
 ds_read_b128 a[164:167], v6 offset:32768
M v[224:227], a[36:39], a[172:175], v[224:227]
 v_cmp_ne_u32 vcc, 1, v17
M v[228:231], a[44:47], a[172:175], v[228:231]
 s_nop 0
M v[228:231], a[40:43], a[168:171], v[228:231]
 s_cbranch_vccnz L_zs1
L_zr1:
M v[232:235], a[48:51], a[168:171], v[232:235]
 buffer_load_dword a240, v24, s[32:35], 0 offen offset:1024
M v[232:235], a[52:55], a[172:175], v[232:235]
M v[236:239], a[60:63], a[172:175], v[236:239]
M v[236:239], a[56:59], a[168:171], v[236:239]
M v[240:243], a[64:67], a[168:171], v[240:243]
M v[240:243], a[68:71], a[172:175], v[240:243]
M v[244:247], a[76:79], a[172:175], v[244:247]
M v[244:247], a[72:75], a[168:171], v[244:247]
M v[248:251], a[80:83], a[168:171], v[248:251]
M v[248:251], a[84:87], a[172:175], v[248:251]
 s_waitcnt lgkmcnt(0)
M v[252:255], a[92:95], a[172:175], v[252:255]
M v[252:255], a[88:91], a[168:171], v[252:255]
M a[0:3], a[96:99], a[160:163], a[0:3]
 ds_read_b128 a[168:171], v5 offset:34816
 ds_read_b128 a[172:175], v6 offset:34816
M a[0:3], a[100:103], a[164:167], a[0:3]
 ds_read_b64_tr_b16 a[32:33], v1 offset:0
 ds_read_b64_tr_b16 a[34:35], v1 offset:1024
M a[4:7], a[108:111], a[164:167], a[4:7]
 s_add_u32 m0, s24, 16384
M a[4:7], a[104:107], a[160:163], a[4:7]
 buffer_load_dwordx4 v12, s[48:51], s22 offen offset:0   lds
M a[8:11], a[112:115], a[160:163], a[8:11]
M a[8:11], a[116:119], a[164:167], a[8:11]
M a[12:15], a[124:127], a[164:167], a[12:15]
 ds_read_b64_tr_b16 a[36:37], v1 offset:8192
 ds_read_b64_tr_b16 a[38:39], v1 offset:9216
M a[12:15], a[120:123], a[160:163], a[12:15]
M a[16:19], a[128:131], a[160:163], a[16:19]
 buffer_load_dwordx4 v13, s[48:51], s22 offen offset:1024   lds
M a[16:19], a[132:135], a[164:167], a[16:19]
M a[20:23], a[140:143], a[164:167], a[20:23]
M a[20:23], a[136:139], a[160:163], a[20:23]
 ds_read_b64_tr_b16 a[40:41], v2 offset:0
 ds_read_b64_tr_b16 a[42:43], v2 offset:1024
M a[24:27], a[144:147], a[160:163], a[24:27]
M a[24:27], a[148:151], a[164:167], a[24:27]
 s_waitcnt lgkmcnt(6)
M a[28:31], a[156:159], a[164:167], a[28:31]
 buffer_load_dwordx4 v14, s[48:51], s22 offen offset:2048   lds
M a[28:31], a[152:155], a[160:163], a[28:31]
M v[32:35], a[96:99], a[168:171], v[32:35]
 ds_read_b128 a[160:163], v5 offset:36864
 ds_read_b128 a[164:167], v6 offset:36864
M v[32:35], a[100:103], a[172:175], v[32:35]
 ds_read_b64_tr_b16 a[44:45], v2 offset:8192
 ds_read_b64_tr_b16 a[46:47], v2 offset:9216
M v[36:39], a[108:111], a[172:175], v[36:39]
 buffer_load_dwordx4 v15, s[48:51], s22 offen offset:3072   lds
M v[36:39], a[104:107], a[168:171], v[36:39]
 s_sub_u32 s22, s22, 2097024
M v[40:43], a[112:115], a[168:171], v[40:43]
M v[40:43], a[116:119], a[172:175], v[40:43]
 ds_read_b64_tr_b16 a[48:49], v3 offset:0
 ds_read_b64_tr_b16 a[50:51], v3 offset:1024
M v[44:47], a[124:127], a[172:175], v[44:47]
 s_add_u32 m0, s23, 49152
M v[44:47], a[120:123], a[168:171], v[44:47]
 buffer_load_dwordx4 v8, s[16:19], s21 offen offset:0  nt lds
M v[48:51], a[128:131], a[168:171], v[48:51]
M v[48:51], a[132:135], a[172:175], v[48:51]
M v[52:55], a[140:143], a[172:175], v[52:55]
 ds_read_b64_tr_b16 a[52:53], v3 offset:8192
 ds_read_b64_tr_b16 a[54:55], v3 offset:9216
M v[52:55], a[136:139], a[168:171], v[52:55]
M v[56:59], a[144:147], a[168:171], v[56:59]
 buffer_load_dwordx4 v9, s[16:19], s21 offen offset:1024  nt lds
M v[56:59], a[148:151], a[172:175], v[56:59]
 s_waitcnt lgkmcnt(6)
M v[60:63], a[156:159], a[172:175], v[60:63]
M v[60:63], a[152:155], a[168:171], v[60:63]
 ds_read_b64_tr_b16 a[56:57], v4 offset:0
 ds_read_b64_tr_b16 a[58:59], v4 offset:1024
M v[64:67], a[96:99], a[160:163], v[64:67]
 ds_read_b128 a[168:171], v5 offset:38912
 ds_read_b128 a[172:175], v6 offset:38912
M v[64:67], a[100:103], a[164:167], v[64:67]
 buffer_load_dwordx4 v10, s[16:19], s21 offen offset:2048  nt lds
M v[68:71], a[108:111], a[164:167], v[68:71]
M v[68:71], a[104:107], a[160:163], v[68:71]
M v[72:75], a[112:115], a[160:163], v[72:75]
 ds_read_b64_tr_b16 a[60:61], v4 offset:8192
 ds_read_b64_tr_b16 a[62:63], v4 offset:9216
M v[72:75], a[116:119], a[164:167], v[72:75]
M v[76:79], a[124:127], a[164:167], v[76:79]
 buffer_load_dwordx4 v11, s[16:19], s21 offen offset:3072  nt lds
M v[76:79], a[120:123], a[160:163], v[76:79]
 s_add_u32 s21, s21, 524160
M v[80:83], a[128:131], a[160:163], v[80:83]
M v[80:83], a[132:135], a[164:167], v[80:83]
M v[84:87], a[140:143], a[164:167], v[84:87]
M v[84:87], a[136:139], a[160:163], v[84:87]
 s_and_b32 s64, s42, 7
M v[88:91], a[144:147], a[160:163], v[88:91]
 s_lshl_b32 s72, s41, 3
 s_add_u32 s64, s64, s72
 s_lshl_b32 s64, s64, 2
M v[88:91], a[148:151], a[164:167], v[88:91]
 s_waitcnt lgkmcnt(2)
 s_add_u32 s64, s64, s20
 s_mul_i32 s67, s64, 7168
M v[92:95], a[156:159], a[164:167], v[92:95]
 s_waitcnt vmcnt(17) lgkmcnt(0)
 s_mul_i32 s86, s20, 7168
 s_add_u32 s86, s86, 131072
M v[92:95], a[152:155], a[160:163], v[92:95]
 s_barrier
M v[96:99], a[96:99], a[168:171], v[96:99]
 ds_read_b128 a[160:163], v5 offset:49152
 ds_read_b128 a[164:167], v6 offset:49152
M v[96:99], a[100:103], a[172:175], v[96:99]
M v[100:103], a[108:111], a[172:175], v[100:103]
 s_add_u32 m0, s24, 32768
 ds_read_b64_tr_b16 a[64:65], v1 offset:16384
 ds_read_b64_tr_b16 a[66:67], v1 offset:17408
M v[100:103], a[104:107], a[168:171], v[100:103]
 buffer_load_dwordx4 v12, s[48:51], s22 offen offset:0   lds
M v[104:107], a[112:115], a[168:171], v[104:107]
M v[104:107], a[116:119], a[172:175], v[104:107]
M v[108:111], a[124:127], a[172:175], v[108:111]
M v[108:111], a[120:123], a[168:171], v[108:111]
 buffer_load_dwordx4 v13, s[48:51], s22 offen offset:1024   lds
M v[112:115], a[128:131], a[168:171], v[112:115]
M v[112:115], a[132:135], a[172:175], v[112:115]
 ds_read_b64_tr_b16 a[68:69], v1 offset:24576
 ds_read_b64_tr_b16 a[70:71], v1 offset:25600
M v[116:119], a[140:143], a[172:175], v[116:119]
M v[116:119], a[136:139], a[168:171], v[116:119]
M v[120:123], a[144:147], a[168:171], v[120:123]
 buffer_load_dwordx4 v14, s[48:51], s22 offen offset:2048   lds
M v[120:123], a[148:151], a[172:175], v[120:123]
 s_waitcnt lgkmcnt(4)
M v[124:127], a[156:159], a[172:175], v[124:127]
M v[124:127], a[152:155], a[168:171], v[124:127]
M v[128:131], a[96:99], a[160:163], v[128:131]
 ds_read_b128 a[168:171], v5 offset:51200
 ds_read_b128 a[172:175], v6 offset:51200
M v[128:131], a[100:103], a[164:167], v[128:131]
 ds_read_b64_tr_b16 a[72:73], v2 offset:16384
 ds_read_b64_tr_b16 a[74:75], v2 offset:17408
M v[132:135], a[108:111], a[164:167], v[132:135]
 buffer_load_dwordx4 v15, s[48:51], s22 offen offset:3072   lds
M v[132:135], a[104:107], a[160:163], v[132:135]
 s_add_u32 s22, s22, 2097152
M v[136:139], a[112:115], a[160:163], v[136:139]
M v[136:139], a[116:119], a[164:167], v[136:139]
 s_add_u32 m0, s23, 0
M v[140:143], a[124:127], a[164:167], v[140:143]
 buffer_load_dwordx4 v8, s[16:19], s21 offen offset:0  nt lds
M v[140:143], a[120:123], a[160:163], v[140:143]
 ds_read_b64_tr_b16 a[76:77], v2 offset:24576
 ds_read_b64_tr_b16 a[78:79], v2 offset:25600
M v[144:147], a[128:131], a[160:163], v[144:147]
M v[144:147], a[132:135], a[164:167], v[144:147]
M v[148:151], a[140:143], a[164:167], v[148:151]
 buffer_load_dwordx4 v9, s[16:19], s21 offen offset:1024  nt lds
M v[148:151], a[136:139], a[160:163], v[148:151]
M v[152:155], a[144:147], a[160:163], v[152:155]
M v[152:155], a[148:151], a[164:167], v[152:155]
 s_waitcnt lgkmcnt(4)
M v[156:159], a[156:159], a[164:167], v[156:159]
 ds_read_b64_tr_b16 a[80:81], v3 offset:16384
 ds_read_b64_tr_b16 a[82:83], v3 offset:17408
M v[156:159], a[152:155], a[160:163], v[156:159]
 buffer_load_dwordx4 v10, s[16:19], s21 offen offset:2048  nt lds
M v[160:163], a[96:99], a[168:171], v[160:163]
 ds_read_b128 a[160:163], v5 offset:53248
 ds_read_b128 a[164:167], v6 offset:53248
M v[160:163], a[100:103], a[172:175], v[160:163]
M v[164:167], a[108:111], a[172:175], v[164:167]
M v[164:167], a[104:107], a[168:171], v[164:167]
M v[168:171], a[112:115], a[168:171], v[168:171]
 buffer_load_dwordx4 v11, s[16:19], s21 offen offset:3072  nt lds
M v[168:171], a[116:119], a[172:175], v[168:171]
 s_add_u32 s21, s21, 128
 ds_read_b64_tr_b16 a[84:85], v3 offset:24576
 ds_read_b64_tr_b16 a[86:87], v3 offset:25600
M v[172:175], a[124:127], a[172:175], v[172:175]
M v[172:175], a[120:123], a[168:171], v[172:175]
M v[176:179], a[128:131], a[168:171], v[176:179]
 s_add_u32 m0, s86, 0
M v[176:179], a[132:135], a[172:175], v[176:179]
 buffer_load_dwordx4 v7, s[60:63], s67 offen offset:0 nt lds
M v[180:183], a[140:143], a[172:175], v[180:183]
M v[180:183], a[136:139], a[168:171], v[180:183]
M v[184:187], a[144:147], a[168:171], v[184:187]
 ds_read_b64_tr_b16 a[88:89], v4 offset:16384
 ds_read_b64_tr_b16 a[90:91], v4 offset:17408
M v[184:187], a[148:151], a[172:175], v[184:187]
 s_waitcnt lgkmcnt(4)
M v[188:191], a[156:159], a[172:175], v[188:191]
 buffer_load_dwordx4 v7, s[60:63], s67 offen offset:1024 nt lds
M v[188:191], a[152:155], a[168:171], v[188:191]
M v[192:195], a[96:99], a[160:163], v[192:195]
 ds_read_b128 a[168:171], v5 offset:55296
 ds_read_b128 a[172:175], v6 offset:55296
M v[192:195], a[100:103], a[164:167], v[192:195]
M v[196:199], a[108:111], a[164:167], v[196:199]
 buffer_load_dwordx4 v7, s[60:63], s67 offen offset:2048 nt lds
M v[196:199], a[104:107], a[160:163], v[196:199]
 ds_read_b64_tr_b16 a[92:93], v4 offset:24576
 ds_read_b64_tr_b16 a[94:95], v4 offset:25600
M v[200:203], a[112:115], a[160:163], v[200:203]
M v[200:203], a[116:119], a[164:167], v[200:203]
M v[204:207], a[124:127], a[164:167], v[204:207]
M v[204:207], a[120:123], a[160:163], v[204:207]
 buffer_load_dwordx4 v7, s[60:63], s67 offen offset:3072 nt lds
M v[208:211], a[128:131], a[160:163], v[208:211]
 s_add_u32 s67, s67, 4096
M v[208:211], a[132:135], a[164:167], v[208:211]
M v[212:215], a[140:143], a[164:167], v[212:215]
M v[212:215], a[136:139], a[160:163], v[212:215]
M v[216:219], a[144:147], a[160:163], v[216:219]
M v[216:219], a[148:151], a[164:167], v[216:219]
 s_waitcnt lgkmcnt(2)
M v[220:223], a[156:159], a[164:167], v[220:223]
 s_waitcnt vmcnt(21) lgkmcnt(0)
M v[220:223], a[152:155], a[160:163], v[220:223]
 s_barrier
M v[224:227], a[96:99], a[168:171], v[224:227]
 ds_read_b128 a[160:163], v5 offset:0
 ds_read_b128 a[164:167], v6 offset:0
M v[224:227], a[100:103], a[172:175], v[224:227]
M v[228:231], a[108:111], a[172:175], v[228:231]
M v[228:231], a[104:107], a[168:171], v[228:231]
M v[232:235], a[112:115], a[168:171], v[232:235]
M v[232:235], a[116:119], a[172:175], v[232:235]
M v[236:239], a[124:127], a[172:175], v[236:239]
M v[236:239], a[120:123], a[168:171], v[236:239]
M v[240:243], a[128:131], a[168:171], v[240:243]
M v[240:243], a[132:135], a[172:175], v[240:243]
M v[244:247], a[140:143], a[172:175], v[244:247]
M v[244:247], a[136:139], a[168:171], v[244:247]
M v[248:251], a[144:147], a[168:171], v[248:251]
M v[248:251], a[148:151], a[172:175], v[248:251]
 s_waitcnt lgkmcnt(0)
M v[252:255], a[156:159], a[172:175], v[252:255]
M v[252:255], a[152:155], a[168:171], v[252:255]
M a[0:3], a[32:35], a[160:163], a[0:3]
 ds_read_b128 a[168:171], v5 offset:2048
 ds_read_b128 a[172:175], v6 offset:2048
M a[0:3], a[36:39], a[164:167], a[0:3]
 ds_read_b64_tr_b16 a[96:97], v1 offset:32768
 ds_read_b64_tr_b16 a[98:99], v1 offset:33792
M a[4:7], a[44:47], a[164:167], a[4:7]
 s_add_u32 m0, s24, 49152
M a[4:7], a[40:43], a[160:163], a[4:7]
 buffer_load_dwordx4 v12, s[48:51], s22 offen offset:0   lds
M a[8:11], a[48:51], a[160:163], a[8:11]
M a[8:11], a[52:55], a[164:167], a[8:11]
M a[12:15], a[60:63], a[164:167], a[12:15]
 ds_read_b64_tr_b16 a[100:101], v1 offset:40960
 ds_read_b64_tr_b16 a[102:103], v1 offset:41984
M a[12:15], a[56:59], a[160:163], a[12:15]
M a[16:19], a[64:67], a[160:163], a[16:19]
 buffer_load_dwordx4 v13, s[48:51], s22 offen offset:1024   lds
M a[16:19], a[68:71], a[164:167], a[16:19]
M a[20:23], a[76:79], a[164:167], a[20:23]
M a[20:23], a[72:75], a[160:163], a[20:23]
 ds_read_b64_tr_b16 a[104:105], v2 offset:32768
 ds_read_b64_tr_b16 a[106:107], v2 offset:33792
M a[24:27], a[80:83], a[160:163], a[24:27]
M a[24:27], a[84:87], a[164:167], a[24:27]
 s_waitcnt lgkmcnt(6)
M a[28:31], a[92:95], a[164:167], a[28:31]
 buffer_load_dwordx4 v14, s[48:51], s22 offen offset:2048   lds
M a[28:31], a[88:91], a[160:163], a[28:31]
M v[32:35], a[32:35], a[168:171], v[32:35]
 ds_read_b128 a[160:163], v5 offset:4096
 ds_read_b128 a[164:167], v6 offset:4096
M v[32:35], a[36:39], a[172:175], v[32:35]
 ds_read_b64_tr_b16 a[108:109], v2 offset:40960
 ds_read_b64_tr_b16 a[110:111], v2 offset:41984
M v[36:39], a[44:47], a[172:175], v[36:39]
 buffer_load_dwordx4 v15, s[48:51], s22 offen offset:3072   lds
M v[36:39], a[40:43], a[168:171], v[36:39]
 s_sub_u32 s22, s22, 2097024
M v[40:43], a[48:51], a[168:171], v[40:43]
M v[40:43], a[52:55], a[172:175], v[40:43]
 ds_read_b64_tr_b16 a[112:113], v3 offset:32768
 ds_read_b64_tr_b16 a[114:115], v3 offset:33792
M v[44:47], a[60:63], a[172:175], v[44:47]
 s_add_u32 m0, s23, 16384
M v[44:47], a[56:59], a[168:171], v[44:47]
 buffer_load_dwordx4 v8, s[16:19], s21 offen offset:0  nt lds
M v[48:51], a[64:67], a[168:171], v[48:51]
M v[48:51], a[68:71], a[172:175], v[48:51]
M v[52:55], a[76:79], a[172:175], v[52:55]
 ds_read_b64_tr_b16 a[116:117], v3 offset:40960
 ds_read_b64_tr_b16 a[118:119], v3 offset:41984
M v[52:55], a[72:75], a[168:171], v[52:55]
M v[56:59], a[80:83], a[168:171], v[56:59]
 buffer_load_dwordx4 v9, s[16:19], s21 offen offset:1024  nt lds
M v[56:59], a[84:87], a[172:175], v[56:59]
 s_waitcnt lgkmcnt(6)
M v[60:63], a[92:95], a[172:175], v[60:63]
M v[60:63], a[88:91], a[168:171], v[60:63]
 ds_read_b64_tr_b16 a[120:121], v4 offset:32768
 ds_read_b64_tr_b16 a[122:123], v4 offset:33792
M v[64:67], a[32:35], a[160:163], v[64:67]
 ds_read_b128 a[168:171], v5 offset:6144
 ds_read_b128 a[172:175], v6 offset:6144
M v[64:67], a[36:39], a[164:167], v[64:67]
 buffer_load_dwordx4 v10, s[16:19], s21 offen offset:2048  nt lds
M v[68:71], a[44:47], a[164:167], v[68:71]
M v[68:71], a[40:43], a[160:163], v[68:71]
M v[72:75], a[48:51], a[160:163], v[72:75]
 ds_read_b64_tr_b16 a[124:125], v4 offset:40960
 ds_read_b64_tr_b16 a[126:127], v4 offset:41984
M v[72:75], a[52:55], a[164:167], v[72:75]
M v[76:79], a[60:63], a[164:167], v[76:79]
 buffer_load_dwordx4 v11, s[16:19], s21 offen offset:3072  nt lds
M v[76:79], a[56:59], a[160:163], v[76:79]
 s_add_u32 s21, s21, 524160
M v[80:83], a[64:67], a[160:163], v[80:83]
M v[80:83], a[68:71], a[164:167], v[80:83]
M v[84:87], a[76:79], a[164:167], v[84:87]
M v[84:87], a[72:75], a[160:163], v[84:87]
M v[88:91], a[80:83], a[160:163], v[88:91]
M v[88:91], a[84:87], a[164:167], v[88:91]
 s_waitcnt lgkmcnt(2)
M v[92:95], a[92:95], a[164:167], v[92:95]
 s_waitcnt vmcnt(20) lgkmcnt(0)
M v[92:95], a[88:91], a[160:163], v[92:95]
 s_barrier
M v[96:99], a[32:35], a[168:171], v[96:99]
 ds_read_b128 a[160:163], v5 offset:16384
 ds_read_b128 a[164:167], v6 offset:16384
M v[96:99], a[36:39], a[172:175], v[96:99]
M v[100:103], a[44:47], a[172:175], v[100:103]
 s_add_u32 m0, s24, 0
 ds_read_b64_tr_b16 a[128:129], v1 offset:49152
 ds_read_b64_tr_b16 a[130:131], v1 offset:50176
M v[100:103], a[40:43], a[168:171], v[100:103]
 buffer_load_dwordx4 v12, s[48:51], s22 offen offset:0   lds
M v[104:107], a[48:51], a[168:171], v[104:107]
M v[104:107], a[52:55], a[172:175], v[104:107]
M v[108:111], a[60:63], a[172:175], v[108:111]
M v[108:111], a[56:59], a[168:171], v[108:111]
M v[112:115], a[64:67], a[168:171], v[112:115]
 buffer_load_dwordx4 v13, s[48:51], s22 offen offset:1024   lds
M v[112:115], a[68:71], a[172:175], v[112:115]
 ds_read_b64_tr_b16 a[132:133], v1 offset:57344
 ds_read_b64_tr_b16 a[134:135], v1 offset:58368
M v[116:119], a[76:79], a[172:175], v[116:119]
M v[116:119], a[72:75], a[168:171], v[116:119]
M v[120:123], a[80:83], a[168:171], v[120:123]
M v[120:123], a[84:87], a[172:175], v[120:123]
 s_waitcnt lgkmcnt(4)
M v[124:127], a[92:95], a[172:175], v[124:127]
 buffer_load_dwordx4 v14, s[48:51], s22 offen offset:2048   lds
M v[124:127], a[88:91], a[168:171], v[124:127]
M v[128:131], a[32:35], a[160:163], v[128:131]
 ds_read_b128 a[168:171], v5 offset:18432
 ds_read_b128 a[172:175], v6 offset:18432
M v[128:131], a[36:39], a[164:167], v[128:131]
 ds_read_b64_tr_b16 a[136:137], v2 offset:49152
 ds_read_b64_tr_b16 a[138:139], v2 offset:50176
M v[132:135], a[44:47], a[164:167], v[132:135]
 buffer_load_dwordx4 v15, s[48:51], s22 offen offset:3072   lds
M v[132:135], a[40:43], a[160:163], v[132:135]
 s_add_u32 s22, s22, 2097152
M v[136:139], a[48:51], a[160:163], v[136:139]
M v[136:139], a[52:55], a[164:167], v[136:139]
M v[140:143], a[60:63], a[164:167], v[140:143]
 s_add_u32 m0, s23, 32768
M v[140:143], a[56:59], a[160:163], v[140:143]
 ds_read_b64_tr_b16 a[140:141], v2 offset:57344
 ds_read_b64_tr_b16 a[142:143], v2 offset:58368
M v[144:147], a[64:67], a[160:163], v[144:147]
 buffer_load_dwordx4 v8, s[16:19], s21 offen offset:0  nt lds
M v[144:147], a[68:71], a[164:167], v[144:147]
M v[148:151], a[76:79], a[164:167], v[148:151]
M v[148:151], a[72:75], a[160:163], v[148:151]
M v[152:155], a[80:83], a[160:163], v[152:155]
 buffer_load_dwordx4 v9, s[16:19], s21 offen offset:1024  nt lds
M v[152:155], a[84:87], a[164:167], v[152:155]
 s_waitcnt lgkmcnt(4)
M v[156:159], a[92:95], a[164:167], v[156:159]
 ds_read_b64_tr_b16 a[144:145], v3 offset:49152
 ds_read_b64_tr_b16 a[146:147], v3 offset:50176
M v[156:159], a[88:91], a[160:163], v[156:159]
M v[160:163], a[32:35], a[168:171], v[160:163]
 ds_read_b128 a[160:163], v5 offset:20480
 ds_read_b128 a[164:167], v6 offset:20480
M v[160:163], a[36:39], a[172:175], v[160:163]
M v[164:167], a[44:47], a[172:175], v[164:167]
 buffer_load_dwordx4 v10, s[16:19], s21 offen offset:2048  nt lds
M v[164:167], a[40:43], a[168:171], v[164:167]
M v[168:171], a[48:51], a[168:171], v[168:171]
M v[168:171], a[52:55], a[172:175], v[168:171]
 ds_read_b64_tr_b16 a[148:149], v3 offset:57344
 ds_read_b64_tr_b16 a[150:151], v3 offset:58368
M v[172:175], a[60:63], a[172:175], v[172:175]
M v[172:175], a[56:59], a[168:171], v[172:175]
 buffer_load_dwordx4 v11, s[16:19], s21 offen offset:3072  nt lds
M v[176:179], a[64:67], a[168:171], v[176:179]
 s_add_u32 s21, s21, 128
M v[176:179], a[68:71], a[172:175], v[176:179]
M v[180:183], a[76:79], a[172:175], v[180:183]
M v[180:183], a[72:75], a[168:171], v[180:183]
 s_add_u32 m0, s86, 4096
M v[184:187], a[80:83], a[168:171], v[184:187]
 ds_read_b64_tr_b16 a[152:153], v4 offset:49152
 ds_read_b64_tr_b16 a[154:155], v4 offset:50176
M v[184:187], a[84:87], a[172:175], v[184:187]
 s_waitcnt lgkmcnt(4)
M v[188:191], a[92:95], a[172:175], v[188:191]
 buffer_load_dwordx4 v7, s[60:63], s67 offen offset:0 nt lds
M v[188:191], a[88:91], a[168:171], v[188:191]
M v[192:195], a[32:35], a[160:163], v[192:195]
 ds_read_b128 a[168:171], v5 offset:22528
 ds_read_b128 a[172:175], v6 offset:22528
M v[192:195], a[36:39], a[164:167], v[192:195]
 buffer_load_dwordx4 v7, s[60:63], s67 offen offset:1024 nt lds
M v[196:199], a[44:47], a[164:167], v[196:199]
M v[196:199], a[40:43], a[160:163], v[196:199]
 ds_read_b64_tr_b16 a[156:157], v4 offset:57344
 ds_read_b64_tr_b16 a[158:159], v4 offset:58368
M v[200:203], a[48:51], a[160:163], v[200:203]
M v[200:203], a[52:55], a[164:167], v[200:203]
M v[204:207], a[60:63], a[164:167], v[204:207]
 buffer_load_dwordx4 v7, s[60:63], s67 offen offset:2048 nt lds
M v[204:207], a[56:59], a[160:163], v[204:207]
 s_add_u32 s67, s67, 4096
M v[208:211], a[64:67], a[160:163], v[208:211]
M v[208:211], a[68:71], a[164:167], v[208:211]
M v[212:215], a[76:79], a[164:167], v[212:215]
M v[212:215], a[72:75], a[160:163], v[212:215]
M v[216:219], a[80:83], a[160:163], v[216:219]
M v[216:219], a[84:87], a[164:167], v[216:219]
 s_waitcnt lgkmcnt(2)
M v[220:223], a[92:95], a[164:167], v[220:223]
 s_waitcnt vmcnt(23) lgkmcnt(0)
M v[220:223], a[88:91], a[160:163], v[220:223]
 s_barrier
M v[224:227], a[32:35], a[168:171], v[224:227]
 ds_read_b128 a[160:163], v5 offset:32768
 ds_read_b128 a[164:167], v6 offset:32768
M v[224:227], a[36:39], a[172:175], v[224:227]
 v_and_b32 v26, 48, v0
 v_lshlrev_b32 v26, 17, v26
M v[228:231], a[44:47], a[172:175], v[228:231]
 v_or_b32 v26, v26, v0
 v_lshl_add_u32 v26, v26, 7, s95
M v[228:231], a[40:43], a[168:171], v[228:231]
 buffer_load_dword a240, v26, s[76:79], 0 offen offset:0
M v[232:235], a[48:51], a[168:171], v[232:235]
M v[232:235], a[52:55], a[172:175], v[232:235]
M v[236:239], a[60:63], a[172:175], v[236:239]
M v[236:239], a[56:59], a[168:171], v[236:239]
M v[240:243], a[64:67], a[168:171], v[240:243]
M v[240:243], a[68:71], a[172:175], v[240:243]
M v[244:247], a[76:79], a[172:175], v[244:247]
M v[244:247], a[72:75], a[168:171], v[244:247]
M v[248:251], a[80:83], a[168:171], v[248:251]
M v[248:251], a[84:87], a[172:175], v[248:251]
 s_waitcnt lgkmcnt(0)
M v[252:255], a[92:95], a[172:175], v[252:255]
M v[252:255], a[88:91], a[168:171], v[252:255]
M a[0:3], a[96:99], a[160:163], a[0:3]
 ds_read_b128 a[168:171], v5 offset:34816
 ds_read_b128 a[172:175], v6 offset:34816
M a[0:3], a[100:103], a[164:167], a[0:3]
 ds_read_b64_tr_b16 a[32:33], v1 offset:0
 ds_read_b64_tr_b16 a[34:35], v1 offset:1024
M a[4:7], a[108:111], a[164:167], a[4:7]
 s_add_u32 m0, s24, 16384
M a[4:7], a[104:107], a[160:163], a[4:7]
 buffer_load_dwordx4 v12, s[48:51], s22 offen offset:0   lds
M a[8:11], a[112:115], a[160:163], a[8:11]
M a[8:11], a[116:119], a[164:167], a[8:11]
M a[12:15], a[124:127], a[164:167], a[12:15]
 ds_read_b64_tr_b16 a[36:37], v1 offset:8192
 ds_read_b64_tr_b16 a[38:39], v1 offset:9216
M a[12:15], a[120:123], a[160:163], a[12:15]
M a[16:19], a[128:131], a[160:163], a[16:19]
 buffer_load_dwordx4 v13, s[48:51], s22 offen offset:1024   lds
M a[16:19], a[132:135], a[164:167], a[16:19]
M a[20:23], a[140:143], a[164:167], a[20:23]
M a[20:23], a[136:139], a[160:163], a[20:23]
 ds_read_b64_tr_b16 a[40:41], v2 offset:0
 ds_read_b64_tr_b16 a[42:43], v2 offset:1024
M a[24:27], a[144:147], a[160:163], a[24:27]
M a[24:27], a[148:151], a[164:167], a[24:27]
 s_waitcnt lgkmcnt(6)
M a[28:31], a[156:159], a[164:167], a[28:31]
 buffer_load_dwordx4 v14, s[48:51], s22 offen offset:2048   lds
M a[28:31], a[152:155], a[160:163], a[28:31]
M v[32:35], a[96:99], a[168:171], v[32:35]
 ds_read_b128 a[160:163], v5 offset:36864
 ds_read_b128 a[164:167], v6 offset:36864
M v[32:35], a[100:103], a[172:175], v[32:35]
 ds_read_b64_tr_b16 a[44:45], v2 offset:8192
 ds_read_b64_tr_b16 a[46:47], v2 offset:9216
M v[36:39], a[108:111], a[172:175], v[36:39]
 buffer_load_dwordx4 v15, s[48:51], s22 offen offset:3072   lds
M v[36:39], a[104:107], a[168:171], v[36:39]
 s_sub_u32 s22, s22, 2097024
M v[40:43], a[112:115], a[168:171], v[40:43]
M v[40:43], a[116:119], a[172:175], v[40:43]
 ds_read_b64_tr_b16 a[48:49], v3 offset:0
 ds_read_b64_tr_b16 a[50:51], v3 offset:1024
M v[44:47], a[124:127], a[172:175], v[44:47]
 s_add_u32 m0, s23, 49152
M v[44:47], a[120:123], a[168:171], v[44:47]
 buffer_load_dwordx4 v8, s[16:19], s21 offen offset:0  nt lds
M v[48:51], a[128:131], a[168:171], v[48:51]
M v[48:51], a[132:135], a[172:175], v[48:51]
M v[52:55], a[140:143], a[172:175], v[52:55]
 ds_read_b64_tr_b16 a[52:53], v3 offset:8192
 ds_read_b64_tr_b16 a[54:55], v3 offset:9216
M v[52:55], a[136:139], a[168:171], v[52:55]
M v[56:59], a[144:147], a[168:171], v[56:59]
 buffer_load_dwordx4 v9, s[16:19], s21 offen offset:1024  nt lds
M v[56:59], a[148:151], a[172:175], v[56:59]
 s_waitcnt lgkmcnt(6)
M v[60:63], a[156:159], a[172:175], v[60:63]
M v[60:63], a[152:155], a[168:171], v[60:63]
 ds_read_b64_tr_b16 a[56:57], v4 offset:0
 ds_read_b64_tr_b16 a[58:59], v4 offset:1024
M v[64:67], a[96:99], a[160:163], v[64:67]
 ds_read_b128 a[168:171], v5 offset:38912
 ds_read_b128 a[172:175], v6 offset:38912
M v[64:67], a[100:103], a[164:167], v[64:67]
 buffer_load_dwordx4 v10, s[16:19], s21 offen offset:2048  nt lds
M v[68:71], a[108:111], a[164:167], v[68:71]
M v[68:71], a[104:107], a[160:163], v[68:71]
M v[72:75], a[112:115], a[160:163], v[72:75]
 ds_read_b64_tr_b16 a[60:61], v4 offset:8192
 ds_read_b64_tr_b16 a[62:63], v4 offset:9216
M v[72:75], a[116:119], a[164:167], v[72:75]
M v[76:79], a[124:127], a[164:167], v[76:79]
 buffer_load_dwordx4 v11, s[16:19], s21 offen offset:3072  nt lds
M v[76:79], a[120:123], a[160:163], v[76:79]
 s_add_u32 s21, s21, 524160
M v[80:83], a[128:131], a[160:163], v[80:83]
M v[80:83], a[132:135], a[164:167], v[80:83]
M v[84:87], a[140:143], a[164:167], v[84:87]
M v[84:87], a[136:139], a[160:163], v[84:87]
M v[88:91], a[144:147], a[160:163], v[88:91]
M v[88:91], a[148:151], a[164:167], v[88:91]
 s_waitcnt lgkmcnt(2)
M v[92:95], a[156:159], a[164:167], v[92:95]
 s_waitcnt vmcnt(20) lgkmcnt(0)
M v[92:95], a[152:155], a[160:163], v[92:95]
 s_barrier
M v[96:99], a[96:99], a[168:171], v[96:99]
 ds_read_b128 a[160:163], v5 offset:49152
 ds_read_b128 a[164:167], v6 offset:49152
M v[96:99], a[100:103], a[172:175], v[96:99]
M v[100:103], a[108:111], a[172:175], v[100:103]
 s_add_u32 m0, s24, 32768
 ds_read_b64_tr_b16 a[64:65], v1 offset:16384
 ds_read_b64_tr_b16 a[66:67], v1 offset:17408
M v[100:103], a[104:107], a[168:171], v[100:103]
 buffer_load_dwordx4 v12, s[48:51], s22 offen offset:0   lds
M v[104:107], a[112:115], a[168:171], v[104:107]
M v[104:107], a[116:119], a[172:175], v[104:107]
M v[108:111], a[124:127], a[172:175], v[108:111]
M v[108:111], a[120:123], a[168:171], v[108:111]
M v[112:115], a[128:131], a[168:171], v[112:115]
M v[112:115], a[132:135], a[172:175], v[112:115]
 ds_read_b64_tr_b16 a[68:69], v1 offset:24576
 ds_read_b64_tr_b16 a[70:71], v1 offset:25600
M v[116:119], a[140:143], a[172:175], v[116:119]
 buffer_load_dwordx4 v13, s[48:51], s22 offen offset:1024   lds
M v[116:119], a[136:139], a[168:171], v[116:119]
M v[120:123], a[144:147], a[168:171], v[120:123]
M v[120:123], a[148:151], a[172:175], v[120:123]
 s_waitcnt lgkmcnt(4)
M v[124:127], a[156:159], a[172:175], v[124:127]
M v[124:127], a[152:155], a[168:171], v[124:127]
M v[128:131], a[96:99], a[160:163], v[128:131]
 ds_read_b128 a[168:171], v5 offset:51200
 ds_read_b128 a[172:175], v6 offset:51200
M v[128:131], a[100:103], a[164:167], v[128:131]
 ds_read_b64_tr_b16 a[72:73], v2 offset:16384
 ds_read_b64_tr_b16 a[74:75], v2 offset:17408
M v[132:135], a[108:111], a[164:167], v[132:135]
 buffer_load_dwordx4 v14, s[48:51], s22 offen offset:2048   lds
M v[132:135], a[104:107], a[160:163], v[132:135]
M v[136:139], a[112:115], a[160:163], v[136:139]
M v[136:139], a[116:119], a[164:167], v[136:139]
M v[140:143], a[124:127], a[164:167], v[140:143]
M v[140:143], a[120:123], a[160:163], v[140:143]
 ds_read_b64_tr_b16 a[76:77], v2 offset:24576
 ds_read_b64_tr_b16 a[78:79], v2 offset:25600
M v[144:147], a[128:131], a[160:163], v[144:147]
 buffer_load_dwordx4 v15, s[48:51], s22 offen offset:3072   lds
M v[144:147], a[132:135], a[164:167], v[144:147]
 s_add_u32 s22, s22, 2097152
M v[148:151], a[140:143], a[164:167], v[148:151]
M v[148:151], a[136:139], a[160:163], v[148:151]
M v[152:155], a[144:147], a[160:163], v[152:155]
M v[152:155], a[148:151], a[164:167], v[152:155]
 s_waitcnt lgkmcnt(4)
M v[156:159], a[156:159], a[164:167], v[156:159]
 s_add_u32 m0, s23, 0
 ds_read_b64_tr_b16 a[80:81], v3 offset:16384
 ds_read_b64_tr_b16 a[82:83], v3 offset:17408
M v[156:159], a[152:155], a[160:163], v[156:159]
 buffer_load_dwordx4 v8, s[16:19], s21 offen offset:0  nt lds
M v[160:163], a[96:99], a[168:171], v[160:163]
 ds_read_b128 a[160:163], v5 offset:53248
 ds_read_b128 a[164:167], v6 offset:53248
M v[160:163], a[100:103], a[172:175], v[160:163]
M v[164:167], a[108:111], a[172:175], v[164:167]
M v[164:167], a[104:107], a[168:171], v[164:167]
M v[168:171], a[112:115], a[168:171], v[168:171]
M v[168:171], a[116:119], a[172:175], v[168:171]
 ds_read_b64_tr_b16 a[84:85], v3 offset:24576
 ds_read_b64_tr_b16 a[86:87], v3 offset:25600
M v[172:175], a[124:127], a[172:175], v[172:175]
 buffer_load_dwordx4 v9, s[16:19], s21 offen offset:1024  nt lds
M v[172:175], a[120:123], a[168:171], v[172:175]
M v[176:179], a[128:131], a[168:171], v[176:179]
M v[176:179], a[132:135], a[172:175], v[176:179]
M v[180:183], a[140:143], a[172:175], v[180:183]
M v[180:183], a[136:139], a[168:171], v[180:183]
M v[184:187], a[144:147], a[168:171], v[184:187]
 ds_read_b64_tr_b16 a[88:89], v4 offset:16384
 ds_read_b64_tr_b16 a[90:91], v4 offset:17408
M v[184:187], a[148:151], a[172:175], v[184:187]
 s_waitcnt lgkmcnt(4)
M v[188:191], a[156:159], a[172:175], v[188:191]
 buffer_load_dwordx4 v10, s[16:19], s21 offen offset:2048  nt lds
M v[188:191], a[152:155], a[168:171], v[188:191]
M v[192:195], a[96:99], a[160:163], v[192:195]
 ds_read_b128 a[168:171], v5 offset:55296
 ds_read_b128 a[172:175], v6 offset:55296
M v[192:195], a[100:103], a[164:167], v[192:195]
M v[196:199], a[108:111], a[164:167], v[196:199]
M v[196:199], a[104:107], a[160:163], v[196:199]
 ds_read_b64_tr_b16 a[92:93], v4 offset:24576
 ds_read_b64_tr_b16 a[94:95], v4 offset:25600
M v[200:203], a[112:115], a[160:163], v[200:203]
 buffer_load_dwordx4 v11, s[16:19], s21 offen offset:3072  nt lds
M v[200:203], a[116:119], a[164:167], v[200:203]
 s_add_u32 s21, s21, 128
M v[204:207], a[124:127], a[164:167], v[204:207]
M v[204:207], a[120:123], a[160:163], v[204:207]
M v[208:211], a[128:131], a[160:163], v[208:211]
M v[208:211], a[132:135], a[164:167], v[208:211]
M v[212:215], a[140:143], a[164:167], v[212:215]
M v[212:215], a[136:139], a[160:163], v[212:215]
M v[216:219], a[144:147], a[160:163], v[216:219]
M v[216:219], a[148:151], a[164:167], v[216:219]
 s_waitcnt lgkmcnt(2)
M v[220:223], a[156:159], a[164:167], v[220:223]
 s_waitcnt vmcnt(17) lgkmcnt(0)
M v[220:223], a[152:155], a[160:163], v[220:223]
 s_barrier
M v[224:227], a[96:99], a[168:171], v[224:227]
 ds_read_b128 a[160:163], v5 offset:0
 ds_read_b128 a[164:167], v6 offset:0
M v[224:227], a[100:103], a[172:175], v[224:227]
M v[228:231], a[108:111], a[172:175], v[228:231]
M v[228:231], a[104:107], a[168:171], v[228:231]
M v[232:235], a[112:115], a[168:171], v[232:235]
M v[232:235], a[116:119], a[172:175], v[232:235]
M v[236:239], a[124:127], a[172:175], v[236:239]
M v[236:239], a[120:123], a[168:171], v[236:239]
M v[240:243], a[128:131], a[168:171], v[240:243]
M v[240:243], a[132:135], a[172:175], v[240:243]
M v[244:247], a[140:143], a[172:175], v[244:247]
M v[244:247], a[136:139], a[168:171], v[244:247]
M v[248:251], a[144:147], a[168:171], v[248:251]
M v[248:251], a[148:151], a[172:175], v[248:251]
 s_waitcnt lgkmcnt(0)
M v[252:255], a[156:159], a[172:175], v[252:255]
M v[252:255], a[152:155], a[168:171], v[252:255]
M a[0:3], a[32:35], a[160:163], a[0:3]
 ds_read_b128 a[168:171], v5 offset:2048
 ds_read_b128 a[172:175], v6 offset:2048
M a[0:3], a[36:39], a[164:167], a[0:3]
 ds_read_b64_tr_b16 a[96:97], v1 offset:32768
 ds_read_b64_tr_b16 a[98:99], v1 offset:33792
M a[4:7], a[44:47], a[164:167], a[4:7]
 s_add_u32 m0, s24, 49152
 v_lshrrev_b32 v28, 2, v0
M a[4:7], a[40:43], a[160:163], a[4:7]
 buffer_load_dwordx4 v12, s[48:51], s22 offen offset:0   lds
M a[8:11], a[48:51], a[160:163], a[8:11]
 v_mul_u32_u24 v28, 896, v28
M a[8:11], a[52:55], a[164:167], a[8:11]
M a[12:15], a[60:63], a[164:167], a[12:15]
 ds_read_b64_tr_b16 a[100:101], v1 offset:40960
 ds_read_b64_tr_b16 a[102:103], v1 offset:41984
M a[12:15], a[56:59], a[160:163], a[12:15]
 v_and_b32 v29, 3, v0
M a[16:19], a[64:67], a[160:163], a[16:19]
 buffer_load_dwordx4 v13, s[48:51], s22 offen offset:1024   lds
M a[16:19], a[68:71], a[164:167], a[16:19]
 v_lshl_add_u32 v28, v29, 4, v28
M a[20:23], a[76:79], a[164:167], a[20:23]
M a[20:23], a[72:75], a[160:163], a[20:23]
 s_lshr_b32 s64, s20, 1
 ds_read_b64_tr_b16 a[104:105], v2 offset:32768
 ds_read_b64_tr_b16 a[106:107], v2 offset:33792
M a[24:27], a[80:83], a[160:163], a[24:27]
 s_lshl_b32 s64, s64, 6
 s_and_b32 s72, s20, 1
 s_lshl_b32 s72, s72, 3
M a[24:27], a[84:87], a[164:167], a[24:27]
 s_waitcnt lgkmcnt(6)
 s_add_u32 s64, s64, s72
 s_add_u32 s64, s64, 131072
M a[28:31], a[92:95], a[164:167], a[28:31]
 buffer_load_dwordx4 v14, s[48:51], s22 offen offset:2048   lds
M a[28:31], a[88:91], a[160:163], a[28:31]
 v_add_u32 v28, s64, v28
M v[32:35], a[32:35], a[168:171], v[32:35]
 ds_read_b128 a[160:163], v5 offset:4096
 ds_read_b128 a[164:167], v6 offset:4096
M v[32:35], a[36:39], a[172:175], v[32:35]
 s_lshl_b32 s94, s41, 18
 ds_read_b64_tr_b16 a[108:109], v2 offset:40960
 ds_read_b64_tr_b16 a[110:111], v2 offset:41984
M v[36:39], a[44:47], a[172:175], v[36:39]
 buffer_load_dwordx4 v15, s[48:51], s22 offen offset:3072   lds
M v[36:39], a[40:43], a[168:171], v[36:39]
 s_sub_u32 s22, s22, 2097024
 s_and_b32 s64, s42, 7
M v[40:43], a[48:51], a[168:171], v[40:43]
 s_lshl_b32 s64, s64, 10
M v[40:43], a[52:55], a[172:175], v[40:43]
 s_add_u32 s94, s94, s64
 ds_read_b64_tr_b16 a[112:113], v3 offset:32768
 ds_read_b64_tr_b16 a[114:115], v3 offset:33792
M v[44:47], a[60:63], a[172:175], v[44:47]
 s_add_u32 m0, s23, 16384
 s_lshl_b32 s64, s20, 13
 s_add_u32 s94, s94, s64
M v[44:47], a[56:59], a[168:171], v[44:47]
 buffer_load_dwordx4 v8, s[16:19], s21 offen offset:0  nt lds
M v[48:51], a[64:67], a[168:171], v[48:51]
 s_add_u32 s94, s94, 100663296
 ds_read_b64_tr_b16 a[192:193], v28 offset:0
M v[48:51], a[68:71], a[172:175], v[48:51]
M v[52:55], a[76:79], a[172:175], v[52:55]
 ds_read_b64_tr_b16 a[116:117], v3 offset:40960
 ds_read_b64_tr_b16 a[118:119], v3 offset:41984
M v[52:55], a[72:75], a[168:171], v[52:55]
 ds_read_b64_tr_b16 a[194:195], v28 offset:14336
M v[56:59], a[80:83], a[168:171], v[56:59]
 buffer_load_dwordx4 v9, s[16:19], s21 offen offset:1024  nt lds
M v[56:59], a[84:87], a[172:175], v[56:59]
 s_waitcnt lgkmcnt(8)
 ds_read_b64_tr_b16 a[196:197], v28 offset:128
M v[60:63], a[92:95], a[172:175], v[60:63]
M v[60:63], a[88:91], a[168:171], v[60:63]
 ds_read_b64_tr_b16 a[120:121], v4 offset:32768
 ds_read_b64_tr_b16 a[122:123], v4 offset:33792
M v[64:67], a[32:35], a[160:163], v[64:67]
 ds_read_b128 a[168:171], v5 offset:6144
 ds_read_b128 a[172:175], v6 offset:6144
M v[64:67], a[36:39], a[164:167], v[64:67]
 buffer_load_dwordx4 v10, s[16:19], s21 offen offset:2048  nt lds
M v[68:71], a[44:47], a[164:167], v[68:71]
 ds_read_b64_tr_b16 a[198:199], v28 offset:14464
M v[68:71], a[40:43], a[160:163], v[68:71]
M v[72:75], a[48:51], a[160:163], v[72:75]
 ds_read_b64_tr_b16 a[124:125], v4 offset:40960
 ds_read_b64_tr_b16 a[126:127], v4 offset:41984
M v[72:75], a[52:55], a[164:167], v[72:75]
 ds_read_b64_tr_b16 a[200:201], v28 offset:256
M v[76:79], a[60:63], a[164:167], v[76:79]
 buffer_load_dwordx4 v11, s[16:19], s21 offen offset:3072  nt lds
M v[76:79], a[56:59], a[160:163], v[76:79]
 s_add_u32 s21, s21, 524160
 ds_read_b64_tr_b16 a[202:203], v28 offset:14592
M v[80:83], a[64:67], a[160:163], v[80:83]
M v[80:83], a[68:71], a[164:167], v[80:83]
 ds_read_b64_tr_b16 a[204:205], v28 offset:384
M v[84:87], a[76:79], a[164:167], v[84:87]
M v[84:87], a[72:75], a[160:163], v[84:87]
 ds_read_b64_tr_b16 a[206:207], v28 offset:14720
M v[88:91], a[80:83], a[160:163], v[88:91]
M v[88:91], a[84:87], a[164:167], v[88:91]
 s_waitcnt lgkmcnt(7)
 ds_read_b64_tr_b16 a[208:209], v28 offset:512
M v[92:95], a[92:95], a[164:167], v[92:95]
 s_waitcnt vmcnt(16) lgkmcnt(0)
M v[92:95], a[88:91], a[160:163], v[92:95]
 s_barrier
M v[96:99], a[32:35], a[168:171], v[96:99]
 ds_read_b128 a[160:163], v5 offset:16384
 ds_read_b128 a[164:167], v6 offset:16384
M v[96:99], a[36:39], a[172:175], v[96:99]
 ds_read_b64_tr_b16 a[210:211], v28 offset:14848
M v[100:103], a[44:47], a[172:175], v[100:103]
 s_add_u32 m0, s24, 0
 ds_read_b64_tr_b16 a[128:129], v1 offset:49152
 ds_read_b64_tr_b16 a[130:131], v1 offset:50176
M v[100:103], a[40:43], a[168:171], v[100:103]
 buffer_load_dwordx4 v12, s[48:51], s22 offen offset:0   lds
M v[104:107], a[48:51], a[168:171], v[104:107]
 ds_read_b64_tr_b16 a[212:213], v28 offset:640
M v[104:107], a[52:55], a[172:175], v[104:107]
M v[108:111], a[60:63], a[172:175], v[108:111]
 ds_read_b64_tr_b16 a[214:215], v28 offset:14976
M v[108:111], a[56:59], a[168:171], v[108:111]
M v[112:115], a[64:67], a[168:171], v[112:115]
 ds_read_b64_tr_b16 a[216:217], v28 offset:768
M v[112:115], a[68:71], a[172:175], v[112:115]
 ds_read_b64_tr_b16 a[132:133], v1 offset:57344
 ds_read_b64_tr_b16 a[134:135], v1 offset:58368
M v[116:119], a[76:79], a[172:175], v[116:119]
 buffer_load_dwordx4 v13, s[48:51], s22 offen offset:1024   lds
M v[116:119], a[72:75], a[168:171], v[116:119]
 ds_read_b64_tr_b16 a[218:219], v28 offset:15104
M v[120:123], a[80:83], a[168:171], v[120:123]
M v[120:123], a[84:87], a[172:175], v[120:123]
 s_waitcnt lgkmcnt(9)
M v[124:127], a[92:95], a[172:175], v[124:127]
M v[124:127], a[88:91], a[168:171], v[124:127]
M v[128:131], a[32:35], a[160:163], v[128:131]
 ds_read_b128 a[168:171], v5 offset:18432
 ds_read_b128 a[172:175], v6 offset:18432
M v[128:131], a[36:39], a[164:167], v[128:131]
 ds_read_b64_tr_b16 a[136:137], v2 offset:49152
 ds_read_b64_tr_b16 a[138:139], v2 offset:50176
M v[132:135], a[44:47], a[164:167], v[132:135]
 buffer_load_dwordx4 v14, s[48:51], s22 offen offset:2048   lds
M v[132:135], a[40:43], a[160:163], v[132:135]
M v[136:139], a[48:51], a[160:163], v[136:139]
M v[136:139], a[52:55], a[164:167], v[136:139]
M v[140:143], a[60:63], a[164:167], v[140:143]
M v[140:143], a[56:59], a[160:163], v[140:143]
 ds_read_b64_tr_b16 a[140:141], v2 offset:57344
 ds_read_b64_tr_b16 a[142:143], v2 offset:58368
M v[144:147], a[64:67], a[160:163], v[144:147]
 buffer_load_dwordx4 v15, s[48:51], s22 offen offset:3072   lds
M v[144:147], a[68:71], a[164:167], v[144:147]
 s_add_u32 s22, s22, 2097152
M v[148:151], a[76:79], a[164:167], v[148:151]
M v[148:151], a[72:75], a[160:163], v[148:151]
M v[152:155], a[80:83], a[160:163], v[152:155]
M v[152:155], a[84:87], a[164:167], v[152:155]
 s_waitcnt lgkmcnt(4)
M v[156:159], a[92:95], a[164:167], v[156:159]
 s_add_u32 m0, s23, 32768
 ds_read_b64_tr_b16 a[144:145], v3 offset:49152
 ds_read_b64_tr_b16 a[146:147], v3 offset:50176
M v[156:159], a[88:91], a[160:163], v[156:159]
 buffer_load_dwordx4 v8, s[16:19], s21 offen offset:0  nt lds
M v[160:163], a[32:35], a[168:171], v[160:163]
 ds_read_b128 a[160:163], v5 offset:20480
 ds_read_b128 a[164:167], v6 offset:20480
M v[160:163], a[36:39], a[172:175], v[160:163]
M v[164:167], a[44:47], a[172:175], v[164:167]
M v[164:167], a[40:43], a[168:171], v[164:167]
M v[168:171], a[48:51], a[168:171], v[168:171]
M v[168:171], a[52:55], a[172:175], v[168:171]
 ds_read_b64_tr_b16 a[148:149], v3 offset:57344
 ds_read_b64_tr_b16 a[150:151], v3 offset:58368
M v[172:175], a[60:63], a[172:175], v[172:175]
 buffer_load_dwordx4 v9, s[16:19], s21 offen offset:1024  nt lds
M v[172:175], a[56:59], a[168:171], v[172:175]
M v[176:179], a[64:67], a[168:171], v[176:179]
M v[176:179], a[68:71], a[172:175], v[176:179]
M v[180:183], a[76:79], a[172:175], v[180:183]
M v[180:183], a[72:75], a[168:171], v[180:183]
M v[184:187], a[80:83], a[168:171], v[184:187]
 ds_read_b64_tr_b16 a[152:153], v4 offset:49152
 ds_read_b64_tr_b16 a[154:155], v4 offset:50176
M v[184:187], a[84:87], a[172:175], v[184:187]
 s_waitcnt lgkmcnt(4)
M v[188:191], a[92:95], a[172:175], v[188:191]
 buffer_load_dwordx4 v10, s[16:19], s21 offen offset:2048  nt lds
M v[188:191], a[88:91], a[168:171], v[188:191]
M v[192:195], a[32:35], a[160:163], v[192:195]
 ds_read_b128 a[168:171], v5 offset:22528
 ds_read_b128 a[172:175], v6 offset:22528
M v[192:195], a[36:39], a[164:167], v[192:195]
M v[196:199], a[44:47], a[164:167], v[196:199]
M v[196:199], a[40:43], a[160:163], v[196:199]
 ds_read_b64_tr_b16 a[156:157], v4 offset:57344
 ds_read_b64_tr_b16 a[158:159], v4 offset:58368
M v[200:203], a[48:51], a[160:163], v[200:203]
 buffer_load_dwordx4 v11, s[16:19], s21 offen offset:3072  nt lds
M v[200:203], a[52:55], a[164:167], v[200:203]
 s_add_u32 s21, s21, 128
M v[204:207], a[60:63], a[164:167], v[204:207]
M v[204:207], a[56:59], a[160:163], v[204:207]
M v[208:211], a[64:67], a[160:163], v[208:211]
M v[208:211], a[68:71], a[164:167], v[208:211]
M v[212:215], a[76:79], a[164:167], v[212:215]
M v[212:215], a[72:75], a[160:163], v[212:215]
M v[216:219], a[80:83], a[160:163], v[216:219]
M v[216:219], a[84:87], a[164:167], v[216:219]
 s_waitcnt lgkmcnt(2)
M v[220:223], a[92:95], a[164:167], v[220:223]
 s_waitcnt vmcnt(16) lgkmcnt(0)
M v[220:223], a[88:91], a[160:163], v[220:223]
 s_barrier
M v[224:227], a[32:35], a[168:171], v[224:227]
 ds_read_b128 a[160:163], v5 offset:32768
 ds_read_b128 a[164:167], v6 offset:32768
M v[224:227], a[36:39], a[172:175], v[224:227]
 buffer_load_dword a240, v24, s[32:35], 0 offen offset:1536
M v[228:231], a[44:47], a[172:175], v[228:231]
M v[228:231], a[40:43], a[168:171], v[228:231]
M v[232:235], a[48:51], a[168:171], v[232:235]
M v[232:235], a[52:55], a[172:175], v[232:235]
M v[236:239], a[60:63], a[172:175], v[236:239]
M v[236:239], a[56:59], a[168:171], v[236:239]
M v[240:243], a[64:67], a[168:171], v[240:243]
M v[240:243], a[68:71], a[172:175], v[240:243]
M v[244:247], a[76:79], a[172:175], v[244:247]
M v[244:247], a[72:75], a[168:171], v[244:247]
M v[248:251], a[80:83], a[168:171], v[248:251]
M v[248:251], a[84:87], a[172:175], v[248:251]
 s_waitcnt lgkmcnt(0)
M v[252:255], a[92:95], a[172:175], v[252:255]
M v[252:255], a[88:91], a[168:171], v[252:255]
M a[0:3], a[96:99], a[160:163], a[0:3]
 ds_read_b128 a[168:171], v5 offset:34816
 ds_read_b128 a[172:175], v6 offset:34816
M a[0:3], a[100:103], a[164:167], a[0:3]
 ds_read_b64_tr_b16 a[32:33], v1 offset:0
 ds_read_b64_tr_b16 a[34:35], v1 offset:1024
M a[4:7], a[108:111], a[164:167], a[4:7]
 s_add_u32 m0, s24, 16384
M a[4:7], a[104:107], a[160:163], a[4:7]
 buffer_load_dwordx4 v12, s[48:51], s22 offen offset:0   lds
M a[8:11], a[112:115], a[160:163], a[8:11]
M a[8:11], a[116:119], a[164:167], a[8:11]
M a[12:15], a[124:127], a[164:167], a[12:15]
 ds_read_b64_tr_b16 a[36:37], v1 offset:8192
 ds_read_b64_tr_b16 a[38:39], v1 offset:9216
M a[12:15], a[120:123], a[160:163], a[12:15]
M a[16:19], a[128:131], a[160:163], a[16:19]
 buffer_load_dwordx4 v13, s[48:51], s22 offen offset:1024   lds
M a[16:19], a[132:135], a[164:167], a[16:19]
M a[20:23], a[140:143], a[164:167], a[20:23]
M a[20:23], a[136:139], a[160:163], a[20:23]
 ds_read_b64_tr_b16 a[40:41], v2 offset:0
 ds_read_b64_tr_b16 a[42:43], v2 offset:1024
M a[24:27], a[144:147], a[160:163], a[24:27]
M a[24:27], a[148:151], a[164:167], a[24:27]
 s_waitcnt lgkmcnt(6)
M a[28:31], a[156:159], a[164:167], a[28:31]
 buffer_load_dwordx4 v14, s[48:51], s22 offen offset:2048   lds
M a[28:31], a[152:155], a[160:163], a[28:31]
M v[32:35], a[96:99], a[168:171], v[32:35]
 ds_read_b128 a[160:163], v5 offset:36864
 ds_read_b128 a[164:167], v6 offset:36864
M v[32:35], a[100:103], a[172:175], v[32:35]
 ds_read_b64_tr_b16 a[44:45], v2 offset:8192
 ds_read_b64_tr_b16 a[46:47], v2 offset:9216
M v[36:39], a[108:111], a[172:175], v[36:39]
 buffer_load_dwordx4 v15, s[48:51], s22 offen offset:3072   lds
M v[36:39], a[104:107], a[168:171], v[36:39]
 s_sub_u32 s22, s22, 2097024
M v[40:43], a[112:115], a[168:171], v[40:43]
M v[40:43], a[116:119], a[172:175], v[40:43]
 ds_read_b64_tr_b16 a[48:49], v3 offset:0
 ds_read_b64_tr_b16 a[50:51], v3 offset:1024
M v[44:47], a[124:127], a[172:175], v[44:47]
 s_add_u32 m0, s23, 49152
M v[44:47], a[120:123], a[168:171], v[44:47]
 buffer_load_dwordx4 v8, s[16:19], s21 offen offset:0  nt lds
M v[48:51], a[128:131], a[168:171], v[48:51]
M v[48:51], a[132:135], a[172:175], v[48:51]
M v[52:55], a[140:143], a[172:175], v[52:55]
 ds_read_b64_tr_b16 a[52:53], v3 offset:8192
 ds_read_b64_tr_b16 a[54:55], v3 offset:9216
M v[52:55], a[136:139], a[168:171], v[52:55]
M v[56:59], a[144:147], a[168:171], v[56:59]
 buffer_load_dwordx4 v9, s[16:19], s21 offen offset:1024  nt lds
M v[56:59], a[148:151], a[172:175], v[56:59]
 s_waitcnt lgkmcnt(6)
M v[60:63], a[156:159], a[172:175], v[60:63]
M v[60:63], a[152:155], a[168:171], v[60:63]
 ds_read_b64_tr_b16 a[56:57], v4 offset:0
 ds_read_b64_tr_b16 a[58:59], v4 offset:1024
M v[64:67], a[96:99], a[160:163], v[64:67]
 ds_read_b128 a[168:171], v5 offset:38912
 ds_read_b128 a[172:175], v6 offset:38912
M v[64:67], a[100:103], a[164:167], v[64:67]
 buffer_load_dwordx4 v10, s[16:19], s21 offen offset:2048  nt lds
M v[68:71], a[108:111], a[164:167], v[68:71]
M v[68:71], a[104:107], a[160:163], v[68:71]
M v[72:75], a[112:115], a[160:163], v[72:75]
 ds_read_b64_tr_b16 a[60:61], v4 offset:8192
 ds_read_b64_tr_b16 a[62:63], v4 offset:9216
M v[72:75], a[116:119], a[164:167], v[72:75]
M v[76:79], a[124:127], a[164:167], v[76:79]
 buffer_load_dwordx4 v11, s[16:19], s21 offen offset:3072  nt lds
M v[76:79], a[120:123], a[160:163], v[76:79]
 s_add_u32 s21, s21, 524160
M v[80:83], a[128:131], a[160:163], v[80:83]
M v[80:83], a[132:135], a[164:167], v[80:83]
M v[84:87], a[140:143], a[164:167], v[84:87]
M v[84:87], a[136:139], a[160:163], v[84:87]
M v[88:91], a[144:147], a[160:163], v[88:91]
M v[88:91], a[148:151], a[164:167], v[88:91]
 s_waitcnt lgkmcnt(2)
M v[92:95], a[156:159], a[164:167], v[92:95]
 s_waitcnt vmcnt(17) lgkmcnt(0)
M v[92:95], a[152:155], a[160:163], v[92:95]
 s_barrier
M v[96:99], a[96:99], a[168:171], v[96:99]
 ds_read_b128 a[160:163], v5 offset:49152
 ds_read_b128 a[164:167], v6 offset:49152
M v[96:99], a[100:103], a[172:175], v[96:99]
M v[100:103], a[108:111], a[172:175], v[100:103]
 s_add_u32 m0, s24, 32768
 ds_read_b64_tr_b16 a[64:65], v1 offset:16384
 ds_read_b64_tr_b16 a[66:67], v1 offset:17408
M v[100:103], a[104:107], a[168:171], v[100:103]
 buffer_load_dwordx4 v12, s[48:51], s22 offen offset:0   lds
M v[104:107], a[112:115], a[168:171], v[104:107]
M v[104:107], a[116:119], a[172:175], v[104:107]
M v[108:111], a[124:127], a[172:175], v[108:111]
M v[108:111], a[120:123], a[168:171], v[108:111]
M v[112:115], a[128:131], a[168:171], v[112:115]
M v[112:115], a[132:135], a[172:175], v[112:115]
 ds_read_b64_tr_b16 a[68:69], v1 offset:24576
 ds_read_b64_tr_b16 a[70:71], v1 offset:25600
M v[116:119], a[140:143], a[172:175], v[116:119]
 buffer_load_dwordx4 v13, s[48:51], s22 offen offset:1024   lds
M v[116:119], a[136:139], a[168:171], v[116:119]
M v[120:123], a[144:147], a[168:171], v[120:123]
 s_and_b32 s64, s42, 7
 s_lshl_b32 s64, s64, 2
M v[120:123], a[148:151], a[172:175], v[120:123]
 s_waitcnt lgkmcnt(4)
 s_add_u32 s64, s64, s20
M v[124:127], a[156:159], a[172:175], v[124:127]
 s_mul_i32 s64, s64, 114688
 v_bfe_u32 v28, v0, 2, 2
 v_and_b32 v29, 3, v0
M v[124:127], a[152:155], a[168:171], v[124:127]
 v_lshlrev_b32 v29, 7, v29
 v_lshl_add_u32 v28, v28, 13, v29
M v[128:131], a[96:99], a[160:163], v[128:131]
 ds_read_b128 a[168:171], v5 offset:51200
 ds_read_b128 a[172:175], v6 offset:51200
M v[128:131], a[100:103], a[164:167], v[128:131]
 ds_read_b64_tr_b16 a[72:73], v2 offset:16384
 ds_read_b64_tr_b16 a[74:75], v2 offset:17408
M v[132:135], a[108:111], a[164:167], v[132:135]
 buffer_load_dwordx4 v14, s[48:51], s22 offen offset:2048   lds
M v[132:135], a[104:107], a[160:163], v[132:135]
 v_add_u32 v23, s64, v28
 v_and_b32 v28, 48, v0
M v[136:139], a[112:115], a[160:163], v[136:139]
 v_lshl_add_u32 v23, v28, 24, v23
M v[136:139], a[116:119], a[164:167], v[136:139]
M v[140:143], a[124:127], a[164:167], v[140:143]
M v[140:143], a[120:123], a[160:163], v[140:143]
 ds_read_b64_tr_b16 a[76:77], v2 offset:24576
 ds_read_b64_tr_b16 a[78:79], v2 offset:25600
M v[144:147], a[128:131], a[160:163], v[144:147]
 buffer_load_dwordx4 v15, s[48:51], s22 offen offset:3072   lds
M v[144:147], a[132:135], a[164:167], v[144:147]
 s_add_u32 s22, s22, 2097152
M v[148:151], a[140:143], a[164:167], v[148:151]
M v[148:151], a[136:139], a[160:163], v[148:151]
M v[152:155], a[144:147], a[160:163], v[152:155]
M v[152:155], a[148:151], a[164:167], v[152:155]
 s_waitcnt lgkmcnt(4)
M v[156:159], a[156:159], a[164:167], v[156:159]
 s_add_u32 m0, s23, 0
 ds_read_b64_tr_b16 a[80:81], v3 offset:16384
 ds_read_b64_tr_b16 a[82:83], v3 offset:17408
M v[156:159], a[152:155], a[160:163], v[156:159]
 buffer_load_dwordx4 v8, s[16:19], s21 offen offset:0  nt lds
M v[160:163], a[96:99], a[168:171], v[160:163]
 ds_read_b128 a[160:163], v5 offset:53248
 ds_read_b128 a[164:167], v6 offset:53248
M v[160:163], a[100:103], a[172:175], v[160:163]
M v[164:167], a[108:111], a[172:175], v[164:167]
M v[164:167], a[104:107], a[168:171], v[164:167]
M v[168:171], a[112:115], a[168:171], v[168:171]
M v[168:171], a[116:119], a[172:175], v[168:171]
 ds_read_b64_tr_b16 a[84:85], v3 offset:24576
 ds_read_b64_tr_b16 a[86:87], v3 offset:25600
M v[172:175], a[124:127], a[172:175], v[172:175]
 buffer_load_dwordx4 v9, s[16:19], s21 offen offset:1024  nt lds
M v[172:175], a[120:123], a[168:171], v[172:175]
M v[176:179], a[128:131], a[168:171], v[176:179]
M v[176:179], a[132:135], a[172:175], v[176:179]
M v[180:183], a[140:143], a[172:175], v[180:183]
M v[180:183], a[136:139], a[168:171], v[180:183]
M v[184:187], a[144:147], a[168:171], v[184:187]
 ds_read_b64_tr_b16 a[88:89], v4 offset:16384
 ds_read_b64_tr_b16 a[90:91], v4 offset:17408
M v[184:187], a[148:151], a[172:175], v[184:187]
 s_waitcnt lgkmcnt(4)
M v[188:191], a[156:159], a[172:175], v[188:191]
 buffer_load_dwordx4 v10, s[16:19], s21 offen offset:2048  nt lds
M v[188:191], a[152:155], a[168:171], v[188:191]
M v[192:195], a[96:99], a[160:163], v[192:195]
 ds_read_b128 a[168:171], v5 offset:55296
 ds_read_b128 a[172:175], v6 offset:55296
M v[192:195], a[100:103], a[164:167], v[192:195]
M v[196:199], a[108:111], a[164:167], v[196:199]
M v[196:199], a[104:107], a[160:163], v[196:199]
 ds_read_b64_tr_b16 a[92:93], v4 offset:24576
 ds_read_b64_tr_b16 a[94:95], v4 offset:25600
M v[200:203], a[112:115], a[160:163], v[200:203]
 buffer_load_dwordx4 v11, s[16:19], s21 offen offset:3072  nt lds
M v[200:203], a[116:119], a[164:167], v[200:203]
 s_add_u32 s21, s21, 128
M v[204:207], a[124:127], a[164:167], v[204:207]
M v[204:207], a[120:123], a[160:163], v[204:207]
M v[208:211], a[128:131], a[160:163], v[208:211]
M v[208:211], a[132:135], a[164:167], v[208:211]
M v[212:215], a[140:143], a[164:167], v[212:215]
M v[212:215], a[136:139], a[160:163], v[212:215]
M v[216:219], a[144:147], a[160:163], v[216:219]
M v[216:219], a[148:151], a[164:167], v[216:219]
 s_waitcnt lgkmcnt(2)
M v[220:223], a[156:159], a[164:167], v[220:223]
 s_waitcnt vmcnt(17) lgkmcnt(0)
M v[220:223], a[152:155], a[160:163], v[220:223]
 s_barrier
M v[224:227], a[96:99], a[168:171], v[224:227]
 ds_read_b128 a[160:163], v5 offset:0
 ds_read_b128 a[164:167], v6 offset:0
M v[224:227], a[100:103], a[172:175], v[224:227]
 buffer_load_dword a240, v23, s[52:55], 0 offen offset:0
M v[228:231], a[108:111], a[172:175], v[228:231]
 v_add_u32 v23, 32768, v23
M v[228:231], a[104:107], a[168:171], v[228:231]
M v[232:235], a[112:115], a[168:171], v[232:235]
M v[232:235], a[116:119], a[172:175], v[232:235]
M v[236:239], a[124:127], a[172:175], v[236:239]
M v[236:239], a[120:123], a[168:171], v[236:239]
M v[240:243], a[128:131], a[168:171], v[240:243]
M v[240:243], a[132:135], a[172:175], v[240:243]
M v[244:247], a[140:143], a[172:175], v[244:247]
M v[244:247], a[136:139], a[168:171], v[244:247]
M v[248:251], a[144:147], a[168:171], v[248:251]
M v[248:251], a[148:151], a[172:175], v[248:251]
 s_waitcnt lgkmcnt(0)
M v[252:255], a[156:159], a[172:175], v[252:255]
M v[252:255], a[152:155], a[168:171], v[252:255]
M a[0:3], a[32:35], a[160:163], a[0:3]
 ds_read_b128 a[168:171], v5 offset:2048
 ds_read_b128 a[172:175], v6 offset:2048
M a[0:3], a[36:39], a[164:167], a[0:3]
 ds_read_b64_tr_b16 a[96:97], v1 offset:32768
 ds_read_b64_tr_b16 a[98:99], v1 offset:33792
M a[4:7], a[44:47], a[164:167], a[4:7]
 s_add_u32 m0, s24, 49152
M a[4:7], a[40:43], a[160:163], a[4:7]
 buffer_load_dwordx4 v12, s[48:51], s22 offen offset:0   lds
M a[8:11], a[48:51], a[160:163], a[8:11]
M a[8:11], a[52:55], a[164:167], a[8:11]
M a[12:15], a[60:63], a[164:167], a[12:15]
 ds_read_b64_tr_b16 a[100:101], v1 offset:40960
 ds_read_b64_tr_b16 a[102:103], v1 offset:41984
M a[12:15], a[56:59], a[160:163], a[12:15]
M a[16:19], a[64:67], a[160:163], a[16:19]
 buffer_load_dwordx4 v13, s[48:51], s22 offen offset:1024   lds
M a[16:19], a[68:71], a[164:167], a[16:19]
M a[20:23], a[76:79], a[164:167], a[20:23]
M a[20:23], a[72:75], a[160:163], a[20:23]
 ds_read_b64_tr_b16 a[104:105], v2 offset:32768
 ds_read_b64_tr_b16 a[106:107], v2 offset:33792
M a[24:27], a[80:83], a[160:163], a[24:27]
M a[24:27], a[84:87], a[164:167], a[24:27]
 s_waitcnt lgkmcnt(6)
M a[28:31], a[92:95], a[164:167], a[28:31]
 buffer_load_dwordx4 v14, s[48:51], s22 offen offset:2048   lds
M a[28:31], a[88:91], a[160:163], a[28:31]
M v[32:35], a[32:35], a[168:171], v[32:35]
 ds_read_b128 a[160:163], v5 offset:4096
 ds_read_b128 a[164:167], v6 offset:4096
M v[32:35], a[36:39], a[172:175], v[32:35]
 ds_read_b64_tr_b16 a[108:109], v2 offset:40960
 ds_read_b64_tr_b16 a[110:111], v2 offset:41984
M v[36:39], a[44:47], a[172:175], v[36:39]
 buffer_load_dwordx4 v15, s[48:51], s22 offen offset:3072   lds
M v[36:39], a[40:43], a[168:171], v[36:39]
 s_sub_u32 s22, s22, 2097024
M v[40:43], a[48:51], a[168:171], v[40:43]
M v[40:43], a[52:55], a[172:175], v[40:43]
 ds_read_b64_tr_b16 a[112:113], v3 offset:32768
 ds_read_b64_tr_b16 a[114:115], v3 offset:33792
M v[44:47], a[60:63], a[172:175], v[44:47]
 s_add_u32 m0, s23, 16384
M v[44:47], a[56:59], a[168:171], v[44:47]
 buffer_load_dwordx4 v8, s[16:19], s21 offen offset:0  nt lds
M v[48:51], a[64:67], a[168:171], v[48:51]
M v[48:51], a[68:71], a[172:175], v[48:51]
M v[52:55], a[76:79], a[172:175], v[52:55]
 ds_read_b64_tr_b16 a[116:117], v3 offset:40960
 ds_read_b64_tr_b16 a[118:119], v3 offset:41984
M v[52:55], a[72:75], a[168:171], v[52:55]
M v[56:59], a[80:83], a[168:171], v[56:59]
 buffer_load_dwordx4 v9, s[16:19], s21 offen offset:1024  nt lds
M v[56:59], a[84:87], a[172:175], v[56:59]
 s_waitcnt lgkmcnt(6)
M v[60:63], a[92:95], a[172:175], v[60:63]
M v[60:63], a[88:91], a[168:171], v[60:63]
 ds_read_b64_tr_b16 a[120:121], v4 offset:32768
 ds_read_b64_tr_b16 a[122:123], v4 offset:33792
M v[64:67], a[32:35], a[160:163], v[64:67]
 ds_read_b128 a[168:171], v5 offset:6144
 ds_read_b128 a[172:175], v6 offset:6144
M v[64:67], a[36:39], a[164:167], v[64:67]
 buffer_load_dwordx4 v10, s[16:19], s21 offen offset:2048  nt lds
M v[68:71], a[44:47], a[164:167], v[68:71]
M v[68:71], a[40:43], a[160:163], v[68:71]
M v[72:75], a[48:51], a[160:163], v[72:75]
 ds_read_b64_tr_b16 a[124:125], v4 offset:40960
 ds_read_b64_tr_b16 a[126:127], v4 offset:41984
M v[72:75], a[52:55], a[164:167], v[72:75]
M v[76:79], a[60:63], a[164:167], v[76:79]
 buffer_load_dwordx4 v11, s[16:19], s21 offen offset:3072  nt lds
M v[76:79], a[56:59], a[160:163], v[76:79]
 s_add_u32 s21, s21, 524160
M v[80:83], a[64:67], a[160:163], v[80:83]
M v[80:83], a[68:71], a[164:167], v[80:83]
M v[84:87], a[76:79], a[164:167], v[84:87]
M v[84:87], a[72:75], a[160:163], v[84:87]
M v[88:91], a[80:83], a[160:163], v[88:91]
M v[88:91], a[84:87], a[164:167], v[88:91]
 s_waitcnt lgkmcnt(2)
M v[92:95], a[92:95], a[164:167], v[92:95]
 s_waitcnt vmcnt(17) lgkmcnt(0)
M v[92:95], a[88:91], a[160:163], v[92:95]
 s_barrier
M v[96:99], a[32:35], a[168:171], v[96:99]
 ds_read_b128 a[160:163], v5 offset:16384
 ds_read_b128 a[164:167], v6 offset:16384
M v[96:99], a[36:39], a[172:175], v[96:99]
M v[100:103], a[44:47], a[172:175], v[100:103]
 s_add_u32 m0, s24, 0
 ds_read_b64_tr_b16 a[128:129], v1 offset:49152
 ds_read_b64_tr_b16 a[130:131], v1 offset:50176
M v[100:103], a[40:43], a[168:171], v[100:103]
 buffer_load_dwordx4 v12, s[48:51], s22 offen offset:0   lds
M v[104:107], a[48:51], a[168:171], v[104:107]
M v[104:107], a[52:55], a[172:175], v[104:107]
M v[108:111], a[60:63], a[172:175], v[108:111]
M v[108:111], a[56:59], a[168:171], v[108:111]
M v[112:115], a[64:67], a[168:171], v[112:115]
M v[112:115], a[68:71], a[172:175], v[112:115]
 ds_read_b64_tr_b16 a[132:133], v1 offset:57344
 ds_read_b64_tr_b16 a[134:135], v1 offset:58368
M v[116:119], a[76:79], a[172:175], v[116:119]
 buffer_load_dwordx4 v13, s[48:51], s22 offen offset:1024   lds
M v[116:119], a[72:75], a[168:171], v[116:119]
M v[120:123], a[80:83], a[168:171], v[120:123]
M v[120:123], a[84:87], a[172:175], v[120:123]
 s_waitcnt lgkmcnt(4)
M v[124:127], a[92:95], a[172:175], v[124:127]
M v[124:127], a[88:91], a[168:171], v[124:127]
M v[128:131], a[32:35], a[160:163], v[128:131]
 ds_read_b128 a[168:171], v5 offset:18432
 ds_read_b128 a[172:175], v6 offset:18432
M v[128:131], a[36:39], a[164:167], v[128:131]
 ds_read_b64_tr_b16 a[136:137], v2 offset:49152
 ds_read_b64_tr_b16 a[138:139], v2 offset:50176
M v[132:135], a[44:47], a[164:167], v[132:135]
 buffer_load_dwordx4 v14, s[48:51], s22 offen offset:2048   lds
M v[132:135], a[40:43], a[160:163], v[132:135]
M v[136:139], a[48:51], a[160:163], v[136:139]
M v[136:139], a[52:55], a[164:167], v[136:139]
M v[140:143], a[60:63], a[164:167], v[140:143]
M v[140:143], a[56:59], a[160:163], v[140:143]
 ds_read_b64_tr_b16 a[140:141], v2 offset:57344
 ds_read_b64_tr_b16 a[142:143], v2 offset:58368
M v[144:147], a[64:67], a[160:163], v[144:147]
 buffer_load_dwordx4 v15, s[48:51], s22 offen offset:3072   lds
M v[144:147], a[68:71], a[164:167], v[144:147]
 s_add_u32 s22, s22, 2097152
M v[148:151], a[76:79], a[164:167], v[148:151]
M v[148:151], a[72:75], a[160:163], v[148:151]
M v[152:155], a[80:83], a[160:163], v[152:155]
M v[152:155], a[84:87], a[164:167], v[152:155]
 s_waitcnt lgkmcnt(4)
M v[156:159], a[92:95], a[164:167], v[156:159]
 s_add_u32 m0, s23, 32768
 ds_read_b64_tr_b16 a[144:145], v3 offset:49152
 ds_read_b64_tr_b16 a[146:147], v3 offset:50176
M v[156:159], a[88:91], a[160:163], v[156:159]
 buffer_load_dwordx4 v8, s[16:19], s21 offen offset:0  nt lds
M v[160:163], a[32:35], a[168:171], v[160:163]
 ds_read_b128 a[160:163], v5 offset:20480
 ds_read_b128 a[164:167], v6 offset:20480
M v[160:163], a[36:39], a[172:175], v[160:163]
M v[164:167], a[44:47], a[172:175], v[164:167]
M v[164:167], a[40:43], a[168:171], v[164:167]
M v[168:171], a[48:51], a[168:171], v[168:171]
M v[168:171], a[52:55], a[172:175], v[168:171]
 ds_read_b64_tr_b16 a[148:149], v3 offset:57344
 ds_read_b64_tr_b16 a[150:151], v3 offset:58368
M v[172:175], a[60:63], a[172:175], v[172:175]
 buffer_load_dwordx4 v9, s[16:19], s21 offen offset:1024  nt lds
M v[172:175], a[56:59], a[168:171], v[172:175]
M v[176:179], a[64:67], a[168:171], v[176:179]
M v[176:179], a[68:71], a[172:175], v[176:179]
M v[180:183], a[76:79], a[172:175], v[180:183]
M v[180:183], a[72:75], a[168:171], v[180:183]
M v[184:187], a[80:83], a[168:171], v[184:187]
 ds_read_b64_tr_b16 a[152:153], v4 offset:49152
 ds_read_b64_tr_b16 a[154:155], v4 offset:50176
M v[184:187], a[84:87], a[172:175], v[184:187]
 s_waitcnt lgkmcnt(4)
M v[188:191], a[92:95], a[172:175], v[188:191]
 buffer_load_dwordx4 v10, s[16:19], s21 offen offset:2048  nt lds
M v[188:191], a[88:91], a[168:171], v[188:191]
M v[192:195], a[32:35], a[160:163], v[192:195]
 ds_read_b128 a[168:171], v5 offset:22528
 ds_read_b128 a[172:175], v6 offset:22528
M v[192:195], a[36:39], a[164:167], v[192:195]
M v[196:199], a[44:47], a[164:167], v[196:199]
M v[196:199], a[40:43], a[160:163], v[196:199]
 ds_read_b64_tr_b16 a[156:157], v4 offset:57344
 ds_read_b64_tr_b16 a[158:159], v4 offset:58368
M v[200:203], a[48:51], a[160:163], v[200:203]
 buffer_load_dwordx4 v11, s[16:19], s21 offen offset:3072  nt lds
M v[200:203], a[52:55], a[164:167], v[200:203]
 s_add_u32 s21, s21, 128
M v[204:207], a[60:63], a[164:167], v[204:207]
M v[204:207], a[56:59], a[160:163], v[204:207]
M v[208:211], a[64:67], a[160:163], v[208:211]
M v[208:211], a[68:71], a[164:167], v[208:211]
M v[212:215], a[76:79], a[164:167], v[212:215]
M v[212:215], a[72:75], a[160:163], v[212:215]
M v[216:219], a[80:83], a[160:163], v[216:219]
M v[216:219], a[84:87], a[164:167], v[216:219]
 s_waitcnt lgkmcnt(2)
M v[220:223], a[92:95], a[164:167], v[220:223]
 s_waitcnt vmcnt(17) lgkmcnt(0)
M v[220:223], a[88:91], a[160:163], v[220:223]
 s_barrier
M v[224:227], a[32:35], a[168:171], v[224:227]
 ds_read_b128 a[160:163], v5 offset:32768
 ds_read_b128 a[164:167], v6 offset:32768
M v[224:227], a[36:39], a[172:175], v[224:227]
 buffer_load_dword a240, v23, s[52:55], 0 offen offset:0
M v[228:231], a[44:47], a[172:175], v[228:231]
 v_add_u32 v23, 32768, v23
M v[228:231], a[40:43], a[168:171], v[228:231]
M v[232:235], a[48:51], a[168:171], v[232:235]
M v[232:235], a[52:55], a[172:175], v[232:235]
M v[236:239], a[60:63], a[172:175], v[236:239]
M v[236:239], a[56:59], a[168:171], v[236:239]
M v[240:243], a[64:67], a[168:171], v[240:243]
M v[240:243], a[68:71], a[172:175], v[240:243]
M v[244:247], a[76:79], a[172:175], v[244:247]
M v[244:247], a[72:75], a[168:171], v[244:247]
M v[248:251], a[80:83], a[168:171], v[248:251]
M v[248:251], a[84:87], a[172:175], v[248:251]
 s_waitcnt lgkmcnt(0)
M v[252:255], a[92:95], a[172:175], v[252:255]
M v[252:255], a[88:91], a[168:171], v[252:255]
M a[0:3], a[96:99], a[160:163], a[0:3]
 ds_read_b128 a[168:171], v5 offset:34816
 ds_read_b128 a[172:175], v6 offset:34816
M a[0:3], a[100:103], a[164:167], a[0:3]
 ds_read_b64_tr_b16 a[32:33], v1 offset:0
 ds_read_b64_tr_b16 a[34:35], v1 offset:1024
M a[4:7], a[108:111], a[164:167], a[4:7]
 s_add_u32 m0, s24, 16384
M a[4:7], a[104:107], a[160:163], a[4:7]
 buffer_load_dwordx4 v12, s[48:51], s22 offen offset:0   lds
M a[8:11], a[112:115], a[160:163], a[8:11]
M a[8:11], a[116:119], a[164:167], a[8:11]
M a[12:15], a[124:127], a[164:167], a[12:15]
 ds_read_b64_tr_b16 a[36:37], v1 offset:8192
 ds_read_b64_tr_b16 a[38:39], v1 offset:9216
M a[12:15], a[120:123], a[160:163], a[12:15]
M a[16:19], a[128:131], a[160:163], a[16:19]
 buffer_load_dwordx4 v13, s[48:51], s22 offen offset:1024   lds
M a[16:19], a[132:135], a[164:167], a[16:19]
M a[20:23], a[140:143], a[164:167], a[20:23]
M a[20:23], a[136:139], a[160:163], a[20:23]
 ds_read_b64_tr_b16 a[40:41], v2 offset:0
 ds_read_b64_tr_b16 a[42:43], v2 offset:1024
M a[24:27], a[144:147], a[160:163], a[24:27]
M a[24:27], a[148:151], a[164:167], a[24:27]
 s_waitcnt lgkmcnt(6)
M a[28:31], a[156:159], a[164:167], a[28:31]
 buffer_load_dwordx4 v14, s[48:51], s22 offen offset:2048   lds
M a[28:31], a[152:155], a[160:163], a[28:31]
M v[32:35], a[96:99], a[168:171], v[32:35]
 ds_read_b128 a[160:163], v5 offset:36864
 ds_read_b128 a[164:167], v6 offset:36864
M v[32:35], a[100:103], a[172:175], v[32:35]
 ds_read_b64_tr_b16 a[44:45], v2 offset:8192
 ds_read_b64_tr_b16 a[46:47], v2 offset:9216
M v[36:39], a[108:111], a[172:175], v[36:39]
 buffer_load_dwordx4 v15, s[48:51], s22 offen offset:3072   lds
M v[36:39], a[104:107], a[168:171], v[36:39]
 s_sub_u32 s22, s22, 2097024
M v[40:43], a[112:115], a[168:171], v[40:43]
M v[40:43], a[116:119], a[172:175], v[40:43]
 ds_read_b64_tr_b16 a[48:49], v3 offset:0
 ds_read_b64_tr_b16 a[50:51], v3 offset:1024
M v[44:47], a[124:127], a[172:175], v[44:47]
 s_add_u32 m0, s23, 49152
M v[44:47], a[120:123], a[168:171], v[44:47]
 buffer_load_dwordx4 v8, s[16:19], s21 offen offset:0  nt lds
M v[48:51], a[128:131], a[168:171], v[48:51]
M v[48:51], a[132:135], a[172:175], v[48:51]
M v[52:55], a[140:143], a[172:175], v[52:55]
 ds_read_b64_tr_b16 a[52:53], v3 offset:8192
 ds_read_b64_tr_b16 a[54:55], v3 offset:9216
M v[52:55], a[136:139], a[168:171], v[52:55]
M v[56:59], a[144:147], a[168:171], v[56:59]
 buffer_load_dwordx4 v9, s[16:19], s21 offen offset:1024  nt lds
M v[56:59], a[148:151], a[172:175], v[56:59]
 s_waitcnt lgkmcnt(6)
M v[60:63], a[156:159], a[172:175], v[60:63]
M v[60:63], a[152:155], a[168:171], v[60:63]
 ds_read_b64_tr_b16 a[56:57], v4 offset:0
 ds_read_b64_tr_b16 a[58:59], v4 offset:1024
M v[64:67], a[96:99], a[160:163], v[64:67]
 ds_read_b128 a[168:171], v5 offset:38912
 ds_read_b128 a[172:175], v6 offset:38912
M v[64:67], a[100:103], a[164:167], v[64:67]
 buffer_load_dwordx4 v10, s[16:19], s21 offen offset:2048  nt lds
M v[68:71], a[108:111], a[164:167], v[68:71]
M v[68:71], a[104:107], a[160:163], v[68:71]
M v[72:75], a[112:115], a[160:163], v[72:75]
 ds_read_b64_tr_b16 a[60:61], v4 offset:8192
 ds_read_b64_tr_b16 a[62:63], v4 offset:9216
M v[72:75], a[116:119], a[164:167], v[72:75]
M v[76:79], a[124:127], a[164:167], v[76:79]
 buffer_load_dwordx4 v11, s[16:19], s21 offen offset:3072  nt lds
M v[76:79], a[120:123], a[160:163], v[76:79]
 s_add_u32 s21, s21, 524160
M v[80:83], a[128:131], a[160:163], v[80:83]
M v[80:83], a[132:135], a[164:167], v[80:83]
M v[84:87], a[140:143], a[164:167], v[84:87]
M v[84:87], a[136:139], a[160:163], v[84:87]
M v[88:91], a[144:147], a[160:163], v[88:91]
M v[88:91], a[148:151], a[164:167], v[88:91]
 s_waitcnt lgkmcnt(2)
M v[92:95], a[156:159], a[164:167], v[92:95]
 s_waitcnt vmcnt(17) lgkmcnt(0)
M v[92:95], a[152:155], a[160:163], v[92:95]
 s_barrier
M v[96:99], a[96:99], a[168:171], v[96:99]
 ds_read_b128 a[160:163], v5 offset:49152
 ds_read_b128 a[164:167], v6 offset:49152
M v[96:99], a[100:103], a[172:175], v[96:99]
M v[100:103], a[108:111], a[172:175], v[100:103]
 s_add_u32 m0, s24, 32768
 ds_read_b64_tr_b16 a[64:65], v1 offset:16384
 ds_read_b64_tr_b16 a[66:67], v1 offset:17408
M v[100:103], a[104:107], a[168:171], v[100:103]
 buffer_load_dwordx4 v12, s[48:51], s22 offen offset:0   lds
M v[104:107], a[112:115], a[168:171], v[104:107]
M v[104:107], a[116:119], a[172:175], v[104:107]
M v[108:111], a[124:127], a[172:175], v[108:111]
M v[108:111], a[120:123], a[168:171], v[108:111]
M v[112:115], a[128:131], a[168:171], v[112:115]
M v[112:115], a[132:135], a[172:175], v[112:115]
 ds_read_b64_tr_b16 a[68:69], v1 offset:24576
 ds_read_b64_tr_b16 a[70:71], v1 offset:25600
M v[116:119], a[140:143], a[172:175], v[116:119]
 buffer_load_dwordx4 v13, s[48:51], s22 offen offset:1024   lds
M v[116:119], a[136:139], a[168:171], v[116:119]
M v[120:123], a[144:147], a[168:171], v[120:123]
M v[120:123], a[148:151], a[172:175], v[120:123]
 s_waitcnt lgkmcnt(4)
M v[124:127], a[156:159], a[172:175], v[124:127]
M v[124:127], a[152:155], a[168:171], v[124:127]
M v[128:131], a[96:99], a[160:163], v[128:131]
 ds_read_b128 a[168:171], v5 offset:51200
 ds_read_b128 a[172:175], v6 offset:51200
M v[128:131], a[100:103], a[164:167], v[128:131]
 ds_read_b64_tr_b16 a[72:73], v2 offset:16384
 ds_read_b64_tr_b16 a[74:75], v2 offset:17408
M v[132:135], a[108:111], a[164:167], v[132:135]
 buffer_load_dwordx4 v14, s[48:51], s22 offen offset:2048   lds
M v[132:135], a[104:107], a[160:163], v[132:135]
M v[136:139], a[112:115], a[160:163], v[136:139]
M v[136:139], a[116:119], a[164:167], v[136:139]
M v[140:143], a[124:127], a[164:167], v[140:143]
M v[140:143], a[120:123], a[160:163], v[140:143]
 ds_read_b64_tr_b16 a[76:77], v2 offset:24576
 ds_read_b64_tr_b16 a[78:79], v2 offset:25600
M v[144:147], a[128:131], a[160:163], v[144:147]
 buffer_load_dwordx4 v15, s[48:51], s22 offen offset:3072   lds
M v[144:147], a[132:135], a[164:167], v[144:147]
 s_add_u32 s22, s22, 2097152
M v[148:151], a[140:143], a[164:167], v[148:151]
M v[148:151], a[136:139], a[160:163], v[148:151]
M v[152:155], a[144:147], a[160:163], v[152:155]
M v[152:155], a[148:151], a[164:167], v[152:155]
 s_waitcnt lgkmcnt(4)
M v[156:159], a[156:159], a[164:167], v[156:159]
 s_add_u32 m0, s23, 0
 ds_read_b64_tr_b16 a[80:81], v3 offset:16384
 ds_read_b64_tr_b16 a[82:83], v3 offset:17408
M v[156:159], a[152:155], a[160:163], v[156:159]
 buffer_load_dwordx4 v8, s[16:19], s21 offen offset:0  nt lds
M v[160:163], a[96:99], a[168:171], v[160:163]
 ds_read_b128 a[160:163], v5 offset:53248
 ds_read_b128 a[164:167], v6 offset:53248
M v[160:163], a[100:103], a[172:175], v[160:163]
M v[164:167], a[108:111], a[172:175], v[164:167]
M v[164:167], a[104:107], a[168:171], v[164:167]
M v[168:171], a[112:115], a[168:171], v[168:171]
M v[168:171], a[116:119], a[172:175], v[168:171]
 ds_read_b64_tr_b16 a[84:85], v3 offset:24576
 ds_read_b64_tr_b16 a[86:87], v3 offset:25600
M v[172:175], a[124:127], a[172:175], v[172:175]
 buffer_load_dwordx4 v9, s[16:19], s21 offen offset:1024  nt lds
M v[172:175], a[120:123], a[168:171], v[172:175]
M v[176:179], a[128:131], a[168:171], v[176:179]
M v[176:179], a[132:135], a[172:175], v[176:179]
M v[180:183], a[140:143], a[172:175], v[180:183]
M v[180:183], a[136:139], a[168:171], v[180:183]
M v[184:187], a[144:147], a[168:171], v[184:187]
 ds_read_b64_tr_b16 a[88:89], v4 offset:16384
 ds_read_b64_tr_b16 a[90:91], v4 offset:17408
M v[184:187], a[148:151], a[172:175], v[184:187]
 s_waitcnt lgkmcnt(4)
M v[188:191], a[156:159], a[172:175], v[188:191]
 buffer_load_dwordx4 v10, s[16:19], s21 offen offset:2048  nt lds
M v[188:191], a[152:155], a[168:171], v[188:191]
M v[192:195], a[96:99], a[160:163], v[192:195]
 ds_read_b128 a[168:171], v5 offset:55296
 ds_read_b128 a[172:175], v6 offset:55296
M v[192:195], a[100:103], a[164:167], v[192:195]
M v[196:199], a[108:111], a[164:167], v[196:199]
M v[196:199], a[104:107], a[160:163], v[196:199]
 ds_read_b64_tr_b16 a[92:93], v4 offset:24576
 ds_read_b64_tr_b16 a[94:95], v4 offset:25600
M v[200:203], a[112:115], a[160:163], v[200:203]
 buffer_load_dwordx4 v11, s[16:19], s21 offen offset:3072  nt lds
M v[200:203], a[116:119], a[164:167], v[200:203]
 s_add_u32 s21, s21, 128
M v[204:207], a[124:127], a[164:167], v[204:207]
M v[204:207], a[120:123], a[160:163], v[204:207]
M v[208:211], a[128:131], a[160:163], v[208:211]
M v[208:211], a[132:135], a[164:167], v[208:211]
M v[212:215], a[140:143], a[164:167], v[212:215]
M v[212:215], a[136:139], a[160:163], v[212:215]
M v[216:219], a[144:147], a[160:163], v[216:219]
M v[216:219], a[148:151], a[164:167], v[216:219]
 s_waitcnt lgkmcnt(2)
M v[220:223], a[156:159], a[164:167], v[220:223]
 s_waitcnt vmcnt(17) lgkmcnt(0)
M v[220:223], a[152:155], a[160:163], v[220:223]
 s_barrier
M v[224:227], a[96:99], a[168:171], v[224:227]
 ds_read_b128 a[160:163], v5 offset:0
 ds_read_b128 a[164:167], v6 offset:0
M v[224:227], a[100:103], a[172:175], v[224:227]
 buffer_load_dword a240, v23, s[52:55], 0 offen offset:0
M v[228:231], a[108:111], a[172:175], v[228:231]
 v_add_u32 v23, 16384, v23
M v[228:231], a[104:107], a[168:171], v[228:231]
M v[232:235], a[112:115], a[168:171], v[232:235]
M v[232:235], a[116:119], a[172:175], v[232:235]
M v[236:239], a[124:127], a[172:175], v[236:239]
M v[236:239], a[120:123], a[168:171], v[236:239]
M v[240:243], a[128:131], a[168:171], v[240:243]
M v[240:243], a[132:135], a[172:175], v[240:243]
M v[244:247], a[140:143], a[172:175], v[244:247]
M v[244:247], a[136:139], a[168:171], v[244:247]
M v[248:251], a[144:147], a[168:171], v[248:251]
M v[248:251], a[148:151], a[172:175], v[248:251]
 s_waitcnt lgkmcnt(0)
M v[252:255], a[156:159], a[172:175], v[252:255]
M v[252:255], a[152:155], a[168:171], v[252:255]
M a[0:3], a[32:35], a[160:163], a[0:3]
 ds_read_b128 a[168:171], v5 offset:2048
 ds_read_b128 a[172:175], v6 offset:2048
M a[0:3], a[36:39], a[164:167], a[0:3]
 ds_read_b64_tr_b16 a[96:97], v1 offset:32768
 ds_read_b64_tr_b16 a[98:99], v1 offset:33792
M a[4:7], a[44:47], a[164:167], a[4:7]
 s_add_u32 m0, s24, 49152
 v_accvgpr_read_b32 v27, a241
M a[4:7], a[40:43], a[160:163], a[4:7]
 buffer_load_dwordx4 v12, s[48:51], s22 offen offset:0   lds
M a[8:11], a[48:51], a[160:163], a[8:11]
M a[8:11], a[52:55], a[164:167], a[8:11]
M a[12:15], a[60:63], a[164:167], a[12:15]
 ds_read_b64_tr_b16 a[100:101], v1 offset:40960
 ds_read_b64_tr_b16 a[102:103], v1 offset:41984
M a[12:15], a[56:59], a[160:163], a[12:15]
M a[16:19], a[64:67], a[160:163], a[16:19]
 buffer_load_dwordx4 v13, s[48:51], s22 offen offset:1024   lds
M a[16:19], a[68:71], a[164:167], a[16:19]
M a[20:23], a[76:79], a[164:167], a[20:23]
M a[20:23], a[72:75], a[160:163], a[20:23]
 ds_read_b64_tr_b16 a[104:105], v2 offset:32768
 ds_read_b64_tr_b16 a[106:107], v2 offset:33792
M a[24:27], a[80:83], a[160:163], a[24:27]
M a[24:27], a[84:87], a[164:167], a[24:27]
 s_waitcnt lgkmcnt(6)
M a[28:31], a[92:95], a[164:167], a[28:31]
 buffer_load_dwordx4 v14, s[48:51], s22 offen offset:2048   lds
M a[28:31], a[88:91], a[160:163], a[28:31]
M v[32:35], a[32:35], a[168:171], v[32:35]
 ds_read_b128 a[160:163], v5 offset:4096
 ds_read_b128 a[164:167], v6 offset:4096
M v[32:35], a[36:39], a[172:175], v[32:35]
 ds_read_b64_tr_b16 a[108:109], v2 offset:40960
 ds_read_b64_tr_b16 a[110:111], v2 offset:41984
M v[36:39], a[44:47], a[172:175], v[36:39]
 buffer_load_dwordx4 v15, s[48:51], s22 offen offset:3072   lds
M v[36:39], a[40:43], a[168:171], v[36:39]
 s_sub_u32 s22, s22, 2097024
M v[40:43], a[48:51], a[168:171], v[40:43]
M v[40:43], a[52:55], a[172:175], v[40:43]
 ds_read_b64_tr_b16 a[112:113], v3 offset:32768
 ds_read_b64_tr_b16 a[114:115], v3 offset:33792
M v[44:47], a[60:63], a[172:175], v[44:47]
 s_add_u32 m0, s23, 16384
M v[44:47], a[56:59], a[168:171], v[44:47]
 buffer_load_dwordx4 v8, s[16:19], s21 offen offset:0  nt lds
M v[48:51], a[64:67], a[168:171], v[48:51]
M v[48:51], a[68:71], a[172:175], v[48:51]
M v[52:55], a[76:79], a[172:175], v[52:55]
 ds_read_b64_tr_b16 a[116:117], v3 offset:40960
 ds_read_b64_tr_b16 a[118:119], v3 offset:41984
M v[52:55], a[72:75], a[168:171], v[52:55]
M v[56:59], a[80:83], a[168:171], v[56:59]
 buffer_load_dwordx4 v9, s[16:19], s21 offen offset:1024  nt lds
M v[56:59], a[84:87], a[172:175], v[56:59]
 s_waitcnt lgkmcnt(6)
M v[60:63], a[92:95], a[172:175], v[60:63]
M v[60:63], a[88:91], a[168:171], v[60:63]
 ds_read_b64_tr_b16 a[120:121], v4 offset:32768
 ds_read_b64_tr_b16 a[122:123], v4 offset:33792
M v[64:67], a[32:35], a[160:163], v[64:67]
 ds_read_b128 a[168:171], v5 offset:6144
 ds_read_b128 a[172:175], v6 offset:6144
M v[64:67], a[36:39], a[164:167], v[64:67]
 buffer_load_dwordx4 v10, s[16:19], s21 offen offset:2048  nt lds
M v[68:71], a[44:47], a[164:167], v[68:71]
M v[68:71], a[40:43], a[160:163], v[68:71]
M v[72:75], a[48:51], a[160:163], v[72:75]
 ds_read_b64_tr_b16 a[124:125], v4 offset:40960
 ds_read_b64_tr_b16 a[126:127], v4 offset:41984
M v[72:75], a[52:55], a[164:167], v[72:75]
 v_sub_f32 v48, v48, v27
 v_sub_f32 v49, v49, v27
M v[76:79], a[60:63], a[164:167], v[76:79]
 buffer_load_dwordx4 v11, s[16:19], s21 offen offset:3072  nt lds
M v[76:79], a[56:59], a[160:163], v[76:79]
 s_add_u32 s21, s21, 524160
 v_sub_f32 v50, v50, v27
 v_sub_f32 v51, v51, v27
M v[80:83], a[64:67], a[160:163], v[80:83]
 v_sub_f32 v52, v52, v27
 v_sub_f32 v53, v53, v27
M v[80:83], a[68:71], a[164:167], v[80:83]
 v_sub_f32 v54, v54, v27
 v_sub_f32 v55, v55, v27
M v[84:87], a[76:79], a[164:167], v[84:87]
 v_sub_f32 v56, v56, v27
 v_sub_f32 v57, v57, v27
M v[84:87], a[72:75], a[160:163], v[84:87]
 v_sub_f32 v58, v58, v27
 v_sub_f32 v59, v59, v27
M v[88:91], a[80:83], a[160:163], v[88:91]
 v_sub_f32 v60, v60, v27
 v_sub_f32 v61, v61, v27
M v[88:91], a[84:87], a[164:167], v[88:91]
 s_waitcnt lgkmcnt(2)
 v_sub_f32 v62, v62, v27
 v_sub_f32 v63, v63, v27
M v[92:95], a[92:95], a[164:167], v[92:95]
 s_waitcnt vmcnt(17) lgkmcnt(0)
M v[92:95], a[88:91], a[160:163], v[92:95]
 s_barrier
M v[96:99], a[32:35], a[168:171], v[96:99]
 ds_read_b128 a[160:163], v5 offset:16384
 ds_read_b128 a[164:167], v6 offset:16384
M v[96:99], a[36:39], a[172:175], v[96:99]
M v[100:103], a[44:47], a[172:175], v[100:103]
 s_add_u32 m0, s24, 0
 ds_read_b64_tr_b16 a[128:129], v1 offset:49152
 ds_read_b64_tr_b16 a[130:131], v1 offset:50176
M v[100:103], a[40:43], a[168:171], v[100:103]
 buffer_load_dwordx4 v12, s[48:51], s22 offen offset:0   lds
M v[104:107], a[48:51], a[168:171], v[104:107]
 v_sub_f32 v80, v80, v27
 v_sub_f32 v81, v81, v27
M v[104:107], a[52:55], a[172:175], v[104:107]
 v_sub_f32 v82, v82, v27
 v_sub_f32 v83, v83, v27
M v[108:111], a[60:63], a[172:175], v[108:111]
 v_sub_f32 v84, v84, v27
 v_sub_f32 v85, v85, v27
M v[108:111], a[56:59], a[168:171], v[108:111]
 v_sub_f32 v86, v86, v27
 v_sub_f32 v87, v87, v27
M v[112:115], a[64:67], a[168:171], v[112:115]
 v_sub_f32 v88, v88, v27
 v_sub_f32 v89, v89, v27
M v[112:115], a[68:71], a[172:175], v[112:115]
 ds_read_b64_tr_b16 a[132:133], v1 offset:57344
 ds_read_b64_tr_b16 a[134:135], v1 offset:58368
M v[116:119], a[76:79], a[172:175], v[116:119]
 buffer_load_dwordx4 v13, s[48:51], s22 offen offset:1024   lds
M v[116:119], a[72:75], a[168:171], v[116:119]
 v_sub_f32 v90, v90, v27
 v_sub_f32 v91, v91, v27
M v[120:123], a[80:83], a[168:171], v[120:123]
 v_sub_f32 v92, v92, v27
 v_sub_f32 v93, v93, v27
M v[120:123], a[84:87], a[172:175], v[120:123]
 s_waitcnt lgkmcnt(4)
 v_sub_f32 v94, v94, v27
 v_sub_f32 v95, v95, v27
M v[124:127], a[92:95], a[172:175], v[124:127]
M v[124:127], a[88:91], a[168:171], v[124:127]
M v[128:131], a[32:35], a[160:163], v[128:131]
 ds_read_b128 a[168:171], v5 offset:18432
 ds_read_b128 a[172:175], v6 offset:18432
M v[128:131], a[36:39], a[164:167], v[128:131]
 ds_read_b64_tr_b16 a[136:137], v2 offset:49152
 ds_read_b64_tr_b16 a[138:139], v2 offset:50176
M v[132:135], a[44:47], a[164:167], v[132:135]
 buffer_load_dwordx4 v14, s[48:51], s22 offen offset:2048   lds
M v[132:135], a[40:43], a[160:163], v[132:135]
M v[136:139], a[48:51], a[160:163], v[136:139]
 v_sub_f32 v112, v112, v27
 v_sub_f32 v113, v113, v27
M v[136:139], a[52:55], a[164:167], v[136:139]
 v_sub_f32 v114, v114, v27
 v_sub_f32 v115, v115, v27
M v[140:143], a[60:63], a[164:167], v[140:143]
 v_sub_f32 v116, v116, v27
 v_sub_f32 v117, v117, v27
M v[140:143], a[56:59], a[160:163], v[140:143]
 ds_read_b64_tr_b16 a[140:141], v2 offset:57344
 ds_read_b64_tr_b16 a[142:143], v2 offset:58368
M v[144:147], a[64:67], a[160:163], v[144:147]
 buffer_load_dwordx4 v15, s[48:51], s22 offen offset:3072   lds
M v[144:147], a[68:71], a[164:167], v[144:147]
 s_add_u32 s22, s22, 2097152
 v_sub_f32 v118, v118, v27
 v_sub_f32 v119, v119, v27
M v[148:151], a[76:79], a[164:167], v[148:151]
 v_sub_f32 v120, v120, v27
 v_sub_f32 v121, v121, v27
M v[148:151], a[72:75], a[160:163], v[148:151]
 v_sub_f32 v122, v122, v27
 v_sub_f32 v123, v123, v27
M v[152:155], a[80:83], a[160:163], v[152:155]
 v_sub_f32 v124, v124, v27
 v_sub_f32 v125, v125, v27
M v[152:155], a[84:87], a[164:167], v[152:155]
 s_waitcnt lgkmcnt(4)
 v_sub_f32 v126, v126, v27
 v_sub_f32 v127, v127, v27
M v[156:159], a[92:95], a[164:167], v[156:159]
 s_add_u32 m0, s23, 32768
 ds_read_b64_tr_b16 a[144:145], v3 offset:49152
 ds_read_b64_tr_b16 a[146:147], v3 offset:50176
M v[156:159], a[88:91], a[160:163], v[156:159]
 buffer_load_dwordx4 v8, s[16:19], s21 offen offset:0  nt lds
M v[160:163], a[32:35], a[168:171], v[160:163]
 ds_read_b128 a[160:163], v5 offset:20480
 ds_read_b128 a[164:167], v6 offset:20480
M v[160:163], a[36:39], a[172:175], v[160:163]
M v[164:167], a[44:47], a[172:175], v[164:167]
M v[164:167], a[40:43], a[168:171], v[164:167]
M v[168:171], a[48:51], a[168:171], v[168:171]
 v_sub_f32 v128, v128, v27
 v_sub_f32 v129, v129, v27
M v[168:171], a[52:55], a[172:175], v[168:171]
 ds_read_b64_tr_b16 a[148:149], v3 offset:57344
 ds_read_b64_tr_b16 a[150:151], v3 offset:58368
M v[172:175], a[60:63], a[172:175], v[172:175]
 buffer_load_dwordx4 v9, s[16:19], s21 offen offset:1024  nt lds
M v[172:175], a[56:59], a[168:171], v[172:175]
 v_sub_f32 v130, v130, v27
 v_sub_f32 v131, v131, v27
M v[176:179], a[64:67], a[168:171], v[176:179]
 v_sub_f32 v132, v132, v27
 v_sub_f32 v133, v133, v27
M v[176:179], a[68:71], a[172:175], v[176:179]
 v_sub_f32 v134, v134, v27
 v_sub_f32 v135, v135, v27
M v[180:183], a[76:79], a[172:175], v[180:183]
 v_sub_f32 v136, v136, v27
 v_sub_f32 v137, v137, v27
M v[180:183], a[72:75], a[168:171], v[180:183]
 v_sub_f32 v138, v138, v27
 v_sub_f32 v139, v139, v27
M v[184:187], a[80:83], a[168:171], v[184:187]
 ds_read_b64_tr_b16 a[152:153], v4 offset:49152
 ds_read_b64_tr_b16 a[154:155], v4 offset:50176
M v[184:187], a[84:87], a[172:175], v[184:187]
 s_waitcnt lgkmcnt(4)
 v_sub_f32 v140, v140, v27
 v_sub_f32 v141, v141, v27
M v[188:191], a[92:95], a[172:175], v[188:191]
 buffer_load_dwordx4 v10, s[16:19], s21 offen offset:2048  nt lds
M v[188:191], a[88:91], a[168:171], v[188:191]
 v_sub_f32 v142, v142, v27
 v_sub_f32 v143, v143, v27
M v[192:195], a[32:35], a[160:163], v[192:195]
 ds_read_b128 a[168:171], v5 offset:22528
 ds_read_b128 a[172:175], v6 offset:22528
M v[192:195], a[36:39], a[164:167], v[192:195]
 v_sub_f32 v144, v144, v27
 v_sub_f32 v145, v145, v27
M v[196:199], a[44:47], a[164:167], v[196:199]
 v_sub_f32 v146, v146, v27
 v_sub_f32 v147, v147, v27
M v[196:199], a[40:43], a[160:163], v[196:199]
 ds_read_b64_tr_b16 a[156:157], v4 offset:57344
 ds_read_b64_tr_b16 a[158:159], v4 offset:58368
M v[200:203], a[48:51], a[160:163], v[200:203]
 buffer_load_dwordx4 v11, s[16:19], s21 offen offset:3072  nt lds
M v[200:203], a[52:55], a[164:167], v[200:203]
 s_add_u32 s21, s21, 128
 v_sub_f32 v148, v148, v27
 v_sub_f32 v149, v149, v27
M v[204:207], a[60:63], a[164:167], v[204:207]
 v_sub_f32 v150, v150, v27
 v_sub_f32 v151, v151, v27
M v[204:207], a[56:59], a[160:163], v[204:207]
 v_sub_f32 v152, v152, v27
 v_sub_f32 v153, v153, v27
M v[208:211], a[64:67], a[160:163], v[208:211]
 v_sub_f32 v154, v154, v27
 v_sub_f32 v155, v155, v27
M v[208:211], a[68:71], a[164:167], v[208:211]
 v_sub_f32 v156, v156, v27
 v_sub_f32 v157, v157, v27
M v[212:215], a[76:79], a[164:167], v[212:215]
 v_sub_f32 v158, v158, v27
 v_sub_f32 v159, v159, v27
M v[212:215], a[72:75], a[160:163], v[212:215]
M v[216:219], a[80:83], a[160:163], v[216:219]
M v[216:219], a[84:87], a[164:167], v[216:219]
 s_waitcnt lgkmcnt(2)
M v[220:223], a[92:95], a[164:167], v[220:223]
 s_waitcnt vmcnt(17) lgkmcnt(0)
M v[220:223], a[88:91], a[160:163], v[220:223]
 s_barrier
M v[224:227], a[32:35], a[168:171], v[224:227]
 ds_read_b128 a[160:163], v5 offset:32768
 ds_read_b128 a[164:167], v6 offset:32768
M v[224:227], a[36:39], a[172:175], v[224:227]
 buffer_load_dword a240, v23, s[52:55], 0 offen offset:0
M v[228:231], a[44:47], a[172:175], v[228:231]
 v_add_u32 v23, 16384, v23
M v[228:231], a[40:43], a[168:171], v[228:231]
M v[232:235], a[48:51], a[168:171], v[232:235]
M v[232:235], a[52:55], a[172:175], v[232:235]
M v[236:239], a[60:63], a[172:175], v[236:239]
M v[236:239], a[56:59], a[168:171], v[236:239]
M v[240:243], a[64:67], a[168:171], v[240:243]
M v[240:243], a[68:71], a[172:175], v[240:243]
M v[244:247], a[76:79], a[172:175], v[244:247]
M v[244:247], a[72:75], a[168:171], v[244:247]
M v[248:251], a[80:83], a[168:171], v[248:251]
M v[248:251], a[84:87], a[172:175], v[248:251]
 s_waitcnt lgkmcnt(0)
M v[252:255], a[92:95], a[172:175], v[252:255]
M v[252:255], a[88:91], a[168:171], v[252:255]
M a[0:3], a[96:99], a[160:163], a[0:3]
 ds_read_b128 a[168:171], v5 offset:34816
 ds_read_b128 a[172:175], v6 offset:34816
M a[0:3], a[100:103], a[164:167], a[0:3]
 ds_read_b64_tr_b16 a[32:33], v1 offset:0
 ds_read_b64_tr_b16 a[34:35], v1 offset:1024
M a[4:7], a[108:111], a[164:167], a[4:7]
 s_add_u32 m0, s24, 16384
M a[4:7], a[104:107], a[160:163], a[4:7]
 buffer_load_dwordx4 v12, s[48:51], s22 offen offset:0   lds
M a[8:11], a[112:115], a[160:163], a[8:11]
M a[8:11], a[116:119], a[164:167], a[8:11]
M a[12:15], a[124:127], a[164:167], a[12:15]
 ds_read_b64_tr_b16 a[36:37], v1 offset:8192
 ds_read_b64_tr_b16 a[38:39], v1 offset:9216
M a[12:15], a[120:123], a[160:163], a[12:15]
M a[16:19], a[128:131], a[160:163], a[16:19]
 buffer_load_dwordx4 v13, s[48:51], s22 offen offset:1024   lds
M a[16:19], a[132:135], a[164:167], a[16:19]
M a[20:23], a[140:143], a[164:167], a[20:23]
M a[20:23], a[136:139], a[160:163], a[20:23]
 ds_read_b64_tr_b16 a[40:41], v2 offset:0
 ds_read_b64_tr_b16 a[42:43], v2 offset:1024
M a[24:27], a[144:147], a[160:163], a[24:27]
M a[24:27], a[148:151], a[164:167], a[24:27]
 s_waitcnt lgkmcnt(6)
M a[28:31], a[156:159], a[164:167], a[28:31]
 buffer_load_dwordx4 v14, s[48:51], s22 offen offset:2048   lds
M a[28:31], a[152:155], a[160:163], a[28:31]
M v[32:35], a[96:99], a[168:171], v[32:35]
 ds_read_b128 a[160:163], v5 offset:36864
 ds_read_b128 a[164:167], v6 offset:36864
M v[32:35], a[100:103], a[172:175], v[32:35]
 ds_read_b64_tr_b16 a[44:45], v2 offset:8192
 ds_read_b64_tr_b16 a[46:47], v2 offset:9216
M v[36:39], a[108:111], a[172:175], v[36:39]
 buffer_load_dwordx4 v15, s[48:51], s22 offen offset:3072   lds
M v[36:39], a[104:107], a[168:171], v[36:39]
 s_sub_u32 s22, s22, 2097024
M v[40:43], a[112:115], a[168:171], v[40:43]
M v[40:43], a[116:119], a[172:175], v[40:43]
 ds_read_b64_tr_b16 a[48:49], v3 offset:0
 ds_read_b64_tr_b16 a[50:51], v3 offset:1024
M v[44:47], a[124:127], a[172:175], v[44:47]
 s_add_u32 m0, s23, 49152
M v[44:47], a[120:123], a[168:171], v[44:47]
 buffer_load_dwordx4 v8, s[16:19], s21 offen offset:0  nt lds
M v[48:51], a[128:131], a[168:171], v[48:51]
M v[48:51], a[132:135], a[172:175], v[48:51]
M v[52:55], a[140:143], a[172:175], v[52:55]
 ds_read_b64_tr_b16 a[52:53], v3 offset:8192
 ds_read_b64_tr_b16 a[54:55], v3 offset:9216
M v[52:55], a[136:139], a[168:171], v[52:55]
M v[56:59], a[144:147], a[168:171], v[56:59]
 buffer_load_dwordx4 v9, s[16:19], s21 offen offset:1024  nt lds
M v[56:59], a[148:151], a[172:175], v[56:59]
 s_waitcnt lgkmcnt(6)
M v[60:63], a[156:159], a[172:175], v[60:63]
M v[60:63], a[152:155], a[168:171], v[60:63]
 ds_read_b64_tr_b16 a[56:57], v4 offset:0
 ds_read_b64_tr_b16 a[58:59], v4 offset:1024
M v[64:67], a[96:99], a[160:163], v[64:67]
 ds_read_b128 a[168:171], v5 offset:38912
 ds_read_b128 a[172:175], v6 offset:38912
M v[64:67], a[100:103], a[164:167], v[64:67]
 buffer_load_dwordx4 v10, s[16:19], s21 offen offset:2048  nt lds
M v[68:71], a[108:111], a[164:167], v[68:71]
M v[68:71], a[104:107], a[160:163], v[68:71]
M v[72:75], a[112:115], a[160:163], v[72:75]
 ds_read_b64_tr_b16 a[60:61], v4 offset:8192
 ds_read_b64_tr_b16 a[62:63], v4 offset:9216
M v[72:75], a[116:119], a[164:167], v[72:75]
M v[76:79], a[124:127], a[164:167], v[76:79]
 buffer_load_dwordx4 v11, s[16:19], s21 offen offset:3072  nt lds
M v[76:79], a[120:123], a[160:163], v[76:79]
 s_add_u32 s21, s21, 524160
M v[80:83], a[128:131], a[160:163], v[80:83]
M v[80:83], a[132:135], a[164:167], v[80:83]
M v[84:87], a[140:143], a[164:167], v[84:87]
M v[84:87], a[136:139], a[160:163], v[84:87]
M v[88:91], a[144:147], a[160:163], v[88:91]
M v[88:91], a[148:151], a[164:167], v[88:91]
 s_waitcnt lgkmcnt(2)
M v[92:95], a[156:159], a[164:167], v[92:95]
 s_waitcnt vmcnt(17) lgkmcnt(0)
M v[92:95], a[152:155], a[160:163], v[92:95]
 s_barrier
M v[96:99], a[96:99], a[168:171], v[96:99]
 ds_read_b128 a[160:163], v5 offset:49152
 ds_read_b128 a[164:167], v6 offset:49152
M v[96:99], a[100:103], a[172:175], v[96:99]
M v[100:103], a[108:111], a[172:175], v[100:103]
 s_add_u32 m0, s24, 32768
 ds_read_b64_tr_b16 a[64:65], v1 offset:16384
 ds_read_b64_tr_b16 a[66:67], v1 offset:17408
M v[100:103], a[104:107], a[168:171], v[100:103]
 buffer_load_dwordx4 v12, s[48:51], s22 offen offset:0   lds
M v[104:107], a[112:115], a[168:171], v[104:107]
M v[104:107], a[116:119], a[172:175], v[104:107]
M v[108:111], a[124:127], a[172:175], v[108:111]
M v[108:111], a[120:123], a[168:171], v[108:111]
M v[112:115], a[128:131], a[168:171], v[112:115]
M v[112:115], a[132:135], a[172:175], v[112:115]
 ds_read_b64_tr_b16 a[68:69], v1 offset:24576
 ds_read_b64_tr_b16 a[70:71], v1 offset:25600
M v[116:119], a[140:143], a[172:175], v[116:119]
 buffer_load_dwordx4 v13, s[48:51], s22 offen offset:1024   lds
M v[116:119], a[136:139], a[168:171], v[116:119]
M v[120:123], a[144:147], a[168:171], v[120:123]
M v[120:123], a[148:151], a[172:175], v[120:123]
 s_waitcnt lgkmcnt(4)
M v[124:127], a[156:159], a[172:175], v[124:127]
M v[124:127], a[152:155], a[168:171], v[124:127]
M v[128:131], a[96:99], a[160:163], v[128:131]
 ds_read_b128 a[168:171], v5 offset:51200
 ds_read_b128 a[172:175], v6 offset:51200
M v[128:131], a[100:103], a[164:167], v[128:131]
 ds_read_b64_tr_b16 a[72:73], v2 offset:16384
 ds_read_b64_tr_b16 a[74:75], v2 offset:17408
M v[132:135], a[108:111], a[164:167], v[132:135]
 buffer_load_dwordx4 v14, s[48:51], s22 offen offset:2048   lds
M v[132:135], a[104:107], a[160:163], v[132:135]
M v[136:139], a[112:115], a[160:163], v[136:139]
M v[136:139], a[116:119], a[164:167], v[136:139]
M v[140:143], a[124:127], a[164:167], v[140:143]
M v[140:143], a[120:123], a[160:163], v[140:143]
 ds_read_b64_tr_b16 a[76:77], v2 offset:24576
 ds_read_b64_tr_b16 a[78:79], v2 offset:25600
M v[144:147], a[128:131], a[160:163], v[144:147]
 buffer_load_dwordx4 v15, s[48:51], s22 offen offset:3072   lds
M v[144:147], a[132:135], a[164:167], v[144:147]
 s_add_u32 s22, s22, 2097152
M v[148:151], a[140:143], a[164:167], v[148:151]
M v[148:151], a[136:139], a[160:163], v[148:151]
M v[152:155], a[144:147], a[160:163], v[152:155]
M v[152:155], a[148:151], a[164:167], v[152:155]
 s_waitcnt lgkmcnt(4)
M v[156:159], a[156:159], a[164:167], v[156:159]
 s_add_u32 m0, s23, 0
 ds_read_b64_tr_b16 a[80:81], v3 offset:16384
 ds_read_b64_tr_b16 a[82:83], v3 offset:17408
M v[156:159], a[152:155], a[160:163], v[156:159]
 buffer_load_dwordx4 v8, s[52:55], s28 offen offset:0   lds
M v[160:163], a[96:99], a[168:171], v[160:163]
 ds_read_b128 a[160:163], v5 offset:53248
 ds_read_b128 a[164:167], v6 offset:53248
M v[160:163], a[100:103], a[172:175], v[160:163]
M v[164:167], a[108:111], a[172:175], v[164:167]
M v[164:167], a[104:107], a[168:171], v[164:167]
M v[168:171], a[112:115], a[168:171], v[168:171]
M v[168:171], a[116:119], a[172:175], v[168:171]
 ds_read_b64_tr_b16 a[84:85], v3 offset:24576
 ds_read_b64_tr_b16 a[86:87], v3 offset:25600
M v[172:175], a[124:127], a[172:175], v[172:175]
 buffer_load_dwordx4 v9, s[52:55], s28 offen offset:1024   lds
M v[172:175], a[120:123], a[168:171], v[172:175]
M v[176:179], a[128:131], a[168:171], v[176:179]
M v[176:179], a[132:135], a[172:175], v[176:179]
M v[180:183], a[140:143], a[172:175], v[180:183]
M v[180:183], a[136:139], a[168:171], v[180:183]
M v[184:187], a[144:147], a[168:171], v[184:187]
 ds_read_b64_tr_b16 a[88:89], v4 offset:16384
 ds_read_b64_tr_b16 a[90:91], v4 offset:17408
M v[184:187], a[148:151], a[172:175], v[184:187]
 s_waitcnt lgkmcnt(4)
M v[188:191], a[156:159], a[172:175], v[188:191]
 buffer_load_dwordx4 v10, s[52:55], s28 offen offset:2048   lds
M v[188:191], a[152:155], a[168:171], v[188:191]
M v[192:195], a[96:99], a[160:163], v[192:195]
 ds_read_b128 a[168:171], v5 offset:55296
 ds_read_b128 a[172:175], v6 offset:55296
M v[192:195], a[100:103], a[164:167], v[192:195]
M v[196:199], a[108:111], a[164:167], v[196:199]
M v[196:199], a[104:107], a[160:163], v[196:199]
 ds_read_b64_tr_b16 a[92:93], v4 offset:24576
 ds_read_b64_tr_b16 a[94:95], v4 offset:25600
M v[200:203], a[112:115], a[160:163], v[200:203]
 buffer_load_dwordx4 v11, s[52:55], s28 offen offset:3072   lds
M v[200:203], a[116:119], a[164:167], v[200:203]
 s_add_u32 s28, s28, 128
 v_sub_f32 v160, v160, v27
 v_sub_f32 v161, v161, v27
M v[204:207], a[124:127], a[164:167], v[204:207]
 v_sub_f32 v162, v162, v27
 v_sub_f32 v163, v163, v27
M v[204:207], a[120:123], a[160:163], v[204:207]
 v_sub_f32 v164, v164, v27
 v_sub_f32 v165, v165, v27
M v[208:211], a[128:131], a[160:163], v[208:211]
 v_sub_f32 v166, v166, v27
 v_sub_f32 v167, v167, v27
M v[208:211], a[132:135], a[164:167], v[208:211]
 v_sub_f32 v168, v168, v27
 v_sub_f32 v169, v169, v27
M v[212:215], a[140:143], a[164:167], v[212:215]
 v_sub_f32 v170, v170, v27
 v_sub_f32 v171, v171, v27
M v[212:215], a[136:139], a[160:163], v[212:215]
 v_sub_f32 v172, v172, v27
 v_sub_f32 v173, v173, v27
M v[216:219], a[144:147], a[160:163], v[216:219]
 v_sub_f32 v174, v174, v27
 v_sub_f32 v175, v175, v27
M v[216:219], a[148:151], a[164:167], v[216:219]
 s_waitcnt lgkmcnt(2)
 v_sub_f32 v176, v176, v27
 v_sub_f32 v177, v177, v27
M v[220:223], a[156:159], a[164:167], v[220:223]
 s_waitcnt vmcnt(17) lgkmcnt(0)
 v_sub_f32 v178, v178, v27
 v_sub_f32 v179, v179, v27
M v[220:223], a[152:155], a[160:163], v[220:223]
 s_barrier
M v[224:227], a[96:99], a[168:171], v[224:227]
 ds_read_b128 a[160:163], v5 offset:0
 ds_read_b128 a[164:167], v6 offset:0
M v[224:227], a[100:103], a[172:175], v[224:227]
 v_and_b32 v26, 48, v0
 v_lshlrev_b32 v26, 17, v26
M v[228:231], a[108:111], a[172:175], v[228:231]
 v_or_b32 v26, v26, v0
 v_lshl_add_u32 v26, v26, 7, s95
M v[228:231], a[104:107], a[168:171], v[228:231]
 buffer_load_dword a240, v26, s[76:79], 0 offen offset:0
M v[232:235], a[112:115], a[168:171], v[232:235]
 v_sub_f32 v180, v180, v27
 v_sub_f32 v181, v181, v27
M v[232:235], a[116:119], a[172:175], v[232:235]
 v_sub_f32 v182, v182, v27
 v_sub_f32 v183, v183, v27
M v[236:239], a[124:127], a[172:175], v[236:239]
 v_sub_f32 v184, v184, v27
 v_sub_f32 v185, v185, v27
M v[236:239], a[120:123], a[168:171], v[236:239]
 v_sub_f32 v186, v186, v27
 v_sub_f32 v187, v187, v27
M v[240:243], a[128:131], a[168:171], v[240:243]
 v_sub_f32 v188, v188, v27
 v_sub_f32 v189, v189, v27
M v[240:243], a[132:135], a[172:175], v[240:243]
 v_sub_f32 v190, v190, v27
 v_sub_f32 v191, v191, v27
M v[244:247], a[140:143], a[172:175], v[244:247]
 v_sub_f32 v192, v192, v27
 v_sub_f32 v193, v193, v27
M v[244:247], a[136:139], a[168:171], v[244:247]
 v_sub_f32 v194, v194, v27
 v_sub_f32 v195, v195, v27
M v[248:251], a[144:147], a[168:171], v[248:251]
 v_sub_f32 v196, v196, v27
 v_sub_f32 v197, v197, v27
M v[248:251], a[148:151], a[172:175], v[248:251]
 s_waitcnt lgkmcnt(0)
 v_sub_f32 v198, v198, v27
 v_sub_f32 v199, v199, v27
M v[252:255], a[156:159], a[172:175], v[252:255]
 v_sub_f32 v200, v200, v27
 v_sub_f32 v201, v201, v27
M v[252:255], a[152:155], a[168:171], v[252:255]
 v_sub_f32 v202, v202, v27
 v_sub_f32 v203, v203, v27
M a[0:3], a[32:35], a[160:163], a[0:3]
 ds_read_b128 a[168:171], v5 offset:2048
 ds_read_b128 a[172:175], v6 offset:2048
M a[0:3], a[36:39], a[164:167], a[0:3]
 ds_read_b64_tr_b16 a[96:97], v1 offset:32768
 ds_read_b64_tr_b16 a[98:99], v1 offset:33792
M a[4:7], a[44:47], a[164:167], a[4:7]
 s_add_u32 m0, s24, 49152
 v_lshrrev_b32 v28, 4, v0
 v_add_u32 v28, 0, v28
M a[4:7], a[40:43], a[160:163], a[4:7]
 buffer_load_dwordx4 v12, s[48:51], s22 offen offset:0   lds
M a[8:11], a[48:51], a[160:163], a[8:11]
 v_and_b32 v29, 7, v0
 v_xor_b32 v28, v28, v29
M a[8:11], a[52:55], a[164:167], a[8:11]
 v_lshlrev_b32 v28, 4, v28
 v_lshrrev_b32 v29, 3, v0
M a[12:15], a[60:63], a[164:167], a[12:15]
 ds_read_b64_tr_b16 a[100:101], v1 offset:40960
 ds_read_b64_tr_b16 a[102:103], v1 offset:41984
M a[12:15], a[56:59], a[160:163], a[12:15]
 buffer_load_dwordx4 v13, s[48:51], s22 offen offset:1024   lds
M a[16:19], a[64:67], a[160:163], a[16:19]
 v_mul_u32_u24 v29, 896, v29
 s_mul_i32 s64, s20, 28672
M a[16:19], a[68:71], a[164:167], a[16:19]
 buffer_load_dwordx4 v14, s[48:51], s22 offen offset:2048   lds
M a[20:23], a[76:79], a[164:167], a[20:23]
 s_add_u32 s64, s64, 0
 v_add3_u32 v16, v29, v28, s64
M a[20:23], a[72:75], a[160:163], a[20:23]
 ds_read_b64_tr_b16 a[104:105], v2 offset:32768
 ds_read_b64_tr_b16 a[106:107], v2 offset:33792
M a[24:27], a[80:83], a[160:163], a[24:27]
 v_add_u32 v18, 12288, v16
 v_lshrrev_b32 v28, 4, v0
M a[24:27], a[84:87], a[164:167], a[24:27]
 s_waitcnt lgkmcnt(6)
 v_add_u32 v28, 4, v28
 v_and_b32 v29, 7, v0
M a[28:31], a[92:95], a[164:167], a[28:31]
 buffer_load_dwordx4 v15, s[48:51], s22 offen offset:3072   lds
M a[28:31], a[88:91], a[160:163], a[28:31]
 s_sub_u32 s22, s22, 2097024
 v_xor_b32 v28, v28, v29
 v_lshlrev_b32 v28, 4, v28
M v[32:35], a[32:35], a[168:171], v[32:35]
 s_add_u32 m0, s23, 16384
 ds_read_b128 a[160:163], v5 offset:4096
 ds_read_b128 a[164:167], v6 offset:4096
M v[32:35], a[36:39], a[172:175], v[32:35]
 ds_read_b64_tr_b16 a[108:109], v2 offset:40960
 ds_read_b64_tr_b16 a[110:111], v2 offset:41984
M v[36:39], a[44:47], a[172:175], v[36:39]
 buffer_load_dwordx4 v8, s[52:55], s28 offen offset:0   lds
M v[36:39], a[40:43], a[168:171], v[36:39]
 v_lshrrev_b32 v29, 3, v0
 v_mul_u32_u24 v29, 896, v29
M v[40:43], a[48:51], a[168:171], v[40:43]
 buffer_load_dwordx4 v9, s[52:55], s28 offen offset:1024   lds
M v[40:43], a[52:55], a[172:175], v[40:43]
 ds_read_b64_tr_b16 a[112:113], v3 offset:32768
 ds_read_b64_tr_b16 a[114:115], v3 offset:33792
M v[44:47], a[60:63], a[172:175], v[44:47]
 s_mul_i32 s64, s20, 28672
 s_add_u32 s64, s64, 6144
M v[44:47], a[56:59], a[168:171], v[44:47]
 buffer_load_dwordx4 v10, s[52:55], s28 offen offset:2048   lds
M v[48:51], a[64:67], a[168:171], v[48:51]
 v_add3_u32 v17, v29, v28, s64
 v_add_u32 v19, 12288, v17
M v[48:51], a[68:71], a[172:175], v[48:51]
 v_add_u32 v20, 0x20000, v1
 v_add_u32 v21, 0x20000, v2
M v[52:55], a[76:79], a[172:175], v[52:55]
 ds_read_b64_tr_b16 a[116:117], v3 offset:40960
 ds_read_b64_tr_b16 a[118:119], v3 offset:41984
M v[52:55], a[72:75], a[168:171], v[52:55]
 buffer_load_dwordx4 v11, s[52:55], s28 offen offset:3072   lds
M v[56:59], a[80:83], a[168:171], v[56:59]
 s_add_u32 s28, s28, 1048448
 v_add_u32 v22, 0x20000, v3
 v_add_u32 v23, 0x20000, v4
M v[56:59], a[84:87], a[172:175], v[56:59]
 s_waitcnt lgkmcnt(6)
 v_sub_f32 v204, v204, v27
 v_sub_f32 v205, v205, v27
M v[60:63], a[92:95], a[172:175], v[60:63]
 s_add_u32 m0, s23, 131072
 v_sub_f32 v206, v206, v27
 v_sub_f32 v207, v207, v27
M v[60:63], a[88:91], a[168:171], v[60:63]
 ds_read_b64_tr_b16 a[120:121], v4 offset:32768
 ds_read_b64_tr_b16 a[122:123], v4 offset:33792
M v[64:67], a[32:35], a[160:163], v[64:67]
 ds_read_b128 a[168:171], v5 offset:6144
 ds_read_b128 a[172:175], v6 offset:6144
M v[64:67], a[36:39], a[164:167], v[64:67]
 buffer_load_dwordx4 v8, s[52:55], s28 offen offset:0   lds
M v[68:71], a[44:47], a[164:167], v[68:71]
 buffer_load_dwordx4 v9, s[52:55], s28 offen offset:1024   lds
M v[68:71], a[40:43], a[160:163], v[68:71]
 v_sub_f32 v208, v208, v27
 v_sub_f32 v209, v209, v27
M v[72:75], a[48:51], a[160:163], v[72:75]
 ds_read_b64_tr_b16 a[124:125], v4 offset:40960
 ds_read_b64_tr_b16 a[126:127], v4 offset:41984
M v[72:75], a[52:55], a[164:167], v[72:75]
 buffer_load_dwordx4 v10, s[52:55], s28 offen offset:2048   lds
M v[76:79], a[60:63], a[164:167], v[76:79]
 v_sub_f32 v210, v210, v27
 v_sub_f32 v211, v211, v27
M v[76:79], a[56:59], a[160:163], v[76:79]
 v_sub_f32 v212, v212, v27
 v_sub_f32 v213, v213, v27
M v[80:83], a[64:67], a[160:163], v[80:83]
 buffer_load_dwordx4 v11, s[52:55], s28 offen offset:3072   lds
M v[80:83], a[68:71], a[164:167], v[80:83]
 s_sub_u32 s28, s28, 524288
 v_sub_f32 v214, v214, v27
 v_sub_f32 v215, v215, v27
M v[84:87], a[76:79], a[164:167], v[84:87]
 v_sub_f32 v216, v216, v27
 v_sub_f32 v217, v217, v27
M v[84:87], a[72:75], a[160:163], v[84:87]
 v_sub_f32 v218, v218, v27
 v_sub_f32 v219, v219, v27
M v[88:91], a[80:83], a[160:163], v[88:91]
 v_sub_f32 v220, v220, v27
 v_sub_f32 v221, v221, v27
M v[88:91], a[84:87], a[164:167], v[88:91]
 s_waitcnt lgkmcnt(2)
 v_sub_f32 v222, v222, v27
 v_sub_f32 v223, v223, v27
M v[92:95], a[92:95], a[164:167], v[92:95]
 s_waitcnt vmcnt(21) lgkmcnt(0)
 v_sub_f32 v224, v224, v27
 v_sub_f32 v225, v225, v27
M v[92:95], a[88:91], a[160:163], v[92:95]
 s_barrier
M v[96:99], a[32:35], a[168:171], v[96:99]
 ds_read_b128 a[160:163], v5 offset:16384
 ds_read_b128 a[164:167], v6 offset:16384
M v[96:99], a[36:39], a[172:175], v[96:99]
 v_sub_f32 v226, v226, v27
 v_sub_f32 v227, v227, v27
M v[100:103], a[44:47], a[172:175], v[100:103]
 s_add_u32 m0, s24, 0
 ds_read_b64_tr_b16 a[128:129], v1 offset:49152
 ds_read_b64_tr_b16 a[130:131], v1 offset:50176
M v[100:103], a[40:43], a[168:171], v[100:103]
 buffer_load_dwordx4 v16, s[56:59], s29 offen offset:0   lds
M v[104:107], a[48:51], a[168:171], v[104:107]
 s_mul_i32 s72, s41, 4352
 v_sub_f32 v228, v228, v27
M v[104:107], a[52:55], a[172:175], v[104:107]
 s_add_u32 s46, s72, 104923136
 v_sub_f32 v229, v229, v27
 v_sub_f32 v230, v230, v27
M v[108:111], a[60:63], a[172:175], v[108:111]
 s_lshl_b32 s45, s42, 7
 s_add_u32 s45, s45, s46
 s_sub_u32 s66, 15, s42
M v[108:111], a[56:59], a[168:171], v[108:111]
 buffer_load_dwordx4 v17, s[56:59], s29 offen offset:1024   lds
M v[112:115], a[64:67], a[168:171], v[112:115]
 s_min_u32 s66, s66, s42
 v_sub_f32 v231, v231, v27
M v[112:115], a[68:71], a[172:175], v[112:115]
 s_lshl_b32 s47, s66, 7
 ds_read_b64_tr_b16 a[132:133], v1 offset:57344
 ds_read_b64_tr_b16 a[134:135], v1 offset:58368
M v[116:119], a[76:79], a[172:175], v[116:119]
 s_add_u32 s47, s47, s46
 v_sub_f32 v232, v232, v27
 v_sub_f32 v233, v233, v27
M v[116:119], a[72:75], a[168:171], v[116:119]
 s_add_u32 s47, s47, 2048
 s_lshl_b32 s65, s41, 3
 s_add_u32 s65, s65, s66
M v[120:123], a[80:83], a[168:171], v[120:123]
 buffer_load_dwordx4 v18, s[56:59], s29 offen offset:2048   lds
M v[120:123], a[84:87], a[172:175], v[120:123]
 s_waitcnt lgkmcnt(4)
 s_mul_i32 s34, s65, 73728
 v_sub_f32 v234, v234, v27
M v[124:127], a[92:95], a[172:175], v[124:127]
 s_add_u32 s34, s34, 50331648
 v_sub_f32 v235, v235, v27
 v_sub_f32 v236, v236, v27
M v[124:127], a[88:91], a[168:171], v[124:127]
 s_lshl_b32 s65, s42, 4
 v_sub_f32 v237, v237, v27
 v_sub_f32 v238, v238, v27
M v[128:131], a[32:35], a[160:163], v[128:131]
 s_add_u32 s65, s65, s41
 ds_read_b128 a[168:171], v5 offset:18432
 ds_read_b128 a[172:175], v6 offset:18432
M v[128:131], a[36:39], a[164:167], v[128:131]
 s_mul_i32 s33, s65, 114688
 ds_read_b64_tr_b16 a[136:137], v2 offset:49152
 ds_read_b64_tr_b16 a[138:139], v2 offset:50176
M v[132:135], a[44:47], a[164:167], v[132:135]
 buffer_load_dwordx4 v19, s[56:59], s29 offen offset:3072   lds
M v[132:135], a[40:43], a[160:163], v[132:135]
 s_add_u32 s29, s29, 128
 s_mul_i32 s65, s20, 28672
 v_sub_f32 v239, v239, v27
M v[136:139], a[48:51], a[160:163], v[136:139]
 s_add_u32 s33, s33, s65
 s_add_u32 s33, s33, 67108864
 s_sub_u32 s65, 15, s66
M v[136:139], a[52:55], a[164:167], v[136:139]
 s_add_u32 m0, s23, 32768
 s_lshl_b32 s65, s65, 16
 s_lshl_b32 s64, s41, 20
M v[140:143], a[60:63], a[164:167], v[140:143]
 buffer_load_dwordx4 v8, s[52:55], s28 offen offset:0   lds
M v[140:143], a[56:59], a[160:163], v[140:143]
 ds_read_b64_tr_b16 a[140:141], v2 offset:57344
 ds_read_b64_tr_b16 a[142:143], v2 offset:58368
M v[144:147], a[64:67], a[160:163], v[144:147]
 s_add_u32 s32, s64, s65
 v_sub_f32 v240, v240, v27
M v[144:147], a[68:71], a[164:167], v[144:147]
 s_lshl_b32 s65, s20, 14
 s_add_u32 s32, s32, s65
 s_add_u32 s32, s32, 33554432
M v[148:151], a[76:79], a[164:167], v[148:151]
 buffer_load_dwordx4 v9, s[52:55], s28 offen offset:1024   lds
M v[148:151], a[72:75], a[160:163], v[148:151]
 s_mov_b32 s31, 0x53800000
 v_sub_f32 v241, v241, v27
M v[152:155], a[80:83], a[160:163], v[152:155]
 s_mov_b32 s40, 1
 s_sub_u32 s64, s42, 10
 s_and_b32 s35, s64, 536870912
M v[152:155], a[84:87], a[164:167], v[152:155]
 s_waitcnt lgkmcnt(4)
 v_sub_f32 v242, v242, v27
 v_sub_f32 v243, v243, v27
M v[156:159], a[92:95], a[164:167], v[156:159]
 ds_read_b64_tr_b16 a[144:145], v3 offset:49152
 ds_read_b64_tr_b16 a[146:147], v3 offset:50176
M v[156:159], a[88:91], a[160:163], v[156:159]
 buffer_load_dwordx4 v10, s[52:55], s28 offen offset:2048   lds
M v[160:163], a[32:35], a[168:171], v[160:163]
 ds_read_b128 a[160:163], v5 offset:20480
 ds_read_b128 a[164:167], v6 offset:20480
M v[160:163], a[36:39], a[172:175], v[160:163]
 v_sub_f32 v244, v244, v27
 v_sub_f32 v245, v245, v27
M v[164:167], a[44:47], a[172:175], v[164:167]
 v_sub_f32 v246, v246, v27
 v_sub_f32 v247, v247, v27
M v[164:167], a[40:43], a[168:171], v[164:167]
 v_sub_f32 v248, v248, v27
 v_sub_f32 v249, v249, v27
M v[168:171], a[48:51], a[168:171], v[168:171]
 buffer_load_dwordx4 v11, s[52:55], s28 offen offset:3072   lds
M v[168:171], a[52:55], a[172:175], v[168:171]
 s_add_u32 s28, s28, 524416
 ds_read_b64_tr_b16 a[148:149], v3 offset:57344
 ds_read_b64_tr_b16 a[150:151], v3 offset:58368
M v[172:175], a[60:63], a[172:175], v[172:175]
 v_sub_f32 v250, v250, v27
 v_sub_f32 v251, v251, v27
M v[172:175], a[56:59], a[168:171], v[172:175]
 v_sub_f32 v252, v252, v27
 v_sub_f32 v253, v253, v27
M v[176:179], a[64:67], a[168:171], v[176:179]
 s_add_u32 m0, s23, 147456
 v_sub_f32 v254, v254, v27
 v_sub_f32 v255, v255, v27
M v[176:179], a[68:71], a[172:175], v[176:179]
 buffer_load_dwordx4 v8, s[52:55], s28 offen offset:0   lds
M v[180:183], a[76:79], a[172:175], v[180:183]
M v[180:183], a[72:75], a[168:171], v[180:183]
M v[184:187], a[80:83], a[168:171], v[184:187]
 ds_read_b64_tr_b16 a[152:153], v4 offset:49152
 ds_read_b64_tr_b16 a[154:155], v4 offset:50176
M v[184:187], a[84:87], a[172:175], v[184:187]
 s_waitcnt lgkmcnt(4)
M v[188:191], a[92:95], a[172:175], v[188:191]
 buffer_load_dwordx4 v9, s[52:55], s28 offen offset:1024   lds
M v[188:191], a[88:91], a[168:171], v[188:191]
M v[192:195], a[32:35], a[160:163], v[192:195]
 ds_read_b128 a[168:171], v5 offset:22528
 ds_read_b128 a[172:175], v6 offset:22528
M v[192:195], a[36:39], a[164:167], v[192:195]
M v[196:199], a[44:47], a[164:167], v[196:199]
 buffer_load_dwordx4 v10, s[52:55], s28 offen offset:2048   lds
M v[196:199], a[40:43], a[160:163], v[196:199]
 ds_read_b64_tr_b16 a[156:157], v4 offset:57344
 ds_read_b64_tr_b16 a[158:159], v4 offset:58368
M v[200:203], a[48:51], a[160:163], v[200:203]
M v[200:203], a[52:55], a[164:167], v[200:203]
M v[204:207], a[60:63], a[164:167], v[204:207]
M v[204:207], a[56:59], a[160:163], v[204:207]
 buffer_load_dwordx4 v11, s[52:55], s28 offen offset:3072   lds
M v[208:211], a[64:67], a[160:163], v[208:211]
 s_sub_u32 s28, s28, 524288
M v[208:211], a[68:71], a[164:167], v[208:211]
M v[212:215], a[76:79], a[164:167], v[212:215]
M v[212:215], a[72:75], a[160:163], v[212:215]
M v[216:219], a[80:83], a[160:163], v[216:219]
M v[216:219], a[84:87], a[164:167], v[216:219]
 s_waitcnt lgkmcnt(2)
M v[220:223], a[92:95], a[164:167], v[220:223]
 s_waitcnt vmcnt(25) lgkmcnt(0)
M v[220:223], a[88:91], a[160:163], v[220:223]
 s_barrier
M v[224:227], a[32:35], a[168:171], v[224:227]
 ds_read_b128 a[160:163], v5 offset:32768
 ds_read_b128 a[164:167], v6 offset:32768
M v[224:227], a[36:39], a[172:175], v[224:227]
M v[228:231], a[44:47], a[172:175], v[228:231]
M v[228:231], a[40:43], a[168:171], v[228:231]
M v[232:235], a[48:51], a[168:171], v[232:235]
M v[232:235], a[52:55], a[172:175], v[232:235]
M v[236:239], a[60:63], a[172:175], v[236:239]
M v[236:239], a[56:59], a[168:171], v[236:239]
M v[240:243], a[64:67], a[168:171], v[240:243]
M v[240:243], a[68:71], a[172:175], v[240:243]
M v[244:247], a[76:79], a[172:175], v[244:247]
M v[244:247], a[72:75], a[168:171], v[244:247]
M v[248:251], a[80:83], a[168:171], v[248:251]
M v[248:251], a[84:87], a[172:175], v[248:251]
 s_waitcnt lgkmcnt(0)
M v[252:255], a[92:95], a[172:175], v[252:255]
M v[252:255], a[88:91], a[168:171], v[252:255]
M a[0:3], a[96:99], a[160:163], a[0:3]
 ds_read_b128 a[168:171], v5 offset:34816
 ds_read_b128 a[172:175], v6 offset:34816
M a[0:3], a[100:103], a[164:167], a[0:3]
 ds_read_b64_tr_b16 a[32:33], v1 offset:0
 ds_read_b64_tr_b16 a[34:35], v1 offset:1024
M a[4:7], a[108:111], a[164:167], a[4:7]
 s_add_u32 m0, s24, 16384
M a[4:7], a[104:107], a[160:163], a[4:7]
 buffer_load_dwordx4 v16, s[56:59], s29 offen offset:0   lds
M a[8:11], a[112:115], a[160:163], a[8:11]
M a[8:11], a[116:119], a[164:167], a[8:11]
M a[12:15], a[124:127], a[164:167], a[12:15]
 ds_read_b64_tr_b16 a[36:37], v1 offset:8192
 ds_read_b64_tr_b16 a[38:39], v1 offset:9216
M a[12:15], a[120:123], a[160:163], a[12:15]
M a[16:19], a[128:131], a[160:163], a[16:19]
 buffer_load_dwordx4 v17, s[56:59], s29 offen offset:1024   lds
M a[16:19], a[132:135], a[164:167], a[16:19]
 v_accvgpr_read_b32 v24, a0
 v_accvgpr_read_b32 v25, a1
M a[20:23], a[140:143], a[164:167], a[20:23]
 v_accvgpr_read_b32 v26, a2
 v_accvgpr_read_b32 v27, a3
M a[20:23], a[136:139], a[160:163], a[20:23]
 ds_read_b64_tr_b16 a[40:41], v2 offset:0
 ds_read_b64_tr_b16 a[42:43], v2 offset:1024
M a[24:27], a[144:147], a[160:163], a[24:27]
 v_accvgpr_read_b32 v28, a4
 v_accvgpr_read_b32 v29, a5
M a[24:27], a[148:151], a[164:167], a[24:27]
 s_waitcnt lgkmcnt(6)
 buffer_load_dwordx4 v18, s[56:59], s29 offen offset:2048   lds
M a[28:31], a[156:159], a[164:167], a[28:31]
 v_accvgpr_read_b32 v30, a6
 v_accvgpr_read_b32 v31, a7
M a[28:31], a[152:155], a[160:163], a[28:31]
 v_cvt_pk_bf16_f32 v24, v24, v25
 v_cvt_pk_bf16_f32 v25, v26, v27
M v[32:35], a[96:99], a[168:171], v[32:35]
 ds_read_b128 a[160:163], v5 offset:36864
 ds_read_b128 a[164:167], v6 offset:36864
M v[32:35], a[100:103], a[172:175], v[32:35]
 ds_read_b64_tr_b16 a[44:45], v2 offset:8192
 ds_read_b64_tr_b16 a[46:47], v2 offset:9216
M v[36:39], a[108:111], a[172:175], v[36:39]
 buffer_load_dwordx4 v19, s[56:59], s29 offen offset:3072   lds
M v[36:39], a[104:107], a[168:171], v[36:39]
 s_add_u32 s29, s29, 128
 v_cvt_pk_bf16_f32 v26, v28, v29
 v_cvt_pk_bf16_f32 v27, v30, v31
M v[40:43], a[112:115], a[168:171], v[40:43]
 s_add_u32 s3, s93, 0
 buffer_store_dwordx4 v[24:27], v7, s[8:11], s3 offen offset:0 sc1
M v[40:43], a[116:119], a[172:175], v[40:43]
 ds_read_b64_tr_b16 a[48:49], v3 offset:0
 ds_read_b64_tr_b16 a[50:51], v3 offset:1024
M v[44:47], a[124:127], a[172:175], v[44:47]
 s_add_u32 m0, s23, 49152
 v_accvgpr_read_b32 v24, a8
 v_accvgpr_read_b32 v25, a9
M v[44:47], a[120:123], a[168:171], v[44:47]
 buffer_load_dwordx4 v8, s[52:55], s28 offen offset:0   lds
M v[48:51], a[128:131], a[168:171], v[48:51]
 v_accvgpr_read_b32 v26, a10
 v_accvgpr_read_b32 v27, a11
M v[48:51], a[132:135], a[172:175], v[48:51]
 v_accvgpr_read_b32 v28, a12
 v_accvgpr_read_b32 v29, a13
M v[52:55], a[140:143], a[172:175], v[52:55]
 ds_read_b64_tr_b16 a[52:53], v3 offset:8192
 ds_read_b64_tr_b16 a[54:55], v3 offset:9216
M v[52:55], a[136:139], a[168:171], v[52:55]
 v_accvgpr_read_b32 v30, a14
 v_accvgpr_read_b32 v31, a15
M v[56:59], a[144:147], a[168:171], v[56:59]
 buffer_load_dwordx4 v9, s[52:55], s28 offen offset:1024   lds
M v[56:59], a[148:151], a[172:175], v[56:59]
 s_waitcnt lgkmcnt(6)
 v_cvt_pk_bf16_f32 v24, v24, v25
 v_cvt_pk_bf16_f32 v25, v26, v27
M v[60:63], a[156:159], a[172:175], v[60:63]
 v_cvt_pk_bf16_f32 v26, v28, v29
 v_cvt_pk_bf16_f32 v27, v30, v31
M v[60:63], a[152:155], a[168:171], v[60:63]
 ds_read_b64_tr_b16 a[56:57], v4 offset:0
 ds_read_b64_tr_b16 a[58:59], v4 offset:1024
M v[64:67], a[96:99], a[160:163], v[64:67]
 ds_read_b128 a[168:171], v5 offset:38912
 ds_read_b128 a[172:175], v6 offset:38912
M v[64:67], a[100:103], a[164:167], v[64:67]
 buffer_load_dwordx4 v10, s[52:55], s28 offen offset:2048   lds
M v[68:71], a[108:111], a[164:167], v[68:71]
M v[68:71], a[104:107], a[160:163], v[68:71]
 buffer_store_dwordx4 v[24:27], v7, s[8:11], s3 offen offset:1024 sc1
M v[72:75], a[112:115], a[160:163], v[72:75]
 ds_read_b64_tr_b16 a[60:61], v4 offset:8192
 ds_read_b64_tr_b16 a[62:63], v4 offset:9216
M v[72:75], a[116:119], a[164:167], v[72:75]
 v_accvgpr_read_b32 v24, a16
 v_accvgpr_read_b32 v25, a17
M v[76:79], a[124:127], a[164:167], v[76:79]
 buffer_load_dwordx4 v11, s[52:55], s28 offen offset:3072   lds
M v[76:79], a[120:123], a[160:163], v[76:79]
 s_add_u32 s28, s28, 1048448
 v_accvgpr_read_b32 v26, a18
 v_accvgpr_read_b32 v27, a19
M v[80:83], a[128:131], a[160:163], v[80:83]
 v_accvgpr_read_b32 v28, a20
 v_accvgpr_read_b32 v29, a21
M v[80:83], a[132:135], a[164:167], v[80:83]
 v_accvgpr_read_b32 v30, a22
 v_accvgpr_read_b32 v31, a23
M v[84:87], a[140:143], a[164:167], v[84:87]
 v_cvt_pk_bf16_f32 v24, v24, v25
 v_cvt_pk_bf16_f32 v25, v26, v27
M v[84:87], a[136:139], a[160:163], v[84:87]
 v_cvt_pk_bf16_f32 v26, v28, v29
 v_cvt_pk_bf16_f32 v27, v30, v31
M v[88:91], a[144:147], a[160:163], v[88:91]
 buffer_store_dwordx4 v[24:27], v7, s[8:11], s3 offen offset:2048 sc1
M v[88:91], a[148:151], a[164:167], v[88:91]
 s_waitcnt lgkmcnt(2)
 v_accvgpr_read_b32 v24, a24
 v_accvgpr_read_b32 v25, a25
M v[92:95], a[156:159], a[164:167], v[92:95]
 s_waitcnt vmcnt(27) lgkmcnt(0)
 v_accvgpr_read_b32 v26, a26
 v_accvgpr_read_b32 v27, a27
M v[92:95], a[152:155], a[160:163], v[92:95]
 s_barrier
M v[96:99], a[96:99], a[168:171], v[96:99]
 ds_read_b128 a[160:163], v5 offset:49152
 ds_read_b128 a[164:167], v6 offset:49152
M v[96:99], a[100:103], a[172:175], v[96:99]
 v_accvgpr_read_b32 v28, a28
 v_accvgpr_read_b32 v29, a29
M v[100:103], a[108:111], a[172:175], v[100:103]
 s_add_u32 m0, s24, 32768
 ds_read_b64_tr_b16 a[64:65], v1 offset:16384
 ds_read_b64_tr_b16 a[66:67], v1 offset:17408
M v[100:103], a[104:107], a[168:171], v[100:103]
 buffer_load_dwordx4 v16, s[56:59], s29 offen offset:0   lds
M v[104:107], a[112:115], a[168:171], v[104:107]
 v_accvgpr_read_b32 v30, a30
 v_accvgpr_read_b32 v31, a31
M v[104:107], a[116:119], a[172:175], v[104:107]
 v_cvt_pk_bf16_f32 v24, v24, v25
 v_cvt_pk_bf16_f32 v25, v26, v27
M v[108:111], a[124:127], a[172:175], v[108:111]
 v_cvt_pk_bf16_f32 v26, v28, v29
 v_cvt_pk_bf16_f32 v27, v30, v31
M v[108:111], a[120:123], a[168:171], v[108:111]
 buffer_store_dwordx4 v[24:27], v7, s[8:11], s3 offen offset:3072 sc1
M v[112:115], a[128:131], a[168:171], v[112:115]
 v_cvt_pk_bf16_f32 v32, v32, v33
 v_cvt_pk_bf16_f32 v33, v34, v35
M v[112:115], a[132:135], a[172:175], v[112:115]
 ds_read_b64_tr_b16 a[68:69], v1 offset:24576
 ds_read_b64_tr_b16 a[70:71], v1 offset:25600
M v[116:119], a[140:143], a[172:175], v[116:119]
 buffer_load_dwordx4 v17, s[56:59], s29 offen offset:1024   lds
M v[116:119], a[136:139], a[168:171], v[116:119]
 v_cvt_pk_bf16_f32 v34, v36, v37
 v_cvt_pk_bf16_f32 v35, v38, v39
M v[120:123], a[144:147], a[168:171], v[120:123]
 v_accvgpr_write_b32 a4, v32
 v_accvgpr_write_b32 a5, v33
M v[120:123], a[148:151], a[172:175], v[120:123]
 s_waitcnt lgkmcnt(4)
 v_accvgpr_write_b32 a6, v34
 v_accvgpr_write_b32 a7, v35
M v[124:127], a[156:159], a[172:175], v[124:127]
 v_cvt_pk_bf16_f32 v40, v40, v41
 v_cvt_pk_bf16_f32 v41, v42, v43
M v[124:127], a[152:155], a[168:171], v[124:127]
 v_cvt_pk_bf16_f32 v42, v44, v45
 v_cvt_pk_bf16_f32 v43, v46, v47
M v[128:131], a[96:99], a[160:163], v[128:131]
 ds_read_b128 a[168:171], v5 offset:51200
 ds_read_b128 a[172:175], v6 offset:51200
M v[128:131], a[100:103], a[164:167], v[128:131]
 ds_read_b64_tr_b16 a[72:73], v2 offset:16384
 ds_read_b64_tr_b16 a[74:75], v2 offset:17408
M v[132:135], a[108:111], a[164:167], v[132:135]
 buffer_load_dwordx4 v18, s[56:59], s29 offen offset:2048   lds
M v[132:135], a[104:107], a[160:163], v[132:135]
 v_accvgpr_write_b32 a12, v40
 v_accvgpr_write_b32 a13, v41
M v[136:139], a[112:115], a[160:163], v[136:139]
 v_accvgpr_write_b32 a14, v42
 v_accvgpr_write_b32 a15, v43
M v[136:139], a[116:119], a[164:167], v[136:139]
 v_cvt_pk_bf16_f32 v48, v48, v49
 v_cvt_pk_bf16_f32 v49, v50, v51
M v[140:143], a[124:127], a[164:167], v[140:143]
 v_cvt_pk_bf16_f32 v50, v52, v53
 v_cvt_pk_bf16_f32 v51, v54, v55
M v[140:143], a[120:123], a[160:163], v[140:143]
 ds_read_b64_tr_b16 a[76:77], v2 offset:24576
 ds_read_b64_tr_b16 a[78:79], v2 offset:25600
M v[144:147], a[128:131], a[160:163], v[144:147]
 buffer_load_dwordx4 v19, s[56:59], s29 offen offset:3072   lds
M v[144:147], a[132:135], a[164:167], v[144:147]
 s_add_u32 s29, s29, 128
 v_accvgpr_write_b32 a20, v48
 v_accvgpr_write_b32 a21, v49
M v[148:151], a[140:143], a[164:167], v[148:151]
 v_accvgpr_write_b32 a22, v50
 v_accvgpr_write_b32 a23, v51
M v[148:151], a[136:139], a[160:163], v[148:151]
 v_cvt_pk_bf16_f32 v56, v56, v57
 v_cvt_pk_bf16_f32 v57, v58, v59
M v[152:155], a[144:147], a[160:163], v[152:155]
 v_cvt_pk_bf16_f32 v58, v60, v61
 v_cvt_pk_bf16_f32 v59, v62, v63
M v[152:155], a[148:151], a[164:167], v[152:155]
 s_waitcnt lgkmcnt(4)
 v_accvgpr_write_b32 a28, v56
 v_accvgpr_write_b32 a29, v57
M v[156:159], a[156:159], a[164:167], v[156:159]
 s_add_u32 m0, s23, 0
 ds_read_b64_tr_b16 a[80:81], v3 offset:16384
 ds_read_b64_tr_b16 a[82:83], v3 offset:17408
M v[156:159], a[152:155], a[160:163], v[156:159]
 buffer_load_dwordx4 v8, s[52:55], s28 offen offset:0   lds
M v[160:163], a[96:99], a[168:171], v[160:163]
 ds_read_b128 a[160:163], v5 offset:53248
 ds_read_b128 a[164:167], v6 offset:53248
M v[160:163], a[100:103], a[172:175], v[160:163]
 v_accvgpr_write_b32 a30, v58
 v_accvgpr_write_b32 a31, v59
M v[164:167], a[108:111], a[172:175], v[164:167]
 v_cvt_pk_bf16_f32 v64, v64, v65
 v_cvt_pk_bf16_f32 v65, v66, v67
M v[164:167], a[104:107], a[168:171], v[164:167]
 v_cvt_pk_bf16_f32 v66, v68, v69
 v_cvt_pk_bf16_f32 v67, v70, v71
M v[168:171], a[112:115], a[168:171], v[168:171]
 v_cvt_pk_bf16_f32 v72, v72, v73
 v_cvt_pk_bf16_f32 v73, v74, v75
M v[168:171], a[116:119], a[172:175], v[168:171]
 ds_read_b64_tr_b16 a[84:85], v3 offset:24576
 ds_read_b64_tr_b16 a[86:87], v3 offset:25600
M v[172:175], a[124:127], a[172:175], v[172:175]
 buffer_load_dwordx4 v9, s[52:55], s28 offen offset:1024   lds
M v[172:175], a[120:123], a[168:171], v[172:175]
 v_cvt_pk_bf16_f32 v74, v76, v77
 v_cvt_pk_bf16_f32 v75, v78, v79
M v[176:179], a[128:131], a[168:171], v[176:179]
 v_cvt_pk_bf16_f32 v80, v80, v81
 v_cvt_pk_bf16_f32 v81, v82, v83
M v[176:179], a[132:135], a[172:175], v[176:179]
 v_cvt_pk_bf16_f32 v82, v84, v85
 v_cvt_pk_bf16_f32 v83, v86, v87
M v[180:183], a[140:143], a[172:175], v[180:183]
 v_cvt_pk_bf16_f32 v88, v88, v89
 v_cvt_pk_bf16_f32 v89, v90, v91
M v[180:183], a[136:139], a[168:171], v[180:183]
 v_cvt_pk_bf16_f32 v90, v92, v93
 v_cvt_pk_bf16_f32 v91, v94, v95
M v[184:187], a[144:147], a[168:171], v[184:187]
 ds_read_b64_tr_b16 a[88:89], v4 offset:16384
 ds_read_b64_tr_b16 a[90:91], v4 offset:17408
M v[184:187], a[148:151], a[172:175], v[184:187]
 s_waitcnt lgkmcnt(4)
 buffer_load_dwordx4 v10, s[52:55], s28 offen offset:2048   lds
M v[188:191], a[156:159], a[172:175], v[188:191]
 v_cvt_pk_bf16_f32 v96, v96, v97
 v_cvt_pk_bf16_f32 v97, v98, v99
M v[188:191], a[152:155], a[168:171], v[188:191]
 v_cvt_pk_bf16_f32 v98, v100, v101
 v_cvt_pk_bf16_f32 v99, v102, v103
M v[192:195], a[96:99], a[160:163], v[192:195]
 ds_read_b128 a[168:171], v5 offset:55296
 ds_read_b128 a[172:175], v6 offset:55296
M v[192:195], a[100:103], a[164:167], v[192:195]
 v_cvt_pk_bf16_f32 v104, v104, v105
 v_cvt_pk_bf16_f32 v105, v106, v107
M v[196:199], a[108:111], a[164:167], v[196:199]
 v_cvt_pk_bf16_f32 v106, v108, v109
 v_cvt_pk_bf16_f32 v107, v110, v111
M v[196:199], a[104:107], a[160:163], v[196:199]
 ds_read_b64_tr_b16 a[92:93], v4 offset:24576
 ds_read_b64_tr_b16 a[94:95], v4 offset:25600
M v[200:203], a[112:115], a[160:163], v[200:203]
 buffer_load_dwordx4 v11, s[52:55], s28 offen offset:3072   lds
M v[200:203], a[116:119], a[164:167], v[200:203]
 s_add_u32 s28, s28, 128
 v_cvt_pk_bf16_f32 v112, v112, v113
 v_cvt_pk_bf16_f32 v113, v114, v115
M v[204:207], a[124:127], a[164:167], v[204:207]
 v_cvt_pk_bf16_f32 v114, v116, v117
 v_cvt_pk_bf16_f32 v115, v118, v119
M v[204:207], a[120:123], a[160:163], v[204:207]
 v_cvt_pk_bf16_f32 v120, v120, v121
 v_cvt_pk_bf16_f32 v121, v122, v123
M v[208:211], a[128:131], a[160:163], v[208:211]
 v_cvt_pk_bf16_f32 v122, v124, v125
 v_cvt_pk_bf16_f32 v123, v126, v127
M v[208:211], a[132:135], a[164:167], v[208:211]
 v_cvt_pk_bf16_f32 v128, v128, v129
 v_cvt_pk_bf16_f32 v129, v130, v131
M v[212:215], a[140:143], a[164:167], v[212:215]
 v_cvt_pk_bf16_f32 v130, v132, v133
 v_cvt_pk_bf16_f32 v131, v134, v135
M v[212:215], a[136:139], a[160:163], v[212:215]
 v_cvt_pk_bf16_f32 v136, v136, v137
 v_cvt_pk_bf16_f32 v137, v138, v139
M v[216:219], a[144:147], a[160:163], v[216:219]
 v_cvt_pk_bf16_f32 v138, v140, v141
 v_cvt_pk_bf16_f32 v139, v142, v143
M v[216:219], a[148:151], a[164:167], v[216:219]
 s_waitcnt lgkmcnt(2)
 v_cvt_pk_bf16_f32 v144, v144, v145
 v_cvt_pk_bf16_f32 v145, v146, v147
M v[220:223], a[156:159], a[164:167], v[220:223]
 s_waitcnt vmcnt(24) lgkmcnt(0)
 v_cvt_pk_bf16_f32 v146, v148, v149
 v_cvt_pk_bf16_f32 v147, v150, v151
M v[220:223], a[152:155], a[160:163], v[220:223]
 s_barrier
M v[224:227], a[96:99], a[168:171], v[224:227]
 ds_read_b128 a[160:163], v5 offset:0
 ds_read_b128 a[164:167], v6 offset:0
M v[224:227], a[100:103], a[172:175], v[224:227]
 v_cvt_pk_bf16_f32 v152, v152, v153
 v_cvt_pk_bf16_f32 v153, v154, v155
M v[228:231], a[108:111], a[172:175], v[228:231]
 v_cvt_pk_bf16_f32 v154, v156, v157
 v_cvt_pk_bf16_f32 v155, v158, v159
M v[228:231], a[104:107], a[168:171], v[228:231]
 v_cvt_pk_bf16_f32 v160, v160, v161
 v_cvt_pk_bf16_f32 v161, v162, v163
M v[232:235], a[112:115], a[168:171], v[232:235]
 v_cvt_pk_bf16_f32 v162, v164, v165
 v_cvt_pk_bf16_f32 v163, v166, v167
M v[232:235], a[116:119], a[172:175], v[232:235]
 v_cvt_pk_bf16_f32 v168, v168, v169
 v_cvt_pk_bf16_f32 v169, v170, v171
M v[236:239], a[124:127], a[172:175], v[236:239]
 v_cvt_pk_bf16_f32 v170, v172, v173
 v_cvt_pk_bf16_f32 v171, v174, v175
M v[236:239], a[120:123], a[168:171], v[236:239]
 v_cvt_pk_bf16_f32 v176, v176, v177
 v_cvt_pk_bf16_f32 v177, v178, v179
M v[240:243], a[128:131], a[168:171], v[240:243]
 v_cvt_pk_bf16_f32 v178, v180, v181
 v_cvt_pk_bf16_f32 v179, v182, v183
M v[240:243], a[132:135], a[172:175], v[240:243]
 v_cvt_pk_bf16_f32 v184, v184, v185
 v_cvt_pk_bf16_f32 v185, v186, v187
M v[244:247], a[140:143], a[172:175], v[244:247]
 v_cvt_pk_bf16_f32 v186, v188, v189
 v_cvt_pk_bf16_f32 v187, v190, v191
M v[244:247], a[136:139], a[168:171], v[244:247]
 v_cvt_pk_bf16_f32 v192, v192, v193
 v_cvt_pk_bf16_f32 v193, v194, v195
M v[248:251], a[144:147], a[168:171], v[248:251]
 v_cvt_pk_bf16_f32 v194, v196, v197
 v_cvt_pk_bf16_f32 v195, v198, v199
M v[248:251], a[148:151], a[172:175], v[248:251]
 s_waitcnt lgkmcnt(0)
 v_cvt_pk_bf16_f32 v200, v200, v201
 v_cvt_pk_bf16_f32 v201, v202, v203
M v[252:255], a[156:159], a[172:175], v[252:255]
 v_cvt_pk_bf16_f32 v202, v204, v205
 v_cvt_pk_bf16_f32 v203, v206, v207
M v[252:255], a[152:155], a[168:171], v[252:255]
 v_cvt_pk_bf16_f32 v208, v208, v209
 v_cvt_pk_bf16_f32 v209, v210, v211
M v[32:35], a[32:35], a[160:163], 0
 s_add_u32 m0, s23, 16384
 ds_read_b128 a[168:171], v5 offset:2048
 ds_read_b128 a[172:175], v6 offset:2048
M v[32:35], a[36:39], a[164:167], v[32:35]
 ds_read_b64_tr_b16 a[96:97], v1 offset:32768
 ds_read_b64_tr_b16 a[98:99], v1 offset:33792
M v[36:39], a[44:47], a[164:167], 0
 buffer_load_dwordx4 v8, s[52:55], s28 offen offset:0   lds
M v[36:39], a[40:43], a[160:163], v[36:39]
 v_cvt_pk_bf16_f32 v210, v212, v213
 v_cvt_pk_bf16_f32 v211, v214, v215
M v[40:43], a[48:51], a[160:163], 0
 ds_read_b64_tr_b16 a[100:101], v1 offset:40960
 ds_read_b64_tr_b16 a[102:103], v1 offset:41984
M v[40:43], a[52:55], a[164:167], v[40:43]
 buffer_load_dwordx4 v9, s[52:55], s28 offen offset:1024   lds
M v[44:47], a[60:63], a[164:167], 0
 v_cvt_pk_bf16_f32 v216, v216, v217
 v_cvt_pk_bf16_f32 v217, v218, v219
M v[44:47], a[56:59], a[160:163], v[44:47]
 ds_read_b64_tr_b16 a[104:105], v2 offset:32768
 ds_read_b64_tr_b16 a[106:107], v2 offset:33792
M v[48:51], a[64:67], a[160:163], 0
 v_cvt_pk_bf16_f32 v218, v220, v221
 v_cvt_pk_bf16_f32 v219, v222, v223
M v[48:51], a[68:71], a[164:167], v[48:51]
 v_cvt_pk_bf16_f32 v224, v224, v225
 v_cvt_pk_bf16_f32 v225, v226, v227
M v[52:55], a[76:79], a[164:167], 0
 ds_read_b64_tr_b16 a[108:109], v2 offset:40960
 ds_read_b64_tr_b16 a[110:111], v2 offset:41984
M v[52:55], a[72:75], a[160:163], v[52:55]
 buffer_load_dwordx4 v10, s[52:55], s28 offen offset:2048   lds
M v[56:59], a[80:83], a[160:163], 0
 v_cvt_pk_bf16_f32 v226, v228, v229
 v_cvt_pk_bf16_f32 v227, v230, v231
M v[56:59], a[84:87], a[164:167], v[56:59]
 s_waitcnt lgkmcnt(8)
 ds_read_b64_tr_b16 a[112:113], v3 offset:32768
 ds_read_b64_tr_b16 a[114:115], v3 offset:33792
M v[60:63], a[92:95], a[164:167], 0
 v_cvt_pk_bf16_f32 v232, v232, v233
 v_cvt_pk_bf16_f32 v233, v234, v235
M v[60:63], a[88:91], a[160:163], v[60:63]
 buffer_load_dwordx4 v11, s[52:55], s28 offen offset:3072   lds
M v[68:71], a[32:35], a[168:171], 0
 s_add_u32 s28, s28, 524160
 ds_read_b128 a[160:163], v5 offset:4096
 ds_read_b128 a[164:167], v6 offset:4096
M v[68:71], a[36:39], a[172:175], v[68:71]
 ds_read_b64_tr_b16 a[116:117], v3 offset:40960
 ds_read_b64_tr_b16 a[118:119], v3 offset:41984
M v[76:79], a[44:47], a[172:175], 0
 v_cvt_pk_bf16_f32 v234, v236, v237
 v_cvt_pk_bf16_f32 v235, v238, v239
M v[76:79], a[40:43], a[168:171], v[76:79]
 s_add_u32 m0, s24, 49152
 ds_read_b64_tr_b16 a[120:121], v4 offset:32768
 ds_read_b64_tr_b16 a[122:123], v4 offset:33792
M v[84:87], a[48:51], a[168:171], 0
 buffer_load_dwordx4 v16, s[56:59], s29 offen offset:0   lds
M v[84:87], a[52:55], a[172:175], v[84:87]
 v_cvt_pk_bf16_f32 v240, v240, v241
 v_cvt_pk_bf16_f32 v241, v242, v243
M v[92:95], a[60:63], a[172:175], 0
 ds_read_b64_tr_b16 a[124:125], v4 offset:40960
 ds_read_b64_tr_b16 a[126:127], v4 offset:41984
M v[92:95], a[56:59], a[168:171], v[92:95]
 v_cvt_pk_bf16_f32 v242, v244, v245
 v_cvt_pk_bf16_f32 v243, v246, v247
M v[100:103], a[64:67], a[168:171], 0
 v_cvt_pk_bf16_f32 v248, v248, v249
 v_cvt_pk_bf16_f32 v249, v250, v251
M v[100:103], a[68:71], a[172:175], v[100:103]
 buffer_load_dwordx4 v17, s[56:59], s29 offen offset:1024   lds
M v[108:111], a[76:79], a[172:175], 0
 v_cvt_pk_bf16_f32 v250, v252, v253
 v_cvt_pk_bf16_f32 v251, v254, v255
M v[108:111], a[72:75], a[168:171], v[108:111]
 s_add_u32 s3, s93, 8192
 v_mov_b32 v12, 1
 v_or_b32 v15, s20, v0
M v[116:119], a[80:83], a[168:171], 0
 v_min_u32 v15, 1, v15
 v_lshlrev_b32 v15, 29, v15
M v[116:119], a[84:87], a[172:175], v[116:119]
 s_waitcnt lgkmcnt(6)
 buffer_store_dwordx4 a[4:7], v7, s[8:11], s3 offen offset:0 sc1
M v[124:127], a[92:95], a[172:175], 0
 s_waitcnt vmcnt(17) lgkmcnt(0)
 buffer_load_dwordx4 v18, s[56:59], s29 offen offset:2048   lds
M v[124:127], a[88:91], a[168:171], v[124:127]
 s_barrier
M v[132:135], a[32:35], a[160:163], 0
 ds_read_b128 a[168:171], v5 offset:6144
 ds_read_b128 a[172:175], v6 offset:6144
M v[132:135], a[36:39], a[164:167], v[132:135]
 ds_read_b64_tr_b16 a[128:129], v1 offset:49152
 ds_read_b64_tr_b16 a[130:131], v1 offset:50176
M v[140:143], a[44:47], a[164:167], 0
M v[140:143], a[40:43], a[160:163], v[140:143]
 buffer_load_dwordx4 v19, s[56:59], s29 offen offset:3072   lds
M v[148:151], a[48:51], a[160:163], 0
 s_add_u32 s29, s29, 128
 ds_read_b64_tr_b16 a[132:133], v1 offset:57344
 ds_read_b64_tr_b16 a[134:135], v1 offset:58368
M v[148:151], a[52:55], a[164:167], v[148:151]
 buffer_store_dwordx4 a[12:15], v7, s[8:11], s3 offen offset:1024 sc1
M v[156:159], a[60:63], a[164:167], 0
M v[156:159], a[56:59], a[160:163], v[156:159]
 s_add_u32 m0, s23, 32768
 ds_read_b64_tr_b16 a[136:137], v2 offset:49152
 ds_read_b64_tr_b16 a[138:139], v2 offset:50176
M v[164:167], a[64:67], a[160:163], 0
 buffer_load_dwordx4 v8, s[52:55], s28 offen offset:0   lds
M v[164:167], a[68:71], a[164:167], v[164:167]
M v[172:175], a[76:79], a[164:167], 0
 ds_read_b64_tr_b16 a[140:141], v2 offset:57344
 ds_read_b64_tr_b16 a[142:143], v2 offset:58368
M v[172:175], a[72:75], a[160:163], v[172:175]
M v[180:183], a[80:83], a[160:163], 0
M v[180:183], a[84:87], a[164:167], v[180:183]
 s_waitcnt lgkmcnt(8)
 ds_read_b64_tr_b16 a[144:145], v3 offset:49152
 ds_read_b64_tr_b16 a[146:147], v3 offset:50176
M v[188:191], a[92:95], a[164:167], 0
 buffer_load_dwordx4 v9, s[52:55], s28 offen offset:1024   lds
M v[188:191], a[88:91], a[160:163], v[188:191]
M v[196:199], a[32:35], a[168:171], 0
 ds_read_b128 a[160:163], v5 offset:16384
 ds_read_b128 a[164:167], v6 offset:16384
M v[196:199], a[36:39], a[172:175], v[196:199]
 ds_read_b64_tr_b16 a[148:149], v3 offset:57344
 ds_read_b64_tr_b16 a[150:151], v3 offset:58368
M v[204:207], a[44:47], a[172:175], 0
 buffer_load_dwordx4 v10, s[52:55], s28 offen offset:2048   lds
M v[204:207], a[40:43], a[168:171], v[204:207]
 ds_read_b64_tr_b16 a[152:153], v4 offset:49152
 ds_read_b64_tr_b16 a[154:155], v4 offset:50176
M v[212:215], a[48:51], a[168:171], 0
M v[212:215], a[52:55], a[172:175], v[212:215]
M v[220:223], a[60:63], a[172:175], 0
 ds_read_b64_tr_b16 a[156:157], v4 offset:57344
 ds_read_b64_tr_b16 a[158:159], v4 offset:58368
M v[220:223], a[56:59], a[168:171], v[220:223]
 buffer_load_dwordx4 v11, s[52:55], s28 offen offset:3072   lds
M v[228:231], a[64:67], a[168:171], 0
 s_add_u32 s28, s28, 128
M v[228:231], a[68:71], a[172:175], v[228:231]
M v[236:239], a[76:79], a[172:175], 0
M v[236:239], a[72:75], a[168:171], v[236:239]
M v[244:247], a[80:83], a[168:171], 0
M v[244:247], a[84:87], a[172:175], v[244:247]
 s_waitcnt lgkmcnt(6)
M v[252:255], a[92:95], a[172:175], 0
 s_waitcnt lgkmcnt(0)
M v[252:255], a[88:91], a[168:171], v[252:255]
 s_barrier
M v[32:35], a[96:99], a[160:163], v[32:35]
 s_add_u32 m0, s23, 49152
 ds_read_b128 a[168:171], v5 offset:18432
 ds_read_b128 a[172:175], v6 offset:18432
M v[32:35], a[100:103], a[164:167], v[32:35]
 ds_read_b64_tr_b16 a[32:33], v20 offset:0
 ds_read_b64_tr_b16 a[34:35], v20 offset:1024
M v[36:39], a[108:111], a[164:167], v[36:39]
 s_mov_b32 s39, 1280
 buffer_load_dwordx4 v8, s[52:55], s28 offen offset:0   lds
M v[36:39], a[104:107], a[160:163], v[36:39]
 s_lshl_b32 s64, s20, 14
M v[40:43], a[112:115], a[160:163], v[40:43]
 s_add_u32 s12, s64, s34
 ds_read_b64_tr_b16 a[36:37], v20 offset:8192
 ds_read_b64_tr_b16 a[38:39], v20 offset:9216
M v[40:43], a[116:119], a[164:167], v[40:43]
 s_add_u32 s13, s12, 4096
 buffer_load_dwordx4 v9, s[52:55], s28 offen offset:1024   lds
M v[44:47], a[124:127], a[164:167], v[44:47]
 s_add_u32 s14, s12, 8192
M v[44:47], a[120:123], a[160:163], v[44:47]
 s_add_u32 s15, s12, 12288
 ds_read_b64_tr_b16 a[40:41], v21 offset:0
 ds_read_b64_tr_b16 a[42:43], v21 offset:1024
M v[48:51], a[128:131], a[160:163], v[48:51]
 buffer_store_dwordx4 a[20:23], v7, s[8:11], s3 offen offset:2048 sc1
M v[48:51], a[132:135], a[164:167], v[48:51]
M v[52:55], a[140:143], a[164:167], v[52:55]
 ds_read_b64_tr_b16 a[44:45], v21 offset:8192
 ds_read_b64_tr_b16 a[46:47], v21 offset:9216
M v[52:55], a[136:139], a[160:163], v[52:55]
 buffer_load_dwordx4 v10, s[52:55], s28 offen offset:2048   lds
M v[56:59], a[144:147], a[160:163], v[56:59]
M v[56:59], a[148:151], a[164:167], v[56:59]
 s_waitcnt lgkmcnt(8)
 ds_read_b64_tr_b16 a[48:49], v22 offset:0
 ds_read_b64_tr_b16 a[50:51], v22 offset:1024
M v[60:63], a[156:159], a[164:167], v[60:63]
M v[60:63], a[152:155], a[160:163], v[60:63]
 buffer_load_dwordx4 v11, s[52:55], s28 offen offset:3072   lds
M v[68:71], a[96:99], a[168:171], v[68:71]
 s_add_u32 s28, s28, 524160
 ds_read_b128 a[160:163], v5 offset:20480
 ds_read_b128 a[164:167], v6 offset:20480
M v[68:71], a[100:103], a[172:175], v[68:71]
 ds_read_b64_tr_b16 a[52:53], v22 offset:8192
 ds_read_b64_tr_b16 a[54:55], v22 offset:9216
M v[76:79], a[108:111], a[172:175], v[76:79]
M v[76:79], a[104:107], a[168:171], v[76:79]
 s_add_u32 m0, s24, 0
 ds_read_b64_tr_b16 a[56:57], v23 offset:0
 ds_read_b64_tr_b16 a[58:59], v23 offset:1024
M v[84:87], a[112:115], a[168:171], v[84:87]
 buffer_load_dwordx4 v16, s[56:59], s29 offen offset:0   lds
M v[84:87], a[116:119], a[172:175], v[84:87]
M v[92:95], a[124:127], a[172:175], v[92:95]
 ds_read_b64_tr_b16 a[60:61], v23 offset:8192
 ds_read_b64_tr_b16 a[62:63], v23 offset:9216
M v[92:95], a[120:123], a[168:171], v[92:95]
M v[100:103], a[128:131], a[168:171], v[100:103]
M v[100:103], a[132:135], a[172:175], v[100:103]
 buffer_load_dwordx4 v17, s[56:59], s29 offen offset:1024   lds
M v[108:111], a[140:143], a[172:175], v[108:111]
M v[108:111], a[136:139], a[168:171], v[108:111]
M v[116:119], a[144:147], a[168:171], v[116:119]
M v[116:119], a[148:151], a[172:175], v[116:119]
 s_waitcnt lgkmcnt(6)
M v[124:127], a[156:159], a[172:175], v[124:127]
 s_waitcnt vmcnt(25) lgkmcnt(0)
 buffer_load_dwordx4 v18, s[56:59], s29 offen offset:2048   lds
M v[124:127], a[152:155], a[168:171], v[124:127]
 s_barrier
M v[132:135], a[96:99], a[160:163], v[132:135]
 ds_read_b128 a[168:171], v5 offset:22528
 ds_read_b128 a[172:175], v6 offset:22528
M v[132:135], a[100:103], a[164:167], v[132:135]
 ds_read_b64_tr_b16 a[64:65], v20 offset:16384
 ds_read_b64_tr_b16 a[66:67], v20 offset:17408
M v[140:143], a[108:111], a[164:167], v[140:143]
M v[140:143], a[104:107], a[160:163], v[140:143]
 buffer_load_dwordx4 v19, s[56:59], s29 offen offset:3072   lds
M v[148:151], a[112:115], a[160:163], v[148:151]
 s_add_u32 s29, s29, 128
 ds_read_b64_tr_b16 a[68:69], v20 offset:24576
 ds_read_b64_tr_b16 a[70:71], v20 offset:25600
M v[148:151], a[116:119], a[164:167], v[148:151]
 buffer_store_dwordx4 a[28:31], v7, s[8:11], s3 offen offset:3072 sc1
M v[156:159], a[124:127], a[164:167], v[156:159]
M v[156:159], a[120:123], a[160:163], v[156:159]
 s_add_u32 m0, s23, 131072
 ds_read_b64_tr_b16 a[72:73], v21 offset:16384
 ds_read_b64_tr_b16 a[74:75], v21 offset:17408
M v[164:167], a[128:131], a[160:163], v[164:167]
 buffer_load_dwordx4 v8, s[52:55], s28 offen offset:0   lds
M v[164:167], a[132:135], a[164:167], v[164:167]
M v[172:175], a[140:143], a[164:167], v[172:175]
 ds_read_b64_tr_b16 a[76:77], v21 offset:24576
 ds_read_b64_tr_b16 a[78:79], v21 offset:25600
M v[172:175], a[136:139], a[160:163], v[172:175]
M v[180:183], a[144:147], a[160:163], v[180:183]
M v[180:183], a[148:151], a[164:167], v[180:183]
 s_waitcnt lgkmcnt(8)
 ds_read_b64_tr_b16 a[80:81], v22 offset:16384
 ds_read_b64_tr_b16 a[82:83], v22 offset:17408
M v[188:191], a[156:159], a[164:167], v[188:191]
 buffer_load_dwordx4 v9, s[52:55], s28 offen offset:1024   lds
M v[188:191], a[152:155], a[160:163], v[188:191]
M v[196:199], a[96:99], a[168:171], v[196:199]
 ds_read_b128 a[160:163], v5 offset:32768
 ds_read_b128 a[164:167], v6 offset:32768
M v[196:199], a[100:103], a[172:175], v[196:199]
 ds_read_b64_tr_b16 a[84:85], v22 offset:24576
 ds_read_b64_tr_b16 a[86:87], v22 offset:25600
M v[204:207], a[108:111], a[172:175], v[204:207]
 buffer_load_dwordx4 v10, s[52:55], s28 offen offset:2048   lds
M v[204:207], a[104:107], a[168:171], v[204:207]
 ds_read_b64_tr_b16 a[88:89], v23 offset:16384
 ds_read_b64_tr_b16 a[90:91], v23 offset:17408
M v[212:215], a[112:115], a[168:171], v[212:215]
M v[212:215], a[116:119], a[172:175], v[212:215]
M v[220:223], a[124:127], a[172:175], v[220:223]
 ds_read_b64_tr_b16 a[92:93], v23 offset:24576
 ds_read_b64_tr_b16 a[94:95], v23 offset:25600
M v[220:223], a[120:123], a[168:171], v[220:223]
 buffer_load_dwordx4 v11, s[52:55], s28 offen offset:3072   lds
M v[228:231], a[128:131], a[168:171], v[228:231]
 s_add_u32 s28, s28, 128
M v[228:231], a[132:135], a[172:175], v[228:231]
M v[236:239], a[140:143], a[172:175], v[236:239]
M v[236:239], a[136:139], a[168:171], v[236:239]
M v[244:247], a[144:147], a[168:171], v[244:247]
M v[244:247], a[148:151], a[172:175], v[244:247]
 s_waitcnt lgkmcnt(6)
M v[252:255], a[156:159], a[172:175], v[252:255]
 s_waitcnt vmcnt(28) lgkmcnt(0)
M v[252:255], a[152:155], a[168:171], v[252:255]
 s_barrier
M v[32:35], a[32:35], a[160:163], v[32:35]
 s_add_u32 m0, s23, 147456
 ds_read_b128 a[168:171], v5 offset:34816
 ds_read_b128 a[172:175], v6 offset:34816
M v[32:35], a[36:39], a[164:167], v[32:35]
 ds_read_b64_tr_b16 a[96:97], v1 offset:0
 ds_read_b64_tr_b16 a[98:99], v1 offset:1024
M v[36:39], a[44:47], a[164:167], v[36:39]
 buffer_load_dwordx4 v8, s[52:55], s28 offen offset:0   lds
M v[36:39], a[40:43], a[160:163], v[36:39]
M v[40:43], a[48:51], a[160:163], v[40:43]
 ds_read_b64_tr_b16 a[100:101], v1 offset:8192
 ds_read_b64_tr_b16 a[102:103], v1 offset:9216
M v[40:43], a[52:55], a[164:167], v[40:43]
 buffer_load_dwordx4 v9, s[52:55], s28 offen offset:1024   lds
M v[44:47], a[60:63], a[164:167], v[44:47]
M v[44:47], a[56:59], a[160:163], v[44:47]
 ds_read_b64_tr_b16 a[104:105], v2 offset:0
 ds_read_b64_tr_b16 a[106:107], v2 offset:1024
M v[48:51], a[64:67], a[160:163], v[48:51]
M v[48:51], a[68:71], a[164:167], v[48:51]
M v[52:55], a[76:79], a[164:167], v[52:55]
 ds_read_b64_tr_b16 a[108:109], v2 offset:8192
 ds_read_b64_tr_b16 a[110:111], v2 offset:9216
M v[52:55], a[72:75], a[160:163], v[52:55]
 buffer_load_dwordx4 v10, s[52:55], s28 offen offset:2048   lds
M v[56:59], a[80:83], a[160:163], v[56:59]
M v[56:59], a[84:87], a[164:167], v[56:59]
 s_waitcnt lgkmcnt(8)
 ds_read_b64_tr_b16 a[112:113], v3 offset:0
 ds_read_b64_tr_b16 a[114:115], v3 offset:1024
M v[60:63], a[92:95], a[164:167], v[60:63]
M v[60:63], a[88:91], a[160:163], v[60:63]
 buffer_load_dwordx4 v11, s[52:55], s28 offen offset:3072   lds
M v[68:71], a[32:35], a[168:171], v[68:71]
 s_add_u32 s28, s28, 524160
 ds_read_b128 a[160:163], v5 offset:36864
 ds_read_b128 a[164:167], v6 offset:36864
M v[68:71], a[36:39], a[172:175], v[68:71]
 ds_read_b64_tr_b16 a[116:117], v3 offset:8192
 ds_read_b64_tr_b16 a[118:119], v3 offset:9216
M v[76:79], a[44:47], a[172:175], v[76:79]
M v[76:79], a[40:43], a[168:171], v[76:79]
 s_add_u32 m0, s24, 16384
 ds_read_b64_tr_b16 a[120:121], v4 offset:0
 ds_read_b64_tr_b16 a[122:123], v4 offset:1024
M v[84:87], a[48:51], a[168:171], v[84:87]
 buffer_load_dwordx4 v16, s[56:59], s29 offen offset:0   lds
M v[84:87], a[52:55], a[172:175], v[84:87]
M v[92:95], a[60:63], a[172:175], v[92:95]
 ds_read_b64_tr_b16 a[124:125], v4 offset:8192
 ds_read_b64_tr_b16 a[126:127], v4 offset:9216
M v[92:95], a[56:59], a[168:171], v[92:95]
M v[100:103], a[64:67], a[168:171], v[100:103]
M v[100:103], a[68:71], a[172:175], v[100:103]
 buffer_load_dwordx4 v17, s[56:59], s29 offen offset:1024   lds
M v[108:111], a[76:79], a[172:175], v[108:111]
M v[108:111], a[72:75], a[168:171], v[108:111]
M v[116:119], a[80:83], a[168:171], v[116:119]
M v[116:119], a[84:87], a[172:175], v[116:119]
 s_waitcnt lgkmcnt(6)
M v[124:127], a[92:95], a[172:175], v[124:127]
 s_waitcnt vmcnt(25) lgkmcnt(0)
 buffer_load_dwordx4 v18, s[56:59], s29 offen offset:2048   lds
M v[124:127], a[88:91], a[168:171], v[124:127]
 s_barrier
M v[132:135], a[32:35], a[160:163], v[132:135]
 ds_read_b128 a[168:171], v5 offset:38912
 ds_read_b128 a[172:175], v6 offset:38912
M v[132:135], a[36:39], a[164:167], v[132:135]
 ds_read_b64_tr_b16 a[128:129], v1 offset:16384
 ds_read_b64_tr_b16 a[130:131], v1 offset:17408
M v[140:143], a[44:47], a[164:167], v[140:143]
M v[140:143], a[40:43], a[160:163], v[140:143]
 buffer_load_dwordx4 v19, s[56:59], s29 offen offset:3072   lds
M v[148:151], a[48:51], a[160:163], v[148:151]
 s_add_u32 s29, s29, 128
 ds_read_b64_tr_b16 a[132:133], v1 offset:24576
 ds_read_b64_tr_b16 a[134:135], v1 offset:25600
M v[148:151], a[52:55], a[164:167], v[148:151]
M v[156:159], a[60:63], a[164:167], v[156:159]
M v[156:159], a[56:59], a[160:163], v[156:159]
 s_add_u32 m0, s23, 0
 ds_read_b64_tr_b16 a[136:137], v2 offset:16384
 ds_read_b64_tr_b16 a[138:139], v2 offset:17408
M v[164:167], a[64:67], a[160:163], v[164:167]
 buffer_load_dwordx4 v8, s[52:55], s28 offen offset:0   lds
M v[164:167], a[68:71], a[164:167], v[164:167]
M v[172:175], a[76:79], a[164:167], v[172:175]
 ds_read_b64_tr_b16 a[140:141], v2 offset:24576
 ds_read_b64_tr_b16 a[142:143], v2 offset:25600
M v[172:175], a[72:75], a[160:163], v[172:175]
M v[180:183], a[80:83], a[160:163], v[180:183]
M v[180:183], a[84:87], a[164:167], v[180:183]
 s_waitcnt lgkmcnt(8)
 ds_read_b64_tr_b16 a[144:145], v3 offset:16384
 ds_read_b64_tr_b16 a[146:147], v3 offset:17408
M v[188:191], a[92:95], a[164:167], v[188:191]
 buffer_load_dwordx4 v9, s[52:55], s28 offen offset:1024   lds
M v[188:191], a[88:91], a[160:163], v[188:191]
M v[196:199], a[32:35], a[168:171], v[196:199]
 ds_read_b128 a[160:163], v5 offset:49152
 ds_read_b128 a[164:167], v6 offset:49152
M v[196:199], a[36:39], a[172:175], v[196:199]
 ds_read_b64_tr_b16 a[148:149], v3 offset:24576
 ds_read_b64_tr_b16 a[150:151], v3 offset:25600
M v[204:207], a[44:47], a[172:175], v[204:207]
 buffer_load_dwordx4 v10, s[52:55], s28 offen offset:2048   lds
M v[204:207], a[40:43], a[168:171], v[204:207]
 ds_read_b64_tr_b16 a[152:153], v4 offset:16384
 ds_read_b64_tr_b16 a[154:155], v4 offset:17408
M v[212:215], a[48:51], a[168:171], v[212:215]
M v[212:215], a[52:55], a[172:175], v[212:215]
M v[220:223], a[60:63], a[172:175], v[220:223]
 ds_read_b64_tr_b16 a[156:157], v4 offset:24576
 ds_read_b64_tr_b16 a[158:159], v4 offset:25600
M v[220:223], a[56:59], a[168:171], v[220:223]
 buffer_load_dwordx4 v11, s[52:55], s28 offen offset:3072   lds
M v[228:231], a[64:67], a[168:171], v[228:231]
 s_add_u32 s28, s28, 128
M v[228:231], a[68:71], a[172:175], v[228:231]
M v[236:239], a[76:79], a[172:175], v[236:239]
M v[236:239], a[72:75], a[168:171], v[236:239]
M v[244:247], a[80:83], a[168:171], v[244:247]
M v[244:247], a[84:87], a[172:175], v[244:247]
 s_waitcnt lgkmcnt(6)
M v[252:255], a[92:95], a[172:175], v[252:255]
 s_waitcnt vmcnt(16) lgkmcnt(0)
M v[252:255], a[88:91], a[168:171], v[252:255]
 s_barrier
M v[32:35], a[96:99], a[160:163], v[32:35]
 s_add_u32 m0, s23, 16384
 ds_read_b128 a[168:171], v5 offset:51200
 ds_read_b128 a[172:175], v6 offset:51200
M v[32:35], a[100:103], a[164:167], v[32:35]
 ds_read_b64_tr_b16 a[32:33], v1 offset:32768
 ds_read_b64_tr_b16 a[34:35], v1 offset:33792
M v[36:39], a[108:111], a[164:167], v[36:39]
 buffer_load_dwordx4 v8, s[52:55], s28 offen offset:0   lds
M v[36:39], a[104:107], a[160:163], v[36:39]
 buffer_store_dword v12, v15, s[8:11], s45 offen sc1
M v[40:43], a[112:115], a[160:163], v[40:43]
 s_add_u32 s3, s93, 262144
 ds_read_b64_tr_b16 a[36:37], v1 offset:40960
 ds_read_b64_tr_b16 a[38:39], v1 offset:41984
M v[40:43], a[116:119], a[164:167], v[40:43]
 v_min_u32 v25, 15, v0
 v_lshlrev_b32 v25, 7, v25
M v[44:47], a[124:127], a[164:167], v[44:47]
 v_max_u32 v13, 1024, v25
M v[44:47], a[120:123], a[160:163], v[44:47]
 ds_read_b64_tr_b16 a[40:41], v2 offset:32768
 ds_read_b64_tr_b16 a[42:43], v2 offset:33792
M v[48:51], a[128:131], a[160:163], v[48:51]
 buffer_load_dwordx4 v9, s[52:55], s28 offen offset:1024   lds
M v[48:51], a[132:135], a[164:167], v[48:51]
 buffer_store_dwordx4 v[64:67], v7, s[8:11], s3 offen offset:0 sc1
M v[52:55], a[140:143], a[164:167], v[52:55]
 ds_read_b64_tr_b16 a[44:45], v2 offset:40960
 ds_read_b64_tr_b16 a[46:47], v2 offset:41984
M v[52:55], a[136:139], a[160:163], v[52:55]
M v[56:59], a[144:147], a[160:163], v[56:59]
M v[56:59], a[148:151], a[164:167], v[56:59]
 s_waitcnt lgkmcnt(8)
 ds_read_b64_tr_b16 a[48:49], v3 offset:32768
 ds_read_b64_tr_b16 a[50:51], v3 offset:33792
M v[60:63], a[156:159], a[164:167], v[60:63]
 buffer_load_dwordx4 v10, s[52:55], s28 offen offset:2048   lds
M v[60:63], a[152:155], a[160:163], v[60:63]
M v[68:71], a[96:99], a[168:171], v[68:71]
 ds_read_b128 a[160:163], v5 offset:53248
 ds_read_b128 a[164:167], v6 offset:53248
M v[68:71], a[100:103], a[172:175], v[68:71]
 ds_read_b64_tr_b16 a[52:53], v3 offset:40960
 ds_read_b64_tr_b16 a[54:55], v3 offset:41984
M v[76:79], a[108:111], a[172:175], v[76:79]
 buffer_store_dwordx4 v[72:75], v7, s[8:11], s3 offen offset:1024 sc1
M v[76:79], a[104:107], a[168:171], v[76:79]
 ds_read_b64_tr_b16 a[56:57], v4 offset:32768
 ds_read_b64_tr_b16 a[58:59], v4 offset:33792
M v[84:87], a[112:115], a[168:171], v[84:87]
M v[84:87], a[116:119], a[172:175], v[84:87]
 buffer_load_dwordx4 v11, s[52:55], s28 offen offset:3072   lds
M v[92:95], a[124:127], a[172:175], v[92:95]
 s_add_u32 s28, s28, 524160
 ds_read_b64_tr_b16 a[60:61], v4 offset:40960
 ds_read_b64_tr_b16 a[62:63], v4 offset:41984
M v[92:95], a[120:123], a[168:171], v[92:95]
M v[100:103], a[128:131], a[168:171], v[100:103]
M v[100:103], a[132:135], a[172:175], v[100:103]
M v[108:111], a[140:143], a[172:175], v[108:111]
M v[108:111], a[136:139], a[168:171], v[108:111]
M v[116:119], a[144:147], a[168:171], v[116:119]
M v[116:119], a[148:151], a[172:175], v[116:119]
 s_waitcnt lgkmcnt(6)
M v[124:127], a[156:159], a[172:175], v[124:127]
 s_waitcnt lgkmcnt(0)
M v[124:127], a[152:155], a[168:171], v[124:127]
 s_barrier
M v[132:135], a[96:99], a[160:163], v[132:135]
 ds_read_b128 a[168:171], v5 offset:55296
 ds_read_b128 a[172:175], v6 offset:55296
M v[132:135], a[100:103], a[164:167], v[132:135]
 ds_read_b64_tr_b16 a[64:65], v1 offset:49152
 ds_read_b64_tr_b16 a[66:67], v1 offset:50176
M v[140:143], a[108:111], a[164:167], v[140:143]
 buffer_store_dwordx4 v[80:83], v7, s[8:11], s3 offen offset:2048 sc1
M v[140:143], a[104:107], a[160:163], v[140:143]
M v[148:151], a[112:115], a[160:163], v[148:151]
 ds_read_b64_tr_b16 a[68:69], v1 offset:57344
 ds_read_b64_tr_b16 a[70:71], v1 offset:58368
M v[148:151], a[116:119], a[164:167], v[148:151]
M v[156:159], a[124:127], a[164:167], v[156:159]
M v[156:159], a[120:123], a[160:163], v[156:159]
 ds_read_b64_tr_b16 a[72:73], v2 offset:49152
 ds_read_b64_tr_b16 a[74:75], v2 offset:50176
M v[164:167], a[128:131], a[160:163], v[164:167]
M v[164:167], a[132:135], a[164:167], v[164:167]
M v[172:175], a[140:143], a[164:167], v[172:175]
 ds_read_b64_tr_b16 a[76:77], v2 offset:57344
 ds_read_b64_tr_b16 a[78:79], v2 offset:58368
M v[172:175], a[136:139], a[160:163], v[172:175]
M v[180:183], a[144:147], a[160:163], v[180:183]
M v[180:183], a[148:151], a[164:167], v[180:183]
 s_waitcnt lgkmcnt(8)
 ds_read_b64_tr_b16 a[80:81], v3 offset:49152
 ds_read_b64_tr_b16 a[82:83], v3 offset:50176
M v[188:191], a[156:159], a[164:167], v[188:191]
 buffer_store_dwordx4 v[88:91], v7, s[8:11], s3 offen offset:3072 sc1
M v[188:191], a[152:155], a[160:163], v[188:191]
M v[196:199], a[96:99], a[168:171], v[196:199]
 ds_read_b128 a[160:163], v5 offset:0
 ds_read_b128 a[164:167], v6 offset:0
M v[196:199], a[100:103], a[172:175], v[196:199]
 ds_read_b64_tr_b16 a[84:85], v3 offset:57344
 ds_read_b64_tr_b16 a[86:87], v3 offset:58368
M v[204:207], a[108:111], a[172:175], v[204:207]
M v[204:207], a[104:107], a[168:171], v[204:207]
 ds_read_b64_tr_b16 a[88:89], v4 offset:49152
 ds_read_b64_tr_b16 a[90:91], v4 offset:50176
M v[212:215], a[112:115], a[168:171], v[212:215]
M v[212:215], a[116:119], a[172:175], v[212:215]
M v[220:223], a[124:127], a[172:175], v[220:223]
 ds_read_b64_tr_b16 a[92:93], v4 offset:57344
 ds_read_b64_tr_b16 a[94:95], v4 offset:58368
M v[220:223], a[120:123], a[168:171], v[220:223]
M v[228:231], a[128:131], a[168:171], v[228:231]
M v[228:231], a[132:135], a[172:175], v[228:231]
M v[236:239], a[140:143], a[172:175], v[236:239]
M v[236:239], a[136:139], a[168:171], v[236:239]
M v[244:247], a[144:147], a[168:171], v[244:247]
M v[244:247], a[148:151], a[172:175], v[244:247]
 s_waitcnt lgkmcnt(6)
M v[252:255], a[156:159], a[172:175], v[252:255]
 s_waitcnt vmcnt(21) lgkmcnt(0)
M v[252:255], a[152:155], a[168:171], v[252:255]
 s_barrier
M v[32:35], a[32:35], a[160:163], v[32:35]
 s_add_u32 m0, s23, 32768
 ds_read_b128 a[168:171], v5 offset:2048
 ds_read_b128 a[172:175], v6 offset:2048
M v[32:35], a[36:39], a[164:167], v[32:35]
 ds_read_b64_tr_b16 a[96:97], v20 offset:0
 ds_read_b64_tr_b16 a[98:99], v20 offset:1024
M v[36:39], a[44:47], a[164:167], v[36:39]
 buffer_load_dwordx4 v16, s[56:59], s29 offen offset:0   lds
M v[36:39], a[40:43], a[160:163], v[36:39]
M v[40:43], a[48:51], a[160:163], v[40:43]
 s_add_u32 s3, s93, 270336
 ds_read_b64_tr_b16 a[100:101], v20 offset:8192
 ds_read_b64_tr_b16 a[102:103], v20 offset:9216
M v[40:43], a[52:55], a[164:167], v[40:43]
 buffer_load_dwordx4 v17, s[56:59], s29 offen offset:1024   lds
M v[44:47], a[60:63], a[164:167], v[44:47]
 buffer_store_dwordx4 v[96:99], v7, s[8:11], s3 offen offset:0 sc1
M v[44:47], a[56:59], a[160:163], v[44:47]
 ds_read_b64_tr_b16 a[104:105], v21 offset:0
 ds_read_b64_tr_b16 a[106:107], v21 offset:1024
M v[48:51], a[64:67], a[160:163], v[48:51]
M v[48:51], a[68:71], a[164:167], v[48:51]
 buffer_load_dwordx4 v18, s[56:59], s29 offen offset:2048   lds
M v[52:55], a[76:79], a[164:167], v[52:55]
 ds_read_b64_tr_b16 a[108:109], v21 offset:8192
 ds_read_b64_tr_b16 a[110:111], v21 offset:9216
M v[52:55], a[72:75], a[160:163], v[52:55]
M v[56:59], a[80:83], a[160:163], v[56:59]
M v[56:59], a[84:87], a[164:167], v[56:59]
 s_waitcnt lgkmcnt(8)
 ds_read_b64_tr_b16 a[112:113], v22 offset:0
 ds_read_b64_tr_b16 a[114:115], v22 offset:1024
M v[60:63], a[92:95], a[164:167], v[60:63]
 buffer_load_dwordx4 v19, s[56:59], s29 offen offset:3072   lds
M v[60:63], a[88:91], a[160:163], v[60:63]
 s_add_u32 s29, s29, 128
M v[68:71], a[32:35], a[168:171], v[68:71]
 ds_read_b128 a[160:163], v5 offset:4096
 ds_read_b128 a[164:167], v6 offset:4096
M v[68:71], a[36:39], a[172:175], v[68:71]
 ds_read_b64_tr_b16 a[116:117], v22 offset:8192
 ds_read_b64_tr_b16 a[118:119], v22 offset:9216
M v[76:79], a[44:47], a[172:175], v[76:79]
 s_lshl_b32 s28, s20, 13
 buffer_store_dwordx4 v[104:107], v7, s[8:11], s3 offen offset:1024 sc1
M v[76:79], a[40:43], a[168:171], v[76:79]
 s_lshl_b32 s21, s41, 20
 ds_read_b64_tr_b16 a[120:121], v23 offset:0
 ds_read_b64_tr_b16 a[122:123], v23 offset:1024
M v[84:87], a[48:51], a[168:171], v[84:87]
 s_mov_b32 s22, 0
M v[84:87], a[52:55], a[172:175], v[84:87]
 s_lshl_b32 s7, s41, 18
M v[92:95], a[60:63], a[172:175], v[92:95]
 s_add_u32 s7, s7, 100663296
 ds_read_b64_tr_b16 a[124:125], v23 offset:8192
 ds_read_b64_tr_b16 a[126:127], v23 offset:9216
M v[92:95], a[56:59], a[168:171], v[92:95]
 s_add_u32 s38, s7, 65536
M v[100:103], a[64:67], a[168:171], v[100:103]
 s_add_u32 s64, s42, 1
M v[100:103], a[68:71], a[172:175], v[100:103]
 s_min_u32 s64, s64, 10
M v[108:111], a[76:79], a[172:175], v[108:111]
 s_sub_u32 s27, s64, 3
 buffer_load_dword v24, v13, s[8:11], s46 offen sc1
M v[108:111], a[72:75], a[168:171], v[108:111]
 s_lshl_b32 s6, s64, 1
M v[116:119], a[80:83], a[168:171], v[116:119]
 s_sub_u32 s43, s6, 2
 s_lshl_b32 s64, s42, 16
 s_add_u32 s4, s21, s64
M v[116:119], a[84:87], a[172:175], v[116:119]
 s_waitcnt lgkmcnt(6)
 s_sub_u32 s26, 1114112, s64
 s_add_u32 s26, s26, s21
M v[124:127], a[92:95], a[172:175], v[124:127]
 s_waitcnt vmcnt(20) lgkmcnt(0)
 s_lshl_b32 s64, s42, 1
 s_sub_u32 s64, 32, s64
M v[124:127], a[88:91], a[168:171], v[124:127]
 s_barrier
M v[132:135], a[32:35], a[160:163], v[132:135]
 s_cmp_ge_u32 s42, 10
 ds_read_b128 a[168:171], v5 offset:6144
 ds_read_b128 a[172:175], v6 offset:6144
M v[132:135], a[36:39], a[164:167], v[132:135]
 s_cselect_b32 s25, s64, 32767
 ds_read_b64_tr_b16 a[128:129], v20 offset:16384
 ds_read_b64_tr_b16 a[130:131], v20 offset:17408
M v[140:143], a[44:47], a[164:167], v[140:143]
 s_mov_b32 s23, 0
 buffer_store_dwordx4 v[112:115], v7, s[8:11], s3 offen offset:2048 sc1
M v[140:143], a[40:43], a[160:163], v[140:143]
M v[148:151], a[48:51], a[160:163], v[148:151]
 ds_read_b64_tr_b16 a[132:133], v20 offset:24576
 ds_read_b64_tr_b16 a[134:135], v20 offset:25600
M v[148:151], a[52:55], a[164:167], v[148:151]
M v[156:159], a[60:63], a[164:167], v[156:159]
M v[156:159], a[56:59], a[160:163], v[156:159]
 ds_read_b64_tr_b16 a[136:137], v21 offset:16384
 ds_read_b64_tr_b16 a[138:139], v21 offset:17408
M v[164:167], a[64:67], a[160:163], v[164:167]
M v[164:167], a[68:71], a[164:167], v[164:167]
M v[172:175], a[76:79], a[164:167], v[172:175]
 ds_read_b64_tr_b16 a[140:141], v21 offset:24576
 ds_read_b64_tr_b16 a[142:143], v21 offset:25600
M v[172:175], a[72:75], a[160:163], v[172:175]
M v[180:183], a[80:83], a[160:163], v[180:183]
M v[180:183], a[84:87], a[164:167], v[180:183]
 s_waitcnt lgkmcnt(8)
 ds_read_b64_tr_b16 a[144:145], v22 offset:16384
 ds_read_b64_tr_b16 a[146:147], v22 offset:17408
M v[188:191], a[92:95], a[164:167], v[188:191]
 buffer_store_dwordx4 v[120:123], v7, s[8:11], s3 offen offset:3072 sc1
M v[188:191], a[88:91], a[160:163], v[188:191]
M v[196:199], a[32:35], a[168:171], v[196:199]
 ds_read_b128 a[160:163], v5 offset:16384
 ds_read_b128 a[164:167], v6 offset:16384
M v[196:199], a[36:39], a[172:175], v[196:199]
 ds_read_b64_tr_b16 a[148:149], v22 offset:24576
 ds_read_b64_tr_b16 a[150:151], v22 offset:25600
M v[204:207], a[44:47], a[172:175], v[204:207]
M v[204:207], a[40:43], a[168:171], v[204:207]
 ds_read_b64_tr_b16 a[152:153], v23 offset:16384
 ds_read_b64_tr_b16 a[154:155], v23 offset:17408
M v[212:215], a[48:51], a[168:171], v[212:215]
M v[212:215], a[52:55], a[172:175], v[212:215]
M v[220:223], a[60:63], a[172:175], v[220:223]
 ds_read_b64_tr_b16 a[156:157], v23 offset:24576
 ds_read_b64_tr_b16 a[158:159], v23 offset:25600
M v[220:223], a[56:59], a[168:171], v[220:223]
M v[228:231], a[64:67], a[168:171], v[228:231]
M v[228:231], a[68:71], a[172:175], v[228:231]
M v[236:239], a[76:79], a[172:175], v[236:239]
M v[236:239], a[72:75], a[168:171], v[236:239]
M v[244:247], a[80:83], a[168:171], v[244:247]
M v[244:247], a[84:87], a[172:175], v[244:247]
 s_waitcnt lgkmcnt(6)
M v[252:255], a[92:95], a[172:175], v[252:255]
 s_waitcnt vmcnt(18) lgkmcnt(0)
M v[252:255], a[88:91], a[168:171], v[252:255]
 s_barrier
M v[32:35], a[96:99], a[160:163], v[32:35]
 ds_read_b128 a[168:171], v5 offset:18432
 ds_read_b128 a[172:175], v6 offset:18432
M v[32:35], a[100:103], a[164:167], v[32:35]
 ds_read_b64_tr_b16 a[32:33], v1 offset:0
 ds_read_b64_tr_b16 a[34:35], v1 offset:1024
M v[36:39], a[108:111], a[164:167], v[36:39]
 v_add_u32 v10, s28, v7
 v_add_u32 v11, 0x1000, v10
M v[36:39], a[104:107], a[160:163], v[36:39]
 s_waitcnt vmcnt(2)
 v_cmp_eq_u32 vcc, 0, v24
 s_add_u32 s3, s93, 524288
M v[40:43], a[112:115], a[160:163], v[40:43]
 s_lshl_b32 s64, s20, 10
 ds_read_b64_tr_b16 a[36:37], v1 offset:8192
 ds_read_b64_tr_b16 a[38:39], v1 offset:9216
M v[40:43], a[116:119], a[164:167], v[40:43]
 s_cbranch_vccnz L_f1s14
L_f1r14:
M v[44:47], a[124:127], a[164:167], v[44:47]
 s_add_u32 m0, s28, 98304
 s_nop 0
 buffer_load_dwordx4 v10, s[8:11], s21 offen offset:0 sc1 lds
M v[44:47], a[120:123], a[160:163], v[44:47]
 ds_read_b64_tr_b16 a[40:41], v2 offset:0
 ds_read_b64_tr_b16 a[42:43], v2 offset:1024
M v[48:51], a[128:131], a[160:163], v[48:51]
 buffer_store_dwordx4 v[128:131], v7, s[8:11], s3 offen offset:0 sc1
M v[48:51], a[132:135], a[164:167], v[48:51]
M v[52:55], a[140:143], a[164:167], v[52:55]
 ds_read_b64_tr_b16 a[44:45], v2 offset:8192
 ds_read_b64_tr_b16 a[46:47], v2 offset:9216
M v[52:55], a[136:139], a[160:163], v[52:55]
 buffer_load_dwordx4 v10, s[8:11], s21 offen offset:1024 sc1 lds
M v[56:59], a[144:147], a[160:163], v[56:59]
M v[56:59], a[148:151], a[164:167], v[56:59]
 s_waitcnt lgkmcnt(8)
 ds_read_b64_tr_b16 a[48:49], v3 offset:0
 ds_read_b64_tr_b16 a[50:51], v3 offset:1024
M v[60:63], a[156:159], a[164:167], v[60:63]
M v[60:63], a[152:155], a[160:163], v[60:63]
 buffer_load_dwordx4 v10, s[8:11], s21 offen offset:2048 sc1 lds
M v[68:71], a[96:99], a[168:171], v[68:71]
 ds_read_b128 a[160:163], v5 offset:20480
 ds_read_b128 a[164:167], v6 offset:20480
M v[68:71], a[100:103], a[172:175], v[68:71]
 ds_read_b64_tr_b16 a[52:53], v3 offset:8192
 ds_read_b64_tr_b16 a[54:55], v3 offset:9216
M v[76:79], a[108:111], a[172:175], v[76:79]
 buffer_store_dwordx4 v[136:139], v7, s[8:11], s3 offen offset:1024 sc1
M v[76:79], a[104:107], a[168:171], v[76:79]
 ds_read_b64_tr_b16 a[56:57], v4 offset:0
 ds_read_b64_tr_b16 a[58:59], v4 offset:1024
M v[84:87], a[112:115], a[168:171], v[84:87]
 buffer_load_dwordx4 v10, s[8:11], s21 offen offset:3072 sc1 lds
M v[84:87], a[116:119], a[172:175], v[84:87]
 s_add_u32 m0, s28, 102400
M v[92:95], a[124:127], a[172:175], v[92:95]
 ds_read_b64_tr_b16 a[60:61], v4 offset:8192
 ds_read_b64_tr_b16 a[62:63], v4 offset:9216
M v[92:95], a[120:123], a[168:171], v[92:95]
M v[100:103], a[128:131], a[168:171], v[100:103]
 buffer_load_dwordx4 v11, s[8:11], s21 offen offset:0 sc1 lds
M v[100:103], a[132:135], a[172:175], v[100:103]
M v[108:111], a[140:143], a[172:175], v[108:111]
M v[108:111], a[136:139], a[168:171], v[108:111]
M v[116:119], a[144:147], a[168:171], v[116:119]
 buffer_load_dwordx4 v11, s[8:11], s21 offen offset:1024 sc1 lds
M v[116:119], a[148:151], a[172:175], v[116:119]
 s_waitcnt lgkmcnt(6)
M v[124:127], a[156:159], a[172:175], v[124:127]
 s_waitcnt lgkmcnt(0)
 buffer_load_dwordx4 v11, s[8:11], s21 offen offset:2048 sc1 lds
M v[124:127], a[152:155], a[168:171], v[124:127]
 s_barrier
M v[132:135], a[96:99], a[160:163], v[132:135]
 ds_read_b128 a[168:171], v5 offset:22528
 ds_read_b128 a[172:175], v6 offset:22528
M v[132:135], a[100:103], a[164:167], v[132:135]
 ds_read_b64_tr_b16 a[64:65], v1 offset:16384
 ds_read_b64_tr_b16 a[66:67], v1 offset:17408
M v[140:143], a[108:111], a[164:167], v[140:143]
 buffer_load_dwordx4 v11, s[8:11], s21 offen offset:3072 sc1 lds
M v[140:143], a[104:107], a[160:163], v[140:143]
 s_add_u32 s24, s23, 16777216
 buffer_store_dwordx4 v[144:147], v7, s[8:11], s3 offen offset:2048 sc1
M v[148:151], a[112:115], a[160:163], v[148:151]
 s_mov_b32 s23, s21
 ds_read_b64_tr_b16 a[68:69], v1 offset:24576
 ds_read_b64_tr_b16 a[70:71], v1 offset:25600
M v[148:151], a[116:119], a[164:167], v[148:151]
 s_add_u32 s21, s21, 32768
M v[156:159], a[124:127], a[164:167], v[156:159]
 s_add_u32 s22, s22, 1
M v[156:159], a[120:123], a[160:163], v[156:159]
 s_cmp_eq_u32 s22, s25
 ds_read_b64_tr_b16 a[72:73], v2 offset:16384
 ds_read_b64_tr_b16 a[74:75], v2 offset:17408
M v[164:167], a[128:131], a[160:163], v[164:167]
 s_cselect_b32 s21, s26, s21
 v_subrev_u32 v5, 0x10000, v5
 v_subrev_u32 v6, 0x10000, v6
M v[164:167], a[132:135], a[164:167], v[164:167]
 s_cmp_eq_u32 s22, s43
M v[172:175], a[140:143], a[164:167], v[172:175]
 s_cselect_b32 s21, s4, s21
 ds_read_b64_tr_b16 a[76:77], v2 offset:24576
 ds_read_b64_tr_b16 a[78:79], v2 offset:25600
M v[172:175], a[136:139], a[160:163], v[172:175]
 s_cmp_eq_u32 s22, s6
M v[180:183], a[144:147], a[160:163], v[180:183]
 s_cselect_b32 s21, s7, s21
 v_mov_b32 v9, v25
 v_lshrrev_b32 v24, 4, v0
M v[180:183], a[148:151], a[164:167], v[180:183]
 s_waitcnt lgkmcnt(8)
 ds_read_b64_tr_b16 a[80:81], v3 offset:16384
 ds_read_b64_tr_b16 a[82:83], v3 offset:17408
M v[188:191], a[156:159], a[164:167], v[188:191]
 v_lshlrev_b32 v24, 2, v24
 v_and_b32 v25, 15, v0
M v[188:191], a[152:155], a[160:163], v[188:191]
 v_sub_u32 v24, v24, v25
M v[196:199], a[96:99], a[168:171], v[196:199]
 s_add_u32 s64, s64, s34
 ds_read_b128 a[160:163], v5 offset:32768
 ds_read_b128 a[164:167], v6 offset:32768
M v[196:199], a[100:103], a[172:175], v[196:199]
 s_add_u32 s52, s64, 65536
 ds_read_b64_tr_b16 a[84:85], v3 offset:24576
 ds_read_b64_tr_b16 a[86:87], v3 offset:25600
M v[204:207], a[108:111], a[172:175], v[204:207]
 s_mov_b32 s55, 0x21800000
 buffer_store_dwordx4 v[152:155], v7, s[8:11], s3 offen offset:3072 sc1
M v[204:207], a[104:107], a[168:171], v[204:207]
 s_cmp_eq_u32 s20, 0
 ds_read_b64_tr_b16 a[88:89], v4 offset:16384
 ds_read_b64_tr_b16 a[90:91], v4 offset:17408
M v[212:215], a[112:115], a[168:171], v[212:215]
 s_cselect_b32 s54, s39, 0
M v[212:215], a[116:119], a[172:175], v[212:215]
 s_lshr_b32 s64, s20, 1
M v[220:223], a[124:127], a[172:175], v[220:223]
 s_lshl_b32 s64, s64, 17
 ds_read_b64_tr_b16 a[92:93], v4 offset:24576
 ds_read_b64_tr_b16 a[94:95], v4 offset:25600
M v[220:223], a[120:123], a[168:171], v[220:223]
 s_and_b32 s65, s20, 1
M v[228:231], a[128:131], a[168:171], v[228:231]
 s_lshl_b32 s65, s65, 12
M v[228:231], a[132:135], a[172:175], v[228:231]
 s_add_u32 s64, s64, s65
 v_add_u32 v14, s64, v7
 v_mov_b32 v8, 0xff800000
M v[236:239], a[140:143], a[172:175], v[236:239]
 v_cmp_lt_i32 s[16:17], 0, v24
 v_cmp_lt_i32 s[18:19], -1, v24
M v[236:239], a[136:139], a[168:171], v[236:239]
 v_cmp_lt_i32 s[48:49], -2, v24
 v_cmp_lt_i32 s[50:51], -3, v24
M v[244:247], a[144:147], a[168:171], v[244:247]
M v[244:247], a[148:151], a[172:175], v[244:247]
 s_waitcnt lgkmcnt(6)
M v[252:255], a[156:159], a[172:175], v[252:255]
 s_waitcnt lgkmcnt(0)
M v[252:255], a[152:155], a[168:171], v[252:255]
 s_barrier
M v[32:35], a[32:35], a[160:163], v[32:35]
 ds_read_b128 a[168:171], v5 offset:34816
 ds_read_b128 a[172:175], v6 offset:34816
M v[32:35], a[36:39], a[164:167], v[32:35]
 buffer_load_dword v24, v9, s[8:11], s46 offen sc1
M v[36:39], a[44:47], a[164:167], v[36:39]
 v_mov_b32 v1, v15
 v_add_u32 v2, 0x10000, v7
M v[36:39], a[40:43], a[160:163], v[36:39]
 v_mov_b32 v3, v10
 v_mov_b32 v4, v11
M v[40:43], a[48:51], a[160:163], v[40:43]
 s_mov_b64 s[60:61], s[76:77]
M v[40:43], a[52:55], a[164:167], v[40:43]
 s_mov_b32 s62, s78
M v[44:47], a[60:63], a[164:167], v[44:47]
 s_mov_b32 s63, 0x20000
 v_lshl_add_u32 v10, v0, 7, s95
 v_and_b32 v0, 48, v0
M v[44:47], a[56:59], a[160:163], v[44:47]
 v_lshl_add_u32 v0, v0, 24, v10
 v_mul_f32 v32, s5, v32
M v[48:51], a[64:67], a[160:163], v[48:51]
 v_mul_f32 v33, s5, v33
 v_mul_f32 v34, s5, v34
M v[48:51], a[68:71], a[164:167], v[48:51]
 v_mul_f32 v35, s5, v35
 v_mul_f32 v36, s5, v36
M v[52:55], a[76:79], a[164:167], v[52:55]
 v_mul_f32 v37, s5, v37
 v_mul_f32 v38, s5, v38
M v[52:55], a[72:75], a[160:163], v[52:55]
 v_mul_f32 v39, s5, v39
 v_cvt_pk_bf16_f32 v32, v32, v33
M v[56:59], a[80:83], a[160:163], v[56:59]
 v_cvt_pk_bf16_f32 v33, v34, v35
 v_cvt_pk_bf16_f32 v34, v36, v37
M v[56:59], a[84:87], a[164:167], v[56:59]
 s_waitcnt lgkmcnt(0)
 v_cvt_pk_bf16_f32 v35, v38, v39
 ds_write_b128 v14, v[32:35] offset:0
M v[60:63], a[92:95], a[164:167], v[60:63]
 s_add_u32 s3, s93, 532480
 buffer_store_dwordx4 v[160:163], v7, s[8:11], s3 offen offset:0 sc1
M v[60:63], a[88:91], a[160:163], v[60:63]
 v_mul_f32 v40, s5, v40
 v_mul_f32 v41, s5, v41
M v[68:71], a[32:35], a[168:171], v[68:71]
 ds_read_b128 a[160:163], v5 offset:36864
 ds_read_b128 a[164:167], v6 offset:36864
M v[68:71], a[36:39], a[172:175], v[68:71]
 v_mul_f32 v42, s5, v42
 v_mul_f32 v43, s5, v43
M v[76:79], a[44:47], a[172:175], v[76:79]
 v_mul_f32 v44, s5, v44
 v_mul_f32 v45, s5, v45
M v[76:79], a[40:43], a[168:171], v[76:79]
 v_mul_f32 v46, s5, v46
 v_mul_f32 v47, s5, v47
M v[84:87], a[48:51], a[168:171], v[84:87]
 v_cvt_pk_bf16_f32 v40, v40, v41
 v_cvt_pk_bf16_f32 v41, v42, v43
M v[84:87], a[52:55], a[172:175], v[84:87]
 v_cvt_pk_bf16_f32 v42, v44, v45
 v_cvt_pk_bf16_f32 v43, v46, v47
M v[92:95], a[60:63], a[172:175], v[92:95]
 ds_write_b128 v14, v[40:43] offset:1024
M v[92:95], a[56:59], a[168:171], v[92:95]
 buffer_store_dwordx4 v[168:171], v7, s[8:11], s3 offen offset:1024 sc1
M v[100:103], a[64:67], a[168:171], v[100:103]
 v_mul_f32 v48, s5, v48
 v_mul_f32 v49, s5, v49
M v[100:103], a[68:71], a[172:175], v[100:103]
 v_mul_f32 v50, s5, v50
 v_mul_f32 v51, s5, v51
M v[108:111], a[76:79], a[172:175], v[108:111]
 v_mul_f32 v52, s5, v52
 v_mul_f32 v53, s5, v53
M v[108:111], a[72:75], a[168:171], v[108:111]
 v_mul_f32 v54, s5, v54
 v_mul_f32 v55, s5, v55
M v[116:119], a[80:83], a[168:171], v[116:119]
 v_cvt_pk_bf16_f32 v48, v48, v49
 v_cvt_pk_bf16_f32 v49, v50, v51
M v[116:119], a[84:87], a[172:175], v[116:119]
 s_waitcnt lgkmcnt(1)
 v_cvt_pk_bf16_f32 v50, v52, v53
 v_cvt_pk_bf16_f32 v51, v54, v55
M v[124:127], a[92:95], a[172:175], v[124:127]
 ds_write_b128 v14, v[48:51] offset:2048
M v[124:127], a[88:91], a[168:171], v[124:127]
 buffer_store_dwordx4 v[176:179], v7, s[8:11], s3 offen offset:2048 sc1
M v[132:135], a[32:35], a[160:163], v[132:135]
 ds_read_b128 a[168:171], v5 offset:38912
 ds_read_b128 a[172:175], v6 offset:38912
M v[132:135], a[36:39], a[164:167], v[132:135]
 v_mul_f32 v56, s5, v56
 v_mul_f32 v57, s5, v57
M v[140:143], a[44:47], a[164:167], v[140:143]
 v_mul_f32 v58, s5, v58
 v_mul_f32 v59, s5, v59
M v[140:143], a[40:43], a[160:163], v[140:143]
 v_mul_f32 v60, s5, v60
 v_mul_f32 v61, s5, v61
M v[148:151], a[48:51], a[160:163], v[148:151]
 v_mul_f32 v62, s5, v62
 v_mul_f32 v63, s5, v63
M v[148:151], a[52:55], a[164:167], v[148:151]
 v_cvt_pk_bf16_f32 v56, v56, v57
 v_cvt_pk_bf16_f32 v57, v58, v59
M v[156:159], a[60:63], a[164:167], v[156:159]
 v_cvt_pk_bf16_f32 v58, v60, v61
 v_cvt_pk_bf16_f32 v59, v62, v63
M v[156:159], a[56:59], a[160:163], v[156:159]
 s_waitcnt lgkmcnt(0)
 ds_write_b128 v14, v[56:59] offset:3072
M v[164:167], a[64:67], a[160:163], v[164:167]
 s_barrier
M v[164:167], a[68:71], a[164:167], v[164:167]
M v[172:175], a[76:79], a[164:167], v[172:175]
 s_add_u32 m0, s28, 32768
 s_nop 0
 buffer_load_dwordx4 v3, s[8:11], s21 offen offset:0 sc1 lds
M v[172:175], a[72:75], a[160:163], v[172:175]
M v[180:183], a[80:83], a[160:163], v[180:183]
 buffer_store_dwordx4 v[184:187], v7, s[8:11], s3 offen offset:3072 sc1
M v[180:183], a[84:87], a[164:167], v[180:183]
 v_mul_f32 v68, s5, v68
 v_mul_f32 v69, s5, v69
M v[188:191], a[92:95], a[164:167], v[188:191]
 buffer_load_dwordx4 v3, s[8:11], s21 offen offset:1024 sc1 lds
M v[188:191], a[88:91], a[160:163], v[188:191]
 v_mul_f32 v70, s5, v70
 v_mul_f32 v71, s5, v71
M v[196:199], a[32:35], a[168:171], v[196:199]
 v_mul_f32 v76, s5, v76
 v_mul_f32 v77, s5, v77
M v[196:199], a[36:39], a[172:175], v[196:199]
 v_mul_f32 v78, s5, v78
 v_mul_f32 v79, s5, v79
M v[204:207], a[44:47], a[172:175], v[204:207]
 buffer_load_dwordx4 v3, s[8:11], s21 offen offset:2048 sc1 lds
M v[204:207], a[40:43], a[168:171], v[204:207]
 v_cvt_pk_bf16_f32 v68, v68, v69
 v_cvt_pk_bf16_f32 v69, v70, v71
M v[212:215], a[48:51], a[168:171], v[212:215]
 v_cvt_pk_bf16_f32 v70, v76, v77
 v_cvt_pk_bf16_f32 v71, v78, v79
M v[212:215], a[52:55], a[172:175], v[212:215]
 ds_write_b128 v14, v[68:71] offset:8192
 v_mul_f32 v84, s5, v84
M v[220:223], a[60:63], a[172:175], v[220:223]
 buffer_load_dwordx4 v3, s[8:11], s21 offen offset:3072 sc1 lds
M v[220:223], a[56:59], a[168:171], v[220:223]
 s_add_u32 m0, s28, 36864
 v_mul_f32 v85, s5, v85
 v_mul_f32 v86, s5, v86
M v[228:231], a[64:67], a[168:171], v[228:231]
 v_mul_f32 v87, s5, v87
 v_mul_f32 v92, s5, v92
M v[228:231], a[68:71], a[172:175], v[228:231]
 v_mul_f32 v93, s5, v93
 v_mul_f32 v94, s5, v94
M v[236:239], a[76:79], a[172:175], v[236:239]
 buffer_load_dwordx4 v4, s[8:11], s21 offen offset:0 sc1 lds
M v[236:239], a[72:75], a[168:171], v[236:239]
 v_mul_f32 v95, s5, v95
 v_cvt_pk_bf16_f32 v84, v84, v85
M v[244:247], a[80:83], a[168:171], v[244:247]
 v_cvt_pk_bf16_f32 v85, v86, v87
 v_cvt_pk_bf16_f32 v86, v92, v93
M v[244:247], a[84:87], a[172:175], v[244:247]
 v_cvt_pk_bf16_f32 v87, v94, v95
 ds_write_b128 v14, v[84:87] offset:9216
M v[252:255], a[92:95], a[172:175], v[252:255]
 buffer_load_dwordx4 v4, s[8:11], s21 offen offset:1024 sc1 lds
M v[252:255], a[88:91], a[168:171], v[252:255]
 buffer_load_dwordx4 v4, s[8:11], s21 offen offset:2048 sc1 lds
 buffer_load_dwordx4 v4, s[8:11], s21 offen offset:3072 sc1 lds
 s_add_u32 s24, s23, 16777216
 s_mov_b32 s23, s21
 s_add_u32 s21, s21, 32768
 s_add_u32 s22, s22, 1
 s_cmp_eq_u32 s22, s25
 s_cselect_b32 s21, s26, s21
 s_cmp_eq_u32 s22, s43
 s_cselect_b32 s21, s4, s21
 s_cmp_eq_u32 s22, s6
 s_cselect_b32 s21, s7, s21
 v_mul_f32 v100, s5, v100
 v_mul_f32 v101, s5, v101
 v_mul_f32 v102, s5, v102
 v_mul_f32 v103, s5, v103
 v_mul_f32 v108, s5, v108
 v_mul_f32 v109, s5, v109
 v_mul_f32 v110, s5, v110
 v_mul_f32 v111, s5, v111
 v_cvt_pk_bf16_f32 v100, v100, v101
 v_cvt_pk_bf16_f32 v101, v102, v103
 v_cvt_pk_bf16_f32 v102, v108, v109
 v_cvt_pk_bf16_f32 v103, v110, v111
 ds_write_b128 v14, v[100:103] offset:10240
 v_pk_mul_f32 v[116:117], v[116:117], s[4:5] op_sel:[0,1] op_sel_hi:[1,1]
 v_pk_mul_f32 v[118:119], v[118:119], s[4:5] op_sel:[0,1] op_sel_hi:[1,1]
 v_pk_mul_f32 v[124:125], v[124:125], s[4:5] op_sel:[0,1] op_sel_hi:[1,1]
 v_pk_mul_f32 v[126:127], v[126:127], s[4:5] op_sel:[0,1] op_sel_hi:[1,1]
 v_cvt_pk_bf16_f32 v116, v116, v117
 v_cvt_pk_bf16_f32 v117, v118, v119
 v_cvt_pk_bf16_f32 v118, v124, v125
 v_cvt_pk_bf16_f32 v119, v126, v127
 ds_write_b128 v14, v[116:119] offset:11264
 v_pk_mul_f32 v[132:133], v[132:133], s[4:5] op_sel:[0,1] op_sel_hi:[1,1]
 v_pk_mul_f32 v[134:135], v[134:135], s[4:5] op_sel:[0,1] op_sel_hi:[1,1]
 v_pk_mul_f32 v[140:141], v[140:141], s[4:5] op_sel:[0,1] op_sel_hi:[1,1]
 v_pk_mul_f32 v[142:143], v[142:143], s[4:5] op_sel:[0,1] op_sel_hi:[1,1]
 v_cvt_pk_bf16_f32 v132, v132, v133
 v_cvt_pk_bf16_f32 v133, v134, v135
 v_cvt_pk_bf16_f32 v134, v140, v141
 v_cvt_pk_bf16_f32 v135, v142, v143
 ds_write_b128 v14, v[132:135] offset:16384
 v_pk_mul_f32 v[148:149], v[148:149], s[4:5] op_sel:[0,1] op_sel_hi:[1,1]
 v_pk_mul_f32 v[150:151], v[150:151], s[4:5] op_sel:[0,1] op_sel_hi:[1,1]
 v_pk_mul_f32 v[156:157], v[156:157], s[4:5] op_sel:[0,1] op_sel_hi:[1,1]
 v_pk_mul_f32 v[158:159], v[158:159], s[4:5] op_sel:[0,1] op_sel_hi:[1,1]
 v_cvt_pk_bf16_f32 v148, v148, v149
 v_cvt_pk_bf16_f32 v149, v150, v151
 v_cvt_pk_bf16_f32 v150, v156, v157
 v_cvt_pk_bf16_f32 v151, v158, v159
 ds_write_b128 v14, v[148:151] offset:17408
 v_pk_mul_f32 v[164:165], v[164:165], s[4:5] op_sel:[0,1] op_sel_hi:[1,1]
 v_pk_mul_f32 v[166:167], v[166:167], s[4:5] op_sel:[0,1] op_sel_hi:[1,1]
 v_pk_mul_f32 v[172:173], v[172:173], s[4:5] op_sel:[0,1] op_sel_hi:[1,1]
 v_pk_mul_f32 v[174:175], v[174:175], s[4:5] op_sel:[0,1] op_sel_hi:[1,1]
 v_cvt_pk_bf16_f32 v164, v164, v165
 v_cvt_pk_bf16_f32 v165, v166, v167
 v_cvt_pk_bf16_f32 v166, v172, v173
 v_cvt_pk_bf16_f32 v167, v174, v175
 ds_write_b128 v14, v[164:167] offset:18432
 v_pk_mul_f32 v[180:181], v[180:181], s[4:5] op_sel:[0,1] op_sel_hi:[1,1]
 v_pk_mul_f32 v[182:183], v[182:183], s[4:5] op_sel:[0,1] op_sel_hi:[1,1]
 v_pk_mul_f32 v[188:189], v[188:189], s[4:5] op_sel:[0,1] op_sel_hi:[1,1]
 v_pk_mul_f32 v[190:191], v[190:191], s[4:5] op_sel:[0,1] op_sel_hi:[1,1]
 v_cvt_pk_bf16_f32 v180, v180, v181
 v_cvt_pk_bf16_f32 v181, v182, v183
 v_cvt_pk_bf16_f32 v182, v188, v189
 v_cvt_pk_bf16_f32 v183, v190, v191
 ds_write_b128 v14, v[180:183] offset:19456
 v_pk_mul_f32 v[196:197], v[196:197], s[4:5] op_sel:[0,1] op_sel_hi:[1,1]
 v_pk_mul_f32 v[198:199], v[198:199], s[4:5] op_sel:[0,1] op_sel_hi:[1,1]
 v_pk_mul_f32 v[204:205], v[204:205], s[4:5] op_sel:[0,1] op_sel_hi:[1,1]
 v_pk_mul_f32 v[206:207], v[206:207], s[4:5] op_sel:[0,1] op_sel_hi:[1,1]
 v_cvt_pk_bf16_f32 v196, v196, v197
 v_cvt_pk_bf16_f32 v197, v198, v199
 v_cvt_pk_bf16_f32 v198, v204, v205
 v_cvt_pk_bf16_f32 v199, v206, v207
 ds_write_b128 v14, v[196:199] offset:24576
 v_pk_mul_f32 v[212:213], v[212:213], s[4:5] op_sel:[0,1] op_sel_hi:[1,1]
 v_pk_mul_f32 v[214:215], v[214:215], s[4:5] op_sel:[0,1] op_sel_hi:[1,1]
 v_pk_mul_f32 v[220:221], v[220:221], s[4:5] op_sel:[0,1] op_sel_hi:[1,1]
 v_pk_mul_f32 v[222:223], v[222:223], s[4:5] op_sel:[0,1] op_sel_hi:[1,1]
 v_cvt_pk_bf16_f32 v212, v212, v213
 v_cvt_pk_bf16_f32 v213, v214, v215
 v_cvt_pk_bf16_f32 v214, v220, v221
 v_cvt_pk_bf16_f32 v215, v222, v223
 ds_write_b128 v14, v[212:215] offset:25600
 v_pk_mul_f32 v[228:229], v[228:229], s[4:5] op_sel:[0,1] op_sel_hi:[1,1]
 v_pk_mul_f32 v[230:231], v[230:231], s[4:5] op_sel:[0,1] op_sel_hi:[1,1]
 v_pk_mul_f32 v[236:237], v[236:237], s[4:5] op_sel:[0,1] op_sel_hi:[1,1]
 v_pk_mul_f32 v[238:239], v[238:239], s[4:5] op_sel:[0,1] op_sel_hi:[1,1]
 v_cvt_pk_bf16_f32 v228, v228, v229
 v_cvt_pk_bf16_f32 v229, v230, v231
 v_cvt_pk_bf16_f32 v230, v236, v237
 v_cvt_pk_bf16_f32 v231, v238, v239
 ds_write_b128 v14, v[228:231] offset:26624
 v_pk_mul_f32 v[244:245], v[244:245], s[4:5] op_sel:[0,1] op_sel_hi:[1,1]
 v_pk_mul_f32 v[246:247], v[246:247], s[4:5] op_sel:[0,1] op_sel_hi:[1,1]
 v_pk_mul_f32 v[252:253], v[252:253], s[4:5] op_sel:[0,1] op_sel_hi:[1,1]
 v_pk_mul_f32 v[254:255], v[254:255], s[4:5] op_sel:[0,1] op_sel_hi:[1,1]
 v_cvt_pk_bf16_f32 v244, v244, v245
 v_cvt_pk_bf16_f32 v245, v246, v247
 v_cvt_pk_bf16_f32 v246, v252, v253
 v_cvt_pk_bf16_f32 v247, v254, v255
 ds_write_b128 v14, v[244:247] offset:27648
 s_waitcnt vmcnt(15) lgkmcnt(0)
 s_barrier
 ds_read_b128 a[64:67], v2 offset:32768
 ds_read_b128 a[68:71], v2 offset:33792
 ds_read_b128 a[72:75], v2 offset:34816
 ds_read_b128 a[76:79], v2 offset:35840
 ds_read_b128 a[80:83], v2 offset:36864
 ds_read_b128 a[84:87], v2 offset:37888
 ds_read_b128 a[88:91], v2 offset:38912
 ds_read_b128 a[92:95], v2 offset:39936
 s_lshl_b32 s64, s20, 13
 s_sub_u32 s65, 155648, s64
 v_add_u32 v10, s64, v7
 v_add_u32 v11, s65, v7
 ds_read_b128 a[0:3], v10 offset:0
 ds_read_b128 a[4:7], v10 offset:1024
 ds_read_b128 a[8:11], v10 offset:2048
 ds_read_b128 a[12:15], v10 offset:3072
 ds_read_b128 a[16:19], v10 offset:4096
 ds_read_b128 a[20:23], v10 offset:5120
 ds_read_b128 a[24:27], v10 offset:6144
 ds_read_b128 a[28:31], v10 offset:7168
 ds_read_b128 a[32:35], v11 offset:0
 ds_read_b128 a[36:39], v11 offset:1024
 ds_read_b128 a[40:43], v11 offset:2048
 ds_read_b128 a[44:47], v11 offset:3072
 ds_read_b128 a[48:51], v11 offset:4096
 ds_read_b128 a[52:55], v11 offset:5120
 ds_read_b128 a[56:59], v11 offset:6144
 ds_read_b128 a[60:63], v11 offset:7168
 s_waitcnt vmcnt(12)
 v_cmp_eq_u32 vcc, 0, v24
 v_mov_b32 v17, 3
 v_or_b32 v6, s35, v7
 s_cbranch_vccnz L_f1s15
L_f1r15:
 s_mov_b32 s30, s93
 s_mov_b32 s29, s94
 s_cmp_eq_u32 s20, 0
 s_cselect_b32 s5, 5, 0
 v_mov_b32 v32, 0xc1800000
 v_mov_b32 v33, 0xc1800000
 v_mov_b32 v34, 0xc1800000
 v_mov_b32 v35, 0xc1800000
 v_mov_b32 v36, 0xc1800000
 v_mov_b32 v37, 0xc1800000
 v_mov_b32 v38, 0xc1800000
 v_mov_b32 v39, 0xc1800000
 s_waitcnt lgkmcnt(0)
M v[64:67], a[64:67], a[0:3], v[32:35]
 ds_read_b128 a[96:99], v2 offset:40960
 v_mov_b32 v30, 0
M v[64:67], a[68:71], a[4:7], v[64:67]
 s_add_u32 m0, s28, 65536
 ds_read_b128 a[100:103], v2 offset:41984
 v_mov_b32 v31, 0
M v[64:67], a[72:75], a[8:11], v[64:67]
 buffer_load_dwordx4 v3, s[8:11], s24 offen offset:0 sc1 lds
M v[64:67], a[76:79], a[12:15], v[64:67]
 ds_read_b128 a[104:107], v2 offset:43008
 v_accvgpr_write_b32 a128, v192
M v[64:67], a[80:83], a[16:19], v[64:67]
 ds_read_b128 a[108:111], v2 offset:44032
 v_accvgpr_write_b32 a129, v193
M v[64:67], a[84:87], a[20:23], v[64:67]
 buffer_load_dwordx4 v3, s[8:11], s24 offen offset:1024 sc1 lds
M v[64:67], a[88:91], a[24:27], v[64:67]
 ds_read_b128 a[112:115], v2 offset:45056
 v_accvgpr_write_b32 a130, v194
M v[64:67], a[92:95], a[28:31], v[64:67]
 ds_read_b128 a[116:119], v2 offset:46080
 v_accvgpr_write_b32 a131, v195
M v[68:71], a[92:95], a[60:63], v[36:39]
 v_accvgpr_write_b32 a132, v200
 v_accvgpr_write_b32 a133, v201
M v[68:71], a[88:91], a[56:59], v[68:71]
 ds_read_b128 a[120:123], v2 offset:47104
 v_accvgpr_write_b32 a134, v202
M v[68:71], a[84:87], a[52:55], v[68:71]
 ds_read_b128 a[124:127], v2 offset:48128
 v_accvgpr_write_b32 a135, v203
M v[68:71], a[80:83], a[48:51], v[68:71]
 buffer_load_dwordx4 v3, s[8:11], s24 offen offset:2048 sc1 lds
M v[68:71], a[76:79], a[44:47], v[68:71]
 v_accvgpr_write_b32 a136, v208
 v_accvgpr_write_b32 a137, v209
M v[68:71], a[72:75], a[40:43], v[68:71]
 v_accvgpr_write_b32 a138, v210
 v_accvgpr_write_b32 a139, v211
M v[68:71], a[68:71], a[36:39], v[68:71]
 v_exp_f32 v18, v64
M v[68:71], a[64:67], a[32:35], v[68:71]
 s_waitcnt lgkmcnt(0)
 v_exp_f32 v19, v65
M v[72:75], a[96:99], a[0:3], v[32:35]
 ds_read_b128 a[64:67], v2 offset:49152
 v_add_f32 v26, v18, v19
M v[72:75], a[100:103], a[4:7], v[72:75]
 ds_read_b128 a[68:71], v2 offset:50176
 v_cvt_pk_bf16_f32 v40, v18, v19
M v[72:75], a[104:107], a[8:11], v[72:75]
 buffer_load_dwordx4 v3, s[8:11], s24 offen offset:3072 sc1 lds
M v[72:75], a[108:111], a[12:15], v[72:75]
 ds_read_b128 a[72:75], v2 offset:51200
 v_accvgpr_write_b32 a140, v216
M v[72:75], a[112:115], a[16:19], v[72:75]
 s_add_u32 m0, s28, 69632
 ds_read_b128 a[76:79], v2 offset:52224
 v_accvgpr_write_b32 a141, v217
M v[72:75], a[116:119], a[20:23], v[72:75]
 buffer_load_dwordx4 v4, s[8:11], s24 offen offset:0 sc1 lds
M v[72:75], a[120:123], a[24:27], v[72:75]
 ds_read_b128 a[80:83], v2 offset:53248
 v_accvgpr_write_b32 a142, v218
M v[72:75], a[124:127], a[28:31], v[72:75]
 s_add_u32 s3, s32, 0
 ds_read_b128 a[84:87], v2 offset:54272
 v_accvgpr_write_b32 a143, v219
M v[76:79], a[124:127], a[60:63], v[36:39]
 buffer_store_dwordx4 a[0:3], v6, s[8:11], s3 offen offset:0 sc1
M v[76:79], a[120:123], a[56:59], v[76:79]
 ds_read_b128 a[88:91], v2 offset:55296
 v_accvgpr_write_b32 a144, v224
M v[76:79], a[116:119], a[52:55], v[76:79]
 ds_read_b128 a[92:95], v2 offset:56320
 v_accvgpr_write_b32 a145, v225
M v[76:79], a[112:115], a[48:51], v[76:79]
 buffer_load_dwordx4 v4, s[8:11], s24 offen offset:1024 sc1 lds
M v[76:79], a[108:111], a[44:47], v[76:79]
 v_exp_f32 v20, v66
M v[76:79], a[104:107], a[40:43], v[76:79]
 buffer_store_dwordx4 a[4:7], v6, s[8:11], s3 offen offset:1024 sc1
M v[76:79], a[100:103], a[36:39], v[76:79]
 v_exp_f32 v21, v67
M v[76:79], a[96:99], a[32:35], v[76:79]
 s_waitcnt lgkmcnt(0)
 v_exp_f32 v22, v68
M v[80:83], a[64:67], a[0:3], v[32:35]
 ds_read_b128 a[96:99], v2 offset:57344
 v_add_f32 v26, v20, v26
M v[80:83], a[68:71], a[4:7], v[80:83]
 ds_read_b128 a[100:103], v2 offset:58368
 v_cvt_pk_bf16_f32 v41, v20, v21
M v[80:83], a[72:75], a[8:11], v[80:83]
 buffer_load_dwordx4 v4, s[8:11], s24 offen offset:2048 sc1 lds
M v[80:83], a[76:79], a[12:15], v[80:83]
 ds_read_b128 a[104:107], v2 offset:59392
 v_add_f32 v26, v21, v26
M v[80:83], a[80:83], a[16:19], v[80:83]
 ds_read_b128 a[108:111], v2 offset:60416
 v_accvgpr_write_b32 a146, v226
M v[80:83], a[84:87], a[20:23], v[80:83]
 buffer_store_dwordx4 a[8:11], v6, s[8:11], s3 offen offset:2048 sc1
M v[80:83], a[88:91], a[24:27], v[80:83]
 ds_read_b128 a[112:115], v2 offset:61440
 v_accvgpr_write_b32 a147, v227
M v[80:83], a[92:95], a[28:31], v[80:83]
 ds_read_b128 a[116:119], v2 offset:62464
 v_accvgpr_write_b32 a148, v232
M v[84:87], a[92:95], a[60:63], v[36:39]
 buffer_load_dwordx4 v4, s[8:11], s24 offen offset:3072 sc1 lds
M v[84:87], a[88:91], a[56:59], v[84:87]
 ds_read_b128 a[120:123], v2 offset:63488
 v_accvgpr_write_b32 a149, v233
M v[84:87], a[84:87], a[52:55], v[84:87]
 ds_read_b128 a[124:127], v2 offset:64512
 v_accvgpr_write_b32 a150, v234
M v[84:87], a[80:83], a[48:51], v[84:87]
 buffer_store_dwordx4 a[12:15], v6, s[8:11], s3 offen offset:3072 sc1
M v[84:87], a[76:79], a[44:47], v[84:87]
 s_add_u32 s3, s32, 4096
 v_exp_f32 v23, v69
M v[84:87], a[72:75], a[40:43], v[84:87]
 buffer_store_dwordx4 a[16:19], v6, s[8:11], s3 offen offset:0 sc1
M v[84:87], a[68:71], a[36:39], v[84:87]
 s_waitcnt vmcnt(13) lgkmcnt(0)
 v_exp_f32 v24, v70
M v[84:87], a[64:67], a[32:35], v[84:87]
 s_barrier
M v[88:91], a[96:99], a[0:3], v[32:35]
 ds_read_b128 a[64:67], v7 offset:32768
 v_add_f32 v27, v22, v23
M v[88:91], a[100:103], a[4:7], v[88:91]
 ds_read_b128 a[68:71], v7 offset:33792
 v_cvt_pk_bf16_f32 v44, v22, v23
M v[88:91], a[104:107], a[8:11], v[88:91]
 buffer_store_dword v17, v1, s[8:11], s45 offen sc1
M v[88:91], a[108:111], a[12:15], v[88:91]
 ds_read_b128 a[72:75], v7 offset:34816
 v_accvgpr_write_b32 a151, v235
M v[88:91], a[112:115], a[16:19], v[88:91]
 ds_read_b128 a[76:79], v7 offset:35840
 v_accvgpr_write_b32 a152, v240
M v[88:91], a[116:119], a[20:23], v[88:91]
 buffer_store_dwordx4 a[20:23], v6, s[8:11], s3 offen offset:1024 sc1
M v[88:91], a[120:123], a[24:27], v[88:91]
 ds_read_b128 a[80:83], v7 offset:36864
 v_accvgpr_write_b32 a153, v241
M v[88:91], a[124:127], a[28:31], v[88:91]
 ds_read_b128 a[84:87], v7 offset:37888
 v_accvgpr_write_b32 a154, v242
M v[92:95], a[124:127], a[60:63], v[36:39]
 buffer_store_dwordx4 a[24:27], v6, s[8:11], s3 offen offset:2048 sc1
M v[92:95], a[120:123], a[56:59], v[92:95]
 ds_read_b128 a[88:91], v7 offset:38912
 v_accvgpr_write_b32 a155, v243
M v[92:95], a[116:119], a[52:55], v[92:95]
 ds_read_b128 a[92:95], v7 offset:39936
 v_accvgpr_write_b32 a156, v248
M v[92:95], a[112:115], a[48:51], v[92:95]
 buffer_store_dwordx4 a[28:31], v6, s[8:11], s3 offen offset:3072 sc1
M v[92:95], a[108:111], a[44:47], v[92:95]
 v_exp_f32 v25, v71
M v[92:95], a[104:107], a[40:43], v[92:95]
 v_exp_f32 v18, v72
M v[92:95], a[100:103], a[36:39], v[92:95]
 s_waitcnt lgkmcnt(0)
 v_exp_f32 v19, v73
M v[92:95], a[96:99], a[32:35], v[92:95]
 v_exp_f32 v20, v74
M v[96:99], a[64:67], a[0:3], v[32:35]
 s_add_u32 m0, s28, 98304
 ds_read_b128 a[96:99], v7 offset:40960
 ds_read_b128 a[100:103], v7 offset:41984
M v[96:99], a[68:71], a[4:7], v[96:99]
 buffer_load_dwordx4 v3, s[8:11], s21 offen offset:0 sc1 lds
M v[96:99], a[72:75], a[8:11], v[96:99]
 v_exp_f32 v21, v75
M v[96:99], a[76:79], a[12:15], v[96:99]
 s_add_u32 s3, s32, 8192
 ds_read_b128 a[104:107], v7 offset:43008
 ds_read_b128 a[108:111], v7 offset:44032
M v[96:99], a[80:83], a[16:19], v[96:99]
 buffer_store_dwordx4 a[32:35], v6, s[8:11], s3 offen offset:0 sc1
M v[96:99], a[84:87], a[20:23], v[96:99]
 v_exp_f32 v22, v76
M v[96:99], a[88:91], a[24:27], v[96:99]
 ds_read_b128 a[112:115], v7 offset:45056
 ds_read_b128 a[116:119], v7 offset:46080
M v[96:99], a[92:95], a[28:31], v[96:99]
 buffer_load_dwordx4 v3, s[8:11], s21 offen offset:1024 sc1 lds
M v[100:103], a[92:95], a[60:63], v[36:39]
 v_exp_f32 v23, v77
M v[100:103], a[88:91], a[56:59], v[100:103]
 ds_read_b128 a[120:123], v7 offset:47104
 ds_read_b128 a[124:127], v7 offset:48128
M v[100:103], a[84:87], a[52:55], v[100:103]
 buffer_store_dwordx4 a[36:39], v6, s[8:11], s3 offen offset:1024 sc1
M v[100:103], a[80:83], a[48:51], v[100:103]
 v_add_f32 v27, v24, v27
 v_cvt_pk_bf16_f32 v45, v24, v25
M v[100:103], a[76:79], a[44:47], v[100:103]
 buffer_load_dwordx4 v3, s[8:11], s21 offen offset:2048 sc1 lds
M v[100:103], a[72:75], a[40:43], v[100:103]
 v_add_f32 v27, v25, v27
 v_add_f32 v26, v18, v26
M v[100:103], a[68:71], a[36:39], v[100:103]
 v_exp_f32 v24, v78
M v[100:103], a[64:67], a[32:35], v[100:103]
 s_waitcnt lgkmcnt(0)
 v_exp_f32 v25, v79
M v[104:107], a[96:99], a[0:3], v[32:35]
 ds_read_b128 a[64:67], v7 offset:49152
 ds_read_b128 a[68:71], v7 offset:50176
M v[104:107], a[100:103], a[4:7], v[104:107]
 buffer_load_dwordx4 v3, s[8:11], s21 offen offset:3072 sc1 lds
M v[104:107], a[104:107], a[8:11], v[104:107]
 v_cvt_pk_bf16_f32 v42, v18, v19
 v_add_f32 v26, v19, v26
M v[104:107], a[108:111], a[12:15], v[104:107]
 ds_read_b128 a[72:75], v7 offset:51200
 ds_read_b128 a[76:79], v7 offset:52224
M v[104:107], a[112:115], a[16:19], v[104:107]
 buffer_store_dwordx4 a[40:43], v6, s[8:11], s3 offen offset:2048 sc1
M v[104:107], a[116:119], a[20:23], v[104:107]
 v_exp_f32 v18, v80
M v[104:107], a[120:123], a[24:27], v[104:107]
 s_add_u32 m0, s28, 102400
 ds_read_b128 a[80:83], v7 offset:53248
 ds_read_b128 a[84:87], v7 offset:54272
M v[104:107], a[124:127], a[28:31], v[104:107]
 buffer_load_dwordx4 v4, s[8:11], s21 offen offset:0 sc1 lds
M v[108:111], a[124:127], a[60:63], v[36:39]
 v_exp_f32 v19, v81
M v[108:111], a[120:123], a[56:59], v[108:111]
 ds_read_b128 a[88:91], v7 offset:55296
 ds_read_b128 a[92:95], v7 offset:56320
M v[108:111], a[116:119], a[52:55], v[108:111]
 buffer_store_dwordx4 a[44:47], v6, s[8:11], s3 offen offset:3072 sc1
M v[108:111], a[112:115], a[48:51], v[108:111]
 v_add_f32 v26, v20, v26
 v_cvt_pk_bf16_f32 v43, v20, v21
M v[108:111], a[108:111], a[44:47], v[108:111]
 buffer_load_dwordx4 v4, s[8:11], s21 offen offset:1024 sc1 lds
M v[108:111], a[104:107], a[40:43], v[108:111]
 s_add_u32 s3, s32, 12288
 v_add_f32 v26, v21, v26
 v_add_f32 v27, v22, v27
M v[108:111], a[100:103], a[36:39], v[108:111]
 buffer_store_dwordx4 a[48:51], v6, s[8:11], s3 offen offset:0 sc1
M v[108:111], a[96:99], a[32:35], v[108:111]
 s_waitcnt lgkmcnt(0)
 v_exp_f32 v20, v82
M v[112:115], a[64:67], a[0:3], v[32:35]
 ds_read_b128 a[96:99], v7 offset:57344
 ds_read_b128 a[100:103], v7 offset:58368
M v[112:115], a[68:71], a[4:7], v[112:115]
 buffer_load_dwordx4 v4, s[8:11], s21 offen offset:2048 sc1 lds
M v[112:115], a[72:75], a[8:11], v[112:115]
 v_exp_f32 v21, v83
M v[112:115], a[76:79], a[12:15], v[112:115]
 ds_read_b128 a[104:107], v7 offset:59392
 ds_read_b128 a[108:111], v7 offset:60416
M v[112:115], a[80:83], a[16:19], v[112:115]
 buffer_load_dwordx4 v4, s[8:11], s21 offen offset:3072 sc1 lds
M v[112:115], a[84:87], a[20:23], v[112:115]
 s_add_u32 s24, s23, 16777216
 v_cvt_pk_bf16_f32 v46, v22, v23
 v_add_f32 v27, v23, v27
M v[112:115], a[88:91], a[24:27], v[112:115]
 s_mov_b32 s23, s21
 ds_read_b128 a[112:115], v7 offset:61440
 ds_read_b128 a[116:119], v7 offset:62464
M v[112:115], a[92:95], a[28:31], v[112:115]
 buffer_store_dwordx4 a[52:55], v6, s[8:11], s3 offen offset:1024 sc1
M v[116:119], a[92:95], a[60:63], v[36:39]
 s_add_u32 s21, s21, 32768
 v_add_f32 v27, v24, v27
M v[116:119], a[88:91], a[56:59], v[116:119]
 s_add_u32 s22, s22, 1
 ds_read_b128 a[120:123], v7 offset:63488
 ds_read_b128 a[124:127], v7 offset:64512
M v[116:119], a[84:87], a[52:55], v[116:119]
 s_cmp_eq_u32 s22, s25
 v_exp_f32 v22, v88
M v[116:119], a[80:83], a[48:51], v[116:119]
 s_cselect_b32 s21, s26, s21
 v_exp_f32 v23, v89
M v[116:119], a[76:79], a[44:47], v[116:119]
 buffer_store_dwordx4 a[56:59], v6, s[8:11], s3 offen offset:2048 sc1
M v[116:119], a[72:75], a[40:43], v[116:119]
 s_cmp_eq_u32 s22, s43
 v_cvt_pk_bf16_f32 v47, v24, v25
 v_add_f32 v27, v25, v27
M v[116:119], a[68:71], a[36:39], v[116:119]
 s_waitcnt vmcnt(21) lgkmcnt(0)
 v_exp_f32 v24, v90
M v[116:119], a[64:67], a[32:35], v[116:119]
 s_barrier
M v[120:123], a[96:99], a[0:3], v[32:35]
 s_cselect_b32 s21, s4, s21
 ds_read_b128 a[64:67], v2 offset:0
 ds_read_b128 a[68:71], v2 offset:1024
M v[120:123], a[100:103], a[4:7], v[120:123]
 s_cmp_eq_u32 s22, s6
 v_exp_f32 v25, v91
M v[120:123], a[104:107], a[8:11], v[120:123]
 s_cselect_b32 s21, s7, s21
 v_add_f32 v26, v18, v26
 v_cvt_pk_bf16_f32 v56, v18, v19
M v[120:123], a[108:111], a[12:15], v[120:123]
 ds_read_b128 a[72:75], v2 offset:2048
 ds_read_b128 a[76:79], v2 offset:3072
M v[120:123], a[112:115], a[16:19], v[120:123]
 buffer_store_dwordx4 a[60:63], v6, s[8:11], s3 offen offset:3072 sc1
M v[120:123], a[116:119], a[20:23], v[120:123]
 v_add_f32 v26, v19, v26
 v_add_f32 v26, v20, v26
M v[120:123], a[120:123], a[24:27], v[120:123]
 ds_read_b128 a[80:83], v2 offset:4096
 ds_read_b128 a[84:87], v2 offset:5120
M v[120:123], a[124:127], a[28:31], v[120:123]
 v_exp_f32 v18, v84
M v[124:127], a[124:127], a[60:63], v[36:39]
 v_exp_f32 v19, v85
M v[124:127], a[120:123], a[56:59], v[124:127]
 ds_read_b128 a[88:91], v2 offset:6144
 ds_read_b128 a[92:95], v2 offset:7168
M v[124:127], a[116:119], a[52:55], v[124:127]
 v_cvt_pk_bf16_f32 v57, v20, v21
 v_add_f32 v26, v21, v26
M v[124:127], a[112:115], a[48:51], v[124:127]
 v_exp_f32 v20, v86
M v[124:127], a[108:111], a[44:47], v[124:127]
 v_exp_f32 v21, v87
M v[124:127], a[104:107], a[40:43], v[124:127]
 v_add_f32 v26, v22, v26
 v_cvt_pk_bf16_f32 v58, v22, v23
M v[124:127], a[100:103], a[36:39], v[124:127]
 s_waitcnt lgkmcnt(0)
 v_add_f32 v26, v23, v26
 v_add_f32 v26, v24, v26
M v[124:127], a[96:99], a[32:35], v[124:127]
 v_exp_f32 v22, v92
 v_cvt_pk_bf16_f32 v59, v24, v25
 v_add_f32 v26, v25, v26
 v_add_f32 v27, v18, v27
 v_cvt_pk_bf16_f32 v60, v18, v19
 v_add_f32 v27, v19, v27
 v_exp_f32 v23, v93
 v_add_f32 v27, v20, v27
 v_cvt_pk_bf16_f32 v61, v20, v21
 v_add_f32 v27, v21, v27
 v_exp_f32 v24, v94
 v_add_f32 v27, v22, v27
 v_cvt_pk_bf16_f32 v62, v22, v23
 v_exp_f32 v25, v95
 v_add_f32 v27, v23, v27
 v_add_f32 v27, v24, v27
 v_cvt_pk_bf16_f32 v63, v24, v25
 v_add_f32 v27, v25, v27
 v_max_f32 v10, v26, v27
 v_min_f32 v11, v26, v27
 v_cmp_lt_f32 s[36:37], s31, v10
 v_cmp_gt_f32 vcc, s55, v11
 s_nop 0
 s_or_b64 vcc, vcc, s[36:37]
 s_cbranch_vccnz L_st8
L_rt8:
M v[128:131], a[64:67], v[40:43], 0
 s_add_u32 m0, s28, 0
 ds_read_b128 a[96:99], v2 offset:8192
 ds_read_b128 a[100:103], v2 offset:9216
M v[128:131], a[68:71], v[56:59], v[128:131]
 buffer_load_dwordx4 v3, s[8:11], s24 offen offset:0 sc1 lds
M v[132:135], a[68:71], v[60:63], 0
 v_accvgpr_write_b32 a157, v249
 v_accvgpr_write_b32 a158, v250
M v[132:135], a[64:67], v[44:47], v[132:135]
 ds_read_b128 a[104:107], v2 offset:10240
 ds_read_b128 a[108:111], v2 offset:11264
M v[136:139], a[72:75], v[40:43], 0
 buffer_load_dwordx4 v3, s[8:11], s24 offen offset:1024 sc1 lds
M v[136:139], a[76:79], v[56:59], v[136:139]
 v_accvgpr_write_b32 a159, v251
 v_add_f32 v30, v26, v30
M v[140:143], a[76:79], v[60:63], 0
 ds_read_b128 a[112:115], v2 offset:12288
 ds_read_b128 a[116:119], v2 offset:13312
M v[140:143], a[72:75], v[44:47], v[140:143]
 buffer_load_dwordx4 v3, s[8:11], s24 offen offset:2048 sc1 lds
M v[144:147], a[80:83], v[40:43], 0
 v_exp_f32 v18, v96
M v[144:147], a[84:87], v[56:59], v[144:147]
 ds_read_b128 a[120:123], v2 offset:14336
 ds_read_b128 a[124:127], v2 offset:15360
M v[148:151], a[84:87], v[60:63], 0
 buffer_load_dwordx4 v3, s[8:11], s24 offen offset:3072 sc1 lds
M v[148:151], a[80:83], v[44:47], v[148:151]
 s_add_u32 m0, s28, 4096
 v_exp_f32 v19, v97
M v[152:155], a[88:91], v[40:43], 0
 buffer_load_dwordx4 v4, s[8:11], s24 offen offset:0 sc1 lds
M v[152:155], a[92:95], v[56:59], v[152:155]
 v_exp_f32 v20, v98
M v[156:159], a[92:95], v[60:63], 0
 v_exp_f32 v21, v99
M v[156:159], a[88:91], v[44:47], v[156:159]
 s_waitcnt lgkmcnt(0)
 v_exp_f32 v22, v104
M v[160:163], a[96:99], v[40:43], 0
 ds_read_b128 a[64:67], v2 offset:16384
 ds_read_b128 a[68:71], v2 offset:17408
M v[160:163], a[100:103], v[56:59], v[160:163]
 buffer_load_dwordx4 v4, s[8:11], s24 offen offset:1024 sc1 lds
M v[164:167], a[100:103], v[60:63], 0
 v_exp_f32 v23, v105
M v[164:167], a[96:99], v[44:47], v[164:167]
 ds_read_b128 a[72:75], v2 offset:18432
 ds_read_b128 a[76:79], v2 offset:19456
M v[168:171], a[104:107], v[40:43], 0
 buffer_load_dwordx4 v4, s[8:11], s24 offen offset:2048 sc1 lds
M v[168:171], a[108:111], v[56:59], v[168:171]
 v_add_f32 v31, v27, v31
 v_add_f32 v28, v18, v19
M v[172:175], a[108:111], v[60:63], 0
 ds_read_b128 a[80:83], v2 offset:20480
 ds_read_b128 a[84:87], v2 offset:21504
M v[172:175], a[104:107], v[44:47], v[172:175]
 buffer_load_dwordx4 v4, s[8:11], s24 offen offset:3072 sc1 lds
M v[176:179], a[112:115], v[40:43], 0
 v_exp_f32 v24, v106
M v[176:179], a[116:119], v[56:59], v[176:179]
 s_add_u32 m0, s28, 32768
 ds_read_b128 a[88:91], v2 offset:22528
 ds_read_b128 a[92:95], v2 offset:23552
M v[180:183], a[116:119], v[60:63], 0
 buffer_load_dwordx4 v3, s[8:11], s21 offen offset:0 sc1 lds
M v[180:183], a[112:115], v[44:47], v[180:183]
 v_exp_f32 v25, v107
M v[184:187], a[120:123], v[40:43], 0
 buffer_load_dwordx4 v3, s[8:11], s21 offen offset:1024 sc1 lds
M v[184:187], a[124:127], v[56:59], v[184:187]
 v_cvt_pk_bf16_f32 v48, v18, v19
 v_add_f32 v28, v20, v28
M v[188:191], a[124:127], v[60:63], 0
 buffer_load_dwordx4 v3, s[8:11], s21 offen offset:2048 sc1 lds
M v[188:191], a[120:123], v[44:47], v[188:191]
 s_waitcnt lgkmcnt(0)
 v_exp_f32 v18, v100
M v[192:195], a[64:67], v[40:43], 0
 ds_read_b128 a[96:99], v2 offset:24576
 ds_read_b128 a[100:103], v2 offset:25600
M v[192:195], a[68:71], v[56:59], v[192:195]
 buffer_load_dwordx4 v3, s[8:11], s21 offen offset:3072 sc1 lds
M v[196:199], a[68:71], v[60:63], 0
 v_exp_f32 v19, v101
M v[196:199], a[64:67], v[44:47], v[196:199]
 s_add_u32 m0, s28, 36864
 ds_read_b128 a[104:107], v2 offset:26624
 ds_read_b128 a[108:111], v2 offset:27648
M v[200:203], a[72:75], v[40:43], 0
 buffer_load_dwordx4 v4, s[8:11], s21 offen offset:0 sc1 lds
M v[200:203], a[76:79], v[56:59], v[200:203]
 v_cvt_pk_bf16_f32 v49, v20, v21
 v_add_f32 v28, v21, v28
M v[204:207], a[76:79], v[60:63], 0
 ds_read_b128 a[112:115], v2 offset:28672
 ds_read_b128 a[116:119], v2 offset:29696
M v[204:207], a[72:75], v[44:47], v[204:207]
 buffer_load_dwordx4 v4, s[8:11], s21 offen offset:1024 sc1 lds
M v[208:211], a[80:83], v[40:43], 0
 v_exp_f32 v20, v102
M v[208:211], a[84:87], v[56:59], v[208:211]
 ds_read_b128 a[120:123], v2 offset:30720
 ds_read_b128 a[124:127], v2 offset:31744
M v[212:215], a[84:87], v[60:63], 0
 buffer_load_dwordx4 v4, s[8:11], s21 offen offset:2048 sc1 lds
M v[212:215], a[80:83], v[44:47], v[212:215]
 v_exp_f32 v21, v103
M v[216:219], a[88:91], v[40:43], 0
 v_add_f32 v28, v22, v28
 v_cvt_pk_bf16_f32 v50, v22, v23
M v[216:219], a[92:95], v[56:59], v[216:219]
 buffer_load_dwordx4 v4, s[8:11], s21 offen offset:3072 sc1 lds
M v[220:223], a[92:95], v[60:63], 0
 s_waitcnt vmcnt(16) lgkmcnt(0)
 s_add_u32 s24, s23, 16777216
 s_mov_b32 s23, s21
M v[220:223], a[88:91], v[44:47], v[220:223]
 s_barrier
M v[224:227], a[96:99], v[40:43], 0
 ds_read_b128 a[64:67], v2 offset:32768
 ds_read_b128 a[68:71], v2 offset:33792
M v[224:227], a[100:103], v[56:59], v[224:227]
 s_xor_b32 s3, s47, 64
 v_mov_b32 v5, 1
M v[228:231], a[100:103], v[60:63], 0
 v_or_b32 v6, s35, v1
 s_add_u32 s21, s21, 32768
M v[228:231], a[96:99], v[44:47], v[228:231]
 s_add_u32 s22, s22, 1
 ds_read_b128 a[72:75], v2 offset:34816
 ds_read_b128 a[76:79], v2 offset:35840
M v[232:235], a[104:107], v[40:43], 0
 buffer_store_dword v5, v6, s[8:11], s3 offen sc1
M v[232:235], a[108:111], v[56:59], v[232:235]
 s_cmp_eq_u32 s22, s25
 v_add_f32 v28, v23, v28
 v_add_f32 v28, v24, v28
M v[236:239], a[108:111], v[60:63], 0
 s_cselect_b32 s21, s26, s21
 ds_read_b128 a[80:83], v2 offset:36864
 ds_read_b128 a[84:87], v2 offset:37888
M v[236:239], a[104:107], v[44:47], v[236:239]
 s_cmp_eq_u32 s22, s43
 v_exp_f32 v22, v108
M v[240:243], a[112:115], v[40:43], 0
 s_cselect_b32 s21, s4, s21
 v_exp_f32 v23, v109
M v[240:243], a[116:119], v[56:59], v[240:243]
 s_cmp_eq_u32 s22, s6
 ds_read_b128 a[88:91], v2 offset:38912
 ds_read_b128 a[92:95], v2 offset:39936
M v[244:247], a[116:119], v[60:63], 0
 s_cselect_b32 s21, s7, s21
 v_cvt_pk_bf16_f32 v51, v24, v25
 v_add_f32 v28, v25, v28
M v[244:247], a[112:115], v[44:47], v[244:247]
 v_exp_f32 v24, v110
M v[248:251], a[120:123], v[40:43], 0
 v_exp_f32 v25, v111
M v[248:251], a[124:127], v[56:59], v[248:251]
 v_add_f32 v29, v18, v19
 v_cvt_pk_bf16_f32 v52, v18, v19
M v[252:255], a[124:127], v[60:63], 0
 s_waitcnt lgkmcnt(0)
 v_add_f32 v29, v20, v29
 v_cvt_pk_bf16_f32 v53, v20, v21
M v[252:255], a[120:123], v[44:47], v[252:255]
 v_add_f32 v29, v21, v29
 v_add_f32 v29, v22, v29
 v_cvt_pk_bf16_f32 v54, v22, v23
 v_add_f32 v29, v23, v29
 v_add_f32 v29, v24, v29
 v_cvt_pk_bf16_f32 v55, v24, v25
 v_add_f32 v29, v25, v29
M v[64:67], a[64:67], a[0:3], v[32:35]
 s_add_u32 m0, s28, 65536
 ds_read_b128 a[96:99], v2 offset:40960
 ds_read_b128 a[100:103], v2 offset:41984
M v[64:67], a[68:71], a[4:7], v[64:67]
 buffer_load_dwordx4 v3, s[8:11], s24 offen offset:0 sc1 lds
M v[64:67], a[72:75], a[8:11], v[64:67]
 v_exp_f32 v18, v112
M v[64:67], a[76:79], a[12:15], v[64:67]
 s_add_u32 s3, s30, 786432
 ds_read_b128 a[104:107], v2 offset:43008
 ds_read_b128 a[108:111], v2 offset:44032
M v[64:67], a[80:83], a[16:19], v[64:67]
 buffer_store_dwordx4 a[128:131], v7, s[8:11], s3 offen offset:0 sc1
M v[64:67], a[84:87], a[20:23], v[64:67]
 v_exp_f32 v19, v113
M v[64:67], a[88:91], a[24:27], v[64:67]
 ds_read_b128 a[112:115], v2 offset:45056
 ds_read_b128 a[116:119], v2 offset:46080
M v[64:67], a[92:95], a[28:31], v[64:67]
 buffer_load_dwordx4 v3, s[8:11], s24 offen offset:1024 sc1 lds
M v[68:71], a[92:95], a[60:63], v[36:39]
 v_exp_f32 v20, v114
M v[68:71], a[88:91], a[56:59], v[68:71]
 ds_read_b128 a[120:123], v2 offset:47104
 ds_read_b128 a[124:127], v2 offset:48128
M v[68:71], a[84:87], a[52:55], v[68:71]
 v_exp_f32 v21, v115
M v[68:71], a[80:83], a[48:51], v[68:71]
 v_add_f32 v28, v18, v28
 v_cvt_pk_bf16_f32 v56, v18, v19
M v[68:71], a[76:79], a[44:47], v[68:71]
 v_add_f32 v28, v19, v28
 v_add_f32 v28, v20, v28
M v[68:71], a[72:75], a[40:43], v[68:71]
 buffer_load_dwordx4 v3, s[8:11], s24 offen offset:2048 sc1 lds
M v[68:71], a[68:71], a[36:39], v[68:71]
 v_exp_f32 v22, v120
M v[68:71], a[64:67], a[32:35], v[68:71]
 s_waitcnt lgkmcnt(0)
 v_cvt_pk_bf16_f32 v57, v20, v21
 v_add_f32 v28, v21, v28
M v[72:75], a[96:99], a[0:3], v[32:35]
 ds_read_b128 a[64:67], v2 offset:49152
 ds_read_b128 a[68:71], v2 offset:50176
M v[72:75], a[100:103], a[4:7], v[72:75]
 buffer_store_dwordx4 a[132:135], v7, s[8:11], s3 offen offset:1024 sc1
M v[72:75], a[104:107], a[8:11], v[72:75]
 v_exp_f32 v23, v121
M v[72:75], a[108:111], a[12:15], v[72:75]
 ds_read_b128 a[72:75], v2 offset:51200
 ds_read_b128 a[76:79], v2 offset:52224
M v[72:75], a[112:115], a[16:19], v[72:75]
 buffer_load_dwordx4 v3, s[8:11], s24 offen offset:3072 sc1 lds
M v[72:75], a[116:119], a[20:23], v[72:75]
 v_exp_f32 v24, v122
M v[72:75], a[120:123], a[24:27], v[72:75]
 ds_read_b128 a[80:83], v2 offset:53248
 ds_read_b128 a[84:87], v2 offset:54272
M v[72:75], a[124:127], a[28:31], v[72:75]
 v_add_f32 v28, v22, v28
 v_cvt_pk_bf16_f32 v58, v22, v23
M v[76:79], a[124:127], a[60:63], v[36:39]
 v_exp_f32 v25, v123
M v[76:79], a[120:123], a[56:59], v[76:79]
 s_add_u32 m0, s28, 69632
 ds_read_b128 a[88:91], v2 offset:55296
 ds_read_b128 a[92:95], v2 offset:56320
M v[76:79], a[116:119], a[52:55], v[76:79]
 buffer_load_dwordx4 v4, s[8:11], s24 offen offset:0 sc1 lds
M v[76:79], a[112:115], a[48:51], v[76:79]
 v_add_f32 v28, v23, v28
 v_add_f32 v28, v24, v28
M v[76:79], a[108:111], a[44:47], v[76:79]
 v_exp_f32 v18, v116
M v[76:79], a[104:107], a[40:43], v[76:79]
 v_cvt_pk_bf16_f32 v59, v24, v25
 v_add_f32 v28, v25, v28
M v[76:79], a[100:103], a[36:39], v[76:79]
M v[76:79], a[96:99], a[32:35], v[76:79]
 s_waitcnt lgkmcnt(0)
 v_exp_f32 v19, v117
M v[80:83], a[64:67], a[0:3], v[32:35]
 ds_read_b128 a[96:99], v2 offset:57344
 ds_read_b128 a[100:103], v2 offset:58368
M v[80:83], a[68:71], a[4:7], v[80:83]
 buffer_store_dwordx4 a[136:139], v7, s[8:11], s3 offen offset:2048 sc1
M v[80:83], a[72:75], a[8:11], v[80:83]
 v_add_f32 v29, v18, v29
 v_cvt_pk_bf16_f32 v60, v18, v19
M v[80:83], a[76:79], a[12:15], v[80:83]
 ds_read_b128 a[104:107], v2 offset:59392
 ds_read_b128 a[108:111], v2 offset:60416
M v[80:83], a[80:83], a[16:19], v[80:83]
 buffer_load_dwordx4 v4, s[8:11], s24 offen offset:1024 sc1 lds
M v[80:83], a[84:87], a[20:23], v[80:83]
 v_exp_f32 v20, v118
M v[80:83], a[88:91], a[24:27], v[80:83]
 ds_read_b128 a[112:115], v2 offset:61440
 ds_read_b128 a[116:119], v2 offset:62464
M v[80:83], a[92:95], a[28:31], v[80:83]
 buffer_load_dwordx4 v4, s[8:11], s24 offen offset:2048 sc1 lds
M v[84:87], a[92:95], a[60:63], v[36:39]
 v_exp_f32 v21, v119
M v[84:87], a[88:91], a[56:59], v[84:87]
 ds_read_b128 a[120:123], v2 offset:63488
 ds_read_b128 a[124:127], v2 offset:64512
M v[84:87], a[84:87], a[52:55], v[84:87]
 v_exp_f32 v22, v124
M v[84:87], a[80:83], a[48:51], v[84:87]
 buffer_load_dwordx4 v4, s[8:11], s24 offen offset:3072 sc1 lds
M v[84:87], a[76:79], a[44:47], v[84:87]
 v_add_f32 v29, v19, v29
 v_add_f32 v29, v20, v29
M v[84:87], a[72:75], a[40:43], v[84:87]
 buffer_store_dwordx4 a[140:143], v7, s[8:11], s3 offen offset:3072 sc1
M v[84:87], a[68:71], a[36:39], v[84:87]
 s_waitcnt vmcnt(21) lgkmcnt(0)
 v_exp_f32 v23, v125
M v[84:87], a[64:67], a[32:35], v[84:87]
 s_barrier
M v[88:91], a[96:99], a[0:3], v[32:35]
 ds_read_b128 a[64:67], v7 offset:0
 ds_read_b128 a[68:71], v7 offset:1024
M v[88:91], a[100:103], a[4:7], v[88:91]
 v_exp_f32 v24, v126
M v[88:91], a[104:107], a[8:11], v[88:91]
 v_cvt_pk_bf16_f32 v61, v20, v21
 v_add_f32 v29, v21, v29
M v[88:91], a[108:111], a[12:15], v[88:91]
 ds_read_b128 a[72:75], v7 offset:2048
 ds_read_b128 a[76:79], v7 offset:3072
M v[88:91], a[112:115], a[16:19], v[88:91]
 v_exp_f32 v25, v127
M v[88:91], a[116:119], a[20:23], v[88:91]
 v_add_f32 v29, v22, v29
 v_cvt_pk_bf16_f32 v62, v22, v23
M v[88:91], a[120:123], a[24:27], v[88:91]
 ds_read_b128 a[80:83], v7 offset:4096
 ds_read_b128 a[84:87], v7 offset:5120
M v[88:91], a[124:127], a[28:31], v[88:91]
 v_add_f32 v29, v23, v29
 v_add_f32 v29, v24, v29
M v[92:95], a[124:127], a[60:63], v[36:39]
 v_cvt_pk_bf16_f32 v63, v24, v25
 v_add_f32 v29, v25, v29
M v[92:95], a[120:123], a[56:59], v[92:95]
 ds_read_b128 a[88:91], v7 offset:6144
 ds_read_b128 a[92:95], v7 offset:7168
M v[92:95], a[116:119], a[52:55], v[92:95]
 v_max_f32 v10, v28, v29
M v[92:95], a[112:115], a[48:51], v[92:95]
 v_cmp_lt_f32 vcc, s31, v10
M v[92:95], a[108:111], a[44:47], v[92:95]
M v[92:95], a[104:107], a[40:43], v[92:95]
M v[92:95], a[100:103], a[36:39], v[92:95]
 s_waitcnt lgkmcnt(0)
M v[92:95], a[96:99], a[32:35], v[92:95]
 s_cbranch_vccnz L_st9
L_rt9:
M v[128:131], a[64:67], v[48:51], v[128:131]
 s_add_u32 m0, s28, 98304
 ds_read_b128 a[96:99], v7 offset:8192
 ds_read_b128 a[100:103], v7 offset:9216
M v[128:131], a[68:71], v[56:59], v[128:131]
 buffer_load_dwordx4 v3, s[8:11], s21 offen offset:0 sc1 lds
M v[132:135], a[68:71], v[60:63], v[132:135]
 v_exp_f32 v18, v64
M v[132:135], a[64:67], v[52:55], v[132:135]
 s_add_u32 s3, s30, 794624
 ds_read_b128 a[104:107], v7 offset:10240
 ds_read_b128 a[108:111], v7 offset:11264
M v[136:139], a[72:75], v[48:51], v[136:139]
 buffer_store_dwordx4 a[144:147], v7, s[8:11], s3 offen offset:0 sc1
M v[136:139], a[76:79], v[56:59], v[136:139]
 v_exp_f32 v19, v65
M v[140:143], a[76:79], v[60:63], v[140:143]
 ds_read_b128 a[112:115], v7 offset:12288
 ds_read_b128 a[116:119], v7 offset:13312
M v[140:143], a[72:75], v[52:55], v[140:143]
 buffer_load_dwordx4 v3, s[8:11], s21 offen offset:1024 sc1 lds
M v[144:147], a[80:83], v[48:51], v[144:147]
 v_exp_f32 v20, v66
M v[144:147], a[84:87], v[56:59], v[144:147]
 ds_read_b128 a[120:123], v7 offset:14336
 ds_read_b128 a[124:127], v7 offset:15360
M v[148:151], a[84:87], v[60:63], v[148:151]
 v_add_f32 v30, v28, v30
 v_add_f32 v31, v29, v31
M v[148:151], a[80:83], v[52:55], v[148:151]
 buffer_load_dwordx4 v3, s[8:11], s21 offen offset:2048 sc1 lds
M v[152:155], a[88:91], v[48:51], v[152:155]
 v_exp_f32 v21, v67
M v[152:155], a[92:95], v[56:59], v[152:155]
 v_add_f32 v26, v18, v19
 v_cvt_pk_bf16_f32 v40, v18, v19
M v[156:159], a[92:95], v[60:63], v[156:159]
 v_exp_f32 v22, v72
M v[156:159], a[88:91], v[52:55], v[156:159]
 s_waitcnt lgkmcnt(0)
 v_add_f32 v26, v20, v26
 v_cvt_pk_bf16_f32 v41, v20, v21
M v[160:163], a[96:99], v[48:51], v[160:163]
 ds_read_b128 a[64:67], v7 offset:16384
 ds_read_b128 a[68:71], v7 offset:17408
M v[160:163], a[100:103], v[56:59], v[160:163]
 buffer_store_dwordx4 a[148:151], v7, s[8:11], s3 offen offset:1024 sc1
M v[164:167], a[100:103], v[60:63], v[164:167]
 v_exp_f32 v23, v73
M v[164:167], a[96:99], v[52:55], v[164:167]
 ds_read_b128 a[72:75], v7 offset:18432
 ds_read_b128 a[76:79], v7 offset:19456
M v[168:171], a[104:107], v[48:51], v[168:171]
 buffer_load_dwordx4 v3, s[8:11], s21 offen offset:3072 sc1 lds
M v[168:171], a[108:111], v[56:59], v[168:171]
 v_add_f32 v26, v21, v26
 v_add_f32 v26, v22, v26
M v[172:175], a[108:111], v[60:63], v[172:175]
 s_add_u32 m0, s28, 102400
 ds_read_b128 a[80:83], v7 offset:20480
 ds_read_b128 a[84:87], v7 offset:21504
M v[172:175], a[104:107], v[52:55], v[172:175]
 buffer_load_dwordx4 v4, s[8:11], s21 offen offset:0 sc1 lds
M v[176:179], a[112:115], v[48:51], v[176:179]
 v_exp_f32 v24, v74
M v[176:179], a[116:119], v[56:59], v[176:179]
 ds_read_b128 a[88:91], v7 offset:22528
 ds_read_b128 a[92:95], v7 offset:23552
M v[180:183], a[116:119], v[60:63], v[180:183]
 v_exp_f32 v25, v75
M v[180:183], a[112:115], v[52:55], v[180:183]
 buffer_load_dwordx4 v4, s[8:11], s21 offen offset:1024 sc1 lds
M v[184:187], a[120:123], v[48:51], v[184:187]
 v_cvt_pk_bf16_f32 v42, v22, v23
 v_add_f32 v26, v23, v26
M v[184:187], a[124:127], v[56:59], v[184:187]
 v_exp_f32 v18, v68
M v[188:191], a[124:127], v[60:63], v[188:191]
 v_add_f32 v26, v24, v26
 v_cvt_pk_bf16_f32 v43, v24, v25
M v[188:191], a[120:123], v[52:55], v[188:191]
 s_waitcnt lgkmcnt(0)
 v_add_f32 v26, v25, v26
M v[192:195], a[64:67], v[48:51], v[192:195]
 ds_read_b128 a[96:99], v7 offset:24576
 ds_read_b128 a[100:103], v7 offset:25600
M v[192:195], a[68:71], v[56:59], v[192:195]
 buffer_store_dwordx4 a[152:155], v7, s[8:11], s3 offen offset:2048 sc1
M v[196:199], a[68:71], v[60:63], v[196:199]
 v_exp_f32 v19, v69
M v[196:199], a[64:67], v[52:55], v[196:199]
 ds_read_b128 a[104:107], v7 offset:26624
 ds_read_b128 a[108:111], v7 offset:27648
M v[200:203], a[72:75], v[48:51], v[200:203]
 buffer_load_dwordx4 v4, s[8:11], s21 offen offset:2048 sc1 lds
M v[200:203], a[76:79], v[56:59], v[200:203]
 v_exp_f32 v20, v70
M v[204:207], a[76:79], v[60:63], v[204:207]
 ds_read_b128 a[112:115], v7 offset:28672
 ds_read_b128 a[116:119], v7 offset:29696
M v[204:207], a[72:75], v[52:55], v[204:207]
 buffer_load_dwordx4 v4, s[8:11], s21 offen offset:3072 sc1 lds
M v[208:211], a[80:83], v[48:51], v[208:211]
 s_add_u32 s24, s23, 16777216
 v_exp_f32 v21, v71
M v[208:211], a[84:87], v[56:59], v[208:211]
 s_mov_b32 s23, s21
 ds_read_b128 a[120:123], v7 offset:30720
 ds_read_b128 a[124:127], v7 offset:31744
M v[212:215], a[84:87], v[60:63], v[212:215]
 s_add_u32 s21, s21, 32768
 v_add_f32 v27, v18, v19
 v_cvt_pk_bf16_f32 v44, v18, v19
M v[212:215], a[80:83], v[52:55], v[212:215]
 s_add_u32 s22, s22, 1
 v_add_f32 v27, v20, v27
 v_cvt_pk_bf16_f32 v45, v20, v21
M v[216:219], a[88:91], v[48:51], v[216:219]
 s_cmp_eq_u32 s22, s25
 v_exp_f32 v22, v76
M v[216:219], a[92:95], v[56:59], v[216:219]
 buffer_store_dwordx4 a[156:159], v7, s[8:11], s3 offen offset:3072 sc1
M v[220:223], a[92:95], v[60:63], v[220:223]
 s_waitcnt vmcnt(25) lgkmcnt(0)
 v_add_f32 v27, v21, v27
M v[220:223], a[88:91], v[52:55], v[220:223]
 s_barrier
M v[224:227], a[96:99], v[48:51], v[224:227]
 s_cselect_b32 s21, s26, s21
 ds_read_b128 a[64:67], v7 offset:32768
 ds_read_b128 a[68:71], v7 offset:33792
M v[224:227], a[100:103], v[56:59], v[224:227]
 s_cmp_eq_u32 s22, s43
 v_exp_f32 v23, v77
M v[228:231], a[100:103], v[60:63], v[228:231]
 s_cselect_b32 s21, s4, s21
 v_add_f32 v27, v22, v27
 v_cvt_pk_bf16_f32 v46, v22, v23
M v[228:231], a[96:99], v[52:55], v[228:231]
 s_cmp_eq_u32 s22, s6
 ds_read_b128 a[72:75], v7 offset:34816
 ds_read_b128 a[76:79], v7 offset:35840
M v[232:235], a[104:107], v[48:51], v[232:235]
 s_cselect_b32 s21, s7, s21
 v_exp_f32 v24, v78
M v[232:235], a[108:111], v[56:59], v[232:235]
 v_add_f32 v27, v23, v27
M v[236:239], a[108:111], v[60:63], v[236:239]
 ds_read_b128 a[80:83], v7 offset:36864
 ds_read_b128 a[84:87], v7 offset:37888
M v[236:239], a[104:107], v[52:55], v[236:239]
 v_exp_f32 v25, v79
M v[240:243], a[112:115], v[48:51], v[240:243]
 v_add_f32 v27, v24, v27
 v_cvt_pk_bf16_f32 v47, v24, v25
M v[240:243], a[116:119], v[56:59], v[240:243]
 ds_read_b128 a[88:91], v7 offset:38912
 ds_read_b128 a[92:95], v7 offset:39936
M v[244:247], a[116:119], v[60:63], v[244:247]
 v_add_f32 v27, v25, v27
M v[244:247], a[112:115], v[52:55], v[244:247]
M v[248:251], a[120:123], v[48:51], v[248:251]
M v[248:251], a[124:127], v[56:59], v[248:251]
M v[252:255], a[124:127], v[60:63], v[252:255]
 s_waitcnt lgkmcnt(0)
M v[252:255], a[120:123], v[52:55], v[252:255]
M v[96:99], a[64:67], a[0:3], v[32:35]
 s_add_u32 m0, s28, 0
 ds_read_b128 a[96:99], v7 offset:40960
M v[96:99], a[68:71], a[4:7], v[96:99]
 ds_read_b128 a[100:103], v7 offset:41984
M v[96:99], a[72:75], a[8:11], v[96:99]
 buffer_load_dword v6, v9, s[8:11], s46 offen sc1
M v[96:99], a[76:79], a[12:15], v[96:99]
 s_cmp_eq_u32 s20, 0
 ds_read_b128 a[104:107], v7 offset:43008
M v[96:99], a[80:83], a[16:19], v[96:99]
 s_cselect_b64 s[64:65], s[16:17], 0
 ds_read_b128 a[108:111], v7 offset:44032
M v[96:99], a[84:87], a[20:23], v[96:99]
 buffer_load_dwordx4 v3, s[8:11], s24 offen offset:0 sc1 lds
M v[96:99], a[88:91], a[24:27], v[96:99]
 s_cselect_b64 s[66:67], s[18:19], 0
 ds_read_b128 a[112:115], v7 offset:45056
M v[96:99], a[92:95], a[28:31], v[96:99]
 s_cselect_b64 s[68:69], s[48:49], 0
 ds_read_b128 a[116:119], v7 offset:46080
M v[100:103], a[92:95], a[60:63], v[36:39]
 buffer_load_dwordx4 v3, s[8:11], s24 offen offset:1024 sc1 lds
M v[100:103], a[88:91], a[56:59], v[100:103]
 s_cselect_b64 s[70:71], s[50:51], 0
 ds_read_b128 a[120:123], v7 offset:47104
M v[100:103], a[84:87], a[52:55], v[100:103]
 s_cmp_lt_u32 s20, 1
 ds_read_b128 a[124:127], v7 offset:48128
M v[100:103], a[80:83], a[48:51], v[100:103]
 s_cselect_b64 s[78:79], -1, 0
 v_exp_f32 v18, v80
M v[100:103], a[76:79], a[44:47], v[100:103]
 buffer_load_dwordx4 v3, s[8:11], s24 offen offset:2048 sc1 lds
M v[100:103], a[72:75], a[40:43], v[100:103]
 s_cmp_eq_u32 s20, 1
 v_exp_f32 v19, v81
M v[100:103], a[68:71], a[36:39], v[100:103]
 s_cselect_b64 s[72:73], s[16:17], s[78:79]
 v_exp_f32 v20, v82
M v[100:103], a[64:67], a[32:35], v[100:103]
 s_waitcnt lgkmcnt(0)
 v_exp_f32 v21, v83
M v[104:107], a[96:99], a[0:3], v[32:35]
 s_cselect_b64 s[74:75], s[18:19], s[78:79]
 ds_read_b128 a[64:67], v7 offset:49152
 v_add_f32 v26, v18, v26
M v[104:107], a[100:103], a[4:7], v[104:107]
 s_cselect_b64 s[76:77], s[48:49], s[78:79]
 ds_read_b128 a[68:71], v7 offset:50176
 v_cvt_pk_bf16_f32 v56, v18, v19
M v[104:107], a[104:107], a[8:11], v[104:107]
 buffer_load_dwordx4 v3, s[8:11], s24 offen offset:3072 sc1 lds
M v[104:107], a[108:111], a[12:15], v[104:107]
 s_cselect_b64 s[78:79], s[50:51], s[78:79]
 ds_read_b128 a[72:75], v7 offset:51200
 v_add_f32 v26, v19, v26
M v[104:107], a[112:115], a[16:19], v[104:107]
 s_add_u32 s3, s29, 0
 ds_read_b128 a[76:79], v7 offset:52224
 v_add_f32 v26, v20, v26
M v[104:107], a[116:119], a[20:23], v[104:107]
 buffer_store_dwordx4 a[192:195], v7, s[8:11], s3 offen sc1
M v[104:107], a[120:123], a[24:27], v[104:107]
 s_add_u32 m0, s28, 4096
 ds_read_b128 a[80:83], v7 offset:53248
 v_cvt_pk_bf16_f32 v57, v20, v21
M v[104:107], a[124:127], a[28:31], v[104:107]
 ds_read_b128 a[84:87], v7 offset:54272
 v_add_f32 v26, v21, v26
M v[108:111], a[124:127], a[60:63], v[36:39]
 buffer_load_dwordx4 v4, s[8:11], s24 offen offset:0 sc1 lds
M v[108:111], a[120:123], a[56:59], v[108:111]
 ds_read_b128 a[88:91], v7 offset:55296
M v[108:111], a[116:119], a[52:55], v[108:111]
 ds_read_b128 a[92:95], v7 offset:56320
M v[108:111], a[112:115], a[48:51], v[108:111]
 v_exp_f32 v22, v88
M v[108:111], a[108:111], a[44:47], v[108:111]
 buffer_load_dwordx4 v4, s[8:11], s24 offen offset:1024 sc1 lds
M v[108:111], a[104:107], a[40:43], v[108:111]
 v_exp_f32 v23, v89
M v[108:111], a[100:103], a[36:39], v[108:111]
 v_exp_f32 v24, v90
M v[108:111], a[96:99], a[32:35], v[108:111]
 s_waitcnt lgkmcnt(0)
 v_exp_f32 v25, v91
M v[112:115], a[64:67], a[0:3], v[32:35]
 s_add_u32 s3, s29, 32768
 ds_read_b128 a[96:99], v7 offset:57344
 v_add_f32 v26, v22, v26
M v[112:115], a[68:71], a[4:7], v[112:115]
 ds_read_b128 a[100:103], v7 offset:58368
 v_cvt_pk_bf16_f32 v58, v22, v23
M v[112:115], a[72:75], a[8:11], v[112:115]
 buffer_load_dwordx4 v4, s[8:11], s24 offen offset:2048 sc1 lds
M v[112:115], a[76:79], a[12:15], v[112:115]
 ds_read_b128 a[104:107], v7 offset:59392
 v_add_f32 v26, v23, v26
M v[112:115], a[80:83], a[16:19], v[112:115]
 ds_read_b128 a[108:111], v7 offset:60416
 v_add_f32 v26, v24, v26
M v[112:115], a[84:87], a[20:23], v[112:115]
 buffer_store_dwordx4 a[196:199], v7, s[8:11], s3 offen sc1
M v[112:115], a[88:91], a[24:27], v[112:115]
 ds_read_b128 a[112:115], v7 offset:61440
 v_cvt_pk_bf16_f32 v59, v24, v25
M v[112:115], a[92:95], a[28:31], v[112:115]
 ds_read_b128 a[116:119], v7 offset:62464
 v_add_f32 v26, v25, v26
M v[116:119], a[92:95], a[60:63], v[36:39]
 buffer_load_dwordx4 v4, s[8:11], s24 offen offset:3072 sc1 lds
M v[116:119], a[88:91], a[56:59], v[116:119]
 ds_read_b128 a[120:123], v7 offset:63488
M v[116:119], a[84:87], a[52:55], v[116:119]
 ds_read_b128 a[124:127], v7 offset:64512
M v[116:119], a[80:83], a[48:51], v[116:119]
 v_exp_f32 v18, v84
M v[116:119], a[76:79], a[44:47], v[116:119]
 v_exp_f32 v19, v85
M v[116:119], a[72:75], a[40:43], v[116:119]
 v_exp_f32 v20, v86
M v[116:119], a[68:71], a[36:39], v[116:119]
 s_waitcnt vmcnt(24) lgkmcnt(0)
 v_exp_f32 v21, v87
M v[116:119], a[64:67], a[32:35], v[116:119]
 s_barrier
M v[120:123], a[96:99], a[0:3], v[32:35]
 ds_read_b128 a[64:67], v2 offset:0
 v_add_f32 v27, v18, v27
M v[120:123], a[100:103], a[4:7], v[120:123]
 ds_read_b128 a[68:71], v2 offset:1024
 v_cvt_pk_bf16_f32 v60, v18, v19
M v[120:123], a[104:107], a[8:11], v[120:123]
 v_exp_f32 v22, v92
M v[120:123], a[108:111], a[12:15], v[120:123]
 ds_read_b128 a[72:75], v2 offset:2048
 v_add_f32 v27, v19, v27
M v[120:123], a[112:115], a[16:19], v[120:123]
 ds_read_b128 a[76:79], v2 offset:3072
 v_add_f32 v27, v20, v27
M v[120:123], a[116:119], a[20:23], v[120:123]
 v_exp_f32 v23, v93
M v[120:123], a[120:123], a[24:27], v[120:123]
 ds_read_b128 a[80:83], v2 offset:4096
 v_cvt_pk_bf16_f32 v61, v20, v21
M v[120:123], a[124:127], a[28:31], v[120:123]
 ds_read_b128 a[84:87], v2 offset:5120
 v_add_f32 v27, v21, v27
M v[124:127], a[124:127], a[60:63], v[36:39]
 v_exp_f32 v24, v94
M v[124:127], a[120:123], a[56:59], v[124:127]
 ds_read_b128 a[88:91], v2 offset:6144
 v_add_f32 v27, v22, v27
M v[124:127], a[116:119], a[52:55], v[124:127]
 ds_read_b128 a[92:95], v2 offset:7168
 v_cvt_pk_bf16_f32 v62, v22, v23
M v[124:127], a[112:115], a[48:51], v[124:127]
 v_exp_f32 v25, v95
M v[124:127], a[108:111], a[44:47], v[124:127]
 v_add_f32 v27, v23, v27
 v_add_f32 v27, v24, v27
M v[124:127], a[104:107], a[40:43], v[124:127]
 v_cvt_pk_bf16_f32 v63, v24, v25
 v_add_f32 v27, v25, v27
M v[124:127], a[100:103], a[36:39], v[124:127]
 s_waitcnt lgkmcnt(0)
M v[124:127], a[96:99], a[32:35], v[124:127]
 v_max_f32 v10, v26, v27
 v_cmp_lt_f32 vcc, s31, v10
 s_nop 0
 s_cbranch_vccnz L_st12
L_rt12:
M v[128:131], a[64:67], v[40:43], v[128:131]
 s_add_u32 m0, s28, 32768
 ds_read_b128 a[96:99], v2 offset:8192
 v_add_f32 v30, v26, v30
M v[128:131], a[68:71], v[56:59], v[128:131]
 ds_read_b128 a[100:103], v2 offset:9216
 v_add_f32 v31, v27, v31
M v[132:135], a[68:71], v[60:63], v[132:135]
 buffer_load_dwordx4 v3, s[8:11], s21 offen offset:0 sc1 lds
M v[132:135], a[64:67], v[44:47], v[132:135]
 s_add_u32 s3, s29, 65536
 ds_read_b128 a[104:107], v2 offset:10240
M v[136:139], a[72:75], v[40:43], v[136:139]
 ds_read_b128 a[108:111], v2 offset:11264
M v[136:139], a[76:79], v[56:59], v[136:139]
 buffer_load_dwordx4 v3, s[8:11], s21 offen offset:1024 sc1 lds
M v[140:143], a[76:79], v[60:63], v[140:143]
 ds_read_b128 a[112:115], v2 offset:12288
M v[140:143], a[72:75], v[44:47], v[140:143]
 ds_read_b128 a[116:119], v2 offset:13312
M v[144:147], a[80:83], v[40:43], v[144:147]
 buffer_store_dwordx4 a[200:203], v7, s[8:11], s3 offen sc1
M v[144:147], a[84:87], v[56:59], v[144:147]
 ds_read_b128 a[120:123], v2 offset:14336
M v[148:151], a[84:87], v[60:63], v[148:151]
 ds_read_b128 a[124:127], v2 offset:15360
M v[148:151], a[80:83], v[44:47], v[148:151]
 buffer_load_dwordx4 v3, s[8:11], s21 offen offset:2048 sc1 lds
M v[152:155], a[88:91], v[40:43], v[152:155]
 v_exp_f32 v18, v96
M v[152:155], a[92:95], v[56:59], v[152:155]
 v_exp_f32 v19, v97
M v[156:159], a[92:95], v[60:63], v[156:159]
 buffer_load_dwordx4 v3, s[8:11], s21 offen offset:3072 sc1 lds
M v[156:159], a[88:91], v[44:47], v[156:159]
 s_waitcnt lgkmcnt(0)
 v_exp_f32 v20, v98
M v[160:163], a[96:99], v[40:43], v[160:163]
 ds_read_b128 a[64:67], v2 offset:16384
 v_add_f32 v28, v18, v19
M v[160:163], a[100:103], v[56:59], v[160:163]
 s_add_u32 m0, s28, 36864
 ds_read_b128 a[68:71], v2 offset:17408
 v_cvt_pk_bf16_f32 v48, v18, v19
M v[164:167], a[100:103], v[60:63], v[164:167]
 buffer_load_dwordx4 v4, s[8:11], s21 offen offset:0 sc1 lds
M v[164:167], a[96:99], v[44:47], v[164:167]
 ds_read_b128 a[72:75], v2 offset:18432
M v[168:171], a[104:107], v[40:43], v[168:171]
 ds_read_b128 a[76:79], v2 offset:19456
M v[168:171], a[108:111], v[56:59], v[168:171]
 v_exp_f32 v21, v99
M v[172:175], a[108:111], v[60:63], v[172:175]
 ds_read_b128 a[80:83], v2 offset:20480
 v_add_f32 v28, v20, v28
M v[172:175], a[104:107], v[44:47], v[172:175]
 s_add_u32 s3, s29, 98304
 ds_read_b128 a[84:87], v2 offset:21504
 v_cvt_pk_bf16_f32 v49, v20, v21
M v[176:179], a[112:115], v[40:43], v[176:179]
 buffer_load_dwordx4 v4, s[8:11], s21 offen offset:1024 sc1 lds
M v[176:179], a[116:119], v[56:59], v[176:179]
 ds_read_b128 a[88:91], v2 offset:22528
 v_add_f32 v28, v21, v28
M v[180:183], a[116:119], v[60:63], v[180:183]
 ds_read_b128 a[92:95], v2 offset:23552
M v[180:183], a[112:115], v[44:47], v[180:183]
 buffer_load_dwordx4 v4, s[8:11], s21 offen offset:2048 sc1 lds
M v[184:187], a[120:123], v[40:43], v[184:187]
 buffer_store_dwordx4 a[204:207], v7, s[8:11], s3 offen sc1
M v[184:187], a[124:127], v[56:59], v[184:187]
 v_exp_f32 v22, v104
M v[188:191], a[124:127], v[60:63], v[188:191]
 v_exp_f32 v23, v105
M v[188:191], a[120:123], v[44:47], v[188:191]
 s_waitcnt lgkmcnt(0)
 v_exp_f32 v24, v106
M v[192:195], a[64:67], v[40:43], v[192:195]
 ds_read_b128 a[96:99], v2 offset:24576
 v_add_f32 v28, v22, v28
M v[192:195], a[68:71], v[56:59], v[192:195]
 ds_read_b128 a[100:103], v2 offset:25600
 v_cvt_pk_bf16_f32 v50, v22, v23
M v[196:199], a[68:71], v[60:63], v[196:199]
 buffer_load_dwordx4 v4, s[8:11], s21 offen offset:3072 sc1 lds
M v[196:199], a[64:67], v[44:47], v[196:199]
 s_add_u32 s24, s23, 16777216
 ds_read_b128 a[104:107], v2 offset:26624
 v_add_f32 v28, v23, v28
M v[200:203], a[72:75], v[40:43], v[200:203]
 s_mov_b32 s23, s21
 ds_read_b128 a[108:111], v2 offset:27648
M v[200:203], a[76:79], v[56:59], v[200:203]
 s_add_u32 s21, s21, 32768
 v_exp_f32 v25, v107
M v[204:207], a[76:79], v[60:63], v[204:207]
 s_add_u32 s22, s22, 1
 ds_read_b128 a[112:115], v2 offset:28672
 v_add_f32 v28, v24, v28
M v[204:207], a[72:75], v[44:47], v[204:207]
 s_cmp_eq_u32 s22, s25
 ds_read_b128 a[116:119], v2 offset:29696
 v_cvt_pk_bf16_f32 v51, v24, v25
M v[208:211], a[80:83], v[40:43], v[208:211]
 s_cselect_b32 s21, s26, s21
 v_exp_f32 v18, v100
M v[208:211], a[84:87], v[56:59], v[208:211]
 s_cmp_eq_u32 s22, s43
 ds_read_b128 a[120:123], v2 offset:30720
 v_add_f32 v28, v25, v28
M v[212:215], a[84:87], v[60:63], v[212:215]
 s_cselect_b32 s21, s4, s21
 ds_read_b128 a[124:127], v2 offset:31744
M v[212:215], a[80:83], v[44:47], v[212:215]
 s_cmp_eq_u32 s22, s6
 v_exp_f32 v19, v101
M v[216:219], a[88:91], v[40:43], v[216:219]
 s_cselect_b32 s21, s7, s21
 v_exp_f32 v20, v102
M v[216:219], a[92:95], v[56:59], v[216:219]
 v_exp_f32 v21, v103
M v[220:223], a[92:95], v[60:63], v[220:223]
 s_waitcnt vmcnt(21) lgkmcnt(0)
 v_exp_f32 v22, v108
M v[220:223], a[88:91], v[44:47], v[220:223]
 s_barrier
M v[224:227], a[96:99], v[40:43], v[224:227]
 ds_read_b128 a[64:67], v2 offset:32768
 v_add_f32 v29, v18, v19
M v[224:227], a[100:103], v[56:59], v[224:227]
 ds_read_b128 a[68:71], v2 offset:33792
 v_mov_b32 v17, 4
M v[228:231], a[100:103], v[60:63], v[228:231]
 s_waitcnt vmcnt(20)
 v_cmp_gt_u32 vcc, 3, v6
 v_cvt_pk_bf16_f32 v52, v18, v19
M v[228:231], a[96:99], v[44:47], v[228:231]
 ds_read_b128 a[72:75], v2 offset:34816
 v_add_f32 v29, v20, v29
M v[232:235], a[104:107], v[40:43], v[232:235]
 ds_read_b128 a[76:79], v2 offset:35840
 v_cvt_pk_bf16_f32 v53, v20, v21
M v[232:235], a[108:111], v[56:59], v[232:235]
 s_cbranch_vccnz L_f4s
L_f4r:
 v_exp_f32 v23, v109
M v[236:239], a[108:111], v[60:63], v[236:239]
 ds_read_b128 a[80:83], v2 offset:36864
 v_add_f32 v29, v21, v29
M v[236:239], a[104:107], v[44:47], v[236:239]
 ds_read_b128 a[84:87], v2 offset:37888
 v_add_f32 v29, v22, v29
M v[240:243], a[112:115], v[40:43], v[240:243]
 buffer_store_dword v17, v1, s[8:11], s45 offen sc1
M v[240:243], a[116:119], v[56:59], v[240:243]
 ds_read_b128 a[88:91], v2 offset:38912
 v_cvt_pk_bf16_f32 v54, v22, v23
M v[244:247], a[116:119], v[60:63], v[244:247]
 ds_read_b128 a[92:95], v2 offset:39936
 v_add_f32 v29, v23, v29
M v[244:247], a[112:115], v[44:47], v[244:247]
 v_exp_f32 v24, v110
M v[248:251], a[120:123], v[40:43], v[248:251]
 v_exp_f32 v25, v111
M v[248:251], a[124:127], v[56:59], v[248:251]
 v_add_f32 v29, v24, v29
 v_cvt_pk_bf16_f32 v55, v24, v25
M v[252:255], a[124:127], v[60:63], v[252:255]
 s_waitcnt lgkmcnt(0)
 v_add_f32 v29, v25, v29
M v[252:255], a[120:123], v[44:47], v[252:255]
M v[64:67], a[64:67], a[0:3], v[32:35]
 s_add_u32 m0, s28, 65536
 ds_read_b128 a[96:99], v2 offset:40960
M v[64:67], a[68:71], a[4:7], v[64:67]
 ds_read_b128 a[100:103], v2 offset:41984
M v[64:67], a[72:75], a[8:11], v[64:67]
 buffer_load_dwordx4 v3, s[8:11], s24 offen offset:0 sc1 lds
M v[64:67], a[76:79], a[12:15], v[64:67]
 s_cmp_lt_u32 s20, 2
 ds_read_b128 a[104:107], v2 offset:43008
M v[64:67], a[80:83], a[16:19], v[64:67]
 s_cselect_b64 s[86:87], -1, 0
 ds_read_b128 a[108:111], v2 offset:44032
M v[64:67], a[84:87], a[20:23], v[64:67]
 s_cmp_eq_u32 s20, 2
 v_exp_f32 v18, v112
M v[64:67], a[88:91], a[24:27], v[64:67]
 s_cselect_b64 s[80:81], s[16:17], s[86:87]
 ds_read_b128 a[112:115], v2 offset:45056
M v[64:67], a[92:95], a[28:31], v[64:67]
 s_cselect_b64 s[82:83], s[18:19], s[86:87]
 ds_read_b128 a[116:119], v2 offset:46080
M v[68:71], a[92:95], a[60:63], v[36:39]
 buffer_load_dwordx4 v3, s[8:11], s24 offen offset:1024 sc1 lds
M v[68:71], a[88:91], a[56:59], v[68:71]
 s_cselect_b64 s[84:85], s[48:49], s[86:87]
 ds_read_b128 a[120:123], v2 offset:47104
M v[68:71], a[84:87], a[52:55], v[68:71]
 s_cselect_b64 s[86:87], s[50:51], s[86:87]
 ds_read_b128 a[124:127], v2 offset:48128
M v[68:71], a[80:83], a[48:51], v[68:71]
 s_cmp_eq_u32 s20, 3
 v_exp_f32 v19, v113
M v[68:71], a[76:79], a[44:47], v[68:71]
 buffer_load_dwordx4 v3, s[8:11], s24 offen offset:2048 sc1 lds
M v[68:71], a[72:75], a[40:43], v[68:71]
 s_cselect_b64 s[88:89], s[16:17], -1
 v_exp_f32 v20, v114
M v[68:71], a[68:71], a[36:39], v[68:71]
 s_cselect_b64 s[90:91], s[18:19], -1
 v_exp_f32 v21, v115
M v[68:71], a[64:67], a[32:35], v[68:71]
 s_waitcnt lgkmcnt(0)
 v_exp_f32 v22, v120
M v[72:75], a[96:99], a[0:3], v[32:35]
 s_cselect_b64 s[92:93], s[48:49], -1
 ds_read_b128 a[64:67], v2 offset:49152
 v_add_f32 v28, v18, v28
M v[72:75], a[100:103], a[4:7], v[72:75]
 s_cselect_b64 s[94:95], s[50:51], -1
 ds_read_b128 a[68:71], v2 offset:50176
 v_cvt_pk_bf16_f32 v56, v18, v19
M v[72:75], a[104:107], a[8:11], v[72:75]
 buffer_load_dwordx4 v3, s[8:11], s24 offen offset:3072 sc1 lds
M v[72:75], a[108:111], a[12:15], v[72:75]
 s_add_u32 s3, s29, 131072
 ds_read_b128 a[72:75], v2 offset:51200
 v_add_f32 v28, v19, v28
M v[72:75], a[112:115], a[16:19], v[72:75]
 ds_read_b128 a[76:79], v2 offset:52224
 v_add_f32 v28, v20, v28
M v[72:75], a[116:119], a[20:23], v[72:75]
 buffer_store_dwordx4 a[208:211], v7, s[8:11], s3 offen sc1
M v[72:75], a[120:123], a[24:27], v[72:75]
 s_add_u32 m0, s28, 69632
 ds_read_b128 a[80:83], v2 offset:53248
 v_cvt_pk_bf16_f32 v57, v20, v21
M v[72:75], a[124:127], a[28:31], v[72:75]
 ds_read_b128 a[84:87], v2 offset:54272
 v_add_f32 v28, v21, v28
M v[76:79], a[124:127], a[60:63], v[36:39]
 buffer_load_dwordx4 v4, s[8:11], s24 offen offset:0 sc1 lds
M v[76:79], a[120:123], a[56:59], v[76:79]
 ds_read_b128 a[88:91], v2 offset:55296
M v[76:79], a[116:119], a[52:55], v[76:79]
 ds_read_b128 a[92:95], v2 offset:56320
M v[76:79], a[112:115], a[48:51], v[76:79]
 v_exp_f32 v23, v121
M v[76:79], a[108:111], a[44:47], v[76:79]
 buffer_load_dwordx4 v4, s[8:11], s24 offen offset:1024 sc1 lds
M v[76:79], a[104:107], a[40:43], v[76:79]
 v_exp_f32 v24, v122
M v[76:79], a[100:103], a[36:39], v[76:79]
 s_add_u32 s3, s29, 163840
 v_exp_f32 v25, v123
M v[76:79], a[96:99], a[32:35], v[76:79]
 s_waitcnt lgkmcnt(0)
 v_exp_f32 v18, v116
M v[80:83], a[64:67], a[0:3], v[32:35]
 ds_read_b128 a[96:99], v2 offset:57344
 v_add_f32 v28, v22, v28
M v[80:83], a[68:71], a[4:7], v[80:83]
 ds_read_b128 a[100:103], v2 offset:58368
 v_cvt_pk_bf16_f32 v58, v22, v23
M v[80:83], a[72:75], a[8:11], v[80:83]
 buffer_load_dwordx4 v4, s[8:11], s24 offen offset:2048 sc1 lds
M v[80:83], a[76:79], a[12:15], v[80:83]
 ds_read_b128 a[104:107], v2 offset:59392
 v_add_f32 v28, v23, v28
M v[80:83], a[80:83], a[16:19], v[80:83]
 ds_read_b128 a[108:111], v2 offset:60416
 v_add_f32 v28, v24, v28
M v[80:83], a[84:87], a[20:23], v[80:83]
 buffer_store_dwordx4 a[212:215], v7, s[8:11], s3 offen sc1
M v[80:83], a[88:91], a[24:27], v[80:83]
 ds_read_b128 a[112:115], v2 offset:61440
 v_cvt_pk_bf16_f32 v59, v24, v25
M v[80:83], a[92:95], a[28:31], v[80:83]
 ds_read_b128 a[116:119], v2 offset:62464
 v_add_f32 v28, v25, v28
M v[84:87], a[92:95], a[60:63], v[36:39]
 buffer_load_dwordx4 v4, s[8:11], s24 offen offset:3072 sc1 lds
M v[84:87], a[88:91], a[56:59], v[84:87]
 ds_read_b128 a[120:123], v2 offset:63488
M v[84:87], a[84:87], a[52:55], v[84:87]
 ds_read_b128 a[124:127], v2 offset:64512
M v[84:87], a[80:83], a[48:51], v[84:87]
 v_exp_f32 v19, v117
M v[84:87], a[76:79], a[44:47], v[84:87]
 v_exp_f32 v20, v118
M v[84:87], a[72:75], a[40:43], v[84:87]
 v_exp_f32 v21, v119
M v[84:87], a[68:71], a[36:39], v[84:87]
 s_waitcnt vmcnt(21) lgkmcnt(0)
 v_exp_f32 v22, v124
M v[84:87], a[64:67], a[32:35], v[84:87]
 s_barrier
M v[88:91], a[96:99], a[0:3], v[32:35]
 ds_read_b128 a[64:67], v7 offset:0
 v_add_f32 v29, v18, v29
M v[88:91], a[100:103], a[4:7], v[88:91]
 ds_read_b128 a[68:71], v7 offset:1024
 v_cvt_pk_bf16_f32 v60, v18, v19
M v[88:91], a[104:107], a[8:11], v[88:91]
 v_exp_f32 v23, v125
M v[88:91], a[108:111], a[12:15], v[88:91]
 ds_read_b128 a[72:75], v7 offset:2048
 v_add_f32 v29, v19, v29
M v[88:91], a[112:115], a[16:19], v[88:91]
 ds_read_b128 a[76:79], v7 offset:3072
 v_add_f32 v29, v20, v29
M v[88:91], a[116:119], a[20:23], v[88:91]
 v_exp_f32 v24, v126
M v[88:91], a[120:123], a[24:27], v[88:91]
 ds_read_b128 a[80:83], v7 offset:4096
 v_cvt_pk_bf16_f32 v61, v20, v21
M v[88:91], a[124:127], a[28:31], v[88:91]
 ds_read_b128 a[84:87], v7 offset:5120
 v_add_f32 v29, v21, v29
M v[92:95], a[124:127], a[60:63], v[36:39]
 v_exp_f32 v25, v127
M v[92:95], a[120:123], a[56:59], v[92:95]
 ds_read_b128 a[88:91], v7 offset:6144
 v_add_f32 v29, v22, v29
M v[92:95], a[116:119], a[52:55], v[92:95]
 ds_read_b128 a[92:95], v7 offset:7168
 v_cvt_pk_bf16_f32 v62, v22, v23
M v[92:95], a[112:115], a[48:51], v[92:95]
 v_add_f32 v29, v23, v29
 v_add_f32 v29, v24, v29
M v[92:95], a[108:111], a[44:47], v[92:95]
 v_cvt_pk_bf16_f32 v63, v24, v25
 v_add_f32 v29, v25, v29
M v[92:95], a[104:107], a[40:43], v[92:95]
M v[92:95], a[100:103], a[36:39], v[92:95]
 s_waitcnt lgkmcnt(0)
M v[92:95], a[96:99], a[32:35], v[92:95]
 v_max_f32 v10, v28, v29
 v_cmp_lt_f32 vcc, s31, v10
 s_nop 0
 s_cbranch_vccnz L_st13
L_rt13:
M v[128:131], a[64:67], v[48:51], v[128:131]
 s_add_u32 m0, s28, 98304
 ds_read_b128 a[96:99], v7 offset:8192
 v_add_f32 v30, v28, v30
M v[128:131], a[68:71], v[56:59], v[128:131]
 s_add_u32 s3, s29, 196608
 ds_read_b128 a[100:103], v7 offset:9216
 v_add_f32 v31, v29, v31
M v[132:135], a[68:71], v[60:63], v[132:135]
 buffer_load_dwordx4 v3, s[8:11], s21 offen offset:0 sc1 lds
M v[132:135], a[64:67], v[52:55], v[132:135]
 ds_read_b128 a[104:107], v7 offset:10240
M v[136:139], a[72:75], v[48:51], v[136:139]
 ds_read_b128 a[108:111], v7 offset:11264
M v[136:139], a[76:79], v[56:59], v[136:139]
 buffer_load_dwordx4 v3, s[8:11], s21 offen offset:1024 sc1 lds
M v[140:143], a[76:79], v[60:63], v[140:143]
 ds_read_b128 a[112:115], v7 offset:12288
M v[140:143], a[72:75], v[52:55], v[140:143]
 ds_read_b128 a[116:119], v7 offset:13312
M v[144:147], a[80:83], v[48:51], v[144:147]
 buffer_store_dwordx4 a[216:219], v7, s[8:11], s3 offen sc1
M v[144:147], a[84:87], v[56:59], v[144:147]
 ds_read_b128 a[120:123], v7 offset:14336
M v[148:151], a[84:87], v[60:63], v[148:151]
 ds_read_b128 a[124:127], v7 offset:15360
M v[148:151], a[80:83], v[52:55], v[148:151]
 buffer_load_dwordx4 v3, s[8:11], s21 offen offset:2048 sc1 lds
M v[152:155], a[88:91], v[48:51], v[152:155]
 v_exp_f32 v18, v64
M v[152:155], a[92:95], v[56:59], v[152:155]
 v_exp_f32 v19, v65
M v[156:159], a[92:95], v[60:63], v[156:159]
 buffer_load_dwordx4 v3, s[8:11], s21 offen offset:3072 sc1 lds
M v[156:159], a[88:91], v[52:55], v[156:159]
 s_waitcnt lgkmcnt(0)
 v_exp_f32 v20, v66
M v[160:163], a[96:99], v[48:51], v[160:163]
 ds_read_b128 a[64:67], v7 offset:16384
 v_add_f32 v26, v18, v19
M v[160:163], a[100:103], v[56:59], v[160:163]
 s_add_u32 m0, s28, 102400
 ds_read_b128 a[68:71], v7 offset:17408
 v_cvt_pk_bf16_f32 v40, v18, v19
M v[164:167], a[100:103], v[60:63], v[164:167]
 buffer_load_dwordx4 v4, s[8:11], s21 offen offset:0 sc1 lds
M v[164:167], a[96:99], v[52:55], v[164:167]
 ds_read_b128 a[72:75], v7 offset:18432
M v[168:171], a[104:107], v[48:51], v[168:171]
 ds_read_b128 a[76:79], v7 offset:19456
M v[168:171], a[108:111], v[56:59], v[168:171]
 v_exp_f32 v21, v67
M v[172:175], a[108:111], v[60:63], v[172:175]
 ds_read_b128 a[80:83], v7 offset:20480
 v_add_f32 v26, v20, v26
M v[172:175], a[104:107], v[52:55], v[172:175]
 ds_read_b128 a[84:87], v7 offset:21504
 v_cvt_pk_bf16_f32 v41, v20, v21
M v[176:179], a[112:115], v[48:51], v[176:179]
 buffer_load_dwordx4 v4, s[8:11], s21 offen offset:1024 sc1 lds
M v[176:179], a[116:119], v[56:59], v[176:179]
 ds_read_b128 a[88:91], v7 offset:22528
 v_add_f32 v26, v21, v26
M v[180:183], a[116:119], v[60:63], v[180:183]
 ds_read_b128 a[92:95], v7 offset:23552
M v[180:183], a[112:115], v[52:55], v[180:183]
 buffer_load_dwordx4 v4, s[8:11], s21 offen offset:2048 sc1 lds
M v[184:187], a[120:123], v[48:51], v[184:187]
 v_exp_f32 v22, v72
M v[184:187], a[124:127], v[56:59], v[184:187]
 v_exp_f32 v23, v73
M v[188:191], a[124:127], v[60:63], v[188:191]
 v_exp_f32 v24, v74
M v[188:191], a[120:123], v[52:55], v[188:191]
 s_waitcnt lgkmcnt(0)
 v_exp_f32 v25, v75
M v[192:195], a[64:67], v[48:51], v[192:195]
 ds_read_b128 a[96:99], v7 offset:24576
 v_add_f32 v26, v22, v26
M v[192:195], a[68:71], v[56:59], v[192:195]
 ds_read_b128 a[100:103], v7 offset:25600
 v_cvt_pk_bf16_f32 v42, v22, v23
M v[196:199], a[68:71], v[60:63], v[196:199]
 buffer_load_dwordx4 v4, s[8:11], s21 offen offset:3072 sc1 lds
M v[196:199], a[64:67], v[52:55], v[196:199]
 s_add_u32 s24, s23, 16777216
 ds_read_b128 a[104:107], v7 offset:26624
 v_add_f32 v26, v23, v26
M v[200:203], a[72:75], v[48:51], v[200:203]
 s_mov_b32 s23, s21
 ds_read_b128 a[108:111], v7 offset:27648
 v_add_f32 v26, v24, v26
M v[200:203], a[76:79], v[56:59], v[200:203]
 s_add_u32 s21, s21, 32768
 v_exp_f32 v18, v68
M v[204:207], a[76:79], v[60:63], v[204:207]
 s_add_u32 s22, s22, 1
 ds_read_b128 a[112:115], v7 offset:28672
 v_cvt_pk_bf16_f32 v43, v24, v25
M v[204:207], a[72:75], v[52:55], v[204:207]
 s_cmp_eq_u32 s22, s25
 ds_read_b128 a[116:119], v7 offset:29696
 v_add_f32 v26, v25, v26
M v[208:211], a[80:83], v[48:51], v[208:211]
 s_cselect_b32 s21, s26, s21
 v_exp_f32 v19, v69
M v[208:211], a[84:87], v[56:59], v[208:211]
 s_cmp_eq_u32 s22, s43
 ds_read_b128 a[120:123], v7 offset:30720
 v_add_f32 v27, v18, v19
M v[212:215], a[84:87], v[60:63], v[212:215]
 s_cselect_b32 s21, s4, s21
 ds_read_b128 a[124:127], v7 offset:31744
 v_cvt_pk_bf16_f32 v44, v18, v19
M v[212:215], a[80:83], v[52:55], v[212:215]
 s_cmp_eq_u32 s22, s6
 v_exp_f32 v20, v70
M v[216:219], a[88:91], v[48:51], v[216:219]
 s_cselect_b32 s21, s7, s21
 v_exp_f32 v21, v71
M v[216:219], a[92:95], v[56:59], v[216:219]
 v_exp_f32 v22, v76
M v[220:223], a[92:95], v[60:63], v[220:223]
 s_waitcnt vmcnt(20) lgkmcnt(0)
 v_add_f32 v27, v20, v27
 v_cvt_pk_bf16_f32 v45, v20, v21
M v[220:223], a[88:91], v[52:55], v[220:223]
 s_barrier
M v[224:227], a[96:99], v[48:51], v[224:227]
 ds_read_b128 a[64:67], v7 offset:32768
 v_add_f32 v27, v21, v27
M v[224:227], a[100:103], v[56:59], v[224:227]
 ds_read_b128 a[68:71], v7 offset:33792
M v[228:231], a[100:103], v[60:63], v[228:231]
 v_exp_f32 v23, v77
M v[228:231], a[96:99], v[52:55], v[228:231]
 ds_read_b128 a[72:75], v7 offset:34816
 v_add_f32 v27, v22, v27
M v[232:235], a[104:107], v[48:51], v[232:235]
 ds_read_b128 a[76:79], v7 offset:35840
 v_cvt_pk_bf16_f32 v46, v22, v23
M v[232:235], a[108:111], v[56:59], v[232:235]
 v_exp_f32 v24, v78
M v[236:239], a[108:111], v[60:63], v[236:239]
 ds_read_b128 a[80:83], v7 offset:36864
 v_add_f32 v27, v23, v27
M v[236:239], a[104:107], v[52:55], v[236:239]
 ds_read_b128 a[84:87], v7 offset:37888
M v[240:243], a[112:115], v[48:51], v[240:243]
 v_exp_f32 v25, v79
M v[240:243], a[116:119], v[56:59], v[240:243]
 ds_read_b128 a[88:91], v7 offset:38912
 v_add_f32 v27, v24, v27
M v[244:247], a[116:119], v[60:63], v[244:247]
 ds_read_b128 a[92:95], v7 offset:39936
 v_cvt_pk_bf16_f32 v47, v24, v25
M v[244:247], a[112:115], v[52:55], v[244:247]
 v_add_f32 v27, v25, v27
M v[248:251], a[120:123], v[48:51], v[248:251]
M v[248:251], a[124:127], v[56:59], v[248:251]
M v[252:255], a[124:127], v[60:63], v[252:255]
 s_waitcnt lgkmcnt(0)
M v[252:255], a[120:123], v[52:55], v[252:255]
 s_branch L_loop_mid
L_zs0:
 s_mov_b32 s64, 65536
L_zs0_l:
 s_sleep 2
 buffer_load_dword v17, v16, s[12:15], 0 offen offset:64 sc1
 s_sub_u32 s64, s64, 1
 s_cbranch_scc1 L_zs0_x
 s_waitcnt vmcnt(0)
 v_cmp_ne_u32 vcc, 1, v17
 s_nop 0
 s_cbranch_vccnz L_zs0_l
L_zs0_x:
 s_waitcnt vmcnt(0)
 s_branch L_zr0
L_zs1:
 s_mov_b32 s64, 65536
L_zs1_l:
 s_sleep 2
 buffer_load_dword v17, v16, s[12:15], 0 offen offset:64 sc1
 s_sub_u32 s64, s64, 1
 s_cbranch_scc1 L_zs1_x
 s_waitcnt vmcnt(0)
 v_cmp_ne_u32 vcc, 1, v17
 s_nop 0
 s_cbranch_vccnz L_zs1_l
L_zs1_x:
 s_waitcnt vmcnt(0)
 s_branch L_zr1
L_hs:
 s_mov_b32 s91, 65536
L_hs_l:
 buffer_load_dwordx4 v[16:19], v7, s[8:11], s67 offen offset:0 sc1
 buffer_load_dwordx4 v[20:23], v7, s[8:11], s67 offen offset:1024 sc1
 s_waitcnt vmcnt(0)
 s_sub_u32 s91, s91, 1
 s_cbranch_scc1 L_hr
 v_min3_u32 v28, v16, v17, v18
 v_min3_u32 v28, v28, v19, v20
 v_min3_u32 v28, v28, v21, v22
 v_min_u32 v28, v28, v23
 v_cmp_eq_u32 vcc, 0, v28
 s_nop 0
 s_cbranch_vccnz L_hs_l
 s_branch L_hr
L_f1s04:
 s_mov_b32 s91, 65536
L_f1s04_l:
 s_sleep 2
 buffer_load_dword v24, v13, s[8:11], s46 offen sc1
 s_sub_u32 s91, s91, 1
 s_cbranch_scc1 L_f1s04_x
 s_waitcnt vmcnt(0)
 v_cmp_eq_u32 vcc, 0, v24
 s_nop 0
 s_cbranch_vccnz L_f1s04_l
L_f1s04_x:
 s_waitcnt vmcnt(0)
 s_branch L_f1r04
L_f1s05:
 s_mov_b32 s91, 65536
L_f1s05_l:
 s_sleep 2
 buffer_load_dword v24, v9, s[8:11], s46 offen sc1
 s_sub_u32 s91, s91, 1
 s_cbranch_scc1 L_f1s05_x
 s_waitcnt vmcnt(0)
 v_cmp_eq_u32 vcc, 0, v24
 s_nop 0
 s_cbranch_vccnz L_f1s05_l
L_f1s05_x:
 s_waitcnt vmcnt(0)
 s_branch L_f1r05
L_f1s14:
 s_mov_b32 s91, 65536
L_f1s14_l:
 s_sleep 2
 buffer_load_dword v24, v13, s[8:11], s46 offen sc1
 s_sub_u32 s91, s91, 1
 s_cbranch_scc1 L_f1s14_x
 s_waitcnt vmcnt(0)
 v_cmp_eq_u32 vcc, 0, v24
 s_nop 0
 s_cbranch_vccnz L_f1s14_l
L_f1s14_x:
 s_waitcnt vmcnt(0)
 s_branch L_f1r14
L_f1s15:
 s_mov_b32 s91, 65536
L_f1s15_l:
 s_sleep 2
 buffer_load_dword v24, v9, s[8:11], s46 offen sc1
 s_sub_u32 s91, s91, 1
 s_cbranch_scc1 L_f1s15_x
 s_waitcnt vmcnt(0)
 v_cmp_eq_u32 vcc, 0, v24
 s_nop 0
 s_cbranch_vccnz L_f1s15_l
L_f1s15_x:
 s_waitcnt vmcnt(0)
 s_branch L_f1r15
.p2align 6
L_loop_top:
M v[64:67], a[64:67], a[0:3], v[32:35]
 s_add_u32 m0, s28, 65536
 ds_read_b128 a[96:99], v2 offset:40960
M v[64:67], a[68:71], a[4:7], v[64:67]
 ds_read_b128 a[100:103], v2 offset:41984
M v[64:67], a[72:75], a[8:11], v[64:67]
 buffer_load_dword a240, v0, s[60:63], 0 offen offset:0
M v[64:67], a[76:79], a[12:15], v[64:67]
 ds_read_b128 a[104:107], v2 offset:43008
M v[64:67], a[80:83], a[16:19], v[64:67]
 ds_read_b128 a[108:111], v2 offset:44032
M v[64:67], a[84:87], a[20:23], v[64:67]
 buffer_load_dwordx4 v3, s[8:11], s24 offen offset:0 sc1 lds
M v[64:67], a[88:91], a[24:27], v[64:67]
 ds_read_b128 a[112:115], v2 offset:45056
M v[64:67], a[92:95], a[28:31], v[64:67]
 ds_read_b128 a[116:119], v2 offset:46080
M v[68:71], a[92:95], a[60:63], v[36:39]
 buffer_load_dwordx4 v3, s[8:11], s24 offen offset:1024 sc1 lds
M v[68:71], a[88:91], a[56:59], v[68:71]
 ds_read_b128 a[120:123], v2 offset:47104
M v[68:71], a[84:87], a[52:55], v[68:71]
 ds_read_b128 a[124:127], v2 offset:48128
M v[68:71], a[80:83], a[48:51], v[68:71]
 v_exp_f32 v18, v112
M v[68:71], a[76:79], a[44:47], v[68:71]
 buffer_load_dwordx4 v3, s[8:11], s24 offen offset:2048 sc1 lds
M v[68:71], a[72:75], a[40:43], v[68:71]
 v_exp_f32 v19, v113
M v[68:71], a[68:71], a[36:39], v[68:71]
 v_exp_f32 v20, v114
M v[68:71], a[64:67], a[32:35], v[68:71]
 s_waitcnt lgkmcnt(0)
 v_exp_f32 v21, v115
M v[72:75], a[96:99], a[0:3], v[32:35]
 ds_read_b128 a[64:67], v2 offset:49152
 v_add_f32 v28, v18, v28
M v[72:75], a[100:103], a[4:7], v[72:75]
 ds_read_b128 a[68:71], v2 offset:50176
 v_cvt_pk_bf16_f32 v56, v18, v19
M v[72:75], a[104:107], a[8:11], v[72:75]
 buffer_load_dwordx4 v3, s[8:11], s24 offen offset:3072 sc1 lds
M v[72:75], a[108:111], a[12:15], v[72:75]
 ds_read_b128 a[72:75], v2 offset:51200
 v_add_f32 v28, v19, v28
M v[72:75], a[112:115], a[16:19], v[72:75]
 ds_read_b128 a[76:79], v2 offset:52224
 v_add_f32 v28, v20, v28
M v[72:75], a[116:119], a[20:23], v[72:75]
 v_exp_f32 v22, v120
M v[72:75], a[120:123], a[24:27], v[72:75]
 s_add_u32 m0, s28, 69632
 ds_read_b128 a[80:83], v2 offset:53248
 v_cvt_pk_bf16_f32 v57, v20, v21
M v[72:75], a[124:127], a[28:31], v[72:75]
 ds_read_b128 a[84:87], v2 offset:54272
 v_add_f32 v28, v21, v28
M v[76:79], a[124:127], a[60:63], v[36:39]
 buffer_load_dwordx4 v4, s[8:11], s24 offen offset:0 sc1 lds
M v[76:79], a[120:123], a[56:59], v[76:79]
 ds_read_b128 a[88:91], v2 offset:55296
M v[76:79], a[116:119], a[52:55], v[76:79]
 ds_read_b128 a[92:95], v2 offset:56320
M v[76:79], a[112:115], a[48:51], v[76:79]
 v_exp_f32 v23, v121
M v[76:79], a[108:111], a[44:47], v[76:79]
 buffer_load_dwordx4 v4, s[8:11], s24 offen offset:1024 sc1 lds
M v[76:79], a[104:107], a[40:43], v[76:79]
 v_exp_f32 v24, v122
M v[76:79], a[100:103], a[36:39], v[76:79]
 v_exp_f32 v25, v123
M v[76:79], a[96:99], a[32:35], v[76:79]
 s_waitcnt lgkmcnt(0)
 v_exp_f32 v18, v116
M v[80:83], a[64:67], a[0:3], v[32:35]
 ds_read_b128 a[96:99], v2 offset:57344
 v_add_f32 v28, v22, v28
M v[80:83], a[68:71], a[4:7], v[80:83]
 ds_read_b128 a[100:103], v2 offset:58368
 v_cvt_pk_bf16_f32 v58, v22, v23
M v[80:83], a[72:75], a[8:11], v[80:83]
 buffer_load_dwordx4 v4, s[8:11], s24 offen offset:2048 sc1 lds
M v[80:83], a[76:79], a[12:15], v[80:83]
 ds_read_b128 a[104:107], v2 offset:59392
 v_add_f32 v28, v23, v28
M v[80:83], a[80:83], a[16:19], v[80:83]
 ds_read_b128 a[108:111], v2 offset:60416
 v_add_f32 v28, v24, v28
M v[80:83], a[84:87], a[20:23], v[80:83]
 v_exp_f32 v19, v117
M v[80:83], a[88:91], a[24:27], v[80:83]
 ds_read_b128 a[112:115], v2 offset:61440
 v_cvt_pk_bf16_f32 v59, v24, v25
M v[80:83], a[92:95], a[28:31], v[80:83]
 ds_read_b128 a[116:119], v2 offset:62464
 v_add_f32 v28, v25, v28
M v[84:87], a[92:95], a[60:63], v[36:39]
 buffer_load_dwordx4 v4, s[8:11], s24 offen offset:3072 sc1 lds
M v[84:87], a[88:91], a[56:59], v[84:87]
 ds_read_b128 a[120:123], v2 offset:63488
 v_add_f32 v29, v18, v29
M v[84:87], a[84:87], a[52:55], v[84:87]
 ds_read_b128 a[124:127], v2 offset:64512
 v_cvt_pk_bf16_f32 v60, v18, v19
M v[84:87], a[80:83], a[48:51], v[84:87]
 v_exp_f32 v20, v118
M v[84:87], a[76:79], a[44:47], v[84:87]
 v_exp_f32 v21, v119
M v[84:87], a[72:75], a[40:43], v[84:87]
 v_exp_f32 v22, v124
M v[84:87], a[68:71], a[36:39], v[84:87]
 s_waitcnt vmcnt(17) lgkmcnt(0)
 v_exp_f32 v23, v125
M v[84:87], a[64:67], a[32:35], v[84:87]
 s_barrier
M v[88:91], a[96:99], a[0:3], v[32:35]
 ds_read_b128 a[64:67], v7 offset:0
 v_add_f32 v29, v19, v29
M v[88:91], a[100:103], a[4:7], v[88:91]
 ds_read_b128 a[68:71], v7 offset:1024
 v_add_f32 v29, v20, v29
M v[88:91], a[104:107], a[8:11], v[88:91]
 v_exp_f32 v24, v126
M v[88:91], a[108:111], a[12:15], v[88:91]
 ds_read_b128 a[72:75], v7 offset:2048
 v_cvt_pk_bf16_f32 v61, v20, v21
M v[88:91], a[112:115], a[16:19], v[88:91]
 ds_read_b128 a[76:79], v7 offset:3072
 v_add_f32 v29, v21, v29
M v[88:91], a[116:119], a[20:23], v[88:91]
 v_exp_f32 v25, v127
M v[88:91], a[120:123], a[24:27], v[88:91]
 ds_read_b128 a[80:83], v7 offset:4096
 v_add_f32 v29, v22, v29
M v[88:91], a[124:127], a[28:31], v[88:91]
 ds_read_b128 a[84:87], v7 offset:5120
 v_cvt_pk_bf16_f32 v62, v22, v23
M v[92:95], a[124:127], a[60:63], v[36:39]
 v_add_f32 v29, v23, v29
 v_add_f32 v29, v24, v29
M v[92:95], a[120:123], a[56:59], v[92:95]
 ds_read_b128 a[88:91], v7 offset:6144
 v_cvt_pk_bf16_f32 v63, v24, v25
M v[92:95], a[116:119], a[52:55], v[92:95]
 ds_read_b128 a[92:95], v7 offset:7168
 v_add_f32 v29, v25, v29
M v[92:95], a[112:115], a[48:51], v[92:95]
 v_max_f32 v10, v28, v29
M v[92:95], a[108:111], a[44:47], v[92:95]
 v_cmp_lt_f32 vcc, s31, v10
M v[92:95], a[104:107], a[40:43], v[92:95]
M v[92:95], a[100:103], a[36:39], v[92:95]
 s_waitcnt lgkmcnt(0)
M v[92:95], a[96:99], a[32:35], v[92:95]
 s_cbranch_vccnz L_st1
L_rt1:
M v[128:131], a[64:67], v[48:51], v[128:131]
 s_add_u32 m0, s28, 98304
 ds_read_b128 a[96:99], v7 offset:8192
 v_add_f32 v30, v28, v30
M v[128:131], a[68:71], v[56:59], v[128:131]
 ds_read_b128 a[100:103], v7 offset:9216
 v_add_f32 v31, v29, v31
M v[132:135], a[68:71], v[60:63], v[132:135]
 buffer_load_dwordx4 v3, s[8:11], s21 offen offset:0 sc1 lds
M v[132:135], a[64:67], v[52:55], v[132:135]
 ds_read_b128 a[104:107], v7 offset:10240
M v[136:139], a[72:75], v[48:51], v[136:139]
 ds_read_b128 a[108:111], v7 offset:11264
M v[136:139], a[76:79], v[56:59], v[136:139]
 buffer_load_dwordx4 v3, s[8:11], s21 offen offset:1024 sc1 lds
M v[140:143], a[76:79], v[60:63], v[140:143]
 ds_read_b128 a[112:115], v7 offset:12288
M v[140:143], a[72:75], v[52:55], v[140:143]
 ds_read_b128 a[116:119], v7 offset:13312
M v[144:147], a[80:83], v[48:51], v[144:147]
 v_exp_f32 v18, v64
M v[144:147], a[84:87], v[56:59], v[144:147]
 ds_read_b128 a[120:123], v7 offset:14336
M v[148:151], a[84:87], v[60:63], v[148:151]
 ds_read_b128 a[124:127], v7 offset:15360
M v[148:151], a[80:83], v[52:55], v[148:151]
 buffer_load_dwordx4 v3, s[8:11], s21 offen offset:2048 sc1 lds
M v[152:155], a[88:91], v[48:51], v[152:155]
 v_exp_f32 v19, v65
M v[152:155], a[92:95], v[56:59], v[152:155]
 v_exp_f32 v20, v66
M v[156:159], a[92:95], v[60:63], v[156:159]
 buffer_load_dwordx4 v3, s[8:11], s21 offen offset:3072 sc1 lds
M v[156:159], a[88:91], v[52:55], v[156:159]
 s_waitcnt lgkmcnt(0)
 v_exp_f32 v21, v67
M v[160:163], a[96:99], v[48:51], v[160:163]
 ds_read_b128 a[64:67], v7 offset:16384
 v_add_f32 v26, v18, v19
M v[160:163], a[100:103], v[56:59], v[160:163]
 s_add_u32 m0, s28, 102400
 ds_read_b128 a[68:71], v7 offset:17408
 v_cvt_pk_bf16_f32 v40, v18, v19
M v[164:167], a[100:103], v[60:63], v[164:167]
 buffer_load_dwordx4 v4, s[8:11], s21 offen offset:0 sc1 lds
M v[164:167], a[96:99], v[52:55], v[164:167]
 ds_read_b128 a[72:75], v7 offset:18432
 v_add_f32 v26, v20, v26
M v[168:171], a[104:107], v[48:51], v[168:171]
 ds_read_b128 a[76:79], v7 offset:19456
 v_cvt_pk_bf16_f32 v41, v20, v21
M v[168:171], a[108:111], v[56:59], v[168:171]
 v_exp_f32 v22, v72
M v[172:175], a[108:111], v[60:63], v[172:175]
 ds_read_b128 a[80:83], v7 offset:20480
 v_add_f32 v26, v21, v26
M v[172:175], a[104:107], v[52:55], v[172:175]
 ds_read_b128 a[84:87], v7 offset:21504
M v[176:179], a[112:115], v[48:51], v[176:179]
 buffer_load_dwordx4 v4, s[8:11], s21 offen offset:1024 sc1 lds
M v[176:179], a[116:119], v[56:59], v[176:179]
 ds_read_b128 a[88:91], v7 offset:22528
M v[180:183], a[116:119], v[60:63], v[180:183]
 ds_read_b128 a[92:95], v7 offset:23552
M v[180:183], a[112:115], v[52:55], v[180:183]
 buffer_load_dwordx4 v4, s[8:11], s21 offen offset:2048 sc1 lds
M v[184:187], a[120:123], v[48:51], v[184:187]
 v_exp_f32 v23, v73
M v[184:187], a[124:127], v[56:59], v[184:187]
 v_exp_f32 v24, v74
M v[188:191], a[124:127], v[60:63], v[188:191]
 v_exp_f32 v25, v75
M v[188:191], a[120:123], v[52:55], v[188:191]
 s_waitcnt lgkmcnt(0)
 v_exp_f32 v18, v68
M v[192:195], a[64:67], v[48:51], v[192:195]
 ds_read_b128 a[96:99], v7 offset:24576
 v_add_f32 v26, v22, v26
M v[192:195], a[68:71], v[56:59], v[192:195]
 ds_read_b128 a[100:103], v7 offset:25600
 v_cvt_pk_bf16_f32 v42, v22, v23
M v[196:199], a[68:71], v[60:63], v[196:199]
 buffer_load_dwordx4 v4, s[8:11], s21 offen offset:3072 sc1 lds
M v[196:199], a[64:67], v[52:55], v[196:199]
 s_add_u32 s24, s23, 16777216
 ds_read_b128 a[104:107], v7 offset:26624
 v_add_f32 v26, v23, v26
M v[200:203], a[72:75], v[48:51], v[200:203]
 s_mov_b32 s23, s21
 ds_read_b128 a[108:111], v7 offset:27648
 v_add_f32 v26, v24, v26
M v[200:203], a[76:79], v[56:59], v[200:203]
 s_add_u32 s21, s21, 32768
 v_exp_f32 v19, v69
M v[204:207], a[76:79], v[60:63], v[204:207]
 s_add_u32 s22, s22, 1
 ds_read_b128 a[112:115], v7 offset:28672
 v_cvt_pk_bf16_f32 v43, v24, v25
M v[204:207], a[72:75], v[52:55], v[204:207]
 s_cmp_eq_u32 s22, s25
 ds_read_b128 a[116:119], v7 offset:29696
 v_add_f32 v26, v25, v26
M v[208:211], a[80:83], v[48:51], v[208:211]
 s_cselect_b32 s21, s26, s21
 v_exp_f32 v20, v70
M v[208:211], a[84:87], v[56:59], v[208:211]
 s_cmp_eq_u32 s22, s43
 ds_read_b128 a[120:123], v7 offset:30720
 v_add_f32 v27, v18, v19
M v[212:215], a[84:87], v[60:63], v[212:215]
 s_cselect_b32 s21, s4, s21
 ds_read_b128 a[124:127], v7 offset:31744
 v_cvt_pk_bf16_f32 v44, v18, v19
M v[212:215], a[80:83], v[52:55], v[212:215]
 s_cmp_eq_u32 s22, s6
 v_exp_f32 v21, v71
M v[216:219], a[88:91], v[48:51], v[216:219]
 s_cselect_b32 s21, s7, s21
 v_exp_f32 v22, v76
M v[216:219], a[92:95], v[56:59], v[216:219]
 v_add_f32 v27, v20, v27
 v_cvt_pk_bf16_f32 v45, v20, v21
M v[220:223], a[92:95], v[60:63], v[220:223]
 s_waitcnt vmcnt(17) lgkmcnt(0)
 v_add_f32 v27, v21, v27
M v[220:223], a[88:91], v[52:55], v[220:223]
 s_barrier
M v[224:227], a[96:99], v[48:51], v[224:227]
 ds_read_b128 a[64:67], v7 offset:32768
M v[224:227], a[100:103], v[56:59], v[224:227]
 ds_read_b128 a[68:71], v7 offset:33792
M v[228:231], a[100:103], v[60:63], v[228:231]
 v_exp_f32 v23, v77
M v[228:231], a[96:99], v[52:55], v[228:231]
 ds_read_b128 a[72:75], v7 offset:34816
 v_add_f32 v27, v22, v27
M v[232:235], a[104:107], v[48:51], v[232:235]
 ds_read_b128 a[76:79], v7 offset:35840
 v_cvt_pk_bf16_f32 v46, v22, v23
M v[232:235], a[108:111], v[56:59], v[232:235]
 v_exp_f32 v24, v78
M v[236:239], a[108:111], v[60:63], v[236:239]
 ds_read_b128 a[80:83], v7 offset:36864
 v_add_f32 v27, v23, v27
M v[236:239], a[104:107], v[52:55], v[236:239]
 ds_read_b128 a[84:87], v7 offset:37888
M v[240:243], a[112:115], v[48:51], v[240:243]
 v_exp_f32 v25, v79
M v[240:243], a[116:119], v[56:59], v[240:243]
 ds_read_b128 a[88:91], v7 offset:38912
 v_add_f32 v27, v24, v27
M v[244:247], a[116:119], v[60:63], v[244:247]
 ds_read_b128 a[92:95], v7 offset:39936
 v_cvt_pk_bf16_f32 v47, v24, v25
M v[244:247], a[112:115], v[52:55], v[244:247]
 v_add_f32 v27, v25, v27
M v[248:251], a[120:123], v[48:51], v[248:251]
M v[248:251], a[124:127], v[56:59], v[248:251]
M v[252:255], a[124:127], v[60:63], v[252:255]
 s_waitcnt lgkmcnt(0)
M v[252:255], a[120:123], v[52:55], v[252:255]
L_loop_mid:
M v[96:99], a[64:67], a[0:3], v[32:35]
 s_and_b32 s39, s54, 15
 ds_read_b128 a[96:99], v7 offset:40960
M v[96:99], a[68:71], a[4:7], v[96:99]
 s_cbranch_scc1 L_fll
L_fllr:
 ds_read_b128 a[100:103], v7 offset:41984
M v[96:99], a[72:75], a[8:11], v[96:99]
 s_lshr_b32 s54, s54, 4
 v_exp_f32 v18, v80
M v[96:99], a[76:79], a[12:15], v[96:99]
 s_add_u32 m0, s28, 0
 ds_read_b128 a[104:107], v7 offset:43008
M v[96:99], a[80:83], a[16:19], v[96:99]
 ds_read_b128 a[108:111], v7 offset:44032
M v[96:99], a[84:87], a[20:23], v[96:99]
 buffer_load_dwordx4 v3, s[8:11], s24 offen offset:0 sc1 lds
M v[96:99], a[88:91], a[24:27], v[96:99]
 ds_read_b128 a[112:115], v7 offset:45056
M v[96:99], a[92:95], a[28:31], v[96:99]
 ds_read_b128 a[116:119], v7 offset:46080
M v[100:103], a[92:95], a[60:63], v[36:39]
 v_exp_f32 v19, v81
M v[100:103], a[88:91], a[56:59], v[100:103]
 ds_read_b128 a[120:123], v7 offset:47104
 v_add_f32 v26, v18, v26
M v[100:103], a[84:87], a[52:55], v[100:103]
 ds_read_b128 a[124:127], v7 offset:48128
 v_cvt_pk_bf16_f32 v56, v18, v19
M v[100:103], a[80:83], a[48:51], v[100:103]
 buffer_load_dwordx4 v3, s[8:11], s24 offen offset:1024 sc1 lds
M v[100:103], a[76:79], a[44:47], v[100:103]
 v_exp_f32 v20, v82
M v[100:103], a[72:75], a[40:43], v[100:103]
 v_exp_f32 v21, v83
M v[100:103], a[68:71], a[36:39], v[100:103]
 buffer_load_dwordx4 v3, s[8:11], s24 offen offset:2048 sc1 lds
M v[100:103], a[64:67], a[32:35], v[100:103]
 s_waitcnt lgkmcnt(0)
 v_exp_f32 v22, v88
M v[104:107], a[96:99], a[0:3], v[32:35]
 ds_read_b128 a[64:67], v7 offset:49152
 v_add_f32 v26, v19, v26
M v[104:107], a[100:103], a[4:7], v[104:107]
 ds_read_b128 a[68:71], v7 offset:50176
 v_add_f32 v26, v20, v26
M v[104:107], a[104:107], a[8:11], v[104:107]
 v_exp_f32 v23, v89
M v[104:107], a[108:111], a[12:15], v[104:107]
 ds_read_b128 a[72:75], v7 offset:51200
 v_cvt_pk_bf16_f32 v57, v20, v21
M v[104:107], a[112:115], a[16:19], v[104:107]
 ds_read_b128 a[76:79], v7 offset:52224
 v_add_f32 v26, v21, v26
M v[104:107], a[116:119], a[20:23], v[104:107]
 buffer_load_dwordx4 v3, s[8:11], s24 offen offset:3072 sc1 lds
M v[104:107], a[120:123], a[24:27], v[104:107]
 ds_read_b128 a[80:83], v7 offset:53248
 v_add_f32 v26, v22, v26
M v[104:107], a[124:127], a[28:31], v[104:107]
 s_add_u32 m0, s28, 4096
 ds_read_b128 a[84:87], v7 offset:54272
 v_cvt_pk_bf16_f32 v58, v22, v23
M v[108:111], a[124:127], a[60:63], v[36:39]
 buffer_load_dwordx4 v4, s[8:11], s24 offen offset:0 sc1 lds
M v[108:111], a[120:123], a[56:59], v[108:111]
 ds_read_b128 a[88:91], v7 offset:55296
 v_add_f32 v26, v23, v26
M v[108:111], a[116:119], a[52:55], v[108:111]
 ds_read_b128 a[92:95], v7 offset:56320
M v[108:111], a[112:115], a[48:51], v[108:111]
 v_exp_f32 v24, v90
M v[108:111], a[108:111], a[44:47], v[108:111]
 v_exp_f32 v25, v91
M v[108:111], a[104:107], a[40:43], v[108:111]
 buffer_load_dwordx4 v4, s[8:11], s24 offen offset:1024 sc1 lds
M v[108:111], a[100:103], a[36:39], v[108:111]
 v_exp_f32 v18, v84
M v[108:111], a[96:99], a[32:35], v[108:111]
 s_waitcnt lgkmcnt(0)
 v_exp_f32 v19, v85
M v[112:115], a[64:67], a[0:3], v[32:35]
 ds_read_b128 a[96:99], v7 offset:57344
 v_add_f32 v26, v24, v26
M v[112:115], a[68:71], a[4:7], v[112:115]
 ds_read_b128 a[100:103], v7 offset:58368
 v_cvt_pk_bf16_f32 v59, v24, v25
M v[112:115], a[72:75], a[8:11], v[112:115]
 buffer_load_dwordx4 v4, s[8:11], s24 offen offset:2048 sc1 lds
M v[112:115], a[76:79], a[12:15], v[112:115]
 ds_read_b128 a[104:107], v7 offset:59392
 v_add_f32 v26, v25, v26
M v[112:115], a[80:83], a[16:19], v[112:115]
 ds_read_b128 a[108:111], v7 offset:60416
 v_add_f32 v27, v18, v27
M v[112:115], a[84:87], a[20:23], v[112:115]
 v_exp_f32 v20, v86
M v[112:115], a[88:91], a[24:27], v[112:115]
 ds_read_b128 a[112:115], v7 offset:61440
 v_cvt_pk_bf16_f32 v60, v18, v19
M v[112:115], a[92:95], a[28:31], v[112:115]
 ds_read_b128 a[116:119], v7 offset:62464
 v_add_f32 v27, v19, v27
M v[116:119], a[92:95], a[60:63], v[36:39]
 buffer_load_dwordx4 v4, s[8:11], s24 offen offset:3072 sc1 lds
M v[116:119], a[88:91], a[56:59], v[116:119]
 ds_read_b128 a[120:123], v7 offset:63488
M v[116:119], a[84:87], a[52:55], v[116:119]
 ds_read_b128 a[124:127], v7 offset:64512
M v[116:119], a[80:83], a[48:51], v[116:119]
 v_exp_f32 v21, v87
M v[116:119], a[76:79], a[44:47], v[116:119]
 v_exp_f32 v22, v92
M v[116:119], a[72:75], a[40:43], v[116:119]
 v_exp_f32 v23, v93
M v[116:119], a[68:71], a[36:39], v[116:119]
 s_waitcnt vmcnt(16) lgkmcnt(0)
 v_add_f32 v27, v20, v27
 v_cvt_pk_bf16_f32 v61, v20, v21
M v[116:119], a[64:67], a[32:35], v[116:119]
 s_barrier
M v[120:123], a[96:99], a[0:3], v[32:35]
 ds_read_b128 a[64:67], v2 offset:0
 v_add_f32 v27, v21, v27
M v[120:123], a[100:103], a[4:7], v[120:123]
 ds_read_b128 a[68:71], v2 offset:1024
 v_add_f32 v27, v22, v27
M v[120:123], a[104:107], a[8:11], v[120:123]
 v_exp_f32 v24, v94
M v[120:123], a[108:111], a[12:15], v[120:123]
 ds_read_b128 a[72:75], v2 offset:2048
 v_cvt_pk_bf16_f32 v62, v22, v23
M v[120:123], a[112:115], a[16:19], v[120:123]
 ds_read_b128 a[76:79], v2 offset:3072
 v_add_f32 v27, v23, v27
M v[120:123], a[116:119], a[20:23], v[120:123]
 v_exp_f32 v25, v95
M v[120:123], a[120:123], a[24:27], v[120:123]
 ds_read_b128 a[80:83], v2 offset:4096
 v_add_f32 v27, v24, v27
M v[120:123], a[124:127], a[28:31], v[120:123]
 ds_read_b128 a[84:87], v2 offset:5120
 v_cvt_pk_bf16_f32 v63, v24, v25
M v[124:127], a[124:127], a[60:63], v[36:39]
 v_add_f32 v27, v25, v27
M v[124:127], a[120:123], a[56:59], v[124:127]
 ds_read_b128 a[88:91], v2 offset:6144
M v[124:127], a[116:119], a[52:55], v[124:127]
 ds_read_b128 a[92:95], v2 offset:7168
 v_max_f32 v10, v26, v27
M v[124:127], a[112:115], a[48:51], v[124:127]
 v_cmp_lt_f32 vcc, s31, v10
M v[124:127], a[108:111], a[44:47], v[124:127]
M v[124:127], a[104:107], a[40:43], v[124:127]
M v[124:127], a[100:103], a[36:39], v[124:127]
 s_waitcnt lgkmcnt(0)
M v[124:127], a[96:99], a[32:35], v[124:127]
 s_cbranch_vccnz L_st0
L_rt0:
M v[128:131], a[64:67], v[40:43], v[128:131]
 s_add_u32 m0, s28, 32768
 ds_read_b128 a[96:99], v2 offset:8192
 v_add_f32 v30, v26, v30
M v[128:131], a[68:71], v[56:59], v[128:131]
 ds_read_b128 a[100:103], v2 offset:9216
 v_add_f32 v31, v27, v31
M v[132:135], a[68:71], v[60:63], v[132:135]
 buffer_load_dwordx4 v3, s[8:11], s21 offen offset:0 sc1 lds
M v[132:135], a[64:67], v[44:47], v[132:135]
 ds_read_b128 a[104:107], v2 offset:10240
M v[136:139], a[72:75], v[40:43], v[136:139]
 ds_read_b128 a[108:111], v2 offset:11264
M v[136:139], a[76:79], v[56:59], v[136:139]
 buffer_load_dwordx4 v3, s[8:11], s21 offen offset:1024 sc1 lds
M v[140:143], a[76:79], v[60:63], v[140:143]
 ds_read_b128 a[112:115], v2 offset:12288
M v[140:143], a[72:75], v[44:47], v[140:143]
 ds_read_b128 a[116:119], v2 offset:13312
M v[144:147], a[80:83], v[40:43], v[144:147]
 v_exp_f32 v18, v96
M v[144:147], a[84:87], v[56:59], v[144:147]
 ds_read_b128 a[120:123], v2 offset:14336
M v[148:151], a[84:87], v[60:63], v[148:151]
 ds_read_b128 a[124:127], v2 offset:15360
M v[148:151], a[80:83], v[44:47], v[148:151]
 buffer_load_dwordx4 v3, s[8:11], s21 offen offset:2048 sc1 lds
M v[152:155], a[88:91], v[40:43], v[152:155]
 v_exp_f32 v19, v97
M v[152:155], a[92:95], v[56:59], v[152:155]
 v_exp_f32 v20, v98
M v[156:159], a[92:95], v[60:63], v[156:159]
 buffer_load_dwordx4 v3, s[8:11], s21 offen offset:3072 sc1 lds
M v[156:159], a[88:91], v[44:47], v[156:159]
 s_waitcnt lgkmcnt(0)
 v_exp_f32 v21, v99
M v[160:163], a[96:99], v[40:43], v[160:163]
 ds_read_b128 a[64:67], v2 offset:16384
 v_add_f32 v28, v18, v19
M v[160:163], a[100:103], v[56:59], v[160:163]
 s_add_u32 m0, s28, 36864
 ds_read_b128 a[68:71], v2 offset:17408
 v_cvt_pk_bf16_f32 v48, v18, v19
M v[164:167], a[100:103], v[60:63], v[164:167]
 buffer_load_dwordx4 v4, s[8:11], s21 offen offset:0 sc1 lds
M v[164:167], a[96:99], v[44:47], v[164:167]
 ds_read_b128 a[72:75], v2 offset:18432
 v_add_f32 v28, v20, v28
M v[168:171], a[104:107], v[40:43], v[168:171]
 ds_read_b128 a[76:79], v2 offset:19456
 v_cvt_pk_bf16_f32 v49, v20, v21
M v[168:171], a[108:111], v[56:59], v[168:171]
 v_exp_f32 v22, v104
M v[172:175], a[108:111], v[60:63], v[172:175]
 ds_read_b128 a[80:83], v2 offset:20480
 v_add_f32 v28, v21, v28
M v[172:175], a[104:107], v[44:47], v[172:175]
 ds_read_b128 a[84:87], v2 offset:21504
M v[176:179], a[112:115], v[40:43], v[176:179]
 buffer_load_dwordx4 v4, s[8:11], s21 offen offset:1024 sc1 lds
M v[176:179], a[116:119], v[56:59], v[176:179]
 ds_read_b128 a[88:91], v2 offset:22528
M v[180:183], a[116:119], v[60:63], v[180:183]
 ds_read_b128 a[92:95], v2 offset:23552
M v[180:183], a[112:115], v[44:47], v[180:183]
 buffer_load_dwordx4 v4, s[8:11], s21 offen offset:2048 sc1 lds
M v[184:187], a[120:123], v[40:43], v[184:187]
 v_exp_f32 v23, v105
M v[184:187], a[124:127], v[56:59], v[184:187]
 v_exp_f32 v24, v106
M v[188:191], a[124:127], v[60:63], v[188:191]
 v_exp_f32 v25, v107
M v[188:191], a[120:123], v[44:47], v[188:191]
 s_waitcnt lgkmcnt(0)
 v_exp_f32 v18, v100
M v[192:195], a[64:67], v[40:43], v[192:195]
 ds_read_b128 a[96:99], v2 offset:24576
 v_add_f32 v28, v22, v28
M v[192:195], a[68:71], v[56:59], v[192:195]
 ds_read_b128 a[100:103], v2 offset:25600
 v_cvt_pk_bf16_f32 v50, v22, v23
M v[196:199], a[68:71], v[60:63], v[196:199]
 buffer_load_dwordx4 v4, s[8:11], s21 offen offset:3072 sc1 lds
M v[196:199], a[64:67], v[44:47], v[196:199]
 s_add_u32 s24, s23, 16777216
 ds_read_b128 a[104:107], v2 offset:26624
 v_add_f32 v28, v23, v28
M v[200:203], a[72:75], v[40:43], v[200:203]
 s_mov_b32 s23, s21
 ds_read_b128 a[108:111], v2 offset:27648
 v_add_f32 v28, v24, v28
M v[200:203], a[76:79], v[56:59], v[200:203]
 s_add_u32 s21, s21, 32768
 v_exp_f32 v19, v101
M v[204:207], a[76:79], v[60:63], v[204:207]
 s_add_u32 s22, s22, 1
 ds_read_b128 a[112:115], v2 offset:28672
 v_cvt_pk_bf16_f32 v51, v24, v25
M v[204:207], a[72:75], v[44:47], v[204:207]
 s_cmp_eq_u32 s22, s25
 ds_read_b128 a[116:119], v2 offset:29696
 v_add_f32 v28, v25, v28
M v[208:211], a[80:83], v[40:43], v[208:211]
 s_cselect_b32 s21, s26, s21
 v_exp_f32 v20, v102
M v[208:211], a[84:87], v[56:59], v[208:211]
 s_cmp_eq_u32 s22, s43
 ds_read_b128 a[120:123], v2 offset:30720
 v_add_f32 v29, v18, v19
M v[212:215], a[84:87], v[60:63], v[212:215]
 s_cselect_b32 s21, s4, s21
 ds_read_b128 a[124:127], v2 offset:31744
 v_cvt_pk_bf16_f32 v52, v18, v19
M v[212:215], a[80:83], v[44:47], v[212:215]
 s_cmp_eq_u32 s22, s6
 v_exp_f32 v21, v103
M v[216:219], a[88:91], v[40:43], v[216:219]
 s_cselect_b32 s21, s7, s21
 v_exp_f32 v22, v108
M v[216:219], a[92:95], v[56:59], v[216:219]
 v_add_f32 v29, v20, v29
 v_cvt_pk_bf16_f32 v53, v20, v21
M v[220:223], a[92:95], v[60:63], v[220:223]
 s_waitcnt vmcnt(16) lgkmcnt(0)
 v_exp_f32 v23, v109
M v[220:223], a[88:91], v[44:47], v[220:223]
 s_barrier
M v[224:227], a[96:99], v[40:43], v[224:227]
 ds_read_b128 a[64:67], v2 offset:32768
 v_add_f32 v29, v21, v29
M v[224:227], a[100:103], v[56:59], v[224:227]
 ds_read_b128 a[68:71], v2 offset:33792
 v_add_f32 v29, v22, v29
M v[228:231], a[100:103], v[60:63], v[228:231]
 v_cmp_gt_u32 vcc, s39, v6
 v_cvt_pk_bf16_f32 v54, v22, v23
M v[228:231], a[96:99], v[44:47], v[228:231]
 ds_read_b128 a[72:75], v2 offset:34816
 v_add_f32 v29, v23, v29
M v[232:235], a[104:107], v[40:43], v[232:235]
 ds_read_b128 a[76:79], v2 offset:35840
M v[232:235], a[108:111], v[56:59], v[232:235]
 s_cbranch_vccnz L_fls0
L_flr0:
 v_exp_f32 v24, v110
M v[236:239], a[108:111], v[60:63], v[236:239]
 s_and_b32 s3, s5, 15
 ds_read_b128 a[80:83], v2 offset:36864
M v[236:239], a[104:107], v[44:47], v[236:239]
 s_cbranch_scc1 L_pub3
L_pub3r:
 ds_read_b128 a[84:87], v2 offset:37888
M v[240:243], a[112:115], v[40:43], v[240:243]
 s_lshr_b32 s5, s5, 4
 v_exp_f32 v25, v111
M v[240:243], a[116:119], v[56:59], v[240:243]
 ds_read_b128 a[88:91], v2 offset:38912
 v_add_f32 v29, v24, v29
M v[244:247], a[116:119], v[60:63], v[244:247]
 ds_read_b128 a[92:95], v2 offset:39936
 v_cvt_pk_bf16_f32 v55, v24, v25
M v[244:247], a[112:115], v[44:47], v[244:247]
 v_add_f32 v29, v25, v29
M v[248:251], a[120:123], v[40:43], v[248:251]
 s_sub_u32 s27, s27, 1
M v[248:251], a[124:127], v[56:59], v[248:251]
 s_cmp_lg_u32 s27, 0
M v[252:255], a[124:127], v[60:63], v[252:255]
 s_waitcnt lgkmcnt(0)
M v[252:255], a[120:123], v[44:47], v[252:255]
 s_cbranch_scc1 L_loop_top
L_p1:
 s_cmp_eq_u32 s40, 0
 s_cbranch_scc1 L_final_h
 v_cndmask_b32 v64, v32, v8, s[64:65]
 v_cndmask_b32 v65, v32, v8, s[66:67]
 v_cndmask_b32 v66, v32, v8, s[68:69]
 v_cndmask_b32 v67, v32, v8, s[70:71]
 s_nop 1
M v[64:67], a[64:67], a[0:3], v[64:67]
 s_add_u32 m0, s28, 65536
 ds_read_b128 a[96:99], v2 offset:40960
 v_cndmask_b32 v72, v32, v8, s[72:73]
M v[64:67], a[68:71], a[4:7], v[64:67]
 ds_read_b128 a[100:103], v2 offset:41984
 v_cndmask_b32 v73, v32, v8, s[74:75]
M v[64:67], a[72:75], a[8:11], v[64:67]
 buffer_load_dwordx4 v3, s[8:11], s24 offen offset:0 sc1 lds
M v[64:67], a[76:79], a[12:15], v[64:67]
 ds_read_b128 a[104:107], v2 offset:43008
 v_cndmask_b32 v74, v32, v8, s[76:77]
M v[64:67], a[80:83], a[16:19], v[64:67]
 ds_read_b128 a[108:111], v2 offset:44032
 v_cndmask_b32 v75, v32, v8, s[78:79]
M v[64:67], a[84:87], a[20:23], v[64:67]
 v_exp_f32 v18, v112
M v[64:67], a[88:91], a[24:27], v[64:67]
 ds_read_b128 a[112:115], v2 offset:45056
M v[64:67], a[92:95], a[28:31], v[64:67]
 ds_read_b128 a[116:119], v2 offset:46080
M v[68:71], a[92:95], a[60:63], v[36:39]
 buffer_load_dwordx4 v3, s[8:11], s24 offen offset:1024 sc1 lds
M v[68:71], a[88:91], a[56:59], v[68:71]
 ds_read_b128 a[120:123], v2 offset:47104
M v[68:71], a[84:87], a[52:55], v[68:71]
 ds_read_b128 a[124:127], v2 offset:48128
M v[68:71], a[80:83], a[48:51], v[68:71]
 v_exp_f32 v19, v113
M v[68:71], a[76:79], a[44:47], v[68:71]
 buffer_load_dwordx4 v3, s[8:11], s24 offen offset:2048 sc1 lds
M v[68:71], a[72:75], a[40:43], v[68:71]
 v_exp_f32 v20, v114
M v[68:71], a[68:71], a[36:39], v[68:71]
 v_exp_f32 v21, v115
M v[68:71], a[64:67], a[32:35], v[68:71]
 s_waitcnt lgkmcnt(0)
 v_exp_f32 v22, v120
M v[72:75], a[96:99], a[0:3], v[72:75]
 ds_read_b128 a[64:67], v2 offset:49152
 v_cndmask_b32 v80, v32, v8, s[80:81]
M v[72:75], a[100:103], a[4:7], v[72:75]
 ds_read_b128 a[68:71], v2 offset:50176
 v_cndmask_b32 v81, v32, v8, s[82:83]
M v[72:75], a[104:107], a[8:11], v[72:75]
 buffer_load_dwordx4 v3, s[8:11], s24 offen offset:3072 sc1 lds
M v[72:75], a[108:111], a[12:15], v[72:75]
 ds_read_b128 a[72:75], v2 offset:51200
 v_cndmask_b32 v82, v32, v8, s[84:85]
M v[72:75], a[112:115], a[16:19], v[72:75]
 ds_read_b128 a[76:79], v2 offset:52224
 v_cndmask_b32 v83, v32, v8, s[86:87]
M v[72:75], a[116:119], a[20:23], v[72:75]
 v_exp_f32 v23, v121
M v[72:75], a[120:123], a[24:27], v[72:75]
 s_add_u32 m0, s28, 69632
 ds_read_b128 a[80:83], v2 offset:53248
 v_add_f32 v28, v18, v28
M v[72:75], a[124:127], a[28:31], v[72:75]
 ds_read_b128 a[84:87], v2 offset:54272
 v_cvt_pk_bf16_f32 v56, v18, v19
M v[76:79], a[124:127], a[60:63], v[36:39]
 buffer_load_dwordx4 v4, s[8:11], s24 offen offset:0 sc1 lds
M v[76:79], a[120:123], a[56:59], v[76:79]
 ds_read_b128 a[88:91], v2 offset:55296
 v_add_f32 v28, v19, v28
M v[76:79], a[116:119], a[52:55], v[76:79]
 ds_read_b128 a[92:95], v2 offset:56320
 v_add_f32 v28, v20, v28
M v[76:79], a[112:115], a[48:51], v[76:79]
 v_exp_f32 v24, v122
M v[76:79], a[108:111], a[44:47], v[76:79]
 buffer_load_dwordx4 v4, s[8:11], s24 offen offset:1024 sc1 lds
M v[76:79], a[104:107], a[40:43], v[76:79]
 v_exp_f32 v25, v123
M v[76:79], a[100:103], a[36:39], v[76:79]
 v_exp_f32 v18, v116
M v[76:79], a[96:99], a[32:35], v[76:79]
 s_waitcnt lgkmcnt(0)
 v_exp_f32 v19, v117
M v[80:83], a[64:67], a[0:3], v[80:83]
 ds_read_b128 a[96:99], v2 offset:57344
 v_cndmask_b32 v88, v32, v8, s[88:89]
M v[80:83], a[68:71], a[4:7], v[80:83]
 ds_read_b128 a[100:103], v2 offset:58368
 v_cndmask_b32 v89, v32, v8, s[90:91]
M v[80:83], a[72:75], a[8:11], v[80:83]
 buffer_load_dwordx4 v4, s[8:11], s24 offen offset:2048 sc1 lds
M v[80:83], a[76:79], a[12:15], v[80:83]
 ds_read_b128 a[104:107], v2 offset:59392
 v_cndmask_b32 v90, v32, v8, s[92:93]
M v[80:83], a[80:83], a[16:19], v[80:83]
 ds_read_b128 a[108:111], v2 offset:60416
 v_cndmask_b32 v91, v32, v8, s[94:95]
M v[80:83], a[84:87], a[20:23], v[80:83]
 v_cvt_pk_bf16_f32 v57, v20, v21
 v_add_f32 v28, v21, v28
M v[80:83], a[88:91], a[24:27], v[80:83]
 ds_read_b128 a[112:115], v2 offset:61440
 v_add_f32 v28, v22, v28
M v[80:83], a[92:95], a[28:31], v[80:83]
 ds_read_b128 a[116:119], v2 offset:62464
 v_cvt_pk_bf16_f32 v58, v22, v23
M v[84:87], a[92:95], a[60:63], v[36:39]
 buffer_load_dwordx4 v4, s[8:11], s24 offen offset:3072 sc1 lds
M v[84:87], a[88:91], a[56:59], v[84:87]
 ds_read_b128 a[120:123], v2 offset:63488
 v_add_f32 v28, v23, v28
M v[84:87], a[84:87], a[52:55], v[84:87]
 ds_read_b128 a[124:127], v2 offset:64512
 v_add_f32 v28, v24, v28
M v[84:87], a[80:83], a[48:51], v[84:87]
 v_exp_f32 v20, v118
M v[84:87], a[76:79], a[44:47], v[84:87]
 v_exp_f32 v21, v119
M v[84:87], a[72:75], a[40:43], v[84:87]
 v_exp_f32 v22, v124
M v[84:87], a[68:71], a[36:39], v[84:87]
 s_waitcnt vmcnt(16) lgkmcnt(0)
 v_exp_f32 v23, v125
M v[84:87], a[64:67], a[32:35], v[84:87]
 s_barrier
M v[88:91], a[96:99], a[0:3], v[88:91]
 ds_read_b128 a[64:67], v7 offset:0
 v_cvt_pk_bf16_f32 v59, v24, v25
M v[88:91], a[100:103], a[4:7], v[88:91]
 ds_read_b128 a[68:71], v7 offset:1024
 v_add_f32 v28, v25, v28
M v[88:91], a[104:107], a[8:11], v[88:91]
 v_exp_f32 v24, v126
M v[88:91], a[108:111], a[12:15], v[88:91]
 ds_read_b128 a[72:75], v7 offset:2048
 v_add_f32 v29, v18, v29
M v[88:91], a[112:115], a[16:19], v[88:91]
 ds_read_b128 a[76:79], v7 offset:3072
 v_cvt_pk_bf16_f32 v60, v18, v19
M v[88:91], a[116:119], a[20:23], v[88:91]
 v_exp_f32 v25, v127
M v[88:91], a[120:123], a[24:27], v[88:91]
 ds_read_b128 a[80:83], v7 offset:4096
 v_add_f32 v29, v19, v29
M v[88:91], a[124:127], a[28:31], v[88:91]
 ds_read_b128 a[84:87], v7 offset:5120
 v_add_f32 v29, v20, v29
M v[92:95], a[124:127], a[60:63], v[36:39]
 v_cvt_pk_bf16_f32 v61, v20, v21
 v_add_f32 v29, v21, v29
M v[92:95], a[120:123], a[56:59], v[92:95]
 ds_read_b128 a[88:91], v7 offset:6144
 v_add_f32 v29, v22, v29
M v[92:95], a[116:119], a[52:55], v[92:95]
 ds_read_b128 a[92:95], v7 offset:7168
 v_cvt_pk_bf16_f32 v62, v22, v23
M v[92:95], a[112:115], a[48:51], v[92:95]
 v_add_f32 v29, v23, v29
 v_add_f32 v29, v24, v29
M v[92:95], a[108:111], a[44:47], v[92:95]
 v_cvt_pk_bf16_f32 v63, v24, v25
 v_add_f32 v29, v25, v29
M v[92:95], a[104:107], a[40:43], v[92:95]
M v[92:95], a[100:103], a[36:39], v[92:95]
 s_waitcnt lgkmcnt(0)
M v[92:95], a[96:99], a[32:35], v[92:95]
 v_max_f32 v10, v28, v29
 v_cmp_lt_f32 vcc, s31, v10
 s_nop 0
 s_cbranch_vccnz L_st5
L_rt5:
M v[128:131], a[64:67], v[48:51], v[128:131]
 s_add_u32 m0, s28, 98304
 ds_read_b128 a[96:99], v7 offset:8192
 v_add_f32 v30, v28, v30
M v[128:131], a[68:71], v[56:59], v[128:131]
 ds_read_b128 a[100:103], v7 offset:9216
 v_add_f32 v31, v29, v31
M v[132:135], a[68:71], v[60:63], v[132:135]
 buffer_load_dwordx4 v3, s[8:11], s21 offen offset:0 sc1 lds
M v[132:135], a[64:67], v[52:55], v[132:135]
 s_cmp_eq_u32 s20, 3
 ds_read_b128 a[104:107], v7 offset:10240
M v[136:139], a[72:75], v[48:51], v[136:139]
 s_cselect_b64 s[64:65], s[16:17], 0
 ds_read_b128 a[108:111], v7 offset:11264
M v[136:139], a[76:79], v[56:59], v[136:139]
 buffer_load_dwordx4 v3, s[8:11], s21 offen offset:1024 sc1 lds
M v[140:143], a[76:79], v[60:63], v[140:143]
 s_cselect_b64 s[66:67], s[18:19], 0
 ds_read_b128 a[112:115], v7 offset:12288
M v[140:143], a[72:75], v[52:55], v[140:143]
 s_cselect_b64 s[68:69], s[48:49], 0
 ds_read_b128 a[116:119], v7 offset:13312
M v[144:147], a[80:83], v[48:51], v[144:147]
 s_cselect_b64 s[70:71], s[50:51], 0
 v_exp_f32 v18, v64
M v[144:147], a[84:87], v[56:59], v[144:147]
 s_cmp_gt_u32 s20, 2
 ds_read_b128 a[120:123], v7 offset:14336
M v[148:151], a[84:87], v[60:63], v[148:151]
 s_cselect_b64 s[78:79], -1, 0
 ds_read_b128 a[124:127], v7 offset:15360
M v[148:151], a[80:83], v[52:55], v[148:151]
 buffer_load_dwordx4 v3, s[8:11], s21 offen offset:2048 sc1 lds
M v[152:155], a[88:91], v[48:51], v[152:155]
 v_exp_f32 v19, v65
M v[152:155], a[92:95], v[56:59], v[152:155]
 v_exp_f32 v20, v66
M v[156:159], a[92:95], v[60:63], v[156:159]
 buffer_load_dwordx4 v3, s[8:11], s21 offen offset:3072 sc1 lds
M v[156:159], a[88:91], v[52:55], v[156:159]
 s_waitcnt lgkmcnt(0)
 v_exp_f32 v21, v67
M v[160:163], a[96:99], v[48:51], v[160:163]
 ds_read_b128 a[64:67], v7 offset:16384
 v_add_f32 v26, v18, v19
M v[160:163], a[100:103], v[56:59], v[160:163]
 s_add_u32 m0, s28, 102400
 ds_read_b128 a[68:71], v7 offset:17408
 v_cvt_pk_bf16_f32 v40, v18, v19
M v[164:167], a[100:103], v[60:63], v[164:167]
 buffer_load_dwordx4 v4, s[8:11], s21 offen offset:0 sc1 lds
M v[164:167], a[96:99], v[52:55], v[164:167]
 s_cmp_eq_u32 s20, 2
 ds_read_b128 a[72:75], v7 offset:18432
 v_add_f32 v26, v20, v26
M v[168:171], a[104:107], v[48:51], v[168:171]
 s_cselect_b64 s[72:73], s[16:17], s[78:79]
 ds_read_b128 a[76:79], v7 offset:19456
 v_cvt_pk_bf16_f32 v41, v20, v21
M v[168:171], a[108:111], v[56:59], v[168:171]
 s_cselect_b64 s[74:75], s[18:19], s[78:79]
 v_exp_f32 v22, v72
M v[172:175], a[108:111], v[60:63], v[172:175]
 s_cselect_b64 s[76:77], s[48:49], s[78:79]
 ds_read_b128 a[80:83], v7 offset:20480
 v_add_f32 v26, v21, v26
M v[172:175], a[104:107], v[52:55], v[172:175]
 s_cselect_b64 s[78:79], s[50:51], s[78:79]
 ds_read_b128 a[84:87], v7 offset:21504
M v[176:179], a[112:115], v[48:51], v[176:179]
 buffer_load_dwordx4 v4, s[8:11], s21 offen offset:1024 sc1 lds
M v[176:179], a[116:119], v[56:59], v[176:179]
 s_cmp_gt_u32 s20, 1
 ds_read_b128 a[88:91], v7 offset:22528
M v[180:183], a[116:119], v[60:63], v[180:183]
 s_cselect_b64 s[86:87], -1, 0
 ds_read_b128 a[92:95], v7 offset:23552
M v[180:183], a[112:115], v[52:55], v[180:183]
 buffer_load_dwordx4 v4, s[8:11], s21 offen offset:2048 sc1 lds
M v[184:187], a[120:123], v[48:51], v[184:187]
 s_cmp_eq_u32 s20, 1
 v_exp_f32 v23, v73
M v[184:187], a[124:127], v[56:59], v[184:187]
 s_cselect_b64 s[80:81], s[16:17], s[86:87]
 v_exp_f32 v24, v74
M v[188:191], a[124:127], v[60:63], v[188:191]
 s_cselect_b64 s[82:83], s[18:19], s[86:87]
 v_exp_f32 v25, v75
M v[188:191], a[120:123], v[52:55], v[188:191]
 s_waitcnt lgkmcnt(0)
 v_exp_f32 v18, v68
M v[192:195], a[64:67], v[48:51], v[192:195]
 s_cselect_b64 s[84:85], s[48:49], s[86:87]
 ds_read_b128 a[96:99], v7 offset:24576
 v_add_f32 v26, v22, v26
M v[192:195], a[68:71], v[56:59], v[192:195]
 s_cselect_b64 s[86:87], s[50:51], s[86:87]
 ds_read_b128 a[100:103], v7 offset:25600
 v_cvt_pk_bf16_f32 v42, v22, v23
M v[196:199], a[68:71], v[60:63], v[196:199]
 buffer_load_dwordx4 v4, s[8:11], s21 offen offset:3072 sc1 lds
M v[196:199], a[64:67], v[52:55], v[196:199]
 s_add_u32 s24, s23, 16777216
 ds_read_b128 a[104:107], v7 offset:26624
 v_add_f32 v26, v23, v26
M v[200:203], a[72:75], v[48:51], v[200:203]
 s_mov_b32 s23, s21
 ds_read_b128 a[108:111], v7 offset:27648
 v_add_f32 v26, v24, v26
M v[200:203], a[76:79], v[56:59], v[200:203]
 s_add_u32 s21, s21, 32768
 v_exp_f32 v19, v69
M v[204:207], a[76:79], v[60:63], v[204:207]
 s_add_u32 s22, s22, 1
 ds_read_b128 a[112:115], v7 offset:28672
 v_cvt_pk_bf16_f32 v43, v24, v25
M v[204:207], a[72:75], v[52:55], v[204:207]
 s_cmp_eq_u32 s22, s25
 ds_read_b128 a[116:119], v7 offset:29696
 v_add_f32 v26, v25, v26
M v[208:211], a[80:83], v[48:51], v[208:211]
 s_cselect_b32 s21, s26, s21
 v_exp_f32 v20, v70
M v[208:211], a[84:87], v[56:59], v[208:211]
 s_cmp_eq_u32 s22, s43
 ds_read_b128 a[120:123], v7 offset:30720
 v_add_f32 v27, v18, v19
M v[212:215], a[84:87], v[60:63], v[212:215]
 s_cselect_b32 s21, s4, s21
 ds_read_b128 a[124:127], v7 offset:31744
 v_cvt_pk_bf16_f32 v44, v18, v19
M v[212:215], a[80:83], v[52:55], v[212:215]
 s_cmp_eq_u32 s22, s6
 v_exp_f32 v21, v71
M v[216:219], a[88:91], v[48:51], v[216:219]
 s_cselect_b32 s21, s7, s21
 v_exp_f32 v22, v76
M v[216:219], a[92:95], v[56:59], v[216:219]
 s_cmp_eq_u32 s20, 0
 v_exp_f32 v23, v77
M v[220:223], a[92:95], v[60:63], v[220:223]
 s_waitcnt vmcnt(16) lgkmcnt(0)
 v_exp_f32 v24, v78
M v[220:223], a[88:91], v[52:55], v[220:223]
 s_barrier
M v[224:227], a[96:99], v[48:51], v[224:227]
 s_cselect_b64 s[88:89], s[16:17], -1
 ds_read_b128 a[64:67], v7 offset:32768
 v_add_f32 v27, v20, v27
M v[224:227], a[100:103], v[56:59], v[224:227]
 s_cselect_b64 s[90:91], s[18:19], -1
 ds_read_b128 a[68:71], v7 offset:33792
 v_cvt_pk_bf16_f32 v45, v20, v21
M v[228:231], a[100:103], v[60:63], v[228:231]
 buffer_load_dword v5, off, s[8:11], s47 sc1
M v[228:231], a[96:99], v[52:55], v[228:231]
 s_cselect_b64 s[92:93], s[48:49], -1
 ds_read_b128 a[72:75], v7 offset:34816
 v_add_f32 v27, v21, v27
M v[232:235], a[104:107], v[48:51], v[232:235]
 s_cselect_b64 s[94:95], s[50:51], -1
 ds_read_b128 a[76:79], v7 offset:35840
 v_add_f32 v27, v22, v27
M v[232:235], a[108:111], v[56:59], v[232:235]
 v_cndmask_b32 v100, v36, v8, s[64:65]
 v_cndmask_b32 v101, v36, v8, s[66:67]
M v[236:239], a[108:111], v[60:63], v[236:239]
 ds_read_b128 a[80:83], v7 offset:36864
 v_cndmask_b32 v102, v36, v8, s[68:69]
M v[236:239], a[104:107], v[52:55], v[236:239]
 ds_read_b128 a[84:87], v7 offset:37888
 v_cndmask_b32 v103, v36, v8, s[70:71]
M v[240:243], a[112:115], v[48:51], v[240:243]
 v_cndmask_b32 v108, v36, v8, s[72:73]
 v_cndmask_b32 v109, v36, v8, s[74:75]
M v[240:243], a[116:119], v[56:59], v[240:243]
 ds_read_b128 a[88:91], v7 offset:38912
 v_cndmask_b32 v110, v36, v8, s[76:77]
M v[244:247], a[116:119], v[60:63], v[244:247]
 ds_read_b128 a[92:95], v7 offset:39936
 v_cndmask_b32 v111, v36, v8, s[78:79]
M v[244:247], a[112:115], v[52:55], v[244:247]
 v_cndmask_b32 v116, v36, v8, s[80:81]
 v_cndmask_b32 v117, v36, v8, s[82:83]
M v[248:251], a[120:123], v[48:51], v[248:251]
 v_cndmask_b32 v118, v36, v8, s[84:85]
 v_cndmask_b32 v119, v36, v8, s[86:87]
M v[248:251], a[124:127], v[56:59], v[248:251]
 v_cndmask_b32 v124, v36, v8, s[88:89]
 v_cndmask_b32 v125, v36, v8, s[90:91]
M v[252:255], a[124:127], v[60:63], v[252:255]
 s_waitcnt lgkmcnt(0)
 v_cndmask_b32 v126, v36, v8, s[92:93]
 v_cndmask_b32 v127, v36, v8, s[94:95]
M v[252:255], a[120:123], v[52:55], v[252:255]
 v_exp_f32 v25, v79
 v_cvt_pk_bf16_f32 v46, v22, v23
 v_add_f32 v27, v23, v27
 v_add_f32 v27, v24, v27
 v_cvt_pk_bf16_f32 v47, v24, v25
 v_add_f32 v27, v25, v27
L_p2:
M v[100:103], a[64:67], a[32:35], v[100:103]
 ds_read_b128 a[96:99], v7 offset:40960
 ds_read_b128 a[100:103], v7 offset:41984
 v_exp_f32 v18, v80
M v[100:103], a[68:71], a[36:39], v[100:103]
 ds_read_b128 a[104:107], v7 offset:43008
 v_exp_f32 v19, v81
M v[100:103], a[72:75], a[40:43], v[100:103]
 ds_read_b128 a[108:111], v7 offset:44032
 ds_read_b128 a[112:115], v7 offset:45056
 v_exp_f32 v20, v82
 v_add_f32 v26, v18, v26
M v[100:103], a[76:79], a[44:47], v[100:103]
 ds_read_b128 a[116:119], v7 offset:46080
 v_cvt_pk_bf16_f32 v56, v18, v19
 v_exp_f32 v21, v83
M v[100:103], a[80:83], a[48:51], v[100:103]
 s_add_u32 m0, s28, 0
 ds_read_b128 a[120:123], v7 offset:47104
 ds_read_b128 a[124:127], v7 offset:48128
 v_add_f32 v26, v19, v26
M v[100:103], a[84:87], a[52:55], v[100:103]
 buffer_load_dwordx4 v3, s[8:11], s24 offen offset:0 sc1 lds
M v[100:103], a[88:91], a[56:59], v[100:103]
 ds_read_b128 a[128:131], v7 offset:49152
 ds_read_b128 a[132:135], v7 offset:50176
 v_exp_f32 v22, v88
 v_add_f32 v26, v20, v26
 v_cvt_pk_bf16_f32 v57, v20, v21
M v[100:103], a[92:95], a[60:63], v[100:103]
 s_waitcnt lgkmcnt(2)
 ds_read_b128 a[136:139], v7 offset:51200
 v_exp_f32 v23, v89
 v_add_f32 v26, v21, v26
M v[108:111], a[124:127], a[60:63], v[108:111]
 ds_read_b128 a[140:143], v7 offset:52224
 ds_read_b128 a[144:147], v7 offset:53248
 v_exp_f32 v24, v90
M v[108:111], a[120:123], a[56:59], v[108:111]
 buffer_load_dwordx4 v3, s[8:11], s24 offen offset:1024 sc1 lds
M v[108:111], a[116:119], a[52:55], v[108:111]
 ds_read_b128 a[148:151], v7 offset:54272
 ds_read_b128 a[152:155], v7 offset:55296
 v_add_f32 v26, v22, v26
 v_cvt_pk_bf16_f32 v58, v22, v23
M v[108:111], a[112:115], a[48:51], v[108:111]
 ds_read_b128 a[156:159], v7 offset:56320
 v_exp_f32 v25, v91
 v_add_f32 v26, v23, v26
M v[108:111], a[108:111], a[44:47], v[108:111]
 ds_read_b128 a[160:163], v7 offset:57344
 ds_read_b128 a[164:167], v7 offset:58368
 v_exp_f32 v18, v84
M v[108:111], a[104:107], a[40:43], v[108:111]
 buffer_load_dwordx4 v3, s[8:11], s24 offen offset:2048 sc1 lds
M v[108:111], a[100:103], a[36:39], v[108:111]
 ds_read_b128 a[168:171], v7 offset:59392
 ds_read_b128 a[172:175], v7 offset:60416
 v_add_f32 v26, v24, v26
 v_cvt_pk_bf16_f32 v59, v24, v25
M v[108:111], a[96:99], a[32:35], v[108:111]
 s_waitcnt lgkmcnt(4)
 ds_read_b128 a[176:179], v7 offset:61440
 v_exp_f32 v19, v85
 v_add_f32 v26, v25, v26
M v[116:119], a[128:131], a[32:35], v[116:119]
 ds_read_b128 a[180:183], v7 offset:62464
 ds_read_b128 a[184:187], v7 offset:63488
 v_exp_f32 v20, v86
M v[116:119], a[132:135], a[36:39], v[116:119]
 ds_read_b128 a[188:191], v7 offset:64512
 v_add_f32 v27, v18, v27
 v_cvt_pk_bf16_f32 v60, v18, v19
M v[116:119], a[136:139], a[40:43], v[116:119]
 buffer_load_dwordx4 v3, s[8:11], s24 offen offset:3072 sc1 lds
M v[116:119], a[140:143], a[44:47], v[116:119]
 s_add_u32 m0, s28, 4096
 v_exp_f32 v21, v87
 v_add_f32 v27, v19, v27
 v_exp_f32 v22, v92
M v[116:119], a[144:147], a[48:51], v[116:119]
 buffer_load_dwordx4 v4, s[8:11], s24 offen offset:0 sc1 lds
M v[116:119], a[148:151], a[52:55], v[116:119]
 s_waitcnt vmcnt(14) lgkmcnt(0)
 v_add_f32 v27, v20, v27
 v_cvt_pk_bf16_f32 v61, v20, v21
 v_exp_f32 v23, v93
 v_add_f32 v27, v21, v27
M v[116:119], a[152:155], a[56:59], v[116:119]
 s_barrier
M v[116:119], a[156:159], a[60:63], v[116:119]
 ds_read_b128 a[64:67], v2 offset:0
 ds_read_b128 a[68:71], v2 offset:1024
 v_exp_f32 v24, v94
M v[124:127], a[188:191], a[60:63], v[124:127]
 ds_read_b128 a[72:75], v2 offset:2048
 v_add_f32 v27, v22, v27
 v_cvt_pk_bf16_f32 v62, v22, v23
M v[124:127], a[184:187], a[56:59], v[124:127]
 ds_read_b128 a[76:79], v2 offset:3072
 ds_read_b128 a[80:83], v2 offset:4096
 v_exp_f32 v25, v95
 v_add_f32 v27, v23, v27
M v[124:127], a[180:183], a[52:55], v[124:127]
 ds_read_b128 a[84:87], v2 offset:5120
 v_add_f32 v27, v24, v27
 v_cvt_pk_bf16_f32 v63, v24, v25
 v_add_f32 v27, v25, v27
M v[124:127], a[176:179], a[48:51], v[124:127]
 ds_read_b128 a[88:91], v2 offset:6144
 ds_read_b128 a[92:95], v2 offset:7168
 v_max_f32 v10, v26, v27
 v_cmp_lt_f32 vcc, s31, v10
M v[124:127], a[172:175], a[44:47], v[124:127]
 buffer_load_dwordx4 v4, s[8:11], s24 offen offset:1024 sc1 lds
M v[124:127], a[168:171], a[40:43], v[124:127]
 buffer_load_dwordx4 v4, s[8:11], s24 offen offset:2048 sc1 lds
M v[124:127], a[164:167], a[36:39], v[124:127]
 buffer_load_dwordx4 v4, s[8:11], s24 offen offset:3072 sc1 lds
M v[124:127], a[160:163], a[32:35], v[124:127]
 s_waitcnt lgkmcnt(0)
 s_cbranch_vccnz L_st6
L_rt6:
 s_cmp_le_u32 s42, 5
 s_cbranch_scc1 L_p3k
 s_cmp_ge_u32 s42, 10
 s_cbranch_scc1 L_p3c
M v[128:131], a[64:67], v[40:43], v[128:131]
 s_add_u32 m0, s28, 32768
 ds_read_b128 a[96:99], v2 offset:8192
 v_add_f32 v30, v26, v30
M v[128:131], a[68:71], v[56:59], v[128:131]
 ds_read_b128 a[100:103], v2 offset:9216
 v_add_f32 v31, v27, v31
M v[132:135], a[68:71], v[60:63], v[132:135]
 buffer_load_dwordx4 v3, s[8:11], s21 offen offset:0 sc1 lds
M v[132:135], a[64:67], v[44:47], v[132:135]
 ds_read_b128 a[104:107], v2 offset:10240
M v[136:139], a[72:75], v[40:43], v[136:139]
 ds_read_b128 a[108:111], v2 offset:11264
M v[136:139], a[76:79], v[56:59], v[136:139]
 buffer_load_dwordx4 v3, s[8:11], s21 offen offset:1024 sc1 lds
M v[140:143], a[76:79], v[60:63], v[140:143]
 ds_read_b128 a[112:115], v2 offset:12288
M v[140:143], a[72:75], v[44:47], v[140:143]
 ds_read_b128 a[116:119], v2 offset:13312
M v[144:147], a[80:83], v[40:43], v[144:147]
 v_exp_f32 v18, v100
M v[144:147], a[84:87], v[56:59], v[144:147]
 ds_read_b128 a[120:123], v2 offset:14336
M v[148:151], a[84:87], v[60:63], v[148:151]
 ds_read_b128 a[124:127], v2 offset:15360
M v[148:151], a[80:83], v[44:47], v[148:151]
 buffer_load_dwordx4 v3, s[8:11], s21 offen offset:2048 sc1 lds
M v[152:155], a[88:91], v[40:43], v[152:155]
 v_exp_f32 v19, v101
M v[152:155], a[92:95], v[56:59], v[152:155]
 v_exp_f32 v20, v102
M v[156:159], a[92:95], v[60:63], v[156:159]
 buffer_load_dwordx4 v3, s[8:11], s21 offen offset:3072 sc1 lds
M v[156:159], a[88:91], v[44:47], v[156:159]
 s_waitcnt lgkmcnt(0)
 v_exp_f32 v21, v103
M v[160:163], a[96:99], v[40:43], v[160:163]
 ds_read_b128 a[64:67], v2 offset:16384
 v_add_f32 v29, v18, v19
M v[160:163], a[100:103], v[56:59], v[160:163]
 s_add_u32 m0, s28, 36864
 ds_read_b128 a[68:71], v2 offset:17408
 v_cvt_pk_bf16_f32 v52, v18, v19
M v[164:167], a[100:103], v[60:63], v[164:167]
 buffer_load_dwordx4 v4, s[8:11], s21 offen offset:0 sc1 lds
M v[164:167], a[96:99], v[44:47], v[164:167]
 ds_read_b128 a[72:75], v2 offset:18432
 v_add_f32 v29, v20, v29
M v[168:171], a[104:107], v[40:43], v[168:171]
 ds_read_b128 a[76:79], v2 offset:19456
 v_cvt_pk_bf16_f32 v53, v20, v21
M v[168:171], a[108:111], v[56:59], v[168:171]
 v_exp_f32 v22, v108
M v[172:175], a[108:111], v[60:63], v[172:175]
 ds_read_b128 a[80:83], v2 offset:20480
 v_add_f32 v29, v21, v29
M v[172:175], a[104:107], v[44:47], v[172:175]
 ds_read_b128 a[84:87], v2 offset:21504
M v[176:179], a[112:115], v[40:43], v[176:179]
 buffer_load_dwordx4 v4, s[8:11], s21 offen offset:1024 sc1 lds
M v[176:179], a[116:119], v[56:59], v[176:179]
 ds_read_b128 a[88:91], v2 offset:22528
M v[180:183], a[116:119], v[60:63], v[180:183]
 ds_read_b128 a[92:95], v2 offset:23552
M v[180:183], a[112:115], v[44:47], v[180:183]
 buffer_load_dwordx4 v4, s[8:11], s21 offen offset:2048 sc1 lds
M v[184:187], a[120:123], v[40:43], v[184:187]
 v_exp_f32 v23, v109
M v[184:187], a[124:127], v[56:59], v[184:187]
 v_exp_f32 v24, v110
M v[188:191], a[124:127], v[60:63], v[188:191]
 v_exp_f32 v25, v111
M v[188:191], a[120:123], v[44:47], v[188:191]
 s_waitcnt lgkmcnt(0)
 v_exp_f32 v18, v116
M v[192:195], a[64:67], v[40:43], v[192:195]
 ds_read_b128 a[96:99], v2 offset:24576
 v_add_f32 v29, v22, v29
M v[192:195], a[68:71], v[56:59], v[192:195]
 ds_read_b128 a[100:103], v2 offset:25600
 v_cvt_pk_bf16_f32 v54, v22, v23
M v[196:199], a[68:71], v[60:63], v[196:199]
 buffer_load_dwordx4 v4, s[8:11], s21 offen offset:3072 sc1 lds
M v[196:199], a[64:67], v[44:47], v[196:199]
 s_add_u32 s24, s23, 16777216
 ds_read_b128 a[104:107], v2 offset:26624
 v_add_f32 v29, v23, v29
M v[200:203], a[72:75], v[40:43], v[200:203]
 s_mov_b32 s23, s21
 ds_read_b128 a[108:111], v2 offset:27648
 v_add_f32 v29, v24, v29
M v[200:203], a[76:79], v[56:59], v[200:203]
 s_add_u32 s21, s21, 32768
 v_exp_f32 v19, v117
M v[204:207], a[76:79], v[60:63], v[204:207]
 s_add_u32 s22, s22, 1
 ds_read_b128 a[112:115], v2 offset:28672
 v_cvt_pk_bf16_f32 v55, v24, v25
M v[204:207], a[72:75], v[44:47], v[204:207]
 s_cmp_eq_u32 s22, s25
 ds_read_b128 a[116:119], v2 offset:29696
 v_add_f32 v29, v25, v29
M v[208:211], a[80:83], v[40:43], v[208:211]
 s_cselect_b32 s21, s26, s21
 v_exp_f32 v20, v118
M v[208:211], a[84:87], v[56:59], v[208:211]
 s_cmp_eq_u32 s22, s43
 ds_read_b128 a[120:123], v2 offset:30720
 v_add_f32 v29, v18, v29
M v[212:215], a[84:87], v[60:63], v[212:215]
 s_cselect_b32 s21, s4, s21
 ds_read_b128 a[124:127], v2 offset:31744
 v_cvt_pk_bf16_f32 v48, v18, v19
M v[212:215], a[80:83], v[44:47], v[212:215]
 s_cmp_eq_u32 s22, s6
 v_exp_f32 v21, v119
M v[216:219], a[88:91], v[40:43], v[216:219]
 s_cselect_b32 s21, s7, s21
 v_exp_f32 v22, v124
M v[216:219], a[92:95], v[56:59], v[216:219]
 v_exp_f32 v23, v125
M v[220:223], a[92:95], v[60:63], v[220:223]
 s_waitcnt vmcnt(8) lgkmcnt(0)
 v_add_f32 v29, v19, v29
 v_add_f32 v29, v20, v29
M v[220:223], a[88:91], v[44:47], v[220:223]
 s_barrier
M v[224:227], a[96:99], v[40:43], v[224:227]
 ds_read_b128 a[64:67], v7 offset:0
 v_cvt_pk_bf16_f32 v49, v20, v21
M v[224:227], a[100:103], v[56:59], v[224:227]
 ds_read_b128 a[68:71], v7 offset:1024
 v_add_f32 v29, v21, v29
M v[228:231], a[100:103], v[60:63], v[228:231]
 v_exp_f32 v24, v126
M v[228:231], a[96:99], v[44:47], v[228:231]
 ds_read_b128 a[72:75], v7 offset:2048
 v_add_f32 v29, v22, v29
M v[232:235], a[104:107], v[40:43], v[232:235]
 ds_read_b128 a[76:79], v7 offset:3072
 v_cvt_pk_bf16_f32 v50, v22, v23
M v[232:235], a[108:111], v[56:59], v[232:235]
 v_exp_f32 v25, v127
M v[236:239], a[108:111], v[60:63], v[236:239]
 ds_read_b128 a[80:83], v7 offset:4096
 v_add_f32 v29, v23, v29
M v[236:239], a[104:107], v[44:47], v[236:239]
 ds_read_b128 a[84:87], v7 offset:5120
 v_add_f32 v29, v24, v29
M v[240:243], a[112:115], v[40:43], v[240:243]
 v_cvt_pk_bf16_f32 v51, v24, v25
 v_add_f32 v29, v25, v29
M v[240:243], a[116:119], v[56:59], v[240:243]
 ds_read_b128 a[88:91], v7 offset:6144
M v[244:247], a[116:119], v[60:63], v[244:247]
 ds_read_b128 a[92:95], v7 offset:7168
M v[244:247], a[112:115], v[44:47], v[244:247]
 v_cmp_lt_f32 vcc, s31, v29
M v[248:251], a[120:123], v[40:43], v[248:251]
M v[248:251], a[124:127], v[56:59], v[248:251]
M v[252:255], a[124:127], v[60:63], v[252:255]
 s_waitcnt lgkmcnt(0)
M v[252:255], a[120:123], v[44:47], v[252:255]
 s_cbranch_vccnz L_st2
L_rt2:
L_pBo:
M v[132:135], a[64:67], v[52:55], v[132:135]
 ds_read_b128 a[96:99], v7 offset:8192
 ds_read_b128 a[100:103], v7 offset:9216
M v[132:135], a[68:71], v[48:51], v[132:135]
 ds_read_b128 a[104:107], v7 offset:10240
 v_cvt_pk_bf16_f32 v128, v128, v129
 v_cvt_pk_bf16_f32 v129, v130, v131
M v[140:143], a[76:79], v[48:51], v[140:143]
 ds_read_b128 a[108:111], v7 offset:11264
 ds_read_b128 a[112:115], v7 offset:12288
 v_cvt_pk_bf16_f32 v130, v136, v137
M v[140:143], a[72:75], v[52:55], v[140:143]
 ds_read_b128 a[116:119], v7 offset:13312
 v_cvt_pk_bf16_f32 v131, v138, v139
 v_cvt_pk_bf16_f32 v144, v144, v145
M v[148:151], a[80:83], v[52:55], v[148:151]
 s_add_u32 m0, s28, 65536
 ds_read_b128 a[120:123], v7 offset:14336
 ds_read_b128 a[124:127], v7 offset:15360
M v[148:151], a[84:87], v[48:51], v[148:151]
 buffer_load_dwordx4 v3, s[8:11], s38 offen offset:0 sc1 lds
M v[156:159], a[92:95], v[48:51], v[156:159]
 ds_read_b128 a[128:131], v7 offset:16384
 ds_read_b128 a[132:135], v7 offset:17408
 v_cvt_pk_bf16_f32 v145, v146, v147
M v[156:159], a[88:91], v[52:55], v[156:159]
 s_waitcnt lgkmcnt(2)
 ds_read_b128 a[136:139], v7 offset:18432
 v_cvt_pk_bf16_f32 v146, v152, v153
 v_cvt_pk_bf16_f32 v147, v154, v155
M v[164:167], a[96:99], v[52:55], v[164:167]
 ds_read_b128 a[140:143], v7 offset:19456
 ds_read_b128 a[144:147], v7 offset:20480
 v_cvt_pk_bf16_f32 v160, v160, v161
M v[164:167], a[100:103], v[48:51], v[164:167]
 buffer_load_dwordx4 v3, s[8:11], s38 offen offset:1024 sc1 lds
M v[172:175], a[108:111], v[48:51], v[172:175]
 ds_read_b128 a[148:151], v7 offset:21504
 ds_read_b128 a[152:155], v7 offset:22528
 v_cvt_pk_bf16_f32 v161, v162, v163
M v[172:175], a[104:107], v[52:55], v[172:175]
 ds_read_b128 a[156:159], v7 offset:23552
 v_cvt_pk_bf16_f32 v162, v168, v169
 v_cvt_pk_bf16_f32 v163, v170, v171
M v[180:183], a[112:115], v[52:55], v[180:183]
 ds_read_b128 a[160:163], v7 offset:24576
 ds_read_b128 a[164:167], v7 offset:25600
 v_cvt_pk_bf16_f32 v176, v176, v177
M v[180:183], a[116:119], v[48:51], v[180:183]
 buffer_load_dwordx4 v3, s[8:11], s38 offen offset:2048 sc1 lds
M v[188:191], a[124:127], v[48:51], v[188:191]
 ds_read_b128 a[168:171], v7 offset:26624
 ds_read_b128 a[172:175], v7 offset:27648
 v_cvt_pk_bf16_f32 v177, v178, v179
M v[188:191], a[120:123], v[52:55], v[188:191]
 s_waitcnt lgkmcnt(4)
 ds_read_b128 a[176:179], v7 offset:28672
 v_cvt_pk_bf16_f32 v178, v184, v185
M v[196:199], a[128:131], v[52:55], v[196:199]
 ds_read_b128 a[180:183], v7 offset:29696
 ds_read_b128 a[184:187], v7 offset:30720
 v_cvt_pk_bf16_f32 v179, v186, v187
M v[196:199], a[132:135], v[48:51], v[196:199]
 ds_read_b128 a[188:191], v7 offset:31744
 v_cvt_pk_bf16_f32 v192, v192, v193
 v_cvt_pk_bf16_f32 v193, v194, v195
M v[204:207], a[140:143], v[48:51], v[204:207]
 buffer_load_dwordx4 v3, s[8:11], s38 offen offset:3072 sc1 lds
M v[204:207], a[136:139], v[52:55], v[204:207]
 s_add_u32 m0, s28, 69632
 v_cvt_pk_bf16_f32 v194, v200, v201
 v_cvt_pk_bf16_f32 v195, v202, v203
 v_cvt_pk_bf16_f32 v208, v208, v209
M v[212:215], a[144:147], v[52:55], v[212:215]
 buffer_load_dwordx4 v4, s[8:11], s38 offen offset:0 sc1 lds
M v[212:215], a[148:151], v[48:51], v[212:215]
 s_waitcnt lgkmcnt(0)
 v_cvt_pk_bf16_f32 v209, v210, v211
 v_cvt_pk_bf16_f32 v210, v216, v217
 v_cvt_pk_bf16_f32 v211, v218, v219
M v[220:223], a[156:159], v[48:51], v[220:223]
 s_barrier
M v[220:223], a[152:155], v[52:55], v[220:223]
 ds_read_b128 a[64:67], v2 offset:32768
 ds_read_b128 a[68:71], v2 offset:33792
 v_cvt_pk_bf16_f32 v224, v224, v225
M v[228:231], a[160:163], v[52:55], v[228:231]
 ds_read_b128 a[72:75], v2 offset:34816
 v_cvt_pk_bf16_f32 v225, v226, v227
 v_cvt_pk_bf16_f32 v226, v232, v233
M v[228:231], a[164:167], v[48:51], v[228:231]
 ds_read_b128 a[76:79], v2 offset:35840
 ds_read_b128 a[80:83], v2 offset:36864
M v[236:239], a[172:175], v[48:51], v[236:239]
 ds_read_b128 a[84:87], v2 offset:37888
 v_cvt_pk_bf16_f32 v227, v234, v235
 v_cvt_pk_bf16_f32 v240, v240, v241
M v[236:239], a[168:171], v[52:55], v[236:239]
 ds_read_b128 a[88:91], v2 offset:38912
 ds_read_b128 a[92:95], v2 offset:39936
 v_cvt_pk_bf16_f32 v241, v242, v243
M v[244:247], a[176:179], v[52:55], v[244:247]
 buffer_load_dwordx4 v4, s[8:11], s38 offen offset:1024 sc1 lds
M v[244:247], a[180:183], v[48:51], v[244:247]
 buffer_load_dwordx4 v4, s[8:11], s38 offen offset:2048 sc1 lds
M v[252:255], a[188:191], v[48:51], v[252:255]
 buffer_load_dwordx4 v4, s[8:11], s38 offen offset:3072 sc1 lds
M v[252:255], a[184:187], v[52:55], v[252:255]
 s_waitcnt lgkmcnt(0)
 s_add_u32 s38, s38, 32768
 v_cvt_pk_bf16_f32 v242, v248, v249
 v_cvt_pk_bf16_f32 v243, v250, v251
 s_branch L_op1
L_p3c:
 s_waitcnt vmcnt(8)
 v_cmp_ne_u32 vcc, 1, v5
 s_nop 0
 s_cbranch_vccnz L_fps0
L_fpr0:
M v[128:131], a[64:67], v[40:43], v[128:131]
 ds_read_b128 a[96:99], v2 offset:8192
 ds_read_b128 a[100:103], v2 offset:9216
M v[128:131], a[68:71], v[56:59], v[128:131]
 buffer_load_dwordx4 v[14:17], v7, s[8:11], s52 offen sc1
M v[132:135], a[68:71], v[60:63], v[132:135]
 v_exp_f32 v18, v100
M v[132:135], a[64:67], v[44:47], v[132:135]
 ds_read_b128 a[104:107], v2 offset:10240
 ds_read_b128 a[108:111], v2 offset:11264
M v[136:139], a[72:75], v[40:43], v[136:139]
 buffer_load_dwordx4 a[128:131], v7, s[8:11], s12 offen offset:0 sc1
M v[136:139], a[76:79], v[56:59], v[136:139]
 v_exp_f32 v19, v101
M v[140:143], a[76:79], v[60:63], v[140:143]
 ds_read_b128 a[112:115], v2 offset:12288
 ds_read_b128 a[116:119], v2 offset:13312
M v[140:143], a[72:75], v[44:47], v[140:143]
 buffer_load_dwordx4 a[132:135], v7, s[8:11], s12 offen offset:1024 sc1
M v[144:147], a[80:83], v[40:43], v[144:147]
 v_exp_f32 v20, v102
M v[144:147], a[84:87], v[56:59], v[144:147]
 ds_read_b128 a[120:123], v2 offset:14336
 ds_read_b128 a[124:127], v2 offset:15360
M v[148:151], a[84:87], v[60:63], v[148:151]
 buffer_load_dwordx4 a[136:139], v7, s[8:11], s12 offen offset:2048 sc1
M v[148:151], a[80:83], v[44:47], v[148:151]
 v_exp_f32 v21, v103
M v[152:155], a[88:91], v[40:43], v[152:155]
 v_add_f32 v30, v26, v30
 v_add_f32 v31, v27, v31
M v[152:155], a[92:95], v[56:59], v[152:155]
 v_add_f32 v29, v18, v19
 v_cvt_pk_bf16_f32 v52, v18, v19
M v[156:159], a[92:95], v[60:63], v[156:159]
 buffer_load_dwordx4 a[140:143], v7, s[8:11], s12 offen offset:3072 sc1
M v[156:159], a[88:91], v[44:47], v[156:159]
 s_waitcnt lgkmcnt(0)
 v_exp_f32 v22, v108
M v[160:163], a[96:99], v[40:43], v[160:163]
 ds_read_b128 a[64:67], v2 offset:16384
 ds_read_b128 a[68:71], v2 offset:17408
M v[160:163], a[100:103], v[56:59], v[160:163]
 buffer_load_dwordx4 a[144:147], v7, s[8:11], s13 offen offset:0 sc1
M v[164:167], a[100:103], v[60:63], v[164:167]
 v_exp_f32 v23, v109
M v[164:167], a[96:99], v[44:47], v[164:167]
 ds_read_b128 a[72:75], v2 offset:18432
 ds_read_b128 a[76:79], v2 offset:19456
M v[168:171], a[104:107], v[40:43], v[168:171]
 v_add_f32 v29, v20, v29
 v_cvt_pk_bf16_f32 v53, v20, v21
M v[168:171], a[108:111], v[56:59], v[168:171]
 buffer_load_dwordx4 a[148:151], v7, s[8:11], s13 offen offset:1024 sc1
M v[172:175], a[108:111], v[60:63], v[172:175]
 ds_read_b128 a[80:83], v2 offset:20480
 ds_read_b128 a[84:87], v2 offset:21504
M v[172:175], a[104:107], v[44:47], v[172:175]
 v_exp_f32 v24, v110
M v[176:179], a[112:115], v[40:43], v[176:179]
 buffer_load_dwordx4 a[152:155], v7, s[8:11], s13 offen offset:2048 sc1
M v[176:179], a[116:119], v[56:59], v[176:179]
 ds_read_b128 a[88:91], v2 offset:22528
 ds_read_b128 a[92:95], v2 offset:23552
M v[180:183], a[116:119], v[60:63], v[180:183]
 v_exp_f32 v25, v111
M v[180:183], a[112:115], v[44:47], v[180:183]
 v_add_f32 v29, v21, v29
 v_add_f32 v29, v22, v29
M v[184:187], a[120:123], v[40:43], v[184:187]
 buffer_load_dwordx4 a[156:159], v7, s[8:11], s13 offen offset:3072 sc1
M v[184:187], a[124:127], v[56:59], v[184:187]
 v_exp_f32 v18, v116
M v[188:191], a[124:127], v[60:63], v[188:191]
 v_cvt_pk_bf16_f32 v54, v22, v23
 v_add_f32 v29, v23, v29
M v[188:191], a[120:123], v[44:47], v[188:191]
 s_waitcnt lgkmcnt(0)
 v_exp_f32 v19, v117
M v[192:195], a[64:67], v[40:43], v[192:195]
 ds_read_b128 a[96:99], v2 offset:24576
 ds_read_b128 a[100:103], v2 offset:25600
M v[192:195], a[68:71], v[56:59], v[192:195]
 buffer_load_dwordx4 a[160:163], v7, s[8:11], s14 offen offset:0 sc1
M v[196:199], a[68:71], v[60:63], v[196:199]
 v_add_f32 v29, v24, v29
 v_cvt_pk_bf16_f32 v55, v24, v25
M v[196:199], a[64:67], v[44:47], v[196:199]
 ds_read_b128 a[104:107], v2 offset:26624
 ds_read_b128 a[108:111], v2 offset:27648
M v[200:203], a[72:75], v[40:43], v[200:203]
 buffer_load_dwordx4 a[164:167], v7, s[8:11], s14 offen offset:1024 sc1
M v[200:203], a[76:79], v[56:59], v[200:203]
 v_exp_f32 v20, v118
M v[204:207], a[76:79], v[60:63], v[204:207]
 ds_read_b128 a[112:115], v2 offset:28672
 ds_read_b128 a[116:119], v2 offset:29696
M v[204:207], a[72:75], v[44:47], v[204:207]
 buffer_load_dwordx4 a[168:171], v7, s[8:11], s14 offen offset:2048 sc1
M v[208:211], a[80:83], v[40:43], v[208:211]
 v_exp_f32 v21, v119
M v[208:211], a[84:87], v[56:59], v[208:211]
 ds_read_b128 a[120:123], v2 offset:30720
 ds_read_b128 a[124:127], v2 offset:31744
M v[212:215], a[84:87], v[60:63], v[212:215]
 buffer_load_dwordx4 a[172:175], v7, s[8:11], s14 offen offset:3072 sc1
M v[212:215], a[80:83], v[44:47], v[212:215]
 v_exp_f32 v22, v124
M v[216:219], a[88:91], v[40:43], v[216:219]
 v_add_f32 v29, v25, v29
 v_add_f32 v29, v18, v29
M v[216:219], a[92:95], v[56:59], v[216:219]
 buffer_load_dwordx4 a[176:179], v7, s[8:11], s15 offen offset:0 sc1
M v[220:223], a[92:95], v[60:63], v[220:223]
 s_waitcnt vmcnt(14) lgkmcnt(0)
 v_exp_f32 v23, v125
M v[220:223], a[88:91], v[44:47], v[220:223]
 s_barrier
M v[224:227], a[96:99], v[40:43], v[224:227]
 ds_read_b128 a[64:67], v7 offset:0
 ds_read_b128 a[68:71], v7 offset:1024
M v[224:227], a[100:103], v[56:59], v[224:227]
 buffer_load_dwordx4 a[180:183], v7, s[8:11], s15 offen offset:1024 sc1
M v[228:231], a[100:103], v[60:63], v[228:231]
 v_exp_f32 v24, v126
M v[228:231], a[96:99], v[44:47], v[228:231]
 ds_read_b128 a[72:75], v7 offset:2048
 ds_read_b128 a[76:79], v7 offset:3072
M v[232:235], a[104:107], v[40:43], v[232:235]
 buffer_load_dwordx4 a[184:187], v7, s[8:11], s15 offen offset:2048 sc1
M v[232:235], a[108:111], v[56:59], v[232:235]
 v_exp_f32 v25, v127
M v[236:239], a[108:111], v[60:63], v[236:239]
 ds_read_b128 a[80:83], v7 offset:4096
 ds_read_b128 a[84:87], v7 offset:5120
M v[236:239], a[104:107], v[44:47], v[236:239]
 v_cvt_pk_bf16_f32 v48, v18, v19
 v_add_f32 v29, v19, v29
M v[240:243], a[112:115], v[40:43], v[240:243]
 buffer_load_dwordx4 a[188:191], v7, s[8:11], s15 offen offset:3072 sc1
M v[240:243], a[116:119], v[56:59], v[240:243]
 ds_read_b128 a[88:91], v7 offset:6144
 ds_read_b128 a[92:95], v7 offset:7168
M v[244:247], a[116:119], v[60:63], v[244:247]
 v_add_f32 v29, v20, v29
 v_cvt_pk_bf16_f32 v49, v20, v21
M v[244:247], a[112:115], v[44:47], v[244:247]
 v_add_f32 v29, v21, v29
 v_add_f32 v29, v22, v29
M v[248:251], a[120:123], v[40:43], v[248:251]
 v_cvt_pk_bf16_f32 v50, v22, v23
 v_add_f32 v29, v23, v29
M v[248:251], a[124:127], v[56:59], v[248:251]
 v_add_f32 v29, v24, v29
 v_cvt_pk_bf16_f32 v51, v24, v25
M v[252:255], a[124:127], v[60:63], v[252:255]
 s_waitcnt lgkmcnt(0)
 v_add_f32 v29, v25, v29
M v[252:255], a[120:123], v[44:47], v[252:255]
 v_cmp_lt_f32 vcc, s31, v29
 s_nop 0
 s_cbranch_vccnz L_st3
L_rt3:
 s_waitcnt vmcnt(16)
 v_cmp_neq_f32 vcc, v32, v14
 v_cmp_neq_f32 s[64:65], v36, v15
 v_add_f32 v16, v16, v30
 v_add_f32 v17, v17, v31
 s_or_b64 vcc, vcc, s[64:65]
 s_cbranch_vccnz L_comb
M v[132:135], a[64:67], v[52:55], v[132:135]
 s_add_u32 m0, s28, 32768
 ds_read_b128 a[96:99], v7 offset:8192
 ds_read_b128 a[100:103], v7 offset:9216
M v[132:135], a[68:71], v[48:51], v[132:135]
 buffer_load_dwordx4 v3, s[8:11], s21 offen offset:0 sc1 lds
M v[140:143], a[76:79], v[48:51], v[140:143]
 ds_read_b128 a[104:107], v7 offset:10240
 ds_read_b128 a[108:111], v7 offset:11264
M v[140:143], a[72:75], v[52:55], v[140:143]
 v_mov_b32 v30, v16
 v_mov_b32 v31, v17
M v[148:151], a[80:83], v[52:55], v[148:151]
 ds_read_b128 a[112:115], v7 offset:12288
 ds_read_b128 a[116:119], v7 offset:13312
M v[148:151], a[84:87], v[48:51], v[148:151]
 ds_read_b128 a[120:123], v7 offset:14336
M v[156:159], a[92:95], v[48:51], v[156:159]
 ds_read_b128 a[124:127], v7 offset:15360
 ds_read_b128 a[192:195], v7 offset:16384
M v[156:159], a[88:91], v[52:55], v[156:159]
 s_waitcnt lgkmcnt(5)
M v[164:167], a[96:99], v[52:55], v[164:167]
 ds_read_b128 a[196:199], v7 offset:17408
 ds_read_b128 a[200:203], v7 offset:18432
M v[164:167], a[100:103], v[48:51], v[164:167]
 buffer_load_dwordx4 v3, s[8:11], s21 offen offset:1024 sc1 lds
M v[172:175], a[108:111], v[48:51], v[172:175]
 ds_read_b128 a[204:207], v7 offset:19456
 ds_read_b128 a[208:211], v7 offset:20480
M v[172:175], a[104:107], v[52:55], v[172:175]
 s_waitcnt lgkmcnt(5)
M v[180:183], a[112:115], v[52:55], v[180:183]
 ds_read_b128 a[212:215], v7 offset:21504
 ds_read_b128 a[216:219], v7 offset:22528
M v[180:183], a[116:119], v[48:51], v[180:183]
 buffer_load_dwordx4 v3, s[8:11], s21 offen offset:2048 sc1 lds
M v[188:191], a[124:127], v[48:51], v[188:191]
 ds_read_b128 a[220:223], v7 offset:23552
M v[188:191], a[120:123], v[52:55], v[188:191]
 s_waitcnt lgkmcnt(4)
M v[196:199], a[192:195], v[52:55], v[196:199]
 ds_read_b128 a[96:99], v7 offset:24576
 ds_read_b128 a[100:103], v7 offset:25600
M v[196:199], a[196:199], v[48:51], v[196:199]
 ds_read_b128 a[104:107], v7 offset:26624
M v[204:207], a[204:207], v[48:51], v[204:207]
 ds_read_b128 a[108:111], v7 offset:27648
 ds_read_b128 a[112:115], v7 offset:28672
M v[204:207], a[200:203], v[52:55], v[204:207]
 s_waitcnt lgkmcnt(5)
 ds_read_b128 a[116:119], v7 offset:29696
M v[212:215], a[208:211], v[52:55], v[212:215]
 ds_read_b128 a[120:123], v7 offset:30720
 ds_read_b128 a[124:127], v7 offset:31744
M v[212:215], a[212:215], v[48:51], v[212:215]
 buffer_load_dwordx4 v3, s[8:11], s21 offen offset:3072 sc1 lds
M v[220:223], a[220:223], v[48:51], v[220:223]
 s_add_u32 m0, s28, 36864
M v[220:223], a[216:219], v[52:55], v[220:223]
 s_waitcnt lgkmcnt(0)
M v[228:231], a[96:99], v[52:55], v[228:231]
 buffer_load_dwordx4 v4, s[8:11], s21 offen offset:0 sc1 lds
M v[228:231], a[100:103], v[48:51], v[228:231]
M v[236:239], a[108:111], v[48:51], v[236:239]
 buffer_load_dwordx4 v4, s[8:11], s21 offen offset:1024 sc1 lds
M v[236:239], a[104:107], v[52:55], v[236:239]
M v[244:247], a[112:115], v[52:55], v[244:247]
 buffer_load_dwordx4 v4, s[8:11], s21 offen offset:2048 sc1 lds
M v[244:247], a[116:119], v[48:51], v[244:247]
M v[252:255], a[124:127], v[48:51], v[252:255]
 buffer_load_dwordx4 v4, s[8:11], s21 offen offset:3072 sc1 lds
M v[252:255], a[120:123], v[52:55], v[252:255]
 s_waitcnt vmcnt(16)
M v[128:131], a[246:249], a[128:131], v[128:131]
 s_add_u32 m0, s28, 65536
M v[136:139], a[244:247], a[128:131], v[136:139]
 buffer_load_dwordx4 v3, s[8:11], s38 offen offset:0 sc1 lds
M v[144:147], a[246:249], a[132:135], v[144:147]
M v[152:155], a[244:247], a[132:135], v[152:155]
 s_barrier
M v[160:163], a[246:249], a[136:139], v[160:163]
 buffer_load_dwordx4 v3, s[8:11], s38 offen offset:1024 sc1 lds
M v[168:171], a[244:247], a[136:139], v[168:171]
 v_cvt_pk_bf16_f32 v128, v128, v129
 v_cvt_pk_bf16_f32 v129, v130, v131
M v[176:179], a[246:249], a[140:143], v[176:179]
 buffer_load_dwordx4 v3, s[8:11], s38 offen offset:2048 sc1 lds
M v[184:187], a[244:247], a[140:143], v[184:187]
 v_cvt_pk_bf16_f32 v130, v136, v137
 v_cvt_pk_bf16_f32 v131, v138, v139
M v[192:195], a[246:249], a[144:147], v[192:195]
 v_cvt_pk_bf16_f32 v144, v144, v145
 v_cvt_pk_bf16_f32 v145, v146, v147
M v[200:203], a[244:247], a[144:147], v[200:203]
 v_cvt_pk_bf16_f32 v146, v152, v153
 v_cvt_pk_bf16_f32 v147, v154, v155
M v[208:211], a[246:249], a[148:151], v[208:211]
 buffer_load_dwordx4 v3, s[8:11], s38 offen offset:3072 sc1 lds
M v[216:219], a[244:247], a[148:151], v[216:219]
 v_cvt_pk_bf16_f32 v160, v160, v161
 v_cvt_pk_bf16_f32 v161, v162, v163
M v[224:227], a[246:249], a[152:155], v[224:227]
 ds_read_b128 a[64:67], v2 offset:32768
 v_cvt_pk_bf16_f32 v162, v168, v169
M v[232:235], a[244:247], a[152:155], v[232:235]
 s_add_u32 m0, s28, 69632
 ds_read_b128 a[68:71], v2 offset:33792
 v_cvt_pk_bf16_f32 v163, v170, v171
M v[240:243], a[246:249], a[156:159], v[240:243]
 buffer_load_dwordx4 v4, s[8:11], s38 offen offset:0 sc1 lds
M v[248:251], a[244:247], a[156:159], v[248:251]
 s_waitcnt vmcnt(17)
 ds_read_b128 a[72:75], v2 offset:34816
 v_cvt_pk_bf16_f32 v176, v176, v177
M v[132:135], a[246:249], a[160:163], v[132:135]
 ds_read_b128 a[76:79], v2 offset:35840
 v_cvt_pk_bf16_f32 v177, v178, v179
M v[140:143], a[244:247], a[160:163], v[140:143]
 buffer_load_dwordx4 v4, s[8:11], s38 offen offset:1024 sc1 lds
M v[148:151], a[246:249], a[164:167], v[148:151]
 ds_read_b128 a[80:83], v2 offset:36864
 v_cvt_pk_bf16_f32 v178, v184, v185
M v[156:159], a[244:247], a[164:167], v[156:159]
 ds_read_b128 a[84:87], v2 offset:37888
 v_cvt_pk_bf16_f32 v179, v186, v187
M v[164:167], a[246:249], a[168:171], v[164:167]
 v_cvt_pk_bf16_f32 v192, v192, v193
 v_cvt_pk_bf16_f32 v193, v194, v195
M v[172:175], a[244:247], a[168:171], v[172:175]
 ds_read_b128 a[88:91], v2 offset:38912
 v_cvt_pk_bf16_f32 v194, v200, v201
M v[180:183], a[246:249], a[172:175], v[180:183]
 ds_read_b128 a[92:95], v2 offset:39936
 v_cvt_pk_bf16_f32 v195, v202, v203
M v[188:191], a[244:247], a[172:175], v[188:191]
 s_waitcnt vmcnt(14)
 v_cvt_pk_bf16_f32 v208, v208, v209
 v_cvt_pk_bf16_f32 v209, v210, v211
M v[196:199], a[246:249], a[176:179], v[196:199]
 buffer_load_dwordx4 v4, s[8:11], s38 offen offset:2048 sc1 lds
M v[204:207], a[244:247], a[176:179], v[204:207]
 v_cvt_pk_bf16_f32 v210, v216, v217
 v_cvt_pk_bf16_f32 v211, v218, v219
M v[212:215], a[246:249], a[180:183], v[212:215]
 buffer_load_dwordx4 v4, s[8:11], s38 offen offset:3072 sc1 lds
M v[220:223], a[244:247], a[180:183], v[220:223]
 s_add_u32 s38, s38, 32768
 v_cvt_pk_bf16_f32 v224, v224, v225
 v_cvt_pk_bf16_f32 v225, v226, v227
M v[228:231], a[246:249], a[184:187], v[228:231]
 v_cvt_pk_bf16_f32 v226, v232, v233
 v_cvt_pk_bf16_f32 v227, v234, v235
M v[236:239], a[244:247], a[184:187], v[236:239]
 v_cvt_pk_bf16_f32 v240, v240, v241
 v_cvt_pk_bf16_f32 v241, v242, v243
M v[244:247], a[246:249], a[188:191], v[244:247]
 s_waitcnt lgkmcnt(0)
 v_cvt_pk_bf16_f32 v242, v248, v249
 v_cvt_pk_bf16_f32 v243, v250, v251
M v[252:255], a[244:247], a[188:191], v[252:255]
L_op1:
M v[64:67], a[64:67], v[128:131], 0
 ds_read_b128 a[96:99], v2 offset:40960
 ds_read_b128 a[100:103], v2 offset:41984
M v[64:67], a[68:71], v[144:147], v[64:67]
 ds_read_b128 a[104:107], v2 offset:43008
 v_cvt_pk_bf16_f32 v132, v132, v133
 v_cvt_pk_bf16_f32 v133, v134, v135
M v[64:67], a[72:75], v[160:163], v[64:67]
 ds_read_b128 a[108:111], v2 offset:44032
 ds_read_b128 a[112:115], v2 offset:45056
M v[64:67], a[76:79], v[176:179], v[64:67]
 ds_read_b128 a[116:119], v2 offset:46080
 v_cvt_pk_bf16_f32 v134, v140, v141
 v_cvt_pk_bf16_f32 v135, v142, v143
M v[64:67], a[80:83], v[192:195], v[64:67]
 s_add_u32 m0, s28, 0
 ds_read_b128 a[120:123], v2 offset:47104
 ds_read_b128 a[124:127], v2 offset:48128
M v[64:67], a[84:87], v[208:211], v[64:67]
 buffer_load_dwordx4 v3, s[8:11], s38 offen offset:0 sc1 lds
M v[64:67], a[88:91], v[224:227], v[64:67]
 ds_read_b128 a[128:131], v2 offset:49152
 ds_read_b128 a[132:135], v2 offset:50176
 v_cvt_pk_bf16_f32 v148, v148, v149
M v[64:67], a[92:95], v[240:243], v[64:67]
 s_waitcnt lgkmcnt(2)
 ds_read_b128 a[136:139], v2 offset:51200
 v_cvt_pk_bf16_f32 v149, v150, v151
M v[72:75], a[96:99], v[128:131], 0
 ds_read_b128 a[140:143], v2 offset:52224
 ds_read_b128 a[144:147], v2 offset:53248
M v[72:75], a[100:103], v[144:147], v[72:75]
 buffer_load_dwordx4 v3, s[8:11], s38 offen offset:1024 sc1 lds
M v[72:75], a[104:107], v[160:163], v[72:75]
 ds_read_b128 a[148:151], v2 offset:54272
 ds_read_b128 a[152:155], v2 offset:55296
 v_cvt_pk_bf16_f32 v150, v156, v157
M v[72:75], a[108:111], v[176:179], v[72:75]
 ds_read_b128 a[156:159], v2 offset:56320
 v_cvt_pk_bf16_f32 v151, v158, v159
M v[72:75], a[112:115], v[192:195], v[72:75]
 ds_read_b128 a[160:163], v2 offset:57344
 ds_read_b128 a[164:167], v2 offset:58368
 v_cvt_pk_bf16_f32 v164, v164, v165
M v[72:75], a[116:119], v[208:211], v[72:75]
 buffer_load_dwordx4 v3, s[8:11], s38 offen offset:2048 sc1 lds
M v[72:75], a[120:123], v[224:227], v[72:75]
 ds_read_b128 a[168:171], v2 offset:59392
 ds_read_b128 a[172:175], v2 offset:60416
M v[72:75], a[124:127], v[240:243], v[72:75]
 s_waitcnt lgkmcnt(4)
 ds_read_b128 a[176:179], v2 offset:61440
 v_cvt_pk_bf16_f32 v165, v166, v167
 v_cvt_pk_bf16_f32 v166, v172, v173
M v[80:83], a[128:131], v[128:131], 0
 ds_read_b128 a[180:183], v2 offset:62464
 ds_read_b128 a[184:187], v2 offset:63488
M v[80:83], a[132:135], v[144:147], v[80:83]
 ds_read_b128 a[188:191], v2 offset:64512
 v_cvt_pk_bf16_f32 v167, v174, v175
 v_cvt_pk_bf16_f32 v180, v180, v181
M v[80:83], a[136:139], v[160:163], v[80:83]
 buffer_load_dwordx4 v3, s[8:11], s38 offen offset:3072 sc1 lds
M v[80:83], a[140:143], v[176:179], v[80:83]
 s_add_u32 m0, s28, 4096
 v_cvt_pk_bf16_f32 v181, v182, v183
 v_cvt_pk_bf16_f32 v182, v188, v189
M v[80:83], a[144:147], v[192:195], v[80:83]
 buffer_load_dwordx4 v4, s[8:11], s38 offen offset:0 sc1 lds
M v[80:83], a[148:151], v[208:211], v[80:83]
 v_cvt_pk_bf16_f32 v183, v190, v191
 v_cvt_pk_bf16_f32 v196, v196, v197
M v[80:83], a[152:155], v[224:227], v[80:83]
 buffer_load_dwordx4 v4, s[8:11], s38 offen offset:1024 sc1 lds
M v[80:83], a[156:159], v[240:243], v[80:83]
 s_waitcnt lgkmcnt(0)
 v_cvt_pk_bf16_f32 v197, v198, v199
 v_cvt_pk_bf16_f32 v198, v204, v205
 v_cvt_pk_bf16_f32 v199, v206, v207
M v[88:91], a[160:163], v[128:131], 0
 v_cvt_pk_bf16_f32 v212, v212, v213
 v_cvt_pk_bf16_f32 v213, v214, v215
M v[88:91], a[164:167], v[144:147], v[88:91]
 v_cvt_pk_bf16_f32 v214, v220, v221
 v_cvt_pk_bf16_f32 v215, v222, v223
 v_cvt_pk_bf16_f32 v228, v228, v229
M v[88:91], a[168:171], v[160:163], v[88:91]
 buffer_load_dwordx4 v4, s[8:11], s38 offen offset:2048 sc1 lds
M v[88:91], a[172:175], v[176:179], v[88:91]
 v_cvt_pk_bf16_f32 v229, v230, v231
 v_cvt_pk_bf16_f32 v230, v236, v237
M v[88:91], a[176:179], v[192:195], v[88:91]
 v_cvt_pk_bf16_f32 v231, v238, v239
 v_cvt_pk_bf16_f32 v244, v244, v245
 v_cvt_pk_bf16_f32 v245, v246, v247
M v[88:91], a[180:183], v[208:211], v[88:91]
 buffer_load_dwordx4 v4, s[8:11], s38 offen offset:3072 sc1 lds
M v[88:91], a[184:187], v[224:227], v[88:91]
 v_cvt_pk_bf16_f32 v246, v252, v253
 v_cvt_pk_bf16_f32 v247, v254, v255
M v[88:91], a[188:191], v[240:243], v[88:91]
 s_add_u32 s38, s38, 32768
 v_add_f32 v31, v29, v31
 v_mov_b32 v10, v30
M v[68:71], a[64:67], v[132:135], 0
 s_add_u32 m0, s28, 131072
 v_mov_b32 v11, v31
 v_permlane16_swap_b32 v10, v30
M v[68:71], a[68:71], v[148:151], v[68:71]
 buffer_load_dwordx4 v3, s[8:11], s38 offen offset:0 sc1 lds
M v[68:71], a[72:75], v[164:167], v[68:71]
 v_permlane16_swap_b32 v11, v31
 v_add_f32 v30, v10, v30
M v[68:71], a[76:79], v[180:183], v[68:71]
 v_add_f32 v31, v11, v31
 v_mov_b32 v10, v30
M v[68:71], a[80:83], v[196:199], v[68:71]
 buffer_load_dwordx4 v3, s[8:11], s38 offen offset:1024 sc1 lds
M v[68:71], a[84:87], v[212:215], v[68:71]
 v_mov_b32 v11, v31
 v_permlane32_swap_b32 v10, v30
M v[68:71], a[88:91], v[228:231], v[68:71]
 v_permlane32_swap_b32 v11, v31
 v_add_f32 v30, v10, v30
M v[68:71], a[92:95], v[244:247], v[68:71]
 v_add_f32 v31, v11, v31
M v[76:79], a[96:99], v[132:135], 0
 buffer_load_dwordx4 v3, s[8:11], s38 offen offset:2048 sc1 lds
M v[76:79], a[100:103], v[148:151], v[76:79]
 v_rcp_f32 v5, v30
M v[76:79], a[104:107], v[164:167], v[76:79]
 v_rcp_f32 v6, v31
M v[76:79], a[108:111], v[180:183], v[76:79]
 buffer_load_dwordx4 v3, s[8:11], s38 offen offset:3072 sc1 lds
M v[76:79], a[112:115], v[196:199], v[76:79]
M v[76:79], a[116:119], v[212:215], v[76:79]
M v[76:79], a[120:123], v[228:231], v[76:79]
 s_waitcnt vmcnt(20)
M v[76:79], a[124:127], v[244:247], v[76:79]
 s_barrier
M v[84:87], a[128:131], v[132:135], 0
 ds_read_b128 a[64:67], v7 offset:32768
M v[84:87], a[132:135], v[148:151], v[84:87]
 s_add_u32 m0, s28, 135168
 ds_read_b128 a[68:71], v7 offset:33792
M v[84:87], a[136:139], v[164:167], v[84:87]
 buffer_load_dwordx4 v4, s[8:11], s38 offen offset:0 sc1 lds
M v[84:87], a[140:143], v[180:183], v[84:87]
 ds_read_b128 a[72:75], v7 offset:34816
M v[84:87], a[144:147], v[196:199], v[84:87]
 ds_read_b128 a[76:79], v7 offset:35840
M v[84:87], a[148:151], v[212:215], v[84:87]
 buffer_load_dwordx4 v4, s[8:11], s38 offen offset:1024 sc1 lds
M v[84:87], a[152:155], v[228:231], v[84:87]
 ds_read_b128 a[80:83], v7 offset:36864
M v[84:87], a[156:159], v[244:247], v[84:87]
 ds_read_b128 a[84:87], v7 offset:37888
M v[92:95], a[160:163], v[132:135], 0
 buffer_load_dwordx4 v4, s[8:11], s38 offen offset:2048 sc1 lds
M v[92:95], a[164:167], v[148:151], v[92:95]
 ds_read_b128 a[88:91], v7 offset:38912
M v[92:95], a[168:171], v[164:167], v[92:95]
 ds_read_b128 a[92:95], v7 offset:39936
M v[92:95], a[172:175], v[180:183], v[92:95]
 buffer_load_dwordx4 v4, s[8:11], s38 offen offset:3072 sc1 lds
M v[92:95], a[176:179], v[196:199], v[92:95]
 s_add_u32 s38, s38, 32768
M v[92:95], a[180:183], v[212:215], v[92:95]
M v[92:95], a[184:187], v[228:231], v[92:95]
 s_waitcnt lgkmcnt(0)
 s_cmp_eq_u32 s42, 6
M v[92:95], a[188:191], v[244:247], v[92:95]
 s_cbranch_scc1 L_y1
L_y1r:
M v[96:99], a[64:67], v[128:131], 0
 s_add_u32 m0, s28, 98304
 ds_read_b128 a[96:99], v7 offset:40960
M v[96:99], a[68:71], v[144:147], v[96:99]
 ds_read_b128 a[100:103], v7 offset:41984
M v[96:99], a[72:75], v[160:163], v[96:99]
 buffer_load_dwordx4 v3, s[8:11], s38 offen offset:0 sc1 lds
M v[96:99], a[76:79], v[176:179], v[96:99]
 ds_read_b128 a[104:107], v7 offset:43008
 s_add_u32 s29, s33, 0
M v[96:99], a[80:83], v[192:195], v[96:99]
 ds_read_b128 a[108:111], v7 offset:44032
 s_add_u32 s30, s33, 14336
M v[96:99], a[84:87], v[208:211], v[96:99]
 buffer_load_dwordx4 v3, s[8:11], s38 offen offset:1024 sc1 lds
M v[96:99], a[88:91], v[224:227], v[96:99]
 ds_read_b128 a[112:115], v7 offset:45056
 v_max3_f32 v32, |v64|, |v65|, |v66|
M v[96:99], a[92:95], v[240:243], v[96:99]
 ds_read_b128 a[116:119], v7 offset:46080
 v_max3_f32 v32, |v67|, |v72|, v32
M v[100:103], a[92:95], v[244:247], 0
 buffer_load_dwordx4 v3, s[8:11], s38 offen offset:2048 sc1 lds
M v[100:103], a[88:91], v[228:231], v[100:103]
 ds_read_b128 a[120:123], v7 offset:47104
 v_max3_f32 v32, |v73|, |v74|, v32
M v[100:103], a[84:87], v[212:215], v[100:103]
 ds_read_b128 a[124:127], v7 offset:48128
 v_mul_f32 v32, 2.0, v32
M v[100:103], a[80:83], v[196:199], v[100:103]
 buffer_load_dwordx4 v3, s[8:11], s38 offen offset:3072 sc1 lds
M v[100:103], a[76:79], v[180:183], v[100:103]
 s_add_u32 m0, s28, 102400
 v_mov_b32 v33, v32
 v_mov_b32 v34, v32
M v[100:103], a[72:75], v[164:167], v[100:103]
 buffer_load_dwordx4 v4, s[8:11], s38 offen offset:0 sc1 lds
M v[100:103], a[68:71], v[148:151], v[100:103]
 v_mov_b32 v35, v32
 v_mul_f32 v28, -v32, v5
M v[100:103], a[64:67], v[132:135], v[100:103]
 s_waitcnt lgkmcnt(0)
 v_mul_f32 v64, v5, v64
 v_mul_f32 v65, v5, v65
M v[104:107], a[96:99], v[128:131], 0
 ds_read_b128 a[64:67], v7 offset:49152
 v_mul_f32 v66, v5, v66
M v[104:107], a[100:103], v[144:147], v[104:107]
 ds_read_b128 a[68:71], v7 offset:50176
 v_mul_f32 v67, v5, v67
M v[104:107], a[104:107], v[160:163], v[104:107]
 buffer_load_dwordx4 v4, s[8:11], s38 offen offset:1024 sc1 lds
M v[104:107], a[108:111], v[176:179], v[104:107]
 ds_read_b128 a[72:75], v7 offset:51200
 v_mul_f32 v72, v5, v72
M v[104:107], a[112:115], v[192:195], v[104:107]
 ds_read_b128 a[76:79], v7 offset:52224
 v_mul_f32 v73, v5, v73
M v[104:107], a[116:119], v[208:211], v[104:107]
 buffer_load_dwordx4 v4, s[8:11], s38 offen offset:2048 sc1 lds
M v[104:107], a[120:123], v[224:227], v[104:107]
 ds_read_b128 a[80:83], v7 offset:53248
 v_mul_f32 v74, v5, v74
M v[104:107], a[124:127], v[240:243], v[104:107]
 ds_read_b128 a[84:87], v7 offset:54272
 v_mul_f32 v75, v5, v75
M v[108:111], a[124:127], v[244:247], 0
 buffer_load_dwordx4 v4, s[8:11], s38 offen offset:3072 sc1 lds
M v[108:111], a[120:123], v[228:231], v[108:111]
 s_add_u32 s38, s38, 32768
 ds_read_b128 a[88:91], v7 offset:55296
 v_cvt_pk_bf16_f32 v64, v64, v65
M v[108:111], a[116:119], v[212:215], v[108:111]
 ds_read_b128 a[92:95], v7 offset:56320
 v_cvt_pk_bf16_f32 v65, v66, v67
M v[108:111], a[112:115], v[196:199], v[108:111]
 v_cvt_pk_bf16_f32 v66, v72, v73
 v_cvt_pk_bf16_f32 v67, v74, v75
M v[108:111], a[108:111], v[180:183], v[108:111]
 buffer_store_dwordx4 v[64:67], v7, s[8:11], s29 offen offset:0 sc1
M v[108:111], a[104:107], v[164:167], v[108:111]
 v_max3_f32 v36, |v68|, |v69|, |v70|
 v_max3_f32 v36, |v71|, |v76|, v36
M v[108:111], a[100:103], v[148:151], v[108:111]
 v_max3_f32 v36, |v77|, |v78|, v36
 v_mul_f32 v36, 2.0, v36
M v[108:111], a[96:99], v[132:135], v[108:111]
 s_waitcnt lgkmcnt(0)
 v_mov_b32 v37, v36
 v_mov_b32 v38, v36
M v[112:115], a[64:67], v[128:131], 0
 ds_read_b128 a[96:99], v7 offset:57344
 v_mov_b32 v39, v36
M v[112:115], a[68:71], v[144:147], v[112:115]
 ds_read_b128 a[100:103], v7 offset:58368
 v_mul_f32 v29, -v36, v6
M v[112:115], a[72:75], v[160:163], v[112:115]
 v_mul_f32 v68, v6, v68
 v_mul_f32 v69, v6, v69
M v[112:115], a[76:79], v[176:179], v[112:115]
 ds_read_b128 a[104:107], v7 offset:59392
 v_mul_f32 v70, v6, v70
M v[112:115], a[80:83], v[192:195], v[112:115]
 ds_read_b128 a[108:111], v7 offset:60416
 v_mul_f32 v71, v6, v71
M v[112:115], a[84:87], v[208:211], v[112:115]
 v_mul_f32 v76, v6, v76
 v_mul_f32 v77, v6, v77
M v[112:115], a[88:91], v[224:227], v[112:115]
 ds_read_b128 a[112:115], v7 offset:61440
 v_mul_f32 v78, v6, v78
M v[112:115], a[92:95], v[240:243], v[112:115]
 ds_read_b128 a[116:119], v7 offset:62464
 v_mul_f32 v79, v6, v79
M v[116:119], a[92:95], v[244:247], 0
 v_cvt_pk_bf16_f32 v68, v68, v69
 v_cvt_pk_bf16_f32 v69, v70, v71
M v[116:119], a[88:91], v[228:231], v[116:119]
 ds_read_b128 a[120:123], v7 offset:63488
 v_cvt_pk_bf16_f32 v70, v76, v77
M v[116:119], a[84:87], v[212:215], v[116:119]
 ds_read_b128 a[124:127], v7 offset:64512
 v_cvt_pk_bf16_f32 v71, v78, v79
M v[116:119], a[80:83], v[196:199], v[116:119]
 buffer_store_dwordx4 v[68:71], v7, s[8:11], s30 offen offset:0 sc1
M v[116:119], a[76:79], v[180:183], v[116:119]
 v_mul_f32 v80, v5, v80
 v_mul_f32 v81, v5, v81
M v[116:119], a[72:75], v[164:167], v[116:119]
 v_mul_f32 v82, v5, v82
 v_mul_f32 v83, v5, v83
M v[116:119], a[68:71], v[148:151], v[116:119]
 s_waitcnt vmcnt(26) lgkmcnt(0)
 v_mul_f32 v88, v5, v88
 v_mul_f32 v89, v5, v89
M v[116:119], a[64:67], v[132:135], v[116:119]
 s_barrier
M v[120:123], a[96:99], v[128:131], 0
 ds_read_b128 a[64:67], v2 offset:0
 v_mul_f32 v90, v5, v90
M v[120:123], a[100:103], v[144:147], v[120:123]
 ds_read_b128 a[68:71], v2 offset:1024
 v_mul_f32 v91, v5, v91
M v[120:123], a[104:107], v[160:163], v[120:123]
 v_cvt_pk_bf16_f32 v80, v80, v81
 v_cvt_pk_bf16_f32 v81, v82, v83
M v[120:123], a[108:111], v[176:179], v[120:123]
 ds_read_b128 a[72:75], v2 offset:2048
 v_cvt_pk_bf16_f32 v82, v88, v89
M v[120:123], a[112:115], v[192:195], v[120:123]
 ds_read_b128 a[76:79], v2 offset:3072
 v_cvt_pk_bf16_f32 v83, v90, v91
M v[120:123], a[116:119], v[208:211], v[120:123]
 buffer_store_dwordx4 v[80:83], v7, s[8:11], s29 offen offset:1024 sc1
M v[120:123], a[120:123], v[224:227], v[120:123]
 ds_read_b128 a[80:83], v2 offset:4096
 v_mul_f32 v84, v6, v84
M v[120:123], a[124:127], v[240:243], v[120:123]
 ds_read_b128 a[84:87], v2 offset:5120
 v_mul_f32 v85, v6, v85
M v[124:127], a[124:127], v[244:247], 0
 v_mul_f32 v86, v6, v86
 v_mul_f32 v87, v6, v87
M v[124:127], a[120:123], v[228:231], v[124:127]
 ds_read_b128 a[88:91], v2 offset:6144
 v_mul_f32 v92, v6, v92
M v[124:127], a[116:119], v[212:215], v[124:127]
 ds_read_b128 a[92:95], v2 offset:7168
 v_mul_f32 v93, v6, v93
M v[124:127], a[112:115], v[196:199], v[124:127]
 v_mul_f32 v94, v6, v94
 v_mul_f32 v95, v6, v95
M v[124:127], a[108:111], v[180:183], v[124:127]
 v_cvt_pk_bf16_f32 v84, v84, v85
 v_cvt_pk_bf16_f32 v85, v86, v87
M v[124:127], a[104:107], v[164:167], v[124:127]
 v_cvt_pk_bf16_f32 v86, v92, v93
 v_cvt_pk_bf16_f32 v87, v94, v95
M v[124:127], a[100:103], v[148:151], v[124:127]
 s_waitcnt lgkmcnt(0)
M v[124:127], a[96:99], v[132:135], v[124:127]
 buffer_store_dwordx4 v[84:87], v7, s[8:11], s30 offen offset:1024 sc1
M v[64:67], a[64:67], v[128:131], v[32:35]
 s_add_u32 m0, s28, 32768
 ds_read_b128 a[96:99], v2 offset:8192
M v[64:67], a[68:71], v[144:147], v[64:67]
 ds_read_b128 a[100:103], v2 offset:9216
 s_mov_b32 s79, 104923136
M v[64:67], a[72:75], v[160:163], v[64:67]
 buffer_load_dwordx4 v3, s[8:11], s38 offen offset:0 sc1 lds
M v[64:67], a[76:79], v[176:179], v[64:67]
 ds_read_b128 a[104:107], v2 offset:10240
 s_add_u32 s29, s33, 2048
M v[64:67], a[80:83], v[192:195], v[64:67]
 ds_read_b128 a[108:111], v2 offset:11264
 s_add_u32 s30, s33, 16384
M v[64:67], a[84:87], v[208:211], v[64:67]
 buffer_load_dwordx4 v3, s[8:11], s38 offen offset:1024 sc1 lds
M v[64:67], a[88:91], v[224:227], v[64:67]
 ds_read_b128 a[112:115], v2 offset:12288
 v_mul_f32 v96, v5, v96
M v[64:67], a[92:95], v[240:243], v[64:67]
 ds_read_b128 a[116:119], v2 offset:13312
 v_mul_f32 v97, v5, v97
M v[68:71], a[92:95], v[244:247], v[36:39]
 buffer_load_dwordx4 v3, s[8:11], s38 offen offset:2048 sc1 lds
M v[68:71], a[88:91], v[228:231], v[68:71]
 ds_read_b128 a[120:123], v2 offset:14336
 v_mul_f32 v98, v5, v98
M v[68:71], a[84:87], v[212:215], v[68:71]
 ds_read_b128 a[124:127], v2 offset:15360
 v_mul_f32 v99, v5, v99
M v[68:71], a[80:83], v[196:199], v[68:71]
 buffer_load_dwordx4 v3, s[8:11], s38 offen offset:3072 sc1 lds
M v[68:71], a[76:79], v[180:183], v[68:71]
 s_add_u32 m0, s28, 36864
 v_mul_f32 v104, v5, v104
 v_mul_f32 v105, v5, v105
M v[68:71], a[72:75], v[164:167], v[68:71]
 buffer_load_dwordx4 v4, s[8:11], s38 offen offset:0 sc1 lds
M v[68:71], a[68:71], v[148:151], v[68:71]
 buffer_load_dword v24, off, s[8:11], s79 sc1
M v[68:71], a[64:67], v[132:135], v[68:71]
 s_waitcnt lgkmcnt(0)
 v_lshrrev_b32 v0, 4, v7
 v_and_b32 v14, 15, v0
M v[72:75], a[96:99], v[128:131], v[32:35]
 ds_read_b128 a[64:67], v2 offset:16384
 v_lshlrev_b32 v14, 2, v14
M v[72:75], a[100:103], v[144:147], v[72:75]
 ds_read_b128 a[68:71], v2 offset:17408
 v_lshrrev_b32 v11, 4, v0
M v[72:75], a[104:107], v[160:163], v[72:75]
 buffer_load_dwordx4 v4, s[8:11], s38 offen offset:1024 sc1 lds
M v[72:75], a[108:111], v[176:179], v[72:75]
 ds_read_b128 a[72:75], v2 offset:18432
 s_mov_b32 s52, s96
M v[72:75], a[112:115], v[192:195], v[72:75]
 s_and_b32 s53, s97, 0xffff
 ds_read_b128 a[76:79], v2 offset:19456
 s_mov_b32 s54, 1835008
M v[72:75], a[116:119], v[208:211], v[72:75]
 buffer_load_dwordx4 v4, s[8:11], s38 offen offset:2048 sc1 lds
M v[72:75], a[120:123], v[224:227], v[72:75]
 ds_read_b128 a[80:83], v2 offset:20480
 s_mov_b32 s55, 0x20000
M v[72:75], a[124:127], v[240:243], v[72:75]
 s_lshr_b32 s74, s41, 3
 ds_read_b128 a[84:87], v2 offset:21504
 s_xor_b32 s74, s74, 0
M v[76:79], a[124:127], v[244:247], v[36:39]
 buffer_load_dwordx4 v4, s[8:11], s38 offen offset:3072 sc1 lds
M v[76:79], a[120:123], v[228:231], v[76:79]
 s_add_u32 s38, s38, 32768
 ds_read_b128 a[88:91], v2 offset:22528
 s_mul_i32 s67, s74, -2
M v[76:79], a[116:119], v[212:215], v[76:79]
 s_mul_i32 s74, s74, 8
 ds_read_b128 a[92:95], v2 offset:23552
 v_mul_f32 v106, v5, v106
M v[76:79], a[112:115], v[196:199], v[76:79]
 s_add_u32 s74, s74, s20
 v_mul_f32 v107, v5, v107
 v_cvt_pk_bf16_f32 v96, v96, v97
M v[76:79], a[108:111], v[180:183], v[76:79]
 s_lshl_b32 s75, s74, 6
 v_cvt_pk_bf16_f32 v97, v98, v99
 v_cvt_pk_bf16_f32 v98, v104, v105
M v[76:79], a[104:107], v[164:167], v[76:79]
 s_add_u32 s76, s75, 256
 v_cvt_pk_bf16_f32 v99, v106, v107
M v[76:79], a[100:103], v[148:151], v[76:79]
 s_add_u32 s67, s67, 3
 v_add_u32 v43, 0x20000, v7
 s_sub_u32 s67, s67, s20
M v[76:79], a[96:99], v[132:135], v[76:79]
 s_waitcnt lgkmcnt(0)
 s_and_b32 s67, s67, 536870912
M v[80:83], a[64:67], v[128:131], v[32:35]
 s_or_b32 s76, s76, s67
 ds_read_b128 a[96:99], v2 offset:24576
 v_or_b32 v27, s67, v7
M v[80:83], a[68:71], v[144:147], v[80:83]
 ds_read_b128 a[100:103], v2 offset:25600
 v_add_u32 v27, 4096, v27
M v[80:83], a[72:75], v[160:163], v[80:83]
 buffer_store_dwordx4 v[96:99], v7, s[8:11], s29 offen offset:0 sc1
M v[80:83], a[76:79], v[176:179], v[80:83]
 ds_read_b128 a[104:107], v2 offset:26624
 v_mul_f32 v100, v6, v100
M v[80:83], a[80:83], v[192:195], v[80:83]
 ds_read_b128 a[108:111], v2 offset:27648
 v_mul_f32 v101, v6, v101
M v[80:83], a[84:87], v[208:211], v[80:83]
 v_mul_f32 v102, v6, v102
 v_mul_f32 v103, v6, v103
M v[80:83], a[88:91], v[224:227], v[80:83]
 ds_read_b128 a[112:115], v2 offset:28672
 v_mul_f32 v108, v6, v108
M v[80:83], a[92:95], v[240:243], v[80:83]
 ds_read_b128 a[116:119], v2 offset:29696
 v_mul_f32 v109, v6, v109
M v[84:87], a[92:95], v[244:247], v[36:39]
 v_mul_f32 v110, v6, v110
 v_mul_f32 v111, v6, v111
M v[84:87], a[88:91], v[228:231], v[84:87]
 ds_read_b128 a[120:123], v2 offset:30720
 v_cvt_pk_bf16_f32 v100, v100, v101
M v[84:87], a[84:87], v[212:215], v[84:87]
 ds_read_b128 a[124:127], v2 offset:31744
 v_cvt_pk_bf16_f32 v101, v102, v103
M v[84:87], a[80:83], v[196:199], v[84:87]
 v_cvt_pk_bf16_f32 v102, v108, v109
 v_cvt_pk_bf16_f32 v103, v110, v111
M v[84:87], a[76:79], v[180:183], v[84:87]
 buffer_store_dwordx4 v[100:103], v7, s[8:11], s30 offen offset:0 sc1
M v[84:87], a[72:75], v[164:167], v[84:87]
 v_mul_f32 v112, v5, v112
 v_mul_f32 v113, v5, v113
M v[84:87], a[68:71], v[148:151], v[84:87]
 s_waitcnt vmcnt(31) lgkmcnt(0)
 v_mul_f32 v114, v5, v114
 v_mul_f32 v115, v5, v115
M v[84:87], a[64:67], v[132:135], v[84:87]
 s_barrier
M v[88:91], a[96:99], v[128:131], v[32:35]
 ds_read_b128 a[64:67], v7 offset:0
 v_mul_f32 v120, v5, v120
M v[88:91], a[100:103], v[144:147], v[88:91]
 ds_read_b128 a[68:71], v7 offset:1024
 v_mul_f32 v121, v5, v121
M v[88:91], a[104:107], v[160:163], v[88:91]
 v_mul_f32 v122, v5, v122
 v_mul_f32 v123, v5, v123
M v[88:91], a[108:111], v[176:179], v[88:91]
 ds_read_b128 a[72:75], v7 offset:2048
 v_cvt_pk_bf16_f32 v112, v112, v113
M v[88:91], a[112:115], v[192:195], v[88:91]
 ds_read_b128 a[76:79], v7 offset:3072
 v_cvt_pk_bf16_f32 v113, v114, v115
M v[88:91], a[116:119], v[208:211], v[88:91]
 v_cvt_pk_bf16_f32 v114, v120, v121
 v_cvt_pk_bf16_f32 v115, v122, v123
M v[88:91], a[120:123], v[224:227], v[88:91]
 ds_read_b128 a[80:83], v7 offset:4096
M v[88:91], a[124:127], v[240:243], v[88:91]
 ds_read_b128 a[84:87], v7 offset:5120
M v[92:95], a[124:127], v[244:247], v[36:39]
 buffer_store_dwordx4 v[112:115], v7, s[8:11], s29 offen offset:1024 sc1
M v[92:95], a[120:123], v[228:231], v[92:95]
 ds_read_b128 a[88:91], v7 offset:6144
 v_mul_f32 v116, v6, v116
M v[92:95], a[116:119], v[212:215], v[92:95]
 ds_read_b128 a[92:95], v7 offset:7168
 v_mul_f32 v117, v6, v117
M v[92:95], a[112:115], v[196:199], v[92:95]
 v_mul_f32 v118, v6, v118
 v_mul_f32 v119, v6, v119
M v[92:95], a[108:111], v[180:183], v[92:95]
 v_mul_f32 v124, v6, v124
 v_mul_f32 v125, v6, v125
M v[92:95], a[104:107], v[164:167], v[92:95]
 v_mul_f32 v126, v6, v126
 v_mul_f32 v127, v6, v127
M v[92:95], a[100:103], v[148:151], v[92:95]
 s_waitcnt lgkmcnt(0)
 v_cvt_pk_bf16_f32 v116, v116, v117
 v_cvt_pk_bf16_f32 v117, v118, v119
M v[92:95], a[96:99], v[132:135], v[92:95]
 v_cvt_pk_bf16_f32 v118, v124, v125
 v_cvt_pk_bf16_f32 v119, v126, v127
 buffer_store_dwordx4 v[116:119], v7, s[8:11], s30 offen offset:1024 sc1
M v[96:99], a[64:67], v[128:131], v[32:35]
 ds_read_b128 a[96:99], v7 offset:8192
M v[96:99], a[68:71], v[144:147], v[96:99]
 ds_read_b128 a[100:103], v7 offset:9216
M v[96:99], a[72:75], v[160:163], v[96:99]
 s_sub_u32 s64, 15, s42
M v[96:99], a[76:79], v[176:179], v[96:99]
 s_min_u32 s64, s64, s42
 ds_read_b128 a[104:107], v7 offset:10240
 s_add_u32 s29, s33, 4096
M v[96:99], a[80:83], v[192:195], v[96:99]
 s_mul_i32 s45, s64, 8704
 ds_read_b128 a[108:111], v7 offset:11264
 s_add_u32 s30, s33, 18432
M v[96:99], a[84:87], v[208:211], v[96:99]
 s_lshl_b32 s64, s20, 6
 v_fma_f32 v64, v64, v5, v28
 v_fma_f32 v65, v65, v5, v28
M v[96:99], a[88:91], v[224:227], v[96:99]
 s_add_u32 s64, s64, s41
 ds_read_b128 a[112:115], v7 offset:12288
 v_fma_f32 v66, v66, v5, v28
M v[96:99], a[92:95], v[240:243], v[96:99]
 s_lshl2_add_u32 s45, s64, s45
 ds_read_b128 a[116:119], v7 offset:13312
 v_fma_f32 v67, v67, v5, v28
M v[100:103], a[92:95], v[244:247], v[36:39]
 s_add_u32 s45, s45, 104992768
 v_fma_f32 v72, v72, v5, v28
M v[100:103], a[88:91], v[228:231], v[100:103]
 s_movk_i32 s65, 1024
 ds_read_b128 a[120:123], v7 offset:14336
 v_fma_f32 v73, v73, v5, v28
M v[100:103], a[84:87], v[212:215], v[100:103]
 s_cmp_lt_u32 s42, 8
 ds_read_b128 a[124:127], v7 offset:15360
 v_fma_f32 v74, v74, v5, v28
M v[100:103], a[80:83], v[196:199], v[100:103]
 s_cselect_b32 s64, 4352, s65
 v_fma_f32 v75, v75, v5, v28
M v[100:103], a[76:79], v[180:183], v[100:103]
 s_cselect_b32 s65, 0, 64
 v_cvt_pk_bf16_f32 v64, v64, v65
M v[100:103], a[72:75], v[164:167], v[100:103]
 s_cselect_b32 s66, 32, 64
 v_cvt_pk_bf16_f32 v65, v66, v67
M v[100:103], a[68:71], v[148:151], v[100:103]
 s_add_u32 s3, s45, s64
 s_add_u32 s45, s45, s65
 v_lshrrev_b32 v42, 5, v7
M v[100:103], a[64:67], v[132:135], v[100:103]
 s_waitcnt lgkmcnt(0)
 v_mul_u32_u24 v42, 4352, v42
 v_and_b32 v41, 16, v7
M v[104:107], a[96:99], v[128:131], v[32:35]
 ds_read_b128 a[64:67], v7 offset:16384
 v_lshl_add_u32 v41, v41, 3, v42
M v[104:107], a[100:103], v[144:147], v[104:107]
 ds_read_b128 a[68:71], v7 offset:17408
 v_mov_b32 v42, 536870912
M v[104:107], a[104:107], v[160:163], v[104:107]
 v_cmp_gt_u32 vcc, s66, v7
 v_mov_b32 v40, 1
M v[104:107], a[108:111], v[176:179], v[104:107]
 s_nop 0
 ds_read_b128 a[72:75], v7 offset:18432
 v_cndmask_b32 v41, v42, v41, vcc
M v[104:107], a[112:115], v[192:195], v[104:107]
 ds_read_b128 a[76:79], v7 offset:19456
 v_cvt_pk_bf16_f32 v66, v72, v73
M v[104:107], a[116:119], v[208:211], v[104:107]
 v_cvt_pk_bf16_f32 v67, v74, v75
M v[104:107], a[120:123], v[224:227], v[104:107]
 ds_read_b128 a[80:83], v7 offset:20480
M v[104:107], a[124:127], v[240:243], v[104:107]
 ds_read_b128 a[84:87], v7 offset:21504
M v[108:111], a[124:127], v[244:247], v[36:39]
 buffer_store_dwordx4 v[64:67], v7, s[8:11], s29 offen offset:0 sc1
M v[108:111], a[120:123], v[228:231], v[108:111]
 ds_read_b128 a[88:91], v7 offset:22528
 v_fma_f32 v68, v68, v6, v29
M v[108:111], a[116:119], v[212:215], v[108:111]
 ds_read_b128 a[92:95], v7 offset:23552
 v_fma_f32 v69, v69, v6, v29
M v[108:111], a[112:115], v[196:199], v[108:111]
 v_fma_f32 v70, v70, v6, v29
 v_fma_f32 v71, v71, v6, v29
M v[108:111], a[108:111], v[180:183], v[108:111]
 v_fma_f32 v76, v76, v6, v29
 v_fma_f32 v77, v77, v6, v29
M v[108:111], a[104:107], v[164:167], v[108:111]
 v_fma_f32 v78, v78, v6, v29
 v_fma_f32 v79, v79, v6, v29
M v[108:111], a[100:103], v[148:151], v[108:111]
 v_cvt_pk_bf16_f32 v68, v68, v69
 v_cvt_pk_bf16_f32 v69, v70, v71
M v[108:111], a[96:99], v[132:135], v[108:111]
 s_waitcnt lgkmcnt(0)
 v_cvt_pk_bf16_f32 v70, v76, v77
 v_cvt_pk_bf16_f32 v71, v78, v79
M v[112:115], a[64:67], v[128:131], v[32:35]
 ds_read_b128 a[96:99], v7 offset:24576
M v[112:115], a[68:71], v[144:147], v[112:115]
 ds_read_b128 a[100:103], v7 offset:25600
M v[112:115], a[72:75], v[160:163], v[112:115]
 buffer_store_dwordx4 v[68:71], v7, s[8:11], s30 offen offset:0 sc1
M v[112:115], a[76:79], v[176:179], v[112:115]
 ds_read_b128 a[104:107], v7 offset:26624
 v_fma_f32 v80, v80, v5, v28
M v[112:115], a[80:83], v[192:195], v[112:115]
 ds_read_b128 a[108:111], v7 offset:27648
 v_fma_f32 v81, v81, v5, v28
M v[112:115], a[84:87], v[208:211], v[112:115]
 v_fma_f32 v82, v82, v5, v28
 v_fma_f32 v83, v83, v5, v28
M v[112:115], a[88:91], v[224:227], v[112:115]
 ds_read_b128 a[112:115], v7 offset:28672
 v_fma_f32 v88, v88, v5, v28
M v[112:115], a[92:95], v[240:243], v[112:115]
 ds_read_b128 a[116:119], v7 offset:29696
 v_fma_f32 v89, v89, v5, v28
M v[116:119], a[92:95], v[244:247], v[36:39]
 v_fma_f32 v90, v90, v5, v28
 v_fma_f32 v91, v91, v5, v28
M v[116:119], a[88:91], v[228:231], v[116:119]
 ds_read_b128 a[120:123], v7 offset:30720
 v_cvt_pk_bf16_f32 v80, v80, v81
M v[116:119], a[84:87], v[212:215], v[116:119]
 ds_read_b128 a[124:127], v7 offset:31744
 v_cvt_pk_bf16_f32 v81, v82, v83
M v[116:119], a[80:83], v[196:199], v[116:119]
 v_cvt_pk_bf16_f32 v82, v88, v89
 v_cvt_pk_bf16_f32 v83, v90, v91
M v[116:119], a[76:79], v[180:183], v[116:119]
 buffer_store_dwordx4 v[80:83], v7, s[8:11], s29 offen offset:1024 sc1
M v[116:119], a[72:75], v[164:167], v[116:119]
 v_fma_f32 v84, v84, v6, v29
 v_fma_f32 v85, v85, v6, v29
M v[116:119], a[68:71], v[148:151], v[116:119]
 s_waitcnt vmcnt(28) lgkmcnt(0)
 v_fma_f32 v86, v86, v6, v29
M v[116:119], a[64:67], v[132:135], v[116:119]
 s_barrier
M v[120:123], a[96:99], v[128:131], v[32:35]
 ds_read_b128 a[64:67], v43 offset:0
 v_fma_f32 v87, v87, v6, v29
M v[120:123], a[100:103], v[144:147], v[120:123]
 ds_read_b128 a[68:71], v43 offset:1024
 v_fma_f32 v92, v92, v6, v29
M v[120:123], a[104:107], v[160:163], v[120:123]
 v_fma_f32 v93, v93, v6, v29
 v_fma_f32 v94, v94, v6, v29
M v[120:123], a[108:111], v[176:179], v[120:123]
 ds_read_b128 a[72:75], v43 offset:2048
 v_fma_f32 v95, v95, v6, v29
M v[120:123], a[112:115], v[192:195], v[120:123]
 ds_read_b128 a[76:79], v43 offset:3072
 v_cvt_pk_bf16_f32 v84, v84, v85
M v[120:123], a[116:119], v[208:211], v[120:123]
 v_cvt_pk_bf16_f32 v85, v86, v87
M v[120:123], a[120:123], v[224:227], v[120:123]
 ds_read_b128 a[80:83], v43 offset:4096
 v_cvt_pk_bf16_f32 v86, v92, v93
M v[120:123], a[124:127], v[240:243], v[120:123]
 ds_read_b128 a[84:87], v43 offset:5120
 v_cvt_pk_bf16_f32 v87, v94, v95
M v[124:127], a[124:127], v[244:247], v[36:39]
 buffer_store_dwordx4 v[84:87], v7, s[8:11], s30 offen offset:1024 sc1
M v[124:127], a[120:123], v[228:231], v[124:127]
 ds_read_b128 a[88:91], v43 offset:6144
M v[124:127], a[116:119], v[212:215], v[124:127]
 ds_read_b128 a[92:95], v43 offset:7168
M v[124:127], a[112:115], v[196:199], v[124:127]
M v[124:127], a[108:111], v[180:183], v[124:127]
M v[124:127], a[104:107], v[164:167], v[124:127]
M v[124:127], a[100:103], v[148:151], v[124:127]
 s_waitcnt lgkmcnt(0)
 s_cmp_eq_u32 s42, 6
M v[124:127], a[96:99], v[132:135], v[124:127]
 s_cbranch_scc1 L_y2
L_y2r:
M v[64:67], a[64:67], v[128:131], v[32:35]
 ds_read_b128 a[96:99], v43 offset:8192
M v[64:67], a[68:71], v[144:147], v[64:67]
 ds_read_b128 a[100:103], v43 offset:9216
M v[64:67], a[72:75], v[160:163], v[64:67]
 s_waitcnt vmcnt(11)
 v_cmp_gt_u32 vcc, 1, v24
M v[64:67], a[76:79], v[176:179], v[64:67]
 s_mov_b32 s65, 104890368
 ds_read_b128 a[104:107], v43 offset:10240
 s_add_u32 s29, s33, 6144
M v[64:67], a[80:83], v[192:195], v[64:67]
 s_cbranch_vccnz L_fhs1
L_fhr1:
 ds_read_b128 a[108:111], v43 offset:11264
 s_add_u32 s30, s33, 20480
M v[64:67], a[84:87], v[208:211], v[64:67]
 buffer_load_dword v25, v14, s[8:11], s65 offen sc1
M v[64:67], a[88:91], v[224:227], v[64:67]
 ds_read_b128 a[112:115], v43 offset:12288
 v_fma_f32 v96, v96, v5, v28
M v[64:67], a[92:95], v[240:243], v[64:67]
 ds_read_b128 a[116:119], v43 offset:13312
 v_fma_f32 v97, v97, v5, v28
M v[68:71], a[92:95], v[244:247], v[36:39]
 v_fma_f32 v98, v98, v5, v28
 v_fma_f32 v99, v99, v5, v28
M v[68:71], a[88:91], v[228:231], v[68:71]
 ds_read_b128 a[120:123], v43 offset:14336
 v_fma_f32 v104, v104, v5, v28
M v[68:71], a[84:87], v[212:215], v[68:71]
 ds_read_b128 a[124:127], v43 offset:15360
 v_fma_f32 v105, v105, v5, v28
M v[68:71], a[80:83], v[196:199], v[68:71]
 v_fma_f32 v106, v106, v5, v28
 v_fma_f32 v107, v107, v5, v28
M v[68:71], a[76:79], v[180:183], v[68:71]
 v_cvt_pk_bf16_f32 v96, v96, v97
M v[68:71], a[72:75], v[164:167], v[68:71]
 v_cvt_pk_bf16_f32 v97, v98, v99
M v[68:71], a[68:71], v[148:151], v[68:71]
 v_cvt_pk_bf16_f32 v98, v104, v105
M v[68:71], a[64:67], v[132:135], v[68:71]
 s_waitcnt lgkmcnt(0)
 v_cvt_pk_bf16_f32 v99, v106, v107
M v[72:75], a[96:99], v[128:131], v[32:35]
 ds_read_b128 a[64:67], v43 offset:16384
M v[72:75], a[100:103], v[144:147], v[72:75]
 ds_read_b128 a[68:71], v43 offset:17408
M v[72:75], a[104:107], v[160:163], v[72:75]
 buffer_store_dwordx4 v[96:99], v7, s[8:11], s29 offen offset:0 sc1
M v[72:75], a[108:111], v[176:179], v[72:75]
 ds_read_b128 a[72:75], v43 offset:18432
 v_fma_f32 v100, v100, v6, v29
M v[72:75], a[112:115], v[192:195], v[72:75]
 ds_read_b128 a[76:79], v43 offset:19456
 v_fma_f32 v101, v101, v6, v29
M v[72:75], a[116:119], v[208:211], v[72:75]
 v_fma_f32 v102, v102, v6, v29
 v_fma_f32 v103, v103, v6, v29
M v[72:75], a[120:123], v[224:227], v[72:75]
 ds_read_b128 a[80:83], v43 offset:20480
 v_fma_f32 v108, v108, v6, v29
M v[72:75], a[124:127], v[240:243], v[72:75]
 ds_read_b128 a[84:87], v43 offset:21504
 v_fma_f32 v109, v109, v6, v29
M v[76:79], a[124:127], v[244:247], v[36:39]
 v_fma_f32 v110, v110, v6, v29
 v_fma_f32 v111, v111, v6, v29
M v[76:79], a[120:123], v[228:231], v[76:79]
 ds_read_b128 a[88:91], v43 offset:22528
 v_cvt_pk_bf16_f32 v100, v100, v101
M v[76:79], a[116:119], v[212:215], v[76:79]
 ds_read_b128 a[92:95], v43 offset:23552
 v_cvt_pk_bf16_f32 v101, v102, v103
M v[76:79], a[112:115], v[196:199], v[76:79]
 v_cvt_pk_bf16_f32 v102, v108, v109
M v[76:79], a[108:111], v[180:183], v[76:79]
 v_cvt_pk_bf16_f32 v103, v110, v111
M v[76:79], a[104:107], v[164:167], v[76:79]
 buffer_store_dwordx4 v[100:103], v7, s[8:11], s30 offen offset:0 sc1
M v[76:79], a[100:103], v[148:151], v[76:79]
M v[76:79], a[96:99], v[132:135], v[76:79]
 s_waitcnt lgkmcnt(0)
 v_fma_f32 v112, v112, v5, v28
M v[80:83], a[64:67], v[128:131], v[32:35]
 ds_read_b128 a[96:99], v43 offset:24576
 v_fma_f32 v113, v113, v5, v28
M v[80:83], a[68:71], v[144:147], v[80:83]
 ds_read_b128 a[100:103], v43 offset:25600
 v_fma_f32 v114, v114, v5, v28
M v[80:83], a[72:75], v[160:163], v[80:83]
 v_fma_f32 v115, v115, v5, v28
M v[80:83], a[76:79], v[176:179], v[80:83]
 ds_read_b128 a[104:107], v43 offset:26624
 v_fma_f32 v120, v120, v5, v28
M v[80:83], a[80:83], v[192:195], v[80:83]
 ds_read_b128 a[108:111], v43 offset:27648
 v_fma_f32 v121, v121, v5, v28
M v[80:83], a[84:87], v[208:211], v[80:83]
 v_fma_f32 v122, v122, v5, v28
M v[80:83], a[88:91], v[224:227], v[80:83]
 ds_read_b128 a[112:115], v43 offset:28672
 v_fma_f32 v123, v123, v5, v28
M v[80:83], a[92:95], v[240:243], v[80:83]
 ds_read_b128 a[116:119], v43 offset:29696
 v_cvt_pk_bf16_f32 v112, v112, v113
M v[84:87], a[92:95], v[244:247], v[36:39]
 v_cvt_pk_bf16_f32 v113, v114, v115
 v_cvt_pk_bf16_f32 v114, v120, v121
M v[84:87], a[88:91], v[228:231], v[84:87]
 ds_read_b128 a[120:123], v43 offset:30720
 v_cvt_pk_bf16_f32 v115, v122, v123
M v[84:87], a[84:87], v[212:215], v[84:87]
 ds_read_b128 a[124:127], v43 offset:31744
M v[84:87], a[80:83], v[196:199], v[84:87]
 buffer_store_dwordx4 v[112:115], v7, s[8:11], s29 offen offset:1024 sc1
M v[84:87], a[76:79], v[180:183], v[84:87]
 v_fma_f32 v116, v116, v6, v29
M v[84:87], a[72:75], v[164:167], v[84:87]
 v_fma_f32 v117, v117, v6, v29
M v[84:87], a[68:71], v[148:151], v[84:87]
 s_waitcnt lgkmcnt(0)
 v_fma_f32 v118, v118, v6, v29
M v[84:87], a[64:67], v[132:135], v[84:87]
 s_barrier
M v[88:91], a[96:99], v[128:131], v[32:35]
 ds_read_b128 a[64:67], v2 offset:32768
 v_fma_f32 v119, v119, v6, v29
M v[88:91], a[100:103], v[144:147], v[88:91]
 ds_read_b128 a[68:71], v2 offset:33792
 v_fma_f32 v124, v124, v6, v29
M v[88:91], a[104:107], v[160:163], v[88:91]
 v_fma_f32 v125, v125, v6, v29
 v_fma_f32 v126, v126, v6, v29
M v[88:91], a[108:111], v[176:179], v[88:91]
 ds_read_b128 a[72:75], v2 offset:34816
 v_fma_f32 v127, v127, v6, v29
M v[88:91], a[112:115], v[192:195], v[88:91]
 ds_read_b128 a[76:79], v2 offset:35840
 v_cvt_pk_bf16_f32 v116, v116, v117
M v[88:91], a[116:119], v[208:211], v[88:91]
 v_cvt_pk_bf16_f32 v117, v118, v119
M v[88:91], a[120:123], v[224:227], v[88:91]
 ds_read_b128 a[80:83], v2 offset:36864
 v_cvt_pk_bf16_f32 v118, v124, v125
M v[88:91], a[124:127], v[240:243], v[88:91]
 ds_read_b128 a[84:87], v2 offset:37888
 v_cvt_pk_bf16_f32 v119, v126, v127
M v[92:95], a[124:127], v[244:247], v[36:39]
 buffer_store_dwordx4 v[116:119], v7, s[8:11], s30 offen offset:1024 sc1
M v[92:95], a[120:123], v[228:231], v[92:95]
 ds_read_b128 a[88:91], v2 offset:38912
M v[92:95], a[116:119], v[212:215], v[92:95]
 ds_read_b128 a[92:95], v2 offset:39936
M v[92:95], a[112:115], v[196:199], v[92:95]
M v[92:95], a[108:111], v[180:183], v[92:95]
M v[92:95], a[104:107], v[164:167], v[92:95]
M v[92:95], a[100:103], v[148:151], v[92:95]
 s_waitcnt lgkmcnt(0)
M v[92:95], a[96:99], v[132:135], v[92:95]
M v[96:99], a[64:67], v[128:131], v[32:35]
 ds_read_b128 a[96:99], v2 offset:40960
M v[96:99], a[68:71], v[144:147], v[96:99]
 ds_read_b128 a[100:103], v2 offset:41984
M v[96:99], a[72:75], v[160:163], v[96:99]
M v[96:99], a[76:79], v[176:179], v[96:99]
 ds_read_b128 a[104:107], v2 offset:43008
 s_add_u32 s29, s33, 8192
M v[96:99], a[80:83], v[192:195], v[96:99]
 ds_read_b128 a[108:111], v2 offset:44032
 s_add_u32 s30, s33, 22528
M v[96:99], a[84:87], v[208:211], v[96:99]
 v_fma_f32 v64, v64, v5, v28
 v_fma_f32 v65, v65, v5, v28
M v[96:99], a[88:91], v[224:227], v[96:99]
 ds_read_b128 a[112:115], v2 offset:45056
 v_fma_f32 v66, v66, v5, v28
M v[96:99], a[92:95], v[240:243], v[96:99]
 ds_read_b128 a[116:119], v2 offset:46080
 v_fma_f32 v67, v67, v5, v28
M v[100:103], a[92:95], v[244:247], v[36:39]
 v_fma_f32 v72, v72, v5, v28
M v[100:103], a[88:91], v[228:231], v[100:103]
 ds_read_b128 a[120:123], v2 offset:47104
 v_fma_f32 v73, v73, v5, v28
M v[100:103], a[84:87], v[212:215], v[100:103]
 ds_read_b128 a[124:127], v2 offset:48128
 v_fma_f32 v74, v74, v5, v28
M v[100:103], a[80:83], v[196:199], v[100:103]
 v_fma_f32 v75, v75, v5, v28
M v[100:103], a[76:79], v[180:183], v[100:103]
 v_cvt_pk_bf16_f32 v64, v64, v65
M v[100:103], a[72:75], v[164:167], v[100:103]
 v_cvt_pk_bf16_f32 v65, v66, v67
M v[100:103], a[68:71], v[148:151], v[100:103]
 v_cvt_pk_bf16_f32 v66, v72, v73
M v[100:103], a[64:67], v[132:135], v[100:103]
 s_waitcnt lgkmcnt(0)
 v_cvt_pk_bf16_f32 v67, v74, v75
M v[104:107], a[96:99], v[128:131], v[32:35]
 ds_read_b128 a[64:67], v2 offset:49152
M v[104:107], a[100:103], v[144:147], v[104:107]
 ds_read_b128 a[68:71], v2 offset:50176
M v[104:107], a[104:107], v[160:163], v[104:107]
 buffer_store_dwordx4 v[64:67], v7, s[8:11], s29 offen offset:0 sc1
M v[104:107], a[108:111], v[176:179], v[104:107]
 ds_read_b128 a[72:75], v2 offset:51200
 v_fma_f32 v68, v68, v6, v29
M v[104:107], a[112:115], v[192:195], v[104:107]
 ds_read_b128 a[76:79], v2 offset:52224
 v_fma_f32 v69, v69, v6, v29
M v[104:107], a[116:119], v[208:211], v[104:107]
 v_fma_f32 v70, v70, v6, v29
 v_fma_f32 v71, v71, v6, v29
M v[104:107], a[120:123], v[224:227], v[104:107]
 ds_read_b128 a[80:83], v2 offset:53248
 v_fma_f32 v76, v76, v6, v29
M v[104:107], a[124:127], v[240:243], v[104:107]
 ds_read_b128 a[84:87], v2 offset:54272
 v_fma_f32 v77, v77, v6, v29
M v[108:111], a[124:127], v[244:247], v[36:39]
 v_fma_f32 v78, v78, v6, v29
 v_fma_f32 v79, v79, v6, v29
M v[108:111], a[120:123], v[228:231], v[108:111]
 ds_read_b128 a[88:91], v2 offset:55296
 v_cvt_pk_bf16_f32 v68, v68, v69
M v[108:111], a[116:119], v[212:215], v[108:111]
 ds_read_b128 a[92:95], v2 offset:56320
 v_cvt_pk_bf16_f32 v69, v70, v71
M v[108:111], a[112:115], v[196:199], v[108:111]
 v_cvt_pk_bf16_f32 v70, v76, v77
M v[108:111], a[108:111], v[180:183], v[108:111]
 v_cvt_pk_bf16_f32 v71, v78, v79
M v[108:111], a[104:107], v[164:167], v[108:111]
 buffer_store_dwordx4 v[68:71], v7, s[8:11], s30 offen offset:0 sc1
M v[108:111], a[100:103], v[148:151], v[108:111]
M v[108:111], a[96:99], v[132:135], v[108:111]
 s_waitcnt lgkmcnt(0)
 v_fma_f32 v80, v80, v5, v28
M v[112:115], a[64:67], v[128:131], v[32:35]
 ds_read_b128 a[96:99], v2 offset:57344
 v_fma_f32 v81, v81, v5, v28
M v[112:115], a[68:71], v[144:147], v[112:115]
 ds_read_b128 a[100:103], v2 offset:58368
 v_fma_f32 v82, v82, v5, v28
M v[112:115], a[72:75], v[160:163], v[112:115]
 v_fma_f32 v83, v83, v5, v28
M v[112:115], a[76:79], v[176:179], v[112:115]
 ds_read_b128 a[104:107], v2 offset:59392
 v_fma_f32 v88, v88, v5, v28
M v[112:115], a[80:83], v[192:195], v[112:115]
 ds_read_b128 a[108:111], v2 offset:60416
 v_fma_f32 v89, v89, v5, v28
M v[112:115], a[84:87], v[208:211], v[112:115]
 v_fma_f32 v90, v90, v5, v28
M v[112:115], a[88:91], v[224:227], v[112:115]
 ds_read_b128 a[112:115], v2 offset:61440
 v_fma_f32 v91, v91, v5, v28
M v[112:115], a[92:95], v[240:243], v[112:115]
 ds_read_b128 a[116:119], v2 offset:62464
 v_cvt_pk_bf16_f32 v80, v80, v81
M v[116:119], a[92:95], v[244:247], v[36:39]
 s_waitcnt vmcnt(6)
 v_readlane_b32 s84, v25, 0
 v_readlane_b32 s85, v25, 1
M v[116:119], a[88:91], v[228:231], v[116:119]
 ds_read_b128 a[120:123], v2 offset:63488
 v_mov_b32 v24, 0x3f80
M v[116:119], a[84:87], v[212:215], v[116:119]
 ds_read_b128 a[124:127], v2 offset:64512
 v_mov_b32 v25, 0x3f800000
M v[116:119], a[80:83], v[196:199], v[116:119]
 v_cvt_pk_bf16_f32 v81, v82, v83
 v_cvt_pk_bf16_f32 v82, v88, v89
M v[116:119], a[76:79], v[180:183], v[116:119]
 v_cvt_pk_bf16_f32 v83, v90, v91
M v[116:119], a[72:75], v[164:167], v[116:119]
 buffer_store_dwordx4 v[80:83], v7, s[8:11], s29 offen offset:1024 sc1
M v[116:119], a[68:71], v[148:151], v[116:119]
 s_waitcnt lgkmcnt(0)
 v_fma_f32 v84, v84, v6, v29
 v_fma_f32 v85, v85, v6, v29
M v[116:119], a[64:67], v[132:135], v[116:119]
 s_barrier
M v[120:123], a[96:99], v[128:131], v[32:35]
 ds_read_b128 a[64:67], v7 offset:32768
 v_fma_f32 v86, v86, v6, v29
M v[120:123], a[100:103], v[144:147], v[120:123]
 ds_read_b128 a[68:71], v7 offset:33792
 v_fma_f32 v87, v87, v6, v29
M v[120:123], a[104:107], v[160:163], v[120:123]
 v_fma_f32 v92, v92, v6, v29
 v_fma_f32 v93, v93, v6, v29
M v[120:123], a[108:111], v[176:179], v[120:123]
 ds_read_b128 a[72:75], v7 offset:34816
 v_fma_f32 v94, v94, v6, v29
M v[120:123], a[112:115], v[192:195], v[120:123]
 ds_read_b128 a[76:79], v7 offset:35840
 v_fma_f32 v95, v95, v6, v29
M v[120:123], a[116:119], v[208:211], v[120:123]
 s_waitcnt vmcnt(3)
 v_cvt_pk_bf16_f32 v84, v84, v85
 v_cvt_pk_bf16_f32 v85, v86, v87
M v[120:123], a[120:123], v[224:227], v[120:123]
 ds_read_b128 a[80:83], v7 offset:36864
 v_cvt_pk_bf16_f32 v86, v92, v93
M v[120:123], a[124:127], v[240:243], v[120:123]
 ds_read_b128 a[84:87], v7 offset:37888
 v_cvt_pk_bf16_f32 v87, v94, v95
M v[124:127], a[124:127], v[244:247], v[36:39]
 buffer_store_dword v40, v41, s[8:11], s45 offen sc1
M v[124:127], a[120:123], v[228:231], v[124:127]
 ds_read_b128 a[88:91], v7 offset:38912
M v[124:127], a[116:119], v[212:215], v[124:127]
 ds_read_b128 a[92:95], v7 offset:39936
M v[124:127], a[112:115], v[196:199], v[124:127]
 buffer_store_dwordx4 v[84:87], v7, s[8:11], s30 offen offset:1024 sc1
M v[124:127], a[108:111], v[180:183], v[124:127]
M v[124:127], a[104:107], v[164:167], v[124:127]
M v[124:127], a[100:103], v[148:151], v[124:127]
 s_waitcnt lgkmcnt(0)
 s_cmp_eq_u32 s42, 6
M v[124:127], a[96:99], v[132:135], v[124:127]
 s_cbranch_scc1 L_y3
L_y3r:
M v[64:67], a[64:67], v[128:131], v[32:35]
 ds_read_b128 a[96:99], v7 offset:40960
M v[64:67], a[68:71], v[144:147], v[64:67]
 ds_read_b128 a[100:103], v7 offset:41984
M v[64:67], a[72:75], v[160:163], v[64:67]
M v[64:67], a[76:79], v[176:179], v[64:67]
 ds_read_b128 a[104:107], v7 offset:43008
 s_add_u32 s29, s33, 10240
M v[64:67], a[80:83], v[192:195], v[64:67]
 ds_read_b128 a[108:111], v7 offset:44032
 s_add_u32 s30, s33, 24576
M v[64:67], a[84:87], v[208:211], v[64:67]
 v_fma_f32 v96, v96, v5, v28
 v_fma_f32 v97, v97, v5, v28
M v[64:67], a[88:91], v[224:227], v[64:67]
 ds_read_b128 a[112:115], v7 offset:45056
 v_fma_f32 v98, v98, v5, v28
M v[64:67], a[92:95], v[240:243], v[64:67]
 ds_read_b128 a[116:119], v7 offset:46080
 v_fma_f32 v99, v99, v5, v28
M v[68:71], a[92:95], v[244:247], v[36:39]
 v_fma_f32 v104, v104, v5, v28
 v_fma_f32 v105, v105, v5, v28
M v[68:71], a[88:91], v[228:231], v[68:71]
 ds_read_b128 a[120:123], v7 offset:47104
 v_fma_f32 v106, v106, v5, v28
M v[68:71], a[84:87], v[212:215], v[68:71]
 ds_read_b128 a[124:127], v7 offset:48128
 v_fma_f32 v107, v107, v5, v28
M v[68:71], a[80:83], v[196:199], v[68:71]
 v_cvt_pk_bf16_f32 v96, v96, v97
 v_cvt_pk_bf16_f32 v97, v98, v99
M v[68:71], a[76:79], v[180:183], v[68:71]
 v_cvt_pk_bf16_f32 v98, v104, v105
 v_cvt_pk_bf16_f32 v99, v106, v107
M v[68:71], a[72:75], v[164:167], v[68:71]
 buffer_store_dwordx4 v[96:99], v7, s[8:11], s29 offen offset:0 sc1
M v[68:71], a[68:71], v[148:151], v[68:71]
 v_fma_f32 v100, v100, v6, v29
 v_fma_f32 v101, v101, v6, v29
M v[68:71], a[64:67], v[132:135], v[68:71]
 s_waitcnt lgkmcnt(0)
 v_fma_f32 v102, v102, v6, v29
 v_fma_f32 v103, v103, v6, v29
M v[72:75], a[96:99], v[128:131], v[32:35]
 ds_read_b128 a[64:67], v7 offset:49152
 v_fma_f32 v108, v108, v6, v29
M v[72:75], a[100:103], v[144:147], v[72:75]
 ds_read_b128 a[68:71], v7 offset:50176
 v_fma_f32 v109, v109, v6, v29
M v[72:75], a[104:107], v[160:163], v[72:75]
 v_fma_f32 v110, v110, v6, v29
 v_fma_f32 v111, v111, v6, v29
M v[72:75], a[108:111], v[176:179], v[72:75]
 ds_read_b128 a[72:75], v7 offset:51200
 v_cvt_pk_bf16_f32 v100, v100, v101
M v[72:75], a[112:115], v[192:195], v[72:75]
 ds_read_b128 a[76:79], v7 offset:52224
 v_cvt_pk_bf16_f32 v101, v102, v103
M v[72:75], a[116:119], v[208:211], v[72:75]
 v_cvt_pk_bf16_f32 v102, v108, v109
 v_cvt_pk_bf16_f32 v103, v110, v111
M v[72:75], a[120:123], v[224:227], v[72:75]
 ds_read_b128 a[80:83], v7 offset:53248
M v[72:75], a[124:127], v[240:243], v[72:75]
 ds_read_b128 a[84:87], v7 offset:54272
M v[76:79], a[124:127], v[244:247], v[36:39]
 buffer_store_dwordx4 v[100:103], v7, s[8:11], s30 offen offset:0 sc1
M v[76:79], a[120:123], v[228:231], v[76:79]
 ds_read_b128 a[88:91], v7 offset:55296
 v_fma_f32 v112, v112, v5, v28
M v[76:79], a[116:119], v[212:215], v[76:79]
 ds_read_b128 a[92:95], v7 offset:56320
 v_fma_f32 v113, v113, v5, v28
M v[76:79], a[112:115], v[196:199], v[76:79]
 v_fma_f32 v114, v114, v5, v28
 v_fma_f32 v115, v115, v5, v28
M v[76:79], a[108:111], v[180:183], v[76:79]
 v_fma_f32 v120, v120, v5, v28
 v_fma_f32 v121, v121, v5, v28
M v[76:79], a[104:107], v[164:167], v[76:79]
 v_fma_f32 v122, v122, v5, v28
 v_fma_f32 v123, v123, v5, v28
M v[76:79], a[100:103], v[148:151], v[76:79]
 v_cvt_pk_bf16_f32 v112, v112, v113
 v_cvt_pk_bf16_f32 v113, v114, v115
M v[76:79], a[96:99], v[132:135], v[76:79]
 s_waitcnt lgkmcnt(0)
 v_cvt_pk_bf16_f32 v114, v120, v121
 v_cvt_pk_bf16_f32 v115, v122, v123
M v[80:83], a[64:67], v[128:131], v[32:35]
 ds_read_b128 a[96:99], v7 offset:57344
M v[80:83], a[68:71], v[144:147], v[80:83]
 ds_read_b128 a[100:103], v7 offset:58368
M v[80:83], a[72:75], v[160:163], v[80:83]
 buffer_store_dwordx4 v[112:115], v7, s[8:11], s29 offen offset:1024 sc1
M v[80:83], a[76:79], v[176:179], v[80:83]
 ds_read_b128 a[104:107], v7 offset:59392
 v_fma_f32 v116, v116, v6, v29
M v[80:83], a[80:83], v[192:195], v[80:83]
 ds_read_b128 a[108:111], v7 offset:60416
 v_fma_f32 v117, v117, v6, v29
M v[80:83], a[84:87], v[208:211], v[80:83]
 v_fma_f32 v118, v118, v6, v29
 v_fma_f32 v119, v119, v6, v29
M v[80:83], a[88:91], v[224:227], v[80:83]
 ds_read_b128 a[112:115], v7 offset:61440
 v_fma_f32 v124, v124, v6, v29
M v[80:83], a[92:95], v[240:243], v[80:83]
 ds_read_b128 a[116:119], v7 offset:62464
 v_fma_f32 v125, v125, v6, v29
M v[84:87], a[92:95], v[244:247], v[36:39]
 v_fma_f32 v126, v126, v6, v29
 v_fma_f32 v127, v127, v6, v29
M v[84:87], a[88:91], v[228:231], v[84:87]
 ds_read_b128 a[120:123], v7 offset:63488
 v_cvt_pk_bf16_f32 v116, v116, v117
M v[84:87], a[84:87], v[212:215], v[84:87]
 ds_read_b128 a[124:127], v7 offset:64512
 v_cvt_pk_bf16_f32 v117, v118, v119
M v[84:87], a[80:83], v[196:199], v[84:87]
 v_cvt_pk_bf16_f32 v118, v124, v125
 v_cvt_pk_bf16_f32 v119, v126, v127
M v[84:87], a[76:79], v[180:183], v[84:87]
 buffer_store_dwordx4 v[116:119], v7, s[8:11], s30 offen offset:1024 sc1
M v[84:87], a[72:75], v[164:167], v[84:87]
 s_add_u32 s29, s33, 12288
M v[84:87], a[68:71], v[148:151], v[84:87]
 s_add_u32 s30, s33, 26624
 v_fma_f32 v64, v64, v5, v28
 v_fma_f32 v65, v65, v5, v28
M v[84:87], a[64:67], v[132:135], v[84:87]
 s_waitcnt lgkmcnt(0)
 v_fma_f32 v66, v66, v5, v28
 v_fma_f32 v67, v67, v5, v28
M v[88:91], a[96:99], v[128:131], v[32:35]
 v_fma_f32 v72, v72, v5, v28
 v_fma_f32 v73, v73, v5, v28
M v[88:91], a[100:103], v[144:147], v[88:91]
 v_fma_f32 v74, v74, v5, v28
 v_fma_f32 v75, v75, v5, v28
M v[88:91], a[104:107], v[160:163], v[88:91]
 v_cvt_pk_bf16_f32 v64, v64, v65
 v_cvt_pk_bf16_f32 v65, v66, v67
M v[88:91], a[108:111], v[176:179], v[88:91]
 v_cvt_pk_bf16_f32 v66, v72, v73
 v_cvt_pk_bf16_f32 v67, v74, v75
M v[88:91], a[112:115], v[192:195], v[88:91]
 buffer_store_dwordx4 v[64:67], v7, s[8:11], s29 offen offset:0 sc1
M v[88:91], a[116:119], v[208:211], v[88:91]
 v_fma_f32 v68, v68, v6, v29
 v_fma_f32 v69, v69, v6, v29
M v[88:91], a[120:123], v[224:227], v[88:91]
 v_fma_f32 v70, v70, v6, v29
 v_fma_f32 v71, v71, v6, v29
M v[88:91], a[124:127], v[240:243], v[88:91]
 v_fma_f32 v76, v76, v6, v29
 v_fma_f32 v77, v77, v6, v29
M v[92:95], a[124:127], v[244:247], v[36:39]
 v_fma_f32 v78, v78, v6, v29
 v_fma_f32 v79, v79, v6, v29
M v[92:95], a[120:123], v[228:231], v[92:95]
 v_cvt_pk_bf16_f32 v68, v68, v69
 v_cvt_pk_bf16_f32 v69, v70, v71
M v[92:95], a[116:119], v[212:215], v[92:95]
 v_cvt_pk_bf16_f32 v70, v76, v77
 v_cvt_pk_bf16_f32 v71, v78, v79
M v[92:95], a[112:115], v[196:199], v[92:95]
 buffer_store_dwordx4 v[68:71], v7, s[8:11], s30 offen offset:0 sc1
M v[92:95], a[108:111], v[180:183], v[92:95]
M v[92:95], a[104:107], v[164:167], v[92:95]
M v[92:95], a[100:103], v[148:151], v[92:95]
M v[92:95], a[96:99], v[132:135], v[92:95]
 v_fma_f32 v80, v80, v5, v28
 v_fma_f32 v81, v81, v5, v28
 v_fma_f32 v82, v82, v5, v28
 v_fma_f32 v83, v83, v5, v28
 v_fma_f32 v88, v88, v5, v28
 v_fma_f32 v89, v89, v5, v28
 v_fma_f32 v90, v90, v5, v28
 v_fma_f32 v91, v91, v5, v28
 v_cvt_pk_bf16_f32 v80, v80, v81
 v_cvt_pk_bf16_f32 v81, v82, v83
 v_cvt_pk_bf16_f32 v82, v88, v89
 v_cvt_pk_bf16_f32 v83, v90, v91
 buffer_store_dwordx4 v[80:83], v7, s[8:11], s29 offen offset:1024 sc1
 v_fma_f32 v84, v84, v6, v29
 v_fma_f32 v85, v85, v6, v29
 v_fma_f32 v86, v86, v6, v29
 v_fma_f32 v87, v87, v6, v29
 v_fma_f32 v92, v92, v6, v29
 v_fma_f32 v93, v93, v6, v29
 v_fma_f32 v94, v94, v6, v29
 v_fma_f32 v95, v95, v6, v29
 v_cvt_pk_bf16_f32 v84, v84, v85
 v_cvt_pk_bf16_f32 v85, v86, v87
 v_cvt_pk_bf16_f32 v86, v92, v93
 v_cvt_pk_bf16_f32 v87, v94, v95
 buffer_store_dwordx4 v[84:87], v7, s[8:11], s30 offen offset:1024 sc1
 s_cmp_lt_u32 s42, 8
 s_cbranch_scc1 L_red
 s_cmp_eq_u32 s20, 3
 s_cbranch_scc1 L_vend3
 s_sub_u32 s64, 15, s42
 s_lshl_b32 s64, s64, 1
 s_lshr_b32 s65, s41, 3
 s_add_u32 s46, s64, s65
 s_mul_i32 s46, s46, 4352
 s_and_b32 s72, s41, 7
 s_lshl_b32 s66, s72, 7
 s_add_u32 s46, s46, s66
 s_add_u32 s46, s46, 104993792
 v_and_b32 v14, 15, v0
 v_lshlrev_b32 v14, 2, v14
 buffer_load_dword v9, v14, s[8:11], s46 offen sc1
 s_mul_i32 s86, s65, 3
 s_add_u32 s86, s86, s20
 s_add_u32 s86, s86, 8
 s_mul_i32 s77, s42, 1835008
 s_mul_i32 s78, s72, 14336
 s_add_u32 s77, s77, s78
 s_add_u32 s77, s77, 67108864
 s_lshl_b32 s78, s86, 10
 s_add_u32 s77, s77, s78
 s_lshl_b32 s86, s86, 6
 s_lshr_b32 s73, s72, 1
 s_sub_u32 s65, 7, s73
 s_bitcmp1_b32 s72, 0
 s_cselect_b32 s73, s65, s73
 s_lshl_b32 s73, s73, 4
 s_lshl_b32 s65, s42, 7
 s_add_u32 s73, s73, s65
 v_and_b32 v10, 15, v0
 v_add_u32 v10, s73, v10
 s_mov_b32 s64, 104857664
 v_mul_u32_u24 v12, 896, v10
 v_lshl_add_u32 v12, v11, 4, v12
 v_lshrrev_b32 v13, 4, v10
 v_lshlrev_b32 v13, 5, v13
 v_and_b32 v104, 15, v10
 v_add_lshl_u32 v13, v13, v104, 2
 buffer_load_dword v15, v13, s[8:11], s64 offen sc1
 buffer_load_dwordx4 v[16:19], v12, s[56:59], s86 offen
 v_mov_b32 v48, 0
 v_mov_b32 v49, 0
 v_mov_b32 v50, 0
 v_mov_b32 v51, 0
 v_mov_b32 v52, 0
 v_mov_b32 v53, 0
 v_mov_b32 v54, 0
 v_mov_b32 v55, 0
 s_waitcnt vmcnt(3)
 buffer_store_dword v40, v41, s[8:11], s3 offen sc1
 s_waitcnt vmcnt(3)
 v_cmp_eq_u32 vcc, 1, v9
 s_mov_b32 s91, 65536
 s_mov_b32 s69, 0
 s_and_b32 s70, vcc_lo, 0xffff
 s_or_b32 s68, s70, 0xffff0000
 s_cmp_lg_u32 s70, 0
 s_cbranch_scc1 L_vk0
 s_call_b64 s[36:37], L_rpoll
L_vk0:
 s_ff1_i32_b32 s71, s70
 s_bitset0_b32 s70, s71
 s_mul_i32 s71, s71, 114688
 s_add_u32 s12, s71, s77
 buffer_load_dwordx4 v[128:131], v7, s[8:11], s12 offen sc1
 s_cmp_lg_u32 s70, 0
 s_cbranch_scc1 L_vk1
 s_call_b64 s[36:37], L_rpoll
L_vk1:
 s_ff1_i32_b32 s71, s70
 s_bitset0_b32 s70, s71
 s_mul_i32 s71, s71, 114688
 s_add_u32 s13, s71, s77
 buffer_load_dwordx4 v[132:135], v7, s[8:11], s13 offen sc1
 s_waitcnt vmcnt(3)
 v_lshlrev_b32 v32, 16, v16
 v_and_b32 v33, 0xffff0000, v16
 v_lshlrev_b32 v34, 16, v17
 v_and_b32 v35, 0xffff0000, v17
 v_lshlrev_b32 v36, 16, v18
 v_and_b32 v37, 0xffff0000, v18
 v_lshlrev_b32 v38, 16, v19
 v_and_b32 v39, 0xffff0000, v19
 v_sub_f32 v13, 1.0, v15
 v_cmp_eq_u32 s[80:81], s84, v10
 v_cmp_eq_u32 s[82:83], s85, v10
 s_nop 0
 s_or_b64 vcc, s[80:81], s[82:83]
 s_cbranch_vccnz L_moe2
L_moe_ret2:
 v_mul_f32 v32, v13, v32
 v_mul_f32 v33, v13, v33
 v_mul_f32 v34, v13, v34
 v_mul_f32 v35, v13, v35
 v_mul_f32 v36, v13, v36
 v_mul_f32 v37, v13, v37
 v_mul_f32 v38, v13, v38
 v_mul_f32 v39, v13, v39
 s_cmp_lg_u32 s70, 0
 s_cbranch_scc1 L_vk2
 s_call_b64 s[36:37], L_rpoll
L_vk2:
 s_ff1_i32_b32 s71, s70
 s_bitset0_b32 s70, s71
 s_mul_i32 s71, s71, 114688
 s_add_u32 s14, s71, s77
 buffer_load_dwordx4 v[136:139], v7, s[8:11], s14 offen sc1
 s_cmp_lg_u32 s70, 0
 s_cbranch_scc1 L_vk3
 s_call_b64 s[36:37], L_rpoll
L_vk3:
 s_ff1_i32_b32 s71, s70
 s_bitset0_b32 s70, s71
 s_mul_i32 s71, s71, 114688
 s_add_u32 s15, s71, s77
 buffer_load_dwordx4 v[140:143], v7, s[8:11], s15 offen sc1
 s_cmp_lg_u32 s70, 0
 s_cbranch_scc1 L_vk4
 s_call_b64 s[36:37], L_rpoll
L_vk4:
 s_ff1_i32_b32 s71, s70
 s_bitset0_b32 s70, s71
 s_mul_i32 s71, s71, 114688
 s_add_u32 s16, s71, s77
 buffer_load_dwordx4 v[144:147], v7, s[8:11], s16 offen sc1
 s_cmp_lg_u32 s70, 0
 s_cbranch_scc1 L_vk5
 s_call_b64 s[36:37], L_rpoll
L_vk5:
 s_ff1_i32_b32 s71, s70
 s_bitset0_b32 s70, s71
 s_mul_i32 s71, s71, 114688
 s_add_u32 s17, s71, s77
 buffer_load_dwordx4 v[148:151], v7, s[8:11], s17 offen sc1
 s_cmp_lg_u32 s70, 0
 s_cbranch_scc1 L_vk6
 s_call_b64 s[36:37], L_rpoll
L_vk6:
 s_ff1_i32_b32 s71, s70
 s_bitset0_b32 s70, s71
 s_mul_i32 s71, s71, 114688
 s_add_u32 s18, s71, s77
 buffer_load_dwordx4 v[152:155], v7, s[8:11], s18 offen sc1
 s_cmp_lg_u32 s70, 0
 s_cbranch_scc1 L_vk7
 s_call_b64 s[36:37], L_rpoll
L_vk7:
 s_ff1_i32_b32 s71, s70
 s_bitset0_b32 s70, s71
 s_mul_i32 s71, s71, 114688
 s_add_u32 s19, s71, s77
 buffer_load_dwordx4 v[156:159], v7, s[8:11], s19 offen sc1
 s_cmp_lg_u32 s70, 0
 s_cbranch_scc1 L_vk8
 s_call_b64 s[36:37], L_rpoll
L_vk8:
 s_ff1_i32_b32 s71, s70
 s_bitset0_b32 s70, s71
 s_mul_i32 s71, s71, 114688
 s_add_u32 s21, s71, s77
 buffer_load_dwordx4 v[160:163], v7, s[8:11], s21 offen sc1
 s_cmp_lg_u32 s70, 0
 s_cbranch_scc1 L_vk9
 s_call_b64 s[36:37], L_rpoll
L_vk9:
 s_ff1_i32_b32 s71, s70
 s_bitset0_b32 s70, s71
 s_mul_i32 s71, s71, 114688
 s_add_u32 s22, s71, s77
 buffer_load_dwordx4 v[164:167], v7, s[8:11], s22 offen sc1
 s_cmp_lg_u32 s70, 0
 s_cbranch_scc1 L_vk10
 s_call_b64 s[36:37], L_rpoll
L_vk10:
 s_ff1_i32_b32 s71, s70
 s_bitset0_b32 s70, s71
 s_mul_i32 s71, s71, 114688
 s_add_u32 s23, s71, s77
 buffer_load_dwordx4 v[168:171], v7, s[8:11], s23 offen sc1
 s_cmp_lg_u32 s70, 0
 s_cbranch_scc1 L_vk11
 s_call_b64 s[36:37], L_rpoll
L_vk11:
 s_ff1_i32_b32 s71, s70
 s_bitset0_b32 s70, s71
 s_mul_i32 s71, s71, 114688
 s_add_u32 s24, s71, s77
 buffer_load_dwordx4 v[172:175], v7, s[8:11], s24 offen sc1
 s_cmp_lg_u32 s70, 0
 s_cbranch_scc1 L_vk12
 s_call_b64 s[36:37], L_rpoll
L_vk12:
 s_ff1_i32_b32 s71, s70
 s_bitset0_b32 s70, s71
 s_mul_i32 s71, s71, 114688
 s_add_u32 s48, s71, s77
 buffer_load_dwordx4 v[176:179], v7, s[8:11], s48 offen sc1
 s_cmp_lg_u32 s70, 0
 s_cbranch_scc1 L_vk13
 s_call_b64 s[36:37], L_rpoll
L_vk13:
 s_ff1_i32_b32 s71, s70
 s_bitset0_b32 s70, s71
 s_mul_i32 s71, s71, 114688
 s_add_u32 s49, s71, s77
 buffer_load_dwordx4 v[180:183], v7, s[8:11], s49 offen sc1
 s_cmp_lg_u32 s70, 0
 s_cbranch_scc1 L_vk14
 s_call_b64 s[36:37], L_rpoll
L_vk14:
 s_ff1_i32_b32 s71, s70
 s_bitset0_b32 s70, s71
 s_mul_i32 s71, s71, 114688
 s_add_u32 s50, s71, s77
 buffer_load_dwordx4 v[184:187], v7, s[8:11], s50 offen sc1
 s_cmp_lg_u32 s70, 0
 s_cbranch_scc1 L_vk15
 s_call_b64 s[36:37], L_rpoll
L_vk15:
 s_ff1_i32_b32 s71, s70
 s_bitset0_b32 s70, s71
 s_mul_i32 s71, s71, 114688
 s_add_u32 s51, s71, s77
 buffer_load_dwordx4 v[188:191], v7, s[8:11], s51 offen sc1
 s_waitcnt vmcnt(15)
 v_dot2c_f32_bf16 v48, v128, v24
 v_dot2c_f32_bf16 v49, v128, v25
 v_dot2c_f32_bf16 v50, v129, v24
 v_dot2c_f32_bf16 v51, v129, v25
 v_dot2c_f32_bf16 v52, v130, v24
 v_dot2c_f32_bf16 v53, v130, v25
 v_dot2c_f32_bf16 v54, v131, v24
 v_dot2c_f32_bf16 v55, v131, v25
 s_waitcnt vmcnt(14)
 v_dot2c_f32_bf16 v48, v132, v24
 v_dot2c_f32_bf16 v49, v132, v25
 v_dot2c_f32_bf16 v50, v133, v24
 v_dot2c_f32_bf16 v51, v133, v25
 v_dot2c_f32_bf16 v52, v134, v24
 v_dot2c_f32_bf16 v53, v134, v25
 v_dot2c_f32_bf16 v54, v135, v24
 v_dot2c_f32_bf16 v55, v135, v25
 s_waitcnt vmcnt(13)
 v_dot2c_f32_bf16 v48, v136, v24
 v_dot2c_f32_bf16 v49, v136, v25
 v_dot2c_f32_bf16 v50, v137, v24
 v_dot2c_f32_bf16 v51, v137, v25
 v_dot2c_f32_bf16 v52, v138, v24
 v_dot2c_f32_bf16 v53, v138, v25
 v_dot2c_f32_bf16 v54, v139, v24
 v_dot2c_f32_bf16 v55, v139, v25
 s_waitcnt vmcnt(12)
 v_dot2c_f32_bf16 v48, v140, v24
 v_dot2c_f32_bf16 v49, v140, v25
 v_dot2c_f32_bf16 v50, v141, v24
 v_dot2c_f32_bf16 v51, v141, v25
 v_dot2c_f32_bf16 v52, v142, v24
 v_dot2c_f32_bf16 v53, v142, v25
 v_dot2c_f32_bf16 v54, v143, v24
 v_dot2c_f32_bf16 v55, v143, v25
 s_waitcnt vmcnt(11)
 v_dot2c_f32_bf16 v48, v144, v24
 v_dot2c_f32_bf16 v49, v144, v25
 v_dot2c_f32_bf16 v50, v145, v24
 v_dot2c_f32_bf16 v51, v145, v25
 v_dot2c_f32_bf16 v52, v146, v24
 v_dot2c_f32_bf16 v53, v146, v25
 v_dot2c_f32_bf16 v54, v147, v24
 v_dot2c_f32_bf16 v55, v147, v25
 s_waitcnt vmcnt(10)
 v_dot2c_f32_bf16 v48, v148, v24
 v_dot2c_f32_bf16 v49, v148, v25
 v_dot2c_f32_bf16 v50, v149, v24
 v_dot2c_f32_bf16 v51, v149, v25
 v_dot2c_f32_bf16 v52, v150, v24
 v_dot2c_f32_bf16 v53, v150, v25
 v_dot2c_f32_bf16 v54, v151, v24
 v_dot2c_f32_bf16 v55, v151, v25
 s_waitcnt vmcnt(9)
 v_dot2c_f32_bf16 v48, v152, v24
 v_dot2c_f32_bf16 v49, v152, v25
 v_dot2c_f32_bf16 v50, v153, v24
 v_dot2c_f32_bf16 v51, v153, v25
 v_dot2c_f32_bf16 v52, v154, v24
 v_dot2c_f32_bf16 v53, v154, v25
 v_dot2c_f32_bf16 v54, v155, v24
 v_dot2c_f32_bf16 v55, v155, v25
 s_waitcnt vmcnt(8)
 v_dot2c_f32_bf16 v48, v156, v24
 v_dot2c_f32_bf16 v49, v156, v25
 v_dot2c_f32_bf16 v50, v157, v24
 v_dot2c_f32_bf16 v51, v157, v25
 v_dot2c_f32_bf16 v52, v158, v24
 v_dot2c_f32_bf16 v53, v158, v25
 v_dot2c_f32_bf16 v54, v159, v24
 v_dot2c_f32_bf16 v55, v159, v25
 s_waitcnt vmcnt(7)
 v_dot2c_f32_bf16 v48, v160, v24
 v_dot2c_f32_bf16 v49, v160, v25
 v_dot2c_f32_bf16 v50, v161, v24
 v_dot2c_f32_bf16 v51, v161, v25
 v_dot2c_f32_bf16 v52, v162, v24
 v_dot2c_f32_bf16 v53, v162, v25
 v_dot2c_f32_bf16 v54, v163, v24
 v_dot2c_f32_bf16 v55, v163, v25
 s_waitcnt vmcnt(6)
 v_dot2c_f32_bf16 v48, v164, v24
 v_dot2c_f32_bf16 v49, v164, v25
 v_dot2c_f32_bf16 v50, v165, v24
 v_dot2c_f32_bf16 v51, v165, v25
 v_dot2c_f32_bf16 v52, v166, v24
 v_dot2c_f32_bf16 v53, v166, v25
 v_dot2c_f32_bf16 v54, v167, v24
 v_dot2c_f32_bf16 v55, v167, v25
 s_waitcnt vmcnt(5)
 v_dot2c_f32_bf16 v48, v168, v24
 v_dot2c_f32_bf16 v49, v168, v25
 v_dot2c_f32_bf16 v50, v169, v24
 v_dot2c_f32_bf16 v51, v169, v25
 v_dot2c_f32_bf16 v52, v170, v24
 v_dot2c_f32_bf16 v53, v170, v25
 v_dot2c_f32_bf16 v54, v171, v24
 v_dot2c_f32_bf16 v55, v171, v25
 s_waitcnt vmcnt(4)
 v_dot2c_f32_bf16 v48, v172, v24
 v_dot2c_f32_bf16 v49, v172, v25
 v_dot2c_f32_bf16 v50, v173, v24
 v_dot2c_f32_bf16 v51, v173, v25
 v_dot2c_f32_bf16 v52, v174, v24
 v_dot2c_f32_bf16 v53, v174, v25
 v_dot2c_f32_bf16 v54, v175, v24
 v_dot2c_f32_bf16 v55, v175, v25
 s_waitcnt vmcnt(3)
 v_dot2c_f32_bf16 v48, v176, v24
 v_dot2c_f32_bf16 v49, v176, v25
 v_dot2c_f32_bf16 v50, v177, v24
 v_dot2c_f32_bf16 v51, v177, v25
 v_dot2c_f32_bf16 v52, v178, v24
 v_dot2c_f32_bf16 v53, v178, v25
 v_dot2c_f32_bf16 v54, v179, v24
 v_dot2c_f32_bf16 v55, v179, v25
 s_waitcnt vmcnt(2)
 v_dot2c_f32_bf16 v48, v180, v24
 v_dot2c_f32_bf16 v49, v180, v25
 v_dot2c_f32_bf16 v50, v181, v24
 v_dot2c_f32_bf16 v51, v181, v25
 v_dot2c_f32_bf16 v52, v182, v24
 v_dot2c_f32_bf16 v53, v182, v25
 v_dot2c_f32_bf16 v54, v183, v24
 v_dot2c_f32_bf16 v55, v183, v25
 s_waitcnt vmcnt(1)
 v_dot2c_f32_bf16 v48, v184, v24
 v_dot2c_f32_bf16 v49, v184, v25
 v_dot2c_f32_bf16 v50, v185, v24
 v_dot2c_f32_bf16 v51, v185, v25
 v_dot2c_f32_bf16 v52, v186, v24
 v_dot2c_f32_bf16 v53, v186, v25
 v_dot2c_f32_bf16 v54, v187, v24
 v_dot2c_f32_bf16 v55, v187, v25
 s_waitcnt vmcnt(0)
 v_dot2c_f32_bf16 v48, v188, v24
 v_dot2c_f32_bf16 v49, v188, v25
 v_dot2c_f32_bf16 v50, v189, v24
 v_dot2c_f32_bf16 v51, v189, v25
 v_dot2c_f32_bf16 v52, v190, v24
 v_dot2c_f32_bf16 v53, v190, v25
 v_dot2c_f32_bf16 v54, v191, v24
 v_dot2c_f32_bf16 v55, v191, v25
 s_nop 1
 v_fmac_f32 v32, v15, v48
 v_fmac_f32 v33, v15, v49
 v_fmac_f32 v34, v15, v50
 v_fmac_f32 v35, v15, v51
 v_fmac_f32 v36, v15, v52
 v_fmac_f32 v37, v15, v53
 v_fmac_f32 v38, v15, v54
 v_fmac_f32 v39, v15, v55
 v_cvt_pk_bf16_f32 v16, v32, v33
 v_cvt_pk_bf16_f32 v17, v34, v35
 v_cvt_pk_bf16_f32 v18, v36, v37
 v_cvt_pk_bf16_f32 v19, v38, v39
 buffer_store_dwordx4 v[16:19], v12, s[52:55], s86 offen sc1
L_vend:
 s_endpgm
L_vend3:
 s_waitcnt vmcnt(0)
 buffer_store_dword v40, v41, s[8:11], s3 offen sc1
 s_branch L_vend
 s_waitcnt vmcnt(0)
L_p3k:
 s_mov_b32 s72, s32
 s_add_u32 s73, s72, 4096
 s_add_u32 s74, s72, 8192
 s_add_u32 s75, s72, 12288
 s_waitcnt vmcnt(8)
 v_cmp_ne_u32 vcc, 1, v5
 s_nop 0
 s_cbranch_vccnz L_fps1
L_fpr1:
M v[128:131], a[64:67], v[40:43], v[128:131]
 ds_read_b128 a[96:99], v2 offset:8192
 ds_read_b128 a[100:103], v2 offset:9216
M v[128:131], a[68:71], v[56:59], v[128:131]
 buffer_load_dwordx4 a[0:3], v7, s[8:11], s72 offen offset:0 sc1
M v[132:135], a[68:71], v[60:63], v[132:135]
 v_exp_f32 v18, v100
M v[132:135], a[64:67], v[44:47], v[132:135]
 ds_read_b128 a[104:107], v2 offset:10240
 ds_read_b128 a[108:111], v2 offset:11264
M v[136:139], a[72:75], v[40:43], v[136:139]
 buffer_load_dwordx4 a[4:7], v7, s[8:11], s72 offen offset:1024 sc1
M v[136:139], a[76:79], v[56:59], v[136:139]
 v_exp_f32 v19, v101
M v[140:143], a[76:79], v[60:63], v[140:143]
 ds_read_b128 a[112:115], v2 offset:12288
 ds_read_b128 a[116:119], v2 offset:13312
M v[140:143], a[72:75], v[44:47], v[140:143]
 buffer_load_dwordx4 a[8:11], v7, s[8:11], s72 offen offset:2048 sc1
M v[144:147], a[80:83], v[40:43], v[144:147]
 v_exp_f32 v20, v102
M v[144:147], a[84:87], v[56:59], v[144:147]
 ds_read_b128 a[120:123], v2 offset:14336
 ds_read_b128 a[124:127], v2 offset:15360
M v[148:151], a[84:87], v[60:63], v[148:151]
 v_exp_f32 v21, v103
M v[148:151], a[80:83], v[44:47], v[148:151]
 buffer_load_dwordx4 a[12:15], v7, s[8:11], s72 offen offset:3072 sc1
M v[152:155], a[88:91], v[40:43], v[152:155]
 v_add_f32 v30, v26, v30
 v_add_f32 v31, v27, v31
M v[152:155], a[92:95], v[56:59], v[152:155]
 v_add_f32 v29, v18, v19
 v_cvt_pk_bf16_f32 v52, v18, v19
M v[156:159], a[92:95], v[60:63], v[156:159]
 v_exp_f32 v22, v108
M v[156:159], a[88:91], v[44:47], v[156:159]
 s_waitcnt lgkmcnt(0)
 v_add_f32 v29, v20, v29
 v_cvt_pk_bf16_f32 v53, v20, v21
M v[160:163], a[96:99], v[40:43], v[160:163]
 ds_read_b128 a[64:67], v2 offset:16384
 ds_read_b128 a[68:71], v2 offset:17408
M v[160:163], a[100:103], v[56:59], v[160:163]
 buffer_load_dwordx4 a[16:19], v7, s[8:11], s73 offen offset:0 sc1
M v[164:167], a[100:103], v[60:63], v[164:167]
 v_exp_f32 v23, v109
M v[164:167], a[96:99], v[44:47], v[164:167]
 ds_read_b128 a[72:75], v2 offset:18432
 ds_read_b128 a[76:79], v2 offset:19456
M v[168:171], a[104:107], v[40:43], v[168:171]
 buffer_load_dwordx4 a[20:23], v7, s[8:11], s73 offen offset:1024 sc1
M v[168:171], a[108:111], v[56:59], v[168:171]
 v_exp_f32 v24, v110
M v[172:175], a[108:111], v[60:63], v[172:175]
 ds_read_b128 a[80:83], v2 offset:20480
 ds_read_b128 a[84:87], v2 offset:21504
M v[172:175], a[104:107], v[44:47], v[172:175]
 buffer_load_dwordx4 a[24:27], v7, s[8:11], s73 offen offset:2048 sc1
M v[176:179], a[112:115], v[40:43], v[176:179]
 v_exp_f32 v25, v111
M v[176:179], a[116:119], v[56:59], v[176:179]
 ds_read_b128 a[88:91], v2 offset:22528
 ds_read_b128 a[92:95], v2 offset:23552
M v[180:183], a[116:119], v[60:63], v[180:183]
 buffer_load_dwordx4 a[28:31], v7, s[8:11], s73 offen offset:3072 sc1
M v[180:183], a[112:115], v[44:47], v[180:183]
 v_add_f32 v29, v21, v29
 v_add_f32 v29, v22, v29
M v[184:187], a[120:123], v[40:43], v[184:187]
 v_exp_f32 v18, v116
M v[184:187], a[124:127], v[56:59], v[184:187]
 v_cvt_pk_bf16_f32 v54, v22, v23
 v_add_f32 v29, v23, v29
M v[188:191], a[124:127], v[60:63], v[188:191]
 buffer_load_dwordx4 a[32:35], v7, s[8:11], s74 offen offset:0 sc1
M v[188:191], a[120:123], v[44:47], v[188:191]
 s_waitcnt lgkmcnt(0)
 v_exp_f32 v19, v117
M v[192:195], a[64:67], v[40:43], v[192:195]
 ds_read_b128 a[96:99], v2 offset:24576
 ds_read_b128 a[100:103], v2 offset:25600
M v[192:195], a[68:71], v[56:59], v[192:195]
 buffer_load_dwordx4 a[36:39], v7, s[8:11], s74 offen offset:1024 sc1
M v[196:199], a[68:71], v[60:63], v[196:199]
 v_add_f32 v29, v24, v29
 v_cvt_pk_bf16_f32 v55, v24, v25
M v[196:199], a[64:67], v[44:47], v[196:199]
 ds_read_b128 a[104:107], v2 offset:26624
 ds_read_b128 a[108:111], v2 offset:27648
M v[200:203], a[72:75], v[40:43], v[200:203]
 v_exp_f32 v20, v118
M v[200:203], a[76:79], v[56:59], v[200:203]
 buffer_load_dwordx4 a[40:43], v7, s[8:11], s74 offen offset:2048 sc1
M v[204:207], a[76:79], v[60:63], v[204:207]
 ds_read_b128 a[112:115], v2 offset:28672
 ds_read_b128 a[116:119], v2 offset:29696
M v[204:207], a[72:75], v[44:47], v[204:207]
 v_exp_f32 v21, v119
M v[208:211], a[80:83], v[40:43], v[208:211]
 v_add_f32 v29, v25, v29
 v_add_f32 v29, v18, v29
M v[208:211], a[84:87], v[56:59], v[208:211]
 ds_read_b128 a[120:123], v2 offset:30720
 ds_read_b128 a[124:127], v2 offset:31744
M v[212:215], a[84:87], v[60:63], v[212:215]
 buffer_load_dwordx4 a[44:47], v7, s[8:11], s74 offen offset:3072 sc1
M v[212:215], a[80:83], v[44:47], v[212:215]
 v_exp_f32 v22, v124
M v[216:219], a[88:91], v[40:43], v[216:219]
 v_cvt_pk_bf16_f32 v48, v18, v19
 v_add_f32 v29, v19, v29
M v[216:219], a[92:95], v[56:59], v[216:219]
 buffer_load_dwordx4 a[48:51], v7, s[8:11], s75 offen offset:0 sc1
M v[220:223], a[92:95], v[60:63], v[220:223]
 s_waitcnt vmcnt(13) lgkmcnt(0)
 v_exp_f32 v23, v125
M v[220:223], a[88:91], v[44:47], v[220:223]
 s_barrier
M v[224:227], a[96:99], v[40:43], v[224:227]
 ds_read_b128 a[64:67], v7 offset:0
 ds_read_b128 a[68:71], v7 offset:1024
M v[224:227], a[100:103], v[56:59], v[224:227]
 buffer_load_dwordx4 a[52:55], v7, s[8:11], s75 offen offset:1024 sc1
M v[228:231], a[100:103], v[60:63], v[228:231]
 v_exp_f32 v24, v126
M v[228:231], a[96:99], v[44:47], v[228:231]
 ds_read_b128 a[72:75], v7 offset:2048
 ds_read_b128 a[76:79], v7 offset:3072
M v[232:235], a[104:107], v[40:43], v[232:235]
 buffer_load_dwordx4 a[56:59], v7, s[8:11], s75 offen offset:2048 sc1
M v[232:235], a[108:111], v[56:59], v[232:235]
 v_exp_f32 v25, v127
M v[236:239], a[108:111], v[60:63], v[236:239]
 ds_read_b128 a[80:83], v7 offset:4096
 ds_read_b128 a[84:87], v7 offset:5120
M v[236:239], a[104:107], v[44:47], v[236:239]
 v_add_f32 v29, v20, v29
 v_cvt_pk_bf16_f32 v49, v20, v21
M v[240:243], a[112:115], v[40:43], v[240:243]
 buffer_load_dwordx4 a[60:63], v7, s[8:11], s75 offen offset:3072 sc1
M v[240:243], a[116:119], v[56:59], v[240:243]
 ds_read_b128 a[88:91], v7 offset:6144
 ds_read_b128 a[92:95], v7 offset:7168
M v[244:247], a[116:119], v[60:63], v[244:247]
 v_add_f32 v29, v21, v29
 v_add_f32 v29, v22, v29
M v[244:247], a[112:115], v[44:47], v[244:247]
 v_cvt_pk_bf16_f32 v50, v22, v23
 v_add_f32 v29, v23, v29
M v[248:251], a[120:123], v[40:43], v[248:251]
 v_add_f32 v29, v24, v29
 v_cvt_pk_bf16_f32 v51, v24, v25
M v[248:251], a[124:127], v[56:59], v[248:251]
 v_add_f32 v29, v25, v29
M v[252:255], a[124:127], v[60:63], v[252:255]
 s_waitcnt lgkmcnt(0)
M v[252:255], a[120:123], v[44:47], v[252:255]
 v_cmp_lt_f32 vcc, s31, v29
 s_nop 0
 s_cbranch_vccnz L_st7
L_rt7:
M v[132:135], a[64:67], v[52:55], v[132:135]
 ds_read_b128 a[96:99], v7 offset:8192
 ds_read_b128 a[100:103], v7 offset:9216
M v[132:135], a[68:71], v[48:51], v[132:135]
 ds_read_b128 a[104:107], v7 offset:10240
 v_add_f32 v31, v29, v31
M v[140:143], a[76:79], v[48:51], v[140:143]
 s_sub_u32 s27, 5, s42
 ds_read_b128 a[108:111], v7 offset:11264
 ds_read_b128 a[112:115], v7 offset:12288
M v[140:143], a[72:75], v[52:55], v[140:143]
 s_mov_b32 s40, 0
 ds_read_b128 a[116:119], v7 offset:13312
 v_mov_b32 v10, v30
M v[148:151], a[80:83], v[52:55], v[148:151]
 s_add_u32 m0, s28, 32768
 ds_read_b128 a[120:123], v7 offset:14336
 ds_read_b128 a[124:127], v7 offset:15360
M v[148:151], a[84:87], v[48:51], v[148:151]
 buffer_load_dwordx4 v3, s[8:11], s21 offen offset:0 sc1 lds
M v[156:159], a[92:95], v[48:51], v[156:159]
 ds_read_b128 a[128:131], v7 offset:16384
 ds_read_b128 a[132:135], v7 offset:17408
M v[156:159], a[88:91], v[52:55], v[156:159]
 s_waitcnt lgkmcnt(2)
 ds_read_b128 a[136:139], v7 offset:18432
 v_mov_b32 v11, v31
M v[164:167], a[96:99], v[52:55], v[164:167]
 ds_read_b128 a[140:143], v7 offset:19456
 ds_read_b128 a[144:147], v7 offset:20480
M v[164:167], a[100:103], v[48:51], v[164:167]
 buffer_load_dwordx4 v3, s[8:11], s21 offen offset:1024 sc1 lds
M v[172:175], a[108:111], v[48:51], v[172:175]
 ds_read_b128 a[148:151], v7 offset:21504
 ds_read_b128 a[152:155], v7 offset:22528
M v[172:175], a[104:107], v[52:55], v[172:175]
 ds_read_b128 a[156:159], v7 offset:23552
 v_permlane16_swap_b32 v10, v30
M v[180:183], a[112:115], v[52:55], v[180:183]
 ds_read_b128 a[160:163], v7 offset:24576
 ds_read_b128 a[164:167], v7 offset:25600
M v[180:183], a[116:119], v[48:51], v[180:183]
 buffer_load_dwordx4 v3, s[8:11], s21 offen offset:2048 sc1 lds
M v[188:191], a[124:127], v[48:51], v[188:191]
 ds_read_b128 a[168:171], v7 offset:26624
 ds_read_b128 a[172:175], v7 offset:27648
M v[188:191], a[120:123], v[52:55], v[188:191]
 s_waitcnt lgkmcnt(4)
 ds_read_b128 a[176:179], v7 offset:28672
 v_permlane16_swap_b32 v11, v31
M v[196:199], a[128:131], v[52:55], v[196:199]
 ds_read_b128 a[180:183], v7 offset:29696
 ds_read_b128 a[184:187], v7 offset:30720
M v[196:199], a[132:135], v[48:51], v[196:199]
 ds_read_b128 a[188:191], v7 offset:31744
 v_add_f32 v30, v10, v30
M v[204:207], a[140:143], v[48:51], v[204:207]
 buffer_load_dwordx4 v3, s[8:11], s21 offen offset:3072 sc1 lds
M v[204:207], a[136:139], v[52:55], v[204:207]
 s_add_u32 m0, s28, 36864
 v_add_f32 v31, v11, v31
 v_mov_b32 v10, v30
M v[212:215], a[144:147], v[52:55], v[212:215]
 buffer_load_dwordx4 v4, s[8:11], s21 offen offset:0 sc1 lds
M v[212:215], a[148:151], v[48:51], v[212:215]
 s_waitcnt lgkmcnt(0)
 v_mov_b32 v11, v31
 v_permlane32_swap_b32 v10, v30
M v[220:223], a[156:159], v[48:51], v[220:223]
 s_barrier
M v[220:223], a[152:155], v[52:55], v[220:223]
 ds_read_b128 a[64:67], v2 offset:32768
 ds_read_b128 a[68:71], v2 offset:33792
M v[228:231], a[160:163], v[52:55], v[228:231]
 ds_read_b128 a[72:75], v2 offset:34816
 v_permlane32_swap_b32 v11, v31
M v[228:231], a[164:167], v[48:51], v[228:231]
 ds_read_b128 a[76:79], v2 offset:35840
 ds_read_b128 a[80:83], v2 offset:36864
M v[236:239], a[172:175], v[48:51], v[236:239]
 ds_read_b128 a[84:87], v2 offset:37888
 v_add_f32 v30, v10, v30
M v[236:239], a[168:171], v[52:55], v[236:239]
 ds_read_b128 a[88:91], v2 offset:38912
 ds_read_b128 a[92:95], v2 offset:39936
M v[244:247], a[176:179], v[52:55], v[244:247]
 buffer_load_dwordx4 v4, s[8:11], s21 offen offset:1024 sc1 lds
M v[244:247], a[180:183], v[48:51], v[244:247]
 buffer_load_dwordx4 v4, s[8:11], s21 offen offset:2048 sc1 lds
M v[252:255], a[188:191], v[48:51], v[252:255]
 buffer_load_dwordx4 v4, s[8:11], s21 offen offset:3072 sc1 lds
M v[252:255], a[184:187], v[52:55], v[252:255]
 s_waitcnt lgkmcnt(0)
 s_add_u32 s24, s23, 16777216
 s_mov_b32 s23, s21
 s_add_u32 s21, s21, 32768
 s_add_u32 s22, s22, 1
 s_cmp_eq_u32 s22, s25
 s_cselect_b32 s21, s26, s21
 s_cmp_eq_u32 s22, s43
 s_cselect_b32 s21, s4, s21
 s_cmp_eq_u32 s22, s6
 s_cselect_b32 s21, s7, s21
 v_add_f32 v31, v11, v31
 v_rcp_f32 v5, v30
 v_rcp_f32 v6, v31
 v_accvgpr_write_b32 a192, v5
 v_accvgpr_write_b32 a193, v6
 v_mov_b32 v30, 0
 v_mov_b32 v31, 0
 v_mov_b32 v32, 0xc1800000
 v_mov_b32 v33, 0xc1800000
 v_mov_b32 v34, 0xc1800000
 v_mov_b32 v35, 0xc1800000
 v_mov_b32 v36, 0xc1800000
 v_mov_b32 v37, 0xc1800000
 v_mov_b32 v38, 0xc1800000
 v_mov_b32 v39, 0xc1800000
 s_waitcnt vmcnt(8)
M v[64:67], a[64:67], a[0:3], v[32:35]
 ds_read_b128 a[96:99], v2 offset:40960
 v_cvt_pk_bf16_f32 v128, v128, v129
M v[64:67], a[68:71], a[4:7], v[64:67]
 ds_read_b128 a[100:103], v2 offset:41984
 v_cvt_pk_bf16_f32 v129, v130, v131
M v[64:67], a[72:75], a[8:11], v[64:67]
 buffer_load_dword v6, v9, s[8:11], s46 offen sc1
M v[64:67], a[76:79], a[12:15], v[64:67]
 ds_read_b128 a[104:107], v2 offset:43008
 v_cvt_pk_bf16_f32 v130, v136, v137
M v[64:67], a[80:83], a[16:19], v[64:67]
 s_add_u32 m0, s28, 65536
 ds_read_b128 a[108:111], v2 offset:44032
 v_cvt_pk_bf16_f32 v131, v138, v139
M v[64:67], a[84:87], a[20:23], v[64:67]
 buffer_load_dwordx4 v3, s[8:11], s24 offen offset:0 sc1 lds
M v[64:67], a[88:91], a[24:27], v[64:67]
 ds_read_b128 a[112:115], v2 offset:45056
 v_accvgpr_write_b32 a128, v128
M v[64:67], a[92:95], a[28:31], v[64:67]
 ds_read_b128 a[116:119], v2 offset:46080
 v_accvgpr_write_b32 a129, v129
M v[68:71], a[92:95], a[60:63], v[36:39]
 buffer_load_dwordx4 v3, s[8:11], s24 offen offset:1024 sc1 lds
M v[68:71], a[88:91], a[56:59], v[68:71]
 ds_read_b128 a[120:123], v2 offset:47104
 v_accvgpr_write_b32 a130, v130
M v[68:71], a[84:87], a[52:55], v[68:71]
 ds_read_b128 a[124:127], v2 offset:48128
 v_accvgpr_write_b32 a131, v131
M v[68:71], a[80:83], a[48:51], v[68:71]
 v_exp_f32 v18, v64
M v[68:71], a[76:79], a[44:47], v[68:71]
 v_exp_f32 v19, v65
M v[68:71], a[72:75], a[40:43], v[68:71]
 buffer_load_dwordx4 v3, s[8:11], s24 offen offset:2048 sc1 lds
M v[68:71], a[68:71], a[36:39], v[68:71]
 v_exp_f32 v20, v66
M v[68:71], a[64:67], a[32:35], v[68:71]
 s_waitcnt lgkmcnt(0)
 v_exp_f32 v21, v67
M v[72:75], a[96:99], a[0:3], v[32:35]
 ds_read_b128 a[64:67], v2 offset:49152
 v_add_f32 v26, v18, v19
M v[72:75], a[100:103], a[4:7], v[72:75]
 ds_read_b128 a[68:71], v2 offset:50176
 v_cvt_pk_bf16_f32 v40, v18, v19
M v[72:75], a[104:107], a[8:11], v[72:75]
 buffer_load_dwordx4 v3, s[8:11], s24 offen offset:3072 sc1 lds
M v[72:75], a[108:111], a[12:15], v[72:75]
 ds_read_b128 a[72:75], v2 offset:51200
 v_add_f32 v26, v20, v26
M v[72:75], a[112:115], a[16:19], v[72:75]
 ds_read_b128 a[76:79], v2 offset:52224
 v_cvt_pk_bf16_f32 v41, v20, v21
M v[72:75], a[116:119], a[20:23], v[72:75]
 v_exp_f32 v22, v68
M v[72:75], a[120:123], a[24:27], v[72:75]
 ds_read_b128 a[80:83], v2 offset:53248
 v_add_f32 v26, v21, v26
M v[72:75], a[124:127], a[28:31], v[72:75]
 s_add_u32 m0, s28, 69632
 ds_read_b128 a[84:87], v2 offset:54272
 v_cvt_pk_bf16_f32 v132, v132, v133
M v[76:79], a[124:127], a[60:63], v[36:39]
 buffer_load_dwordx4 v4, s[8:11], s24 offen offset:0 sc1 lds
M v[76:79], a[120:123], a[56:59], v[76:79]
 ds_read_b128 a[88:91], v2 offset:55296
 v_cvt_pk_bf16_f32 v133, v134, v135
M v[76:79], a[116:119], a[52:55], v[76:79]
 ds_read_b128 a[92:95], v2 offset:56320
 v_cvt_pk_bf16_f32 v134, v140, v141
M v[76:79], a[112:115], a[48:51], v[76:79]
 v_exp_f32 v23, v69
M v[76:79], a[108:111], a[44:47], v[76:79]
 buffer_load_dwordx4 v4, s[8:11], s24 offen offset:1024 sc1 lds
M v[76:79], a[104:107], a[40:43], v[76:79]
 v_exp_f32 v24, v70
M v[76:79], a[100:103], a[36:39], v[76:79]
 v_exp_f32 v25, v71
M v[76:79], a[96:99], a[32:35], v[76:79]
 s_waitcnt lgkmcnt(0)
 v_exp_f32 v18, v72
M v[80:83], a[64:67], a[0:3], v[32:35]
 ds_read_b128 a[96:99], v2 offset:57344
 v_add_f32 v27, v22, v23
M v[80:83], a[68:71], a[4:7], v[80:83]
 ds_read_b128 a[100:103], v2 offset:58368
 v_cvt_pk_bf16_f32 v44, v22, v23
M v[80:83], a[72:75], a[8:11], v[80:83]
 buffer_load_dwordx4 v4, s[8:11], s24 offen offset:2048 sc1 lds
M v[80:83], a[76:79], a[12:15], v[80:83]
 ds_read_b128 a[104:107], v2 offset:59392
 v_add_f32 v27, v24, v27
M v[80:83], a[80:83], a[16:19], v[80:83]
 ds_read_b128 a[108:111], v2 offset:60416
 v_cvt_pk_bf16_f32 v45, v24, v25
M v[80:83], a[84:87], a[20:23], v[80:83]
 v_exp_f32 v19, v73
M v[80:83], a[88:91], a[24:27], v[80:83]
 ds_read_b128 a[112:115], v2 offset:61440
 v_add_f32 v27, v25, v27
M v[80:83], a[92:95], a[28:31], v[80:83]
 ds_read_b128 a[116:119], v2 offset:62464
 v_add_f32 v26, v18, v26
M v[84:87], a[92:95], a[60:63], v[36:39]
 s_waitcnt vmcnt(7)
 v_cmp_gt_u32 vcc, 3, v6
 v_cvt_pk_bf16_f32 v42, v18, v19
M v[84:87], a[88:91], a[56:59], v[84:87]
 ds_read_b128 a[120:123], v2 offset:63488
 v_add_f32 v26, v19, v26
M v[84:87], a[84:87], a[52:55], v[84:87]
 ds_read_b128 a[124:127], v2 offset:64512
 v_cvt_pk_bf16_f32 v135, v142, v143
M v[84:87], a[80:83], a[48:51], v[84:87]
 s_cbranch_vccnz L_f2s
L_f2r:
 v_exp_f32 v20, v74
M v[84:87], a[76:79], a[44:47], v[84:87]
 buffer_load_dwordx4 v4, s[8:11], s24 offen offset:3072 sc1 lds
M v[84:87], a[72:75], a[40:43], v[84:87]
 v_exp_f32 v21, v75
M v[84:87], a[68:71], a[36:39], v[84:87]
 s_waitcnt lgkmcnt(0)
 v_exp_f32 v22, v76
M v[84:87], a[64:67], a[32:35], v[84:87]
 s_barrier
M v[88:91], a[96:99], a[0:3], v[32:35]
 ds_read_b128 a[64:67], v7 offset:32768
 v_add_f32 v26, v20, v26
M v[88:91], a[100:103], a[4:7], v[88:91]
 ds_read_b128 a[68:71], v7 offset:33792
 v_cvt_pk_bf16_f32 v43, v20, v21
M v[88:91], a[104:107], a[8:11], v[88:91]
 v_exp_f32 v23, v77
M v[88:91], a[108:111], a[12:15], v[88:91]
 ds_read_b128 a[72:75], v7 offset:34816
 v_add_f32 v26, v21, v26
M v[88:91], a[112:115], a[16:19], v[88:91]
 ds_read_b128 a[76:79], v7 offset:35840
 v_add_f32 v27, v22, v27
M v[88:91], a[116:119], a[20:23], v[88:91]
 v_exp_f32 v24, v78
M v[88:91], a[120:123], a[24:27], v[88:91]
 ds_read_b128 a[80:83], v7 offset:36864
 v_cvt_pk_bf16_f32 v46, v22, v23
M v[88:91], a[124:127], a[28:31], v[88:91]
 ds_read_b128 a[84:87], v7 offset:37888
 v_add_f32 v27, v23, v27
M v[92:95], a[124:127], a[60:63], v[36:39]
 v_exp_f32 v25, v79
M v[92:95], a[120:123], a[56:59], v[92:95]
 ds_read_b128 a[88:91], v7 offset:38912
 v_add_f32 v27, v24, v27
M v[92:95], a[116:119], a[52:55], v[92:95]
 ds_read_b128 a[92:95], v7 offset:39936
 v_cvt_pk_bf16_f32 v47, v24, v25
M v[92:95], a[112:115], a[48:51], v[92:95]
 v_add_f32 v27, v25, v27
 v_accvgpr_write_b32 a160, v132
M v[92:95], a[108:111], a[44:47], v[92:95]
 v_accvgpr_write_b32 a161, v133
 v_accvgpr_write_b32 a162, v134
M v[92:95], a[104:107], a[40:43], v[92:95]
 v_accvgpr_write_b32 a163, v135
 v_cvt_pk_bf16_f32 v144, v144, v145
M v[92:95], a[100:103], a[36:39], v[92:95]
 s_waitcnt lgkmcnt(0)
 v_cvt_pk_bf16_f32 v145, v146, v147
 v_cvt_pk_bf16_f32 v146, v152, v153
M v[92:95], a[96:99], a[32:35], v[92:95]
 v_cvt_pk_bf16_f32 v147, v154, v155
 v_accvgpr_write_b32 a132, v144
M v[96:99], a[64:67], a[0:3], v[32:35]
 s_add_u32 m0, s28, 98304
 ds_read_b128 a[96:99], v7 offset:40960
 v_accvgpr_write_b32 a133, v145
M v[96:99], a[68:71], a[4:7], v[96:99]
 ds_read_b128 a[100:103], v7 offset:41984
 v_accvgpr_write_b32 a134, v146
M v[96:99], a[72:75], a[8:11], v[96:99]
 buffer_load_dwordx4 v3, s[8:11], s21 offen offset:0 sc1 lds
M v[96:99], a[76:79], a[12:15], v[96:99]
 ds_read_b128 a[104:107], v7 offset:43008
 v_accvgpr_write_b32 a135, v147
M v[96:99], a[80:83], a[16:19], v[96:99]
 ds_read_b128 a[108:111], v7 offset:44032
 v_cvt_pk_bf16_f32 v148, v148, v149
M v[96:99], a[84:87], a[20:23], v[96:99]
 buffer_load_dwordx4 v3, s[8:11], s21 offen offset:1024 sc1 lds
M v[96:99], a[88:91], a[24:27], v[96:99]
 ds_read_b128 a[112:115], v7 offset:45056
 v_cvt_pk_bf16_f32 v149, v150, v151
M v[96:99], a[92:95], a[28:31], v[96:99]
 ds_read_b128 a[116:119], v7 offset:46080
 v_cvt_pk_bf16_f32 v150, v156, v157
M v[100:103], a[92:95], a[60:63], v[36:39]
 v_exp_f32 v18, v80
M v[100:103], a[88:91], a[56:59], v[100:103]
 ds_read_b128 a[120:123], v7 offset:47104
 v_cvt_pk_bf16_f32 v151, v158, v159
M v[100:103], a[84:87], a[52:55], v[100:103]
 ds_read_b128 a[124:127], v7 offset:48128
 v_accvgpr_write_b32 a164, v148
M v[100:103], a[80:83], a[48:51], v[100:103]
 buffer_load_dwordx4 v3, s[8:11], s21 offen offset:2048 sc1 lds
M v[100:103], a[76:79], a[44:47], v[100:103]
 v_exp_f32 v19, v81
M v[100:103], a[72:75], a[40:43], v[100:103]
 v_exp_f32 v20, v82
M v[100:103], a[68:71], a[36:39], v[100:103]
 v_exp_f32 v21, v83
M v[100:103], a[64:67], a[32:35], v[100:103]
 s_waitcnt lgkmcnt(0)
 v_exp_f32 v22, v88
M v[104:107], a[96:99], a[0:3], v[32:35]
 ds_read_b128 a[64:67], v7 offset:49152
 v_add_f32 v26, v18, v26
M v[104:107], a[100:103], a[4:7], v[104:107]
 ds_read_b128 a[68:71], v7 offset:50176
 v_cvt_pk_bf16_f32 v56, v18, v19
M v[104:107], a[104:107], a[8:11], v[104:107]
 buffer_load_dwordx4 v3, s[8:11], s21 offen offset:3072 sc1 lds
M v[104:107], a[108:111], a[12:15], v[104:107]
 s_add_u32 m0, s28, 102400
 ds_read_b128 a[72:75], v7 offset:51200
 v_add_f32 v26, v19, v26
M v[104:107], a[112:115], a[16:19], v[104:107]
 ds_read_b128 a[76:79], v7 offset:52224
 v_add_f32 v26, v20, v26
M v[104:107], a[116:119], a[20:23], v[104:107]
 buffer_load_dwordx4 v4, s[8:11], s21 offen offset:0 sc1 lds
M v[104:107], a[120:123], a[24:27], v[104:107]
 ds_read_b128 a[80:83], v7 offset:53248
 v_cvt_pk_bf16_f32 v57, v20, v21
M v[104:107], a[124:127], a[28:31], v[104:107]
 ds_read_b128 a[84:87], v7 offset:54272
 v_add_f32 v26, v21, v26
M v[108:111], a[124:127], a[60:63], v[36:39]
 v_exp_f32 v23, v89
M v[108:111], a[120:123], a[56:59], v[108:111]
 ds_read_b128 a[88:91], v7 offset:55296
 v_add_f32 v26, v22, v26
M v[108:111], a[116:119], a[52:55], v[108:111]
 ds_read_b128 a[92:95], v7 offset:56320
 v_cvt_pk_bf16_f32 v58, v22, v23
M v[108:111], a[112:115], a[48:51], v[108:111]
 buffer_load_dwordx4 v4, s[8:11], s21 offen offset:1024 sc1 lds
M v[108:111], a[108:111], a[44:47], v[108:111]
 v_exp_f32 v24, v90
M v[108:111], a[104:107], a[40:43], v[108:111]
 v_exp_f32 v25, v91
M v[108:111], a[100:103], a[36:39], v[108:111]
 buffer_load_dwordx4 v4, s[8:11], s21 offen offset:2048 sc1 lds
M v[108:111], a[96:99], a[32:35], v[108:111]
 s_waitcnt lgkmcnt(0)
 v_exp_f32 v18, v84
M v[112:115], a[64:67], a[0:3], v[32:35]
 ds_read_b128 a[96:99], v7 offset:57344
 v_add_f32 v26, v23, v26
M v[112:115], a[68:71], a[4:7], v[112:115]
 ds_read_b128 a[100:103], v7 offset:58368
 v_add_f32 v26, v24, v26
M v[112:115], a[72:75], a[8:11], v[112:115]
 v_exp_f32 v19, v85
M v[112:115], a[76:79], a[12:15], v[112:115]
 ds_read_b128 a[104:107], v7 offset:59392
 v_cvt_pk_bf16_f32 v59, v24, v25
M v[112:115], a[80:83], a[16:19], v[112:115]
 ds_read_b128 a[108:111], v7 offset:60416
 v_add_f32 v26, v25, v26
M v[112:115], a[84:87], a[20:23], v[112:115]
 buffer_load_dwordx4 v4, s[8:11], s21 offen offset:3072 sc1 lds
M v[112:115], a[88:91], a[24:27], v[112:115]
 s_add_u32 s24, s23, 16777216
 ds_read_b128 a[112:115], v7 offset:61440
 v_add_f32 v27, v18, v27
M v[112:115], a[92:95], a[28:31], v[112:115]
 s_mov_b32 s23, s21
 ds_read_b128 a[116:119], v7 offset:62464
 v_cvt_pk_bf16_f32 v60, v18, v19
M v[116:119], a[92:95], a[60:63], v[36:39]
 s_add_u32 s21, s21, 32768
 v_exp_f32 v20, v86
M v[116:119], a[88:91], a[56:59], v[116:119]
 s_add_u32 s22, s22, 1
 ds_read_b128 a[120:123], v7 offset:63488
 v_add_f32 v27, v19, v27
M v[116:119], a[84:87], a[52:55], v[116:119]
 s_cmp_eq_u32 s22, s25
 ds_read_b128 a[124:127], v7 offset:64512
 v_accvgpr_write_b32 a165, v149
M v[116:119], a[80:83], a[48:51], v[116:119]
 s_cselect_b32 s21, s26, s21
 v_exp_f32 v21, v87
M v[116:119], a[76:79], a[44:47], v[116:119]
 s_cmp_eq_u32 s22, s43
 v_exp_f32 v22, v92
M v[116:119], a[72:75], a[40:43], v[116:119]
 s_cselect_b32 s21, s4, s21
 v_exp_f32 v23, v93
M v[116:119], a[68:71], a[36:39], v[116:119]
 s_waitcnt vmcnt(8) lgkmcnt(0)
 v_add_f32 v27, v20, v27
 v_cvt_pk_bf16_f32 v61, v20, v21
M v[116:119], a[64:67], a[32:35], v[116:119]
 s_barrier
M v[120:123], a[96:99], a[0:3], v[32:35]
 s_cmp_eq_u32 s22, s6
 ds_read_b128 a[64:67], v2 offset:0
 v_add_f32 v27, v21, v27
M v[120:123], a[100:103], a[4:7], v[120:123]
 s_cselect_b32 s21, s7, s21
 ds_read_b128 a[68:71], v2 offset:1024
 v_add_f32 v27, v22, v27
M v[120:123], a[104:107], a[8:11], v[120:123]
 v_exp_f32 v24, v94
M v[120:123], a[108:111], a[12:15], v[120:123]
 ds_read_b128 a[72:75], v2 offset:2048
 v_cvt_pk_bf16_f32 v62, v22, v23
M v[120:123], a[112:115], a[16:19], v[120:123]
 ds_read_b128 a[76:79], v2 offset:3072
 v_add_f32 v27, v23, v27
M v[120:123], a[116:119], a[20:23], v[120:123]
 v_exp_f32 v25, v95
M v[120:123], a[120:123], a[24:27], v[120:123]
 ds_read_b128 a[80:83], v2 offset:4096
 v_add_f32 v27, v24, v27
M v[120:123], a[124:127], a[28:31], v[120:123]
 ds_read_b128 a[84:87], v2 offset:5120
 v_cvt_pk_bf16_f32 v63, v24, v25
M v[124:127], a[124:127], a[60:63], v[36:39]
 v_add_f32 v27, v25, v27
 v_accvgpr_write_b32 a166, v150
M v[124:127], a[120:123], a[56:59], v[124:127]
 ds_read_b128 a[88:91], v2 offset:6144
 v_max_f32 v10, v26, v27
M v[124:127], a[116:119], a[52:55], v[124:127]
 ds_read_b128 a[92:95], v2 offset:7168
 v_min_f32 v11, v26, v27
M v[124:127], a[112:115], a[48:51], v[124:127]
 v_cmp_lt_f32 s[36:37], s31, v10
 v_accvgpr_write_b32 a167, v151
M v[124:127], a[108:111], a[44:47], v[124:127]
 v_cmp_gt_f32 vcc, s55, v11
 v_cvt_pk_bf16_f32 v160, v160, v161
M v[124:127], a[104:107], a[40:43], v[124:127]
 v_cvt_pk_bf16_f32 v161, v162, v163
 v_cvt_pk_bf16_f32 v162, v168, v169
M v[124:127], a[100:103], a[36:39], v[124:127]
 s_waitcnt lgkmcnt(0)
 s_or_b64 vcc, vcc, s[36:37]
M v[124:127], a[96:99], a[32:35], v[124:127]
 s_cbranch_vccnz L_st11
L_rt11:
 v_cvt_pk_bf16_f32 v163, v170, v171
 v_accvgpr_write_b32 a136, v160
 v_accvgpr_write_b32 a137, v161
 v_accvgpr_write_b32 a138, v162
 v_accvgpr_write_b32 a139, v163
 v_cvt_pk_bf16_f32 v164, v164, v165
 v_cvt_pk_bf16_f32 v165, v166, v167
 v_cvt_pk_bf16_f32 v166, v172, v173
 v_cvt_pk_bf16_f32 v167, v174, v175
 v_accvgpr_write_b32 a168, v164
 v_accvgpr_write_b32 a169, v165
 v_accvgpr_write_b32 a170, v166
 v_accvgpr_write_b32 a171, v167
 v_cvt_pk_bf16_f32 v176, v176, v177
 v_cvt_pk_bf16_f32 v177, v178, v179
 v_cvt_pk_bf16_f32 v178, v184, v185
 v_cvt_pk_bf16_f32 v179, v186, v187
 v_accvgpr_write_b32 a140, v176
 v_accvgpr_write_b32 a141, v177
 v_accvgpr_write_b32 a142, v178
 v_accvgpr_write_b32 a143, v179
 v_cvt_pk_bf16_f32 v180, v180, v181
 v_cvt_pk_bf16_f32 v181, v182, v183
 v_cvt_pk_bf16_f32 v182, v188, v189
 v_cvt_pk_bf16_f32 v183, v190, v191
 v_accvgpr_write_b32 a172, v180
 v_accvgpr_write_b32 a173, v181
 v_accvgpr_write_b32 a174, v182
 v_accvgpr_write_b32 a175, v183
 v_cvt_pk_bf16_f32 v192, v192, v193
 v_cvt_pk_bf16_f32 v193, v194, v195
 v_cvt_pk_bf16_f32 v194, v200, v201
 v_cvt_pk_bf16_f32 v195, v202, v203
 v_accvgpr_write_b32 a144, v192
 v_accvgpr_write_b32 a145, v193
 v_accvgpr_write_b32 a146, v194
 v_accvgpr_write_b32 a147, v195
 v_cvt_pk_bf16_f32 v196, v196, v197
 v_cvt_pk_bf16_f32 v197, v198, v199
 v_cvt_pk_bf16_f32 v198, v204, v205
 v_cvt_pk_bf16_f32 v199, v206, v207
 v_accvgpr_write_b32 a176, v196
 v_accvgpr_write_b32 a177, v197
 v_accvgpr_write_b32 a178, v198
 v_accvgpr_write_b32 a179, v199
 v_cvt_pk_bf16_f32 v208, v208, v209
 v_cvt_pk_bf16_f32 v209, v210, v211
 v_cvt_pk_bf16_f32 v210, v216, v217
 v_cvt_pk_bf16_f32 v211, v218, v219
 v_accvgpr_write_b32 a148, v208
 v_accvgpr_write_b32 a149, v209
 v_accvgpr_write_b32 a150, v210
 v_accvgpr_write_b32 a151, v211
 v_cvt_pk_bf16_f32 v212, v212, v213
 v_cvt_pk_bf16_f32 v213, v214, v215
 v_cvt_pk_bf16_f32 v214, v220, v221
 v_cvt_pk_bf16_f32 v215, v222, v223
 v_accvgpr_write_b32 a180, v212
 v_accvgpr_write_b32 a181, v213
 v_accvgpr_write_b32 a182, v214
 v_accvgpr_write_b32 a183, v215
 v_cvt_pk_bf16_f32 v224, v224, v225
 v_cvt_pk_bf16_f32 v225, v226, v227
 v_cvt_pk_bf16_f32 v226, v232, v233
 v_cvt_pk_bf16_f32 v227, v234, v235
 v_accvgpr_write_b32 a152, v224
 v_accvgpr_write_b32 a153, v225
 v_accvgpr_write_b32 a154, v226
 v_accvgpr_write_b32 a155, v227
 v_cvt_pk_bf16_f32 v228, v228, v229
 v_cvt_pk_bf16_f32 v229, v230, v231
 v_cvt_pk_bf16_f32 v230, v236, v237
 v_cvt_pk_bf16_f32 v231, v238, v239
 v_accvgpr_write_b32 a184, v228
 v_accvgpr_write_b32 a185, v229
 v_accvgpr_write_b32 a186, v230
 v_accvgpr_write_b32 a187, v231
M v[128:131], a[64:67], v[40:43], 0
 s_add_u32 m0, s28, 0
 ds_read_b128 a[96:99], v2 offset:8192
 ds_read_b128 a[100:103], v2 offset:9216
M v[128:131], a[68:71], v[56:59], v[128:131]
 buffer_load_dwordx4 v3, s[8:11], s24 offen offset:0 sc1 lds
M v[132:135], a[68:71], v[60:63], 0
 v_cvt_pk_bf16_f32 v240, v240, v241
 v_cvt_pk_bf16_f32 v241, v242, v243
M v[132:135], a[64:67], v[44:47], v[132:135]
 ds_read_b128 a[104:107], v2 offset:10240
 ds_read_b128 a[108:111], v2 offset:11264
M v[136:139], a[72:75], v[40:43], 0
 buffer_load_dwordx4 v3, s[8:11], s24 offen offset:1024 sc1 lds
M v[136:139], a[76:79], v[56:59], v[136:139]
 v_cvt_pk_bf16_f32 v242, v248, v249
 v_cvt_pk_bf16_f32 v243, v250, v251
M v[140:143], a[76:79], v[60:63], 0
 ds_read_b128 a[112:115], v2 offset:12288
 ds_read_b128 a[116:119], v2 offset:13312
M v[140:143], a[72:75], v[44:47], v[140:143]
 buffer_load_dwordx4 v3, s[8:11], s24 offen offset:2048 sc1 lds
M v[144:147], a[80:83], v[40:43], 0
 v_accvgpr_write_b32 a156, v240
 v_accvgpr_write_b32 a157, v241
M v[144:147], a[84:87], v[56:59], v[144:147]
 ds_read_b128 a[120:123], v2 offset:14336
 ds_read_b128 a[124:127], v2 offset:15360
M v[148:151], a[84:87], v[60:63], 0
 buffer_load_dwordx4 v3, s[8:11], s24 offen offset:3072 sc1 lds
M v[148:151], a[80:83], v[44:47], v[148:151]
 s_add_u32 m0, s28, 4096
 v_accvgpr_write_b32 a158, v242
 v_accvgpr_write_b32 a159, v243
M v[152:155], a[88:91], v[40:43], 0
 buffer_load_dwordx4 v4, s[8:11], s24 offen offset:0 sc1 lds
M v[152:155], a[92:95], v[56:59], v[152:155]
 v_cvt_pk_bf16_f32 v244, v244, v245
 v_cvt_pk_bf16_f32 v245, v246, v247
M v[156:159], a[92:95], v[60:63], 0
 v_cvt_pk_bf16_f32 v246, v252, v253
 v_cvt_pk_bf16_f32 v247, v254, v255
M v[156:159], a[88:91], v[44:47], v[156:159]
 s_waitcnt lgkmcnt(0)
 v_accvgpr_write_b32 a188, v244
 v_accvgpr_write_b32 a189, v245
M v[160:163], a[96:99], v[40:43], 0
 ds_read_b128 a[64:67], v2 offset:16384
 ds_read_b128 a[68:71], v2 offset:17408
M v[160:163], a[100:103], v[56:59], v[160:163]
 buffer_load_dwordx4 v4, s[8:11], s24 offen offset:1024 sc1 lds
M v[164:167], a[100:103], v[60:63], 0
 v_accvgpr_write_b32 a190, v246
 v_accvgpr_write_b32 a191, v247
M v[164:167], a[96:99], v[44:47], v[164:167]
 ds_read_b128 a[72:75], v2 offset:18432
 ds_read_b128 a[76:79], v2 offset:19456
M v[168:171], a[104:107], v[40:43], 0
 buffer_load_dwordx4 v4, s[8:11], s24 offen offset:2048 sc1 lds
M v[168:171], a[108:111], v[56:59], v[168:171]
 v_exp_f32 v18, v96
M v[172:175], a[108:111], v[60:63], 0
 ds_read_b128 a[80:83], v2 offset:20480
 ds_read_b128 a[84:87], v2 offset:21504
M v[172:175], a[104:107], v[44:47], v[172:175]
 buffer_load_dwordx4 v4, s[8:11], s24 offen offset:3072 sc1 lds
M v[176:179], a[112:115], v[40:43], 0
 v_exp_f32 v19, v97
M v[176:179], a[116:119], v[56:59], v[176:179]
 s_add_u32 m0, s28, 32768
 ds_read_b128 a[88:91], v2 offset:22528
 ds_read_b128 a[92:95], v2 offset:23552
M v[180:183], a[116:119], v[60:63], 0
 buffer_load_dwordx4 v3, s[8:11], s21 offen offset:0 sc1 lds
M v[180:183], a[112:115], v[44:47], v[180:183]
 v_exp_f32 v20, v98
M v[184:187], a[120:123], v[40:43], 0
 buffer_load_dwordx4 v3, s[8:11], s21 offen offset:1024 sc1 lds
M v[184:187], a[124:127], v[56:59], v[184:187]
 v_exp_f32 v21, v99
M v[188:191], a[124:127], v[60:63], 0
 buffer_load_dwordx4 v3, s[8:11], s21 offen offset:2048 sc1 lds
M v[188:191], a[120:123], v[44:47], v[188:191]
 s_waitcnt lgkmcnt(0)
 v_exp_f32 v22, v104
M v[192:195], a[64:67], v[40:43], 0
 ds_read_b128 a[96:99], v2 offset:24576
 ds_read_b128 a[100:103], v2 offset:25600
M v[192:195], a[68:71], v[56:59], v[192:195]
 buffer_load_dwordx4 v3, s[8:11], s21 offen offset:3072 sc1 lds
M v[196:199], a[68:71], v[60:63], 0
 v_exp_f32 v23, v105
M v[196:199], a[64:67], v[44:47], v[196:199]
 s_add_u32 m0, s28, 36864
 ds_read_b128 a[104:107], v2 offset:26624
 ds_read_b128 a[108:111], v2 offset:27648
M v[200:203], a[72:75], v[40:43], 0
 buffer_load_dwordx4 v4, s[8:11], s21 offen offset:0 sc1 lds
M v[200:203], a[76:79], v[56:59], v[200:203]
 v_add_f32 v30, v26, v30
 v_add_f32 v31, v27, v31
M v[204:207], a[76:79], v[60:63], 0
 ds_read_b128 a[112:115], v2 offset:28672
 ds_read_b128 a[116:119], v2 offset:29696
M v[204:207], a[72:75], v[44:47], v[204:207]
 buffer_load_dwordx4 v4, s[8:11], s21 offen offset:1024 sc1 lds
M v[208:211], a[80:83], v[40:43], 0
 v_exp_f32 v24, v106
M v[208:211], a[84:87], v[56:59], v[208:211]
 ds_read_b128 a[120:123], v2 offset:30720
 ds_read_b128 a[124:127], v2 offset:31744
M v[212:215], a[84:87], v[60:63], 0
 buffer_load_dwordx4 v4, s[8:11], s21 offen offset:2048 sc1 lds
M v[212:215], a[80:83], v[44:47], v[212:215]
 v_exp_f32 v25, v107
M v[216:219], a[88:91], v[40:43], 0
 v_add_f32 v28, v18, v19
 v_cvt_pk_bf16_f32 v48, v18, v19
M v[216:219], a[92:95], v[56:59], v[216:219]
 buffer_load_dwordx4 v4, s[8:11], s21 offen offset:3072 sc1 lds
M v[220:223], a[92:95], v[60:63], 0
 s_waitcnt vmcnt(16) lgkmcnt(0)
 s_add_u32 s24, s23, 16777216
 s_mov_b32 s23, s21
M v[220:223], a[88:91], v[44:47], v[220:223]
 s_barrier
M v[224:227], a[96:99], v[40:43], 0
 ds_read_b128 a[64:67], v2 offset:32768
 ds_read_b128 a[68:71], v2 offset:33792
M v[224:227], a[100:103], v[56:59], v[224:227]
 s_add_u32 s21, s21, 32768
 v_add_f32 v28, v20, v28
M v[228:231], a[100:103], v[60:63], 0
 s_add_u32 s22, s22, 1
 v_exp_f32 v18, v100
M v[228:231], a[96:99], v[44:47], v[228:231]
 s_cmp_eq_u32 s22, s25
 ds_read_b128 a[72:75], v2 offset:34816
 ds_read_b128 a[76:79], v2 offset:35840
M v[232:235], a[104:107], v[40:43], 0
 s_cselect_b32 s21, s26, s21
 v_exp_f32 v19, v101
M v[232:235], a[108:111], v[56:59], v[232:235]
 s_cmp_eq_u32 s22, s43
 v_cvt_pk_bf16_f32 v49, v20, v21
 v_add_f32 v28, v21, v28
M v[236:239], a[108:111], v[60:63], 0
 s_cselect_b32 s21, s4, s21
 ds_read_b128 a[80:83], v2 offset:36864
 ds_read_b128 a[84:87], v2 offset:37888
M v[236:239], a[104:107], v[44:47], v[236:239]
 s_cmp_eq_u32 s22, s6
 v_exp_f32 v20, v102
M v[240:243], a[112:115], v[40:43], 0
 s_cselect_b32 s21, s7, s21
 v_exp_f32 v21, v103
M v[240:243], a[116:119], v[56:59], v[240:243]
 ds_read_b128 a[88:91], v2 offset:38912
 ds_read_b128 a[92:95], v2 offset:39936
M v[244:247], a[116:119], v[60:63], 0
 v_add_f32 v28, v22, v28
 v_cvt_pk_bf16_f32 v50, v22, v23
M v[244:247], a[112:115], v[44:47], v[244:247]
 v_add_f32 v28, v23, v28
 v_add_f32 v28, v24, v28
M v[248:251], a[120:123], v[40:43], 0
 v_exp_f32 v22, v108
M v[248:251], a[124:127], v[56:59], v[248:251]
 s_cmp_lg_u32 s27, 0
 v_exp_f32 v23, v109
M v[252:255], a[124:127], v[60:63], 0
 s_waitcnt lgkmcnt(0)
 v_cvt_pk_bf16_f32 v51, v24, v25
 v_add_f32 v28, v25, v28
M v[252:255], a[120:123], v[44:47], v[252:255]
 v_exp_f32 v24, v110
 v_add_f32 v29, v18, v19
 v_cvt_pk_bf16_f32 v52, v18, v19
 v_add_f32 v29, v20, v29
 v_cvt_pk_bf16_f32 v53, v20, v21
 v_add_f32 v29, v21, v29
 v_exp_f32 v25, v111
 v_add_f32 v29, v22, v29
 v_cvt_pk_bf16_f32 v54, v22, v23
 v_add_f32 v29, v23, v29
 v_add_f32 v29, v24, v29
 v_cvt_pk_bf16_f32 v55, v24, v25
 v_add_f32 v29, v25, v29
 s_cbranch_scc1 L_loop_top
L_final_h:
 s_waitcnt vmcnt(8)
 s_barrier
 ds_read_b128 a[64:67], v7 offset:0
 ds_read_b128 a[68:71], v7 offset:1024
 ds_read_b128 a[72:75], v7 offset:2048
 ds_read_b128 a[76:79], v7 offset:3072
 ds_read_b128 a[80:83], v7 offset:4096
 ds_read_b128 a[84:87], v7 offset:5120
 ds_read_b128 a[88:91], v7 offset:6144
 ds_read_b128 a[92:95], v7 offset:7168
 s_add_u32 m0, s28, 65536
 v_exp_f32 v18, v112
 buffer_load_dwordx4 v3, s[8:11], s38 offen offset:0 sc1 lds
 v_exp_f32 v19, v113
 v_exp_f32 v20, v114
 v_add_f32 v28, v18, v28
 v_cvt_pk_bf16_f32 v56, v18, v19
 buffer_load_dwordx4 v3, s[8:11], s38 offen offset:1024 sc1 lds
 v_exp_f32 v21, v115
 v_add_f32 v28, v19, v28
 v_exp_f32 v22, v120
 v_add_f32 v28, v20, v28
 v_cvt_pk_bf16_f32 v57, v20, v21
 buffer_load_dwordx4 v3, s[8:11], s38 offen offset:2048 sc1 lds
 v_exp_f32 v23, v121
 v_add_f32 v28, v21, v28
 v_exp_f32 v24, v122
 v_add_f32 v28, v22, v28
 v_cvt_pk_bf16_f32 v58, v22, v23
 buffer_load_dwordx4 v3, s[8:11], s38 offen offset:3072 sc1 lds
 v_exp_f32 v25, v123
 v_add_f32 v28, v23, v28
 v_exp_f32 v18, v116
 v_add_f32 v28, v24, v28
 s_add_u32 m0, s28, 69632
 v_cvt_pk_bf16_f32 v59, v24, v25
 buffer_load_dwordx4 v4, s[8:11], s38 offen offset:0 sc1 lds
 v_exp_f32 v19, v117
 v_add_f32 v28, v25, v28
 v_exp_f32 v20, v118
 v_add_f32 v29, v18, v29
 v_cvt_pk_bf16_f32 v60, v18, v19
 buffer_load_dwordx4 v4, s[8:11], s38 offen offset:1024 sc1 lds
 v_exp_f32 v21, v119
 v_add_f32 v29, v19, v29
 v_exp_f32 v22, v124
 v_add_f32 v29, v20, v29
 v_cvt_pk_bf16_f32 v61, v20, v21
 buffer_load_dwordx4 v4, s[8:11], s38 offen offset:2048 sc1 lds
 v_exp_f32 v23, v125
 v_add_f32 v29, v21, v29
 v_exp_f32 v24, v126
 v_add_f32 v29, v22, v29
 v_cvt_pk_bf16_f32 v62, v22, v23
 buffer_load_dwordx4 v4, s[8:11], s38 offen offset:3072 sc1 lds
 s_add_u32 s38, s38, 32768
 v_exp_f32 v25, v127
 v_add_f32 v29, v23, v29
 v_add_f32 v29, v24, v29
 v_cvt_pk_bf16_f32 v63, v24, v25
 v_add_f32 v29, v25, v29
 v_max_f32 v10, v28, v29
 v_cmp_lt_f32 vcc, s31, v10
 s_nop 0
 s_cbranch_vccnz L_st4
L_rt4:
 v_add_f32 v30, v28, v30
 v_add_f32 v31, v29, v31
 v_mov_b32 v12, v32
 v_mov_b32 v13, v36
 v_mov_b32 v14, v30
 v_mov_b32 v15, v31
 buffer_store_dwordx4 v[12:15], v7, s[8:11], s52 offen sc1
 s_waitcnt lgkmcnt(0)
M v[128:131], a[64:67], v[48:51], v[128:131]
 ds_read_b128 a[96:99], v7 offset:8192
M v[128:131], a[68:71], v[56:59], v[128:131]
 ds_read_b128 a[100:103], v7 offset:9216
M v[132:135], a[68:71], v[60:63], v[132:135]
M v[132:135], a[64:67], v[52:55], v[132:135]
 ds_read_b128 a[104:107], v7 offset:10240
M v[136:139], a[72:75], v[48:51], v[136:139]
 ds_read_b128 a[108:111], v7 offset:11264
M v[136:139], a[76:79], v[56:59], v[136:139]
M v[140:143], a[76:79], v[60:63], v[140:143]
 ds_read_b128 a[112:115], v7 offset:12288
M v[140:143], a[72:75], v[52:55], v[140:143]
 ds_read_b128 a[116:119], v7 offset:13312
M v[144:147], a[80:83], v[48:51], v[144:147]
M v[144:147], a[84:87], v[56:59], v[144:147]
 ds_read_b128 a[120:123], v7 offset:14336
 v_cvt_pk_bf16_f32 v128, v128, v129
M v[148:151], a[84:87], v[60:63], v[148:151]
 ds_read_b128 a[124:127], v7 offset:15360
 v_cvt_pk_bf16_f32 v129, v130, v131
M v[148:151], a[80:83], v[52:55], v[148:151]
 v_cvt_pk_bf16_f32 v130, v136, v137
 v_cvt_pk_bf16_f32 v131, v138, v139
M v[152:155], a[88:91], v[48:51], v[152:155]
 buffer_store_dwordx4 v[128:131], v7, s[8:11], s12 offen offset:0 sc1
M v[152:155], a[92:95], v[56:59], v[152:155]
 v_cvt_pk_bf16_f32 v132, v132, v133
 v_cvt_pk_bf16_f32 v133, v134, v135
M v[156:159], a[92:95], v[60:63], v[156:159]
 v_cvt_pk_bf16_f32 v134, v140, v141
 v_cvt_pk_bf16_f32 v135, v142, v143
M v[156:159], a[88:91], v[52:55], v[156:159]
 s_waitcnt lgkmcnt(0)
M v[160:163], a[96:99], v[48:51], v[160:163]
 ds_read_b128 a[64:67], v7 offset:16384
M v[160:163], a[100:103], v[56:59], v[160:163]
 ds_read_b128 a[68:71], v7 offset:17408
M v[164:167], a[100:103], v[60:63], v[164:167]
 buffer_store_dwordx4 v[132:135], v7, s[8:11], s14 offen offset:0 sc1
M v[164:167], a[96:99], v[52:55], v[164:167]
 ds_read_b128 a[72:75], v7 offset:18432
 v_cvt_pk_bf16_f32 v144, v144, v145
M v[168:171], a[104:107], v[48:51], v[168:171]
 ds_read_b128 a[76:79], v7 offset:19456
 v_cvt_pk_bf16_f32 v145, v146, v147
M v[168:171], a[108:111], v[56:59], v[168:171]
 v_cvt_pk_bf16_f32 v146, v152, v153
 v_cvt_pk_bf16_f32 v147, v154, v155
M v[172:175], a[108:111], v[60:63], v[172:175]
 ds_read_b128 a[80:83], v7 offset:20480
M v[172:175], a[104:107], v[52:55], v[172:175]
 ds_read_b128 a[84:87], v7 offset:21504
M v[176:179], a[112:115], v[48:51], v[176:179]
 buffer_store_dwordx4 v[144:147], v7, s[8:11], s12 offen offset:1024 sc1
M v[176:179], a[116:119], v[56:59], v[176:179]
 ds_read_b128 a[88:91], v7 offset:22528
 v_cvt_pk_bf16_f32 v148, v148, v149
M v[180:183], a[116:119], v[60:63], v[180:183]
 ds_read_b128 a[92:95], v7 offset:23552
 v_cvt_pk_bf16_f32 v149, v150, v151
M v[180:183], a[112:115], v[52:55], v[180:183]
 v_cvt_pk_bf16_f32 v150, v156, v157
 v_cvt_pk_bf16_f32 v151, v158, v159
M v[184:187], a[120:123], v[48:51], v[184:187]
 buffer_store_dwordx4 v[148:151], v7, s[8:11], s14 offen offset:1024 sc1
M v[184:187], a[124:127], v[56:59], v[184:187]
 v_cvt_pk_bf16_f32 v160, v160, v161
 v_cvt_pk_bf16_f32 v161, v162, v163
M v[188:191], a[124:127], v[60:63], v[188:191]
 v_cvt_pk_bf16_f32 v162, v168, v169
 v_cvt_pk_bf16_f32 v163, v170, v171
M v[188:191], a[120:123], v[52:55], v[188:191]
 s_waitcnt lgkmcnt(0)
M v[192:195], a[64:67], v[48:51], v[192:195]
 ds_read_b128 a[96:99], v7 offset:24576
M v[192:195], a[68:71], v[56:59], v[192:195]
 ds_read_b128 a[100:103], v7 offset:25600
M v[196:199], a[68:71], v[60:63], v[196:199]
 buffer_store_dwordx4 v[160:163], v7, s[8:11], s12 offen offset:2048 sc1
M v[196:199], a[64:67], v[52:55], v[196:199]
 ds_read_b128 a[104:107], v7 offset:26624
 v_cvt_pk_bf16_f32 v164, v164, v165
M v[200:203], a[72:75], v[48:51], v[200:203]
 ds_read_b128 a[108:111], v7 offset:27648
 v_cvt_pk_bf16_f32 v165, v166, v167
M v[200:203], a[76:79], v[56:59], v[200:203]
 v_cvt_pk_bf16_f32 v166, v172, v173
 v_cvt_pk_bf16_f32 v167, v174, v175
M v[204:207], a[76:79], v[60:63], v[204:207]
 ds_read_b128 a[112:115], v7 offset:28672
M v[204:207], a[72:75], v[52:55], v[204:207]
 ds_read_b128 a[116:119], v7 offset:29696
M v[208:211], a[80:83], v[48:51], v[208:211]
 buffer_store_dwordx4 v[164:167], v7, s[8:11], s14 offen offset:2048 sc1
M v[208:211], a[84:87], v[56:59], v[208:211]
 ds_read_b128 a[120:123], v7 offset:30720
 v_cvt_pk_bf16_f32 v176, v176, v177
M v[212:215], a[84:87], v[60:63], v[212:215]
 ds_read_b128 a[124:127], v7 offset:31744
 v_cvt_pk_bf16_f32 v177, v178, v179
M v[212:215], a[80:83], v[52:55], v[212:215]
 v_cvt_pk_bf16_f32 v178, v184, v185
 v_cvt_pk_bf16_f32 v179, v186, v187
M v[216:219], a[88:91], v[48:51], v[216:219]
 buffer_store_dwordx4 v[176:179], v7, s[8:11], s12 offen offset:3072 sc1
M v[216:219], a[92:95], v[56:59], v[216:219]
 v_cvt_pk_bf16_f32 v180, v180, v181
 v_cvt_pk_bf16_f32 v181, v182, v183
M v[220:223], a[92:95], v[60:63], v[220:223]
 s_waitcnt lgkmcnt(0)
 v_cvt_pk_bf16_f32 v182, v188, v189
 v_cvt_pk_bf16_f32 v183, v190, v191
M v[220:223], a[88:91], v[52:55], v[220:223]
 s_barrier
M v[224:227], a[96:99], v[48:51], v[224:227]
 ds_read_b128 a[64:67], v2 offset:32768
M v[224:227], a[100:103], v[56:59], v[224:227]
 ds_read_b128 a[68:71], v2 offset:33792
M v[228:231], a[100:103], v[60:63], v[228:231]
 buffer_store_dwordx4 v[180:183], v7, s[8:11], s14 offen offset:3072 sc1
M v[228:231], a[96:99], v[52:55], v[228:231]
 ds_read_b128 a[72:75], v2 offset:34816
 v_cvt_pk_bf16_f32 v192, v192, v193
M v[232:235], a[104:107], v[48:51], v[232:235]
 ds_read_b128 a[76:79], v2 offset:35840
 v_cvt_pk_bf16_f32 v193, v194, v195
M v[232:235], a[108:111], v[56:59], v[232:235]
 v_cvt_pk_bf16_f32 v194, v200, v201
 v_cvt_pk_bf16_f32 v195, v202, v203
M v[236:239], a[108:111], v[60:63], v[236:239]
 ds_read_b128 a[80:83], v2 offset:36864
M v[236:239], a[104:107], v[52:55], v[236:239]
 ds_read_b128 a[84:87], v2 offset:37888
M v[240:243], a[112:115], v[48:51], v[240:243]
 buffer_store_dwordx4 v[192:195], v7, s[8:11], s13 offen offset:0 sc1
M v[240:243], a[116:119], v[56:59], v[240:243]
 ds_read_b128 a[88:91], v2 offset:38912
 v_cvt_pk_bf16_f32 v196, v196, v197
M v[244:247], a[116:119], v[60:63], v[244:247]
 ds_read_b128 a[92:95], v2 offset:39936
 v_cvt_pk_bf16_f32 v197, v198, v199
M v[244:247], a[112:115], v[52:55], v[244:247]
 v_cvt_pk_bf16_f32 v198, v204, v205
 v_cvt_pk_bf16_f32 v199, v206, v207
M v[248:251], a[120:123], v[48:51], v[248:251]
 buffer_store_dwordx4 v[196:199], v7, s[8:11], s15 offen offset:0 sc1
M v[248:251], a[124:127], v[56:59], v[248:251]
 v_cvt_pk_bf16_f32 v208, v208, v209
 v_cvt_pk_bf16_f32 v209, v210, v211
M v[252:255], a[124:127], v[60:63], v[252:255]
 s_waitcnt lgkmcnt(0)
 v_cvt_pk_bf16_f32 v210, v216, v217
 v_cvt_pk_bf16_f32 v211, v218, v219
M v[252:255], a[120:123], v[52:55], v[252:255]
 buffer_store_dwordx4 v[208:211], v7, s[8:11], s13 offen offset:1024 sc1
 v_cvt_pk_bf16_f32 v212, v212, v213
 v_cvt_pk_bf16_f32 v213, v214, v215
 v_cvt_pk_bf16_f32 v214, v220, v221
 v_cvt_pk_bf16_f32 v215, v222, v223
 buffer_store_dwordx4 v[212:215], v7, s[8:11], s15 offen offset:1024 sc1
 v_cvt_pk_bf16_f32 v224, v224, v225
 v_cvt_pk_bf16_f32 v225, v226, v227
 v_cvt_pk_bf16_f32 v226, v232, v233
 v_cvt_pk_bf16_f32 v227, v234, v235
 buffer_store_dwordx4 v[224:227], v7, s[8:11], s13 offen offset:2048 sc1
 v_cvt_pk_bf16_f32 v228, v228, v229
 v_cvt_pk_bf16_f32 v229, v230, v231
 v_cvt_pk_bf16_f32 v230, v236, v237
 v_cvt_pk_bf16_f32 v231, v238, v239
 buffer_store_dwordx4 v[228:231], v7, s[8:11], s15 offen offset:2048 sc1
 v_cvt_pk_bf16_f32 v240, v240, v241
 v_cvt_pk_bf16_f32 v241, v242, v243
 v_cvt_pk_bf16_f32 v242, v248, v249
 v_cvt_pk_bf16_f32 v243, v250, v251
 buffer_store_dwordx4 v[240:243], v7, s[8:11], s13 offen offset:3072 sc1
 v_cvt_pk_bf16_f32 v244, v244, v245
 v_cvt_pk_bf16_f32 v245, v246, v247
 v_cvt_pk_bf16_f32 v246, v252, v253
 v_cvt_pk_bf16_f32 v247, v254, v255
 buffer_store_dwordx4 v[244:247], v7, s[8:11], s15 offen offset:3072 sc1
M v[64:67], a[64:67], a[128:131], 0
 ds_read_b128 a[96:99], v2 offset:40960
M v[64:67], a[68:71], a[132:135], v[64:67]
 s_add_u32 m0, s28, 0
 ds_read_b128 a[100:103], v2 offset:41984
M v[64:67], a[72:75], a[136:139], v[64:67]
 buffer_load_dwordx4 v3, s[8:11], s38 offen offset:0 sc1 lds
M v[64:67], a[76:79], a[140:143], v[64:67]
 ds_read_b128 a[104:107], v2 offset:43008
 v_accvgpr_read_b32 v5, a192
M v[64:67], a[80:83], a[144:147], v[64:67]
 ds_read_b128 a[108:111], v2 offset:44032
 v_accvgpr_read_b32 v6, a193
M v[64:67], a[84:87], a[148:151], v[64:67]
 buffer_load_dwordx4 v3, s[8:11], s38 offen offset:1024 sc1 lds
M v[64:67], a[88:91], a[152:155], v[64:67]
 ds_read_b128 a[112:115], v2 offset:45056
M v[64:67], a[92:95], a[156:159], v[64:67]
 ds_read_b128 a[116:119], v2 offset:46080
M v[68:71], a[92:95], a[188:191], 0
 buffer_load_dwordx4 v3, s[8:11], s38 offen offset:2048 sc1 lds
M v[68:71], a[88:91], a[184:187], v[68:71]
 ds_read_b128 a[120:123], v2 offset:47104
M v[68:71], a[84:87], a[180:183], v[68:71]
 ds_read_b128 a[124:127], v2 offset:48128
M v[68:71], a[80:83], a[176:179], v[68:71]
M v[68:71], a[76:79], a[172:175], v[68:71]
 buffer_load_dwordx4 v3, s[8:11], s38 offen offset:3072 sc1 lds
M v[68:71], a[72:75], a[168:171], v[68:71]
M v[68:71], a[68:71], a[164:167], v[68:71]
M v[68:71], a[64:67], a[160:163], v[68:71]
 s_waitcnt lgkmcnt(0)
M v[72:75], a[96:99], a[128:131], 0
 ds_read_b128 a[64:67], v2 offset:49152
M v[72:75], a[100:103], a[132:135], v[72:75]
 s_add_u32 m0, s28, 4096
 ds_read_b128 a[68:71], v2 offset:50176
M v[72:75], a[104:107], a[136:139], v[72:75]
 buffer_load_dwordx4 v4, s[8:11], s38 offen offset:0 sc1 lds
M v[72:75], a[108:111], a[140:143], v[72:75]
 ds_read_b128 a[72:75], v2 offset:51200
M v[72:75], a[112:115], a[144:147], v[72:75]
 ds_read_b128 a[76:79], v2 offset:52224
M v[72:75], a[116:119], a[148:151], v[72:75]
 buffer_load_dwordx4 v4, s[8:11], s38 offen offset:1024 sc1 lds
M v[72:75], a[120:123], a[152:155], v[72:75]
 ds_read_b128 a[80:83], v2 offset:53248
M v[72:75], a[124:127], a[156:159], v[72:75]
 ds_read_b128 a[84:87], v2 offset:54272
M v[76:79], a[124:127], a[188:191], 0
 buffer_load_dwordx4 v4, s[8:11], s38 offen offset:2048 sc1 lds
M v[76:79], a[120:123], a[184:187], v[76:79]
 ds_read_b128 a[88:91], v2 offset:55296
M v[76:79], a[116:119], a[180:183], v[76:79]
 ds_read_b128 a[92:95], v2 offset:56320
M v[76:79], a[112:115], a[176:179], v[76:79]
 buffer_load_dwordx4 v4, s[8:11], s38 offen offset:3072 sc1 lds
M v[76:79], a[108:111], a[172:175], v[76:79]
M v[76:79], a[104:107], a[168:171], v[76:79]
M v[76:79], a[100:103], a[164:167], v[76:79]
M v[76:79], a[96:99], a[160:163], v[76:79]
 s_waitcnt lgkmcnt(0)
M v[80:83], a[64:67], a[128:131], 0
 s_add_u32 s38, s38, 32768
 ds_read_b128 a[96:99], v2 offset:57344
M v[80:83], a[68:71], a[132:135], v[80:83]
 s_add_u32 m0, s28, 131072
 ds_read_b128 a[100:103], v2 offset:58368
M v[80:83], a[72:75], a[136:139], v[80:83]
 buffer_load_dwordx4 v3, s[8:11], s38 offen offset:0 sc1 lds
M v[80:83], a[76:79], a[140:143], v[80:83]
 ds_read_b128 a[104:107], v2 offset:59392
M v[80:83], a[80:83], a[144:147], v[80:83]
 ds_read_b128 a[108:111], v2 offset:60416
M v[80:83], a[84:87], a[148:151], v[80:83]
 buffer_load_dwordx4 v3, s[8:11], s38 offen offset:1024 sc1 lds
M v[80:83], a[88:91], a[152:155], v[80:83]
 ds_read_b128 a[112:115], v2 offset:61440
M v[80:83], a[92:95], a[156:159], v[80:83]
 ds_read_b128 a[116:119], v2 offset:62464
M v[84:87], a[92:95], a[188:191], 0
 buffer_load_dwordx4 v3, s[8:11], s38 offen offset:2048 sc1 lds
M v[84:87], a[88:91], a[184:187], v[84:87]
 ds_read_b128 a[120:123], v2 offset:63488
M v[84:87], a[84:87], a[180:183], v[84:87]
 ds_read_b128 a[124:127], v2 offset:64512
M v[84:87], a[80:83], a[176:179], v[84:87]
 buffer_load_dwordx4 v3, s[8:11], s38 offen offset:3072 sc1 lds
M v[84:87], a[76:79], a[172:175], v[84:87]
M v[84:87], a[72:75], a[168:171], v[84:87]
M v[84:87], a[68:71], a[164:167], v[84:87]
 s_waitcnt vmcnt(12) lgkmcnt(0)
M v[84:87], a[64:67], a[160:163], v[84:87]
 s_barrier
M v[88:91], a[96:99], a[128:131], 0
 s_xor_b32 s47, s47, 64
 ds_read_b128 a[64:67], v7 offset:32768
M v[88:91], a[100:103], a[132:135], v[88:91]
 ds_read_b128 a[68:71], v7 offset:33792
 v_mov_b32 v18, 1
M v[88:91], a[104:107], a[136:139], v[88:91]
 buffer_store_dword v18, v1, s[8:11], s47 offen sc1
M v[88:91], a[108:111], a[140:143], v[88:91]
 ds_read_b128 a[72:75], v7 offset:34816
M v[88:91], a[112:115], a[144:147], v[88:91]
 s_add_u32 m0, s28, 135168
 ds_read_b128 a[76:79], v7 offset:35840
M v[88:91], a[116:119], a[148:151], v[88:91]
 buffer_load_dwordx4 v4, s[8:11], s38 offen offset:0 sc1 lds
M v[88:91], a[120:123], a[152:155], v[88:91]
 ds_read_b128 a[80:83], v7 offset:36864
M v[88:91], a[124:127], a[156:159], v[88:91]
 ds_read_b128 a[84:87], v7 offset:37888
M v[92:95], a[124:127], a[188:191], 0
 buffer_load_dwordx4 v4, s[8:11], s38 offen offset:1024 sc1 lds
M v[92:95], a[120:123], a[184:187], v[92:95]
 ds_read_b128 a[88:91], v7 offset:38912
M v[92:95], a[116:119], a[180:183], v[92:95]
 ds_read_b128 a[92:95], v7 offset:39936
M v[92:95], a[112:115], a[176:179], v[92:95]
 buffer_load_dwordx4 v4, s[8:11], s38 offen offset:2048 sc1 lds
M v[92:95], a[108:111], a[172:175], v[92:95]
M v[92:95], a[104:107], a[168:171], v[92:95]
 buffer_load_dwordx4 v4, s[8:11], s38 offen offset:3072 sc1 lds
M v[92:95], a[100:103], a[164:167], v[92:95]
 s_waitcnt lgkmcnt(0)
M v[92:95], a[96:99], a[160:163], v[92:95]
 s_add_u32 s38, s38, 32768
M v[96:99], a[64:67], a[128:131], 0
 s_add_u32 m0, s28, 98304
 ds_read_b128 a[96:99], v7 offset:40960
M v[96:99], a[68:71], a[132:135], v[96:99]
 ds_read_b128 a[100:103], v7 offset:41984
M v[96:99], a[72:75], a[136:139], v[96:99]
 buffer_load_dwordx4 v3, s[8:11], s38 offen offset:0 sc1 lds
M v[96:99], a[76:79], a[140:143], v[96:99]
 ds_read_b128 a[104:107], v7 offset:43008
 s_add_u32 s29, s33, 0
M v[96:99], a[80:83], a[144:147], v[96:99]
 ds_read_b128 a[108:111], v7 offset:44032
 s_add_u32 s30, s33, 14336
M v[96:99], a[84:87], a[148:151], v[96:99]
 buffer_load_dwordx4 v3, s[8:11], s38 offen offset:1024 sc1 lds
M v[96:99], a[88:91], a[152:155], v[96:99]
 ds_read_b128 a[112:115], v7 offset:45056
 v_max3_f32 v32, |v64|, |v65|, |v66|
M v[96:99], a[92:95], a[156:159], v[96:99]
 ds_read_b128 a[116:119], v7 offset:46080
 v_max3_f32 v32, |v67|, |v72|, v32
M v[100:103], a[92:95], a[188:191], 0
 buffer_load_dwordx4 v3, s[8:11], s38 offen offset:2048 sc1 lds
M v[100:103], a[88:91], a[184:187], v[100:103]
 ds_read_b128 a[120:123], v7 offset:47104
 v_max3_f32 v32, |v73|, |v74|, v32
M v[100:103], a[84:87], a[180:183], v[100:103]
 ds_read_b128 a[124:127], v7 offset:48128
 v_mul_f32 v32, 2.0, v32
M v[100:103], a[80:83], a[176:179], v[100:103]
 buffer_load_dwordx4 v3, s[8:11], s38 offen offset:3072 sc1 lds
M v[100:103], a[76:79], a[172:175], v[100:103]
 s_add_u32 m0, s28, 102400
 v_mov_b32 v33, v32
 v_mov_b32 v34, v32
M v[100:103], a[72:75], a[168:171], v[100:103]
 buffer_load_dwordx4 v4, s[8:11], s38 offen offset:0 sc1 lds
M v[100:103], a[68:71], a[164:167], v[100:103]
 v_mov_b32 v35, v32
 v_mul_f32 v28, -v32, v5
M v[100:103], a[64:67], a[160:163], v[100:103]
 s_waitcnt lgkmcnt(0)
 v_mul_f32 v64, v5, v64
 v_mul_f32 v65, v5, v65
M v[104:107], a[96:99], a[128:131], 0
 ds_read_b128 a[64:67], v7 offset:49152
 v_mul_f32 v66, v5, v66
M v[104:107], a[100:103], a[132:135], v[104:107]
 ds_read_b128 a[68:71], v7 offset:50176
 v_mul_f32 v67, v5, v67
M v[104:107], a[104:107], a[136:139], v[104:107]
 buffer_load_dwordx4 v4, s[8:11], s38 offen offset:1024 sc1 lds
M v[104:107], a[108:111], a[140:143], v[104:107]
 ds_read_b128 a[72:75], v7 offset:51200
 v_mul_f32 v72, v5, v72
M v[104:107], a[112:115], a[144:147], v[104:107]
 ds_read_b128 a[76:79], v7 offset:52224
 v_mul_f32 v73, v5, v73
M v[104:107], a[116:119], a[148:151], v[104:107]
 buffer_load_dwordx4 v4, s[8:11], s38 offen offset:2048 sc1 lds
M v[104:107], a[120:123], a[152:155], v[104:107]
 ds_read_b128 a[80:83], v7 offset:53248
 v_mul_f32 v74, v5, v74
M v[104:107], a[124:127], a[156:159], v[104:107]
 ds_read_b128 a[84:87], v7 offset:54272
 v_mul_f32 v75, v5, v75
M v[108:111], a[124:127], a[188:191], 0
 buffer_load_dwordx4 v4, s[8:11], s38 offen offset:3072 sc1 lds
M v[108:111], a[120:123], a[184:187], v[108:111]
 s_add_u32 s38, s38, 32768
 ds_read_b128 a[88:91], v7 offset:55296
 v_cvt_pk_bf16_f32 v64, v64, v65
M v[108:111], a[116:119], a[180:183], v[108:111]
 ds_read_b128 a[92:95], v7 offset:56320
 v_cvt_pk_bf16_f32 v65, v66, v67
M v[108:111], a[112:115], a[176:179], v[108:111]
 v_cvt_pk_bf16_f32 v66, v72, v73
 v_cvt_pk_bf16_f32 v67, v74, v75
M v[108:111], a[108:111], a[172:175], v[108:111]
 buffer_store_dwordx4 v[64:67], v7, s[8:11], s29 offen offset:0 sc1
M v[108:111], a[104:107], a[168:171], v[108:111]
 v_max3_f32 v36, |v68|, |v69|, |v70|
 v_max3_f32 v36, |v71|, |v76|, v36
M v[108:111], a[100:103], a[164:167], v[108:111]
 v_max3_f32 v36, |v77|, |v78|, v36
 v_mul_f32 v36, 2.0, v36
M v[108:111], a[96:99], a[160:163], v[108:111]
 s_waitcnt lgkmcnt(0)
 v_mov_b32 v37, v36
 v_mov_b32 v38, v36
M v[112:115], a[64:67], a[128:131], 0
 ds_read_b128 a[96:99], v7 offset:57344
 v_mov_b32 v39, v36
M v[112:115], a[68:71], a[132:135], v[112:115]
 ds_read_b128 a[100:103], v7 offset:58368
 v_mul_f32 v29, -v36, v6
M v[112:115], a[72:75], a[136:139], v[112:115]
 v_mul_f32 v68, v6, v68
 v_mul_f32 v69, v6, v69
M v[112:115], a[76:79], a[140:143], v[112:115]
 ds_read_b128 a[104:107], v7 offset:59392
 v_mul_f32 v70, v6, v70
M v[112:115], a[80:83], a[144:147], v[112:115]
 ds_read_b128 a[108:111], v7 offset:60416
 v_mul_f32 v71, v6, v71
M v[112:115], a[84:87], a[148:151], v[112:115]
 v_mul_f32 v76, v6, v76
 v_mul_f32 v77, v6, v77
M v[112:115], a[88:91], a[152:155], v[112:115]
 ds_read_b128 a[112:115], v7 offset:61440
 v_mul_f32 v78, v6, v78
M v[112:115], a[92:95], a[156:159], v[112:115]
 ds_read_b128 a[116:119], v7 offset:62464
 v_mul_f32 v79, v6, v79
M v[116:119], a[92:95], a[188:191], 0
 v_cvt_pk_bf16_f32 v68, v68, v69
 v_cvt_pk_bf16_f32 v69, v70, v71
M v[116:119], a[88:91], a[184:187], v[116:119]
 ds_read_b128 a[120:123], v7 offset:63488
 v_cvt_pk_bf16_f32 v70, v76, v77
M v[116:119], a[84:87], a[180:183], v[116:119]
 ds_read_b128 a[124:127], v7 offset:64512
 v_cvt_pk_bf16_f32 v71, v78, v79
M v[116:119], a[80:83], a[176:179], v[116:119]
 buffer_store_dwordx4 v[68:71], v7, s[8:11], s30 offen offset:0 sc1
M v[116:119], a[76:79], a[172:175], v[116:119]
 v_mul_f32 v80, v5, v80
 v_mul_f32 v81, v5, v81
M v[116:119], a[72:75], a[168:171], v[116:119]
 v_mul_f32 v82, v5, v82
 v_mul_f32 v83, v5, v83
M v[116:119], a[68:71], a[164:167], v[116:119]
 s_waitcnt lgkmcnt(0)
 v_mul_f32 v88, v5, v88
 v_mul_f32 v89, v5, v89
M v[116:119], a[64:67], a[160:163], v[116:119]
 s_barrier
M v[120:123], a[96:99], a[128:131], 0
 ds_read_b128 a[64:67], v2 offset:0
 v_mul_f32 v90, v5, v90
M v[120:123], a[100:103], a[132:135], v[120:123]
 ds_read_b128 a[68:71], v2 offset:1024
 v_mul_f32 v91, v5, v91
M v[120:123], a[104:107], a[136:139], v[120:123]
 v_cvt_pk_bf16_f32 v80, v80, v81
 v_cvt_pk_bf16_f32 v81, v82, v83
M v[120:123], a[108:111], a[140:143], v[120:123]
 ds_read_b128 a[72:75], v2 offset:2048
 v_cvt_pk_bf16_f32 v82, v88, v89
M v[120:123], a[112:115], a[144:147], v[120:123]
 ds_read_b128 a[76:79], v2 offset:3072
 v_cvt_pk_bf16_f32 v83, v90, v91
M v[120:123], a[116:119], a[148:151], v[120:123]
 buffer_store_dwordx4 v[80:83], v7, s[8:11], s29 offen offset:1024 sc1
M v[120:123], a[120:123], a[152:155], v[120:123]
 ds_read_b128 a[80:83], v2 offset:4096
 v_mul_f32 v84, v6, v84
M v[120:123], a[124:127], a[156:159], v[120:123]
 ds_read_b128 a[84:87], v2 offset:5120
 v_mul_f32 v85, v6, v85
M v[124:127], a[124:127], a[188:191], 0
 v_mul_f32 v86, v6, v86
 v_mul_f32 v87, v6, v87
M v[124:127], a[120:123], a[184:187], v[124:127]
 ds_read_b128 a[88:91], v2 offset:6144
 v_mul_f32 v92, v6, v92
M v[124:127], a[116:119], a[180:183], v[124:127]
 ds_read_b128 a[92:95], v2 offset:7168
 v_mul_f32 v93, v6, v93
M v[124:127], a[112:115], a[176:179], v[124:127]
 v_mul_f32 v94, v6, v94
 v_mul_f32 v95, v6, v95
M v[124:127], a[108:111], a[172:175], v[124:127]
 v_cvt_pk_bf16_f32 v84, v84, v85
 v_cvt_pk_bf16_f32 v85, v86, v87
M v[124:127], a[104:107], a[168:171], v[124:127]
 v_cvt_pk_bf16_f32 v86, v92, v93
 v_cvt_pk_bf16_f32 v87, v94, v95
M v[124:127], a[100:103], a[164:167], v[124:127]
 s_waitcnt lgkmcnt(0)
M v[124:127], a[96:99], a[160:163], v[124:127]
 buffer_store_dwordx4 v[84:87], v7, s[8:11], s30 offen offset:1024 sc1
M v[64:67], a[64:67], a[128:131], v[32:35]
 s_add_u32 m0, s28, 32768
 ds_read_b128 a[96:99], v2 offset:8192
M v[64:67], a[68:71], a[132:135], v[64:67]
 ds_read_b128 a[100:103], v2 offset:9216
 s_mov_b32 s79, 104923136
M v[64:67], a[72:75], a[136:139], v[64:67]
 buffer_load_dwordx4 v3, s[8:11], s38 offen offset:0 sc1 lds
M v[64:67], a[76:79], a[140:143], v[64:67]
 ds_read_b128 a[104:107], v2 offset:10240
 s_add_u32 s29, s33, 2048
M v[64:67], a[80:83], a[144:147], v[64:67]
 ds_read_b128 a[108:111], v2 offset:11264
 s_add_u32 s30, s33, 16384
M v[64:67], a[84:87], a[148:151], v[64:67]
 buffer_load_dwordx4 v3, s[8:11], s38 offen offset:1024 sc1 lds
M v[64:67], a[88:91], a[152:155], v[64:67]
 ds_read_b128 a[112:115], v2 offset:12288
 v_mul_f32 v96, v5, v96
M v[64:67], a[92:95], a[156:159], v[64:67]
 ds_read_b128 a[116:119], v2 offset:13312
 v_mul_f32 v97, v5, v97
M v[68:71], a[92:95], a[188:191], v[36:39]
 buffer_load_dwordx4 v3, s[8:11], s38 offen offset:2048 sc1 lds
M v[68:71], a[88:91], a[184:187], v[68:71]
 ds_read_b128 a[120:123], v2 offset:14336
 v_mul_f32 v98, v5, v98
M v[68:71], a[84:87], a[180:183], v[68:71]
 ds_read_b128 a[124:127], v2 offset:15360
 v_mul_f32 v99, v5, v99
M v[68:71], a[80:83], a[176:179], v[68:71]
 buffer_load_dwordx4 v3, s[8:11], s38 offen offset:3072 sc1 lds
M v[68:71], a[76:79], a[172:175], v[68:71]
 s_add_u32 m0, s28, 36864
 v_mul_f32 v104, v5, v104
 v_mul_f32 v105, v5, v105
M v[68:71], a[72:75], a[168:171], v[68:71]
 buffer_load_dwordx4 v4, s[8:11], s38 offen offset:0 sc1 lds
M v[68:71], a[68:71], a[164:167], v[68:71]
 buffer_load_dword v24, off, s[8:11], s79 sc1
M v[68:71], a[64:67], a[160:163], v[68:71]
 s_waitcnt lgkmcnt(0)
 v_lshrrev_b32 v0, 4, v7
 v_and_b32 v14, 15, v0
M v[72:75], a[96:99], a[128:131], v[32:35]
 ds_read_b128 a[64:67], v2 offset:16384
 v_lshlrev_b32 v14, 2, v14
M v[72:75], a[100:103], a[132:135], v[72:75]
 ds_read_b128 a[68:71], v2 offset:17408
 v_lshrrev_b32 v11, 4, v0
M v[72:75], a[104:107], a[136:139], v[72:75]
 buffer_load_dwordx4 v4, s[8:11], s38 offen offset:1024 sc1 lds
M v[72:75], a[108:111], a[140:143], v[72:75]
 ds_read_b128 a[72:75], v2 offset:18432
 s_mov_b32 s52, s96
M v[72:75], a[112:115], a[144:147], v[72:75]
 s_and_b32 s53, s97, 0xffff
 ds_read_b128 a[76:79], v2 offset:19456
 s_mov_b32 s54, 1835008
M v[72:75], a[116:119], a[148:151], v[72:75]
 buffer_load_dwordx4 v4, s[8:11], s38 offen offset:2048 sc1 lds
M v[72:75], a[120:123], a[152:155], v[72:75]
 ds_read_b128 a[80:83], v2 offset:20480
 s_mov_b32 s55, 0x20000
M v[72:75], a[124:127], a[156:159], v[72:75]
 s_lshr_b32 s74, s41, 3
 ds_read_b128 a[84:87], v2 offset:21504
 s_xor_b32 s74, s74, 0
M v[76:79], a[124:127], a[188:191], v[36:39]
 buffer_load_dwordx4 v4, s[8:11], s38 offen offset:3072 sc1 lds
M v[76:79], a[120:123], a[184:187], v[76:79]
 s_add_u32 s38, s38, 32768
 ds_read_b128 a[88:91], v2 offset:22528
 s_mul_i32 s67, s74, -2
M v[76:79], a[116:119], a[180:183], v[76:79]
 s_mul_i32 s74, s74, 8
 ds_read_b128 a[92:95], v2 offset:23552
 v_mul_f32 v106, v5, v106
M v[76:79], a[112:115], a[176:179], v[76:79]
 s_add_u32 s74, s74, s20
 v_mul_f32 v107, v5, v107
 v_cvt_pk_bf16_f32 v96, v96, v97
M v[76:79], a[108:111], a[172:175], v[76:79]
 s_lshl_b32 s75, s74, 6
 v_cvt_pk_bf16_f32 v97, v98, v99
 v_cvt_pk_bf16_f32 v98, v104, v105
M v[76:79], a[104:107], a[168:171], v[76:79]
 s_add_u32 s76, s75, 256
 v_cvt_pk_bf16_f32 v99, v106, v107
M v[76:79], a[100:103], a[164:167], v[76:79]
 s_add_u32 s67, s67, 3
 v_add_u32 v43, 0x20000, v7
 s_sub_u32 s67, s67, s20
M v[76:79], a[96:99], a[160:163], v[76:79]
 s_waitcnt lgkmcnt(0)
 s_and_b32 s67, s67, 536870912
M v[80:83], a[64:67], a[128:131], v[32:35]
 s_or_b32 s76, s76, s67
 ds_read_b128 a[96:99], v2 offset:24576
 v_or_b32 v27, s67, v7
M v[80:83], a[68:71], a[132:135], v[80:83]
 ds_read_b128 a[100:103], v2 offset:25600
 v_add_u32 v27, 4096, v27
M v[80:83], a[72:75], a[136:139], v[80:83]
 buffer_store_dwordx4 v[96:99], v7, s[8:11], s29 offen offset:0 sc1
M v[80:83], a[76:79], a[140:143], v[80:83]
 ds_read_b128 a[104:107], v2 offset:26624
 v_mul_f32 v100, v6, v100
M v[80:83], a[80:83], a[144:147], v[80:83]
 ds_read_b128 a[108:111], v2 offset:27648
 v_mul_f32 v101, v6, v101
M v[80:83], a[84:87], a[148:151], v[80:83]
 v_mul_f32 v102, v6, v102
 v_mul_f32 v103, v6, v103
M v[80:83], a[88:91], a[152:155], v[80:83]
 ds_read_b128 a[112:115], v2 offset:28672
 v_mul_f32 v108, v6, v108
M v[80:83], a[92:95], a[156:159], v[80:83]
 ds_read_b128 a[116:119], v2 offset:29696
 v_mul_f32 v109, v6, v109
M v[84:87], a[92:95], a[188:191], v[36:39]
 v_mul_f32 v110, v6, v110
 v_mul_f32 v111, v6, v111
M v[84:87], a[88:91], a[184:187], v[84:87]
 ds_read_b128 a[120:123], v2 offset:30720
 v_cvt_pk_bf16_f32 v100, v100, v101
M v[84:87], a[84:87], a[180:183], v[84:87]
 ds_read_b128 a[124:127], v2 offset:31744
 v_cvt_pk_bf16_f32 v101, v102, v103
M v[84:87], a[80:83], a[176:179], v[84:87]
 v_cvt_pk_bf16_f32 v102, v108, v109
 v_cvt_pk_bf16_f32 v103, v110, v111
M v[84:87], a[76:79], a[172:175], v[84:87]
 buffer_store_dwordx4 v[100:103], v7, s[8:11], s30 offen offset:0 sc1
M v[84:87], a[72:75], a[168:171], v[84:87]
 v_mul_f32 v112, v5, v112
 v_mul_f32 v113, v5, v113
M v[84:87], a[68:71], a[164:167], v[84:87]
 s_waitcnt vmcnt(32) lgkmcnt(0)
 v_mul_f32 v114, v5, v114
 v_mul_f32 v115, v5, v115
M v[84:87], a[64:67], a[160:163], v[84:87]
 s_barrier
M v[88:91], a[96:99], a[128:131], v[32:35]
 ds_read_b128 a[64:67], v7 offset:0
 v_mul_f32 v120, v5, v120
M v[88:91], a[100:103], a[132:135], v[88:91]
 ds_read_b128 a[68:71], v7 offset:1024
 v_mul_f32 v121, v5, v121
M v[88:91], a[104:107], a[136:139], v[88:91]
 v_mul_f32 v122, v5, v122
 v_mul_f32 v123, v5, v123
M v[88:91], a[108:111], a[140:143], v[88:91]
 ds_read_b128 a[72:75], v7 offset:2048
 v_cvt_pk_bf16_f32 v112, v112, v113
M v[88:91], a[112:115], a[144:147], v[88:91]
 ds_read_b128 a[76:79], v7 offset:3072
 v_cvt_pk_bf16_f32 v113, v114, v115
M v[88:91], a[116:119], a[148:151], v[88:91]
 v_cvt_pk_bf16_f32 v114, v120, v121
 v_cvt_pk_bf16_f32 v115, v122, v123
M v[88:91], a[120:123], a[152:155], v[88:91]
 ds_read_b128 a[80:83], v7 offset:4096
M v[88:91], a[124:127], a[156:159], v[88:91]
 ds_read_b128 a[84:87], v7 offset:5120
M v[92:95], a[124:127], a[188:191], v[36:39]
 buffer_store_dwordx4 v[112:115], v7, s[8:11], s29 offen offset:1024 sc1
M v[92:95], a[120:123], a[184:187], v[92:95]
 ds_read_b128 a[88:91], v7 offset:6144
 v_mul_f32 v116, v6, v116
M v[92:95], a[116:119], a[180:183], v[92:95]
 ds_read_b128 a[92:95], v7 offset:7168
 v_mul_f32 v117, v6, v117
M v[92:95], a[112:115], a[176:179], v[92:95]
 v_mul_f32 v118, v6, v118
 v_mul_f32 v119, v6, v119
M v[92:95], a[108:111], a[172:175], v[92:95]
 v_mul_f32 v124, v6, v124
 v_mul_f32 v125, v6, v125
M v[92:95], a[104:107], a[168:171], v[92:95]
 v_mul_f32 v126, v6, v126
 v_mul_f32 v127, v6, v127
M v[92:95], a[100:103], a[164:167], v[92:95]
 s_waitcnt lgkmcnt(0)
 v_cvt_pk_bf16_f32 v116, v116, v117
 v_cvt_pk_bf16_f32 v117, v118, v119
M v[92:95], a[96:99], a[160:163], v[92:95]
 v_cvt_pk_bf16_f32 v118, v124, v125
 v_cvt_pk_bf16_f32 v119, v126, v127
 buffer_store_dwordx4 v[116:119], v7, s[8:11], s30 offen offset:1024 sc1
M v[96:99], a[64:67], a[128:131], v[32:35]
 ds_read_b128 a[96:99], v7 offset:8192
M v[96:99], a[68:71], a[132:135], v[96:99]
 ds_read_b128 a[100:103], v7 offset:9216
M v[96:99], a[72:75], a[136:139], v[96:99]
 s_sub_u32 s64, 15, s42
M v[96:99], a[76:79], a[140:143], v[96:99]
 s_min_u32 s64, s64, s42
 ds_read_b128 a[104:107], v7 offset:10240
 s_add_u32 s29, s33, 4096
M v[96:99], a[80:83], a[144:147], v[96:99]
 s_mul_i32 s45, s64, 8704
 ds_read_b128 a[108:111], v7 offset:11264
 s_add_u32 s30, s33, 18432
M v[96:99], a[84:87], a[148:151], v[96:99]
 s_lshl_b32 s64, s20, 6
 v_fma_f32 v64, v64, v5, v28
 v_fma_f32 v65, v65, v5, v28
M v[96:99], a[88:91], a[152:155], v[96:99]
 s_add_u32 s64, s64, s41
 ds_read_b128 a[112:115], v7 offset:12288
 v_fma_f32 v66, v66, v5, v28
M v[96:99], a[92:95], a[156:159], v[96:99]
 s_lshl2_add_u32 s45, s64, s45
 ds_read_b128 a[116:119], v7 offset:13312
 v_fma_f32 v67, v67, v5, v28
M v[100:103], a[92:95], a[188:191], v[36:39]
 s_add_u32 s45, s45, 104992768
 v_fma_f32 v72, v72, v5, v28
M v[100:103], a[88:91], a[184:187], v[100:103]
 s_movk_i32 s65, 1024
 ds_read_b128 a[120:123], v7 offset:14336
 v_fma_f32 v73, v73, v5, v28
M v[100:103], a[84:87], a[180:183], v[100:103]
 s_cmp_lt_u32 s42, 8
 ds_read_b128 a[124:127], v7 offset:15360
 v_fma_f32 v74, v74, v5, v28
M v[100:103], a[80:83], a[176:179], v[100:103]
 s_cselect_b32 s64, 4352, s65
 v_fma_f32 v75, v75, v5, v28
M v[100:103], a[76:79], a[172:175], v[100:103]
 s_cselect_b32 s65, 0, 64
 v_cvt_pk_bf16_f32 v64, v64, v65
M v[100:103], a[72:75], a[168:171], v[100:103]
 s_cselect_b32 s66, 32, 64
 v_cvt_pk_bf16_f32 v65, v66, v67
M v[100:103], a[68:71], a[164:167], v[100:103]
 s_add_u32 s3, s45, s64
 s_add_u32 s45, s45, s65
 v_lshrrev_b32 v42, 5, v7
M v[100:103], a[64:67], a[160:163], v[100:103]
 s_waitcnt lgkmcnt(0)
 v_mul_u32_u24 v42, 4352, v42
 v_and_b32 v41, 16, v7
M v[104:107], a[96:99], a[128:131], v[32:35]
 ds_read_b128 a[64:67], v7 offset:16384
 v_lshl_add_u32 v41, v41, 3, v42
M v[104:107], a[100:103], a[132:135], v[104:107]
 ds_read_b128 a[68:71], v7 offset:17408
 v_mov_b32 v42, 536870912
M v[104:107], a[104:107], a[136:139], v[104:107]
 v_cmp_gt_u32 vcc, s66, v7
 v_mov_b32 v40, 1
M v[104:107], a[108:111], a[140:143], v[104:107]
 s_nop 0
 ds_read_b128 a[72:75], v7 offset:18432
 v_cndmask_b32 v41, v42, v41, vcc
M v[104:107], a[112:115], a[144:147], v[104:107]
 ds_read_b128 a[76:79], v7 offset:19456
 v_cvt_pk_bf16_f32 v66, v72, v73
M v[104:107], a[116:119], a[148:151], v[104:107]
 v_cvt_pk_bf16_f32 v67, v74, v75
M v[104:107], a[120:123], a[152:155], v[104:107]
 ds_read_b128 a[80:83], v7 offset:20480
M v[104:107], a[124:127], a[156:159], v[104:107]
 ds_read_b128 a[84:87], v7 offset:21504
M v[108:111], a[124:127], a[188:191], v[36:39]
 buffer_store_dwordx4 v[64:67], v7, s[8:11], s29 offen offset:0 sc1
M v[108:111], a[120:123], a[184:187], v[108:111]
 ds_read_b128 a[88:91], v7 offset:22528
 v_fma_f32 v68, v68, v6, v29
M v[108:111], a[116:119], a[180:183], v[108:111]
 ds_read_b128 a[92:95], v7 offset:23552
 v_fma_f32 v69, v69, v6, v29
M v[108:111], a[112:115], a[176:179], v[108:111]
 v_fma_f32 v70, v70, v6, v29
 v_fma_f32 v71, v71, v6, v29
M v[108:111], a[108:111], a[172:175], v[108:111]
 v_fma_f32 v76, v76, v6, v29
 v_fma_f32 v77, v77, v6, v29
M v[108:111], a[104:107], a[168:171], v[108:111]
 v_fma_f32 v78, v78, v6, v29
 v_fma_f32 v79, v79, v6, v29
M v[108:111], a[100:103], a[164:167], v[108:111]
 v_cvt_pk_bf16_f32 v68, v68, v69
 v_cvt_pk_bf16_f32 v69, v70, v71
M v[108:111], a[96:99], a[160:163], v[108:111]
 s_waitcnt lgkmcnt(0)
 v_cvt_pk_bf16_f32 v70, v76, v77
 v_cvt_pk_bf16_f32 v71, v78, v79
M v[112:115], a[64:67], a[128:131], v[32:35]
 ds_read_b128 a[96:99], v7 offset:24576
M v[112:115], a[68:71], a[132:135], v[112:115]
 ds_read_b128 a[100:103], v7 offset:25600
M v[112:115], a[72:75], a[136:139], v[112:115]
 buffer_store_dwordx4 v[68:71], v7, s[8:11], s30 offen offset:0 sc1
M v[112:115], a[76:79], a[140:143], v[112:115]
 ds_read_b128 a[104:107], v7 offset:26624
 v_fma_f32 v80, v80, v5, v28
M v[112:115], a[80:83], a[144:147], v[112:115]
 ds_read_b128 a[108:111], v7 offset:27648
 v_fma_f32 v81, v81, v5, v28
M v[112:115], a[84:87], a[148:151], v[112:115]
 v_fma_f32 v82, v82, v5, v28
 v_fma_f32 v83, v83, v5, v28
M v[112:115], a[88:91], a[152:155], v[112:115]
 ds_read_b128 a[112:115], v7 offset:28672
 v_fma_f32 v88, v88, v5, v28
M v[112:115], a[92:95], a[156:159], v[112:115]
 ds_read_b128 a[116:119], v7 offset:29696
 v_fma_f32 v89, v89, v5, v28
M v[116:119], a[92:95], a[188:191], v[36:39]
 v_fma_f32 v90, v90, v5, v28
 v_fma_f32 v91, v91, v5, v28
M v[116:119], a[88:91], a[184:187], v[116:119]
 ds_read_b128 a[120:123], v7 offset:30720
 v_cvt_pk_bf16_f32 v80, v80, v81
M v[116:119], a[84:87], a[180:183], v[116:119]
 ds_read_b128 a[124:127], v7 offset:31744
 v_cvt_pk_bf16_f32 v81, v82, v83
M v[116:119], a[80:83], a[176:179], v[116:119]
 v_cvt_pk_bf16_f32 v82, v88, v89
 v_cvt_pk_bf16_f32 v83, v90, v91
M v[116:119], a[76:79], a[172:175], v[116:119]
 buffer_store_dwordx4 v[80:83], v7, s[8:11], s29 offen offset:1024 sc1
M v[116:119], a[72:75], a[168:171], v[116:119]
 v_fma_f32 v84, v84, v6, v29
 v_fma_f32 v85, v85, v6, v29
M v[116:119], a[68:71], a[164:167], v[116:119]
 s_waitcnt vmcnt(28) lgkmcnt(0)
 v_fma_f32 v86, v86, v6, v29
M v[116:119], a[64:67], a[160:163], v[116:119]
 s_barrier
M v[120:123], a[96:99], a[128:131], v[32:35]
 ds_read_b128 a[64:67], v43 offset:0
 v_fma_f32 v87, v87, v6, v29
M v[120:123], a[100:103], a[132:135], v[120:123]
 ds_read_b128 a[68:71], v43 offset:1024
 v_fma_f32 v92, v92, v6, v29
M v[120:123], a[104:107], a[136:139], v[120:123]
 v_fma_f32 v93, v93, v6, v29
 v_fma_f32 v94, v94, v6, v29
M v[120:123], a[108:111], a[140:143], v[120:123]
 ds_read_b128 a[72:75], v43 offset:2048
 v_fma_f32 v95, v95, v6, v29
M v[120:123], a[112:115], a[144:147], v[120:123]
 ds_read_b128 a[76:79], v43 offset:3072
 v_cvt_pk_bf16_f32 v84, v84, v85
M v[120:123], a[116:119], a[148:151], v[120:123]
 v_cvt_pk_bf16_f32 v85, v86, v87
M v[120:123], a[120:123], a[152:155], v[120:123]
 ds_read_b128 a[80:83], v43 offset:4096
 v_cvt_pk_bf16_f32 v86, v92, v93
M v[120:123], a[124:127], a[156:159], v[120:123]
 ds_read_b128 a[84:87], v43 offset:5120
 v_cvt_pk_bf16_f32 v87, v94, v95
M v[124:127], a[124:127], a[188:191], v[36:39]
 buffer_store_dwordx4 v[84:87], v7, s[8:11], s30 offen offset:1024 sc1
M v[124:127], a[120:123], a[184:187], v[124:127]
 ds_read_b128 a[88:91], v43 offset:6144
M v[124:127], a[116:119], a[180:183], v[124:127]
 ds_read_b128 a[92:95], v43 offset:7168
M v[124:127], a[112:115], a[176:179], v[124:127]
M v[124:127], a[108:111], a[172:175], v[124:127]
M v[124:127], a[104:107], a[168:171], v[124:127]
M v[124:127], a[100:103], a[164:167], v[124:127]
 s_waitcnt lgkmcnt(0)
M v[124:127], a[96:99], a[160:163], v[124:127]
M v[64:67], a[64:67], a[128:131], v[32:35]
 ds_read_b128 a[96:99], v43 offset:8192
M v[64:67], a[68:71], a[132:135], v[64:67]
 ds_read_b128 a[100:103], v43 offset:9216
M v[64:67], a[72:75], a[136:139], v[64:67]
 s_waitcnt vmcnt(11)
 v_cmp_gt_u32 vcc, 1, v24
M v[64:67], a[76:79], a[140:143], v[64:67]
 s_mov_b32 s65, 104890368
 ds_read_b128 a[104:107], v43 offset:10240
 s_add_u32 s29, s33, 6144
M v[64:67], a[80:83], a[144:147], v[64:67]
 s_cbranch_vccnz L_fhs0
L_fhr0:
 ds_read_b128 a[108:111], v43 offset:11264
 s_add_u32 s30, s33, 20480
M v[64:67], a[84:87], a[148:151], v[64:67]
 buffer_load_dword v25, v14, s[8:11], s65 offen sc1
M v[64:67], a[88:91], a[152:155], v[64:67]
 ds_read_b128 a[112:115], v43 offset:12288
 v_fma_f32 v96, v96, v5, v28
M v[64:67], a[92:95], a[156:159], v[64:67]
 ds_read_b128 a[116:119], v43 offset:13312
 v_fma_f32 v97, v97, v5, v28
M v[68:71], a[92:95], a[188:191], v[36:39]
 v_fma_f32 v98, v98, v5, v28
 v_fma_f32 v99, v99, v5, v28
M v[68:71], a[88:91], a[184:187], v[68:71]
 ds_read_b128 a[120:123], v43 offset:14336
 v_fma_f32 v104, v104, v5, v28
M v[68:71], a[84:87], a[180:183], v[68:71]
 ds_read_b128 a[124:127], v43 offset:15360
 v_fma_f32 v105, v105, v5, v28
M v[68:71], a[80:83], a[176:179], v[68:71]
 v_fma_f32 v106, v106, v5, v28
 v_fma_f32 v107, v107, v5, v28
M v[68:71], a[76:79], a[172:175], v[68:71]
 v_cvt_pk_bf16_f32 v96, v96, v97
M v[68:71], a[72:75], a[168:171], v[68:71]
 v_cvt_pk_bf16_f32 v97, v98, v99
M v[68:71], a[68:71], a[164:167], v[68:71]
 v_cvt_pk_bf16_f32 v98, v104, v105
M v[68:71], a[64:67], a[160:163], v[68:71]
 s_waitcnt lgkmcnt(0)
 v_cvt_pk_bf16_f32 v99, v106, v107
M v[72:75], a[96:99], a[128:131], v[32:35]
 ds_read_b128 a[64:67], v43 offset:16384
M v[72:75], a[100:103], a[132:135], v[72:75]
 ds_read_b128 a[68:71], v43 offset:17408
M v[72:75], a[104:107], a[136:139], v[72:75]
 buffer_store_dwordx4 v[96:99], v7, s[8:11], s29 offen offset:0 sc1
M v[72:75], a[108:111], a[140:143], v[72:75]
 ds_read_b128 a[72:75], v43 offset:18432
 v_fma_f32 v100, v100, v6, v29
M v[72:75], a[112:115], a[144:147], v[72:75]
 ds_read_b128 a[76:79], v43 offset:19456
 v_fma_f32 v101, v101, v6, v29
M v[72:75], a[116:119], a[148:151], v[72:75]
 v_fma_f32 v102, v102, v6, v29
 v_fma_f32 v103, v103, v6, v29
M v[72:75], a[120:123], a[152:155], v[72:75]
 ds_read_b128 a[80:83], v43 offset:20480
 v_fma_f32 v108, v108, v6, v29
M v[72:75], a[124:127], a[156:159], v[72:75]
 ds_read_b128 a[84:87], v43 offset:21504
 v_fma_f32 v109, v109, v6, v29
M v[76:79], a[124:127], a[188:191], v[36:39]
 v_fma_f32 v110, v110, v6, v29
 v_fma_f32 v111, v111, v6, v29
M v[76:79], a[120:123], a[184:187], v[76:79]
 ds_read_b128 a[88:91], v43 offset:22528
 v_cvt_pk_bf16_f32 v100, v100, v101
M v[76:79], a[116:119], a[180:183], v[76:79]
 ds_read_b128 a[92:95], v43 offset:23552
 v_cvt_pk_bf16_f32 v101, v102, v103
M v[76:79], a[112:115], a[176:179], v[76:79]
 v_cvt_pk_bf16_f32 v102, v108, v109
M v[76:79], a[108:111], a[172:175], v[76:79]
 v_cvt_pk_bf16_f32 v103, v110, v111
M v[76:79], a[104:107], a[168:171], v[76:79]
 buffer_store_dwordx4 v[100:103], v7, s[8:11], s30 offen offset:0 sc1
M v[76:79], a[100:103], a[164:167], v[76:79]
M v[76:79], a[96:99], a[160:163], v[76:79]
 s_waitcnt lgkmcnt(0)
 v_fma_f32 v112, v112, v5, v28
M v[80:83], a[64:67], a[128:131], v[32:35]
 ds_read_b128 a[96:99], v43 offset:24576
 v_fma_f32 v113, v113, v5, v28
M v[80:83], a[68:71], a[132:135], v[80:83]
 ds_read_b128 a[100:103], v43 offset:25600
 v_fma_f32 v114, v114, v5, v28
M v[80:83], a[72:75], a[136:139], v[80:83]
 v_fma_f32 v115, v115, v5, v28
M v[80:83], a[76:79], a[140:143], v[80:83]
 ds_read_b128 a[104:107], v43 offset:26624
 v_fma_f32 v120, v120, v5, v28
M v[80:83], a[80:83], a[144:147], v[80:83]
 ds_read_b128 a[108:111], v43 offset:27648
 v_fma_f32 v121, v121, v5, v28
M v[80:83], a[84:87], a[148:151], v[80:83]
 v_fma_f32 v122, v122, v5, v28
M v[80:83], a[88:91], a[152:155], v[80:83]
 ds_read_b128 a[112:115], v43 offset:28672
 v_fma_f32 v123, v123, v5, v28
M v[80:83], a[92:95], a[156:159], v[80:83]
 ds_read_b128 a[116:119], v43 offset:29696
 v_cvt_pk_bf16_f32 v112, v112, v113
M v[84:87], a[92:95], a[188:191], v[36:39]
 v_cvt_pk_bf16_f32 v113, v114, v115
 v_cvt_pk_bf16_f32 v114, v120, v121
M v[84:87], a[88:91], a[184:187], v[84:87]
 ds_read_b128 a[120:123], v43 offset:30720
 v_cvt_pk_bf16_f32 v115, v122, v123
M v[84:87], a[84:87], a[180:183], v[84:87]
 ds_read_b128 a[124:127], v43 offset:31744
M v[84:87], a[80:83], a[176:179], v[84:87]
 buffer_store_dwordx4 v[112:115], v7, s[8:11], s29 offen offset:1024 sc1
M v[84:87], a[76:79], a[172:175], v[84:87]
 v_fma_f32 v116, v116, v6, v29
M v[84:87], a[72:75], a[168:171], v[84:87]
 v_fma_f32 v117, v117, v6, v29
M v[84:87], a[68:71], a[164:167], v[84:87]
 s_waitcnt lgkmcnt(0)
 v_fma_f32 v118, v118, v6, v29
M v[84:87], a[64:67], a[160:163], v[84:87]
 s_barrier
M v[88:91], a[96:99], a[128:131], v[32:35]
 ds_read_b128 a[64:67], v2 offset:32768
 v_fma_f32 v119, v119, v6, v29
M v[88:91], a[100:103], a[132:135], v[88:91]
 ds_read_b128 a[68:71], v2 offset:33792
 v_fma_f32 v124, v124, v6, v29
M v[88:91], a[104:107], a[136:139], v[88:91]
 v_fma_f32 v125, v125, v6, v29
 v_fma_f32 v126, v126, v6, v29
M v[88:91], a[108:111], a[140:143], v[88:91]
 ds_read_b128 a[72:75], v2 offset:34816
 v_fma_f32 v127, v127, v6, v29
M v[88:91], a[112:115], a[144:147], v[88:91]
 ds_read_b128 a[76:79], v2 offset:35840
 v_cvt_pk_bf16_f32 v116, v116, v117
M v[88:91], a[116:119], a[148:151], v[88:91]
 v_cvt_pk_bf16_f32 v117, v118, v119
M v[88:91], a[120:123], a[152:155], v[88:91]
 ds_read_b128 a[80:83], v2 offset:36864
 v_cvt_pk_bf16_f32 v118, v124, v125
M v[88:91], a[124:127], a[156:159], v[88:91]
 ds_read_b128 a[84:87], v2 offset:37888
 v_cvt_pk_bf16_f32 v119, v126, v127
M v[92:95], a[124:127], a[188:191], v[36:39]
 buffer_store_dwordx4 v[116:119], v7, s[8:11], s30 offen offset:1024 sc1
M v[92:95], a[120:123], a[184:187], v[92:95]
 ds_read_b128 a[88:91], v2 offset:38912
M v[92:95], a[116:119], a[180:183], v[92:95]
 ds_read_b128 a[92:95], v2 offset:39936
M v[92:95], a[112:115], a[176:179], v[92:95]
M v[92:95], a[108:111], a[172:175], v[92:95]
M v[92:95], a[104:107], a[168:171], v[92:95]
M v[92:95], a[100:103], a[164:167], v[92:95]
 s_waitcnt lgkmcnt(0)
M v[92:95], a[96:99], a[160:163], v[92:95]
M v[96:99], a[64:67], a[128:131], v[32:35]
 ds_read_b128 a[96:99], v2 offset:40960
M v[96:99], a[68:71], a[132:135], v[96:99]
 ds_read_b128 a[100:103], v2 offset:41984
M v[96:99], a[72:75], a[136:139], v[96:99]
M v[96:99], a[76:79], a[140:143], v[96:99]
 ds_read_b128 a[104:107], v2 offset:43008
 s_add_u32 s29, s33, 8192
M v[96:99], a[80:83], a[144:147], v[96:99]
 ds_read_b128 a[108:111], v2 offset:44032
 s_add_u32 s30, s33, 22528
M v[96:99], a[84:87], a[148:151], v[96:99]
 v_fma_f32 v64, v64, v5, v28
 v_fma_f32 v65, v65, v5, v28
M v[96:99], a[88:91], a[152:155], v[96:99]
 ds_read_b128 a[112:115], v2 offset:45056
 v_fma_f32 v66, v66, v5, v28
M v[96:99], a[92:95], a[156:159], v[96:99]
 ds_read_b128 a[116:119], v2 offset:46080
 v_fma_f32 v67, v67, v5, v28
M v[100:103], a[92:95], a[188:191], v[36:39]
 v_fma_f32 v72, v72, v5, v28
M v[100:103], a[88:91], a[184:187], v[100:103]
 ds_read_b128 a[120:123], v2 offset:47104
 v_fma_f32 v73, v73, v5, v28
M v[100:103], a[84:87], a[180:183], v[100:103]
 ds_read_b128 a[124:127], v2 offset:48128
 v_fma_f32 v74, v74, v5, v28
M v[100:103], a[80:83], a[176:179], v[100:103]
 v_fma_f32 v75, v75, v5, v28
M v[100:103], a[76:79], a[172:175], v[100:103]
 v_cvt_pk_bf16_f32 v64, v64, v65
M v[100:103], a[72:75], a[168:171], v[100:103]
 v_cvt_pk_bf16_f32 v65, v66, v67
M v[100:103], a[68:71], a[164:167], v[100:103]
 v_cvt_pk_bf16_f32 v66, v72, v73
M v[100:103], a[64:67], a[160:163], v[100:103]
 s_waitcnt lgkmcnt(0)
 v_cvt_pk_bf16_f32 v67, v74, v75
M v[104:107], a[96:99], a[128:131], v[32:35]
 ds_read_b128 a[64:67], v2 offset:49152
M v[104:107], a[100:103], a[132:135], v[104:107]
 ds_read_b128 a[68:71], v2 offset:50176
M v[104:107], a[104:107], a[136:139], v[104:107]
 buffer_store_dwordx4 v[64:67], v7, s[8:11], s29 offen offset:0 sc1
M v[104:107], a[108:111], a[140:143], v[104:107]
 ds_read_b128 a[72:75], v2 offset:51200
 v_fma_f32 v68, v68, v6, v29
M v[104:107], a[112:115], a[144:147], v[104:107]
 ds_read_b128 a[76:79], v2 offset:52224
 v_fma_f32 v69, v69, v6, v29
M v[104:107], a[116:119], a[148:151], v[104:107]
 v_fma_f32 v70, v70, v6, v29
 v_fma_f32 v71, v71, v6, v29
M v[104:107], a[120:123], a[152:155], v[104:107]
 ds_read_b128 a[80:83], v2 offset:53248
 v_fma_f32 v76, v76, v6, v29
M v[104:107], a[124:127], a[156:159], v[104:107]
 ds_read_b128 a[84:87], v2 offset:54272
 v_fma_f32 v77, v77, v6, v29
M v[108:111], a[124:127], a[188:191], v[36:39]
 v_fma_f32 v78, v78, v6, v29
 v_fma_f32 v79, v79, v6, v29
M v[108:111], a[120:123], a[184:187], v[108:111]
 ds_read_b128 a[88:91], v2 offset:55296
 v_cvt_pk_bf16_f32 v68, v68, v69
M v[108:111], a[116:119], a[180:183], v[108:111]
 ds_read_b128 a[92:95], v2 offset:56320
 v_cvt_pk_bf16_f32 v69, v70, v71
M v[108:111], a[112:115], a[176:179], v[108:111]
 v_cvt_pk_bf16_f32 v70, v76, v77
M v[108:111], a[108:111], a[172:175], v[108:111]
 v_cvt_pk_bf16_f32 v71, v78, v79
M v[108:111], a[104:107], a[168:171], v[108:111]
 buffer_store_dwordx4 v[68:71], v7, s[8:11], s30 offen offset:0 sc1
M v[108:111], a[100:103], a[164:167], v[108:111]
M v[108:111], a[96:99], a[160:163], v[108:111]
 s_waitcnt lgkmcnt(0)
 v_fma_f32 v80, v80, v5, v28
M v[112:115], a[64:67], a[128:131], v[32:35]
 ds_read_b128 a[96:99], v2 offset:57344
 v_fma_f32 v81, v81, v5, v28
M v[112:115], a[68:71], a[132:135], v[112:115]
 ds_read_b128 a[100:103], v2 offset:58368
 v_fma_f32 v82, v82, v5, v28
M v[112:115], a[72:75], a[136:139], v[112:115]
 v_fma_f32 v83, v83, v5, v28
M v[112:115], a[76:79], a[140:143], v[112:115]
 ds_read_b128 a[104:107], v2 offset:59392
 v_fma_f32 v88, v88, v5, v28
M v[112:115], a[80:83], a[144:147], v[112:115]
 ds_read_b128 a[108:111], v2 offset:60416
 v_fma_f32 v89, v89, v5, v28
M v[112:115], a[84:87], a[148:151], v[112:115]
 v_fma_f32 v90, v90, v5, v28
M v[112:115], a[88:91], a[152:155], v[112:115]
 ds_read_b128 a[112:115], v2 offset:61440
 v_fma_f32 v91, v91, v5, v28
M v[112:115], a[92:95], a[156:159], v[112:115]
 ds_read_b128 a[116:119], v2 offset:62464
 v_cvt_pk_bf16_f32 v80, v80, v81
M v[116:119], a[92:95], a[188:191], v[36:39]
 s_waitcnt vmcnt(6)
 v_readlane_b32 s84, v25, 0
 v_readlane_b32 s85, v25, 1
M v[116:119], a[88:91], a[184:187], v[116:119]
 ds_read_b128 a[120:123], v2 offset:63488
 v_mov_b32 v24, 0x3f80
M v[116:119], a[84:87], a[180:183], v[116:119]
 ds_read_b128 a[124:127], v2 offset:64512
 v_mov_b32 v25, 0x3f800000
M v[116:119], a[80:83], a[176:179], v[116:119]
 v_cvt_pk_bf16_f32 v81, v82, v83
 v_cvt_pk_bf16_f32 v82, v88, v89
M v[116:119], a[76:79], a[172:175], v[116:119]
 v_cvt_pk_bf16_f32 v83, v90, v91
M v[116:119], a[72:75], a[168:171], v[116:119]
 buffer_store_dwordx4 v[80:83], v7, s[8:11], s29 offen offset:1024 sc1
M v[116:119], a[68:71], a[164:167], v[116:119]
 s_waitcnt lgkmcnt(0)
 v_fma_f32 v84, v84, v6, v29
 v_fma_f32 v85, v85, v6, v29
M v[116:119], a[64:67], a[160:163], v[116:119]
 s_barrier
M v[120:123], a[96:99], a[128:131], v[32:35]
 ds_read_b128 a[64:67], v7 offset:32768
 v_fma_f32 v86, v86, v6, v29
M v[120:123], a[100:103], a[132:135], v[120:123]
 ds_read_b128 a[68:71], v7 offset:33792
 v_fma_f32 v87, v87, v6, v29
M v[120:123], a[104:107], a[136:139], v[120:123]
 v_fma_f32 v92, v92, v6, v29
 v_fma_f32 v93, v93, v6, v29
M v[120:123], a[108:111], a[140:143], v[120:123]
 ds_read_b128 a[72:75], v7 offset:34816
 v_fma_f32 v94, v94, v6, v29
M v[120:123], a[112:115], a[144:147], v[120:123]
 ds_read_b128 a[76:79], v7 offset:35840
 v_fma_f32 v95, v95, v6, v29
M v[120:123], a[116:119], a[148:151], v[120:123]
 s_waitcnt vmcnt(3)
 v_cvt_pk_bf16_f32 v84, v84, v85
 v_cvt_pk_bf16_f32 v85, v86, v87
M v[120:123], a[120:123], a[152:155], v[120:123]
 ds_read_b128 a[80:83], v7 offset:36864
 v_cvt_pk_bf16_f32 v86, v92, v93
M v[120:123], a[124:127], a[156:159], v[120:123]
 ds_read_b128 a[84:87], v7 offset:37888
 v_cvt_pk_bf16_f32 v87, v94, v95
M v[124:127], a[124:127], a[188:191], v[36:39]
 buffer_store_dword v40, v41, s[8:11], s45 offen sc1
M v[124:127], a[120:123], a[184:187], v[124:127]
 ds_read_b128 a[88:91], v7 offset:38912
M v[124:127], a[116:119], a[180:183], v[124:127]
 ds_read_b128 a[92:95], v7 offset:39936
M v[124:127], a[112:115], a[176:179], v[124:127]
 buffer_store_dwordx4 v[84:87], v7, s[8:11], s30 offen offset:1024 sc1
M v[124:127], a[108:111], a[172:175], v[124:127]
M v[124:127], a[104:107], a[168:171], v[124:127]
M v[124:127], a[100:103], a[164:167], v[124:127]
 s_waitcnt lgkmcnt(0)
M v[124:127], a[96:99], a[160:163], v[124:127]
M v[64:67], a[64:67], a[128:131], v[32:35]
 ds_read_b128 a[96:99], v7 offset:40960
M v[64:67], a[68:71], a[132:135], v[64:67]
 ds_read_b128 a[100:103], v7 offset:41984
M v[64:67], a[72:75], a[136:139], v[64:67]
M v[64:67], a[76:79], a[140:143], v[64:67]
 ds_read_b128 a[104:107], v7 offset:43008
 s_add_u32 s29, s33, 10240
M v[64:67], a[80:83], a[144:147], v[64:67]
 ds_read_b128 a[108:111], v7 offset:44032
 s_add_u32 s30, s33, 24576
M v[64:67], a[84:87], a[148:151], v[64:67]
 v_fma_f32 v96, v96, v5, v28
 v_fma_f32 v97, v97, v5, v28
M v[64:67], a[88:91], a[152:155], v[64:67]
 ds_read_b128 a[112:115], v7 offset:45056
 v_fma_f32 v98, v98, v5, v28
M v[64:67], a[92:95], a[156:159], v[64:67]
 ds_read_b128 a[116:119], v7 offset:46080
 v_fma_f32 v99, v99, v5, v28
M v[68:71], a[92:95], a[188:191], v[36:39]
 v_fma_f32 v104, v104, v5, v28
 v_fma_f32 v105, v105, v5, v28
M v[68:71], a[88:91], a[184:187], v[68:71]
 ds_read_b128 a[120:123], v7 offset:47104
 v_fma_f32 v106, v106, v5, v28
M v[68:71], a[84:87], a[180:183], v[68:71]
 ds_read_b128 a[124:127], v7 offset:48128
 v_fma_f32 v107, v107, v5, v28
M v[68:71], a[80:83], a[176:179], v[68:71]
 v_cvt_pk_bf16_f32 v96, v96, v97
 v_cvt_pk_bf16_f32 v97, v98, v99
M v[68:71], a[76:79], a[172:175], v[68:71]
 v_cvt_pk_bf16_f32 v98, v104, v105
 v_cvt_pk_bf16_f32 v99, v106, v107
M v[68:71], a[72:75], a[168:171], v[68:71]
 buffer_store_dwordx4 v[96:99], v7, s[8:11], s29 offen offset:0 sc1
M v[68:71], a[68:71], a[164:167], v[68:71]
 v_fma_f32 v100, v100, v6, v29
 v_fma_f32 v101, v101, v6, v29
M v[68:71], a[64:67], a[160:163], v[68:71]
 s_waitcnt lgkmcnt(0)
 v_fma_f32 v102, v102, v6, v29
 v_fma_f32 v103, v103, v6, v29
M v[72:75], a[96:99], a[128:131], v[32:35]
 ds_read_b128 a[64:67], v7 offset:49152
 v_fma_f32 v108, v108, v6, v29
M v[72:75], a[100:103], a[132:135], v[72:75]
 ds_read_b128 a[68:71], v7 offset:50176
 v_fma_f32 v109, v109, v6, v29
M v[72:75], a[104:107], a[136:139], v[72:75]
 v_fma_f32 v110, v110, v6, v29
 v_fma_f32 v111, v111, v6, v29
M v[72:75], a[108:111], a[140:143], v[72:75]
 ds_read_b128 a[72:75], v7 offset:51200
 v_cvt_pk_bf16_f32 v100, v100, v101
M v[72:75], a[112:115], a[144:147], v[72:75]
 ds_read_b128 a[76:79], v7 offset:52224
 v_cvt_pk_bf16_f32 v101, v102, v103
M v[72:75], a[116:119], a[148:151], v[72:75]
 v_cvt_pk_bf16_f32 v102, v108, v109
 v_cvt_pk_bf16_f32 v103, v110, v111
M v[72:75], a[120:123], a[152:155], v[72:75]
 ds_read_b128 a[80:83], v7 offset:53248
M v[72:75], a[124:127], a[156:159], v[72:75]
 ds_read_b128 a[84:87], v7 offset:54272
M v[76:79], a[124:127], a[188:191], v[36:39]
 buffer_store_dwordx4 v[100:103], v7, s[8:11], s30 offen offset:0 sc1
M v[76:79], a[120:123], a[184:187], v[76:79]
 ds_read_b128 a[88:91], v7 offset:55296
 v_fma_f32 v112, v112, v5, v28
M v[76:79], a[116:119], a[180:183], v[76:79]
 ds_read_b128 a[92:95], v7 offset:56320
 v_fma_f32 v113, v113, v5, v28
M v[76:79], a[112:115], a[176:179], v[76:79]
 v_fma_f32 v114, v114, v5, v28
 v_fma_f32 v115, v115, v5, v28
M v[76:79], a[108:111], a[172:175], v[76:79]
 v_fma_f32 v120, v120, v5, v28
 v_fma_f32 v121, v121, v5, v28
M v[76:79], a[104:107], a[168:171], v[76:79]
 v_fma_f32 v122, v122, v5, v28
 v_fma_f32 v123, v123, v5, v28
M v[76:79], a[100:103], a[164:167], v[76:79]
 v_cvt_pk_bf16_f32 v112, v112, v113
 v_cvt_pk_bf16_f32 v113, v114, v115
M v[76:79], a[96:99], a[160:163], v[76:79]
 s_waitcnt lgkmcnt(0)
 v_cvt_pk_bf16_f32 v114, v120, v121
 v_cvt_pk_bf16_f32 v115, v122, v123
M v[80:83], a[64:67], a[128:131], v[32:35]
 ds_read_b128 a[96:99], v7 offset:57344
M v[80:83], a[68:71], a[132:135], v[80:83]
 ds_read_b128 a[100:103], v7 offset:58368
M v[80:83], a[72:75], a[136:139], v[80:83]
 buffer_store_dwordx4 v[112:115], v7, s[8:11], s29 offen offset:1024 sc1
M v[80:83], a[76:79], a[140:143], v[80:83]
 ds_read_b128 a[104:107], v7 offset:59392
 v_fma_f32 v116, v116, v6, v29
M v[80:83], a[80:83], a[144:147], v[80:83]
 ds_read_b128 a[108:111], v7 offset:60416
 v_fma_f32 v117, v117, v6, v29
M v[80:83], a[84:87], a[148:151], v[80:83]
 v_fma_f32 v118, v118, v6, v29
 v_fma_f32 v119, v119, v6, v29
M v[80:83], a[88:91], a[152:155], v[80:83]
 ds_read_b128 a[112:115], v7 offset:61440
 v_fma_f32 v124, v124, v6, v29
M v[80:83], a[92:95], a[156:159], v[80:83]
 ds_read_b128 a[116:119], v7 offset:62464
 v_fma_f32 v125, v125, v6, v29
M v[84:87], a[92:95], a[188:191], v[36:39]
 v_fma_f32 v126, v126, v6, v29
 v_fma_f32 v127, v127, v6, v29
M v[84:87], a[88:91], a[184:187], v[84:87]
 ds_read_b128 a[120:123], v7 offset:63488
 v_cvt_pk_bf16_f32 v116, v116, v117
M v[84:87], a[84:87], a[180:183], v[84:87]
 ds_read_b128 a[124:127], v7 offset:64512
 v_cvt_pk_bf16_f32 v117, v118, v119
M v[84:87], a[80:83], a[176:179], v[84:87]
 v_cvt_pk_bf16_f32 v118, v124, v125
 v_cvt_pk_bf16_f32 v119, v126, v127
M v[84:87], a[76:79], a[172:175], v[84:87]
 buffer_store_dwordx4 v[116:119], v7, s[8:11], s30 offen offset:1024 sc1
M v[84:87], a[72:75], a[168:171], v[84:87]
 s_add_u32 s29, s33, 12288
M v[84:87], a[68:71], a[164:167], v[84:87]
 s_add_u32 s30, s33, 26624
 v_fma_f32 v64, v64, v5, v28
 v_fma_f32 v65, v65, v5, v28
M v[84:87], a[64:67], a[160:163], v[84:87]
 s_waitcnt lgkmcnt(0)
 v_fma_f32 v66, v66, v5, v28
 v_fma_f32 v67, v67, v5, v28
M v[88:91], a[96:99], a[128:131], v[32:35]
 v_fma_f32 v72, v72, v5, v28
 v_fma_f32 v73, v73, v5, v28
M v[88:91], a[100:103], a[132:135], v[88:91]
 v_fma_f32 v74, v74, v5, v28
 v_fma_f32 v75, v75, v5, v28
M v[88:91], a[104:107], a[136:139], v[88:91]
 v_cvt_pk_bf16_f32 v64, v64, v65
 v_cvt_pk_bf16_f32 v65, v66, v67
M v[88:91], a[108:111], a[140:143], v[88:91]
 v_cvt_pk_bf16_f32 v66, v72, v73
 v_cvt_pk_bf16_f32 v67, v74, v75
M v[88:91], a[112:115], a[144:147], v[88:91]
 buffer_store_dwordx4 v[64:67], v7, s[8:11], s29 offen offset:0 sc1
M v[88:91], a[116:119], a[148:151], v[88:91]
 v_fma_f32 v68, v68, v6, v29
 v_fma_f32 v69, v69, v6, v29
M v[88:91], a[120:123], a[152:155], v[88:91]
 v_fma_f32 v70, v70, v6, v29
 v_fma_f32 v71, v71, v6, v29
M v[88:91], a[124:127], a[156:159], v[88:91]
 v_fma_f32 v76, v76, v6, v29
 v_fma_f32 v77, v77, v6, v29
M v[92:95], a[124:127], a[188:191], v[36:39]
 v_fma_f32 v78, v78, v6, v29
 v_fma_f32 v79, v79, v6, v29
M v[92:95], a[120:123], a[184:187], v[92:95]
 v_cvt_pk_bf16_f32 v68, v68, v69
 v_cvt_pk_bf16_f32 v69, v70, v71
M v[92:95], a[116:119], a[180:183], v[92:95]
 v_cvt_pk_bf16_f32 v70, v76, v77
 v_cvt_pk_bf16_f32 v71, v78, v79
M v[92:95], a[112:115], a[176:179], v[92:95]
 buffer_store_dwordx4 v[68:71], v7, s[8:11], s30 offen offset:0 sc1
M v[92:95], a[108:111], a[172:175], v[92:95]
M v[92:95], a[104:107], a[168:171], v[92:95]
M v[92:95], a[100:103], a[164:167], v[92:95]
M v[92:95], a[96:99], a[160:163], v[92:95]
 v_fma_f32 v80, v80, v5, v28
 v_fma_f32 v81, v81, v5, v28
 v_fma_f32 v82, v82, v5, v28
 v_fma_f32 v83, v83, v5, v28
 v_fma_f32 v88, v88, v5, v28
 v_fma_f32 v89, v89, v5, v28
 v_fma_f32 v90, v90, v5, v28
 v_fma_f32 v91, v91, v5, v28
 v_cvt_pk_bf16_f32 v80, v80, v81
 v_cvt_pk_bf16_f32 v81, v82, v83
 v_cvt_pk_bf16_f32 v82, v88, v89
 v_cvt_pk_bf16_f32 v83, v90, v91
 buffer_store_dwordx4 v[80:83], v7, s[8:11], s29 offen offset:1024 sc1
 v_fma_f32 v84, v84, v6, v29
 v_fma_f32 v85, v85, v6, v29
 v_fma_f32 v86, v86, v6, v29
 v_fma_f32 v87, v87, v6, v29
 v_fma_f32 v92, v92, v6, v29
 v_fma_f32 v93, v93, v6, v29
 v_fma_f32 v94, v94, v6, v29
 v_fma_f32 v95, v95, v6, v29
 v_cvt_pk_bf16_f32 v84, v84, v85
 v_cvt_pk_bf16_f32 v85, v86, v87
 v_cvt_pk_bf16_f32 v86, v92, v93
 v_cvt_pk_bf16_f32 v87, v94, v95
 buffer_store_dwordx4 v[84:87], v7, s[8:11], s30 offen offset:1024 sc1
L_red:
 s_lshl_b32 s64, s42, 1
 s_lshr_b32 s65, s41, 3
 s_add_u32 s46, s64, s65
 s_mul_i32 s46, s46, 4352
 s_and_b32 s72, s41, 7
 s_lshl_b32 s66, s72, 7
 s_add_u32 s46, s46, s66
 s_add_u32 s46, s46, 104992768
 v_and_b32 v14, 31, v0
 v_lshlrev_b32 v14, 2, v14
 buffer_load_dword v9, v14, s[8:11], s46 offen sc1
 s_mul_i32 s86, s65, 4
 s_add_u32 s86, s86, s20
 s_mul_i32 s77, s42, 1835008
 s_mul_i32 s78, s72, 14336
 s_add_u32 s77, s77, s78
 s_add_u32 s77, s77, 67108864
 s_sub_u32 s64, 15, s64
 s_sub_u32 s78, s64, 1
 s_mul_i32 s78, s78, 1835008
 s_add_u32 s78, s78, s77
 s_lshl_b32 s66, s86, 10
 s_add_u32 s78, s78, s66
 s_lshl_b32 s66, s74, 10
 s_add_u32 s77, s77, s66
 s_lshl_b32 s66, s64, 7
 s_lshl_b32 s86, s86, 6
 s_lshr_b32 s73, s72, 1
 s_sub_u32 s65, 7, s73
 s_bitcmp1_b32 s72, 0
 s_cselect_b32 s73, s65, s73
 s_lshl_b32 s73, s73, 4
 s_lshl_b32 s65, s42, 7
 s_add_u32 s73, s73, s65
 v_and_b32 v10, 15, v0
 v_add_u32 v10, s73, v10
 v_add_u32 v29, s66, v10
 s_mov_b32 s64, 104857664
 v_mul_u32_u24 v12, 896, v10
 v_lshl_add_u32 v12, v11, 4, v12
 v_lshrrev_b32 v13, 4, v10
 v_lshlrev_b32 v13, 5, v13
 v_and_b32 v104, 15, v10
 v_add_lshl_u32 v13, v13, v104, 2
 buffer_load_dword v15, v13, s[8:11], s64 offen sc1
 buffer_load_dwordx4 v[16:19], v12, s[56:59], s75 offen
 buffer_load_dwordx4 v[20:23], v12, s[56:59], s76 offen
 v_mov_b32 v48, 0
 v_mov_b32 v49, 0
 v_mov_b32 v50, 0
 v_mov_b32 v51, 0
 v_mov_b32 v52, 0
 v_mov_b32 v53, 0
 v_mov_b32 v54, 0
 v_mov_b32 v55, 0
 v_mov_b32 v56, 0
 v_mov_b32 v57, 0
 v_mov_b32 v58, 0
 v_mov_b32 v59, 0
 v_mov_b32 v60, 0
 v_mov_b32 v61, 0
 v_mov_b32 v62, 0
 v_mov_b32 v63, 0
 v_mul_u32_u24 v28, 896, v29
 v_lshl_add_u32 v28, v11, 4, v28
 v_lshrrev_b32 v13, 4, v29
 v_lshlrev_b32 v13, 5, v13
 v_and_b32 v104, 15, v29
 v_add_lshl_u32 v13, v13, v104, 2
 buffer_load_dword v26, v13, s[8:11], s64 offen sc1
 buffer_load_dwordx4 v[96:99], v28, s[56:59], s86 offen
 v_mov_b32 v64, 0
 v_mov_b32 v65, 0
 v_mov_b32 v66, 0
 v_mov_b32 v67, 0
 v_mov_b32 v68, 0
 v_mov_b32 v69, 0
 v_mov_b32 v70, 0
 v_mov_b32 v71, 0
 s_waitcnt vmcnt(6)
 buffer_store_dword v40, v41, s[8:11], s3 offen sc1
 s_waitcnt vmcnt(6)
 v_cmp_eq_u32 vcc, 1, v9
 s_mov_b32 s91, 65536
 s_mov_b32 s69, 0
 s_mov_b32 s70, vcc_lo
 s_mov_b32 s68, vcc_lo
 s_cmp_lg_u32 s70, 0
 s_cbranch_scc1 L_rk0
 s_call_b64 s[36:37], L_rpoll
L_rk0:
 s_ff1_i32_b32 s71, s70
 s_bitset0_b32 s70, s71
 s_cmp_ge_u32 s71, 16
 s_cselect_b32 s72, s78, s77
 s_cselect_b32 s73, 0x1, 0
 s_cselect_b32 s87, 536870912, 0
 s_mul_i32 s71, s71, 114688
 s_add_u32 s71, s71, s72
 buffer_load_dwordx4 v[128:131], v7, s[8:11], s71 offen sc1
 s_or_b32 s69, s69, s73
 s_or_b32 s71, s71, s87
 buffer_load_dwordx4 v[132:135], v27, s[8:11], s71 offen sc1
 s_cmp_lg_u32 s70, 0
 s_cbranch_scc1 L_rk1
 s_call_b64 s[36:37], L_rpoll
L_rk1:
 s_ff1_i32_b32 s71, s70
 s_bitset0_b32 s70, s71
 s_cmp_ge_u32 s71, 16
 s_cselect_b32 s72, s78, s77
 s_cselect_b32 s73, 0x2, 0
 s_cselect_b32 s87, 536870912, 0
 s_mul_i32 s71, s71, 114688
 s_add_u32 s71, s71, s72
 buffer_load_dwordx4 v[136:139], v7, s[8:11], s71 offen sc1
 s_or_b32 s69, s69, s73
 s_or_b32 s71, s71, s87
 buffer_load_dwordx4 v[140:143], v27, s[8:11], s71 offen sc1
 s_waitcnt vmcnt(8)
 v_lshlrev_b32 v32, 16, v16
 v_and_b32 v33, 0xffff0000, v16
 v_lshlrev_b32 v34, 16, v17
 v_and_b32 v35, 0xffff0000, v17
 v_lshlrev_b32 v36, 16, v18
 v_and_b32 v37, 0xffff0000, v18
 v_lshlrev_b32 v38, 16, v19
 v_and_b32 v39, 0xffff0000, v19
 s_waitcnt vmcnt(7)
 v_lshlrev_b32 v40, 16, v20
 v_and_b32 v41, 0xffff0000, v20
 v_lshlrev_b32 v42, 16, v21
 v_and_b32 v43, 0xffff0000, v21
 v_lshlrev_b32 v44, 16, v22
 v_and_b32 v45, 0xffff0000, v22
 v_lshlrev_b32 v46, 16, v23
 v_and_b32 v47, 0xffff0000, v23
 v_sub_f32 v13, 1.0, v15
 v_cmp_eq_u32 s[80:81], s84, v10
 v_cmp_eq_u32 s[82:83], s85, v10
 s_nop 0
 s_or_b64 vcc, s[80:81], s[82:83]
 s_cbranch_vccnz L_moe0
L_moe_ret0:
 v_mul_f32 v32, v13, v32
 v_mul_f32 v33, v13, v33
 v_mul_f32 v34, v13, v34
 v_mul_f32 v35, v13, v35
 v_mul_f32 v36, v13, v36
 v_mul_f32 v37, v13, v37
 v_mul_f32 v38, v13, v38
 v_mul_f32 v39, v13, v39
 v_mul_f32 v40, v13, v40
 v_mul_f32 v41, v13, v41
 v_mul_f32 v42, v13, v42
 v_mul_f32 v43, v13, v43
 v_mul_f32 v44, v13, v44
 v_mul_f32 v45, v13, v45
 v_mul_f32 v46, v13, v46
 v_mul_f32 v47, v13, v47
 s_cmp_lg_u32 s70, 0
 s_cbranch_scc1 L_rk2
 s_call_b64 s[36:37], L_rpoll
L_rk2:
 s_ff1_i32_b32 s71, s70
 s_bitset0_b32 s70, s71
 s_cmp_ge_u32 s71, 16
 s_cselect_b32 s72, s78, s77
 s_cselect_b32 s73, 0x4, 0
 s_cselect_b32 s87, 536870912, 0
 s_mul_i32 s71, s71, 114688
 s_add_u32 s71, s71, s72
 buffer_load_dwordx4 v[144:147], v7, s[8:11], s71 offen sc1
 s_or_b32 s69, s69, s73
 s_or_b32 s71, s71, s87
 buffer_load_dwordx4 v[148:151], v27, s[8:11], s71 offen sc1
 s_waitcnt vmcnt(7)
 v_lshlrev_b32 v80, 16, v96
 v_and_b32 v81, 0xffff0000, v96
 v_lshlrev_b32 v82, 16, v97
 v_and_b32 v83, 0xffff0000, v97
 v_lshlrev_b32 v84, 16, v98
 v_and_b32 v85, 0xffff0000, v98
 v_lshlrev_b32 v86, 16, v99
 v_and_b32 v87, 0xffff0000, v99
 v_sub_f32 v13, 1.0, v26
 v_cmp_eq_u32 s[80:81], s84, v29
 v_cmp_eq_u32 s[82:83], s85, v29
 s_nop 0
 s_or_b64 vcc, s[80:81], s[82:83]
 s_cbranch_vccnz L_moe1
L_moe_ret1:
 v_mul_f32 v80, v13, v80
 v_mul_f32 v81, v13, v81
 v_mul_f32 v82, v13, v82
 v_mul_f32 v83, v13, v83
 v_mul_f32 v84, v13, v84
 v_mul_f32 v85, v13, v85
 v_mul_f32 v86, v13, v86
 v_mul_f32 v87, v13, v87
 s_cmp_lg_u32 s70, 0
 s_cbranch_scc1 L_rk3
 s_call_b64 s[36:37], L_rpoll
L_rk3:
 s_ff1_i32_b32 s71, s70
 s_bitset0_b32 s70, s71
 s_cmp_ge_u32 s71, 16
 s_cselect_b32 s72, s78, s77
 s_cselect_b32 s73, 0x8, 0
 s_cselect_b32 s87, 536870912, 0
 s_mul_i32 s71, s71, 114688
 s_add_u32 s71, s71, s72
 buffer_load_dwordx4 v[152:155], v7, s[8:11], s71 offen sc1
 s_or_b32 s69, s69, s73
 s_or_b32 s71, s71, s87
 buffer_load_dwordx4 v[156:159], v27, s[8:11], s71 offen sc1
 s_cmp_lg_u32 s70, 0
 s_cbranch_scc1 L_rk4
 s_call_b64 s[36:37], L_rpoll
L_rk4:
 s_ff1_i32_b32 s71, s70
 s_bitset0_b32 s70, s71
 s_cmp_ge_u32 s71, 16
 s_cselect_b32 s72, s78, s77
 s_cselect_b32 s73, 0x10, 0
 s_cselect_b32 s87, 536870912, 0
 s_mul_i32 s71, s71, 114688
 s_add_u32 s71, s71, s72
 buffer_load_dwordx4 v[160:163], v7, s[8:11], s71 offen sc1
 s_or_b32 s69, s69, s73
 s_or_b32 s71, s71, s87
 buffer_load_dwordx4 v[164:167], v27, s[8:11], s71 offen sc1
 s_cmp_lg_u32 s70, 0
 s_cbranch_scc1 L_rk5
 s_call_b64 s[36:37], L_rpoll
L_rk5:
 s_ff1_i32_b32 s71, s70
 s_bitset0_b32 s70, s71
 s_cmp_ge_u32 s71, 16
 s_cselect_b32 s72, s78, s77
 s_cselect_b32 s73, 0x20, 0
 s_cselect_b32 s87, 536870912, 0
 s_mul_i32 s71, s71, 114688
 s_add_u32 s71, s71, s72
 buffer_load_dwordx4 v[168:171], v7, s[8:11], s71 offen sc1
 s_or_b32 s69, s69, s73
 s_or_b32 s71, s71, s87
 buffer_load_dwordx4 v[172:175], v27, s[8:11], s71 offen sc1
 s_cmp_lg_u32 s70, 0
 s_cbranch_scc1 L_rk6
 s_call_b64 s[36:37], L_rpoll
L_rk6:
 s_ff1_i32_b32 s71, s70
 s_bitset0_b32 s70, s71
 s_cmp_ge_u32 s71, 16
 s_cselect_b32 s72, s78, s77
 s_cselect_b32 s73, 0x40, 0
 s_cselect_b32 s87, 536870912, 0
 s_mul_i32 s71, s71, 114688
 s_add_u32 s71, s71, s72
 buffer_load_dwordx4 v[176:179], v7, s[8:11], s71 offen sc1
 s_or_b32 s69, s69, s73
 s_or_b32 s71, s71, s87
 buffer_load_dwordx4 v[180:183], v27, s[8:11], s71 offen sc1
 s_cmp_lg_u32 s70, 0
 s_cbranch_scc1 L_rk7
 s_call_b64 s[36:37], L_rpoll
L_rk7:
 s_ff1_i32_b32 s71, s70
 s_bitset0_b32 s70, s71
 s_cmp_ge_u32 s71, 16
 s_cselect_b32 s72, s78, s77
 s_cselect_b32 s73, 0x80, 0
 s_cselect_b32 s87, 536870912, 0
 s_mul_i32 s71, s71, 114688
 s_add_u32 s71, s71, s72
 buffer_load_dwordx4 v[184:187], v7, s[8:11], s71 offen sc1
 s_or_b32 s69, s69, s73
 s_or_b32 s71, s71, s87
 buffer_load_dwordx4 v[188:191], v27, s[8:11], s71 offen sc1
 s_cmp_lg_u32 s70, 0
 s_cbranch_scc1 L_rk8
 s_call_b64 s[36:37], L_rpoll
L_rk8:
 s_ff1_i32_b32 s71, s70
 s_bitset0_b32 s70, s71
 s_cmp_ge_u32 s71, 16
 s_cselect_b32 s72, s78, s77
 s_cselect_b32 s73, 0x100, 0
 s_cselect_b32 s87, 536870912, 0
 s_mul_i32 s71, s71, 114688
 s_add_u32 s71, s71, s72
 buffer_load_dwordx4 v[192:195], v7, s[8:11], s71 offen sc1
 s_or_b32 s69, s69, s73
 s_or_b32 s71, s71, s87
 buffer_load_dwordx4 v[196:199], v27, s[8:11], s71 offen sc1
 s_waitcnt vmcnt(16)
 s_bitcmp1_b32 s69, 0
 s_cbranch_scc1 L_rx0
 v_dot2c_f32_bf16 v48, v128, v24
 v_dot2c_f32_bf16 v49, v128, v25
 v_dot2c_f32_bf16 v50, v129, v24
 v_dot2c_f32_bf16 v51, v129, v25
 v_dot2c_f32_bf16 v52, v130, v24
 v_dot2c_f32_bf16 v53, v130, v25
 v_dot2c_f32_bf16 v54, v131, v24
 v_dot2c_f32_bf16 v55, v131, v25
 v_dot2c_f32_bf16 v56, v132, v24
 v_dot2c_f32_bf16 v57, v132, v25
 v_dot2c_f32_bf16 v58, v133, v24
 v_dot2c_f32_bf16 v59, v133, v25
 v_dot2c_f32_bf16 v60, v134, v24
 v_dot2c_f32_bf16 v61, v134, v25
 v_dot2c_f32_bf16 v62, v135, v24
 v_dot2c_f32_bf16 v63, v135, v25
L_ry0:
 s_cmp_lg_u32 s70, 0
 s_cbranch_scc1 L_rk9
 s_call_b64 s[36:37], L_rpoll
L_rk9:
 s_ff1_i32_b32 s71, s70
 s_bitset0_b32 s70, s71
 s_cmp_ge_u32 s71, 16
 s_cselect_b32 s72, s78, s77
 s_cselect_b32 s73, 0x200, 0
 s_cselect_b32 s87, 536870912, 0
 s_mul_i32 s71, s71, 114688
 s_add_u32 s71, s71, s72
 buffer_load_dwordx4 v[200:203], v7, s[8:11], s71 offen sc1
 s_or_b32 s69, s69, s73
 s_or_b32 s71, s71, s87
 buffer_load_dwordx4 v[204:207], v27, s[8:11], s71 offen sc1
 s_waitcnt vmcnt(16)
 s_bitcmp1_b32 s69, 1
 s_cbranch_scc1 L_rx1
 v_dot2c_f32_bf16 v48, v136, v24
 v_dot2c_f32_bf16 v49, v136, v25
 v_dot2c_f32_bf16 v50, v137, v24
 v_dot2c_f32_bf16 v51, v137, v25
 v_dot2c_f32_bf16 v52, v138, v24
 v_dot2c_f32_bf16 v53, v138, v25
 v_dot2c_f32_bf16 v54, v139, v24
 v_dot2c_f32_bf16 v55, v139, v25
 v_dot2c_f32_bf16 v56, v140, v24
 v_dot2c_f32_bf16 v57, v140, v25
 v_dot2c_f32_bf16 v58, v141, v24
 v_dot2c_f32_bf16 v59, v141, v25
 v_dot2c_f32_bf16 v60, v142, v24
 v_dot2c_f32_bf16 v61, v142, v25
 v_dot2c_f32_bf16 v62, v143, v24
 v_dot2c_f32_bf16 v63, v143, v25
L_ry1:
 s_cmp_lg_u32 s70, 0
 s_cbranch_scc1 L_rk10
 s_call_b64 s[36:37], L_rpoll
L_rk10:
 s_ff1_i32_b32 s71, s70
 s_bitset0_b32 s70, s71
 s_cmp_ge_u32 s71, 16
 s_cselect_b32 s72, s78, s77
 s_cselect_b32 s73, 0x400, 0
 s_cselect_b32 s87, 536870912, 0
 s_mul_i32 s71, s71, 114688
 s_add_u32 s71, s71, s72
 buffer_load_dwordx4 v[208:211], v7, s[8:11], s71 offen sc1
 s_or_b32 s69, s69, s73
 s_or_b32 s71, s71, s87
 buffer_load_dwordx4 v[212:215], v27, s[8:11], s71 offen sc1
 s_waitcnt vmcnt(16)
 s_bitcmp1_b32 s69, 2
 s_cbranch_scc1 L_rx2
 v_dot2c_f32_bf16 v48, v144, v24
 v_dot2c_f32_bf16 v49, v144, v25
 v_dot2c_f32_bf16 v50, v145, v24
 v_dot2c_f32_bf16 v51, v145, v25
 v_dot2c_f32_bf16 v52, v146, v24
 v_dot2c_f32_bf16 v53, v146, v25
 v_dot2c_f32_bf16 v54, v147, v24
 v_dot2c_f32_bf16 v55, v147, v25
 v_dot2c_f32_bf16 v56, v148, v24
 v_dot2c_f32_bf16 v57, v148, v25
 v_dot2c_f32_bf16 v58, v149, v24
 v_dot2c_f32_bf16 v59, v149, v25
 v_dot2c_f32_bf16 v60, v150, v24
 v_dot2c_f32_bf16 v61, v150, v25
 v_dot2c_f32_bf16 v62, v151, v24
 v_dot2c_f32_bf16 v63, v151, v25
L_ry2:
 s_cmp_lg_u32 s70, 0
 s_cbranch_scc1 L_rk11
 s_call_b64 s[36:37], L_rpoll
L_rk11:
 s_ff1_i32_b32 s71, s70
 s_bitset0_b32 s70, s71
 s_cmp_ge_u32 s71, 16
 s_cselect_b32 s72, s78, s77
 s_cselect_b32 s73, 0x800, 0
 s_cselect_b32 s87, 536870912, 0
 s_mul_i32 s71, s71, 114688
 s_add_u32 s71, s71, s72
 buffer_load_dwordx4 v[216:219], v7, s[8:11], s71 offen sc1
 s_or_b32 s69, s69, s73
 s_or_b32 s71, s71, s87
 buffer_load_dwordx4 v[220:223], v27, s[8:11], s71 offen sc1
 s_waitcnt vmcnt(16)
 s_bitcmp1_b32 s69, 3
 s_cbranch_scc1 L_rx3
 v_dot2c_f32_bf16 v48, v152, v24
 v_dot2c_f32_bf16 v49, v152, v25
 v_dot2c_f32_bf16 v50, v153, v24
 v_dot2c_f32_bf16 v51, v153, v25
 v_dot2c_f32_bf16 v52, v154, v24
 v_dot2c_f32_bf16 v53, v154, v25
 v_dot2c_f32_bf16 v54, v155, v24
 v_dot2c_f32_bf16 v55, v155, v25
 v_dot2c_f32_bf16 v56, v156, v24
 v_dot2c_f32_bf16 v57, v156, v25
 v_dot2c_f32_bf16 v58, v157, v24
 v_dot2c_f32_bf16 v59, v157, v25
 v_dot2c_f32_bf16 v60, v158, v24
 v_dot2c_f32_bf16 v61, v158, v25
 v_dot2c_f32_bf16 v62, v159, v24
 v_dot2c_f32_bf16 v63, v159, v25
L_ry3:
 s_cmp_lg_u32 s70, 0
 s_cbranch_scc1 L_rk12
 s_call_b64 s[36:37], L_rpoll
L_rk12:
 s_ff1_i32_b32 s71, s70
 s_bitset0_b32 s70, s71
 s_cmp_ge_u32 s71, 16
 s_cselect_b32 s72, s78, s77
 s_cselect_b32 s73, 0x1000, 0
 s_cselect_b32 s87, 536870912, 0
 s_mul_i32 s71, s71, 114688
 s_add_u32 s71, s71, s72
 buffer_load_dwordx4 v[224:227], v7, s[8:11], s71 offen sc1
 s_or_b32 s69, s69, s73
 s_or_b32 s71, s71, s87
 buffer_load_dwordx4 v[228:231], v27, s[8:11], s71 offen sc1
 s_waitcnt vmcnt(16)
 s_bitcmp1_b32 s69, 4
 s_cbranch_scc1 L_rx4
 v_dot2c_f32_bf16 v48, v160, v24
 v_dot2c_f32_bf16 v49, v160, v25
 v_dot2c_f32_bf16 v50, v161, v24
 v_dot2c_f32_bf16 v51, v161, v25
 v_dot2c_f32_bf16 v52, v162, v24
 v_dot2c_f32_bf16 v53, v162, v25
 v_dot2c_f32_bf16 v54, v163, v24
 v_dot2c_f32_bf16 v55, v163, v25
 v_dot2c_f32_bf16 v56, v164, v24
 v_dot2c_f32_bf16 v57, v164, v25
 v_dot2c_f32_bf16 v58, v165, v24
 v_dot2c_f32_bf16 v59, v165, v25
 v_dot2c_f32_bf16 v60, v166, v24
 v_dot2c_f32_bf16 v61, v166, v25
 v_dot2c_f32_bf16 v62, v167, v24
 v_dot2c_f32_bf16 v63, v167, v25
L_ry4:
 s_cmp_lg_u32 s70, 0
 s_cbranch_scc1 L_rk13
 s_call_b64 s[36:37], L_rpoll
L_rk13:
 s_ff1_i32_b32 s71, s70
 s_bitset0_b32 s70, s71
 s_cmp_ge_u32 s71, 16
 s_cselect_b32 s72, s78, s77
 s_cselect_b32 s73, 0x2000, 0
 s_cselect_b32 s87, 536870912, 0
 s_mul_i32 s71, s71, 114688
 s_add_u32 s71, s71, s72
 buffer_load_dwordx4 v[232:235], v7, s[8:11], s71 offen sc1
 s_or_b32 s69, s69, s73
 s_or_b32 s71, s71, s87
 buffer_load_dwordx4 v[236:239], v27, s[8:11], s71 offen sc1
 s_waitcnt vmcnt(16)
 s_bitcmp1_b32 s69, 5
 s_cbranch_scc1 L_rx5
 v_dot2c_f32_bf16 v48, v168, v24
 v_dot2c_f32_bf16 v49, v168, v25
 v_dot2c_f32_bf16 v50, v169, v24
 v_dot2c_f32_bf16 v51, v169, v25
 v_dot2c_f32_bf16 v52, v170, v24
 v_dot2c_f32_bf16 v53, v170, v25
 v_dot2c_f32_bf16 v54, v171, v24
 v_dot2c_f32_bf16 v55, v171, v25
 v_dot2c_f32_bf16 v56, v172, v24
 v_dot2c_f32_bf16 v57, v172, v25
 v_dot2c_f32_bf16 v58, v173, v24
 v_dot2c_f32_bf16 v59, v173, v25
 v_dot2c_f32_bf16 v60, v174, v24
 v_dot2c_f32_bf16 v61, v174, v25
 v_dot2c_f32_bf16 v62, v175, v24
 v_dot2c_f32_bf16 v63, v175, v25
L_ry5:
 s_cmp_lg_u32 s70, 0
 s_cbranch_scc1 L_rk14
 s_call_b64 s[36:37], L_rpoll
L_rk14:
 s_ff1_i32_b32 s71, s70
 s_bitset0_b32 s70, s71
 s_cmp_ge_u32 s71, 16
 s_cselect_b32 s72, s78, s77
 s_cselect_b32 s73, 0x4000, 0
 s_cselect_b32 s87, 536870912, 0
 s_mul_i32 s71, s71, 114688
 s_add_u32 s71, s71, s72
 buffer_load_dwordx4 v[240:243], v7, s[8:11], s71 offen sc1
 s_or_b32 s69, s69, s73
 s_or_b32 s71, s71, s87
 buffer_load_dwordx4 v[244:247], v27, s[8:11], s71 offen sc1
 s_waitcnt vmcnt(16)
 s_bitcmp1_b32 s69, 6
 s_cbranch_scc1 L_rx6
 v_dot2c_f32_bf16 v48, v176, v24
 v_dot2c_f32_bf16 v49, v176, v25
 v_dot2c_f32_bf16 v50, v177, v24
 v_dot2c_f32_bf16 v51, v177, v25
 v_dot2c_f32_bf16 v52, v178, v24
 v_dot2c_f32_bf16 v53, v178, v25
 v_dot2c_f32_bf16 v54, v179, v24
 v_dot2c_f32_bf16 v55, v179, v25
 v_dot2c_f32_bf16 v56, v180, v24
 v_dot2c_f32_bf16 v57, v180, v25
 v_dot2c_f32_bf16 v58, v181, v24
 v_dot2c_f32_bf16 v59, v181, v25
 v_dot2c_f32_bf16 v60, v182, v24
 v_dot2c_f32_bf16 v61, v182, v25
 v_dot2c_f32_bf16 v62, v183, v24
 v_dot2c_f32_bf16 v63, v183, v25
L_ry6:
 s_cmp_lg_u32 s70, 0
 s_cbranch_scc1 L_rk15
 s_call_b64 s[36:37], L_rpoll
L_rk15:
 s_ff1_i32_b32 s71, s70
 s_bitset0_b32 s70, s71
 s_cmp_ge_u32 s71, 16
 s_cselect_b32 s72, s78, s77
 s_cselect_b32 s73, 0x8000, 0
 s_cselect_b32 s87, 536870912, 0
 s_mul_i32 s71, s71, 114688
 s_add_u32 s71, s71, s72
 buffer_load_dwordx4 v[248:251], v7, s[8:11], s71 offen sc1
 s_or_b32 s69, s69, s73
 s_or_b32 s71, s71, s87
 buffer_load_dwordx4 v[252:255], v27, s[8:11], s71 offen sc1
 s_waitcnt vmcnt(16)
 s_bitcmp1_b32 s69, 7
 s_cbranch_scc1 L_rx7
 v_dot2c_f32_bf16 v48, v184, v24
 v_dot2c_f32_bf16 v49, v184, v25
 v_dot2c_f32_bf16 v50, v185, v24
 v_dot2c_f32_bf16 v51, v185, v25
 v_dot2c_f32_bf16 v52, v186, v24
 v_dot2c_f32_bf16 v53, v186, v25
 v_dot2c_f32_bf16 v54, v187, v24
 v_dot2c_f32_bf16 v55, v187, v25
 v_dot2c_f32_bf16 v56, v188, v24
 v_dot2c_f32_bf16 v57, v188, v25
 v_dot2c_f32_bf16 v58, v189, v24
 v_dot2c_f32_bf16 v59, v189, v25
 v_dot2c_f32_bf16 v60, v190, v24
 v_dot2c_f32_bf16 v61, v190, v25
 v_dot2c_f32_bf16 v62, v191, v24
 v_dot2c_f32_bf16 v63, v191, v25
L_ry7:
 s_cmp_lg_u32 s70, 0
 s_cbranch_scc1 L_rk16
 s_call_b64 s[36:37], L_rpoll
L_rk16:
 s_ff1_i32_b32 s71, s70
 s_bitset0_b32 s70, s71
 s_cmp_ge_u32 s71, 16
 s_cselect_b32 s72, s78, s77
 s_cselect_b32 s73, 0x10000, 0
 s_cselect_b32 s87, 536870912, 0
 s_mul_i32 s71, s71, 114688
 s_add_u32 s71, s71, s72
 buffer_load_dwordx4 v[128:131], v7, s[8:11], s71 offen sc1
 s_or_b32 s69, s69, s73
 s_or_b32 s71, s71, s87
 buffer_load_dwordx4 v[132:135], v27, s[8:11], s71 offen sc1
 s_waitcnt vmcnt(16)
 s_bitcmp1_b32 s69, 8
 s_cbranch_scc1 L_rx8
 v_dot2c_f32_bf16 v48, v192, v24
 v_dot2c_f32_bf16 v49, v192, v25
 v_dot2c_f32_bf16 v50, v193, v24
 v_dot2c_f32_bf16 v51, v193, v25
 v_dot2c_f32_bf16 v52, v194, v24
 v_dot2c_f32_bf16 v53, v194, v25
 v_dot2c_f32_bf16 v54, v195, v24
 v_dot2c_f32_bf16 v55, v195, v25
 v_dot2c_f32_bf16 v56, v196, v24
 v_dot2c_f32_bf16 v57, v196, v25
 v_dot2c_f32_bf16 v58, v197, v24
 v_dot2c_f32_bf16 v59, v197, v25
 v_dot2c_f32_bf16 v60, v198, v24
 v_dot2c_f32_bf16 v61, v198, v25
 v_dot2c_f32_bf16 v62, v199, v24
 v_dot2c_f32_bf16 v63, v199, v25
L_ry8:
 s_cmp_lg_u32 s70, 0
 s_cbranch_scc1 L_rk17
 s_call_b64 s[36:37], L_rpoll
L_rk17:
 s_ff1_i32_b32 s71, s70
 s_bitset0_b32 s70, s71
 s_cmp_ge_u32 s71, 16
 s_cselect_b32 s72, s78, s77
 s_cselect_b32 s73, 0x20000, 0
 s_cselect_b32 s87, 536870912, 0
 s_mul_i32 s71, s71, 114688
 s_add_u32 s71, s71, s72
 buffer_load_dwordx4 v[136:139], v7, s[8:11], s71 offen sc1
 s_or_b32 s69, s69, s73
 s_or_b32 s71, s71, s87
 buffer_load_dwordx4 v[140:143], v27, s[8:11], s71 offen sc1
 s_waitcnt vmcnt(16)
 s_bitcmp1_b32 s69, 9
 s_cbranch_scc1 L_rx9
 v_dot2c_f32_bf16 v48, v200, v24
 v_dot2c_f32_bf16 v49, v200, v25
 v_dot2c_f32_bf16 v50, v201, v24
 v_dot2c_f32_bf16 v51, v201, v25
 v_dot2c_f32_bf16 v52, v202, v24
 v_dot2c_f32_bf16 v53, v202, v25
 v_dot2c_f32_bf16 v54, v203, v24
 v_dot2c_f32_bf16 v55, v203, v25
 v_dot2c_f32_bf16 v56, v204, v24
 v_dot2c_f32_bf16 v57, v204, v25
 v_dot2c_f32_bf16 v58, v205, v24
 v_dot2c_f32_bf16 v59, v205, v25
 v_dot2c_f32_bf16 v60, v206, v24
 v_dot2c_f32_bf16 v61, v206, v25
 v_dot2c_f32_bf16 v62, v207, v24
 v_dot2c_f32_bf16 v63, v207, v25
L_ry9:
 s_cmp_lg_u32 s70, 0
 s_cbranch_scc1 L_rk18
 s_call_b64 s[36:37], L_rpoll
L_rk18:
 s_ff1_i32_b32 s71, s70
 s_bitset0_b32 s70, s71
 s_cmp_ge_u32 s71, 16
 s_cselect_b32 s72, s78, s77
 s_cselect_b32 s73, 0x40000, 0
 s_cselect_b32 s87, 536870912, 0
 s_mul_i32 s71, s71, 114688
 s_add_u32 s71, s71, s72
 buffer_load_dwordx4 v[144:147], v7, s[8:11], s71 offen sc1
 s_or_b32 s69, s69, s73
 s_or_b32 s71, s71, s87
 buffer_load_dwordx4 v[148:151], v27, s[8:11], s71 offen sc1
 s_waitcnt vmcnt(16)
 s_bitcmp1_b32 s69, 10
 s_cbranch_scc1 L_rx10
 v_dot2c_f32_bf16 v48, v208, v24
 v_dot2c_f32_bf16 v49, v208, v25
 v_dot2c_f32_bf16 v50, v209, v24
 v_dot2c_f32_bf16 v51, v209, v25
 v_dot2c_f32_bf16 v52, v210, v24
 v_dot2c_f32_bf16 v53, v210, v25
 v_dot2c_f32_bf16 v54, v211, v24
 v_dot2c_f32_bf16 v55, v211, v25
 v_dot2c_f32_bf16 v56, v212, v24
 v_dot2c_f32_bf16 v57, v212, v25
 v_dot2c_f32_bf16 v58, v213, v24
 v_dot2c_f32_bf16 v59, v213, v25
 v_dot2c_f32_bf16 v60, v214, v24
 v_dot2c_f32_bf16 v61, v214, v25
 v_dot2c_f32_bf16 v62, v215, v24
 v_dot2c_f32_bf16 v63, v215, v25
L_ry10:
 s_cmp_lg_u32 s70, 0
 s_cbranch_scc1 L_rk19
 s_call_b64 s[36:37], L_rpoll
L_rk19:
 s_ff1_i32_b32 s71, s70
 s_bitset0_b32 s70, s71
 s_cmp_ge_u32 s71, 16
 s_cselect_b32 s72, s78, s77
 s_cselect_b32 s73, 0x80000, 0
 s_cselect_b32 s87, 536870912, 0
 s_mul_i32 s71, s71, 114688
 s_add_u32 s71, s71, s72
 buffer_load_dwordx4 v[152:155], v7, s[8:11], s71 offen sc1
 s_or_b32 s69, s69, s73
 s_or_b32 s71, s71, s87
 buffer_load_dwordx4 v[156:159], v27, s[8:11], s71 offen sc1
 s_waitcnt vmcnt(16)
 s_bitcmp1_b32 s69, 11
 s_cbranch_scc1 L_rx11
 v_dot2c_f32_bf16 v48, v216, v24
 v_dot2c_f32_bf16 v49, v216, v25
 v_dot2c_f32_bf16 v50, v217, v24
 v_dot2c_f32_bf16 v51, v217, v25
 v_dot2c_f32_bf16 v52, v218, v24
 v_dot2c_f32_bf16 v53, v218, v25
 v_dot2c_f32_bf16 v54, v219, v24
 v_dot2c_f32_bf16 v55, v219, v25
 v_dot2c_f32_bf16 v56, v220, v24
 v_dot2c_f32_bf16 v57, v220, v25
 v_dot2c_f32_bf16 v58, v221, v24
 v_dot2c_f32_bf16 v59, v221, v25
 v_dot2c_f32_bf16 v60, v222, v24
 v_dot2c_f32_bf16 v61, v222, v25
 v_dot2c_f32_bf16 v62, v223, v24
 v_dot2c_f32_bf16 v63, v223, v25
L_ry11:
 s_cmp_lg_u32 s70, 0
 s_cbranch_scc1 L_rk20
 s_call_b64 s[36:37], L_rpoll
L_rk20:
 s_ff1_i32_b32 s71, s70
 s_bitset0_b32 s70, s71
 s_cmp_ge_u32 s71, 16
 s_cselect_b32 s72, s78, s77
 s_cselect_b32 s73, 0x100000, 0
 s_cselect_b32 s87, 536870912, 0
 s_mul_i32 s71, s71, 114688
 s_add_u32 s71, s71, s72
 buffer_load_dwordx4 v[160:163], v7, s[8:11], s71 offen sc1
 s_or_b32 s69, s69, s73
 s_or_b32 s71, s71, s87
 buffer_load_dwordx4 v[164:167], v27, s[8:11], s71 offen sc1
 s_waitcnt vmcnt(16)
 s_bitcmp1_b32 s69, 12
 s_cbranch_scc1 L_rx12
 v_dot2c_f32_bf16 v48, v224, v24
 v_dot2c_f32_bf16 v49, v224, v25
 v_dot2c_f32_bf16 v50, v225, v24
 v_dot2c_f32_bf16 v51, v225, v25
 v_dot2c_f32_bf16 v52, v226, v24
 v_dot2c_f32_bf16 v53, v226, v25
 v_dot2c_f32_bf16 v54, v227, v24
 v_dot2c_f32_bf16 v55, v227, v25
 v_dot2c_f32_bf16 v56, v228, v24
 v_dot2c_f32_bf16 v57, v228, v25
 v_dot2c_f32_bf16 v58, v229, v24
 v_dot2c_f32_bf16 v59, v229, v25
 v_dot2c_f32_bf16 v60, v230, v24
 v_dot2c_f32_bf16 v61, v230, v25
 v_dot2c_f32_bf16 v62, v231, v24
 v_dot2c_f32_bf16 v63, v231, v25
L_ry12:
 s_cmp_lg_u32 s70, 0
 s_cbranch_scc1 L_rk21
 s_call_b64 s[36:37], L_rpoll
L_rk21:
 s_ff1_i32_b32 s71, s70
 s_bitset0_b32 s70, s71
 s_cmp_ge_u32 s71, 16
 s_cselect_b32 s72, s78, s77
 s_cselect_b32 s73, 0x200000, 0
 s_cselect_b32 s87, 536870912, 0
 s_mul_i32 s71, s71, 114688
 s_add_u32 s71, s71, s72
 buffer_load_dwordx4 v[168:171], v7, s[8:11], s71 offen sc1
 s_or_b32 s69, s69, s73
 s_or_b32 s71, s71, s87
 buffer_load_dwordx4 v[172:175], v27, s[8:11], s71 offen sc1
 s_waitcnt vmcnt(16)
 s_bitcmp1_b32 s69, 13
 s_cbranch_scc1 L_rx13
 v_dot2c_f32_bf16 v48, v232, v24
 v_dot2c_f32_bf16 v49, v232, v25
 v_dot2c_f32_bf16 v50, v233, v24
 v_dot2c_f32_bf16 v51, v233, v25
 v_dot2c_f32_bf16 v52, v234, v24
 v_dot2c_f32_bf16 v53, v234, v25
 v_dot2c_f32_bf16 v54, v235, v24
 v_dot2c_f32_bf16 v55, v235, v25
 v_dot2c_f32_bf16 v56, v236, v24
 v_dot2c_f32_bf16 v57, v236, v25
 v_dot2c_f32_bf16 v58, v237, v24
 v_dot2c_f32_bf16 v59, v237, v25
 v_dot2c_f32_bf16 v60, v238, v24
 v_dot2c_f32_bf16 v61, v238, v25
 v_dot2c_f32_bf16 v62, v239, v24
 v_dot2c_f32_bf16 v63, v239, v25
L_ry13:
 s_cmp_lg_u32 s70, 0
 s_cbranch_scc1 L_rk22
 s_call_b64 s[36:37], L_rpoll
L_rk22:
 s_ff1_i32_b32 s71, s70
 s_bitset0_b32 s70, s71
 s_cmp_ge_u32 s71, 16
 s_cselect_b32 s72, s78, s77
 s_cselect_b32 s73, 0x400000, 0
 s_cselect_b32 s87, 536870912, 0
 s_mul_i32 s71, s71, 114688
 s_add_u32 s71, s71, s72
 buffer_load_dwordx4 v[176:179], v7, s[8:11], s71 offen sc1
 s_or_b32 s69, s69, s73
 s_or_b32 s71, s71, s87
 buffer_load_dwordx4 v[180:183], v27, s[8:11], s71 offen sc1
 s_waitcnt vmcnt(16)
 s_bitcmp1_b32 s69, 14
 s_cbranch_scc1 L_rx14
 v_dot2c_f32_bf16 v48, v240, v24
 v_dot2c_f32_bf16 v49, v240, v25
 v_dot2c_f32_bf16 v50, v241, v24
 v_dot2c_f32_bf16 v51, v241, v25
 v_dot2c_f32_bf16 v52, v242, v24
 v_dot2c_f32_bf16 v53, v242, v25
 v_dot2c_f32_bf16 v54, v243, v24
 v_dot2c_f32_bf16 v55, v243, v25
 v_dot2c_f32_bf16 v56, v244, v24
 v_dot2c_f32_bf16 v57, v244, v25
 v_dot2c_f32_bf16 v58, v245, v24
 v_dot2c_f32_bf16 v59, v245, v25
 v_dot2c_f32_bf16 v60, v246, v24
 v_dot2c_f32_bf16 v61, v246, v25
 v_dot2c_f32_bf16 v62, v247, v24
 v_dot2c_f32_bf16 v63, v247, v25
L_ry14:
 s_cmp_lg_u32 s70, 0
 s_cbranch_scc1 L_rk23
 s_call_b64 s[36:37], L_rpoll
L_rk23:
 s_ff1_i32_b32 s71, s70
 s_bitset0_b32 s70, s71
 s_cmp_ge_u32 s71, 16
 s_cselect_b32 s72, s78, s77
 s_cselect_b32 s73, 0x800000, 0
 s_cselect_b32 s87, 536870912, 0
 s_mul_i32 s71, s71, 114688
 s_add_u32 s71, s71, s72
 buffer_load_dwordx4 v[184:187], v7, s[8:11], s71 offen sc1
 s_or_b32 s69, s69, s73
 s_or_b32 s71, s71, s87
 buffer_load_dwordx4 v[188:191], v27, s[8:11], s71 offen sc1
 s_waitcnt vmcnt(16)
 s_bitcmp1_b32 s69, 15
 s_cbranch_scc1 L_rx15
 v_dot2c_f32_bf16 v48, v248, v24
 v_dot2c_f32_bf16 v49, v248, v25
 v_dot2c_f32_bf16 v50, v249, v24
 v_dot2c_f32_bf16 v51, v249, v25
 v_dot2c_f32_bf16 v52, v250, v24
 v_dot2c_f32_bf16 v53, v250, v25
 v_dot2c_f32_bf16 v54, v251, v24
 v_dot2c_f32_bf16 v55, v251, v25
 v_dot2c_f32_bf16 v56, v252, v24
 v_dot2c_f32_bf16 v57, v252, v25
 v_dot2c_f32_bf16 v58, v253, v24
 v_dot2c_f32_bf16 v59, v253, v25
 v_dot2c_f32_bf16 v60, v254, v24
 v_dot2c_f32_bf16 v61, v254, v25
 v_dot2c_f32_bf16 v62, v255, v24
 v_dot2c_f32_bf16 v63, v255, v25
L_ry15:
 s_cmp_lg_u32 s70, 0
 s_cbranch_scc1 L_rk24
 s_call_b64 s[36:37], L_rpoll
L_rk24:
 s_ff1_i32_b32 s71, s70
 s_bitset0_b32 s70, s71
 s_cmp_ge_u32 s71, 16
 s_cselect_b32 s72, s78, s77
 s_cselect_b32 s73, 0x1000000, 0
 s_cselect_b32 s87, 536870912, 0
 s_mul_i32 s71, s71, 114688
 s_add_u32 s71, s71, s72
 buffer_load_dwordx4 v[192:195], v7, s[8:11], s71 offen sc1
 s_or_b32 s69, s69, s73
 s_or_b32 s71, s71, s87
 buffer_load_dwordx4 v[196:199], v27, s[8:11], s71 offen sc1
 s_waitcnt vmcnt(16)
 s_bitcmp0_b32 s69, 16
 s_cbranch_scc1 L_rx16
 v_dot2c_f32_bf16 v64, v128, v24
 v_dot2c_f32_bf16 v65, v128, v25
 v_dot2c_f32_bf16 v66, v129, v24
 v_dot2c_f32_bf16 v67, v129, v25
 v_dot2c_f32_bf16 v68, v130, v24
 v_dot2c_f32_bf16 v69, v130, v25
 v_dot2c_f32_bf16 v70, v131, v24
 v_dot2c_f32_bf16 v71, v131, v25
L_ry16:
 s_cmp_lg_u32 s70, 0
 s_cbranch_scc1 L_rk25
 s_call_b64 s[36:37], L_rpoll
L_rk25:
 s_ff1_i32_b32 s71, s70
 s_bitset0_b32 s70, s71
 s_cmp_ge_u32 s71, 16
 s_cselect_b32 s72, s78, s77
 s_cselect_b32 s73, 0x2000000, 0
 s_cselect_b32 s87, 536870912, 0
 s_mul_i32 s71, s71, 114688
 s_add_u32 s71, s71, s72
 buffer_load_dwordx4 v[200:203], v7, s[8:11], s71 offen sc1
 s_or_b32 s69, s69, s73
 s_or_b32 s71, s71, s87
 buffer_load_dwordx4 v[204:207], v27, s[8:11], s71 offen sc1
 s_waitcnt vmcnt(16)
 s_bitcmp0_b32 s69, 17
 s_cbranch_scc1 L_rx17
 v_dot2c_f32_bf16 v64, v136, v24
 v_dot2c_f32_bf16 v65, v136, v25
 v_dot2c_f32_bf16 v66, v137, v24
 v_dot2c_f32_bf16 v67, v137, v25
 v_dot2c_f32_bf16 v68, v138, v24
 v_dot2c_f32_bf16 v69, v138, v25
 v_dot2c_f32_bf16 v70, v139, v24
 v_dot2c_f32_bf16 v71, v139, v25
L_ry17:
 s_cmp_lg_u32 s70, 0
 s_cbranch_scc1 L_rk26
 s_call_b64 s[36:37], L_rpoll
L_rk26:
 s_ff1_i32_b32 s71, s70
 s_bitset0_b32 s70, s71
 s_cmp_ge_u32 s71, 16
 s_cselect_b32 s72, s78, s77
 s_cselect_b32 s73, 0x4000000, 0
 s_cselect_b32 s87, 536870912, 0
 s_mul_i32 s71, s71, 114688
 s_add_u32 s71, s71, s72
 buffer_load_dwordx4 v[208:211], v7, s[8:11], s71 offen sc1
 s_or_b32 s69, s69, s73
 s_or_b32 s71, s71, s87
 buffer_load_dwordx4 v[212:215], v27, s[8:11], s71 offen sc1
 s_waitcnt vmcnt(16)
 s_bitcmp0_b32 s69, 18
 s_cbranch_scc1 L_rx18
 v_dot2c_f32_bf16 v64, v144, v24
 v_dot2c_f32_bf16 v65, v144, v25
 v_dot2c_f32_bf16 v66, v145, v24
 v_dot2c_f32_bf16 v67, v145, v25
 v_dot2c_f32_bf16 v68, v146, v24
 v_dot2c_f32_bf16 v69, v146, v25
 v_dot2c_f32_bf16 v70, v147, v24
 v_dot2c_f32_bf16 v71, v147, v25
L_ry18:
 s_cmp_lg_u32 s70, 0
 s_cbranch_scc1 L_rk27
 s_call_b64 s[36:37], L_rpoll
L_rk27:
 s_ff1_i32_b32 s71, s70
 s_bitset0_b32 s70, s71
 s_cmp_ge_u32 s71, 16
 s_cselect_b32 s72, s78, s77
 s_cselect_b32 s73, 0x8000000, 0
 s_cselect_b32 s87, 536870912, 0
 s_mul_i32 s71, s71, 114688
 s_add_u32 s71, s71, s72
 buffer_load_dwordx4 v[216:219], v7, s[8:11], s71 offen sc1
 s_or_b32 s69, s69, s73
 s_or_b32 s71, s71, s87
 buffer_load_dwordx4 v[220:223], v27, s[8:11], s71 offen sc1
 s_waitcnt vmcnt(16)
 s_bitcmp0_b32 s69, 19
 s_cbranch_scc1 L_rx19
 v_dot2c_f32_bf16 v64, v152, v24
 v_dot2c_f32_bf16 v65, v152, v25
 v_dot2c_f32_bf16 v66, v153, v24
 v_dot2c_f32_bf16 v67, v153, v25
 v_dot2c_f32_bf16 v68, v154, v24
 v_dot2c_f32_bf16 v69, v154, v25
 v_dot2c_f32_bf16 v70, v155, v24
 v_dot2c_f32_bf16 v71, v155, v25
L_ry19:
 s_and_b32 s71, s69, 0xfffff
 s_bcnt1_i32_b32 s71, s71
 s_cmp_eq_u32 s71, 4
 s_cselect_b32 s66, 1, 0
 s_cbranch_scc0 L_rne
 v_fmac_f32 v32, v15, v48
 v_fmac_f32 v33, v15, v49
 v_fmac_f32 v34, v15, v50
 v_fmac_f32 v35, v15, v51
 v_fmac_f32 v36, v15, v52
 v_fmac_f32 v37, v15, v53
 v_fmac_f32 v38, v15, v54
 v_fmac_f32 v39, v15, v55
 v_cvt_pk_bf16_f32 v16, v32, v33
 v_cvt_pk_bf16_f32 v17, v34, v35
 v_cvt_pk_bf16_f32 v18, v36, v37
 v_cvt_pk_bf16_f32 v19, v38, v39
 buffer_store_dwordx4 v[16:19], v12, s[52:55], s75 offen sc1
 v_fmac_f32 v40, v15, v56
 v_fmac_f32 v41, v15, v57
 v_fmac_f32 v42, v15, v58
 v_fmac_f32 v43, v15, v59
 v_fmac_f32 v44, v15, v60
 v_fmac_f32 v45, v15, v61
 v_fmac_f32 v46, v15, v62
 v_fmac_f32 v47, v15, v63
 v_cvt_pk_bf16_f32 v20, v40, v41
 v_cvt_pk_bf16_f32 v21, v42, v43
 v_cvt_pk_bf16_f32 v22, v44, v45
 v_cvt_pk_bf16_f32 v23, v46, v47
 buffer_store_dwordx4 v[20:23], v12, s[52:55], s76 offen sc1
L_rne:
 s_cmp_lg_u32 s70, 0
 s_cbranch_scc1 L_rk28
 s_call_b64 s[36:37], L_rpoll
L_rk28:
 s_ff1_i32_b32 s71, s70
 s_bitset0_b32 s70, s71
 s_cmp_ge_u32 s71, 16
 s_cselect_b32 s72, s78, s77
 s_cselect_b32 s73, 0x10000000, 0
 s_cselect_b32 s87, 536870912, 0
 s_mul_i32 s71, s71, 114688
 s_add_u32 s71, s71, s72
 buffer_load_dwordx4 v[224:227], v7, s[8:11], s71 offen sc1
 s_or_b32 s69, s69, s73
 s_or_b32 s71, s71, s87
 buffer_load_dwordx4 v[228:231], v27, s[8:11], s71 offen sc1
 s_waitcnt vmcnt(16)
 s_bitcmp0_b32 s69, 20
 s_cbranch_scc1 L_rx20
 v_dot2c_f32_bf16 v64, v160, v24
 v_dot2c_f32_bf16 v65, v160, v25
 v_dot2c_f32_bf16 v66, v161, v24
 v_dot2c_f32_bf16 v67, v161, v25
 v_dot2c_f32_bf16 v68, v162, v24
 v_dot2c_f32_bf16 v69, v162, v25
 v_dot2c_f32_bf16 v70, v163, v24
 v_dot2c_f32_bf16 v71, v163, v25
L_ry20:
 s_cmp_lg_u32 s70, 0
 s_cbranch_scc1 L_rk29
 s_call_b64 s[36:37], L_rpoll
L_rk29:
 s_ff1_i32_b32 s71, s70
 s_bitset0_b32 s70, s71
 s_cmp_ge_u32 s71, 16
 s_cselect_b32 s72, s78, s77
 s_cselect_b32 s73, 0x20000000, 0
 s_cselect_b32 s87, 536870912, 0
 s_mul_i32 s71, s71, 114688
 s_add_u32 s71, s71, s72
 buffer_load_dwordx4 v[232:235], v7, s[8:11], s71 offen sc1
 s_or_b32 s69, s69, s73
 s_or_b32 s71, s71, s87
 buffer_load_dwordx4 v[236:239], v27, s[8:11], s71 offen sc1
 s_waitcnt vmcnt(16)
 s_bitcmp0_b32 s69, 21
 s_cbranch_scc1 L_rx21
 v_dot2c_f32_bf16 v64, v168, v24
 v_dot2c_f32_bf16 v65, v168, v25
 v_dot2c_f32_bf16 v66, v169, v24
 v_dot2c_f32_bf16 v67, v169, v25
 v_dot2c_f32_bf16 v68, v170, v24
 v_dot2c_f32_bf16 v69, v170, v25
 v_dot2c_f32_bf16 v70, v171, v24
 v_dot2c_f32_bf16 v71, v171, v25
L_ry21:
 s_cmp_lg_u32 s70, 0
 s_cbranch_scc1 L_rk30
 s_call_b64 s[36:37], L_rpoll
L_rk30:
 s_ff1_i32_b32 s71, s70
 s_bitset0_b32 s70, s71
 s_cmp_ge_u32 s71, 16
 s_cselect_b32 s72, s78, s77
 s_cselect_b32 s73, 0x40000000, 0
 s_cselect_b32 s87, 536870912, 0
 s_mul_i32 s71, s71, 114688
 s_add_u32 s71, s71, s72
 buffer_load_dwordx4 v[240:243], v7, s[8:11], s71 offen sc1
 s_or_b32 s69, s69, s73
 s_or_b32 s71, s71, s87
 buffer_load_dwordx4 v[244:247], v27, s[8:11], s71 offen sc1
 s_waitcnt vmcnt(16)
 s_bitcmp0_b32 s69, 22
 s_cbranch_scc1 L_rx22
 v_dot2c_f32_bf16 v64, v176, v24
 v_dot2c_f32_bf16 v65, v176, v25
 v_dot2c_f32_bf16 v66, v177, v24
 v_dot2c_f32_bf16 v67, v177, v25
 v_dot2c_f32_bf16 v68, v178, v24
 v_dot2c_f32_bf16 v69, v178, v25
 v_dot2c_f32_bf16 v70, v179, v24
 v_dot2c_f32_bf16 v71, v179, v25
L_ry22:
 s_cmp_lg_u32 s70, 0
 s_cbranch_scc1 L_rk31
 s_call_b64 s[36:37], L_rpoll
L_rk31:
 s_ff1_i32_b32 s71, s70
 s_bitset0_b32 s70, s71
 s_cmp_ge_u32 s71, 16
 s_cselect_b32 s72, s78, s77
 s_cselect_b32 s73, 0x80000000, 0
 s_cselect_b32 s87, 536870912, 0
 s_mul_i32 s71, s71, 114688
 s_add_u32 s71, s71, s72
 buffer_load_dwordx4 v[248:251], v7, s[8:11], s71 offen sc1
 s_or_b32 s69, s69, s73
 s_or_b32 s71, s71, s87
 buffer_load_dwordx4 v[252:255], v27, s[8:11], s71 offen sc1
 s_waitcnt vmcnt(16)
 s_bitcmp0_b32 s69, 23
 s_cbranch_scc1 L_rx23
 v_dot2c_f32_bf16 v64, v184, v24
 v_dot2c_f32_bf16 v65, v184, v25
 v_dot2c_f32_bf16 v66, v185, v24
 v_dot2c_f32_bf16 v67, v185, v25
 v_dot2c_f32_bf16 v68, v186, v24
 v_dot2c_f32_bf16 v69, v186, v25
 v_dot2c_f32_bf16 v70, v187, v24
 v_dot2c_f32_bf16 v71, v187, v25
L_ry23:
 s_waitcnt vmcnt(14)
 s_bitcmp0_b32 s69, 24
 s_cbranch_scc1 L_rx24
 v_dot2c_f32_bf16 v64, v192, v24
 v_dot2c_f32_bf16 v65, v192, v25
 v_dot2c_f32_bf16 v66, v193, v24
 v_dot2c_f32_bf16 v67, v193, v25
 v_dot2c_f32_bf16 v68, v194, v24
 v_dot2c_f32_bf16 v69, v194, v25
 v_dot2c_f32_bf16 v70, v195, v24
 v_dot2c_f32_bf16 v71, v195, v25
L_ry24:
 s_waitcnt vmcnt(12)
 s_bitcmp0_b32 s69, 25
 s_cbranch_scc1 L_rx25
 v_dot2c_f32_bf16 v64, v200, v24
 v_dot2c_f32_bf16 v65, v200, v25
 v_dot2c_f32_bf16 v66, v201, v24
 v_dot2c_f32_bf16 v67, v201, v25
 v_dot2c_f32_bf16 v68, v202, v24
 v_dot2c_f32_bf16 v69, v202, v25
 v_dot2c_f32_bf16 v70, v203, v24
 v_dot2c_f32_bf16 v71, v203, v25
L_ry25:
 s_waitcnt vmcnt(10)
 s_bitcmp0_b32 s69, 26
 s_cbranch_scc1 L_rx26
 v_dot2c_f32_bf16 v64, v208, v24
 v_dot2c_f32_bf16 v65, v208, v25
 v_dot2c_f32_bf16 v66, v209, v24
 v_dot2c_f32_bf16 v67, v209, v25
 v_dot2c_f32_bf16 v68, v210, v24
 v_dot2c_f32_bf16 v69, v210, v25
 v_dot2c_f32_bf16 v70, v211, v24
 v_dot2c_f32_bf16 v71, v211, v25
L_ry26:
 s_waitcnt vmcnt(8)
 s_bitcmp0_b32 s69, 27
 s_cbranch_scc1 L_rx27
 v_dot2c_f32_bf16 v64, v216, v24
 v_dot2c_f32_bf16 v65, v216, v25
 v_dot2c_f32_bf16 v66, v217, v24
 v_dot2c_f32_bf16 v67, v217, v25
 v_dot2c_f32_bf16 v68, v218, v24
 v_dot2c_f32_bf16 v69, v218, v25
 v_dot2c_f32_bf16 v70, v219, v24
 v_dot2c_f32_bf16 v71, v219, v25
L_ry27:
 s_waitcnt vmcnt(6)
 s_bitcmp0_b32 s69, 28
 s_cbranch_scc1 L_rx28
 v_dot2c_f32_bf16 v64, v224, v24
 v_dot2c_f32_bf16 v65, v224, v25
 v_dot2c_f32_bf16 v66, v225, v24
 v_dot2c_f32_bf16 v67, v225, v25
 v_dot2c_f32_bf16 v68, v226, v24
 v_dot2c_f32_bf16 v69, v226, v25
 v_dot2c_f32_bf16 v70, v227, v24
 v_dot2c_f32_bf16 v71, v227, v25
L_ry28:
 s_waitcnt vmcnt(4)
 s_bitcmp0_b32 s69, 29
 s_cbranch_scc1 L_rx29
 v_dot2c_f32_bf16 v64, v232, v24
 v_dot2c_f32_bf16 v65, v232, v25
 v_dot2c_f32_bf16 v66, v233, v24
 v_dot2c_f32_bf16 v67, v233, v25
 v_dot2c_f32_bf16 v68, v234, v24
 v_dot2c_f32_bf16 v69, v234, v25
 v_dot2c_f32_bf16 v70, v235, v24
 v_dot2c_f32_bf16 v71, v235, v25
L_ry29:
 s_waitcnt vmcnt(2)
 s_bitcmp0_b32 s69, 30
 s_cbranch_scc1 L_rx30
 v_dot2c_f32_bf16 v64, v240, v24
 v_dot2c_f32_bf16 v65, v240, v25
 v_dot2c_f32_bf16 v66, v241, v24
 v_dot2c_f32_bf16 v67, v241, v25
 v_dot2c_f32_bf16 v68, v242, v24
 v_dot2c_f32_bf16 v69, v242, v25
 v_dot2c_f32_bf16 v70, v243, v24
 v_dot2c_f32_bf16 v71, v243, v25
L_ry30:
 s_waitcnt vmcnt(0)
 s_bitcmp0_b32 s69, 31
 s_cbranch_scc1 L_rx31
 v_dot2c_f32_bf16 v64, v248, v24
 v_dot2c_f32_bf16 v65, v248, v25
 v_dot2c_f32_bf16 v66, v249, v24
 v_dot2c_f32_bf16 v67, v249, v25
 v_dot2c_f32_bf16 v68, v250, v24
 v_dot2c_f32_bf16 v69, v250, v25
 v_dot2c_f32_bf16 v70, v251, v24
 v_dot2c_f32_bf16 v71, v251, v25
L_ry31:
 s_nop 1
 v_fmac_f32 v80, v26, v64
 v_fmac_f32 v81, v26, v65
 v_fmac_f32 v82, v26, v66
 v_fmac_f32 v83, v26, v67
 v_fmac_f32 v84, v26, v68
 v_fmac_f32 v85, v26, v69
 v_fmac_f32 v86, v26, v70
 v_fmac_f32 v87, v26, v71
 v_cvt_pk_bf16_f32 v96, v80, v81
 v_cvt_pk_bf16_f32 v97, v82, v83
 v_cvt_pk_bf16_f32 v98, v84, v85
 v_cvt_pk_bf16_f32 v99, v86, v87
 buffer_store_dwordx4 v[96:99], v28, s[52:55], s86 offen sc1
 s_cmp_eq_u32 s66, 1
 s_cbranch_scc1 L_rdone
 v_fmac_f32 v32, v15, v48
 v_fmac_f32 v33, v15, v49
 v_fmac_f32 v34, v15, v50
 v_fmac_f32 v35, v15, v51
 v_fmac_f32 v36, v15, v52
 v_fmac_f32 v37, v15, v53
 v_fmac_f32 v38, v15, v54
 v_fmac_f32 v39, v15, v55
 v_cvt_pk_bf16_f32 v16, v32, v33
 v_cvt_pk_bf16_f32 v17, v34, v35
 v_cvt_pk_bf16_f32 v18, v36, v37
 v_cvt_pk_bf16_f32 v19, v38, v39
 buffer_store_dwordx4 v[16:19], v12, s[52:55], s75 offen sc1
 v_fmac_f32 v40, v15, v56
 v_fmac_f32 v41, v15, v57
 v_fmac_f32 v42, v15, v58
 v_fmac_f32 v43, v15, v59
 v_fmac_f32 v44, v15, v60
 v_fmac_f32 v45, v15, v61
 v_fmac_f32 v46, v15, v62
 v_fmac_f32 v47, v15, v63
 v_cvt_pk_bf16_f32 v20, v40, v41
 v_cvt_pk_bf16_f32 v21, v42, v43
 v_cvt_pk_bf16_f32 v22, v44, v45
 v_cvt_pk_bf16_f32 v23, v46, v47
 buffer_store_dwordx4 v[20:23], v12, s[52:55], s76 offen sc1
L_rdone:
 s_endpgm
L_rx0:
 v_dot2c_f32_bf16 v64, v128, v24
 v_dot2c_f32_bf16 v65, v128, v25
 v_dot2c_f32_bf16 v66, v129, v24
 v_dot2c_f32_bf16 v67, v129, v25
 v_dot2c_f32_bf16 v68, v130, v24
 v_dot2c_f32_bf16 v69, v130, v25
 v_dot2c_f32_bf16 v70, v131, v24
 v_dot2c_f32_bf16 v71, v131, v25
 s_branch L_ry0
L_rx1:
 v_dot2c_f32_bf16 v64, v136, v24
 v_dot2c_f32_bf16 v65, v136, v25
 v_dot2c_f32_bf16 v66, v137, v24
 v_dot2c_f32_bf16 v67, v137, v25
 v_dot2c_f32_bf16 v68, v138, v24
 v_dot2c_f32_bf16 v69, v138, v25
 v_dot2c_f32_bf16 v70, v139, v24
 v_dot2c_f32_bf16 v71, v139, v25
 s_branch L_ry1
L_rx2:
 v_dot2c_f32_bf16 v64, v144, v24
 v_dot2c_f32_bf16 v65, v144, v25
 v_dot2c_f32_bf16 v66, v145, v24
 v_dot2c_f32_bf16 v67, v145, v25
 v_dot2c_f32_bf16 v68, v146, v24
 v_dot2c_f32_bf16 v69, v146, v25
 v_dot2c_f32_bf16 v70, v147, v24
 v_dot2c_f32_bf16 v71, v147, v25
 s_branch L_ry2
L_rx3:
 v_dot2c_f32_bf16 v64, v152, v24
 v_dot2c_f32_bf16 v65, v152, v25
 v_dot2c_f32_bf16 v66, v153, v24
 v_dot2c_f32_bf16 v67, v153, v25
 v_dot2c_f32_bf16 v68, v154, v24
 v_dot2c_f32_bf16 v69, v154, v25
 v_dot2c_f32_bf16 v70, v155, v24
 v_dot2c_f32_bf16 v71, v155, v25
 s_branch L_ry3
L_rx4:
 v_dot2c_f32_bf16 v64, v160, v24
 v_dot2c_f32_bf16 v65, v160, v25
 v_dot2c_f32_bf16 v66, v161, v24
 v_dot2c_f32_bf16 v67, v161, v25
 v_dot2c_f32_bf16 v68, v162, v24
 v_dot2c_f32_bf16 v69, v162, v25
 v_dot2c_f32_bf16 v70, v163, v24
 v_dot2c_f32_bf16 v71, v163, v25
 s_branch L_ry4
L_rx5:
 v_dot2c_f32_bf16 v64, v168, v24
 v_dot2c_f32_bf16 v65, v168, v25
 v_dot2c_f32_bf16 v66, v169, v24
 v_dot2c_f32_bf16 v67, v169, v25
 v_dot2c_f32_bf16 v68, v170, v24
 v_dot2c_f32_bf16 v69, v170, v25
 v_dot2c_f32_bf16 v70, v171, v24
 v_dot2c_f32_bf16 v71, v171, v25
 s_branch L_ry5
L_rx6:
 v_dot2c_f32_bf16 v64, v176, v24
 v_dot2c_f32_bf16 v65, v176, v25
 v_dot2c_f32_bf16 v66, v177, v24
 v_dot2c_f32_bf16 v67, v177, v25
 v_dot2c_f32_bf16 v68, v178, v24
 v_dot2c_f32_bf16 v69, v178, v25
 v_dot2c_f32_bf16 v70, v179, v24
 v_dot2c_f32_bf16 v71, v179, v25
 s_branch L_ry6
L_rx7:
 v_dot2c_f32_bf16 v64, v184, v24
 v_dot2c_f32_bf16 v65, v184, v25
 v_dot2c_f32_bf16 v66, v185, v24
 v_dot2c_f32_bf16 v67, v185, v25
 v_dot2c_f32_bf16 v68, v186, v24
 v_dot2c_f32_bf16 v69, v186, v25
 v_dot2c_f32_bf16 v70, v187, v24
 v_dot2c_f32_bf16 v71, v187, v25
 s_branch L_ry7
L_rx8:
 v_dot2c_f32_bf16 v64, v192, v24
 v_dot2c_f32_bf16 v65, v192, v25
 v_dot2c_f32_bf16 v66, v193, v24
 v_dot2c_f32_bf16 v67, v193, v25
 v_dot2c_f32_bf16 v68, v194, v24
 v_dot2c_f32_bf16 v69, v194, v25
 v_dot2c_f32_bf16 v70, v195, v24
 v_dot2c_f32_bf16 v71, v195, v25
 s_branch L_ry8
L_rx9:
 v_dot2c_f32_bf16 v64, v200, v24
 v_dot2c_f32_bf16 v65, v200, v25
 v_dot2c_f32_bf16 v66, v201, v24
 v_dot2c_f32_bf16 v67, v201, v25
 v_dot2c_f32_bf16 v68, v202, v24
 v_dot2c_f32_bf16 v69, v202, v25
 v_dot2c_f32_bf16 v70, v203, v24
 v_dot2c_f32_bf16 v71, v203, v25
 s_branch L_ry9
L_rx10:
 v_dot2c_f32_bf16 v64, v208, v24
 v_dot2c_f32_bf16 v65, v208, v25
 v_dot2c_f32_bf16 v66, v209, v24
 v_dot2c_f32_bf16 v67, v209, v25
 v_dot2c_f32_bf16 v68, v210, v24
 v_dot2c_f32_bf16 v69, v210, v25
 v_dot2c_f32_bf16 v70, v211, v24
 v_dot2c_f32_bf16 v71, v211, v25
 s_branch L_ry10
L_rx11:
 v_dot2c_f32_bf16 v64, v216, v24
 v_dot2c_f32_bf16 v65, v216, v25
 v_dot2c_f32_bf16 v66, v217, v24
 v_dot2c_f32_bf16 v67, v217, v25
 v_dot2c_f32_bf16 v68, v218, v24
 v_dot2c_f32_bf16 v69, v218, v25
 v_dot2c_f32_bf16 v70, v219, v24
 v_dot2c_f32_bf16 v71, v219, v25
 s_branch L_ry11
L_rx12:
 v_dot2c_f32_bf16 v64, v224, v24
 v_dot2c_f32_bf16 v65, v224, v25
 v_dot2c_f32_bf16 v66, v225, v24
 v_dot2c_f32_bf16 v67, v225, v25
 v_dot2c_f32_bf16 v68, v226, v24
 v_dot2c_f32_bf16 v69, v226, v25
 v_dot2c_f32_bf16 v70, v227, v24
 v_dot2c_f32_bf16 v71, v227, v25
 s_branch L_ry12
L_rx13:
 v_dot2c_f32_bf16 v64, v232, v24
 v_dot2c_f32_bf16 v65, v232, v25
 v_dot2c_f32_bf16 v66, v233, v24
 v_dot2c_f32_bf16 v67, v233, v25
 v_dot2c_f32_bf16 v68, v234, v24
 v_dot2c_f32_bf16 v69, v234, v25
 v_dot2c_f32_bf16 v70, v235, v24
 v_dot2c_f32_bf16 v71, v235, v25
 s_branch L_ry13
L_rx14:
 v_dot2c_f32_bf16 v64, v240, v24
 v_dot2c_f32_bf16 v65, v240, v25
 v_dot2c_f32_bf16 v66, v241, v24
 v_dot2c_f32_bf16 v67, v241, v25
 v_dot2c_f32_bf16 v68, v242, v24
 v_dot2c_f32_bf16 v69, v242, v25
 v_dot2c_f32_bf16 v70, v243, v24
 v_dot2c_f32_bf16 v71, v243, v25
 s_branch L_ry14
L_rx15:
 v_dot2c_f32_bf16 v64, v248, v24
 v_dot2c_f32_bf16 v65, v248, v25
 v_dot2c_f32_bf16 v66, v249, v24
 v_dot2c_f32_bf16 v67, v249, v25
 v_dot2c_f32_bf16 v68, v250, v24
 v_dot2c_f32_bf16 v69, v250, v25
 v_dot2c_f32_bf16 v70, v251, v24
 v_dot2c_f32_bf16 v71, v251, v25
 s_branch L_ry15
L_rx16:
 v_dot2c_f32_bf16 v48, v128, v24
 v_dot2c_f32_bf16 v49, v128, v25
 v_dot2c_f32_bf16 v50, v129, v24
 v_dot2c_f32_bf16 v51, v129, v25
 v_dot2c_f32_bf16 v52, v130, v24
 v_dot2c_f32_bf16 v53, v130, v25
 v_dot2c_f32_bf16 v54, v131, v24
 v_dot2c_f32_bf16 v55, v131, v25
 v_dot2c_f32_bf16 v56, v132, v24
 v_dot2c_f32_bf16 v57, v132, v25
 v_dot2c_f32_bf16 v58, v133, v24
 v_dot2c_f32_bf16 v59, v133, v25
 v_dot2c_f32_bf16 v60, v134, v24
 v_dot2c_f32_bf16 v61, v134, v25
 v_dot2c_f32_bf16 v62, v135, v24
 v_dot2c_f32_bf16 v63, v135, v25
 s_branch L_ry16
L_rx17:
 v_dot2c_f32_bf16 v48, v136, v24
 v_dot2c_f32_bf16 v49, v136, v25
 v_dot2c_f32_bf16 v50, v137, v24
 v_dot2c_f32_bf16 v51, v137, v25
 v_dot2c_f32_bf16 v52, v138, v24
 v_dot2c_f32_bf16 v53, v138, v25
 v_dot2c_f32_bf16 v54, v139, v24
 v_dot2c_f32_bf16 v55, v139, v25
 v_dot2c_f32_bf16 v56, v140, v24
 v_dot2c_f32_bf16 v57, v140, v25
 v_dot2c_f32_bf16 v58, v141, v24
 v_dot2c_f32_bf16 v59, v141, v25
 v_dot2c_f32_bf16 v60, v142, v24
 v_dot2c_f32_bf16 v61, v142, v25
 v_dot2c_f32_bf16 v62, v143, v24
 v_dot2c_f32_bf16 v63, v143, v25
 s_branch L_ry17
L_rx18:
 v_dot2c_f32_bf16 v48, v144, v24
 v_dot2c_f32_bf16 v49, v144, v25
 v_dot2c_f32_bf16 v50, v145, v24
 v_dot2c_f32_bf16 v51, v145, v25
 v_dot2c_f32_bf16 v52, v146, v24
 v_dot2c_f32_bf16 v53, v146, v25
 v_dot2c_f32_bf16 v54, v147, v24
 v_dot2c_f32_bf16 v55, v147, v25
 v_dot2c_f32_bf16 v56, v148, v24
 v_dot2c_f32_bf16 v57, v148, v25
 v_dot2c_f32_bf16 v58, v149, v24
 v_dot2c_f32_bf16 v59, v149, v25
 v_dot2c_f32_bf16 v60, v150, v24
 v_dot2c_f32_bf16 v61, v150, v25
 v_dot2c_f32_bf16 v62, v151, v24
 v_dot2c_f32_bf16 v63, v151, v25
 s_branch L_ry18
L_rx19:
 v_dot2c_f32_bf16 v48, v152, v24
 v_dot2c_f32_bf16 v49, v152, v25
 v_dot2c_f32_bf16 v50, v153, v24
 v_dot2c_f32_bf16 v51, v153, v25
 v_dot2c_f32_bf16 v52, v154, v24
 v_dot2c_f32_bf16 v53, v154, v25
 v_dot2c_f32_bf16 v54, v155, v24
 v_dot2c_f32_bf16 v55, v155, v25
 v_dot2c_f32_bf16 v56, v156, v24
 v_dot2c_f32_bf16 v57, v156, v25
 v_dot2c_f32_bf16 v58, v157, v24
 v_dot2c_f32_bf16 v59, v157, v25
 v_dot2c_f32_bf16 v60, v158, v24
 v_dot2c_f32_bf16 v61, v158, v25
 v_dot2c_f32_bf16 v62, v159, v24
 v_dot2c_f32_bf16 v63, v159, v25
 s_branch L_ry19
L_rx20:
 v_dot2c_f32_bf16 v48, v160, v24
 v_dot2c_f32_bf16 v49, v160, v25
 v_dot2c_f32_bf16 v50, v161, v24
 v_dot2c_f32_bf16 v51, v161, v25
 v_dot2c_f32_bf16 v52, v162, v24
 v_dot2c_f32_bf16 v53, v162, v25
 v_dot2c_f32_bf16 v54, v163, v24
 v_dot2c_f32_bf16 v55, v163, v25
 v_dot2c_f32_bf16 v56, v164, v24
 v_dot2c_f32_bf16 v57, v164, v25
 v_dot2c_f32_bf16 v58, v165, v24
 v_dot2c_f32_bf16 v59, v165, v25
 v_dot2c_f32_bf16 v60, v166, v24
 v_dot2c_f32_bf16 v61, v166, v25
 v_dot2c_f32_bf16 v62, v167, v24
 v_dot2c_f32_bf16 v63, v167, v25
 s_branch L_ry20
L_rx21:
 v_dot2c_f32_bf16 v48, v168, v24
 v_dot2c_f32_bf16 v49, v168, v25
 v_dot2c_f32_bf16 v50, v169, v24
 v_dot2c_f32_bf16 v51, v169, v25
 v_dot2c_f32_bf16 v52, v170, v24
 v_dot2c_f32_bf16 v53, v170, v25
 v_dot2c_f32_bf16 v54, v171, v24
 v_dot2c_f32_bf16 v55, v171, v25
 v_dot2c_f32_bf16 v56, v172, v24
 v_dot2c_f32_bf16 v57, v172, v25
 v_dot2c_f32_bf16 v58, v173, v24
 v_dot2c_f32_bf16 v59, v173, v25
 v_dot2c_f32_bf16 v60, v174, v24
 v_dot2c_f32_bf16 v61, v174, v25
 v_dot2c_f32_bf16 v62, v175, v24
 v_dot2c_f32_bf16 v63, v175, v25
 s_branch L_ry21
L_rx22:
 v_dot2c_f32_bf16 v48, v176, v24
 v_dot2c_f32_bf16 v49, v176, v25
 v_dot2c_f32_bf16 v50, v177, v24
 v_dot2c_f32_bf16 v51, v177, v25
 v_dot2c_f32_bf16 v52, v178, v24
 v_dot2c_f32_bf16 v53, v178, v25
 v_dot2c_f32_bf16 v54, v179, v24
 v_dot2c_f32_bf16 v55, v179, v25
 v_dot2c_f32_bf16 v56, v180, v24
 v_dot2c_f32_bf16 v57, v180, v25
 v_dot2c_f32_bf16 v58, v181, v24
 v_dot2c_f32_bf16 v59, v181, v25
 v_dot2c_f32_bf16 v60, v182, v24
 v_dot2c_f32_bf16 v61, v182, v25
 v_dot2c_f32_bf16 v62, v183, v24
 v_dot2c_f32_bf16 v63, v183, v25
 s_branch L_ry22
L_rx23:
 v_dot2c_f32_bf16 v48, v184, v24
 v_dot2c_f32_bf16 v49, v184, v25
 v_dot2c_f32_bf16 v50, v185, v24
 v_dot2c_f32_bf16 v51, v185, v25
 v_dot2c_f32_bf16 v52, v186, v24
 v_dot2c_f32_bf16 v53, v186, v25
 v_dot2c_f32_bf16 v54, v187, v24
 v_dot2c_f32_bf16 v55, v187, v25
 v_dot2c_f32_bf16 v56, v188, v24
 v_dot2c_f32_bf16 v57, v188, v25
 v_dot2c_f32_bf16 v58, v189, v24
 v_dot2c_f32_bf16 v59, v189, v25
 v_dot2c_f32_bf16 v60, v190, v24
 v_dot2c_f32_bf16 v61, v190, v25
 v_dot2c_f32_bf16 v62, v191, v24
 v_dot2c_f32_bf16 v63, v191, v25
 s_branch L_ry23
L_rx24:
 v_dot2c_f32_bf16 v48, v192, v24
 v_dot2c_f32_bf16 v49, v192, v25
 v_dot2c_f32_bf16 v50, v193, v24
 v_dot2c_f32_bf16 v51, v193, v25
 v_dot2c_f32_bf16 v52, v194, v24
 v_dot2c_f32_bf16 v53, v194, v25
 v_dot2c_f32_bf16 v54, v195, v24
 v_dot2c_f32_bf16 v55, v195, v25
 v_dot2c_f32_bf16 v56, v196, v24
 v_dot2c_f32_bf16 v57, v196, v25
 v_dot2c_f32_bf16 v58, v197, v24
 v_dot2c_f32_bf16 v59, v197, v25
 v_dot2c_f32_bf16 v60, v198, v24
 v_dot2c_f32_bf16 v61, v198, v25
 v_dot2c_f32_bf16 v62, v199, v24
 v_dot2c_f32_bf16 v63, v199, v25
 s_branch L_ry24
L_rx25:
 v_dot2c_f32_bf16 v48, v200, v24
 v_dot2c_f32_bf16 v49, v200, v25
 v_dot2c_f32_bf16 v50, v201, v24
 v_dot2c_f32_bf16 v51, v201, v25
 v_dot2c_f32_bf16 v52, v202, v24
 v_dot2c_f32_bf16 v53, v202, v25
 v_dot2c_f32_bf16 v54, v203, v24
 v_dot2c_f32_bf16 v55, v203, v25
 v_dot2c_f32_bf16 v56, v204, v24
 v_dot2c_f32_bf16 v57, v204, v25
 v_dot2c_f32_bf16 v58, v205, v24
 v_dot2c_f32_bf16 v59, v205, v25
 v_dot2c_f32_bf16 v60, v206, v24
 v_dot2c_f32_bf16 v61, v206, v25
 v_dot2c_f32_bf16 v62, v207, v24
 v_dot2c_f32_bf16 v63, v207, v25
 s_branch L_ry25
L_rx26:
 v_dot2c_f32_bf16 v48, v208, v24
 v_dot2c_f32_bf16 v49, v208, v25
 v_dot2c_f32_bf16 v50, v209, v24
 v_dot2c_f32_bf16 v51, v209, v25
 v_dot2c_f32_bf16 v52, v210, v24
 v_dot2c_f32_bf16 v53, v210, v25
 v_dot2c_f32_bf16 v54, v211, v24
 v_dot2c_f32_bf16 v55, v211, v25
 v_dot2c_f32_bf16 v56, v212, v24
 v_dot2c_f32_bf16 v57, v212, v25
 v_dot2c_f32_bf16 v58, v213, v24
 v_dot2c_f32_bf16 v59, v213, v25
 v_dot2c_f32_bf16 v60, v214, v24
 v_dot2c_f32_bf16 v61, v214, v25
 v_dot2c_f32_bf16 v62, v215, v24
 v_dot2c_f32_bf16 v63, v215, v25
 s_branch L_ry26
L_rx27:
 v_dot2c_f32_bf16 v48, v216, v24
 v_dot2c_f32_bf16 v49, v216, v25
 v_dot2c_f32_bf16 v50, v217, v24
 v_dot2c_f32_bf16 v51, v217, v25
 v_dot2c_f32_bf16 v52, v218, v24
 v_dot2c_f32_bf16 v53, v218, v25
 v_dot2c_f32_bf16 v54, v219, v24
 v_dot2c_f32_bf16 v55, v219, v25
 v_dot2c_f32_bf16 v56, v220, v24
 v_dot2c_f32_bf16 v57, v220, v25
 v_dot2c_f32_bf16 v58, v221, v24
 v_dot2c_f32_bf16 v59, v221, v25
 v_dot2c_f32_bf16 v60, v222, v24
 v_dot2c_f32_bf16 v61, v222, v25
 v_dot2c_f32_bf16 v62, v223, v24
 v_dot2c_f32_bf16 v63, v223, v25
 s_branch L_ry27
L_rx28:
 v_dot2c_f32_bf16 v48, v224, v24
 v_dot2c_f32_bf16 v49, v224, v25
 v_dot2c_f32_bf16 v50, v225, v24
 v_dot2c_f32_bf16 v51, v225, v25
 v_dot2c_f32_bf16 v52, v226, v24
 v_dot2c_f32_bf16 v53, v226, v25
 v_dot2c_f32_bf16 v54, v227, v24
 v_dot2c_f32_bf16 v55, v227, v25
 v_dot2c_f32_bf16 v56, v228, v24
 v_dot2c_f32_bf16 v57, v228, v25
 v_dot2c_f32_bf16 v58, v229, v24
 v_dot2c_f32_bf16 v59, v229, v25
 v_dot2c_f32_bf16 v60, v230, v24
 v_dot2c_f32_bf16 v61, v230, v25
 v_dot2c_f32_bf16 v62, v231, v24
 v_dot2c_f32_bf16 v63, v231, v25
 s_branch L_ry28
L_rx29:
 v_dot2c_f32_bf16 v48, v232, v24
 v_dot2c_f32_bf16 v49, v232, v25
 v_dot2c_f32_bf16 v50, v233, v24
 v_dot2c_f32_bf16 v51, v233, v25
 v_dot2c_f32_bf16 v52, v234, v24
 v_dot2c_f32_bf16 v53, v234, v25
 v_dot2c_f32_bf16 v54, v235, v24
 v_dot2c_f32_bf16 v55, v235, v25
 v_dot2c_f32_bf16 v56, v236, v24
 v_dot2c_f32_bf16 v57, v236, v25
 v_dot2c_f32_bf16 v58, v237, v24
 v_dot2c_f32_bf16 v59, v237, v25
 v_dot2c_f32_bf16 v60, v238, v24
 v_dot2c_f32_bf16 v61, v238, v25
 v_dot2c_f32_bf16 v62, v239, v24
 v_dot2c_f32_bf16 v63, v239, v25
 s_branch L_ry29
L_rx30:
 v_dot2c_f32_bf16 v48, v240, v24
 v_dot2c_f32_bf16 v49, v240, v25
 v_dot2c_f32_bf16 v50, v241, v24
 v_dot2c_f32_bf16 v51, v241, v25
 v_dot2c_f32_bf16 v52, v242, v24
 v_dot2c_f32_bf16 v53, v242, v25
 v_dot2c_f32_bf16 v54, v243, v24
 v_dot2c_f32_bf16 v55, v243, v25
 v_dot2c_f32_bf16 v56, v244, v24
 v_dot2c_f32_bf16 v57, v244, v25
 v_dot2c_f32_bf16 v58, v245, v24
 v_dot2c_f32_bf16 v59, v245, v25
 v_dot2c_f32_bf16 v60, v246, v24
 v_dot2c_f32_bf16 v61, v246, v25
 v_dot2c_f32_bf16 v62, v247, v24
 v_dot2c_f32_bf16 v63, v247, v25
 s_branch L_ry30
L_rx31:
 v_dot2c_f32_bf16 v48, v248, v24
 v_dot2c_f32_bf16 v49, v248, v25
 v_dot2c_f32_bf16 v50, v249, v24
 v_dot2c_f32_bf16 v51, v249, v25
 v_dot2c_f32_bf16 v52, v250, v24
 v_dot2c_f32_bf16 v53, v250, v25
 v_dot2c_f32_bf16 v54, v251, v24
 v_dot2c_f32_bf16 v55, v251, v25
 v_dot2c_f32_bf16 v56, v252, v24
 v_dot2c_f32_bf16 v57, v252, v25
 v_dot2c_f32_bf16 v58, v253, v24
 v_dot2c_f32_bf16 v59, v253, v25
 v_dot2c_f32_bf16 v60, v254, v24
 v_dot2c_f32_bf16 v61, v254, v25
 v_dot2c_f32_bf16 v62, v255, v24
 v_dot2c_f32_bf16 v63, v255, v25
 s_branch L_ry31
L_rpoll0:
 s_sleep 1
L_rpoll:
 buffer_load_dword v9, v14, s[8:11], s46 offen sc1
 s_waitcnt vmcnt(0)
 v_cmp_eq_u32 vcc, 1, v9
 s_sub_u32 s91, s91, 1
 s_cselect_b32 s70, -1, 0
 s_or_b32 s70, s70, vcc_lo
 s_andn2_b32 s70, s70, s68
 s_cbranch_scc0 L_rpoll0
 s_or_b32 s68, s68, s70
 s_setpc_b64 s[36:37]
L_comb:
 buffer_load_dwordx4 v[14:17], v7, s[8:11], s52 offen sc1
 s_waitcnt vmcnt(0)
 s_add_u32 m0, s28, 32768
 s_nop 0
 buffer_load_dwordx4 v3, s[8:11], s21 offen offset:0 sc1 lds
 buffer_load_dwordx4 v3, s[8:11], s21 offen offset:1024 sc1 lds
 buffer_load_dwordx4 v3, s[8:11], s21 offen offset:2048 sc1 lds
 buffer_load_dwordx4 v3, s[8:11], s21 offen offset:3072 sc1 lds
 s_add_u32 m0, s28, 36864
 s_nop 0
 buffer_load_dwordx4 v4, s[8:11], s21 offen offset:0 sc1 lds
 buffer_load_dwordx4 v4, s[8:11], s21 offen offset:1024 sc1 lds
 buffer_load_dwordx4 v4, s[8:11], s21 offen offset:2048 sc1 lds
 buffer_load_dwordx4 v4, s[8:11], s21 offen offset:3072 sc1 lds
 s_nop 7
 v_sub_f32 v10, v32, v14
 v_sub_f32 v11, v36, v15
 v_max_f32 v10, 0, v10
 v_max_f32 v11, 0, v11
 v_sub_f32 v100, v100, v11
 v_sub_f32 v101, v101, v11
 v_sub_f32 v102, v102, v11
 v_sub_f32 v103, v103, v11
 v_sub_f32 v108, v108, v11
 v_sub_f32 v109, v109, v11
 v_sub_f32 v110, v110, v11
 v_sub_f32 v111, v111, v11
 v_sub_f32 v116, v116, v11
 v_sub_f32 v117, v117, v11
 v_sub_f32 v118, v118, v11
 v_sub_f32 v119, v119, v11
 v_sub_f32 v124, v124, v11
 v_sub_f32 v125, v125, v11
 v_sub_f32 v126, v126, v11
 v_sub_f32 v127, v127, v11
 v_sub_f32 v32, v32, v10
 v_sub_f32 v33, v33, v10
 v_sub_f32 v34, v34, v10
 v_sub_f32 v35, v35, v10
 v_sub_f32 v36, v36, v11
 v_sub_f32 v37, v37, v11
 v_sub_f32 v38, v38, v11
 v_sub_f32 v39, v39, v11
 v_exp_f32 v12, -v10
 v_exp_f32 v13, -v11
 v_mul_f32 v30, v12, v30
 v_mul_f32 v31, v13, v31
 v_mul_f32 v128, v12, v128
 v_mul_f32 v129, v12, v129
 v_mul_f32 v130, v12, v130
 v_mul_f32 v131, v12, v131
 v_mul_f32 v132, v13, v132
 v_mul_f32 v133, v13, v133
 v_mul_f32 v134, v13, v134
 v_mul_f32 v135, v13, v135
 v_mul_f32 v136, v12, v136
 v_mul_f32 v137, v12, v137
 v_mul_f32 v138, v12, v138
 v_mul_f32 v139, v12, v139
 v_mul_f32 v140, v13, v140
 v_mul_f32 v141, v13, v141
 v_mul_f32 v142, v13, v142
 v_mul_f32 v143, v13, v143
 v_mul_f32 v144, v12, v144
 v_mul_f32 v145, v12, v145
 v_mul_f32 v146, v12, v146
 v_mul_f32 v147, v12, v147
 v_mul_f32 v148, v13, v148
 v_mul_f32 v149, v13, v149
 v_mul_f32 v150, v13, v150
 v_mul_f32 v151, v13, v151
 v_mul_f32 v152, v12, v152
 v_mul_f32 v153, v12, v153
 v_mul_f32 v154, v12, v154
 v_mul_f32 v155, v12, v155
 v_mul_f32 v156, v13, v156
 v_mul_f32 v157, v13, v157
 v_mul_f32 v158, v13, v158
 v_mul_f32 v159, v13, v159
 v_mul_f32 v160, v12, v160
 v_mul_f32 v161, v12, v161
 v_mul_f32 v162, v12, v162
 v_mul_f32 v163, v12, v163
 v_mul_f32 v164, v13, v164
 v_mul_f32 v165, v13, v165
 v_mul_f32 v166, v13, v166
 v_mul_f32 v167, v13, v167
 v_mul_f32 v168, v12, v168
 v_mul_f32 v169, v12, v169
 v_mul_f32 v170, v12, v170
 v_mul_f32 v171, v12, v171
 v_mul_f32 v172, v13, v172
 v_mul_f32 v173, v13, v173
 v_mul_f32 v174, v13, v174
 v_mul_f32 v175, v13, v175
 v_mul_f32 v176, v12, v176
 v_mul_f32 v177, v12, v177
 v_mul_f32 v178, v12, v178
 v_mul_f32 v179, v12, v179
 v_mul_f32 v180, v13, v180
 v_mul_f32 v181, v13, v181
 v_mul_f32 v182, v13, v182
 v_mul_f32 v183, v13, v183
 v_mul_f32 v184, v12, v184
 v_mul_f32 v185, v12, v185
 v_mul_f32 v186, v12, v186
 v_mul_f32 v187, v12, v187
 v_mul_f32 v188, v13, v188
 v_mul_f32 v189, v13, v189
 v_mul_f32 v190, v13, v190
 v_mul_f32 v191, v13, v191
 v_mul_f32 v192, v12, v192
 v_mul_f32 v193, v12, v193
 v_mul_f32 v194, v12, v194
 v_mul_f32 v195, v12, v195
 v_mul_f32 v196, v13, v196
 v_mul_f32 v197, v13, v197
 v_mul_f32 v198, v13, v198
 v_mul_f32 v199, v13, v199
 v_mul_f32 v200, v12, v200
 v_mul_f32 v201, v12, v201
 v_mul_f32 v202, v12, v202
 v_mul_f32 v203, v12, v203
 v_mul_f32 v204, v13, v204
 v_mul_f32 v205, v13, v205
 v_mul_f32 v206, v13, v206
 v_mul_f32 v207, v13, v207
 v_mul_f32 v208, v12, v208
 v_mul_f32 v209, v12, v209
 v_mul_f32 v210, v12, v210
 v_mul_f32 v211, v12, v211
 v_mul_f32 v212, v13, v212
 v_mul_f32 v213, v13, v213
 v_mul_f32 v214, v13, v214
 v_mul_f32 v215, v13, v215
 v_mul_f32 v216, v12, v216
 v_mul_f32 v217, v12, v217
 v_mul_f32 v218, v12, v218
 v_mul_f32 v219, v12, v219
 v_mul_f32 v220, v13, v220
 v_mul_f32 v221, v13, v221
 v_mul_f32 v222, v13, v222
 v_mul_f32 v223, v13, v223
 v_mul_f32 v224, v12, v224
 v_mul_f32 v225, v12, v225
 v_mul_f32 v226, v12, v226
 v_mul_f32 v227, v12, v227
 v_mul_f32 v228, v13, v228
 v_mul_f32 v229, v13, v229
 v_mul_f32 v230, v13, v230
 v_mul_f32 v231, v13, v231
 v_mul_f32 v232, v12, v232
 v_mul_f32 v233, v12, v233
 v_mul_f32 v234, v12, v234
 v_mul_f32 v235, v12, v235
 v_mul_f32 v236, v13, v236
 v_mul_f32 v237, v13, v237
 v_mul_f32 v238, v13, v238
 v_mul_f32 v239, v13, v239
 v_mul_f32 v240, v12, v240
 v_mul_f32 v241, v12, v241
 v_mul_f32 v242, v12, v242
 v_mul_f32 v243, v12, v243
 v_mul_f32 v244, v13, v244
 v_mul_f32 v245, v13, v245
 v_mul_f32 v246, v13, v246
 v_mul_f32 v247, v13, v247
 v_mul_f32 v248, v12, v248
 v_mul_f32 v249, v12, v249
 v_mul_f32 v250, v12, v250
 v_mul_f32 v251, v12, v251
 v_mul_f32 v252, v13, v252
 v_mul_f32 v253, v13, v253
 v_mul_f32 v254, v13, v254
 v_mul_f32 v255, v13, v255
 v_exp_f32 v18, v100
 v_exp_f32 v19, v101
 v_exp_f32 v20, v102
 v_add_f32 v29, v18, v19
 v_cvt_pk_bf16_f32 v52, v18, v19
 v_exp_f32 v21, v103
 v_exp_f32 v22, v108
 v_add_f32 v29, v20, v29
 v_cvt_pk_bf16_f32 v53, v20, v21
 v_exp_f32 v23, v109
 v_add_f32 v29, v21, v29
 v_exp_f32 v24, v110
 v_add_f32 v29, v22, v29
 v_cvt_pk_bf16_f32 v54, v22, v23
 v_exp_f32 v25, v111
 v_add_f32 v29, v23, v29
 v_exp_f32 v18, v116
 v_add_f32 v29, v24, v29
 v_cvt_pk_bf16_f32 v55, v24, v25
 v_exp_f32 v19, v117
 v_add_f32 v29, v25, v29
 v_exp_f32 v20, v118
 v_add_f32 v29, v18, v29
 v_cvt_pk_bf16_f32 v48, v18, v19
 v_exp_f32 v21, v119
 v_add_f32 v29, v19, v29
 v_exp_f32 v22, v124
 v_add_f32 v29, v20, v29
 v_cvt_pk_bf16_f32 v49, v20, v21
 v_exp_f32 v23, v125
 v_add_f32 v29, v21, v29
 v_exp_f32 v24, v126
 v_add_f32 v29, v22, v29
 v_cvt_pk_bf16_f32 v50, v22, v23
 v_exp_f32 v25, v127
 v_add_f32 v29, v23, v29
 v_add_f32 v29, v24, v29
 v_cvt_pk_bf16_f32 v51, v24, v25
 v_add_f32 v29, v25, v29
 v_sub_f32 v10, v32, v14
 v_sub_f32 v11, v36, v15
 v_cvt_i32_f32 v10, v10
 v_cvt_i32_f32 v11, v11
 v_ldexp_f32 v10, 1.0, v10
 v_ldexp_f32 v11, 1.0, v11
 v_and_b32 v10, 0xffff0000, v10
 v_and_b32 v11, 0xffff0000, v11
 v_fmac_f32 v30, v10, v16
 v_fmac_f32 v31, v11, v17
 v_lshrrev_b32 v12, 16, v10
 v_lshrrev_b32 v13, 16, v11
 v_accvgpr_read_b32 v18, a128
 v_dot2c_f32_bf16 v128, v18, v12
 v_dot2c_f32_bf16 v129, v18, v10
 v_accvgpr_read_b32 v19, a129
 v_dot2c_f32_bf16 v130, v19, v12
 v_dot2c_f32_bf16 v131, v19, v10
 v_accvgpr_read_b32 v20, a130
 v_dot2c_f32_bf16 v136, v20, v12
 v_dot2c_f32_bf16 v137, v20, v10
 v_accvgpr_read_b32 v21, a131
 v_dot2c_f32_bf16 v138, v21, v12
 v_dot2c_f32_bf16 v139, v21, v10
 v_accvgpr_read_b32 v22, a132
 v_dot2c_f32_bf16 v144, v22, v12
 v_dot2c_f32_bf16 v145, v22, v10
 v_accvgpr_read_b32 v23, a133
 v_dot2c_f32_bf16 v146, v23, v12
 v_dot2c_f32_bf16 v147, v23, v10
 v_accvgpr_read_b32 v24, a134
 v_dot2c_f32_bf16 v152, v24, v12
 v_dot2c_f32_bf16 v153, v24, v10
 v_accvgpr_read_b32 v25, a135
 v_dot2c_f32_bf16 v154, v25, v12
 v_dot2c_f32_bf16 v155, v25, v10
 v_accvgpr_read_b32 v18, a136
 v_dot2c_f32_bf16 v160, v18, v12
 v_dot2c_f32_bf16 v161, v18, v10
 v_accvgpr_read_b32 v19, a137
 v_dot2c_f32_bf16 v162, v19, v12
 v_dot2c_f32_bf16 v163, v19, v10
 v_accvgpr_read_b32 v20, a138
 v_dot2c_f32_bf16 v168, v20, v12
 v_dot2c_f32_bf16 v169, v20, v10
 v_accvgpr_read_b32 v21, a139
 v_dot2c_f32_bf16 v170, v21, v12
 v_dot2c_f32_bf16 v171, v21, v10
 v_accvgpr_read_b32 v22, a140
 v_dot2c_f32_bf16 v176, v22, v12
 v_dot2c_f32_bf16 v177, v22, v10
 v_accvgpr_read_b32 v23, a141
 v_dot2c_f32_bf16 v178, v23, v12
 v_dot2c_f32_bf16 v179, v23, v10
 v_accvgpr_read_b32 v24, a142
 v_dot2c_f32_bf16 v184, v24, v12
 v_dot2c_f32_bf16 v185, v24, v10
 v_accvgpr_read_b32 v25, a143
 v_dot2c_f32_bf16 v186, v25, v12
 v_dot2c_f32_bf16 v187, v25, v10
 v_accvgpr_read_b32 v18, a144
 v_dot2c_f32_bf16 v192, v18, v12
 v_dot2c_f32_bf16 v193, v18, v10
 v_accvgpr_read_b32 v19, a145
 v_dot2c_f32_bf16 v194, v19, v12
 v_dot2c_f32_bf16 v195, v19, v10
 v_accvgpr_read_b32 v20, a146
 v_dot2c_f32_bf16 v200, v20, v12
 v_dot2c_f32_bf16 v201, v20, v10
 v_accvgpr_read_b32 v21, a147
 v_dot2c_f32_bf16 v202, v21, v12
 v_dot2c_f32_bf16 v203, v21, v10
 v_accvgpr_read_b32 v22, a148
 v_dot2c_f32_bf16 v208, v22, v12
 v_dot2c_f32_bf16 v209, v22, v10
 v_accvgpr_read_b32 v23, a149
 v_dot2c_f32_bf16 v210, v23, v12
 v_dot2c_f32_bf16 v211, v23, v10
 v_accvgpr_read_b32 v24, a150
 v_dot2c_f32_bf16 v216, v24, v12
 v_dot2c_f32_bf16 v217, v24, v10
 v_accvgpr_read_b32 v25, a151
 v_dot2c_f32_bf16 v218, v25, v12
 v_dot2c_f32_bf16 v219, v25, v10
 v_accvgpr_read_b32 v18, a152
 v_dot2c_f32_bf16 v224, v18, v12
 v_dot2c_f32_bf16 v225, v18, v10
 v_accvgpr_read_b32 v19, a153
 v_dot2c_f32_bf16 v226, v19, v12
 v_dot2c_f32_bf16 v227, v19, v10
 v_accvgpr_read_b32 v20, a154
 v_dot2c_f32_bf16 v232, v20, v12
 v_dot2c_f32_bf16 v233, v20, v10
 v_accvgpr_read_b32 v21, a155
 v_dot2c_f32_bf16 v234, v21, v12
 v_dot2c_f32_bf16 v235, v21, v10
 v_accvgpr_read_b32 v22, a156
 v_dot2c_f32_bf16 v240, v22, v12
 v_dot2c_f32_bf16 v241, v22, v10
 v_accvgpr_read_b32 v23, a157
 v_dot2c_f32_bf16 v242, v23, v12
 v_dot2c_f32_bf16 v243, v23, v10
 v_accvgpr_read_b32 v24, a158
 v_dot2c_f32_bf16 v248, v24, v12
 v_dot2c_f32_bf16 v249, v24, v10
 v_accvgpr_read_b32 v25, a159
 v_dot2c_f32_bf16 v250, v25, v12
 v_dot2c_f32_bf16 v251, v25, v10
 v_accvgpr_read_b32 v18, a160
 v_dot2c_f32_bf16 v132, v18, v13
 v_dot2c_f32_bf16 v133, v18, v11
 v_accvgpr_read_b32 v19, a161
 v_dot2c_f32_bf16 v134, v19, v13
 v_dot2c_f32_bf16 v135, v19, v11
 v_accvgpr_read_b32 v20, a162
 v_dot2c_f32_bf16 v140, v20, v13
 v_dot2c_f32_bf16 v141, v20, v11
 v_accvgpr_read_b32 v21, a163
 v_dot2c_f32_bf16 v142, v21, v13
 v_dot2c_f32_bf16 v143, v21, v11
 v_accvgpr_read_b32 v22, a164
 v_dot2c_f32_bf16 v148, v22, v13
 v_dot2c_f32_bf16 v149, v22, v11
 v_accvgpr_read_b32 v23, a165
 v_dot2c_f32_bf16 v150, v23, v13
 v_dot2c_f32_bf16 v151, v23, v11
 v_accvgpr_read_b32 v24, a166
 v_dot2c_f32_bf16 v156, v24, v13
 v_dot2c_f32_bf16 v157, v24, v11
 v_accvgpr_read_b32 v25, a167
 v_dot2c_f32_bf16 v158, v25, v13
 v_dot2c_f32_bf16 v159, v25, v11
 v_accvgpr_read_b32 v18, a168
 v_dot2c_f32_bf16 v164, v18, v13
 v_dot2c_f32_bf16 v165, v18, v11
 v_accvgpr_read_b32 v19, a169
 v_dot2c_f32_bf16 v166, v19, v13
 v_dot2c_f32_bf16 v167, v19, v11
 v_accvgpr_read_b32 v20, a170
 v_dot2c_f32_bf16 v172, v20, v13
 v_dot2c_f32_bf16 v173, v20, v11
 v_accvgpr_read_b32 v21, a171
 v_dot2c_f32_bf16 v174, v21, v13
 v_dot2c_f32_bf16 v175, v21, v11
 v_accvgpr_read_b32 v22, a172
 v_dot2c_f32_bf16 v180, v22, v13
 v_dot2c_f32_bf16 v181, v22, v11
 v_accvgpr_read_b32 v23, a173
 v_dot2c_f32_bf16 v182, v23, v13
 v_dot2c_f32_bf16 v183, v23, v11
 v_accvgpr_read_b32 v24, a174
 v_dot2c_f32_bf16 v188, v24, v13
 v_dot2c_f32_bf16 v189, v24, v11
 v_accvgpr_read_b32 v25, a175
 v_dot2c_f32_bf16 v190, v25, v13
 v_dot2c_f32_bf16 v191, v25, v11
 v_accvgpr_read_b32 v18, a176
 v_dot2c_f32_bf16 v196, v18, v13
 v_dot2c_f32_bf16 v197, v18, v11
 v_accvgpr_read_b32 v19, a177
 v_dot2c_f32_bf16 v198, v19, v13
 v_dot2c_f32_bf16 v199, v19, v11
 v_accvgpr_read_b32 v20, a178
 v_dot2c_f32_bf16 v204, v20, v13
 v_dot2c_f32_bf16 v205, v20, v11
 v_accvgpr_read_b32 v21, a179
 v_dot2c_f32_bf16 v206, v21, v13
 v_dot2c_f32_bf16 v207, v21, v11
 v_accvgpr_read_b32 v22, a180
 v_dot2c_f32_bf16 v212, v22, v13
 v_dot2c_f32_bf16 v213, v22, v11
 v_accvgpr_read_b32 v23, a181
 v_dot2c_f32_bf16 v214, v23, v13
 v_dot2c_f32_bf16 v215, v23, v11
 v_accvgpr_read_b32 v24, a182
 v_dot2c_f32_bf16 v220, v24, v13
 v_dot2c_f32_bf16 v221, v24, v11
 v_accvgpr_read_b32 v25, a183
 v_dot2c_f32_bf16 v222, v25, v13
 v_dot2c_f32_bf16 v223, v25, v11
 v_accvgpr_read_b32 v18, a184
 v_dot2c_f32_bf16 v228, v18, v13
 v_dot2c_f32_bf16 v229, v18, v11
 v_accvgpr_read_b32 v19, a185
 v_dot2c_f32_bf16 v230, v19, v13
 v_dot2c_f32_bf16 v231, v19, v11
 v_accvgpr_read_b32 v20, a186
 v_dot2c_f32_bf16 v236, v20, v13
 v_dot2c_f32_bf16 v237, v20, v11
 v_accvgpr_read_b32 v21, a187
 v_dot2c_f32_bf16 v238, v21, v13
 v_dot2c_f32_bf16 v239, v21, v11
 v_accvgpr_read_b32 v22, a188
 v_dot2c_f32_bf16 v244, v22, v13
 v_dot2c_f32_bf16 v245, v22, v11
 v_accvgpr_read_b32 v23, a189
 v_dot2c_f32_bf16 v246, v23, v13
 v_dot2c_f32_bf16 v247, v23, v11
 v_accvgpr_read_b32 v24, a190
 v_dot2c_f32_bf16 v252, v24, v13
 v_dot2c_f32_bf16 v253, v24, v11
 v_accvgpr_read_b32 v25, a191
 v_dot2c_f32_bf16 v254, v25, v13
 v_dot2c_f32_bf16 v255, v25, v11
 s_nop 3
 s_branch L_pBo
L_st0:
 s_call_b64 s[36:37], L_slow0
 s_branch L_rt0
L_st1:
 s_call_b64 s[36:37], L_slow1
 s_branch L_rt1
L_st2:
 s_call_b64 s[36:37], L_slowB
 s_branch L_rt2
L_st3:
 s_call_b64 s[36:37], L_slowB
 s_branch L_rt3
L_st4:
 s_call_b64 s[36:37], L_slow1n
 s_branch L_rt4
L_st5:
 s_call_b64 s[36:37], L_slow1
 s_branch L_rt5
L_st6:
 s_call_b64 s[36:37], L_slow0B
 s_branch L_rt6
L_st7:
 s_call_b64 s[36:37], L_slowB
 s_branch L_rt7
L_st8:
 s_call_b64 s[36:37], L_slowf
 s_branch L_rt8
L_st9:
 s_call_b64 s[36:37], L_slow1
 s_branch L_rt9
L_st10:
 s_call_b64 s[36:37], L_slowf
 s_branch L_rt10
L_st11:
 s_call_b64 s[36:37], L_slowf
 s_branch L_rt11
L_st12:
 s_call_b64 s[36:37], L_slow0
 s_branch L_rt12
L_st13:
 s_call_b64 s[36:37], L_slow1
 s_branch L_rt13
L_slow0:
 s_nop 7
 s_nop 3
 v_max3_f32 v10, v64, v65, v66
 v_max3_f32 v10, v67, v72, v10
 v_max3_f32 v10, v73, v74, v10
 v_max3_f32 v10, v75, v80, v10
 v_max3_f32 v10, v81, v82, v10
 v_max3_f32 v10, v83, v88, v10
 v_max3_f32 v10, v89, v90, v10
 v_max_f32 v10, v91, v10
 v_max3_f32 v11, v68, v69, v70
 v_max3_f32 v11, v71, v76, v11
 v_max3_f32 v11, v77, v78, v11
 v_max3_f32 v11, v79, v84, v11
 v_max3_f32 v11, v85, v86, v11
 v_max3_f32 v11, v87, v92, v11
 v_max3_f32 v11, v93, v94, v11
 v_max_f32 v11, v95, v11
 v_mov_b32 v12, v10
 v_mov_b32 v13, v11
 s_nop 0
 v_permlane16_swap_b32 v12, v10
 v_permlane16_swap_b32 v13, v11
 v_max_f32 v10, v12, v10
 v_max_f32 v11, v13, v11
 v_mov_b32 v12, v10
 v_mov_b32 v13, v11
 s_nop 0
 v_permlane32_swap_b32 v12, v10
 v_permlane32_swap_b32 v13, v11
 v_max_f32 v10, v12, v10
 v_max_f32 v11, v13, v11
 v_ceil_f32 v10, v10
 v_ceil_f32 v11, v11
 v_max_f32 v10, 0, v10
 v_max_f32 v11, 0, v11
 v_sub_f32 v64, v64, v10
 v_sub_f32 v65, v65, v10
 v_sub_f32 v66, v66, v10
 v_sub_f32 v67, v67, v10
 v_sub_f32 v68, v68, v11
 v_sub_f32 v69, v69, v11
 v_sub_f32 v70, v70, v11
 v_sub_f32 v71, v71, v11
 v_sub_f32 v72, v72, v10
 v_sub_f32 v73, v73, v10
 v_sub_f32 v74, v74, v10
 v_sub_f32 v75, v75, v10
 v_sub_f32 v76, v76, v11
 v_sub_f32 v77, v77, v11
 v_sub_f32 v78, v78, v11
 v_sub_f32 v79, v79, v11
 v_sub_f32 v80, v80, v10
 v_sub_f32 v81, v81, v10
 v_sub_f32 v82, v82, v10
 v_sub_f32 v83, v83, v10
 v_sub_f32 v84, v84, v11
 v_sub_f32 v85, v85, v11
 v_sub_f32 v86, v86, v11
 v_sub_f32 v87, v87, v11
 v_sub_f32 v88, v88, v10
 v_sub_f32 v89, v89, v10
 v_sub_f32 v90, v90, v10
 v_sub_f32 v91, v91, v10
 v_sub_f32 v92, v92, v11
 v_sub_f32 v93, v93, v11
 v_sub_f32 v94, v94, v11
 v_sub_f32 v95, v95, v11
 v_sub_f32 v96, v96, v10
 v_sub_f32 v97, v97, v10
 v_sub_f32 v98, v98, v10
 v_sub_f32 v99, v99, v10
 v_sub_f32 v100, v100, v11
 v_sub_f32 v101, v101, v11
 v_sub_f32 v102, v102, v11
 v_sub_f32 v103, v103, v11
 v_sub_f32 v104, v104, v10
 v_sub_f32 v105, v105, v10
 v_sub_f32 v106, v106, v10
 v_sub_f32 v107, v107, v10
 v_sub_f32 v108, v108, v11
 v_sub_f32 v109, v109, v11
 v_sub_f32 v110, v110, v11
 v_sub_f32 v111, v111, v11
 v_sub_f32 v112, v112, v10
 v_sub_f32 v113, v113, v10
 v_sub_f32 v114, v114, v10
 v_sub_f32 v115, v115, v10
 v_sub_f32 v116, v116, v11
 v_sub_f32 v117, v117, v11
 v_sub_f32 v118, v118, v11
 v_sub_f32 v119, v119, v11
 v_sub_f32 v120, v120, v10
 v_sub_f32 v121, v121, v10
 v_sub_f32 v122, v122, v10
 v_sub_f32 v123, v123, v10
 v_sub_f32 v124, v124, v11
 v_sub_f32 v125, v125, v11
 v_sub_f32 v126, v126, v11
 v_sub_f32 v127, v127, v11
 v_sub_f32 v32, v32, v10
 v_sub_f32 v33, v33, v10
 v_sub_f32 v34, v34, v10
 v_sub_f32 v35, v35, v10
 v_sub_f32 v36, v36, v11
 v_sub_f32 v37, v37, v11
 v_sub_f32 v38, v38, v11
 v_sub_f32 v39, v39, v11
 v_exp_f32 v12, -v10
 v_exp_f32 v13, -v11
 v_mul_f32 v30, v12, v30
 v_mul_f32 v31, v13, v31
 v_mul_f32 v128, v12, v128
 v_mul_f32 v129, v12, v129
 v_mul_f32 v130, v12, v130
 v_mul_f32 v131, v12, v131
 v_mul_f32 v132, v13, v132
 v_mul_f32 v133, v13, v133
 v_mul_f32 v134, v13, v134
 v_mul_f32 v135, v13, v135
 v_mul_f32 v136, v12, v136
 v_mul_f32 v137, v12, v137
 v_mul_f32 v138, v12, v138
 v_mul_f32 v139, v12, v139
 v_mul_f32 v140, v13, v140
 v_mul_f32 v141, v13, v141
 v_mul_f32 v142, v13, v142
 v_mul_f32 v143, v13, v143
 v_mul_f32 v144, v12, v144
 v_mul_f32 v145, v12, v145
 v_mul_f32 v146, v12, v146
 v_mul_f32 v147, v12, v147
 v_mul_f32 v148, v13, v148
 v_mul_f32 v149, v13, v149
 v_mul_f32 v150, v13, v150
 v_mul_f32 v151, v13, v151
 v_mul_f32 v152, v12, v152
 v_mul_f32 v153, v12, v153
 v_mul_f32 v154, v12, v154
 v_mul_f32 v155, v12, v155
 v_mul_f32 v156, v13, v156
 v_mul_f32 v157, v13, v157
 v_mul_f32 v158, v13, v158
 v_mul_f32 v159, v13, v159
 v_mul_f32 v160, v12, v160
 v_mul_f32 v161, v12, v161
 v_mul_f32 v162, v12, v162
 v_mul_f32 v163, v12, v163
 v_mul_f32 v164, v13, v164
 v_mul_f32 v165, v13, v165
 v_mul_f32 v166, v13, v166
 v_mul_f32 v167, v13, v167
 v_mul_f32 v168, v12, v168
 v_mul_f32 v169, v12, v169
 v_mul_f32 v170, v12, v170
 v_mul_f32 v171, v12, v171
 v_mul_f32 v172, v13, v172
 v_mul_f32 v173, v13, v173
 v_mul_f32 v174, v13, v174
 v_mul_f32 v175, v13, v175
 v_mul_f32 v176, v12, v176
 v_mul_f32 v177, v12, v177
 v_mul_f32 v178, v12, v178
 v_mul_f32 v179, v12, v179
 v_mul_f32 v180, v13, v180
 v_mul_f32 v181, v13, v181
 v_mul_f32 v182, v13, v182
 v_mul_f32 v183, v13, v183
 v_mul_f32 v184, v12, v184
 v_mul_f32 v185, v12, v185
 v_mul_f32 v186, v12, v186
 v_mul_f32 v187, v12, v187
 v_mul_f32 v188, v13, v188
 v_mul_f32 v189, v13, v189
 v_mul_f32 v190, v13, v190
 v_mul_f32 v191, v13, v191
 v_mul_f32 v192, v12, v192
 v_mul_f32 v193, v12, v193
 v_mul_f32 v194, v12, v194
 v_mul_f32 v195, v12, v195
 v_mul_f32 v196, v13, v196
 v_mul_f32 v197, v13, v197
 v_mul_f32 v198, v13, v198
 v_mul_f32 v199, v13, v199
 v_mul_f32 v200, v12, v200
 v_mul_f32 v201, v12, v201
 v_mul_f32 v202, v12, v202
 v_mul_f32 v203, v12, v203
 v_mul_f32 v204, v13, v204
 v_mul_f32 v205, v13, v205
 v_mul_f32 v206, v13, v206
 v_mul_f32 v207, v13, v207
 v_mul_f32 v208, v12, v208
 v_mul_f32 v209, v12, v209
 v_mul_f32 v210, v12, v210
 v_mul_f32 v211, v12, v211
 v_mul_f32 v212, v13, v212
 v_mul_f32 v213, v13, v213
 v_mul_f32 v214, v13, v214
 v_mul_f32 v215, v13, v215
 v_mul_f32 v216, v12, v216
 v_mul_f32 v217, v12, v217
 v_mul_f32 v218, v12, v218
 v_mul_f32 v219, v12, v219
 v_mul_f32 v220, v13, v220
 v_mul_f32 v221, v13, v221
 v_mul_f32 v222, v13, v222
 v_mul_f32 v223, v13, v223
 v_mul_f32 v224, v12, v224
 v_mul_f32 v225, v12, v225
 v_mul_f32 v226, v12, v226
 v_mul_f32 v227, v12, v227
 v_mul_f32 v228, v13, v228
 v_mul_f32 v229, v13, v229
 v_mul_f32 v230, v13, v230
 v_mul_f32 v231, v13, v231
 v_mul_f32 v232, v12, v232
 v_mul_f32 v233, v12, v233
 v_mul_f32 v234, v12, v234
 v_mul_f32 v235, v12, v235
 v_mul_f32 v236, v13, v236
 v_mul_f32 v237, v13, v237
 v_mul_f32 v238, v13, v238
 v_mul_f32 v239, v13, v239
 v_mul_f32 v240, v12, v240
 v_mul_f32 v241, v12, v241
 v_mul_f32 v242, v12, v242
 v_mul_f32 v243, v12, v243
 v_mul_f32 v244, v13, v244
 v_mul_f32 v245, v13, v245
 v_mul_f32 v246, v13, v246
 v_mul_f32 v247, v13, v247
 v_mul_f32 v248, v12, v248
 v_mul_f32 v249, v12, v249
 v_mul_f32 v250, v12, v250
 v_mul_f32 v251, v12, v251
 v_mul_f32 v252, v13, v252
 v_mul_f32 v253, v13, v253
 v_mul_f32 v254, v13, v254
 v_mul_f32 v255, v13, v255
 v_exp_f32 v18, v64
 v_exp_f32 v19, v65
 v_exp_f32 v20, v66
 v_add_f32 v26, v18, v19
 v_cvt_pk_bf16_f32 v40, v18, v19
 v_exp_f32 v21, v67
 v_exp_f32 v22, v72
 v_add_f32 v26, v20, v26
 v_cvt_pk_bf16_f32 v41, v20, v21
 v_exp_f32 v23, v73
 v_add_f32 v26, v21, v26
 v_exp_f32 v24, v74
 v_add_f32 v26, v22, v26
 v_cvt_pk_bf16_f32 v42, v22, v23
 v_exp_f32 v25, v75
 v_add_f32 v26, v23, v26
 v_exp_f32 v18, v68
 v_add_f32 v26, v24, v26
 v_cvt_pk_bf16_f32 v43, v24, v25
 v_exp_f32 v19, v69
 v_add_f32 v26, v25, v26
 v_exp_f32 v20, v70
 v_add_f32 v27, v18, v19
 v_cvt_pk_bf16_f32 v44, v18, v19
 v_exp_f32 v21, v71
 v_exp_f32 v22, v76
 v_add_f32 v27, v20, v27
 v_cvt_pk_bf16_f32 v45, v20, v21
 v_exp_f32 v23, v77
 v_add_f32 v27, v21, v27
 v_exp_f32 v24, v78
 v_add_f32 v27, v22, v27
 v_cvt_pk_bf16_f32 v46, v22, v23
 v_exp_f32 v25, v79
 v_add_f32 v27, v23, v27
 v_add_f32 v27, v24, v27
 v_cvt_pk_bf16_f32 v47, v24, v25
 v_add_f32 v27, v25, v27
 v_exp_f32 v18, v80
 v_exp_f32 v19, v81
 v_exp_f32 v20, v82
 v_add_f32 v26, v18, v26
 v_cvt_pk_bf16_f32 v56, v18, v19
 v_exp_f32 v21, v83
 v_add_f32 v26, v19, v26
 v_exp_f32 v22, v88
 v_add_f32 v26, v20, v26
 v_cvt_pk_bf16_f32 v57, v20, v21
 v_exp_f32 v23, v89
 v_add_f32 v26, v21, v26
 v_exp_f32 v24, v90
 v_add_f32 v26, v22, v26
 v_cvt_pk_bf16_f32 v58, v22, v23
 v_exp_f32 v25, v91
 v_add_f32 v26, v23, v26
 v_exp_f32 v18, v84
 v_add_f32 v26, v24, v26
 v_cvt_pk_bf16_f32 v59, v24, v25
 v_exp_f32 v19, v85
 v_add_f32 v26, v25, v26
 v_exp_f32 v20, v86
 v_add_f32 v27, v18, v27
 v_cvt_pk_bf16_f32 v60, v18, v19
 v_exp_f32 v21, v87
 v_add_f32 v27, v19, v27
 v_exp_f32 v22, v92
 v_add_f32 v27, v20, v27
 v_cvt_pk_bf16_f32 v61, v20, v21
 v_exp_f32 v23, v93
 v_add_f32 v27, v21, v27
 v_exp_f32 v24, v94
 v_add_f32 v27, v22, v27
 v_cvt_pk_bf16_f32 v62, v22, v23
 v_exp_f32 v25, v95
 v_add_f32 v27, v23, v27
 v_add_f32 v27, v24, v27
 v_cvt_pk_bf16_f32 v63, v24, v25
 v_add_f32 v27, v25, v27
 s_nop 3
 s_setpc_b64 s[36:37]
L_slow1:
 s_nop 7
 s_nop 3
 v_max3_f32 v10, v96, v97, v98
 v_max3_f32 v10, v99, v104, v10
 v_max3_f32 v10, v105, v106, v10
 v_max3_f32 v10, v107, v112, v10
 v_max3_f32 v10, v113, v114, v10
 v_max3_f32 v10, v115, v120, v10
 v_max3_f32 v10, v121, v122, v10
 v_max_f32 v10, v123, v10
 v_max3_f32 v11, v100, v101, v102
 v_max3_f32 v11, v103, v108, v11
 v_max3_f32 v11, v109, v110, v11
 v_max3_f32 v11, v111, v116, v11
 v_max3_f32 v11, v117, v118, v11
 v_max3_f32 v11, v119, v124, v11
 v_max3_f32 v11, v125, v126, v11
 v_max_f32 v11, v127, v11
 v_mov_b32 v12, v10
 v_mov_b32 v13, v11
 s_nop 0
 v_permlane16_swap_b32 v12, v10
 v_permlane16_swap_b32 v13, v11
 v_max_f32 v10, v12, v10
 v_max_f32 v11, v13, v11
 v_mov_b32 v12, v10
 v_mov_b32 v13, v11
 s_nop 0
 v_permlane32_swap_b32 v12, v10
 v_permlane32_swap_b32 v13, v11
 v_max_f32 v10, v12, v10
 v_max_f32 v11, v13, v11
 v_ceil_f32 v10, v10
 v_ceil_f32 v11, v11
 v_max_f32 v10, 0, v10
 v_max_f32 v11, 0, v11
 v_sub_f32 v96, v96, v10
 v_sub_f32 v97, v97, v10
 v_sub_f32 v98, v98, v10
 v_sub_f32 v99, v99, v10
 v_sub_f32 v100, v100, v11
 v_sub_f32 v101, v101, v11
 v_sub_f32 v102, v102, v11
 v_sub_f32 v103, v103, v11
 v_sub_f32 v104, v104, v10
 v_sub_f32 v105, v105, v10
 v_sub_f32 v106, v106, v10
 v_sub_f32 v107, v107, v10
 v_sub_f32 v108, v108, v11
 v_sub_f32 v109, v109, v11
 v_sub_f32 v110, v110, v11
 v_sub_f32 v111, v111, v11
 v_sub_f32 v112, v112, v10
 v_sub_f32 v113, v113, v10
 v_sub_f32 v114, v114, v10
 v_sub_f32 v115, v115, v10
 v_sub_f32 v116, v116, v11
 v_sub_f32 v117, v117, v11
 v_sub_f32 v118, v118, v11
 v_sub_f32 v119, v119, v11
 v_sub_f32 v120, v120, v10
 v_sub_f32 v121, v121, v10
 v_sub_f32 v122, v122, v10
 v_sub_f32 v123, v123, v10
 v_sub_f32 v124, v124, v11
 v_sub_f32 v125, v125, v11
 v_sub_f32 v126, v126, v11
 v_sub_f32 v127, v127, v11
 v_sub_f32 v64, v64, v10
 v_sub_f32 v65, v65, v10
 v_sub_f32 v66, v66, v10
 v_sub_f32 v67, v67, v10
 v_sub_f32 v68, v68, v11
 v_sub_f32 v69, v69, v11
 v_sub_f32 v70, v70, v11
 v_sub_f32 v71, v71, v11
 v_sub_f32 v72, v72, v10
 v_sub_f32 v73, v73, v10
 v_sub_f32 v74, v74, v10
 v_sub_f32 v75, v75, v10
 v_sub_f32 v76, v76, v11
 v_sub_f32 v77, v77, v11
 v_sub_f32 v78, v78, v11
 v_sub_f32 v79, v79, v11
 v_sub_f32 v80, v80, v10
 v_sub_f32 v81, v81, v10
 v_sub_f32 v82, v82, v10
 v_sub_f32 v83, v83, v10
 v_sub_f32 v84, v84, v11
 v_sub_f32 v85, v85, v11
 v_sub_f32 v86, v86, v11
 v_sub_f32 v87, v87, v11
 v_sub_f32 v88, v88, v10
 v_sub_f32 v89, v89, v10
 v_sub_f32 v90, v90, v10
 v_sub_f32 v91, v91, v10
 v_sub_f32 v92, v92, v11
 v_sub_f32 v93, v93, v11
 v_sub_f32 v94, v94, v11
 v_sub_f32 v95, v95, v11
 v_sub_f32 v32, v32, v10
 v_sub_f32 v33, v33, v10
 v_sub_f32 v34, v34, v10
 v_sub_f32 v35, v35, v10
 v_sub_f32 v36, v36, v11
 v_sub_f32 v37, v37, v11
 v_sub_f32 v38, v38, v11
 v_sub_f32 v39, v39, v11
 v_exp_f32 v12, -v10
 v_exp_f32 v13, -v11
 v_mul_f32 v30, v12, v30
 v_mul_f32 v31, v13, v31
 v_mul_f32 v128, v12, v128
 v_mul_f32 v129, v12, v129
 v_mul_f32 v130, v12, v130
 v_mul_f32 v131, v12, v131
 v_mul_f32 v132, v13, v132
 v_mul_f32 v133, v13, v133
 v_mul_f32 v134, v13, v134
 v_mul_f32 v135, v13, v135
 v_mul_f32 v136, v12, v136
 v_mul_f32 v137, v12, v137
 v_mul_f32 v138, v12, v138
 v_mul_f32 v139, v12, v139
 v_mul_f32 v140, v13, v140
 v_mul_f32 v141, v13, v141
 v_mul_f32 v142, v13, v142
 v_mul_f32 v143, v13, v143
 v_mul_f32 v144, v12, v144
 v_mul_f32 v145, v12, v145
 v_mul_f32 v146, v12, v146
 v_mul_f32 v147, v12, v147
 v_mul_f32 v148, v13, v148
 v_mul_f32 v149, v13, v149
 v_mul_f32 v150, v13, v150
 v_mul_f32 v151, v13, v151
 v_mul_f32 v152, v12, v152
 v_mul_f32 v153, v12, v153
 v_mul_f32 v154, v12, v154
 v_mul_f32 v155, v12, v155
 v_mul_f32 v156, v13, v156
 v_mul_f32 v157, v13, v157
 v_mul_f32 v158, v13, v158
 v_mul_f32 v159, v13, v159
 v_mul_f32 v160, v12, v160
 v_mul_f32 v161, v12, v161
 v_mul_f32 v162, v12, v162
 v_mul_f32 v163, v12, v163
 v_mul_f32 v164, v13, v164
 v_mul_f32 v165, v13, v165
 v_mul_f32 v166, v13, v166
 v_mul_f32 v167, v13, v167
 v_mul_f32 v168, v12, v168
 v_mul_f32 v169, v12, v169
 v_mul_f32 v170, v12, v170
 v_mul_f32 v171, v12, v171
 v_mul_f32 v172, v13, v172
 v_mul_f32 v173, v13, v173
 v_mul_f32 v174, v13, v174
 v_mul_f32 v175, v13, v175
 v_mul_f32 v176, v12, v176
 v_mul_f32 v177, v12, v177
 v_mul_f32 v178, v12, v178
 v_mul_f32 v179, v12, v179
 v_mul_f32 v180, v13, v180
 v_mul_f32 v181, v13, v181
 v_mul_f32 v182, v13, v182
 v_mul_f32 v183, v13, v183
 v_mul_f32 v184, v12, v184
 v_mul_f32 v185, v12, v185
 v_mul_f32 v186, v12, v186
 v_mul_f32 v187, v12, v187
 v_mul_f32 v188, v13, v188
 v_mul_f32 v189, v13, v189
 v_mul_f32 v190, v13, v190
 v_mul_f32 v191, v13, v191
 v_mul_f32 v192, v12, v192
 v_mul_f32 v193, v12, v193
 v_mul_f32 v194, v12, v194
 v_mul_f32 v195, v12, v195
 v_mul_f32 v196, v13, v196
 v_mul_f32 v197, v13, v197
 v_mul_f32 v198, v13, v198
 v_mul_f32 v199, v13, v199
 v_mul_f32 v200, v12, v200
 v_mul_f32 v201, v12, v201
 v_mul_f32 v202, v12, v202
 v_mul_f32 v203, v12, v203
 v_mul_f32 v204, v13, v204
 v_mul_f32 v205, v13, v205
 v_mul_f32 v206, v13, v206
 v_mul_f32 v207, v13, v207
 v_mul_f32 v208, v12, v208
 v_mul_f32 v209, v12, v209
 v_mul_f32 v210, v12, v210
 v_mul_f32 v211, v12, v211
 v_mul_f32 v212, v13, v212
 v_mul_f32 v213, v13, v213
 v_mul_f32 v214, v13, v214
 v_mul_f32 v215, v13, v215
 v_mul_f32 v216, v12, v216
 v_mul_f32 v217, v12, v217
 v_mul_f32 v218, v12, v218
 v_mul_f32 v219, v12, v219
 v_mul_f32 v220, v13, v220
 v_mul_f32 v221, v13, v221
 v_mul_f32 v222, v13, v222
 v_mul_f32 v223, v13, v223
 v_mul_f32 v224, v12, v224
 v_mul_f32 v225, v12, v225
 v_mul_f32 v226, v12, v226
 v_mul_f32 v227, v12, v227
 v_mul_f32 v228, v13, v228
 v_mul_f32 v229, v13, v229
 v_mul_f32 v230, v13, v230
 v_mul_f32 v231, v13, v231
 v_mul_f32 v232, v12, v232
 v_mul_f32 v233, v12, v233
 v_mul_f32 v234, v12, v234
 v_mul_f32 v235, v12, v235
 v_mul_f32 v236, v13, v236
 v_mul_f32 v237, v13, v237
 v_mul_f32 v238, v13, v238
 v_mul_f32 v239, v13, v239
 v_mul_f32 v240, v12, v240
 v_mul_f32 v241, v12, v241
 v_mul_f32 v242, v12, v242
 v_mul_f32 v243, v12, v243
 v_mul_f32 v244, v13, v244
 v_mul_f32 v245, v13, v245
 v_mul_f32 v246, v13, v246
 v_mul_f32 v247, v13, v247
 v_mul_f32 v248, v12, v248
 v_mul_f32 v249, v12, v249
 v_mul_f32 v250, v12, v250
 v_mul_f32 v251, v12, v251
 v_mul_f32 v252, v13, v252
 v_mul_f32 v253, v13, v253
 v_mul_f32 v254, v13, v254
 v_mul_f32 v255, v13, v255
 v_exp_f32 v18, v96
 v_exp_f32 v19, v97
 v_exp_f32 v20, v98
 v_add_f32 v28, v18, v19
 v_cvt_pk_bf16_f32 v48, v18, v19
 v_exp_f32 v21, v99
 v_exp_f32 v22, v104
 v_add_f32 v28, v20, v28
 v_cvt_pk_bf16_f32 v49, v20, v21
 v_exp_f32 v23, v105
 v_add_f32 v28, v21, v28
 v_exp_f32 v24, v106
 v_add_f32 v28, v22, v28
 v_cvt_pk_bf16_f32 v50, v22, v23
 v_exp_f32 v25, v107
 v_add_f32 v28, v23, v28
 v_exp_f32 v18, v100
 v_add_f32 v28, v24, v28
 v_cvt_pk_bf16_f32 v51, v24, v25
 v_exp_f32 v19, v101
 v_add_f32 v28, v25, v28
 v_exp_f32 v20, v102
 v_add_f32 v29, v18, v19
 v_cvt_pk_bf16_f32 v52, v18, v19
 v_exp_f32 v21, v103
 v_exp_f32 v22, v108
 v_add_f32 v29, v20, v29
 v_cvt_pk_bf16_f32 v53, v20, v21
 v_exp_f32 v23, v109
 v_add_f32 v29, v21, v29
 v_exp_f32 v24, v110
 v_add_f32 v29, v22, v29
 v_cvt_pk_bf16_f32 v54, v22, v23
 v_exp_f32 v25, v111
 v_add_f32 v29, v23, v29
 v_add_f32 v29, v24, v29
 v_cvt_pk_bf16_f32 v55, v24, v25
 v_add_f32 v29, v25, v29
 v_exp_f32 v18, v112
 v_exp_f32 v19, v113
 v_exp_f32 v20, v114
 v_add_f32 v28, v18, v28
 v_cvt_pk_bf16_f32 v56, v18, v19
 v_exp_f32 v21, v115
 v_add_f32 v28, v19, v28
 v_exp_f32 v22, v120
 v_add_f32 v28, v20, v28
 v_cvt_pk_bf16_f32 v57, v20, v21
 v_exp_f32 v23, v121
 v_add_f32 v28, v21, v28
 v_exp_f32 v24, v122
 v_add_f32 v28, v22, v28
 v_cvt_pk_bf16_f32 v58, v22, v23
 v_exp_f32 v25, v123
 v_add_f32 v28, v23, v28
 v_exp_f32 v18, v116
 v_add_f32 v28, v24, v28
 v_cvt_pk_bf16_f32 v59, v24, v25
 v_exp_f32 v19, v117
 v_add_f32 v28, v25, v28
 v_exp_f32 v20, v118
 v_add_f32 v29, v18, v29
 v_cvt_pk_bf16_f32 v60, v18, v19
 v_exp_f32 v21, v119
 v_add_f32 v29, v19, v29
 v_exp_f32 v22, v124
 v_add_f32 v29, v20, v29
 v_cvt_pk_bf16_f32 v61, v20, v21
 v_exp_f32 v23, v125
 v_add_f32 v29, v21, v29
 v_exp_f32 v24, v126
 v_add_f32 v29, v22, v29
 v_cvt_pk_bf16_f32 v62, v22, v23
 v_exp_f32 v25, v127
 v_add_f32 v29, v23, v29
 v_add_f32 v29, v24, v29
 v_cvt_pk_bf16_f32 v63, v24, v25
 v_add_f32 v29, v25, v29
 s_nop 3
 s_setpc_b64 s[36:37]
L_slow1n:
 s_nop 7
 s_nop 3
 v_max3_f32 v10, v96, v97, v98
 v_max3_f32 v10, v99, v104, v10
 v_max3_f32 v10, v105, v106, v10
 v_max3_f32 v10, v107, v112, v10
 v_max3_f32 v10, v113, v114, v10
 v_max3_f32 v10, v115, v120, v10
 v_max3_f32 v10, v121, v122, v10
 v_max_f32 v10, v123, v10
 v_max3_f32 v11, v100, v101, v102
 v_max3_f32 v11, v103, v108, v11
 v_max3_f32 v11, v109, v110, v11
 v_max3_f32 v11, v111, v116, v11
 v_max3_f32 v11, v117, v118, v11
 v_max3_f32 v11, v119, v124, v11
 v_max3_f32 v11, v125, v126, v11
 v_max_f32 v11, v127, v11
 v_mov_b32 v12, v10
 v_mov_b32 v13, v11
 s_nop 0
 v_permlane16_swap_b32 v12, v10
 v_permlane16_swap_b32 v13, v11
 v_max_f32 v10, v12, v10
 v_max_f32 v11, v13, v11
 v_mov_b32 v12, v10
 v_mov_b32 v13, v11
 s_nop 0
 v_permlane32_swap_b32 v12, v10
 v_permlane32_swap_b32 v13, v11
 v_max_f32 v10, v12, v10
 v_max_f32 v11, v13, v11
 v_ceil_f32 v10, v10
 v_ceil_f32 v11, v11
 v_max_f32 v10, 0, v10
 v_max_f32 v11, 0, v11
 v_sub_f32 v96, v96, v10
 v_sub_f32 v97, v97, v10
 v_sub_f32 v98, v98, v10
 v_sub_f32 v99, v99, v10
 v_sub_f32 v100, v100, v11
 v_sub_f32 v101, v101, v11
 v_sub_f32 v102, v102, v11
 v_sub_f32 v103, v103, v11
 v_sub_f32 v104, v104, v10
 v_sub_f32 v105, v105, v10
 v_sub_f32 v106, v106, v10
 v_sub_f32 v107, v107, v10
 v_sub_f32 v108, v108, v11
 v_sub_f32 v109, v109, v11
 v_sub_f32 v110, v110, v11
 v_sub_f32 v111, v111, v11
 v_sub_f32 v112, v112, v10
 v_sub_f32 v113, v113, v10
 v_sub_f32 v114, v114, v10
 v_sub_f32 v115, v115, v10
 v_sub_f32 v116, v116, v11
 v_sub_f32 v117, v117, v11
 v_sub_f32 v118, v118, v11
 v_sub_f32 v119, v119, v11
 v_sub_f32 v120, v120, v10
 v_sub_f32 v121, v121, v10
 v_sub_f32 v122, v122, v10
 v_sub_f32 v123, v123, v10
 v_sub_f32 v124, v124, v11
 v_sub_f32 v125, v125, v11
 v_sub_f32 v126, v126, v11
 v_sub_f32 v127, v127, v11
 v_sub_f32 v32, v32, v10
 v_sub_f32 v33, v33, v10
 v_sub_f32 v34, v34, v10
 v_sub_f32 v35, v35, v10
 v_sub_f32 v36, v36, v11
 v_sub_f32 v37, v37, v11
 v_sub_f32 v38, v38, v11
 v_sub_f32 v39, v39, v11
 v_exp_f32 v12, -v10
 v_exp_f32 v13, -v11
 v_mul_f32 v30, v12, v30
 v_mul_f32 v31, v13, v31
 v_mul_f32 v128, v12, v128
 v_mul_f32 v129, v12, v129
 v_mul_f32 v130, v12, v130
 v_mul_f32 v131, v12, v131
 v_mul_f32 v132, v13, v132
 v_mul_f32 v133, v13, v133
 v_mul_f32 v134, v13, v134
 v_mul_f32 v135, v13, v135
 v_mul_f32 v136, v12, v136
 v_mul_f32 v137, v12, v137
 v_mul_f32 v138, v12, v138
 v_mul_f32 v139, v12, v139
 v_mul_f32 v140, v13, v140
 v_mul_f32 v141, v13, v141
 v_mul_f32 v142, v13, v142
 v_mul_f32 v143, v13, v143
 v_mul_f32 v144, v12, v144
 v_mul_f32 v145, v12, v145
 v_mul_f32 v146, v12, v146
 v_mul_f32 v147, v12, v147
 v_mul_f32 v148, v13, v148
 v_mul_f32 v149, v13, v149
 v_mul_f32 v150, v13, v150
 v_mul_f32 v151, v13, v151
 v_mul_f32 v152, v12, v152
 v_mul_f32 v153, v12, v153
 v_mul_f32 v154, v12, v154
 v_mul_f32 v155, v12, v155
 v_mul_f32 v156, v13, v156
 v_mul_f32 v157, v13, v157
 v_mul_f32 v158, v13, v158
 v_mul_f32 v159, v13, v159
 v_mul_f32 v160, v12, v160
 v_mul_f32 v161, v12, v161
 v_mul_f32 v162, v12, v162
 v_mul_f32 v163, v12, v163
 v_mul_f32 v164, v13, v164
 v_mul_f32 v165, v13, v165
 v_mul_f32 v166, v13, v166
 v_mul_f32 v167, v13, v167
 v_mul_f32 v168, v12, v168
 v_mul_f32 v169, v12, v169
 v_mul_f32 v170, v12, v170
 v_mul_f32 v171, v12, v171
 v_mul_f32 v172, v13, v172
 v_mul_f32 v173, v13, v173
 v_mul_f32 v174, v13, v174
 v_mul_f32 v175, v13, v175
 v_mul_f32 v176, v12, v176
 v_mul_f32 v177, v12, v177
 v_mul_f32 v178, v12, v178
 v_mul_f32 v179, v12, v179
 v_mul_f32 v180, v13, v180
 v_mul_f32 v181, v13, v181
 v_mul_f32 v182, v13, v182
 v_mul_f32 v183, v13, v183
 v_mul_f32 v184, v12, v184
 v_mul_f32 v185, v12, v185
 v_mul_f32 v186, v12, v186
 v_mul_f32 v187, v12, v187
 v_mul_f32 v188, v13, v188
 v_mul_f32 v189, v13, v189
 v_mul_f32 v190, v13, v190
 v_mul_f32 v191, v13, v191
 v_mul_f32 v192, v12, v192
 v_mul_f32 v193, v12, v193
 v_mul_f32 v194, v12, v194
 v_mul_f32 v195, v12, v195
 v_mul_f32 v196, v13, v196
 v_mul_f32 v197, v13, v197
 v_mul_f32 v198, v13, v198
 v_mul_f32 v199, v13, v199
 v_mul_f32 v200, v12, v200
 v_mul_f32 v201, v12, v201
 v_mul_f32 v202, v12, v202
 v_mul_f32 v203, v12, v203
 v_mul_f32 v204, v13, v204
 v_mul_f32 v205, v13, v205
 v_mul_f32 v206, v13, v206
 v_mul_f32 v207, v13, v207
 v_mul_f32 v208, v12, v208
 v_mul_f32 v209, v12, v209
 v_mul_f32 v210, v12, v210
 v_mul_f32 v211, v12, v211
 v_mul_f32 v212, v13, v212
 v_mul_f32 v213, v13, v213
 v_mul_f32 v214, v13, v214
 v_mul_f32 v215, v13, v215
 v_mul_f32 v216, v12, v216
 v_mul_f32 v217, v12, v217
 v_mul_f32 v218, v12, v218
 v_mul_f32 v219, v12, v219
 v_mul_f32 v220, v13, v220
 v_mul_f32 v221, v13, v221
 v_mul_f32 v222, v13, v222
 v_mul_f32 v223, v13, v223
 v_mul_f32 v224, v12, v224
 v_mul_f32 v225, v12, v225
 v_mul_f32 v226, v12, v226
 v_mul_f32 v227, v12, v227
 v_mul_f32 v228, v13, v228
 v_mul_f32 v229, v13, v229
 v_mul_f32 v230, v13, v230
 v_mul_f32 v231, v13, v231
 v_mul_f32 v232, v12, v232
 v_mul_f32 v233, v12, v233
 v_mul_f32 v234, v12, v234
 v_mul_f32 v235, v12, v235
 v_mul_f32 v236, v13, v236
 v_mul_f32 v237, v13, v237
 v_mul_f32 v238, v13, v238
 v_mul_f32 v239, v13, v239
 v_mul_f32 v240, v12, v240
 v_mul_f32 v241, v12, v241
 v_mul_f32 v242, v12, v242
 v_mul_f32 v243, v12, v243
 v_mul_f32 v244, v13, v244
 v_mul_f32 v245, v13, v245
 v_mul_f32 v246, v13, v246
 v_mul_f32 v247, v13, v247
 v_mul_f32 v248, v12, v248
 v_mul_f32 v249, v12, v249
 v_mul_f32 v250, v12, v250
 v_mul_f32 v251, v12, v251
 v_mul_f32 v252, v13, v252
 v_mul_f32 v253, v13, v253
 v_mul_f32 v254, v13, v254
 v_mul_f32 v255, v13, v255
 v_exp_f32 v18, v96
 v_exp_f32 v19, v97
 v_exp_f32 v20, v98
 v_add_f32 v28, v18, v19
 v_cvt_pk_bf16_f32 v48, v18, v19
 v_exp_f32 v21, v99
 v_exp_f32 v22, v104
 v_add_f32 v28, v20, v28
 v_cvt_pk_bf16_f32 v49, v20, v21
 v_exp_f32 v23, v105
 v_add_f32 v28, v21, v28
 v_exp_f32 v24, v106
 v_add_f32 v28, v22, v28
 v_cvt_pk_bf16_f32 v50, v22, v23
 v_exp_f32 v25, v107
 v_add_f32 v28, v23, v28
 v_exp_f32 v18, v100
 v_add_f32 v28, v24, v28
 v_cvt_pk_bf16_f32 v51, v24, v25
 v_exp_f32 v19, v101
 v_add_f32 v28, v25, v28
 v_exp_f32 v20, v102
 v_add_f32 v29, v18, v19
 v_cvt_pk_bf16_f32 v52, v18, v19
 v_exp_f32 v21, v103
 v_exp_f32 v22, v108
 v_add_f32 v29, v20, v29
 v_cvt_pk_bf16_f32 v53, v20, v21
 v_exp_f32 v23, v109
 v_add_f32 v29, v21, v29
 v_exp_f32 v24, v110
 v_add_f32 v29, v22, v29
 v_cvt_pk_bf16_f32 v54, v22, v23
 v_exp_f32 v25, v111
 v_add_f32 v29, v23, v29
 v_add_f32 v29, v24, v29
 v_cvt_pk_bf16_f32 v55, v24, v25
 v_add_f32 v29, v25, v29
 v_exp_f32 v18, v112
 v_exp_f32 v19, v113
 v_exp_f32 v20, v114
 v_add_f32 v28, v18, v28
 v_cvt_pk_bf16_f32 v56, v18, v19
 v_exp_f32 v21, v115
 v_add_f32 v28, v19, v28
 v_exp_f32 v22, v120
 v_add_f32 v28, v20, v28
 v_cvt_pk_bf16_f32 v57, v20, v21
 v_exp_f32 v23, v121
 v_add_f32 v28, v21, v28
 v_exp_f32 v24, v122
 v_add_f32 v28, v22, v28
 v_cvt_pk_bf16_f32 v58, v22, v23
 v_exp_f32 v25, v123
 v_add_f32 v28, v23, v28
 v_exp_f32 v18, v116
 v_add_f32 v28, v24, v28
 v_cvt_pk_bf16_f32 v59, v24, v25
 v_exp_f32 v19, v117
 v_add_f32 v28, v25, v28
 v_exp_f32 v20, v118
 v_add_f32 v29, v18, v29
 v_cvt_pk_bf16_f32 v60, v18, v19
 v_exp_f32 v21, v119
 v_add_f32 v29, v19, v29
 v_exp_f32 v22, v124
 v_add_f32 v29, v20, v29
 v_cvt_pk_bf16_f32 v61, v20, v21
 v_exp_f32 v23, v125
 v_add_f32 v29, v21, v29
 v_exp_f32 v24, v126
 v_add_f32 v29, v22, v29
 v_cvt_pk_bf16_f32 v62, v22, v23
 v_exp_f32 v25, v127
 v_add_f32 v29, v23, v29
 v_add_f32 v29, v24, v29
 v_cvt_pk_bf16_f32 v63, v24, v25
 v_add_f32 v29, v25, v29
 s_nop 3
 s_setpc_b64 s[36:37]
L_slow0B:
 s_nop 7
 s_nop 3
 v_max3_f32 v10, v64, v65, v66
 v_max3_f32 v10, v67, v72, v10
 v_max3_f32 v10, v73, v74, v10
 v_max3_f32 v10, v75, v80, v10
 v_max3_f32 v10, v81, v82, v10
 v_max3_f32 v10, v83, v88, v10
 v_max3_f32 v10, v89, v90, v10
 v_max_f32 v10, v91, v10
 v_max3_f32 v11, v68, v69, v70
 v_max3_f32 v11, v71, v76, v11
 v_max3_f32 v11, v77, v78, v11
 v_max3_f32 v11, v79, v84, v11
 v_max3_f32 v11, v85, v86, v11
 v_max3_f32 v11, v87, v92, v11
 v_max3_f32 v11, v93, v94, v11
 v_max_f32 v11, v95, v11
 v_mov_b32 v12, v10
 v_mov_b32 v13, v11
 s_nop 0
 v_permlane16_swap_b32 v12, v10
 v_permlane16_swap_b32 v13, v11
 v_max_f32 v10, v12, v10
 v_max_f32 v11, v13, v11
 v_mov_b32 v12, v10
 v_mov_b32 v13, v11
 s_nop 0
 v_permlane32_swap_b32 v12, v10
 v_permlane32_swap_b32 v13, v11
 v_max_f32 v10, v12, v10
 v_max_f32 v11, v13, v11
 v_ceil_f32 v10, v10
 v_ceil_f32 v11, v11
 v_max_f32 v10, 0, v10
 v_max_f32 v11, 0, v11
 v_sub_f32 v64, v64, v10
 v_sub_f32 v65, v65, v10
 v_sub_f32 v66, v66, v10
 v_sub_f32 v67, v67, v10
 v_sub_f32 v68, v68, v11
 v_sub_f32 v69, v69, v11
 v_sub_f32 v70, v70, v11
 v_sub_f32 v71, v71, v11
 v_sub_f32 v72, v72, v10
 v_sub_f32 v73, v73, v10
 v_sub_f32 v74, v74, v10
 v_sub_f32 v75, v75, v10
 v_sub_f32 v76, v76, v11
 v_sub_f32 v77, v77, v11
 v_sub_f32 v78, v78, v11
 v_sub_f32 v79, v79, v11
 v_sub_f32 v80, v80, v10
 v_sub_f32 v81, v81, v10
 v_sub_f32 v82, v82, v10
 v_sub_f32 v83, v83, v10
 v_sub_f32 v84, v84, v11
 v_sub_f32 v85, v85, v11
 v_sub_f32 v86, v86, v11
 v_sub_f32 v87, v87, v11
 v_sub_f32 v88, v88, v10
 v_sub_f32 v89, v89, v10
 v_sub_f32 v90, v90, v10
 v_sub_f32 v91, v91, v10
 v_sub_f32 v92, v92, v11
 v_sub_f32 v93, v93, v11
 v_sub_f32 v94, v94, v11
 v_sub_f32 v95, v95, v11
 v_sub_f32 v100, v100, v11
 v_sub_f32 v101, v101, v11
 v_sub_f32 v102, v102, v11
 v_sub_f32 v103, v103, v11
 v_sub_f32 v108, v108, v11
 v_sub_f32 v109, v109, v11
 v_sub_f32 v110, v110, v11
 v_sub_f32 v111, v111, v11
 v_sub_f32 v116, v116, v11
 v_sub_f32 v117, v117, v11
 v_sub_f32 v118, v118, v11
 v_sub_f32 v119, v119, v11
 v_sub_f32 v124, v124, v11
 v_sub_f32 v125, v125, v11
 v_sub_f32 v126, v126, v11
 v_sub_f32 v127, v127, v11
 v_sub_f32 v32, v32, v10
 v_sub_f32 v33, v33, v10
 v_sub_f32 v34, v34, v10
 v_sub_f32 v35, v35, v10
 v_sub_f32 v36, v36, v11
 v_sub_f32 v37, v37, v11
 v_sub_f32 v38, v38, v11
 v_sub_f32 v39, v39, v11
 v_exp_f32 v12, -v10
 v_exp_f32 v13, -v11
 v_mul_f32 v30, v12, v30
 v_mul_f32 v31, v13, v31
 v_mul_f32 v128, v12, v128
 v_mul_f32 v129, v12, v129
 v_mul_f32 v130, v12, v130
 v_mul_f32 v131, v12, v131
 v_mul_f32 v132, v13, v132
 v_mul_f32 v133, v13, v133
 v_mul_f32 v134, v13, v134
 v_mul_f32 v135, v13, v135
 v_mul_f32 v136, v12, v136
 v_mul_f32 v137, v12, v137
 v_mul_f32 v138, v12, v138
 v_mul_f32 v139, v12, v139
 v_mul_f32 v140, v13, v140
 v_mul_f32 v141, v13, v141
 v_mul_f32 v142, v13, v142
 v_mul_f32 v143, v13, v143
 v_mul_f32 v144, v12, v144
 v_mul_f32 v145, v12, v145
 v_mul_f32 v146, v12, v146
 v_mul_f32 v147, v12, v147
 v_mul_f32 v148, v13, v148
 v_mul_f32 v149, v13, v149
 v_mul_f32 v150, v13, v150
 v_mul_f32 v151, v13, v151
 v_mul_f32 v152, v12, v152
 v_mul_f32 v153, v12, v153
 v_mul_f32 v154, v12, v154
 v_mul_f32 v155, v12, v155
 v_mul_f32 v156, v13, v156
 v_mul_f32 v157, v13, v157
 v_mul_f32 v158, v13, v158
 v_mul_f32 v159, v13, v159
 v_mul_f32 v160, v12, v160
 v_mul_f32 v161, v12, v161
 v_mul_f32 v162, v12, v162
 v_mul_f32 v163, v12, v163
 v_mul_f32 v164, v13, v164
 v_mul_f32 v165, v13, v165
 v_mul_f32 v166, v13, v166
 v_mul_f32 v167, v13, v167
 v_mul_f32 v168, v12, v168
 v_mul_f32 v169, v12, v169
 v_mul_f32 v170, v12, v170
 v_mul_f32 v171, v12, v171
 v_mul_f32 v172, v13, v172
 v_mul_f32 v173, v13, v173
 v_mul_f32 v174, v13, v174
 v_mul_f32 v175, v13, v175
 v_mul_f32 v176, v12, v176
 v_mul_f32 v177, v12, v177
 v_mul_f32 v178, v12, v178
 v_mul_f32 v179, v12, v179
 v_mul_f32 v180, v13, v180
 v_mul_f32 v181, v13, v181
 v_mul_f32 v182, v13, v182
 v_mul_f32 v183, v13, v183
 v_mul_f32 v184, v12, v184
 v_mul_f32 v185, v12, v185
 v_mul_f32 v186, v12, v186
 v_mul_f32 v187, v12, v187
 v_mul_f32 v188, v13, v188
 v_mul_f32 v189, v13, v189
 v_mul_f32 v190, v13, v190
 v_mul_f32 v191, v13, v191
 v_mul_f32 v192, v12, v192
 v_mul_f32 v193, v12, v193
 v_mul_f32 v194, v12, v194
 v_mul_f32 v195, v12, v195
 v_mul_f32 v196, v13, v196
 v_mul_f32 v197, v13, v197
 v_mul_f32 v198, v13, v198
 v_mul_f32 v199, v13, v199
 v_mul_f32 v200, v12, v200
 v_mul_f32 v201, v12, v201
 v_mul_f32 v202, v12, v202
 v_mul_f32 v203, v12, v203
 v_mul_f32 v204, v13, v204
 v_mul_f32 v205, v13, v205
 v_mul_f32 v206, v13, v206
 v_mul_f32 v207, v13, v207
 v_mul_f32 v208, v12, v208
 v_mul_f32 v209, v12, v209
 v_mul_f32 v210, v12, v210
 v_mul_f32 v211, v12, v211
 v_mul_f32 v212, v13, v212
 v_mul_f32 v213, v13, v213
 v_mul_f32 v214, v13, v214
 v_mul_f32 v215, v13, v215
 v_mul_f32 v216, v12, v216
 v_mul_f32 v217, v12, v217
 v_mul_f32 v218, v12, v218
 v_mul_f32 v219, v12, v219
 v_mul_f32 v220, v13, v220
 v_mul_f32 v221, v13, v221
 v_mul_f32 v222, v13, v222
 v_mul_f32 v223, v13, v223
 v_mul_f32 v224, v12, v224
 v_mul_f32 v225, v12, v225
 v_mul_f32 v226, v12, v226
 v_mul_f32 v227, v12, v227
 v_mul_f32 v228, v13, v228
 v_mul_f32 v229, v13, v229
 v_mul_f32 v230, v13, v230
 v_mul_f32 v231, v13, v231
 v_mul_f32 v232, v12, v232
 v_mul_f32 v233, v12, v233
 v_mul_f32 v234, v12, v234
 v_mul_f32 v235, v12, v235
 v_mul_f32 v236, v13, v236
 v_mul_f32 v237, v13, v237
 v_mul_f32 v238, v13, v238
 v_mul_f32 v239, v13, v239
 v_mul_f32 v240, v12, v240
 v_mul_f32 v241, v12, v241
 v_mul_f32 v242, v12, v242
 v_mul_f32 v243, v12, v243
 v_mul_f32 v244, v13, v244
 v_mul_f32 v245, v13, v245
 v_mul_f32 v246, v13, v246
 v_mul_f32 v247, v13, v247
 v_mul_f32 v248, v12, v248
 v_mul_f32 v249, v12, v249
 v_mul_f32 v250, v12, v250
 v_mul_f32 v251, v12, v251
 v_mul_f32 v252, v13, v252
 v_mul_f32 v253, v13, v253
 v_mul_f32 v254, v13, v254
 v_mul_f32 v255, v13, v255
 v_exp_f32 v18, v64
 v_exp_f32 v19, v65
 v_exp_f32 v20, v66
 v_add_f32 v26, v18, v19
 v_cvt_pk_bf16_f32 v40, v18, v19
 v_exp_f32 v21, v67
 v_exp_f32 v22, v72
 v_add_f32 v26, v20, v26
 v_cvt_pk_bf16_f32 v41, v20, v21
 v_exp_f32 v23, v73
 v_add_f32 v26, v21, v26
 v_exp_f32 v24, v74
 v_add_f32 v26, v22, v26
 v_cvt_pk_bf16_f32 v42, v22, v23
 v_exp_f32 v25, v75
 v_add_f32 v26, v23, v26
 v_exp_f32 v18, v68
 v_add_f32 v26, v24, v26
 v_cvt_pk_bf16_f32 v43, v24, v25
 v_exp_f32 v19, v69
 v_add_f32 v26, v25, v26
 v_exp_f32 v20, v70
 v_add_f32 v27, v18, v19
 v_cvt_pk_bf16_f32 v44, v18, v19
 v_exp_f32 v21, v71
 v_exp_f32 v22, v76
 v_add_f32 v27, v20, v27
 v_cvt_pk_bf16_f32 v45, v20, v21
 v_exp_f32 v23, v77
 v_add_f32 v27, v21, v27
 v_exp_f32 v24, v78
 v_add_f32 v27, v22, v27
 v_cvt_pk_bf16_f32 v46, v22, v23
 v_exp_f32 v25, v79
 v_add_f32 v27, v23, v27
 v_add_f32 v27, v24, v27
 v_cvt_pk_bf16_f32 v47, v24, v25
 v_add_f32 v27, v25, v27
 v_exp_f32 v18, v80
 v_exp_f32 v19, v81
 v_exp_f32 v20, v82
 v_add_f32 v26, v18, v26
 v_cvt_pk_bf16_f32 v56, v18, v19
 v_exp_f32 v21, v83
 v_add_f32 v26, v19, v26
 v_exp_f32 v22, v88
 v_add_f32 v26, v20, v26
 v_cvt_pk_bf16_f32 v57, v20, v21
 v_exp_f32 v23, v89
 v_add_f32 v26, v21, v26
 v_exp_f32 v24, v90
 v_add_f32 v26, v22, v26
 v_cvt_pk_bf16_f32 v58, v22, v23
 v_exp_f32 v25, v91
 v_add_f32 v26, v23, v26
 v_exp_f32 v18, v84
 v_add_f32 v26, v24, v26
 v_cvt_pk_bf16_f32 v59, v24, v25
 v_exp_f32 v19, v85
 v_add_f32 v26, v25, v26
 v_exp_f32 v20, v86
 v_add_f32 v27, v18, v27
 v_cvt_pk_bf16_f32 v60, v18, v19
 v_exp_f32 v21, v87
 v_add_f32 v27, v19, v27
 v_exp_f32 v22, v92
 v_add_f32 v27, v20, v27
 v_cvt_pk_bf16_f32 v61, v20, v21
 v_exp_f32 v23, v93
 v_add_f32 v27, v21, v27
 v_exp_f32 v24, v94
 v_add_f32 v27, v22, v27
 v_cvt_pk_bf16_f32 v62, v22, v23
 v_exp_f32 v25, v95
 v_add_f32 v27, v23, v27
 v_add_f32 v27, v24, v27
 v_cvt_pk_bf16_f32 v63, v24, v25
 v_add_f32 v27, v25, v27
 s_nop 3
 s_setpc_b64 s[36:37]
L_slowB:
 s_nop 7
 s_nop 3
 v_max3_f32 v11, v100, v101, v102
 v_max3_f32 v11, v103, v108, v11
 v_max3_f32 v11, v109, v110, v11
 v_max3_f32 v11, v111, v116, v11
 v_max3_f32 v11, v117, v118, v11
 v_max3_f32 v11, v119, v124, v11
 v_max3_f32 v11, v125, v126, v11
 v_max_f32 v11, v127, v11
 v_mov_b32 v13, v11
 s_nop 1
 v_permlane16_swap_b32 v13, v11
 v_max_f32 v11, v13, v11
 v_mov_b32 v13, v11
 s_nop 1
 v_permlane32_swap_b32 v13, v11
 v_max_f32 v11, v13, v11
 v_ceil_f32 v11, v11
 v_max_f32 v11, 0, v11
 v_sub_f32 v100, v100, v11
 v_sub_f32 v101, v101, v11
 v_sub_f32 v102, v102, v11
 v_sub_f32 v103, v103, v11
 v_sub_f32 v108, v108, v11
 v_sub_f32 v109, v109, v11
 v_sub_f32 v110, v110, v11
 v_sub_f32 v111, v111, v11
 v_sub_f32 v116, v116, v11
 v_sub_f32 v117, v117, v11
 v_sub_f32 v118, v118, v11
 v_sub_f32 v119, v119, v11
 v_sub_f32 v124, v124, v11
 v_sub_f32 v125, v125, v11
 v_sub_f32 v126, v126, v11
 v_sub_f32 v127, v127, v11
 v_sub_f32 v36, v36, v11
 v_sub_f32 v37, v37, v11
 v_sub_f32 v38, v38, v11
 v_sub_f32 v39, v39, v11
 v_exp_f32 v13, -v11
 s_nop 0
 v_mul_f32 v31, v13, v31
 v_mul_f32 v132, v13, v132
 v_mul_f32 v133, v13, v133
 v_mul_f32 v134, v13, v134
 v_mul_f32 v135, v13, v135
 v_mul_f32 v140, v13, v140
 v_mul_f32 v141, v13, v141
 v_mul_f32 v142, v13, v142
 v_mul_f32 v143, v13, v143
 v_mul_f32 v148, v13, v148
 v_mul_f32 v149, v13, v149
 v_mul_f32 v150, v13, v150
 v_mul_f32 v151, v13, v151
 v_mul_f32 v156, v13, v156
 v_mul_f32 v157, v13, v157
 v_mul_f32 v158, v13, v158
 v_mul_f32 v159, v13, v159
 v_mul_f32 v164, v13, v164
 v_mul_f32 v165, v13, v165
 v_mul_f32 v166, v13, v166
 v_mul_f32 v167, v13, v167
 v_mul_f32 v172, v13, v172
 v_mul_f32 v173, v13, v173
 v_mul_f32 v174, v13, v174
 v_mul_f32 v175, v13, v175
 v_mul_f32 v180, v13, v180
 v_mul_f32 v181, v13, v181
 v_mul_f32 v182, v13, v182
 v_mul_f32 v183, v13, v183
 v_mul_f32 v188, v13, v188
 v_mul_f32 v189, v13, v189
 v_mul_f32 v190, v13, v190
 v_mul_f32 v191, v13, v191
 v_mul_f32 v196, v13, v196
 v_mul_f32 v197, v13, v197
 v_mul_f32 v198, v13, v198
 v_mul_f32 v199, v13, v199
 v_mul_f32 v204, v13, v204
 v_mul_f32 v205, v13, v205
 v_mul_f32 v206, v13, v206
 v_mul_f32 v207, v13, v207
 v_mul_f32 v212, v13, v212
 v_mul_f32 v213, v13, v213
 v_mul_f32 v214, v13, v214
 v_mul_f32 v215, v13, v215
 v_mul_f32 v220, v13, v220
 v_mul_f32 v221, v13, v221
 v_mul_f32 v222, v13, v222
 v_mul_f32 v223, v13, v223
 v_mul_f32 v228, v13, v228
 v_mul_f32 v229, v13, v229
 v_mul_f32 v230, v13, v230
 v_mul_f32 v231, v13, v231
 v_mul_f32 v236, v13, v236
 v_mul_f32 v237, v13, v237
 v_mul_f32 v238, v13, v238
 v_mul_f32 v239, v13, v239
 v_mul_f32 v244, v13, v244
 v_mul_f32 v245, v13, v245
 v_mul_f32 v246, v13, v246
 v_mul_f32 v247, v13, v247
 v_mul_f32 v252, v13, v252
 v_mul_f32 v253, v13, v253
 v_mul_f32 v254, v13, v254
 v_mul_f32 v255, v13, v255
 v_exp_f32 v18, v100
 v_exp_f32 v19, v101
 v_exp_f32 v20, v102
 v_add_f32 v29, v18, v19
 v_cvt_pk_bf16_f32 v52, v18, v19
 v_exp_f32 v21, v103
 v_exp_f32 v22, v108
 v_add_f32 v29, v20, v29
 v_cvt_pk_bf16_f32 v53, v20, v21
 v_exp_f32 v23, v109
 v_add_f32 v29, v21, v29
 v_exp_f32 v24, v110
 v_add_f32 v29, v22, v29
 v_cvt_pk_bf16_f32 v54, v22, v23
 v_exp_f32 v25, v111
 v_add_f32 v29, v23, v29
 v_exp_f32 v18, v116
 v_add_f32 v29, v24, v29
 v_cvt_pk_bf16_f32 v55, v24, v25
 v_exp_f32 v19, v117
 v_add_f32 v29, v25, v29
 v_exp_f32 v20, v118
 v_add_f32 v29, v18, v29
 v_cvt_pk_bf16_f32 v48, v18, v19
 v_exp_f32 v21, v119
 v_add_f32 v29, v19, v29
 v_exp_f32 v22, v124
 v_add_f32 v29, v20, v29
 v_cvt_pk_bf16_f32 v49, v20, v21
 v_exp_f32 v23, v125
 v_add_f32 v29, v21, v29
 v_exp_f32 v24, v126
 v_add_f32 v29, v22, v29
 v_cvt_pk_bf16_f32 v50, v22, v23
 v_exp_f32 v25, v127
 v_add_f32 v29, v23, v29
 v_add_f32 v29, v24, v29
 v_cvt_pk_bf16_f32 v51, v24, v25
 v_add_f32 v29, v25, v29
 s_nop 3
 s_setpc_b64 s[36:37]
L_slowf:
 s_nop 7
 s_nop 3
 v_max3_f32 v10, v64, v65, v66
 v_max3_f32 v10, v67, v72, v10
 v_max3_f32 v10, v73, v74, v10
 v_max3_f32 v10, v75, v80, v10
 v_max3_f32 v10, v81, v82, v10
 v_max3_f32 v10, v83, v88, v10
 v_max3_f32 v10, v89, v90, v10
 v_max_f32 v10, v91, v10
 v_max3_f32 v11, v68, v69, v70
 v_max3_f32 v11, v71, v76, v11
 v_max3_f32 v11, v77, v78, v11
 v_max3_f32 v11, v79, v84, v11
 v_max3_f32 v11, v85, v86, v11
 v_max3_f32 v11, v87, v92, v11
 v_max3_f32 v11, v93, v94, v11
 v_max_f32 v11, v95, v11
 v_mov_b32 v12, v10
 v_mov_b32 v13, v11
 s_nop 0
 v_permlane16_swap_b32 v12, v10
 v_permlane16_swap_b32 v13, v11
 v_max_f32 v10, v12, v10
 v_max_f32 v11, v13, v11
 v_mov_b32 v12, v10
 v_mov_b32 v13, v11
 s_nop 0
 v_permlane32_swap_b32 v12, v10
 v_permlane32_swap_b32 v13, v11
 v_max_f32 v10, v12, v10
 v_max_f32 v11, v13, v11
 v_ceil_f32 v10, v10
 v_ceil_f32 v11, v11
 v_sub_f32 v64, v64, v10
 v_sub_f32 v65, v65, v10
 v_sub_f32 v66, v66, v10
 v_sub_f32 v67, v67, v10
 v_sub_f32 v68, v68, v11
 v_sub_f32 v69, v69, v11
 v_sub_f32 v70, v70, v11
 v_sub_f32 v71, v71, v11
 v_sub_f32 v72, v72, v10
 v_sub_f32 v73, v73, v10
 v_sub_f32 v74, v74, v10
 v_sub_f32 v75, v75, v10
 v_sub_f32 v76, v76, v11
 v_sub_f32 v77, v77, v11
 v_sub_f32 v78, v78, v11
 v_sub_f32 v79, v79, v11
 v_sub_f32 v80, v80, v10
 v_sub_f32 v81, v81, v10
 v_sub_f32 v82, v82, v10
 v_sub_f32 v83, v83, v10
 v_sub_f32 v84, v84, v11
 v_sub_f32 v85, v85, v11
 v_sub_f32 v86, v86, v11
 v_sub_f32 v87, v87, v11
 v_sub_f32 v88, v88, v10
 v_sub_f32 v89, v89, v10
 v_sub_f32 v90, v90, v10
 v_sub_f32 v91, v91, v10
 v_sub_f32 v92, v92, v11
 v_sub_f32 v93, v93, v11
 v_sub_f32 v94, v94, v11
 v_sub_f32 v95, v95, v11
 v_sub_f32 v96, v96, v10
 v_sub_f32 v97, v97, v10
 v_sub_f32 v98, v98, v10
 v_sub_f32 v99, v99, v10
 v_sub_f32 v100, v100, v11
 v_sub_f32 v101, v101, v11
 v_sub_f32 v102, v102, v11
 v_sub_f32 v103, v103, v11
 v_sub_f32 v104, v104, v10
 v_sub_f32 v105, v105, v10
 v_sub_f32 v106, v106, v10
 v_sub_f32 v107, v107, v10
 v_sub_f32 v108, v108, v11
 v_sub_f32 v109, v109, v11
 v_sub_f32 v110, v110, v11
 v_sub_f32 v111, v111, v11
 v_sub_f32 v112, v112, v10
 v_sub_f32 v113, v113, v10
 v_sub_f32 v114, v114, v10
 v_sub_f32 v115, v115, v10
 v_sub_f32 v116, v116, v11
 v_sub_f32 v117, v117, v11
 v_sub_f32 v118, v118, v11
 v_sub_f32 v119, v119, v11
 v_sub_f32 v120, v120, v10
 v_sub_f32 v121, v121, v10
 v_sub_f32 v122, v122, v10
 v_sub_f32 v123, v123, v10
 v_sub_f32 v124, v124, v11
 v_sub_f32 v125, v125, v11
 v_sub_f32 v126, v126, v11
 v_sub_f32 v127, v127, v11
 v_sub_f32 v32, v32, v10
 v_sub_f32 v33, v33, v10
 v_sub_f32 v34, v34, v10
 v_sub_f32 v35, v35, v10
 v_sub_f32 v36, v36, v11
 v_sub_f32 v37, v37, v11
 v_sub_f32 v38, v38, v11
 v_sub_f32 v39, v39, v11
 v_exp_f32 v18, v64
 v_exp_f32 v19, v65
 v_exp_f32 v20, v66
 v_add_f32 v26, v18, v19
 v_cvt_pk_bf16_f32 v40, v18, v19
 v_exp_f32 v21, v67
 v_exp_f32 v22, v72
 v_add_f32 v26, v20, v26
 v_cvt_pk_bf16_f32 v41, v20, v21
 v_exp_f32 v23, v73
 v_add_f32 v26, v21, v26
 v_exp_f32 v24, v74
 v_add_f32 v26, v22, v26
 v_cvt_pk_bf16_f32 v42, v22, v23
 v_exp_f32 v25, v75
 v_add_f32 v26, v23, v26
 v_exp_f32 v18, v68
 v_add_f32 v26, v24, v26
 v_cvt_pk_bf16_f32 v43, v24, v25
 v_exp_f32 v19, v69
 v_add_f32 v26, v25, v26
 v_exp_f32 v20, v70
 v_add_f32 v27, v18, v19
 v_cvt_pk_bf16_f32 v44, v18, v19
 v_exp_f32 v21, v71
 v_exp_f32 v22, v76
 v_add_f32 v27, v20, v27
 v_cvt_pk_bf16_f32 v45, v20, v21
 v_exp_f32 v23, v77
 v_add_f32 v27, v21, v27
 v_exp_f32 v24, v78
 v_add_f32 v27, v22, v27
 v_cvt_pk_bf16_f32 v46, v22, v23
 v_exp_f32 v25, v79
 v_add_f32 v27, v23, v27
 v_add_f32 v27, v24, v27
 v_cvt_pk_bf16_f32 v47, v24, v25
 v_add_f32 v27, v25, v27
 v_exp_f32 v18, v80
 v_exp_f32 v19, v81
 v_exp_f32 v20, v82
 v_add_f32 v26, v18, v26
 v_cvt_pk_bf16_f32 v56, v18, v19
 v_exp_f32 v21, v83
 v_add_f32 v26, v19, v26
 v_exp_f32 v22, v88
 v_add_f32 v26, v20, v26
 v_cvt_pk_bf16_f32 v57, v20, v21
 v_exp_f32 v23, v89
 v_add_f32 v26, v21, v26
 v_exp_f32 v24, v90
 v_add_f32 v26, v22, v26
 v_cvt_pk_bf16_f32 v58, v22, v23
 v_exp_f32 v25, v91
 v_add_f32 v26, v23, v26
 v_exp_f32 v18, v84
 v_add_f32 v26, v24, v26
 v_cvt_pk_bf16_f32 v59, v24, v25
 v_exp_f32 v19, v85
 v_add_f32 v26, v25, v26
 v_exp_f32 v20, v86
 v_add_f32 v27, v18, v27
 v_cvt_pk_bf16_f32 v60, v18, v19
 v_exp_f32 v21, v87
 v_add_f32 v27, v19, v27
 v_exp_f32 v22, v92
 v_add_f32 v27, v20, v27
 v_cvt_pk_bf16_f32 v61, v20, v21
 v_exp_f32 v23, v93
 v_add_f32 v27, v21, v27
 v_exp_f32 v24, v94
 v_add_f32 v27, v22, v27
 v_cvt_pk_bf16_f32 v62, v22, v23
 v_exp_f32 v25, v95
 v_add_f32 v27, v23, v27
 v_add_f32 v27, v24, v27
 v_cvt_pk_bf16_f32 v63, v24, v25
 v_add_f32 v27, v25, v27
 s_nop 3
 s_setpc_b64 s[36:37]
L_moe0:
 s_lshl_b32 s88, s75, 1
 s_call_b64 s[36:37], L_moe
 v_add_f32 v32, v108, v32
 v_add_f32 v33, v109, v33
 v_add_f32 v34, v110, v34
 v_add_f32 v35, v111, v35
 v_add_f32 v36, v112, v36
 v_add_f32 v37, v113, v37
 v_add_f32 v38, v114, v38
 v_add_f32 v39, v115, v39
 v_add_f32 v40, v116, v40
 v_add_f32 v41, v117, v41
 v_add_f32 v42, v118, v42
 v_add_f32 v43, v119, v43
 v_add_f32 v44, v120, v44
 v_add_f32 v45, v121, v45
 v_add_f32 v46, v122, v46
 v_add_f32 v47, v123, v47
 s_mov_b64 exec, -1
 s_branch L_moe_ret0
L_moe1:
 s_lshl_b32 s88, s86, 1
 s_call_b64 s[36:37], L_moe
 v_add_f32 v80, v108, v80
 v_add_f32 v81, v109, v81
 v_add_f32 v82, v110, v82
 v_add_f32 v83, v111, v83
 v_add_f32 v84, v112, v84
 v_add_f32 v85, v113, v85
 v_add_f32 v86, v114, v86
 v_add_f32 v87, v115, v87
 s_mov_b64 exec, -1
 s_branch L_moe_ret1
L_moe2:
 s_lshl_b32 s88, s86, 1
 s_call_b64 s[36:37], L_moe
 v_add_f32 v32, v108, v32
 v_add_f32 v33, v109, v33
 v_add_f32 v34, v110, v34
 v_add_f32 v35, v111, v35
 v_add_f32 v36, v112, v36
 v_add_f32 v37, v113, v37
 v_add_f32 v38, v114, v38
 v_add_f32 v39, v115, v39
 s_mov_b64 exec, -1
 s_branch L_moe_ret2
L_moe:
 v_min_u32 v104, 27, v0
 v_lshlrev_b32 v104, 2, v104
 s_mov_b32 s64, 105062912
 s_mov_b32 s65, 65536
 s_mov_b32 exec_lo, 0xffffffff
 s_mov_b32 exec_hi, 0xffffffff
L_pfy:
 buffer_load_dword v105, v104, s[8:11], s64 offen sc1
 s_sub_u32 s65, s65, 1
 s_cbranch_scc1 L_pfy_x
 s_waitcnt vmcnt(0)
 v_cmp_ne_u32 vcc, 1, v105
 s_nop 0
 s_cbranch_vccz L_pfy_x
 s_sleep 2
 s_branch L_pfy
L_pfy_x:
 s_waitcnt vmcnt(0)
 s_mov_b64 exec, -1
 s_or_b64 exec, s[80:81], s[82:83]
 v_mov_b32 v104, 1792
 v_cndmask_b32 v104, v104, 0, s[80:81]
 v_lshl_add_u32 v104, v11, 5, v104
 s_add_u32 s88, s88, 104898560
 buffer_load_dwordx4 v[108:111], v104, s[8:11], s88 offen sc1
 buffer_load_dwordx4 v[112:115], v104, s[8:11], s88 offen offset:16 sc1
 buffer_load_dwordx4 v[116:119], v104, s[8:11], s88 offen offset:512 sc1
 buffer_load_dwordx4 v[120:123], v104, s[8:11], s88 offen offset:528 sc1
 s_waitcnt vmcnt(0)
 s_setpc_b64 s[36:37]
L_y1:
 s_lshl_b32 s89, s41, 1
 s_add_u32 s89, s89, s20
 s_cmp_ge_u32 s20, 2
 s_cselect_b32 s89, 28, s89
 s_cmp_ge_u32 s89, 28
 s_cbranch_scc1 L_y1r
 v_lshrrev_b32 v50, 4, v7
 v_lshrrev_b32 v51, 3, v50
 v_mul_u32_u24 v51, 4352, v51
 v_and_b32 v52, 7, v50
 v_lshl_add_u32 v51, v52, 7, v51
 s_mov_b32 s90, 104923136
 s_mov_b32 s88, 104957952
 s_mov_b32 s91, 65536
L_yp:
 buffer_load_dword v52, v51, s[8:11], s90 offen sc1
 buffer_load_dword v53, v51, s[8:11], s88 offen sc1
 s_waitcnt vmcnt(0)
 v_min_u32 v52, v52, v53
 v_cmp_gt_u32 vcc, 4, v52
 s_sub_u32 s91, s91, 1
 s_cbranch_scc1 L_ypx
 s_cbranch_vccnz L_yp
L_ypx:
 s_cmp_lt_u32 s89, 14
 s_cselect_b32 s90, 8, 12
 s_add_u32 s90, s90, 104890368
 buffer_load_dword v53, off, s[8:11], s90 sc1
 v_lshrrev_b32 v51, 3, v50
 v_mul_u32_u24 v51, 3584, v51
 v_and_b32 v52, 7, v50
 v_lshl_add_u32 v51, v52, 4, v51
 s_lshl_b32 s88, s89, 7
 s_add_u32 s90, s88, 104898560
 s_add_u32 s88, s88, 105906176
 buffer_load_dwordx4 v[136:139], v51, s[8:11], s88 offen sc1
 s_add_u32 s88, s88, 28672
 buffer_load_dwordx4 v[140:143], v51, s[8:11], s88 offen sc1
 s_add_u32 s88, s88, 28672
 buffer_load_dwordx4 v[152:155], v51, s[8:11], s88 offen sc1
 s_add_u32 s88, s88, 28672
 buffer_load_dwordx4 v[156:159], v51, s[8:11], s88 offen sc1
 s_add_u32 s88, s88, 28672
 buffer_load_dwordx4 v[168:171], v51, s[8:11], s88 offen sc1
 s_add_u32 s88, s88, 28672
 buffer_load_dwordx4 v[172:175], v51, s[8:11], s88 offen sc1
 s_add_u32 s88, s88, 28672
 buffer_load_dwordx4 v[184:187], v51, s[8:11], s88 offen sc1
 s_add_u32 s88, s88, 28672
 buffer_load_dwordx4 v[188:191], v51, s[8:11], s88 offen sc1
 s_add_u32 s88, s88, 28672
 buffer_load_dwordx4 v[200:203], v51, s[8:11], s88 offen sc1
 s_add_u32 s88, s88, 28672
 buffer_load_dwordx4 v[204:207], v51, s[8:11], s88 offen sc1
 s_add_u32 s88, s88, 28672
 buffer_load_dwordx4 v[216:219], v51, s[8:11], s88 offen sc1
 s_add_u32 s88, s88, 28672
 buffer_load_dwordx4 v[220:223], v51, s[8:11], s88 offen sc1
 s_add_u32 s88, s88, 28672
 buffer_load_dwordx4 v[232:235], v51, s[8:11], s88 offen sc1
 s_add_u32 s88, s88, 28672
 buffer_load_dwordx4 v[236:239], v51, s[8:11], s88 offen sc1
 s_add_u32 s88, s88, 28672
 s_branch L_y1r
L_y2:
 s_cmp_ge_u32 s89, 28
 s_cbranch_scc1 L_y2r
 s_waitcnt vmcnt(24)
 s_waitcnt vmcnt(12)
 v_add_f32 v136, v140, v136
 v_add_f32 v137, v141, v137
 v_add_f32 v138, v142, v138
 v_add_f32 v139, v143, v139
 s_waitcnt vmcnt(11)
 v_add_f32 v136, v152, v136
 v_add_f32 v137, v153, v137
 v_add_f32 v138, v154, v138
 v_add_f32 v139, v155, v139
 s_waitcnt vmcnt(10)
 v_add_f32 v136, v156, v136
 v_add_f32 v137, v157, v137
 v_add_f32 v138, v158, v138
 v_add_f32 v139, v159, v139
 s_waitcnt vmcnt(9)
 v_add_f32 v136, v168, v136
 v_add_f32 v137, v169, v137
 v_add_f32 v138, v170, v138
 v_add_f32 v139, v171, v139
 s_waitcnt vmcnt(8)
 v_add_f32 v136, v172, v136
 v_add_f32 v137, v173, v137
 v_add_f32 v138, v174, v138
 v_add_f32 v139, v175, v139
 s_waitcnt vmcnt(7)
 v_add_f32 v136, v184, v136
 v_add_f32 v137, v185, v137
 v_add_f32 v138, v186, v138
 v_add_f32 v139, v187, v139
 s_waitcnt vmcnt(6)
 v_add_f32 v136, v188, v136
 v_add_f32 v137, v189, v137
 v_add_f32 v138, v190, v138
 v_add_f32 v139, v191, v139
 s_waitcnt vmcnt(5)
 v_add_f32 v136, v200, v136
 v_add_f32 v137, v201, v137
 v_add_f32 v138, v202, v138
 v_add_f32 v139, v203, v139
 s_waitcnt vmcnt(4)
 v_add_f32 v136, v204, v136
 v_add_f32 v137, v205, v137
 v_add_f32 v138, v206, v138
 v_add_f32 v139, v207, v139
 s_waitcnt vmcnt(3)
 v_add_f32 v136, v216, v136
 v_add_f32 v137, v217, v137
 v_add_f32 v138, v218, v138
 v_add_f32 v139, v219, v139
 s_waitcnt vmcnt(2)
 v_add_f32 v136, v220, v136
 v_add_f32 v137, v221, v137
 v_add_f32 v138, v222, v138
 v_add_f32 v139, v223, v139
 s_waitcnt vmcnt(1)
 v_add_f32 v136, v232, v136
 v_add_f32 v137, v233, v137
 v_add_f32 v138, v234, v138
 v_add_f32 v139, v235, v139
 s_waitcnt vmcnt(0)
 v_add_f32 v136, v236, v136
 v_add_f32 v137, v237, v137
 v_add_f32 v138, v238, v138
 v_add_f32 v139, v239, v139
 v_add_f32 v136, v136, v136 row_ror:8 row_mask:0xf bank_mask:0xf
 v_add_f32 v137, v137, v137 row_ror:8 row_mask:0xf bank_mask:0xf
 v_add_f32 v138, v138, v138 row_ror:8 row_mask:0xf bank_mask:0xf
 v_add_f32 v139, v139, v139 row_ror:8 row_mask:0xf bank_mask:0xf
 v_mov_b32 v140, v136
 v_mov_b32 v141, v137
 v_mov_b32 v142, v138
 v_mov_b32 v143, v139
 v_permlane16_swap_b32 v140, v136
 v_permlane16_swap_b32 v141, v137
 v_permlane16_swap_b32 v142, v138
 v_permlane16_swap_b32 v143, v139
 v_add_f32 v136, v140, v136
 v_add_f32 v137, v141, v137
 v_add_f32 v138, v142, v138
 v_add_f32 v139, v143, v139
 v_mov_b32 v140, v136
 v_mov_b32 v141, v137
 v_mov_b32 v142, v138
 v_mov_b32 v143, v139
 v_permlane32_swap_b32 v140, v136
 v_permlane32_swap_b32 v141, v137
 v_permlane32_swap_b32 v142, v138
 v_permlane32_swap_b32 v143, v139
 v_add_f32 v136, v140, v136
 v_add_f32 v137, v141, v137
 v_add_f32 v138, v142, v138
 v_add_f32 v139, v143, v139
 v_cvt_pk_bf16_f32 v51, v136, v137
 v_lshlrev_b32 v136, 16, v51
 v_and_b32 v137, 0xffff0000, v51
 v_cvt_pk_bf16_f32 v51, v138, v139
 v_lshlrev_b32 v138, 16, v51
 v_and_b32 v139, 0xffff0000, v51
 v_mul_f32 v136, v53, v136
 v_mul_f32 v137, v53, v137
 v_mul_f32 v138, v53, v138
 v_mul_f32 v139, v53, v139
 v_cvt_pk_bf16_f32 v51, v136, v137
 v_lshlrev_b32 v136, 16, v51
 v_and_b32 v137, 0xffff0000, v51
 v_cvt_pk_bf16_f32 v51, v138, v139
 v_lshlrev_b32 v138, 16, v51
 v_and_b32 v139, 0xffff0000, v51
 s_mov_b64 exec, 0xff
 buffer_store_dwordx4 v[136:139], v7, s[8:11], s90 offen sc1
 s_mov_b64 exec, -1
 s_branch L_y2r
L_y3:
 s_cmp_ge_u32 s89, 28
 s_cbranch_scc1 L_y3r
 v_mov_b32 v52, 1
 s_lshl_b32 s89, s89, 2
 s_add_u32 s89, s89, 105062912
 s_mov_b64 exec, 1
 s_waitcnt vmcnt(5)
 buffer_store_dword v52, off, s[8:11], s89 sc1
 s_mov_b64 exec, -1
 s_branch L_y3r
L_fll:
 buffer_load_dword v6, v9, s[8:11], s46 offen sc1
 s_branch L_fllr
L_pub3:
 v_mov_b32 v17, s3
 buffer_store_dword v17, v1, s[8:11], s45 offen sc1
 s_branch L_pub3r
L_fhs0:
 s_mov_b32 s91, 65536
L_fhs0_l:
 s_sleep 2
 buffer_load_dword v24, off, s[8:11], s79 sc1
 s_sub_u32 s91, s91, 1
 s_cbranch_scc1 L_fhs0_x
 s_waitcnt vmcnt(0)
 v_cmp_gt_u32 vcc, 1, v24
 s_nop 0
 s_cbranch_vccnz L_fhs0_l
L_fhs0_x:
 s_waitcnt vmcnt(0)
 s_branch L_fhr0
L_fhs1:
 s_mov_b32 s91, 65536
L_fhs1_l:
 s_sleep 2
 buffer_load_dword v24, off, s[8:11], s79 sc1
 s_sub_u32 s91, s91, 1
 s_cbranch_scc1 L_fhs1_x
 s_waitcnt vmcnt(0)
 v_cmp_gt_u32 vcc, 1, v24
 s_nop 0
 s_cbranch_vccnz L_fhs1_l
L_fhs1_x:
 s_waitcnt vmcnt(0)
 s_branch L_fhr1
L_fps0:
 s_mov_b32 s53, 65536
L_fps0_l:
 s_sleep 2
 buffer_load_dword v5, off, s[8:11], s47 sc1
 s_sub_u32 s53, s53, 1
 s_cbranch_scc1 L_fps0_x
 s_waitcnt vmcnt(0)
 v_cmp_ne_u32 vcc, 1, v5
 s_nop 0
 s_cbranch_vccnz L_fps0_l
L_fps0_x:
 s_waitcnt vmcnt(0)
 s_branch L_fpr0
L_fps1:
 s_mov_b32 s53, 65536
L_fps1_l:
 s_sleep 2
 buffer_load_dword v5, off, s[8:11], s47 sc1
 s_sub_u32 s53, s53, 1
 s_cbranch_scc1 L_fps1_x
 s_waitcnt vmcnt(0)
 v_cmp_ne_u32 vcc, 1, v5
 s_nop 0
 s_cbranch_vccnz L_fps1_l
L_fps1_x:
 s_waitcnt vmcnt(0)
 s_branch L_fpr1
L_f4s:
 s_mov_b32 s53, 65536
L_f4s_l:
 s_sleep 2
 buffer_load_dword v6, v9, s[8:11], s46 offen sc1
 s_sub_u32 s53, s53, 1
 s_cbranch_scc1 L_f4s_x
 s_waitcnt vmcnt(0)
 v_cmp_gt_u32 vcc, 3, v6
 s_nop 0
 s_cbranch_vccnz L_f4s_l
L_f4s_x:
 s_waitcnt vmcnt(0)
 s_branch L_f4r
L_f2s:
 s_mov_b32 s53, 65536
L_f2s_l:
 s_sleep 2
 buffer_load_dword v6, v9, s[8:11], s46 offen sc1
 s_sub_u32 s53, s53, 1
 s_cbranch_scc1 L_f2s_x
 s_waitcnt vmcnt(0)
 v_cmp_gt_u32 vcc, 3, v6
 s_nop 0
 s_cbranch_vccnz L_f2s_l
L_f2s_x:
 s_waitcnt vmcnt(0)
 s_branch L_f2r
L_fls0:
 s_mov_b32 s53, 65536
L_fls0_l:
 s_sleep 2
 buffer_load_dword v6, v9, s[8:11], s46 offen sc1
 s_sub_u32 s53, s53, 1
 s_cbranch_scc1 L_fls0_x
 s_waitcnt vmcnt(0)
 v_cmp_gt_u32 vcc, s39, v6
 s_nop 0
 s_cbranch_vccnz L_fls0_l
L_fls0_x:
 s_waitcnt vmcnt(0)
 s_branch L_flr0
L_code_end:
.section .rodata,"a"
.p2align 6
.amdhsa_kernel gated_mix__compressed_kv_cla__moe_arch_mod__prompt_kernel
  .amdhsa_next_free_vgpr 512
  .amdhsa_next_free_sgpr 102
  .amdhsa_accum_offset 256
  .amdhsa_group_segment_fixed_size 0
  .amdhsa_kernarg_size 120
  .amdhsa_user_sgpr_count 2
  .amdhsa_user_sgpr_kernarg_segment_ptr 1
  .amdhsa_system_sgpr_workgroup_id_x 1
  .amdhsa_float_denorm_mode_32 3
.end_amdhsa_kernel
```

```asm
; @launch grid=(256,1,1) block=(256,1,1) lds=163840
.amdgcn_target "amdgcn-amd-amdhsa--gfx950"
.text
.macro M d, a, b, c
v_mfma_f32_16x16x32_bf16 \d, \a, \b, \c
.endm
.globl gated_mix__compressed_kv_cla__moe_arch_mod__prompt_kernel
.p2align 8
.type gated_mix__compressed_kv_cla__moe_arch_mod__prompt_kernel,@function
gated_mix__compressed_kv_cla__moe_arch_mod__prompt_kernel:
 s_cmp_lt_u32 s2, 256
 s_cbranch_scc1 L_go
 s_endpgm
L_go:
 s_load_dwordx8 s[80:87], s[0:1], 0
 s_load_dwordx4 s[88:91], s[0:1], 32
 s_load_dwordx2 s[92:93], s[0:1], 56
 s_load_dwordx2 s[30:31], s[0:1], 88
 s_load_dwordx4 s[4:7], s[0:1], 104
 v_lshrrev_b32 v24, 6, v0
 v_and_b32 v0, 63, v0
 v_readfirstlane_b32 s20, v24
 s_getpc_b64 s[76:77]
L_pc0:
 s_and_b32 s77, s77, 0xffff
 s_mov_b32 s78, L_code_end-L_pc0
 s_mov_b32 s79, 0x20000
 s_lshr_b32 s64, s2, 3
 s_lshl_b32 s64, s64, 2
 s_add_u32 s64, s64, s20
 s_lshl_b32 s95, s64, 11
 v_lshl_add_u32 v29, v0, 7, s95
 v_and_b32 v28, 48, v0
 v_lshl_add_u32 v28, v28, 24, v29
 buffer_load_dword a240, v28, s[76:79], 0 offen offset:0
 s_and_b32 s41, s2, 7
 s_lshr_b32 s42, s2, 3
 s_lshr_b32 s64, s42, 4
 s_lshl_b32 s64, s64, 3
 s_add_u32 s41, s41, s64
 s_and_b32 s42, s42, 15
 s_lshr_b32 s45, s42, 3
 s_xor_b32 s45, s45, 1
 s_mov_b32 s44, 0
 v_accvgpr_write_b32 a250, 0
 v_accvgpr_write_b32 a251, 0
 v_and_b32 v24, 15, v0
 v_lshrrev_b32 v25, 4, v0
 v_lshlrev_b32 v7, 4, v0
 s_and_b32 s65, s20, 1
 s_lshr_b32 s66, s20, 1
 v_or_b32 v28, 0, v25
 v_lshlrev_b32 v28, 1, v28
 v_xor_b32 v28, v28, v24
 v_lshrrev_b32 v29, 3, v28
 v_lshlrev_b32 v29, 8, v29
 v_and_b32 v28, 7, v28
 v_lshl_add_u32 v28, v28, 4, v29
 v_lshl_add_u32 v28, v25, 13, v28
 s_lshl_b32 s64, s20, 17
 s_add_u32 s64, s64, 0
 v_add_u32 v8, s64, v28
 v_add_u32 v9, 31744, v8
 v_or_b32 v28, 4, v25
 v_lshlrev_b32 v28, 1, v28
 v_xor_b32 v28, v28, v24
 v_lshrrev_b32 v29, 3, v28
 v_lshlrev_b32 v29, 8, v29
 v_and_b32 v28, 7, v28
 v_lshl_add_u32 v28, v28, 4, v29
 v_lshl_add_u32 v28, v25, 13, v28
 s_lshl_b32 s64, s20, 17
 s_add_u32 s64, s64, 63488
 v_add_u32 v10, s64, v28
 v_add_u32 v11, 31744, v10
 v_add_u32 v28, 0, v25
 v_and_b32 v29, 7, v0
 v_xor_b32 v28, v28, v29
 v_lshlrev_b32 v28, 4, v28
 v_lshrrev_b32 v29, 3, v0
 v_lshl_add_u32 v30, v29, 11, v28
 s_lshl_b32 s64, s66, 19
 s_lshl_b32 s67, s65, 20
 s_add_u32 s64, s64, s67
 s_add_u32 s64, s64, 0
 v_add_u32 v12, s64, v30
 v_add_u32 v14, 30720, v12
 v_add_u32 v28, 4, v25
 v_and_b32 v29, 7, v0
 v_xor_b32 v28, v28, v29
 v_lshlrev_b32 v28, 4, v28
 v_lshrrev_b32 v29, 3, v0
 v_lshl_add_u32 v30, v29, 11, v28
 s_lshl_b32 s64, s66, 19
 s_lshl_b32 s67, s65, 20
 s_add_u32 s64, s64, s67
 s_add_u32 s64, s64, 15360
 v_add_u32 v13, s64, v30
 v_add_u32 v15, 30720, v13
 s_mov_b32 s21, 0
 s_mov_b32 s22, 0
 s_lshl_b32 s23, s20, 12
 s_add_u32 s24, s23, 65536
 s_lshl_b32 s74, s41, 9
 s_sub_u32 s18, 8388608, s74
 s_mov_b32 s19, 0x20000
 s_and_b32 s75, s42, 7
 s_lshl_b32 s75, s75, 16
 s_sub_u32 s50, 4194304, s75
 s_mov_b32 s51, 0x20000
 s_mov_b32 m0, s23
 s_cmp_eq_u32 s45, 0
 s_waitcnt lgkmcnt(0)
 s_cselect_b64 s[72:73], s[86:87], s[88:89]
 s_add_u32 s16, s72, s74
 s_addc_u32 s17, s73, 0
 s_and_b32 s17, s17, 0xffff
 buffer_load_dwordx4 v8, s[16:19], s21 offen offset:0  nt lds
 buffer_load_dwordx4 v9, s[16:19], s21 offen offset:1024  nt lds
 buffer_load_dwordx4 v10, s[16:19], s21 offen offset:2048  nt lds
 buffer_load_dwordx4 v11, s[16:19], s21 offen offset:3072  nt lds
 s_add_u32 s21, s21, 128
 s_add_u32 s48, s82, s75
 s_addc_u32 s49, s83, 0
 s_and_b32 s49, s49, 0xffff
 s_add_u32 m0, s24, 0
 s_nop 0
 buffer_load_dwordx4 v12, s[48:51], s22 offen offset:0   lds
 buffer_load_dwordx4 v13, s[48:51], s22 offen offset:1024   lds
 buffer_load_dwordx4 v14, s[48:51], s22 offen offset:2048   lds
 buffer_load_dwordx4 v15, s[48:51], s22 offen offset:3072   lds
 s_add_u32 s22, s22, 2097152
 s_add_u32 m0, s23, 16384
 s_nop 0
 buffer_load_dwordx4 v8, s[16:19], s21 offen offset:0  nt lds
 buffer_load_dwordx4 v9, s[16:19], s21 offen offset:1024  nt lds
 buffer_load_dwordx4 v10, s[16:19], s21 offen offset:2048  nt lds
 buffer_load_dwordx4 v11, s[16:19], s21 offen offset:3072  nt lds
 s_add_u32 s21, s21, 524160
 v_lshrrev_b32 v26, 2, v24
 v_and_b32 v28, 1, v25
 v_lshl_or_b32 v28, v28, 2, v26
 v_lshl_add_u32 v29, v25, 3, v26
 v_lshlrev_b32 v29, 8, v29
 v_and_b32 v30, 3, v0
 v_lshl_add_u32 v29, v30, 3, v29
 s_lshl_b32 s64, s65, 2
 s_add_u32 s64, s64, 0
 v_xor_b32 v30, s64, v28
 v_lshl_add_u32 v1, v30, 5, v29
 s_lshl_b32 s64, s65, 2
 s_add_u32 s64, s64, 1
 v_xor_b32 v30, s64, v28
 v_lshl_add_u32 v2, v30, 5, v29
 s_lshl_b32 s64, s65, 2
 s_add_u32 s64, s64, 2
 v_xor_b32 v30, s64, v28
 v_lshl_add_u32 v3, v30, 5, v29
 s_lshl_b32 s64, s65, 2
 s_add_u32 s64, s64, 3
 v_xor_b32 v30, s64, v28
 v_lshl_add_u32 v4, v30, 5, v29
 v_add_u32 v28, 0, v25
 v_lshrrev_b32 v29, 1, v24
 v_xor_b32 v28, v28, v29
 v_lshlrev_b32 v28, 4, v28
 v_lshl_add_u32 v28, v24, 7, v28
 s_lshl_b32 s64, s66, 13
 s_add_u32 s64, s64, 65536
 v_add_u32 v5, s64, v28
 v_add_u32 v28, 4, v25
 v_lshrrev_b32 v29, 1, v24
 v_xor_b32 v28, v28, v29
 v_lshlrev_b32 v28, 4, v28
 v_lshl_add_u32 v28, v24, 7, v28
 s_lshl_b32 s64, s66, 13
 s_add_u32 s64, s64, 65536
 v_add_u32 v6, s64, v28
 s_lshl_b32 s64, s2, 2
 s_add_u32 s64, s64, s20
 s_lshl_b32 s64, s64, 12
 v_lshrrev_b32 v28, 2, v0
 v_and_b32 v29, 3, v0
 v_lshlrev_b32 v29, 7, v29
 v_lshl_add_u32 v28, v28, 11, v29
 v_add_u32 v24, s64, v28
 v_and_b32 v28, 56, v0
 v_lshl_add_u32 v24, v28, 24, v24
 s_mov_b32 s32, s82
 s_and_b32 s33, s83, 0xffff
 s_mov_b32 s34, 4194304
 s_mov_b32 s35, 0x20000
 s_mov_b32 s56, s80
 s_and_b32 s57, s81, 0xffff
 s_mov_b32 s58, 1835008
 s_mov_b32 s59, 0x20000
 s_mov_b32 s60, s92
 s_and_b32 s61, s93, 0xffff
 s_mov_b32 s62, 896
 s_mov_b32 s63, 0x20000
 s_mov_b32 s68, s30
 s_and_b32 s69, s31, 0xffff
 s_mov_b32 s70, 896
 s_mov_b32 s71, 0x20000
 s_mov_b32 s8, s6
 s_and_b32 s9, s7, 0xffff
 s_mov_b32 s10, 268435456
 s_mov_b32 s11, 0x20000
 s_mov_b32 s12, s4
 s_and_b32 s13, s5, 0xffff
 s_mov_b32 s14, 256
 s_mov_b32 s15, 0x20000
 s_add_u32 s72, s84, s74
 s_addc_u32 s73, s85, 0
 s_sub_u32 s75, 3670016, s74
 s_mov_b32 s52, s72
 s_and_b32 s53, s73, 0xffff
 s_mov_b32 s54, s75
 s_mov_b32 s55, 0x20000
 s_mov_b32 s5, 0x3db8aa3b
 s_mov_b32 s28, 0
 s_mul_i32 s29, s42, 114688
 s_lshl_b32 s72, s45, 24
 s_lshl_b32 s73, s41, 20
 s_add_u32 s72, s72, s73
 s_bfe_u32 s64, s42, 0x20001
 s_lshl_b32 s64, s64, 15
 s_add_u32 s72, s72, s64
 s_lshl_b32 s64, s66, 17
 s_add_u32 s72, s72, s64
 s_and_b32 s67, s42, 1
 s_cmp_eq_u32 s45, 0
 s_cselect_b32 s64, 12, 14
 s_cselect_b32 s75, 14, 10
 s_lshl_b32 s67, s67, s75
 s_add_u32 s72, s72, s67
 s_lshl_b32 s64, s65, s64
 s_add_u32 s93, s72, s64
 s_load_dwordx4 s[80:83], s[0:1], 64
 s_load_dwordx2 s[84:85], s[0:1], 80
 s_load_dwordx2 s[96:97], s[0:1], 96
 s_cmp_lt_u32 s42, 8
 s_cbranch_scc0 L_kv1
L_kv0:
 s_lshl_b32 s64, s42, 4
 s_add_u32 s64, s64, s41
 s_lshl_b32 s64, s64, 2
 s_add_u32 s64, s64, s20
 s_cmp_lt_u32 s64, 41
 s_cselect_b32 s39, 0, 536870912
 s_min_u32 s64, s64, 41
 s_lshl_b32 s38, s64, 2
 s_max_u32 s67, s64, 8
 s_sub_u32 s67, s67, 8
 s_mul_i32 s67, s67, 3328
 s_lshl_b32 s64, s64, 10
 s_add_u32 s64, s64, s67
 s_add_u32 s73, s64, 104914944
 v_or_b32 v64, s39, v7
 v_mov_b32 v68, 0
 v_mov_b32 v69, 0
 v_mov_b32 v70, 0
 v_mov_b32 v71, 0
 s_lshl_b32 s30, s41, 3
 s_add_u32 s30, s30, s42
 s_lshl_b32 s64, s30, 2
 s_add_u32 s64, s64, s20
 s_mul_i32 s72, s64, 3584
 v_mov_b32 v32, 536870912
 v_cmp_gt_u32 vcc, 56, v0
 s_lshl_b32 s67, s64, 2
 s_nop 0
 v_cndmask_b32 v32, v32, v7, vcc
 buffer_load_dwordx4 v[40:43], v32, s[56:59], s72 offen offset:0
 buffer_load_dwordx4 v[44:47], v32, s[56:59], s72 offen offset:896
 buffer_load_dwordx4 v[48:51], v32, s[56:59], s72 offen offset:1792
 buffer_load_dwordx4 v[52:55], v32, s[56:59], s72 offen offset:2688
 buffer_load_dwordx4 v[56:59], v32, s[60:63], 0 offen
 buffer_load_dwordx4 v[60:63], v32, s[68:71], 0 offen
 buffer_store_dwordx4 v[68:71], v64, s[8:11], s73 offen offset:0 sc1
 buffer_store_dwordx4 v[68:71], v64, s[8:11], s73 offen offset:1024 sc1
 buffer_store_dwordx4 v[68:71], v64, s[8:11], s73 offen offset:2048 sc1
 s_waitcnt vmcnt(13) lgkmcnt(0)
 s_barrier
 ds_read_b128 a[160:163], v5 offset:0
 ds_read_b128 a[164:167], v6 offset:0
 ds_read_b64_tr_b16 a[32:33], v1 offset:0
 ds_read_b64_tr_b16 a[34:35], v1 offset:1024
 ds_read_b64_tr_b16 a[36:37], v1 offset:8192
 ds_read_b64_tr_b16 a[38:39], v1 offset:9216
 ds_read_b64_tr_b16 a[40:41], v2 offset:0
 ds_read_b64_tr_b16 a[42:43], v2 offset:1024
 ds_read_b64_tr_b16 a[44:45], v2 offset:8192
 ds_read_b64_tr_b16 a[46:47], v2 offset:9216
 ds_read_b128 a[168:171], v5 offset:2048
 ds_read_b128 a[172:175], v6 offset:2048
 ds_read_b64_tr_b16 a[48:49], v3 offset:0
 ds_read_b64_tr_b16 a[50:51], v3 offset:1024
 ds_read_b64_tr_b16 a[52:53], v3 offset:8192
 ds_read_b64_tr_b16 a[54:55], v3 offset:9216
 ds_read_b64_tr_b16 a[56:57], v4 offset:0
 ds_read_b64_tr_b16 a[58:59], v4 offset:1024
 ds_read_b64_tr_b16 a[60:61], v4 offset:8192
 ds_read_b64_tr_b16 a[62:63], v4 offset:9216
 ds_read_b128 a[176:179], v5 offset:4096
 ds_read_b128 a[180:183], v6 offset:4096
 ds_read_b128 a[184:187], v5 offset:6144
 ds_read_b128 a[188:191], v6 offset:6144
 s_add_u32 m0, s24, 16384
 s_nop 0
 buffer_load_dwordx4 v12, s[48:51], s22 offen offset:0   lds
 buffer_load_dwordx4 v13, s[48:51], s22 offen offset:1024   lds
 buffer_load_dwordx4 v14, s[48:51], s22 offen offset:2048   lds
 buffer_load_dwordx4 v15, s[48:51], s22 offen offset:3072   lds
 s_sub_u32 s22, s22, 2097024
 s_add_u32 m0, s23, 32768
 s_nop 0
 buffer_load_dwordx4 v8, s[16:19], s21 offen offset:0  nt lds
 buffer_load_dwordx4 v9, s[16:19], s21 offen offset:1024  nt lds
 buffer_load_dwordx4 v10, s[16:19], s21 offen offset:2048  nt lds
 buffer_load_dwordx4 v11, s[16:19], s21 offen offset:3072  nt lds
 s_add_u32 s21, s21, 128
 v_mov_b32 v72, 0
 v_mov_b32 v73, 0
 v_mov_b32 v74, 0
 v_mov_b32 v75, 0
 v_mov_b32 v76, 0
 v_mov_b32 v77, 0
 v_mov_b32 v78, 0
 v_mov_b32 v79, 0
 s_waitcnt vmcnt(12)
 v_dot2c_f32_bf16 v72, v40, v56
 v_dot2c_f32_bf16 v73, v44, v56
 v_dot2c_f32_bf16 v74, v48, v56
 v_dot2c_f32_bf16 v75, v52, v56
 s_waitcnt vmcnt(11)
 v_dot2c_f32_bf16 v76, v40, v60
 v_dot2c_f32_bf16 v77, v44, v60
 v_dot2c_f32_bf16 v78, v48, v60
 v_dot2c_f32_bf16 v79, v52, v60
 v_dot2c_f32_bf16 v72, v41, v57
 v_dot2c_f32_bf16 v73, v45, v57
 v_dot2c_f32_bf16 v74, v49, v57
 v_dot2c_f32_bf16 v75, v53, v57
 v_dot2c_f32_bf16 v76, v41, v61
 v_dot2c_f32_bf16 v77, v45, v61
 v_dot2c_f32_bf16 v78, v49, v61
 v_dot2c_f32_bf16 v79, v53, v61
 v_dot2c_f32_bf16 v72, v42, v58
 v_dot2c_f32_bf16 v73, v46, v58
 v_dot2c_f32_bf16 v74, v50, v58
 v_dot2c_f32_bf16 v75, v54, v58
 v_dot2c_f32_bf16 v76, v42, v62
 v_dot2c_f32_bf16 v77, v46, v62
 v_dot2c_f32_bf16 v78, v50, v62
 v_dot2c_f32_bf16 v79, v54, v62
 v_dot2c_f32_bf16 v72, v43, v59
 v_dot2c_f32_bf16 v73, v47, v59
 v_dot2c_f32_bf16 v74, v51, v59
 v_dot2c_f32_bf16 v75, v55, v59
 v_dot2c_f32_bf16 v76, v43, v63
 v_dot2c_f32_bf16 v77, v47, v63
 v_dot2c_f32_bf16 v78, v51, v63
 v_dot2c_f32_bf16 v79, v55, v63
 v_permlane32_swap_b32 v72, v74
 v_permlane32_swap_b32 v73, v75
 v_permlane32_swap_b32 v76, v78
 v_permlane32_swap_b32 v77, v79
 v_add_f32 v72, v72, v74
 v_add_f32 v73, v73, v75
 v_add_f32 v76, v76, v78
 v_add_f32 v77, v77, v79
 v_lshrrev_b32 v80, 4, v0
 v_permlane16_swap_b32 v72, v73
 v_permlane16_swap_b32 v76, v77
 v_add_f32 v72, v72, v73
 v_add_f32 v76, v76, v77
 v_add_u32 v81, s67, v80
 v_add_f32 v72, v72, v72 row_ror:8 row_mask:0xf bank_mask:0xf
 v_add_f32 v76, v76, v76 row_ror:8 row_mask:0xf bank_mask:0xf
 s_nop 0
 v_add_f32 v72, v72, v72 row_ror:4 row_mask:0xf bank_mask:0xf
 v_add_f32 v76, v76, v76 row_ror:4 row_mask:0xf bank_mask:0xf
 s_nop 0
 v_add_f32 v72, v72, v72 row_ror:2 row_mask:0xf bank_mask:0xf
 v_add_f32 v76, v76, v76 row_ror:2 row_mask:0xf bank_mask:0xf
 s_nop 0
 v_add_f32 v72, v72, v72 row_ror:1 row_mask:0xf bank_mask:0xf
 v_add_f32 v76, v76, v76 row_ror:1 row_mask:0xf bank_mask:0xf
 v_ashrrev_i32 v82, 31, v72
 v_or_b32 v82, 0x80000000, v82
 v_xor_b32 v82, v82, v72
 v_and_b32 v82, 0xfffff800, v82
 v_sub_u32 v81, 2047, v81
 v_or_b32 v82, v82, v81
 v_max_u32 v82, 1, v82
 v_mul_f32 v77, 0xbfb8aa3b, v76
 v_exp_f32 v77, v77
 s_nop 0
 v_add_f32 v77, 1.0, v77
 v_rcp_f32 v76, v77
 s_lshl_b32 s72, s20, 4
 s_add_u32 s72, s72, 163584
 v_lshl_add_u32 v80, v80, 2, s72
 ds_write_b32 v80, v82
 ds_write_b32 v80, v72 offset:64
 ds_write_b32 v80, v76 offset:128
 s_waitcnt lgkmcnt(15)
M a[0:3], a[160:163], a[32:35], 0
M a[0:3], a[164:167], a[36:39], a[0:3]
M a[4:7], a[164:167], a[44:47], 0
M a[4:7], a[160:163], a[40:43], a[4:7]
 s_waitcnt lgkmcnt(11)
M a[8:11], a[160:163], a[48:51], 0
M a[8:11], a[164:167], a[52:55], a[8:11]
 s_waitcnt lgkmcnt(7)
M a[12:15], a[164:167], a[60:63], 0
 s_add_u32 m0, s23, 49152
M a[12:15], a[160:163], a[56:59], a[12:15]
 buffer_load_dwordx4 v8, s[16:19], s21 offen offset:0  nt lds
M v[32:35], a[168:171], a[32:35], 0
 buffer_load_dwordx4 v9, s[16:19], s21 offen offset:1024  nt lds
M v[32:35], a[172:175], a[36:39], v[32:35]
M v[36:39], a[172:175], a[44:47], 0
 buffer_load_dwordx4 v10, s[16:19], s21 offen offset:2048  nt lds
M v[36:39], a[168:171], a[40:43], v[36:39]
M v[40:43], a[168:171], a[48:51], 0
 buffer_load_dwordx4 v11, s[16:19], s21 offen offset:3072  nt lds
M v[40:43], a[172:175], a[52:55], v[40:43]
 s_add_u32 s21, s21, 524160
M v[44:47], a[172:175], a[60:63], 0
 s_waitcnt lgkmcnt(0)
M v[44:47], a[168:171], a[56:59], v[44:47]
 s_barrier
M v[64:67], a[176:179], a[32:35], 0
 s_add_u32 m0, s24, 32768
 ds_read_b64_tr_b16 a[64:65], v1 offset:16384
 ds_read_b64_tr_b16 a[66:67], v1 offset:17408
M v[64:67], a[180:183], a[36:39], v[64:67]
 ds_read_b64_tr_b16 a[68:69], v1 offset:24576
 ds_read_b64_tr_b16 a[70:71], v1 offset:25600
M v[68:71], a[180:183], a[44:47], 0
 buffer_load_dwordx4 v12, s[48:51], s22 offen offset:0   lds
M v[68:71], a[176:179], a[40:43], v[68:71]
 ds_read_b64_tr_b16 a[72:73], v2 offset:16384
 ds_read_b64_tr_b16 a[74:75], v2 offset:17408
M v[72:75], a[176:179], a[48:51], 0
 ds_read_b64_tr_b16 a[76:77], v2 offset:24576
 ds_read_b64_tr_b16 a[78:79], v2 offset:25600
M v[72:75], a[180:183], a[52:55], v[72:75]
 buffer_load_dwordx4 v13, s[48:51], s22 offen offset:1024   lds
M v[76:79], a[180:183], a[60:63], 0
 ds_read_b64_tr_b16 a[80:81], v3 offset:16384
 ds_read_b64_tr_b16 a[82:83], v3 offset:17408
M v[76:79], a[176:179], a[56:59], v[76:79]
 ds_read_b64_tr_b16 a[84:85], v3 offset:24576
 ds_read_b64_tr_b16 a[86:87], v3 offset:25600
M v[96:99], a[184:187], a[32:35], 0
 buffer_load_dwordx4 v14, s[48:51], s22 offen offset:2048   lds
M v[96:99], a[188:191], a[36:39], v[96:99]
 ds_read_b64_tr_b16 a[88:89], v4 offset:16384
 ds_read_b64_tr_b16 a[90:91], v4 offset:17408
M v[100:103], a[188:191], a[44:47], 0
 ds_read_b64_tr_b16 a[92:93], v4 offset:24576
 ds_read_b64_tr_b16 a[94:95], v4 offset:25600
M v[100:103], a[184:187], a[40:43], v[100:103]
 buffer_load_dwordx4 v15, s[48:51], s22 offen offset:3072   lds
M v[104:107], a[184:187], a[48:51], 0
 s_add_u32 s22, s22, 2097152
 v_max3_f32 v20, |v32|, |v33|, |v34|
 v_max3_f32 v20, |v35|, |v36|, v20
M v[104:107], a[188:191], a[52:55], v[104:107]
 v_max3_f32 v20, |v37|, |v38|, v20
 v_max3_f32 v21, |v64|, |v65|, |v66|
M v[108:111], a[188:191], a[60:63], 0
 s_add_u32 m0, s23, 0
 v_max3_f32 v21, |v67|, |v68|, v21
 v_max3_f32 v21, |v69|, |v70|, v21
M v[108:111], a[184:187], a[56:59], v[108:111]
 s_waitcnt lgkmcnt(0)
 v_min_f32 v20, v20, v21
 v_mul_f32 v20, 0x41000000, v20
M a[16:19], a[160:163], a[64:67], 0
 buffer_load_dwordx4 v8, s[16:19], s21 offen offset:0  nt lds
M a[16:19], a[164:167], a[68:71], a[16:19]
 v_mov_b32 v21, v20
 v_mov_b32 v22, v20
M a[20:23], a[164:167], a[76:79], 0
 buffer_load_dwordx4 v9, s[16:19], s21 offen offset:1024  nt lds
M a[20:23], a[160:163], a[72:75], a[20:23]
 v_mov_b32 v23, v20
 v_accvgpr_write_b32 a241, v20
M a[24:27], a[160:163], a[80:83], 0
M a[24:27], a[164:167], a[84:87], a[24:27]
M a[28:31], a[164:167], a[92:95], 0
 buffer_load_dwordx4 v10, s[16:19], s21 offen offset:2048  nt lds
M a[28:31], a[160:163], a[88:91], a[28:31]
M v[48:51], a[168:171], a[64:67], v[20:23]
M v[48:51], a[172:175], a[68:71], v[48:51]
 buffer_load_dwordx4 v11, s[16:19], s21 offen offset:3072  nt lds
M v[52:55], a[172:175], a[76:79], v[20:23]
 s_add_u32 s21, s21, 128
M v[52:55], a[168:171], a[72:75], v[52:55]
M v[56:59], a[168:171], a[80:83], v[20:23]
M v[56:59], a[172:175], a[84:87], v[56:59]
M v[60:63], a[172:175], a[92:95], v[20:23]
 s_waitcnt vmcnt(12)
M v[60:63], a[168:171], a[88:91], v[60:63]
 s_barrier
M v[80:83], a[176:179], a[64:67], v[20:23]
 s_add_u32 m0, s24, 49152
 ds_read_b128 a[160:163], v5 offset:16384
 ds_read_b128 a[164:167], v6 offset:16384
M v[80:83], a[180:183], a[68:71], v[80:83]
 buffer_load_dwordx4 v12, s[48:51], s22 offen offset:0   lds
M v[84:87], a[180:183], a[76:79], v[20:23]
 ds_read_b64_tr_b16 a[96:97], v1 offset:32768
 ds_read_b64_tr_b16 a[98:99], v1 offset:33792
M v[84:87], a[176:179], a[72:75], v[84:87]
M v[88:91], a[176:179], a[80:83], v[20:23]
 buffer_load_dwordx4 v13, s[48:51], s22 offen offset:1024   lds
M v[88:91], a[180:183], a[84:87], v[88:91]
 ds_read_b64_tr_b16 a[100:101], v1 offset:40960
 ds_read_b64_tr_b16 a[102:103], v1 offset:41984
M v[92:95], a[180:183], a[92:95], v[20:23]
M v[92:95], a[176:179], a[88:91], v[92:95]
M v[112:115], a[184:187], a[64:67], v[20:23]
 ds_read_b64_tr_b16 a[104:105], v2 offset:32768
 ds_read_b64_tr_b16 a[106:107], v2 offset:33792
M v[112:115], a[188:191], a[68:71], v[112:115]
 buffer_load_dwordx4 v14, s[48:51], s22 offen offset:2048   lds
M v[116:119], a[188:191], a[76:79], v[20:23]
M v[116:119], a[184:187], a[72:75], v[116:119]
 ds_read_b64_tr_b16 a[108:109], v2 offset:40960
 ds_read_b64_tr_b16 a[110:111], v2 offset:41984
M v[120:123], a[184:187], a[80:83], v[20:23]
 buffer_load_dwordx4 v15, s[48:51], s22 offen offset:3072   lds
M v[120:123], a[188:191], a[84:87], v[120:123]
 s_waitcnt lgkmcnt(8)
M v[124:127], a[188:191], a[92:95], v[20:23]
 s_sub_u32 s22, s22, 2097024
M v[124:127], a[184:187], a[88:91], v[124:127]
 s_add_u32 m0, s23, 16384
 ds_read_b64_tr_b16 a[112:113], v3 offset:32768
 ds_read_b64_tr_b16 a[114:115], v3 offset:33792
M v[128:131], a[160:163], a[32:35], v[20:23]
 ds_read_b128 a[168:171], v5 offset:18432
 ds_read_b128 a[172:175], v6 offset:18432
M v[128:131], a[164:167], a[36:39], v[128:131]
 buffer_load_dwordx4 v8, s[16:19], s21 offen offset:0  nt lds
M v[132:135], a[164:167], a[44:47], v[20:23]
 ds_read_b64_tr_b16 a[116:117], v3 offset:40960
 ds_read_b64_tr_b16 a[118:119], v3 offset:41984
M v[132:135], a[160:163], a[40:43], v[132:135]
 buffer_load_dwordx4 v9, s[16:19], s21 offen offset:1024  nt lds
M v[136:139], a[160:163], a[48:51], v[20:23]
M v[136:139], a[164:167], a[52:55], v[136:139]
 ds_read_b64_tr_b16 a[120:121], v4 offset:32768
 ds_read_b64_tr_b16 a[122:123], v4 offset:33792
M v[140:143], a[164:167], a[60:63], v[20:23]
 buffer_load_dwordx4 v10, s[16:19], s21 offen offset:2048  nt lds
M v[140:143], a[160:163], a[56:59], v[140:143]
M v[144:147], a[160:163], a[64:67], v[20:23]
 ds_read_b64_tr_b16 a[124:125], v4 offset:40960
 ds_read_b64_tr_b16 a[126:127], v4 offset:41984
M v[144:147], a[164:167], a[68:71], v[144:147]
 buffer_load_dwordx4 v11, s[16:19], s21 offen offset:3072  nt lds
M v[148:151], a[164:167], a[76:79], v[20:23]
 s_add_u32 s21, s21, 524160
M v[148:151], a[160:163], a[72:75], v[148:151]
M v[152:155], a[160:163], a[80:83], v[20:23]
M v[152:155], a[164:167], a[84:87], v[152:155]
 s_waitcnt lgkmcnt(6)
M v[156:159], a[164:167], a[92:95], v[20:23]
 s_waitcnt vmcnt(16) lgkmcnt(0)
M v[156:159], a[160:163], a[88:91], v[156:159]
 s_barrier
M v[160:163], a[168:171], a[32:35], v[20:23]
 s_add_u32 m0, s24, 0
 ds_read_b128 a[160:163], v5 offset:20480
 ds_read_b128 a[164:167], v6 offset:20480
M v[160:163], a[172:175], a[36:39], v[160:163]
 buffer_load_dwordx4 v12, s[48:51], s22 offen offset:0   lds
M v[164:167], a[172:175], a[44:47], v[20:23]
 ds_read_b64_tr_b16 a[128:129], v1 offset:49152
 ds_read_b64_tr_b16 a[130:131], v1 offset:50176
M v[164:167], a[168:171], a[40:43], v[164:167]
M v[168:171], a[168:171], a[48:51], v[20:23]
 buffer_load_dwordx4 v13, s[48:51], s22 offen offset:1024   lds
M v[168:171], a[172:175], a[52:55], v[168:171]
 ds_read_b64_tr_b16 a[132:133], v1 offset:57344
 ds_read_b64_tr_b16 a[134:135], v1 offset:58368
M v[172:175], a[172:175], a[60:63], v[20:23]
M v[172:175], a[168:171], a[56:59], v[172:175]
M v[176:179], a[168:171], a[64:67], v[20:23]
 ds_read_b64_tr_b16 a[136:137], v2 offset:49152
 ds_read_b64_tr_b16 a[138:139], v2 offset:50176
M v[176:179], a[172:175], a[68:71], v[176:179]
 buffer_load_dwordx4 v14, s[48:51], s22 offen offset:2048   lds
M v[180:183], a[172:175], a[76:79], v[20:23]
M v[180:183], a[168:171], a[72:75], v[180:183]
 ds_read_b64_tr_b16 a[140:141], v2 offset:57344
 ds_read_b64_tr_b16 a[142:143], v2 offset:58368
M v[184:187], a[168:171], a[80:83], v[20:23]
 buffer_load_dwordx4 v15, s[48:51], s22 offen offset:3072   lds
M v[184:187], a[172:175], a[84:87], v[184:187]
 s_waitcnt lgkmcnt(8)
M v[188:191], a[172:175], a[92:95], v[20:23]
 s_add_u32 s22, s22, 2097152
M v[188:191], a[168:171], a[88:91], v[188:191]
 s_add_u32 m0, s23, 32768
 ds_read_b64_tr_b16 a[144:145], v3 offset:49152
 ds_read_b64_tr_b16 a[146:147], v3 offset:50176
M v[192:195], a[160:163], a[32:35], v[20:23]
 ds_read_b128 a[168:171], v5 offset:22528
 ds_read_b128 a[172:175], v6 offset:22528
M v[192:195], a[164:167], a[36:39], v[192:195]
 buffer_load_dwordx4 v8, s[16:19], s21 offen offset:0  nt lds
M v[196:199], a[164:167], a[44:47], v[20:23]
 ds_read_b64_tr_b16 a[148:149], v3 offset:57344
 ds_read_b64_tr_b16 a[150:151], v3 offset:58368
M v[196:199], a[160:163], a[40:43], v[196:199]
 buffer_load_dwordx4 v9, s[16:19], s21 offen offset:1024  nt lds
M v[200:203], a[160:163], a[48:51], v[20:23]
M v[200:203], a[164:167], a[52:55], v[200:203]
 ds_read_b64_tr_b16 a[152:153], v4 offset:49152
 ds_read_b64_tr_b16 a[154:155], v4 offset:50176
M v[204:207], a[164:167], a[60:63], v[20:23]
 buffer_load_dwordx4 v10, s[16:19], s21 offen offset:2048  nt lds
M v[204:207], a[160:163], a[56:59], v[204:207]
M v[208:211], a[160:163], a[64:67], v[20:23]
 ds_read_b64_tr_b16 a[156:157], v4 offset:57344
 ds_read_b64_tr_b16 a[158:159], v4 offset:58368
M v[208:211], a[164:167], a[68:71], v[208:211]
 buffer_load_dwordx4 v11, s[16:19], s21 offen offset:3072  nt lds
M v[212:215], a[164:167], a[76:79], v[20:23]
 s_add_u32 s21, s21, 128
M v[212:215], a[160:163], a[72:75], v[212:215]
M v[216:219], a[160:163], a[80:83], v[20:23]
M v[216:219], a[164:167], a[84:87], v[216:219]
 s_waitcnt lgkmcnt(6)
M v[220:223], a[164:167], a[92:95], v[20:23]
 s_waitcnt vmcnt(16) lgkmcnt(0)
M v[220:223], a[160:163], a[88:91], v[220:223]
 s_barrier
M v[224:227], a[168:171], a[32:35], v[20:23]
 ds_read_b128 a[160:163], v5 offset:32768
 ds_read_b128 a[164:167], v6 offset:32768
M v[224:227], a[172:175], a[36:39], v[224:227]
 buffer_load_dword a240, v24, s[32:35], 0 offen offset:512
M v[228:231], a[172:175], a[44:47], v[20:23]
M v[228:231], a[168:171], a[40:43], v[228:231]
M v[232:235], a[168:171], a[48:51], v[20:23]
M v[232:235], a[172:175], a[52:55], v[232:235]
M v[236:239], a[172:175], a[60:63], v[20:23]
M v[236:239], a[168:171], a[56:59], v[236:239]
M v[240:243], a[168:171], a[64:67], v[20:23]
M v[240:243], a[172:175], a[68:71], v[240:243]
M v[244:247], a[172:175], a[76:79], v[20:23]
M v[244:247], a[168:171], a[72:75], v[244:247]
M v[248:251], a[168:171], a[80:83], v[20:23]
M v[248:251], a[172:175], a[84:87], v[248:251]
 s_waitcnt lgkmcnt(0)
M v[252:255], a[172:175], a[92:95], v[20:23]
M v[252:255], a[168:171], a[88:91], v[252:255]
M a[0:3], a[160:163], a[96:99], a[0:3]
 ds_read_b128 a[168:171], v5 offset:34816
 ds_read_b128 a[172:175], v6 offset:34816
M a[0:3], a[164:167], a[100:103], a[0:3]
 ds_read_b64_tr_b16 a[32:33], v1 offset:0
 ds_read_b64_tr_b16 a[34:35], v1 offset:1024
M a[4:7], a[164:167], a[108:111], a[4:7]
 s_add_u32 m0, s24, 16384
M a[4:7], a[160:163], a[104:107], a[4:7]
 buffer_load_dwordx4 v12, s[48:51], s22 offen offset:0   lds
M a[8:11], a[160:163], a[112:115], a[8:11]
M a[8:11], a[164:167], a[116:119], a[8:11]
M a[12:15], a[164:167], a[124:127], a[12:15]
 ds_read_b64_tr_b16 a[36:37], v1 offset:8192
 ds_read_b64_tr_b16 a[38:39], v1 offset:9216
M a[12:15], a[160:163], a[120:123], a[12:15]
M a[16:19], a[160:163], a[128:131], a[16:19]
 buffer_load_dwordx4 v13, s[48:51], s22 offen offset:1024   lds
M a[16:19], a[164:167], a[132:135], a[16:19]
M a[20:23], a[164:167], a[140:143], a[20:23]
M a[20:23], a[160:163], a[136:139], a[20:23]
 ds_read_b64_tr_b16 a[40:41], v2 offset:0
 ds_read_b64_tr_b16 a[42:43], v2 offset:1024
M a[24:27], a[160:163], a[144:147], a[24:27]
M a[24:27], a[164:167], a[148:151], a[24:27]
 s_waitcnt lgkmcnt(6)
M a[28:31], a[164:167], a[156:159], a[28:31]
 buffer_load_dwordx4 v14, s[48:51], s22 offen offset:2048   lds
M a[28:31], a[160:163], a[152:155], a[28:31]
M v[32:35], a[168:171], a[96:99], v[32:35]
 ds_read_b128 a[160:163], v5 offset:36864
 ds_read_b128 a[164:167], v6 offset:36864
M v[32:35], a[172:175], a[100:103], v[32:35]
 ds_read_b64_tr_b16 a[44:45], v2 offset:8192
 ds_read_b64_tr_b16 a[46:47], v2 offset:9216
M v[36:39], a[172:175], a[108:111], v[36:39]
 buffer_load_dwordx4 v15, s[48:51], s22 offen offset:3072   lds
M v[36:39], a[168:171], a[104:107], v[36:39]
 s_sub_u32 s22, s22, 2097024
M v[40:43], a[168:171], a[112:115], v[40:43]
M v[40:43], a[172:175], a[116:119], v[40:43]
 ds_read_b64_tr_b16 a[48:49], v3 offset:0
 ds_read_b64_tr_b16 a[50:51], v3 offset:1024
M v[44:47], a[172:175], a[124:127], v[44:47]
 s_add_u32 m0, s23, 49152
M v[44:47], a[168:171], a[120:123], v[44:47]
 buffer_load_dwordx4 v8, s[16:19], s21 offen offset:0  nt lds
M v[48:51], a[168:171], a[128:131], v[48:51]
M v[48:51], a[172:175], a[132:135], v[48:51]
M v[52:55], a[172:175], a[140:143], v[52:55]
 ds_read_b64_tr_b16 a[52:53], v3 offset:8192
 ds_read_b64_tr_b16 a[54:55], v3 offset:9216
M v[52:55], a[168:171], a[136:139], v[52:55]
M v[56:59], a[168:171], a[144:147], v[56:59]
 buffer_load_dwordx4 v9, s[16:19], s21 offen offset:1024  nt lds
M v[56:59], a[172:175], a[148:151], v[56:59]
 s_waitcnt lgkmcnt(6)
M v[60:63], a[172:175], a[156:159], v[60:63]
M v[60:63], a[168:171], a[152:155], v[60:63]
 ds_read_b64_tr_b16 a[56:57], v4 offset:0
 ds_read_b64_tr_b16 a[58:59], v4 offset:1024
M v[64:67], a[160:163], a[96:99], v[64:67]
 ds_read_b128 a[168:171], v5 offset:38912
 ds_read_b128 a[172:175], v6 offset:38912
M v[64:67], a[164:167], a[100:103], v[64:67]
 buffer_load_dwordx4 v10, s[16:19], s21 offen offset:2048  nt lds
M v[68:71], a[164:167], a[108:111], v[68:71]
M v[68:71], a[160:163], a[104:107], v[68:71]
M v[72:75], a[160:163], a[112:115], v[72:75]
 ds_read_b64_tr_b16 a[60:61], v4 offset:8192
 ds_read_b64_tr_b16 a[62:63], v4 offset:9216
M v[72:75], a[164:167], a[116:119], v[72:75]
M v[76:79], a[164:167], a[124:127], v[76:79]
 buffer_load_dwordx4 v11, s[16:19], s21 offen offset:3072  nt lds
M v[76:79], a[160:163], a[120:123], v[76:79]
 s_add_u32 s21, s21, 524160
M v[80:83], a[160:163], a[128:131], v[80:83]
M v[80:83], a[164:167], a[132:135], v[80:83]
M v[84:87], a[164:167], a[140:143], v[84:87]
M v[84:87], a[160:163], a[136:139], v[84:87]
M v[88:91], a[160:163], a[144:147], v[88:91]
M v[88:91], a[164:167], a[148:151], v[88:91]
 s_waitcnt lgkmcnt(2)
M v[92:95], a[164:167], a[156:159], v[92:95]
 s_waitcnt vmcnt(17) lgkmcnt(0)
M v[92:95], a[160:163], a[152:155], v[92:95]
 s_barrier
M v[96:99], a[168:171], a[96:99], v[96:99]
 ds_read_b128 a[160:163], v5 offset:49152
 ds_read_b128 a[164:167], v6 offset:49152
M v[96:99], a[172:175], a[100:103], v[96:99]
M v[100:103], a[172:175], a[108:111], v[100:103]
 s_add_u32 m0, s24, 32768
 ds_read_b64_tr_b16 a[64:65], v1 offset:16384
 ds_read_b64_tr_b16 a[66:67], v1 offset:17408
M v[100:103], a[168:171], a[104:107], v[100:103]
 buffer_load_dwordx4 v12, s[48:51], s22 offen offset:0   lds
M v[104:107], a[168:171], a[112:115], v[104:107]
M v[104:107], a[172:175], a[116:119], v[104:107]
M v[108:111], a[172:175], a[124:127], v[108:111]
M v[108:111], a[168:171], a[120:123], v[108:111]
M v[112:115], a[168:171], a[128:131], v[112:115]
M v[112:115], a[172:175], a[132:135], v[112:115]
 ds_read_b64_tr_b16 a[68:69], v1 offset:24576
 ds_read_b64_tr_b16 a[70:71], v1 offset:25600
M v[116:119], a[172:175], a[140:143], v[116:119]
 buffer_load_dwordx4 v13, s[48:51], s22 offen offset:1024   lds
M v[116:119], a[168:171], a[136:139], v[116:119]
M v[120:123], a[168:171], a[144:147], v[120:123]
M v[120:123], a[172:175], a[148:151], v[120:123]
 s_waitcnt lgkmcnt(4)
M v[124:127], a[172:175], a[156:159], v[124:127]
M v[124:127], a[168:171], a[152:155], v[124:127]
M v[128:131], a[160:163], a[96:99], v[128:131]
 ds_read_b128 a[168:171], v5 offset:51200
 ds_read_b128 a[172:175], v6 offset:51200
M v[128:131], a[164:167], a[100:103], v[128:131]
 ds_read_b64_tr_b16 a[72:73], v2 offset:16384
 ds_read_b64_tr_b16 a[74:75], v2 offset:17408
M v[132:135], a[164:167], a[108:111], v[132:135]
 buffer_load_dwordx4 v14, s[48:51], s22 offen offset:2048   lds
M v[132:135], a[160:163], a[104:107], v[132:135]
M v[136:139], a[160:163], a[112:115], v[136:139]
M v[136:139], a[164:167], a[116:119], v[136:139]
M v[140:143], a[164:167], a[124:127], v[140:143]
M v[140:143], a[160:163], a[120:123], v[140:143]
 ds_read_b64_tr_b16 a[76:77], v2 offset:24576
 ds_read_b64_tr_b16 a[78:79], v2 offset:25600
M v[144:147], a[160:163], a[128:131], v[144:147]
 buffer_load_dwordx4 v15, s[48:51], s22 offen offset:3072   lds
M v[144:147], a[164:167], a[132:135], v[144:147]
 s_add_u32 s22, s22, 2097152
M v[148:151], a[164:167], a[140:143], v[148:151]
M v[148:151], a[160:163], a[136:139], v[148:151]
M v[152:155], a[160:163], a[144:147], v[152:155]
M v[152:155], a[164:167], a[148:151], v[152:155]
 s_waitcnt lgkmcnt(4)
M v[156:159], a[164:167], a[156:159], v[156:159]
 s_add_u32 m0, s23, 0
 ds_read_b64_tr_b16 a[80:81], v3 offset:16384
 ds_read_b64_tr_b16 a[82:83], v3 offset:17408
M v[156:159], a[160:163], a[152:155], v[156:159]
 buffer_load_dwordx4 v8, s[16:19], s21 offen offset:0  nt lds
M v[160:163], a[168:171], a[96:99], v[160:163]
 ds_read_b128 a[160:163], v5 offset:53248
 ds_read_b128 a[164:167], v6 offset:53248
M v[160:163], a[172:175], a[100:103], v[160:163]
M v[164:167], a[172:175], a[108:111], v[164:167]
M v[164:167], a[168:171], a[104:107], v[164:167]
M v[168:171], a[168:171], a[112:115], v[168:171]
M v[168:171], a[172:175], a[116:119], v[168:171]
 ds_read_b64_tr_b16 a[84:85], v3 offset:24576
 ds_read_b64_tr_b16 a[86:87], v3 offset:25600
M v[172:175], a[172:175], a[124:127], v[172:175]
 buffer_load_dwordx4 v9, s[16:19], s21 offen offset:1024  nt lds
M v[172:175], a[168:171], a[120:123], v[172:175]
M v[176:179], a[168:171], a[128:131], v[176:179]
M v[176:179], a[172:175], a[132:135], v[176:179]
M v[180:183], a[172:175], a[140:143], v[180:183]
M v[180:183], a[168:171], a[136:139], v[180:183]
M v[184:187], a[168:171], a[144:147], v[184:187]
 ds_read_b64_tr_b16 a[88:89], v4 offset:16384
 ds_read_b64_tr_b16 a[90:91], v4 offset:17408
M v[184:187], a[172:175], a[148:151], v[184:187]
 s_waitcnt lgkmcnt(4)
M v[188:191], a[172:175], a[156:159], v[188:191]
 buffer_load_dwordx4 v10, s[16:19], s21 offen offset:2048  nt lds
M v[188:191], a[168:171], a[152:155], v[188:191]
M v[192:195], a[160:163], a[96:99], v[192:195]
 ds_read_b128 a[168:171], v5 offset:55296
 ds_read_b128 a[172:175], v6 offset:55296
M v[192:195], a[164:167], a[100:103], v[192:195]
M v[196:199], a[164:167], a[108:111], v[196:199]
M v[196:199], a[160:163], a[104:107], v[196:199]
 ds_read_b64_tr_b16 a[92:93], v4 offset:24576
 ds_read_b64_tr_b16 a[94:95], v4 offset:25600
M v[200:203], a[160:163], a[112:115], v[200:203]
 buffer_load_dwordx4 v11, s[16:19], s21 offen offset:3072  nt lds
M v[200:203], a[164:167], a[116:119], v[200:203]
 s_add_u32 s21, s21, 128
M v[204:207], a[164:167], a[124:127], v[204:207]
M v[204:207], a[160:163], a[120:123], v[204:207]
M v[208:211], a[160:163], a[128:131], v[208:211]
M v[208:211], a[164:167], a[132:135], v[208:211]
M v[212:215], a[164:167], a[140:143], v[212:215]
M v[212:215], a[160:163], a[136:139], v[212:215]
M v[216:219], a[160:163], a[144:147], v[216:219]
M v[216:219], a[164:167], a[148:151], v[216:219]
 s_waitcnt lgkmcnt(2)
M v[220:223], a[164:167], a[156:159], v[220:223]
 s_waitcnt vmcnt(17) lgkmcnt(0)
M v[220:223], a[160:163], a[152:155], v[220:223]
 s_barrier
M v[224:227], a[168:171], a[96:99], v[224:227]
 ds_read_b128 a[160:163], v5 offset:0
 ds_read_b128 a[164:167], v6 offset:0
M v[224:227], a[172:175], a[100:103], v[224:227]
 v_min_u32 v16, 1, v0
 v_lshlrev_b32 v16, 29, v16
M v[228:231], a[172:175], a[108:111], v[228:231]
 v_or_b32 v16, s39, v16
 v_mov_b32 v17, 1
M v[228:231], a[168:171], a[104:107], v[228:231]
M v[232:235], a[168:171], a[112:115], v[232:235]
 buffer_store_dword v17, v16, s[12:15], s38 offen offset:64 sc1
M v[232:235], a[172:175], a[116:119], v[232:235]
M v[236:239], a[172:175], a[124:127], v[236:239]
M v[236:239], a[168:171], a[120:123], v[236:239]
M v[240:243], a[168:171], a[128:131], v[240:243]
M v[240:243], a[172:175], a[132:135], v[240:243]
M v[244:247], a[172:175], a[140:143], v[244:247]
M v[244:247], a[168:171], a[136:139], v[244:247]
M v[248:251], a[168:171], a[144:147], v[248:251]
M v[248:251], a[172:175], a[148:151], v[248:251]
 s_waitcnt lgkmcnt(0)
M v[252:255], a[172:175], a[156:159], v[252:255]
M v[252:255], a[168:171], a[152:155], v[252:255]
M a[0:3], a[160:163], a[32:35], a[0:3]
 ds_read_b128 a[168:171], v5 offset:2048
 ds_read_b128 a[172:175], v6 offset:2048
M a[0:3], a[164:167], a[36:39], a[0:3]
 ds_read_b64_tr_b16 a[96:97], v1 offset:32768
 ds_read_b64_tr_b16 a[98:99], v1 offset:33792
M a[4:7], a[164:167], a[44:47], a[4:7]
 s_add_u32 m0, s24, 49152
M a[4:7], a[160:163], a[40:43], a[4:7]
 buffer_load_dwordx4 v12, s[48:51], s22 offen offset:0   lds
M a[8:11], a[160:163], a[48:51], a[8:11]
 v_and_b32 v20, 31, v0
M a[8:11], a[164:167], a[52:55], a[8:11]
 v_lshlrev_b32 v20, 2, v20
M a[12:15], a[164:167], a[60:63], a[12:15]
 ds_read_b64_tr_b16 a[100:101], v1 offset:40960
 ds_read_b64_tr_b16 a[102:103], v1 offset:41984
M a[12:15], a[160:163], a[56:59], a[12:15]
 v_add_u32 v21, 163584, v20
M a[16:19], a[160:163], a[64:67], a[16:19]
 buffer_load_dwordx4 v13, s[48:51], s22 offen offset:1024   lds
M a[16:19], a[164:167], a[68:71], a[16:19]
 ds_read_b32 v19, v21
M a[20:23], a[164:167], a[76:79], a[20:23]
 ds_read_b32 v21, v21 offset:64
M a[20:23], a[160:163], a[72:75], a[20:23]
 s_min_u32 s64, s20, 1
 ds_read_b64_tr_b16 a[104:105], v2 offset:32768
 ds_read_b64_tr_b16 a[106:107], v2 offset:33792
M a[24:27], a[160:163], a[80:83], a[24:27]
 s_lshl_b32 s64, s64, 29
 v_and_b32 v22, 32, v0
M a[24:27], a[164:167], a[84:87], a[24:27]
 s_waitcnt lgkmcnt(8)
 v_lshl_or_b32 v20, v22, 24, v20
M a[28:31], a[164:167], a[92:95], a[28:31]
 buffer_load_dwordx4 v14, s[48:51], s22 offen offset:2048   lds
M a[28:31], a[160:163], a[88:91], a[28:31]
 v_or_b32 v20, s64, v20
M v[32:35], a[168:171], a[32:35], v[32:35]
 ds_read_b128 a[160:163], v5 offset:4096
 ds_read_b128 a[164:167], v6 offset:4096
M v[32:35], a[172:175], a[36:39], v[32:35]
 ds_read_b64_tr_b16 a[108:109], v2 offset:40960
 ds_read_b64_tr_b16 a[110:111], v2 offset:41984
M v[36:39], a[172:175], a[44:47], v[36:39]
 buffer_load_dwordx4 v15, s[48:51], s22 offen offset:3072   lds
M v[36:39], a[168:171], a[40:43], v[36:39]
 s_sub_u32 s22, s22, 2097024
 v_and_b32 v22, 16, v0
M v[40:43], a[168:171], a[48:51], v[40:43]
 v_lshl_or_b32 v18, v22, 25, v20
M v[40:43], a[172:175], a[52:55], v[40:43]
 s_lshl_b32 s72, s30, 7
 ds_read_b64_tr_b16 a[112:113], v3 offset:32768
 ds_read_b64_tr_b16 a[114:115], v3 offset:33792
M v[44:47], a[172:175], a[60:63], v[44:47]
 s_add_u32 m0, s23, 16384
 s_add_u32 s72, s72, 104857600
M v[44:47], a[168:171], a[56:59], v[44:47]
 buffer_load_dwordx4 v8, s[16:19], s21 offen offset:0  nt lds
M v[48:51], a[168:171], a[64:67], v[48:51]
M v[48:51], a[172:175], a[68:71], v[48:51]
M v[52:55], a[172:175], a[76:79], v[52:55]
 ds_read_b64_tr_b16 a[116:117], v3 offset:40960
 ds_read_b64_tr_b16 a[118:119], v3 offset:41984
M v[52:55], a[168:171], a[72:75], v[52:55]
M v[56:59], a[168:171], a[80:83], v[56:59]
 buffer_load_dwordx4 v9, s[16:19], s21 offen offset:1024  nt lds
M v[56:59], a[172:175], a[84:87], v[56:59]
 s_waitcnt lgkmcnt(6)
M v[60:63], a[172:175], a[92:95], v[60:63]
 buffer_store_dword v21, v20, s[8:11], s72 offen sc1
M v[60:63], a[168:171], a[88:91], v[60:63]
 ds_read_b64_tr_b16 a[120:121], v4 offset:32768
 ds_read_b64_tr_b16 a[122:123], v4 offset:33792
M v[64:67], a[160:163], a[32:35], v[64:67]
 ds_read_b128 a[168:171], v5 offset:6144
 ds_read_b128 a[172:175], v6 offset:6144
M v[64:67], a[164:167], a[36:39], v[64:67]
 buffer_load_dwordx4 v10, s[16:19], s21 offen offset:2048  nt lds
M v[68:71], a[164:167], a[44:47], v[68:71]
M v[68:71], a[160:163], a[40:43], v[68:71]
M v[72:75], a[160:163], a[48:51], v[72:75]
 ds_read_b64_tr_b16 a[124:125], v4 offset:40960
 ds_read_b64_tr_b16 a[126:127], v4 offset:41984
M v[72:75], a[164:167], a[52:55], v[72:75]
M v[76:79], a[164:167], a[60:63], v[76:79]
 buffer_load_dwordx4 v11, s[16:19], s21 offen offset:3072  nt lds
M v[76:79], a[160:163], a[56:59], v[76:79]
 s_add_u32 s21, s21, 524160
M v[80:83], a[160:163], a[64:67], v[80:83]
M v[80:83], a[164:167], a[68:71], v[80:83]
M v[84:87], a[164:167], a[76:79], v[84:87]
M v[84:87], a[160:163], a[72:75], v[84:87]
 s_and_b32 s86, s41, 7
M v[88:91], a[160:163], a[80:83], v[88:91]
 s_mul_i32 s86, s86, 14
 s_lshr_b32 s64, s41, 3
 s_mul_i32 s64, s64, 7
M v[88:91], a[164:167], a[84:87], v[88:91]
 s_waitcnt lgkmcnt(2)
 s_add_u32 s86, s86, s64
 s_min_u32 s64, s42, 6
M v[92:95], a[164:167], a[92:95], v[92:95]
 s_waitcnt vmcnt(18) lgkmcnt(0)
 s_add_u32 s86, s86, s64
 s_sub_u32 s64, 6, s42
M v[92:95], a[160:163], a[88:91], v[92:95]
 s_barrier
M v[96:99], a[168:171], a[32:35], v[96:99]
 ds_read_b128 a[160:163], v5 offset:16384
 ds_read_b128 a[164:167], v6 offset:16384
M v[96:99], a[172:175], a[36:39], v[96:99]
 s_and_b32 s88, s64, 536870912
 s_mul_i32 s87, s20, 7168
M v[100:103], a[172:175], a[44:47], v[100:103]
 s_add_u32 m0, s24, 0
 ds_read_b64_tr_b16 a[128:129], v1 offset:49152
 ds_read_b64_tr_b16 a[130:131], v1 offset:50176
M v[100:103], a[168:171], a[40:43], v[100:103]
 buffer_load_dwordx4 v12, s[48:51], s22 offen offset:0   lds
M v[104:107], a[168:171], a[48:51], v[104:107]
 s_add_u32 s87, s87, 131072
M v[104:107], a[172:175], a[52:55], v[104:107]
 s_cmp_lt_u32 s20, 2
M v[108:111], a[172:175], a[60:63], v[108:111]
 s_cselect_b64 s[72:73], s[80:81], s[82:83]
M v[108:111], a[168:171], a[56:59], v[108:111]
 s_mov_b32 s60, s72
M v[112:115], a[168:171], a[64:67], v[112:115]
 s_and_b32 s61, s73, 0xffff
M v[112:115], a[172:175], a[68:71], v[112:115]
 s_mov_b32 s62, 1605632
 ds_read_b64_tr_b16 a[132:133], v1 offset:57344
 ds_read_b64_tr_b16 a[134:135], v1 offset:58368
M v[116:119], a[172:175], a[76:79], v[116:119]
 buffer_load_dwordx4 v13, s[48:51], s22 offen offset:1024   lds
M v[116:119], a[168:171], a[72:75], v[116:119]
 s_mov_b32 s63, 0x20000
M v[120:123], a[168:171], a[80:83], v[120:123]
 s_mov_b32 s68, s84
 s_and_b32 s69, s85, 0xffff
 s_mov_b32 s70, 1605632
M v[120:123], a[172:175], a[84:87], v[120:123]
 s_waitcnt lgkmcnt(4)
 s_mov_b32 s71, 0x20000
M v[124:127], a[172:175], a[92:95], v[124:127]
 s_lshl_b32 s89, s86, 5
 s_and_b32 s64, s20, 1
 s_mul_i32 s64, s64, 802816
M v[124:127], a[168:171], a[88:91], v[124:127]
 buffer_load_dwordx4 v14, s[48:51], s22 offen offset:2048   lds
M v[128:131], a[160:163], a[32:35], v[128:131]
 ds_read_b128 a[168:171], v5 offset:18432
 ds_read_b128 a[172:175], v6 offset:18432
M v[128:131], a[164:167], a[36:39], v[128:131]
 ds_read_b64_tr_b16 a[136:137], v2 offset:49152
 ds_read_b64_tr_b16 a[138:139], v2 offset:50176
M v[132:135], a[164:167], a[44:47], v[132:135]
 s_add_u32 s89, s89, s64
 v_lshrrev_b32 v28, 1, v0
M v[132:135], a[160:163], a[40:43], v[132:135]
 v_mul_u32_u24 v28, 3584, v28
 v_and_b32 v29, 1, v0
M v[136:139], a[160:163], a[48:51], v[136:139]
 v_lshl_add_u32 v25, v29, 4, v28
 v_or_b32 v25, s88, v25
M v[136:139], a[164:167], a[52:55], v[136:139]
M v[140:143], a[164:167], a[60:63], v[140:143]
 buffer_load_dwordx4 v15, s[48:51], s22 offen offset:3072   lds
M v[140:143], a[160:163], a[56:59], v[140:143]
 s_add_u32 s22, s22, 2097152
 ds_read_b64_tr_b16 a[140:141], v2 offset:57344
 ds_read_b64_tr_b16 a[142:143], v2 offset:58368
M v[144:147], a[160:163], a[64:67], v[144:147]
M v[144:147], a[164:167], a[68:71], v[144:147]
M v[148:151], a[164:167], a[76:79], v[148:151]
M v[148:151], a[160:163], a[72:75], v[148:151]
 s_add_u32 m0, s23, 32768
M v[152:155], a[160:163], a[80:83], v[152:155]
 buffer_load_dwordx4 v8, s[16:19], s21 offen offset:0  nt lds
M v[152:155], a[164:167], a[84:87], v[152:155]
 s_waitcnt lgkmcnt(4)
M v[156:159], a[164:167], a[92:95], v[156:159]
 ds_read_b64_tr_b16 a[144:145], v3 offset:49152
 ds_read_b64_tr_b16 a[146:147], v3 offset:50176
M v[156:159], a[160:163], a[88:91], v[156:159]
M v[160:163], a[168:171], a[32:35], v[160:163]
 ds_read_b128 a[160:163], v5 offset:20480
 ds_read_b128 a[164:167], v6 offset:20480
M v[160:163], a[172:175], a[36:39], v[160:163]
M v[164:167], a[172:175], a[44:47], v[164:167]
 buffer_load_dwordx4 v9, s[16:19], s21 offen offset:1024  nt lds
M v[164:167], a[168:171], a[40:43], v[164:167]
M v[168:171], a[168:171], a[48:51], v[168:171]
M v[168:171], a[172:175], a[52:55], v[168:171]
 ds_read_b64_tr_b16 a[148:149], v3 offset:57344
 ds_read_b64_tr_b16 a[150:151], v3 offset:58368
M v[172:175], a[172:175], a[60:63], v[172:175]
M v[172:175], a[168:171], a[56:59], v[172:175]
M v[176:179], a[168:171], a[64:67], v[176:179]
M v[176:179], a[172:175], a[68:71], v[176:179]
 buffer_load_dwordx4 v10, s[16:19], s21 offen offset:2048  nt lds
M v[180:183], a[172:175], a[76:79], v[180:183]
M v[180:183], a[168:171], a[72:75], v[180:183]
M v[184:187], a[168:171], a[80:83], v[184:187]
 ds_read_b64_tr_b16 a[152:153], v4 offset:49152
 ds_read_b64_tr_b16 a[154:155], v4 offset:50176
M v[184:187], a[172:175], a[84:87], v[184:187]
 s_waitcnt lgkmcnt(4)
M v[188:191], a[172:175], a[92:95], v[188:191]
M v[188:191], a[168:171], a[88:91], v[188:191]
 buffer_load_dwordx4 v11, s[16:19], s21 offen offset:3072  nt lds
M v[192:195], a[160:163], a[32:35], v[192:195]
 s_add_u32 s21, s21, 128
 ds_read_b128 a[168:171], v5 offset:22528
 ds_read_b128 a[172:175], v6 offset:22528
M v[192:195], a[164:167], a[36:39], v[192:195]
M v[196:199], a[164:167], a[44:47], v[196:199]
M v[196:199], a[160:163], a[40:43], v[196:199]
 ds_read_b64_tr_b16 a[156:157], v4 offset:57344
 ds_read_b64_tr_b16 a[158:159], v4 offset:58368
M v[200:203], a[160:163], a[48:51], v[200:203]
 s_add_u32 m0, s87, 0
M v[200:203], a[164:167], a[52:55], v[200:203]
 buffer_load_dwordx4 v25, s[60:63], s89 offen offset:0 nt lds
M v[204:207], a[164:167], a[60:63], v[204:207]
 s_add_u32 s89, s89, 114688
M v[204:207], a[160:163], a[56:59], v[204:207]
M v[208:211], a[160:163], a[64:67], v[208:211]
M v[208:211], a[164:167], a[68:71], v[208:211]
M v[212:215], a[164:167], a[76:79], v[212:215]
M v[212:215], a[160:163], a[72:75], v[212:215]
M v[216:219], a[160:163], a[80:83], v[216:219]
M v[216:219], a[164:167], a[84:87], v[216:219]
 s_waitcnt lgkmcnt(2)
M v[220:223], a[164:167], a[92:95], v[220:223]
 s_waitcnt vmcnt(19) lgkmcnt(0)
M v[220:223], a[160:163], a[88:91], v[220:223]
 s_barrier
M v[224:227], a[168:171], a[32:35], v[224:227]
 ds_read_b128 a[160:163], v5 offset:32768
 ds_read_b128 a[164:167], v6 offset:32768
M v[224:227], a[172:175], a[36:39], v[224:227]
M v[228:231], a[172:175], a[44:47], v[228:231]
M v[228:231], a[168:171], a[40:43], v[228:231]
M v[232:235], a[168:171], a[48:51], v[232:235]
M v[232:235], a[172:175], a[52:55], v[232:235]
M v[236:239], a[172:175], a[60:63], v[236:239]
M v[236:239], a[168:171], a[56:59], v[236:239]
M v[240:243], a[168:171], a[64:67], v[240:243]
M v[240:243], a[172:175], a[68:71], v[240:243]
M v[244:247], a[172:175], a[76:79], v[244:247]
M v[244:247], a[168:171], a[72:75], v[244:247]
M v[248:251], a[168:171], a[80:83], v[248:251]
M v[248:251], a[172:175], a[84:87], v[248:251]
 s_waitcnt lgkmcnt(0)
M v[252:255], a[172:175], a[92:95], v[252:255]
M v[252:255], a[168:171], a[88:91], v[252:255]
M a[0:3], a[160:163], a[96:99], a[0:3]
 ds_read_b128 a[168:171], v5 offset:34816
 ds_read_b128 a[172:175], v6 offset:34816
M a[0:3], a[164:167], a[100:103], a[0:3]
 ds_read_b64_tr_b16 a[32:33], v1 offset:0
 ds_read_b64_tr_b16 a[34:35], v1 offset:1024
M a[4:7], a[164:167], a[108:111], a[4:7]
 s_add_u32 m0, s24, 16384
M a[4:7], a[160:163], a[104:107], a[4:7]
 buffer_load_dwordx4 v12, s[48:51], s22 offen offset:0   lds
M a[8:11], a[160:163], a[112:115], a[8:11]
M a[8:11], a[164:167], a[116:119], a[8:11]
M a[12:15], a[164:167], a[124:127], a[12:15]
 ds_read_b64_tr_b16 a[36:37], v1 offset:8192
 ds_read_b64_tr_b16 a[38:39], v1 offset:9216
M a[12:15], a[160:163], a[120:123], a[12:15]
M a[16:19], a[160:163], a[128:131], a[16:19]
 buffer_load_dwordx4 v13, s[48:51], s22 offen offset:1024   lds
M a[16:19], a[164:167], a[132:135], a[16:19]
M a[20:23], a[164:167], a[140:143], a[20:23]
M a[20:23], a[160:163], a[136:139], a[20:23]
 ds_read_b64_tr_b16 a[40:41], v2 offset:0
 ds_read_b64_tr_b16 a[42:43], v2 offset:1024
M a[24:27], a[160:163], a[144:147], a[24:27]
M a[24:27], a[164:167], a[148:151], a[24:27]
 s_waitcnt lgkmcnt(6)
M a[28:31], a[164:167], a[156:159], a[28:31]
 buffer_load_dwordx4 v14, s[48:51], s22 offen offset:2048   lds
M a[28:31], a[160:163], a[152:155], a[28:31]
M v[32:35], a[168:171], a[96:99], v[32:35]
 ds_read_b128 a[160:163], v5 offset:36864
 ds_read_b128 a[164:167], v6 offset:36864
M v[32:35], a[172:175], a[100:103], v[32:35]
 ds_read_b64_tr_b16 a[44:45], v2 offset:8192
 ds_read_b64_tr_b16 a[46:47], v2 offset:9216
M v[36:39], a[172:175], a[108:111], v[36:39]
 buffer_load_dwordx4 v15, s[48:51], s22 offen offset:3072   lds
M v[36:39], a[168:171], a[104:107], v[36:39]
 s_sub_u32 s22, s22, 2097024
M v[40:43], a[168:171], a[112:115], v[40:43]
M v[40:43], a[172:175], a[116:119], v[40:43]
 ds_read_b64_tr_b16 a[48:49], v3 offset:0
 ds_read_b64_tr_b16 a[50:51], v3 offset:1024
M v[44:47], a[172:175], a[124:127], v[44:47]
 s_add_u32 m0, s23, 49152
M v[44:47], a[168:171], a[120:123], v[44:47]
 buffer_load_dwordx4 v8, s[16:19], s21 offen offset:0  nt lds
M v[48:51], a[168:171], a[128:131], v[48:51]
M v[48:51], a[172:175], a[132:135], v[48:51]
M v[52:55], a[172:175], a[140:143], v[52:55]
 ds_read_b64_tr_b16 a[52:53], v3 offset:8192
 ds_read_b64_tr_b16 a[54:55], v3 offset:9216
M v[52:55], a[168:171], a[136:139], v[52:55]
M v[56:59], a[168:171], a[144:147], v[56:59]
 buffer_load_dwordx4 v9, s[16:19], s21 offen offset:1024  nt lds
M v[56:59], a[172:175], a[148:151], v[56:59]
 s_waitcnt lgkmcnt(6)
M v[60:63], a[172:175], a[156:159], v[60:63]
M v[60:63], a[168:171], a[152:155], v[60:63]
 ds_read_b64_tr_b16 a[56:57], v4 offset:0
 ds_read_b64_tr_b16 a[58:59], v4 offset:1024
M v[64:67], a[160:163], a[96:99], v[64:67]
 ds_read_b128 a[168:171], v5 offset:38912
 ds_read_b128 a[172:175], v6 offset:38912
M v[64:67], a[164:167], a[100:103], v[64:67]
 buffer_load_dwordx4 v10, s[16:19], s21 offen offset:2048  nt lds
M v[68:71], a[164:167], a[108:111], v[68:71]
M v[68:71], a[160:163], a[104:107], v[68:71]
M v[72:75], a[160:163], a[112:115], v[72:75]
 ds_read_b64_tr_b16 a[60:61], v4 offset:8192
 ds_read_b64_tr_b16 a[62:63], v4 offset:9216
M v[72:75], a[164:167], a[116:119], v[72:75]
M v[76:79], a[164:167], a[124:127], v[76:79]
 buffer_load_dwordx4 v11, s[16:19], s21 offen offset:3072  nt lds
M v[76:79], a[160:163], a[120:123], v[76:79]
 s_add_u32 s21, s21, 524160
M v[80:83], a[160:163], a[128:131], v[80:83]
M v[80:83], a[164:167], a[132:135], v[80:83]
M v[84:87], a[164:167], a[140:143], v[84:87]
M v[84:87], a[160:163], a[136:139], v[84:87]
M v[88:91], a[160:163], a[144:147], v[88:91]
M v[88:91], a[164:167], a[148:151], v[88:91]
 s_waitcnt lgkmcnt(2)
M v[92:95], a[164:167], a[156:159], v[92:95]
 s_waitcnt vmcnt(17) lgkmcnt(0)
M v[92:95], a[160:163], a[152:155], v[92:95]
 s_barrier
M v[96:99], a[168:171], a[96:99], v[96:99]
 ds_read_b128 a[160:163], v5 offset:49152
 ds_read_b128 a[164:167], v6 offset:49152
M v[96:99], a[172:175], a[100:103], v[96:99]
M v[100:103], a[172:175], a[108:111], v[100:103]
 s_add_u32 m0, s24, 32768
 ds_read_b64_tr_b16 a[64:65], v1 offset:16384
 ds_read_b64_tr_b16 a[66:67], v1 offset:17408
M v[100:103], a[168:171], a[104:107], v[100:103]
 buffer_load_dwordx4 v12, s[48:51], s22 offen offset:0   lds
M v[104:107], a[168:171], a[112:115], v[104:107]
 v_min_u32 v16, 40, v0
 v_lshlrev_b32 v16, 2, v16
M v[104:107], a[172:175], a[116:119], v[104:107]
 buffer_load_dword v17, v16, s[12:15], 0 offen offset:64 sc1
M v[108:111], a[172:175], a[124:127], v[108:111]
M v[108:111], a[168:171], a[120:123], v[108:111]
M v[112:115], a[168:171], a[128:131], v[112:115]
M v[112:115], a[172:175], a[132:135], v[112:115]
 ds_read_b64_tr_b16 a[68:69], v1 offset:24576
 ds_read_b64_tr_b16 a[70:71], v1 offset:25600
M v[116:119], a[172:175], a[140:143], v[116:119]
 buffer_load_dwordx4 v13, s[48:51], s22 offen offset:1024   lds
M v[116:119], a[168:171], a[136:139], v[116:119]
M v[120:123], a[168:171], a[144:147], v[120:123]
M v[120:123], a[172:175], a[148:151], v[120:123]
 s_waitcnt lgkmcnt(4)
M v[124:127], a[172:175], a[156:159], v[124:127]
M v[124:127], a[168:171], a[152:155], v[124:127]
 buffer_load_dwordx4 v14, s[48:51], s22 offen offset:2048   lds
M v[128:131], a[160:163], a[96:99], v[128:131]
 ds_read_b128 a[168:171], v5 offset:51200
 ds_read_b128 a[172:175], v6 offset:51200
M v[128:131], a[164:167], a[100:103], v[128:131]
 ds_read_b64_tr_b16 a[72:73], v2 offset:16384
 ds_read_b64_tr_b16 a[74:75], v2 offset:17408
M v[132:135], a[164:167], a[108:111], v[132:135]
M v[132:135], a[160:163], a[104:107], v[132:135]
M v[136:139], a[160:163], a[112:115], v[136:139]
M v[136:139], a[164:167], a[116:119], v[136:139]
M v[140:143], a[164:167], a[124:127], v[140:143]
 buffer_load_dwordx4 v15, s[48:51], s22 offen offset:3072   lds
M v[140:143], a[160:163], a[120:123], v[140:143]
 s_add_u32 s22, s22, 2097152
 ds_read_b64_tr_b16 a[76:77], v2 offset:24576
 ds_read_b64_tr_b16 a[78:79], v2 offset:25600
M v[144:147], a[160:163], a[128:131], v[144:147]
M v[144:147], a[164:167], a[132:135], v[144:147]
M v[148:151], a[164:167], a[140:143], v[148:151]
M v[148:151], a[160:163], a[136:139], v[148:151]
 s_add_u32 m0, s23, 0
M v[152:155], a[160:163], a[144:147], v[152:155]
 buffer_load_dwordx4 v8, s[16:19], s21 offen offset:0  nt lds
M v[152:155], a[164:167], a[148:151], v[152:155]
 s_waitcnt lgkmcnt(4)
M v[156:159], a[164:167], a[156:159], v[156:159]
 ds_read_b64_tr_b16 a[80:81], v3 offset:16384
 ds_read_b64_tr_b16 a[82:83], v3 offset:17408
M v[156:159], a[160:163], a[152:155], v[156:159]
M v[160:163], a[168:171], a[96:99], v[160:163]
 ds_read_b128 a[160:163], v5 offset:53248
 ds_read_b128 a[164:167], v6 offset:53248
M v[160:163], a[172:175], a[100:103], v[160:163]
M v[164:167], a[172:175], a[108:111], v[164:167]
 buffer_load_dwordx4 v9, s[16:19], s21 offen offset:1024  nt lds
M v[164:167], a[168:171], a[104:107], v[164:167]
M v[168:171], a[168:171], a[112:115], v[168:171]
M v[168:171], a[172:175], a[116:119], v[168:171]
 ds_read_b64_tr_b16 a[84:85], v3 offset:24576
 ds_read_b64_tr_b16 a[86:87], v3 offset:25600
M v[172:175], a[172:175], a[124:127], v[172:175]
M v[172:175], a[168:171], a[120:123], v[172:175]
M v[176:179], a[168:171], a[128:131], v[176:179]
M v[176:179], a[172:175], a[132:135], v[176:179]
 buffer_load_dwordx4 v10, s[16:19], s21 offen offset:2048  nt lds
M v[180:183], a[172:175], a[140:143], v[180:183]
M v[180:183], a[168:171], a[136:139], v[180:183]
M v[184:187], a[168:171], a[144:147], v[184:187]
 ds_read_b64_tr_b16 a[88:89], v4 offset:16384
 ds_read_b64_tr_b16 a[90:91], v4 offset:17408
M v[184:187], a[172:175], a[148:151], v[184:187]
 s_waitcnt lgkmcnt(4)
M v[188:191], a[172:175], a[156:159], v[188:191]
M v[188:191], a[168:171], a[152:155], v[188:191]
 buffer_load_dwordx4 v11, s[16:19], s21 offen offset:3072  nt lds
M v[192:195], a[160:163], a[96:99], v[192:195]
 s_add_u32 s21, s21, 128
 ds_read_b128 a[168:171], v5 offset:55296
 ds_read_b128 a[172:175], v6 offset:55296
M v[192:195], a[164:167], a[100:103], v[192:195]
M v[196:199], a[164:167], a[108:111], v[196:199]
M v[196:199], a[160:163], a[104:107], v[196:199]
 ds_read_b64_tr_b16 a[92:93], v4 offset:24576
 ds_read_b64_tr_b16 a[94:95], v4 offset:25600
M v[200:203], a[160:163], a[112:115], v[200:203]
 s_add_u32 m0, s87, 1024
M v[200:203], a[164:167], a[116:119], v[200:203]
 buffer_load_dwordx4 v25, s[60:63], s89 offen offset:0 nt lds
M v[204:207], a[164:167], a[124:127], v[204:207]
 s_add_u32 s89, s89, 114688
M v[204:207], a[160:163], a[120:123], v[204:207]
M v[208:211], a[160:163], a[128:131], v[208:211]
M v[208:211], a[164:167], a[132:135], v[208:211]
M v[212:215], a[164:167], a[140:143], v[212:215]
M v[212:215], a[160:163], a[136:139], v[212:215]
M v[216:219], a[160:163], a[144:147], v[216:219]
M v[216:219], a[164:167], a[148:151], v[216:219]
 s_waitcnt lgkmcnt(2)
M v[220:223], a[164:167], a[156:159], v[220:223]
 s_waitcnt vmcnt(19) lgkmcnt(0)
M v[220:223], a[160:163], a[152:155], v[220:223]
 s_barrier
M v[224:227], a[168:171], a[96:99], v[224:227]
 ds_read_b128 a[160:163], v5 offset:0
 ds_read_b128 a[164:167], v6 offset:0
M v[224:227], a[172:175], a[100:103], v[224:227]
M v[228:231], a[172:175], a[108:111], v[228:231]
M v[228:231], a[168:171], a[104:107], v[228:231]
M v[232:235], a[168:171], a[112:115], v[232:235]
M v[232:235], a[172:175], a[116:119], v[232:235]
M v[236:239], a[172:175], a[124:127], v[236:239]
M v[236:239], a[168:171], a[120:123], v[236:239]
M v[240:243], a[168:171], a[128:131], v[240:243]
M v[240:243], a[172:175], a[132:135], v[240:243]
M v[244:247], a[172:175], a[140:143], v[244:247]
M v[244:247], a[168:171], a[136:139], v[244:247]
M v[248:251], a[168:171], a[144:147], v[248:251]
M v[248:251], a[172:175], a[148:151], v[248:251]
 s_waitcnt lgkmcnt(0)
M v[252:255], a[172:175], a[156:159], v[252:255]
M v[252:255], a[168:171], a[152:155], v[252:255]
M a[0:3], a[160:163], a[32:35], a[0:3]
 ds_read_b128 a[168:171], v5 offset:2048
 ds_read_b128 a[172:175], v6 offset:2048
M a[0:3], a[164:167], a[36:39], a[0:3]
 ds_read_b64_tr_b16 a[96:97], v1 offset:32768
 ds_read_b64_tr_b16 a[98:99], v1 offset:33792
M a[4:7], a[164:167], a[44:47], a[4:7]
 s_add_u32 m0, s24, 49152
M a[4:7], a[160:163], a[40:43], a[4:7]
 buffer_load_dwordx4 v12, s[48:51], s22 offen offset:0   lds
M a[8:11], a[160:163], a[48:51], a[8:11]
M a[8:11], a[164:167], a[52:55], a[8:11]
M a[12:15], a[164:167], a[60:63], a[12:15]
 ds_read_b64_tr_b16 a[100:101], v1 offset:40960
 ds_read_b64_tr_b16 a[102:103], v1 offset:41984
M a[12:15], a[160:163], a[56:59], a[12:15]
M a[16:19], a[160:163], a[64:67], a[16:19]
 buffer_load_dwordx4 v13, s[48:51], s22 offen offset:1024   lds
M a[16:19], a[164:167], a[68:71], a[16:19]
M a[20:23], a[164:167], a[76:79], a[20:23]
M a[20:23], a[160:163], a[72:75], a[20:23]
 ds_read_b64_tr_b16 a[104:105], v2 offset:32768
 ds_read_b64_tr_b16 a[106:107], v2 offset:33792
M a[24:27], a[160:163], a[80:83], a[24:27]
M a[24:27], a[164:167], a[84:87], a[24:27]
 s_waitcnt lgkmcnt(6)
M a[28:31], a[164:167], a[92:95], a[28:31]
 buffer_load_dwordx4 v14, s[48:51], s22 offen offset:2048   lds
M a[28:31], a[160:163], a[88:91], a[28:31]
M v[32:35], a[168:171], a[32:35], v[32:35]
 ds_read_b128 a[160:163], v5 offset:4096
 ds_read_b128 a[164:167], v6 offset:4096
M v[32:35], a[172:175], a[36:39], v[32:35]
 ds_read_b64_tr_b16 a[108:109], v2 offset:40960
 ds_read_b64_tr_b16 a[110:111], v2 offset:41984
M v[36:39], a[172:175], a[44:47], v[36:39]
 buffer_load_dwordx4 v15, s[48:51], s22 offen offset:3072   lds
M v[36:39], a[168:171], a[40:43], v[36:39]
 s_sub_u32 s22, s22, 2097024
M v[40:43], a[168:171], a[48:51], v[40:43]
M v[40:43], a[172:175], a[52:55], v[40:43]
 ds_read_b64_tr_b16 a[112:113], v3 offset:32768
 ds_read_b64_tr_b16 a[114:115], v3 offset:33792
M v[44:47], a[172:175], a[60:63], v[44:47]
 s_add_u32 m0, s23, 16384
M v[44:47], a[168:171], a[56:59], v[44:47]
 buffer_load_dwordx4 v8, s[16:19], s21 offen offset:0  nt lds
M v[48:51], a[168:171], a[64:67], v[48:51]
M v[48:51], a[172:175], a[68:71], v[48:51]
M v[52:55], a[172:175], a[76:79], v[52:55]
 ds_read_b64_tr_b16 a[116:117], v3 offset:40960
 ds_read_b64_tr_b16 a[118:119], v3 offset:41984
M v[52:55], a[168:171], a[72:75], v[52:55]
M v[56:59], a[168:171], a[80:83], v[56:59]
 buffer_load_dwordx4 v9, s[16:19], s21 offen offset:1024  nt lds
M v[56:59], a[172:175], a[84:87], v[56:59]
 s_waitcnt lgkmcnt(6)
M v[60:63], a[172:175], a[92:95], v[60:63]
M v[60:63], a[168:171], a[88:91], v[60:63]
 ds_read_b64_tr_b16 a[120:121], v4 offset:32768
 ds_read_b64_tr_b16 a[122:123], v4 offset:33792
M v[64:67], a[160:163], a[32:35], v[64:67]
 ds_read_b128 a[168:171], v5 offset:6144
 ds_read_b128 a[172:175], v6 offset:6144
M v[64:67], a[164:167], a[36:39], v[64:67]
 buffer_load_dwordx4 v10, s[16:19], s21 offen offset:2048  nt lds
M v[68:71], a[164:167], a[44:47], v[68:71]
M v[68:71], a[160:163], a[40:43], v[68:71]
M v[72:75], a[160:163], a[48:51], v[72:75]
 ds_read_b64_tr_b16 a[124:125], v4 offset:40960
 ds_read_b64_tr_b16 a[126:127], v4 offset:41984
M v[72:75], a[164:167], a[52:55], v[72:75]
M v[76:79], a[164:167], a[60:63], v[76:79]
 buffer_load_dwordx4 v11, s[16:19], s21 offen offset:3072  nt lds
M v[76:79], a[160:163], a[56:59], v[76:79]
 s_add_u32 s21, s21, 524160
M v[80:83], a[160:163], a[64:67], v[80:83]
M v[80:83], a[164:167], a[68:71], v[80:83]
M v[84:87], a[164:167], a[76:79], v[84:87]
M v[84:87], a[160:163], a[72:75], v[84:87]
M v[88:91], a[160:163], a[80:83], v[88:91]
M v[88:91], a[164:167], a[84:87], v[88:91]
 s_waitcnt lgkmcnt(2)
M v[92:95], a[164:167], a[92:95], v[92:95]
 s_waitcnt vmcnt(18) lgkmcnt(0)
M v[92:95], a[160:163], a[88:91], v[92:95]
 s_barrier
M v[96:99], a[168:171], a[32:35], v[96:99]
 ds_read_b128 a[160:163], v5 offset:16384
 ds_read_b128 a[164:167], v6 offset:16384
M v[96:99], a[172:175], a[36:39], v[96:99]
M v[100:103], a[172:175], a[44:47], v[100:103]
 s_add_u32 m0, s24, 0
 ds_read_b64_tr_b16 a[128:129], v1 offset:49152
 ds_read_b64_tr_b16 a[130:131], v1 offset:50176
M v[100:103], a[168:171], a[40:43], v[100:103]
 buffer_load_dwordx4 v12, s[48:51], s22 offen offset:0   lds
M v[104:107], a[168:171], a[48:51], v[104:107]
M v[104:107], a[172:175], a[52:55], v[104:107]
M v[108:111], a[172:175], a[60:63], v[108:111]
M v[108:111], a[168:171], a[56:59], v[108:111]
M v[112:115], a[168:171], a[64:67], v[112:115]
M v[112:115], a[172:175], a[68:71], v[112:115]
 ds_read_b64_tr_b16 a[132:133], v1 offset:57344
 ds_read_b64_tr_b16 a[134:135], v1 offset:58368
M v[116:119], a[172:175], a[76:79], v[116:119]
 buffer_load_dwordx4 v13, s[48:51], s22 offen offset:1024   lds
M v[116:119], a[168:171], a[72:75], v[116:119]
M v[120:123], a[168:171], a[80:83], v[120:123]
M v[120:123], a[172:175], a[84:87], v[120:123]
 s_waitcnt lgkmcnt(4)
M v[124:127], a[172:175], a[92:95], v[124:127]
M v[124:127], a[168:171], a[88:91], v[124:127]
 buffer_load_dwordx4 v14, s[48:51], s22 offen offset:2048   lds
M v[128:131], a[160:163], a[32:35], v[128:131]
 ds_read_b128 a[168:171], v5 offset:18432
 ds_read_b128 a[172:175], v6 offset:18432
M v[128:131], a[164:167], a[36:39], v[128:131]
 ds_read_b64_tr_b16 a[136:137], v2 offset:49152
 ds_read_b64_tr_b16 a[138:139], v2 offset:50176
M v[132:135], a[164:167], a[44:47], v[132:135]
M v[132:135], a[160:163], a[40:43], v[132:135]
M v[136:139], a[160:163], a[48:51], v[136:139]
M v[136:139], a[164:167], a[52:55], v[136:139]
M v[140:143], a[164:167], a[60:63], v[140:143]
 buffer_load_dwordx4 v15, s[48:51], s22 offen offset:3072   lds
M v[140:143], a[160:163], a[56:59], v[140:143]
 s_add_u32 s22, s22, 2097152
 ds_read_b64_tr_b16 a[140:141], v2 offset:57344
 ds_read_b64_tr_b16 a[142:143], v2 offset:58368
M v[144:147], a[160:163], a[64:67], v[144:147]
M v[144:147], a[164:167], a[68:71], v[144:147]
M v[148:151], a[164:167], a[76:79], v[148:151]
M v[148:151], a[160:163], a[72:75], v[148:151]
 s_add_u32 m0, s23, 32768
M v[152:155], a[160:163], a[80:83], v[152:155]
 buffer_load_dwordx4 v8, s[16:19], s21 offen offset:0  nt lds
M v[152:155], a[164:167], a[84:87], v[152:155]
 s_waitcnt lgkmcnt(4)
M v[156:159], a[164:167], a[92:95], v[156:159]
 ds_read_b64_tr_b16 a[144:145], v3 offset:49152
 ds_read_b64_tr_b16 a[146:147], v3 offset:50176
M v[156:159], a[160:163], a[88:91], v[156:159]
M v[160:163], a[168:171], a[32:35], v[160:163]
 ds_read_b128 a[160:163], v5 offset:20480
 ds_read_b128 a[164:167], v6 offset:20480
M v[160:163], a[172:175], a[36:39], v[160:163]
M v[164:167], a[172:175], a[44:47], v[164:167]
 buffer_load_dwordx4 v9, s[16:19], s21 offen offset:1024  nt lds
M v[164:167], a[168:171], a[40:43], v[164:167]
M v[168:171], a[168:171], a[48:51], v[168:171]
M v[168:171], a[172:175], a[52:55], v[168:171]
 ds_read_b64_tr_b16 a[148:149], v3 offset:57344
 ds_read_b64_tr_b16 a[150:151], v3 offset:58368
M v[172:175], a[172:175], a[60:63], v[172:175]
M v[172:175], a[168:171], a[56:59], v[172:175]
M v[176:179], a[168:171], a[64:67], v[176:179]
M v[176:179], a[172:175], a[68:71], v[176:179]
 buffer_load_dwordx4 v10, s[16:19], s21 offen offset:2048  nt lds
M v[180:183], a[172:175], a[76:79], v[180:183]
M v[180:183], a[168:171], a[72:75], v[180:183]
M v[184:187], a[168:171], a[80:83], v[184:187]
 ds_read_b64_tr_b16 a[152:153], v4 offset:49152
 ds_read_b64_tr_b16 a[154:155], v4 offset:50176
M v[184:187], a[172:175], a[84:87], v[184:187]
 s_waitcnt lgkmcnt(4)
M v[188:191], a[172:175], a[92:95], v[188:191]
M v[188:191], a[168:171], a[88:91], v[188:191]
 buffer_load_dwordx4 v11, s[16:19], s21 offen offset:3072  nt lds
M v[192:195], a[160:163], a[32:35], v[192:195]
 s_add_u32 s21, s21, 128
 ds_read_b128 a[168:171], v5 offset:22528
 ds_read_b128 a[172:175], v6 offset:22528
M v[192:195], a[164:167], a[36:39], v[192:195]
M v[196:199], a[164:167], a[44:47], v[196:199]
M v[196:199], a[160:163], a[40:43], v[196:199]
 ds_read_b64_tr_b16 a[156:157], v4 offset:57344
 ds_read_b64_tr_b16 a[158:159], v4 offset:58368
M v[200:203], a[160:163], a[48:51], v[200:203]
 s_add_u32 m0, s87, 2048
M v[200:203], a[164:167], a[52:55], v[200:203]
 buffer_load_dwordx4 v25, s[60:63], s89 offen offset:0 nt lds
M v[204:207], a[164:167], a[60:63], v[204:207]
 s_add_u32 s89, s89, 114688
M v[204:207], a[160:163], a[56:59], v[204:207]
M v[208:211], a[160:163], a[64:67], v[208:211]
M v[208:211], a[164:167], a[68:71], v[208:211]
M v[212:215], a[164:167], a[76:79], v[212:215]
M v[212:215], a[160:163], a[72:75], v[212:215]
M v[216:219], a[160:163], a[80:83], v[216:219]
M v[216:219], a[164:167], a[84:87], v[216:219]
 s_waitcnt lgkmcnt(2)
M v[220:223], a[164:167], a[92:95], v[220:223]
 s_waitcnt vmcnt(18) lgkmcnt(0)
M v[220:223], a[160:163], a[88:91], v[220:223]
 s_barrier
M v[224:227], a[168:171], a[32:35], v[224:227]
 ds_read_b128 a[160:163], v5 offset:32768
 ds_read_b128 a[164:167], v6 offset:32768
M v[224:227], a[172:175], a[36:39], v[224:227]
 v_cmp_ne_u32 vcc, 1, v17
M v[228:231], a[172:175], a[44:47], v[228:231]
 s_nop 0
M v[228:231], a[168:171], a[40:43], v[228:231]
 s_cbranch_vccnz L_zs0
L_zr0:
M v[232:235], a[168:171], a[48:51], v[232:235]
 buffer_load_dword a240, v24, s[32:35], 0 offen offset:1024
M v[232:235], a[172:175], a[52:55], v[232:235]
 s_lshl_b32 s72, s30, 6
M v[236:239], a[172:175], a[60:63], v[236:239]
 s_add_u32 s72, s72, 104914944
M v[236:239], a[168:171], a[56:59], v[236:239]
M v[240:243], a[168:171], a[64:67], v[240:243]
 buffer_store_dword v19, v18, s[8:11], s72 offen sc1
M v[240:243], a[172:175], a[68:71], v[240:243]
M v[244:247], a[172:175], a[76:79], v[244:247]
M v[244:247], a[168:171], a[72:75], v[244:247]
M v[248:251], a[168:171], a[80:83], v[248:251]
M v[248:251], a[172:175], a[84:87], v[248:251]
 s_waitcnt lgkmcnt(0)
M v[252:255], a[172:175], a[92:95], v[252:255]
M v[252:255], a[168:171], a[88:91], v[252:255]
M a[0:3], a[160:163], a[96:99], a[0:3]
 ds_read_b128 a[168:171], v5 offset:34816
 ds_read_b128 a[172:175], v6 offset:34816
M a[0:3], a[164:167], a[100:103], a[0:3]
 ds_read_b64_tr_b16 a[32:33], v1 offset:0
 ds_read_b64_tr_b16 a[34:35], v1 offset:1024
M a[4:7], a[164:167], a[108:111], a[4:7]
 s_add_u32 m0, s24, 16384
M a[4:7], a[160:163], a[104:107], a[4:7]
 buffer_load_dwordx4 v12, s[48:51], s22 offen offset:0   lds
M a[8:11], a[160:163], a[112:115], a[8:11]
M a[8:11], a[164:167], a[116:119], a[8:11]
M a[12:15], a[164:167], a[124:127], a[12:15]
 ds_read_b64_tr_b16 a[36:37], v1 offset:8192
 ds_read_b64_tr_b16 a[38:39], v1 offset:9216
M a[12:15], a[160:163], a[120:123], a[12:15]
M a[16:19], a[160:163], a[128:131], a[16:19]
 buffer_load_dwordx4 v13, s[48:51], s22 offen offset:1024   lds
M a[16:19], a[164:167], a[132:135], a[16:19]
M a[20:23], a[164:167], a[140:143], a[20:23]
M a[20:23], a[160:163], a[136:139], a[20:23]
 ds_read_b64_tr_b16 a[40:41], v2 offset:0
 ds_read_b64_tr_b16 a[42:43], v2 offset:1024
M a[24:27], a[160:163], a[144:147], a[24:27]
M a[24:27], a[164:167], a[148:151], a[24:27]
 s_waitcnt lgkmcnt(6)
M a[28:31], a[164:167], a[156:159], a[28:31]
 buffer_load_dwordx4 v14, s[48:51], s22 offen offset:2048   lds
M a[28:31], a[160:163], a[152:155], a[28:31]
M v[32:35], a[168:171], a[96:99], v[32:35]
 ds_read_b128 a[160:163], v5 offset:36864
 ds_read_b128 a[164:167], v6 offset:36864
M v[32:35], a[172:175], a[100:103], v[32:35]
 ds_read_b64_tr_b16 a[44:45], v2 offset:8192
 ds_read_b64_tr_b16 a[46:47], v2 offset:9216
M v[36:39], a[172:175], a[108:111], v[36:39]
 buffer_load_dwordx4 v15, s[48:51], s22 offen offset:3072   lds
M v[36:39], a[168:171], a[104:107], v[36:39]
 s_sub_u32 s22, s22, 2097024
M v[40:43], a[168:171], a[112:115], v[40:43]
M v[40:43], a[172:175], a[116:119], v[40:43]
 ds_read_b64_tr_b16 a[48:49], v3 offset:0
 ds_read_b64_tr_b16 a[50:51], v3 offset:1024
M v[44:47], a[172:175], a[124:127], v[44:47]
 s_add_u32 m0, s23, 49152
M v[44:47], a[168:171], a[120:123], v[44:47]
 buffer_load_dwordx4 v8, s[16:19], s21 offen offset:0  nt lds
M v[48:51], a[168:171], a[128:131], v[48:51]
M v[48:51], a[172:175], a[132:135], v[48:51]
M v[52:55], a[172:175], a[140:143], v[52:55]
 ds_read_b64_tr_b16 a[52:53], v3 offset:8192
 ds_read_b64_tr_b16 a[54:55], v3 offset:9216
M v[52:55], a[168:171], a[136:139], v[52:55]
M v[56:59], a[168:171], a[144:147], v[56:59]
 buffer_load_dwordx4 v9, s[16:19], s21 offen offset:1024  nt lds
M v[56:59], a[172:175], a[148:151], v[56:59]
 s_waitcnt lgkmcnt(6)
M v[60:63], a[172:175], a[156:159], v[60:63]
M v[60:63], a[168:171], a[152:155], v[60:63]
 ds_read_b64_tr_b16 a[56:57], v4 offset:0
 ds_read_b64_tr_b16 a[58:59], v4 offset:1024
M v[64:67], a[160:163], a[96:99], v[64:67]
 ds_read_b128 a[168:171], v5 offset:38912
 ds_read_b128 a[172:175], v6 offset:38912
M v[64:67], a[164:167], a[100:103], v[64:67]
 buffer_load_dwordx4 v10, s[16:19], s21 offen offset:2048  nt lds
M v[68:71], a[164:167], a[108:111], v[68:71]
M v[68:71], a[160:163], a[104:107], v[68:71]
M v[72:75], a[160:163], a[112:115], v[72:75]
 ds_read_b64_tr_b16 a[60:61], v4 offset:8192
 ds_read_b64_tr_b16 a[62:63], v4 offset:9216
M v[72:75], a[164:167], a[116:119], v[72:75]
M v[76:79], a[164:167], a[124:127], v[76:79]
 buffer_load_dwordx4 v11, s[16:19], s21 offen offset:3072  nt lds
M v[76:79], a[160:163], a[120:123], v[76:79]
 s_add_u32 s21, s21, 524160
M v[80:83], a[160:163], a[128:131], v[80:83]
M v[80:83], a[164:167], a[132:135], v[80:83]
M v[84:87], a[164:167], a[140:143], v[84:87]
M v[84:87], a[160:163], a[136:139], v[84:87]
M v[88:91], a[160:163], a[144:147], v[88:91]
M v[88:91], a[164:167], a[148:151], v[88:91]
 s_waitcnt lgkmcnt(2)
M v[92:95], a[164:167], a[156:159], v[92:95]
 s_waitcnt vmcnt(19) lgkmcnt(0)
M v[92:95], a[160:163], a[152:155], v[92:95]
 s_barrier
M v[96:99], a[168:171], a[96:99], v[96:99]
 ds_read_b128 a[160:163], v5 offset:49152
 ds_read_b128 a[164:167], v6 offset:49152
M v[96:99], a[172:175], a[100:103], v[96:99]
M v[100:103], a[172:175], a[108:111], v[100:103]
 s_add_u32 m0, s24, 32768
 ds_read_b64_tr_b16 a[64:65], v1 offset:16384
 ds_read_b64_tr_b16 a[66:67], v1 offset:17408
M v[100:103], a[168:171], a[104:107], v[100:103]
 buffer_load_dwordx4 v12, s[48:51], s22 offen offset:0   lds
M v[104:107], a[168:171], a[112:115], v[104:107]
M v[104:107], a[172:175], a[116:119], v[104:107]
M v[108:111], a[172:175], a[124:127], v[108:111]
M v[108:111], a[168:171], a[120:123], v[108:111]
M v[112:115], a[168:171], a[128:131], v[112:115]
M v[112:115], a[172:175], a[132:135], v[112:115]
 ds_read_b64_tr_b16 a[68:69], v1 offset:24576
 ds_read_b64_tr_b16 a[70:71], v1 offset:25600
M v[116:119], a[172:175], a[140:143], v[116:119]
 buffer_load_dwordx4 v13, s[48:51], s22 offen offset:1024   lds
M v[116:119], a[168:171], a[136:139], v[116:119]
M v[120:123], a[168:171], a[144:147], v[120:123]
M v[120:123], a[172:175], a[148:151], v[120:123]
 s_waitcnt lgkmcnt(4)
M v[124:127], a[172:175], a[156:159], v[124:127]
M v[124:127], a[168:171], a[152:155], v[124:127]
 buffer_load_dwordx4 v14, s[48:51], s22 offen offset:2048   lds
M v[128:131], a[160:163], a[96:99], v[128:131]
 ds_read_b128 a[168:171], v5 offset:51200
 ds_read_b128 a[172:175], v6 offset:51200
M v[128:131], a[164:167], a[100:103], v[128:131]
 ds_read_b64_tr_b16 a[72:73], v2 offset:16384
 ds_read_b64_tr_b16 a[74:75], v2 offset:17408
M v[132:135], a[164:167], a[108:111], v[132:135]
M v[132:135], a[160:163], a[104:107], v[132:135]
M v[136:139], a[160:163], a[112:115], v[136:139]
M v[136:139], a[164:167], a[116:119], v[136:139]
M v[140:143], a[164:167], a[124:127], v[140:143]
 buffer_load_dwordx4 v15, s[48:51], s22 offen offset:3072   lds
M v[140:143], a[160:163], a[120:123], v[140:143]
 s_add_u32 s22, s22, 2097152
 ds_read_b64_tr_b16 a[76:77], v2 offset:24576
 ds_read_b64_tr_b16 a[78:79], v2 offset:25600
M v[144:147], a[160:163], a[128:131], v[144:147]
M v[144:147], a[164:167], a[132:135], v[144:147]
M v[148:151], a[164:167], a[140:143], v[148:151]
M v[148:151], a[160:163], a[136:139], v[148:151]
 s_add_u32 m0, s23, 0
M v[152:155], a[160:163], a[144:147], v[152:155]
 buffer_load_dwordx4 v8, s[16:19], s21 offen offset:0  nt lds
M v[152:155], a[164:167], a[148:151], v[152:155]
 s_waitcnt lgkmcnt(4)
M v[156:159], a[164:167], a[156:159], v[156:159]
 ds_read_b64_tr_b16 a[80:81], v3 offset:16384
 ds_read_b64_tr_b16 a[82:83], v3 offset:17408
M v[156:159], a[160:163], a[152:155], v[156:159]
M v[160:163], a[168:171], a[96:99], v[160:163]
 ds_read_b128 a[160:163], v5 offset:53248
 ds_read_b128 a[164:167], v6 offset:53248
M v[160:163], a[172:175], a[100:103], v[160:163]
M v[164:167], a[172:175], a[108:111], v[164:167]
 buffer_load_dwordx4 v9, s[16:19], s21 offen offset:1024  nt lds
M v[164:167], a[168:171], a[104:107], v[164:167]
M v[168:171], a[168:171], a[112:115], v[168:171]
M v[168:171], a[172:175], a[116:119], v[168:171]
 ds_read_b64_tr_b16 a[84:85], v3 offset:24576
 ds_read_b64_tr_b16 a[86:87], v3 offset:25600
M v[172:175], a[172:175], a[124:127], v[172:175]
M v[172:175], a[168:171], a[120:123], v[172:175]
M v[176:179], a[168:171], a[128:131], v[176:179]
M v[176:179], a[172:175], a[132:135], v[176:179]
 buffer_load_dwordx4 v10, s[16:19], s21 offen offset:2048  nt lds
M v[180:183], a[172:175], a[140:143], v[180:183]
M v[180:183], a[168:171], a[136:139], v[180:183]
M v[184:187], a[168:171], a[144:147], v[184:187]
 ds_read_b64_tr_b16 a[88:89], v4 offset:16384
 ds_read_b64_tr_b16 a[90:91], v4 offset:17408
M v[184:187], a[172:175], a[148:151], v[184:187]
 s_waitcnt lgkmcnt(4)
M v[188:191], a[172:175], a[156:159], v[188:191]
M v[188:191], a[168:171], a[152:155], v[188:191]
 buffer_load_dwordx4 v11, s[16:19], s21 offen offset:3072  nt lds
M v[192:195], a[160:163], a[96:99], v[192:195]
 s_add_u32 s21, s21, 128
 ds_read_b128 a[168:171], v5 offset:55296
 ds_read_b128 a[172:175], v6 offset:55296
M v[192:195], a[164:167], a[100:103], v[192:195]
M v[196:199], a[164:167], a[108:111], v[196:199]
M v[196:199], a[160:163], a[104:107], v[196:199]
 ds_read_b64_tr_b16 a[92:93], v4 offset:24576
 ds_read_b64_tr_b16 a[94:95], v4 offset:25600
M v[200:203], a[160:163], a[112:115], v[200:203]
 s_add_u32 m0, s87, 3072
M v[200:203], a[164:167], a[116:119], v[200:203]
 buffer_load_dwordx4 v25, s[60:63], s89 offen offset:0 nt lds
M v[204:207], a[164:167], a[124:127], v[204:207]
 s_add_u32 s89, s89, 114688
M v[204:207], a[160:163], a[120:123], v[204:207]
M v[208:211], a[160:163], a[128:131], v[208:211]
M v[208:211], a[164:167], a[132:135], v[208:211]
M v[212:215], a[164:167], a[140:143], v[212:215]
M v[212:215], a[160:163], a[136:139], v[212:215]
M v[216:219], a[160:163], a[144:147], v[216:219]
M v[216:219], a[164:167], a[148:151], v[216:219]
 s_waitcnt lgkmcnt(2)
M v[220:223], a[164:167], a[156:159], v[220:223]
 s_waitcnt vmcnt(20) lgkmcnt(0)
M v[220:223], a[160:163], a[152:155], v[220:223]
 s_barrier
M v[224:227], a[168:171], a[96:99], v[224:227]
 ds_read_b128 a[160:163], v5 offset:0
 ds_read_b128 a[164:167], v6 offset:0
M v[224:227], a[172:175], a[100:103], v[224:227]
M v[228:231], a[172:175], a[108:111], v[228:231]
M v[228:231], a[168:171], a[104:107], v[228:231]
M v[232:235], a[168:171], a[112:115], v[232:235]
M v[232:235], a[172:175], a[116:119], v[232:235]
M v[236:239], a[172:175], a[124:127], v[236:239]
M v[236:239], a[168:171], a[120:123], v[236:239]
M v[240:243], a[168:171], a[128:131], v[240:243]
M v[240:243], a[172:175], a[132:135], v[240:243]
M v[244:247], a[172:175], a[140:143], v[244:247]
M v[244:247], a[168:171], a[136:139], v[244:247]
M v[248:251], a[168:171], a[144:147], v[248:251]
M v[248:251], a[172:175], a[148:151], v[248:251]
 s_waitcnt lgkmcnt(0)
M v[252:255], a[172:175], a[156:159], v[252:255]
M v[252:255], a[168:171], a[152:155], v[252:255]
M a[0:3], a[160:163], a[32:35], a[0:3]
 ds_read_b128 a[168:171], v5 offset:2048
 ds_read_b128 a[172:175], v6 offset:2048
M a[0:3], a[164:167], a[36:39], a[0:3]
 ds_read_b64_tr_b16 a[96:97], v1 offset:32768
 ds_read_b64_tr_b16 a[98:99], v1 offset:33792
M a[4:7], a[164:167], a[44:47], a[4:7]
 s_add_u32 m0, s24, 49152
M a[4:7], a[160:163], a[40:43], a[4:7]
 buffer_load_dwordx4 v12, s[48:51], s22 offen offset:0   lds
M a[8:11], a[160:163], a[48:51], a[8:11]
M a[8:11], a[164:167], a[52:55], a[8:11]
M a[12:15], a[164:167], a[60:63], a[12:15]
 ds_read_b64_tr_b16 a[100:101], v1 offset:40960
 ds_read_b64_tr_b16 a[102:103], v1 offset:41984
M a[12:15], a[160:163], a[56:59], a[12:15]
M a[16:19], a[160:163], a[64:67], a[16:19]
 buffer_load_dwordx4 v13, s[48:51], s22 offen offset:1024   lds
M a[16:19], a[164:167], a[68:71], a[16:19]
M a[20:23], a[164:167], a[76:79], a[20:23]
M a[20:23], a[160:163], a[72:75], a[20:23]
 ds_read_b64_tr_b16 a[104:105], v2 offset:32768
 ds_read_b64_tr_b16 a[106:107], v2 offset:33792
M a[24:27], a[160:163], a[80:83], a[24:27]
M a[24:27], a[164:167], a[84:87], a[24:27]
 s_waitcnt lgkmcnt(6)
M a[28:31], a[164:167], a[92:95], a[28:31]
 buffer_load_dwordx4 v14, s[48:51], s22 offen offset:2048   lds
M a[28:31], a[160:163], a[88:91], a[28:31]
M v[32:35], a[168:171], a[32:35], v[32:35]
 ds_read_b128 a[160:163], v5 offset:4096
 ds_read_b128 a[164:167], v6 offset:4096
M v[32:35], a[172:175], a[36:39], v[32:35]
 ds_read_b64_tr_b16 a[108:109], v2 offset:40960
 ds_read_b64_tr_b16 a[110:111], v2 offset:41984
M v[36:39], a[172:175], a[44:47], v[36:39]
 buffer_load_dwordx4 v15, s[48:51], s22 offen offset:3072   lds
M v[36:39], a[168:171], a[40:43], v[36:39]
 s_sub_u32 s22, s22, 2097024
M v[40:43], a[168:171], a[48:51], v[40:43]
M v[40:43], a[172:175], a[52:55], v[40:43]
 ds_read_b64_tr_b16 a[112:113], v3 offset:32768
 ds_read_b64_tr_b16 a[114:115], v3 offset:33792
M v[44:47], a[172:175], a[60:63], v[44:47]
 s_add_u32 m0, s23, 16384
M v[44:47], a[168:171], a[56:59], v[44:47]
 buffer_load_dwordx4 v8, s[16:19], s21 offen offset:0  nt lds
M v[48:51], a[168:171], a[64:67], v[48:51]
M v[48:51], a[172:175], a[68:71], v[48:51]
M v[52:55], a[172:175], a[76:79], v[52:55]
 ds_read_b64_tr_b16 a[116:117], v3 offset:40960
 ds_read_b64_tr_b16 a[118:119], v3 offset:41984
M v[52:55], a[168:171], a[72:75], v[52:55]
M v[56:59], a[168:171], a[80:83], v[56:59]
 buffer_load_dwordx4 v9, s[16:19], s21 offen offset:1024  nt lds
M v[56:59], a[172:175], a[84:87], v[56:59]
 s_waitcnt lgkmcnt(6)
M v[60:63], a[172:175], a[92:95], v[60:63]
M v[60:63], a[168:171], a[88:91], v[60:63]
 ds_read_b64_tr_b16 a[120:121], v4 offset:32768
 ds_read_b64_tr_b16 a[122:123], v4 offset:33792
M v[64:67], a[160:163], a[32:35], v[64:67]
 ds_read_b128 a[168:171], v5 offset:6144
 ds_read_b128 a[172:175], v6 offset:6144
M v[64:67], a[164:167], a[36:39], v[64:67]
 buffer_load_dwordx4 v10, s[16:19], s21 offen offset:2048  nt lds
M v[68:71], a[164:167], a[44:47], v[68:71]
M v[68:71], a[160:163], a[40:43], v[68:71]
M v[72:75], a[160:163], a[48:51], v[72:75]
 ds_read_b64_tr_b16 a[124:125], v4 offset:40960
 ds_read_b64_tr_b16 a[126:127], v4 offset:41984
M v[72:75], a[164:167], a[52:55], v[72:75]
M v[76:79], a[164:167], a[60:63], v[76:79]
 buffer_load_dwordx4 v11, s[16:19], s21 offen offset:3072  nt lds
M v[76:79], a[160:163], a[56:59], v[76:79]
 s_add_u32 s21, s21, 524160
M v[80:83], a[160:163], a[64:67], v[80:83]
M v[80:83], a[164:167], a[68:71], v[80:83]
M v[84:87], a[164:167], a[76:79], v[84:87]
M v[84:87], a[160:163], a[72:75], v[84:87]
M v[88:91], a[160:163], a[80:83], v[88:91]
M v[88:91], a[164:167], a[84:87], v[88:91]
 s_waitcnt lgkmcnt(2)
M v[92:95], a[164:167], a[92:95], v[92:95]
 s_waitcnt vmcnt(17) lgkmcnt(0)
M v[92:95], a[160:163], a[88:91], v[92:95]
 s_barrier
M v[96:99], a[168:171], a[32:35], v[96:99]
 ds_read_b128 a[160:163], v5 offset:16384
 ds_read_b128 a[164:167], v6 offset:16384
M v[96:99], a[172:175], a[36:39], v[96:99]
M v[100:103], a[172:175], a[44:47], v[100:103]
 s_add_u32 m0, s24, 0
 ds_read_b64_tr_b16 a[128:129], v1 offset:49152
 ds_read_b64_tr_b16 a[130:131], v1 offset:50176
M v[100:103], a[168:171], a[40:43], v[100:103]
 buffer_load_dwordx4 v12, s[48:51], s22 offen offset:0   lds
M v[104:107], a[168:171], a[48:51], v[104:107]
M v[104:107], a[172:175], a[52:55], v[104:107]
M v[108:111], a[172:175], a[60:63], v[108:111]
M v[108:111], a[168:171], a[56:59], v[108:111]
M v[112:115], a[168:171], a[64:67], v[112:115]
M v[112:115], a[172:175], a[68:71], v[112:115]
 ds_read_b64_tr_b16 a[132:133], v1 offset:57344
 ds_read_b64_tr_b16 a[134:135], v1 offset:58368
M v[116:119], a[172:175], a[76:79], v[116:119]
 buffer_load_dwordx4 v13, s[48:51], s22 offen offset:1024   lds
M v[116:119], a[168:171], a[72:75], v[116:119]
M v[120:123], a[168:171], a[80:83], v[120:123]
M v[120:123], a[172:175], a[84:87], v[120:123]
 s_waitcnt lgkmcnt(4)
M v[124:127], a[172:175], a[92:95], v[124:127]
M v[124:127], a[168:171], a[88:91], v[124:127]
 buffer_load_dwordx4 v14, s[48:51], s22 offen offset:2048   lds
M v[128:131], a[160:163], a[32:35], v[128:131]
 ds_read_b128 a[168:171], v5 offset:18432
 ds_read_b128 a[172:175], v6 offset:18432
M v[128:131], a[164:167], a[36:39], v[128:131]
 ds_read_b64_tr_b16 a[136:137], v2 offset:49152
 ds_read_b64_tr_b16 a[138:139], v2 offset:50176
M v[132:135], a[164:167], a[44:47], v[132:135]
M v[132:135], a[160:163], a[40:43], v[132:135]
M v[136:139], a[160:163], a[48:51], v[136:139]
M v[136:139], a[164:167], a[52:55], v[136:139]
M v[140:143], a[164:167], a[60:63], v[140:143]
 buffer_load_dwordx4 v15, s[48:51], s22 offen offset:3072   lds
M v[140:143], a[160:163], a[56:59], v[140:143]
 s_add_u32 s22, s22, 2097152
 ds_read_b64_tr_b16 a[140:141], v2 offset:57344
 ds_read_b64_tr_b16 a[142:143], v2 offset:58368
M v[144:147], a[160:163], a[64:67], v[144:147]
M v[144:147], a[164:167], a[68:71], v[144:147]
M v[148:151], a[164:167], a[76:79], v[148:151]
M v[148:151], a[160:163], a[72:75], v[148:151]
 s_add_u32 m0, s23, 32768
M v[152:155], a[160:163], a[80:83], v[152:155]
 buffer_load_dwordx4 v8, s[16:19], s21 offen offset:0  nt lds
M v[152:155], a[164:167], a[84:87], v[152:155]
 s_waitcnt lgkmcnt(4)
M v[156:159], a[164:167], a[92:95], v[156:159]
 ds_read_b64_tr_b16 a[144:145], v3 offset:49152
 ds_read_b64_tr_b16 a[146:147], v3 offset:50176
M v[156:159], a[160:163], a[88:91], v[156:159]
M v[160:163], a[168:171], a[32:35], v[160:163]
 ds_read_b128 a[160:163], v5 offset:20480
 ds_read_b128 a[164:167], v6 offset:20480
M v[160:163], a[172:175], a[36:39], v[160:163]
M v[164:167], a[172:175], a[44:47], v[164:167]
 buffer_load_dwordx4 v9, s[16:19], s21 offen offset:1024  nt lds
M v[164:167], a[168:171], a[40:43], v[164:167]
M v[168:171], a[168:171], a[48:51], v[168:171]
M v[168:171], a[172:175], a[52:55], v[168:171]
 ds_read_b64_tr_b16 a[148:149], v3 offset:57344
 ds_read_b64_tr_b16 a[150:151], v3 offset:58368
M v[172:175], a[172:175], a[60:63], v[172:175]
M v[172:175], a[168:171], a[56:59], v[172:175]
M v[176:179], a[168:171], a[64:67], v[176:179]
M v[176:179], a[172:175], a[68:71], v[176:179]
 buffer_load_dwordx4 v10, s[16:19], s21 offen offset:2048  nt lds
M v[180:183], a[172:175], a[76:79], v[180:183]
M v[180:183], a[168:171], a[72:75], v[180:183]
M v[184:187], a[168:171], a[80:83], v[184:187]
 ds_read_b64_tr_b16 a[152:153], v4 offset:49152
 ds_read_b64_tr_b16 a[154:155], v4 offset:50176
M v[184:187], a[172:175], a[84:87], v[184:187]
 s_waitcnt lgkmcnt(4)
M v[188:191], a[172:175], a[92:95], v[188:191]
M v[188:191], a[168:171], a[88:91], v[188:191]
 buffer_load_dwordx4 v11, s[16:19], s21 offen offset:3072  nt lds
M v[192:195], a[160:163], a[32:35], v[192:195]
 s_add_u32 s21, s21, 128
 ds_read_b128 a[168:171], v5 offset:22528
 ds_read_b128 a[172:175], v6 offset:22528
M v[192:195], a[164:167], a[36:39], v[192:195]
M v[196:199], a[164:167], a[44:47], v[196:199]
M v[196:199], a[160:163], a[40:43], v[196:199]
 ds_read_b64_tr_b16 a[156:157], v4 offset:57344
 ds_read_b64_tr_b16 a[158:159], v4 offset:58368
M v[200:203], a[160:163], a[48:51], v[200:203]
 s_add_u32 m0, s87, 4096
M v[200:203], a[164:167], a[52:55], v[200:203]
 buffer_load_dwordx4 v25, s[60:63], s89 offen offset:0 nt lds
M v[204:207], a[164:167], a[60:63], v[204:207]
 s_add_u32 s89, s89, 114688
M v[204:207], a[160:163], a[56:59], v[204:207]
M v[208:211], a[160:163], a[64:67], v[208:211]
M v[208:211], a[164:167], a[68:71], v[208:211]
M v[212:215], a[164:167], a[76:79], v[212:215]
M v[212:215], a[160:163], a[72:75], v[212:215]
M v[216:219], a[160:163], a[80:83], v[216:219]
M v[216:219], a[164:167], a[84:87], v[216:219]
 s_waitcnt lgkmcnt(2)
M v[220:223], a[164:167], a[92:95], v[220:223]
 s_waitcnt vmcnt(18) lgkmcnt(0)
M v[220:223], a[160:163], a[88:91], v[220:223]
 s_barrier
M v[224:227], a[168:171], a[32:35], v[224:227]
 ds_read_b128 a[160:163], v5 offset:32768
 ds_read_b128 a[164:167], v6 offset:32768
M v[224:227], a[172:175], a[36:39], v[224:227]
 v_and_b32 v26, 48, v0
 v_lshlrev_b32 v26, 17, v26
M v[228:231], a[172:175], a[44:47], v[228:231]
 v_or_b32 v26, v26, v0
 v_lshl_add_u32 v26, v26, 7, s95
M v[228:231], a[168:171], a[40:43], v[228:231]
 buffer_load_dword a240, v26, s[76:79], 0 offen offset:0
M v[232:235], a[168:171], a[48:51], v[232:235]
M v[232:235], a[172:175], a[52:55], v[232:235]
M v[236:239], a[172:175], a[60:63], v[236:239]
M v[236:239], a[168:171], a[56:59], v[236:239]
M v[240:243], a[168:171], a[64:67], v[240:243]
M v[240:243], a[172:175], a[68:71], v[240:243]
M v[244:247], a[172:175], a[76:79], v[244:247]
M v[244:247], a[168:171], a[72:75], v[244:247]
M v[248:251], a[168:171], a[80:83], v[248:251]
M v[248:251], a[172:175], a[84:87], v[248:251]
 s_waitcnt lgkmcnt(0)
M v[252:255], a[172:175], a[92:95], v[252:255]
M v[252:255], a[168:171], a[88:91], v[252:255]
M a[0:3], a[160:163], a[96:99], a[0:3]
 ds_read_b128 a[168:171], v5 offset:34816
 ds_read_b128 a[172:175], v6 offset:34816
M a[0:3], a[164:167], a[100:103], a[0:3]
 ds_read_b64_tr_b16 a[32:33], v1 offset:0
 ds_read_b64_tr_b16 a[34:35], v1 offset:1024
M a[4:7], a[164:167], a[108:111], a[4:7]
 s_add_u32 m0, s24, 16384
M a[4:7], a[160:163], a[104:107], a[4:7]
 buffer_load_dwordx4 v12, s[48:51], s22 offen offset:0   lds
M a[8:11], a[160:163], a[112:115], a[8:11]
M a[8:11], a[164:167], a[116:119], a[8:11]
 s_lshl_b32 s67, s20, 11
M a[12:15], a[164:167], a[124:127], a[12:15]
 s_add_u32 s67, s67, 104914944
 ds_read_b64_tr_b16 a[36:37], v1 offset:8192
 ds_read_b64_tr_b16 a[38:39], v1 offset:9216
M a[12:15], a[160:163], a[120:123], a[12:15]
M a[16:19], a[160:163], a[128:131], a[16:19]
 buffer_load_dwordx4 v13, s[48:51], s22 offen offset:1024   lds
M a[16:19], a[164:167], a[132:135], a[16:19]
M a[20:23], a[164:167], a[140:143], a[20:23]
 buffer_load_dwordx4 v[16:19], v7, s[8:11], s67 offen offset:0 sc1
M a[20:23], a[160:163], a[136:139], a[20:23]
 ds_read_b64_tr_b16 a[40:41], v2 offset:0
 ds_read_b64_tr_b16 a[42:43], v2 offset:1024
M a[24:27], a[160:163], a[144:147], a[24:27]
 buffer_load_dwordx4 v[20:23], v7, s[8:11], s67 offen offset:1024 sc1
M a[24:27], a[164:167], a[148:151], a[24:27]
 s_waitcnt lgkmcnt(6)
M a[28:31], a[164:167], a[156:159], a[28:31]
 buffer_load_dwordx4 v14, s[48:51], s22 offen offset:2048   lds
M a[28:31], a[160:163], a[152:155], a[28:31]
M v[32:35], a[168:171], a[96:99], v[32:35]
 ds_read_b128 a[160:163], v5 offset:36864
 ds_read_b128 a[164:167], v6 offset:36864
M v[32:35], a[172:175], a[100:103], v[32:35]
 ds_read_b64_tr_b16 a[44:45], v2 offset:8192
 ds_read_b64_tr_b16 a[46:47], v2 offset:9216
M v[36:39], a[172:175], a[108:111], v[36:39]
 buffer_load_dwordx4 v15, s[48:51], s22 offen offset:3072   lds
M v[36:39], a[168:171], a[104:107], v[36:39]
 s_sub_u32 s22, s22, 2097024
M v[40:43], a[168:171], a[112:115], v[40:43]
M v[40:43], a[172:175], a[116:119], v[40:43]
 ds_read_b64_tr_b16 a[48:49], v3 offset:0
 ds_read_b64_tr_b16 a[50:51], v3 offset:1024
M v[44:47], a[172:175], a[124:127], v[44:47]
 s_add_u32 m0, s23, 49152
M v[44:47], a[168:171], a[120:123], v[44:47]
 buffer_load_dwordx4 v8, s[16:19], s21 offen offset:0  nt lds
M v[48:51], a[168:171], a[128:131], v[48:51]
M v[48:51], a[172:175], a[132:135], v[48:51]
M v[52:55], a[172:175], a[140:143], v[52:55]
 ds_read_b64_tr_b16 a[52:53], v3 offset:8192
 ds_read_b64_tr_b16 a[54:55], v3 offset:9216
M v[52:55], a[168:171], a[136:139], v[52:55]
M v[56:59], a[168:171], a[144:147], v[56:59]
 buffer_load_dwordx4 v9, s[16:19], s21 offen offset:1024  nt lds
M v[56:59], a[172:175], a[148:151], v[56:59]
 s_waitcnt lgkmcnt(6)
M v[60:63], a[172:175], a[156:159], v[60:63]
M v[60:63], a[168:171], a[152:155], v[60:63]
 ds_read_b64_tr_b16 a[56:57], v4 offset:0
 ds_read_b64_tr_b16 a[58:59], v4 offset:1024
M v[64:67], a[160:163], a[96:99], v[64:67]
 ds_read_b128 a[168:171], v5 offset:38912
 ds_read_b128 a[172:175], v6 offset:38912
M v[64:67], a[164:167], a[100:103], v[64:67]
 buffer_load_dwordx4 v10, s[16:19], s21 offen offset:2048  nt lds
M v[68:71], a[164:167], a[108:111], v[68:71]
M v[68:71], a[160:163], a[104:107], v[68:71]
M v[72:75], a[160:163], a[112:115], v[72:75]
 ds_read_b64_tr_b16 a[60:61], v4 offset:8192
 ds_read_b64_tr_b16 a[62:63], v4 offset:9216
M v[72:75], a[164:167], a[116:119], v[72:75]
M v[76:79], a[164:167], a[124:127], v[76:79]
 buffer_load_dwordx4 v11, s[16:19], s21 offen offset:3072  nt lds
M v[76:79], a[160:163], a[120:123], v[76:79]
 s_add_u32 s21, s21, 524160
M v[80:83], a[160:163], a[128:131], v[80:83]
M v[80:83], a[164:167], a[132:135], v[80:83]
M v[84:87], a[164:167], a[140:143], v[84:87]
M v[84:87], a[160:163], a[136:139], v[84:87]
M v[88:91], a[160:163], a[144:147], v[88:91]
M v[88:91], a[164:167], a[148:151], v[88:91]
 s_waitcnt lgkmcnt(2)
M v[92:95], a[164:167], a[156:159], v[92:95]
 s_waitcnt vmcnt(20) lgkmcnt(0)
M v[92:95], a[160:163], a[152:155], v[92:95]
 s_barrier
M v[96:99], a[168:171], a[96:99], v[96:99]
 ds_read_b128 a[160:163], v5 offset:49152
 ds_read_b128 a[164:167], v6 offset:49152
M v[96:99], a[172:175], a[100:103], v[96:99]
M v[100:103], a[172:175], a[108:111], v[100:103]
 s_add_u32 m0, s24, 32768
 ds_read_b64_tr_b16 a[64:65], v1 offset:16384
 ds_read_b64_tr_b16 a[66:67], v1 offset:17408
M v[100:103], a[168:171], a[104:107], v[100:103]
 buffer_load_dwordx4 v12, s[48:51], s22 offen offset:0   lds
M v[104:107], a[168:171], a[112:115], v[104:107]
M v[104:107], a[172:175], a[116:119], v[104:107]
M v[108:111], a[172:175], a[124:127], v[108:111]
M v[108:111], a[168:171], a[120:123], v[108:111]
M v[112:115], a[168:171], a[128:131], v[112:115]
M v[112:115], a[172:175], a[132:135], v[112:115]
 ds_read_b64_tr_b16 a[68:69], v1 offset:24576
 ds_read_b64_tr_b16 a[70:71], v1 offset:25600
M v[116:119], a[172:175], a[140:143], v[116:119]
 buffer_load_dwordx4 v13, s[48:51], s22 offen offset:1024   lds
M v[116:119], a[168:171], a[136:139], v[116:119]
M v[120:123], a[168:171], a[144:147], v[120:123]
M v[120:123], a[172:175], a[148:151], v[120:123]
 s_waitcnt lgkmcnt(4)
M v[124:127], a[172:175], a[156:159], v[124:127]
M v[124:127], a[168:171], a[152:155], v[124:127]
 buffer_load_dwordx4 v14, s[48:51], s22 offen offset:2048   lds
M v[128:131], a[160:163], a[96:99], v[128:131]
 ds_read_b128 a[168:171], v5 offset:51200
 ds_read_b128 a[172:175], v6 offset:51200
M v[128:131], a[164:167], a[100:103], v[128:131]
 ds_read_b64_tr_b16 a[72:73], v2 offset:16384
 ds_read_b64_tr_b16 a[74:75], v2 offset:17408
M v[132:135], a[164:167], a[108:111], v[132:135]
M v[132:135], a[160:163], a[104:107], v[132:135]
M v[136:139], a[160:163], a[112:115], v[136:139]
M v[136:139], a[164:167], a[116:119], v[136:139]
M v[140:143], a[164:167], a[124:127], v[140:143]
 buffer_load_dwordx4 v15, s[48:51], s22 offen offset:3072   lds
M v[140:143], a[160:163], a[120:123], v[140:143]
 s_add_u32 s22, s22, 2097152
 ds_read_b64_tr_b16 a[76:77], v2 offset:24576
 ds_read_b64_tr_b16 a[78:79], v2 offset:25600
M v[144:147], a[160:163], a[128:131], v[144:147]
M v[144:147], a[164:167], a[132:135], v[144:147]
M v[148:151], a[164:167], a[140:143], v[148:151]
M v[148:151], a[160:163], a[136:139], v[148:151]
 s_add_u32 m0, s23, 0
M v[152:155], a[160:163], a[144:147], v[152:155]
 buffer_load_dwordx4 v8, s[16:19], s21 offen offset:0  nt lds
M v[152:155], a[164:167], a[148:151], v[152:155]
 s_waitcnt lgkmcnt(4)
M v[156:159], a[164:167], a[156:159], v[156:159]
 ds_read_b64_tr_b16 a[80:81], v3 offset:16384
 ds_read_b64_tr_b16 a[82:83], v3 offset:17408
M v[156:159], a[160:163], a[152:155], v[156:159]
M v[160:163], a[168:171], a[96:99], v[160:163]
 ds_read_b128 a[160:163], v5 offset:53248
 ds_read_b128 a[164:167], v6 offset:53248
M v[160:163], a[172:175], a[100:103], v[160:163]
M v[164:167], a[172:175], a[108:111], v[164:167]
 buffer_load_dwordx4 v9, s[16:19], s21 offen offset:1024  nt lds
M v[164:167], a[168:171], a[104:107], v[164:167]
M v[168:171], a[168:171], a[112:115], v[168:171]
M v[168:171], a[172:175], a[116:119], v[168:171]
 ds_read_b64_tr_b16 a[84:85], v3 offset:24576
 ds_read_b64_tr_b16 a[86:87], v3 offset:25600
M v[172:175], a[172:175], a[124:127], v[172:175]
M v[172:175], a[168:171], a[120:123], v[172:175]
M v[176:179], a[168:171], a[128:131], v[176:179]
M v[176:179], a[172:175], a[132:135], v[176:179]
 buffer_load_dwordx4 v10, s[16:19], s21 offen offset:2048  nt lds
M v[180:183], a[172:175], a[140:143], v[180:183]
M v[180:183], a[168:171], a[136:139], v[180:183]
M v[184:187], a[168:171], a[144:147], v[184:187]
 ds_read_b64_tr_b16 a[88:89], v4 offset:16384
 ds_read_b64_tr_b16 a[90:91], v4 offset:17408
M v[184:187], a[172:175], a[148:151], v[184:187]
 s_waitcnt lgkmcnt(4)
M v[188:191], a[172:175], a[156:159], v[188:191]
M v[188:191], a[168:171], a[152:155], v[188:191]
 buffer_load_dwordx4 v11, s[16:19], s21 offen offset:3072  nt lds
M v[192:195], a[160:163], a[96:99], v[192:195]
 s_add_u32 s21, s21, 128
 ds_read_b128 a[168:171], v5 offset:55296
 ds_read_b128 a[172:175], v6 offset:55296
M v[192:195], a[164:167], a[100:103], v[192:195]
M v[196:199], a[164:167], a[108:111], v[196:199]
M v[196:199], a[160:163], a[104:107], v[196:199]
 ds_read_b64_tr_b16 a[92:93], v4 offset:24576
 ds_read_b64_tr_b16 a[94:95], v4 offset:25600
M v[200:203], a[160:163], a[112:115], v[200:203]
 s_add_u32 m0, s87, 5120
M v[200:203], a[164:167], a[116:119], v[200:203]
 buffer_load_dwordx4 v25, s[60:63], s89 offen offset:0 nt lds
M v[204:207], a[164:167], a[124:127], v[204:207]
 s_add_u32 s89, s89, 114688
M v[204:207], a[160:163], a[120:123], v[204:207]
M v[208:211], a[160:163], a[128:131], v[208:211]
M v[208:211], a[164:167], a[132:135], v[208:211]
M v[212:215], a[164:167], a[140:143], v[212:215]
M v[212:215], a[160:163], a[136:139], v[212:215]
M v[216:219], a[160:163], a[144:147], v[216:219]
M v[216:219], a[164:167], a[148:151], v[216:219]
 s_waitcnt lgkmcnt(2)
M v[220:223], a[164:167], a[156:159], v[220:223]
 s_waitcnt vmcnt(21) lgkmcnt(0)
M v[220:223], a[160:163], a[152:155], v[220:223]
 s_barrier
M v[224:227], a[168:171], a[96:99], v[224:227]
 ds_read_b128 a[160:163], v5 offset:0
 ds_read_b128 a[164:167], v6 offset:0
M v[224:227], a[172:175], a[100:103], v[224:227]
M v[228:231], a[172:175], a[108:111], v[228:231]
M v[228:231], a[168:171], a[104:107], v[228:231]
M v[232:235], a[168:171], a[112:115], v[232:235]
M v[232:235], a[172:175], a[116:119], v[232:235]
M v[236:239], a[172:175], a[124:127], v[236:239]
M v[236:239], a[168:171], a[120:123], v[236:239]
M v[240:243], a[168:171], a[128:131], v[240:243]
M v[240:243], a[172:175], a[132:135], v[240:243]
M v[244:247], a[172:175], a[140:143], v[244:247]
M v[244:247], a[168:171], a[136:139], v[244:247]
M v[248:251], a[168:171], a[144:147], v[248:251]
M v[248:251], a[172:175], a[148:151], v[248:251]
 s_waitcnt lgkmcnt(0)
M v[252:255], a[172:175], a[156:159], v[252:255]
M v[252:255], a[168:171], a[152:155], v[252:255]
M a[0:3], a[160:163], a[32:35], a[0:3]
 ds_read_b128 a[168:171], v5 offset:2048
 ds_read_b128 a[172:175], v6 offset:2048
M a[0:3], a[164:167], a[36:39], a[0:3]
 ds_read_b64_tr_b16 a[96:97], v1 offset:32768
 ds_read_b64_tr_b16 a[98:99], v1 offset:33792
M a[4:7], a[164:167], a[44:47], a[4:7]
 s_add_u32 m0, s24, 49152
M a[4:7], a[160:163], a[40:43], a[4:7]
 buffer_load_dwordx4 v12, s[48:51], s22 offen offset:0   lds
M a[8:11], a[160:163], a[48:51], a[8:11]
M a[8:11], a[164:167], a[52:55], a[8:11]
M a[12:15], a[164:167], a[60:63], a[12:15]
 ds_read_b64_tr_b16 a[100:101], v1 offset:40960
 ds_read_b64_tr_b16 a[102:103], v1 offset:41984
M a[12:15], a[160:163], a[56:59], a[12:15]
M a[16:19], a[160:163], a[64:67], a[16:19]
 buffer_load_dwordx4 v13, s[48:51], s22 offen offset:1024   lds
M a[16:19], a[164:167], a[68:71], a[16:19]
M a[20:23], a[164:167], a[76:79], a[20:23]
 s_waitcnt vmcnt(18)
 v_min3_u32 v28, v16, v17, v18
M a[20:23], a[160:163], a[72:75], a[20:23]
 ds_read_b64_tr_b16 a[104:105], v2 offset:32768
 ds_read_b64_tr_b16 a[106:107], v2 offset:33792
M a[24:27], a[160:163], a[80:83], a[24:27]
 s_waitcnt vmcnt(17)
 v_min3_u32 v28, v28, v19, v20
M a[24:27], a[164:167], a[84:87], a[24:27]
 s_waitcnt lgkmcnt(6)
 v_min3_u32 v28, v28, v21, v22
M a[28:31], a[164:167], a[92:95], a[28:31]
 buffer_load_dwordx4 v14, s[48:51], s22 offen offset:2048   lds
M a[28:31], a[160:163], a[88:91], a[28:31]
 v_min_u32 v28, v28, v23
M v[32:35], a[168:171], a[32:35], v[32:35]
 ds_read_b128 a[160:163], v5 offset:4096
 ds_read_b128 a[164:167], v6 offset:4096
M v[32:35], a[172:175], a[36:39], v[32:35]
 ds_read_b64_tr_b16 a[108:109], v2 offset:40960
 ds_read_b64_tr_b16 a[110:111], v2 offset:41984
M v[36:39], a[172:175], a[44:47], v[36:39]
 buffer_load_dwordx4 v15, s[48:51], s22 offen offset:3072   lds
M v[36:39], a[168:171], a[40:43], v[36:39]
 s_sub_u32 s22, s22, 2097024
 v_cmp_eq_u32 vcc, 0, v28
M v[40:43], a[168:171], a[48:51], v[40:43]
 s_nop 0
M v[40:43], a[172:175], a[52:55], v[40:43]
 s_cbranch_vccnz L_hs
L_hr:
 ds_read_b64_tr_b16 a[112:113], v3 offset:32768
 ds_read_b64_tr_b16 a[114:115], v3 offset:33792
M v[44:47], a[172:175], a[60:63], v[44:47]
 s_add_u32 m0, s23, 16384
 v_max_u32 v28, v16, v17
M v[44:47], a[168:171], a[56:59], v[44:47]
 buffer_load_dwordx4 v8, s[16:19], s21 offen offset:0  nt lds
M v[48:51], a[168:171], a[64:67], v[48:51]
 v_min_u32 v29, v16, v17
M v[48:51], a[172:175], a[68:71], v[48:51]
 v_med3_u32 v29, v28, v29, v18
M v[52:55], a[172:175], a[76:79], v[52:55]
 ds_read_b64_tr_b16 a[116:117], v3 offset:40960
 ds_read_b64_tr_b16 a[118:119], v3 offset:41984
M v[52:55], a[168:171], a[72:75], v[52:55]
 v_max_u32 v28, v28, v18
M v[56:59], a[168:171], a[80:83], v[56:59]
 buffer_load_dwordx4 v9, s[16:19], s21 offen offset:1024  nt lds
M v[56:59], a[172:175], a[84:87], v[56:59]
 s_waitcnt lgkmcnt(6)
 v_med3_u32 v29, v28, v29, v19
M v[60:63], a[172:175], a[92:95], v[60:63]
 v_max_u32 v28, v28, v19
M v[60:63], a[168:171], a[88:91], v[60:63]
 ds_read_b64_tr_b16 a[120:121], v4 offset:32768
 ds_read_b64_tr_b16 a[122:123], v4 offset:33792
M v[64:67], a[160:163], a[32:35], v[64:67]
 ds_read_b128 a[168:171], v5 offset:6144
 ds_read_b128 a[172:175], v6 offset:6144
M v[64:67], a[164:167], a[36:39], v[64:67]
 buffer_load_dwordx4 v10, s[16:19], s21 offen offset:2048  nt lds
M v[68:71], a[164:167], a[44:47], v[68:71]
 v_med3_u32 v29, v28, v29, v20
M v[68:71], a[160:163], a[40:43], v[68:71]
 v_max_u32 v28, v28, v20
M v[72:75], a[160:163], a[48:51], v[72:75]
 ds_read_b64_tr_b16 a[124:125], v4 offset:40960
 ds_read_b64_tr_b16 a[126:127], v4 offset:41984
M v[72:75], a[164:167], a[52:55], v[72:75]
 v_med3_u32 v29, v28, v29, v21
M v[76:79], a[164:167], a[60:63], v[76:79]
 buffer_load_dwordx4 v11, s[16:19], s21 offen offset:3072  nt lds
M v[76:79], a[160:163], a[56:59], v[76:79]
 s_add_u32 s21, s21, 524160
 v_max_u32 v28, v28, v21
M v[80:83], a[160:163], a[64:67], v[80:83]
 v_med3_u32 v29, v28, v29, v22
M v[80:83], a[164:167], a[68:71], v[80:83]
 v_max_u32 v28, v28, v22
M v[84:87], a[164:167], a[76:79], v[84:87]
 v_med3_u32 v29, v28, v29, v23
M v[84:87], a[160:163], a[72:75], v[84:87]
 v_max_u32 v28, v28, v23
M v[88:91], a[160:163], a[80:83], v[88:91]
 s_nop 0
 v_mov_b32 v30, v28 row_ror:8 row_mask:0xf bank_mask:0xf
M v[88:91], a[164:167], a[84:87], v[88:91]
 s_waitcnt lgkmcnt(2)
 v_mov_b32 v31, v29 row_ror:8 row_mask:0xf bank_mask:0xf
M v[92:95], a[164:167], a[92:95], v[92:95]
 s_waitcnt vmcnt(17) lgkmcnt(0)
 v_min_u32 v16, v28, v30
M v[92:95], a[160:163], a[88:91], v[92:95]
 s_barrier
M v[96:99], a[168:171], a[32:35], v[96:99]
 ds_read_b128 a[160:163], v5 offset:16384
 ds_read_b128 a[164:167], v6 offset:16384
M v[96:99], a[172:175], a[36:39], v[96:99]
 v_max_u32 v28, v28, v30
M v[100:103], a[172:175], a[44:47], v[100:103]
 s_add_u32 m0, s24, 0
 ds_read_b64_tr_b16 a[128:129], v1 offset:49152
 ds_read_b64_tr_b16 a[130:131], v1 offset:50176
M v[100:103], a[168:171], a[40:43], v[100:103]
 buffer_load_dwordx4 v12, s[48:51], s22 offen offset:0   lds
M v[104:107], a[168:171], a[48:51], v[104:107]
 v_max3_u32 v29, v29, v31, v16
M v[104:107], a[172:175], a[52:55], v[104:107]
 v_mov_b32 v30, v28 row_ror:4 row_mask:0xf bank_mask:0xf
M v[108:111], a[172:175], a[60:63], v[108:111]
 v_mov_b32 v31, v29 row_ror:4 row_mask:0xf bank_mask:0xf
M v[108:111], a[168:171], a[56:59], v[108:111]
 v_min_u32 v16, v28, v30
M v[112:115], a[168:171], a[64:67], v[112:115]
 v_max_u32 v28, v28, v30
M v[112:115], a[172:175], a[68:71], v[112:115]
 ds_read_b64_tr_b16 a[132:133], v1 offset:57344
 ds_read_b64_tr_b16 a[134:135], v1 offset:58368
M v[116:119], a[172:175], a[76:79], v[116:119]
 buffer_load_dwordx4 v13, s[48:51], s22 offen offset:1024   lds
M v[116:119], a[168:171], a[72:75], v[116:119]
 v_max3_u32 v29, v29, v31, v16
M v[120:123], a[168:171], a[80:83], v[120:123]
 v_mov_b32 v30, v28 row_ror:2 row_mask:0xf bank_mask:0xf
M v[120:123], a[172:175], a[84:87], v[120:123]
 s_waitcnt lgkmcnt(4)
 v_mov_b32 v31, v29 row_ror:2 row_mask:0xf bank_mask:0xf
M v[124:127], a[172:175], a[92:95], v[124:127]
 v_min_u32 v16, v28, v30
M v[124:127], a[168:171], a[88:91], v[124:127]
 buffer_load_dwordx4 v14, s[48:51], s22 offen offset:2048   lds
M v[128:131], a[160:163], a[32:35], v[128:131]
 ds_read_b128 a[168:171], v5 offset:18432
 ds_read_b128 a[172:175], v6 offset:18432
M v[128:131], a[164:167], a[36:39], v[128:131]
 ds_read_b64_tr_b16 a[136:137], v2 offset:49152
 ds_read_b64_tr_b16 a[138:139], v2 offset:50176
M v[132:135], a[164:167], a[44:47], v[132:135]
 v_max_u32 v28, v28, v30
M v[132:135], a[160:163], a[40:43], v[132:135]
 v_max3_u32 v29, v29, v31, v16
M v[136:139], a[160:163], a[48:51], v[136:139]
 v_mov_b32 v30, v28 row_ror:1 row_mask:0xf bank_mask:0xf
M v[136:139], a[164:167], a[52:55], v[136:139]
 v_mov_b32 v31, v29 row_ror:1 row_mask:0xf bank_mask:0xf
M v[140:143], a[164:167], a[60:63], v[140:143]
 buffer_load_dwordx4 v15, s[48:51], s22 offen offset:3072   lds
M v[140:143], a[160:163], a[56:59], v[140:143]
 s_add_u32 s22, s22, 2097152
 ds_read_b64_tr_b16 a[140:141], v2 offset:57344
 ds_read_b64_tr_b16 a[142:143], v2 offset:58368
M v[144:147], a[160:163], a[64:67], v[144:147]
 v_min_u32 v16, v28, v30
M v[144:147], a[164:167], a[68:71], v[144:147]
 v_max_u32 v28, v28, v30
M v[148:151], a[164:167], a[76:79], v[148:151]
 v_max3_u32 v29, v29, v31, v16
M v[148:151], a[160:163], a[72:75], v[148:151]
 s_add_u32 m0, s23, 32768
 v_mov_b32 v30, v28
M v[152:155], a[160:163], a[80:83], v[152:155]
 buffer_load_dwordx4 v8, s[16:19], s21 offen offset:0  nt lds
M v[152:155], a[164:167], a[84:87], v[152:155]
 s_waitcnt lgkmcnt(4)
 v_mov_b32 v31, v29
M v[156:159], a[164:167], a[92:95], v[156:159]
 ds_read_b64_tr_b16 a[144:145], v3 offset:49152
 ds_read_b64_tr_b16 a[146:147], v3 offset:50176
M v[156:159], a[160:163], a[88:91], v[156:159]
 v_permlane16_swap_b32 v30, v28
M v[160:163], a[168:171], a[32:35], v[160:163]
 ds_read_b128 a[160:163], v5 offset:20480
 ds_read_b128 a[164:167], v6 offset:20480
M v[160:163], a[172:175], a[36:39], v[160:163]
 v_permlane16_swap_b32 v31, v29
M v[164:167], a[172:175], a[44:47], v[164:167]
 buffer_load_dwordx4 v9, s[16:19], s21 offen offset:1024  nt lds
M v[164:167], a[168:171], a[40:43], v[164:167]
 v_min_u32 v16, v28, v30
M v[168:171], a[168:171], a[48:51], v[168:171]
 v_max_u32 v28, v28, v30
M v[168:171], a[172:175], a[52:55], v[168:171]
 ds_read_b64_tr_b16 a[148:149], v3 offset:57344
 ds_read_b64_tr_b16 a[150:151], v3 offset:58368
M v[172:175], a[172:175], a[60:63], v[172:175]
 v_max3_u32 v29, v29, v31, v16
M v[172:175], a[168:171], a[56:59], v[172:175]
 v_mov_b32 v30, v28
M v[176:179], a[168:171], a[64:67], v[176:179]
 v_mov_b32 v31, v29
M v[176:179], a[172:175], a[68:71], v[176:179]
 buffer_load_dwordx4 v10, s[16:19], s21 offen offset:2048  nt lds
M v[180:183], a[172:175], a[76:79], v[180:183]
 v_permlane32_swap_b32 v30, v28
M v[180:183], a[168:171], a[72:75], v[180:183]
 v_permlane32_swap_b32 v31, v29
M v[184:187], a[168:171], a[80:83], v[184:187]
 ds_read_b64_tr_b16 a[152:153], v4 offset:49152
 ds_read_b64_tr_b16 a[154:155], v4 offset:50176
M v[184:187], a[172:175], a[84:87], v[184:187]
 s_waitcnt lgkmcnt(4)
 v_min_u32 v16, v28, v30
M v[188:191], a[172:175], a[92:95], v[188:191]
 v_max_u32 v28, v28, v30
M v[188:191], a[168:171], a[88:91], v[188:191]
 buffer_load_dwordx4 v11, s[16:19], s21 offen offset:3072  nt lds
M v[192:195], a[160:163], a[32:35], v[192:195]
 s_add_u32 s21, s21, 128
 ds_read_b128 a[168:171], v5 offset:22528
 ds_read_b128 a[172:175], v6 offset:22528
M v[192:195], a[164:167], a[36:39], v[192:195]
 v_max3_u32 v29, v29, v31, v16
M v[196:199], a[164:167], a[44:47], v[196:199]
 s_lshl_b32 s64, s20, 3
M v[196:199], a[160:163], a[40:43], v[196:199]
 s_add_u32 s64, s64, 159744
 ds_read_b64_tr_b16 a[156:157], v4 offset:57344
 ds_read_b64_tr_b16 a[158:159], v4 offset:58368
M v[200:203], a[160:163], a[48:51], v[200:203]
 s_add_u32 m0, s87, 6144
 v_mov_b32 v16, s64
M v[200:203], a[164:167], a[52:55], v[200:203]
 buffer_load_dwordx4 v25, s[60:63], s89 offen offset:0 nt lds
M v[204:207], a[164:167], a[60:63], v[204:207]
 s_add_u32 s89, s89, 114688
 ds_write_b64 v16, v[28:29]
M v[204:207], a[160:163], a[56:59], v[204:207]
M v[208:211], a[160:163], a[64:67], v[208:211]
M v[208:211], a[164:167], a[68:71], v[208:211]
M v[212:215], a[164:167], a[76:79], v[212:215]
M v[212:215], a[160:163], a[72:75], v[212:215]
M v[216:219], a[160:163], a[80:83], v[216:219]
M v[216:219], a[164:167], a[84:87], v[216:219]
 s_waitcnt lgkmcnt(3)
M v[220:223], a[164:167], a[92:95], v[220:223]
 s_waitcnt vmcnt(18) lgkmcnt(0)
M v[220:223], a[160:163], a[88:91], v[220:223]
 s_barrier
M v[224:227], a[168:171], a[32:35], v[224:227]
 ds_read_b128 a[160:163], v5 offset:32768
 ds_read_b128 a[164:167], v6 offset:32768
M v[224:227], a[172:175], a[36:39], v[224:227]
 buffer_load_dword a240, v24, s[32:35], 0 offen offset:1536
M v[228:231], a[172:175], a[44:47], v[228:231]
M v[228:231], a[168:171], a[40:43], v[228:231]
M v[232:235], a[168:171], a[48:51], v[232:235]
M v[232:235], a[172:175], a[52:55], v[232:235]
M v[236:239], a[172:175], a[60:63], v[236:239]
M v[236:239], a[168:171], a[56:59], v[236:239]
M v[240:243], a[168:171], a[64:67], v[240:243]
M v[240:243], a[172:175], a[68:71], v[240:243]
M v[244:247], a[172:175], a[76:79], v[244:247]
M v[244:247], a[168:171], a[72:75], v[244:247]
M v[248:251], a[168:171], a[80:83], v[248:251]
M v[248:251], a[172:175], a[84:87], v[248:251]
 s_waitcnt lgkmcnt(0)
M v[252:255], a[172:175], a[92:95], v[252:255]
M v[252:255], a[168:171], a[88:91], v[252:255]
M a[0:3], a[160:163], a[96:99], a[0:3]
 ds_read_b128 a[168:171], v5 offset:34816
 ds_read_b128 a[172:175], v6 offset:34816
M a[0:3], a[164:167], a[100:103], a[0:3]
 ds_read_b64_tr_b16 a[32:33], v1 offset:0
 ds_read_b64_tr_b16 a[34:35], v1 offset:1024
M a[4:7], a[164:167], a[108:111], a[4:7]
 s_add_u32 m0, s24, 16384
M a[4:7], a[160:163], a[104:107], a[4:7]
 buffer_load_dwordx4 v12, s[48:51], s22 offen offset:0   lds
M a[8:11], a[160:163], a[112:115], a[8:11]
 v_mov_b32 v28, 159744
M a[8:11], a[164:167], a[116:119], a[8:11]
 ds_read_b128 v[16:19], v28
M a[12:15], a[164:167], a[124:127], a[12:15]
 ds_read_b64_tr_b16 a[36:37], v1 offset:8192
 ds_read_b64_tr_b16 a[38:39], v1 offset:9216
M a[12:15], a[160:163], a[120:123], a[12:15]
 ds_read_b128 v[20:23], v28 offset:16
M a[16:19], a[160:163], a[128:131], a[16:19]
 buffer_load_dwordx4 v13, s[48:51], s22 offen offset:1024   lds
M a[16:19], a[164:167], a[132:135], a[16:19]
M a[20:23], a[164:167], a[140:143], a[20:23]
M a[20:23], a[160:163], a[136:139], a[20:23]
 ds_read_b64_tr_b16 a[40:41], v2 offset:0
 ds_read_b64_tr_b16 a[42:43], v2 offset:1024
M a[24:27], a[160:163], a[144:147], a[24:27]
M a[24:27], a[164:167], a[148:151], a[24:27]
 s_waitcnt lgkmcnt(8)
M a[28:31], a[164:167], a[156:159], a[28:31]
 buffer_load_dwordx4 v14, s[48:51], s22 offen offset:2048   lds
M a[28:31], a[160:163], a[152:155], a[28:31]
M v[32:35], a[168:171], a[96:99], v[32:35]
 ds_read_b128 a[160:163], v5 offset:36864
 ds_read_b128 a[164:167], v6 offset:36864
M v[32:35], a[172:175], a[100:103], v[32:35]
 ds_read_b64_tr_b16 a[44:45], v2 offset:8192
 ds_read_b64_tr_b16 a[46:47], v2 offset:9216
M v[36:39], a[172:175], a[108:111], v[36:39]
 buffer_load_dwordx4 v15, s[48:51], s22 offen offset:3072   lds
M v[36:39], a[168:171], a[104:107], v[36:39]
 s_sub_u32 s22, s22, 2097024
 s_waitcnt lgkmcnt(9)
 v_min_u32 v28, v16, v18
M v[40:43], a[168:171], a[112:115], v[40:43]
 v_max_u32 v16, v16, v18
M v[40:43], a[172:175], a[116:119], v[40:43]
 ds_read_b64_tr_b16 a[48:49], v3 offset:0
 ds_read_b64_tr_b16 a[50:51], v3 offset:1024
M v[44:47], a[172:175], a[124:127], v[44:47]
 s_add_u32 m0, s23, 49152
 v_max3_u32 v17, v17, v19, v28
M v[44:47], a[168:171], a[120:123], v[44:47]
 buffer_load_dwordx4 v8, s[16:19], s21 offen offset:0  nt lds
M v[48:51], a[168:171], a[128:131], v[48:51]
 s_waitcnt lgkmcnt(8)
 v_min_u32 v29, v20, v22
M v[48:51], a[172:175], a[132:135], v[48:51]
 v_max_u32 v20, v20, v22
M v[52:55], a[172:175], a[140:143], v[52:55]
 ds_read_b64_tr_b16 a[52:53], v3 offset:8192
 ds_read_b64_tr_b16 a[54:55], v3 offset:9216
M v[52:55], a[168:171], a[136:139], v[52:55]
 v_max3_u32 v21, v21, v23, v29
M v[56:59], a[168:171], a[144:147], v[56:59]
 buffer_load_dwordx4 v9, s[16:19], s21 offen offset:1024  nt lds
M v[56:59], a[172:175], a[148:151], v[56:59]
 s_waitcnt lgkmcnt(6)
 v_min_u32 v28, v16, v20
M v[60:63], a[172:175], a[156:159], v[60:63]
 v_max_u32 v16, v16, v20
M v[60:63], a[168:171], a[152:155], v[60:63]
 ds_read_b64_tr_b16 a[56:57], v4 offset:0
 ds_read_b64_tr_b16 a[58:59], v4 offset:1024
M v[64:67], a[160:163], a[96:99], v[64:67]
 ds_read_b128 a[168:171], v5 offset:38912
 ds_read_b128 a[172:175], v6 offset:38912
M v[64:67], a[164:167], a[100:103], v[64:67]
 buffer_load_dwordx4 v10, s[16:19], s21 offen offset:2048  nt lds
M v[68:71], a[164:167], a[108:111], v[68:71]
 v_max3_u32 v17, v17, v21, v28
M v[68:71], a[160:163], a[104:107], v[68:71]
 v_and_b32 v28, 1, v0
M v[72:75], a[160:163], a[112:115], v[72:75]
 ds_read_b64_tr_b16 a[60:61], v4 offset:8192
 ds_read_b64_tr_b16 a[62:63], v4 offset:9216
M v[72:75], a[164:167], a[116:119], v[72:75]
 v_cmp_eq_u32 vcc, 0, v28
M v[76:79], a[164:167], a[124:127], v[76:79]
 buffer_load_dwordx4 v11, s[16:19], s21 offen offset:3072  nt lds
M v[76:79], a[160:163], a[120:123], v[76:79]
 s_add_u32 s21, s21, 524160
 s_and_b32 s64, s20, 1
M v[80:83], a[160:163], a[128:131], v[80:83]
 s_mul_i32 s64, s64, 448
 v_cndmask_b32 v24, v17, v16, vcc
M v[80:83], a[164:167], a[132:135], v[80:83]
 v_and_b32 v24, 0x7ff, v24
M v[84:87], a[164:167], a[140:143], v[84:87]
 v_sub_u32 v24, 2047, v24
M v[84:87], a[160:163], a[136:139], v[84:87]
 v_mul_u32_u24 v28, 896, v24
M v[88:91], a[160:163], a[144:147], v[88:91]
 v_lshrrev_b32 v29, 4, v0
M v[88:91], a[164:167], a[148:151], v[88:91]
 s_waitcnt lgkmcnt(2)
 v_lshl_add_u32 v28, v29, 4, v28
M v[92:95], a[164:167], a[156:159], v[92:95]
 s_waitcnt vmcnt(18) lgkmcnt(0)
 v_bfe_u32 v30, v0, 1, 3
M v[92:95], a[160:163], a[152:155], v[92:95]
 s_barrier
M v[96:99], a[168:171], a[96:99], v[96:99]
 ds_read_b128 a[160:163], v5 offset:49152
 ds_read_b128 a[164:167], v6 offset:49152
M v[96:99], a[172:175], a[100:103], v[96:99]
 v_lshl_or_b32 v28, v30, 26, v28
M v[100:103], a[172:175], a[108:111], v[100:103]
 s_add_u32 m0, s24, 32768
 ds_read_b64_tr_b16 a[64:65], v1 offset:16384
 ds_read_b64_tr_b16 a[66:67], v1 offset:17408
M v[100:103], a[168:171], a[104:107], v[100:103]
 buffer_load_dwordx4 v12, s[48:51], s22 offen offset:0   lds
M v[104:107], a[168:171], a[112:115], v[104:107]
M v[104:107], a[172:175], a[116:119], v[104:107]
M v[108:111], a[172:175], a[124:127], v[108:111]
 buffer_load_dwordx4 a[208:211], v28, s[56:59], s64 offen offset:0
M v[108:111], a[168:171], a[120:123], v[108:111]
M v[112:115], a[168:171], a[128:131], v[112:115]
 buffer_load_dwordx4 a[212:215], v28, s[56:59], s64 offen offset:64
M v[112:115], a[172:175], a[132:135], v[112:115]
 ds_read_b64_tr_b16 a[68:69], v1 offset:24576
 ds_read_b64_tr_b16 a[70:71], v1 offset:25600
M v[116:119], a[172:175], a[140:143], v[116:119]
 buffer_load_dwordx4 v13, s[48:51], s22 offen offset:1024   lds
M v[116:119], a[168:171], a[136:139], v[116:119]
M v[120:123], a[168:171], a[144:147], v[120:123]
M v[120:123], a[172:175], a[148:151], v[120:123]
 s_waitcnt lgkmcnt(4)
M v[124:127], a[172:175], a[156:159], v[124:127]
 buffer_load_dwordx4 a[216:219], v28, s[56:59], s64 offen offset:128
M v[124:127], a[168:171], a[152:155], v[124:127]
M v[128:131], a[160:163], a[96:99], v[128:131]
 ds_read_b128 a[168:171], v5 offset:51200
 ds_read_b128 a[172:175], v6 offset:51200
M v[128:131], a[164:167], a[100:103], v[128:131]
 ds_read_b64_tr_b16 a[72:73], v2 offset:16384
 ds_read_b64_tr_b16 a[74:75], v2 offset:17408
M v[132:135], a[164:167], a[108:111], v[132:135]
 buffer_load_dwordx4 v14, s[48:51], s22 offen offset:2048   lds
M v[132:135], a[160:163], a[104:107], v[132:135]
M v[136:139], a[160:163], a[112:115], v[136:139]
 buffer_load_dwordx4 a[220:223], v28, s[56:59], s64 offen offset:192
M v[136:139], a[164:167], a[116:119], v[136:139]
M v[140:143], a[164:167], a[124:127], v[140:143]
 buffer_load_dwordx4 a[224:227], v28, s[56:59], s64 offen offset:256
M v[140:143], a[160:163], a[120:123], v[140:143]
 ds_read_b64_tr_b16 a[76:77], v2 offset:24576
 ds_read_b64_tr_b16 a[78:79], v2 offset:25600
M v[144:147], a[160:163], a[128:131], v[144:147]
 buffer_load_dwordx4 v15, s[48:51], s22 offen offset:3072   lds
M v[144:147], a[164:167], a[132:135], v[144:147]
 s_add_u32 s22, s22, 2097152
M v[148:151], a[164:167], a[140:143], v[148:151]
M v[148:151], a[160:163], a[136:139], v[148:151]
 buffer_load_dwordx4 a[228:231], v28, s[56:59], s64 offen offset:320
M v[152:155], a[160:163], a[144:147], v[152:155]
M v[152:155], a[164:167], a[148:151], v[152:155]
 s_waitcnt lgkmcnt(4)
M v[156:159], a[164:167], a[156:159], v[156:159]
 s_add_u32 m0, s23, 0
 ds_read_b64_tr_b16 a[80:81], v3 offset:16384
 ds_read_b64_tr_b16 a[82:83], v3 offset:17408
M v[156:159], a[160:163], a[152:155], v[156:159]
 buffer_load_dwordx4 v8, s[16:19], s21 offen offset:0  nt lds
M v[160:163], a[168:171], a[96:99], v[160:163]
 ds_read_b128 a[160:163], v5 offset:53248
 ds_read_b128 a[164:167], v6 offset:53248
M v[160:163], a[172:175], a[100:103], v[160:163]
 buffer_load_dwordx4 a[232:235], v28, s[56:59], s64 offen offset:384
M v[164:167], a[172:175], a[108:111], v[164:167]
 v_lshrrev_b32 v28, 4, v24
M v[164:167], a[168:171], a[104:107], v[164:167]
 v_lshlrev_b32 v28, 5, v28
M v[168:171], a[168:171], a[112:115], v[168:171]
 v_and_b32 v30, 15, v24
M v[168:171], a[172:175], a[116:119], v[168:171]
 ds_read_b64_tr_b16 a[84:85], v3 offset:24576
 ds_read_b64_tr_b16 a[86:87], v3 offset:25600
M v[172:175], a[172:175], a[124:127], v[172:175]
 buffer_load_dwordx4 v9, s[16:19], s21 offen offset:1024  nt lds
M v[172:175], a[168:171], a[120:123], v[172:175]
 v_add_lshl_u32 v28, v28, v30, 2
M v[176:179], a[168:171], a[128:131], v[176:179]
 v_lshrrev_b32 v30, 1, v0
M v[176:179], a[172:175], a[132:135], v[176:179]
 v_min_u32 v30, 1, v30
M v[180:183], a[172:175], a[140:143], v[180:183]
 v_lshl_or_b32 v28, v30, 29, v28
M v[180:183], a[168:171], a[136:139], v[180:183]
 s_mov_b32 s64, 104857600
M v[184:187], a[168:171], a[144:147], v[184:187]
 ds_read_b64_tr_b16 a[88:89], v4 offset:16384
 ds_read_b64_tr_b16 a[90:91], v4 offset:17408
M v[184:187], a[172:175], a[148:151], v[184:187]
 s_waitcnt lgkmcnt(4)
M v[188:191], a[172:175], a[156:159], v[188:191]
 buffer_load_dwordx4 v10, s[16:19], s21 offen offset:2048  nt lds
M v[188:191], a[168:171], a[152:155], v[188:191]
 buffer_load_dword v23, v28, s[8:11], s64 offen sc1
M v[192:195], a[160:163], a[96:99], v[192:195]
 ds_read_b128 a[168:171], v5 offset:55296
 ds_read_b128 a[172:175], v6 offset:55296
M v[192:195], a[164:167], a[100:103], v[192:195]
 v_bfe_u32 v28, v0, 2, 2
M v[196:199], a[164:167], a[108:111], v[196:199]
 v_lshl_add_u32 v28, v29, 3, v28
M v[196:199], a[160:163], a[104:107], v[196:199]
 ds_read_b64_tr_b16 a[92:93], v4 offset:24576
 ds_read_b64_tr_b16 a[94:95], v4 offset:25600
M v[200:203], a[160:163], a[112:115], v[200:203]
 buffer_load_dwordx4 v11, s[16:19], s21 offen offset:3072  nt lds
M v[200:203], a[164:167], a[116:119], v[200:203]
 s_add_u32 s21, s21, 128
 v_lshlrev_b32 v28, 5, v28
M v[204:207], a[164:167], a[124:127], v[204:207]
 v_and_b32 v30, 3, v0
M v[204:207], a[160:163], a[120:123], v[204:207]
 v_lshl_add_u32 v28, v30, 3, v28
M v[208:211], a[160:163], a[128:131], v[208:211]
 v_add_u32 v22, s87, v28
M v[208:211], a[164:167], a[132:135], v[208:211]
M v[212:215], a[164:167], a[140:143], v[212:215]
M v[212:215], a[160:163], a[136:139], v[212:215]
M v[216:219], a[160:163], a[144:147], v[216:219]
M v[216:219], a[164:167], a[148:151], v[216:219]
 s_waitcnt lgkmcnt(2)
M v[220:223], a[164:167], a[156:159], v[220:223]
 s_waitcnt vmcnt(26) lgkmcnt(0)
M v[220:223], a[160:163], a[152:155], v[220:223]
 s_barrier
M v[224:227], a[168:171], a[96:99], v[224:227]
 ds_read_b128 a[160:163], v5 offset:0
 ds_read_b128 a[164:167], v6 offset:0
M v[224:227], a[172:175], a[100:103], v[224:227]
M v[228:231], a[172:175], a[108:111], v[228:231]
M v[228:231], a[168:171], a[104:107], v[228:231]
M v[232:235], a[168:171], a[112:115], v[232:235]
M v[232:235], a[172:175], a[116:119], v[232:235]
M v[236:239], a[172:175], a[124:127], v[236:239]
M v[236:239], a[168:171], a[120:123], v[236:239]
M v[240:243], a[168:171], a[128:131], v[240:243]
M v[240:243], a[172:175], a[132:135], v[240:243]
M v[244:247], a[172:175], a[140:143], v[244:247]
M v[244:247], a[168:171], a[136:139], v[244:247]
M v[248:251], a[168:171], a[144:147], v[248:251]
M v[248:251], a[172:175], a[148:151], v[248:251]
 s_waitcnt lgkmcnt(0)
M v[252:255], a[172:175], a[156:159], v[252:255]
M v[252:255], a[168:171], a[152:155], v[252:255]
M a[0:3], a[160:163], a[32:35], a[0:3]
 ds_read_b128 a[168:171], v5 offset:2048
 ds_read_b128 a[172:175], v6 offset:2048
M a[0:3], a[164:167], a[36:39], a[0:3]
 ds_read_b64_tr_b16 a[96:97], v1 offset:32768
 ds_read_b64_tr_b16 a[98:99], v1 offset:33792
M a[4:7], a[164:167], a[44:47], a[4:7]
 s_add_u32 m0, s24, 49152
M a[4:7], a[160:163], a[40:43], a[4:7]
 buffer_load_dwordx4 v12, s[48:51], s22 offen offset:0   lds
M a[8:11], a[160:163], a[48:51], a[8:11]
M a[8:11], a[164:167], a[52:55], a[8:11]
M a[12:15], a[164:167], a[60:63], a[12:15]
 ds_read_b64_tr_b16 a[100:101], v1 offset:40960
 ds_read_b64_tr_b16 a[102:103], v1 offset:41984
M a[12:15], a[160:163], a[56:59], a[12:15]
M a[16:19], a[160:163], a[64:67], a[16:19]
 buffer_load_dwordx4 v13, s[48:51], s22 offen offset:1024   lds
M a[16:19], a[164:167], a[68:71], a[16:19]
M a[20:23], a[164:167], a[76:79], a[20:23]
M a[20:23], a[160:163], a[72:75], a[20:23]
 ds_read_b64_tr_b16 a[104:105], v2 offset:32768
 ds_read_b64_tr_b16 a[106:107], v2 offset:33792
M a[24:27], a[160:163], a[80:83], a[24:27]
M a[24:27], a[164:167], a[84:87], a[24:27]
 s_waitcnt lgkmcnt(6)
M a[28:31], a[164:167], a[92:95], a[28:31]
 buffer_load_dwordx4 v14, s[48:51], s22 offen offset:2048   lds
M a[28:31], a[160:163], a[88:91], a[28:31]
M v[32:35], a[168:171], a[32:35], v[32:35]
 ds_read_b128 a[160:163], v5 offset:4096
 ds_read_b128 a[164:167], v6 offset:4096
M v[32:35], a[172:175], a[36:39], v[32:35]
 ds_read_b64_tr_b16 a[108:109], v2 offset:40960
 ds_read_b64_tr_b16 a[110:111], v2 offset:41984
M v[36:39], a[172:175], a[44:47], v[36:39]
 buffer_load_dwordx4 v15, s[48:51], s22 offen offset:3072   lds
M v[36:39], a[168:171], a[40:43], v[36:39]
 s_sub_u32 s22, s22, 2097024
M v[40:43], a[168:171], a[48:51], v[40:43]
M v[40:43], a[172:175], a[52:55], v[40:43]
 ds_read_b64_tr_b16 a[112:113], v3 offset:32768
 ds_read_b64_tr_b16 a[114:115], v3 offset:33792
M v[44:47], a[172:175], a[60:63], v[44:47]
 s_add_u32 m0, s23, 16384
M v[44:47], a[168:171], a[56:59], v[44:47]
 buffer_load_dwordx4 v8, s[16:19], s21 offen offset:0  nt lds
M v[48:51], a[168:171], a[64:67], v[48:51]
M v[48:51], a[172:175], a[68:71], v[48:51]
M v[52:55], a[172:175], a[76:79], v[52:55]
 ds_read_b64_tr_b16 a[116:117], v3 offset:40960
 ds_read_b64_tr_b16 a[118:119], v3 offset:41984
M v[52:55], a[168:171], a[72:75], v[52:55]
M v[56:59], a[168:171], a[80:83], v[56:59]
 buffer_load_dwordx4 v9, s[16:19], s21 offen offset:1024  nt lds
M v[56:59], a[172:175], a[84:87], v[56:59]
 s_waitcnt lgkmcnt(6)
M v[60:63], a[172:175], a[92:95], v[60:63]
M v[60:63], a[168:171], a[88:91], v[60:63]
 ds_read_b64_tr_b16 a[120:121], v4 offset:32768
 ds_read_b64_tr_b16 a[122:123], v4 offset:33792
M v[64:67], a[160:163], a[32:35], v[64:67]
 ds_read_b128 a[168:171], v5 offset:6144
 ds_read_b128 a[172:175], v6 offset:6144
M v[64:67], a[164:167], a[36:39], v[64:67]
 buffer_load_dwordx4 v10, s[16:19], s21 offen offset:2048  nt lds
M v[68:71], a[164:167], a[44:47], v[68:71]
M v[68:71], a[160:163], a[40:43], v[68:71]
M v[72:75], a[160:163], a[48:51], v[72:75]
 ds_read_b64_tr_b16 a[124:125], v4 offset:40960
 ds_read_b64_tr_b16 a[126:127], v4 offset:41984
M v[72:75], a[164:167], a[52:55], v[72:75]
M v[76:79], a[164:167], a[60:63], v[76:79]
 buffer_load_dwordx4 v11, s[16:19], s21 offen offset:3072  nt lds
M v[76:79], a[160:163], a[56:59], v[76:79]
 s_add_u32 s21, s21, 524160
M v[80:83], a[160:163], a[64:67], v[80:83]
M v[80:83], a[164:167], a[68:71], v[80:83]
M v[84:87], a[164:167], a[76:79], v[84:87]
M v[84:87], a[160:163], a[72:75], v[84:87]
M v[88:91], a[160:163], a[80:83], v[88:91]
M v[88:91], a[164:167], a[84:87], v[88:91]
 s_waitcnt lgkmcnt(2)
M v[92:95], a[164:167], a[92:95], v[92:95]
 s_waitcnt vmcnt(24) lgkmcnt(0)
M v[92:95], a[160:163], a[88:91], v[92:95]
 s_barrier
M v[96:99], a[168:171], a[32:35], v[96:99]
 ds_read_b128 a[160:163], v5 offset:16384
 ds_read_b128 a[164:167], v6 offset:16384
M v[96:99], a[172:175], a[36:39], v[96:99]
M v[100:103], a[172:175], a[44:47], v[100:103]
 s_add_u32 m0, s24, 0
 ds_read_b64_tr_b16 a[128:129], v1 offset:49152
 ds_read_b64_tr_b16 a[130:131], v1 offset:50176
M v[100:103], a[168:171], a[40:43], v[100:103]
 buffer_load_dwordx4 v12, s[48:51], s22 offen offset:0   lds
M v[104:107], a[168:171], a[48:51], v[104:107]
 ds_read_b64_tr_b16 a[176:177], v22 offset:0
M v[104:107], a[172:175], a[52:55], v[104:107]
 ds_read_b64_tr_b16 a[178:179], v22 offset:128
 ds_read_b64_tr_b16 a[180:181], v22 offset:1024
M v[108:111], a[172:175], a[60:63], v[108:111]
 ds_read_b64_tr_b16 a[182:183], v22 offset:1152
M v[108:111], a[168:171], a[56:59], v[108:111]
 ds_read_b64_tr_b16 a[184:185], v22 offset:2048
 ds_read_b64_tr_b16 a[186:187], v22 offset:2176
M v[112:115], a[168:171], a[64:67], v[112:115]
 ds_read_b64_tr_b16 a[188:189], v22 offset:3072
M v[112:115], a[172:175], a[68:71], v[112:115]
 ds_read_b64_tr_b16 a[132:133], v1 offset:57344
 ds_read_b64_tr_b16 a[134:135], v1 offset:58368
M v[116:119], a[172:175], a[76:79], v[116:119]
 buffer_load_dwordx4 v13, s[48:51], s22 offen offset:1024   lds
M v[116:119], a[168:171], a[72:75], v[116:119]
 ds_read_b64_tr_b16 a[190:191], v22 offset:3200
M v[120:123], a[168:171], a[80:83], v[120:123]
M v[120:123], a[172:175], a[84:87], v[120:123]
 s_waitcnt lgkmcnt(12)
M v[124:127], a[172:175], a[92:95], v[124:127]
M v[124:127], a[168:171], a[88:91], v[124:127]
M v[128:131], a[160:163], a[32:35], v[128:131]
 ds_read_b128 a[168:171], v5 offset:18432
 ds_read_b128 a[172:175], v6 offset:18432
M v[128:131], a[164:167], a[36:39], v[128:131]
 ds_read_b64_tr_b16 a[136:137], v2 offset:49152
 ds_read_b64_tr_b16 a[138:139], v2 offset:50176
M v[132:135], a[164:167], a[44:47], v[132:135]
 buffer_load_dwordx4 v14, s[48:51], s22 offen offset:2048   lds
M v[132:135], a[160:163], a[40:43], v[132:135]
M v[136:139], a[160:163], a[48:51], v[136:139]
M v[136:139], a[164:167], a[52:55], v[136:139]
M v[140:143], a[164:167], a[60:63], v[140:143]
M v[140:143], a[160:163], a[56:59], v[140:143]
 ds_read_b64_tr_b16 a[140:141], v2 offset:57344
 ds_read_b64_tr_b16 a[142:143], v2 offset:58368
M v[144:147], a[160:163], a[64:67], v[144:147]
 buffer_load_dwordx4 v15, s[48:51], s22 offen offset:3072   lds
M v[144:147], a[164:167], a[68:71], v[144:147]
 s_add_u32 s22, s22, 2097152
M v[148:151], a[164:167], a[76:79], v[148:151]
M v[148:151], a[160:163], a[72:75], v[148:151]
M v[152:155], a[160:163], a[80:83], v[152:155]
M v[152:155], a[164:167], a[84:87], v[152:155]
 s_waitcnt lgkmcnt(4)
M v[156:159], a[164:167], a[92:95], v[156:159]
 s_add_u32 m0, s23, 32768
 ds_read_b64_tr_b16 a[144:145], v3 offset:49152
 ds_read_b64_tr_b16 a[146:147], v3 offset:50176
M v[156:159], a[160:163], a[88:91], v[156:159]
 buffer_load_dwordx4 v8, s[16:19], s21 offen offset:0  nt lds
 s_waitcnt vmcnt(27)
M v[16:19], a[176:179], a[208:211], 0
 s_waitcnt vmcnt(26)
M v[16:19], a[180:183], a[212:215], v[16:19]
 s_waitcnt vmcnt(24)
M v[16:19], a[184:187], a[216:219], v[16:19]
 s_waitcnt vmcnt(22)
M v[16:19], a[188:191], a[220:223], v[16:19]
M v[160:163], a[168:171], a[32:35], v[160:163]
 ds_read_b128 a[160:163], v5 offset:20480
 ds_read_b128 a[164:167], v6 offset:20480
M v[160:163], a[172:175], a[36:39], v[160:163]
 ds_read_b64_tr_b16 a[176:177], v22 offset:4096
M v[164:167], a[172:175], a[44:47], v[164:167]
 ds_read_b64_tr_b16 a[178:179], v22 offset:4224
 ds_read_b64_tr_b16 a[180:181], v22 offset:5120
M v[164:167], a[168:171], a[40:43], v[164:167]
 ds_read_b64_tr_b16 a[182:183], v22 offset:5248
M v[168:171], a[168:171], a[48:51], v[168:171]
 ds_read_b64_tr_b16 a[184:185], v22 offset:6144
M v[168:171], a[172:175], a[52:55], v[168:171]
 ds_read_b64_tr_b16 a[148:149], v3 offset:57344
 ds_read_b64_tr_b16 a[150:151], v3 offset:58368
M v[172:175], a[172:175], a[60:63], v[172:175]
 buffer_load_dwordx4 v9, s[16:19], s21 offen offset:1024  nt lds
M v[172:175], a[168:171], a[56:59], v[172:175]
 ds_read_b64_tr_b16 a[186:187], v22 offset:6272
M v[176:179], a[168:171], a[64:67], v[176:179]
M v[176:179], a[172:175], a[68:71], v[176:179]
M v[180:183], a[172:175], a[76:79], v[180:183]
M v[180:183], a[168:171], a[72:75], v[180:183]
M v[184:187], a[168:171], a[80:83], v[184:187]
 ds_read_b64_tr_b16 a[152:153], v4 offset:49152
 ds_read_b64_tr_b16 a[154:155], v4 offset:50176
M v[184:187], a[172:175], a[84:87], v[184:187]
 s_waitcnt lgkmcnt(10)
M v[188:191], a[172:175], a[92:95], v[188:191]
 buffer_load_dwordx4 v10, s[16:19], s21 offen offset:2048  nt lds
M v[188:191], a[168:171], a[88:91], v[188:191]
M v[192:195], a[160:163], a[32:35], v[192:195]
 ds_read_b128 a[168:171], v5 offset:22528
 ds_read_b128 a[172:175], v6 offset:22528
M v[192:195], a[164:167], a[36:39], v[192:195]
M v[196:199], a[164:167], a[44:47], v[196:199]
M v[196:199], a[160:163], a[40:43], v[196:199]
 ds_read_b64_tr_b16 a[156:157], v4 offset:57344
 ds_read_b64_tr_b16 a[158:159], v4 offset:58368
M v[200:203], a[160:163], a[48:51], v[200:203]
 buffer_load_dwordx4 v11, s[16:19], s21 offen offset:3072  nt lds
M v[200:203], a[164:167], a[52:55], v[200:203]
 s_add_u32 s21, s21, 128
M v[204:207], a[164:167], a[60:63], v[204:207]
M v[204:207], a[160:163], a[56:59], v[204:207]
M v[208:211], a[160:163], a[64:67], v[208:211]
M v[208:211], a[164:167], a[68:71], v[208:211]
M v[212:215], a[164:167], a[76:79], v[212:215]
M v[212:215], a[160:163], a[72:75], v[212:215]
M v[216:219], a[160:163], a[80:83], v[216:219]
M v[216:219], a[164:167], a[84:87], v[216:219]
 s_waitcnt lgkmcnt(2)
M v[220:223], a[164:167], a[92:95], v[220:223]
 s_waitcnt vmcnt(16) lgkmcnt(0)
M v[220:223], a[160:163], a[88:91], v[220:223]
 s_barrier
M v[16:19], a[176:179], a[224:227], v[16:19]
M v[16:19], a[180:183], a[228:231], v[16:19]
M v[16:19], a[184:187], a[232:235], v[16:19]
M v[224:227], a[168:171], a[32:35], v[224:227]
 ds_read_b128 a[160:163], v5 offset:32768
 ds_read_b128 a[164:167], v6 offset:32768
M v[224:227], a[172:175], a[36:39], v[224:227]
M v[228:231], a[172:175], a[44:47], v[228:231]
M v[228:231], a[168:171], a[40:43], v[228:231]
M v[232:235], a[168:171], a[48:51], v[232:235]
M v[232:235], a[172:175], a[52:55], v[232:235]
M v[236:239], a[172:175], a[60:63], v[236:239]
M v[236:239], a[168:171], a[56:59], v[236:239]
M v[240:243], a[168:171], a[64:67], v[240:243]
M v[240:243], a[172:175], a[68:71], v[240:243]
M v[244:247], a[172:175], a[76:79], v[244:247]
M v[244:247], a[168:171], a[72:75], v[244:247]
M v[248:251], a[168:171], a[80:83], v[248:251]
M v[248:251], a[172:175], a[84:87], v[248:251]
 s_waitcnt lgkmcnt(0)
M v[252:255], a[172:175], a[92:95], v[252:255]
M v[252:255], a[168:171], a[88:91], v[252:255]
M a[0:3], a[160:163], a[96:99], a[0:3]
 ds_read_b128 a[168:171], v5 offset:34816
 ds_read_b128 a[172:175], v6 offset:34816
M a[0:3], a[164:167], a[100:103], a[0:3]
 ds_read_b64_tr_b16 a[32:33], v1 offset:0
 ds_read_b64_tr_b16 a[34:35], v1 offset:1024
M a[4:7], a[164:167], a[108:111], a[4:7]
 s_add_u32 m0, s24, 16384
M a[4:7], a[160:163], a[104:107], a[4:7]
 buffer_load_dwordx4 v12, s[48:51], s22 offen offset:0   lds
M a[8:11], a[160:163], a[112:115], a[8:11]
M a[8:11], a[164:167], a[116:119], a[8:11]
 s_lshl_b32 s64, s20, 10
M a[12:15], a[164:167], a[124:127], a[12:15]
 s_add_u32 s64, s64, 159744
 ds_read_b64_tr_b16 a[36:37], v1 offset:8192
 ds_read_b64_tr_b16 a[38:39], v1 offset:9216
M a[12:15], a[160:163], a[120:123], a[12:15]
 v_add_u32 v21, s64, v7
 ds_write_b128 v21, v[16:19]
M a[16:19], a[160:163], a[128:131], a[16:19]
 buffer_load_dwordx4 v13, s[48:51], s22 offen offset:1024   lds
M a[16:19], a[164:167], a[132:135], a[16:19]
 s_mul_i32 s67, s86, 14336
M a[20:23], a[164:167], a[140:143], a[20:23]
 s_mul_i32 s64, s20, 224
M a[20:23], a[160:163], a[136:139], a[20:23]
 s_add_u32 s67, s67, s64
 ds_read_b64_tr_b16 a[40:41], v2 offset:0
 ds_read_b64_tr_b16 a[42:43], v2 offset:1024
M a[24:27], a[160:163], a[144:147], a[24:27]
 v_lshrrev_b32 v28, 4, v0
 v_mul_u32_u24 v28, 896, v28
M a[24:27], a[164:167], a[148:151], a[24:27]
 s_waitcnt lgkmcnt(7)
 v_and_b32 v29, 15, v0
 v_lshl_add_u32 v28, v29, 4, v28
M a[28:31], a[164:167], a[156:159], a[28:31]
 buffer_load_dwordx4 v14, s[48:51], s22 offen offset:2048   lds
M a[28:31], a[160:163], a[152:155], a[28:31]
 v_mov_b32 v30, 536870912
 v_cmp_gt_u32 vcc, 14, v29
M v[32:35], a[168:171], a[96:99], v[32:35]
 s_nop 0
 ds_read_b128 a[160:163], v5 offset:36864
 ds_read_b128 a[164:167], v6 offset:36864
M v[32:35], a[172:175], a[100:103], v[32:35]
 s_nop 0
 ds_read_b64_tr_b16 a[44:45], v2 offset:8192
 ds_read_b64_tr_b16 a[46:47], v2 offset:9216
M v[36:39], a[172:175], a[108:111], v[36:39]
 buffer_load_dwordx4 v15, s[48:51], s22 offen offset:3072   lds
M v[36:39], a[168:171], a[104:107], v[36:39]
 s_sub_u32 s22, s22, 2097024
 v_cndmask_b32 v28, v30, v28, vcc
 v_add_u32 v29, 2560, v28
M v[40:43], a[168:171], a[112:115], v[40:43]
 v_add_u32 v30, 5120, v28
 v_add_u32 v31, 7680, v28
M v[40:43], a[172:175], a[116:119], v[40:43]
 ds_read_b64_tr_b16 a[48:49], v3 offset:0
 ds_read_b64_tr_b16 a[50:51], v3 offset:1024
M v[44:47], a[172:175], a[124:127], v[44:47]
 s_add_u32 m0, s23, 49152
M v[44:47], a[168:171], a[120:123], v[44:47]
 buffer_load_dwordx4 v8, s[16:19], s21 offen offset:0  nt lds
M v[48:51], a[168:171], a[128:131], v[48:51]
M v[48:51], a[172:175], a[132:135], v[48:51]
M v[52:55], a[172:175], a[140:143], v[52:55]
 ds_read_b64_tr_b16 a[52:53], v3 offset:8192
 ds_read_b64_tr_b16 a[54:55], v3 offset:9216
M v[52:55], a[168:171], a[136:139], v[52:55]
M v[56:59], a[168:171], a[144:147], v[56:59]
 buffer_load_dwordx4 v9, s[16:19], s21 offen offset:1024  nt lds
M v[56:59], a[172:175], a[148:151], v[56:59]
 s_waitcnt lgkmcnt(6)
M v[60:63], a[172:175], a[156:159], v[60:63]
M v[60:63], a[168:171], a[152:155], v[60:63]
 ds_read_b64_tr_b16 a[56:57], v4 offset:0
 ds_read_b64_tr_b16 a[58:59], v4 offset:1024
M v[64:67], a[160:163], a[96:99], v[64:67]
 ds_read_b128 a[168:171], v5 offset:38912
 ds_read_b128 a[172:175], v6 offset:38912
M v[64:67], a[164:167], a[100:103], v[64:67]
 buffer_load_dwordx4 v10, s[16:19], s21 offen offset:2048  nt lds
M v[68:71], a[164:167], a[108:111], v[68:71]
M v[68:71], a[160:163], a[104:107], v[68:71]
M v[72:75], a[160:163], a[112:115], v[72:75]
 ds_read_b64_tr_b16 a[60:61], v4 offset:8192
 ds_read_b64_tr_b16 a[62:63], v4 offset:9216
M v[72:75], a[164:167], a[116:119], v[72:75]
M v[76:79], a[164:167], a[124:127], v[76:79]
 buffer_load_dwordx4 v11, s[16:19], s21 offen offset:3072  nt lds
M v[76:79], a[160:163], a[120:123], v[76:79]
 s_add_u32 s21, s21, 524160
M v[80:83], a[160:163], a[128:131], v[80:83]
M v[80:83], a[164:167], a[132:135], v[80:83]
M v[84:87], a[164:167], a[140:143], v[84:87]
M v[84:87], a[160:163], a[136:139], v[84:87]
M v[88:91], a[160:163], a[144:147], v[88:91]
M v[88:91], a[164:167], a[148:151], v[88:91]
 s_waitcnt lgkmcnt(2)
M v[92:95], a[164:167], a[156:159], v[92:95]
 s_waitcnt vmcnt(16) lgkmcnt(0)
M v[92:95], a[160:163], a[152:155], v[92:95]
 s_barrier
M v[96:99], a[168:171], a[96:99], v[96:99]
 ds_read_b128 a[160:163], v5 offset:49152
 ds_read_b128 a[164:167], v6 offset:49152
M v[96:99], a[172:175], a[100:103], v[96:99]
M v[100:103], a[172:175], a[108:111], v[100:103]
 s_add_u32 m0, s24, 32768
 ds_read_b64_tr_b16 a[64:65], v1 offset:16384
 ds_read_b64_tr_b16 a[66:67], v1 offset:17408
M v[100:103], a[168:171], a[104:107], v[100:103]
 buffer_load_dwordx4 v12, s[48:51], s22 offen offset:0   lds
M v[104:107], a[168:171], a[112:115], v[104:107]
M v[104:107], a[172:175], a[116:119], v[104:107]
M v[108:111], a[172:175], a[124:127], v[108:111]
M v[108:111], a[168:171], a[120:123], v[108:111]
 buffer_load_dwordx4 v13, s[48:51], s22 offen offset:1024   lds
M v[112:115], a[168:171], a[128:131], v[112:115]
M v[112:115], a[172:175], a[132:135], v[112:115]
 ds_read_b64_tr_b16 a[68:69], v1 offset:24576
 ds_read_b64_tr_b16 a[70:71], v1 offset:25600
M v[116:119], a[172:175], a[140:143], v[116:119]
M v[116:119], a[168:171], a[136:139], v[116:119]
M v[120:123], a[168:171], a[144:147], v[120:123]
 buffer_load_dwordx4 v14, s[48:51], s22 offen offset:2048   lds
M v[120:123], a[172:175], a[148:151], v[120:123]
 s_waitcnt lgkmcnt(4)
M v[124:127], a[172:175], a[156:159], v[124:127]
M v[124:127], a[168:171], a[152:155], v[124:127]
M v[128:131], a[160:163], a[96:99], v[128:131]
 ds_read_b128 a[168:171], v5 offset:51200
 ds_read_b128 a[172:175], v6 offset:51200
M v[128:131], a[164:167], a[100:103], v[128:131]
 ds_read_b64_tr_b16 a[72:73], v2 offset:16384
 ds_read_b64_tr_b16 a[74:75], v2 offset:17408
M v[132:135], a[164:167], a[108:111], v[132:135]
 buffer_load_dwordx4 v15, s[48:51], s22 offen offset:3072   lds
M v[132:135], a[160:163], a[104:107], v[132:135]
 s_add_u32 s22, s22, 2097152
M v[136:139], a[160:163], a[112:115], v[136:139]
M v[136:139], a[164:167], a[116:119], v[136:139]
 s_add_u32 m0, s23, 0
M v[140:143], a[164:167], a[124:127], v[140:143]
 buffer_load_dwordx4 v8, s[16:19], s21 offen offset:0  nt lds
M v[140:143], a[160:163], a[120:123], v[140:143]
 ds_read_b64_tr_b16 a[76:77], v2 offset:24576
 ds_read_b64_tr_b16 a[78:79], v2 offset:25600
M v[144:147], a[160:163], a[128:131], v[144:147]
M v[144:147], a[164:167], a[132:135], v[144:147]
M v[148:151], a[164:167], a[140:143], v[148:151]
 buffer_load_dwordx4 v9, s[16:19], s21 offen offset:1024  nt lds
M v[148:151], a[160:163], a[136:139], v[148:151]
M v[152:155], a[160:163], a[144:147], v[152:155]
M v[152:155], a[164:167], a[148:151], v[152:155]
 s_waitcnt lgkmcnt(4)
M v[156:159], a[164:167], a[156:159], v[156:159]
 ds_read_b64_tr_b16 a[80:81], v3 offset:16384
 ds_read_b64_tr_b16 a[82:83], v3 offset:17408
M v[156:159], a[160:163], a[152:155], v[156:159]
 buffer_load_dwordx4 v10, s[16:19], s21 offen offset:2048  nt lds
M v[160:163], a[168:171], a[96:99], v[160:163]
 ds_read_b128 a[160:163], v5 offset:53248
 ds_read_b128 a[164:167], v6 offset:53248
M v[160:163], a[172:175], a[100:103], v[160:163]
M v[164:167], a[172:175], a[108:111], v[164:167]
M v[164:167], a[168:171], a[104:107], v[164:167]
M v[168:171], a[168:171], a[112:115], v[168:171]
 buffer_load_dwordx4 v11, s[16:19], s21 offen offset:3072  nt lds
M v[168:171], a[172:175], a[116:119], v[168:171]
 s_add_u32 s21, s21, 128
 ds_read_b64_tr_b16 a[84:85], v3 offset:24576
 ds_read_b64_tr_b16 a[86:87], v3 offset:25600
M v[172:175], a[172:175], a[124:127], v[172:175]
M v[172:175], a[168:171], a[120:123], v[172:175]
M v[176:179], a[168:171], a[128:131], v[176:179]
 s_add_u32 m0, s87, 0
M v[176:179], a[172:175], a[132:135], v[176:179]
 buffer_load_dwordx4 v28, s[68:71], s67 offen offset:0 nt lds
M v[180:183], a[172:175], a[140:143], v[180:183]
M v[180:183], a[168:171], a[136:139], v[180:183]
M v[184:187], a[168:171], a[144:147], v[184:187]
 ds_read_b64_tr_b16 a[88:89], v4 offset:16384
 ds_read_b64_tr_b16 a[90:91], v4 offset:17408
M v[184:187], a[172:175], a[148:151], v[184:187]
 s_waitcnt lgkmcnt(4)
M v[188:191], a[172:175], a[156:159], v[188:191]
 buffer_load_dwordx4 v29, s[68:71], s67 offen offset:1024 nt lds
M v[188:191], a[168:171], a[152:155], v[188:191]
M v[192:195], a[160:163], a[96:99], v[192:195]
 ds_read_b128 a[168:171], v5 offset:55296
 ds_read_b128 a[172:175], v6 offset:55296
M v[192:195], a[164:167], a[100:103], v[192:195]
M v[196:199], a[164:167], a[108:111], v[196:199]
 buffer_load_dwordx4 v30, s[68:71], s67 offen offset:2048 nt lds
M v[196:199], a[160:163], a[104:107], v[196:199]
 ds_read_b64_tr_b16 a[92:93], v4 offset:24576
 ds_read_b64_tr_b16 a[94:95], v4 offset:25600
M v[200:203], a[160:163], a[112:115], v[200:203]
M v[200:203], a[164:167], a[116:119], v[200:203]
M v[204:207], a[164:167], a[124:127], v[204:207]
M v[204:207], a[160:163], a[120:123], v[204:207]
 buffer_load_dwordx4 v31, s[68:71], s67 offen offset:3072 nt lds
M v[208:211], a[160:163], a[128:131], v[208:211]
 s_add_u32 s67, s67, 0
M v[208:211], a[164:167], a[132:135], v[208:211]
M v[212:215], a[164:167], a[140:143], v[212:215]
M v[212:215], a[160:163], a[136:139], v[212:215]
M v[216:219], a[160:163], a[144:147], v[216:219]
M v[216:219], a[164:167], a[148:151], v[216:219]
 s_waitcnt lgkmcnt(2)
M v[220:223], a[164:167], a[156:159], v[220:223]
 s_waitcnt vmcnt(20) lgkmcnt(0)
M v[220:223], a[160:163], a[152:155], v[220:223]
 s_barrier
M v[224:227], a[168:171], a[96:99], v[224:227]
 ds_read_b128 a[160:163], v5 offset:0
 ds_read_b128 a[164:167], v6 offset:0
M v[224:227], a[172:175], a[100:103], v[224:227]
M v[228:231], a[172:175], a[108:111], v[228:231]
M v[228:231], a[168:171], a[104:107], v[228:231]
M v[232:235], a[168:171], a[112:115], v[232:235]
M v[232:235], a[172:175], a[116:119], v[232:235]
M v[236:239], a[172:175], a[124:127], v[236:239]
M v[236:239], a[168:171], a[120:123], v[236:239]
M v[240:243], a[168:171], a[128:131], v[240:243]
M v[240:243], a[172:175], a[132:135], v[240:243]
M v[244:247], a[172:175], a[140:143], v[244:247]
M v[244:247], a[168:171], a[136:139], v[244:247]
M v[248:251], a[168:171], a[144:147], v[248:251]
M v[248:251], a[172:175], a[148:151], v[248:251]
 s_waitcnt lgkmcnt(0)
M v[252:255], a[172:175], a[156:159], v[252:255]
M v[252:255], a[168:171], a[152:155], v[252:255]
M a[0:3], a[160:163], a[32:35], a[0:3]
 ds_read_b128 a[168:171], v5 offset:2048
 ds_read_b128 a[172:175], v6 offset:2048
M a[0:3], a[164:167], a[36:39], a[0:3]
 ds_read_b64_tr_b16 a[96:97], v1 offset:32768
 ds_read_b64_tr_b16 a[98:99], v1 offset:33792
M a[4:7], a[164:167], a[44:47], a[4:7]
 s_add_u32 m0, s24, 49152
 v_cvt_pk_bf16_f32 v23, v23, v23
 v_accvgpr_read_b32 v27, a241
M a[4:7], a[160:163], a[40:43], a[4:7]
 buffer_load_dwordx4 v12, s[48:51], s22 offen offset:0   lds
M a[8:11], a[160:163], a[48:51], a[8:11]
 v_and_b32 v23, 0xffff0000, v23
M a[8:11], a[164:167], a[52:55], a[8:11]
 v_mul_f32 v22, 0xbfb8aa3b, v23
M a[12:15], a[164:167], a[60:63], a[12:15]
 ds_read_b64_tr_b16 a[100:101], v1 offset:40960
 ds_read_b64_tr_b16 a[102:103], v1 offset:41984
M a[12:15], a[160:163], a[56:59], a[12:15]
 v_exp_f32 v22, v22
M a[16:19], a[160:163], a[64:67], a[16:19]
 buffer_load_dwordx4 v13, s[48:51], s22 offen offset:1024   lds
M a[16:19], a[164:167], a[68:71], a[16:19]
 v_add_f32 v22, 1.0, v22
M a[20:23], a[164:167], a[76:79], a[20:23]
 v_rcp_f32 v23, v22
M a[20:23], a[160:163], a[72:75], a[20:23]
 s_or_b32 s64, s86, s20
 ds_read_b64_tr_b16 a[104:105], v2 offset:32768
 ds_read_b64_tr_b16 a[106:107], v2 offset:33792
M a[24:27], a[160:163], a[80:83], a[24:27]
 s_min_u32 s64, s64, 1
 s_lshl_b32 s64, s64, 29
 v_lshrrev_b32 v22, 1, v0
M a[24:27], a[164:167], a[84:87], a[24:27]
 s_waitcnt lgkmcnt(6)
 v_min_u32 v22, 1, v22
M a[28:31], a[164:167], a[92:95], a[28:31]
 buffer_load_dwordx4 v14, s[48:51], s22 offen offset:2048   lds
M a[28:31], a[160:163], a[88:91], a[28:31]
 v_lshlrev_b32 v22, 29, v22
M v[32:35], a[168:171], a[32:35], v[32:35]
 ds_read_b128 a[160:163], v5 offset:4096
 ds_read_b128 a[164:167], v6 offset:4096
M v[32:35], a[172:175], a[36:39], v[32:35]
 ds_read_b64_tr_b16 a[108:109], v2 offset:40960
 ds_read_b64_tr_b16 a[110:111], v2 offset:41984
M v[36:39], a[172:175], a[44:47], v[36:39]
 buffer_load_dwordx4 v15, s[48:51], s22 offen offset:3072   lds
M v[36:39], a[168:171], a[40:43], v[36:39]
 s_sub_u32 s22, s22, 2097024
 v_lshl_or_b32 v22, v0, 2, v22
M v[40:43], a[168:171], a[48:51], v[40:43]
 v_or_b32 v22, s64, v22
M v[40:43], a[172:175], a[52:55], v[40:43]
 ds_read_b64_tr_b16 a[112:113], v3 offset:32768
 ds_read_b64_tr_b16 a[114:115], v3 offset:33792
M v[44:47], a[172:175], a[60:63], v[44:47]
 s_add_u32 m0, s23, 16384
 v_cvt_pk_bf16_f32 v23, v23, v23
M v[44:47], a[168:171], a[56:59], v[44:47]
 buffer_load_dwordx4 v8, s[16:19], s21 offen offset:0  nt lds
M v[48:51], a[168:171], a[64:67], v[48:51]
 v_and_b32 v23, 0xffff0000, v23
M v[48:51], a[172:175], a[68:71], v[48:51]
 s_mov_b32 s64, 104890368
M v[52:55], a[172:175], a[76:79], v[52:55]
 ds_read_b64_tr_b16 a[116:117], v3 offset:40960
 ds_read_b64_tr_b16 a[118:119], v3 offset:41984
M v[52:55], a[168:171], a[72:75], v[52:55]
 buffer_store_dword v24, v22, s[8:11], s64 offen sc1
M v[56:59], a[168:171], a[80:83], v[56:59]
 buffer_load_dwordx4 v9, s[16:19], s21 offen offset:1024  nt lds
M v[56:59], a[172:175], a[84:87], v[56:59]
 s_waitcnt lgkmcnt(6)
M v[60:63], a[172:175], a[92:95], v[60:63]
 buffer_store_dword v23, v22, s[8:11], s64 offen offset:8 sc1
M v[60:63], a[168:171], a[88:91], v[60:63]
 ds_read_b64_tr_b16 a[120:121], v4 offset:32768
 ds_read_b64_tr_b16 a[122:123], v4 offset:33792
M v[64:67], a[160:163], a[32:35], v[64:67]
 ds_read_b128 a[168:171], v5 offset:6144
 ds_read_b128 a[172:175], v6 offset:6144
M v[64:67], a[164:167], a[36:39], v[64:67]
 buffer_load_dwordx4 v10, s[16:19], s21 offen offset:2048  nt lds
M v[68:71], a[164:167], a[44:47], v[68:71]
 v_add_u32 v25, 159744, v7
M v[68:71], a[160:163], a[40:43], v[68:71]
 ds_read_b128 v[16:19], v25
M v[72:75], a[160:163], a[48:51], v[72:75]
 ds_read_b64_tr_b16 a[124:125], v4 offset:40960
 ds_read_b64_tr_b16 a[126:127], v4 offset:41984
M v[72:75], a[164:167], a[52:55], v[72:75]
 ds_read_b128 v[28:31], v25 offset:1024
 v_sub_f32 v48, v48, v27
M v[76:79], a[164:167], a[60:63], v[76:79]
 buffer_load_dwordx4 v11, s[16:19], s21 offen offset:3072  nt lds
M v[76:79], a[160:163], a[56:59], v[76:79]
 s_add_u32 s21, s21, 524160
 ds_read_b128 v[20:23], v25 offset:2048
 v_sub_f32 v49, v49, v27
M v[80:83], a[160:163], a[64:67], v[80:83]
 v_sub_f32 v50, v50, v27
 v_sub_f32 v51, v51, v27
M v[80:83], a[164:167], a[68:71], v[80:83]
 v_sub_f32 v52, v52, v27
 v_sub_f32 v53, v53, v27
M v[84:87], a[164:167], a[76:79], v[84:87]
 v_sub_f32 v54, v54, v27
 v_sub_f32 v55, v55, v27
M v[84:87], a[160:163], a[72:75], v[84:87]
 v_sub_f32 v56, v56, v27
 v_sub_f32 v57, v57, v27
M v[88:91], a[160:163], a[80:83], v[88:91]
 v_sub_f32 v58, v58, v27
 v_sub_f32 v59, v59, v27
M v[88:91], a[164:167], a[84:87], v[88:91]
 s_waitcnt lgkmcnt(5)
 v_sub_f32 v60, v60, v27
 v_sub_f32 v61, v61, v27
M v[92:95], a[164:167], a[92:95], v[92:95]
 s_waitcnt vmcnt(22) lgkmcnt(0)
 v_sub_f32 v62, v62, v27
 v_sub_f32 v63, v63, v27
M v[92:95], a[160:163], a[88:91], v[92:95]
 s_barrier
M v[96:99], a[168:171], a[32:35], v[96:99]
 ds_read_b128 a[160:163], v5 offset:16384
 ds_read_b128 a[164:167], v6 offset:16384
M v[96:99], a[172:175], a[36:39], v[96:99]
 v_add_f32 v16, v28, v16
M v[100:103], a[172:175], a[44:47], v[100:103]
 s_add_u32 m0, s24, 0
 ds_read_b64_tr_b16 a[128:129], v1 offset:49152
 ds_read_b64_tr_b16 a[130:131], v1 offset:50176
M v[100:103], a[168:171], a[40:43], v[100:103]
 buffer_load_dwordx4 v12, s[48:51], s22 offen offset:0   lds
M v[104:107], a[168:171], a[48:51], v[104:107]
 v_add_f32 v17, v29, v17
 v_sub_f32 v80, v80, v27
M v[104:107], a[172:175], a[52:55], v[104:107]
 v_add_f32 v18, v30, v18
 v_sub_f32 v81, v81, v27
M v[108:111], a[172:175], a[60:63], v[108:111]
 v_add_f32 v19, v31, v19
 v_sub_f32 v82, v82, v27
M v[108:111], a[168:171], a[56:59], v[108:111]
 ds_read_b128 v[28:31], v25 offset:3072
 v_sub_f32 v83, v83, v27
M v[112:115], a[168:171], a[64:67], v[112:115]
 v_cvt_pk_bf16_f32 v25, v16, v17
 v_sub_f32 v84, v84, v27
M v[112:115], a[172:175], a[68:71], v[112:115]
 ds_read_b64_tr_b16 a[132:133], v1 offset:57344
 ds_read_b64_tr_b16 a[134:135], v1 offset:58368
M v[116:119], a[172:175], a[76:79], v[116:119]
 buffer_load_dwordx4 v13, s[48:51], s22 offen offset:1024   lds
M v[116:119], a[168:171], a[72:75], v[116:119]
 v_lshlrev_b32 v16, 16, v25
 v_sub_f32 v85, v85, v27
M v[120:123], a[168:171], a[80:83], v[120:123]
 v_and_b32 v17, 0xffff0000, v25
 v_sub_f32 v86, v86, v27
M v[120:123], a[172:175], a[84:87], v[120:123]
 s_waitcnt lgkmcnt(5)
 v_cvt_pk_bf16_f32 v25, v18, v19
 v_sub_f32 v87, v87, v27
M v[124:127], a[172:175], a[92:95], v[124:127]
 v_lshlrev_b32 v18, 16, v25
 v_sub_f32 v88, v88, v27
M v[124:127], a[168:171], a[88:91], v[124:127]
 v_and_b32 v19, 0xffff0000, v25
 v_sub_f32 v89, v89, v27
M v[128:131], a[160:163], a[32:35], v[128:131]
 ds_read_b128 a[168:171], v5 offset:18432
 ds_read_b128 a[172:175], v6 offset:18432
M v[128:131], a[164:167], a[36:39], v[128:131]
 ds_read_b64_tr_b16 a[136:137], v2 offset:49152
 ds_read_b64_tr_b16 a[138:139], v2 offset:50176
M v[132:135], a[164:167], a[44:47], v[132:135]
 buffer_load_dwordx4 v14, s[48:51], s22 offen offset:2048   lds
M v[132:135], a[160:163], a[40:43], v[132:135]
 s_waitcnt lgkmcnt(6)
 v_add_f32 v20, v28, v20
 v_sub_f32 v90, v90, v27
M v[136:139], a[160:163], a[48:51], v[136:139]
 v_add_f32 v21, v29, v21
 v_sub_f32 v91, v91, v27
M v[136:139], a[164:167], a[52:55], v[136:139]
 v_add_f32 v22, v30, v22
 v_sub_f32 v92, v92, v27
M v[140:143], a[164:167], a[60:63], v[140:143]
 v_add_f32 v23, v31, v23
 v_sub_f32 v93, v93, v27
M v[140:143], a[160:163], a[56:59], v[140:143]
 ds_read_b64_tr_b16 a[140:141], v2 offset:57344
 ds_read_b64_tr_b16 a[142:143], v2 offset:58368
M v[144:147], a[160:163], a[64:67], v[144:147]
 buffer_load_dwordx4 v15, s[48:51], s22 offen offset:3072   lds
M v[144:147], a[164:167], a[68:71], v[144:147]
 s_add_u32 s22, s22, 2097152
 v_mul_f32 v28, 0xbfb8aa3b, v16
 v_sub_f32 v94, v94, v27
M v[148:151], a[164:167], a[76:79], v[148:151]
 v_mul_f32 v29, 0xbfb8aa3b, v17
 v_sub_f32 v95, v95, v27
M v[148:151], a[160:163], a[72:75], v[148:151]
 v_mul_f32 v30, 0xbfb8aa3b, v18
 v_sub_f32 v112, v112, v27
M v[152:155], a[160:163], a[80:83], v[152:155]
 v_mul_f32 v31, 0xbfb8aa3b, v19
 v_sub_f32 v113, v113, v27
M v[152:155], a[164:167], a[84:87], v[152:155]
 s_waitcnt lgkmcnt(4)
 v_exp_f32 v28, v28
M v[156:159], a[164:167], a[92:95], v[156:159]
 s_add_u32 m0, s23, 32768
 ds_read_b64_tr_b16 a[144:145], v3 offset:49152
 ds_read_b64_tr_b16 a[146:147], v3 offset:50176
M v[156:159], a[160:163], a[88:91], v[156:159]
 buffer_load_dwordx4 v8, s[16:19], s21 offen offset:0  nt lds
M v[160:163], a[168:171], a[32:35], v[160:163]
 ds_read_b128 a[160:163], v5 offset:20480
 ds_read_b128 a[164:167], v6 offset:20480
M v[160:163], a[172:175], a[36:39], v[160:163]
 v_exp_f32 v29, v29
M v[164:167], a[172:175], a[44:47], v[164:167]
 v_exp_f32 v30, v30
M v[164:167], a[168:171], a[40:43], v[164:167]
 v_exp_f32 v31, v31
M v[168:171], a[168:171], a[48:51], v[168:171]
 v_cvt_pk_bf16_f32 v25, v20, v21
 v_sub_f32 v114, v114, v27
M v[168:171], a[172:175], a[52:55], v[168:171]
 ds_read_b64_tr_b16 a[148:149], v3 offset:57344
 ds_read_b64_tr_b16 a[150:151], v3 offset:58368
M v[172:175], a[172:175], a[60:63], v[172:175]
 buffer_load_dwordx4 v9, s[16:19], s21 offen offset:1024  nt lds
M v[172:175], a[168:171], a[56:59], v[172:175]
 v_lshlrev_b32 v20, 16, v25
 v_sub_f32 v115, v115, v27
M v[176:179], a[168:171], a[64:67], v[176:179]
 v_and_b32 v21, 0xffff0000, v25
 v_sub_f32 v116, v116, v27
M v[176:179], a[172:175], a[68:71], v[176:179]
 v_cvt_pk_bf16_f32 v25, v22, v23
 v_sub_f32 v117, v117, v27
M v[180:183], a[172:175], a[76:79], v[180:183]
 v_lshlrev_b32 v22, 16, v25
 v_sub_f32 v118, v118, v27
M v[180:183], a[168:171], a[72:75], v[180:183]
 v_and_b32 v23, 0xffff0000, v25
 v_sub_f32 v119, v119, v27
M v[184:187], a[168:171], a[80:83], v[184:187]
 ds_read_b64_tr_b16 a[152:153], v4 offset:49152
 ds_read_b64_tr_b16 a[154:155], v4 offset:50176
M v[184:187], a[172:175], a[84:87], v[184:187]
 s_waitcnt lgkmcnt(4)
 v_add_f32 v28, 1.0, v28
 v_sub_f32 v120, v120, v27
M v[188:191], a[172:175], a[92:95], v[188:191]
 buffer_load_dwordx4 v10, s[16:19], s21 offen offset:2048  nt lds
M v[188:191], a[168:171], a[88:91], v[188:191]
 v_add_f32 v29, 1.0, v29
 v_sub_f32 v121, v121, v27
M v[192:195], a[160:163], a[32:35], v[192:195]
 ds_read_b128 a[168:171], v5 offset:22528
 ds_read_b128 a[172:175], v6 offset:22528
M v[192:195], a[164:167], a[36:39], v[192:195]
 v_add_f32 v30, 1.0, v30
 v_sub_f32 v122, v122, v27
M v[196:199], a[164:167], a[44:47], v[196:199]
 v_add_f32 v31, 1.0, v31
 v_sub_f32 v123, v123, v27
M v[196:199], a[160:163], a[40:43], v[196:199]
 ds_read_b64_tr_b16 a[156:157], v4 offset:57344
 ds_read_b64_tr_b16 a[158:159], v4 offset:58368
M v[200:203], a[160:163], a[48:51], v[200:203]
 buffer_load_dwordx4 v11, s[16:19], s21 offen offset:3072  nt lds
M v[200:203], a[164:167], a[52:55], v[200:203]
 s_add_u32 s21, s21, 128
 v_rcp_f32 v28, v28
M v[204:207], a[164:167], a[60:63], v[204:207]
 v_rcp_f32 v29, v29
M v[204:207], a[160:163], a[56:59], v[204:207]
 v_rcp_f32 v30, v30
M v[208:211], a[160:163], a[64:67], v[208:211]
 v_rcp_f32 v31, v31
M v[208:211], a[164:167], a[68:71], v[208:211]
 v_mul_f32 v16, v28, v16
 v_sub_f32 v124, v124, v27
M v[212:215], a[164:167], a[76:79], v[212:215]
 v_mul_f32 v17, v29, v17
 v_sub_f32 v125, v125, v27
M v[212:215], a[160:163], a[72:75], v[212:215]
 v_mul_f32 v18, v30, v18
 v_sub_f32 v126, v126, v27
M v[216:219], a[160:163], a[80:83], v[216:219]
 v_mul_f32 v19, v31, v19
 v_sub_f32 v127, v127, v27
M v[216:219], a[164:167], a[84:87], v[216:219]
 s_waitcnt lgkmcnt(2)
 v_cvt_pk_bf16_f32 v25, v16, v17
 v_sub_f32 v128, v128, v27
M v[220:223], a[164:167], a[92:95], v[220:223]
 s_waitcnt vmcnt(22) lgkmcnt(0)
 v_lshlrev_b32 v16, 16, v25
 v_sub_f32 v129, v129, v27
M v[220:223], a[160:163], a[88:91], v[220:223]
 s_barrier
M v[224:227], a[168:171], a[32:35], v[224:227]
 ds_read_b128 a[160:163], v5 offset:32768
 ds_read_b128 a[164:167], v6 offset:32768
M v[224:227], a[172:175], a[36:39], v[224:227]
 v_and_b32 v17, 0xffff0000, v25
 v_sub_f32 v130, v130, v27
M v[228:231], a[172:175], a[44:47], v[228:231]
 v_cvt_pk_bf16_f32 v25, v18, v19
 v_sub_f32 v131, v131, v27
M v[228:231], a[168:171], a[40:43], v[228:231]
 v_lshlrev_b32 v18, 16, v25
 v_sub_f32 v132, v132, v27
M v[232:235], a[168:171], a[48:51], v[232:235]
 v_and_b32 v19, 0xffff0000, v25
 v_sub_f32 v133, v133, v27
M v[232:235], a[172:175], a[52:55], v[232:235]
 v_mul_f32 v16, v20, v16
 v_sub_f32 v134, v134, v27
M v[236:239], a[172:175], a[60:63], v[236:239]
 v_mul_f32 v17, v21, v17
 v_sub_f32 v135, v135, v27
M v[236:239], a[168:171], a[56:59], v[236:239]
 v_mul_f32 v18, v22, v18
 v_sub_f32 v136, v136, v27
M v[240:243], a[168:171], a[64:67], v[240:243]
 v_mul_f32 v19, v23, v19
 v_sub_f32 v137, v137, v27
M v[240:243], a[172:175], a[68:71], v[240:243]
 v_cvt_pk_bf16_f32 v16, v16, v17
 v_sub_f32 v138, v138, v27
M v[244:247], a[172:175], a[76:79], v[244:247]
 v_cvt_pk_bf16_f32 v17, v18, v19
 v_sub_f32 v139, v139, v27
M v[244:247], a[168:171], a[72:75], v[244:247]
 v_sub_f32 v140, v140, v27
 v_sub_f32 v141, v141, v27
M v[248:251], a[168:171], a[80:83], v[248:251]
 v_sub_f32 v142, v142, v27
 v_sub_f32 v143, v143, v27
M v[248:251], a[172:175], a[84:87], v[248:251]
 s_waitcnt lgkmcnt(0)
 v_sub_f32 v144, v144, v27
 v_sub_f32 v145, v145, v27
M v[252:255], a[172:175], a[92:95], v[252:255]
 v_sub_f32 v146, v146, v27
 v_sub_f32 v147, v147, v27
M v[252:255], a[168:171], a[88:91], v[252:255]
 v_sub_f32 v148, v148, v27
 v_sub_f32 v149, v149, v27
M a[0:3], a[160:163], a[96:99], a[0:3]
 ds_read_b128 a[168:171], v5 offset:34816
 ds_read_b128 a[172:175], v6 offset:34816
M a[0:3], a[164:167], a[100:103], a[0:3]
 ds_read_b64_tr_b16 a[32:33], v1 offset:0
 ds_read_b64_tr_b16 a[34:35], v1 offset:1024
M a[4:7], a[164:167], a[108:111], a[4:7]
 s_add_u32 m0, s24, 16384
 v_lshrrev_b32 v28, 2, v0
 v_lshlrev_b32 v28, 8, v28
M a[4:7], a[160:163], a[104:107], a[4:7]
 buffer_load_dwordx4 v12, s[48:51], s22 offen offset:0   lds
M a[8:11], a[160:163], a[112:115], a[8:11]
 v_and_b32 v29, 3, v0
 v_lshl_add_u32 v28, v29, 3, v28
M a[8:11], a[164:167], a[116:119], a[8:11]
 v_add_u32 v28, s87, v28
 v_sub_f32 v150, v150, v27
M a[12:15], a[164:167], a[124:127], a[12:15]
 s_waitcnt vmcnt(19)
 ds_read_b64_tr_b16 a[36:37], v1 offset:8192
 ds_read_b64_tr_b16 a[38:39], v1 offset:9216
M a[12:15], a[160:163], a[120:123], a[12:15]
 ds_read_b64_tr_b16 a[176:177], v28 offset:0
 v_sub_f32 v151, v151, v27
M a[16:19], a[160:163], a[128:131], a[16:19]
 buffer_load_dwordx4 v13, s[48:51], s22 offen offset:1024   lds
M a[16:19], a[164:167], a[132:135], a[16:19]
 ds_read_b64_tr_b16 a[178:179], v28 offset:32
 ds_read_b64_tr_b16 a[180:181], v28 offset:64
M a[20:23], a[164:167], a[140:143], a[20:23]
 ds_read_b64_tr_b16 a[182:183], v28 offset:96
 v_sub_f32 v152, v152, v27
M a[20:23], a[160:163], a[136:139], a[20:23]
 ds_read_b64_tr_b16 a[40:41], v2 offset:0
 ds_read_b64_tr_b16 a[42:43], v2 offset:1024
M a[24:27], a[160:163], a[144:147], a[24:27]
 ds_read_b64_tr_b16 a[184:185], v28 offset:128
 v_sub_f32 v153, v153, v27
M a[24:27], a[164:167], a[148:151], a[24:27]
 s_waitcnt lgkmcnt(11)
 ds_read_b64_tr_b16 a[186:187], v28 offset:160
 ds_read_b64_tr_b16 a[188:189], v28 offset:192
M a[28:31], a[164:167], a[156:159], a[28:31]
 buffer_load_dwordx4 v14, s[48:51], s22 offen offset:2048   lds
M a[28:31], a[160:163], a[152:155], a[28:31]
 v_sub_f32 v154, v154, v27
 v_sub_f32 v155, v155, v27
M v[32:35], a[168:171], a[96:99], v[32:35]
 ds_read_b128 a[160:163], v5 offset:36864
 ds_read_b128 a[164:167], v6 offset:36864
M v[32:35], a[172:175], a[100:103], v[32:35]
 ds_read_b64_tr_b16 a[44:45], v2 offset:8192
 ds_read_b64_tr_b16 a[46:47], v2 offset:9216
M v[36:39], a[172:175], a[108:111], v[36:39]
 buffer_load_dwordx4 v15, s[48:51], s22 offen offset:3072   lds
M v[36:39], a[168:171], a[104:107], v[36:39]
 s_sub_u32 s22, s22, 2097024
 v_sub_f32 v156, v156, v27
 v_sub_f32 v157, v157, v27
M v[40:43], a[168:171], a[112:115], v[40:43]
 v_sub_f32 v158, v158, v27
 v_sub_f32 v159, v159, v27
M v[40:43], a[172:175], a[116:119], v[40:43]
 ds_read_b64_tr_b16 a[48:49], v3 offset:0
 ds_read_b64_tr_b16 a[50:51], v3 offset:1024
M v[44:47], a[172:175], a[124:127], v[44:47]
 s_add_u32 m0, s23, 49152
M v[44:47], a[168:171], a[120:123], v[44:47]
 buffer_load_dwordx4 v8, s[16:19], s21 offen offset:0  nt lds
M v[48:51], a[168:171], a[128:131], v[48:51]
M v[48:51], a[172:175], a[132:135], v[48:51]
M v[52:55], a[172:175], a[140:143], v[52:55]
 ds_read_b64_tr_b16 a[52:53], v3 offset:8192
 ds_read_b64_tr_b16 a[54:55], v3 offset:9216
M v[52:55], a[168:171], a[136:139], v[52:55]
M v[56:59], a[168:171], a[144:147], v[56:59]
 buffer_load_dwordx4 v9, s[16:19], s21 offen offset:1024  nt lds
M v[56:59], a[172:175], a[148:151], v[56:59]
 s_waitcnt lgkmcnt(6)
M v[60:63], a[172:175], a[156:159], v[60:63]
M v[60:63], a[168:171], a[152:155], v[60:63]
 ds_read_b64_tr_b16 a[56:57], v4 offset:0
 ds_read_b64_tr_b16 a[58:59], v4 offset:1024
M v[64:67], a[160:163], a[96:99], v[64:67]
 ds_read_b128 a[168:171], v5 offset:38912
 ds_read_b128 a[172:175], v6 offset:38912
M v[64:67], a[164:167], a[100:103], v[64:67]
 buffer_load_dwordx4 v10, s[16:19], s21 offen offset:2048  nt lds
M v[68:71], a[164:167], a[108:111], v[68:71]
M v[68:71], a[160:163], a[104:107], v[68:71]
M v[72:75], a[160:163], a[112:115], v[72:75]
 ds_read_b64_tr_b16 a[60:61], v4 offset:8192
 ds_read_b64_tr_b16 a[62:63], v4 offset:9216
M v[72:75], a[164:167], a[116:119], v[72:75]
M v[76:79], a[164:167], a[124:127], v[76:79]
 buffer_load_dwordx4 v11, s[16:19], s21 offen offset:3072  nt lds
M v[76:79], a[160:163], a[120:123], v[76:79]
 s_add_u32 s21, s21, 524160
M v[80:83], a[160:163], a[128:131], v[80:83]
M v[80:83], a[164:167], a[132:135], v[80:83]
M v[84:87], a[164:167], a[140:143], v[84:87]
M v[84:87], a[160:163], a[136:139], v[84:87]
M v[88:91], a[160:163], a[144:147], v[88:91]
M v[88:91], a[164:167], a[148:151], v[88:91]
 s_waitcnt lgkmcnt(2)
M v[92:95], a[164:167], a[156:159], v[92:95]
 s_waitcnt vmcnt(16) lgkmcnt(0)
M v[92:95], a[160:163], a[152:155], v[92:95]
 s_barrier
 v_mfma_f32_16x16x16_bf16 a[208:211], a[176:177], v[16:17], 0
 v_mfma_f32_16x16x16_bf16 a[212:215], a[178:179], v[16:17], 0
 v_mfma_f32_16x16x16_bf16 a[216:219], a[180:181], v[16:17], 0
 v_mfma_f32_16x16x16_bf16 a[220:223], a[182:183], v[16:17], 0
 v_mfma_f32_16x16x16_bf16 a[224:227], a[184:185], v[16:17], 0
 v_mfma_f32_16x16x16_bf16 a[228:231], a[186:187], v[16:17], 0
 v_mfma_f32_16x16x16_bf16 a[232:235], a[188:189], v[16:17], 0
M v[96:99], a[168:171], a[96:99], v[96:99]
 ds_read_b128 a[160:163], v5 offset:49152
 ds_read_b128 a[164:167], v6 offset:49152
M v[96:99], a[172:175], a[100:103], v[96:99]
M v[100:103], a[172:175], a[108:111], v[100:103]
 s_add_u32 m0, s24, 32768
 ds_read_b64_tr_b16 a[64:65], v1 offset:16384
 ds_read_b64_tr_b16 a[66:67], v1 offset:17408
M v[100:103], a[168:171], a[104:107], v[100:103]
 buffer_load_dwordx4 v12, s[48:51], s22 offen offset:0   lds
M v[104:107], a[168:171], a[112:115], v[104:107]
M v[104:107], a[172:175], a[116:119], v[104:107]
M v[108:111], a[172:175], a[124:127], v[108:111]
M v[108:111], a[168:171], a[120:123], v[108:111]
M v[112:115], a[168:171], a[128:131], v[112:115]
M v[112:115], a[172:175], a[132:135], v[112:115]
 ds_read_b64_tr_b16 a[68:69], v1 offset:24576
 ds_read_b64_tr_b16 a[70:71], v1 offset:25600
M v[116:119], a[172:175], a[140:143], v[116:119]
 buffer_load_dwordx4 v13, s[48:51], s22 offen offset:1024   lds
M v[116:119], a[168:171], a[136:139], v[116:119]
M v[120:123], a[168:171], a[144:147], v[120:123]
M v[120:123], a[172:175], a[148:151], v[120:123]
 s_waitcnt lgkmcnt(4)
M v[124:127], a[172:175], a[156:159], v[124:127]
M v[124:127], a[168:171], a[152:155], v[124:127]
M v[128:131], a[160:163], a[96:99], v[128:131]
 ds_read_b128 a[168:171], v5 offset:51200
 ds_read_b128 a[172:175], v6 offset:51200
M v[128:131], a[164:167], a[100:103], v[128:131]
 ds_read_b64_tr_b16 a[72:73], v2 offset:16384
 ds_read_b64_tr_b16 a[74:75], v2 offset:17408
M v[132:135], a[164:167], a[108:111], v[132:135]
 buffer_load_dwordx4 v14, s[48:51], s22 offen offset:2048   lds
M v[132:135], a[160:163], a[104:107], v[132:135]
M v[136:139], a[160:163], a[112:115], v[136:139]
M v[136:139], a[164:167], a[116:119], v[136:139]
M v[140:143], a[164:167], a[124:127], v[140:143]
M v[140:143], a[160:163], a[120:123], v[140:143]
 ds_read_b64_tr_b16 a[76:77], v2 offset:24576
 ds_read_b64_tr_b16 a[78:79], v2 offset:25600
M v[144:147], a[160:163], a[128:131], v[144:147]
 buffer_load_dwordx4 v15, s[48:51], s22 offen offset:3072   lds
M v[144:147], a[164:167], a[132:135], v[144:147]
 s_add_u32 s22, s22, 2097152
M v[148:151], a[164:167], a[140:143], v[148:151]
M v[148:151], a[160:163], a[136:139], v[148:151]
M v[152:155], a[160:163], a[144:147], v[152:155]
M v[152:155], a[164:167], a[148:151], v[152:155]
 s_waitcnt lgkmcnt(4)
M v[156:159], a[164:167], a[156:159], v[156:159]
 s_add_u32 m0, s23, 0
 ds_read_b64_tr_b16 a[80:81], v3 offset:16384
 ds_read_b64_tr_b16 a[82:83], v3 offset:17408
M v[156:159], a[160:163], a[152:155], v[156:159]
 buffer_load_dwordx4 v8, s[52:55], s28 offen offset:0   lds
M v[160:163], a[168:171], a[96:99], v[160:163]
 ds_read_b128 a[160:163], v5 offset:53248
 ds_read_b128 a[164:167], v6 offset:53248
M v[160:163], a[172:175], a[100:103], v[160:163]
M v[164:167], a[172:175], a[108:111], v[164:167]
M v[164:167], a[168:171], a[104:107], v[164:167]
M v[168:171], a[168:171], a[112:115], v[168:171]
M v[168:171], a[172:175], a[116:119], v[168:171]
 ds_read_b64_tr_b16 a[84:85], v3 offset:24576
 ds_read_b64_tr_b16 a[86:87], v3 offset:25600
M v[172:175], a[172:175], a[124:127], v[172:175]
 buffer_load_dwordx4 v9, s[52:55], s28 offen offset:1024   lds
M v[172:175], a[168:171], a[120:123], v[172:175]
M v[176:179], a[168:171], a[128:131], v[176:179]
M v[176:179], a[172:175], a[132:135], v[176:179]
M v[180:183], a[172:175], a[140:143], v[180:183]
M v[180:183], a[168:171], a[136:139], v[180:183]
M v[184:187], a[168:171], a[144:147], v[184:187]
 ds_read_b64_tr_b16 a[88:89], v4 offset:16384
 ds_read_b64_tr_b16 a[90:91], v4 offset:17408
M v[184:187], a[172:175], a[148:151], v[184:187]
 s_waitcnt lgkmcnt(4)
M v[188:191], a[172:175], a[156:159], v[188:191]
 buffer_load_dwordx4 v10, s[52:55], s28 offen offset:2048   lds
M v[188:191], a[168:171], a[152:155], v[188:191]
M v[192:195], a[160:163], a[96:99], v[192:195]
 ds_read_b128 a[168:171], v5 offset:55296
 ds_read_b128 a[172:175], v6 offset:55296
M v[192:195], a[164:167], a[100:103], v[192:195]
M v[196:199], a[164:167], a[108:111], v[196:199]
M v[196:199], a[160:163], a[104:107], v[196:199]
 ds_read_b64_tr_b16 a[92:93], v4 offset:24576
 ds_read_b64_tr_b16 a[94:95], v4 offset:25600
M v[200:203], a[160:163], a[112:115], v[200:203]
 buffer_load_dwordx4 v11, s[52:55], s28 offen offset:3072   lds
M v[200:203], a[164:167], a[116:119], v[200:203]
 s_add_u32 s28, s28, 128
 v_sub_f32 v160, v160, v27
 v_sub_f32 v161, v161, v27
M v[204:207], a[164:167], a[124:127], v[204:207]
 v_sub_f32 v162, v162, v27
 v_sub_f32 v163, v163, v27
M v[204:207], a[160:163], a[120:123], v[204:207]
 v_sub_f32 v164, v164, v27
 v_sub_f32 v165, v165, v27
M v[208:211], a[160:163], a[128:131], v[208:211]
 v_sub_f32 v166, v166, v27
 v_sub_f32 v167, v167, v27
M v[208:211], a[164:167], a[132:135], v[208:211]
 v_sub_f32 v168, v168, v27
 v_sub_f32 v169, v169, v27
M v[212:215], a[164:167], a[140:143], v[212:215]
 v_sub_f32 v170, v170, v27
 v_sub_f32 v171, v171, v27
M v[212:215], a[160:163], a[136:139], v[212:215]
 v_sub_f32 v172, v172, v27
 v_sub_f32 v173, v173, v27
M v[216:219], a[160:163], a[144:147], v[216:219]
 v_sub_f32 v174, v174, v27
 v_sub_f32 v175, v175, v27
M v[216:219], a[164:167], a[148:151], v[216:219]
 s_waitcnt lgkmcnt(2)
 v_sub_f32 v176, v176, v27
 v_sub_f32 v177, v177, v27
M v[220:223], a[164:167], a[156:159], v[220:223]
 s_waitcnt vmcnt(16) lgkmcnt(0)
 v_sub_f32 v178, v178, v27
 v_sub_f32 v179, v179, v27
M v[220:223], a[160:163], a[152:155], v[220:223]
 s_barrier
M v[224:227], a[168:171], a[96:99], v[224:227]
 ds_read_b128 a[160:163], v5 offset:0
 ds_read_b128 a[164:167], v6 offset:0
M v[224:227], a[172:175], a[100:103], v[224:227]
 v_and_b32 v26, 48, v0
 v_lshlrev_b32 v26, 17, v26
M v[228:231], a[172:175], a[108:111], v[228:231]
 v_or_b32 v26, v26, v0
 v_lshl_add_u32 v26, v26, 7, s95
M v[228:231], a[168:171], a[104:107], v[228:231]
 buffer_load_dword a240, v26, s[76:79], 0 offen offset:0
M v[232:235], a[168:171], a[112:115], v[232:235]
 v_sub_f32 v180, v180, v27
 v_sub_f32 v181, v181, v27
M v[232:235], a[172:175], a[116:119], v[232:235]
 v_sub_f32 v182, v182, v27
 v_sub_f32 v183, v183, v27
M v[236:239], a[172:175], a[124:127], v[236:239]
 v_sub_f32 v184, v184, v27
 v_sub_f32 v185, v185, v27
M v[236:239], a[168:171], a[120:123], v[236:239]
 v_sub_f32 v186, v186, v27
 v_sub_f32 v187, v187, v27
M v[240:243], a[168:171], a[128:131], v[240:243]
 v_sub_f32 v188, v188, v27
 v_sub_f32 v189, v189, v27
M v[240:243], a[172:175], a[132:135], v[240:243]
 v_sub_f32 v190, v190, v27
 v_sub_f32 v191, v191, v27
M v[244:247], a[172:175], a[140:143], v[244:247]
 v_sub_f32 v192, v192, v27
 v_sub_f32 v193, v193, v27
M v[244:247], a[168:171], a[136:139], v[244:247]
 v_sub_f32 v194, v194, v27
 v_sub_f32 v195, v195, v27
M v[248:251], a[168:171], a[144:147], v[248:251]
 v_sub_f32 v196, v196, v27
 v_sub_f32 v197, v197, v27
M v[248:251], a[172:175], a[148:151], v[248:251]
 s_waitcnt lgkmcnt(0)
 v_sub_f32 v198, v198, v27
 v_sub_f32 v199, v199, v27
M v[252:255], a[172:175], a[156:159], v[252:255]
 v_sub_f32 v200, v200, v27
 v_sub_f32 v201, v201, v27
M v[252:255], a[168:171], a[152:155], v[252:255]
 v_sub_f32 v202, v202, v27
 v_sub_f32 v203, v203, v27
M a[0:3], a[160:163], a[32:35], a[0:3]
 ds_read_b128 a[168:171], v5 offset:2048
 ds_read_b128 a[172:175], v6 offset:2048
M a[0:3], a[164:167], a[36:39], a[0:3]
 ds_read_b64_tr_b16 a[96:97], v1 offset:32768
 ds_read_b64_tr_b16 a[98:99], v1 offset:33792
M a[4:7], a[164:167], a[44:47], a[4:7]
 s_add_u32 m0, s24, 49152
 v_lshrrev_b32 v28, 4, v0
 v_add_u32 v28, 0, v28
M a[4:7], a[160:163], a[40:43], a[4:7]
 buffer_load_dwordx4 v12, s[48:51], s22 offen offset:0   lds
M a[8:11], a[160:163], a[48:51], a[8:11]
 v_and_b32 v29, 7, v0
 v_xor_b32 v28, v28, v29
M a[8:11], a[164:167], a[52:55], a[8:11]
 v_lshlrev_b32 v28, 4, v28
 v_lshrrev_b32 v29, 3, v0
M a[12:15], a[164:167], a[60:63], a[12:15]
 ds_read_b64_tr_b16 a[100:101], v1 offset:40960
 ds_read_b64_tr_b16 a[102:103], v1 offset:41984
M a[12:15], a[160:163], a[56:59], a[12:15]
 buffer_load_dwordx4 v13, s[48:51], s22 offen offset:1024   lds
M a[16:19], a[160:163], a[64:67], a[16:19]
 v_mul_u32_u24 v29, 896, v29
 s_mul_i32 s64, s20, 28672
M a[16:19], a[164:167], a[68:71], a[16:19]
 buffer_load_dwordx4 v14, s[48:51], s22 offen offset:2048   lds
M a[20:23], a[164:167], a[76:79], a[20:23]
 s_add_u32 s64, s64, 0
 v_add3_u32 v16, v29, v28, s64
M a[20:23], a[160:163], a[72:75], a[20:23]
 ds_read_b64_tr_b16 a[104:105], v2 offset:32768
 ds_read_b64_tr_b16 a[106:107], v2 offset:33792
M a[24:27], a[160:163], a[80:83], a[24:27]
 v_add_u32 v18, 12288, v16
 v_lshrrev_b32 v28, 4, v0
M a[24:27], a[164:167], a[84:87], a[24:27]
 s_waitcnt lgkmcnt(6)
 v_add_u32 v28, 4, v28
 v_and_b32 v29, 7, v0
M a[28:31], a[164:167], a[92:95], a[28:31]
 buffer_load_dwordx4 v15, s[48:51], s22 offen offset:3072   lds
M a[28:31], a[160:163], a[88:91], a[28:31]
 s_sub_u32 s22, s22, 2097024
 v_xor_b32 v28, v28, v29
 v_lshlrev_b32 v28, 4, v28
M v[32:35], a[168:171], a[32:35], v[32:35]
 s_add_u32 m0, s23, 16384
 ds_read_b128 a[160:163], v5 offset:4096
 ds_read_b128 a[164:167], v6 offset:4096
M v[32:35], a[172:175], a[36:39], v[32:35]
 ds_read_b64_tr_b16 a[108:109], v2 offset:40960
 ds_read_b64_tr_b16 a[110:111], v2 offset:41984
M v[36:39], a[172:175], a[44:47], v[36:39]
 buffer_load_dwordx4 v8, s[52:55], s28 offen offset:0   lds
M v[36:39], a[168:171], a[40:43], v[36:39]
 v_lshrrev_b32 v29, 3, v0
 v_mul_u32_u24 v29, 896, v29
M v[40:43], a[168:171], a[48:51], v[40:43]
 buffer_load_dwordx4 v9, s[52:55], s28 offen offset:1024   lds
M v[40:43], a[172:175], a[52:55], v[40:43]
 ds_read_b64_tr_b16 a[112:113], v3 offset:32768
 ds_read_b64_tr_b16 a[114:115], v3 offset:33792
M v[44:47], a[172:175], a[60:63], v[44:47]
 s_mul_i32 s64, s20, 28672
 s_add_u32 s64, s64, 6144
M v[44:47], a[168:171], a[56:59], v[44:47]
 buffer_load_dwordx4 v10, s[52:55], s28 offen offset:2048   lds
M v[48:51], a[168:171], a[64:67], v[48:51]
 v_add3_u32 v17, v29, v28, s64
 v_add_u32 v19, 12288, v17
M v[48:51], a[172:175], a[68:71], v[48:51]
 v_add_u32 v20, 0x20000, v1
 v_add_u32 v21, 0x20000, v2
M v[52:55], a[172:175], a[76:79], v[52:55]
 ds_read_b64_tr_b16 a[116:117], v3 offset:40960
 ds_read_b64_tr_b16 a[118:119], v3 offset:41984
M v[52:55], a[168:171], a[72:75], v[52:55]
 buffer_load_dwordx4 v11, s[52:55], s28 offen offset:3072   lds
M v[56:59], a[168:171], a[80:83], v[56:59]
 s_add_u32 s28, s28, 1048448
 v_add_u32 v22, 0x20000, v3
 v_add_u32 v23, 0x20000, v4
M v[56:59], a[172:175], a[84:87], v[56:59]
 s_waitcnt lgkmcnt(6)
 v_sub_f32 v204, v204, v27
 v_sub_f32 v205, v205, v27
M v[60:63], a[172:175], a[92:95], v[60:63]
 s_add_u32 m0, s23, 131072
 v_sub_f32 v206, v206, v27
 v_sub_f32 v207, v207, v27
M v[60:63], a[168:171], a[88:91], v[60:63]
 ds_read_b64_tr_b16 a[120:121], v4 offset:32768
 ds_read_b64_tr_b16 a[122:123], v4 offset:33792
M v[64:67], a[160:163], a[32:35], v[64:67]
 ds_read_b128 a[168:171], v5 offset:6144
 ds_read_b128 a[172:175], v6 offset:6144
M v[64:67], a[164:167], a[36:39], v[64:67]
 buffer_load_dwordx4 v8, s[52:55], s28 offen offset:0   lds
M v[68:71], a[164:167], a[44:47], v[68:71]
 buffer_load_dwordx4 v9, s[52:55], s28 offen offset:1024   lds
M v[68:71], a[160:163], a[40:43], v[68:71]
 v_sub_f32 v208, v208, v27
 v_sub_f32 v209, v209, v27
M v[72:75], a[160:163], a[48:51], v[72:75]
 ds_read_b64_tr_b16 a[124:125], v4 offset:40960
 ds_read_b64_tr_b16 a[126:127], v4 offset:41984
M v[72:75], a[164:167], a[52:55], v[72:75]
 buffer_load_dwordx4 v10, s[52:55], s28 offen offset:2048   lds
M v[76:79], a[164:167], a[60:63], v[76:79]
 v_sub_f32 v210, v210, v27
 v_sub_f32 v211, v211, v27
M v[76:79], a[160:163], a[56:59], v[76:79]
 v_sub_f32 v212, v212, v27
 v_sub_f32 v213, v213, v27
M v[80:83], a[160:163], a[64:67], v[80:83]
 buffer_load_dwordx4 v11, s[52:55], s28 offen offset:3072   lds
M v[80:83], a[164:167], a[68:71], v[80:83]
 s_sub_u32 s28, s28, 524288
 v_sub_f32 v214, v214, v27
 v_sub_f32 v215, v215, v27
M v[84:87], a[164:167], a[76:79], v[84:87]
 v_sub_f32 v216, v216, v27
 v_sub_f32 v217, v217, v27
M v[84:87], a[160:163], a[72:75], v[84:87]
 v_sub_f32 v218, v218, v27
 v_sub_f32 v219, v219, v27
M v[88:91], a[160:163], a[80:83], v[88:91]
 v_sub_f32 v220, v220, v27
 v_sub_f32 v221, v221, v27
M v[88:91], a[164:167], a[84:87], v[88:91]
 s_waitcnt lgkmcnt(2)
 v_sub_f32 v222, v222, v27
 v_sub_f32 v223, v223, v27
M v[92:95], a[164:167], a[92:95], v[92:95]
 s_waitcnt vmcnt(21) lgkmcnt(0)
 v_sub_f32 v224, v224, v27
 v_sub_f32 v225, v225, v27
M v[92:95], a[160:163], a[88:91], v[92:95]
 s_barrier
M v[96:99], a[168:171], a[32:35], v[96:99]
 ds_read_b128 a[160:163], v5 offset:16384
 ds_read_b128 a[164:167], v6 offset:16384
M v[96:99], a[172:175], a[36:39], v[96:99]
 v_sub_f32 v226, v226, v27
 v_sub_f32 v227, v227, v27
M v[100:103], a[172:175], a[44:47], v[100:103]
 s_add_u32 m0, s24, 0
 ds_read_b64_tr_b16 a[128:129], v1 offset:49152
 ds_read_b64_tr_b16 a[130:131], v1 offset:50176
M v[100:103], a[168:171], a[40:43], v[100:103]
 buffer_load_dwordx4 v16, s[56:59], s29 offen offset:0   lds
M v[104:107], a[168:171], a[48:51], v[104:107]
 s_mul_i32 s72, s41, 4352
 v_sub_f32 v228, v228, v27
M v[104:107], a[172:175], a[52:55], v[104:107]
 s_add_u32 s46, s72, 104923136
 v_sub_f32 v229, v229, v27
 v_sub_f32 v230, v230, v27
M v[108:111], a[172:175], a[60:63], v[108:111]
 s_lshl_b32 s45, s42, 7
 s_add_u32 s45, s45, s46
 s_sub_u32 s66, 15, s42
M v[108:111], a[168:171], a[56:59], v[108:111]
 buffer_load_dwordx4 v17, s[56:59], s29 offen offset:1024   lds
M v[112:115], a[168:171], a[64:67], v[112:115]
 s_min_u32 s66, s66, s42
 v_sub_f32 v231, v231, v27
M v[112:115], a[172:175], a[68:71], v[112:115]
 s_lshl_b32 s47, s66, 7
 ds_read_b64_tr_b16 a[132:133], v1 offset:57344
 ds_read_b64_tr_b16 a[134:135], v1 offset:58368
M v[116:119], a[172:175], a[76:79], v[116:119]
 s_add_u32 s47, s47, s46
 v_sub_f32 v232, v232, v27
 v_sub_f32 v233, v233, v27
M v[116:119], a[168:171], a[72:75], v[116:119]
 s_add_u32 s47, s47, 2112
 s_lshl_b32 s65, s41, 3
 s_add_u32 s65, s65, s66
M v[120:123], a[168:171], a[80:83], v[120:123]
 buffer_load_dwordx4 v18, s[56:59], s29 offen offset:2048   lds
M v[120:123], a[172:175], a[84:87], v[120:123]
 s_waitcnt lgkmcnt(4)
 s_mul_i32 s34, s65, 73728
 v_sub_f32 v234, v234, v27
M v[124:127], a[172:175], a[92:95], v[124:127]
 s_add_u32 s34, s34, 50331648
 v_sub_f32 v235, v235, v27
 v_sub_f32 v236, v236, v27
M v[124:127], a[168:171], a[88:91], v[124:127]
 s_lshl_b32 s65, s42, 4
 v_sub_f32 v237, v237, v27
 v_sub_f32 v238, v238, v27
M v[128:131], a[160:163], a[32:35], v[128:131]
 s_add_u32 s65, s65, s41
 ds_read_b128 a[168:171], v5 offset:18432
 ds_read_b128 a[172:175], v6 offset:18432
M v[128:131], a[164:167], a[36:39], v[128:131]
 s_mul_i32 s33, s65, 114688
 ds_read_b64_tr_b16 a[136:137], v2 offset:49152
 ds_read_b64_tr_b16 a[138:139], v2 offset:50176
M v[132:135], a[164:167], a[44:47], v[132:135]
 buffer_load_dwordx4 v19, s[56:59], s29 offen offset:3072   lds
M v[132:135], a[160:163], a[40:43], v[132:135]
 s_add_u32 s29, s29, 128
 s_mul_i32 s65, s20, 28672
 v_sub_f32 v239, v239, v27
M v[136:139], a[160:163], a[48:51], v[136:139]
 s_add_u32 s33, s33, s65
 s_add_u32 s33, s33, 67108864
 s_sub_u32 s65, 15, s66
M v[136:139], a[164:167], a[52:55], v[136:139]
 s_add_u32 m0, s23, 32768
 s_lshl_b32 s65, s65, 16
 s_lshl_b32 s64, s41, 20
M v[140:143], a[164:167], a[60:63], v[140:143]
 buffer_load_dwordx4 v8, s[52:55], s28 offen offset:0   lds
M v[140:143], a[160:163], a[56:59], v[140:143]
 ds_read_b64_tr_b16 a[140:141], v2 offset:57344
 ds_read_b64_tr_b16 a[142:143], v2 offset:58368
M v[144:147], a[160:163], a[64:67], v[144:147]
 s_add_u32 s32, s64, s65
 v_sub_f32 v240, v240, v27
M v[144:147], a[164:167], a[68:71], v[144:147]
 s_lshl_b32 s65, s20, 14
 s_add_u32 s32, s32, s65
 s_add_u32 s32, s32, 33554432
M v[148:151], a[164:167], a[76:79], v[148:151]
 buffer_load_dwordx4 v9, s[52:55], s28 offen offset:1024   lds
M v[148:151], a[160:163], a[72:75], v[148:151]
 s_mov_b32 s31, 0x53800000
 v_sub_f32 v241, v241, v27
M v[152:155], a[160:163], a[80:83], v[152:155]
 s_mov_b32 s40, 1
 s_sub_u32 s64, s42, 10
 s_and_b32 s35, s64, 536870912
M v[152:155], a[164:167], a[84:87], v[152:155]
 s_waitcnt lgkmcnt(4)
 v_sub_f32 v242, v242, v27
 v_sub_f32 v243, v243, v27
M v[156:159], a[164:167], a[92:95], v[156:159]
 ds_read_b64_tr_b16 a[144:145], v3 offset:49152
 ds_read_b64_tr_b16 a[146:147], v3 offset:50176
M v[156:159], a[160:163], a[88:91], v[156:159]
 buffer_load_dwordx4 v10, s[52:55], s28 offen offset:2048   lds
M v[160:163], a[168:171], a[32:35], v[160:163]
 ds_read_b128 a[160:163], v5 offset:20480
 ds_read_b128 a[164:167], v6 offset:20480
M v[160:163], a[172:175], a[36:39], v[160:163]
 v_sub_f32 v244, v244, v27
 v_sub_f32 v245, v245, v27
M v[164:167], a[172:175], a[44:47], v[164:167]
 v_sub_f32 v246, v246, v27
 v_sub_f32 v247, v247, v27
M v[164:167], a[168:171], a[40:43], v[164:167]
 v_sub_f32 v248, v248, v27
 v_sub_f32 v249, v249, v27
M v[168:171], a[168:171], a[48:51], v[168:171]
 buffer_load_dwordx4 v11, s[52:55], s28 offen offset:3072   lds
M v[168:171], a[172:175], a[52:55], v[168:171]
 s_add_u32 s28, s28, 524416
 ds_read_b64_tr_b16 a[148:149], v3 offset:57344
 ds_read_b64_tr_b16 a[150:151], v3 offset:58368
M v[172:175], a[172:175], a[60:63], v[172:175]
 v_sub_f32 v250, v250, v27
 v_sub_f32 v251, v251, v27
M v[172:175], a[168:171], a[56:59], v[172:175]
 v_sub_f32 v252, v252, v27
 v_sub_f32 v253, v253, v27
M v[176:179], a[168:171], a[64:67], v[176:179]
 s_add_u32 m0, s23, 147456
 v_sub_f32 v254, v254, v27
 v_sub_f32 v255, v255, v27
M v[176:179], a[172:175], a[68:71], v[176:179]
 buffer_load_dwordx4 v8, s[52:55], s28 offen offset:0   lds
M v[180:183], a[172:175], a[76:79], v[180:183]
M v[180:183], a[168:171], a[72:75], v[180:183]
M v[184:187], a[168:171], a[80:83], v[184:187]
 ds_read_b64_tr_b16 a[152:153], v4 offset:49152
 ds_read_b64_tr_b16 a[154:155], v4 offset:50176
M v[184:187], a[172:175], a[84:87], v[184:187]
 s_waitcnt lgkmcnt(4)
M v[188:191], a[172:175], a[92:95], v[188:191]
 buffer_load_dwordx4 v9, s[52:55], s28 offen offset:1024   lds
M v[188:191], a[168:171], a[88:91], v[188:191]
M v[192:195], a[160:163], a[32:35], v[192:195]
 ds_read_b128 a[168:171], v5 offset:22528
 ds_read_b128 a[172:175], v6 offset:22528
M v[192:195], a[164:167], a[36:39], v[192:195]
M v[196:199], a[164:167], a[44:47], v[196:199]
 buffer_load_dwordx4 v10, s[52:55], s28 offen offset:2048   lds
M v[196:199], a[160:163], a[40:43], v[196:199]
 ds_read_b64_tr_b16 a[156:157], v4 offset:57344
 ds_read_b64_tr_b16 a[158:159], v4 offset:58368
M v[200:203], a[160:163], a[48:51], v[200:203]
M v[200:203], a[164:167], a[52:55], v[200:203]
M v[204:207], a[164:167], a[60:63], v[204:207]
M v[204:207], a[160:163], a[56:59], v[204:207]
 buffer_load_dwordx4 v11, s[52:55], s28 offen offset:3072   lds
M v[208:211], a[160:163], a[64:67], v[208:211]
 s_sub_u32 s28, s28, 524288
M v[208:211], a[164:167], a[68:71], v[208:211]
M v[212:215], a[164:167], a[76:79], v[212:215]
M v[212:215], a[160:163], a[72:75], v[212:215]
M v[216:219], a[160:163], a[80:83], v[216:219]
M v[216:219], a[164:167], a[84:87], v[216:219]
 s_waitcnt lgkmcnt(2)
M v[220:223], a[164:167], a[92:95], v[220:223]
 s_waitcnt vmcnt(25) lgkmcnt(0)
M v[220:223], a[160:163], a[88:91], v[220:223]
 s_barrier
M v[224:227], a[168:171], a[32:35], v[224:227]
 ds_read_b128 a[160:163], v5 offset:32768
 ds_read_b128 a[164:167], v6 offset:32768
M v[224:227], a[172:175], a[36:39], v[224:227]
M v[228:231], a[172:175], a[44:47], v[228:231]
M v[228:231], a[168:171], a[40:43], v[228:231]
M v[232:235], a[168:171], a[48:51], v[232:235]
M v[232:235], a[172:175], a[52:55], v[232:235]
M v[236:239], a[172:175], a[60:63], v[236:239]
M v[236:239], a[168:171], a[56:59], v[236:239]
M v[240:243], a[168:171], a[64:67], v[240:243]
M v[240:243], a[172:175], a[68:71], v[240:243]
M v[244:247], a[172:175], a[76:79], v[244:247]
M v[244:247], a[168:171], a[72:75], v[244:247]
M v[248:251], a[168:171], a[80:83], v[248:251]
M v[248:251], a[172:175], a[84:87], v[248:251]
 s_waitcnt lgkmcnt(0)
M v[252:255], a[172:175], a[92:95], v[252:255]
M v[252:255], a[168:171], a[88:91], v[252:255]
M a[0:3], a[160:163], a[96:99], a[0:3]
 ds_read_b128 a[168:171], v5 offset:34816
 ds_read_b128 a[172:175], v6 offset:34816
M a[0:3], a[164:167], a[100:103], a[0:3]
 ds_read_b64_tr_b16 a[32:33], v1 offset:0
 ds_read_b64_tr_b16 a[34:35], v1 offset:1024
M a[4:7], a[164:167], a[108:111], a[4:7]
 s_add_u32 m0, s24, 16384
M a[4:7], a[160:163], a[104:107], a[4:7]
 buffer_load_dwordx4 v16, s[56:59], s29 offen offset:0   lds
M a[8:11], a[160:163], a[112:115], a[8:11]
M a[8:11], a[164:167], a[116:119], a[8:11]
M a[12:15], a[164:167], a[124:127], a[12:15]
 ds_read_b64_tr_b16 a[36:37], v1 offset:8192
 ds_read_b64_tr_b16 a[38:39], v1 offset:9216
M a[12:15], a[160:163], a[120:123], a[12:15]
M a[16:19], a[160:163], a[128:131], a[16:19]
 buffer_load_dwordx4 v17, s[56:59], s29 offen offset:1024   lds
M a[16:19], a[164:167], a[132:135], a[16:19]
M a[20:23], a[164:167], a[140:143], a[20:23]
M a[20:23], a[160:163], a[136:139], a[20:23]
 ds_read_b64_tr_b16 a[40:41], v2 offset:0
 ds_read_b64_tr_b16 a[42:43], v2 offset:1024
M a[24:27], a[160:163], a[144:147], a[24:27]
M a[24:27], a[164:167], a[148:151], a[24:27]
 s_waitcnt lgkmcnt(6)
 buffer_load_dwordx4 v18, s[56:59], s29 offen offset:2048   lds
M a[28:31], a[164:167], a[156:159], a[28:31]
M a[28:31], a[160:163], a[152:155], a[28:31]
M v[32:35], a[168:171], a[96:99], v[32:35]
 ds_read_b128 a[160:163], v5 offset:36864
 ds_read_b128 a[164:167], v6 offset:36864
M v[32:35], a[172:175], a[100:103], v[32:35]
 ds_read_b64_tr_b16 a[44:45], v2 offset:8192
 ds_read_b64_tr_b16 a[46:47], v2 offset:9216
M v[36:39], a[172:175], a[108:111], v[36:39]
 buffer_load_dwordx4 v19, s[56:59], s29 offen offset:3072   lds
M v[36:39], a[168:171], a[104:107], v[36:39]
 s_add_u32 s29, s29, 128
M v[40:43], a[168:171], a[112:115], v[40:43]
M v[40:43], a[172:175], a[116:119], v[40:43]
 ds_read_b64_tr_b16 a[48:49], v3 offset:0
 ds_read_b64_tr_b16 a[50:51], v3 offset:1024
M v[44:47], a[172:175], a[124:127], v[44:47]
 s_add_u32 m0, s23, 49152
 v_accvgpr_read_b32 v24, a0
 v_accvgpr_read_b32 v25, a1
M v[44:47], a[168:171], a[120:123], v[44:47]
 buffer_load_dwordx4 v8, s[52:55], s28 offen offset:0   lds
M v[48:51], a[168:171], a[128:131], v[48:51]
 v_accvgpr_read_b32 v26, a2
 v_accvgpr_read_b32 v27, a3
M v[48:51], a[172:175], a[132:135], v[48:51]
 v_cvt_pk_bf16_f32 v24, v24, v25
 v_cvt_pk_bf16_f32 v25, v26, v27
M v[52:55], a[172:175], a[140:143], v[52:55]
 ds_read_b64_tr_b16 a[52:53], v3 offset:8192
 ds_read_b64_tr_b16 a[54:55], v3 offset:9216
M v[52:55], a[168:171], a[136:139], v[52:55]
 v_cvt_pk_bf16_f32 v26, v32, v33
 v_cvt_pk_bf16_f32 v27, v34, v35
M v[56:59], a[168:171], a[144:147], v[56:59]
 s_add_u32 s3, s93, 0
 buffer_load_dwordx4 v9, s[52:55], s28 offen offset:1024   lds
M v[56:59], a[172:175], a[148:151], v[56:59]
 s_waitcnt lgkmcnt(6)
M v[60:63], a[172:175], a[156:159], v[60:63]
 buffer_store_dwordx4 v[24:27], v7, s[8:11], s3 offen offset:0 sc1
M v[60:63], a[168:171], a[152:155], v[60:63]
 ds_read_b64_tr_b16 a[56:57], v4 offset:0
 ds_read_b64_tr_b16 a[58:59], v4 offset:1024
M v[64:67], a[160:163], a[96:99], v[64:67]
 ds_read_b128 a[168:171], v5 offset:38912
 ds_read_b128 a[172:175], v6 offset:38912
M v[64:67], a[164:167], a[100:103], v[64:67]
 buffer_load_dwordx4 v10, s[52:55], s28 offen offset:2048   lds
M v[68:71], a[164:167], a[108:111], v[68:71]
 v_accvgpr_read_b32 v24, a4
 v_accvgpr_read_b32 v25, a5
M v[68:71], a[160:163], a[104:107], v[68:71]
 v_accvgpr_read_b32 v26, a6
 v_accvgpr_read_b32 v27, a7
M v[72:75], a[160:163], a[112:115], v[72:75]
 ds_read_b64_tr_b16 a[60:61], v4 offset:8192
 ds_read_b64_tr_b16 a[62:63], v4 offset:9216
M v[72:75], a[164:167], a[116:119], v[72:75]
 v_cvt_pk_bf16_f32 v24, v24, v25
 v_cvt_pk_bf16_f32 v25, v26, v27
M v[76:79], a[164:167], a[124:127], v[76:79]
 buffer_load_dwordx4 v11, s[52:55], s28 offen offset:3072   lds
M v[76:79], a[160:163], a[120:123], v[76:79]
 s_add_u32 s28, s28, 1048448
 v_cvt_pk_bf16_f32 v26, v36, v37
 v_cvt_pk_bf16_f32 v27, v38, v39
M v[80:83], a[160:163], a[128:131], v[80:83]
M v[80:83], a[164:167], a[132:135], v[80:83]
M v[84:87], a[164:167], a[140:143], v[84:87]
 buffer_store_dwordx4 v[24:27], v7, s[8:11], s3 offen offset:2048 sc1
M v[84:87], a[160:163], a[136:139], v[84:87]
M v[88:91], a[160:163], a[144:147], v[88:91]
M v[88:91], a[164:167], a[148:151], v[88:91]
 s_waitcnt lgkmcnt(2)
M v[92:95], a[164:167], a[156:159], v[92:95]
 s_waitcnt vmcnt(26) lgkmcnt(0)
 v_accvgpr_read_b32 v24, a8
 v_accvgpr_read_b32 v25, a9
M v[92:95], a[160:163], a[152:155], v[92:95]
 s_barrier
M v[96:99], a[168:171], a[96:99], v[96:99]
 ds_read_b128 a[160:163], v5 offset:49152
 ds_read_b128 a[164:167], v6 offset:49152
M v[96:99], a[172:175], a[100:103], v[96:99]
 v_accvgpr_read_b32 v26, a10
 v_accvgpr_read_b32 v27, a11
M v[100:103], a[172:175], a[108:111], v[100:103]
 s_add_u32 m0, s24, 32768
 ds_read_b64_tr_b16 a[64:65], v1 offset:16384
 ds_read_b64_tr_b16 a[66:67], v1 offset:17408
M v[100:103], a[168:171], a[104:107], v[100:103]
 buffer_load_dwordx4 v16, s[56:59], s29 offen offset:0   lds
M v[104:107], a[168:171], a[112:115], v[104:107]
 v_cvt_pk_bf16_f32 v24, v24, v25
 v_cvt_pk_bf16_f32 v25, v26, v27
M v[104:107], a[172:175], a[116:119], v[104:107]
 v_cvt_pk_bf16_f32 v26, v40, v41
 v_cvt_pk_bf16_f32 v27, v42, v43
M v[108:111], a[172:175], a[124:127], v[108:111]
 s_add_u32 s3, s93, 4096
 buffer_store_dwordx4 v[24:27], v7, s[8:11], s3 offen offset:0 sc1
M v[108:111], a[168:171], a[120:123], v[108:111]
 v_cvt_pk_bf16_f32 v64, v64, v65
 v_cvt_pk_bf16_f32 v65, v66, v67
M v[112:115], a[168:171], a[128:131], v[112:115]
 v_cvt_pk_bf16_f32 v66, v96, v97
 v_cvt_pk_bf16_f32 v67, v98, v99
M v[112:115], a[172:175], a[132:135], v[112:115]
 ds_read_b64_tr_b16 a[68:69], v1 offset:24576
 ds_read_b64_tr_b16 a[70:71], v1 offset:25600
M v[116:119], a[172:175], a[140:143], v[116:119]
 buffer_load_dwordx4 v17, s[56:59], s29 offen offset:1024   lds
M v[116:119], a[168:171], a[136:139], v[116:119]
 v_accvgpr_read_b32 v24, a12
 v_accvgpr_read_b32 v25, a13
M v[120:123], a[168:171], a[144:147], v[120:123]
 v_accvgpr_read_b32 v26, a14
 v_accvgpr_read_b32 v27, a15
M v[120:123], a[172:175], a[148:151], v[120:123]
 s_waitcnt lgkmcnt(4)
 v_cvt_pk_bf16_f32 v24, v24, v25
 v_cvt_pk_bf16_f32 v25, v26, v27
M v[124:127], a[172:175], a[156:159], v[124:127]
 v_cvt_pk_bf16_f32 v26, v44, v45
 v_cvt_pk_bf16_f32 v27, v46, v47
M v[124:127], a[168:171], a[152:155], v[124:127]
 buffer_store_dwordx4 v[24:27], v7, s[8:11], s3 offen offset:2048 sc1
M v[128:131], a[160:163], a[96:99], v[128:131]
 ds_read_b128 a[168:171], v5 offset:51200
 ds_read_b128 a[172:175], v6 offset:51200
M v[128:131], a[164:167], a[100:103], v[128:131]
 ds_read_b64_tr_b16 a[72:73], v2 offset:16384
 ds_read_b64_tr_b16 a[74:75], v2 offset:17408
M v[132:135], a[164:167], a[108:111], v[132:135]
 buffer_load_dwordx4 v18, s[56:59], s29 offen offset:2048   lds
M v[132:135], a[160:163], a[104:107], v[132:135]
 v_cvt_pk_bf16_f32 v68, v68, v69
 v_cvt_pk_bf16_f32 v69, v70, v71
M v[136:139], a[160:163], a[112:115], v[136:139]
 v_cvt_pk_bf16_f32 v70, v100, v101
 v_cvt_pk_bf16_f32 v71, v102, v103
M v[136:139], a[164:167], a[116:119], v[136:139]
 v_cvt_pk_bf16_f32 v72, v72, v73
 v_cvt_pk_bf16_f32 v73, v74, v75
M v[140:143], a[164:167], a[124:127], v[140:143]
 v_accvgpr_read_b32 v24, a16
 v_accvgpr_read_b32 v25, a17
M v[140:143], a[160:163], a[120:123], v[140:143]
 ds_read_b64_tr_b16 a[76:77], v2 offset:24576
 ds_read_b64_tr_b16 a[78:79], v2 offset:25600
M v[144:147], a[160:163], a[128:131], v[144:147]
 buffer_load_dwordx4 v19, s[56:59], s29 offen offset:3072   lds
M v[144:147], a[164:167], a[132:135], v[144:147]
 s_add_u32 s29, s29, 128
 v_accvgpr_read_b32 v26, a18
 v_accvgpr_read_b32 v27, a19
M v[148:151], a[164:167], a[140:143], v[148:151]
 v_cvt_pk_bf16_f32 v24, v24, v25
 v_cvt_pk_bf16_f32 v25, v26, v27
M v[148:151], a[160:163], a[136:139], v[148:151]
 v_cvt_pk_bf16_f32 v26, v48, v49
 v_cvt_pk_bf16_f32 v27, v50, v51
M v[152:155], a[160:163], a[144:147], v[152:155]
 s_add_u32 s3, s93, 8192
 buffer_store_dwordx4 v[24:27], v7, s[8:11], s3 offen offset:0 sc1
M v[152:155], a[164:167], a[148:151], v[152:155]
 s_waitcnt lgkmcnt(4)
 v_cvt_pk_bf16_f32 v74, v104, v105
 v_cvt_pk_bf16_f32 v75, v106, v107
M v[156:159], a[164:167], a[156:159], v[156:159]
 s_add_u32 m0, s23, 0
 ds_read_b64_tr_b16 a[80:81], v3 offset:16384
 ds_read_b64_tr_b16 a[82:83], v3 offset:17408
M v[156:159], a[160:163], a[152:155], v[156:159]
 buffer_load_dwordx4 v8, s[52:55], s28 offen offset:0   lds
M v[160:163], a[168:171], a[96:99], v[160:163]
 ds_read_b128 a[160:163], v5 offset:53248
 ds_read_b128 a[164:167], v6 offset:53248
M v[160:163], a[172:175], a[100:103], v[160:163]
 v_cvt_pk_bf16_f32 v76, v76, v77
 v_cvt_pk_bf16_f32 v77, v78, v79
M v[164:167], a[172:175], a[108:111], v[164:167]
 v_accvgpr_read_b32 v24, a20
 v_accvgpr_read_b32 v25, a21
M v[164:167], a[168:171], a[104:107], v[164:167]
 v_accvgpr_read_b32 v26, a22
 v_accvgpr_read_b32 v27, a23
M v[168:171], a[168:171], a[112:115], v[168:171]
 v_cvt_pk_bf16_f32 v24, v24, v25
 v_cvt_pk_bf16_f32 v25, v26, v27
M v[168:171], a[172:175], a[116:119], v[168:171]
 ds_read_b64_tr_b16 a[84:85], v3 offset:24576
 ds_read_b64_tr_b16 a[86:87], v3 offset:25600
M v[172:175], a[172:175], a[124:127], v[172:175]
 buffer_load_dwordx4 v9, s[52:55], s28 offen offset:1024   lds
M v[172:175], a[168:171], a[120:123], v[172:175]
 v_cvt_pk_bf16_f32 v26, v52, v53
 v_cvt_pk_bf16_f32 v27, v54, v55
M v[176:179], a[168:171], a[128:131], v[176:179]
 v_cvt_pk_bf16_f32 v78, v108, v109
 v_cvt_pk_bf16_f32 v79, v110, v111
M v[176:179], a[172:175], a[132:135], v[176:179]
 buffer_store_dwordx4 v[24:27], v7, s[8:11], s3 offen offset:2048 sc1
M v[180:183], a[172:175], a[140:143], v[180:183]
 v_cvt_pk_bf16_f32 v80, v80, v81
 v_cvt_pk_bf16_f32 v81, v82, v83
M v[180:183], a[168:171], a[136:139], v[180:183]
 v_cvt_pk_bf16_f32 v82, v112, v113
 v_cvt_pk_bf16_f32 v83, v114, v115
M v[184:187], a[168:171], a[144:147], v[184:187]
 ds_read_b64_tr_b16 a[88:89], v4 offset:16384
 ds_read_b64_tr_b16 a[90:91], v4 offset:17408
M v[184:187], a[172:175], a[148:151], v[184:187]
 s_waitcnt lgkmcnt(4)
 buffer_load_dwordx4 v10, s[52:55], s28 offen offset:2048   lds
M v[188:191], a[172:175], a[156:159], v[188:191]
 v_accvgpr_read_b32 v24, a24
 v_accvgpr_read_b32 v25, a25
M v[188:191], a[168:171], a[152:155], v[188:191]
 v_accvgpr_read_b32 v26, a26
 v_accvgpr_read_b32 v27, a27
M v[192:195], a[160:163], a[96:99], v[192:195]
 ds_read_b128 a[168:171], v5 offset:55296
 ds_read_b128 a[172:175], v6 offset:55296
M v[192:195], a[164:167], a[100:103], v[192:195]
 v_cvt_pk_bf16_f32 v24, v24, v25
 v_cvt_pk_bf16_f32 v25, v26, v27
M v[196:199], a[164:167], a[108:111], v[196:199]
 v_cvt_pk_bf16_f32 v26, v56, v57
 v_cvt_pk_bf16_f32 v27, v58, v59
M v[196:199], a[160:163], a[104:107], v[196:199]
 s_add_u32 s3, s93, 12288
 ds_read_b64_tr_b16 a[92:93], v4 offset:24576
 ds_read_b64_tr_b16 a[94:95], v4 offset:25600
M v[200:203], a[160:163], a[112:115], v[200:203]
 buffer_load_dwordx4 v11, s[52:55], s28 offen offset:3072   lds
M v[200:203], a[164:167], a[116:119], v[200:203]
 s_add_u32 s28, s28, 128
 v_cvt_pk_bf16_f32 v84, v84, v85
 v_cvt_pk_bf16_f32 v85, v86, v87
M v[204:207], a[164:167], a[124:127], v[204:207]
 v_cvt_pk_bf16_f32 v86, v116, v117
 v_cvt_pk_bf16_f32 v87, v118, v119
M v[204:207], a[160:163], a[120:123], v[204:207]
 v_cvt_pk_bf16_f32 v88, v88, v89
 v_cvt_pk_bf16_f32 v89, v90, v91
M v[208:211], a[160:163], a[128:131], v[208:211]
 buffer_store_dwordx4 v[24:27], v7, s[8:11], s3 offen offset:0 sc1
M v[208:211], a[164:167], a[132:135], v[208:211]
 v_cvt_pk_bf16_f32 v90, v120, v121
 v_cvt_pk_bf16_f32 v91, v122, v123
M v[212:215], a[164:167], a[140:143], v[212:215]
 v_accvgpr_read_b32 v24, a28
 v_accvgpr_read_b32 v25, a29
M v[212:215], a[160:163], a[136:139], v[212:215]
 v_accvgpr_read_b32 v26, a30
 v_accvgpr_read_b32 v27, a31
M v[216:219], a[160:163], a[144:147], v[216:219]
 v_cvt_pk_bf16_f32 v24, v24, v25
 v_cvt_pk_bf16_f32 v25, v26, v27
M v[216:219], a[164:167], a[148:151], v[216:219]
 s_waitcnt lgkmcnt(2)
 v_cvt_pk_bf16_f32 v26, v60, v61
 v_cvt_pk_bf16_f32 v27, v62, v63
M v[220:223], a[164:167], a[156:159], v[220:223]
 s_waitcnt vmcnt(27) lgkmcnt(0)
 buffer_store_dwordx4 v[24:27], v7, s[8:11], s3 offen offset:2048 sc1
M v[220:223], a[160:163], a[152:155], v[220:223]
 s_barrier
M v[224:227], a[168:171], a[96:99], v[224:227]
 ds_read_b128 a[160:163], v5 offset:0
 ds_read_b128 a[164:167], v6 offset:0
M v[224:227], a[172:175], a[100:103], v[224:227]
 v_cvt_pk_bf16_f32 v92, v92, v93
 v_cvt_pk_bf16_f32 v93, v94, v95
M v[228:231], a[172:175], a[108:111], v[228:231]
 v_cvt_pk_bf16_f32 v94, v124, v125
 v_cvt_pk_bf16_f32 v95, v126, v127
M v[228:231], a[168:171], a[104:107], v[228:231]
 v_cvt_pk_bf16_f32 v128, v128, v129
 v_cvt_pk_bf16_f32 v129, v130, v131
M v[232:235], a[168:171], a[112:115], v[232:235]
 v_cvt_pk_bf16_f32 v130, v160, v161
 v_cvt_pk_bf16_f32 v131, v162, v163
M v[232:235], a[172:175], a[116:119], v[232:235]
 v_cvt_pk_bf16_f32 v132, v132, v133
 v_cvt_pk_bf16_f32 v133, v134, v135
M v[236:239], a[172:175], a[124:127], v[236:239]
 v_cvt_pk_bf16_f32 v134, v164, v165
 v_cvt_pk_bf16_f32 v135, v166, v167
M v[236:239], a[168:171], a[120:123], v[236:239]
 v_cvt_pk_bf16_f32 v136, v136, v137
 v_cvt_pk_bf16_f32 v137, v138, v139
M v[240:243], a[168:171], a[128:131], v[240:243]
 v_cvt_pk_bf16_f32 v138, v168, v169
 v_cvt_pk_bf16_f32 v139, v170, v171
M v[240:243], a[172:175], a[132:135], v[240:243]
 v_cvt_pk_bf16_f32 v140, v140, v141
 v_cvt_pk_bf16_f32 v141, v142, v143
M v[244:247], a[172:175], a[140:143], v[244:247]
 v_cvt_pk_bf16_f32 v142, v172, v173
 v_cvt_pk_bf16_f32 v143, v174, v175
M v[244:247], a[168:171], a[136:139], v[244:247]
 v_cvt_pk_bf16_f32 v144, v144, v145
 v_cvt_pk_bf16_f32 v145, v146, v147
M v[248:251], a[168:171], a[144:147], v[248:251]
 v_cvt_pk_bf16_f32 v146, v176, v177
 v_cvt_pk_bf16_f32 v147, v178, v179
M v[248:251], a[172:175], a[148:151], v[248:251]
 s_waitcnt lgkmcnt(0)
 v_cvt_pk_bf16_f32 v148, v148, v149
 v_cvt_pk_bf16_f32 v149, v150, v151
M v[252:255], a[172:175], a[156:159], v[252:255]
 v_cvt_pk_bf16_f32 v150, v180, v181
 v_cvt_pk_bf16_f32 v151, v182, v183
M v[252:255], a[168:171], a[152:155], v[252:255]
 v_cvt_pk_bf16_f32 v152, v152, v153
 v_cvt_pk_bf16_f32 v153, v154, v155
M v[32:35], a[32:35], a[160:163], 0
 s_add_u32 m0, s23, 16384
 ds_read_b128 a[168:171], v5 offset:2048
 ds_read_b128 a[172:175], v6 offset:2048
M v[32:35], a[36:39], a[164:167], v[32:35]
 ds_read_b64_tr_b16 a[96:97], v1 offset:32768
 ds_read_b64_tr_b16 a[98:99], v1 offset:33792
M v[36:39], a[44:47], a[164:167], 0
 buffer_load_dwordx4 v8, s[52:55], s28 offen offset:0   lds
M v[36:39], a[40:43], a[160:163], v[36:39]
 v_cvt_pk_bf16_f32 v154, v184, v185
 v_cvt_pk_bf16_f32 v155, v186, v187
M v[40:43], a[48:51], a[160:163], 0
 ds_read_b64_tr_b16 a[100:101], v1 offset:40960
 ds_read_b64_tr_b16 a[102:103], v1 offset:41984
M v[40:43], a[52:55], a[164:167], v[40:43]
 buffer_load_dwordx4 v9, s[52:55], s28 offen offset:1024   lds
M v[44:47], a[60:63], a[164:167], 0
 v_cvt_pk_bf16_f32 v156, v156, v157
 v_cvt_pk_bf16_f32 v157, v158, v159
M v[44:47], a[56:59], a[160:163], v[44:47]
 ds_read_b64_tr_b16 a[104:105], v2 offset:32768
 ds_read_b64_tr_b16 a[106:107], v2 offset:33792
M v[48:51], a[64:67], a[160:163], 0
 v_cvt_pk_bf16_f32 v158, v188, v189
 v_cvt_pk_bf16_f32 v159, v190, v191
M v[48:51], a[68:71], a[164:167], v[48:51]
 v_cvt_pk_bf16_f32 v192, v192, v193
 v_cvt_pk_bf16_f32 v193, v194, v195
M v[52:55], a[76:79], a[164:167], 0
 ds_read_b64_tr_b16 a[108:109], v2 offset:40960
 ds_read_b64_tr_b16 a[110:111], v2 offset:41984
M v[52:55], a[72:75], a[160:163], v[52:55]
 buffer_load_dwordx4 v10, s[52:55], s28 offen offset:2048   lds
M v[56:59], a[80:83], a[160:163], 0
 v_cvt_pk_bf16_f32 v194, v224, v225
 v_cvt_pk_bf16_f32 v195, v226, v227
M v[56:59], a[84:87], a[164:167], v[56:59]
 s_waitcnt lgkmcnt(8)
 ds_read_b64_tr_b16 a[112:113], v3 offset:32768
 ds_read_b64_tr_b16 a[114:115], v3 offset:33792
M v[60:63], a[92:95], a[164:167], 0
 v_cvt_pk_bf16_f32 v196, v196, v197
 v_cvt_pk_bf16_f32 v197, v198, v199
M v[60:63], a[88:91], a[160:163], v[60:63]
 buffer_load_dwordx4 v11, s[52:55], s28 offen offset:3072   lds
M v[96:99], a[32:35], a[168:171], 0
 s_add_u32 s28, s28, 524160
 ds_read_b128 a[160:163], v5 offset:4096
 ds_read_b128 a[164:167], v6 offset:4096
M v[96:99], a[36:39], a[172:175], v[96:99]
 ds_read_b64_tr_b16 a[116:117], v3 offset:40960
 ds_read_b64_tr_b16 a[118:119], v3 offset:41984
M v[100:103], a[44:47], a[172:175], 0
 v_cvt_pk_bf16_f32 v198, v228, v229
 v_cvt_pk_bf16_f32 v199, v230, v231
M v[100:103], a[40:43], a[168:171], v[100:103]
 s_add_u32 m0, s24, 49152
 ds_read_b64_tr_b16 a[120:121], v4 offset:32768
 ds_read_b64_tr_b16 a[122:123], v4 offset:33792
M v[104:107], a[48:51], a[168:171], 0
 buffer_load_dwordx4 v16, s[56:59], s29 offen offset:0   lds
M v[104:107], a[52:55], a[172:175], v[104:107]
 v_cvt_pk_bf16_f32 v200, v200, v201
 v_cvt_pk_bf16_f32 v201, v202, v203
M v[108:111], a[60:63], a[172:175], 0
 ds_read_b64_tr_b16 a[124:125], v4 offset:40960
 ds_read_b64_tr_b16 a[126:127], v4 offset:41984
M v[108:111], a[56:59], a[168:171], v[108:111]
 v_cvt_pk_bf16_f32 v202, v232, v233
 v_cvt_pk_bf16_f32 v203, v234, v235
M v[112:115], a[64:67], a[168:171], 0
 v_cvt_pk_bf16_f32 v204, v204, v205
 v_cvt_pk_bf16_f32 v205, v206, v207
M v[112:115], a[68:71], a[172:175], v[112:115]
 buffer_load_dwordx4 v17, s[56:59], s29 offen offset:1024   lds
M v[116:119], a[76:79], a[172:175], 0
 v_cvt_pk_bf16_f32 v206, v236, v237
 v_cvt_pk_bf16_f32 v207, v238, v239
M v[116:119], a[72:75], a[168:171], v[116:119]
 v_cvt_pk_bf16_f32 v208, v208, v209
 v_cvt_pk_bf16_f32 v209, v210, v211
M v[120:123], a[80:83], a[168:171], 0
 v_cvt_pk_bf16_f32 v210, v240, v241
 v_cvt_pk_bf16_f32 v211, v242, v243
M v[120:123], a[84:87], a[172:175], v[120:123]
 s_waitcnt lgkmcnt(6)
 v_cvt_pk_bf16_f32 v212, v212, v213
 v_cvt_pk_bf16_f32 v213, v214, v215
M v[124:127], a[92:95], a[172:175], 0
 s_waitcnt vmcnt(21) lgkmcnt(0)
 buffer_load_dwordx4 v18, s[56:59], s29 offen offset:2048   lds
M v[124:127], a[88:91], a[168:171], v[124:127]
 s_barrier
M v[160:163], a[32:35], a[160:163], 0
 ds_read_b128 a[168:171], v5 offset:6144
 ds_read_b128 a[172:175], v6 offset:6144
M v[160:163], a[36:39], a[164:167], v[160:163]
 ds_read_b64_tr_b16 a[128:129], v1 offset:49152
 ds_read_b64_tr_b16 a[130:131], v1 offset:50176
M v[164:167], a[44:47], a[164:167], 0
 v_cvt_pk_bf16_f32 v214, v244, v245
 v_cvt_pk_bf16_f32 v215, v246, v247
M v[164:167], a[40:43], a[160:163], v[164:167]
 buffer_load_dwordx4 v19, s[56:59], s29 offen offset:3072   lds
M v[168:171], a[48:51], a[160:163], 0
 s_add_u32 s29, s29, 128
 ds_read_b64_tr_b16 a[132:133], v1 offset:57344
 ds_read_b64_tr_b16 a[134:135], v1 offset:58368
M v[168:171], a[52:55], a[164:167], v[168:171]
 v_cvt_pk_bf16_f32 v216, v216, v217
 v_cvt_pk_bf16_f32 v217, v218, v219
M v[172:175], a[60:63], a[164:167], 0
 v_cvt_pk_bf16_f32 v218, v248, v249
 v_cvt_pk_bf16_f32 v219, v250, v251
M v[172:175], a[56:59], a[160:163], v[172:175]
 s_add_u32 m0, s23, 32768
 ds_read_b64_tr_b16 a[136:137], v2 offset:49152
 ds_read_b64_tr_b16 a[138:139], v2 offset:50176
M v[176:179], a[64:67], a[160:163], 0
 buffer_load_dwordx4 v8, s[52:55], s28 offen offset:0   lds
M v[176:179], a[68:71], a[164:167], v[176:179]
 v_cvt_pk_bf16_f32 v220, v220, v221
 v_cvt_pk_bf16_f32 v221, v222, v223
M v[180:183], a[76:79], a[164:167], 0
 ds_read_b64_tr_b16 a[140:141], v2 offset:57344
 ds_read_b64_tr_b16 a[142:143], v2 offset:58368
M v[180:183], a[72:75], a[160:163], v[180:183]
 v_cvt_pk_bf16_f32 v222, v252, v253
 v_cvt_pk_bf16_f32 v223, v254, v255
M v[184:187], a[80:83], a[160:163], 0
 s_add_u32 s3, s93, 262144
 v_mov_b32 v12, 1
 v_or_b32 v15, s20, v0
M v[184:187], a[84:87], a[164:167], v[184:187]
 s_waitcnt lgkmcnt(8)
 ds_read_b64_tr_b16 a[144:145], v3 offset:49152
 ds_read_b64_tr_b16 a[146:147], v3 offset:50176
M v[188:191], a[92:95], a[164:167], 0
 buffer_load_dwordx4 v9, s[52:55], s28 offen offset:1024   lds
M v[188:191], a[88:91], a[160:163], v[188:191]
 v_min_u32 v15, 1, v15
 v_lshlrev_b32 v15, 29, v15
M v[224:227], a[32:35], a[168:171], 0
 ds_read_b128 a[160:163], v5 offset:16384
 ds_read_b128 a[164:167], v6 offset:16384
M v[224:227], a[36:39], a[172:175], v[224:227]
 ds_read_b64_tr_b16 a[148:149], v3 offset:57344
 ds_read_b64_tr_b16 a[150:151], v3 offset:58368
M v[228:231], a[44:47], a[172:175], 0
 buffer_load_dwordx4 v10, s[52:55], s28 offen offset:2048   lds
M v[228:231], a[40:43], a[168:171], v[228:231]
 ds_read_b64_tr_b16 a[152:153], v4 offset:49152
 ds_read_b64_tr_b16 a[154:155], v4 offset:50176
M v[232:235], a[48:51], a[168:171], 0
 buffer_store_dwordx4 v[64:67], v7, s[8:11], s3 offen offset:0 sc1
M v[232:235], a[52:55], a[172:175], v[232:235]
M v[236:239], a[60:63], a[172:175], 0
 ds_read_b64_tr_b16 a[156:157], v4 offset:57344
 ds_read_b64_tr_b16 a[158:159], v4 offset:58368
M v[236:239], a[56:59], a[168:171], v[236:239]
 buffer_load_dwordx4 v11, s[52:55], s28 offen offset:3072   lds
M v[240:243], a[64:67], a[168:171], 0
 s_add_u32 s28, s28, 128
M v[240:243], a[68:71], a[172:175], v[240:243]
 buffer_store_dwordx4 v[68:71], v7, s[8:11], s3 offen offset:2048 sc1
M v[244:247], a[76:79], a[172:175], 0
M v[244:247], a[72:75], a[168:171], v[244:247]
M v[248:251], a[80:83], a[168:171], 0
M v[248:251], a[84:87], a[172:175], v[248:251]
 s_waitcnt lgkmcnt(6)
M v[252:255], a[92:95], a[172:175], 0
 s_waitcnt vmcnt(14) lgkmcnt(0)
M v[252:255], a[88:91], a[168:171], v[252:255]
 s_barrier
M v[32:35], a[96:99], a[160:163], v[32:35]
 s_add_u32 m0, s23, 49152
 ds_read_b128 a[168:171], v5 offset:18432
 ds_read_b128 a[172:175], v6 offset:18432
M v[32:35], a[100:103], a[164:167], v[32:35]
 ds_read_b64_tr_b16 a[32:33], v20 offset:0
 ds_read_b64_tr_b16 a[34:35], v20 offset:1024
M v[36:39], a[108:111], a[164:167], v[36:39]
 s_mov_b32 s39, 1347
 buffer_load_dwordx4 v8, s[52:55], s28 offen offset:0   lds
M v[36:39], a[104:107], a[160:163], v[36:39]
 s_cmp_lt_u32 s42, 2
 buffer_store_dword v12, v15, s[8:11], s45 offen sc1
M v[40:43], a[112:115], a[160:163], v[40:43]
 s_cselect_b32 s39, 1284, s39
 ds_read_b64_tr_b16 a[36:37], v20 offset:8192
 ds_read_b64_tr_b16 a[38:39], v20 offset:9216
M v[40:43], a[116:119], a[164:167], v[40:43]
 s_lshl_b32 s64, s20, 14
 buffer_load_dwordx4 v9, s[52:55], s28 offen offset:1024   lds
M v[44:47], a[124:127], a[164:167], v[44:47]
 s_add_u32 s12, s64, s34
 s_add_u32 s3, s93, 266240
M v[44:47], a[120:123], a[160:163], v[44:47]
 s_add_u32 s13, s12, 4096
 ds_read_b64_tr_b16 a[40:41], v21 offset:0
 ds_read_b64_tr_b16 a[42:43], v21 offset:1024
M v[48:51], a[128:131], a[160:163], v[48:51]
 s_add_u32 s14, s12, 8192
 buffer_store_dwordx4 v[72:75], v7, s[8:11], s3 offen offset:0 sc1
M v[48:51], a[132:135], a[164:167], v[48:51]
 s_add_u32 s15, s12, 12288
M v[52:55], a[140:143], a[164:167], v[52:55]
 ds_read_b64_tr_b16 a[44:45], v21 offset:8192
 ds_read_b64_tr_b16 a[46:47], v21 offset:9216
M v[52:55], a[136:139], a[160:163], v[52:55]
 buffer_load_dwordx4 v10, s[52:55], s28 offen offset:2048   lds
M v[56:59], a[144:147], a[160:163], v[56:59]
M v[56:59], a[148:151], a[164:167], v[56:59]
 s_waitcnt lgkmcnt(8)
 ds_read_b64_tr_b16 a[48:49], v22 offset:0
 ds_read_b64_tr_b16 a[50:51], v22 offset:1024
M v[60:63], a[156:159], a[164:167], v[60:63]
M v[60:63], a[152:155], a[160:163], v[60:63]
 buffer_load_dwordx4 v11, s[52:55], s28 offen offset:3072   lds
M v[96:99], a[96:99], a[168:171], v[96:99]
 s_add_u32 s28, s28, 524160
 ds_read_b128 a[160:163], v5 offset:20480
 ds_read_b128 a[164:167], v6 offset:20480
M v[96:99], a[100:103], a[172:175], v[96:99]
 ds_read_b64_tr_b16 a[52:53], v22 offset:8192
 ds_read_b64_tr_b16 a[54:55], v22 offset:9216
M v[100:103], a[108:111], a[172:175], v[100:103]
M v[100:103], a[104:107], a[168:171], v[100:103]
 s_add_u32 m0, s24, 0
 ds_read_b64_tr_b16 a[56:57], v23 offset:0
 ds_read_b64_tr_b16 a[58:59], v23 offset:1024
M v[104:107], a[112:115], a[168:171], v[104:107]
 buffer_load_dwordx4 v16, s[56:59], s29 offen offset:0   lds
M v[104:107], a[116:119], a[172:175], v[104:107]
M v[108:111], a[124:127], a[172:175], v[108:111]
 ds_read_b64_tr_b16 a[60:61], v23 offset:8192
 ds_read_b64_tr_b16 a[62:63], v23 offset:9216
M v[108:111], a[120:123], a[168:171], v[108:111]
M v[112:115], a[128:131], a[168:171], v[112:115]
M v[112:115], a[132:135], a[172:175], v[112:115]
 buffer_load_dwordx4 v17, s[56:59], s29 offen offset:1024   lds
M v[116:119], a[140:143], a[172:175], v[116:119]
M v[116:119], a[136:139], a[168:171], v[116:119]
M v[120:123], a[144:147], a[168:171], v[120:123]
M v[120:123], a[148:151], a[172:175], v[120:123]
 s_waitcnt lgkmcnt(6)
M v[124:127], a[156:159], a[172:175], v[124:127]
 s_waitcnt lgkmcnt(0)
 buffer_load_dwordx4 v18, s[56:59], s29 offen offset:2048   lds
M v[124:127], a[152:155], a[168:171], v[124:127]
 s_barrier
M v[160:163], a[96:99], a[160:163], v[160:163]
 ds_read_b128 a[168:171], v5 offset:22528
 ds_read_b128 a[172:175], v6 offset:22528
M v[160:163], a[100:103], a[164:167], v[160:163]
 ds_read_b64_tr_b16 a[64:65], v20 offset:16384
 ds_read_b64_tr_b16 a[66:67], v20 offset:17408
M v[164:167], a[108:111], a[164:167], v[164:167]
M v[164:167], a[104:107], a[160:163], v[164:167]
 buffer_load_dwordx4 v19, s[56:59], s29 offen offset:3072   lds
M v[168:171], a[112:115], a[160:163], v[168:171]
 s_add_u32 s29, s29, 128
 ds_read_b64_tr_b16 a[68:69], v20 offset:24576
 ds_read_b64_tr_b16 a[70:71], v20 offset:25600
M v[168:171], a[116:119], a[164:167], v[168:171]
 buffer_store_dwordx4 v[76:79], v7, s[8:11], s3 offen offset:2048 sc1
M v[172:175], a[124:127], a[164:167], v[172:175]
M v[172:175], a[120:123], a[160:163], v[172:175]
 s_add_u32 m0, s23, 131072
 ds_read_b64_tr_b16 a[72:73], v21 offset:16384
 ds_read_b64_tr_b16 a[74:75], v21 offset:17408
M v[176:179], a[128:131], a[160:163], v[176:179]
 buffer_load_dwordx4 v8, s[52:55], s28 offen offset:0   lds
M v[176:179], a[132:135], a[164:167], v[176:179]
M v[180:183], a[140:143], a[164:167], v[180:183]
 ds_read_b64_tr_b16 a[76:77], v21 offset:24576
 ds_read_b64_tr_b16 a[78:79], v21 offset:25600
M v[180:183], a[136:139], a[160:163], v[180:183]
M v[184:187], a[144:147], a[160:163], v[184:187]
M v[184:187], a[148:151], a[164:167], v[184:187]
 s_waitcnt lgkmcnt(8)
 ds_read_b64_tr_b16 a[80:81], v22 offset:16384
 ds_read_b64_tr_b16 a[82:83], v22 offset:17408
M v[188:191], a[156:159], a[164:167], v[188:191]
 buffer_load_dwordx4 v9, s[52:55], s28 offen offset:1024   lds
M v[188:191], a[152:155], a[160:163], v[188:191]
M v[224:227], a[96:99], a[168:171], v[224:227]
 ds_read_b128 a[160:163], v5 offset:32768
 ds_read_b128 a[164:167], v6 offset:32768
M v[224:227], a[100:103], a[172:175], v[224:227]
 ds_read_b64_tr_b16 a[84:85], v22 offset:24576
 ds_read_b64_tr_b16 a[86:87], v22 offset:25600
M v[228:231], a[108:111], a[172:175], v[228:231]
 buffer_load_dwordx4 v10, s[52:55], s28 offen offset:2048   lds
M v[228:231], a[104:107], a[168:171], v[228:231]
 ds_read_b64_tr_b16 a[88:89], v23 offset:16384
 ds_read_b64_tr_b16 a[90:91], v23 offset:17408
M v[232:235], a[112:115], a[168:171], v[232:235]
M v[232:235], a[116:119], a[172:175], v[232:235]
M v[236:239], a[124:127], a[172:175], v[236:239]
 ds_read_b64_tr_b16 a[92:93], v23 offset:24576
 ds_read_b64_tr_b16 a[94:95], v23 offset:25600
M v[236:239], a[120:123], a[168:171], v[236:239]
 buffer_load_dwordx4 v11, s[52:55], s28 offen offset:3072   lds
M v[240:243], a[128:131], a[168:171], v[240:243]
 s_add_u32 s28, s28, 128
M v[240:243], a[132:135], a[172:175], v[240:243]
M v[244:247], a[140:143], a[172:175], v[244:247]
M v[244:247], a[136:139], a[168:171], v[244:247]
M v[248:251], a[144:147], a[168:171], v[248:251]
M v[248:251], a[148:151], a[172:175], v[248:251]
 s_waitcnt lgkmcnt(6)
M v[252:255], a[156:159], a[172:175], v[252:255]
 s_waitcnt lgkmcnt(0)
M v[252:255], a[152:155], a[168:171], v[252:255]
 s_barrier
M v[32:35], a[32:35], a[160:163], v[32:35]
 s_add_u32 m0, s23, 147456
 ds_read_b128 a[168:171], v5 offset:34816
 ds_read_b128 a[172:175], v6 offset:34816
M v[32:35], a[36:39], a[164:167], v[32:35]
 ds_read_b64_tr_b16 a[96:97], v1 offset:0
 ds_read_b64_tr_b16 a[98:99], v1 offset:1024
M v[36:39], a[44:47], a[164:167], v[36:39]
 buffer_load_dwordx4 v8, s[52:55], s28 offen offset:0   lds
M v[36:39], a[40:43], a[160:163], v[36:39]
 v_and_b32 v29, 15, v0
 v_mul_u32_u24 v30, 1792, v29
M v[40:43], a[48:51], a[160:163], v[40:43]
 s_add_u32 s3, s93, 270336
 ds_read_b64_tr_b16 a[100:101], v1 offset:8192
 ds_read_b64_tr_b16 a[102:103], v1 offset:9216
M v[40:43], a[52:55], a[164:167], v[40:43]
 buffer_load_dwordx4 v9, s[52:55], s28 offen offset:1024   lds
M v[44:47], a[60:63], a[164:167], v[44:47]
 v_lshrrev_b32 v31, 4, v0
 v_lshl_add_u32 v30, v31, 4, v30
M v[44:47], a[56:59], a[160:163], v[44:47]
 ds_read_b64_tr_b16 a[104:105], v2 offset:0
 ds_read_b64_tr_b16 a[106:107], v2 offset:1024
M v[48:51], a[64:67], a[160:163], v[48:51]
 v_lshrrev_b32 v29, 1, v29
 v_min_u32 v29, 1, v29
M v[48:51], a[68:71], a[164:167], v[48:51]
 v_lshl_or_b32 v30, v29, 29, v30
 v_or_b32 v30, s88, v30
M v[52:55], a[76:79], a[164:167], v[52:55]
 s_mul_i32 s89, s86, 3584
 ds_read_b64_tr_b16 a[108:109], v2 offset:8192
 ds_read_b64_tr_b16 a[110:111], v2 offset:9216
M v[52:55], a[72:75], a[160:163], v[52:55]
 s_mul_i32 s64, s20, 448
 buffer_load_dwordx4 v10, s[52:55], s28 offen offset:2048   lds
M v[56:59], a[80:83], a[160:163], v[56:59]
 s_add_u32 s89, s89, s64
 s_add_u32 s89, s89, 105906176
M v[56:59], a[84:87], a[164:167], v[56:59]
 s_waitcnt lgkmcnt(8)
 ds_read_b64_tr_b16 a[112:113], v3 offset:0
 ds_read_b64_tr_b16 a[114:115], v3 offset:1024
M v[60:63], a[92:95], a[164:167], v[60:63]
 buffer_store_dwordx4 v[80:83], v7, s[8:11], s3 offen offset:0 sc1
M v[60:63], a[88:91], a[160:163], v[60:63]
 buffer_load_dwordx4 v11, s[52:55], s28 offen offset:3072   lds
M v[96:99], a[32:35], a[168:171], v[96:99]
 s_add_u32 s28, s28, 524160
 ds_read_b128 a[160:163], v5 offset:36864
 ds_read_b128 a[164:167], v6 offset:36864
M v[96:99], a[36:39], a[172:175], v[96:99]
 ds_read_b64_tr_b16 a[116:117], v3 offset:8192
 ds_read_b64_tr_b16 a[118:119], v3 offset:9216
M v[100:103], a[44:47], a[172:175], v[100:103]
M v[100:103], a[40:43], a[168:171], v[100:103]
 s_add_u32 m0, s24, 16384
 ds_read_b64_tr_b16 a[120:121], v4 offset:0
 ds_read_b64_tr_b16 a[122:123], v4 offset:1024
M v[104:107], a[48:51], a[168:171], v[104:107]
 buffer_load_dwordx4 v16, s[56:59], s29 offen offset:0   lds
M v[104:107], a[52:55], a[172:175], v[104:107]
M v[108:111], a[60:63], a[172:175], v[108:111]
 ds_read_b64_tr_b16 a[124:125], v4 offset:8192
 ds_read_b64_tr_b16 a[126:127], v4 offset:9216
M v[108:111], a[56:59], a[168:171], v[108:111]
M v[112:115], a[64:67], a[168:171], v[112:115]
M v[112:115], a[68:71], a[172:175], v[112:115]
 buffer_load_dwordx4 v17, s[56:59], s29 offen offset:1024   lds
M v[116:119], a[76:79], a[172:175], v[116:119]
M v[116:119], a[72:75], a[168:171], v[116:119]
M v[120:123], a[80:83], a[168:171], v[120:123]
M v[120:123], a[84:87], a[172:175], v[120:123]
 s_waitcnt lgkmcnt(6)
M v[124:127], a[92:95], a[172:175], v[124:127]
 s_waitcnt vmcnt(28) lgkmcnt(0)
 buffer_load_dwordx4 v18, s[56:59], s29 offen offset:2048   lds
M v[124:127], a[88:91], a[168:171], v[124:127]
 s_barrier
M v[160:163], a[32:35], a[160:163], v[160:163]
 ds_read_b128 a[168:171], v5 offset:38912
 ds_read_b128 a[172:175], v6 offset:38912
M v[160:163], a[36:39], a[164:167], v[160:163]
 ds_read_b64_tr_b16 a[128:129], v1 offset:16384
 ds_read_b64_tr_b16 a[130:131], v1 offset:17408
M v[164:167], a[44:47], a[164:167], v[164:167]
M v[164:167], a[40:43], a[160:163], v[164:167]
 buffer_load_dwordx4 v19, s[56:59], s29 offen offset:3072   lds
M v[168:171], a[48:51], a[160:163], v[168:171]
 s_add_u32 s29, s29, 128
 ds_read_b64_tr_b16 a[132:133], v1 offset:24576
 ds_read_b64_tr_b16 a[134:135], v1 offset:25600
M v[168:171], a[52:55], a[164:167], v[168:171]
 buffer_store_dwordx4 v[84:87], v7, s[8:11], s3 offen offset:2048 sc1
M v[172:175], a[60:63], a[164:167], v[172:175]
M v[172:175], a[56:59], a[160:163], v[172:175]
 s_add_u32 m0, s23, 0
 ds_read_b64_tr_b16 a[136:137], v2 offset:16384
 ds_read_b64_tr_b16 a[138:139], v2 offset:17408
M v[176:179], a[64:67], a[160:163], v[176:179]
 buffer_load_dwordx4 v8, s[52:55], s28 offen offset:0   lds
M v[176:179], a[68:71], a[164:167], v[176:179]
M v[180:183], a[76:79], a[164:167], v[180:183]
 ds_read_b64_tr_b16 a[140:141], v2 offset:24576
 ds_read_b64_tr_b16 a[142:143], v2 offset:25600
M v[180:183], a[72:75], a[160:163], v[180:183]
M v[184:187], a[80:83], a[160:163], v[184:187]
M v[184:187], a[84:87], a[164:167], v[184:187]
 s_waitcnt lgkmcnt(8)
 ds_read_b64_tr_b16 a[144:145], v3 offset:16384
 ds_read_b64_tr_b16 a[146:147], v3 offset:17408
M v[188:191], a[92:95], a[164:167], v[188:191]
 buffer_load_dwordx4 v9, s[52:55], s28 offen offset:1024   lds
M v[188:191], a[88:91], a[160:163], v[188:191]
M v[224:227], a[32:35], a[168:171], v[224:227]
 ds_read_b128 a[160:163], v5 offset:49152
 ds_read_b128 a[164:167], v6 offset:49152
M v[224:227], a[36:39], a[172:175], v[224:227]
 ds_read_b64_tr_b16 a[148:149], v3 offset:24576
 ds_read_b64_tr_b16 a[150:151], v3 offset:25600
M v[228:231], a[44:47], a[172:175], v[228:231]
 buffer_load_dwordx4 v10, s[52:55], s28 offen offset:2048   lds
M v[228:231], a[40:43], a[168:171], v[228:231]
 ds_read_b64_tr_b16 a[152:153], v4 offset:16384
 ds_read_b64_tr_b16 a[154:155], v4 offset:17408
M v[232:235], a[48:51], a[168:171], v[232:235]
M v[232:235], a[52:55], a[172:175], v[232:235]
M v[236:239], a[60:63], a[172:175], v[236:239]
 ds_read_b64_tr_b16 a[156:157], v4 offset:24576
 ds_read_b64_tr_b16 a[158:159], v4 offset:25600
M v[236:239], a[56:59], a[168:171], v[236:239]
 buffer_load_dwordx4 v11, s[52:55], s28 offen offset:3072   lds
M v[240:243], a[64:67], a[168:171], v[240:243]
 s_add_u32 s28, s28, 128
M v[240:243], a[68:71], a[172:175], v[240:243]
M v[244:247], a[76:79], a[172:175], v[244:247]
M v[244:247], a[72:75], a[168:171], v[244:247]
M v[248:251], a[80:83], a[168:171], v[248:251]
M v[248:251], a[84:87], a[172:175], v[248:251]
 s_waitcnt lgkmcnt(6)
M v[252:255], a[92:95], a[172:175], v[252:255]
 s_waitcnt vmcnt(30) lgkmcnt(0)
M v[252:255], a[88:91], a[168:171], v[252:255]
 s_barrier
M v[32:35], a[96:99], a[160:163], v[32:35]
 s_add_u32 m0, s23, 16384
 ds_read_b128 a[168:171], v5 offset:51200
 ds_read_b128 a[172:175], v6 offset:51200
M v[32:35], a[100:103], a[164:167], v[32:35]
 ds_read_b64_tr_b16 a[32:33], v1 offset:32768
 ds_read_b64_tr_b16 a[34:35], v1 offset:33792
M v[36:39], a[108:111], a[164:167], v[36:39]
 buffer_load_dwordx4 v8, s[52:55], s28 offen offset:0   lds
M v[36:39], a[104:107], a[160:163], v[36:39]
 v_min_u32 v25, 15, v0
 v_lshlrev_b32 v25, 7, v25
M v[40:43], a[112:115], a[160:163], v[40:43]
 s_add_u32 s3, s93, 274432
 ds_read_b64_tr_b16 a[36:37], v1 offset:40960
 ds_read_b64_tr_b16 a[38:39], v1 offset:41984
M v[40:43], a[116:119], a[164:167], v[40:43]
 v_max_u32 v13, 1024, v25
M v[44:47], a[124:127], a[164:167], v[44:47]
 buffer_store_dwordx4 v[88:91], v7, s[8:11], s3 offen offset:0 sc1
M v[44:47], a[120:123], a[160:163], v[44:47]
 ds_read_b64_tr_b16 a[40:41], v2 offset:32768
 ds_read_b64_tr_b16 a[42:43], v2 offset:33792
M v[48:51], a[128:131], a[160:163], v[48:51]
 buffer_load_dwordx4 v9, s[52:55], s28 offen offset:1024   lds
M v[48:51], a[132:135], a[164:167], v[48:51]
M v[52:55], a[140:143], a[164:167], v[52:55]
 ds_read_b64_tr_b16 a[44:45], v2 offset:40960
 ds_read_b64_tr_b16 a[46:47], v2 offset:41984
M v[52:55], a[136:139], a[160:163], v[52:55]
M v[56:59], a[144:147], a[160:163], v[56:59]
M v[56:59], a[148:151], a[164:167], v[56:59]
 s_waitcnt lgkmcnt(8)
 ds_read_b64_tr_b16 a[48:49], v3 offset:32768
 ds_read_b64_tr_b16 a[50:51], v3 offset:33792
M v[60:63], a[156:159], a[164:167], v[60:63]
 buffer_load_dwordx4 v10, s[52:55], s28 offen offset:2048   lds
M v[60:63], a[152:155], a[160:163], v[60:63]
M v[96:99], a[96:99], a[168:171], v[96:99]
 ds_read_b128 a[160:163], v5 offset:53248
 ds_read_b128 a[164:167], v6 offset:53248
M v[96:99], a[100:103], a[172:175], v[96:99]
 ds_read_b64_tr_b16 a[52:53], v3 offset:40960
 ds_read_b64_tr_b16 a[54:55], v3 offset:41984
M v[100:103], a[108:111], a[172:175], v[100:103]
 buffer_store_dwordx4 v[92:95], v7, s[8:11], s3 offen offset:2048 sc1
M v[100:103], a[104:107], a[168:171], v[100:103]
 ds_read_b64_tr_b16 a[56:57], v4 offset:32768
 ds_read_b64_tr_b16 a[58:59], v4 offset:33792
M v[104:107], a[112:115], a[168:171], v[104:107]
M v[104:107], a[116:119], a[172:175], v[104:107]
 buffer_load_dwordx4 v11, s[52:55], s28 offen offset:3072   lds
M v[108:111], a[124:127], a[172:175], v[108:111]
 s_add_u32 s28, s28, 524160
 ds_read_b64_tr_b16 a[60:61], v4 offset:40960
 ds_read_b64_tr_b16 a[62:63], v4 offset:41984
M v[108:111], a[120:123], a[168:171], v[108:111]
M v[112:115], a[128:131], a[168:171], v[112:115]
M v[112:115], a[132:135], a[172:175], v[112:115]
M v[116:119], a[140:143], a[172:175], v[116:119]
M v[116:119], a[136:139], a[168:171], v[116:119]
M v[120:123], a[144:147], a[168:171], v[120:123]
M v[120:123], a[148:151], a[172:175], v[120:123]
 s_waitcnt lgkmcnt(6)
M v[124:127], a[156:159], a[172:175], v[124:127]
 s_waitcnt vmcnt(25) lgkmcnt(0)
M v[124:127], a[152:155], a[168:171], v[124:127]
 s_barrier
M v[160:163], a[96:99], a[160:163], v[160:163]
 ds_read_b128 a[168:171], v5 offset:55296
 ds_read_b128 a[172:175], v6 offset:55296
M v[160:163], a[100:103], a[164:167], v[160:163]
 ds_read_b64_tr_b16 a[64:65], v1 offset:49152
 ds_read_b64_tr_b16 a[66:67], v1 offset:50176
M v[164:167], a[108:111], a[164:167], v[164:167]
 buffer_store_dwordx4 a[208:211], v30, s[8:11], s89 offen offset:0 sc1
M v[164:167], a[104:107], a[160:163], v[164:167]
M v[168:171], a[112:115], a[160:163], v[168:171]
 ds_read_b64_tr_b16 a[68:69], v1 offset:57344
 ds_read_b64_tr_b16 a[70:71], v1 offset:58368
M v[168:171], a[116:119], a[164:167], v[168:171]
M v[172:175], a[124:127], a[164:167], v[172:175]
M v[172:175], a[120:123], a[160:163], v[172:175]
 ds_read_b64_tr_b16 a[72:73], v2 offset:49152
 ds_read_b64_tr_b16 a[74:75], v2 offset:50176
M v[176:179], a[128:131], a[160:163], v[176:179]
M v[176:179], a[132:135], a[164:167], v[176:179]
M v[180:183], a[140:143], a[164:167], v[180:183]
 ds_read_b64_tr_b16 a[76:77], v2 offset:57344
 ds_read_b64_tr_b16 a[78:79], v2 offset:58368
M v[180:183], a[136:139], a[160:163], v[180:183]
M v[184:187], a[144:147], a[160:163], v[184:187]
M v[184:187], a[148:151], a[164:167], v[184:187]
 s_waitcnt lgkmcnt(8)
 ds_read_b64_tr_b16 a[80:81], v3 offset:49152
 ds_read_b64_tr_b16 a[82:83], v3 offset:50176
M v[188:191], a[156:159], a[164:167], v[188:191]
 buffer_store_dwordx4 a[212:215], v30, s[8:11], s89 offen offset:64 sc1
M v[188:191], a[152:155], a[160:163], v[188:191]
M v[224:227], a[96:99], a[168:171], v[224:227]
 ds_read_b128 a[160:163], v5 offset:0
 ds_read_b128 a[164:167], v6 offset:0
M v[224:227], a[100:103], a[172:175], v[224:227]
 ds_read_b64_tr_b16 a[84:85], v3 offset:57344
 ds_read_b64_tr_b16 a[86:87], v3 offset:58368
M v[228:231], a[108:111], a[172:175], v[228:231]
M v[228:231], a[104:107], a[168:171], v[228:231]
 ds_read_b64_tr_b16 a[88:89], v4 offset:49152
 ds_read_b64_tr_b16 a[90:91], v4 offset:50176
M v[232:235], a[112:115], a[168:171], v[232:235]
M v[232:235], a[116:119], a[172:175], v[232:235]
M v[236:239], a[124:127], a[172:175], v[236:239]
 ds_read_b64_tr_b16 a[92:93], v4 offset:57344
 ds_read_b64_tr_b16 a[94:95], v4 offset:58368
M v[236:239], a[120:123], a[168:171], v[236:239]
M v[240:243], a[128:131], a[168:171], v[240:243]
M v[240:243], a[132:135], a[172:175], v[240:243]
M v[244:247], a[140:143], a[172:175], v[244:247]
M v[244:247], a[136:139], a[168:171], v[244:247]
M v[248:251], a[144:147], a[168:171], v[248:251]
M v[248:251], a[148:151], a[172:175], v[248:251]
 s_waitcnt lgkmcnt(6)
M v[252:255], a[156:159], a[172:175], v[252:255]
 s_waitcnt vmcnt(22) lgkmcnt(0)
M v[252:255], a[152:155], a[168:171], v[252:255]
 s_barrier
M v[32:35], a[32:35], a[160:163], v[32:35]
 s_add_u32 m0, s23, 32768
 ds_read_b128 a[168:171], v5 offset:2048
 ds_read_b128 a[172:175], v6 offset:2048
M v[32:35], a[36:39], a[164:167], v[32:35]
 ds_read_b64_tr_b16 a[96:97], v20 offset:0
 ds_read_b64_tr_b16 a[98:99], v20 offset:1024
M v[36:39], a[44:47], a[164:167], v[36:39]
 buffer_load_dwordx4 v16, s[56:59], s29 offen offset:0   lds
M v[36:39], a[40:43], a[160:163], v[36:39]
 buffer_store_dwordx4 a[216:219], v30, s[8:11], s89 offen offset:128 sc1
M v[40:43], a[48:51], a[160:163], v[40:43]
 ds_read_b64_tr_b16 a[100:101], v20 offset:8192
 ds_read_b64_tr_b16 a[102:103], v20 offset:9216
M v[40:43], a[52:55], a[164:167], v[40:43]
 buffer_load_dwordx4 v17, s[56:59], s29 offen offset:1024   lds
M v[44:47], a[60:63], a[164:167], v[44:47]
M v[44:47], a[56:59], a[160:163], v[44:47]
 ds_read_b64_tr_b16 a[104:105], v21 offset:0
 ds_read_b64_tr_b16 a[106:107], v21 offset:1024
M v[48:51], a[64:67], a[160:163], v[48:51]
M v[48:51], a[68:71], a[164:167], v[48:51]
 buffer_load_dwordx4 v18, s[56:59], s29 offen offset:2048   lds
M v[52:55], a[76:79], a[164:167], v[52:55]
 ds_read_b64_tr_b16 a[108:109], v21 offset:8192
 ds_read_b64_tr_b16 a[110:111], v21 offset:9216
M v[52:55], a[72:75], a[160:163], v[52:55]
 buffer_store_dwordx4 a[220:223], v30, s[8:11], s89 offen offset:192 sc1
M v[56:59], a[80:83], a[160:163], v[56:59]
M v[56:59], a[84:87], a[164:167], v[56:59]
 s_waitcnt lgkmcnt(8)
 ds_read_b64_tr_b16 a[112:113], v22 offset:0
 ds_read_b64_tr_b16 a[114:115], v22 offset:1024
M v[60:63], a[92:95], a[164:167], v[60:63]
 buffer_load_dwordx4 v19, s[56:59], s29 offen offset:3072   lds
M v[60:63], a[88:91], a[160:163], v[60:63]
 s_add_u32 s29, s29, 128
M v[96:99], a[32:35], a[168:171], v[96:99]
 ds_read_b128 a[160:163], v5 offset:4096
 ds_read_b128 a[164:167], v6 offset:4096
M v[96:99], a[36:39], a[172:175], v[96:99]
 ds_read_b64_tr_b16 a[116:117], v22 offset:8192
 ds_read_b64_tr_b16 a[118:119], v22 offset:9216
M v[100:103], a[44:47], a[172:175], v[100:103]
 s_lshl_b32 s28, s20, 13
 buffer_store_dwordx4 a[224:227], v30, s[8:11], s89 offen offset:256 sc1
M v[100:103], a[40:43], a[168:171], v[100:103]
 s_lshl_b32 s21, s41, 20
 ds_read_b64_tr_b16 a[120:121], v23 offset:0
 ds_read_b64_tr_b16 a[122:123], v23 offset:1024
M v[104:107], a[48:51], a[168:171], v[104:107]
 s_mov_b32 s22, 0
M v[104:107], a[52:55], a[172:175], v[104:107]
 s_lshl_b32 s7, s41, 18
M v[108:111], a[60:63], a[172:175], v[108:111]
 s_add_u32 s7, s7, 100663296
 ds_read_b64_tr_b16 a[124:125], v23 offset:8192
 ds_read_b64_tr_b16 a[126:127], v23 offset:9216
M v[108:111], a[56:59], a[168:171], v[108:111]
 s_add_u32 s38, s7, 65536
 buffer_store_dwordx4 a[228:231], v30, s[8:11], s89 offen offset:320 sc1
M v[112:115], a[64:67], a[168:171], v[112:115]
 s_sub_u32 s27, s42, 1
M v[112:115], a[68:71], a[172:175], v[112:115]
 s_mov_b32 s43, 32767
M v[116:119], a[76:79], a[172:175], v[116:119]
 s_mov_b32 s4, 0
 buffer_load_dword v24, v13, s[8:11], s46 offen sc1
M v[116:119], a[72:75], a[168:171], v[116:119]
 s_add_u32 s26, s21, 655360
 buffer_store_dwordx4 a[232:235], v30, s[8:11], s89 offen offset:384 sc1
M v[120:123], a[80:83], a[168:171], v[120:123]
 s_lshl_b32 s64, s42, 1
 s_add_u32 s65, s64, 4
 s_add_u32 s64, s64, 2
M v[120:123], a[84:87], a[172:175], v[120:123]
 s_waitcnt lgkmcnt(6)
 s_add_u32 s3, s93, 524288
M v[124:127], a[92:95], a[172:175], v[124:127]
 s_waitcnt vmcnt(23) lgkmcnt(0)
M v[124:127], a[88:91], a[168:171], v[124:127]
 s_barrier
M v[160:163], a[32:35], a[160:163], v[160:163]
 s_cmp_le_u32 s42, 5
 ds_read_b128 a[168:171], v5 offset:6144
 ds_read_b128 a[172:175], v6 offset:6144
M v[160:163], a[36:39], a[164:167], v[160:163]
 s_cselect_b32 s25, s65, 32767
 ds_read_b64_tr_b16 a[128:129], v20 offset:16384
 ds_read_b64_tr_b16 a[130:131], v20 offset:17408
M v[164:167], a[44:47], a[164:167], v[164:167]
 s_cselect_b32 s6, 14, s64
 buffer_store_dwordx4 v[128:131], v7, s[8:11], s3 offen offset:0 sc1
M v[164:167], a[40:43], a[160:163], v[164:167]
 s_mov_b32 s23, 0
M v[168:171], a[48:51], a[160:163], v[168:171]
 ds_read_b64_tr_b16 a[132:133], v20 offset:24576
 ds_read_b64_tr_b16 a[134:135], v20 offset:25600
M v[168:171], a[52:55], a[164:167], v[168:171]
M v[172:175], a[60:63], a[164:167], v[172:175]
 buffer_store_dwordx4 v[132:135], v7, s[8:11], s3 offen offset:2048 sc1
M v[172:175], a[56:59], a[160:163], v[172:175]
 s_add_u32 s3, s93, 528384
 ds_read_b64_tr_b16 a[136:137], v21 offset:16384
 ds_read_b64_tr_b16 a[138:139], v21 offset:17408
M v[176:179], a[64:67], a[160:163], v[176:179]
M v[176:179], a[68:71], a[164:167], v[176:179]
M v[180:183], a[76:79], a[164:167], v[180:183]
 ds_read_b64_tr_b16 a[140:141], v21 offset:24576
 ds_read_b64_tr_b16 a[142:143], v21 offset:25600
M v[180:183], a[72:75], a[160:163], v[180:183]
 buffer_store_dwordx4 v[136:139], v7, s[8:11], s3 offen offset:0 sc1
M v[184:187], a[80:83], a[160:163], v[184:187]
M v[184:187], a[84:87], a[164:167], v[184:187]
 s_waitcnt lgkmcnt(8)
 ds_read_b64_tr_b16 a[144:145], v22 offset:16384
 ds_read_b64_tr_b16 a[146:147], v22 offset:17408
M v[188:191], a[92:95], a[164:167], v[188:191]
M v[188:191], a[88:91], a[160:163], v[188:191]
 buffer_store_dwordx4 v[140:143], v7, s[8:11], s3 offen offset:2048 sc1
M v[224:227], a[32:35], a[168:171], v[224:227]
 ds_read_b128 a[160:163], v5 offset:16384
 ds_read_b128 a[164:167], v6 offset:16384
M v[224:227], a[36:39], a[172:175], v[224:227]
 s_add_u32 s3, s93, 532480
 ds_read_b64_tr_b16 a[148:149], v22 offset:24576
 ds_read_b64_tr_b16 a[150:151], v22 offset:25600
M v[228:231], a[44:47], a[172:175], v[228:231]
M v[228:231], a[40:43], a[168:171], v[228:231]
 ds_read_b64_tr_b16 a[152:153], v23 offset:16384
 ds_read_b64_tr_b16 a[154:155], v23 offset:17408
M v[232:235], a[48:51], a[168:171], v[232:235]
 buffer_store_dwordx4 v[144:147], v7, s[8:11], s3 offen offset:0 sc1
M v[232:235], a[52:55], a[172:175], v[232:235]
M v[236:239], a[60:63], a[172:175], v[236:239]
 ds_read_b64_tr_b16 a[156:157], v23 offset:24576
 ds_read_b64_tr_b16 a[158:159], v23 offset:25600
M v[236:239], a[56:59], a[168:171], v[236:239]
M v[240:243], a[64:67], a[168:171], v[240:243]
M v[240:243], a[68:71], a[172:175], v[240:243]
M v[244:247], a[76:79], a[172:175], v[244:247]
M v[244:247], a[72:75], a[168:171], v[244:247]
M v[248:251], a[80:83], a[168:171], v[248:251]
M v[248:251], a[84:87], a[172:175], v[248:251]
 s_waitcnt lgkmcnt(6)
M v[252:255], a[92:95], a[172:175], v[252:255]
 s_waitcnt vmcnt(23) lgkmcnt(0)
M v[252:255], a[88:91], a[168:171], v[252:255]
 s_barrier
M v[32:35], a[96:99], a[160:163], v[32:35]
 ds_read_b128 a[168:171], v5 offset:18432
 ds_read_b128 a[172:175], v6 offset:18432
M v[32:35], a[100:103], a[164:167], v[32:35]
 ds_read_b64_tr_b16 a[32:33], v1 offset:0
 ds_read_b64_tr_b16 a[34:35], v1 offset:1024
M v[36:39], a[108:111], a[164:167], v[36:39]
 v_add_u32 v10, s28, v7
 v_add_u32 v11, 0x1000, v10
M v[36:39], a[104:107], a[160:163], v[36:39]
 s_waitcnt vmcnt(6)
 v_cmp_eq_u32 vcc, 0, v24
M v[40:43], a[112:115], a[160:163], v[40:43]
 s_lshl_b32 s64, s20, 10
 ds_read_b64_tr_b16 a[36:37], v1 offset:8192
 ds_read_b64_tr_b16 a[38:39], v1 offset:9216
M v[40:43], a[116:119], a[164:167], v[40:43]
 s_cbranch_vccnz L_f1s04
L_f1r04:
M v[44:47], a[124:127], a[164:167], v[44:47]
 s_add_u32 m0, s28, 98304
 s_nop 0
 buffer_load_dwordx4 v10, s[8:11], s21 offen offset:0 sc1 lds
M v[44:47], a[120:123], a[160:163], v[44:47]
 ds_read_b64_tr_b16 a[40:41], v2 offset:0
 ds_read_b64_tr_b16 a[42:43], v2 offset:1024
M v[48:51], a[128:131], a[160:163], v[48:51]
 buffer_store_dwordx4 v[148:151], v7, s[8:11], s3 offen offset:2048 sc1
M v[48:51], a[132:135], a[164:167], v[48:51]
M v[52:55], a[140:143], a[164:167], v[52:55]
 ds_read_b64_tr_b16 a[44:45], v2 offset:8192
 ds_read_b64_tr_b16 a[46:47], v2 offset:9216
M v[52:55], a[136:139], a[160:163], v[52:55]
 buffer_load_dwordx4 v10, s[8:11], s21 offen offset:1024 sc1 lds
M v[56:59], a[144:147], a[160:163], v[56:59]
M v[56:59], a[148:151], a[164:167], v[56:59]
 s_waitcnt lgkmcnt(8)
 ds_read_b64_tr_b16 a[48:49], v3 offset:0
 ds_read_b64_tr_b16 a[50:51], v3 offset:1024
M v[60:63], a[156:159], a[164:167], v[60:63]
M v[60:63], a[152:155], a[160:163], v[60:63]
 s_add_u32 s3, s93, 536576
 buffer_load_dwordx4 v10, s[8:11], s21 offen offset:2048 sc1 lds
M v[96:99], a[96:99], a[168:171], v[96:99]
 ds_read_b128 a[160:163], v5 offset:20480
 ds_read_b128 a[164:167], v6 offset:20480
M v[96:99], a[100:103], a[172:175], v[96:99]
 ds_read_b64_tr_b16 a[52:53], v3 offset:8192
 ds_read_b64_tr_b16 a[54:55], v3 offset:9216
M v[100:103], a[108:111], a[172:175], v[100:103]
 buffer_store_dwordx4 v[152:155], v7, s[8:11], s3 offen offset:0 sc1
M v[100:103], a[104:107], a[168:171], v[100:103]
 ds_read_b64_tr_b16 a[56:57], v4 offset:0
 ds_read_b64_tr_b16 a[58:59], v4 offset:1024
M v[104:107], a[112:115], a[168:171], v[104:107]
 buffer_load_dwordx4 v10, s[8:11], s21 offen offset:3072 sc1 lds
M v[104:107], a[116:119], a[172:175], v[104:107]
 s_add_u32 m0, s28, 102400
M v[108:111], a[124:127], a[172:175], v[108:111]
 ds_read_b64_tr_b16 a[60:61], v4 offset:8192
 ds_read_b64_tr_b16 a[62:63], v4 offset:9216
M v[108:111], a[120:123], a[168:171], v[108:111]
M v[112:115], a[128:131], a[168:171], v[112:115]
 buffer_load_dwordx4 v11, s[8:11], s21 offen offset:0 sc1 lds
M v[112:115], a[132:135], a[172:175], v[112:115]
M v[116:119], a[140:143], a[172:175], v[116:119]
 buffer_store_dwordx4 v[156:159], v7, s[8:11], s3 offen offset:2048 sc1
M v[116:119], a[136:139], a[168:171], v[116:119]
M v[120:123], a[144:147], a[168:171], v[120:123]
 buffer_load_dwordx4 v11, s[8:11], s21 offen offset:1024 sc1 lds
M v[120:123], a[148:151], a[172:175], v[120:123]
 s_waitcnt lgkmcnt(6)
M v[124:127], a[156:159], a[172:175], v[124:127]
 s_waitcnt lgkmcnt(0)
 buffer_load_dwordx4 v11, s[8:11], s21 offen offset:2048 sc1 lds
M v[124:127], a[152:155], a[168:171], v[124:127]
 s_barrier
M v[160:163], a[96:99], a[160:163], v[160:163]
 ds_read_b128 a[168:171], v5 offset:22528
 ds_read_b128 a[172:175], v6 offset:22528
M v[160:163], a[100:103], a[164:167], v[160:163]
 ds_read_b64_tr_b16 a[64:65], v1 offset:16384
 ds_read_b64_tr_b16 a[66:67], v1 offset:17408
M v[164:167], a[108:111], a[164:167], v[164:167]
 buffer_load_dwordx4 v11, s[8:11], s21 offen offset:3072 sc1 lds
M v[164:167], a[104:107], a[160:163], v[164:167]
 s_add_u32 s24, s23, 16777216
M v[168:171], a[112:115], a[160:163], v[168:171]
 s_mov_b32 s23, s21
 ds_read_b64_tr_b16 a[68:69], v1 offset:24576
 ds_read_b64_tr_b16 a[70:71], v1 offset:25600
M v[168:171], a[116:119], a[164:167], v[168:171]
 s_add_u32 s21, s21, 32768
 s_add_u32 s3, s93, 786432
M v[172:175], a[124:127], a[164:167], v[172:175]
 s_add_u32 s22, s22, 1
 buffer_store_dwordx4 v[192:195], v7, s[8:11], s3 offen offset:0 sc1
M v[172:175], a[120:123], a[160:163], v[172:175]
 s_cmp_eq_u32 s22, s25
 ds_read_b64_tr_b16 a[72:73], v2 offset:16384
 ds_read_b64_tr_b16 a[74:75], v2 offset:17408
M v[176:179], a[128:131], a[160:163], v[176:179]
 s_cselect_b32 s21, s26, s21
 v_subrev_u32 v5, 0x10000, v5
 v_subrev_u32 v6, 0x10000, v6
M v[176:179], a[132:135], a[164:167], v[176:179]
 s_cmp_eq_u32 s22, s43
M v[180:183], a[140:143], a[164:167], v[180:183]
 s_cselect_b32 s21, s4, s21
 ds_read_b64_tr_b16 a[76:77], v2 offset:24576
 ds_read_b64_tr_b16 a[78:79], v2 offset:25600
M v[180:183], a[136:139], a[160:163], v[180:183]
 s_cmp_eq_u32 s22, s6
M v[184:187], a[144:147], a[160:163], v[184:187]
 s_cselect_b32 s21, s7, s21
 v_mov_b32 v9, v25
 v_lshrrev_b32 v24, 4, v0
M v[184:187], a[148:151], a[164:167], v[184:187]
 s_waitcnt lgkmcnt(8)
 ds_read_b64_tr_b16 a[80:81], v3 offset:16384
 ds_read_b64_tr_b16 a[82:83], v3 offset:17408
M v[188:191], a[156:159], a[164:167], v[188:191]
 v_lshlrev_b32 v24, 2, v24
 v_and_b32 v25, 15, v0
M v[188:191], a[152:155], a[160:163], v[188:191]
 v_sub_u32 v24, v24, v25
M v[224:227], a[96:99], a[168:171], v[224:227]
 s_add_u32 s64, s64, s34
 ds_read_b128 a[160:163], v5 offset:32768
 ds_read_b128 a[164:167], v6 offset:32768
M v[224:227], a[100:103], a[172:175], v[224:227]
 s_add_u32 s52, s64, 65536
 ds_read_b64_tr_b16 a[84:85], v3 offset:24576
 ds_read_b64_tr_b16 a[86:87], v3 offset:25600
M v[228:231], a[108:111], a[172:175], v[228:231]
 s_mov_b32 s55, 0x21800000
 buffer_store_dwordx4 v[196:199], v7, s[8:11], s3 offen offset:2048 sc1
M v[228:231], a[104:107], a[168:171], v[228:231]
 s_and_b32 s65, s39, 0
 ds_read_b64_tr_b16 a[88:89], v4 offset:16384
 ds_read_b64_tr_b16 a[90:91], v4 offset:17408
M v[232:235], a[112:115], a[168:171], v[232:235]
 s_cmp_eq_u32 s20, 0
M v[232:235], a[116:119], a[172:175], v[232:235]
 s_cselect_b32 s54, s39, s65
M v[236:239], a[124:127], a[172:175], v[236:239]
 s_lshr_b32 s64, s20, 1
 ds_read_b64_tr_b16 a[92:93], v4 offset:24576
 ds_read_b64_tr_b16 a[94:95], v4 offset:25600
M v[236:239], a[120:123], a[168:171], v[236:239]
 s_lshl_b32 s64, s64, 17
M v[240:243], a[128:131], a[168:171], v[240:243]
 s_and_b32 s65, s20, 1
M v[240:243], a[132:135], a[172:175], v[240:243]
 s_lshl_b32 s65, s65, 12
M v[244:247], a[140:143], a[172:175], v[244:247]
 s_add_u32 s64, s64, s65
 v_add_u32 v14, s64, v7
 v_mov_b32 v8, 0xff800000
M v[244:247], a[136:139], a[168:171], v[244:247]
 v_cmp_lt_i32 s[16:17], 0, v24
 v_cmp_lt_i32 s[18:19], -1, v24
M v[248:251], a[144:147], a[168:171], v[248:251]
 v_cmp_lt_i32 s[48:49], -2, v24
 v_cmp_lt_i32 s[50:51], -3, v24
M v[248:251], a[148:151], a[172:175], v[248:251]
 s_waitcnt lgkmcnt(6)
M v[252:255], a[156:159], a[172:175], v[252:255]
 s_waitcnt lgkmcnt(0)
M v[252:255], a[152:155], a[168:171], v[252:255]
 s_barrier
M v[32:35], a[32:35], a[160:163], v[32:35]
 ds_read_b128 a[168:171], v5 offset:34816
 ds_read_b128 a[172:175], v6 offset:34816
M v[32:35], a[36:39], a[164:167], v[32:35]
 buffer_load_dword v24, v9, s[8:11], s46 offen sc1
M v[36:39], a[44:47], a[164:167], v[36:39]
 v_mov_b32 v1, v15
 v_add_u32 v2, 0x10000, v7
M v[36:39], a[40:43], a[160:163], v[36:39]
 v_mov_b32 v3, v10
 v_mov_b32 v4, v11
M v[40:43], a[48:51], a[160:163], v[40:43]
 s_mov_b64 s[60:61], s[76:77]
M v[40:43], a[52:55], a[164:167], v[40:43]
 s_mov_b32 s62, s78
M v[44:47], a[60:63], a[164:167], v[44:47]
 s_mov_b32 s63, 0x20000
 v_lshl_add_u32 v10, v0, 7, s95
 v_and_b32 v0, 48, v0
M v[44:47], a[56:59], a[160:163], v[44:47]
 v_lshl_add_u32 v0, v0, 24, v10
 v_mul_f32 v32, s5, v32
M v[48:51], a[64:67], a[160:163], v[48:51]
 v_mul_f32 v33, s5, v33
 v_mul_f32 v34, s5, v34
M v[48:51], a[68:71], a[164:167], v[48:51]
 v_mul_f32 v35, s5, v35
 v_mul_f32 v36, s5, v36
M v[52:55], a[76:79], a[164:167], v[52:55]
 v_mul_f32 v37, s5, v37
 v_mul_f32 v38, s5, v38
M v[52:55], a[72:75], a[160:163], v[52:55]
 v_mul_f32 v39, s5, v39
 v_cvt_pk_bf16_f32 v32, v32, v33
M v[56:59], a[80:83], a[160:163], v[56:59]
 v_cvt_pk_bf16_f32 v33, v34, v35
 v_cvt_pk_bf16_f32 v34, v36, v37
M v[56:59], a[84:87], a[164:167], v[56:59]
 s_waitcnt lgkmcnt(0)
 v_cvt_pk_bf16_f32 v35, v38, v39
 ds_write_b128 v14, v[32:35] offset:0
M v[60:63], a[92:95], a[164:167], v[60:63]
 s_add_u32 s3, s93, 790528
 buffer_store_dwordx4 v[200:203], v7, s[8:11], s3 offen offset:0 sc1
M v[60:63], a[88:91], a[160:163], v[60:63]
 v_mul_f32 v40, s5, v40
 v_mul_f32 v41, s5, v41
M v[96:99], a[32:35], a[168:171], v[96:99]
 ds_read_b128 a[160:163], v5 offset:36864
 ds_read_b128 a[164:167], v6 offset:36864
M v[96:99], a[36:39], a[172:175], v[96:99]
 v_mul_f32 v42, s5, v42
 v_mul_f32 v43, s5, v43
M v[100:103], a[44:47], a[172:175], v[100:103]
 v_mul_f32 v44, s5, v44
 v_mul_f32 v45, s5, v45
M v[100:103], a[40:43], a[168:171], v[100:103]
 v_mul_f32 v46, s5, v46
 v_mul_f32 v47, s5, v47
M v[104:107], a[48:51], a[168:171], v[104:107]
 v_cvt_pk_bf16_f32 v40, v40, v41
 v_cvt_pk_bf16_f32 v41, v42, v43
M v[104:107], a[52:55], a[172:175], v[104:107]
 v_cvt_pk_bf16_f32 v42, v44, v45
 v_cvt_pk_bf16_f32 v43, v46, v47
M v[108:111], a[60:63], a[172:175], v[108:111]
 ds_write_b128 v14, v[40:43] offset:1024
M v[108:111], a[56:59], a[168:171], v[108:111]
 buffer_store_dwordx4 v[204:207], v7, s[8:11], s3 offen offset:2048 sc1
M v[112:115], a[64:67], a[168:171], v[112:115]
 v_mul_f32 v48, s5, v48
 v_mul_f32 v49, s5, v49
M v[112:115], a[68:71], a[172:175], v[112:115]
 v_mul_f32 v50, s5, v50
 v_mul_f32 v51, s5, v51
M v[116:119], a[76:79], a[172:175], v[116:119]
 v_mul_f32 v52, s5, v52
 v_mul_f32 v53, s5, v53
M v[116:119], a[72:75], a[168:171], v[116:119]
 v_mul_f32 v54, s5, v54
 v_mul_f32 v55, s5, v55
M v[120:123], a[80:83], a[168:171], v[120:123]
 v_cvt_pk_bf16_f32 v48, v48, v49
 v_cvt_pk_bf16_f32 v49, v50, v51
M v[120:123], a[84:87], a[172:175], v[120:123]
 s_waitcnt lgkmcnt(1)
 v_cvt_pk_bf16_f32 v50, v52, v53
 v_cvt_pk_bf16_f32 v51, v54, v55
M v[124:127], a[92:95], a[172:175], v[124:127]
 ds_write_b128 v14, v[48:51] offset:2048
M v[124:127], a[88:91], a[168:171], v[124:127]
 s_add_u32 s3, s93, 794624
 buffer_store_dwordx4 v[208:211], v7, s[8:11], s3 offen offset:0 sc1
M v[160:163], a[32:35], a[160:163], v[160:163]
 ds_read_b128 a[168:171], v5 offset:38912
 ds_read_b128 a[172:175], v6 offset:38912
M v[160:163], a[36:39], a[164:167], v[160:163]
 v_mul_f32 v56, s5, v56
 v_mul_f32 v57, s5, v57
M v[164:167], a[44:47], a[164:167], v[164:167]
 v_mul_f32 v58, s5, v58
 v_mul_f32 v59, s5, v59
M v[164:167], a[40:43], a[160:163], v[164:167]
 v_mul_f32 v60, s5, v60
 v_mul_f32 v61, s5, v61
M v[168:171], a[48:51], a[160:163], v[168:171]
 v_mul_f32 v62, s5, v62
 v_mul_f32 v63, s5, v63
M v[168:171], a[52:55], a[164:167], v[168:171]
 v_cvt_pk_bf16_f32 v56, v56, v57
 v_cvt_pk_bf16_f32 v57, v58, v59
M v[172:175], a[60:63], a[164:167], v[172:175]
 v_cvt_pk_bf16_f32 v58, v60, v61
 v_cvt_pk_bf16_f32 v59, v62, v63
M v[172:175], a[56:59], a[160:163], v[172:175]
 s_waitcnt lgkmcnt(0)
 ds_write_b128 v14, v[56:59] offset:3072
M v[176:179], a[64:67], a[160:163], v[176:179]
 s_barrier
M v[176:179], a[68:71], a[164:167], v[176:179]
M v[180:183], a[76:79], a[164:167], v[180:183]
 s_add_u32 m0, s28, 32768
 s_nop 0
 buffer_load_dwordx4 v3, s[8:11], s21 offen offset:0 sc1 lds
M v[180:183], a[72:75], a[160:163], v[180:183]
M v[184:187], a[80:83], a[160:163], v[184:187]
 buffer_store_dwordx4 v[212:215], v7, s[8:11], s3 offen offset:2048 sc1
M v[184:187], a[84:87], a[164:167], v[184:187]
 v_mul_f32 v96, s5, v96
 v_mul_f32 v97, s5, v97
M v[188:191], a[92:95], a[164:167], v[188:191]
 buffer_load_dwordx4 v3, s[8:11], s21 offen offset:1024 sc1 lds
M v[188:191], a[88:91], a[160:163], v[188:191]
 v_mul_f32 v98, s5, v98
 v_mul_f32 v99, s5, v99
M v[224:227], a[32:35], a[168:171], v[224:227]
 v_mul_f32 v100, s5, v100
 v_mul_f32 v101, s5, v101
M v[224:227], a[36:39], a[172:175], v[224:227]
 v_mul_f32 v102, s5, v102
 v_mul_f32 v103, s5, v103
M v[228:231], a[44:47], a[172:175], v[228:231]
 buffer_load_dwordx4 v3, s[8:11], s21 offen offset:2048 sc1 lds
M v[228:231], a[40:43], a[168:171], v[228:231]
 v_cvt_pk_bf16_f32 v96, v96, v97
 v_cvt_pk_bf16_f32 v97, v98, v99
M v[232:235], a[48:51], a[168:171], v[232:235]
 v_cvt_pk_bf16_f32 v98, v100, v101
 v_cvt_pk_bf16_f32 v99, v102, v103
M v[232:235], a[52:55], a[172:175], v[232:235]
 ds_write_b128 v14, v[96:99] offset:8192
M v[236:239], a[60:63], a[172:175], v[236:239]
 s_add_u32 s3, s93, 798720
 buffer_load_dwordx4 v3, s[8:11], s21 offen offset:3072 sc1 lds
M v[236:239], a[56:59], a[168:171], v[236:239]
 s_add_u32 m0, s28, 36864
M v[240:243], a[64:67], a[168:171], v[240:243]
 buffer_store_dwordx4 v[216:219], v7, s[8:11], s3 offen offset:0 sc1
M v[240:243], a[68:71], a[172:175], v[240:243]
 v_mul_f32 v104, s5, v104
 v_mul_f32 v105, s5, v105
M v[244:247], a[76:79], a[172:175], v[244:247]
 buffer_load_dwordx4 v4, s[8:11], s21 offen offset:0 sc1 lds
M v[244:247], a[72:75], a[168:171], v[244:247]
 v_mul_f32 v106, s5, v106
 v_mul_f32 v107, s5, v107
M v[248:251], a[80:83], a[168:171], v[248:251]
 v_mul_f32 v108, s5, v108
 v_mul_f32 v109, s5, v109
M v[248:251], a[84:87], a[172:175], v[248:251]
 v_mul_f32 v110, s5, v110
 v_mul_f32 v111, s5, v111
M v[252:255], a[92:95], a[172:175], v[252:255]
 buffer_load_dwordx4 v4, s[8:11], s21 offen offset:1024 sc1 lds
M v[252:255], a[88:91], a[168:171], v[252:255]
 buffer_load_dwordx4 v4, s[8:11], s21 offen offset:2048 sc1 lds
 buffer_load_dwordx4 v4, s[8:11], s21 offen offset:3072 sc1 lds
 s_add_u32 s24, s23, 16777216
 s_mov_b32 s23, s21
 s_add_u32 s21, s21, 32768
 s_add_u32 s22, s22, 1
 s_cmp_eq_u32 s22, s25
 s_cselect_b32 s21, s26, s21
 s_cmp_eq_u32 s22, s43
 s_cselect_b32 s21, s4, s21
 s_cmp_eq_u32 s22, s6
 s_cselect_b32 s21, s7, s21
 v_cvt_pk_bf16_f32 v104, v104, v105
 v_cvt_pk_bf16_f32 v105, v106, v107
 v_cvt_pk_bf16_f32 v106, v108, v109
 v_cvt_pk_bf16_f32 v107, v110, v111
 ds_write_b128 v14, v[104:107] offset:9216
 buffer_store_dwordx4 v[220:223], v7, s[8:11], s3 offen offset:2048 sc1
 v_pk_mul_f32 v[112:113], v[112:113], s[4:5] op_sel:[0,1] op_sel_hi:[1,1]
 v_pk_mul_f32 v[114:115], v[114:115], s[4:5] op_sel:[0,1] op_sel_hi:[1,1]
 v_pk_mul_f32 v[116:117], v[116:117], s[4:5] op_sel:[0,1] op_sel_hi:[1,1]
 v_pk_mul_f32 v[118:119], v[118:119], s[4:5] op_sel:[0,1] op_sel_hi:[1,1]
 v_cvt_pk_bf16_f32 v112, v112, v113
 v_cvt_pk_bf16_f32 v113, v114, v115
 v_cvt_pk_bf16_f32 v114, v116, v117
 v_cvt_pk_bf16_f32 v115, v118, v119
 ds_write_b128 v14, v[112:115] offset:10240
 v_pk_mul_f32 v[120:121], v[120:121], s[4:5] op_sel:[0,1] op_sel_hi:[1,1]
 v_pk_mul_f32 v[122:123], v[122:123], s[4:5] op_sel:[0,1] op_sel_hi:[1,1]
 v_pk_mul_f32 v[124:125], v[124:125], s[4:5] op_sel:[0,1] op_sel_hi:[1,1]
 v_pk_mul_f32 v[126:127], v[126:127], s[4:5] op_sel:[0,1] op_sel_hi:[1,1]
 v_cvt_pk_bf16_f32 v120, v120, v121
 v_cvt_pk_bf16_f32 v121, v122, v123
 v_cvt_pk_bf16_f32 v122, v124, v125
 v_cvt_pk_bf16_f32 v123, v126, v127
 ds_write_b128 v14, v[120:123] offset:11264
 v_pk_mul_f32 v[160:161], v[160:161], s[4:5] op_sel:[0,1] op_sel_hi:[1,1]
 v_pk_mul_f32 v[162:163], v[162:163], s[4:5] op_sel:[0,1] op_sel_hi:[1,1]
 v_pk_mul_f32 v[164:165], v[164:165], s[4:5] op_sel:[0,1] op_sel_hi:[1,1]
 v_pk_mul_f32 v[166:167], v[166:167], s[4:5] op_sel:[0,1] op_sel_hi:[1,1]
 v_cvt_pk_bf16_f32 v160, v160, v161
 v_cvt_pk_bf16_f32 v161, v162, v163
 v_cvt_pk_bf16_f32 v162, v164, v165
 v_cvt_pk_bf16_f32 v163, v166, v167
 ds_write_b128 v14, v[160:163] offset:16384
 v_pk_mul_f32 v[168:169], v[168:169], s[4:5] op_sel:[0,1] op_sel_hi:[1,1]
 v_pk_mul_f32 v[170:171], v[170:171], s[4:5] op_sel:[0,1] op_sel_hi:[1,1]
 v_pk_mul_f32 v[172:173], v[172:173], s[4:5] op_sel:[0,1] op_sel_hi:[1,1]
 v_pk_mul_f32 v[174:175], v[174:175], s[4:5] op_sel:[0,1] op_sel_hi:[1,1]
 v_cvt_pk_bf16_f32 v168, v168, v169
 v_cvt_pk_bf16_f32 v169, v170, v171
 v_cvt_pk_bf16_f32 v170, v172, v173
 v_cvt_pk_bf16_f32 v171, v174, v175
 ds_write_b128 v14, v[168:171] offset:17408
 v_pk_mul_f32 v[176:177], v[176:177], s[4:5] op_sel:[0,1] op_sel_hi:[1,1]
 v_pk_mul_f32 v[178:179], v[178:179], s[4:5] op_sel:[0,1] op_sel_hi:[1,1]
 v_pk_mul_f32 v[180:181], v[180:181], s[4:5] op_sel:[0,1] op_sel_hi:[1,1]
 v_pk_mul_f32 v[182:183], v[182:183], s[4:5] op_sel:[0,1] op_sel_hi:[1,1]
 v_cvt_pk_bf16_f32 v176, v176, v177
 v_cvt_pk_bf16_f32 v177, v178, v179
 v_cvt_pk_bf16_f32 v178, v180, v181
 v_cvt_pk_bf16_f32 v179, v182, v183
 ds_write_b128 v14, v[176:179] offset:18432
 v_pk_mul_f32 v[184:185], v[184:185], s[4:5] op_sel:[0,1] op_sel_hi:[1,1]
 v_pk_mul_f32 v[186:187], v[186:187], s[4:5] op_sel:[0,1] op_sel_hi:[1,1]
 v_pk_mul_f32 v[188:189], v[188:189], s[4:5] op_sel:[0,1] op_sel_hi:[1,1]
 v_pk_mul_f32 v[190:191], v[190:191], s[4:5] op_sel:[0,1] op_sel_hi:[1,1]
 v_cvt_pk_bf16_f32 v184, v184, v185
 v_cvt_pk_bf16_f32 v185, v186, v187
 v_cvt_pk_bf16_f32 v186, v188, v189
 v_cvt_pk_bf16_f32 v187, v190, v191
 ds_write_b128 v14, v[184:187] offset:19456
 v_pk_mul_f32 v[224:225], v[224:225], s[4:5] op_sel:[0,1] op_sel_hi:[1,1]
 v_pk_mul_f32 v[226:227], v[226:227], s[4:5] op_sel:[0,1] op_sel_hi:[1,1]
 v_pk_mul_f32 v[228:229], v[228:229], s[4:5] op_sel:[0,1] op_sel_hi:[1,1]
 v_pk_mul_f32 v[230:231], v[230:231], s[4:5] op_sel:[0,1] op_sel_hi:[1,1]
 v_cvt_pk_bf16_f32 v224, v224, v225
 v_cvt_pk_bf16_f32 v225, v226, v227
 v_cvt_pk_bf16_f32 v226, v228, v229
 v_cvt_pk_bf16_f32 v227, v230, v231
 ds_write_b128 v14, v[224:227] offset:24576
 v_pk_mul_f32 v[232:233], v[232:233], s[4:5] op_sel:[0,1] op_sel_hi:[1,1]
 v_pk_mul_f32 v[234:235], v[234:235], s[4:5] op_sel:[0,1] op_sel_hi:[1,1]
 v_pk_mul_f32 v[236:237], v[236:237], s[4:5] op_sel:[0,1] op_sel_hi:[1,1]
 v_pk_mul_f32 v[238:239], v[238:239], s[4:5] op_sel:[0,1] op_sel_hi:[1,1]
 v_cvt_pk_bf16_f32 v232, v232, v233
 v_cvt_pk_bf16_f32 v233, v234, v235
 v_cvt_pk_bf16_f32 v234, v236, v237
 v_cvt_pk_bf16_f32 v235, v238, v239
 ds_write_b128 v14, v[232:235] offset:25600
 v_pk_mul_f32 v[240:241], v[240:241], s[4:5] op_sel:[0,1] op_sel_hi:[1,1]
 v_pk_mul_f32 v[242:243], v[242:243], s[4:5] op_sel:[0,1] op_sel_hi:[1,1]
 v_pk_mul_f32 v[244:245], v[244:245], s[4:5] op_sel:[0,1] op_sel_hi:[1,1]
 v_pk_mul_f32 v[246:247], v[246:247], s[4:5] op_sel:[0,1] op_sel_hi:[1,1]
 v_cvt_pk_bf16_f32 v240, v240, v241
 v_cvt_pk_bf16_f32 v241, v242, v243
 v_cvt_pk_bf16_f32 v242, v244, v245
 v_cvt_pk_bf16_f32 v243, v246, v247
 ds_write_b128 v14, v[240:243] offset:26624
 v_pk_mul_f32 v[248:249], v[248:249], s[4:5] op_sel:[0,1] op_sel_hi:[1,1]
 v_pk_mul_f32 v[250:251], v[250:251], s[4:5] op_sel:[0,1] op_sel_hi:[1,1]
 v_pk_mul_f32 v[252:253], v[252:253], s[4:5] op_sel:[0,1] op_sel_hi:[1,1]
 v_pk_mul_f32 v[254:255], v[254:255], s[4:5] op_sel:[0,1] op_sel_hi:[1,1]
 v_cvt_pk_bf16_f32 v248, v248, v249
 v_cvt_pk_bf16_f32 v249, v250, v251
 v_cvt_pk_bf16_f32 v250, v252, v253
 v_cvt_pk_bf16_f32 v251, v254, v255
 ds_write_b128 v14, v[248:251] offset:27648
 s_waitcnt vmcnt(17) lgkmcnt(0)
 s_barrier
 ds_read_b128 a[64:67], v2 offset:32768
 ds_read_b128 a[68:71], v2 offset:33792
 ds_read_b128 a[72:75], v2 offset:34816
 ds_read_b128 a[76:79], v2 offset:35840
 ds_read_b128 a[80:83], v2 offset:36864
 ds_read_b128 a[84:87], v2 offset:37888
 ds_read_b128 a[88:91], v2 offset:38912
 ds_read_b128 a[92:95], v2 offset:39936
 s_lshl_b32 s64, s20, 13
 s_sub_u32 s65, 155648, s64
 v_add_u32 v10, s64, v7
 v_add_u32 v11, s65, v7
 ds_read_b128 a[0:3], v10 offset:0
 ds_read_b128 a[4:7], v10 offset:1024
 ds_read_b128 a[8:11], v10 offset:2048
 ds_read_b128 a[12:15], v10 offset:3072
 ds_read_b128 a[16:19], v10 offset:4096
 ds_read_b128 a[20:23], v10 offset:5120
 ds_read_b128 a[24:27], v10 offset:6144
 ds_read_b128 a[28:31], v10 offset:7168
 ds_read_b128 a[32:35], v11 offset:0
 ds_read_b128 a[36:39], v11 offset:1024
 ds_read_b128 a[40:43], v11 offset:2048
 ds_read_b128 a[44:47], v11 offset:3072
 ds_read_b128 a[48:51], v11 offset:4096
 ds_read_b128 a[52:55], v11 offset:5120
 ds_read_b128 a[56:59], v11 offset:6144
 ds_read_b128 a[60:63], v11 offset:7168
 s_waitcnt vmcnt(14)
 v_cmp_eq_u32 vcc, 0, v24
 v_mov_b32 v17, 5
 v_or_b32 v6, s35, v7
 s_cbranch_vccnz L_f1s05
L_f1r05:
 s_mov_b32 s30, s93
 s_mov_b32 s29, s94
 s_cmp_eq_u32 s20, 0
 s_cselect_b32 s5, 0, 0
 v_mov_b32 v32, 0xc1800000
 v_mov_b32 v33, 0xc1800000
 v_mov_b32 v34, 0xc1800000
 v_mov_b32 v35, 0xc1800000
 v_mov_b32 v36, 0xc1800000
 v_mov_b32 v37, 0xc1800000
 v_mov_b32 v38, 0xc1800000
 v_mov_b32 v39, 0xc1800000
 s_waitcnt lgkmcnt(0)
M v[64:67], a[64:67], a[0:3], v[32:35]
 ds_read_b128 a[96:99], v2 offset:40960
 v_mov_b32 v30, 0
M v[64:67], a[68:71], a[4:7], v[64:67]
 s_add_u32 m0, s28, 65536
 ds_read_b128 a[100:103], v2 offset:41984
 v_mov_b32 v31, 0
M v[64:67], a[72:75], a[8:11], v[64:67]
 buffer_load_dwordx4 v3, s[8:11], s24 offen offset:0 sc1 lds
M v[64:67], a[76:79], a[12:15], v[64:67]
 ds_read_b128 a[104:107], v2 offset:43008
M v[64:67], a[80:83], a[16:19], v[64:67]
 ds_read_b128 a[108:111], v2 offset:44032
M v[64:67], a[84:87], a[20:23], v[64:67]
 buffer_load_dwordx4 v3, s[8:11], s24 offen offset:1024 sc1 lds
M v[64:67], a[88:91], a[24:27], v[64:67]
 ds_read_b128 a[112:115], v2 offset:45056
M v[64:67], a[92:95], a[28:31], v[64:67]
 ds_read_b128 a[116:119], v2 offset:46080
M v[68:71], a[92:95], a[60:63], v[36:39]
M v[68:71], a[88:91], a[56:59], v[68:71]
 ds_read_b128 a[120:123], v2 offset:47104
M v[68:71], a[84:87], a[52:55], v[68:71]
 ds_read_b128 a[124:127], v2 offset:48128
M v[68:71], a[80:83], a[48:51], v[68:71]
 buffer_load_dwordx4 v3, s[8:11], s24 offen offset:2048 sc1 lds
M v[68:71], a[76:79], a[44:47], v[68:71]
 v_exp_f32 v18, v64
M v[68:71], a[72:75], a[40:43], v[68:71]
 v_exp_f32 v19, v65
M v[68:71], a[68:71], a[36:39], v[68:71]
 v_exp_f32 v20, v66
M v[68:71], a[64:67], a[32:35], v[68:71]
 s_waitcnt lgkmcnt(0)
 v_exp_f32 v21, v67
M v[72:75], a[96:99], a[0:3], v[32:35]
 ds_read_b128 a[64:67], v2 offset:49152
 v_add_f32 v26, v18, v19
M v[72:75], a[100:103], a[4:7], v[72:75]
 ds_read_b128 a[68:71], v2 offset:50176
 v_cvt_pk_bf16_f32 v40, v18, v19
M v[72:75], a[104:107], a[8:11], v[72:75]
 buffer_load_dwordx4 v3, s[8:11], s24 offen offset:3072 sc1 lds
M v[72:75], a[108:111], a[12:15], v[72:75]
 ds_read_b128 a[72:75], v2 offset:51200
 v_add_f32 v26, v20, v26
M v[72:75], a[112:115], a[16:19], v[72:75]
 s_add_u32 m0, s28, 69632
 ds_read_b128 a[76:79], v2 offset:52224
 v_cvt_pk_bf16_f32 v41, v20, v21
M v[72:75], a[116:119], a[20:23], v[72:75]
 buffer_load_dwordx4 v4, s[8:11], s24 offen offset:0 sc1 lds
M v[72:75], a[120:123], a[24:27], v[72:75]
 ds_read_b128 a[80:83], v2 offset:53248
 v_add_f32 v26, v21, v26
M v[72:75], a[124:127], a[28:31], v[72:75]
 ds_read_b128 a[84:87], v2 offset:54272
M v[76:79], a[124:127], a[60:63], v[36:39]
 v_exp_f32 v22, v68
M v[76:79], a[120:123], a[56:59], v[76:79]
 ds_read_b128 a[88:91], v2 offset:55296
M v[76:79], a[116:119], a[52:55], v[76:79]
 ds_read_b128 a[92:95], v2 offset:56320
M v[76:79], a[112:115], a[48:51], v[76:79]
 buffer_load_dwordx4 v4, s[8:11], s24 offen offset:1024 sc1 lds
M v[76:79], a[108:111], a[44:47], v[76:79]
 v_exp_f32 v23, v69
M v[76:79], a[104:107], a[40:43], v[76:79]
 v_exp_f32 v24, v70
M v[76:79], a[100:103], a[36:39], v[76:79]
 buffer_load_dwordx4 v4, s[8:11], s24 offen offset:2048 sc1 lds
M v[76:79], a[96:99], a[32:35], v[76:79]
 s_waitcnt lgkmcnt(0)
 v_exp_f32 v25, v71
M v[80:83], a[64:67], a[0:3], v[32:35]
 ds_read_b128 a[96:99], v2 offset:57344
 v_add_f32 v27, v22, v23
M v[80:83], a[68:71], a[4:7], v[80:83]
 ds_read_b128 a[100:103], v2 offset:58368
 v_cvt_pk_bf16_f32 v44, v22, v23
M v[80:83], a[72:75], a[8:11], v[80:83]
 v_exp_f32 v18, v72
M v[80:83], a[76:79], a[12:15], v[80:83]
 ds_read_b128 a[104:107], v2 offset:59392
 v_add_f32 v27, v24, v27
M v[80:83], a[80:83], a[16:19], v[80:83]
 ds_read_b128 a[108:111], v2 offset:60416
 v_cvt_pk_bf16_f32 v45, v24, v25
M v[80:83], a[84:87], a[20:23], v[80:83]
 buffer_load_dwordx4 v4, s[8:11], s24 offen offset:3072 sc1 lds
M v[80:83], a[88:91], a[24:27], v[80:83]
 ds_read_b128 a[112:115], v2 offset:61440
 v_add_f32 v27, v25, v27
M v[80:83], a[92:95], a[28:31], v[80:83]
 ds_read_b128 a[116:119], v2 offset:62464
M v[84:87], a[92:95], a[60:63], v[36:39]
 v_exp_f32 v19, v73
M v[84:87], a[88:91], a[56:59], v[84:87]
 ds_read_b128 a[120:123], v2 offset:63488
 v_add_f32 v26, v18, v26
M v[84:87], a[84:87], a[52:55], v[84:87]
 ds_read_b128 a[124:127], v2 offset:64512
 v_cvt_pk_bf16_f32 v42, v18, v19
M v[84:87], a[80:83], a[48:51], v[84:87]
 v_exp_f32 v20, v74
M v[84:87], a[76:79], a[44:47], v[84:87]
 v_exp_f32 v21, v75
M v[84:87], a[72:75], a[40:43], v[84:87]
 v_exp_f32 v22, v76
M v[84:87], a[68:71], a[36:39], v[84:87]
 s_waitcnt vmcnt(8) lgkmcnt(0)
 v_exp_f32 v23, v77
M v[84:87], a[64:67], a[32:35], v[84:87]
 s_barrier
M v[88:91], a[96:99], a[0:3], v[32:35]
 ds_read_b128 a[64:67], v7 offset:32768
 v_add_f32 v26, v19, v26
M v[88:91], a[100:103], a[4:7], v[88:91]
 ds_read_b128 a[68:71], v7 offset:33792
 v_add_f32 v26, v20, v26
M v[88:91], a[104:107], a[8:11], v[88:91]
 buffer_store_dword v17, v1, s[8:11], s45 offen sc1
M v[88:91], a[108:111], a[12:15], v[88:91]
 ds_read_b128 a[72:75], v7 offset:34816
 v_cvt_pk_bf16_f32 v43, v20, v21
M v[88:91], a[112:115], a[16:19], v[88:91]
 ds_read_b128 a[76:79], v7 offset:35840
 v_add_f32 v26, v21, v26
M v[88:91], a[116:119], a[20:23], v[88:91]
 v_exp_f32 v24, v78
M v[88:91], a[120:123], a[24:27], v[88:91]
 ds_read_b128 a[80:83], v7 offset:36864
 v_add_f32 v27, v22, v27
M v[88:91], a[124:127], a[28:31], v[88:91]
 ds_read_b128 a[84:87], v7 offset:37888
 v_cvt_pk_bf16_f32 v46, v22, v23
M v[92:95], a[124:127], a[60:63], v[36:39]
 v_exp_f32 v25, v79
M v[92:95], a[120:123], a[56:59], v[92:95]
 ds_read_b128 a[88:91], v7 offset:38912
 v_add_f32 v27, v23, v27
M v[92:95], a[116:119], a[52:55], v[92:95]
 ds_read_b128 a[92:95], v7 offset:39936
 v_add_f32 v27, v24, v27
M v[92:95], a[112:115], a[48:51], v[92:95]
 v_cvt_pk_bf16_f32 v47, v24, v25
 v_add_f32 v27, v25, v27
M v[92:95], a[108:111], a[44:47], v[92:95]
M v[92:95], a[104:107], a[40:43], v[92:95]
M v[92:95], a[100:103], a[36:39], v[92:95]
 s_waitcnt lgkmcnt(0)
M v[92:95], a[96:99], a[32:35], v[92:95]
 s_cmp_eq_u32 s42, 0
 s_cbranch_scc1 L_j0
M v[96:99], a[64:67], a[0:3], v[32:35]
 s_add_u32 m0, s28, 98304
 ds_read_b128 a[96:99], v7 offset:40960
M v[96:99], a[68:71], a[4:7], v[96:99]
 ds_read_b128 a[100:103], v7 offset:41984
M v[96:99], a[72:75], a[8:11], v[96:99]
 buffer_load_dwordx4 v3, s[8:11], s21 offen offset:0 sc1 lds
M v[96:99], a[76:79], a[12:15], v[96:99]
 s_cmp_eq_u32 s20, 0
 ds_read_b128 a[104:107], v7 offset:43008
M v[96:99], a[80:83], a[16:19], v[96:99]
 s_cselect_b64 s[64:65], s[16:17], 0
 ds_read_b128 a[108:111], v7 offset:44032
M v[96:99], a[84:87], a[20:23], v[96:99]
 buffer_load_dwordx4 v3, s[8:11], s21 offen offset:1024 sc1 lds
M v[96:99], a[88:91], a[24:27], v[96:99]
 s_cselect_b64 s[66:67], s[18:19], 0
 ds_read_b128 a[112:115], v7 offset:45056
M v[96:99], a[92:95], a[28:31], v[96:99]
 s_cselect_b64 s[68:69], s[48:49], 0
 ds_read_b128 a[116:119], v7 offset:46080
M v[100:103], a[92:95], a[60:63], v[36:39]
 s_cselect_b64 s[70:71], s[50:51], 0
 v_exp_f32 v18, v80
M v[100:103], a[88:91], a[56:59], v[100:103]
 s_cmp_lt_u32 s20, 1
 ds_read_b128 a[120:123], v7 offset:47104
M v[100:103], a[84:87], a[52:55], v[100:103]
 s_cselect_b64 s[78:79], -1, 0
 ds_read_b128 a[124:127], v7 offset:48128
M v[100:103], a[80:83], a[48:51], v[100:103]
 buffer_load_dwordx4 v3, s[8:11], s21 offen offset:2048 sc1 lds
M v[100:103], a[76:79], a[44:47], v[100:103]
 s_cmp_eq_u32 s20, 1
 v_exp_f32 v19, v81
M v[100:103], a[72:75], a[40:43], v[100:103]
 s_cselect_b64 s[72:73], s[16:17], s[78:79]
 v_exp_f32 v20, v82
M v[100:103], a[68:71], a[36:39], v[100:103]
 s_cselect_b64 s[74:75], s[18:19], s[78:79]
 v_exp_f32 v21, v83
M v[100:103], a[64:67], a[32:35], v[100:103]
 s_waitcnt lgkmcnt(0)
 v_exp_f32 v22, v88
M v[104:107], a[96:99], a[0:3], v[32:35]
 s_cselect_b64 s[76:77], s[48:49], s[78:79]
 ds_read_b128 a[64:67], v7 offset:49152
 v_add_f32 v26, v18, v26
M v[104:107], a[100:103], a[4:7], v[104:107]
 s_cselect_b64 s[78:79], s[50:51], s[78:79]
 ds_read_b128 a[68:71], v7 offset:50176
 v_cvt_pk_bf16_f32 v56, v18, v19
M v[104:107], a[104:107], a[8:11], v[104:107]
 buffer_load_dwordx4 v3, s[8:11], s21 offen offset:3072 sc1 lds
M v[104:107], a[108:111], a[12:15], v[104:107]
 s_add_u32 m0, s28, 102400
 ds_read_b128 a[72:75], v7 offset:51200
 v_add_f32 v26, v19, v26
M v[104:107], a[112:115], a[16:19], v[104:107]
 s_cmp_lt_u32 s20, 2
 ds_read_b128 a[76:79], v7 offset:52224
 v_add_f32 v26, v20, v26
M v[104:107], a[116:119], a[20:23], v[104:107]
 buffer_load_dwordx4 v4, s[8:11], s21 offen offset:0 sc1 lds
M v[104:107], a[120:123], a[24:27], v[104:107]
 s_cselect_b64 s[86:87], -1, 0
 ds_read_b128 a[80:83], v7 offset:53248
 v_cvt_pk_bf16_f32 v57, v20, v21
M v[104:107], a[124:127], a[28:31], v[104:107]
 s_cmp_eq_u32 s20, 2
 ds_read_b128 a[84:87], v7 offset:54272
 v_add_f32 v26, v21, v26
M v[108:111], a[124:127], a[60:63], v[36:39]
 s_cselect_b64 s[80:81], s[16:17], s[86:87]
 v_exp_f32 v23, v89
M v[108:111], a[120:123], a[56:59], v[108:111]
 s_cselect_b64 s[82:83], s[18:19], s[86:87]
 ds_read_b128 a[88:91], v7 offset:55296
 v_add_f32 v26, v22, v26
M v[108:111], a[116:119], a[52:55], v[108:111]
 s_cselect_b64 s[84:85], s[48:49], s[86:87]
 ds_read_b128 a[92:95], v7 offset:56320
 v_cvt_pk_bf16_f32 v58, v22, v23
M v[108:111], a[112:115], a[48:51], v[108:111]
 buffer_load_dwordx4 v4, s[8:11], s21 offen offset:1024 sc1 lds
M v[108:111], a[108:111], a[44:47], v[108:111]
 s_cselect_b64 s[86:87], s[50:51], s[86:87]
 v_exp_f32 v24, v90
M v[108:111], a[104:107], a[40:43], v[108:111]
 s_cmp_eq_u32 s20, 3
 v_exp_f32 v25, v91
M v[108:111], a[100:103], a[36:39], v[108:111]
 buffer_load_dwordx4 v4, s[8:11], s21 offen offset:2048 sc1 lds
M v[108:111], a[96:99], a[32:35], v[108:111]
 s_waitcnt lgkmcnt(0)
 v_exp_f32 v18, v84
M v[112:115], a[64:67], a[0:3], v[32:35]
 s_cselect_b64 s[88:89], s[16:17], -1
 ds_read_b128 a[96:99], v7 offset:57344
 v_add_f32 v26, v23, v26
M v[112:115], a[68:71], a[4:7], v[112:115]
 s_cselect_b64 s[90:91], s[18:19], -1
 ds_read_b128 a[100:103], v7 offset:58368
 v_add_f32 v26, v24, v26
M v[112:115], a[72:75], a[8:11], v[112:115]
 s_cselect_b64 s[92:93], s[48:49], -1
 v_exp_f32 v19, v85
M v[112:115], a[76:79], a[12:15], v[112:115]
 s_cselect_b64 s[94:95], s[50:51], -1
 ds_read_b128 a[104:107], v7 offset:59392
 v_cvt_pk_bf16_f32 v59, v24, v25
M v[112:115], a[80:83], a[16:19], v[112:115]
 ds_read_b128 a[108:111], v7 offset:60416
 v_add_f32 v26, v25, v26
M v[112:115], a[84:87], a[20:23], v[112:115]
 buffer_load_dwordx4 v4, s[8:11], s21 offen offset:3072 sc1 lds
M v[112:115], a[88:91], a[24:27], v[112:115]
 s_add_u32 s24, s23, 16777216
 ds_read_b128 a[112:115], v7 offset:61440
 v_add_f32 v27, v18, v27
M v[112:115], a[92:95], a[28:31], v[112:115]
 s_mov_b32 s23, s21
 ds_read_b128 a[116:119], v7 offset:62464
 v_cvt_pk_bf16_f32 v60, v18, v19
M v[116:119], a[92:95], a[60:63], v[36:39]
 s_add_u32 s21, s21, 32768
 v_exp_f32 v20, v86
M v[116:119], a[88:91], a[56:59], v[116:119]
 s_add_u32 s22, s22, 1
 ds_read_b128 a[120:123], v7 offset:63488
 v_add_f32 v27, v19, v27
M v[116:119], a[84:87], a[52:55], v[116:119]
 s_cmp_eq_u32 s22, s25
 ds_read_b128 a[124:127], v7 offset:64512
M v[116:119], a[80:83], a[48:51], v[116:119]
 s_cselect_b32 s21, s26, s21
 v_exp_f32 v21, v87
M v[116:119], a[76:79], a[44:47], v[116:119]
 s_cmp_eq_u32 s22, s43
 v_exp_f32 v22, v92
M v[116:119], a[72:75], a[40:43], v[116:119]
 s_cselect_b32 s21, s4, s21
 v_exp_f32 v23, v93
M v[116:119], a[68:71], a[36:39], v[116:119]
 s_waitcnt vmcnt(9) lgkmcnt(0)
 v_add_f32 v27, v20, v27
 v_cvt_pk_bf16_f32 v61, v20, v21
M v[116:119], a[64:67], a[32:35], v[116:119]
 s_barrier
M v[120:123], a[96:99], a[0:3], v[32:35]
 s_cmp_eq_u32 s22, s6
 ds_read_b128 a[64:67], v2 offset:0
 v_add_f32 v27, v21, v27
M v[120:123], a[100:103], a[4:7], v[120:123]
 s_cselect_b32 s21, s7, s21
 ds_read_b128 a[68:71], v2 offset:1024
 v_add_f32 v27, v22, v27
M v[120:123], a[104:107], a[8:11], v[120:123]
 v_exp_f32 v24, v94
M v[120:123], a[108:111], a[12:15], v[120:123]
 ds_read_b128 a[72:75], v2 offset:2048
 v_cvt_pk_bf16_f32 v62, v22, v23
M v[120:123], a[112:115], a[16:19], v[120:123]
 ds_read_b128 a[76:79], v2 offset:3072
 v_add_f32 v27, v23, v27
M v[120:123], a[116:119], a[20:23], v[120:123]
 v_exp_f32 v25, v95
M v[120:123], a[120:123], a[24:27], v[120:123]
 ds_read_b128 a[80:83], v2 offset:4096
 v_add_f32 v27, v24, v27
M v[120:123], a[124:127], a[28:31], v[120:123]
 ds_read_b128 a[84:87], v2 offset:5120
 v_cvt_pk_bf16_f32 v63, v24, v25
M v[124:127], a[124:127], a[60:63], v[36:39]
 v_add_f32 v27, v25, v27
M v[124:127], a[120:123], a[56:59], v[124:127]
 ds_read_b128 a[88:91], v2 offset:6144
 v_max_f32 v10, v26, v27
M v[124:127], a[116:119], a[52:55], v[124:127]
 ds_read_b128 a[92:95], v2 offset:7168
 v_min_f32 v11, v26, v27
M v[124:127], a[112:115], a[48:51], v[124:127]
 v_cmp_lt_f32 s[36:37], s31, v10
M v[124:127], a[108:111], a[44:47], v[124:127]
 v_cmp_gt_f32 vcc, s55, v11
M v[124:127], a[104:107], a[40:43], v[124:127]
M v[124:127], a[100:103], a[36:39], v[124:127]
 s_waitcnt lgkmcnt(0)
 s_or_b64 vcc, vcc, s[36:37]
M v[124:127], a[96:99], a[32:35], v[124:127]
 s_cbranch_vccnz L_st10
L_rt10:
M v[128:131], a[64:67], v[40:43], 0
 s_add_u32 m0, s28, 0
 ds_read_b128 a[96:99], v2 offset:8192
 ds_read_b128 a[100:103], v2 offset:9216
M v[128:131], a[68:71], v[56:59], v[128:131]
 buffer_load_dwordx4 v3, s[8:11], s24 offen offset:0 sc1 lds
M v[132:135], a[68:71], v[60:63], 0
 v_exp_f32 v18, v96
M v[132:135], a[64:67], v[44:47], v[132:135]
 ds_read_b128 a[104:107], v2 offset:10240
 ds_read_b128 a[108:111], v2 offset:11264
M v[136:139], a[72:75], v[40:43], 0
 buffer_load_dwordx4 v3, s[8:11], s24 offen offset:1024 sc1 lds
M v[136:139], a[76:79], v[56:59], v[136:139]
 v_exp_f32 v19, v97
M v[140:143], a[76:79], v[60:63], 0
 ds_read_b128 a[112:115], v2 offset:12288
 ds_read_b128 a[116:119], v2 offset:13312
M v[140:143], a[72:75], v[44:47], v[140:143]
 buffer_load_dwordx4 v3, s[8:11], s24 offen offset:2048 sc1 lds
M v[144:147], a[80:83], v[40:43], 0
 v_exp_f32 v20, v98
M v[144:147], a[84:87], v[56:59], v[144:147]
 ds_read_b128 a[120:123], v2 offset:14336
 ds_read_b128 a[124:127], v2 offset:15360
M v[148:151], a[84:87], v[60:63], 0
 buffer_load_dwordx4 v3, s[8:11], s24 offen offset:3072 sc1 lds
M v[148:151], a[80:83], v[44:47], v[148:151]
 s_add_u32 m0, s28, 4096
 v_exp_f32 v21, v99
M v[152:155], a[88:91], v[40:43], 0
 buffer_load_dwordx4 v4, s[8:11], s24 offen offset:0 sc1 lds
M v[152:155], a[92:95], v[56:59], v[152:155]
 v_add_f32 v30, v26, v30
 v_add_f32 v31, v27, v31
M v[156:159], a[92:95], v[60:63], 0
 v_exp_f32 v22, v104
M v[156:159], a[88:91], v[44:47], v[156:159]
 s_waitcnt lgkmcnt(0)
 v_add_f32 v28, v18, v19
 v_cvt_pk_bf16_f32 v48, v18, v19
M v[160:163], a[96:99], v[40:43], 0
 ds_read_b128 a[64:67], v2 offset:16384
 ds_read_b128 a[68:71], v2 offset:17408
M v[160:163], a[100:103], v[56:59], v[160:163]
 buffer_load_dwordx4 v4, s[8:11], s24 offen offset:1024 sc1 lds
M v[164:167], a[100:103], v[60:63], 0
 v_exp_f32 v23, v105
M v[164:167], a[96:99], v[44:47], v[164:167]
 ds_read_b128 a[72:75], v2 offset:18432
 ds_read_b128 a[76:79], v2 offset:19456
M v[168:171], a[104:107], v[40:43], 0
 buffer_load_dwordx4 v4, s[8:11], s24 offen offset:2048 sc1 lds
M v[168:171], a[108:111], v[56:59], v[168:171]
 v_add_f32 v28, v20, v28
 v_cvt_pk_bf16_f32 v49, v20, v21
M v[172:175], a[108:111], v[60:63], 0
 ds_read_b128 a[80:83], v2 offset:20480
 ds_read_b128 a[84:87], v2 offset:21504
M v[172:175], a[104:107], v[44:47], v[172:175]
 buffer_load_dwordx4 v4, s[8:11], s24 offen offset:3072 sc1 lds
M v[176:179], a[112:115], v[40:43], 0
 v_exp_f32 v24, v106
M v[176:179], a[116:119], v[56:59], v[176:179]
 s_add_u32 m0, s28, 32768
 ds_read_b128 a[88:91], v2 offset:22528
 ds_read_b128 a[92:95], v2 offset:23552
M v[180:183], a[116:119], v[60:63], 0
 buffer_load_dwordx4 v3, s[8:11], s21 offen offset:0 sc1 lds
M v[180:183], a[112:115], v[44:47], v[180:183]
 v_exp_f32 v25, v107
M v[184:187], a[120:123], v[40:43], 0
 buffer_load_dwordx4 v3, s[8:11], s21 offen offset:1024 sc1 lds
M v[184:187], a[124:127], v[56:59], v[184:187]
 v_exp_f32 v18, v100
M v[188:191], a[124:127], v[60:63], 0
 buffer_load_dwordx4 v3, s[8:11], s21 offen offset:2048 sc1 lds
M v[188:191], a[120:123], v[44:47], v[188:191]
 s_waitcnt lgkmcnt(0)
 v_add_f32 v28, v21, v28
 v_add_f32 v28, v22, v28
M v[192:195], a[64:67], v[40:43], 0
 ds_read_b128 a[96:99], v2 offset:24576
 ds_read_b128 a[100:103], v2 offset:25600
M v[192:195], a[68:71], v[56:59], v[192:195]
 buffer_load_dwordx4 v3, s[8:11], s21 offen offset:3072 sc1 lds
M v[196:199], a[68:71], v[60:63], 0
 v_exp_f32 v19, v101
M v[196:199], a[64:67], v[44:47], v[196:199]
 s_add_u32 m0, s28, 36864
 ds_read_b128 a[104:107], v2 offset:26624
 ds_read_b128 a[108:111], v2 offset:27648
M v[200:203], a[72:75], v[40:43], 0
 buffer_load_dwordx4 v4, s[8:11], s21 offen offset:0 sc1 lds
M v[200:203], a[76:79], v[56:59], v[200:203]
 v_exp_f32 v20, v102
M v[204:207], a[76:79], v[60:63], 0
 ds_read_b128 a[112:115], v2 offset:28672
 ds_read_b128 a[116:119], v2 offset:29696
M v[204:207], a[72:75], v[44:47], v[204:207]
 buffer_load_dwordx4 v4, s[8:11], s21 offen offset:1024 sc1 lds
M v[208:211], a[80:83], v[40:43], 0
 v_exp_f32 v21, v103
M v[208:211], a[84:87], v[56:59], v[208:211]
 ds_read_b128 a[120:123], v2 offset:30720
 ds_read_b128 a[124:127], v2 offset:31744
M v[212:215], a[84:87], v[60:63], 0
 buffer_load_dwordx4 v4, s[8:11], s21 offen offset:2048 sc1 lds
M v[212:215], a[80:83], v[44:47], v[212:215]
 v_cvt_pk_bf16_f32 v50, v22, v23
 v_add_f32 v28, v23, v28
M v[216:219], a[88:91], v[40:43], 0
 v_exp_f32 v22, v108
M v[216:219], a[92:95], v[56:59], v[216:219]
 buffer_load_dwordx4 v4, s[8:11], s21 offen offset:3072 sc1 lds
M v[220:223], a[92:95], v[60:63], 0
 s_waitcnt vmcnt(16) lgkmcnt(0)
 s_add_u32 s24, s23, 16777216
 s_mov_b32 s23, s21
M v[220:223], a[88:91], v[44:47], v[220:223]
 s_barrier
M v[224:227], a[96:99], v[40:43], 0
 ds_read_b128 a[64:67], v2 offset:32768
 ds_read_b128 a[68:71], v2 offset:33792
M v[224:227], a[100:103], v[56:59], v[224:227]
 s_add_u32 s21, s21, 32768
 v_add_f32 v28, v24, v28
M v[228:231], a[100:103], v[60:63], 0
 s_add_u32 s22, s22, 1
 v_exp_f32 v23, v109
M v[228:231], a[96:99], v[44:47], v[228:231]
 s_cmp_eq_u32 s22, s25
 ds_read_b128 a[72:75], v2 offset:34816
 ds_read_b128 a[76:79], v2 offset:35840
M v[232:235], a[104:107], v[40:43], 0
 s_cselect_b32 s21, s26, s21
 v_cvt_pk_bf16_f32 v51, v24, v25
 v_add_f32 v28, v25, v28
M v[232:235], a[108:111], v[56:59], v[232:235]
 s_cmp_eq_u32 s22, s43
 v_exp_f32 v24, v110
M v[236:239], a[108:111], v[60:63], 0
 s_cselect_b32 s21, s4, s21
 ds_read_b128 a[80:83], v2 offset:36864
 ds_read_b128 a[84:87], v2 offset:37888
M v[236:239], a[104:107], v[44:47], v[236:239]
 s_cmp_eq_u32 s22, s6
 v_exp_f32 v25, v111
M v[240:243], a[112:115], v[40:43], 0
 s_cselect_b32 s21, s7, s21
 v_add_f32 v29, v18, v19
 v_cvt_pk_bf16_f32 v52, v18, v19
M v[240:243], a[116:119], v[56:59], v[240:243]
 ds_read_b128 a[88:91], v2 offset:38912
 ds_read_b128 a[92:95], v2 offset:39936
M v[244:247], a[116:119], v[60:63], 0
 v_add_f32 v29, v20, v29
 v_cvt_pk_bf16_f32 v53, v20, v21
M v[244:247], a[112:115], v[44:47], v[244:247]
 v_add_f32 v29, v21, v29
 v_add_f32 v29, v22, v29
M v[248:251], a[120:123], v[40:43], 0
 v_cvt_pk_bf16_f32 v54, v22, v23
 v_add_f32 v29, v23, v29
M v[248:251], a[124:127], v[56:59], v[248:251]
 s_cmp_lg_u32 s27, 0
 v_add_f32 v29, v24, v29
 v_cvt_pk_bf16_f32 v55, v24, v25
M v[252:255], a[124:127], v[60:63], 0
 s_waitcnt lgkmcnt(0)
 v_add_f32 v29, v25, v29
M v[252:255], a[120:123], v[44:47], v[252:255]
 s_cbranch_scc1 L_loop_top
 s_branch L_p1
L_j0:
 s_cmp_eq_u32 s20, 0
 s_cselect_b64 s[64:65], s[16:17], 0
 s_cselect_b64 s[66:67], s[18:19], 0
 s_cselect_b64 s[68:69], s[48:49], 0
 s_cselect_b64 s[70:71], s[50:51], 0
 s_cmp_lt_u32 s20, 1
 s_cselect_b64 s[78:79], -1, 0
 s_cmp_eq_u32 s20, 1
 s_cselect_b64 s[72:73], s[16:17], s[78:79]
 s_cselect_b64 s[74:75], s[18:19], s[78:79]
 s_cselect_b64 s[76:77], s[48:49], s[78:79]
 s_cselect_b64 s[78:79], s[50:51], s[78:79]
 s_cmp_lt_u32 s20, 2
 s_cselect_b64 s[86:87], -1, 0
 s_cmp_eq_u32 s20, 2
 s_cselect_b64 s[80:81], s[16:17], s[86:87]
 s_cselect_b64 s[82:83], s[18:19], s[86:87]
 s_cselect_b64 s[84:85], s[48:49], s[86:87]
 s_cselect_b64 s[86:87], s[50:51], s[86:87]
 s_cmp_eq_u32 s20, 3
 s_cselect_b64 s[88:89], s[16:17], -1
 s_cselect_b64 s[90:91], s[18:19], -1
 s_cselect_b64 s[92:93], s[48:49], -1
 s_cselect_b64 s[94:95], s[50:51], -1
 v_mov_b32 v56, 0
 v_mov_b32 v57, 0
 v_mov_b32 v58, 0
 v_mov_b32 v59, 0
 v_accvgpr_write_b32 a242, 0
 v_accvgpr_write_b32 a243, 0
 v_cndmask_b32 v64, v64, v8, s[64:65]
 v_cndmask_b32 v65, v65, v8, s[66:67]
 v_cndmask_b32 v66, v66, v8, s[68:69]
 v_cndmask_b32 v67, v67, v8, s[70:71]
 v_cndmask_b32 v72, v72, v8, s[72:73]
 v_cndmask_b32 v73, v73, v8, s[74:75]
 v_cndmask_b32 v74, v74, v8, s[76:77]
 v_cndmask_b32 v75, v75, v8, s[78:79]
 v_cndmask_b32 v80, v80, v8, s[80:81]
 v_cndmask_b32 v81, v81, v8, s[82:83]
 v_cndmask_b32 v82, v82, v8, s[84:85]
 v_cndmask_b32 v83, v83, v8, s[86:87]
 v_cndmask_b32 v88, v88, v8, s[88:89]
 v_cndmask_b32 v89, v89, v8, s[90:91]
 v_cndmask_b32 v90, v90, v8, s[92:93]
 v_cndmask_b32 v91, v91, v8, s[94:95]
 s_cmp_eq_u32 s20, 3
 s_cselect_b64 s[64:65], s[16:17], 0
 s_cselect_b64 s[66:67], s[18:19], 0
 s_cselect_b64 s[68:69], s[48:49], 0
 s_cselect_b64 s[70:71], s[50:51], 0
 s_cmp_gt_u32 s20, 2
 s_cselect_b64 s[78:79], -1, 0
 s_cmp_eq_u32 s20, 2
 s_cselect_b64 s[72:73], s[16:17], s[78:79]
 s_cselect_b64 s[74:75], s[18:19], s[78:79]
 s_cselect_b64 s[76:77], s[48:49], s[78:79]
 s_cselect_b64 s[78:79], s[50:51], s[78:79]
 s_cmp_gt_u32 s20, 1
 s_cselect_b64 s[86:87], -1, 0
 s_cmp_eq_u32 s20, 1
 s_cselect_b64 s[80:81], s[16:17], s[86:87]
 s_cselect_b64 s[82:83], s[18:19], s[86:87]
 s_cselect_b64 s[84:85], s[48:49], s[86:87]
 s_cselect_b64 s[86:87], s[50:51], s[86:87]
 s_cmp_eq_u32 s20, 0
 s_cselect_b64 s[88:89], s[16:17], -1
 s_cselect_b64 s[90:91], s[18:19], -1
 s_cselect_b64 s[92:93], s[48:49], -1
 s_cselect_b64 s[94:95], s[50:51], -1
 s_add_u32 m0, s28, 98304
 v_max3_f32 v10, v64, v65, v66
 buffer_load_dwordx4 v3, s[8:11], s21 offen offset:0 sc1 lds
 v_max3_f32 v10, v67, v72, v10
 v_max3_f32 v10, v73, v74, v10
 v_max3_f32 v10, v75, v80, v10
 v_max3_f32 v10, v81, v82, v10
 v_max3_f32 v10, v83, v88, v10
 v_max3_f32 v10, v89, v90, v10
 v_max_f32 v10, v91, v10
 v_max3_f32 v11, v68, v69, v70
 v_max3_f32 v11, v71, v76, v11
 v_max3_f32 v11, v77, v78, v11
 v_max3_f32 v11, v79, v84, v11
 v_mfma_f32_32x32x16_bf16 v[128:143], v[56:59], v[56:59], 0
 buffer_load_dwordx4 v3, s[8:11], s21 offen offset:1024 sc1 lds
 v_max3_f32 v11, v85, v86, v11
 v_max3_f32 v11, v87, v92, v11
 v_max3_f32 v11, v93, v94, v11
 v_max_f32 v11, v95, v11
 v_mov_b32 v12, v10
 v_mov_b32 v13, v11
 s_nop 0
 v_permlane16_swap_b32 v12, v10
 v_permlane16_swap_b32 v13, v11
 v_max_f32 v10, v12, v10
 v_max_f32 v11, v13, v11
 v_mov_b32 v12, v10
 buffer_load_dwordx4 v3, s[8:11], s21 offen offset:2048 sc1 lds
 v_mov_b32 v13, v11
 v_mfma_f32_32x32x16_bf16 v[144:159], v[56:59], v[56:59], 0
 v_permlane32_swap_b32 v12, v10
 v_permlane32_swap_b32 v13, v11
 v_max_f32 v10, v12, v10
 v_max_f32 v11, v13, v11
 v_ceil_f32 v10, v10
 v_ceil_f32 v11, v11
 v_sub_f32 v32, v32, v10
 v_sub_f32 v33, v33, v10
 v_sub_f32 v34, v34, v10
 v_sub_f32 v35, v35, v10
 buffer_load_dwordx4 v3, s[8:11], s21 offen offset:3072 sc1 lds
 v_sub_f32 v36, v36, v11
 v_sub_f32 v37, v37, v11
 v_sub_f32 v38, v38, v11
 v_mfma_f32_32x32x16_bf16 v[160:175], v[56:59], v[56:59], 0
 v_sub_f32 v39, v39, v11
 v_sub_f32 v64, v64, v10
 v_sub_f32 v65, v65, v10
 v_sub_f32 v66, v66, v10
 v_sub_f32 v67, v67, v10
 v_sub_f32 v68, v68, v11
 v_sub_f32 v69, v69, v11
 s_add_u32 m0, s28, 102400
 v_sub_f32 v70, v70, v11
 buffer_load_dwordx4 v4, s[8:11], s21 offen offset:0 sc1 lds
 v_sub_f32 v71, v71, v11
 v_sub_f32 v72, v72, v10
 v_sub_f32 v73, v73, v10
 v_sub_f32 v74, v74, v10
 v_mfma_f32_32x32x16_bf16 v[176:191], v[56:59], v[56:59], 0
 v_sub_f32 v75, v75, v10
 v_sub_f32 v76, v76, v11
 v_sub_f32 v77, v77, v11
 v_sub_f32 v78, v78, v11
 v_sub_f32 v79, v79, v11
 v_sub_f32 v80, v80, v10
 v_sub_f32 v81, v81, v10
 buffer_load_dwordx4 v4, s[8:11], s21 offen offset:1024 sc1 lds
 v_sub_f32 v82, v82, v10
 v_sub_f32 v83, v83, v10
 v_sub_f32 v84, v84, v11
 v_sub_f32 v85, v85, v11
 v_sub_f32 v86, v86, v11
 v_sub_f32 v87, v87, v11
 v_mfma_f32_32x32x16_bf16 v[192:207], v[56:59], v[56:59], 0
 v_sub_f32 v88, v88, v10
 v_sub_f32 v89, v89, v10
 v_sub_f32 v90, v90, v10
 v_sub_f32 v91, v91, v10
 v_sub_f32 v92, v92, v11
 buffer_load_dwordx4 v4, s[8:11], s21 offen offset:2048 sc1 lds
 v_sub_f32 v93, v93, v11
 v_sub_f32 v94, v94, v11
 v_sub_f32 v95, v95, v11
 v_exp_f32 v18, v64
 v_exp_f32 v19, v65
 v_exp_f32 v20, v66
 v_add_f32 v26, v18, v19
 v_cvt_pk_bf16_f32 v40, v18, v19
 v_mfma_f32_32x32x16_bf16 v[208:223], v[56:59], v[56:59], 0
 v_exp_f32 v21, v67
 v_exp_f32 v22, v72
 v_add_f32 v26, v20, v26
 buffer_load_dwordx4 v4, s[8:11], s21 offen offset:3072 sc1 lds
 v_cvt_pk_bf16_f32 v41, v20, v21
 v_exp_f32 v23, v73
 v_add_f32 v26, v21, v26
 v_exp_f32 v24, v74
 v_add_f32 v26, v22, v26
 v_cvt_pk_bf16_f32 v42, v22, v23
 v_exp_f32 v25, v75
 v_add_f32 v26, v23, v26
 v_exp_f32 v18, v68
 v_add_f32 v26, v24, v26
 v_mfma_f32_32x32x16_bf16 v[224:239], v[56:59], v[56:59], 0
 s_add_u32 s24, s23, 16777216
 s_mov_b32 s23, s21
 s_add_u32 s21, s21, 32768
 s_add_u32 s22, s22, 1
 s_cmp_eq_u32 s22, s25
 s_cselect_b32 s21, s26, s21
 s_cmp_eq_u32 s22, s43
 s_cselect_b32 s21, s4, s21
 s_cmp_eq_u32 s22, s6
 s_cselect_b32 s21, s7, s21
 v_cvt_pk_bf16_f32 v43, v24, v25
 buffer_load_dword v5, off, s[8:11], s47 sc1
 v_exp_f32 v19, v69
 v_add_f32 v26, v25, v26
 v_mfma_f32_32x32x16_bf16 v[240:255], v[56:59], v[56:59], 0
 v_exp_f32 v20, v70
 v_add_f32 v27, v18, v19
 v_cvt_pk_bf16_f32 v44, v18, v19
 v_exp_f32 v21, v71
 v_exp_f32 v22, v76
 v_add_f32 v27, v20, v27
 v_cvt_pk_bf16_f32 v45, v20, v21
 v_exp_f32 v23, v77
 v_add_f32 v27, v21, v27
 v_exp_f32 v24, v78
 v_add_f32 v27, v22, v27
 v_cvt_pk_bf16_f32 v46, v22, v23
 v_exp_f32 v25, v79
 v_add_f32 v27, v23, v27
 v_add_f32 v27, v24, v27
 v_cvt_pk_bf16_f32 v47, v24, v25
 v_add_f32 v27, v25, v27
 v_cndmask_b32 v100, v36, v8, s[64:65]
 v_cndmask_b32 v101, v36, v8, s[66:67]
 v_cndmask_b32 v102, v36, v8, s[68:69]
 v_cndmask_b32 v103, v36, v8, s[70:71]
 v_cndmask_b32 v108, v36, v8, s[72:73]
 v_cndmask_b32 v109, v36, v8, s[74:75]
 v_cndmask_b32 v110, v36, v8, s[76:77]
 v_cndmask_b32 v111, v36, v8, s[78:79]
 v_cndmask_b32 v116, v36, v8, s[80:81]
 v_cndmask_b32 v117, v36, v8, s[82:83]
 v_cndmask_b32 v118, v36, v8, s[84:85]
 v_cndmask_b32 v119, v36, v8, s[86:87]
 v_cndmask_b32 v124, v36, v8, s[88:89]
 v_cndmask_b32 v125, v36, v8, s[90:91]
 v_cndmask_b32 v126, v36, v8, s[92:93]
 v_cndmask_b32 v127, v36, v8, s[94:95]
 s_branch L_p2
L_kv1:
 s_mov_b32 s60, s90
 s_and_b32 s61, s91, 0xffff
 s_mov_b32 s62, 3670016
 s_mov_b32 s63, 0x20000
 s_waitcnt vmcnt(4) lgkmcnt(0)
 s_barrier
 ds_read_b128 a[160:163], v5 offset:0
 ds_read_b128 a[164:167], v6 offset:0
 ds_read_b64_tr_b16 a[32:33], v1 offset:0
 ds_read_b64_tr_b16 a[34:35], v1 offset:1024
 ds_read_b64_tr_b16 a[36:37], v1 offset:8192
 ds_read_b64_tr_b16 a[38:39], v1 offset:9216
 ds_read_b64_tr_b16 a[40:41], v2 offset:0
 ds_read_b64_tr_b16 a[42:43], v2 offset:1024
 ds_read_b64_tr_b16 a[44:45], v2 offset:8192
 ds_read_b64_tr_b16 a[46:47], v2 offset:9216
 ds_read_b128 a[168:171], v5 offset:2048
 ds_read_b128 a[172:175], v6 offset:2048
 ds_read_b64_tr_b16 a[48:49], v3 offset:0
 ds_read_b64_tr_b16 a[50:51], v3 offset:1024
 ds_read_b64_tr_b16 a[52:53], v3 offset:8192
 ds_read_b64_tr_b16 a[54:55], v3 offset:9216
 ds_read_b64_tr_b16 a[56:57], v4 offset:0
 ds_read_b64_tr_b16 a[58:59], v4 offset:1024
 ds_read_b64_tr_b16 a[60:61], v4 offset:8192
 ds_read_b64_tr_b16 a[62:63], v4 offset:9216
 ds_read_b128 a[176:179], v5 offset:4096
 ds_read_b128 a[180:183], v6 offset:4096
 ds_read_b128 a[184:187], v5 offset:6144
 ds_read_b128 a[188:191], v6 offset:6144
 s_add_u32 m0, s24, 16384
 s_nop 0
 buffer_load_dwordx4 v12, s[48:51], s22 offen offset:0   lds
 buffer_load_dwordx4 v13, s[48:51], s22 offen offset:1024   lds
 buffer_load_dwordx4 v14, s[48:51], s22 offen offset:2048   lds
 buffer_load_dwordx4 v15, s[48:51], s22 offen offset:3072   lds
 s_sub_u32 s22, s22, 2097024
 s_add_u32 m0, s23, 32768
 s_nop 0
 buffer_load_dwordx4 v8, s[16:19], s21 offen offset:0  nt lds
 buffer_load_dwordx4 v9, s[16:19], s21 offen offset:1024  nt lds
 buffer_load_dwordx4 v10, s[16:19], s21 offen offset:2048  nt lds
 buffer_load_dwordx4 v11, s[16:19], s21 offen offset:3072  nt lds
 s_add_u32 s21, s21, 128
 s_waitcnt lgkmcnt(15)
M a[0:3], a[32:35], a[160:163], 0
M a[0:3], a[36:39], a[164:167], a[0:3]
 s_waitcnt lgkmcnt(14)
M a[4:7], a[44:47], a[164:167], 0
M a[4:7], a[40:43], a[160:163], a[4:7]
 s_waitcnt lgkmcnt(8)
M a[8:11], a[48:51], a[160:163], 0
M a[8:11], a[52:55], a[164:167], a[8:11]
 s_waitcnt lgkmcnt(4)
M a[12:15], a[60:63], a[164:167], 0
 s_add_u32 m0, s23, 49152
M a[12:15], a[56:59], a[160:163], a[12:15]
 buffer_load_dwordx4 v8, s[16:19], s21 offen offset:0  nt lds
M v[32:35], a[32:35], a[168:171], 0
 buffer_load_dwordx4 v9, s[16:19], s21 offen offset:1024  nt lds
M v[32:35], a[36:39], a[172:175], v[32:35]
M v[36:39], a[44:47], a[172:175], 0
 buffer_load_dwordx4 v10, s[16:19], s21 offen offset:2048  nt lds
M v[36:39], a[40:43], a[168:171], v[36:39]
M v[40:43], a[48:51], a[168:171], 0
 buffer_load_dwordx4 v11, s[16:19], s21 offen offset:3072  nt lds
M v[40:43], a[52:55], a[172:175], v[40:43]
 s_add_u32 s21, s21, 524160
M v[44:47], a[60:63], a[172:175], 0
 s_waitcnt vmcnt(12) lgkmcnt(0)
M v[44:47], a[56:59], a[168:171], v[44:47]
 s_barrier
M v[64:67], a[32:35], a[176:179], 0
 s_add_u32 m0, s24, 32768
 ds_read_b64_tr_b16 a[64:65], v1 offset:16384
 ds_read_b64_tr_b16 a[66:67], v1 offset:17408
M v[64:67], a[36:39], a[180:183], v[64:67]
 ds_read_b64_tr_b16 a[68:69], v1 offset:24576
 ds_read_b64_tr_b16 a[70:71], v1 offset:25600
M v[68:71], a[44:47], a[180:183], 0
 buffer_load_dwordx4 v12, s[48:51], s22 offen offset:0   lds
M v[68:71], a[40:43], a[176:179], v[68:71]
 ds_read_b64_tr_b16 a[72:73], v2 offset:16384
 ds_read_b64_tr_b16 a[74:75], v2 offset:17408
M v[72:75], a[48:51], a[176:179], 0
 ds_read_b64_tr_b16 a[76:77], v2 offset:24576
 ds_read_b64_tr_b16 a[78:79], v2 offset:25600
M v[72:75], a[52:55], a[180:183], v[72:75]
 buffer_load_dwordx4 v13, s[48:51], s22 offen offset:1024   lds
M v[76:79], a[60:63], a[180:183], 0
 ds_read_b64_tr_b16 a[80:81], v3 offset:16384
 ds_read_b64_tr_b16 a[82:83], v3 offset:17408
M v[76:79], a[56:59], a[176:179], v[76:79]
 ds_read_b64_tr_b16 a[84:85], v3 offset:24576
 ds_read_b64_tr_b16 a[86:87], v3 offset:25600
M v[96:99], a[32:35], a[184:187], 0
 buffer_load_dwordx4 v14, s[48:51], s22 offen offset:2048   lds
M v[96:99], a[36:39], a[188:191], v[96:99]
 ds_read_b64_tr_b16 a[88:89], v4 offset:16384
 ds_read_b64_tr_b16 a[90:91], v4 offset:17408
M v[100:103], a[44:47], a[188:191], 0
 ds_read_b64_tr_b16 a[92:93], v4 offset:24576
 ds_read_b64_tr_b16 a[94:95], v4 offset:25600
M v[100:103], a[40:43], a[184:187], v[100:103]
 buffer_load_dwordx4 v15, s[48:51], s22 offen offset:3072   lds
M v[104:107], a[48:51], a[184:187], 0
 s_add_u32 s22, s22, 2097152
 v_max3_f32 v20, |v32|, |v33|, |v34|
 v_max3_f32 v20, |v35|, |v36|, v20
M v[104:107], a[52:55], a[188:191], v[104:107]
 v_max3_f32 v20, |v37|, |v38|, v20
 v_max3_f32 v21, |v64|, |v65|, |v66|
M v[108:111], a[60:63], a[188:191], 0
 s_add_u32 m0, s23, 0
 v_max3_f32 v21, |v67|, |v68|, v21
 v_max3_f32 v21, |v69|, |v70|, v21
M v[108:111], a[56:59], a[184:187], v[108:111]
 s_waitcnt lgkmcnt(0)
 v_min_f32 v20, v20, v21
 v_mul_f32 v20, 0x41000000, v20
M a[16:19], a[64:67], a[160:163], 0
 buffer_load_dwordx4 v8, s[16:19], s21 offen offset:0  nt lds
M a[16:19], a[68:71], a[164:167], a[16:19]
 v_mov_b32 v21, v20
 v_mov_b32 v22, v20
M a[20:23], a[76:79], a[164:167], 0
 buffer_load_dwordx4 v9, s[16:19], s21 offen offset:1024  nt lds
M a[20:23], a[72:75], a[160:163], a[20:23]
 v_mov_b32 v23, v20
 v_accvgpr_write_b32 a241, v20
M a[24:27], a[80:83], a[160:163], 0
M a[24:27], a[84:87], a[164:167], a[24:27]
M a[28:31], a[92:95], a[164:167], 0
 buffer_load_dwordx4 v10, s[16:19], s21 offen offset:2048  nt lds
M a[28:31], a[88:91], a[160:163], a[28:31]
M v[48:51], a[64:67], a[168:171], v[20:23]
M v[48:51], a[68:71], a[172:175], v[48:51]
 buffer_load_dwordx4 v11, s[16:19], s21 offen offset:3072  nt lds
M v[52:55], a[76:79], a[172:175], v[20:23]
 s_add_u32 s21, s21, 128
M v[52:55], a[72:75], a[168:171], v[52:55]
M v[56:59], a[80:83], a[168:171], v[20:23]
M v[56:59], a[84:87], a[172:175], v[56:59]
M v[60:63], a[92:95], a[172:175], v[20:23]
 s_waitcnt vmcnt(12)
M v[60:63], a[88:91], a[168:171], v[60:63]
 s_barrier
M v[80:83], a[64:67], a[176:179], v[20:23]
 s_add_u32 m0, s24, 49152
 ds_read_b128 a[160:163], v5 offset:16384
 ds_read_b128 a[164:167], v6 offset:16384
M v[80:83], a[68:71], a[180:183], v[80:83]
 buffer_load_dwordx4 v12, s[48:51], s22 offen offset:0   lds
M v[84:87], a[76:79], a[180:183], v[20:23]
 ds_read_b64_tr_b16 a[96:97], v1 offset:32768
 ds_read_b64_tr_b16 a[98:99], v1 offset:33792
M v[84:87], a[72:75], a[176:179], v[84:87]
M v[88:91], a[80:83], a[176:179], v[20:23]
 buffer_load_dwordx4 v13, s[48:51], s22 offen offset:1024   lds
M v[88:91], a[84:87], a[180:183], v[88:91]
 ds_read_b64_tr_b16 a[100:101], v1 offset:40960
 ds_read_b64_tr_b16 a[102:103], v1 offset:41984
M v[92:95], a[92:95], a[180:183], v[20:23]
M v[92:95], a[88:91], a[176:179], v[92:95]
M v[112:115], a[64:67], a[184:187], v[20:23]
 ds_read_b64_tr_b16 a[104:105], v2 offset:32768
 ds_read_b64_tr_b16 a[106:107], v2 offset:33792
M v[112:115], a[68:71], a[188:191], v[112:115]
 buffer_load_dwordx4 v14, s[48:51], s22 offen offset:2048   lds
M v[116:119], a[76:79], a[188:191], v[20:23]
M v[116:119], a[72:75], a[184:187], v[116:119]
 ds_read_b64_tr_b16 a[108:109], v2 offset:40960
 ds_read_b64_tr_b16 a[110:111], v2 offset:41984
M v[120:123], a[80:83], a[184:187], v[20:23]
 buffer_load_dwordx4 v15, s[48:51], s22 offen offset:3072   lds
M v[120:123], a[84:87], a[188:191], v[120:123]
 s_waitcnt lgkmcnt(8)
M v[124:127], a[92:95], a[188:191], v[20:23]
 s_sub_u32 s22, s22, 2097024
M v[124:127], a[88:91], a[184:187], v[124:127]
 s_add_u32 m0, s23, 16384
 ds_read_b64_tr_b16 a[112:113], v3 offset:32768
 ds_read_b64_tr_b16 a[114:115], v3 offset:33792
M v[128:131], a[32:35], a[160:163], v[20:23]
 ds_read_b128 a[168:171], v5 offset:18432
 ds_read_b128 a[172:175], v6 offset:18432
M v[128:131], a[36:39], a[164:167], v[128:131]
 buffer_load_dwordx4 v8, s[16:19], s21 offen offset:0  nt lds
M v[132:135], a[44:47], a[164:167], v[20:23]
 ds_read_b64_tr_b16 a[116:117], v3 offset:40960
 ds_read_b64_tr_b16 a[118:119], v3 offset:41984
M v[132:135], a[40:43], a[160:163], v[132:135]
 buffer_load_dwordx4 v9, s[16:19], s21 offen offset:1024  nt lds
M v[136:139], a[48:51], a[160:163], v[20:23]
M v[136:139], a[52:55], a[164:167], v[136:139]
 ds_read_b64_tr_b16 a[120:121], v4 offset:32768
 ds_read_b64_tr_b16 a[122:123], v4 offset:33792
M v[140:143], a[60:63], a[164:167], v[20:23]
 buffer_load_dwordx4 v10, s[16:19], s21 offen offset:2048  nt lds
M v[140:143], a[56:59], a[160:163], v[140:143]
M v[144:147], a[64:67], a[160:163], v[20:23]
 ds_read_b64_tr_b16 a[124:125], v4 offset:40960
 ds_read_b64_tr_b16 a[126:127], v4 offset:41984
M v[144:147], a[68:71], a[164:167], v[144:147]
 buffer_load_dwordx4 v11, s[16:19], s21 offen offset:3072  nt lds
M v[148:151], a[76:79], a[164:167], v[20:23]
 s_add_u32 s21, s21, 524160
M v[148:151], a[72:75], a[160:163], v[148:151]
M v[152:155], a[80:83], a[160:163], v[20:23]
M v[152:155], a[84:87], a[164:167], v[152:155]
 s_waitcnt lgkmcnt(6)
M v[156:159], a[92:95], a[164:167], v[20:23]
 s_waitcnt vmcnt(16) lgkmcnt(0)
M v[156:159], a[88:91], a[160:163], v[156:159]
 s_barrier
M v[160:163], a[32:35], a[168:171], v[20:23]
 s_add_u32 m0, s24, 0
 ds_read_b128 a[160:163], v5 offset:20480
 ds_read_b128 a[164:167], v6 offset:20480
M v[160:163], a[36:39], a[172:175], v[160:163]
 buffer_load_dwordx4 v12, s[48:51], s22 offen offset:0   lds
M v[164:167], a[44:47], a[172:175], v[20:23]
 ds_read_b64_tr_b16 a[128:129], v1 offset:49152
 ds_read_b64_tr_b16 a[130:131], v1 offset:50176
M v[164:167], a[40:43], a[168:171], v[164:167]
M v[168:171], a[48:51], a[168:171], v[20:23]
 buffer_load_dwordx4 v13, s[48:51], s22 offen offset:1024   lds
M v[168:171], a[52:55], a[172:175], v[168:171]
 ds_read_b64_tr_b16 a[132:133], v1 offset:57344
 ds_read_b64_tr_b16 a[134:135], v1 offset:58368
M v[172:175], a[60:63], a[172:175], v[20:23]
M v[172:175], a[56:59], a[168:171], v[172:175]
M v[176:179], a[64:67], a[168:171], v[20:23]
 ds_read_b64_tr_b16 a[136:137], v2 offset:49152
 ds_read_b64_tr_b16 a[138:139], v2 offset:50176
M v[176:179], a[68:71], a[172:175], v[176:179]
 buffer_load_dwordx4 v14, s[48:51], s22 offen offset:2048   lds
M v[180:183], a[76:79], a[172:175], v[20:23]
M v[180:183], a[72:75], a[168:171], v[180:183]
 ds_read_b64_tr_b16 a[140:141], v2 offset:57344
 ds_read_b64_tr_b16 a[142:143], v2 offset:58368
M v[184:187], a[80:83], a[168:171], v[20:23]
 buffer_load_dwordx4 v15, s[48:51], s22 offen offset:3072   lds
M v[184:187], a[84:87], a[172:175], v[184:187]
 s_waitcnt lgkmcnt(8)
M v[188:191], a[92:95], a[172:175], v[20:23]
 s_add_u32 s22, s22, 2097152
M v[188:191], a[88:91], a[168:171], v[188:191]
 s_add_u32 m0, s23, 32768
 ds_read_b64_tr_b16 a[144:145], v3 offset:49152
 ds_read_b64_tr_b16 a[146:147], v3 offset:50176
M v[192:195], a[32:35], a[160:163], v[20:23]
 ds_read_b128 a[168:171], v5 offset:22528
 ds_read_b128 a[172:175], v6 offset:22528
M v[192:195], a[36:39], a[164:167], v[192:195]
 buffer_load_dwordx4 v8, s[16:19], s21 offen offset:0  nt lds
M v[196:199], a[44:47], a[164:167], v[20:23]
 ds_read_b64_tr_b16 a[148:149], v3 offset:57344
 ds_read_b64_tr_b16 a[150:151], v3 offset:58368
M v[196:199], a[40:43], a[160:163], v[196:199]
 buffer_load_dwordx4 v9, s[16:19], s21 offen offset:1024  nt lds
M v[200:203], a[48:51], a[160:163], v[20:23]
M v[200:203], a[52:55], a[164:167], v[200:203]
 ds_read_b64_tr_b16 a[152:153], v4 offset:49152
 ds_read_b64_tr_b16 a[154:155], v4 offset:50176
M v[204:207], a[60:63], a[164:167], v[20:23]
 buffer_load_dwordx4 v10, s[16:19], s21 offen offset:2048  nt lds
M v[204:207], a[56:59], a[160:163], v[204:207]
M v[208:211], a[64:67], a[160:163], v[20:23]
 ds_read_b64_tr_b16 a[156:157], v4 offset:57344
 ds_read_b64_tr_b16 a[158:159], v4 offset:58368
M v[208:211], a[68:71], a[164:167], v[208:211]
 buffer_load_dwordx4 v11, s[16:19], s21 offen offset:3072  nt lds
M v[212:215], a[76:79], a[164:167], v[20:23]
 s_add_u32 s21, s21, 128
M v[212:215], a[72:75], a[160:163], v[212:215]
M v[216:219], a[80:83], a[160:163], v[20:23]
M v[216:219], a[84:87], a[164:167], v[216:219]
 s_waitcnt lgkmcnt(6)
M v[220:223], a[92:95], a[164:167], v[20:23]
 s_waitcnt vmcnt(16) lgkmcnt(0)
M v[220:223], a[88:91], a[160:163], v[220:223]
 s_barrier
M v[224:227], a[32:35], a[168:171], v[20:23]
 ds_read_b128 a[160:163], v5 offset:32768
 ds_read_b128 a[164:167], v6 offset:32768
M v[224:227], a[36:39], a[172:175], v[224:227]
 buffer_load_dword a240, v24, s[32:35], 0 offen offset:512
M v[228:231], a[44:47], a[172:175], v[20:23]
M v[228:231], a[40:43], a[168:171], v[228:231]
M v[232:235], a[48:51], a[168:171], v[20:23]
M v[232:235], a[52:55], a[172:175], v[232:235]
M v[236:239], a[60:63], a[172:175], v[20:23]
M v[236:239], a[56:59], a[168:171], v[236:239]
M v[240:243], a[64:67], a[168:171], v[20:23]
M v[240:243], a[68:71], a[172:175], v[240:243]
M v[244:247], a[76:79], a[172:175], v[20:23]
M v[244:247], a[72:75], a[168:171], v[244:247]
M v[248:251], a[80:83], a[168:171], v[20:23]
M v[248:251], a[84:87], a[172:175], v[248:251]
 s_waitcnt lgkmcnt(0)
M v[252:255], a[92:95], a[172:175], v[20:23]
M v[252:255], a[88:91], a[168:171], v[252:255]
M a[0:3], a[96:99], a[160:163], a[0:3]
 ds_read_b128 a[168:171], v5 offset:34816
 ds_read_b128 a[172:175], v6 offset:34816
M a[0:3], a[100:103], a[164:167], a[0:3]
 ds_read_b64_tr_b16 a[32:33], v1 offset:0
 ds_read_b64_tr_b16 a[34:35], v1 offset:1024
M a[4:7], a[108:111], a[164:167], a[4:7]
 s_add_u32 m0, s24, 16384
M a[4:7], a[104:107], a[160:163], a[4:7]
 buffer_load_dwordx4 v12, s[48:51], s22 offen offset:0   lds
M a[8:11], a[112:115], a[160:163], a[8:11]
M a[8:11], a[116:119], a[164:167], a[8:11]
M a[12:15], a[124:127], a[164:167], a[12:15]
 ds_read_b64_tr_b16 a[36:37], v1 offset:8192
 ds_read_b64_tr_b16 a[38:39], v1 offset:9216
M a[12:15], a[120:123], a[160:163], a[12:15]
M a[16:19], a[128:131], a[160:163], a[16:19]
 buffer_load_dwordx4 v13, s[48:51], s22 offen offset:1024   lds
M a[16:19], a[132:135], a[164:167], a[16:19]
M a[20:23], a[140:143], a[164:167], a[20:23]
M a[20:23], a[136:139], a[160:163], a[20:23]
 ds_read_b64_tr_b16 a[40:41], v2 offset:0
 ds_read_b64_tr_b16 a[42:43], v2 offset:1024
M a[24:27], a[144:147], a[160:163], a[24:27]
M a[24:27], a[148:151], a[164:167], a[24:27]
 s_waitcnt lgkmcnt(6)
M a[28:31], a[156:159], a[164:167], a[28:31]
 buffer_load_dwordx4 v14, s[48:51], s22 offen offset:2048   lds
M a[28:31], a[152:155], a[160:163], a[28:31]
M v[32:35], a[96:99], a[168:171], v[32:35]
 ds_read_b128 a[160:163], v5 offset:36864
 ds_read_b128 a[164:167], v6 offset:36864
M v[32:35], a[100:103], a[172:175], v[32:35]
 ds_read_b64_tr_b16 a[44:45], v2 offset:8192
 ds_read_b64_tr_b16 a[46:47], v2 offset:9216
M v[36:39], a[108:111], a[172:175], v[36:39]
 buffer_load_dwordx4 v15, s[48:51], s22 offen offset:3072   lds
M v[36:39], a[104:107], a[168:171], v[36:39]
 s_sub_u32 s22, s22, 2097024
M v[40:43], a[112:115], a[168:171], v[40:43]
M v[40:43], a[116:119], a[172:175], v[40:43]
 ds_read_b64_tr_b16 a[48:49], v3 offset:0
 ds_read_b64_tr_b16 a[50:51], v3 offset:1024
M v[44:47], a[124:127], a[172:175], v[44:47]
 s_add_u32 m0, s23, 49152
M v[44:47], a[120:123], a[168:171], v[44:47]
 buffer_load_dwordx4 v8, s[16:19], s21 offen offset:0  nt lds
M v[48:51], a[128:131], a[168:171], v[48:51]
M v[48:51], a[132:135], a[172:175], v[48:51]
M v[52:55], a[140:143], a[172:175], v[52:55]
 ds_read_b64_tr_b16 a[52:53], v3 offset:8192
 ds_read_b64_tr_b16 a[54:55], v3 offset:9216
M v[52:55], a[136:139], a[168:171], v[52:55]
M v[56:59], a[144:147], a[168:171], v[56:59]
 buffer_load_dwordx4 v9, s[16:19], s21 offen offset:1024  nt lds
M v[56:59], a[148:151], a[172:175], v[56:59]
 s_waitcnt lgkmcnt(6)
M v[60:63], a[156:159], a[172:175], v[60:63]
M v[60:63], a[152:155], a[168:171], v[60:63]
 ds_read_b64_tr_b16 a[56:57], v4 offset:0
 ds_read_b64_tr_b16 a[58:59], v4 offset:1024
M v[64:67], a[96:99], a[160:163], v[64:67]
 ds_read_b128 a[168:171], v5 offset:38912
 ds_read_b128 a[172:175], v6 offset:38912
M v[64:67], a[100:103], a[164:167], v[64:67]
 buffer_load_dwordx4 v10, s[16:19], s21 offen offset:2048  nt lds
M v[68:71], a[108:111], a[164:167], v[68:71]
M v[68:71], a[104:107], a[160:163], v[68:71]
M v[72:75], a[112:115], a[160:163], v[72:75]
 ds_read_b64_tr_b16 a[60:61], v4 offset:8192
 ds_read_b64_tr_b16 a[62:63], v4 offset:9216
M v[72:75], a[116:119], a[164:167], v[72:75]
M v[76:79], a[124:127], a[164:167], v[76:79]
 buffer_load_dwordx4 v11, s[16:19], s21 offen offset:3072  nt lds
M v[76:79], a[120:123], a[160:163], v[76:79]
 s_add_u32 s21, s21, 524160
M v[80:83], a[128:131], a[160:163], v[80:83]
M v[80:83], a[132:135], a[164:167], v[80:83]
M v[84:87], a[140:143], a[164:167], v[84:87]
M v[84:87], a[136:139], a[160:163], v[84:87]
M v[88:91], a[144:147], a[160:163], v[88:91]
M v[88:91], a[148:151], a[164:167], v[88:91]
 s_waitcnt lgkmcnt(2)
M v[92:95], a[156:159], a[164:167], v[92:95]
 s_waitcnt vmcnt(17) lgkmcnt(0)
M v[92:95], a[152:155], a[160:163], v[92:95]
 s_barrier
M v[96:99], a[96:99], a[168:171], v[96:99]
 ds_read_b128 a[160:163], v5 offset:49152
 ds_read_b128 a[164:167], v6 offset:49152
M v[96:99], a[100:103], a[172:175], v[96:99]
M v[100:103], a[108:111], a[172:175], v[100:103]
 s_add_u32 m0, s24, 32768
 ds_read_b64_tr_b16 a[64:65], v1 offset:16384
 ds_read_b64_tr_b16 a[66:67], v1 offset:17408
M v[100:103], a[104:107], a[168:171], v[100:103]
 buffer_load_dwordx4 v12, s[48:51], s22 offen offset:0   lds
M v[104:107], a[112:115], a[168:171], v[104:107]
M v[104:107], a[116:119], a[172:175], v[104:107]
M v[108:111], a[124:127], a[172:175], v[108:111]
M v[108:111], a[120:123], a[168:171], v[108:111]
M v[112:115], a[128:131], a[168:171], v[112:115]
M v[112:115], a[132:135], a[172:175], v[112:115]
 ds_read_b64_tr_b16 a[68:69], v1 offset:24576
 ds_read_b64_tr_b16 a[70:71], v1 offset:25600
M v[116:119], a[140:143], a[172:175], v[116:119]
 buffer_load_dwordx4 v13, s[48:51], s22 offen offset:1024   lds
M v[116:119], a[136:139], a[168:171], v[116:119]
M v[120:123], a[144:147], a[168:171], v[120:123]
M v[120:123], a[148:151], a[172:175], v[120:123]
 s_waitcnt lgkmcnt(4)
M v[124:127], a[156:159], a[172:175], v[124:127]
M v[124:127], a[152:155], a[168:171], v[124:127]
M v[128:131], a[96:99], a[160:163], v[128:131]
 ds_read_b128 a[168:171], v5 offset:51200
 ds_read_b128 a[172:175], v6 offset:51200
M v[128:131], a[100:103], a[164:167], v[128:131]
 ds_read_b64_tr_b16 a[72:73], v2 offset:16384
 ds_read_b64_tr_b16 a[74:75], v2 offset:17408
M v[132:135], a[108:111], a[164:167], v[132:135]
 buffer_load_dwordx4 v14, s[48:51], s22 offen offset:2048   lds
M v[132:135], a[104:107], a[160:163], v[132:135]
M v[136:139], a[112:115], a[160:163], v[136:139]
M v[136:139], a[116:119], a[164:167], v[136:139]
M v[140:143], a[124:127], a[164:167], v[140:143]
M v[140:143], a[120:123], a[160:163], v[140:143]
 ds_read_b64_tr_b16 a[76:77], v2 offset:24576
 ds_read_b64_tr_b16 a[78:79], v2 offset:25600
M v[144:147], a[128:131], a[160:163], v[144:147]
 buffer_load_dwordx4 v15, s[48:51], s22 offen offset:3072   lds
M v[144:147], a[132:135], a[164:167], v[144:147]
 s_add_u32 s22, s22, 2097152
M v[148:151], a[140:143], a[164:167], v[148:151]
M v[148:151], a[136:139], a[160:163], v[148:151]
M v[152:155], a[144:147], a[160:163], v[152:155]
M v[152:155], a[148:151], a[164:167], v[152:155]
 s_waitcnt lgkmcnt(4)
M v[156:159], a[156:159], a[164:167], v[156:159]
 s_add_u32 m0, s23, 0
 ds_read_b64_tr_b16 a[80:81], v3 offset:16384
 ds_read_b64_tr_b16 a[82:83], v3 offset:17408
M v[156:159], a[152:155], a[160:163], v[156:159]
 buffer_load_dwordx4 v8, s[16:19], s21 offen offset:0  nt lds
M v[160:163], a[96:99], a[168:171], v[160:163]
 ds_read_b128 a[160:163], v5 offset:53248
 ds_read_b128 a[164:167], v6 offset:53248
M v[160:163], a[100:103], a[172:175], v[160:163]
M v[164:167], a[108:111], a[172:175], v[164:167]
M v[164:167], a[104:107], a[168:171], v[164:167]
M v[168:171], a[112:115], a[168:171], v[168:171]
M v[168:171], a[116:119], a[172:175], v[168:171]
 ds_read_b64_tr_b16 a[84:85], v3 offset:24576
 ds_read_b64_tr_b16 a[86:87], v3 offset:25600
M v[172:175], a[124:127], a[172:175], v[172:175]
 buffer_load_dwordx4 v9, s[16:19], s21 offen offset:1024  nt lds
M v[172:175], a[120:123], a[168:171], v[172:175]
M v[176:179], a[128:131], a[168:171], v[176:179]
M v[176:179], a[132:135], a[172:175], v[176:179]
M v[180:183], a[140:143], a[172:175], v[180:183]
M v[180:183], a[136:139], a[168:171], v[180:183]
M v[184:187], a[144:147], a[168:171], v[184:187]
 ds_read_b64_tr_b16 a[88:89], v4 offset:16384
 ds_read_b64_tr_b16 a[90:91], v4 offset:17408
M v[184:187], a[148:151], a[172:175], v[184:187]
 s_waitcnt lgkmcnt(4)
M v[188:191], a[156:159], a[172:175], v[188:191]
 buffer_load_dwordx4 v10, s[16:19], s21 offen offset:2048  nt lds
M v[188:191], a[152:155], a[168:171], v[188:191]
M v[192:195], a[96:99], a[160:163], v[192:195]
 ds_read_b128 a[168:171], v5 offset:55296
 ds_read_b128 a[172:175], v6 offset:55296
M v[192:195], a[100:103], a[164:167], v[192:195]
M v[196:199], a[108:111], a[164:167], v[196:199]
M v[196:199], a[104:107], a[160:163], v[196:199]
 ds_read_b64_tr_b16 a[92:93], v4 offset:24576
 ds_read_b64_tr_b16 a[94:95], v4 offset:25600
M v[200:203], a[112:115], a[160:163], v[200:203]
 buffer_load_dwordx4 v11, s[16:19], s21 offen offset:3072  nt lds
M v[200:203], a[116:119], a[164:167], v[200:203]
 s_add_u32 s21, s21, 128
M v[204:207], a[124:127], a[164:167], v[204:207]
M v[204:207], a[120:123], a[160:163], v[204:207]
M v[208:211], a[128:131], a[160:163], v[208:211]
M v[208:211], a[132:135], a[164:167], v[208:211]
M v[212:215], a[140:143], a[164:167], v[212:215]
M v[212:215], a[136:139], a[160:163], v[212:215]
M v[216:219], a[144:147], a[160:163], v[216:219]
M v[216:219], a[148:151], a[164:167], v[216:219]
 s_waitcnt lgkmcnt(2)
M v[220:223], a[156:159], a[164:167], v[220:223]
 s_waitcnt vmcnt(17) lgkmcnt(0)
M v[220:223], a[152:155], a[160:163], v[220:223]
 s_barrier
M v[224:227], a[96:99], a[168:171], v[224:227]
 ds_read_b128 a[160:163], v5 offset:0
 ds_read_b128 a[164:167], v6 offset:0
M v[224:227], a[100:103], a[172:175], v[224:227]
M v[228:231], a[108:111], a[172:175], v[228:231]
M v[228:231], a[104:107], a[168:171], v[228:231]
M v[232:235], a[112:115], a[168:171], v[232:235]
M v[232:235], a[116:119], a[172:175], v[232:235]
M v[236:239], a[124:127], a[172:175], v[236:239]
M v[236:239], a[120:123], a[168:171], v[236:239]
M v[240:243], a[128:131], a[168:171], v[240:243]
M v[240:243], a[132:135], a[172:175], v[240:243]
M v[244:247], a[140:143], a[172:175], v[244:247]
M v[244:247], a[136:139], a[168:171], v[244:247]
M v[248:251], a[144:147], a[168:171], v[248:251]
M v[248:251], a[148:151], a[172:175], v[248:251]
 s_waitcnt lgkmcnt(0)
M v[252:255], a[156:159], a[172:175], v[252:255]
M v[252:255], a[152:155], a[168:171], v[252:255]
M a[0:3], a[32:35], a[160:163], a[0:3]
 ds_read_b128 a[168:171], v5 offset:2048
 ds_read_b128 a[172:175], v6 offset:2048
M a[0:3], a[36:39], a[164:167], a[0:3]
 ds_read_b64_tr_b16 a[96:97], v1 offset:32768
 ds_read_b64_tr_b16 a[98:99], v1 offset:33792
M a[4:7], a[44:47], a[164:167], a[4:7]
 s_add_u32 m0, s24, 49152
M a[4:7], a[40:43], a[160:163], a[4:7]
 buffer_load_dwordx4 v12, s[48:51], s22 offen offset:0   lds
M a[8:11], a[48:51], a[160:163], a[8:11]
M a[8:11], a[52:55], a[164:167], a[8:11]
M a[12:15], a[60:63], a[164:167], a[12:15]
 ds_read_b64_tr_b16 a[100:101], v1 offset:40960
 ds_read_b64_tr_b16 a[102:103], v1 offset:41984
M a[12:15], a[56:59], a[160:163], a[12:15]
M a[16:19], a[64:67], a[160:163], a[16:19]
 buffer_load_dwordx4 v13, s[48:51], s22 offen offset:1024   lds
M a[16:19], a[68:71], a[164:167], a[16:19]
M a[20:23], a[76:79], a[164:167], a[20:23]
 v_mov_b32 v16, 0x3f80
M a[20:23], a[72:75], a[160:163], a[20:23]
 ds_read_b64_tr_b16 a[104:105], v2 offset:32768
 ds_read_b64_tr_b16 a[106:107], v2 offset:33792
M a[24:27], a[80:83], a[160:163], a[24:27]
 v_lshrrev_b32 v17, 8, v7
M a[24:27], a[84:87], a[164:167], a[24:27]
 s_waitcnt lgkmcnt(6)
 v_bfe_u32 v18, v7, 6, 2
M a[28:31], a[92:95], a[164:167], a[28:31]
 buffer_load_dwordx4 v14, s[48:51], s22 offen offset:2048   lds
M a[28:31], a[88:91], a[160:163], a[28:31]
 v_and_b32 v19, 16, v7
M v[32:35], a[32:35], a[168:171], v[32:35]
 ds_read_b128 a[160:163], v5 offset:4096
 ds_read_b128 a[164:167], v6 offset:4096
M v[32:35], a[36:39], a[172:175], v[32:35]
 ds_read_b64_tr_b16 a[108:109], v2 offset:40960
 ds_read_b64_tr_b16 a[110:111], v2 offset:41984
M v[36:39], a[44:47], a[172:175], v[36:39]
 buffer_load_dwordx4 v15, s[48:51], s22 offen offset:3072   lds
M v[36:39], a[40:43], a[168:171], v[36:39]
 s_sub_u32 s22, s22, 2097024
 v_lshlrev_b32 v19, v19, v16
M v[40:43], a[48:51], a[168:171], v[40:43]
 v_cmp_eq_u32 vcc, v17, v18
M v[40:43], a[52:55], a[172:175], v[40:43]
 ds_read_b64_tr_b16 a[112:113], v3 offset:32768
 ds_read_b64_tr_b16 a[114:115], v3 offset:33792
M v[44:47], a[60:63], a[172:175], v[44:47]
 s_add_u32 m0, s23, 16384
 v_and_b32 v16, 32, v7
M v[44:47], a[56:59], a[168:171], v[44:47]
 buffer_load_dwordx4 v8, s[16:19], s21 offen offset:0  nt lds
M v[48:51], a[64:67], a[168:171], v[48:51]
 v_accvgpr_write_b32 a244, 0
M v[48:51], a[68:71], a[172:175], v[48:51]
 v_accvgpr_write_b32 a245, 0
M v[52:55], a[76:79], a[172:175], v[52:55]
 ds_read_b64_tr_b16 a[116:117], v3 offset:40960
 ds_read_b64_tr_b16 a[118:119], v3 offset:41984
M v[52:55], a[72:75], a[168:171], v[52:55]
 v_cndmask_b32 v19, 0, v19, vcc
M v[56:59], a[80:83], a[168:171], v[56:59]
 buffer_load_dwordx4 v9, s[16:19], s21 offen offset:1024  nt lds
M v[56:59], a[84:87], a[172:175], v[56:59]
 s_waitcnt lgkmcnt(6)
 v_cmp_eq_u32 vcc, 0, v16
M v[60:63], a[92:95], a[172:175], v[60:63]
 v_accvgpr_write_b32 a248, 0
M v[60:63], a[88:91], a[168:171], v[60:63]
 ds_read_b64_tr_b16 a[120:121], v4 offset:32768
 ds_read_b64_tr_b16 a[122:123], v4 offset:33792
M v[64:67], a[32:35], a[160:163], v[64:67]
 ds_read_b128 a[168:171], v5 offset:6144
 ds_read_b128 a[172:175], v6 offset:6144
M v[64:67], a[36:39], a[164:167], v[64:67]
 buffer_load_dwordx4 v10, s[16:19], s21 offen offset:2048  nt lds
M v[68:71], a[44:47], a[164:167], v[68:71]
 v_accvgpr_write_b32 a249, 0
M v[68:71], a[40:43], a[160:163], v[68:71]
 v_cndmask_b32 v17, 0, v19, vcc
M v[72:75], a[48:51], a[160:163], v[72:75]
 ds_read_b64_tr_b16 a[124:125], v4 offset:40960
 ds_read_b64_tr_b16 a[126:127], v4 offset:41984
M v[72:75], a[52:55], a[164:167], v[72:75]
 v_sub_u32 v18, v19, v17
M v[76:79], a[60:63], a[164:167], v[76:79]
 buffer_load_dwordx4 v11, s[16:19], s21 offen offset:3072  nt lds
M v[76:79], a[56:59], a[160:163], v[76:79]
 s_add_u32 s21, s21, 524160
 v_accvgpr_write_b32 a246, v17
M v[80:83], a[64:67], a[160:163], v[80:83]
 v_accvgpr_write_b32 a247, v18
M v[80:83], a[68:71], a[164:167], v[80:83]
M v[84:87], a[76:79], a[164:167], v[84:87]
M v[84:87], a[72:75], a[160:163], v[84:87]
M v[88:91], a[80:83], a[160:163], v[88:91]
M v[88:91], a[84:87], a[164:167], v[88:91]
 s_waitcnt lgkmcnt(2)
M v[92:95], a[92:95], a[164:167], v[92:95]
 s_waitcnt vmcnt(16) lgkmcnt(0)
M v[92:95], a[88:91], a[160:163], v[92:95]
 s_barrier
M v[96:99], a[32:35], a[168:171], v[96:99]
 ds_read_b128 a[160:163], v5 offset:16384
 ds_read_b128 a[164:167], v6 offset:16384
M v[96:99], a[36:39], a[172:175], v[96:99]
M v[100:103], a[44:47], a[172:175], v[100:103]
 s_add_u32 m0, s24, 0
 ds_read_b64_tr_b16 a[128:129], v1 offset:49152
 ds_read_b64_tr_b16 a[130:131], v1 offset:50176
M v[100:103], a[40:43], a[168:171], v[100:103]
 buffer_load_dwordx4 v12, s[48:51], s22 offen offset:0   lds
M v[104:107], a[48:51], a[168:171], v[104:107]
M v[104:107], a[52:55], a[172:175], v[104:107]
M v[108:111], a[60:63], a[172:175], v[108:111]
M v[108:111], a[56:59], a[168:171], v[108:111]
M v[112:115], a[64:67], a[168:171], v[112:115]
M v[112:115], a[68:71], a[172:175], v[112:115]
 ds_read_b64_tr_b16 a[132:133], v1 offset:57344
 ds_read_b64_tr_b16 a[134:135], v1 offset:58368
M v[116:119], a[76:79], a[172:175], v[116:119]
 buffer_load_dwordx4 v13, s[48:51], s22 offen offset:1024   lds
M v[116:119], a[72:75], a[168:171], v[116:119]
M v[120:123], a[80:83], a[168:171], v[120:123]
M v[120:123], a[84:87], a[172:175], v[120:123]
 s_waitcnt lgkmcnt(4)
M v[124:127], a[92:95], a[172:175], v[124:127]
M v[124:127], a[88:91], a[168:171], v[124:127]
M v[128:131], a[32:35], a[160:163], v[128:131]
 ds_read_b128 a[168:171], v5 offset:18432
 ds_read_b128 a[172:175], v6 offset:18432
M v[128:131], a[36:39], a[164:167], v[128:131]
 ds_read_b64_tr_b16 a[136:137], v2 offset:49152
 ds_read_b64_tr_b16 a[138:139], v2 offset:50176
M v[132:135], a[44:47], a[164:167], v[132:135]
 buffer_load_dwordx4 v14, s[48:51], s22 offen offset:2048   lds
M v[132:135], a[40:43], a[160:163], v[132:135]
M v[136:139], a[48:51], a[160:163], v[136:139]
M v[136:139], a[52:55], a[164:167], v[136:139]
M v[140:143], a[60:63], a[164:167], v[140:143]
M v[140:143], a[56:59], a[160:163], v[140:143]
 ds_read_b64_tr_b16 a[140:141], v2 offset:57344
 ds_read_b64_tr_b16 a[142:143], v2 offset:58368
M v[144:147], a[64:67], a[160:163], v[144:147]
 buffer_load_dwordx4 v15, s[48:51], s22 offen offset:3072   lds
M v[144:147], a[68:71], a[164:167], v[144:147]
 s_add_u32 s22, s22, 2097152
M v[148:151], a[76:79], a[164:167], v[148:151]
M v[148:151], a[72:75], a[160:163], v[148:151]
M v[152:155], a[80:83], a[160:163], v[152:155]
M v[152:155], a[84:87], a[164:167], v[152:155]
 s_waitcnt lgkmcnt(4)
M v[156:159], a[92:95], a[164:167], v[156:159]
 s_add_u32 m0, s23, 32768
 ds_read_b64_tr_b16 a[144:145], v3 offset:49152
 ds_read_b64_tr_b16 a[146:147], v3 offset:50176
M v[156:159], a[88:91], a[160:163], v[156:159]
 buffer_load_dwordx4 v8, s[16:19], s21 offen offset:0  nt lds
M v[160:163], a[32:35], a[168:171], v[160:163]
 ds_read_b128 a[160:163], v5 offset:20480
 ds_read_b128 a[164:167], v6 offset:20480
M v[160:163], a[36:39], a[172:175], v[160:163]
M v[164:167], a[44:47], a[172:175], v[164:167]
M v[164:167], a[40:43], a[168:171], v[164:167]
M v[168:171], a[48:51], a[168:171], v[168:171]
M v[168:171], a[52:55], a[172:175], v[168:171]
 ds_read_b64_tr_b16 a[148:149], v3 offset:57344
 ds_read_b64_tr_b16 a[150:151], v3 offset:58368
M v[172:175], a[60:63], a[172:175], v[172:175]
 buffer_load_dwordx4 v9, s[16:19], s21 offen offset:1024  nt lds
M v[172:175], a[56:59], a[168:171], v[172:175]
M v[176:179], a[64:67], a[168:171], v[176:179]
M v[176:179], a[68:71], a[172:175], v[176:179]
M v[180:183], a[76:79], a[172:175], v[180:183]
M v[180:183], a[72:75], a[168:171], v[180:183]
M v[184:187], a[80:83], a[168:171], v[184:187]
 ds_read_b64_tr_b16 a[152:153], v4 offset:49152
 ds_read_b64_tr_b16 a[154:155], v4 offset:50176
M v[184:187], a[84:87], a[172:175], v[184:187]
 s_waitcnt lgkmcnt(4)
M v[188:191], a[92:95], a[172:175], v[188:191]
 buffer_load_dwordx4 v10, s[16:19], s21 offen offset:2048  nt lds
M v[188:191], a[88:91], a[168:171], v[188:191]
M v[192:195], a[32:35], a[160:163], v[192:195]
 ds_read_b128 a[168:171], v5 offset:22528
 ds_read_b128 a[172:175], v6 offset:22528
M v[192:195], a[36:39], a[164:167], v[192:195]
M v[196:199], a[44:47], a[164:167], v[196:199]
M v[196:199], a[40:43], a[160:163], v[196:199]
 ds_read_b64_tr_b16 a[156:157], v4 offset:57344
 ds_read_b64_tr_b16 a[158:159], v4 offset:58368
M v[200:203], a[48:51], a[160:163], v[200:203]
 buffer_load_dwordx4 v11, s[16:19], s21 offen offset:3072  nt lds
M v[200:203], a[52:55], a[164:167], v[200:203]
 s_add_u32 s21, s21, 128
M v[204:207], a[60:63], a[164:167], v[204:207]
M v[204:207], a[56:59], a[160:163], v[204:207]
M v[208:211], a[64:67], a[160:163], v[208:211]
M v[208:211], a[68:71], a[164:167], v[208:211]
M v[212:215], a[76:79], a[164:167], v[212:215]
M v[212:215], a[72:75], a[160:163], v[212:215]
M v[216:219], a[80:83], a[160:163], v[216:219]
M v[216:219], a[84:87], a[164:167], v[216:219]
 s_waitcnt lgkmcnt(2)
M v[220:223], a[92:95], a[164:167], v[220:223]
 s_waitcnt vmcnt(16) lgkmcnt(0)
M v[220:223], a[88:91], a[160:163], v[220:223]
 s_barrier
M v[224:227], a[32:35], a[168:171], v[224:227]
 ds_read_b128 a[160:163], v5 offset:32768
 ds_read_b128 a[164:167], v6 offset:32768
M v[224:227], a[36:39], a[172:175], v[224:227]
M v[228:231], a[44:47], a[172:175], v[228:231]
M v[228:231], a[40:43], a[168:171], v[228:231]
M v[232:235], a[48:51], a[168:171], v[232:235]
M v[232:235], a[52:55], a[172:175], v[232:235]
M v[236:239], a[60:63], a[172:175], v[236:239]
M v[236:239], a[56:59], a[168:171], v[236:239]
M v[240:243], a[64:67], a[168:171], v[240:243]
M v[240:243], a[68:71], a[172:175], v[240:243]
M v[244:247], a[76:79], a[172:175], v[244:247]
M v[244:247], a[72:75], a[168:171], v[244:247]
M v[248:251], a[80:83], a[168:171], v[248:251]
M v[248:251], a[84:87], a[172:175], v[248:251]
 s_waitcnt lgkmcnt(0)
M v[252:255], a[92:95], a[172:175], v[252:255]
M v[252:255], a[88:91], a[168:171], v[252:255]
M a[0:3], a[96:99], a[160:163], a[0:3]
 ds_read_b128 a[168:171], v5 offset:34816
 ds_read_b128 a[172:175], v6 offset:34816
M a[0:3], a[100:103], a[164:167], a[0:3]
 ds_read_b64_tr_b16 a[32:33], v1 offset:0
 ds_read_b64_tr_b16 a[34:35], v1 offset:1024
M a[4:7], a[108:111], a[164:167], a[4:7]
 s_add_u32 m0, s24, 16384
M a[4:7], a[104:107], a[160:163], a[4:7]
 buffer_load_dwordx4 v12, s[48:51], s22 offen offset:0   lds
M a[8:11], a[112:115], a[160:163], a[8:11]
M a[8:11], a[116:119], a[164:167], a[8:11]
M a[12:15], a[124:127], a[164:167], a[12:15]
 ds_read_b64_tr_b16 a[36:37], v1 offset:8192
 ds_read_b64_tr_b16 a[38:39], v1 offset:9216
M a[12:15], a[120:123], a[160:163], a[12:15]
M a[16:19], a[128:131], a[160:163], a[16:19]
 buffer_load_dwordx4 v13, s[48:51], s22 offen offset:1024   lds
M a[16:19], a[132:135], a[164:167], a[16:19]
M a[20:23], a[140:143], a[164:167], a[20:23]
M a[20:23], a[136:139], a[160:163], a[20:23]
 ds_read_b64_tr_b16 a[40:41], v2 offset:0
 ds_read_b64_tr_b16 a[42:43], v2 offset:1024
M a[24:27], a[144:147], a[160:163], a[24:27]
M a[24:27], a[148:151], a[164:167], a[24:27]
 s_waitcnt lgkmcnt(6)
M a[28:31], a[156:159], a[164:167], a[28:31]
 buffer_load_dwordx4 v14, s[48:51], s22 offen offset:2048   lds
M a[28:31], a[152:155], a[160:163], a[28:31]
M v[32:35], a[96:99], a[168:171], v[32:35]
 ds_read_b128 a[160:163], v5 offset:36864
 ds_read_b128 a[164:167], v6 offset:36864
M v[32:35], a[100:103], a[172:175], v[32:35]
 ds_read_b64_tr_b16 a[44:45], v2 offset:8192
 ds_read_b64_tr_b16 a[46:47], v2 offset:9216
M v[36:39], a[108:111], a[172:175], v[36:39]
 buffer_load_dwordx4 v15, s[48:51], s22 offen offset:3072   lds
M v[36:39], a[104:107], a[168:171], v[36:39]
 s_sub_u32 s22, s22, 2097024
M v[40:43], a[112:115], a[168:171], v[40:43]
M v[40:43], a[116:119], a[172:175], v[40:43]
 ds_read_b64_tr_b16 a[48:49], v3 offset:0
 ds_read_b64_tr_b16 a[50:51], v3 offset:1024
M v[44:47], a[124:127], a[172:175], v[44:47]
 s_add_u32 m0, s23, 49152
M v[44:47], a[120:123], a[168:171], v[44:47]
 buffer_load_dwordx4 v8, s[16:19], s21 offen offset:0  nt lds
M v[48:51], a[128:131], a[168:171], v[48:51]
M v[48:51], a[132:135], a[172:175], v[48:51]
M v[52:55], a[140:143], a[172:175], v[52:55]
 ds_read_b64_tr_b16 a[52:53], v3 offset:8192
 ds_read_b64_tr_b16 a[54:55], v3 offset:9216
M v[52:55], a[136:139], a[168:171], v[52:55]
M v[56:59], a[144:147], a[168:171], v[56:59]
 buffer_load_dwordx4 v9, s[16:19], s21 offen offset:1024  nt lds
M v[56:59], a[148:151], a[172:175], v[56:59]
 s_waitcnt lgkmcnt(6)
M v[60:63], a[156:159], a[172:175], v[60:63]
M v[60:63], a[152:155], a[168:171], v[60:63]
 ds_read_b64_tr_b16 a[56:57], v4 offset:0
 ds_read_b64_tr_b16 a[58:59], v4 offset:1024
M v[64:67], a[96:99], a[160:163], v[64:67]
 ds_read_b128 a[168:171], v5 offset:38912
 ds_read_b128 a[172:175], v6 offset:38912
M v[64:67], a[100:103], a[164:167], v[64:67]
 buffer_load_dwordx4 v10, s[16:19], s21 offen offset:2048  nt lds
M v[68:71], a[108:111], a[164:167], v[68:71]
M v[68:71], a[104:107], a[160:163], v[68:71]
M v[72:75], a[112:115], a[160:163], v[72:75]
 ds_read_b64_tr_b16 a[60:61], v4 offset:8192
 ds_read_b64_tr_b16 a[62:63], v4 offset:9216
M v[72:75], a[116:119], a[164:167], v[72:75]
M v[76:79], a[124:127], a[164:167], v[76:79]
 buffer_load_dwordx4 v11, s[16:19], s21 offen offset:3072  nt lds
M v[76:79], a[120:123], a[160:163], v[76:79]
 s_add_u32 s21, s21, 524160
M v[80:83], a[128:131], a[160:163], v[80:83]
M v[80:83], a[132:135], a[164:167], v[80:83]
M v[84:87], a[140:143], a[164:167], v[84:87]
M v[84:87], a[136:139], a[160:163], v[84:87]
M v[88:91], a[144:147], a[160:163], v[88:91]
M v[88:91], a[148:151], a[164:167], v[88:91]
 s_waitcnt lgkmcnt(2)
M v[92:95], a[156:159], a[164:167], v[92:95]
 s_waitcnt vmcnt(16) lgkmcnt(0)
M v[92:95], a[152:155], a[160:163], v[92:95]
 s_barrier
M v[96:99], a[96:99], a[168:171], v[96:99]
 ds_read_b128 a[160:163], v5 offset:49152
 ds_read_b128 a[164:167], v6 offset:49152
M v[96:99], a[100:103], a[172:175], v[96:99]
M v[100:103], a[108:111], a[172:175], v[100:103]
 s_add_u32 m0, s24, 32768
 ds_read_b64_tr_b16 a[64:65], v1 offset:16384
 ds_read_b64_tr_b16 a[66:67], v1 offset:17408
M v[100:103], a[104:107], a[168:171], v[100:103]
 buffer_load_dwordx4 v12, s[48:51], s22 offen offset:0   lds
M v[104:107], a[112:115], a[168:171], v[104:107]
 v_min_u32 v16, 40, v0
 v_lshlrev_b32 v16, 2, v16
M v[104:107], a[116:119], a[172:175], v[104:107]
 buffer_load_dword v17, v16, s[12:15], 0 offen offset:64 sc1
M v[108:111], a[124:127], a[172:175], v[108:111]
M v[108:111], a[120:123], a[168:171], v[108:111]
M v[112:115], a[128:131], a[168:171], v[112:115]
M v[112:115], a[132:135], a[172:175], v[112:115]
 ds_read_b64_tr_b16 a[68:69], v1 offset:24576
 ds_read_b64_tr_b16 a[70:71], v1 offset:25600
M v[116:119], a[140:143], a[172:175], v[116:119]
 buffer_load_dwordx4 v13, s[48:51], s22 offen offset:1024   lds
M v[116:119], a[136:139], a[168:171], v[116:119]
M v[120:123], a[144:147], a[168:171], v[120:123]
M v[120:123], a[148:151], a[172:175], v[120:123]
 s_waitcnt lgkmcnt(4)
M v[124:127], a[156:159], a[172:175], v[124:127]
M v[124:127], a[152:155], a[168:171], v[124:127]
M v[128:131], a[96:99], a[160:163], v[128:131]
 ds_read_b128 a[168:171], v5 offset:51200
 ds_read_b128 a[172:175], v6 offset:51200
M v[128:131], a[100:103], a[164:167], v[128:131]
 ds_read_b64_tr_b16 a[72:73], v2 offset:16384
 ds_read_b64_tr_b16 a[74:75], v2 offset:17408
M v[132:135], a[108:111], a[164:167], v[132:135]
 buffer_load_dwordx4 v14, s[48:51], s22 offen offset:2048   lds
M v[132:135], a[104:107], a[160:163], v[132:135]
M v[136:139], a[112:115], a[160:163], v[136:139]
M v[136:139], a[116:119], a[164:167], v[136:139]
M v[140:143], a[124:127], a[164:167], v[140:143]
M v[140:143], a[120:123], a[160:163], v[140:143]
 ds_read_b64_tr_b16 a[76:77], v2 offset:24576
 ds_read_b64_tr_b16 a[78:79], v2 offset:25600
M v[144:147], a[128:131], a[160:163], v[144:147]
 buffer_load_dwordx4 v15, s[48:51], s22 offen offset:3072   lds
M v[144:147], a[132:135], a[164:167], v[144:147]
 s_add_u32 s22, s22, 2097152
M v[148:151], a[140:143], a[164:167], v[148:151]
M v[148:151], a[136:139], a[160:163], v[148:151]
M v[152:155], a[144:147], a[160:163], v[152:155]
M v[152:155], a[148:151], a[164:167], v[152:155]
 s_waitcnt lgkmcnt(4)
M v[156:159], a[156:159], a[164:167], v[156:159]
 s_add_u32 m0, s23, 0
 ds_read_b64_tr_b16 a[80:81], v3 offset:16384
 ds_read_b64_tr_b16 a[82:83], v3 offset:17408
M v[156:159], a[152:155], a[160:163], v[156:159]
 buffer_load_dwordx4 v8, s[16:19], s21 offen offset:0  nt lds
M v[160:163], a[96:99], a[168:171], v[160:163]
 ds_read_b128 a[160:163], v5 offset:53248
 ds_read_b128 a[164:167], v6 offset:53248
M v[160:163], a[100:103], a[172:175], v[160:163]
M v[164:167], a[108:111], a[172:175], v[164:167]
M v[164:167], a[104:107], a[168:171], v[164:167]
M v[168:171], a[112:115], a[168:171], v[168:171]
M v[168:171], a[116:119], a[172:175], v[168:171]
 ds_read_b64_tr_b16 a[84:85], v3 offset:24576
 ds_read_b64_tr_b16 a[86:87], v3 offset:25600
M v[172:175], a[124:127], a[172:175], v[172:175]
 buffer_load_dwordx4 v9, s[16:19], s21 offen offset:1024  nt lds
M v[172:175], a[120:123], a[168:171], v[172:175]
M v[176:179], a[128:131], a[168:171], v[176:179]
M v[176:179], a[132:135], a[172:175], v[176:179]
M v[180:183], a[140:143], a[172:175], v[180:183]
M v[180:183], a[136:139], a[168:171], v[180:183]
M v[184:187], a[144:147], a[168:171], v[184:187]
 ds_read_b64_tr_b16 a[88:89], v4 offset:16384
 ds_read_b64_tr_b16 a[90:91], v4 offset:17408
M v[184:187], a[148:151], a[172:175], v[184:187]
 s_waitcnt lgkmcnt(4)
M v[188:191], a[156:159], a[172:175], v[188:191]
 buffer_load_dwordx4 v10, s[16:19], s21 offen offset:2048  nt lds
M v[188:191], a[152:155], a[168:171], v[188:191]
M v[192:195], a[96:99], a[160:163], v[192:195]
 ds_read_b128 a[168:171], v5 offset:55296
 ds_read_b128 a[172:175], v6 offset:55296
M v[192:195], a[100:103], a[164:167], v[192:195]
M v[196:199], a[108:111], a[164:167], v[196:199]
M v[196:199], a[104:107], a[160:163], v[196:199]
 ds_read_b64_tr_b16 a[92:93], v4 offset:24576
 ds_read_b64_tr_b16 a[94:95], v4 offset:25600
M v[200:203], a[112:115], a[160:163], v[200:203]
 buffer_load_dwordx4 v11, s[16:19], s21 offen offset:3072  nt lds
M v[200:203], a[116:119], a[164:167], v[200:203]
 s_add_u32 s21, s21, 128
M v[204:207], a[124:127], a[164:167], v[204:207]
M v[204:207], a[120:123], a[160:163], v[204:207]
M v[208:211], a[128:131], a[160:163], v[208:211]
M v[208:211], a[132:135], a[164:167], v[208:211]
M v[212:215], a[140:143], a[164:167], v[212:215]
M v[212:215], a[136:139], a[160:163], v[212:215]
M v[216:219], a[144:147], a[160:163], v[216:219]
M v[216:219], a[148:151], a[164:167], v[216:219]
 s_waitcnt lgkmcnt(2)
M v[220:223], a[156:159], a[164:167], v[220:223]
 s_waitcnt vmcnt(17) lgkmcnt(0)
M v[220:223], a[152:155], a[160:163], v[220:223]
 s_barrier
M v[224:227], a[96:99], a[168:171], v[224:227]
 ds_read_b128 a[160:163], v5 offset:0
 ds_read_b128 a[164:167], v6 offset:0
M v[224:227], a[100:103], a[172:175], v[224:227]
M v[228:231], a[108:111], a[172:175], v[228:231]
M v[228:231], a[104:107], a[168:171], v[228:231]
M v[232:235], a[112:115], a[168:171], v[232:235]
M v[232:235], a[116:119], a[172:175], v[232:235]
M v[236:239], a[124:127], a[172:175], v[236:239]
M v[236:239], a[120:123], a[168:171], v[236:239]
M v[240:243], a[128:131], a[168:171], v[240:243]
M v[240:243], a[132:135], a[172:175], v[240:243]
M v[244:247], a[140:143], a[172:175], v[244:247]
M v[244:247], a[136:139], a[168:171], v[244:247]
M v[248:251], a[144:147], a[168:171], v[248:251]
M v[248:251], a[148:151], a[172:175], v[248:251]
 s_waitcnt lgkmcnt(0)
M v[252:255], a[156:159], a[172:175], v[252:255]
M v[252:255], a[152:155], a[168:171], v[252:255]
M a[0:3], a[32:35], a[160:163], a[0:3]
 ds_read_b128 a[168:171], v5 offset:2048
 ds_read_b128 a[172:175], v6 offset:2048
M a[0:3], a[36:39], a[164:167], a[0:3]
 ds_read_b64_tr_b16 a[96:97], v1 offset:32768
 ds_read_b64_tr_b16 a[98:99], v1 offset:33792
M a[4:7], a[44:47], a[164:167], a[4:7]
 s_add_u32 m0, s24, 49152
M a[4:7], a[40:43], a[160:163], a[4:7]
 buffer_load_dwordx4 v12, s[48:51], s22 offen offset:0   lds
M a[8:11], a[48:51], a[160:163], a[8:11]
M a[8:11], a[52:55], a[164:167], a[8:11]
M a[12:15], a[60:63], a[164:167], a[12:15]
 ds_read_b64_tr_b16 a[100:101], v1 offset:40960
 ds_read_b64_tr_b16 a[102:103], v1 offset:41984
M a[12:15], a[56:59], a[160:163], a[12:15]
M a[16:19], a[64:67], a[160:163], a[16:19]
 buffer_load_dwordx4 v13, s[48:51], s22 offen offset:1024   lds
M a[16:19], a[68:71], a[164:167], a[16:19]
M a[20:23], a[76:79], a[164:167], a[20:23]
M a[20:23], a[72:75], a[160:163], a[20:23]
 ds_read_b64_tr_b16 a[104:105], v2 offset:32768
 ds_read_b64_tr_b16 a[106:107], v2 offset:33792
M a[24:27], a[80:83], a[160:163], a[24:27]
M a[24:27], a[84:87], a[164:167], a[24:27]
 s_waitcnt lgkmcnt(6)
M a[28:31], a[92:95], a[164:167], a[28:31]
 buffer_load_dwordx4 v14, s[48:51], s22 offen offset:2048   lds
M a[28:31], a[88:91], a[160:163], a[28:31]
M v[32:35], a[32:35], a[168:171], v[32:35]
 ds_read_b128 a[160:163], v5 offset:4096
 ds_read_b128 a[164:167], v6 offset:4096
M v[32:35], a[36:39], a[172:175], v[32:35]
 ds_read_b64_tr_b16 a[108:109], v2 offset:40960
 ds_read_b64_tr_b16 a[110:111], v2 offset:41984
M v[36:39], a[44:47], a[172:175], v[36:39]
 buffer_load_dwordx4 v15, s[48:51], s22 offen offset:3072   lds
M v[36:39], a[40:43], a[168:171], v[36:39]
 s_sub_u32 s22, s22, 2097024
M v[40:43], a[48:51], a[168:171], v[40:43]
M v[40:43], a[52:55], a[172:175], v[40:43]
 ds_read_b64_tr_b16 a[112:113], v3 offset:32768
 ds_read_b64_tr_b16 a[114:115], v3 offset:33792
M v[44:47], a[60:63], a[172:175], v[44:47]
 s_add_u32 m0, s23, 16384
M v[44:47], a[56:59], a[168:171], v[44:47]
 buffer_load_dwordx4 v8, s[16:19], s21 offen offset:0  nt lds
M v[48:51], a[64:67], a[168:171], v[48:51]
M v[48:51], a[68:71], a[172:175], v[48:51]
M v[52:55], a[76:79], a[172:175], v[52:55]
 ds_read_b64_tr_b16 a[116:117], v3 offset:40960
 ds_read_b64_tr_b16 a[118:119], v3 offset:41984
M v[52:55], a[72:75], a[168:171], v[52:55]
M v[56:59], a[80:83], a[168:171], v[56:59]
 buffer_load_dwordx4 v9, s[16:19], s21 offen offset:1024  nt lds
M v[56:59], a[84:87], a[172:175], v[56:59]
 s_waitcnt lgkmcnt(6)
M v[60:63], a[92:95], a[172:175], v[60:63]
M v[60:63], a[88:91], a[168:171], v[60:63]
 ds_read_b64_tr_b16 a[120:121], v4 offset:32768
 ds_read_b64_tr_b16 a[122:123], v4 offset:33792
M v[64:67], a[32:35], a[160:163], v[64:67]
 ds_read_b128 a[168:171], v5 offset:6144
 ds_read_b128 a[172:175], v6 offset:6144
M v[64:67], a[36:39], a[164:167], v[64:67]
 buffer_load_dwordx4 v10, s[16:19], s21 offen offset:2048  nt lds
M v[68:71], a[44:47], a[164:167], v[68:71]
M v[68:71], a[40:43], a[160:163], v[68:71]
M v[72:75], a[48:51], a[160:163], v[72:75]
 ds_read_b64_tr_b16 a[124:125], v4 offset:40960
 ds_read_b64_tr_b16 a[126:127], v4 offset:41984
M v[72:75], a[52:55], a[164:167], v[72:75]
M v[76:79], a[60:63], a[164:167], v[76:79]
 buffer_load_dwordx4 v11, s[16:19], s21 offen offset:3072  nt lds
M v[76:79], a[56:59], a[160:163], v[76:79]
 s_add_u32 s21, s21, 524160
M v[80:83], a[64:67], a[160:163], v[80:83]
M v[80:83], a[68:71], a[164:167], v[80:83]
M v[84:87], a[76:79], a[164:167], v[84:87]
M v[84:87], a[72:75], a[160:163], v[84:87]
M v[88:91], a[80:83], a[160:163], v[88:91]
M v[88:91], a[84:87], a[164:167], v[88:91]
 s_waitcnt lgkmcnt(2)
M v[92:95], a[92:95], a[164:167], v[92:95]
 s_waitcnt vmcnt(17) lgkmcnt(0)
M v[92:95], a[88:91], a[160:163], v[92:95]
 s_barrier
M v[96:99], a[32:35], a[168:171], v[96:99]
 ds_read_b128 a[160:163], v5 offset:16384
 ds_read_b128 a[164:167], v6 offset:16384
M v[96:99], a[36:39], a[172:175], v[96:99]
M v[100:103], a[44:47], a[172:175], v[100:103]
 s_add_u32 m0, s24, 0
 ds_read_b64_tr_b16 a[128:129], v1 offset:49152
 ds_read_b64_tr_b16 a[130:131], v1 offset:50176
M v[100:103], a[40:43], a[168:171], v[100:103]
 buffer_load_dwordx4 v12, s[48:51], s22 offen offset:0   lds
M v[104:107], a[48:51], a[168:171], v[104:107]
M v[104:107], a[52:55], a[172:175], v[104:107]
M v[108:111], a[60:63], a[172:175], v[108:111]
M v[108:111], a[56:59], a[168:171], v[108:111]
M v[112:115], a[64:67], a[168:171], v[112:115]
M v[112:115], a[68:71], a[172:175], v[112:115]
 ds_read_b64_tr_b16 a[132:133], v1 offset:57344
 ds_read_b64_tr_b16 a[134:135], v1 offset:58368
M v[116:119], a[76:79], a[172:175], v[116:119]
 buffer_load_dwordx4 v13, s[48:51], s22 offen offset:1024   lds
M v[116:119], a[72:75], a[168:171], v[116:119]
M v[120:123], a[80:83], a[168:171], v[120:123]
M v[120:123], a[84:87], a[172:175], v[120:123]
 s_waitcnt lgkmcnt(4)
M v[124:127], a[92:95], a[172:175], v[124:127]
M v[124:127], a[88:91], a[168:171], v[124:127]
M v[128:131], a[32:35], a[160:163], v[128:131]
 ds_read_b128 a[168:171], v5 offset:18432
 ds_read_b128 a[172:175], v6 offset:18432
M v[128:131], a[36:39], a[164:167], v[128:131]
 ds_read_b64_tr_b16 a[136:137], v2 offset:49152
 ds_read_b64_tr_b16 a[138:139], v2 offset:50176
M v[132:135], a[44:47], a[164:167], v[132:135]
 buffer_load_dwordx4 v14, s[48:51], s22 offen offset:2048   lds
M v[132:135], a[40:43], a[160:163], v[132:135]
M v[136:139], a[48:51], a[160:163], v[136:139]
M v[136:139], a[52:55], a[164:167], v[136:139]
M v[140:143], a[60:63], a[164:167], v[140:143]
M v[140:143], a[56:59], a[160:163], v[140:143]
 ds_read_b64_tr_b16 a[140:141], v2 offset:57344
 ds_read_b64_tr_b16 a[142:143], v2 offset:58368
M v[144:147], a[64:67], a[160:163], v[144:147]
 buffer_load_dwordx4 v15, s[48:51], s22 offen offset:3072   lds
M v[144:147], a[68:71], a[164:167], v[144:147]
 s_add_u32 s22, s22, 2097152
M v[148:151], a[76:79], a[164:167], v[148:151]
M v[148:151], a[72:75], a[160:163], v[148:151]
M v[152:155], a[80:83], a[160:163], v[152:155]
M v[152:155], a[84:87], a[164:167], v[152:155]
 s_waitcnt lgkmcnt(4)
M v[156:159], a[92:95], a[164:167], v[156:159]
 s_add_u32 m0, s23, 32768
 ds_read_b64_tr_b16 a[144:145], v3 offset:49152
 ds_read_b64_tr_b16 a[146:147], v3 offset:50176
M v[156:159], a[88:91], a[160:163], v[156:159]
 buffer_load_dwordx4 v8, s[16:19], s21 offen offset:0  nt lds
M v[160:163], a[32:35], a[168:171], v[160:163]
 ds_read_b128 a[160:163], v5 offset:20480
 ds_read_b128 a[164:167], v6 offset:20480
M v[160:163], a[36:39], a[172:175], v[160:163]
M v[164:167], a[44:47], a[172:175], v[164:167]
M v[164:167], a[40:43], a[168:171], v[164:167]
M v[168:171], a[48:51], a[168:171], v[168:171]
M v[168:171], a[52:55], a[172:175], v[168:171]
 ds_read_b64_tr_b16 a[148:149], v3 offset:57344
 ds_read_b64_tr_b16 a[150:151], v3 offset:58368
M v[172:175], a[60:63], a[172:175], v[172:175]
 buffer_load_dwordx4 v9, s[16:19], s21 offen offset:1024  nt lds
M v[172:175], a[56:59], a[168:171], v[172:175]
M v[176:179], a[64:67], a[168:171], v[176:179]
M v[176:179], a[68:71], a[172:175], v[176:179]
M v[180:183], a[76:79], a[172:175], v[180:183]
M v[180:183], a[72:75], a[168:171], v[180:183]
M v[184:187], a[80:83], a[168:171], v[184:187]
 ds_read_b64_tr_b16 a[152:153], v4 offset:49152
 ds_read_b64_tr_b16 a[154:155], v4 offset:50176
M v[184:187], a[84:87], a[172:175], v[184:187]
 s_waitcnt lgkmcnt(4)
M v[188:191], a[92:95], a[172:175], v[188:191]
 buffer_load_dwordx4 v10, s[16:19], s21 offen offset:2048  nt lds
M v[188:191], a[88:91], a[168:171], v[188:191]
M v[192:195], a[32:35], a[160:163], v[192:195]
 ds_read_b128 a[168:171], v5 offset:22528
 ds_read_b128 a[172:175], v6 offset:22528
M v[192:195], a[36:39], a[164:167], v[192:195]
M v[196:199], a[44:47], a[164:167], v[196:199]
M v[196:199], a[40:43], a[160:163], v[196:199]
 ds_read_b64_tr_b16 a[156:157], v4 offset:57344
 ds_read_b64_tr_b16 a[158:159], v4 offset:58368
M v[200:203], a[48:51], a[160:163], v[200:203]
 buffer_load_dwordx4 v11, s[16:19], s21 offen offset:3072  nt lds
M v[200:203], a[52:55], a[164:167], v[200:203]
 s_add_u32 s21, s21, 128
M v[204:207], a[60:63], a[164:167], v[204:207]
M v[204:207], a[56:59], a[160:163], v[204:207]
M v[208:211], a[64:67], a[160:163], v[208:211]
M v[208:211], a[68:71], a[164:167], v[208:211]
M v[212:215], a[76:79], a[164:167], v[212:215]
M v[212:215], a[72:75], a[160:163], v[212:215]
M v[216:219], a[80:83], a[160:163], v[216:219]
M v[216:219], a[84:87], a[164:167], v[216:219]
 s_waitcnt lgkmcnt(2)
M v[220:223], a[92:95], a[164:167], v[220:223]
 s_waitcnt vmcnt(16) lgkmcnt(0)
M v[220:223], a[88:91], a[160:163], v[220:223]
 s_barrier
M v[224:227], a[32:35], a[168:171], v[224:227]
 ds_read_b128 a[160:163], v5 offset:32768
 ds_read_b128 a[164:167], v6 offset:32768
M v[224:227], a[36:39], a[172:175], v[224:227]
 v_cmp_ne_u32 vcc, 1, v17
M v[228:231], a[44:47], a[172:175], v[228:231]
 s_nop 0
M v[228:231], a[40:43], a[168:171], v[228:231]
 s_cbranch_vccnz L_zs1
L_zr1:
M v[232:235], a[48:51], a[168:171], v[232:235]
 buffer_load_dword a240, v24, s[32:35], 0 offen offset:1024
M v[232:235], a[52:55], a[172:175], v[232:235]
M v[236:239], a[60:63], a[172:175], v[236:239]
M v[236:239], a[56:59], a[168:171], v[236:239]
M v[240:243], a[64:67], a[168:171], v[240:243]
M v[240:243], a[68:71], a[172:175], v[240:243]
M v[244:247], a[76:79], a[172:175], v[244:247]
M v[244:247], a[72:75], a[168:171], v[244:247]
M v[248:251], a[80:83], a[168:171], v[248:251]
M v[248:251], a[84:87], a[172:175], v[248:251]
 s_waitcnt lgkmcnt(0)
M v[252:255], a[92:95], a[172:175], v[252:255]
M v[252:255], a[88:91], a[168:171], v[252:255]
M a[0:3], a[96:99], a[160:163], a[0:3]
 ds_read_b128 a[168:171], v5 offset:34816
 ds_read_b128 a[172:175], v6 offset:34816
M a[0:3], a[100:103], a[164:167], a[0:3]
 ds_read_b64_tr_b16 a[32:33], v1 offset:0
 ds_read_b64_tr_b16 a[34:35], v1 offset:1024
M a[4:7], a[108:111], a[164:167], a[4:7]
 s_add_u32 m0, s24, 16384
M a[4:7], a[104:107], a[160:163], a[4:7]
 buffer_load_dwordx4 v12, s[48:51], s22 offen offset:0   lds
M a[8:11], a[112:115], a[160:163], a[8:11]
M a[8:11], a[116:119], a[164:167], a[8:11]
M a[12:15], a[124:127], a[164:167], a[12:15]
 ds_read_b64_tr_b16 a[36:37], v1 offset:8192
 ds_read_b64_tr_b16 a[38:39], v1 offset:9216
M a[12:15], a[120:123], a[160:163], a[12:15]
M a[16:19], a[128:131], a[160:163], a[16:19]
 buffer_load_dwordx4 v13, s[48:51], s22 offen offset:1024   lds
M a[16:19], a[132:135], a[164:167], a[16:19]
M a[20:23], a[140:143], a[164:167], a[20:23]
M a[20:23], a[136:139], a[160:163], a[20:23]
 ds_read_b64_tr_b16 a[40:41], v2 offset:0
 ds_read_b64_tr_b16 a[42:43], v2 offset:1024
M a[24:27], a[144:147], a[160:163], a[24:27]
M a[24:27], a[148:151], a[164:167], a[24:27]
 s_waitcnt lgkmcnt(6)
M a[28:31], a[156:159], a[164:167], a[28:31]
 buffer_load_dwordx4 v14, s[48:51], s22 offen offset:2048   lds
M a[28:31], a[152:155], a[160:163], a[28:31]
M v[32:35], a[96:99], a[168:171], v[32:35]
 ds_read_b128 a[160:163], v5 offset:36864
 ds_read_b128 a[164:167], v6 offset:36864
M v[32:35], a[100:103], a[172:175], v[32:35]
 ds_read_b64_tr_b16 a[44:45], v2 offset:8192
 ds_read_b64_tr_b16 a[46:47], v2 offset:9216
M v[36:39], a[108:111], a[172:175], v[36:39]
 buffer_load_dwordx4 v15, s[48:51], s22 offen offset:3072   lds
M v[36:39], a[104:107], a[168:171], v[36:39]
 s_sub_u32 s22, s22, 2097024
M v[40:43], a[112:115], a[168:171], v[40:43]
M v[40:43], a[116:119], a[172:175], v[40:43]
 ds_read_b64_tr_b16 a[48:49], v3 offset:0
 ds_read_b64_tr_b16 a[50:51], v3 offset:1024
M v[44:47], a[124:127], a[172:175], v[44:47]
 s_add_u32 m0, s23, 49152
M v[44:47], a[120:123], a[168:171], v[44:47]
 buffer_load_dwordx4 v8, s[16:19], s21 offen offset:0  nt lds
M v[48:51], a[128:131], a[168:171], v[48:51]
M v[48:51], a[132:135], a[172:175], v[48:51]
M v[52:55], a[140:143], a[172:175], v[52:55]
 ds_read_b64_tr_b16 a[52:53], v3 offset:8192
 ds_read_b64_tr_b16 a[54:55], v3 offset:9216
M v[52:55], a[136:139], a[168:171], v[52:55]
M v[56:59], a[144:147], a[168:171], v[56:59]
 buffer_load_dwordx4 v9, s[16:19], s21 offen offset:1024  nt lds
M v[56:59], a[148:151], a[172:175], v[56:59]
 s_waitcnt lgkmcnt(6)
M v[60:63], a[156:159], a[172:175], v[60:63]
M v[60:63], a[152:155], a[168:171], v[60:63]
 ds_read_b64_tr_b16 a[56:57], v4 offset:0
 ds_read_b64_tr_b16 a[58:59], v4 offset:1024
M v[64:67], a[96:99], a[160:163], v[64:67]
 ds_read_b128 a[168:171], v5 offset:38912
 ds_read_b128 a[172:175], v6 offset:38912
M v[64:67], a[100:103], a[164:167], v[64:67]
 buffer_load_dwordx4 v10, s[16:19], s21 offen offset:2048  nt lds
M v[68:71], a[108:111], a[164:167], v[68:71]
M v[68:71], a[104:107], a[160:163], v[68:71]
M v[72:75], a[112:115], a[160:163], v[72:75]
 ds_read_b64_tr_b16 a[60:61], v4 offset:8192
 ds_read_b64_tr_b16 a[62:63], v4 offset:9216
M v[72:75], a[116:119], a[164:167], v[72:75]
M v[76:79], a[124:127], a[164:167], v[76:79]
 buffer_load_dwordx4 v11, s[16:19], s21 offen offset:3072  nt lds
M v[76:79], a[120:123], a[160:163], v[76:79]
 s_add_u32 s21, s21, 524160
M v[80:83], a[128:131], a[160:163], v[80:83]
M v[80:83], a[132:135], a[164:167], v[80:83]
M v[84:87], a[140:143], a[164:167], v[84:87]
M v[84:87], a[136:139], a[160:163], v[84:87]
 s_and_b32 s64, s42, 7
M v[88:91], a[144:147], a[160:163], v[88:91]
 s_lshl_b32 s72, s41, 3
 s_add_u32 s64, s64, s72
 s_lshl_b32 s64, s64, 2
M v[88:91], a[148:151], a[164:167], v[88:91]
 s_waitcnt lgkmcnt(2)
 s_add_u32 s64, s64, s20
 s_mul_i32 s67, s64, 7168
M v[92:95], a[156:159], a[164:167], v[92:95]
 s_waitcnt vmcnt(17) lgkmcnt(0)
 s_mul_i32 s86, s20, 7168
 s_add_u32 s86, s86, 131072
M v[92:95], a[152:155], a[160:163], v[92:95]
 s_barrier
M v[96:99], a[96:99], a[168:171], v[96:99]
 ds_read_b128 a[160:163], v5 offset:49152
 ds_read_b128 a[164:167], v6 offset:49152
M v[96:99], a[100:103], a[172:175], v[96:99]
M v[100:103], a[108:111], a[172:175], v[100:103]
 s_add_u32 m0, s24, 32768
 ds_read_b64_tr_b16 a[64:65], v1 offset:16384
 ds_read_b64_tr_b16 a[66:67], v1 offset:17408
M v[100:103], a[104:107], a[168:171], v[100:103]
 buffer_load_dwordx4 v12, s[48:51], s22 offen offset:0   lds
M v[104:107], a[112:115], a[168:171], v[104:107]
M v[104:107], a[116:119], a[172:175], v[104:107]
M v[108:111], a[124:127], a[172:175], v[108:111]
M v[108:111], a[120:123], a[168:171], v[108:111]
 buffer_load_dwordx4 v13, s[48:51], s22 offen offset:1024   lds
M v[112:115], a[128:131], a[168:171], v[112:115]
M v[112:115], a[132:135], a[172:175], v[112:115]
 ds_read_b64_tr_b16 a[68:69], v1 offset:24576
 ds_read_b64_tr_b16 a[70:71], v1 offset:25600
M v[116:119], a[140:143], a[172:175], v[116:119]
M v[116:119], a[136:139], a[168:171], v[116:119]
M v[120:123], a[144:147], a[168:171], v[120:123]
 buffer_load_dwordx4 v14, s[48:51], s22 offen offset:2048   lds
M v[120:123], a[148:151], a[172:175], v[120:123]
 s_waitcnt lgkmcnt(4)
M v[124:127], a[156:159], a[172:175], v[124:127]
M v[124:127], a[152:155], a[168:171], v[124:127]
M v[128:131], a[96:99], a[160:163], v[128:131]
 ds_read_b128 a[168:171], v5 offset:51200
 ds_read_b128 a[172:175], v6 offset:51200
M v[128:131], a[100:103], a[164:167], v[128:131]
 ds_read_b64_tr_b16 a[72:73], v2 offset:16384
 ds_read_b64_tr_b16 a[74:75], v2 offset:17408
M v[132:135], a[108:111], a[164:167], v[132:135]
 buffer_load_dwordx4 v15, s[48:51], s22 offen offset:3072   lds
M v[132:135], a[104:107], a[160:163], v[132:135]
 s_add_u32 s22, s22, 2097152
M v[136:139], a[112:115], a[160:163], v[136:139]
M v[136:139], a[116:119], a[164:167], v[136:139]
 s_add_u32 m0, s23, 0
M v[140:143], a[124:127], a[164:167], v[140:143]
 buffer_load_dwordx4 v8, s[16:19], s21 offen offset:0  nt lds
M v[140:143], a[120:123], a[160:163], v[140:143]
 ds_read_b64_tr_b16 a[76:77], v2 offset:24576
 ds_read_b64_tr_b16 a[78:79], v2 offset:25600
M v[144:147], a[128:131], a[160:163], v[144:147]
M v[144:147], a[132:135], a[164:167], v[144:147]
M v[148:151], a[140:143], a[164:167], v[148:151]
 buffer_load_dwordx4 v9, s[16:19], s21 offen offset:1024  nt lds
M v[148:151], a[136:139], a[160:163], v[148:151]
M v[152:155], a[144:147], a[160:163], v[152:155]
M v[152:155], a[148:151], a[164:167], v[152:155]
 s_waitcnt lgkmcnt(4)
M v[156:159], a[156:159], a[164:167], v[156:159]
 ds_read_b64_tr_b16 a[80:81], v3 offset:16384
 ds_read_b64_tr_b16 a[82:83], v3 offset:17408
M v[156:159], a[152:155], a[160:163], v[156:159]
 buffer_load_dwordx4 v10, s[16:19], s21 offen offset:2048  nt lds
M v[160:163], a[96:99], a[168:171], v[160:163]
 ds_read_b128 a[160:163], v5 offset:53248
 ds_read_b128 a[164:167], v6 offset:53248
M v[160:163], a[100:103], a[172:175], v[160:163]
M v[164:167], a[108:111], a[172:175], v[164:167]
M v[164:167], a[104:107], a[168:171], v[164:167]
M v[168:171], a[112:115], a[168:171], v[168:171]
 buffer_load_dwordx4 v11, s[16:19], s21 offen offset:3072  nt lds
M v[168:171], a[116:119], a[172:175], v[168:171]
 s_add_u32 s21, s21, 128
 ds_read_b64_tr_b16 a[84:85], v3 offset:24576
 ds_read_b64_tr_b16 a[86:87], v3 offset:25600
M v[172:175], a[124:127], a[172:175], v[172:175]
M v[172:175], a[120:123], a[168:171], v[172:175]
M v[176:179], a[128:131], a[168:171], v[176:179]
 s_add_u32 m0, s86, 0
M v[176:179], a[132:135], a[172:175], v[176:179]
 buffer_load_dwordx4 v7, s[60:63], s67 offen offset:0 nt lds
M v[180:183], a[140:143], a[172:175], v[180:183]
M v[180:183], a[136:139], a[168:171], v[180:183]
M v[184:187], a[144:147], a[168:171], v[184:187]
 ds_read_b64_tr_b16 a[88:89], v4 offset:16384
 ds_read_b64_tr_b16 a[90:91], v4 offset:17408
M v[184:187], a[148:151], a[172:175], v[184:187]
 s_waitcnt lgkmcnt(4)
M v[188:191], a[156:159], a[172:175], v[188:191]
 buffer_load_dwordx4 v7, s[60:63], s67 offen offset:1024 nt lds
M v[188:191], a[152:155], a[168:171], v[188:191]
M v[192:195], a[96:99], a[160:163], v[192:195]
 ds_read_b128 a[168:171], v5 offset:55296
 ds_read_b128 a[172:175], v6 offset:55296
M v[192:195], a[100:103], a[164:167], v[192:195]
M v[196:199], a[108:111], a[164:167], v[196:199]
 buffer_load_dwordx4 v7, s[60:63], s67 offen offset:2048 nt lds
M v[196:199], a[104:107], a[160:163], v[196:199]
 ds_read_b64_tr_b16 a[92:93], v4 offset:24576
 ds_read_b64_tr_b16 a[94:95], v4 offset:25600
M v[200:203], a[112:115], a[160:163], v[200:203]
M v[200:203], a[116:119], a[164:167], v[200:203]
M v[204:207], a[124:127], a[164:167], v[204:207]
M v[204:207], a[120:123], a[160:163], v[204:207]
 buffer_load_dwordx4 v7, s[60:63], s67 offen offset:3072 nt lds
M v[208:211], a[128:131], a[160:163], v[208:211]
 s_add_u32 s67, s67, 4096
M v[208:211], a[132:135], a[164:167], v[208:211]
M v[212:215], a[140:143], a[164:167], v[212:215]
M v[212:215], a[136:139], a[160:163], v[212:215]
M v[216:219], a[144:147], a[160:163], v[216:219]
M v[216:219], a[148:151], a[164:167], v[216:219]
 s_waitcnt lgkmcnt(2)
M v[220:223], a[156:159], a[164:167], v[220:223]
 s_waitcnt vmcnt(21) lgkmcnt(0)
M v[220:223], a[152:155], a[160:163], v[220:223]
 s_barrier
M v[224:227], a[96:99], a[168:171], v[224:227]
 ds_read_b128 a[160:163], v5 offset:0
 ds_read_b128 a[164:167], v6 offset:0
M v[224:227], a[100:103], a[172:175], v[224:227]
M v[228:231], a[108:111], a[172:175], v[228:231]
M v[228:231], a[104:107], a[168:171], v[228:231]
M v[232:235], a[112:115], a[168:171], v[232:235]
M v[232:235], a[116:119], a[172:175], v[232:235]
M v[236:239], a[124:127], a[172:175], v[236:239]
M v[236:239], a[120:123], a[168:171], v[236:239]
M v[240:243], a[128:131], a[168:171], v[240:243]
M v[240:243], a[132:135], a[172:175], v[240:243]
M v[244:247], a[140:143], a[172:175], v[244:247]
M v[244:247], a[136:139], a[168:171], v[244:247]
M v[248:251], a[144:147], a[168:171], v[248:251]
M v[248:251], a[148:151], a[172:175], v[248:251]
 s_waitcnt lgkmcnt(0)
M v[252:255], a[156:159], a[172:175], v[252:255]
M v[252:255], a[152:155], a[168:171], v[252:255]
M a[0:3], a[32:35], a[160:163], a[0:3]
 ds_read_b128 a[168:171], v5 offset:2048
 ds_read_b128 a[172:175], v6 offset:2048
M a[0:3], a[36:39], a[164:167], a[0:3]
 ds_read_b64_tr_b16 a[96:97], v1 offset:32768
 ds_read_b64_tr_b16 a[98:99], v1 offset:33792
M a[4:7], a[44:47], a[164:167], a[4:7]
 s_add_u32 m0, s24, 49152
M a[4:7], a[40:43], a[160:163], a[4:7]
 buffer_load_dwordx4 v12, s[48:51], s22 offen offset:0   lds
M a[8:11], a[48:51], a[160:163], a[8:11]
M a[8:11], a[52:55], a[164:167], a[8:11]
M a[12:15], a[60:63], a[164:167], a[12:15]
 ds_read_b64_tr_b16 a[100:101], v1 offset:40960
 ds_read_b64_tr_b16 a[102:103], v1 offset:41984
M a[12:15], a[56:59], a[160:163], a[12:15]
M a[16:19], a[64:67], a[160:163], a[16:19]
 buffer_load_dwordx4 v13, s[48:51], s22 offen offset:1024   lds
M a[16:19], a[68:71], a[164:167], a[16:19]
M a[20:23], a[76:79], a[164:167], a[20:23]
M a[20:23], a[72:75], a[160:163], a[20:23]
 ds_read_b64_tr_b16 a[104:105], v2 offset:32768
 ds_read_b64_tr_b16 a[106:107], v2 offset:33792
M a[24:27], a[80:83], a[160:163], a[24:27]
M a[24:27], a[84:87], a[164:167], a[24:27]
 s_waitcnt lgkmcnt(6)
M a[28:31], a[92:95], a[164:167], a[28:31]
 buffer_load_dwordx4 v14, s[48:51], s22 offen offset:2048   lds
M a[28:31], a[88:91], a[160:163], a[28:31]
M v[32:35], a[32:35], a[168:171], v[32:35]
 ds_read_b128 a[160:163], v5 offset:4096
 ds_read_b128 a[164:167], v6 offset:4096
M v[32:35], a[36:39], a[172:175], v[32:35]
 ds_read_b64_tr_b16 a[108:109], v2 offset:40960
 ds_read_b64_tr_b16 a[110:111], v2 offset:41984
M v[36:39], a[44:47], a[172:175], v[36:39]
 buffer_load_dwordx4 v15, s[48:51], s22 offen offset:3072   lds
M v[36:39], a[40:43], a[168:171], v[36:39]
 s_sub_u32 s22, s22, 2097024
M v[40:43], a[48:51], a[168:171], v[40:43]
M v[40:43], a[52:55], a[172:175], v[40:43]
 ds_read_b64_tr_b16 a[112:113], v3 offset:32768
 ds_read_b64_tr_b16 a[114:115], v3 offset:33792
M v[44:47], a[60:63], a[172:175], v[44:47]
 s_add_u32 m0, s23, 16384
M v[44:47], a[56:59], a[168:171], v[44:47]
 buffer_load_dwordx4 v8, s[16:19], s21 offen offset:0  nt lds
M v[48:51], a[64:67], a[168:171], v[48:51]
M v[48:51], a[68:71], a[172:175], v[48:51]
M v[52:55], a[76:79], a[172:175], v[52:55]
 ds_read_b64_tr_b16 a[116:117], v3 offset:40960
 ds_read_b64_tr_b16 a[118:119], v3 offset:41984
M v[52:55], a[72:75], a[168:171], v[52:55]
M v[56:59], a[80:83], a[168:171], v[56:59]
 buffer_load_dwordx4 v9, s[16:19], s21 offen offset:1024  nt lds
M v[56:59], a[84:87], a[172:175], v[56:59]
 s_waitcnt lgkmcnt(6)
M v[60:63], a[92:95], a[172:175], v[60:63]
M v[60:63], a[88:91], a[168:171], v[60:63]
 ds_read_b64_tr_b16 a[120:121], v4 offset:32768
 ds_read_b64_tr_b16 a[122:123], v4 offset:33792
M v[64:67], a[32:35], a[160:163], v[64:67]
 ds_read_b128 a[168:171], v5 offset:6144
 ds_read_b128 a[172:175], v6 offset:6144
M v[64:67], a[36:39], a[164:167], v[64:67]
 buffer_load_dwordx4 v10, s[16:19], s21 offen offset:2048  nt lds
M v[68:71], a[44:47], a[164:167], v[68:71]
M v[68:71], a[40:43], a[160:163], v[68:71]
M v[72:75], a[48:51], a[160:163], v[72:75]
 ds_read_b64_tr_b16 a[124:125], v4 offset:40960
 ds_read_b64_tr_b16 a[126:127], v4 offset:41984
M v[72:75], a[52:55], a[164:167], v[72:75]
M v[76:79], a[60:63], a[164:167], v[76:79]
 buffer_load_dwordx4 v11, s[16:19], s21 offen offset:3072  nt lds
M v[76:79], a[56:59], a[160:163], v[76:79]
 s_add_u32 s21, s21, 524160
M v[80:83], a[64:67], a[160:163], v[80:83]
M v[80:83], a[68:71], a[164:167], v[80:83]
M v[84:87], a[76:79], a[164:167], v[84:87]
M v[84:87], a[72:75], a[160:163], v[84:87]
M v[88:91], a[80:83], a[160:163], v[88:91]
M v[88:91], a[84:87], a[164:167], v[88:91]
 s_waitcnt lgkmcnt(2)
M v[92:95], a[92:95], a[164:167], v[92:95]
 s_waitcnt vmcnt(20) lgkmcnt(0)
M v[92:95], a[88:91], a[160:163], v[92:95]
 s_barrier
M v[96:99], a[32:35], a[168:171], v[96:99]
 ds_read_b128 a[160:163], v5 offset:16384
 ds_read_b128 a[164:167], v6 offset:16384
M v[96:99], a[36:39], a[172:175], v[96:99]
M v[100:103], a[44:47], a[172:175], v[100:103]
 s_add_u32 m0, s24, 0
 ds_read_b64_tr_b16 a[128:129], v1 offset:49152
 ds_read_b64_tr_b16 a[130:131], v1 offset:50176
M v[100:103], a[40:43], a[168:171], v[100:103]
 buffer_load_dwordx4 v12, s[48:51], s22 offen offset:0   lds
M v[104:107], a[48:51], a[168:171], v[104:107]
M v[104:107], a[52:55], a[172:175], v[104:107]
M v[108:111], a[60:63], a[172:175], v[108:111]
M v[108:111], a[56:59], a[168:171], v[108:111]
M v[112:115], a[64:67], a[168:171], v[112:115]
 buffer_load_dwordx4 v13, s[48:51], s22 offen offset:1024   lds
M v[112:115], a[68:71], a[172:175], v[112:115]
 ds_read_b64_tr_b16 a[132:133], v1 offset:57344
 ds_read_b64_tr_b16 a[134:135], v1 offset:58368
M v[116:119], a[76:79], a[172:175], v[116:119]
M v[116:119], a[72:75], a[168:171], v[116:119]
M v[120:123], a[80:83], a[168:171], v[120:123]
M v[120:123], a[84:87], a[172:175], v[120:123]
 s_waitcnt lgkmcnt(4)
M v[124:127], a[92:95], a[172:175], v[124:127]
 buffer_load_dwordx4 v14, s[48:51], s22 offen offset:2048   lds
M v[124:127], a[88:91], a[168:171], v[124:127]
M v[128:131], a[32:35], a[160:163], v[128:131]
 ds_read_b128 a[168:171], v5 offset:18432
 ds_read_b128 a[172:175], v6 offset:18432
M v[128:131], a[36:39], a[164:167], v[128:131]
 ds_read_b64_tr_b16 a[136:137], v2 offset:49152
 ds_read_b64_tr_b16 a[138:139], v2 offset:50176
M v[132:135], a[44:47], a[164:167], v[132:135]
 buffer_load_dwordx4 v15, s[48:51], s22 offen offset:3072   lds
M v[132:135], a[40:43], a[160:163], v[132:135]
 s_add_u32 s22, s22, 2097152
M v[136:139], a[48:51], a[160:163], v[136:139]
M v[136:139], a[52:55], a[164:167], v[136:139]
M v[140:143], a[60:63], a[164:167], v[140:143]
 s_add_u32 m0, s23, 32768
M v[140:143], a[56:59], a[160:163], v[140:143]
 ds_read_b64_tr_b16 a[140:141], v2 offset:57344
 ds_read_b64_tr_b16 a[142:143], v2 offset:58368
M v[144:147], a[64:67], a[160:163], v[144:147]
 buffer_load_dwordx4 v8, s[16:19], s21 offen offset:0  nt lds
M v[144:147], a[68:71], a[164:167], v[144:147]
M v[148:151], a[76:79], a[164:167], v[148:151]
M v[148:151], a[72:75], a[160:163], v[148:151]
M v[152:155], a[80:83], a[160:163], v[152:155]
 buffer_load_dwordx4 v9, s[16:19], s21 offen offset:1024  nt lds
M v[152:155], a[84:87], a[164:167], v[152:155]
 s_waitcnt lgkmcnt(4)
M v[156:159], a[92:95], a[164:167], v[156:159]
 ds_read_b64_tr_b16 a[144:145], v3 offset:49152
 ds_read_b64_tr_b16 a[146:147], v3 offset:50176
M v[156:159], a[88:91], a[160:163], v[156:159]
M v[160:163], a[32:35], a[168:171], v[160:163]
 ds_read_b128 a[160:163], v5 offset:20480
 ds_read_b128 a[164:167], v6 offset:20480
M v[160:163], a[36:39], a[172:175], v[160:163]
M v[164:167], a[44:47], a[172:175], v[164:167]
 buffer_load_dwordx4 v10, s[16:19], s21 offen offset:2048  nt lds
M v[164:167], a[40:43], a[168:171], v[164:167]
M v[168:171], a[48:51], a[168:171], v[168:171]
M v[168:171], a[52:55], a[172:175], v[168:171]
 ds_read_b64_tr_b16 a[148:149], v3 offset:57344
 ds_read_b64_tr_b16 a[150:151], v3 offset:58368
M v[172:175], a[60:63], a[172:175], v[172:175]
M v[172:175], a[56:59], a[168:171], v[172:175]
 buffer_load_dwordx4 v11, s[16:19], s21 offen offset:3072  nt lds
M v[176:179], a[64:67], a[168:171], v[176:179]
 s_add_u32 s21, s21, 128
M v[176:179], a[68:71], a[172:175], v[176:179]
M v[180:183], a[76:79], a[172:175], v[180:183]
M v[180:183], a[72:75], a[168:171], v[180:183]
 s_add_u32 m0, s86, 4096
M v[184:187], a[80:83], a[168:171], v[184:187]
 ds_read_b64_tr_b16 a[152:153], v4 offset:49152
 ds_read_b64_tr_b16 a[154:155], v4 offset:50176
M v[184:187], a[84:87], a[172:175], v[184:187]
 s_waitcnt lgkmcnt(4)
M v[188:191], a[92:95], a[172:175], v[188:191]
 buffer_load_dwordx4 v7, s[60:63], s67 offen offset:0 nt lds
M v[188:191], a[88:91], a[168:171], v[188:191]
M v[192:195], a[32:35], a[160:163], v[192:195]
 ds_read_b128 a[168:171], v5 offset:22528
 ds_read_b128 a[172:175], v6 offset:22528
M v[192:195], a[36:39], a[164:167], v[192:195]
 buffer_load_dwordx4 v7, s[60:63], s67 offen offset:1024 nt lds
M v[196:199], a[44:47], a[164:167], v[196:199]
M v[196:199], a[40:43], a[160:163], v[196:199]
 ds_read_b64_tr_b16 a[156:157], v4 offset:57344
 ds_read_b64_tr_b16 a[158:159], v4 offset:58368
M v[200:203], a[48:51], a[160:163], v[200:203]
M v[200:203], a[52:55], a[164:167], v[200:203]
M v[204:207], a[60:63], a[164:167], v[204:207]
 buffer_load_dwordx4 v7, s[60:63], s67 offen offset:2048 nt lds
M v[204:207], a[56:59], a[160:163], v[204:207]
 s_add_u32 s67, s67, 4096
M v[208:211], a[64:67], a[160:163], v[208:211]
M v[208:211], a[68:71], a[164:167], v[208:211]
M v[212:215], a[76:79], a[164:167], v[212:215]
M v[212:215], a[72:75], a[160:163], v[212:215]
M v[216:219], a[80:83], a[160:163], v[216:219]
M v[216:219], a[84:87], a[164:167], v[216:219]
 s_waitcnt lgkmcnt(2)
M v[220:223], a[92:95], a[164:167], v[220:223]
 s_waitcnt vmcnt(23) lgkmcnt(0)
M v[220:223], a[88:91], a[160:163], v[220:223]
 s_barrier
M v[224:227], a[32:35], a[168:171], v[224:227]
 ds_read_b128 a[160:163], v5 offset:32768
 ds_read_b128 a[164:167], v6 offset:32768
M v[224:227], a[36:39], a[172:175], v[224:227]
 v_and_b32 v26, 48, v0
 v_lshlrev_b32 v26, 17, v26
M v[228:231], a[44:47], a[172:175], v[228:231]
 v_or_b32 v26, v26, v0
 v_lshl_add_u32 v26, v26, 7, s95
M v[228:231], a[40:43], a[168:171], v[228:231]
 buffer_load_dword a240, v26, s[76:79], 0 offen offset:0
M v[232:235], a[48:51], a[168:171], v[232:235]
M v[232:235], a[52:55], a[172:175], v[232:235]
M v[236:239], a[60:63], a[172:175], v[236:239]
M v[236:239], a[56:59], a[168:171], v[236:239]
M v[240:243], a[64:67], a[168:171], v[240:243]
M v[240:243], a[68:71], a[172:175], v[240:243]
M v[244:247], a[76:79], a[172:175], v[244:247]
M v[244:247], a[72:75], a[168:171], v[244:247]
M v[248:251], a[80:83], a[168:171], v[248:251]
M v[248:251], a[84:87], a[172:175], v[248:251]
 s_waitcnt lgkmcnt(0)
M v[252:255], a[92:95], a[172:175], v[252:255]
M v[252:255], a[88:91], a[168:171], v[252:255]
M a[0:3], a[96:99], a[160:163], a[0:3]
 ds_read_b128 a[168:171], v5 offset:34816
 ds_read_b128 a[172:175], v6 offset:34816
M a[0:3], a[100:103], a[164:167], a[0:3]
 ds_read_b64_tr_b16 a[32:33], v1 offset:0
 ds_read_b64_tr_b16 a[34:35], v1 offset:1024
M a[4:7], a[108:111], a[164:167], a[4:7]
 s_add_u32 m0, s24, 16384
M a[4:7], a[104:107], a[160:163], a[4:7]
 buffer_load_dwordx4 v12, s[48:51], s22 offen offset:0   lds
M a[8:11], a[112:115], a[160:163], a[8:11]
M a[8:11], a[116:119], a[164:167], a[8:11]
M a[12:15], a[124:127], a[164:167], a[12:15]
 ds_read_b64_tr_b16 a[36:37], v1 offset:8192
 ds_read_b64_tr_b16 a[38:39], v1 offset:9216
M a[12:15], a[120:123], a[160:163], a[12:15]
M a[16:19], a[128:131], a[160:163], a[16:19]
 buffer_load_dwordx4 v13, s[48:51], s22 offen offset:1024   lds
M a[16:19], a[132:135], a[164:167], a[16:19]
M a[20:23], a[140:143], a[164:167], a[20:23]
M a[20:23], a[136:139], a[160:163], a[20:23]
 ds_read_b64_tr_b16 a[40:41], v2 offset:0
 ds_read_b64_tr_b16 a[42:43], v2 offset:1024
M a[24:27], a[144:147], a[160:163], a[24:27]
M a[24:27], a[148:151], a[164:167], a[24:27]
 s_waitcnt lgkmcnt(6)
M a[28:31], a[156:159], a[164:167], a[28:31]
 buffer_load_dwordx4 v14, s[48:51], s22 offen offset:2048   lds
M a[28:31], a[152:155], a[160:163], a[28:31]
M v[32:35], a[96:99], a[168:171], v[32:35]
 ds_read_b128 a[160:163], v5 offset:36864
 ds_read_b128 a[164:167], v6 offset:36864
M v[32:35], a[100:103], a[172:175], v[32:35]
 ds_read_b64_tr_b16 a[44:45], v2 offset:8192
 ds_read_b64_tr_b16 a[46:47], v2 offset:9216
M v[36:39], a[108:111], a[172:175], v[36:39]
 buffer_load_dwordx4 v15, s[48:51], s22 offen offset:3072   lds
M v[36:39], a[104:107], a[168:171], v[36:39]
 s_sub_u32 s22, s22, 2097024
M v[40:43], a[112:115], a[168:171], v[40:43]
M v[40:43], a[116:119], a[172:175], v[40:43]
 ds_read_b64_tr_b16 a[48:49], v3 offset:0
 ds_read_b64_tr_b16 a[50:51], v3 offset:1024
M v[44:47], a[124:127], a[172:175], v[44:47]
 s_add_u32 m0, s23, 49152
M v[44:47], a[120:123], a[168:171], v[44:47]
 buffer_load_dwordx4 v8, s[16:19], s21 offen offset:0  nt lds
M v[48:51], a[128:131], a[168:171], v[48:51]
M v[48:51], a[132:135], a[172:175], v[48:51]
M v[52:55], a[140:143], a[172:175], v[52:55]
 ds_read_b64_tr_b16 a[52:53], v3 offset:8192
 ds_read_b64_tr_b16 a[54:55], v3 offset:9216
M v[52:55], a[136:139], a[168:171], v[52:55]
M v[56:59], a[144:147], a[168:171], v[56:59]
 buffer_load_dwordx4 v9, s[16:19], s21 offen offset:1024  nt lds
M v[56:59], a[148:151], a[172:175], v[56:59]
 s_waitcnt lgkmcnt(6)
M v[60:63], a[156:159], a[172:175], v[60:63]
M v[60:63], a[152:155], a[168:171], v[60:63]
 ds_read_b64_tr_b16 a[56:57], v4 offset:0
 ds_read_b64_tr_b16 a[58:59], v4 offset:1024
M v[64:67], a[96:99], a[160:163], v[64:67]
 ds_read_b128 a[168:171], v5 offset:38912
 ds_read_b128 a[172:175], v6 offset:38912
M v[64:67], a[100:103], a[164:167], v[64:67]
 buffer_load_dwordx4 v10, s[16:19], s21 offen offset:2048  nt lds
M v[68:71], a[108:111], a[164:167], v[68:71]
M v[68:71], a[104:107], a[160:163], v[68:71]
M v[72:75], a[112:115], a[160:163], v[72:75]
 ds_read_b64_tr_b16 a[60:61], v4 offset:8192
 ds_read_b64_tr_b16 a[62:63], v4 offset:9216
M v[72:75], a[116:119], a[164:167], v[72:75]
M v[76:79], a[124:127], a[164:167], v[76:79]
 buffer_load_dwordx4 v11, s[16:19], s21 offen offset:3072  nt lds
M v[76:79], a[120:123], a[160:163], v[76:79]
 s_add_u32 s21, s21, 524160
M v[80:83], a[128:131], a[160:163], v[80:83]
M v[80:83], a[132:135], a[164:167], v[80:83]
M v[84:87], a[140:143], a[164:167], v[84:87]
M v[84:87], a[136:139], a[160:163], v[84:87]
M v[88:91], a[144:147], a[160:163], v[88:91]
M v[88:91], a[148:151], a[164:167], v[88:91]
 s_waitcnt lgkmcnt(2)
M v[92:95], a[156:159], a[164:167], v[92:95]
 s_waitcnt vmcnt(20) lgkmcnt(0)
M v[92:95], a[152:155], a[160:163], v[92:95]
 s_barrier
M v[96:99], a[96:99], a[168:171], v[96:99]
 ds_read_b128 a[160:163], v5 offset:49152
 ds_read_b128 a[164:167], v6 offset:49152
M v[96:99], a[100:103], a[172:175], v[96:99]
M v[100:103], a[108:111], a[172:175], v[100:103]
 s_add_u32 m0, s24, 32768
 ds_read_b64_tr_b16 a[64:65], v1 offset:16384
 ds_read_b64_tr_b16 a[66:67], v1 offset:17408
M v[100:103], a[104:107], a[168:171], v[100:103]
 buffer_load_dwordx4 v12, s[48:51], s22 offen offset:0   lds
M v[104:107], a[112:115], a[168:171], v[104:107]
M v[104:107], a[116:119], a[172:175], v[104:107]
M v[108:111], a[124:127], a[172:175], v[108:111]
M v[108:111], a[120:123], a[168:171], v[108:111]
M v[112:115], a[128:131], a[168:171], v[112:115]
M v[112:115], a[132:135], a[172:175], v[112:115]
 ds_read_b64_tr_b16 a[68:69], v1 offset:24576
 ds_read_b64_tr_b16 a[70:71], v1 offset:25600
M v[116:119], a[140:143], a[172:175], v[116:119]
 buffer_load_dwordx4 v13, s[48:51], s22 offen offset:1024   lds
M v[116:119], a[136:139], a[168:171], v[116:119]
M v[120:123], a[144:147], a[168:171], v[120:123]
M v[120:123], a[148:151], a[172:175], v[120:123]
 s_waitcnt lgkmcnt(4)
M v[124:127], a[156:159], a[172:175], v[124:127]
M v[124:127], a[152:155], a[168:171], v[124:127]
M v[128:131], a[96:99], a[160:163], v[128:131]
 ds_read_b128 a[168:171], v5 offset:51200
 ds_read_b128 a[172:175], v6 offset:51200
M v[128:131], a[100:103], a[164:167], v[128:131]
 ds_read_b64_tr_b16 a[72:73], v2 offset:16384
 ds_read_b64_tr_b16 a[74:75], v2 offset:17408
M v[132:135], a[108:111], a[164:167], v[132:135]
 buffer_load_dwordx4 v14, s[48:51], s22 offen offset:2048   lds
M v[132:135], a[104:107], a[160:163], v[132:135]
M v[136:139], a[112:115], a[160:163], v[136:139]
M v[136:139], a[116:119], a[164:167], v[136:139]
M v[140:143], a[124:127], a[164:167], v[140:143]
M v[140:143], a[120:123], a[160:163], v[140:143]
 ds_read_b64_tr_b16 a[76:77], v2 offset:24576
 ds_read_b64_tr_b16 a[78:79], v2 offset:25600
M v[144:147], a[128:131], a[160:163], v[144:147]
 buffer_load_dwordx4 v15, s[48:51], s22 offen offset:3072   lds
M v[144:147], a[132:135], a[164:167], v[144:147]
 s_add_u32 s22, s22, 2097152
M v[148:151], a[140:143], a[164:167], v[148:151]
M v[148:151], a[136:139], a[160:163], v[148:151]
M v[152:155], a[144:147], a[160:163], v[152:155]
M v[152:155], a[148:151], a[164:167], v[152:155]
 s_waitcnt lgkmcnt(4)
M v[156:159], a[156:159], a[164:167], v[156:159]
 s_add_u32 m0, s23, 0
 ds_read_b64_tr_b16 a[80:81], v3 offset:16384
 ds_read_b64_tr_b16 a[82:83], v3 offset:17408
M v[156:159], a[152:155], a[160:163], v[156:159]
 buffer_load_dwordx4 v8, s[16:19], s21 offen offset:0  nt lds
M v[160:163], a[96:99], a[168:171], v[160:163]
 ds_read_b128 a[160:163], v5 offset:53248
 ds_read_b128 a[164:167], v6 offset:53248
M v[160:163], a[100:103], a[172:175], v[160:163]
M v[164:167], a[108:111], a[172:175], v[164:167]
M v[164:167], a[104:107], a[168:171], v[164:167]
M v[168:171], a[112:115], a[168:171], v[168:171]
M v[168:171], a[116:119], a[172:175], v[168:171]
 ds_read_b64_tr_b16 a[84:85], v3 offset:24576
 ds_read_b64_tr_b16 a[86:87], v3 offset:25600
M v[172:175], a[124:127], a[172:175], v[172:175]
 buffer_load_dwordx4 v9, s[16:19], s21 offen offset:1024  nt lds
M v[172:175], a[120:123], a[168:171], v[172:175]
M v[176:179], a[128:131], a[168:171], v[176:179]
M v[176:179], a[132:135], a[172:175], v[176:179]
M v[180:183], a[140:143], a[172:175], v[180:183]
M v[180:183], a[136:139], a[168:171], v[180:183]
M v[184:187], a[144:147], a[168:171], v[184:187]
 ds_read_b64_tr_b16 a[88:89], v4 offset:16384
 ds_read_b64_tr_b16 a[90:91], v4 offset:17408
M v[184:187], a[148:151], a[172:175], v[184:187]
 s_waitcnt lgkmcnt(4)
M v[188:191], a[156:159], a[172:175], v[188:191]
 buffer_load_dwordx4 v10, s[16:19], s21 offen offset:2048  nt lds
M v[188:191], a[152:155], a[168:171], v[188:191]
M v[192:195], a[96:99], a[160:163], v[192:195]
 ds_read_b128 a[168:171], v5 offset:55296
 ds_read_b128 a[172:175], v6 offset:55296
M v[192:195], a[100:103], a[164:167], v[192:195]
M v[196:199], a[108:111], a[164:167], v[196:199]
M v[196:199], a[104:107], a[160:163], v[196:199]
 ds_read_b64_tr_b16 a[92:93], v4 offset:24576
 ds_read_b64_tr_b16 a[94:95], v4 offset:25600
M v[200:203], a[112:115], a[160:163], v[200:203]
 buffer_load_dwordx4 v11, s[16:19], s21 offen offset:3072  nt lds
M v[200:203], a[116:119], a[164:167], v[200:203]
 s_add_u32 s21, s21, 128
M v[204:207], a[124:127], a[164:167], v[204:207]
M v[204:207], a[120:123], a[160:163], v[204:207]
M v[208:211], a[128:131], a[160:163], v[208:211]
M v[208:211], a[132:135], a[164:167], v[208:211]
M v[212:215], a[140:143], a[164:167], v[212:215]
M v[212:215], a[136:139], a[160:163], v[212:215]
M v[216:219], a[144:147], a[160:163], v[216:219]
M v[216:219], a[148:151], a[164:167], v[216:219]
 s_waitcnt lgkmcnt(2)
M v[220:223], a[156:159], a[164:167], v[220:223]
 s_waitcnt vmcnt(17) lgkmcnt(0)
M v[220:223], a[152:155], a[160:163], v[220:223]
 s_barrier
M v[224:227], a[96:99], a[168:171], v[224:227]
 ds_read_b128 a[160:163], v5 offset:0
 ds_read_b128 a[164:167], v6 offset:0
M v[224:227], a[100:103], a[172:175], v[224:227]
M v[228:231], a[108:111], a[172:175], v[228:231]
M v[228:231], a[104:107], a[168:171], v[228:231]
M v[232:235], a[112:115], a[168:171], v[232:235]
M v[232:235], a[116:119], a[172:175], v[232:235]
M v[236:239], a[124:127], a[172:175], v[236:239]
M v[236:239], a[120:123], a[168:171], v[236:239]
M v[240:243], a[128:131], a[168:171], v[240:243]
M v[240:243], a[132:135], a[172:175], v[240:243]
M v[244:247], a[140:143], a[172:175], v[244:247]
M v[244:247], a[136:139], a[168:171], v[244:247]
M v[248:251], a[144:147], a[168:171], v[248:251]
M v[248:251], a[148:151], a[172:175], v[248:251]
 s_waitcnt lgkmcnt(0)
M v[252:255], a[156:159], a[172:175], v[252:255]
M v[252:255], a[152:155], a[168:171], v[252:255]
M a[0:3], a[32:35], a[160:163], a[0:3]
 ds_read_b128 a[168:171], v5 offset:2048
 ds_read_b128 a[172:175], v6 offset:2048
M a[0:3], a[36:39], a[164:167], a[0:3]
 ds_read_b64_tr_b16 a[96:97], v1 offset:32768
 ds_read_b64_tr_b16 a[98:99], v1 offset:33792
M a[4:7], a[44:47], a[164:167], a[4:7]
 s_add_u32 m0, s24, 49152
 v_lshrrev_b32 v28, 2, v0
M a[4:7], a[40:43], a[160:163], a[4:7]
 buffer_load_dwordx4 v12, s[48:51], s22 offen offset:0   lds
M a[8:11], a[48:51], a[160:163], a[8:11]
 v_mul_u32_u24 v28, 896, v28
M a[8:11], a[52:55], a[164:167], a[8:11]
M a[12:15], a[60:63], a[164:167], a[12:15]
 ds_read_b64_tr_b16 a[100:101], v1 offset:40960
 ds_read_b64_tr_b16 a[102:103], v1 offset:41984
M a[12:15], a[56:59], a[160:163], a[12:15]
 v_and_b32 v29, 3, v0
M a[16:19], a[64:67], a[160:163], a[16:19]
 buffer_load_dwordx4 v13, s[48:51], s22 offen offset:1024   lds
M a[16:19], a[68:71], a[164:167], a[16:19]
 v_lshl_add_u32 v28, v29, 4, v28
M a[20:23], a[76:79], a[164:167], a[20:23]
M a[20:23], a[72:75], a[160:163], a[20:23]
 s_lshr_b32 s64, s20, 1
 ds_read_b64_tr_b16 a[104:105], v2 offset:32768
 ds_read_b64_tr_b16 a[106:107], v2 offset:33792
M a[24:27], a[80:83], a[160:163], a[24:27]
 s_lshl_b32 s64, s64, 6
 s_and_b32 s72, s20, 1
 s_lshl_b32 s72, s72, 3
M a[24:27], a[84:87], a[164:167], a[24:27]
 s_waitcnt lgkmcnt(6)
 s_add_u32 s64, s64, s72
 s_add_u32 s64, s64, 131072
M a[28:31], a[92:95], a[164:167], a[28:31]
 buffer_load_dwordx4 v14, s[48:51], s22 offen offset:2048   lds
M a[28:31], a[88:91], a[160:163], a[28:31]
 v_add_u32 v28, s64, v28
M v[32:35], a[32:35], a[168:171], v[32:35]
 ds_read_b128 a[160:163], v5 offset:4096
 ds_read_b128 a[164:167], v6 offset:4096
M v[32:35], a[36:39], a[172:175], v[32:35]
 s_lshl_b32 s94, s41, 18
 ds_read_b64_tr_b16 a[108:109], v2 offset:40960
 ds_read_b64_tr_b16 a[110:111], v2 offset:41984
M v[36:39], a[44:47], a[172:175], v[36:39]
 buffer_load_dwordx4 v15, s[48:51], s22 offen offset:3072   lds
M v[36:39], a[40:43], a[168:171], v[36:39]
 s_sub_u32 s22, s22, 2097024
 s_and_b32 s64, s42, 7
M v[40:43], a[48:51], a[168:171], v[40:43]
 s_lshl_b32 s64, s64, 10
M v[40:43], a[52:55], a[172:175], v[40:43]
 s_add_u32 s94, s94, s64
 ds_read_b64_tr_b16 a[112:113], v3 offset:32768
 ds_read_b64_tr_b16 a[114:115], v3 offset:33792
M v[44:47], a[60:63], a[172:175], v[44:47]
 s_add_u32 m0, s23, 16384
 s_lshl_b32 s64, s20, 13
 s_add_u32 s94, s94, s64
M v[44:47], a[56:59], a[168:171], v[44:47]
 buffer_load_dwordx4 v8, s[16:19], s21 offen offset:0  nt lds
M v[48:51], a[64:67], a[168:171], v[48:51]
 s_add_u32 s94, s94, 100663296
 ds_read_b64_tr_b16 a[192:193], v28 offset:0
M v[48:51], a[68:71], a[172:175], v[48:51]
M v[52:55], a[76:79], a[172:175], v[52:55]
 ds_read_b64_tr_b16 a[116:117], v3 offset:40960
 ds_read_b64_tr_b16 a[118:119], v3 offset:41984
M v[52:55], a[72:75], a[168:171], v[52:55]
 ds_read_b64_tr_b16 a[194:195], v28 offset:14336
M v[56:59], a[80:83], a[168:171], v[56:59]
 buffer_load_dwordx4 v9, s[16:19], s21 offen offset:1024  nt lds
M v[56:59], a[84:87], a[172:175], v[56:59]
 s_waitcnt lgkmcnt(8)
 ds_read_b64_tr_b16 a[196:197], v28 offset:128
M v[60:63], a[92:95], a[172:175], v[60:63]
M v[60:63], a[88:91], a[168:171], v[60:63]
 ds_read_b64_tr_b16 a[120:121], v4 offset:32768
 ds_read_b64_tr_b16 a[122:123], v4 offset:33792
M v[64:67], a[32:35], a[160:163], v[64:67]
 ds_read_b128 a[168:171], v5 offset:6144
 ds_read_b128 a[172:175], v6 offset:6144
M v[64:67], a[36:39], a[164:167], v[64:67]
 buffer_load_dwordx4 v10, s[16:19], s21 offen offset:2048  nt lds
M v[68:71], a[44:47], a[164:167], v[68:71]
 ds_read_b64_tr_b16 a[198:199], v28 offset:14464
M v[68:71], a[40:43], a[160:163], v[68:71]
M v[72:75], a[48:51], a[160:163], v[72:75]
 ds_read_b64_tr_b16 a[124:125], v4 offset:40960
 ds_read_b64_tr_b16 a[126:127], v4 offset:41984
M v[72:75], a[52:55], a[164:167], v[72:75]
 ds_read_b64_tr_b16 a[200:201], v28 offset:256
M v[76:79], a[60:63], a[164:167], v[76:79]
 buffer_load_dwordx4 v11, s[16:19], s21 offen offset:3072  nt lds
M v[76:79], a[56:59], a[160:163], v[76:79]
 s_add_u32 s21, s21, 524160
 ds_read_b64_tr_b16 a[202:203], v28 offset:14592
M v[80:83], a[64:67], a[160:163], v[80:83]
M v[80:83], a[68:71], a[164:167], v[80:83]
 ds_read_b64_tr_b16 a[204:205], v28 offset:384
M v[84:87], a[76:79], a[164:167], v[84:87]
M v[84:87], a[72:75], a[160:163], v[84:87]
 ds_read_b64_tr_b16 a[206:207], v28 offset:14720
M v[88:91], a[80:83], a[160:163], v[88:91]
M v[88:91], a[84:87], a[164:167], v[88:91]
 s_waitcnt lgkmcnt(7)
 ds_read_b64_tr_b16 a[208:209], v28 offset:512
M v[92:95], a[92:95], a[164:167], v[92:95]
 s_waitcnt vmcnt(16) lgkmcnt(0)
M v[92:95], a[88:91], a[160:163], v[92:95]
 s_barrier
M v[96:99], a[32:35], a[168:171], v[96:99]
 ds_read_b128 a[160:163], v5 offset:16384
 ds_read_b128 a[164:167], v6 offset:16384
M v[96:99], a[36:39], a[172:175], v[96:99]
 ds_read_b64_tr_b16 a[210:211], v28 offset:14848
M v[100:103], a[44:47], a[172:175], v[100:103]
 s_add_u32 m0, s24, 0
 ds_read_b64_tr_b16 a[128:129], v1 offset:49152
 ds_read_b64_tr_b16 a[130:131], v1 offset:50176
M v[100:103], a[40:43], a[168:171], v[100:103]
 buffer_load_dwordx4 v12, s[48:51], s22 offen offset:0   lds
M v[104:107], a[48:51], a[168:171], v[104:107]
 ds_read_b64_tr_b16 a[212:213], v28 offset:640
M v[104:107], a[52:55], a[172:175], v[104:107]
M v[108:111], a[60:63], a[172:175], v[108:111]
 ds_read_b64_tr_b16 a[214:215], v28 offset:14976
M v[108:111], a[56:59], a[168:171], v[108:111]
M v[112:115], a[64:67], a[168:171], v[112:115]
 ds_read_b64_tr_b16 a[216:217], v28 offset:768
M v[112:115], a[68:71], a[172:175], v[112:115]
 ds_read_b64_tr_b16 a[132:133], v1 offset:57344
 ds_read_b64_tr_b16 a[134:135], v1 offset:58368
M v[116:119], a[76:79], a[172:175], v[116:119]
 buffer_load_dwordx4 v13, s[48:51], s22 offen offset:1024   lds
M v[116:119], a[72:75], a[168:171], v[116:119]
 ds_read_b64_tr_b16 a[218:219], v28 offset:15104
M v[120:123], a[80:83], a[168:171], v[120:123]
M v[120:123], a[84:87], a[172:175], v[120:123]
 s_waitcnt lgkmcnt(9)
M v[124:127], a[92:95], a[172:175], v[124:127]
M v[124:127], a[88:91], a[168:171], v[124:127]
M v[128:131], a[32:35], a[160:163], v[128:131]
 ds_read_b128 a[168:171], v5 offset:18432
 ds_read_b128 a[172:175], v6 offset:18432
M v[128:131], a[36:39], a[164:167], v[128:131]
 ds_read_b64_tr_b16 a[136:137], v2 offset:49152
 ds_read_b64_tr_b16 a[138:139], v2 offset:50176
M v[132:135], a[44:47], a[164:167], v[132:135]
 buffer_load_dwordx4 v14, s[48:51], s22 offen offset:2048   lds
M v[132:135], a[40:43], a[160:163], v[132:135]
M v[136:139], a[48:51], a[160:163], v[136:139]
M v[136:139], a[52:55], a[164:167], v[136:139]
M v[140:143], a[60:63], a[164:167], v[140:143]
M v[140:143], a[56:59], a[160:163], v[140:143]
 ds_read_b64_tr_b16 a[140:141], v2 offset:57344
 ds_read_b64_tr_b16 a[142:143], v2 offset:58368
M v[144:147], a[64:67], a[160:163], v[144:147]
 buffer_load_dwordx4 v15, s[48:51], s22 offen offset:3072   lds
M v[144:147], a[68:71], a[164:167], v[144:147]
 s_add_u32 s22, s22, 2097152
M v[148:151], a[76:79], a[164:167], v[148:151]
M v[148:151], a[72:75], a[160:163], v[148:151]
M v[152:155], a[80:83], a[160:163], v[152:155]
M v[152:155], a[84:87], a[164:167], v[152:155]
 s_waitcnt lgkmcnt(4)
M v[156:159], a[92:95], a[164:167], v[156:159]
 s_add_u32 m0, s23, 32768
 ds_read_b64_tr_b16 a[144:145], v3 offset:49152
 ds_read_b64_tr_b16 a[146:147], v3 offset:50176
M v[156:159], a[88:91], a[160:163], v[156:159]
 buffer_load_dwordx4 v8, s[16:19], s21 offen offset:0  nt lds
M v[160:163], a[32:35], a[168:171], v[160:163]
 ds_read_b128 a[160:163], v5 offset:20480
 ds_read_b128 a[164:167], v6 offset:20480
M v[160:163], a[36:39], a[172:175], v[160:163]
M v[164:167], a[44:47], a[172:175], v[164:167]
M v[164:167], a[40:43], a[168:171], v[164:167]
M v[168:171], a[48:51], a[168:171], v[168:171]
M v[168:171], a[52:55], a[172:175], v[168:171]
 ds_read_b64_tr_b16 a[148:149], v3 offset:57344
 ds_read_b64_tr_b16 a[150:151], v3 offset:58368
M v[172:175], a[60:63], a[172:175], v[172:175]
 buffer_load_dwordx4 v9, s[16:19], s21 offen offset:1024  nt lds
M v[172:175], a[56:59], a[168:171], v[172:175]
M v[176:179], a[64:67], a[168:171], v[176:179]
M v[176:179], a[68:71], a[172:175], v[176:179]
M v[180:183], a[76:79], a[172:175], v[180:183]
M v[180:183], a[72:75], a[168:171], v[180:183]
M v[184:187], a[80:83], a[168:171], v[184:187]
 ds_read_b64_tr_b16 a[152:153], v4 offset:49152
 ds_read_b64_tr_b16 a[154:155], v4 offset:50176
M v[184:187], a[84:87], a[172:175], v[184:187]
 s_waitcnt lgkmcnt(4)
M v[188:191], a[92:95], a[172:175], v[188:191]
 buffer_load_dwordx4 v10, s[16:19], s21 offen offset:2048  nt lds
M v[188:191], a[88:91], a[168:171], v[188:191]
M v[192:195], a[32:35], a[160:163], v[192:195]
 ds_read_b128 a[168:171], v5 offset:22528
 ds_read_b128 a[172:175], v6 offset:22528
M v[192:195], a[36:39], a[164:167], v[192:195]
M v[196:199], a[44:47], a[164:167], v[196:199]
M v[196:199], a[40:43], a[160:163], v[196:199]
 ds_read_b64_tr_b16 a[156:157], v4 offset:57344
 ds_read_b64_tr_b16 a[158:159], v4 offset:58368
M v[200:203], a[48:51], a[160:163], v[200:203]
 buffer_load_dwordx4 v11, s[16:19], s21 offen offset:3072  nt lds
M v[200:203], a[52:55], a[164:167], v[200:203]
 s_add_u32 s21, s21, 128
M v[204:207], a[60:63], a[164:167], v[204:207]
M v[204:207], a[56:59], a[160:163], v[204:207]
M v[208:211], a[64:67], a[160:163], v[208:211]
M v[208:211], a[68:71], a[164:167], v[208:211]
M v[212:215], a[76:79], a[164:167], v[212:215]
M v[212:215], a[72:75], a[160:163], v[212:215]
M v[216:219], a[80:83], a[160:163], v[216:219]
M v[216:219], a[84:87], a[164:167], v[216:219]
 s_waitcnt lgkmcnt(2)
M v[220:223], a[92:95], a[164:167], v[220:223]
 s_waitcnt vmcnt(16) lgkmcnt(0)
M v[220:223], a[88:91], a[160:163], v[220:223]
 s_barrier
M v[224:227], a[32:35], a[168:171], v[224:227]
 ds_read_b128 a[160:163], v5 offset:32768
 ds_read_b128 a[164:167], v6 offset:32768
M v[224:227], a[36:39], a[172:175], v[224:227]
 buffer_load_dword a240, v24, s[32:35], 0 offen offset:1536
M v[228:231], a[44:47], a[172:175], v[228:231]
M v[228:231], a[40:43], a[168:171], v[228:231]
M v[232:235], a[48:51], a[168:171], v[232:235]
M v[232:235], a[52:55], a[172:175], v[232:235]
M v[236:239], a[60:63], a[172:175], v[236:239]
M v[236:239], a[56:59], a[168:171], v[236:239]
M v[240:243], a[64:67], a[168:171], v[240:243]
M v[240:243], a[68:71], a[172:175], v[240:243]
M v[244:247], a[76:79], a[172:175], v[244:247]
M v[244:247], a[72:75], a[168:171], v[244:247]
M v[248:251], a[80:83], a[168:171], v[248:251]
M v[248:251], a[84:87], a[172:175], v[248:251]
 s_waitcnt lgkmcnt(0)
M v[252:255], a[92:95], a[172:175], v[252:255]
M v[252:255], a[88:91], a[168:171], v[252:255]
M a[0:3], a[96:99], a[160:163], a[0:3]
 ds_read_b128 a[168:171], v5 offset:34816
 ds_read_b128 a[172:175], v6 offset:34816
M a[0:3], a[100:103], a[164:167], a[0:3]
 ds_read_b64_tr_b16 a[32:33], v1 offset:0
 ds_read_b64_tr_b16 a[34:35], v1 offset:1024
M a[4:7], a[108:111], a[164:167], a[4:7]
 s_add_u32 m0, s24, 16384
M a[4:7], a[104:107], a[160:163], a[4:7]
 buffer_load_dwordx4 v12, s[48:51], s22 offen offset:0   lds
M a[8:11], a[112:115], a[160:163], a[8:11]
M a[8:11], a[116:119], a[164:167], a[8:11]
M a[12:15], a[124:127], a[164:167], a[12:15]
 ds_read_b64_tr_b16 a[36:37], v1 offset:8192
 ds_read_b64_tr_b16 a[38:39], v1 offset:9216
M a[12:15], a[120:123], a[160:163], a[12:15]
M a[16:19], a[128:131], a[160:163], a[16:19]
 buffer_load_dwordx4 v13, s[48:51], s22 offen offset:1024   lds
M a[16:19], a[132:135], a[164:167], a[16:19]
M a[20:23], a[140:143], a[164:167], a[20:23]
M a[20:23], a[136:139], a[160:163], a[20:23]
 ds_read_b64_tr_b16 a[40:41], v2 offset:0
 ds_read_b64_tr_b16 a[42:43], v2 offset:1024
M a[24:27], a[144:147], a[160:163], a[24:27]
M a[24:27], a[148:151], a[164:167], a[24:27]
 s_waitcnt lgkmcnt(6)
M a[28:31], a[156:159], a[164:167], a[28:31]
 buffer_load_dwordx4 v14, s[48:51], s22 offen offset:2048   lds
M a[28:31], a[152:155], a[160:163], a[28:31]
M v[32:35], a[96:99], a[168:171], v[32:35]
 ds_read_b128 a[160:163], v5 offset:36864
 ds_read_b128 a[164:167], v6 offset:36864
M v[32:35], a[100:103], a[172:175], v[32:35]
 ds_read_b64_tr_b16 a[44:45], v2 offset:8192
 ds_read_b64_tr_b16 a[46:47], v2 offset:9216
M v[36:39], a[108:111], a[172:175], v[36:39]
 buffer_load_dwordx4 v15, s[48:51], s22 offen offset:3072   lds
M v[36:39], a[104:107], a[168:171], v[36:39]
 s_sub_u32 s22, s22, 2097024
M v[40:43], a[112:115], a[168:171], v[40:43]
M v[40:43], a[116:119], a[172:175], v[40:43]
 ds_read_b64_tr_b16 a[48:49], v3 offset:0
 ds_read_b64_tr_b16 a[50:51], v3 offset:1024
M v[44:47], a[124:127], a[172:175], v[44:47]
 s_add_u32 m0, s23, 49152
M v[44:47], a[120:123], a[168:171], v[44:47]
 buffer_load_dwordx4 v8, s[16:19], s21 offen offset:0  nt lds
M v[48:51], a[128:131], a[168:171], v[48:51]
M v[48:51], a[132:135], a[172:175], v[48:51]
M v[52:55], a[140:143], a[172:175], v[52:55]
 ds_read_b64_tr_b16 a[52:53], v3 offset:8192
 ds_read_b64_tr_b16 a[54:55], v3 offset:9216
M v[52:55], a[136:139], a[168:171], v[52:55]
M v[56:59], a[144:147], a[168:171], v[56:59]
 buffer_load_dwordx4 v9, s[16:19], s21 offen offset:1024  nt lds
M v[56:59], a[148:151], a[172:175], v[56:59]
 s_waitcnt lgkmcnt(6)
M v[60:63], a[156:159], a[172:175], v[60:63]
M v[60:63], a[152:155], a[168:171], v[60:63]
 ds_read_b64_tr_b16 a[56:57], v4 offset:0
 ds_read_b64_tr_b16 a[58:59], v4 offset:1024
M v[64:67], a[96:99], a[160:163], v[64:67]
 ds_read_b128 a[168:171], v5 offset:38912
 ds_read_b128 a[172:175], v6 offset:38912
M v[64:67], a[100:103], a[164:167], v[64:67]
 buffer_load_dwordx4 v10, s[16:19], s21 offen offset:2048  nt lds
M v[68:71], a[108:111], a[164:167], v[68:71]
M v[68:71], a[104:107], a[160:163], v[68:71]
M v[72:75], a[112:115], a[160:163], v[72:75]
 ds_read_b64_tr_b16 a[60:61], v4 offset:8192
 ds_read_b64_tr_b16 a[62:63], v4 offset:9216
M v[72:75], a[116:119], a[164:167], v[72:75]
M v[76:79], a[124:127], a[164:167], v[76:79]
 buffer_load_dwordx4 v11, s[16:19], s21 offen offset:3072  nt lds
M v[76:79], a[120:123], a[160:163], v[76:79]
 s_add_u32 s21, s21, 524160
M v[80:83], a[128:131], a[160:163], v[80:83]
M v[80:83], a[132:135], a[164:167], v[80:83]
M v[84:87], a[140:143], a[164:167], v[84:87]
M v[84:87], a[136:139], a[160:163], v[84:87]
M v[88:91], a[144:147], a[160:163], v[88:91]
M v[88:91], a[148:151], a[164:167], v[88:91]
 s_waitcnt lgkmcnt(2)
M v[92:95], a[156:159], a[164:167], v[92:95]
 s_waitcnt vmcnt(17) lgkmcnt(0)
M v[92:95], a[152:155], a[160:163], v[92:95]
 s_barrier
M v[96:99], a[96:99], a[168:171], v[96:99]
 ds_read_b128 a[160:163], v5 offset:49152
 ds_read_b128 a[164:167], v6 offset:49152
M v[96:99], a[100:103], a[172:175], v[96:99]
M v[100:103], a[108:111], a[172:175], v[100:103]
 s_add_u32 m0, s24, 32768
 ds_read_b64_tr_b16 a[64:65], v1 offset:16384
 ds_read_b64_tr_b16 a[66:67], v1 offset:17408
M v[100:103], a[104:107], a[168:171], v[100:103]
 buffer_load_dwordx4 v12, s[48:51], s22 offen offset:0   lds
M v[104:107], a[112:115], a[168:171], v[104:107]
M v[104:107], a[116:119], a[172:175], v[104:107]
M v[108:111], a[124:127], a[172:175], v[108:111]
M v[108:111], a[120:123], a[168:171], v[108:111]
M v[112:115], a[128:131], a[168:171], v[112:115]
M v[112:115], a[132:135], a[172:175], v[112:115]
 ds_read_b64_tr_b16 a[68:69], v1 offset:24576
 ds_read_b64_tr_b16 a[70:71], v1 offset:25600
M v[116:119], a[140:143], a[172:175], v[116:119]
 buffer_load_dwordx4 v13, s[48:51], s22 offen offset:1024   lds
M v[116:119], a[136:139], a[168:171], v[116:119]
M v[120:123], a[144:147], a[168:171], v[120:123]
 s_and_b32 s64, s42, 7
 s_lshl_b32 s64, s64, 2
M v[120:123], a[148:151], a[172:175], v[120:123]
 s_waitcnt lgkmcnt(4)
 s_add_u32 s64, s64, s20
M v[124:127], a[156:159], a[172:175], v[124:127]
 s_mul_i32 s64, s64, 114688
 v_bfe_u32 v28, v0, 2, 2
 v_and_b32 v29, 3, v0
M v[124:127], a[152:155], a[168:171], v[124:127]
 v_lshlrev_b32 v29, 7, v29
 v_lshl_add_u32 v28, v28, 13, v29
M v[128:131], a[96:99], a[160:163], v[128:131]
 ds_read_b128 a[168:171], v5 offset:51200
 ds_read_b128 a[172:175], v6 offset:51200
M v[128:131], a[100:103], a[164:167], v[128:131]
 ds_read_b64_tr_b16 a[72:73], v2 offset:16384
 ds_read_b64_tr_b16 a[74:75], v2 offset:17408
M v[132:135], a[108:111], a[164:167], v[132:135]
 buffer_load_dwordx4 v14, s[48:51], s22 offen offset:2048   lds
M v[132:135], a[104:107], a[160:163], v[132:135]
 v_add_u32 v23, s64, v28
 v_and_b32 v28, 48, v0
M v[136:139], a[112:115], a[160:163], v[136:139]
 v_lshl_add_u32 v23, v28, 24, v23
M v[136:139], a[116:119], a[164:167], v[136:139]
M v[140:143], a[124:127], a[164:167], v[140:143]
M v[140:143], a[120:123], a[160:163], v[140:143]
 ds_read_b64_tr_b16 a[76:77], v2 offset:24576
 ds_read_b64_tr_b16 a[78:79], v2 offset:25600
M v[144:147], a[128:131], a[160:163], v[144:147]
 buffer_load_dwordx4 v15, s[48:51], s22 offen offset:3072   lds
M v[144:147], a[132:135], a[164:167], v[144:147]
 s_add_u32 s22, s22, 2097152
M v[148:151], a[140:143], a[164:167], v[148:151]
M v[148:151], a[136:139], a[160:163], v[148:151]
M v[152:155], a[144:147], a[160:163], v[152:155]
M v[152:155], a[148:151], a[164:167], v[152:155]
 s_waitcnt lgkmcnt(4)
M v[156:159], a[156:159], a[164:167], v[156:159]
 s_add_u32 m0, s23, 0
 ds_read_b64_tr_b16 a[80:81], v3 offset:16384
 ds_read_b64_tr_b16 a[82:83], v3 offset:17408
M v[156:159], a[152:155], a[160:163], v[156:159]
 buffer_load_dwordx4 v8, s[16:19], s21 offen offset:0  nt lds
M v[160:163], a[96:99], a[168:171], v[160:163]
 ds_read_b128 a[160:163], v5 offset:53248
 ds_read_b128 a[164:167], v6 offset:53248
M v[160:163], a[100:103], a[172:175], v[160:163]
M v[164:167], a[108:111], a[172:175], v[164:167]
M v[164:167], a[104:107], a[168:171], v[164:167]
M v[168:171], a[112:115], a[168:171], v[168:171]
M v[168:171], a[116:119], a[172:175], v[168:171]
 ds_read_b64_tr_b16 a[84:85], v3 offset:24576
 ds_read_b64_tr_b16 a[86:87], v3 offset:25600
M v[172:175], a[124:127], a[172:175], v[172:175]
 buffer_load_dwordx4 v9, s[16:19], s21 offen offset:1024  nt lds
M v[172:175], a[120:123], a[168:171], v[172:175]
M v[176:179], a[128:131], a[168:171], v[176:179]
M v[176:179], a[132:135], a[172:175], v[176:179]
M v[180:183], a[140:143], a[172:175], v[180:183]
M v[180:183], a[136:139], a[168:171], v[180:183]
M v[184:187], a[144:147], a[168:171], v[184:187]
 ds_read_b64_tr_b16 a[88:89], v4 offset:16384
 ds_read_b64_tr_b16 a[90:91], v4 offset:17408
M v[184:187], a[148:151], a[172:175], v[184:187]
 s_waitcnt lgkmcnt(4)
M v[188:191], a[156:159], a[172:175], v[188:191]
 buffer_load_dwordx4 v10, s[16:19], s21 offen offset:2048  nt lds
M v[188:191], a[152:155], a[168:171], v[188:191]
M v[192:195], a[96:99], a[160:163], v[192:195]
 ds_read_b128 a[168:171], v5 offset:55296
 ds_read_b128 a[172:175], v6 offset:55296
M v[192:195], a[100:103], a[164:167], v[192:195]
M v[196:199], a[108:111], a[164:167], v[196:199]
M v[196:199], a[104:107], a[160:163], v[196:199]
 ds_read_b64_tr_b16 a[92:93], v4 offset:24576
 ds_read_b64_tr_b16 a[94:95], v4 offset:25600
M v[200:203], a[112:115], a[160:163], v[200:203]
 buffer_load_dwordx4 v11, s[16:19], s21 offen offset:3072  nt lds
M v[200:203], a[116:119], a[164:167], v[200:203]
 s_add_u32 s21, s21, 128
M v[204:207], a[124:127], a[164:167], v[204:207]
M v[204:207], a[120:123], a[160:163], v[204:207]
M v[208:211], a[128:131], a[160:163], v[208:211]
M v[208:211], a[132:135], a[164:167], v[208:211]
M v[212:215], a[140:143], a[164:167], v[212:215]
M v[212:215], a[136:139], a[160:163], v[212:215]
M v[216:219], a[144:147], a[160:163], v[216:219]
M v[216:219], a[148:151], a[164:167], v[216:219]
 s_waitcnt lgkmcnt(2)
M v[220:223], a[156:159], a[164:167], v[220:223]
 s_waitcnt vmcnt(17) lgkmcnt(0)
M v[220:223], a[152:155], a[160:163], v[220:223]
 s_barrier
M v[224:227], a[96:99], a[168:171], v[224:227]
 ds_read_b128 a[160:163], v5 offset:0
 ds_read_b128 a[164:167], v6 offset:0
M v[224:227], a[100:103], a[172:175], v[224:227]
 buffer_load_dword a240, v23, s[52:55], 0 offen offset:0
M v[228:231], a[108:111], a[172:175], v[228:231]
 v_add_u32 v23, 32768, v23
M v[228:231], a[104:107], a[168:171], v[228:231]
M v[232:235], a[112:115], a[168:171], v[232:235]
M v[232:235], a[116:119], a[172:175], v[232:235]
M v[236:239], a[124:127], a[172:175], v[236:239]
M v[236:239], a[120:123], a[168:171], v[236:239]
M v[240:243], a[128:131], a[168:171], v[240:243]
M v[240:243], a[132:135], a[172:175], v[240:243]
M v[244:247], a[140:143], a[172:175], v[244:247]
M v[244:247], a[136:139], a[168:171], v[244:247]
M v[248:251], a[144:147], a[168:171], v[248:251]
M v[248:251], a[148:151], a[172:175], v[248:251]
 s_waitcnt lgkmcnt(0)
M v[252:255], a[156:159], a[172:175], v[252:255]
M v[252:255], a[152:155], a[168:171], v[252:255]
M a[0:3], a[32:35], a[160:163], a[0:3]
 ds_read_b128 a[168:171], v5 offset:2048
 ds_read_b128 a[172:175], v6 offset:2048
M a[0:3], a[36:39], a[164:167], a[0:3]
 ds_read_b64_tr_b16 a[96:97], v1 offset:32768
 ds_read_b64_tr_b16 a[98:99], v1 offset:33792
M a[4:7], a[44:47], a[164:167], a[4:7]
 s_add_u32 m0, s24, 49152
M a[4:7], a[40:43], a[160:163], a[4:7]
 buffer_load_dwordx4 v12, s[48:51], s22 offen offset:0   lds
M a[8:11], a[48:51], a[160:163], a[8:11]
M a[8:11], a[52:55], a[164:167], a[8:11]
M a[12:15], a[60:63], a[164:167], a[12:15]
 ds_read_b64_tr_b16 a[100:101], v1 offset:40960
 ds_read_b64_tr_b16 a[102:103], v1 offset:41984
M a[12:15], a[56:59], a[160:163], a[12:15]
M a[16:19], a[64:67], a[160:163], a[16:19]
 buffer_load_dwordx4 v13, s[48:51], s22 offen offset:1024   lds
M a[16:19], a[68:71], a[164:167], a[16:19]
M a[20:23], a[76:79], a[164:167], a[20:23]
M a[20:23], a[72:75], a[160:163], a[20:23]
 ds_read_b64_tr_b16 a[104:105], v2 offset:32768
 ds_read_b64_tr_b16 a[106:107], v2 offset:33792
M a[24:27], a[80:83], a[160:163], a[24:27]
M a[24:27], a[84:87], a[164:167], a[24:27]
 s_waitcnt lgkmcnt(6)
M a[28:31], a[92:95], a[164:167], a[28:31]
 buffer_load_dwordx4 v14, s[48:51], s22 offen offset:2048   lds
M a[28:31], a[88:91], a[160:163], a[28:31]
M v[32:35], a[32:35], a[168:171], v[32:35]
 ds_read_b128 a[160:163], v5 offset:4096
 ds_read_b128 a[164:167], v6 offset:4096
M v[32:35], a[36:39], a[172:175], v[32:35]
 ds_read_b64_tr_b16 a[108:109], v2 offset:40960
 ds_read_b64_tr_b16 a[110:111], v2 offset:41984
M v[36:39], a[44:47], a[172:175], v[36:39]
 buffer_load_dwordx4 v15, s[48:51], s22 offen offset:3072   lds
M v[36:39], a[40:43], a[168:171], v[36:39]
 s_sub_u32 s22, s22, 2097024
M v[40:43], a[48:51], a[168:171], v[40:43]
M v[40:43], a[52:55], a[172:175], v[40:43]
 ds_read_b64_tr_b16 a[112:113], v3 offset:32768
 ds_read_b64_tr_b16 a[114:115], v3 offset:33792
M v[44:47], a[60:63], a[172:175], v[44:47]
 s_add_u32 m0, s23, 16384
M v[44:47], a[56:59], a[168:171], v[44:47]
 buffer_load_dwordx4 v8, s[16:19], s21 offen offset:0  nt lds
M v[48:51], a[64:67], a[168:171], v[48:51]
M v[48:51], a[68:71], a[172:175], v[48:51]
M v[52:55], a[76:79], a[172:175], v[52:55]
 ds_read_b64_tr_b16 a[116:117], v3 offset:40960
 ds_read_b64_tr_b16 a[118:119], v3 offset:41984
M v[52:55], a[72:75], a[168:171], v[52:55]
M v[56:59], a[80:83], a[168:171], v[56:59]
 buffer_load_dwordx4 v9, s[16:19], s21 offen offset:1024  nt lds
M v[56:59], a[84:87], a[172:175], v[56:59]
 s_waitcnt lgkmcnt(6)
M v[60:63], a[92:95], a[172:175], v[60:63]
M v[60:63], a[88:91], a[168:171], v[60:63]
 ds_read_b64_tr_b16 a[120:121], v4 offset:32768
 ds_read_b64_tr_b16 a[122:123], v4 offset:33792
M v[64:67], a[32:35], a[160:163], v[64:67]
 ds_read_b128 a[168:171], v5 offset:6144
 ds_read_b128 a[172:175], v6 offset:6144
M v[64:67], a[36:39], a[164:167], v[64:67]
 buffer_load_dwordx4 v10, s[16:19], s21 offen offset:2048  nt lds
M v[68:71], a[44:47], a[164:167], v[68:71]
M v[68:71], a[40:43], a[160:163], v[68:71]
M v[72:75], a[48:51], a[160:163], v[72:75]
 ds_read_b64_tr_b16 a[124:125], v4 offset:40960
 ds_read_b64_tr_b16 a[126:127], v4 offset:41984
M v[72:75], a[52:55], a[164:167], v[72:75]
M v[76:79], a[60:63], a[164:167], v[76:79]
 buffer_load_dwordx4 v11, s[16:19], s21 offen offset:3072  nt lds
M v[76:79], a[56:59], a[160:163], v[76:79]
 s_add_u32 s21, s21, 524160
M v[80:83], a[64:67], a[160:163], v[80:83]
M v[80:83], a[68:71], a[164:167], v[80:83]
M v[84:87], a[76:79], a[164:167], v[84:87]
M v[84:87], a[72:75], a[160:163], v[84:87]
M v[88:91], a[80:83], a[160:163], v[88:91]
M v[88:91], a[84:87], a[164:167], v[88:91]
 s_waitcnt lgkmcnt(2)
M v[92:95], a[92:95], a[164:167], v[92:95]
 s_waitcnt vmcnt(17) lgkmcnt(0)
M v[92:95], a[88:91], a[160:163], v[92:95]
 s_barrier
M v[96:99], a[32:35], a[168:171], v[96:99]
 ds_read_b128 a[160:163], v5 offset:16384
 ds_read_b128 a[164:167], v6 offset:16384
M v[96:99], a[36:39], a[172:175], v[96:99]
M v[100:103], a[44:47], a[172:175], v[100:103]
 s_add_u32 m0, s24, 0
 ds_read_b64_tr_b16 a[128:129], v1 offset:49152
 ds_read_b64_tr_b16 a[130:131], v1 offset:50176
M v[100:103], a[40:43], a[168:171], v[100:103]
 buffer_load_dwordx4 v12, s[48:51], s22 offen offset:0   lds
M v[104:107], a[48:51], a[168:171], v[104:107]
M v[104:107], a[52:55], a[172:175], v[104:107]
M v[108:111], a[60:63], a[172:175], v[108:111]
M v[108:111], a[56:59], a[168:171], v[108:111]
M v[112:115], a[64:67], a[168:171], v[112:115]
M v[112:115], a[68:71], a[172:175], v[112:115]
 ds_read_b64_tr_b16 a[132:133], v1 offset:57344
 ds_read_b64_tr_b16 a[134:135], v1 offset:58368
M v[116:119], a[76:79], a[172:175], v[116:119]
 buffer_load_dwordx4 v13, s[48:51], s22 offen offset:1024   lds
M v[116:119], a[72:75], a[168:171], v[116:119]
M v[120:123], a[80:83], a[168:171], v[120:123]
M v[120:123], a[84:87], a[172:175], v[120:123]
 s_waitcnt lgkmcnt(4)
M v[124:127], a[92:95], a[172:175], v[124:127]
M v[124:127], a[88:91], a[168:171], v[124:127]
M v[128:131], a[32:35], a[160:163], v[128:131]
 ds_read_b128 a[168:171], v5 offset:18432
 ds_read_b128 a[172:175], v6 offset:18432
M v[128:131], a[36:39], a[164:167], v[128:131]
 ds_read_b64_tr_b16 a[136:137], v2 offset:49152
 ds_read_b64_tr_b16 a[138:139], v2 offset:50176
M v[132:135], a[44:47], a[164:167], v[132:135]
 buffer_load_dwordx4 v14, s[48:51], s22 offen offset:2048   lds
M v[132:135], a[40:43], a[160:163], v[132:135]
M v[136:139], a[48:51], a[160:163], v[136:139]
M v[136:139], a[52:55], a[164:167], v[136:139]
M v[140:143], a[60:63], a[164:167], v[140:143]
M v[140:143], a[56:59], a[160:163], v[140:143]
 ds_read_b64_tr_b16 a[140:141], v2 offset:57344
 ds_read_b64_tr_b16 a[142:143], v2 offset:58368
M v[144:147], a[64:67], a[160:163], v[144:147]
 buffer_load_dwordx4 v15, s[48:51], s22 offen offset:3072   lds
M v[144:147], a[68:71], a[164:167], v[144:147]
 s_add_u32 s22, s22, 2097152
M v[148:151], a[76:79], a[164:167], v[148:151]
M v[148:151], a[72:75], a[160:163], v[148:151]
M v[152:155], a[80:83], a[160:163], v[152:155]
M v[152:155], a[84:87], a[164:167], v[152:155]
 s_waitcnt lgkmcnt(4)
M v[156:159], a[92:95], a[164:167], v[156:159]
 s_add_u32 m0, s23, 32768
 ds_read_b64_tr_b16 a[144:145], v3 offset:49152
 ds_read_b64_tr_b16 a[146:147], v3 offset:50176
M v[156:159], a[88:91], a[160:163], v[156:159]
 buffer_load_dwordx4 v8, s[16:19], s21 offen offset:0  nt lds
M v[160:163], a[32:35], a[168:171], v[160:163]
 ds_read_b128 a[160:163], v5 offset:20480
 ds_read_b128 a[164:167], v6 offset:20480
M v[160:163], a[36:39], a[172:175], v[160:163]
M v[164:167], a[44:47], a[172:175], v[164:167]
M v[164:167], a[40:43], a[168:171], v[164:167]
M v[168:171], a[48:51], a[168:171], v[168:171]
M v[168:171], a[52:55], a[172:175], v[168:171]
 ds_read_b64_tr_b16 a[148:149], v3 offset:57344
 ds_read_b64_tr_b16 a[150:151], v3 offset:58368
M v[172:175], a[60:63], a[172:175], v[172:175]
 buffer_load_dwordx4 v9, s[16:19], s21 offen offset:1024  nt lds
M v[172:175], a[56:59], a[168:171], v[172:175]
M v[176:179], a[64:67], a[168:171], v[176:179]
M v[176:179], a[68:71], a[172:175], v[176:179]
M v[180:183], a[76:79], a[172:175], v[180:183]
M v[180:183], a[72:75], a[168:171], v[180:183]
M v[184:187], a[80:83], a[168:171], v[184:187]
 ds_read_b64_tr_b16 a[152:153], v4 offset:49152
 ds_read_b64_tr_b16 a[154:155], v4 offset:50176
M v[184:187], a[84:87], a[172:175], v[184:187]
 s_waitcnt lgkmcnt(4)
M v[188:191], a[92:95], a[172:175], v[188:191]
 buffer_load_dwordx4 v10, s[16:19], s21 offen offset:2048  nt lds
M v[188:191], a[88:91], a[168:171], v[188:191]
M v[192:195], a[32:35], a[160:163], v[192:195]
 ds_read_b128 a[168:171], v5 offset:22528
 ds_read_b128 a[172:175], v6 offset:22528
M v[192:195], a[36:39], a[164:167], v[192:195]
M v[196:199], a[44:47], a[164:167], v[196:199]
M v[196:199], a[40:43], a[160:163], v[196:199]
 ds_read_b64_tr_b16 a[156:157], v4 offset:57344
 ds_read_b64_tr_b16 a[158:159], v4 offset:58368
M v[200:203], a[48:51], a[160:163], v[200:203]
 buffer_load_dwordx4 v11, s[16:19], s21 offen offset:3072  nt lds
M v[200:203], a[52:55], a[164:167], v[200:203]
 s_add_u32 s21, s21, 128
M v[204:207], a[60:63], a[164:167], v[204:207]
M v[204:207], a[56:59], a[160:163], v[204:207]
M v[208:211], a[64:67], a[160:163], v[208:211]
M v[208:211], a[68:71], a[164:167], v[208:211]
M v[212:215], a[76:79], a[164:167], v[212:215]
M v[212:215], a[72:75], a[160:163], v[212:215]
M v[216:219], a[80:83], a[160:163], v[216:219]
M v[216:219], a[84:87], a[164:167], v[216:219]
 s_waitcnt lgkmcnt(2)
M v[220:223], a[92:95], a[164:167], v[220:223]
 s_waitcnt vmcnt(17) lgkmcnt(0)
M v[220:223], a[88:91], a[160:163], v[220:223]
 s_barrier
M v[224:227], a[32:35], a[168:171], v[224:227]
 ds_read_b128 a[160:163], v5 offset:32768
 ds_read_b128 a[164:167], v6 offset:32768
M v[224:227], a[36:39], a[172:175], v[224:227]
 buffer_load_dword a240, v23, s[52:55], 0 offen offset:0
M v[228:231], a[44:47], a[172:175], v[228:231]
 v_add_u32 v23, 32768, v23
M v[228:231], a[40:43], a[168:171], v[228:231]
M v[232:235], a[48:51], a[168:171], v[232:235]
M v[232:235], a[52:55], a[172:175], v[232:235]
M v[236:239], a[60:63], a[172:175], v[236:239]
M v[236:239], a[56:59], a[168:171], v[236:239]
M v[240:243], a[64:67], a[168:171], v[240:243]
M v[240:243], a[68:71], a[172:175], v[240:243]
M v[244:247], a[76:79], a[172:175], v[244:247]
M v[244:247], a[72:75], a[168:171], v[244:247]
M v[248:251], a[80:83], a[168:171], v[248:251]
M v[248:251], a[84:87], a[172:175], v[248:251]
 s_waitcnt lgkmcnt(0)
M v[252:255], a[92:95], a[172:175], v[252:255]
M v[252:255], a[88:91], a[168:171], v[252:255]
M a[0:3], a[96:99], a[160:163], a[0:3]
 ds_read_b128 a[168:171], v5 offset:34816
 ds_read_b128 a[172:175], v6 offset:34816
M a[0:3], a[100:103], a[164:167], a[0:3]
 ds_read_b64_tr_b16 a[32:33], v1 offset:0
 ds_read_b64_tr_b16 a[34:35], v1 offset:1024
M a[4:7], a[108:111], a[164:167], a[4:7]
 s_add_u32 m0, s24, 16384
M a[4:7], a[104:107], a[160:163], a[4:7]
 buffer_load_dwordx4 v12, s[48:51], s22 offen offset:0   lds
M a[8:11], a[112:115], a[160:163], a[8:11]
M a[8:11], a[116:119], a[164:167], a[8:11]
M a[12:15], a[124:127], a[164:167], a[12:15]
 ds_read_b64_tr_b16 a[36:37], v1 offset:8192
 ds_read_b64_tr_b16 a[38:39], v1 offset:9216
M a[12:15], a[120:123], a[160:163], a[12:15]
M a[16:19], a[128:131], a[160:163], a[16:19]
 buffer_load_dwordx4 v13, s[48:51], s22 offen offset:1024   lds
M a[16:19], a[132:135], a[164:167], a[16:19]
M a[20:23], a[140:143], a[164:167], a[20:23]
M a[20:23], a[136:139], a[160:163], a[20:23]
 ds_read_b64_tr_b16 a[40:41], v2 offset:0
 ds_read_b64_tr_b16 a[42:43], v2 offset:1024
M a[24:27], a[144:147], a[160:163], a[24:27]
M a[24:27], a[148:151], a[164:167], a[24:27]
 s_waitcnt lgkmcnt(6)
M a[28:31], a[156:159], a[164:167], a[28:31]
 buffer_load_dwordx4 v14, s[48:51], s22 offen offset:2048   lds
M a[28:31], a[152:155], a[160:163], a[28:31]
M v[32:35], a[96:99], a[168:171], v[32:35]
 ds_read_b128 a[160:163], v5 offset:36864
 ds_read_b128 a[164:167], v6 offset:36864
M v[32:35], a[100:103], a[172:175], v[32:35]
 ds_read_b64_tr_b16 a[44:45], v2 offset:8192
 ds_read_b64_tr_b16 a[46:47], v2 offset:9216
M v[36:39], a[108:111], a[172:175], v[36:39]
 buffer_load_dwordx4 v15, s[48:51], s22 offen offset:3072   lds
M v[36:39], a[104:107], a[168:171], v[36:39]
 s_sub_u32 s22, s22, 2097024
M v[40:43], a[112:115], a[168:171], v[40:43]
M v[40:43], a[116:119], a[172:175], v[40:43]
 ds_read_b64_tr_b16 a[48:49], v3 offset:0
 ds_read_b64_tr_b16 a[50:51], v3 offset:1024
M v[44:47], a[124:127], a[172:175], v[44:47]
 s_add_u32 m0, s23, 49152
M v[44:47], a[120:123], a[168:171], v[44:47]
 buffer_load_dwordx4 v8, s[16:19], s21 offen offset:0  nt lds
M v[48:51], a[128:131], a[168:171], v[48:51]
M v[48:51], a[132:135], a[172:175], v[48:51]
M v[52:55], a[140:143], a[172:175], v[52:55]
 ds_read_b64_tr_b16 a[52:53], v3 offset:8192
 ds_read_b64_tr_b16 a[54:55], v3 offset:9216
M v[52:55], a[136:139], a[168:171], v[52:55]
M v[56:59], a[144:147], a[168:171], v[56:59]
 buffer_load_dwordx4 v9, s[16:19], s21 offen offset:1024  nt lds
M v[56:59], a[148:151], a[172:175], v[56:59]
 s_waitcnt lgkmcnt(6)
M v[60:63], a[156:159], a[172:175], v[60:63]
M v[60:63], a[152:155], a[168:171], v[60:63]
 ds_read_b64_tr_b16 a[56:57], v4 offset:0
 ds_read_b64_tr_b16 a[58:59], v4 offset:1024
M v[64:67], a[96:99], a[160:163], v[64:67]
 ds_read_b128 a[168:171], v5 offset:38912
 ds_read_b128 a[172:175], v6 offset:38912
M v[64:67], a[100:103], a[164:167], v[64:67]
 buffer_load_dwordx4 v10, s[16:19], s21 offen offset:2048  nt lds
M v[68:71], a[108:111], a[164:167], v[68:71]
M v[68:71], a[104:107], a[160:163], v[68:71]
M v[72:75], a[112:115], a[160:163], v[72:75]
 ds_read_b64_tr_b16 a[60:61], v4 offset:8192
 ds_read_b64_tr_b16 a[62:63], v4 offset:9216
M v[72:75], a[116:119], a[164:167], v[72:75]
M v[76:79], a[124:127], a[164:167], v[76:79]
 buffer_load_dwordx4 v11, s[16:19], s21 offen offset:3072  nt lds
M v[76:79], a[120:123], a[160:163], v[76:79]
 s_add_u32 s21, s21, 524160
M v[80:83], a[128:131], a[160:163], v[80:83]
M v[80:83], a[132:135], a[164:167], v[80:83]
M v[84:87], a[140:143], a[164:167], v[84:87]
M v[84:87], a[136:139], a[160:163], v[84:87]
M v[88:91], a[144:147], a[160:163], v[88:91]
M v[88:91], a[148:151], a[164:167], v[88:91]
 s_waitcnt lgkmcnt(2)
M v[92:95], a[156:159], a[164:167], v[92:95]
 s_waitcnt vmcnt(17) lgkmcnt(0)
M v[92:95], a[152:155], a[160:163], v[92:95]
 s_barrier
M v[96:99], a[96:99], a[168:171], v[96:99]
 ds_read_b128 a[160:163], v5 offset:49152
 ds_read_b128 a[164:167], v6 offset:49152
M v[96:99], a[100:103], a[172:175], v[96:99]
M v[100:103], a[108:111], a[172:175], v[100:103]
 s_add_u32 m0, s24, 32768
 ds_read_b64_tr_b16 a[64:65], v1 offset:16384
 ds_read_b64_tr_b16 a[66:67], v1 offset:17408
M v[100:103], a[104:107], a[168:171], v[100:103]
 buffer_load_dwordx4 v12, s[48:51], s22 offen offset:0   lds
M v[104:107], a[112:115], a[168:171], v[104:107]
M v[104:107], a[116:119], a[172:175], v[104:107]
M v[108:111], a[124:127], a[172:175], v[108:111]
M v[108:111], a[120:123], a[168:171], v[108:111]
M v[112:115], a[128:131], a[168:171], v[112:115]
M v[112:115], a[132:135], a[172:175], v[112:115]
 ds_read_b64_tr_b16 a[68:69], v1 offset:24576
 ds_read_b64_tr_b16 a[70:71], v1 offset:25600
M v[116:119], a[140:143], a[172:175], v[116:119]
 buffer_load_dwordx4 v13, s[48:51], s22 offen offset:1024   lds
M v[116:119], a[136:139], a[168:171], v[116:119]
M v[120:123], a[144:147], a[168:171], v[120:123]
M v[120:123], a[148:151], a[172:175], v[120:123]
 s_waitcnt lgkmcnt(4)
M v[124:127], a[156:159], a[172:175], v[124:127]
M v[124:127], a[152:155], a[168:171], v[124:127]
M v[128:131], a[96:99], a[160:163], v[128:131]
 ds_read_b128 a[168:171], v5 offset:51200
 ds_read_b128 a[172:175], v6 offset:51200
M v[128:131], a[100:103], a[164:167], v[128:131]
 ds_read_b64_tr_b16 a[72:73], v2 offset:16384
 ds_read_b64_tr_b16 a[74:75], v2 offset:17408
M v[132:135], a[108:111], a[164:167], v[132:135]
 buffer_load_dwordx4 v14, s[48:51], s22 offen offset:2048   lds
M v[132:135], a[104:107], a[160:163], v[132:135]
M v[136:139], a[112:115], a[160:163], v[136:139]
M v[136:139], a[116:119], a[164:167], v[136:139]
M v[140:143], a[124:127], a[164:167], v[140:143]
M v[140:143], a[120:123], a[160:163], v[140:143]
 ds_read_b64_tr_b16 a[76:77], v2 offset:24576
 ds_read_b64_tr_b16 a[78:79], v2 offset:25600
M v[144:147], a[128:131], a[160:163], v[144:147]
 buffer_load_dwordx4 v15, s[48:51], s22 offen offset:3072   lds
M v[144:147], a[132:135], a[164:167], v[144:147]
 s_add_u32 s22, s22, 2097152
M v[148:151], a[140:143], a[164:167], v[148:151]
M v[148:151], a[136:139], a[160:163], v[148:151]
M v[152:155], a[144:147], a[160:163], v[152:155]
M v[152:155], a[148:151], a[164:167], v[152:155]
 s_waitcnt lgkmcnt(4)
M v[156:159], a[156:159], a[164:167], v[156:159]
 s_add_u32 m0, s23, 0
 ds_read_b64_tr_b16 a[80:81], v3 offset:16384
 ds_read_b64_tr_b16 a[82:83], v3 offset:17408
M v[156:159], a[152:155], a[160:163], v[156:159]
 buffer_load_dwordx4 v8, s[16:19], s21 offen offset:0  nt lds
M v[160:163], a[96:99], a[168:171], v[160:163]
 ds_read_b128 a[160:163], v5 offset:53248
 ds_read_b128 a[164:167], v6 offset:53248
M v[160:163], a[100:103], a[172:175], v[160:163]
M v[164:167], a[108:111], a[172:175], v[164:167]
M v[164:167], a[104:107], a[168:171], v[164:167]
M v[168:171], a[112:115], a[168:171], v[168:171]
M v[168:171], a[116:119], a[172:175], v[168:171]
 ds_read_b64_tr_b16 a[84:85], v3 offset:24576
 ds_read_b64_tr_b16 a[86:87], v3 offset:25600
M v[172:175], a[124:127], a[172:175], v[172:175]
 buffer_load_dwordx4 v9, s[16:19], s21 offen offset:1024  nt lds
M v[172:175], a[120:123], a[168:171], v[172:175]
M v[176:179], a[128:131], a[168:171], v[176:179]
M v[176:179], a[132:135], a[172:175], v[176:179]
M v[180:183], a[140:143], a[172:175], v[180:183]
M v[180:183], a[136:139], a[168:171], v[180:183]
M v[184:187], a[144:147], a[168:171], v[184:187]
 ds_read_b64_tr_b16 a[88:89], v4 offset:16384
 ds_read_b64_tr_b16 a[90:91], v4 offset:17408
M v[184:187], a[148:151], a[172:175], v[184:187]
 s_waitcnt lgkmcnt(4)
M v[188:191], a[156:159], a[172:175], v[188:191]
 buffer_load_dwordx4 v10, s[16:19], s21 offen offset:2048  nt lds
M v[188:191], a[152:155], a[168:171], v[188:191]
M v[192:195], a[96:99], a[160:163], v[192:195]
 ds_read_b128 a[168:171], v5 offset:55296
 ds_read_b128 a[172:175], v6 offset:55296
M v[192:195], a[100:103], a[164:167], v[192:195]
M v[196:199], a[108:111], a[164:167], v[196:199]
M v[196:199], a[104:107], a[160:163], v[196:199]
 ds_read_b64_tr_b16 a[92:93], v4 offset:24576
 ds_read_b64_tr_b16 a[94:95], v4 offset:25600
M v[200:203], a[112:115], a[160:163], v[200:203]
 buffer_load_dwordx4 v11, s[16:19], s21 offen offset:3072  nt lds
M v[200:203], a[116:119], a[164:167], v[200:203]
 s_add_u32 s21, s21, 128
M v[204:207], a[124:127], a[164:167], v[204:207]
M v[204:207], a[120:123], a[160:163], v[204:207]
M v[208:211], a[128:131], a[160:163], v[208:211]
M v[208:211], a[132:135], a[164:167], v[208:211]
M v[212:215], a[140:143], a[164:167], v[212:215]
M v[212:215], a[136:139], a[160:163], v[212:215]
M v[216:219], a[144:147], a[160:163], v[216:219]
M v[216:219], a[148:151], a[164:167], v[216:219]
 s_waitcnt lgkmcnt(2)
M v[220:223], a[156:159], a[164:167], v[220:223]
 s_waitcnt vmcnt(17) lgkmcnt(0)
M v[220:223], a[152:155], a[160:163], v[220:223]
 s_barrier
M v[224:227], a[96:99], a[168:171], v[224:227]
 ds_read_b128 a[160:163], v5 offset:0
 ds_read_b128 a[164:167], v6 offset:0
M v[224:227], a[100:103], a[172:175], v[224:227]
 buffer_load_dword a240, v23, s[52:55], 0 offen offset:0
M v[228:231], a[108:111], a[172:175], v[228:231]
 v_add_u32 v23, 16384, v23
M v[228:231], a[104:107], a[168:171], v[228:231]
M v[232:235], a[112:115], a[168:171], v[232:235]
M v[232:235], a[116:119], a[172:175], v[232:235]
M v[236:239], a[124:127], a[172:175], v[236:239]
M v[236:239], a[120:123], a[168:171], v[236:239]
M v[240:243], a[128:131], a[168:171], v[240:243]
M v[240:243], a[132:135], a[172:175], v[240:243]
M v[244:247], a[140:143], a[172:175], v[244:247]
M v[244:247], a[136:139], a[168:171], v[244:247]
M v[248:251], a[144:147], a[168:171], v[248:251]
M v[248:251], a[148:151], a[172:175], v[248:251]
 s_waitcnt lgkmcnt(0)
M v[252:255], a[156:159], a[172:175], v[252:255]
M v[252:255], a[152:155], a[168:171], v[252:255]
M a[0:3], a[32:35], a[160:163], a[0:3]
 ds_read_b128 a[168:171], v5 offset:2048
 ds_read_b128 a[172:175], v6 offset:2048
M a[0:3], a[36:39], a[164:167], a[0:3]
 ds_read_b64_tr_b16 a[96:97], v1 offset:32768
 ds_read_b64_tr_b16 a[98:99], v1 offset:33792
M a[4:7], a[44:47], a[164:167], a[4:7]
 s_add_u32 m0, s24, 49152
 v_accvgpr_read_b32 v27, a241
M a[4:7], a[40:43], a[160:163], a[4:7]
 buffer_load_dwordx4 v12, s[48:51], s22 offen offset:0   lds
M a[8:11], a[48:51], a[160:163], a[8:11]
M a[8:11], a[52:55], a[164:167], a[8:11]
M a[12:15], a[60:63], a[164:167], a[12:15]
 ds_read_b64_tr_b16 a[100:101], v1 offset:40960
 ds_read_b64_tr_b16 a[102:103], v1 offset:41984
M a[12:15], a[56:59], a[160:163], a[12:15]
M a[16:19], a[64:67], a[160:163], a[16:19]
 buffer_load_dwordx4 v13, s[48:51], s22 offen offset:1024   lds
M a[16:19], a[68:71], a[164:167], a[16:19]
M a[20:23], a[76:79], a[164:167], a[20:23]
M a[20:23], a[72:75], a[160:163], a[20:23]
 ds_read_b64_tr_b16 a[104:105], v2 offset:32768
 ds_read_b64_tr_b16 a[106:107], v2 offset:33792
M a[24:27], a[80:83], a[160:163], a[24:27]
M a[24:27], a[84:87], a[164:167], a[24:27]
 s_waitcnt lgkmcnt(6)
M a[28:31], a[92:95], a[164:167], a[28:31]
 buffer_load_dwordx4 v14, s[48:51], s22 offen offset:2048   lds
M a[28:31], a[88:91], a[160:163], a[28:31]
M v[32:35], a[32:35], a[168:171], v[32:35]
 ds_read_b128 a[160:163], v5 offset:4096
 ds_read_b128 a[164:167], v6 offset:4096
M v[32:35], a[36:39], a[172:175], v[32:35]
 ds_read_b64_tr_b16 a[108:109], v2 offset:40960
 ds_read_b64_tr_b16 a[110:111], v2 offset:41984
M v[36:39], a[44:47], a[172:175], v[36:39]
 buffer_load_dwordx4 v15, s[48:51], s22 offen offset:3072   lds
M v[36:39], a[40:43], a[168:171], v[36:39]
 s_sub_u32 s22, s22, 2097024
M v[40:43], a[48:51], a[168:171], v[40:43]
M v[40:43], a[52:55], a[172:175], v[40:43]
 ds_read_b64_tr_b16 a[112:113], v3 offset:32768
 ds_read_b64_tr_b16 a[114:115], v3 offset:33792
M v[44:47], a[60:63], a[172:175], v[44:47]
 s_add_u32 m0, s23, 16384
M v[44:47], a[56:59], a[168:171], v[44:47]
 buffer_load_dwordx4 v8, s[16:19], s21 offen offset:0  nt lds
M v[48:51], a[64:67], a[168:171], v[48:51]
M v[48:51], a[68:71], a[172:175], v[48:51]
M v[52:55], a[76:79], a[172:175], v[52:55]
 ds_read_b64_tr_b16 a[116:117], v3 offset:40960
 ds_read_b64_tr_b16 a[118:119], v3 offset:41984
M v[52:55], a[72:75], a[168:171], v[52:55]
M v[56:59], a[80:83], a[168:171], v[56:59]
 buffer_load_dwordx4 v9, s[16:19], s21 offen offset:1024  nt lds
M v[56:59], a[84:87], a[172:175], v[56:59]
 s_waitcnt lgkmcnt(6)
M v[60:63], a[92:95], a[172:175], v[60:63]
M v[60:63], a[88:91], a[168:171], v[60:63]
 ds_read_b64_tr_b16 a[120:121], v4 offset:32768
 ds_read_b64_tr_b16 a[122:123], v4 offset:33792
M v[64:67], a[32:35], a[160:163], v[64:67]
 ds_read_b128 a[168:171], v5 offset:6144
 ds_read_b128 a[172:175], v6 offset:6144
M v[64:67], a[36:39], a[164:167], v[64:67]
 buffer_load_dwordx4 v10, s[16:19], s21 offen offset:2048  nt lds
M v[68:71], a[44:47], a[164:167], v[68:71]
M v[68:71], a[40:43], a[160:163], v[68:71]
M v[72:75], a[48:51], a[160:163], v[72:75]
 ds_read_b64_tr_b16 a[124:125], v4 offset:40960
 ds_read_b64_tr_b16 a[126:127], v4 offset:41984
M v[72:75], a[52:55], a[164:167], v[72:75]
 v_sub_f32 v48, v48, v27
 v_sub_f32 v49, v49, v27
M v[76:79], a[60:63], a[164:167], v[76:79]
 buffer_load_dwordx4 v11, s[16:19], s21 offen offset:3072  nt lds
M v[76:79], a[56:59], a[160:163], v[76:79]
 s_add_u32 s21, s21, 524160
 v_sub_f32 v50, v50, v27
 v_sub_f32 v51, v51, v27
M v[80:83], a[64:67], a[160:163], v[80:83]
 v_sub_f32 v52, v52, v27
 v_sub_f32 v53, v53, v27
M v[80:83], a[68:71], a[164:167], v[80:83]
 v_sub_f32 v54, v54, v27
 v_sub_f32 v55, v55, v27
M v[84:87], a[76:79], a[164:167], v[84:87]
 v_sub_f32 v56, v56, v27
 v_sub_f32 v57, v57, v27
M v[84:87], a[72:75], a[160:163], v[84:87]
 v_sub_f32 v58, v58, v27
 v_sub_f32 v59, v59, v27
M v[88:91], a[80:83], a[160:163], v[88:91]
 v_sub_f32 v60, v60, v27
 v_sub_f32 v61, v61, v27
M v[88:91], a[84:87], a[164:167], v[88:91]
 s_waitcnt lgkmcnt(2)
 v_sub_f32 v62, v62, v27
 v_sub_f32 v63, v63, v27
M v[92:95], a[92:95], a[164:167], v[92:95]
 s_waitcnt vmcnt(17) lgkmcnt(0)
M v[92:95], a[88:91], a[160:163], v[92:95]
 s_barrier
M v[96:99], a[32:35], a[168:171], v[96:99]
 ds_read_b128 a[160:163], v5 offset:16384
 ds_read_b128 a[164:167], v6 offset:16384
M v[96:99], a[36:39], a[172:175], v[96:99]
M v[100:103], a[44:47], a[172:175], v[100:103]
 s_add_u32 m0, s24, 0
 ds_read_b64_tr_b16 a[128:129], v1 offset:49152
 ds_read_b64_tr_b16 a[130:131], v1 offset:50176
M v[100:103], a[40:43], a[168:171], v[100:103]
 buffer_load_dwordx4 v12, s[48:51], s22 offen offset:0   lds
M v[104:107], a[48:51], a[168:171], v[104:107]
 v_sub_f32 v80, v80, v27
 v_sub_f32 v81, v81, v27
M v[104:107], a[52:55], a[172:175], v[104:107]
 v_sub_f32 v82, v82, v27
 v_sub_f32 v83, v83, v27
M v[108:111], a[60:63], a[172:175], v[108:111]
 v_sub_f32 v84, v84, v27
 v_sub_f32 v85, v85, v27
M v[108:111], a[56:59], a[168:171], v[108:111]
 v_sub_f32 v86, v86, v27
 v_sub_f32 v87, v87, v27
M v[112:115], a[64:67], a[168:171], v[112:115]
 v_sub_f32 v88, v88, v27
 v_sub_f32 v89, v89, v27
M v[112:115], a[68:71], a[172:175], v[112:115]
 ds_read_b64_tr_b16 a[132:133], v1 offset:57344
 ds_read_b64_tr_b16 a[134:135], v1 offset:58368
M v[116:119], a[76:79], a[172:175], v[116:119]
 buffer_load_dwordx4 v13, s[48:51], s22 offen offset:1024   lds
M v[116:119], a[72:75], a[168:171], v[116:119]
 v_sub_f32 v90, v90, v27
 v_sub_f32 v91, v91, v27
M v[120:123], a[80:83], a[168:171], v[120:123]
 v_sub_f32 v92, v92, v27
 v_sub_f32 v93, v93, v27
M v[120:123], a[84:87], a[172:175], v[120:123]
 s_waitcnt lgkmcnt(4)
 v_sub_f32 v94, v94, v27
 v_sub_f32 v95, v95, v27
M v[124:127], a[92:95], a[172:175], v[124:127]
M v[124:127], a[88:91], a[168:171], v[124:127]
M v[128:131], a[32:35], a[160:163], v[128:131]
 ds_read_b128 a[168:171], v5 offset:18432
 ds_read_b128 a[172:175], v6 offset:18432
M v[128:131], a[36:39], a[164:167], v[128:131]
 ds_read_b64_tr_b16 a[136:137], v2 offset:49152
 ds_read_b64_tr_b16 a[138:139], v2 offset:50176
M v[132:135], a[44:47], a[164:167], v[132:135]
 buffer_load_dwordx4 v14, s[48:51], s22 offen offset:2048   lds
M v[132:135], a[40:43], a[160:163], v[132:135]
M v[136:139], a[48:51], a[160:163], v[136:139]
 v_sub_f32 v112, v112, v27
 v_sub_f32 v113, v113, v27
M v[136:139], a[52:55], a[164:167], v[136:139]
 v_sub_f32 v114, v114, v27
 v_sub_f32 v115, v115, v27
M v[140:143], a[60:63], a[164:167], v[140:143]
 v_sub_f32 v116, v116, v27
 v_sub_f32 v117, v117, v27
M v[140:143], a[56:59], a[160:163], v[140:143]
 ds_read_b64_tr_b16 a[140:141], v2 offset:57344
 ds_read_b64_tr_b16 a[142:143], v2 offset:58368
M v[144:147], a[64:67], a[160:163], v[144:147]
 buffer_load_dwordx4 v15, s[48:51], s22 offen offset:3072   lds
M v[144:147], a[68:71], a[164:167], v[144:147]
 s_add_u32 s22, s22, 2097152
 v_sub_f32 v118, v118, v27
 v_sub_f32 v119, v119, v27
M v[148:151], a[76:79], a[164:167], v[148:151]
 v_sub_f32 v120, v120, v27
 v_sub_f32 v121, v121, v27
M v[148:151], a[72:75], a[160:163], v[148:151]
 v_sub_f32 v122, v122, v27
 v_sub_f32 v123, v123, v27
M v[152:155], a[80:83], a[160:163], v[152:155]
 v_sub_f32 v124, v124, v27
 v_sub_f32 v125, v125, v27
M v[152:155], a[84:87], a[164:167], v[152:155]
 s_waitcnt lgkmcnt(4)
 v_sub_f32 v126, v126, v27
 v_sub_f32 v127, v127, v27
M v[156:159], a[92:95], a[164:167], v[156:159]
 s_add_u32 m0, s23, 32768
 ds_read_b64_tr_b16 a[144:145], v3 offset:49152
 ds_read_b64_tr_b16 a[146:147], v3 offset:50176
M v[156:159], a[88:91], a[160:163], v[156:159]
 buffer_load_dwordx4 v8, s[16:19], s21 offen offset:0  nt lds
M v[160:163], a[32:35], a[168:171], v[160:163]
 ds_read_b128 a[160:163], v5 offset:20480
 ds_read_b128 a[164:167], v6 offset:20480
M v[160:163], a[36:39], a[172:175], v[160:163]
M v[164:167], a[44:47], a[172:175], v[164:167]
M v[164:167], a[40:43], a[168:171], v[164:167]
M v[168:171], a[48:51], a[168:171], v[168:171]
 v_sub_f32 v128, v128, v27
 v_sub_f32 v129, v129, v27
M v[168:171], a[52:55], a[172:175], v[168:171]
 ds_read_b64_tr_b16 a[148:149], v3 offset:57344
 ds_read_b64_tr_b16 a[150:151], v3 offset:58368
M v[172:175], a[60:63], a[172:175], v[172:175]
 buffer_load_dwordx4 v9, s[16:19], s21 offen offset:1024  nt lds
M v[172:175], a[56:59], a[168:171], v[172:175]
 v_sub_f32 v130, v130, v27
 v_sub_f32 v131, v131, v27
M v[176:179], a[64:67], a[168:171], v[176:179]
 v_sub_f32 v132, v132, v27
 v_sub_f32 v133, v133, v27
M v[176:179], a[68:71], a[172:175], v[176:179]
 v_sub_f32 v134, v134, v27
 v_sub_f32 v135, v135, v27
M v[180:183], a[76:79], a[172:175], v[180:183]
 v_sub_f32 v136, v136, v27
 v_sub_f32 v137, v137, v27
M v[180:183], a[72:75], a[168:171], v[180:183]
 v_sub_f32 v138, v138, v27
 v_sub_f32 v139, v139, v27
M v[184:187], a[80:83], a[168:171], v[184:187]
 ds_read_b64_tr_b16 a[152:153], v4 offset:49152
 ds_read_b64_tr_b16 a[154:155], v4 offset:50176
M v[184:187], a[84:87], a[172:175], v[184:187]
 s_waitcnt lgkmcnt(4)
 v_sub_f32 v140, v140, v27
 v_sub_f32 v141, v141, v27
M v[188:191], a[92:95], a[172:175], v[188:191]
 buffer_load_dwordx4 v10, s[16:19], s21 offen offset:2048  nt lds
M v[188:191], a[88:91], a[168:171], v[188:191]
 v_sub_f32 v142, v142, v27
 v_sub_f32 v143, v143, v27
M v[192:195], a[32:35], a[160:163], v[192:195]
 ds_read_b128 a[168:171], v5 offset:22528
 ds_read_b128 a[172:175], v6 offset:22528
M v[192:195], a[36:39], a[164:167], v[192:195]
 v_sub_f32 v144, v144, v27
 v_sub_f32 v145, v145, v27
M v[196:199], a[44:47], a[164:167], v[196:199]
 v_sub_f32 v146, v146, v27
 v_sub_f32 v147, v147, v27
M v[196:199], a[40:43], a[160:163], v[196:199]
 ds_read_b64_tr_b16 a[156:157], v4 offset:57344
 ds_read_b64_tr_b16 a[158:159], v4 offset:58368
M v[200:203], a[48:51], a[160:163], v[200:203]
 buffer_load_dwordx4 v11, s[16:19], s21 offen offset:3072  nt lds
M v[200:203], a[52:55], a[164:167], v[200:203]
 s_add_u32 s21, s21, 128
 v_sub_f32 v148, v148, v27
 v_sub_f32 v149, v149, v27
M v[204:207], a[60:63], a[164:167], v[204:207]
 v_sub_f32 v150, v150, v27
 v_sub_f32 v151, v151, v27
M v[204:207], a[56:59], a[160:163], v[204:207]
 v_sub_f32 v152, v152, v27
 v_sub_f32 v153, v153, v27
M v[208:211], a[64:67], a[160:163], v[208:211]
 v_sub_f32 v154, v154, v27
 v_sub_f32 v155, v155, v27
M v[208:211], a[68:71], a[164:167], v[208:211]
 v_sub_f32 v156, v156, v27
 v_sub_f32 v157, v157, v27
M v[212:215], a[76:79], a[164:167], v[212:215]
 v_sub_f32 v158, v158, v27
 v_sub_f32 v159, v159, v27
M v[212:215], a[72:75], a[160:163], v[212:215]
M v[216:219], a[80:83], a[160:163], v[216:219]
M v[216:219], a[84:87], a[164:167], v[216:219]
 s_waitcnt lgkmcnt(2)
M v[220:223], a[92:95], a[164:167], v[220:223]
 s_waitcnt vmcnt(17) lgkmcnt(0)
M v[220:223], a[88:91], a[160:163], v[220:223]
 s_barrier
M v[224:227], a[32:35], a[168:171], v[224:227]
 ds_read_b128 a[160:163], v5 offset:32768
 ds_read_b128 a[164:167], v6 offset:32768
M v[224:227], a[36:39], a[172:175], v[224:227]
 buffer_load_dword a240, v23, s[52:55], 0 offen offset:0
M v[228:231], a[44:47], a[172:175], v[228:231]
 v_add_u32 v23, 16384, v23
M v[228:231], a[40:43], a[168:171], v[228:231]
M v[232:235], a[48:51], a[168:171], v[232:235]
M v[232:235], a[52:55], a[172:175], v[232:235]
M v[236:239], a[60:63], a[172:175], v[236:239]
M v[236:239], a[56:59], a[168:171], v[236:239]
M v[240:243], a[64:67], a[168:171], v[240:243]
M v[240:243], a[68:71], a[172:175], v[240:243]
M v[244:247], a[76:79], a[172:175], v[244:247]
M v[244:247], a[72:75], a[168:171], v[244:247]
M v[248:251], a[80:83], a[168:171], v[248:251]
M v[248:251], a[84:87], a[172:175], v[248:251]
 s_waitcnt lgkmcnt(0)
M v[252:255], a[92:95], a[172:175], v[252:255]
M v[252:255], a[88:91], a[168:171], v[252:255]
M a[0:3], a[96:99], a[160:163], a[0:3]
 ds_read_b128 a[168:171], v5 offset:34816
 ds_read_b128 a[172:175], v6 offset:34816
M a[0:3], a[100:103], a[164:167], a[0:3]
 ds_read_b64_tr_b16 a[32:33], v1 offset:0
 ds_read_b64_tr_b16 a[34:35], v1 offset:1024
M a[4:7], a[108:111], a[164:167], a[4:7]
 s_add_u32 m0, s24, 16384
M a[4:7], a[104:107], a[160:163], a[4:7]
 buffer_load_dwordx4 v12, s[48:51], s22 offen offset:0   lds
M a[8:11], a[112:115], a[160:163], a[8:11]
M a[8:11], a[116:119], a[164:167], a[8:11]
M a[12:15], a[124:127], a[164:167], a[12:15]
 ds_read_b64_tr_b16 a[36:37], v1 offset:8192
 ds_read_b64_tr_b16 a[38:39], v1 offset:9216
M a[12:15], a[120:123], a[160:163], a[12:15]
M a[16:19], a[128:131], a[160:163], a[16:19]
 buffer_load_dwordx4 v13, s[48:51], s22 offen offset:1024   lds
M a[16:19], a[132:135], a[164:167], a[16:19]
M a[20:23], a[140:143], a[164:167], a[20:23]
M a[20:23], a[136:139], a[160:163], a[20:23]
 ds_read_b64_tr_b16 a[40:41], v2 offset:0
 ds_read_b64_tr_b16 a[42:43], v2 offset:1024
M a[24:27], a[144:147], a[160:163], a[24:27]
M a[24:27], a[148:151], a[164:167], a[24:27]
 s_waitcnt lgkmcnt(6)
M a[28:31], a[156:159], a[164:167], a[28:31]
 buffer_load_dwordx4 v14, s[48:51], s22 offen offset:2048   lds
M a[28:31], a[152:155], a[160:163], a[28:31]
M v[32:35], a[96:99], a[168:171], v[32:35]
 ds_read_b128 a[160:163], v5 offset:36864
 ds_read_b128 a[164:167], v6 offset:36864
M v[32:35], a[100:103], a[172:175], v[32:35]
 ds_read_b64_tr_b16 a[44:45], v2 offset:8192
 ds_read_b64_tr_b16 a[46:47], v2 offset:9216
M v[36:39], a[108:111], a[172:175], v[36:39]
 buffer_load_dwordx4 v15, s[48:51], s22 offen offset:3072   lds
M v[36:39], a[104:107], a[168:171], v[36:39]
 s_sub_u32 s22, s22, 2097024
M v[40:43], a[112:115], a[168:171], v[40:43]
M v[40:43], a[116:119], a[172:175], v[40:43]
 ds_read_b64_tr_b16 a[48:49], v3 offset:0
 ds_read_b64_tr_b16 a[50:51], v3 offset:1024
M v[44:47], a[124:127], a[172:175], v[44:47]
 s_add_u32 m0, s23, 49152
M v[44:47], a[120:123], a[168:171], v[44:47]
 buffer_load_dwordx4 v8, s[16:19], s21 offen offset:0  nt lds
M v[48:51], a[128:131], a[168:171], v[48:51]
M v[48:51], a[132:135], a[172:175], v[48:51]
M v[52:55], a[140:143], a[172:175], v[52:55]
 ds_read_b64_tr_b16 a[52:53], v3 offset:8192
 ds_read_b64_tr_b16 a[54:55], v3 offset:9216
M v[52:55], a[136:139], a[168:171], v[52:55]
M v[56:59], a[144:147], a[168:171], v[56:59]
 buffer_load_dwordx4 v9, s[16:19], s21 offen offset:1024  nt lds
M v[56:59], a[148:151], a[172:175], v[56:59]
 s_waitcnt lgkmcnt(6)
M v[60:63], a[156:159], a[172:175], v[60:63]
M v[60:63], a[152:155], a[168:171], v[60:63]
 ds_read_b64_tr_b16 a[56:57], v4 offset:0
 ds_read_b64_tr_b16 a[58:59], v4 offset:1024
M v[64:67], a[96:99], a[160:163], v[64:67]
 ds_read_b128 a[168:171], v5 offset:38912
 ds_read_b128 a[172:175], v6 offset:38912
M v[64:67], a[100:103], a[164:167], v[64:67]
 buffer_load_dwordx4 v10, s[16:19], s21 offen offset:2048  nt lds
M v[68:71], a[108:111], a[164:167], v[68:71]
M v[68:71], a[104:107], a[160:163], v[68:71]
M v[72:75], a[112:115], a[160:163], v[72:75]
 ds_read_b64_tr_b16 a[60:61], v4 offset:8192
 ds_read_b64_tr_b16 a[62:63], v4 offset:9216
M v[72:75], a[116:119], a[164:167], v[72:75]
M v[76:79], a[124:127], a[164:167], v[76:79]
 buffer_load_dwordx4 v11, s[16:19], s21 offen offset:3072  nt lds
M v[76:79], a[120:123], a[160:163], v[76:79]
 s_add_u32 s21, s21, 524160
M v[80:83], a[128:131], a[160:163], v[80:83]
M v[80:83], a[132:135], a[164:167], v[80:83]
M v[84:87], a[140:143], a[164:167], v[84:87]
M v[84:87], a[136:139], a[160:163], v[84:87]
M v[88:91], a[144:147], a[160:163], v[88:91]
M v[88:91], a[148:151], a[164:167], v[88:91]
 s_waitcnt lgkmcnt(2)
M v[92:95], a[156:159], a[164:167], v[92:95]
 s_waitcnt vmcnt(17) lgkmcnt(0)
M v[92:95], a[152:155], a[160:163], v[92:95]
 s_barrier
M v[96:99], a[96:99], a[168:171], v[96:99]
 ds_read_b128 a[160:163], v5 offset:49152
 ds_read_b128 a[164:167], v6 offset:49152
M v[96:99], a[100:103], a[172:175], v[96:99]
M v[100:103], a[108:111], a[172:175], v[100:103]
 s_add_u32 m0, s24, 32768
 ds_read_b64_tr_b16 a[64:65], v1 offset:16384
 ds_read_b64_tr_b16 a[66:67], v1 offset:17408
M v[100:103], a[104:107], a[168:171], v[100:103]
 buffer_load_dwordx4 v12, s[48:51], s22 offen offset:0   lds
M v[104:107], a[112:115], a[168:171], v[104:107]
M v[104:107], a[116:119], a[172:175], v[104:107]
M v[108:111], a[124:127], a[172:175], v[108:111]
M v[108:111], a[120:123], a[168:171], v[108:111]
M v[112:115], a[128:131], a[168:171], v[112:115]
M v[112:115], a[132:135], a[172:175], v[112:115]
 ds_read_b64_tr_b16 a[68:69], v1 offset:24576
 ds_read_b64_tr_b16 a[70:71], v1 offset:25600
M v[116:119], a[140:143], a[172:175], v[116:119]
 buffer_load_dwordx4 v13, s[48:51], s22 offen offset:1024   lds
M v[116:119], a[136:139], a[168:171], v[116:119]
M v[120:123], a[144:147], a[168:171], v[120:123]
M v[120:123], a[148:151], a[172:175], v[120:123]
 s_waitcnt lgkmcnt(4)
M v[124:127], a[156:159], a[172:175], v[124:127]
M v[124:127], a[152:155], a[168:171], v[124:127]
M v[128:131], a[96:99], a[160:163], v[128:131]
 ds_read_b128 a[168:171], v5 offset:51200
 ds_read_b128 a[172:175], v6 offset:51200
M v[128:131], a[100:103], a[164:167], v[128:131]
 ds_read_b64_tr_b16 a[72:73], v2 offset:16384
 ds_read_b64_tr_b16 a[74:75], v2 offset:17408
M v[132:135], a[108:111], a[164:167], v[132:135]
 buffer_load_dwordx4 v14, s[48:51], s22 offen offset:2048   lds
M v[132:135], a[104:107], a[160:163], v[132:135]
M v[136:139], a[112:115], a[160:163], v[136:139]
M v[136:139], a[116:119], a[164:167], v[136:139]
M v[140:143], a[124:127], a[164:167], v[140:143]
M v[140:143], a[120:123], a[160:163], v[140:143]
 ds_read_b64_tr_b16 a[76:77], v2 offset:24576
 ds_read_b64_tr_b16 a[78:79], v2 offset:25600
M v[144:147], a[128:131], a[160:163], v[144:147]
 buffer_load_dwordx4 v15, s[48:51], s22 offen offset:3072   lds
M v[144:147], a[132:135], a[164:167], v[144:147]
 s_add_u32 s22, s22, 2097152
M v[148:151], a[140:143], a[164:167], v[148:151]
M v[148:151], a[136:139], a[160:163], v[148:151]
M v[152:155], a[144:147], a[160:163], v[152:155]
M v[152:155], a[148:151], a[164:167], v[152:155]
 s_waitcnt lgkmcnt(4)
M v[156:159], a[156:159], a[164:167], v[156:159]
 s_add_u32 m0, s23, 0
 ds_read_b64_tr_b16 a[80:81], v3 offset:16384
 ds_read_b64_tr_b16 a[82:83], v3 offset:17408
M v[156:159], a[152:155], a[160:163], v[156:159]
 buffer_load_dwordx4 v8, s[52:55], s28 offen offset:0   lds
M v[160:163], a[96:99], a[168:171], v[160:163]
 ds_read_b128 a[160:163], v5 offset:53248
 ds_read_b128 a[164:167], v6 offset:53248
M v[160:163], a[100:103], a[172:175], v[160:163]
M v[164:167], a[108:111], a[172:175], v[164:167]
M v[164:167], a[104:107], a[168:171], v[164:167]
M v[168:171], a[112:115], a[168:171], v[168:171]
M v[168:171], a[116:119], a[172:175], v[168:171]
 ds_read_b64_tr_b16 a[84:85], v3 offset:24576
 ds_read_b64_tr_b16 a[86:87], v3 offset:25600
M v[172:175], a[124:127], a[172:175], v[172:175]
 buffer_load_dwordx4 v9, s[52:55], s28 offen offset:1024   lds
M v[172:175], a[120:123], a[168:171], v[172:175]
M v[176:179], a[128:131], a[168:171], v[176:179]
M v[176:179], a[132:135], a[172:175], v[176:179]
M v[180:183], a[140:143], a[172:175], v[180:183]
M v[180:183], a[136:139], a[168:171], v[180:183]
M v[184:187], a[144:147], a[168:171], v[184:187]
 ds_read_b64_tr_b16 a[88:89], v4 offset:16384
 ds_read_b64_tr_b16 a[90:91], v4 offset:17408
M v[184:187], a[148:151], a[172:175], v[184:187]
 s_waitcnt lgkmcnt(4)
M v[188:191], a[156:159], a[172:175], v[188:191]
 buffer_load_dwordx4 v10, s[52:55], s28 offen offset:2048   lds
M v[188:191], a[152:155], a[168:171], v[188:191]
M v[192:195], a[96:99], a[160:163], v[192:195]
 ds_read_b128 a[168:171], v5 offset:55296
 ds_read_b128 a[172:175], v6 offset:55296
M v[192:195], a[100:103], a[164:167], v[192:195]
M v[196:199], a[108:111], a[164:167], v[196:199]
M v[196:199], a[104:107], a[160:163], v[196:199]
 ds_read_b64_tr_b16 a[92:93], v4 offset:24576
 ds_read_b64_tr_b16 a[94:95], v4 offset:25600
M v[200:203], a[112:115], a[160:163], v[200:203]
 buffer_load_dwordx4 v11, s[52:55], s28 offen offset:3072   lds
M v[200:203], a[116:119], a[164:167], v[200:203]
 s_add_u32 s28, s28, 128
 v_sub_f32 v160, v160, v27
 v_sub_f32 v161, v161, v27
M v[204:207], a[124:127], a[164:167], v[204:207]
 v_sub_f32 v162, v162, v27
 v_sub_f32 v163, v163, v27
M v[204:207], a[120:123], a[160:163], v[204:207]
 v_sub_f32 v164, v164, v27
 v_sub_f32 v165, v165, v27
M v[208:211], a[128:131], a[160:163], v[208:211]
 v_sub_f32 v166, v166, v27
 v_sub_f32 v167, v167, v27
M v[208:211], a[132:135], a[164:167], v[208:211]
 v_sub_f32 v168, v168, v27
 v_sub_f32 v169, v169, v27
M v[212:215], a[140:143], a[164:167], v[212:215]
 v_sub_f32 v170, v170, v27
 v_sub_f32 v171, v171, v27
M v[212:215], a[136:139], a[160:163], v[212:215]
 v_sub_f32 v172, v172, v27
 v_sub_f32 v173, v173, v27
M v[216:219], a[144:147], a[160:163], v[216:219]
 v_sub_f32 v174, v174, v27
 v_sub_f32 v175, v175, v27
M v[216:219], a[148:151], a[164:167], v[216:219]
 s_waitcnt lgkmcnt(2)
 v_sub_f32 v176, v176, v27
 v_sub_f32 v177, v177, v27
M v[220:223], a[156:159], a[164:167], v[220:223]
 s_waitcnt vmcnt(17) lgkmcnt(0)
 v_sub_f32 v178, v178, v27
 v_sub_f32 v179, v179, v27
M v[220:223], a[152:155], a[160:163], v[220:223]
 s_barrier
M v[224:227], a[96:99], a[168:171], v[224:227]
 ds_read_b128 a[160:163], v5 offset:0
 ds_read_b128 a[164:167], v6 offset:0
M v[224:227], a[100:103], a[172:175], v[224:227]
 v_and_b32 v26, 48, v0
 v_lshlrev_b32 v26, 17, v26
M v[228:231], a[108:111], a[172:175], v[228:231]
 v_or_b32 v26, v26, v0
 v_lshl_add_u32 v26, v26, 7, s95
M v[228:231], a[104:107], a[168:171], v[228:231]
 buffer_load_dword a240, v26, s[76:79], 0 offen offset:0
M v[232:235], a[112:115], a[168:171], v[232:235]
 v_sub_f32 v180, v180, v27
 v_sub_f32 v181, v181, v27
M v[232:235], a[116:119], a[172:175], v[232:235]
 v_sub_f32 v182, v182, v27
 v_sub_f32 v183, v183, v27
M v[236:239], a[124:127], a[172:175], v[236:239]
 v_sub_f32 v184, v184, v27
 v_sub_f32 v185, v185, v27
M v[236:239], a[120:123], a[168:171], v[236:239]
 v_sub_f32 v186, v186, v27
 v_sub_f32 v187, v187, v27
M v[240:243], a[128:131], a[168:171], v[240:243]
 v_sub_f32 v188, v188, v27
 v_sub_f32 v189, v189, v27
M v[240:243], a[132:135], a[172:175], v[240:243]
 v_sub_f32 v190, v190, v27
 v_sub_f32 v191, v191, v27
M v[244:247], a[140:143], a[172:175], v[244:247]
 v_sub_f32 v192, v192, v27
 v_sub_f32 v193, v193, v27
M v[244:247], a[136:139], a[168:171], v[244:247]
 v_sub_f32 v194, v194, v27
 v_sub_f32 v195, v195, v27
M v[248:251], a[144:147], a[168:171], v[248:251]
 v_sub_f32 v196, v196, v27
 v_sub_f32 v197, v197, v27
M v[248:251], a[148:151], a[172:175], v[248:251]
 s_waitcnt lgkmcnt(0)
 v_sub_f32 v198, v198, v27
 v_sub_f32 v199, v199, v27
M v[252:255], a[156:159], a[172:175], v[252:255]
 v_sub_f32 v200, v200, v27
 v_sub_f32 v201, v201, v27
M v[252:255], a[152:155], a[168:171], v[252:255]
 v_sub_f32 v202, v202, v27
 v_sub_f32 v203, v203, v27
M a[0:3], a[32:35], a[160:163], a[0:3]
 ds_read_b128 a[168:171], v5 offset:2048
 ds_read_b128 a[172:175], v6 offset:2048
M a[0:3], a[36:39], a[164:167], a[0:3]
 ds_read_b64_tr_b16 a[96:97], v1 offset:32768
 ds_read_b64_tr_b16 a[98:99], v1 offset:33792
M a[4:7], a[44:47], a[164:167], a[4:7]
 s_add_u32 m0, s24, 49152
 v_lshrrev_b32 v28, 4, v0
 v_add_u32 v28, 0, v28
M a[4:7], a[40:43], a[160:163], a[4:7]
 buffer_load_dwordx4 v12, s[48:51], s22 offen offset:0   lds
M a[8:11], a[48:51], a[160:163], a[8:11]
 v_and_b32 v29, 7, v0
 v_xor_b32 v28, v28, v29
M a[8:11], a[52:55], a[164:167], a[8:11]
 v_lshlrev_b32 v28, 4, v28
 v_lshrrev_b32 v29, 3, v0
M a[12:15], a[60:63], a[164:167], a[12:15]
 ds_read_b64_tr_b16 a[100:101], v1 offset:40960
 ds_read_b64_tr_b16 a[102:103], v1 offset:41984
M a[12:15], a[56:59], a[160:163], a[12:15]
 buffer_load_dwordx4 v13, s[48:51], s22 offen offset:1024   lds
M a[16:19], a[64:67], a[160:163], a[16:19]
 v_mul_u32_u24 v29, 896, v29
 s_mul_i32 s64, s20, 28672
M a[16:19], a[68:71], a[164:167], a[16:19]
 buffer_load_dwordx4 v14, s[48:51], s22 offen offset:2048   lds
M a[20:23], a[76:79], a[164:167], a[20:23]
 s_add_u32 s64, s64, 0
 v_add3_u32 v16, v29, v28, s64
M a[20:23], a[72:75], a[160:163], a[20:23]
 ds_read_b64_tr_b16 a[104:105], v2 offset:32768
 ds_read_b64_tr_b16 a[106:107], v2 offset:33792
M a[24:27], a[80:83], a[160:163], a[24:27]
 v_add_u32 v18, 12288, v16
 v_lshrrev_b32 v28, 4, v0
M a[24:27], a[84:87], a[164:167], a[24:27]
 s_waitcnt lgkmcnt(6)
 v_add_u32 v28, 4, v28
 v_and_b32 v29, 7, v0
M a[28:31], a[92:95], a[164:167], a[28:31]
 buffer_load_dwordx4 v15, s[48:51], s22 offen offset:3072   lds
M a[28:31], a[88:91], a[160:163], a[28:31]
 s_sub_u32 s22, s22, 2097024
 v_xor_b32 v28, v28, v29
 v_lshlrev_b32 v28, 4, v28
M v[32:35], a[32:35], a[168:171], v[32:35]
 s_add_u32 m0, s23, 16384
 ds_read_b128 a[160:163], v5 offset:4096
 ds_read_b128 a[164:167], v6 offset:4096
M v[32:35], a[36:39], a[172:175], v[32:35]
 ds_read_b64_tr_b16 a[108:109], v2 offset:40960
 ds_read_b64_tr_b16 a[110:111], v2 offset:41984
M v[36:39], a[44:47], a[172:175], v[36:39]
 buffer_load_dwordx4 v8, s[52:55], s28 offen offset:0   lds
M v[36:39], a[40:43], a[168:171], v[36:39]
 v_lshrrev_b32 v29, 3, v0
 v_mul_u32_u24 v29, 896, v29
M v[40:43], a[48:51], a[168:171], v[40:43]
 buffer_load_dwordx4 v9, s[52:55], s28 offen offset:1024   lds
M v[40:43], a[52:55], a[172:175], v[40:43]
 ds_read_b64_tr_b16 a[112:113], v3 offset:32768
 ds_read_b64_tr_b16 a[114:115], v3 offset:33792
M v[44:47], a[60:63], a[172:175], v[44:47]
 s_mul_i32 s64, s20, 28672
 s_add_u32 s64, s64, 6144
M v[44:47], a[56:59], a[168:171], v[44:47]
 buffer_load_dwordx4 v10, s[52:55], s28 offen offset:2048   lds
M v[48:51], a[64:67], a[168:171], v[48:51]
 v_add3_u32 v17, v29, v28, s64
 v_add_u32 v19, 12288, v17
M v[48:51], a[68:71], a[172:175], v[48:51]
 v_add_u32 v20, 0x20000, v1
 v_add_u32 v21, 0x20000, v2
M v[52:55], a[76:79], a[172:175], v[52:55]
 ds_read_b64_tr_b16 a[116:117], v3 offset:40960
 ds_read_b64_tr_b16 a[118:119], v3 offset:41984
M v[52:55], a[72:75], a[168:171], v[52:55]
 buffer_load_dwordx4 v11, s[52:55], s28 offen offset:3072   lds
M v[56:59], a[80:83], a[168:171], v[56:59]
 s_add_u32 s28, s28, 1048448
 v_add_u32 v22, 0x20000, v3
 v_add_u32 v23, 0x20000, v4
M v[56:59], a[84:87], a[172:175], v[56:59]
 s_waitcnt lgkmcnt(6)
 v_sub_f32 v204, v204, v27
 v_sub_f32 v205, v205, v27
M v[60:63], a[92:95], a[172:175], v[60:63]
 s_add_u32 m0, s23, 131072
 v_sub_f32 v206, v206, v27
 v_sub_f32 v207, v207, v27
M v[60:63], a[88:91], a[168:171], v[60:63]
 ds_read_b64_tr_b16 a[120:121], v4 offset:32768
 ds_read_b64_tr_b16 a[122:123], v4 offset:33792
M v[64:67], a[32:35], a[160:163], v[64:67]
 ds_read_b128 a[168:171], v5 offset:6144
 ds_read_b128 a[172:175], v6 offset:6144
M v[64:67], a[36:39], a[164:167], v[64:67]
 buffer_load_dwordx4 v8, s[52:55], s28 offen offset:0   lds
M v[68:71], a[44:47], a[164:167], v[68:71]
 buffer_load_dwordx4 v9, s[52:55], s28 offen offset:1024   lds
M v[68:71], a[40:43], a[160:163], v[68:71]
 v_sub_f32 v208, v208, v27
 v_sub_f32 v209, v209, v27
M v[72:75], a[48:51], a[160:163], v[72:75]
 ds_read_b64_tr_b16 a[124:125], v4 offset:40960
 ds_read_b64_tr_b16 a[126:127], v4 offset:41984
M v[72:75], a[52:55], a[164:167], v[72:75]
 buffer_load_dwordx4 v10, s[52:55], s28 offen offset:2048   lds
M v[76:79], a[60:63], a[164:167], v[76:79]
 v_sub_f32 v210, v210, v27
 v_sub_f32 v211, v211, v27
M v[76:79], a[56:59], a[160:163], v[76:79]
 v_sub_f32 v212, v212, v27
 v_sub_f32 v213, v213, v27
M v[80:83], a[64:67], a[160:163], v[80:83]
 buffer_load_dwordx4 v11, s[52:55], s28 offen offset:3072   lds
M v[80:83], a[68:71], a[164:167], v[80:83]
 s_sub_u32 s28, s28, 524288
 v_sub_f32 v214, v214, v27
 v_sub_f32 v215, v215, v27
M v[84:87], a[76:79], a[164:167], v[84:87]
 v_sub_f32 v216, v216, v27
 v_sub_f32 v217, v217, v27
M v[84:87], a[72:75], a[160:163], v[84:87]
 v_sub_f32 v218, v218, v27
 v_sub_f32 v219, v219, v27
M v[88:91], a[80:83], a[160:163], v[88:91]
 v_sub_f32 v220, v220, v27
 v_sub_f32 v221, v221, v27
M v[88:91], a[84:87], a[164:167], v[88:91]
 s_waitcnt lgkmcnt(2)
 v_sub_f32 v222, v222, v27
 v_sub_f32 v223, v223, v27
M v[92:95], a[92:95], a[164:167], v[92:95]
 s_waitcnt vmcnt(21) lgkmcnt(0)
 v_sub_f32 v224, v224, v27
 v_sub_f32 v225, v225, v27
M v[92:95], a[88:91], a[160:163], v[92:95]
 s_barrier
M v[96:99], a[32:35], a[168:171], v[96:99]
 ds_read_b128 a[160:163], v5 offset:16384
 ds_read_b128 a[164:167], v6 offset:16384
M v[96:99], a[36:39], a[172:175], v[96:99]
 v_sub_f32 v226, v226, v27
 v_sub_f32 v227, v227, v27
M v[100:103], a[44:47], a[172:175], v[100:103]
 s_add_u32 m0, s24, 0
 ds_read_b64_tr_b16 a[128:129], v1 offset:49152
 ds_read_b64_tr_b16 a[130:131], v1 offset:50176
M v[100:103], a[40:43], a[168:171], v[100:103]
 buffer_load_dwordx4 v16, s[56:59], s29 offen offset:0   lds
M v[104:107], a[48:51], a[168:171], v[104:107]
 s_mul_i32 s72, s41, 4352
 v_sub_f32 v228, v228, v27
M v[104:107], a[52:55], a[172:175], v[104:107]
 s_add_u32 s46, s72, 104923136
 v_sub_f32 v229, v229, v27
 v_sub_f32 v230, v230, v27
M v[108:111], a[60:63], a[172:175], v[108:111]
 s_lshl_b32 s45, s42, 7
 s_add_u32 s45, s45, s46
 s_sub_u32 s66, 15, s42
M v[108:111], a[56:59], a[168:171], v[108:111]
 buffer_load_dwordx4 v17, s[56:59], s29 offen offset:1024   lds
M v[112:115], a[64:67], a[168:171], v[112:115]
 s_min_u32 s66, s66, s42
 v_sub_f32 v231, v231, v27
M v[112:115], a[68:71], a[172:175], v[112:115]
 s_lshl_b32 s47, s66, 7
 ds_read_b64_tr_b16 a[132:133], v1 offset:57344
 ds_read_b64_tr_b16 a[134:135], v1 offset:58368
M v[116:119], a[76:79], a[172:175], v[116:119]
 s_add_u32 s47, s47, s46
 v_sub_f32 v232, v232, v27
 v_sub_f32 v233, v233, v27
M v[116:119], a[72:75], a[168:171], v[116:119]
 s_add_u32 s47, s47, 2048
 s_lshl_b32 s65, s41, 3
 s_add_u32 s65, s65, s66
M v[120:123], a[80:83], a[168:171], v[120:123]
 buffer_load_dwordx4 v18, s[56:59], s29 offen offset:2048   lds
M v[120:123], a[84:87], a[172:175], v[120:123]
 s_waitcnt lgkmcnt(4)
 s_mul_i32 s34, s65, 73728
 v_sub_f32 v234, v234, v27
M v[124:127], a[92:95], a[172:175], v[124:127]
 s_add_u32 s34, s34, 50331648
 v_sub_f32 v235, v235, v27
 v_sub_f32 v236, v236, v27
M v[124:127], a[88:91], a[168:171], v[124:127]
 s_lshl_b32 s65, s42, 4
 v_sub_f32 v237, v237, v27
 v_sub_f32 v238, v238, v27
M v[128:131], a[32:35], a[160:163], v[128:131]
 s_add_u32 s65, s65, s41
 ds_read_b128 a[168:171], v5 offset:18432
 ds_read_b128 a[172:175], v6 offset:18432
M v[128:131], a[36:39], a[164:167], v[128:131]
 s_mul_i32 s33, s65, 114688
 ds_read_b64_tr_b16 a[136:137], v2 offset:49152
 ds_read_b64_tr_b16 a[138:139], v2 offset:50176
M v[132:135], a[44:47], a[164:167], v[132:135]
 buffer_load_dwordx4 v19, s[56:59], s29 offen offset:3072   lds
M v[132:135], a[40:43], a[160:163], v[132:135]
 s_add_u32 s29, s29, 128
 s_mul_i32 s65, s20, 28672
 v_sub_f32 v239, v239, v27
M v[136:139], a[48:51], a[160:163], v[136:139]
 s_add_u32 s33, s33, s65
 s_add_u32 s33, s33, 67108864
 s_sub_u32 s65, 15, s66
M v[136:139], a[52:55], a[164:167], v[136:139]
 s_add_u32 m0, s23, 32768
 s_lshl_b32 s65, s65, 16
 s_lshl_b32 s64, s41, 20
M v[140:143], a[60:63], a[164:167], v[140:143]
 buffer_load_dwordx4 v8, s[52:55], s28 offen offset:0   lds
M v[140:143], a[56:59], a[160:163], v[140:143]
 ds_read_b64_tr_b16 a[140:141], v2 offset:57344
 ds_read_b64_tr_b16 a[142:143], v2 offset:58368
M v[144:147], a[64:67], a[160:163], v[144:147]
 s_add_u32 s32, s64, s65
 v_sub_f32 v240, v240, v27
M v[144:147], a[68:71], a[164:167], v[144:147]
 s_lshl_b32 s65, s20, 14
 s_add_u32 s32, s32, s65
 s_add_u32 s32, s32, 33554432
M v[148:151], a[76:79], a[164:167], v[148:151]
 buffer_load_dwordx4 v9, s[52:55], s28 offen offset:1024   lds
M v[148:151], a[72:75], a[160:163], v[148:151]
 s_mov_b32 s31, 0x53800000
 v_sub_f32 v241, v241, v27
M v[152:155], a[80:83], a[160:163], v[152:155]
 s_mov_b32 s40, 1
 s_sub_u32 s64, s42, 10
 s_and_b32 s35, s64, 536870912
M v[152:155], a[84:87], a[164:167], v[152:155]
 s_waitcnt lgkmcnt(4)
 v_sub_f32 v242, v242, v27
 v_sub_f32 v243, v243, v27
M v[156:159], a[92:95], a[164:167], v[156:159]
 ds_read_b64_tr_b16 a[144:145], v3 offset:49152
 ds_read_b64_tr_b16 a[146:147], v3 offset:50176
M v[156:159], a[88:91], a[160:163], v[156:159]
 buffer_load_dwordx4 v10, s[52:55], s28 offen offset:2048   lds
M v[160:163], a[32:35], a[168:171], v[160:163]
 ds_read_b128 a[160:163], v5 offset:20480
 ds_read_b128 a[164:167], v6 offset:20480
M v[160:163], a[36:39], a[172:175], v[160:163]
 v_sub_f32 v244, v244, v27
 v_sub_f32 v245, v245, v27
M v[164:167], a[44:47], a[172:175], v[164:167]
 v_sub_f32 v246, v246, v27
 v_sub_f32 v247, v247, v27
M v[164:167], a[40:43], a[168:171], v[164:167]
 v_sub_f32 v248, v248, v27
 v_sub_f32 v249, v249, v27
M v[168:171], a[48:51], a[168:171], v[168:171]
 buffer_load_dwordx4 v11, s[52:55], s28 offen offset:3072   lds
M v[168:171], a[52:55], a[172:175], v[168:171]
 s_add_u32 s28, s28, 524416
 ds_read_b64_tr_b16 a[148:149], v3 offset:57344
 ds_read_b64_tr_b16 a[150:151], v3 offset:58368
M v[172:175], a[60:63], a[172:175], v[172:175]
 v_sub_f32 v250, v250, v27
 v_sub_f32 v251, v251, v27
M v[172:175], a[56:59], a[168:171], v[172:175]
 v_sub_f32 v252, v252, v27
 v_sub_f32 v253, v253, v27
M v[176:179], a[64:67], a[168:171], v[176:179]
 s_add_u32 m0, s23, 147456
 v_sub_f32 v254, v254, v27
 v_sub_f32 v255, v255, v27
M v[176:179], a[68:71], a[172:175], v[176:179]
 buffer_load_dwordx4 v8, s[52:55], s28 offen offset:0   lds
M v[180:183], a[76:79], a[172:175], v[180:183]
M v[180:183], a[72:75], a[168:171], v[180:183]
M v[184:187], a[80:83], a[168:171], v[184:187]
 ds_read_b64_tr_b16 a[152:153], v4 offset:49152
 ds_read_b64_tr_b16 a[154:155], v4 offset:50176
M v[184:187], a[84:87], a[172:175], v[184:187]
 s_waitcnt lgkmcnt(4)
M v[188:191], a[92:95], a[172:175], v[188:191]
 buffer_load_dwordx4 v9, s[52:55], s28 offen offset:1024   lds
M v[188:191], a[88:91], a[168:171], v[188:191]
M v[192:195], a[32:35], a[160:163], v[192:195]
 ds_read_b128 a[168:171], v5 offset:22528
 ds_read_b128 a[172:175], v6 offset:22528
M v[192:195], a[36:39], a[164:167], v[192:195]
M v[196:199], a[44:47], a[164:167], v[196:199]
 buffer_load_dwordx4 v10, s[52:55], s28 offen offset:2048   lds
M v[196:199], a[40:43], a[160:163], v[196:199]
 ds_read_b64_tr_b16 a[156:157], v4 offset:57344
 ds_read_b64_tr_b16 a[158:159], v4 offset:58368
M v[200:203], a[48:51], a[160:163], v[200:203]
M v[200:203], a[52:55], a[164:167], v[200:203]
M v[204:207], a[60:63], a[164:167], v[204:207]
M v[204:207], a[56:59], a[160:163], v[204:207]
 buffer_load_dwordx4 v11, s[52:55], s28 offen offset:3072   lds
M v[208:211], a[64:67], a[160:163], v[208:211]
 s_sub_u32 s28, s28, 524288
M v[208:211], a[68:71], a[164:167], v[208:211]
M v[212:215], a[76:79], a[164:167], v[212:215]
M v[212:215], a[72:75], a[160:163], v[212:215]
M v[216:219], a[80:83], a[160:163], v[216:219]
M v[216:219], a[84:87], a[164:167], v[216:219]
 s_waitcnt lgkmcnt(2)
M v[220:223], a[92:95], a[164:167], v[220:223]
 s_waitcnt vmcnt(25) lgkmcnt(0)
M v[220:223], a[88:91], a[160:163], v[220:223]
 s_barrier
M v[224:227], a[32:35], a[168:171], v[224:227]
 ds_read_b128 a[160:163], v5 offset:32768
 ds_read_b128 a[164:167], v6 offset:32768
M v[224:227], a[36:39], a[172:175], v[224:227]
M v[228:231], a[44:47], a[172:175], v[228:231]
M v[228:231], a[40:43], a[168:171], v[228:231]
M v[232:235], a[48:51], a[168:171], v[232:235]
M v[232:235], a[52:55], a[172:175], v[232:235]
M v[236:239], a[60:63], a[172:175], v[236:239]
M v[236:239], a[56:59], a[168:171], v[236:239]
M v[240:243], a[64:67], a[168:171], v[240:243]
M v[240:243], a[68:71], a[172:175], v[240:243]
M v[244:247], a[76:79], a[172:175], v[244:247]
M v[244:247], a[72:75], a[168:171], v[244:247]
M v[248:251], a[80:83], a[168:171], v[248:251]
M v[248:251], a[84:87], a[172:175], v[248:251]
 s_waitcnt lgkmcnt(0)
M v[252:255], a[92:95], a[172:175], v[252:255]
M v[252:255], a[88:91], a[168:171], v[252:255]
M a[0:3], a[96:99], a[160:163], a[0:3]
 ds_read_b128 a[168:171], v5 offset:34816
 ds_read_b128 a[172:175], v6 offset:34816
M a[0:3], a[100:103], a[164:167], a[0:3]
 ds_read_b64_tr_b16 a[32:33], v1 offset:0
 ds_read_b64_tr_b16 a[34:35], v1 offset:1024
M a[4:7], a[108:111], a[164:167], a[4:7]
 s_add_u32 m0, s24, 16384
M a[4:7], a[104:107], a[160:163], a[4:7]
 buffer_load_dwordx4 v16, s[56:59], s29 offen offset:0   lds
M a[8:11], a[112:115], a[160:163], a[8:11]
M a[8:11], a[116:119], a[164:167], a[8:11]
M a[12:15], a[124:127], a[164:167], a[12:15]
 ds_read_b64_tr_b16 a[36:37], v1 offset:8192
 ds_read_b64_tr_b16 a[38:39], v1 offset:9216
M a[12:15], a[120:123], a[160:163], a[12:15]
M a[16:19], a[128:131], a[160:163], a[16:19]
 buffer_load_dwordx4 v17, s[56:59], s29 offen offset:1024   lds
M a[16:19], a[132:135], a[164:167], a[16:19]
 v_accvgpr_read_b32 v24, a0
 v_accvgpr_read_b32 v25, a1
M a[20:23], a[140:143], a[164:167], a[20:23]
 v_accvgpr_read_b32 v26, a2
 v_accvgpr_read_b32 v27, a3
M a[20:23], a[136:139], a[160:163], a[20:23]
 ds_read_b64_tr_b16 a[40:41], v2 offset:0
 ds_read_b64_tr_b16 a[42:43], v2 offset:1024
M a[24:27], a[144:147], a[160:163], a[24:27]
 v_accvgpr_read_b32 v28, a4
 v_accvgpr_read_b32 v29, a5
M a[24:27], a[148:151], a[164:167], a[24:27]
 s_waitcnt lgkmcnt(6)
 buffer_load_dwordx4 v18, s[56:59], s29 offen offset:2048   lds
M a[28:31], a[156:159], a[164:167], a[28:31]
 v_accvgpr_read_b32 v30, a6
 v_accvgpr_read_b32 v31, a7
M a[28:31], a[152:155], a[160:163], a[28:31]
 v_cvt_pk_bf16_f32 v24, v24, v25
 v_cvt_pk_bf16_f32 v25, v26, v27
M v[32:35], a[96:99], a[168:171], v[32:35]
 ds_read_b128 a[160:163], v5 offset:36864
 ds_read_b128 a[164:167], v6 offset:36864
M v[32:35], a[100:103], a[172:175], v[32:35]
 ds_read_b64_tr_b16 a[44:45], v2 offset:8192
 ds_read_b64_tr_b16 a[46:47], v2 offset:9216
M v[36:39], a[108:111], a[172:175], v[36:39]
 buffer_load_dwordx4 v19, s[56:59], s29 offen offset:3072   lds
M v[36:39], a[104:107], a[168:171], v[36:39]
 s_add_u32 s29, s29, 128
 v_cvt_pk_bf16_f32 v26, v28, v29
 v_cvt_pk_bf16_f32 v27, v30, v31
M v[40:43], a[112:115], a[168:171], v[40:43]
 s_add_u32 s3, s93, 0
 buffer_store_dwordx4 v[24:27], v7, s[8:11], s3 offen offset:0 sc1
M v[40:43], a[116:119], a[172:175], v[40:43]
 ds_read_b64_tr_b16 a[48:49], v3 offset:0
 ds_read_b64_tr_b16 a[50:51], v3 offset:1024
M v[44:47], a[124:127], a[172:175], v[44:47]
 s_add_u32 m0, s23, 49152
 v_accvgpr_read_b32 v24, a8
 v_accvgpr_read_b32 v25, a9
M v[44:47], a[120:123], a[168:171], v[44:47]
 buffer_load_dwordx4 v8, s[52:55], s28 offen offset:0   lds
M v[48:51], a[128:131], a[168:171], v[48:51]
 v_accvgpr_read_b32 v26, a10
 v_accvgpr_read_b32 v27, a11
M v[48:51], a[132:135], a[172:175], v[48:51]
 v_accvgpr_read_b32 v28, a12
 v_accvgpr_read_b32 v29, a13
M v[52:55], a[140:143], a[172:175], v[52:55]
 ds_read_b64_tr_b16 a[52:53], v3 offset:8192
 ds_read_b64_tr_b16 a[54:55], v3 offset:9216
M v[52:55], a[136:139], a[168:171], v[52:55]
 v_accvgpr_read_b32 v30, a14
 v_accvgpr_read_b32 v31, a15
M v[56:59], a[144:147], a[168:171], v[56:59]
 buffer_load_dwordx4 v9, s[52:55], s28 offen offset:1024   lds
M v[56:59], a[148:151], a[172:175], v[56:59]
 s_waitcnt lgkmcnt(6)
 v_cvt_pk_bf16_f32 v24, v24, v25
 v_cvt_pk_bf16_f32 v25, v26, v27
M v[60:63], a[156:159], a[172:175], v[60:63]
 v_cvt_pk_bf16_f32 v26, v28, v29
 v_cvt_pk_bf16_f32 v27, v30, v31
M v[60:63], a[152:155], a[168:171], v[60:63]
 ds_read_b64_tr_b16 a[56:57], v4 offset:0
 ds_read_b64_tr_b16 a[58:59], v4 offset:1024
M v[64:67], a[96:99], a[160:163], v[64:67]
 ds_read_b128 a[168:171], v5 offset:38912
 ds_read_b128 a[172:175], v6 offset:38912
M v[64:67], a[100:103], a[164:167], v[64:67]
 buffer_load_dwordx4 v10, s[52:55], s28 offen offset:2048   lds
M v[68:71], a[108:111], a[164:167], v[68:71]
M v[68:71], a[104:107], a[160:163], v[68:71]
 buffer_store_dwordx4 v[24:27], v7, s[8:11], s3 offen offset:1024 sc1
M v[72:75], a[112:115], a[160:163], v[72:75]
 ds_read_b64_tr_b16 a[60:61], v4 offset:8192
 ds_read_b64_tr_b16 a[62:63], v4 offset:9216
M v[72:75], a[116:119], a[164:167], v[72:75]
 v_accvgpr_read_b32 v24, a16
 v_accvgpr_read_b32 v25, a17
M v[76:79], a[124:127], a[164:167], v[76:79]
 buffer_load_dwordx4 v11, s[52:55], s28 offen offset:3072   lds
M v[76:79], a[120:123], a[160:163], v[76:79]
 s_add_u32 s28, s28, 1048448
 v_accvgpr_read_b32 v26, a18
 v_accvgpr_read_b32 v27, a19
M v[80:83], a[128:131], a[160:163], v[80:83]
 v_accvgpr_read_b32 v28, a20
 v_accvgpr_read_b32 v29, a21
M v[80:83], a[132:135], a[164:167], v[80:83]
 v_accvgpr_read_b32 v30, a22
 v_accvgpr_read_b32 v31, a23
M v[84:87], a[140:143], a[164:167], v[84:87]
 v_cvt_pk_bf16_f32 v24, v24, v25
 v_cvt_pk_bf16_f32 v25, v26, v27
M v[84:87], a[136:139], a[160:163], v[84:87]
 v_cvt_pk_bf16_f32 v26, v28, v29
 v_cvt_pk_bf16_f32 v27, v30, v31
M v[88:91], a[144:147], a[160:163], v[88:91]
 buffer_store_dwordx4 v[24:27], v7, s[8:11], s3 offen offset:2048 sc1
M v[88:91], a[148:151], a[164:167], v[88:91]
 s_waitcnt lgkmcnt(2)
 v_accvgpr_read_b32 v24, a24
 v_accvgpr_read_b32 v25, a25
M v[92:95], a[156:159], a[164:167], v[92:95]
 s_waitcnt vmcnt(27) lgkmcnt(0)
 v_accvgpr_read_b32 v26, a26
 v_accvgpr_read_b32 v27, a27
M v[92:95], a[152:155], a[160:163], v[92:95]
 s_barrier
M v[96:99], a[96:99], a[168:171], v[96:99]
 ds_read_b128 a[160:163], v5 offset:49152
 ds_read_b128 a[164:167], v6 offset:49152
M v[96:99], a[100:103], a[172:175], v[96:99]
 v_accvgpr_read_b32 v28, a28
 v_accvgpr_read_b32 v29, a29
M v[100:103], a[108:111], a[172:175], v[100:103]
 s_add_u32 m0, s24, 32768
 ds_read_b64_tr_b16 a[64:65], v1 offset:16384
 ds_read_b64_tr_b16 a[66:67], v1 offset:17408
M v[100:103], a[104:107], a[168:171], v[100:103]
 buffer_load_dwordx4 v16, s[56:59], s29 offen offset:0   lds
M v[104:107], a[112:115], a[168:171], v[104:107]
 v_accvgpr_read_b32 v30, a30
 v_accvgpr_read_b32 v31, a31
M v[104:107], a[116:119], a[172:175], v[104:107]
 v_cvt_pk_bf16_f32 v24, v24, v25
 v_cvt_pk_bf16_f32 v25, v26, v27
M v[108:111], a[124:127], a[172:175], v[108:111]
 v_cvt_pk_bf16_f32 v26, v28, v29
 v_cvt_pk_bf16_f32 v27, v30, v31
M v[108:111], a[120:123], a[168:171], v[108:111]
 buffer_store_dwordx4 v[24:27], v7, s[8:11], s3 offen offset:3072 sc1
M v[112:115], a[128:131], a[168:171], v[112:115]
 v_cvt_pk_bf16_f32 v32, v32, v33
 v_cvt_pk_bf16_f32 v33, v34, v35
M v[112:115], a[132:135], a[172:175], v[112:115]
 ds_read_b64_tr_b16 a[68:69], v1 offset:24576
 ds_read_b64_tr_b16 a[70:71], v1 offset:25600
M v[116:119], a[140:143], a[172:175], v[116:119]
 buffer_load_dwordx4 v17, s[56:59], s29 offen offset:1024   lds
M v[116:119], a[136:139], a[168:171], v[116:119]
 v_cvt_pk_bf16_f32 v34, v36, v37
 v_cvt_pk_bf16_f32 v35, v38, v39
M v[120:123], a[144:147], a[168:171], v[120:123]
 v_accvgpr_write_b32 a4, v32
 v_accvgpr_write_b32 a5, v33
M v[120:123], a[148:151], a[172:175], v[120:123]
 s_waitcnt lgkmcnt(4)
 v_accvgpr_write_b32 a6, v34
 v_accvgpr_write_b32 a7, v35
M v[124:127], a[156:159], a[172:175], v[124:127]
 v_cvt_pk_bf16_f32 v40, v40, v41
 v_cvt_pk_bf16_f32 v41, v42, v43
M v[124:127], a[152:155], a[168:171], v[124:127]
 v_cvt_pk_bf16_f32 v42, v44, v45
 v_cvt_pk_bf16_f32 v43, v46, v47
M v[128:131], a[96:99], a[160:163], v[128:131]
 ds_read_b128 a[168:171], v5 offset:51200
 ds_read_b128 a[172:175], v6 offset:51200
M v[128:131], a[100:103], a[164:167], v[128:131]
 ds_read_b64_tr_b16 a[72:73], v2 offset:16384
 ds_read_b64_tr_b16 a[74:75], v2 offset:17408
M v[132:135], a[108:111], a[164:167], v[132:135]
 buffer_load_dwordx4 v18, s[56:59], s29 offen offset:2048   lds
M v[132:135], a[104:107], a[160:163], v[132:135]
 v_accvgpr_write_b32 a12, v40
 v_accvgpr_write_b32 a13, v41
M v[136:139], a[112:115], a[160:163], v[136:139]
 v_accvgpr_write_b32 a14, v42
 v_accvgpr_write_b32 a15, v43
M v[136:139], a[116:119], a[164:167], v[136:139]
 v_cvt_pk_bf16_f32 v48, v48, v49
 v_cvt_pk_bf16_f32 v49, v50, v51
M v[140:143], a[124:127], a[164:167], v[140:143]
 v_cvt_pk_bf16_f32 v50, v52, v53
 v_cvt_pk_bf16_f32 v51, v54, v55
M v[140:143], a[120:123], a[160:163], v[140:143]
 ds_read_b64_tr_b16 a[76:77], v2 offset:24576
 ds_read_b64_tr_b16 a[78:79], v2 offset:25600
M v[144:147], a[128:131], a[160:163], v[144:147]
 buffer_load_dwordx4 v19, s[56:59], s29 offen offset:3072   lds
M v[144:147], a[132:135], a[164:167], v[144:147]
 s_add_u32 s29, s29, 128
 v_accvgpr_write_b32 a20, v48
 v_accvgpr_write_b32 a21, v49
M v[148:151], a[140:143], a[164:167], v[148:151]
 v_accvgpr_write_b32 a22, v50
 v_accvgpr_write_b32 a23, v51
M v[148:151], a[136:139], a[160:163], v[148:151]
 v_cvt_pk_bf16_f32 v56, v56, v57
 v_cvt_pk_bf16_f32 v57, v58, v59
M v[152:155], a[144:147], a[160:163], v[152:155]
 v_cvt_pk_bf16_f32 v58, v60, v61
 v_cvt_pk_bf16_f32 v59, v62, v63
M v[152:155], a[148:151], a[164:167], v[152:155]
 s_waitcnt lgkmcnt(4)
 v_accvgpr_write_b32 a28, v56
 v_accvgpr_write_b32 a29, v57
M v[156:159], a[156:159], a[164:167], v[156:159]
 s_add_u32 m0, s23, 0
 ds_read_b64_tr_b16 a[80:81], v3 offset:16384
 ds_read_b64_tr_b16 a[82:83], v3 offset:17408
M v[156:159], a[152:155], a[160:163], v[156:159]
 buffer_load_dwordx4 v8, s[52:55], s28 offen offset:0   lds
M v[160:163], a[96:99], a[168:171], v[160:163]
 ds_read_b128 a[160:163], v5 offset:53248
 ds_read_b128 a[164:167], v6 offset:53248
M v[160:163], a[100:103], a[172:175], v[160:163]
 v_accvgpr_write_b32 a30, v58
 v_accvgpr_write_b32 a31, v59
M v[164:167], a[108:111], a[172:175], v[164:167]
 v_cvt_pk_bf16_f32 v64, v64, v65
 v_cvt_pk_bf16_f32 v65, v66, v67
M v[164:167], a[104:107], a[168:171], v[164:167]
 v_cvt_pk_bf16_f32 v66, v68, v69
 v_cvt_pk_bf16_f32 v67, v70, v71
M v[168:171], a[112:115], a[168:171], v[168:171]
 v_cvt_pk_bf16_f32 v72, v72, v73
 v_cvt_pk_bf16_f32 v73, v74, v75
M v[168:171], a[116:119], a[172:175], v[168:171]
 ds_read_b64_tr_b16 a[84:85], v3 offset:24576
 ds_read_b64_tr_b16 a[86:87], v3 offset:25600
M v[172:175], a[124:127], a[172:175], v[172:175]
 buffer_load_dwordx4 v9, s[52:55], s28 offen offset:1024   lds
M v[172:175], a[120:123], a[168:171], v[172:175]
 v_cvt_pk_bf16_f32 v74, v76, v77
 v_cvt_pk_bf16_f32 v75, v78, v79
M v[176:179], a[128:131], a[168:171], v[176:179]
 v_cvt_pk_bf16_f32 v80, v80, v81
 v_cvt_pk_bf16_f32 v81, v82, v83
M v[176:179], a[132:135], a[172:175], v[176:179]
 v_cvt_pk_bf16_f32 v82, v84, v85
 v_cvt_pk_bf16_f32 v83, v86, v87
M v[180:183], a[140:143], a[172:175], v[180:183]
 v_cvt_pk_bf16_f32 v88, v88, v89
 v_cvt_pk_bf16_f32 v89, v90, v91
M v[180:183], a[136:139], a[168:171], v[180:183]
 v_cvt_pk_bf16_f32 v90, v92, v93
 v_cvt_pk_bf16_f32 v91, v94, v95
M v[184:187], a[144:147], a[168:171], v[184:187]
 ds_read_b64_tr_b16 a[88:89], v4 offset:16384
 ds_read_b64_tr_b16 a[90:91], v4 offset:17408
M v[184:187], a[148:151], a[172:175], v[184:187]
 s_waitcnt lgkmcnt(4)
 buffer_load_dwordx4 v10, s[52:55], s28 offen offset:2048   lds
M v[188:191], a[156:159], a[172:175], v[188:191]
 v_cvt_pk_bf16_f32 v96, v96, v97
 v_cvt_pk_bf16_f32 v97, v98, v99
M v[188:191], a[152:155], a[168:171], v[188:191]
 v_cvt_pk_bf16_f32 v98, v100, v101
 v_cvt_pk_bf16_f32 v99, v102, v103
M v[192:195], a[96:99], a[160:163], v[192:195]
 ds_read_b128 a[168:171], v5 offset:55296
 ds_read_b128 a[172:175], v6 offset:55296
M v[192:195], a[100:103], a[164:167], v[192:195]
 v_cvt_pk_bf16_f32 v104, v104, v105
 v_cvt_pk_bf16_f32 v105, v106, v107
M v[196:199], a[108:111], a[164:167], v[196:199]
 v_cvt_pk_bf16_f32 v106, v108, v109
 v_cvt_pk_bf16_f32 v107, v110, v111
M v[196:199], a[104:107], a[160:163], v[196:199]
 ds_read_b64_tr_b16 a[92:93], v4 offset:24576
 ds_read_b64_tr_b16 a[94:95], v4 offset:25600
M v[200:203], a[112:115], a[160:163], v[200:203]
 buffer_load_dwordx4 v11, s[52:55], s28 offen offset:3072   lds
M v[200:203], a[116:119], a[164:167], v[200:203]
 s_add_u32 s28, s28, 128
 v_cvt_pk_bf16_f32 v112, v112, v113
 v_cvt_pk_bf16_f32 v113, v114, v115
M v[204:207], a[124:127], a[164:167], v[204:207]
 v_cvt_pk_bf16_f32 v114, v116, v117
 v_cvt_pk_bf16_f32 v115, v118, v119
M v[204:207], a[120:123], a[160:163], v[204:207]
 v_cvt_pk_bf16_f32 v120, v120, v121
 v_cvt_pk_bf16_f32 v121, v122, v123
M v[208:211], a[128:131], a[160:163], v[208:211]
 v_cvt_pk_bf16_f32 v122, v124, v125
 v_cvt_pk_bf16_f32 v123, v126, v127
M v[208:211], a[132:135], a[164:167], v[208:211]
 v_cvt_pk_bf16_f32 v128, v128, v129
 v_cvt_pk_bf16_f32 v129, v130, v131
M v[212:215], a[140:143], a[164:167], v[212:215]
 v_cvt_pk_bf16_f32 v130, v132, v133
 v_cvt_pk_bf16_f32 v131, v134, v135
M v[212:215], a[136:139], a[160:163], v[212:215]
 v_cvt_pk_bf16_f32 v136, v136, v137
 v_cvt_pk_bf16_f32 v137, v138, v139
M v[216:219], a[144:147], a[160:163], v[216:219]
 v_cvt_pk_bf16_f32 v138, v140, v141
 v_cvt_pk_bf16_f32 v139, v142, v143
M v[216:219], a[148:151], a[164:167], v[216:219]
 s_waitcnt lgkmcnt(2)
 v_cvt_pk_bf16_f32 v144, v144, v145
 v_cvt_pk_bf16_f32 v145, v146, v147
M v[220:223], a[156:159], a[164:167], v[220:223]
 s_waitcnt vmcnt(24) lgkmcnt(0)
 v_cvt_pk_bf16_f32 v146, v148, v149
 v_cvt_pk_bf16_f32 v147, v150, v151
M v[220:223], a[152:155], a[160:163], v[220:223]
 s_barrier
M v[224:227], a[96:99], a[168:171], v[224:227]
 ds_read_b128 a[160:163], v5 offset:0
 ds_read_b128 a[164:167], v6 offset:0
M v[224:227], a[100:103], a[172:175], v[224:227]
 v_cvt_pk_bf16_f32 v152, v152, v153
 v_cvt_pk_bf16_f32 v153, v154, v155
M v[228:231], a[108:111], a[172:175], v[228:231]
 v_cvt_pk_bf16_f32 v154, v156, v157
 v_cvt_pk_bf16_f32 v155, v158, v159
M v[228:231], a[104:107], a[168:171], v[228:231]
 v_cvt_pk_bf16_f32 v160, v160, v161
 v_cvt_pk_bf16_f32 v161, v162, v163
M v[232:235], a[112:115], a[168:171], v[232:235]
 v_cvt_pk_bf16_f32 v162, v164, v165
 v_cvt_pk_bf16_f32 v163, v166, v167
M v[232:235], a[116:119], a[172:175], v[232:235]
 v_cvt_pk_bf16_f32 v168, v168, v169
 v_cvt_pk_bf16_f32 v169, v170, v171
M v[236:239], a[124:127], a[172:175], v[236:239]
 v_cvt_pk_bf16_f32 v170, v172, v173
 v_cvt_pk_bf16_f32 v171, v174, v175
M v[236:239], a[120:123], a[168:171], v[236:239]
 v_cvt_pk_bf16_f32 v176, v176, v177
 v_cvt_pk_bf16_f32 v177, v178, v179
M v[240:243], a[128:131], a[168:171], v[240:243]
 v_cvt_pk_bf16_f32 v178, v180, v181
 v_cvt_pk_bf16_f32 v179, v182, v183
M v[240:243], a[132:135], a[172:175], v[240:243]
 v_cvt_pk_bf16_f32 v184, v184, v185
 v_cvt_pk_bf16_f32 v185, v186, v187
M v[244:247], a[140:143], a[172:175], v[244:247]
 v_cvt_pk_bf16_f32 v186, v188, v189
 v_cvt_pk_bf16_f32 v187, v190, v191
M v[244:247], a[136:139], a[168:171], v[244:247]
 v_cvt_pk_bf16_f32 v192, v192, v193
 v_cvt_pk_bf16_f32 v193, v194, v195
M v[248:251], a[144:147], a[168:171], v[248:251]
 v_cvt_pk_bf16_f32 v194, v196, v197
 v_cvt_pk_bf16_f32 v195, v198, v199
M v[248:251], a[148:151], a[172:175], v[248:251]
 s_waitcnt lgkmcnt(0)
 v_cvt_pk_bf16_f32 v200, v200, v201
 v_cvt_pk_bf16_f32 v201, v202, v203
M v[252:255], a[156:159], a[172:175], v[252:255]
 v_cvt_pk_bf16_f32 v202, v204, v205
 v_cvt_pk_bf16_f32 v203, v206, v207
M v[252:255], a[152:155], a[168:171], v[252:255]
 v_cvt_pk_bf16_f32 v208, v208, v209
 v_cvt_pk_bf16_f32 v209, v210, v211
M v[32:35], a[32:35], a[160:163], 0
 s_add_u32 m0, s23, 16384
 ds_read_b128 a[168:171], v5 offset:2048
 ds_read_b128 a[172:175], v6 offset:2048
M v[32:35], a[36:39], a[164:167], v[32:35]
 ds_read_b64_tr_b16 a[96:97], v1 offset:32768
 ds_read_b64_tr_b16 a[98:99], v1 offset:33792
M v[36:39], a[44:47], a[164:167], 0
 buffer_load_dwordx4 v8, s[52:55], s28 offen offset:0   lds
M v[36:39], a[40:43], a[160:163], v[36:39]
 v_cvt_pk_bf16_f32 v210, v212, v213
 v_cvt_pk_bf16_f32 v211, v214, v215
M v[40:43], a[48:51], a[160:163], 0
 ds_read_b64_tr_b16 a[100:101], v1 offset:40960
 ds_read_b64_tr_b16 a[102:103], v1 offset:41984
M v[40:43], a[52:55], a[164:167], v[40:43]
 buffer_load_dwordx4 v9, s[52:55], s28 offen offset:1024   lds
M v[44:47], a[60:63], a[164:167], 0
 v_cvt_pk_bf16_f32 v216, v216, v217
 v_cvt_pk_bf16_f32 v217, v218, v219
M v[44:47], a[56:59], a[160:163], v[44:47]
 ds_read_b64_tr_b16 a[104:105], v2 offset:32768
 ds_read_b64_tr_b16 a[106:107], v2 offset:33792
M v[48:51], a[64:67], a[160:163], 0
 v_cvt_pk_bf16_f32 v218, v220, v221
 v_cvt_pk_bf16_f32 v219, v222, v223
M v[48:51], a[68:71], a[164:167], v[48:51]
 v_cvt_pk_bf16_f32 v224, v224, v225
 v_cvt_pk_bf16_f32 v225, v226, v227
M v[52:55], a[76:79], a[164:167], 0
 ds_read_b64_tr_b16 a[108:109], v2 offset:40960
 ds_read_b64_tr_b16 a[110:111], v2 offset:41984
M v[52:55], a[72:75], a[160:163], v[52:55]
 buffer_load_dwordx4 v10, s[52:55], s28 offen offset:2048   lds
M v[56:59], a[80:83], a[160:163], 0
 v_cvt_pk_bf16_f32 v226, v228, v229
 v_cvt_pk_bf16_f32 v227, v230, v231
M v[56:59], a[84:87], a[164:167], v[56:59]
 s_waitcnt lgkmcnt(8)
 ds_read_b64_tr_b16 a[112:113], v3 offset:32768
 ds_read_b64_tr_b16 a[114:115], v3 offset:33792
M v[60:63], a[92:95], a[164:167], 0
 v_cvt_pk_bf16_f32 v232, v232, v233
 v_cvt_pk_bf16_f32 v233, v234, v235
M v[60:63], a[88:91], a[160:163], v[60:63]
 buffer_load_dwordx4 v11, s[52:55], s28 offen offset:3072   lds
M v[68:71], a[32:35], a[168:171], 0
 s_add_u32 s28, s28, 524160
 ds_read_b128 a[160:163], v5 offset:4096
 ds_read_b128 a[164:167], v6 offset:4096
M v[68:71], a[36:39], a[172:175], v[68:71]
 ds_read_b64_tr_b16 a[116:117], v3 offset:40960
 ds_read_b64_tr_b16 a[118:119], v3 offset:41984
M v[76:79], a[44:47], a[172:175], 0
 v_cvt_pk_bf16_f32 v234, v236, v237
 v_cvt_pk_bf16_f32 v235, v238, v239
M v[76:79], a[40:43], a[168:171], v[76:79]
 s_add_u32 m0, s24, 49152
 ds_read_b64_tr_b16 a[120:121], v4 offset:32768
 ds_read_b64_tr_b16 a[122:123], v4 offset:33792
M v[84:87], a[48:51], a[168:171], 0
 buffer_load_dwordx4 v16, s[56:59], s29 offen offset:0   lds
M v[84:87], a[52:55], a[172:175], v[84:87]
 v_cvt_pk_bf16_f32 v240, v240, v241
 v_cvt_pk_bf16_f32 v241, v242, v243
M v[92:95], a[60:63], a[172:175], 0
 ds_read_b64_tr_b16 a[124:125], v4 offset:40960
 ds_read_b64_tr_b16 a[126:127], v4 offset:41984
M v[92:95], a[56:59], a[168:171], v[92:95]
 v_cvt_pk_bf16_f32 v242, v244, v245
 v_cvt_pk_bf16_f32 v243, v246, v247
M v[100:103], a[64:67], a[168:171], 0
 v_cvt_pk_bf16_f32 v248, v248, v249
 v_cvt_pk_bf16_f32 v249, v250, v251
M v[100:103], a[68:71], a[172:175], v[100:103]
 buffer_load_dwordx4 v17, s[56:59], s29 offen offset:1024   lds
M v[108:111], a[76:79], a[172:175], 0
 v_cvt_pk_bf16_f32 v250, v252, v253
 v_cvt_pk_bf16_f32 v251, v254, v255
M v[108:111], a[72:75], a[168:171], v[108:111]
 s_add_u32 s3, s93, 8192
 v_mov_b32 v12, 1
 v_or_b32 v15, s20, v0
M v[116:119], a[80:83], a[168:171], 0
 v_min_u32 v15, 1, v15
 v_lshlrev_b32 v15, 29, v15
M v[116:119], a[84:87], a[172:175], v[116:119]
 s_waitcnt lgkmcnt(6)
 buffer_store_dwordx4 a[4:7], v7, s[8:11], s3 offen offset:0 sc1
M v[124:127], a[92:95], a[172:175], 0
 s_waitcnt vmcnt(17) lgkmcnt(0)
 buffer_load_dwordx4 v18, s[56:59], s29 offen offset:2048   lds
M v[124:127], a[88:91], a[168:171], v[124:127]
 s_barrier
M v[132:135], a[32:35], a[160:163], 0
 ds_read_b128 a[168:171], v5 offset:6144
 ds_read_b128 a[172:175], v6 offset:6144
M v[132:135], a[36:39], a[164:167], v[132:135]
 ds_read_b64_tr_b16 a[128:129], v1 offset:49152
 ds_read_b64_tr_b16 a[130:131], v1 offset:50176
M v[140:143], a[44:47], a[164:167], 0
M v[140:143], a[40:43], a[160:163], v[140:143]
 buffer_load_dwordx4 v19, s[56:59], s29 offen offset:3072   lds
M v[148:151], a[48:51], a[160:163], 0
 s_add_u32 s29, s29, 128
 ds_read_b64_tr_b16 a[132:133], v1 offset:57344
 ds_read_b64_tr_b16 a[134:135], v1 offset:58368
M v[148:151], a[52:55], a[164:167], v[148:151]
 buffer_store_dwordx4 a[12:15], v7, s[8:11], s3 offen offset:1024 sc1
M v[156:159], a[60:63], a[164:167], 0
M v[156:159], a[56:59], a[160:163], v[156:159]
 s_add_u32 m0, s23, 32768
 ds_read_b64_tr_b16 a[136:137], v2 offset:49152
 ds_read_b64_tr_b16 a[138:139], v2 offset:50176
M v[164:167], a[64:67], a[160:163], 0
 buffer_load_dwordx4 v8, s[52:55], s28 offen offset:0   lds
M v[164:167], a[68:71], a[164:167], v[164:167]
M v[172:175], a[76:79], a[164:167], 0
 ds_read_b64_tr_b16 a[140:141], v2 offset:57344
 ds_read_b64_tr_b16 a[142:143], v2 offset:58368
M v[172:175], a[72:75], a[160:163], v[172:175]
M v[180:183], a[80:83], a[160:163], 0
M v[180:183], a[84:87], a[164:167], v[180:183]
 s_waitcnt lgkmcnt(8)
 ds_read_b64_tr_b16 a[144:145], v3 offset:49152
 ds_read_b64_tr_b16 a[146:147], v3 offset:50176
M v[188:191], a[92:95], a[164:167], 0
 buffer_load_dwordx4 v9, s[52:55], s28 offen offset:1024   lds
M v[188:191], a[88:91], a[160:163], v[188:191]
M v[196:199], a[32:35], a[168:171], 0
 ds_read_b128 a[160:163], v5 offset:16384
 ds_read_b128 a[164:167], v6 offset:16384
M v[196:199], a[36:39], a[172:175], v[196:199]
 ds_read_b64_tr_b16 a[148:149], v3 offset:57344
 ds_read_b64_tr_b16 a[150:151], v3 offset:58368
M v[204:207], a[44:47], a[172:175], 0
 buffer_load_dwordx4 v10, s[52:55], s28 offen offset:2048   lds
M v[204:207], a[40:43], a[168:171], v[204:207]
 ds_read_b64_tr_b16 a[152:153], v4 offset:49152
 ds_read_b64_tr_b16 a[154:155], v4 offset:50176
M v[212:215], a[48:51], a[168:171], 0
M v[212:215], a[52:55], a[172:175], v[212:215]
M v[220:223], a[60:63], a[172:175], 0
 ds_read_b64_tr_b16 a[156:157], v4 offset:57344
 ds_read_b64_tr_b16 a[158:159], v4 offset:58368
M v[220:223], a[56:59], a[168:171], v[220:223]
 buffer_load_dwordx4 v11, s[52:55], s28 offen offset:3072   lds
M v[228:231], a[64:67], a[168:171], 0
 s_add_u32 s28, s28, 128
M v[228:231], a[68:71], a[172:175], v[228:231]
M v[236:239], a[76:79], a[172:175], 0
M v[236:239], a[72:75], a[168:171], v[236:239]
M v[244:247], a[80:83], a[168:171], 0
M v[244:247], a[84:87], a[172:175], v[244:247]
 s_waitcnt lgkmcnt(6)
M v[252:255], a[92:95], a[172:175], 0
 s_waitcnt lgkmcnt(0)
M v[252:255], a[88:91], a[168:171], v[252:255]
 s_barrier
M v[32:35], a[96:99], a[160:163], v[32:35]
 s_add_u32 m0, s23, 49152
 ds_read_b128 a[168:171], v5 offset:18432
 ds_read_b128 a[172:175], v6 offset:18432
M v[32:35], a[100:103], a[164:167], v[32:35]
 ds_read_b64_tr_b16 a[32:33], v20 offset:0
 ds_read_b64_tr_b16 a[34:35], v20 offset:1024
M v[36:39], a[108:111], a[164:167], v[36:39]
 s_mov_b32 s39, 1280
 buffer_load_dwordx4 v8, s[52:55], s28 offen offset:0   lds
M v[36:39], a[104:107], a[160:163], v[36:39]
 s_cmp_ge_u32 s42, 10
M v[40:43], a[112:115], a[160:163], v[40:43]
 s_cselect_b32 s64, 0xf000000, 0
 ds_read_b64_tr_b16 a[36:37], v20 offset:8192
 ds_read_b64_tr_b16 a[38:39], v20 offset:9216
M v[40:43], a[116:119], a[164:167], v[40:43]
 s_or_b32 s39, s39, s64
 buffer_load_dwordx4 v9, s[52:55], s28 offen offset:1024   lds
M v[44:47], a[124:127], a[164:167], v[44:47]
 s_lshl_b32 s64, s20, 14
M v[44:47], a[120:123], a[160:163], v[44:47]
 s_add_u32 s12, s64, s34
 ds_read_b64_tr_b16 a[40:41], v21 offset:0
 ds_read_b64_tr_b16 a[42:43], v21 offset:1024
M v[48:51], a[128:131], a[160:163], v[48:51]
 s_add_u32 s13, s12, 4096
 buffer_store_dwordx4 a[20:23], v7, s[8:11], s3 offen offset:2048 sc1
M v[48:51], a[132:135], a[164:167], v[48:51]
 s_add_u32 s14, s12, 8192
M v[52:55], a[140:143], a[164:167], v[52:55]
 s_add_u32 s15, s12, 12288
 ds_read_b64_tr_b16 a[44:45], v21 offset:8192
 ds_read_b64_tr_b16 a[46:47], v21 offset:9216
M v[52:55], a[136:139], a[160:163], v[52:55]
 buffer_load_dwordx4 v10, s[52:55], s28 offen offset:2048   lds
M v[56:59], a[144:147], a[160:163], v[56:59]
M v[56:59], a[148:151], a[164:167], v[56:59]
 s_waitcnt lgkmcnt(8)
 ds_read_b64_tr_b16 a[48:49], v22 offset:0
 ds_read_b64_tr_b16 a[50:51], v22 offset:1024
M v[60:63], a[156:159], a[164:167], v[60:63]
M v[60:63], a[152:155], a[160:163], v[60:63]
 buffer_load_dwordx4 v11, s[52:55], s28 offen offset:3072   lds
M v[68:71], a[96:99], a[168:171], v[68:71]
 s_add_u32 s28, s28, 524160
 ds_read_b128 a[160:163], v5 offset:20480
 ds_read_b128 a[164:167], v6 offset:20480
M v[68:71], a[100:103], a[172:175], v[68:71]
 ds_read_b64_tr_b16 a[52:53], v22 offset:8192
 ds_read_b64_tr_b16 a[54:55], v22 offset:9216
M v[76:79], a[108:111], a[172:175], v[76:79]
M v[76:79], a[104:107], a[168:171], v[76:79]
 s_add_u32 m0, s24, 0
 ds_read_b64_tr_b16 a[56:57], v23 offset:0
 ds_read_b64_tr_b16 a[58:59], v23 offset:1024
M v[84:87], a[112:115], a[168:171], v[84:87]
 buffer_load_dwordx4 v16, s[56:59], s29 offen offset:0   lds
M v[84:87], a[116:119], a[172:175], v[84:87]
M v[92:95], a[124:127], a[172:175], v[92:95]
 ds_read_b64_tr_b16 a[60:61], v23 offset:8192
 ds_read_b64_tr_b16 a[62:63], v23 offset:9216
M v[92:95], a[120:123], a[168:171], v[92:95]
M v[100:103], a[128:131], a[168:171], v[100:103]
M v[100:103], a[132:135], a[172:175], v[100:103]
 buffer_load_dwordx4 v17, s[56:59], s29 offen offset:1024   lds
M v[108:111], a[140:143], a[172:175], v[108:111]
M v[108:111], a[136:139], a[168:171], v[108:111]
M v[116:119], a[144:147], a[168:171], v[116:119]
M v[116:119], a[148:151], a[172:175], v[116:119]
 s_waitcnt lgkmcnt(6)
M v[124:127], a[156:159], a[172:175], v[124:127]
 s_waitcnt vmcnt(25) lgkmcnt(0)
 buffer_load_dwordx4 v18, s[56:59], s29 offen offset:2048   lds
M v[124:127], a[152:155], a[168:171], v[124:127]
 s_barrier
M v[132:135], a[96:99], a[160:163], v[132:135]
 ds_read_b128 a[168:171], v5 offset:22528
 ds_read_b128 a[172:175], v6 offset:22528
M v[132:135], a[100:103], a[164:167], v[132:135]
 ds_read_b64_tr_b16 a[64:65], v20 offset:16384
 ds_read_b64_tr_b16 a[66:67], v20 offset:17408
M v[140:143], a[108:111], a[164:167], v[140:143]
M v[140:143], a[104:107], a[160:163], v[140:143]
 buffer_load_dwordx4 v19, s[56:59], s29 offen offset:3072   lds
M v[148:151], a[112:115], a[160:163], v[148:151]
 s_add_u32 s29, s29, 128
 ds_read_b64_tr_b16 a[68:69], v20 offset:24576
 ds_read_b64_tr_b16 a[70:71], v20 offset:25600
M v[148:151], a[116:119], a[164:167], v[148:151]
 buffer_store_dwordx4 a[28:31], v7, s[8:11], s3 offen offset:3072 sc1
M v[156:159], a[124:127], a[164:167], v[156:159]
M v[156:159], a[120:123], a[160:163], v[156:159]
 s_add_u32 m0, s23, 131072
 ds_read_b64_tr_b16 a[72:73], v21 offset:16384
 ds_read_b64_tr_b16 a[74:75], v21 offset:17408
M v[164:167], a[128:131], a[160:163], v[164:167]
 buffer_load_dwordx4 v8, s[52:55], s28 offen offset:0   lds
M v[164:167], a[132:135], a[164:167], v[164:167]
M v[172:175], a[140:143], a[164:167], v[172:175]
 ds_read_b64_tr_b16 a[76:77], v21 offset:24576
 ds_read_b64_tr_b16 a[78:79], v21 offset:25600
M v[172:175], a[136:139], a[160:163], v[172:175]
M v[180:183], a[144:147], a[160:163], v[180:183]
M v[180:183], a[148:151], a[164:167], v[180:183]
 s_waitcnt lgkmcnt(8)
 ds_read_b64_tr_b16 a[80:81], v22 offset:16384
 ds_read_b64_tr_b16 a[82:83], v22 offset:17408
M v[188:191], a[156:159], a[164:167], v[188:191]
 buffer_load_dwordx4 v9, s[52:55], s28 offen offset:1024   lds
M v[188:191], a[152:155], a[160:163], v[188:191]
M v[196:199], a[96:99], a[168:171], v[196:199]
 ds_read_b128 a[160:163], v5 offset:32768
 ds_read_b128 a[164:167], v6 offset:32768
M v[196:199], a[100:103], a[172:175], v[196:199]
 ds_read_b64_tr_b16 a[84:85], v22 offset:24576
 ds_read_b64_tr_b16 a[86:87], v22 offset:25600
M v[204:207], a[108:111], a[172:175], v[204:207]
 buffer_load_dwordx4 v10, s[52:55], s28 offen offset:2048   lds
M v[204:207], a[104:107], a[168:171], v[204:207]
 ds_read_b64_tr_b16 a[88:89], v23 offset:16384
 ds_read_b64_tr_b16 a[90:91], v23 offset:17408
M v[212:215], a[112:115], a[168:171], v[212:215]
M v[212:215], a[116:119], a[172:175], v[212:215]
M v[220:223], a[124:127], a[172:175], v[220:223]
 ds_read_b64_tr_b16 a[92:93], v23 offset:24576
 ds_read_b64_tr_b16 a[94:95], v23 offset:25600
M v[220:223], a[120:123], a[168:171], v[220:223]
 buffer_load_dwordx4 v11, s[52:55], s28 offen offset:3072   lds
M v[228:231], a[128:131], a[168:171], v[228:231]
 s_add_u32 s28, s28, 128
M v[228:231], a[132:135], a[172:175], v[228:231]
M v[236:239], a[140:143], a[172:175], v[236:239]
M v[236:239], a[136:139], a[168:171], v[236:239]
M v[244:247], a[144:147], a[168:171], v[244:247]
M v[244:247], a[148:151], a[172:175], v[244:247]
 s_waitcnt lgkmcnt(6)
M v[252:255], a[156:159], a[172:175], v[252:255]
 s_waitcnt vmcnt(28) lgkmcnt(0)
M v[252:255], a[152:155], a[168:171], v[252:255]
 s_barrier
M v[32:35], a[32:35], a[160:163], v[32:35]
 s_add_u32 m0, s23, 147456
 ds_read_b128 a[168:171], v5 offset:34816
 ds_read_b128 a[172:175], v6 offset:34816
M v[32:35], a[36:39], a[164:167], v[32:35]
 ds_read_b64_tr_b16 a[96:97], v1 offset:0
 ds_read_b64_tr_b16 a[98:99], v1 offset:1024
M v[36:39], a[44:47], a[164:167], v[36:39]
 buffer_load_dwordx4 v8, s[52:55], s28 offen offset:0   lds
M v[36:39], a[40:43], a[160:163], v[36:39]
M v[40:43], a[48:51], a[160:163], v[40:43]
 ds_read_b64_tr_b16 a[100:101], v1 offset:8192
 ds_read_b64_tr_b16 a[102:103], v1 offset:9216
M v[40:43], a[52:55], a[164:167], v[40:43]
 buffer_load_dwordx4 v9, s[52:55], s28 offen offset:1024   lds
M v[44:47], a[60:63], a[164:167], v[44:47]
M v[44:47], a[56:59], a[160:163], v[44:47]
 ds_read_b64_tr_b16 a[104:105], v2 offset:0
 ds_read_b64_tr_b16 a[106:107], v2 offset:1024
M v[48:51], a[64:67], a[160:163], v[48:51]
M v[48:51], a[68:71], a[164:167], v[48:51]
M v[52:55], a[76:79], a[164:167], v[52:55]
 ds_read_b64_tr_b16 a[108:109], v2 offset:8192
 ds_read_b64_tr_b16 a[110:111], v2 offset:9216
M v[52:55], a[72:75], a[160:163], v[52:55]
 buffer_load_dwordx4 v10, s[52:55], s28 offen offset:2048   lds
M v[56:59], a[80:83], a[160:163], v[56:59]
M v[56:59], a[84:87], a[164:167], v[56:59]
 s_waitcnt lgkmcnt(8)
 ds_read_b64_tr_b16 a[112:113], v3 offset:0
 ds_read_b64_tr_b16 a[114:115], v3 offset:1024
M v[60:63], a[92:95], a[164:167], v[60:63]
M v[60:63], a[88:91], a[160:163], v[60:63]
 buffer_load_dwordx4 v11, s[52:55], s28 offen offset:3072   lds
M v[68:71], a[32:35], a[168:171], v[68:71]
 s_add_u32 s28, s28, 524160
 ds_read_b128 a[160:163], v5 offset:36864
 ds_read_b128 a[164:167], v6 offset:36864
M v[68:71], a[36:39], a[172:175], v[68:71]
 ds_read_b64_tr_b16 a[116:117], v3 offset:8192
 ds_read_b64_tr_b16 a[118:119], v3 offset:9216
M v[76:79], a[44:47], a[172:175], v[76:79]
M v[76:79], a[40:43], a[168:171], v[76:79]
 s_add_u32 m0, s24, 16384
 ds_read_b64_tr_b16 a[120:121], v4 offset:0
 ds_read_b64_tr_b16 a[122:123], v4 offset:1024
M v[84:87], a[48:51], a[168:171], v[84:87]
 buffer_load_dwordx4 v16, s[56:59], s29 offen offset:0   lds
M v[84:87], a[52:55], a[172:175], v[84:87]
M v[92:95], a[60:63], a[172:175], v[92:95]
 ds_read_b64_tr_b16 a[124:125], v4 offset:8192
 ds_read_b64_tr_b16 a[126:127], v4 offset:9216
M v[92:95], a[56:59], a[168:171], v[92:95]
M v[100:103], a[64:67], a[168:171], v[100:103]
M v[100:103], a[68:71], a[172:175], v[100:103]
 buffer_load_dwordx4 v17, s[56:59], s29 offen offset:1024   lds
M v[108:111], a[76:79], a[172:175], v[108:111]
M v[108:111], a[72:75], a[168:171], v[108:111]
M v[116:119], a[80:83], a[168:171], v[116:119]
M v[116:119], a[84:87], a[172:175], v[116:119]
 s_waitcnt lgkmcnt(6)
M v[124:127], a[92:95], a[172:175], v[124:127]
 s_waitcnt vmcnt(25) lgkmcnt(0)
 buffer_load_dwordx4 v18, s[56:59], s29 offen offset:2048   lds
M v[124:127], a[88:91], a[168:171], v[124:127]
 s_barrier
M v[132:135], a[32:35], a[160:163], v[132:135]
 ds_read_b128 a[168:171], v5 offset:38912
 ds_read_b128 a[172:175], v6 offset:38912
M v[132:135], a[36:39], a[164:167], v[132:135]
 ds_read_b64_tr_b16 a[128:129], v1 offset:16384
 ds_read_b64_tr_b16 a[130:131], v1 offset:17408
M v[140:143], a[44:47], a[164:167], v[140:143]
M v[140:143], a[40:43], a[160:163], v[140:143]
 buffer_load_dwordx4 v19, s[56:59], s29 offen offset:3072   lds
M v[148:151], a[48:51], a[160:163], v[148:151]
 s_add_u32 s29, s29, 128
 ds_read_b64_tr_b16 a[132:133], v1 offset:24576
 ds_read_b64_tr_b16 a[134:135], v1 offset:25600
M v[148:151], a[52:55], a[164:167], v[148:151]
M v[156:159], a[60:63], a[164:167], v[156:159]
M v[156:159], a[56:59], a[160:163], v[156:159]
 s_add_u32 m0, s23, 0
 ds_read_b64_tr_b16 a[136:137], v2 offset:16384
 ds_read_b64_tr_b16 a[138:139], v2 offset:17408
M v[164:167], a[64:67], a[160:163], v[164:167]
 buffer_load_dwordx4 v8, s[52:55], s28 offen offset:0   lds
M v[164:167], a[68:71], a[164:167], v[164:167]
M v[172:175], a[76:79], a[164:167], v[172:175]
 ds_read_b64_tr_b16 a[140:141], v2 offset:24576
 ds_read_b64_tr_b16 a[142:143], v2 offset:25600
M v[172:175], a[72:75], a[160:163], v[172:175]
M v[180:183], a[80:83], a[160:163], v[180:183]
M v[180:183], a[84:87], a[164:167], v[180:183]
 s_waitcnt lgkmcnt(8)
 ds_read_b64_tr_b16 a[144:145], v3 offset:16384
 ds_read_b64_tr_b16 a[146:147], v3 offset:17408
M v[188:191], a[92:95], a[164:167], v[188:191]
 buffer_load_dwordx4 v9, s[52:55], s28 offen offset:1024   lds
M v[188:191], a[88:91], a[160:163], v[188:191]
M v[196:199], a[32:35], a[168:171], v[196:199]
 ds_read_b128 a[160:163], v5 offset:49152
 ds_read_b128 a[164:167], v6 offset:49152
M v[196:199], a[36:39], a[172:175], v[196:199]
 ds_read_b64_tr_b16 a[148:149], v3 offset:24576
 ds_read_b64_tr_b16 a[150:151], v3 offset:25600
M v[204:207], a[44:47], a[172:175], v[204:207]
 buffer_load_dwordx4 v10, s[52:55], s28 offen offset:2048   lds
M v[204:207], a[40:43], a[168:171], v[204:207]
 ds_read_b64_tr_b16 a[152:153], v4 offset:16384
 ds_read_b64_tr_b16 a[154:155], v4 offset:17408
M v[212:215], a[48:51], a[168:171], v[212:215]
M v[212:215], a[52:55], a[172:175], v[212:215]
M v[220:223], a[60:63], a[172:175], v[220:223]
 ds_read_b64_tr_b16 a[156:157], v4 offset:24576
 ds_read_b64_tr_b16 a[158:159], v4 offset:25600
M v[220:223], a[56:59], a[168:171], v[220:223]
 buffer_load_dwordx4 v11, s[52:55], s28 offen offset:3072   lds
M v[228:231], a[64:67], a[168:171], v[228:231]
 s_add_u32 s28, s28, 128
M v[228:231], a[68:71], a[172:175], v[228:231]
M v[236:239], a[76:79], a[172:175], v[236:239]
M v[236:239], a[72:75], a[168:171], v[236:239]
M v[244:247], a[80:83], a[168:171], v[244:247]
M v[244:247], a[84:87], a[172:175], v[244:247]
 s_waitcnt lgkmcnt(6)
M v[252:255], a[92:95], a[172:175], v[252:255]
 s_waitcnt vmcnt(16) lgkmcnt(0)
M v[252:255], a[88:91], a[168:171], v[252:255]
 s_barrier
M v[32:35], a[96:99], a[160:163], v[32:35]
 s_add_u32 m0, s23, 16384
 ds_read_b128 a[168:171], v5 offset:51200
 ds_read_b128 a[172:175], v6 offset:51200
M v[32:35], a[100:103], a[164:167], v[32:35]
 ds_read_b64_tr_b16 a[32:33], v1 offset:32768
 ds_read_b64_tr_b16 a[34:35], v1 offset:33792
M v[36:39], a[108:111], a[164:167], v[36:39]
 buffer_load_dwordx4 v8, s[52:55], s28 offen offset:0   lds
M v[36:39], a[104:107], a[160:163], v[36:39]
 buffer_store_dword v12, v15, s[8:11], s45 offen sc1
M v[40:43], a[112:115], a[160:163], v[40:43]
 s_add_u32 s3, s93, 262144
 ds_read_b64_tr_b16 a[36:37], v1 offset:40960
 ds_read_b64_tr_b16 a[38:39], v1 offset:41984
M v[40:43], a[116:119], a[164:167], v[40:43]
 v_min_u32 v25, 15, v0
 v_lshlrev_b32 v25, 7, v25
M v[44:47], a[124:127], a[164:167], v[44:47]
 v_max_u32 v13, 1024, v25
M v[44:47], a[120:123], a[160:163], v[44:47]
 ds_read_b64_tr_b16 a[40:41], v2 offset:32768
 ds_read_b64_tr_b16 a[42:43], v2 offset:33792
M v[48:51], a[128:131], a[160:163], v[48:51]
 buffer_load_dwordx4 v9, s[52:55], s28 offen offset:1024   lds
M v[48:51], a[132:135], a[164:167], v[48:51]
 buffer_store_dwordx4 v[64:67], v7, s[8:11], s3 offen offset:0 sc1
M v[52:55], a[140:143], a[164:167], v[52:55]
 ds_read_b64_tr_b16 a[44:45], v2 offset:40960
 ds_read_b64_tr_b16 a[46:47], v2 offset:41984
M v[52:55], a[136:139], a[160:163], v[52:55]
M v[56:59], a[144:147], a[160:163], v[56:59]
M v[56:59], a[148:151], a[164:167], v[56:59]
 s_waitcnt lgkmcnt(8)
 ds_read_b64_tr_b16 a[48:49], v3 offset:32768
 ds_read_b64_tr_b16 a[50:51], v3 offset:33792
M v[60:63], a[156:159], a[164:167], v[60:63]
 buffer_load_dwordx4 v10, s[52:55], s28 offen offset:2048   lds
M v[60:63], a[152:155], a[160:163], v[60:63]
M v[68:71], a[96:99], a[168:171], v[68:71]
 ds_read_b128 a[160:163], v5 offset:53248
 ds_read_b128 a[164:167], v6 offset:53248
M v[68:71], a[100:103], a[172:175], v[68:71]
 ds_read_b64_tr_b16 a[52:53], v3 offset:40960
 ds_read_b64_tr_b16 a[54:55], v3 offset:41984
M v[76:79], a[108:111], a[172:175], v[76:79]
 buffer_store_dwordx4 v[72:75], v7, s[8:11], s3 offen offset:1024 sc1
M v[76:79], a[104:107], a[168:171], v[76:79]
 ds_read_b64_tr_b16 a[56:57], v4 offset:32768
 ds_read_b64_tr_b16 a[58:59], v4 offset:33792
M v[84:87], a[112:115], a[168:171], v[84:87]
M v[84:87], a[116:119], a[172:175], v[84:87]
 buffer_load_dwordx4 v11, s[52:55], s28 offen offset:3072   lds
M v[92:95], a[124:127], a[172:175], v[92:95]
 s_add_u32 s28, s28, 524160
 ds_read_b64_tr_b16 a[60:61], v4 offset:40960
 ds_read_b64_tr_b16 a[62:63], v4 offset:41984
M v[92:95], a[120:123], a[168:171], v[92:95]
M v[100:103], a[128:131], a[168:171], v[100:103]
M v[100:103], a[132:135], a[172:175], v[100:103]
M v[108:111], a[140:143], a[172:175], v[108:111]
M v[108:111], a[136:139], a[168:171], v[108:111]
M v[116:119], a[144:147], a[168:171], v[116:119]
M v[116:119], a[148:151], a[172:175], v[116:119]
 s_waitcnt lgkmcnt(6)
M v[124:127], a[156:159], a[172:175], v[124:127]
 s_waitcnt lgkmcnt(0)
M v[124:127], a[152:155], a[168:171], v[124:127]
 s_barrier
M v[132:135], a[96:99], a[160:163], v[132:135]
 ds_read_b128 a[168:171], v5 offset:55296
 ds_read_b128 a[172:175], v6 offset:55296
M v[132:135], a[100:103], a[164:167], v[132:135]
 ds_read_b64_tr_b16 a[64:65], v1 offset:49152
 ds_read_b64_tr_b16 a[66:67], v1 offset:50176
M v[140:143], a[108:111], a[164:167], v[140:143]
 buffer_store_dwordx4 v[80:83], v7, s[8:11], s3 offen offset:2048 sc1
M v[140:143], a[104:107], a[160:163], v[140:143]
M v[148:151], a[112:115], a[160:163], v[148:151]
 ds_read_b64_tr_b16 a[68:69], v1 offset:57344
 ds_read_b64_tr_b16 a[70:71], v1 offset:58368
M v[148:151], a[116:119], a[164:167], v[148:151]
M v[156:159], a[124:127], a[164:167], v[156:159]
M v[156:159], a[120:123], a[160:163], v[156:159]
 ds_read_b64_tr_b16 a[72:73], v2 offset:49152
 ds_read_b64_tr_b16 a[74:75], v2 offset:50176
M v[164:167], a[128:131], a[160:163], v[164:167]
M v[164:167], a[132:135], a[164:167], v[164:167]
M v[172:175], a[140:143], a[164:167], v[172:175]
 ds_read_b64_tr_b16 a[76:77], v2 offset:57344
 ds_read_b64_tr_b16 a[78:79], v2 offset:58368
M v[172:175], a[136:139], a[160:163], v[172:175]
M v[180:183], a[144:147], a[160:163], v[180:183]
M v[180:183], a[148:151], a[164:167], v[180:183]
 s_waitcnt lgkmcnt(8)
 ds_read_b64_tr_b16 a[80:81], v3 offset:49152
 ds_read_b64_tr_b16 a[82:83], v3 offset:50176
M v[188:191], a[156:159], a[164:167], v[188:191]
 buffer_store_dwordx4 v[88:91], v7, s[8:11], s3 offen offset:3072 sc1
M v[188:191], a[152:155], a[160:163], v[188:191]
M v[196:199], a[96:99], a[168:171], v[196:199]
 ds_read_b128 a[160:163], v5 offset:0
 ds_read_b128 a[164:167], v6 offset:0
M v[196:199], a[100:103], a[172:175], v[196:199]
 ds_read_b64_tr_b16 a[84:85], v3 offset:57344
 ds_read_b64_tr_b16 a[86:87], v3 offset:58368
M v[204:207], a[108:111], a[172:175], v[204:207]
M v[204:207], a[104:107], a[168:171], v[204:207]
 ds_read_b64_tr_b16 a[88:89], v4 offset:49152
 ds_read_b64_tr_b16 a[90:91], v4 offset:50176
M v[212:215], a[112:115], a[168:171], v[212:215]
M v[212:215], a[116:119], a[172:175], v[212:215]
M v[220:223], a[124:127], a[172:175], v[220:223]
 ds_read_b64_tr_b16 a[92:93], v4 offset:57344
 ds_read_b64_tr_b16 a[94:95], v4 offset:58368
M v[220:223], a[120:123], a[168:171], v[220:223]
M v[228:231], a[128:131], a[168:171], v[228:231]
M v[228:231], a[132:135], a[172:175], v[228:231]
M v[236:239], a[140:143], a[172:175], v[236:239]
M v[236:239], a[136:139], a[168:171], v[236:239]
M v[244:247], a[144:147], a[168:171], v[244:247]
M v[244:247], a[148:151], a[172:175], v[244:247]
 s_waitcnt lgkmcnt(6)
M v[252:255], a[156:159], a[172:175], v[252:255]
 s_waitcnt vmcnt(21) lgkmcnt(0)
M v[252:255], a[152:155], a[168:171], v[252:255]
 s_barrier
M v[32:35], a[32:35], a[160:163], v[32:35]
 s_add_u32 m0, s23, 32768
 ds_read_b128 a[168:171], v5 offset:2048
 ds_read_b128 a[172:175], v6 offset:2048
M v[32:35], a[36:39], a[164:167], v[32:35]
 ds_read_b64_tr_b16 a[96:97], v20 offset:0
 ds_read_b64_tr_b16 a[98:99], v20 offset:1024
M v[36:39], a[44:47], a[164:167], v[36:39]
 buffer_load_dwordx4 v16, s[56:59], s29 offen offset:0   lds
M v[36:39], a[40:43], a[160:163], v[36:39]
M v[40:43], a[48:51], a[160:163], v[40:43]
 s_add_u32 s3, s93, 270336
 ds_read_b64_tr_b16 a[100:101], v20 offset:8192
 ds_read_b64_tr_b16 a[102:103], v20 offset:9216
M v[40:43], a[52:55], a[164:167], v[40:43]
 buffer_load_dwordx4 v17, s[56:59], s29 offen offset:1024   lds
M v[44:47], a[60:63], a[164:167], v[44:47]
 buffer_store_dwordx4 v[96:99], v7, s[8:11], s3 offen offset:0 sc1
M v[44:47], a[56:59], a[160:163], v[44:47]
 ds_read_b64_tr_b16 a[104:105], v21 offset:0
 ds_read_b64_tr_b16 a[106:107], v21 offset:1024
M v[48:51], a[64:67], a[160:163], v[48:51]
M v[48:51], a[68:71], a[164:167], v[48:51]
 buffer_load_dwordx4 v18, s[56:59], s29 offen offset:2048   lds
M v[52:55], a[76:79], a[164:167], v[52:55]
 ds_read_b64_tr_b16 a[108:109], v21 offset:8192
 ds_read_b64_tr_b16 a[110:111], v21 offset:9216
M v[52:55], a[72:75], a[160:163], v[52:55]
M v[56:59], a[80:83], a[160:163], v[56:59]
M v[56:59], a[84:87], a[164:167], v[56:59]
 s_waitcnt lgkmcnt(8)
 ds_read_b64_tr_b16 a[112:113], v22 offset:0
 ds_read_b64_tr_b16 a[114:115], v22 offset:1024
M v[60:63], a[92:95], a[164:167], v[60:63]
 buffer_load_dwordx4 v19, s[56:59], s29 offen offset:3072   lds
M v[60:63], a[88:91], a[160:163], v[60:63]
 s_add_u32 s29, s29, 128
M v[68:71], a[32:35], a[168:171], v[68:71]
 ds_read_b128 a[160:163], v5 offset:4096
 ds_read_b128 a[164:167], v6 offset:4096
M v[68:71], a[36:39], a[172:175], v[68:71]
 ds_read_b64_tr_b16 a[116:117], v22 offset:8192
 ds_read_b64_tr_b16 a[118:119], v22 offset:9216
M v[76:79], a[44:47], a[172:175], v[76:79]
 s_lshl_b32 s28, s20, 13
 buffer_store_dwordx4 v[104:107], v7, s[8:11], s3 offen offset:1024 sc1
M v[76:79], a[40:43], a[168:171], v[76:79]
 s_lshl_b32 s21, s41, 20
 ds_read_b64_tr_b16 a[120:121], v23 offset:0
 ds_read_b64_tr_b16 a[122:123], v23 offset:1024
M v[84:87], a[48:51], a[168:171], v[84:87]
 s_mov_b32 s22, 0
M v[84:87], a[52:55], a[172:175], v[84:87]
 s_lshl_b32 s7, s41, 18
M v[92:95], a[60:63], a[172:175], v[92:95]
 s_add_u32 s7, s7, 100663296
 ds_read_b64_tr_b16 a[124:125], v23 offset:8192
 ds_read_b64_tr_b16 a[126:127], v23 offset:9216
M v[92:95], a[56:59], a[168:171], v[92:95]
 s_add_u32 s38, s7, 65536
M v[100:103], a[64:67], a[168:171], v[100:103]
 s_add_u32 s64, s42, 1
M v[100:103], a[68:71], a[172:175], v[100:103]
 s_min_u32 s64, s64, 10
M v[108:111], a[76:79], a[172:175], v[108:111]
 s_sub_u32 s27, s64, 3
 buffer_load_dword v24, v13, s[8:11], s46 offen sc1
M v[108:111], a[72:75], a[168:171], v[108:111]
 s_lshl_b32 s6, s64, 1
M v[116:119], a[80:83], a[168:171], v[116:119]
 s_sub_u32 s43, s6, 2
 s_lshl_b32 s64, s42, 16
 s_add_u32 s4, s21, s64
M v[116:119], a[84:87], a[172:175], v[116:119]
 s_waitcnt lgkmcnt(6)
 s_sub_u32 s26, 1114112, s64
 s_add_u32 s26, s26, s21
M v[124:127], a[92:95], a[172:175], v[124:127]
 s_waitcnt vmcnt(20) lgkmcnt(0)
 s_lshl_b32 s64, s42, 1
 s_sub_u32 s64, 32, s64
M v[124:127], a[88:91], a[168:171], v[124:127]
 s_barrier
M v[132:135], a[32:35], a[160:163], v[132:135]
 s_cmp_ge_u32 s42, 10
 ds_read_b128 a[168:171], v5 offset:6144
 ds_read_b128 a[172:175], v6 offset:6144
M v[132:135], a[36:39], a[164:167], v[132:135]
 s_cselect_b32 s25, s64, 32767
 ds_read_b64_tr_b16 a[128:129], v20 offset:16384
 ds_read_b64_tr_b16 a[130:131], v20 offset:17408
M v[140:143], a[44:47], a[164:167], v[140:143]
 s_mov_b32 s23, 0
 buffer_store_dwordx4 v[112:115], v7, s[8:11], s3 offen offset:2048 sc1
M v[140:143], a[40:43], a[160:163], v[140:143]
M v[148:151], a[48:51], a[160:163], v[148:151]
 ds_read_b64_tr_b16 a[132:133], v20 offset:24576
 ds_read_b64_tr_b16 a[134:135], v20 offset:25600
M v[148:151], a[52:55], a[164:167], v[148:151]
M v[156:159], a[60:63], a[164:167], v[156:159]
M v[156:159], a[56:59], a[160:163], v[156:159]
 ds_read_b64_tr_b16 a[136:137], v21 offset:16384
 ds_read_b64_tr_b16 a[138:139], v21 offset:17408
M v[164:167], a[64:67], a[160:163], v[164:167]
M v[164:167], a[68:71], a[164:167], v[164:167]
M v[172:175], a[76:79], a[164:167], v[172:175]
 ds_read_b64_tr_b16 a[140:141], v21 offset:24576
 ds_read_b64_tr_b16 a[142:143], v21 offset:25600
M v[172:175], a[72:75], a[160:163], v[172:175]
M v[180:183], a[80:83], a[160:163], v[180:183]
M v[180:183], a[84:87], a[164:167], v[180:183]
 s_waitcnt lgkmcnt(8)
 ds_read_b64_tr_b16 a[144:145], v22 offset:16384
 ds_read_b64_tr_b16 a[146:147], v22 offset:17408
M v[188:191], a[92:95], a[164:167], v[188:191]
 buffer_store_dwordx4 v[120:123], v7, s[8:11], s3 offen offset:3072 sc1
M v[188:191], a[88:91], a[160:163], v[188:191]
M v[196:199], a[32:35], a[168:171], v[196:199]
 ds_read_b128 a[160:163], v5 offset:16384
 ds_read_b128 a[164:167], v6 offset:16384
M v[196:199], a[36:39], a[172:175], v[196:199]
 ds_read_b64_tr_b16 a[148:149], v22 offset:24576
 ds_read_b64_tr_b16 a[150:151], v22 offset:25600
M v[204:207], a[44:47], a[172:175], v[204:207]
M v[204:207], a[40:43], a[168:171], v[204:207]
 ds_read_b64_tr_b16 a[152:153], v23 offset:16384
 ds_read_b64_tr_b16 a[154:155], v23 offset:17408
M v[212:215], a[48:51], a[168:171], v[212:215]
M v[212:215], a[52:55], a[172:175], v[212:215]
M v[220:223], a[60:63], a[172:175], v[220:223]
 ds_read_b64_tr_b16 a[156:157], v23 offset:24576
 ds_read_b64_tr_b16 a[158:159], v23 offset:25600
M v[220:223], a[56:59], a[168:171], v[220:223]
M v[228:231], a[64:67], a[168:171], v[228:231]
M v[228:231], a[68:71], a[172:175], v[228:231]
M v[236:239], a[76:79], a[172:175], v[236:239]
M v[236:239], a[72:75], a[168:171], v[236:239]
M v[244:247], a[80:83], a[168:171], v[244:247]
M v[244:247], a[84:87], a[172:175], v[244:247]
 s_waitcnt lgkmcnt(6)
M v[252:255], a[92:95], a[172:175], v[252:255]
 s_waitcnt vmcnt(18) lgkmcnt(0)
M v[252:255], a[88:91], a[168:171], v[252:255]
 s_barrier
M v[32:35], a[96:99], a[160:163], v[32:35]
 ds_read_b128 a[168:171], v5 offset:18432
 ds_read_b128 a[172:175], v6 offset:18432
M v[32:35], a[100:103], a[164:167], v[32:35]
 ds_read_b64_tr_b16 a[32:33], v1 offset:0
 ds_read_b64_tr_b16 a[34:35], v1 offset:1024
M v[36:39], a[108:111], a[164:167], v[36:39]
 v_add_u32 v10, s28, v7
 v_add_u32 v11, 0x1000, v10
M v[36:39], a[104:107], a[160:163], v[36:39]
 s_waitcnt vmcnt(2)
 v_cmp_eq_u32 vcc, 0, v24
 s_add_u32 s3, s93, 524288
M v[40:43], a[112:115], a[160:163], v[40:43]
 s_lshl_b32 s64, s20, 10
 ds_read_b64_tr_b16 a[36:37], v1 offset:8192
 ds_read_b64_tr_b16 a[38:39], v1 offset:9216
M v[40:43], a[116:119], a[164:167], v[40:43]
 s_cbranch_vccnz L_f1s14
L_f1r14:
M v[44:47], a[124:127], a[164:167], v[44:47]
 s_add_u32 m0, s28, 98304
 s_nop 0
 buffer_load_dwordx4 v10, s[8:11], s21 offen offset:0 sc1 lds
M v[44:47], a[120:123], a[160:163], v[44:47]
 ds_read_b64_tr_b16 a[40:41], v2 offset:0
 ds_read_b64_tr_b16 a[42:43], v2 offset:1024
M v[48:51], a[128:131], a[160:163], v[48:51]
 buffer_store_dwordx4 v[128:131], v7, s[8:11], s3 offen offset:0 sc1
M v[48:51], a[132:135], a[164:167], v[48:51]
M v[52:55], a[140:143], a[164:167], v[52:55]
 ds_read_b64_tr_b16 a[44:45], v2 offset:8192
 ds_read_b64_tr_b16 a[46:47], v2 offset:9216
M v[52:55], a[136:139], a[160:163], v[52:55]
 buffer_load_dwordx4 v10, s[8:11], s21 offen offset:1024 sc1 lds
M v[56:59], a[144:147], a[160:163], v[56:59]
M v[56:59], a[148:151], a[164:167], v[56:59]
 s_waitcnt lgkmcnt(8)
 ds_read_b64_tr_b16 a[48:49], v3 offset:0
 ds_read_b64_tr_b16 a[50:51], v3 offset:1024
M v[60:63], a[156:159], a[164:167], v[60:63]
M v[60:63], a[152:155], a[160:163], v[60:63]
 buffer_load_dwordx4 v10, s[8:11], s21 offen offset:2048 sc1 lds
M v[68:71], a[96:99], a[168:171], v[68:71]
 ds_read_b128 a[160:163], v5 offset:20480
 ds_read_b128 a[164:167], v6 offset:20480
M v[68:71], a[100:103], a[172:175], v[68:71]
 ds_read_b64_tr_b16 a[52:53], v3 offset:8192
 ds_read_b64_tr_b16 a[54:55], v3 offset:9216
M v[76:79], a[108:111], a[172:175], v[76:79]
 buffer_store_dwordx4 v[136:139], v7, s[8:11], s3 offen offset:1024 sc1
M v[76:79], a[104:107], a[168:171], v[76:79]
 ds_read_b64_tr_b16 a[56:57], v4 offset:0
 ds_read_b64_tr_b16 a[58:59], v4 offset:1024
M v[84:87], a[112:115], a[168:171], v[84:87]
 buffer_load_dwordx4 v10, s[8:11], s21 offen offset:3072 sc1 lds
M v[84:87], a[116:119], a[172:175], v[84:87]
 s_add_u32 m0, s28, 102400
M v[92:95], a[124:127], a[172:175], v[92:95]
 ds_read_b64_tr_b16 a[60:61], v4 offset:8192
 ds_read_b64_tr_b16 a[62:63], v4 offset:9216
M v[92:95], a[120:123], a[168:171], v[92:95]
M v[100:103], a[128:131], a[168:171], v[100:103]
 buffer_load_dwordx4 v11, s[8:11], s21 offen offset:0 sc1 lds
M v[100:103], a[132:135], a[172:175], v[100:103]
M v[108:111], a[140:143], a[172:175], v[108:111]
M v[108:111], a[136:139], a[168:171], v[108:111]
M v[116:119], a[144:147], a[168:171], v[116:119]
 buffer_load_dwordx4 v11, s[8:11], s21 offen offset:1024 sc1 lds
M v[116:119], a[148:151], a[172:175], v[116:119]
 s_waitcnt lgkmcnt(6)
M v[124:127], a[156:159], a[172:175], v[124:127]
 s_waitcnt lgkmcnt(0)
 buffer_load_dwordx4 v11, s[8:11], s21 offen offset:2048 sc1 lds
M v[124:127], a[152:155], a[168:171], v[124:127]
 s_barrier
M v[132:135], a[96:99], a[160:163], v[132:135]
 ds_read_b128 a[168:171], v5 offset:22528
 ds_read_b128 a[172:175], v6 offset:22528
M v[132:135], a[100:103], a[164:167], v[132:135]
 ds_read_b64_tr_b16 a[64:65], v1 offset:16384
 ds_read_b64_tr_b16 a[66:67], v1 offset:17408
M v[140:143], a[108:111], a[164:167], v[140:143]
 buffer_load_dwordx4 v11, s[8:11], s21 offen offset:3072 sc1 lds
M v[140:143], a[104:107], a[160:163], v[140:143]
 s_add_u32 s24, s23, 16777216
 buffer_store_dwordx4 v[144:147], v7, s[8:11], s3 offen offset:2048 sc1
M v[148:151], a[112:115], a[160:163], v[148:151]
 s_mov_b32 s23, s21
 ds_read_b64_tr_b16 a[68:69], v1 offset:24576
 ds_read_b64_tr_b16 a[70:71], v1 offset:25600
M v[148:151], a[116:119], a[164:167], v[148:151]
 s_add_u32 s21, s21, 32768
M v[156:159], a[124:127], a[164:167], v[156:159]
 s_add_u32 s22, s22, 1
M v[156:159], a[120:123], a[160:163], v[156:159]
 s_cmp_eq_u32 s22, s25
 ds_read_b64_tr_b16 a[72:73], v2 offset:16384
 ds_read_b64_tr_b16 a[74:75], v2 offset:17408
M v[164:167], a[128:131], a[160:163], v[164:167]
 s_cselect_b32 s21, s26, s21
 v_subrev_u32 v5, 0x10000, v5
 v_subrev_u32 v6, 0x10000, v6
M v[164:167], a[132:135], a[164:167], v[164:167]
 s_cmp_eq_u32 s22, s43
M v[172:175], a[140:143], a[164:167], v[172:175]
 s_cselect_b32 s21, s4, s21
 ds_read_b64_tr_b16 a[76:77], v2 offset:24576
 ds_read_b64_tr_b16 a[78:79], v2 offset:25600
M v[172:175], a[136:139], a[160:163], v[172:175]
 s_cmp_eq_u32 s22, s6
M v[180:183], a[144:147], a[160:163], v[180:183]
 s_cselect_b32 s21, s7, s21
 v_mov_b32 v9, v25
 v_lshrrev_b32 v24, 4, v0
M v[180:183], a[148:151], a[164:167], v[180:183]
 s_waitcnt lgkmcnt(8)
 ds_read_b64_tr_b16 a[80:81], v3 offset:16384
 ds_read_b64_tr_b16 a[82:83], v3 offset:17408
M v[188:191], a[156:159], a[164:167], v[188:191]
 v_lshlrev_b32 v24, 2, v24
 v_and_b32 v25, 15, v0
M v[188:191], a[152:155], a[160:163], v[188:191]
 v_sub_u32 v24, v24, v25
M v[196:199], a[96:99], a[168:171], v[196:199]
 s_add_u32 s64, s64, s34
 ds_read_b128 a[160:163], v5 offset:32768
 ds_read_b128 a[164:167], v6 offset:32768
M v[196:199], a[100:103], a[172:175], v[196:199]
 s_add_u32 s52, s64, 65536
 ds_read_b64_tr_b16 a[84:85], v3 offset:24576
 ds_read_b64_tr_b16 a[86:87], v3 offset:25600
M v[204:207], a[108:111], a[172:175], v[204:207]
 s_mov_b32 s55, 0x21800000
 buffer_store_dwordx4 v[152:155], v7, s[8:11], s3 offen offset:3072 sc1
M v[204:207], a[104:107], a[168:171], v[204:207]
 s_and_b32 s65, s39, 0xf000000
 ds_read_b64_tr_b16 a[88:89], v4 offset:16384
 ds_read_b64_tr_b16 a[90:91], v4 offset:17408
M v[212:215], a[112:115], a[168:171], v[212:215]
 s_cmp_eq_u32 s20, 0
M v[212:215], a[116:119], a[172:175], v[212:215]
 s_cselect_b32 s54, s39, s65
M v[220:223], a[124:127], a[172:175], v[220:223]
 s_lshr_b32 s64, s20, 1
 ds_read_b64_tr_b16 a[92:93], v4 offset:24576
 ds_read_b64_tr_b16 a[94:95], v4 offset:25600
M v[220:223], a[120:123], a[168:171], v[220:223]
 s_lshl_b32 s64, s64, 17
M v[228:231], a[128:131], a[168:171], v[228:231]
 s_and_b32 s65, s20, 1
M v[228:231], a[132:135], a[172:175], v[228:231]
 s_lshl_b32 s65, s65, 12
M v[236:239], a[140:143], a[172:175], v[236:239]
 s_add_u32 s64, s64, s65
 v_add_u32 v14, s64, v7
 v_mov_b32 v8, 0xff800000
M v[236:239], a[136:139], a[168:171], v[236:239]
 v_cmp_lt_i32 s[16:17], 0, v24
 v_cmp_lt_i32 s[18:19], -1, v24
M v[244:247], a[144:147], a[168:171], v[244:247]
 v_cmp_lt_i32 s[48:49], -2, v24
 v_cmp_lt_i32 s[50:51], -3, v24
M v[244:247], a[148:151], a[172:175], v[244:247]
 s_waitcnt lgkmcnt(6)
M v[252:255], a[156:159], a[172:175], v[252:255]
 s_waitcnt lgkmcnt(0)
M v[252:255], a[152:155], a[168:171], v[252:255]
 s_barrier
M v[32:35], a[32:35], a[160:163], v[32:35]
 ds_read_b128 a[168:171], v5 offset:34816
 ds_read_b128 a[172:175], v6 offset:34816
M v[32:35], a[36:39], a[164:167], v[32:35]
 buffer_load_dword v24, v9, s[8:11], s46 offen sc1
M v[36:39], a[44:47], a[164:167], v[36:39]
 v_mov_b32 v1, v15
 v_add_u32 v2, 0x10000, v7
M v[36:39], a[40:43], a[160:163], v[36:39]
 v_mov_b32 v3, v10
 v_mov_b32 v4, v11
M v[40:43], a[48:51], a[160:163], v[40:43]
 s_mov_b64 s[60:61], s[76:77]
M v[40:43], a[52:55], a[164:167], v[40:43]
 s_mov_b32 s62, s78
M v[44:47], a[60:63], a[164:167], v[44:47]
 s_mov_b32 s63, 0x20000
 v_lshl_add_u32 v10, v0, 7, s95
 v_and_b32 v0, 48, v0
M v[44:47], a[56:59], a[160:163], v[44:47]
 v_lshl_add_u32 v0, v0, 24, v10
 v_mul_f32 v32, s5, v32
M v[48:51], a[64:67], a[160:163], v[48:51]
 v_mul_f32 v33, s5, v33
 v_mul_f32 v34, s5, v34
M v[48:51], a[68:71], a[164:167], v[48:51]
 v_mul_f32 v35, s5, v35
 v_mul_f32 v36, s5, v36
M v[52:55], a[76:79], a[164:167], v[52:55]
 v_mul_f32 v37, s5, v37
 v_mul_f32 v38, s5, v38
M v[52:55], a[72:75], a[160:163], v[52:55]
 v_mul_f32 v39, s5, v39
 v_cvt_pk_bf16_f32 v32, v32, v33
M v[56:59], a[80:83], a[160:163], v[56:59]
 v_cvt_pk_bf16_f32 v33, v34, v35
 v_cvt_pk_bf16_f32 v34, v36, v37
M v[56:59], a[84:87], a[164:167], v[56:59]
 s_waitcnt lgkmcnt(0)
 v_cvt_pk_bf16_f32 v35, v38, v39
 ds_write_b128 v14, v[32:35] offset:0
M v[60:63], a[92:95], a[164:167], v[60:63]
 s_add_u32 s3, s93, 532480
 buffer_store_dwordx4 v[160:163], v7, s[8:11], s3 offen offset:0 sc1
M v[60:63], a[88:91], a[160:163], v[60:63]
 v_mul_f32 v40, s5, v40
 v_mul_f32 v41, s5, v41
M v[68:71], a[32:35], a[168:171], v[68:71]
 ds_read_b128 a[160:163], v5 offset:36864
 ds_read_b128 a[164:167], v6 offset:36864
M v[68:71], a[36:39], a[172:175], v[68:71]
 v_mul_f32 v42, s5, v42
 v_mul_f32 v43, s5, v43
M v[76:79], a[44:47], a[172:175], v[76:79]
 v_mul_f32 v44, s5, v44
 v_mul_f32 v45, s5, v45
M v[76:79], a[40:43], a[168:171], v[76:79]
 v_mul_f32 v46, s5, v46
 v_mul_f32 v47, s5, v47
M v[84:87], a[48:51], a[168:171], v[84:87]
 v_cvt_pk_bf16_f32 v40, v40, v41
 v_cvt_pk_bf16_f32 v41, v42, v43
M v[84:87], a[52:55], a[172:175], v[84:87]
 v_cvt_pk_bf16_f32 v42, v44, v45
 v_cvt_pk_bf16_f32 v43, v46, v47
M v[92:95], a[60:63], a[172:175], v[92:95]
 ds_write_b128 v14, v[40:43] offset:1024
M v[92:95], a[56:59], a[168:171], v[92:95]
 buffer_store_dwordx4 v[168:171], v7, s[8:11], s3 offen offset:1024 sc1
M v[100:103], a[64:67], a[168:171], v[100:103]
 v_mul_f32 v48, s5, v48
 v_mul_f32 v49, s5, v49
M v[100:103], a[68:71], a[172:175], v[100:103]
 v_mul_f32 v50, s5, v50
 v_mul_f32 v51, s5, v51
M v[108:111], a[76:79], a[172:175], v[108:111]
 v_mul_f32 v52, s5, v52
 v_mul_f32 v53, s5, v53
M v[108:111], a[72:75], a[168:171], v[108:111]
 v_mul_f32 v54, s5, v54
 v_mul_f32 v55, s5, v55
M v[116:119], a[80:83], a[168:171], v[116:119]
 v_cvt_pk_bf16_f32 v48, v48, v49
 v_cvt_pk_bf16_f32 v49, v50, v51
M v[116:119], a[84:87], a[172:175], v[116:119]
 s_waitcnt lgkmcnt(1)
 v_cvt_pk_bf16_f32 v50, v52, v53
 v_cvt_pk_bf16_f32 v51, v54, v55
M v[124:127], a[92:95], a[172:175], v[124:127]
 ds_write_b128 v14, v[48:51] offset:2048
M v[124:127], a[88:91], a[168:171], v[124:127]
 buffer_store_dwordx4 v[176:179], v7, s[8:11], s3 offen offset:2048 sc1
M v[132:135], a[32:35], a[160:163], v[132:135]
 ds_read_b128 a[168:171], v5 offset:38912
 ds_read_b128 a[172:175], v6 offset:38912
M v[132:135], a[36:39], a[164:167], v[132:135]
 v_mul_f32 v56, s5, v56
 v_mul_f32 v57, s5, v57
M v[140:143], a[44:47], a[164:167], v[140:143]
 v_mul_f32 v58, s5, v58
 v_mul_f32 v59, s5, v59
M v[140:143], a[40:43], a[160:163], v[140:143]
 v_mul_f32 v60, s5, v60
 v_mul_f32 v61, s5, v61
M v[148:151], a[48:51], a[160:163], v[148:151]
 v_mul_f32 v62, s5, v62
 v_mul_f32 v63, s5, v63
M v[148:151], a[52:55], a[164:167], v[148:151]
 v_cvt_pk_bf16_f32 v56, v56, v57
 v_cvt_pk_bf16_f32 v57, v58, v59
M v[156:159], a[60:63], a[164:167], v[156:159]
 v_cvt_pk_bf16_f32 v58, v60, v61
 v_cvt_pk_bf16_f32 v59, v62, v63
M v[156:159], a[56:59], a[160:163], v[156:159]
 s_waitcnt lgkmcnt(0)
 ds_write_b128 v14, v[56:59] offset:3072
M v[164:167], a[64:67], a[160:163], v[164:167]
 s_barrier
M v[164:167], a[68:71], a[164:167], v[164:167]
M v[172:175], a[76:79], a[164:167], v[172:175]
 s_add_u32 m0, s28, 32768
 s_nop 0
 buffer_load_dwordx4 v3, s[8:11], s21 offen offset:0 sc1 lds
M v[172:175], a[72:75], a[160:163], v[172:175]
M v[180:183], a[80:83], a[160:163], v[180:183]
 buffer_store_dwordx4 v[184:187], v7, s[8:11], s3 offen offset:3072 sc1
M v[180:183], a[84:87], a[164:167], v[180:183]
 v_mul_f32 v68, s5, v68
 v_mul_f32 v69, s5, v69
M v[188:191], a[92:95], a[164:167], v[188:191]
 buffer_load_dwordx4 v3, s[8:11], s21 offen offset:1024 sc1 lds
M v[188:191], a[88:91], a[160:163], v[188:191]
 v_mul_f32 v70, s5, v70
 v_mul_f32 v71, s5, v71
M v[196:199], a[32:35], a[168:171], v[196:199]
 v_mul_f32 v76, s5, v76
 v_mul_f32 v77, s5, v77
M v[196:199], a[36:39], a[172:175], v[196:199]
 v_mul_f32 v78, s5, v78
 v_mul_f32 v79, s5, v79
M v[204:207], a[44:47], a[172:175], v[204:207]
 buffer_load_dwordx4 v3, s[8:11], s21 offen offset:2048 sc1 lds
M v[204:207], a[40:43], a[168:171], v[204:207]
 v_cvt_pk_bf16_f32 v68, v68, v69
 v_cvt_pk_bf16_f32 v69, v70, v71
M v[212:215], a[48:51], a[168:171], v[212:215]
 v_cvt_pk_bf16_f32 v70, v76, v77
 v_cvt_pk_bf16_f32 v71, v78, v79
M v[212:215], a[52:55], a[172:175], v[212:215]
 ds_write_b128 v14, v[68:71] offset:8192
 v_mul_f32 v84, s5, v84
M v[220:223], a[60:63], a[172:175], v[220:223]
 buffer_load_dwordx4 v3, s[8:11], s21 offen offset:3072 sc1 lds
M v[220:223], a[56:59], a[168:171], v[220:223]
 s_add_u32 m0, s28, 36864
 v_mul_f32 v85, s5, v85
 v_mul_f32 v86, s5, v86
M v[228:231], a[64:67], a[168:171], v[228:231]
 v_mul_f32 v87, s5, v87
 v_mul_f32 v92, s5, v92
M v[228:231], a[68:71], a[172:175], v[228:231]
 v_mul_f32 v93, s5, v93
 v_mul_f32 v94, s5, v94
M v[236:239], a[76:79], a[172:175], v[236:239]
 buffer_load_dwordx4 v4, s[8:11], s21 offen offset:0 sc1 lds
M v[236:239], a[72:75], a[168:171], v[236:239]
 v_mul_f32 v95, s5, v95
 v_cvt_pk_bf16_f32 v84, v84, v85
M v[244:247], a[80:83], a[168:171], v[244:247]
 v_cvt_pk_bf16_f32 v85, v86, v87
 v_cvt_pk_bf16_f32 v86, v92, v93
M v[244:247], a[84:87], a[172:175], v[244:247]
 v_cvt_pk_bf16_f32 v87, v94, v95
 ds_write_b128 v14, v[84:87] offset:9216
M v[252:255], a[92:95], a[172:175], v[252:255]
 buffer_load_dwordx4 v4, s[8:11], s21 offen offset:1024 sc1 lds
M v[252:255], a[88:91], a[168:171], v[252:255]
 buffer_load_dwordx4 v4, s[8:11], s21 offen offset:2048 sc1 lds
 buffer_load_dwordx4 v4, s[8:11], s21 offen offset:3072 sc1 lds
 s_add_u32 s24, s23, 16777216
 s_mov_b32 s23, s21
 s_add_u32 s21, s21, 32768
 s_add_u32 s22, s22, 1
 s_cmp_eq_u32 s22, s25
 s_cselect_b32 s21, s26, s21
 s_cmp_eq_u32 s22, s43
 s_cselect_b32 s21, s4, s21
 s_cmp_eq_u32 s22, s6
 s_cselect_b32 s21, s7, s21
 v_mul_f32 v100, s5, v100
 v_mul_f32 v101, s5, v101
 v_mul_f32 v102, s5, v102
 v_mul_f32 v103, s5, v103
 v_mul_f32 v108, s5, v108
 v_mul_f32 v109, s5, v109
 v_mul_f32 v110, s5, v110
 v_mul_f32 v111, s5, v111
 v_cvt_pk_bf16_f32 v100, v100, v101
 v_cvt_pk_bf16_f32 v101, v102, v103
 v_cvt_pk_bf16_f32 v102, v108, v109
 v_cvt_pk_bf16_f32 v103, v110, v111
 ds_write_b128 v14, v[100:103] offset:10240
 v_pk_mul_f32 v[116:117], v[116:117], s[4:5] op_sel:[0,1] op_sel_hi:[1,1]
 v_pk_mul_f32 v[118:119], v[118:119], s[4:5] op_sel:[0,1] op_sel_hi:[1,1]
 v_pk_mul_f32 v[124:125], v[124:125], s[4:5] op_sel:[0,1] op_sel_hi:[1,1]
 v_pk_mul_f32 v[126:127], v[126:127], s[4:5] op_sel:[0,1] op_sel_hi:[1,1]
 v_cvt_pk_bf16_f32 v116, v116, v117
 v_cvt_pk_bf16_f32 v117, v118, v119
 v_cvt_pk_bf16_f32 v118, v124, v125
 v_cvt_pk_bf16_f32 v119, v126, v127
 ds_write_b128 v14, v[116:119] offset:11264
 v_pk_mul_f32 v[132:133], v[132:133], s[4:5] op_sel:[0,1] op_sel_hi:[1,1]
 v_pk_mul_f32 v[134:135], v[134:135], s[4:5] op_sel:[0,1] op_sel_hi:[1,1]
 v_pk_mul_f32 v[140:141], v[140:141], s[4:5] op_sel:[0,1] op_sel_hi:[1,1]
 v_pk_mul_f32 v[142:143], v[142:143], s[4:5] op_sel:[0,1] op_sel_hi:[1,1]
 v_cvt_pk_bf16_f32 v132, v132, v133
 v_cvt_pk_bf16_f32 v133, v134, v135
 v_cvt_pk_bf16_f32 v134, v140, v141
 v_cvt_pk_bf16_f32 v135, v142, v143
 ds_write_b128 v14, v[132:135] offset:16384
 v_pk_mul_f32 v[148:149], v[148:149], s[4:5] op_sel:[0,1] op_sel_hi:[1,1]
 v_pk_mul_f32 v[150:151], v[150:151], s[4:5] op_sel:[0,1] op_sel_hi:[1,1]
 v_pk_mul_f32 v[156:157], v[156:157], s[4:5] op_sel:[0,1] op_sel_hi:[1,1]
 v_pk_mul_f32 v[158:159], v[158:159], s[4:5] op_sel:[0,1] op_sel_hi:[1,1]
 v_cvt_pk_bf16_f32 v148, v148, v149
 v_cvt_pk_bf16_f32 v149, v150, v151
 v_cvt_pk_bf16_f32 v150, v156, v157
 v_cvt_pk_bf16_f32 v151, v158, v159
 ds_write_b128 v14, v[148:151] offset:17408
 v_pk_mul_f32 v[164:165], v[164:165], s[4:5] op_sel:[0,1] op_sel_hi:[1,1]
 v_pk_mul_f32 v[166:167], v[166:167], s[4:5] op_sel:[0,1] op_sel_hi:[1,1]
 v_pk_mul_f32 v[172:173], v[172:173], s[4:5] op_sel:[0,1] op_sel_hi:[1,1]
 v_pk_mul_f32 v[174:175], v[174:175], s[4:5] op_sel:[0,1] op_sel_hi:[1,1]
 v_cvt_pk_bf16_f32 v164, v164, v165
 v_cvt_pk_bf16_f32 v165, v166, v167
 v_cvt_pk_bf16_f32 v166, v172, v173
 v_cvt_pk_bf16_f32 v167, v174, v175
 ds_write_b128 v14, v[164:167] offset:18432
 v_pk_mul_f32 v[180:181], v[180:181], s[4:5] op_sel:[0,1] op_sel_hi:[1,1]
 v_pk_mul_f32 v[182:183], v[182:183], s[4:5] op_sel:[0,1] op_sel_hi:[1,1]
 v_pk_mul_f32 v[188:189], v[188:189], s[4:5] op_sel:[0,1] op_sel_hi:[1,1]
 v_pk_mul_f32 v[190:191], v[190:191], s[4:5] op_sel:[0,1] op_sel_hi:[1,1]
 v_cvt_pk_bf16_f32 v180, v180, v181
 v_cvt_pk_bf16_f32 v181, v182, v183
 v_cvt_pk_bf16_f32 v182, v188, v189
 v_cvt_pk_bf16_f32 v183, v190, v191
 ds_write_b128 v14, v[180:183] offset:19456
 v_pk_mul_f32 v[196:197], v[196:197], s[4:5] op_sel:[0,1] op_sel_hi:[1,1]
 v_pk_mul_f32 v[198:199], v[198:199], s[4:5] op_sel:[0,1] op_sel_hi:[1,1]
 v_pk_mul_f32 v[204:205], v[204:205], s[4:5] op_sel:[0,1] op_sel_hi:[1,1]
 v_pk_mul_f32 v[206:207], v[206:207], s[4:5] op_sel:[0,1] op_sel_hi:[1,1]
 v_cvt_pk_bf16_f32 v196, v196, v197
 v_cvt_pk_bf16_f32 v197, v198, v199
 v_cvt_pk_bf16_f32 v198, v204, v205
 v_cvt_pk_bf16_f32 v199, v206, v207
 ds_write_b128 v14, v[196:199] offset:24576
 v_pk_mul_f32 v[212:213], v[212:213], s[4:5] op_sel:[0,1] op_sel_hi:[1,1]
 v_pk_mul_f32 v[214:215], v[214:215], s[4:5] op_sel:[0,1] op_sel_hi:[1,1]
 v_pk_mul_f32 v[220:221], v[220:221], s[4:5] op_sel:[0,1] op_sel_hi:[1,1]
 v_pk_mul_f32 v[222:223], v[222:223], s[4:5] op_sel:[0,1] op_sel_hi:[1,1]
 v_cvt_pk_bf16_f32 v212, v212, v213
 v_cvt_pk_bf16_f32 v213, v214, v215
 v_cvt_pk_bf16_f32 v214, v220, v221
 v_cvt_pk_bf16_f32 v215, v222, v223
 ds_write_b128 v14, v[212:215] offset:25600
 v_pk_mul_f32 v[228:229], v[228:229], s[4:5] op_sel:[0,1] op_sel_hi:[1,1]
 v_pk_mul_f32 v[230:231], v[230:231], s[4:5] op_sel:[0,1] op_sel_hi:[1,1]
 v_pk_mul_f32 v[236:237], v[236:237], s[4:5] op_sel:[0,1] op_sel_hi:[1,1]
 v_pk_mul_f32 v[238:239], v[238:239], s[4:5] op_sel:[0,1] op_sel_hi:[1,1]
 v_cvt_pk_bf16_f32 v228, v228, v229
 v_cvt_pk_bf16_f32 v229, v230, v231
 v_cvt_pk_bf16_f32 v230, v236, v237
 v_cvt_pk_bf16_f32 v231, v238, v239
 ds_write_b128 v14, v[228:231] offset:26624
 v_pk_mul_f32 v[244:245], v[244:245], s[4:5] op_sel:[0,1] op_sel_hi:[1,1]
 v_pk_mul_f32 v[246:247], v[246:247], s[4:5] op_sel:[0,1] op_sel_hi:[1,1]
 v_pk_mul_f32 v[252:253], v[252:253], s[4:5] op_sel:[0,1] op_sel_hi:[1,1]
 v_pk_mul_f32 v[254:255], v[254:255], s[4:5] op_sel:[0,1] op_sel_hi:[1,1]
 v_cvt_pk_bf16_f32 v244, v244, v245
 v_cvt_pk_bf16_f32 v245, v246, v247
 v_cvt_pk_bf16_f32 v246, v252, v253
 v_cvt_pk_bf16_f32 v247, v254, v255
 ds_write_b128 v14, v[244:247] offset:27648
 s_waitcnt vmcnt(15) lgkmcnt(0)
 s_barrier
 ds_read_b128 a[64:67], v2 offset:32768
 ds_read_b128 a[68:71], v2 offset:33792
 ds_read_b128 a[72:75], v2 offset:34816
 ds_read_b128 a[76:79], v2 offset:35840
 ds_read_b128 a[80:83], v2 offset:36864
 ds_read_b128 a[84:87], v2 offset:37888
 ds_read_b128 a[88:91], v2 offset:38912
 ds_read_b128 a[92:95], v2 offset:39936
 s_lshl_b32 s64, s20, 13
 s_sub_u32 s65, 155648, s64
 v_add_u32 v10, s64, v7
 v_add_u32 v11, s65, v7
 ds_read_b128 a[0:3], v10 offset:0
 ds_read_b128 a[4:7], v10 offset:1024
 ds_read_b128 a[8:11], v10 offset:2048
 ds_read_b128 a[12:15], v10 offset:3072
 ds_read_b128 a[16:19], v10 offset:4096
 ds_read_b128 a[20:23], v10 offset:5120
 ds_read_b128 a[24:27], v10 offset:6144
 ds_read_b128 a[28:31], v10 offset:7168
 ds_read_b128 a[32:35], v11 offset:0
 ds_read_b128 a[36:39], v11 offset:1024
 ds_read_b128 a[40:43], v11 offset:2048
 ds_read_b128 a[44:47], v11 offset:3072
 ds_read_b128 a[48:51], v11 offset:4096
 ds_read_b128 a[52:55], v11 offset:5120
 ds_read_b128 a[56:59], v11 offset:6144
 ds_read_b128 a[60:63], v11 offset:7168
 s_waitcnt vmcnt(12)
 v_cmp_eq_u32 vcc, 0, v24
 v_mov_b32 v17, 3
 v_or_b32 v6, s35, v7
 s_cbranch_vccnz L_f1s15
L_f1r15:
 s_mov_b32 s30, s93
 s_mov_b32 s29, s94
 s_cmp_eq_u32 s20, 0
 s_cselect_b32 s5, 5, 0
 v_mov_b32 v32, 0xc1800000
 v_mov_b32 v33, 0xc1800000
 v_mov_b32 v34, 0xc1800000
 v_mov_b32 v35, 0xc1800000
 v_mov_b32 v36, 0xc1800000
 v_mov_b32 v37, 0xc1800000
 v_mov_b32 v38, 0xc1800000
 v_mov_b32 v39, 0xc1800000
 s_waitcnt lgkmcnt(0)
M v[64:67], a[64:67], a[0:3], v[32:35]
 ds_read_b128 a[96:99], v2 offset:40960
 v_mov_b32 v30, 0
M v[64:67], a[68:71], a[4:7], v[64:67]
 s_add_u32 m0, s28, 65536
 ds_read_b128 a[100:103], v2 offset:41984
 v_mov_b32 v31, 0
M v[64:67], a[72:75], a[8:11], v[64:67]
 buffer_load_dwordx4 v3, s[8:11], s24 offen offset:0 sc1 lds
M v[64:67], a[76:79], a[12:15], v[64:67]
 ds_read_b128 a[104:107], v2 offset:43008
 v_accvgpr_write_b32 a128, v192
M v[64:67], a[80:83], a[16:19], v[64:67]
 ds_read_b128 a[108:111], v2 offset:44032
 v_accvgpr_write_b32 a129, v193
M v[64:67], a[84:87], a[20:23], v[64:67]
 buffer_load_dwordx4 v3, s[8:11], s24 offen offset:1024 sc1 lds
M v[64:67], a[88:91], a[24:27], v[64:67]
 ds_read_b128 a[112:115], v2 offset:45056
 v_accvgpr_write_b32 a130, v194
M v[64:67], a[92:95], a[28:31], v[64:67]
 ds_read_b128 a[116:119], v2 offset:46080
 v_accvgpr_write_b32 a131, v195
M v[68:71], a[92:95], a[60:63], v[36:39]
 v_accvgpr_write_b32 a132, v200
 v_accvgpr_write_b32 a133, v201
M v[68:71], a[88:91], a[56:59], v[68:71]
 ds_read_b128 a[120:123], v2 offset:47104
 v_accvgpr_write_b32 a134, v202
M v[68:71], a[84:87], a[52:55], v[68:71]
 ds_read_b128 a[124:127], v2 offset:48128
 v_accvgpr_write_b32 a135, v203
M v[68:71], a[80:83], a[48:51], v[68:71]
 buffer_load_dwordx4 v3, s[8:11], s24 offen offset:2048 sc1 lds
M v[68:71], a[76:79], a[44:47], v[68:71]
 v_accvgpr_write_b32 a136, v208
 v_accvgpr_write_b32 a137, v209
M v[68:71], a[72:75], a[40:43], v[68:71]
 v_accvgpr_write_b32 a138, v210
 v_accvgpr_write_b32 a139, v211
M v[68:71], a[68:71], a[36:39], v[68:71]
 v_exp_f32 v18, v64
M v[68:71], a[64:67], a[32:35], v[68:71]
 s_waitcnt lgkmcnt(0)
 v_exp_f32 v19, v65
M v[72:75], a[96:99], a[0:3], v[32:35]
 ds_read_b128 a[64:67], v2 offset:49152
 v_add_f32 v26, v18, v19
M v[72:75], a[100:103], a[4:7], v[72:75]
 ds_read_b128 a[68:71], v2 offset:50176
 v_cvt_pk_bf16_f32 v40, v18, v19
M v[72:75], a[104:107], a[8:11], v[72:75]
 buffer_load_dwordx4 v3, s[8:11], s24 offen offset:3072 sc1 lds
M v[72:75], a[108:111], a[12:15], v[72:75]
 ds_read_b128 a[72:75], v2 offset:51200
 v_accvgpr_write_b32 a140, v216
M v[72:75], a[112:115], a[16:19], v[72:75]
 s_add_u32 m0, s28, 69632
 ds_read_b128 a[76:79], v2 offset:52224
 v_accvgpr_write_b32 a141, v217
M v[72:75], a[116:119], a[20:23], v[72:75]
 buffer_load_dwordx4 v4, s[8:11], s24 offen offset:0 sc1 lds
M v[72:75], a[120:123], a[24:27], v[72:75]
 ds_read_b128 a[80:83], v2 offset:53248
 v_accvgpr_write_b32 a142, v218
M v[72:75], a[124:127], a[28:31], v[72:75]
 s_add_u32 s3, s32, 0
 ds_read_b128 a[84:87], v2 offset:54272
 v_accvgpr_write_b32 a143, v219
M v[76:79], a[124:127], a[60:63], v[36:39]
 buffer_store_dwordx4 a[0:3], v6, s[8:11], s3 offen offset:0 sc1
M v[76:79], a[120:123], a[56:59], v[76:79]
 ds_read_b128 a[88:91], v2 offset:55296
 v_accvgpr_write_b32 a144, v224
M v[76:79], a[116:119], a[52:55], v[76:79]
 ds_read_b128 a[92:95], v2 offset:56320
 v_accvgpr_write_b32 a145, v225
M v[76:79], a[112:115], a[48:51], v[76:79]
 buffer_load_dwordx4 v4, s[8:11], s24 offen offset:1024 sc1 lds
M v[76:79], a[108:111], a[44:47], v[76:79]
 v_exp_f32 v20, v66
M v[76:79], a[104:107], a[40:43], v[76:79]
 buffer_store_dwordx4 a[4:7], v6, s[8:11], s3 offen offset:1024 sc1
M v[76:79], a[100:103], a[36:39], v[76:79]
 v_exp_f32 v21, v67
M v[76:79], a[96:99], a[32:35], v[76:79]
 s_waitcnt lgkmcnt(0)
 v_exp_f32 v22, v68
M v[80:83], a[64:67], a[0:3], v[32:35]
 ds_read_b128 a[96:99], v2 offset:57344
 v_add_f32 v26, v20, v26
M v[80:83], a[68:71], a[4:7], v[80:83]
 ds_read_b128 a[100:103], v2 offset:58368
 v_cvt_pk_bf16_f32 v41, v20, v21
M v[80:83], a[72:75], a[8:11], v[80:83]
 buffer_load_dwordx4 v4, s[8:11], s24 offen offset:2048 sc1 lds
M v[80:83], a[76:79], a[12:15], v[80:83]
 ds_read_b128 a[104:107], v2 offset:59392
 v_add_f32 v26, v21, v26
M v[80:83], a[80:83], a[16:19], v[80:83]
 ds_read_b128 a[108:111], v2 offset:60416
 v_accvgpr_write_b32 a146, v226
M v[80:83], a[84:87], a[20:23], v[80:83]
 buffer_store_dwordx4 a[8:11], v6, s[8:11], s3 offen offset:2048 sc1
M v[80:83], a[88:91], a[24:27], v[80:83]
 ds_read_b128 a[112:115], v2 offset:61440
 v_accvgpr_write_b32 a147, v227
M v[80:83], a[92:95], a[28:31], v[80:83]
 ds_read_b128 a[116:119], v2 offset:62464
 v_accvgpr_write_b32 a148, v232
M v[84:87], a[92:95], a[60:63], v[36:39]
 buffer_load_dwordx4 v4, s[8:11], s24 offen offset:3072 sc1 lds
M v[84:87], a[88:91], a[56:59], v[84:87]
 ds_read_b128 a[120:123], v2 offset:63488
 v_accvgpr_write_b32 a149, v233
M v[84:87], a[84:87], a[52:55], v[84:87]
 ds_read_b128 a[124:127], v2 offset:64512
 v_accvgpr_write_b32 a150, v234
M v[84:87], a[80:83], a[48:51], v[84:87]
 buffer_store_dwordx4 a[12:15], v6, s[8:11], s3 offen offset:3072 sc1
M v[84:87], a[76:79], a[44:47], v[84:87]
 s_add_u32 s3, s32, 4096
 v_exp_f32 v23, v69
M v[84:87], a[72:75], a[40:43], v[84:87]
 buffer_store_dwordx4 a[16:19], v6, s[8:11], s3 offen offset:0 sc1
M v[84:87], a[68:71], a[36:39], v[84:87]
 s_waitcnt vmcnt(13) lgkmcnt(0)
 v_exp_f32 v24, v70
M v[84:87], a[64:67], a[32:35], v[84:87]
 s_barrier
M v[88:91], a[96:99], a[0:3], v[32:35]
 ds_read_b128 a[64:67], v7 offset:32768
 v_add_f32 v27, v22, v23
M v[88:91], a[100:103], a[4:7], v[88:91]
 ds_read_b128 a[68:71], v7 offset:33792
 v_cvt_pk_bf16_f32 v44, v22, v23
M v[88:91], a[104:107], a[8:11], v[88:91]
 buffer_store_dword v17, v1, s[8:11], s45 offen sc1
M v[88:91], a[108:111], a[12:15], v[88:91]
 ds_read_b128 a[72:75], v7 offset:34816
 v_accvgpr_write_b32 a151, v235
M v[88:91], a[112:115], a[16:19], v[88:91]
 ds_read_b128 a[76:79], v7 offset:35840
 v_accvgpr_write_b32 a152, v240
M v[88:91], a[116:119], a[20:23], v[88:91]
 buffer_store_dwordx4 a[20:23], v6, s[8:11], s3 offen offset:1024 sc1
M v[88:91], a[120:123], a[24:27], v[88:91]
 ds_read_b128 a[80:83], v7 offset:36864
 v_accvgpr_write_b32 a153, v241
M v[88:91], a[124:127], a[28:31], v[88:91]
 ds_read_b128 a[84:87], v7 offset:37888
 v_accvgpr_write_b32 a154, v242
M v[92:95], a[124:127], a[60:63], v[36:39]
 buffer_store_dwordx4 a[24:27], v6, s[8:11], s3 offen offset:2048 sc1
M v[92:95], a[120:123], a[56:59], v[92:95]
 ds_read_b128 a[88:91], v7 offset:38912
 v_accvgpr_write_b32 a155, v243
M v[92:95], a[116:119], a[52:55], v[92:95]
 ds_read_b128 a[92:95], v7 offset:39936
 v_accvgpr_write_b32 a156, v248
M v[92:95], a[112:115], a[48:51], v[92:95]
 buffer_store_dwordx4 a[28:31], v6, s[8:11], s3 offen offset:3072 sc1
M v[92:95], a[108:111], a[44:47], v[92:95]
 v_exp_f32 v25, v71
M v[92:95], a[104:107], a[40:43], v[92:95]
 v_exp_f32 v18, v72
M v[92:95], a[100:103], a[36:39], v[92:95]
 s_waitcnt lgkmcnt(0)
 v_exp_f32 v19, v73
M v[92:95], a[96:99], a[32:35], v[92:95]
 v_exp_f32 v20, v74
M v[96:99], a[64:67], a[0:3], v[32:35]
 s_add_u32 m0, s28, 98304
 ds_read_b128 a[96:99], v7 offset:40960
 ds_read_b128 a[100:103], v7 offset:41984
M v[96:99], a[68:71], a[4:7], v[96:99]
 buffer_load_dwordx4 v3, s[8:11], s21 offen offset:0 sc1 lds
M v[96:99], a[72:75], a[8:11], v[96:99]
 v_exp_f32 v21, v75
M v[96:99], a[76:79], a[12:15], v[96:99]
 s_add_u32 s3, s32, 8192
 ds_read_b128 a[104:107], v7 offset:43008
 ds_read_b128 a[108:111], v7 offset:44032
M v[96:99], a[80:83], a[16:19], v[96:99]
 buffer_store_dwordx4 a[32:35], v6, s[8:11], s3 offen offset:0 sc1
M v[96:99], a[84:87], a[20:23], v[96:99]
 v_exp_f32 v22, v76
M v[96:99], a[88:91], a[24:27], v[96:99]
 ds_read_b128 a[112:115], v7 offset:45056
 ds_read_b128 a[116:119], v7 offset:46080
M v[96:99], a[92:95], a[28:31], v[96:99]
 buffer_load_dwordx4 v3, s[8:11], s21 offen offset:1024 sc1 lds
M v[100:103], a[92:95], a[60:63], v[36:39]
 v_exp_f32 v23, v77
M v[100:103], a[88:91], a[56:59], v[100:103]
 ds_read_b128 a[120:123], v7 offset:47104
 ds_read_b128 a[124:127], v7 offset:48128
M v[100:103], a[84:87], a[52:55], v[100:103]
 buffer_store_dwordx4 a[36:39], v6, s[8:11], s3 offen offset:1024 sc1
M v[100:103], a[80:83], a[48:51], v[100:103]
 v_add_f32 v27, v24, v27
 v_cvt_pk_bf16_f32 v45, v24, v25
M v[100:103], a[76:79], a[44:47], v[100:103]
 buffer_load_dwordx4 v3, s[8:11], s21 offen offset:2048 sc1 lds
M v[100:103], a[72:75], a[40:43], v[100:103]
 v_add_f32 v27, v25, v27
 v_add_f32 v26, v18, v26
M v[100:103], a[68:71], a[36:39], v[100:103]
 v_exp_f32 v24, v78
M v[100:103], a[64:67], a[32:35], v[100:103]
 s_waitcnt lgkmcnt(0)
 v_exp_f32 v25, v79
M v[104:107], a[96:99], a[0:3], v[32:35]
 ds_read_b128 a[64:67], v7 offset:49152
 ds_read_b128 a[68:71], v7 offset:50176
M v[104:107], a[100:103], a[4:7], v[104:107]
 buffer_load_dwordx4 v3, s[8:11], s21 offen offset:3072 sc1 lds
M v[104:107], a[104:107], a[8:11], v[104:107]
 v_cvt_pk_bf16_f32 v42, v18, v19
 v_add_f32 v26, v19, v26
M v[104:107], a[108:111], a[12:15], v[104:107]
 ds_read_b128 a[72:75], v7 offset:51200
 ds_read_b128 a[76:79], v7 offset:52224
M v[104:107], a[112:115], a[16:19], v[104:107]
 buffer_store_dwordx4 a[40:43], v6, s[8:11], s3 offen offset:2048 sc1
M v[104:107], a[116:119], a[20:23], v[104:107]
 v_exp_f32 v18, v80
M v[104:107], a[120:123], a[24:27], v[104:107]
 s_add_u32 m0, s28, 102400
 ds_read_b128 a[80:83], v7 offset:53248
 ds_read_b128 a[84:87], v7 offset:54272
M v[104:107], a[124:127], a[28:31], v[104:107]
 buffer_load_dwordx4 v4, s[8:11], s21 offen offset:0 sc1 lds
M v[108:111], a[124:127], a[60:63], v[36:39]
 v_exp_f32 v19, v81
M v[108:111], a[120:123], a[56:59], v[108:111]
 ds_read_b128 a[88:91], v7 offset:55296
 ds_read_b128 a[92:95], v7 offset:56320
M v[108:111], a[116:119], a[52:55], v[108:111]
 buffer_store_dwordx4 a[44:47], v6, s[8:11], s3 offen offset:3072 sc1
M v[108:111], a[112:115], a[48:51], v[108:111]
 v_add_f32 v26, v20, v26
 v_cvt_pk_bf16_f32 v43, v20, v21
M v[108:111], a[108:111], a[44:47], v[108:111]
 buffer_load_dwordx4 v4, s[8:11], s21 offen offset:1024 sc1 lds
M v[108:111], a[104:107], a[40:43], v[108:111]
 s_add_u32 s3, s32, 12288
 v_add_f32 v26, v21, v26
 v_add_f32 v27, v22, v27
M v[108:111], a[100:103], a[36:39], v[108:111]
 buffer_store_dwordx4 a[48:51], v6, s[8:11], s3 offen offset:0 sc1
M v[108:111], a[96:99], a[32:35], v[108:111]
 s_waitcnt lgkmcnt(0)
 v_exp_f32 v20, v82
M v[112:115], a[64:67], a[0:3], v[32:35]
 ds_read_b128 a[96:99], v7 offset:57344
 ds_read_b128 a[100:103], v7 offset:58368
M v[112:115], a[68:71], a[4:7], v[112:115]
 buffer_load_dwordx4 v4, s[8:11], s21 offen offset:2048 sc1 lds
M v[112:115], a[72:75], a[8:11], v[112:115]
 v_exp_f32 v21, v83
M v[112:115], a[76:79], a[12:15], v[112:115]
 ds_read_b128 a[104:107], v7 offset:59392
 ds_read_b128 a[108:111], v7 offset:60416
M v[112:115], a[80:83], a[16:19], v[112:115]
 buffer_load_dwordx4 v4, s[8:11], s21 offen offset:3072 sc1 lds
M v[112:115], a[84:87], a[20:23], v[112:115]
 s_add_u32 s24, s23, 16777216
 v_cvt_pk_bf16_f32 v46, v22, v23
 v_add_f32 v27, v23, v27
M v[112:115], a[88:91], a[24:27], v[112:115]
 s_mov_b32 s23, s21
 ds_read_b128 a[112:115], v7 offset:61440
 ds_read_b128 a[116:119], v7 offset:62464
M v[112:115], a[92:95], a[28:31], v[112:115]
 buffer_store_dwordx4 a[52:55], v6, s[8:11], s3 offen offset:1024 sc1
M v[116:119], a[92:95], a[60:63], v[36:39]
 s_add_u32 s21, s21, 32768
 v_add_f32 v27, v24, v27
M v[116:119], a[88:91], a[56:59], v[116:119]
 s_add_u32 s22, s22, 1
 ds_read_b128 a[120:123], v7 offset:63488
 ds_read_b128 a[124:127], v7 offset:64512
M v[116:119], a[84:87], a[52:55], v[116:119]
 s_cmp_eq_u32 s22, s25
 v_exp_f32 v22, v88
M v[116:119], a[80:83], a[48:51], v[116:119]
 s_cselect_b32 s21, s26, s21
 v_exp_f32 v23, v89
M v[116:119], a[76:79], a[44:47], v[116:119]
 buffer_store_dwordx4 a[56:59], v6, s[8:11], s3 offen offset:2048 sc1
M v[116:119], a[72:75], a[40:43], v[116:119]
 s_cmp_eq_u32 s22, s43
 v_cvt_pk_bf16_f32 v47, v24, v25
 v_add_f32 v27, v25, v27
M v[116:119], a[68:71], a[36:39], v[116:119]
 s_waitcnt vmcnt(21) lgkmcnt(0)
 v_exp_f32 v24, v90
M v[116:119], a[64:67], a[32:35], v[116:119]
 s_barrier
M v[120:123], a[96:99], a[0:3], v[32:35]
 s_cselect_b32 s21, s4, s21
 ds_read_b128 a[64:67], v2 offset:0
 ds_read_b128 a[68:71], v2 offset:1024
M v[120:123], a[100:103], a[4:7], v[120:123]
 s_cmp_eq_u32 s22, s6
 v_exp_f32 v25, v91
M v[120:123], a[104:107], a[8:11], v[120:123]
 s_cselect_b32 s21, s7, s21
 v_add_f32 v26, v18, v26
 v_cvt_pk_bf16_f32 v56, v18, v19
M v[120:123], a[108:111], a[12:15], v[120:123]
 ds_read_b128 a[72:75], v2 offset:2048
 ds_read_b128 a[76:79], v2 offset:3072
M v[120:123], a[112:115], a[16:19], v[120:123]
 buffer_store_dwordx4 a[60:63], v6, s[8:11], s3 offen offset:3072 sc1
M v[120:123], a[116:119], a[20:23], v[120:123]
 v_add_f32 v26, v19, v26
 v_add_f32 v26, v20, v26
M v[120:123], a[120:123], a[24:27], v[120:123]
 ds_read_b128 a[80:83], v2 offset:4096
 ds_read_b128 a[84:87], v2 offset:5120
M v[120:123], a[124:127], a[28:31], v[120:123]
 v_exp_f32 v18, v84
M v[124:127], a[124:127], a[60:63], v[36:39]
 v_exp_f32 v19, v85
M v[124:127], a[120:123], a[56:59], v[124:127]
 ds_read_b128 a[88:91], v2 offset:6144
 ds_read_b128 a[92:95], v2 offset:7168
M v[124:127], a[116:119], a[52:55], v[124:127]
 v_cvt_pk_bf16_f32 v57, v20, v21
 v_add_f32 v26, v21, v26
M v[124:127], a[112:115], a[48:51], v[124:127]
 v_exp_f32 v20, v86
M v[124:127], a[108:111], a[44:47], v[124:127]
 v_exp_f32 v21, v87
M v[124:127], a[104:107], a[40:43], v[124:127]
 v_add_f32 v26, v22, v26
 v_cvt_pk_bf16_f32 v58, v22, v23
M v[124:127], a[100:103], a[36:39], v[124:127]
 s_waitcnt lgkmcnt(0)
 v_add_f32 v26, v23, v26
 v_add_f32 v26, v24, v26
M v[124:127], a[96:99], a[32:35], v[124:127]
 v_exp_f32 v22, v92
 v_cvt_pk_bf16_f32 v59, v24, v25
 v_add_f32 v26, v25, v26
 v_add_f32 v27, v18, v27
 v_cvt_pk_bf16_f32 v60, v18, v19
 v_add_f32 v27, v19, v27
 v_exp_f32 v23, v93
 v_add_f32 v27, v20, v27
 v_cvt_pk_bf16_f32 v61, v20, v21
 v_add_f32 v27, v21, v27
 v_exp_f32 v24, v94
 v_add_f32 v27, v22, v27
 v_cvt_pk_bf16_f32 v62, v22, v23
 v_exp_f32 v25, v95
 v_add_f32 v27, v23, v27
 v_add_f32 v27, v24, v27
 v_cvt_pk_bf16_f32 v63, v24, v25
 v_add_f32 v27, v25, v27
 v_max_f32 v10, v26, v27
 v_min_f32 v11, v26, v27
 v_cmp_lt_f32 s[36:37], s31, v10
 v_cmp_gt_f32 vcc, s55, v11
 s_nop 0
 s_or_b64 vcc, vcc, s[36:37]
 s_cbranch_vccnz L_st8
L_rt8:
M v[128:131], a[64:67], v[40:43], 0
 s_add_u32 m0, s28, 0
 ds_read_b128 a[96:99], v2 offset:8192
 ds_read_b128 a[100:103], v2 offset:9216
M v[128:131], a[68:71], v[56:59], v[128:131]
 buffer_load_dwordx4 v3, s[8:11], s24 offen offset:0 sc1 lds
M v[132:135], a[68:71], v[60:63], 0
 v_accvgpr_write_b32 a157, v249
 v_accvgpr_write_b32 a158, v250
M v[132:135], a[64:67], v[44:47], v[132:135]
 ds_read_b128 a[104:107], v2 offset:10240
 ds_read_b128 a[108:111], v2 offset:11264
M v[136:139], a[72:75], v[40:43], 0
 buffer_load_dwordx4 v3, s[8:11], s24 offen offset:1024 sc1 lds
M v[136:139], a[76:79], v[56:59], v[136:139]
 v_accvgpr_write_b32 a159, v251
 v_add_f32 v30, v26, v30
M v[140:143], a[76:79], v[60:63], 0
 ds_read_b128 a[112:115], v2 offset:12288
 ds_read_b128 a[116:119], v2 offset:13312
M v[140:143], a[72:75], v[44:47], v[140:143]
 buffer_load_dwordx4 v3, s[8:11], s24 offen offset:2048 sc1 lds
M v[144:147], a[80:83], v[40:43], 0
 v_exp_f32 v18, v96
M v[144:147], a[84:87], v[56:59], v[144:147]
 ds_read_b128 a[120:123], v2 offset:14336
 ds_read_b128 a[124:127], v2 offset:15360
M v[148:151], a[84:87], v[60:63], 0
 buffer_load_dwordx4 v3, s[8:11], s24 offen offset:3072 sc1 lds
M v[148:151], a[80:83], v[44:47], v[148:151]
 s_add_u32 m0, s28, 4096
 v_exp_f32 v19, v97
M v[152:155], a[88:91], v[40:43], 0
 buffer_load_dwordx4 v4, s[8:11], s24 offen offset:0 sc1 lds
M v[152:155], a[92:95], v[56:59], v[152:155]
 v_exp_f32 v20, v98
M v[156:159], a[92:95], v[60:63], 0
 v_exp_f32 v21, v99
M v[156:159], a[88:91], v[44:47], v[156:159]
 s_waitcnt lgkmcnt(0)
 v_exp_f32 v22, v104
M v[160:163], a[96:99], v[40:43], 0
 ds_read_b128 a[64:67], v2 offset:16384
 ds_read_b128 a[68:71], v2 offset:17408
M v[160:163], a[100:103], v[56:59], v[160:163]
 buffer_load_dwordx4 v4, s[8:11], s24 offen offset:1024 sc1 lds
M v[164:167], a[100:103], v[60:63], 0
 v_exp_f32 v23, v105
M v[164:167], a[96:99], v[44:47], v[164:167]
 ds_read_b128 a[72:75], v2 offset:18432
 ds_read_b128 a[76:79], v2 offset:19456
M v[168:171], a[104:107], v[40:43], 0
 buffer_load_dwordx4 v4, s[8:11], s24 offen offset:2048 sc1 lds
M v[168:171], a[108:111], v[56:59], v[168:171]
 v_add_f32 v31, v27, v31
 v_add_f32 v28, v18, v19
M v[172:175], a[108:111], v[60:63], 0
 ds_read_b128 a[80:83], v2 offset:20480
 ds_read_b128 a[84:87], v2 offset:21504
M v[172:175], a[104:107], v[44:47], v[172:175]
 buffer_load_dwordx4 v4, s[8:11], s24 offen offset:3072 sc1 lds
M v[176:179], a[112:115], v[40:43], 0
 v_exp_f32 v24, v106
M v[176:179], a[116:119], v[56:59], v[176:179]
 s_add_u32 m0, s28, 32768
 ds_read_b128 a[88:91], v2 offset:22528
 ds_read_b128 a[92:95], v2 offset:23552
M v[180:183], a[116:119], v[60:63], 0
 buffer_load_dwordx4 v3, s[8:11], s21 offen offset:0 sc1 lds
M v[180:183], a[112:115], v[44:47], v[180:183]
 v_exp_f32 v25, v107
M v[184:187], a[120:123], v[40:43], 0
 buffer_load_dwordx4 v3, s[8:11], s21 offen offset:1024 sc1 lds
M v[184:187], a[124:127], v[56:59], v[184:187]
 v_cvt_pk_bf16_f32 v48, v18, v19
 v_add_f32 v28, v20, v28
M v[188:191], a[124:127], v[60:63], 0
 buffer_load_dwordx4 v3, s[8:11], s21 offen offset:2048 sc1 lds
M v[188:191], a[120:123], v[44:47], v[188:191]
 s_waitcnt lgkmcnt(0)
 v_exp_f32 v18, v100
M v[192:195], a[64:67], v[40:43], 0
 ds_read_b128 a[96:99], v2 offset:24576
 ds_read_b128 a[100:103], v2 offset:25600
M v[192:195], a[68:71], v[56:59], v[192:195]
 buffer_load_dwordx4 v3, s[8:11], s21 offen offset:3072 sc1 lds
M v[196:199], a[68:71], v[60:63], 0
 v_exp_f32 v19, v101
M v[196:199], a[64:67], v[44:47], v[196:199]
 s_add_u32 m0, s28, 36864
 ds_read_b128 a[104:107], v2 offset:26624
 ds_read_b128 a[108:111], v2 offset:27648
M v[200:203], a[72:75], v[40:43], 0
 buffer_load_dwordx4 v4, s[8:11], s21 offen offset:0 sc1 lds
M v[200:203], a[76:79], v[56:59], v[200:203]
 v_cvt_pk_bf16_f32 v49, v20, v21
 v_add_f32 v28, v21, v28
M v[204:207], a[76:79], v[60:63], 0
 ds_read_b128 a[112:115], v2 offset:28672
 ds_read_b128 a[116:119], v2 offset:29696
M v[204:207], a[72:75], v[44:47], v[204:207]
 buffer_load_dwordx4 v4, s[8:11], s21 offen offset:1024 sc1 lds
M v[208:211], a[80:83], v[40:43], 0
 v_exp_f32 v20, v102
M v[208:211], a[84:87], v[56:59], v[208:211]
 ds_read_b128 a[120:123], v2 offset:30720
 ds_read_b128 a[124:127], v2 offset:31744
M v[212:215], a[84:87], v[60:63], 0
 buffer_load_dwordx4 v4, s[8:11], s21 offen offset:2048 sc1 lds
M v[212:215], a[80:83], v[44:47], v[212:215]
 v_exp_f32 v21, v103
M v[216:219], a[88:91], v[40:43], 0
 v_add_f32 v28, v22, v28
 v_cvt_pk_bf16_f32 v50, v22, v23
M v[216:219], a[92:95], v[56:59], v[216:219]
 buffer_load_dwordx4 v4, s[8:11], s21 offen offset:3072 sc1 lds
M v[220:223], a[92:95], v[60:63], 0
 s_waitcnt vmcnt(16) lgkmcnt(0)
 s_add_u32 s24, s23, 16777216
 s_mov_b32 s23, s21
M v[220:223], a[88:91], v[44:47], v[220:223]
 s_barrier
M v[224:227], a[96:99], v[40:43], 0
 ds_read_b128 a[64:67], v2 offset:32768
 ds_read_b128 a[68:71], v2 offset:33792
M v[224:227], a[100:103], v[56:59], v[224:227]
 s_xor_b32 s3, s47, 64
 v_mov_b32 v5, 1
M v[228:231], a[100:103], v[60:63], 0
 v_or_b32 v6, s35, v1
 s_add_u32 s21, s21, 32768
M v[228:231], a[96:99], v[44:47], v[228:231]
 s_add_u32 s22, s22, 1
 ds_read_b128 a[72:75], v2 offset:34816
 ds_read_b128 a[76:79], v2 offset:35840
M v[232:235], a[104:107], v[40:43], 0
 buffer_store_dword v5, v6, s[8:11], s3 offen sc1
M v[232:235], a[108:111], v[56:59], v[232:235]
 s_cmp_eq_u32 s22, s25
 v_add_f32 v28, v23, v28
 v_add_f32 v28, v24, v28
M v[236:239], a[108:111], v[60:63], 0
 s_cselect_b32 s21, s26, s21
 ds_read_b128 a[80:83], v2 offset:36864
 ds_read_b128 a[84:87], v2 offset:37888
M v[236:239], a[104:107], v[44:47], v[236:239]
 s_cmp_eq_u32 s22, s43
 v_exp_f32 v22, v108
M v[240:243], a[112:115], v[40:43], 0
 s_cselect_b32 s21, s4, s21
 v_exp_f32 v23, v109
M v[240:243], a[116:119], v[56:59], v[240:243]
 s_cmp_eq_u32 s22, s6
 ds_read_b128 a[88:91], v2 offset:38912
 ds_read_b128 a[92:95], v2 offset:39936
M v[244:247], a[116:119], v[60:63], 0
 s_cselect_b32 s21, s7, s21
 v_cvt_pk_bf16_f32 v51, v24, v25
 v_add_f32 v28, v25, v28
M v[244:247], a[112:115], v[44:47], v[244:247]
 v_exp_f32 v24, v110
M v[248:251], a[120:123], v[40:43], 0
 v_exp_f32 v25, v111
M v[248:251], a[124:127], v[56:59], v[248:251]
 v_add_f32 v29, v18, v19
 v_cvt_pk_bf16_f32 v52, v18, v19
M v[252:255], a[124:127], v[60:63], 0
 s_waitcnt lgkmcnt(0)
 v_add_f32 v29, v20, v29
 v_cvt_pk_bf16_f32 v53, v20, v21
M v[252:255], a[120:123], v[44:47], v[252:255]
 v_add_f32 v29, v21, v29
 v_add_f32 v29, v22, v29
 v_cvt_pk_bf16_f32 v54, v22, v23
 v_add_f32 v29, v23, v29
 v_add_f32 v29, v24, v29
 v_cvt_pk_bf16_f32 v55, v24, v25
 v_add_f32 v29, v25, v29
M v[64:67], a[64:67], a[0:3], v[32:35]
 s_add_u32 m0, s28, 65536
 ds_read_b128 a[96:99], v2 offset:40960
 ds_read_b128 a[100:103], v2 offset:41984
M v[64:67], a[68:71], a[4:7], v[64:67]
 buffer_load_dwordx4 v3, s[8:11], s24 offen offset:0 sc1 lds
M v[64:67], a[72:75], a[8:11], v[64:67]
 v_exp_f32 v18, v112
M v[64:67], a[76:79], a[12:15], v[64:67]
 s_add_u32 s3, s30, 786432
 ds_read_b128 a[104:107], v2 offset:43008
 ds_read_b128 a[108:111], v2 offset:44032
M v[64:67], a[80:83], a[16:19], v[64:67]
 buffer_store_dwordx4 a[128:131], v7, s[8:11], s3 offen offset:0 sc1
M v[64:67], a[84:87], a[20:23], v[64:67]
 v_exp_f32 v19, v113
M v[64:67], a[88:91], a[24:27], v[64:67]
 ds_read_b128 a[112:115], v2 offset:45056
 ds_read_b128 a[116:119], v2 offset:46080
M v[64:67], a[92:95], a[28:31], v[64:67]
 buffer_load_dwordx4 v3, s[8:11], s24 offen offset:1024 sc1 lds
M v[68:71], a[92:95], a[60:63], v[36:39]
 v_exp_f32 v20, v114
M v[68:71], a[88:91], a[56:59], v[68:71]
 ds_read_b128 a[120:123], v2 offset:47104
 ds_read_b128 a[124:127], v2 offset:48128
M v[68:71], a[84:87], a[52:55], v[68:71]
 v_exp_f32 v21, v115
M v[68:71], a[80:83], a[48:51], v[68:71]
 v_add_f32 v28, v18, v28
 v_cvt_pk_bf16_f32 v56, v18, v19
M v[68:71], a[76:79], a[44:47], v[68:71]
 v_add_f32 v28, v19, v28
 v_add_f32 v28, v20, v28
M v[68:71], a[72:75], a[40:43], v[68:71]
 buffer_load_dwordx4 v3, s[8:11], s24 offen offset:2048 sc1 lds
M v[68:71], a[68:71], a[36:39], v[68:71]
 v_exp_f32 v22, v120
M v[68:71], a[64:67], a[32:35], v[68:71]
 s_waitcnt lgkmcnt(0)
 v_cvt_pk_bf16_f32 v57, v20, v21
 v_add_f32 v28, v21, v28
M v[72:75], a[96:99], a[0:3], v[32:35]
 ds_read_b128 a[64:67], v2 offset:49152
 ds_read_b128 a[68:71], v2 offset:50176
M v[72:75], a[100:103], a[4:7], v[72:75]
 buffer_store_dwordx4 a[132:135], v7, s[8:11], s3 offen offset:1024 sc1
M v[72:75], a[104:107], a[8:11], v[72:75]
 v_exp_f32 v23, v121
M v[72:75], a[108:111], a[12:15], v[72:75]
 ds_read_b128 a[72:75], v2 offset:51200
 ds_read_b128 a[76:79], v2 offset:52224
M v[72:75], a[112:115], a[16:19], v[72:75]
 buffer_load_dwordx4 v3, s[8:11], s24 offen offset:3072 sc1 lds
M v[72:75], a[116:119], a[20:23], v[72:75]
 v_exp_f32 v24, v122
M v[72:75], a[120:123], a[24:27], v[72:75]
 ds_read_b128 a[80:83], v2 offset:53248
 ds_read_b128 a[84:87], v2 offset:54272
M v[72:75], a[124:127], a[28:31], v[72:75]
 v_add_f32 v28, v22, v28
 v_cvt_pk_bf16_f32 v58, v22, v23
M v[76:79], a[124:127], a[60:63], v[36:39]
 v_exp_f32 v25, v123
M v[76:79], a[120:123], a[56:59], v[76:79]
 s_add_u32 m0, s28, 69632
 ds_read_b128 a[88:91], v2 offset:55296
 ds_read_b128 a[92:95], v2 offset:56320
M v[76:79], a[116:119], a[52:55], v[76:79]
 buffer_load_dwordx4 v4, s[8:11], s24 offen offset:0 sc1 lds
M v[76:79], a[112:115], a[48:51], v[76:79]
 v_add_f32 v28, v23, v28
 v_add_f32 v28, v24, v28
M v[76:79], a[108:111], a[44:47], v[76:79]
 v_exp_f32 v18, v116
M v[76:79], a[104:107], a[40:43], v[76:79]
 v_cvt_pk_bf16_f32 v59, v24, v25
 v_add_f32 v28, v25, v28
M v[76:79], a[100:103], a[36:39], v[76:79]
M v[76:79], a[96:99], a[32:35], v[76:79]
 s_waitcnt lgkmcnt(0)
 v_exp_f32 v19, v117
M v[80:83], a[64:67], a[0:3], v[32:35]
 ds_read_b128 a[96:99], v2 offset:57344
 ds_read_b128 a[100:103], v2 offset:58368
M v[80:83], a[68:71], a[4:7], v[80:83]
 buffer_store_dwordx4 a[136:139], v7, s[8:11], s3 offen offset:2048 sc1
M v[80:83], a[72:75], a[8:11], v[80:83]
 v_add_f32 v29, v18, v29
 v_cvt_pk_bf16_f32 v60, v18, v19
M v[80:83], a[76:79], a[12:15], v[80:83]
 ds_read_b128 a[104:107], v2 offset:59392
 ds_read_b128 a[108:111], v2 offset:60416
M v[80:83], a[80:83], a[16:19], v[80:83]
 buffer_load_dwordx4 v4, s[8:11], s24 offen offset:1024 sc1 lds
M v[80:83], a[84:87], a[20:23], v[80:83]
 v_exp_f32 v20, v118
M v[80:83], a[88:91], a[24:27], v[80:83]
 ds_read_b128 a[112:115], v2 offset:61440
 ds_read_b128 a[116:119], v2 offset:62464
M v[80:83], a[92:95], a[28:31], v[80:83]
 buffer_load_dwordx4 v4, s[8:11], s24 offen offset:2048 sc1 lds
M v[84:87], a[92:95], a[60:63], v[36:39]
 v_exp_f32 v21, v119
M v[84:87], a[88:91], a[56:59], v[84:87]
 ds_read_b128 a[120:123], v2 offset:63488
 ds_read_b128 a[124:127], v2 offset:64512
M v[84:87], a[84:87], a[52:55], v[84:87]
 v_exp_f32 v22, v124
M v[84:87], a[80:83], a[48:51], v[84:87]
 buffer_load_dwordx4 v4, s[8:11], s24 offen offset:3072 sc1 lds
M v[84:87], a[76:79], a[44:47], v[84:87]
 v_add_f32 v29, v19, v29
 v_add_f32 v29, v20, v29
M v[84:87], a[72:75], a[40:43], v[84:87]
 buffer_store_dwordx4 a[140:143], v7, s[8:11], s3 offen offset:3072 sc1
M v[84:87], a[68:71], a[36:39], v[84:87]
 s_waitcnt vmcnt(21) lgkmcnt(0)
 v_exp_f32 v23, v125
M v[84:87], a[64:67], a[32:35], v[84:87]
 s_barrier
M v[88:91], a[96:99], a[0:3], v[32:35]
 ds_read_b128 a[64:67], v7 offset:0
 ds_read_b128 a[68:71], v7 offset:1024
M v[88:91], a[100:103], a[4:7], v[88:91]
 v_exp_f32 v24, v126
M v[88:91], a[104:107], a[8:11], v[88:91]
 v_cvt_pk_bf16_f32 v61, v20, v21
 v_add_f32 v29, v21, v29
M v[88:91], a[108:111], a[12:15], v[88:91]
 ds_read_b128 a[72:75], v7 offset:2048
 ds_read_b128 a[76:79], v7 offset:3072
M v[88:91], a[112:115], a[16:19], v[88:91]
 v_exp_f32 v25, v127
M v[88:91], a[116:119], a[20:23], v[88:91]
 v_add_f32 v29, v22, v29
 v_cvt_pk_bf16_f32 v62, v22, v23
M v[88:91], a[120:123], a[24:27], v[88:91]
 ds_read_b128 a[80:83], v7 offset:4096
 ds_read_b128 a[84:87], v7 offset:5120
M v[88:91], a[124:127], a[28:31], v[88:91]
 v_add_f32 v29, v23, v29
 v_add_f32 v29, v24, v29
M v[92:95], a[124:127], a[60:63], v[36:39]
 v_cvt_pk_bf16_f32 v63, v24, v25
 v_add_f32 v29, v25, v29
M v[92:95], a[120:123], a[56:59], v[92:95]
 ds_read_b128 a[88:91], v7 offset:6144
 ds_read_b128 a[92:95], v7 offset:7168
M v[92:95], a[116:119], a[52:55], v[92:95]
 v_max_f32 v10, v28, v29
M v[92:95], a[112:115], a[48:51], v[92:95]
 v_cmp_lt_f32 vcc, s31, v10
M v[92:95], a[108:111], a[44:47], v[92:95]
M v[92:95], a[104:107], a[40:43], v[92:95]
M v[92:95], a[100:103], a[36:39], v[92:95]
 s_waitcnt lgkmcnt(0)
M v[92:95], a[96:99], a[32:35], v[92:95]
 s_cbranch_vccnz L_st9
L_rt9:
M v[128:131], a[64:67], v[48:51], v[128:131]
 s_add_u32 m0, s28, 98304
 ds_read_b128 a[96:99], v7 offset:8192
 ds_read_b128 a[100:103], v7 offset:9216
M v[128:131], a[68:71], v[56:59], v[128:131]
 buffer_load_dwordx4 v3, s[8:11], s21 offen offset:0 sc1 lds
M v[132:135], a[68:71], v[60:63], v[132:135]
 v_exp_f32 v18, v64
M v[132:135], a[64:67], v[52:55], v[132:135]
 s_add_u32 s3, s30, 794624
 ds_read_b128 a[104:107], v7 offset:10240
 ds_read_b128 a[108:111], v7 offset:11264
M v[136:139], a[72:75], v[48:51], v[136:139]
 buffer_store_dwordx4 a[144:147], v7, s[8:11], s3 offen offset:0 sc1
M v[136:139], a[76:79], v[56:59], v[136:139]
 v_exp_f32 v19, v65
M v[140:143], a[76:79], v[60:63], v[140:143]
 ds_read_b128 a[112:115], v7 offset:12288
 ds_read_b128 a[116:119], v7 offset:13312
M v[140:143], a[72:75], v[52:55], v[140:143]
 buffer_load_dwordx4 v3, s[8:11], s21 offen offset:1024 sc1 lds
M v[144:147], a[80:83], v[48:51], v[144:147]
 v_exp_f32 v20, v66
M v[144:147], a[84:87], v[56:59], v[144:147]
 ds_read_b128 a[120:123], v7 offset:14336
 ds_read_b128 a[124:127], v7 offset:15360
M v[148:151], a[84:87], v[60:63], v[148:151]
 v_add_f32 v30, v28, v30
 v_add_f32 v31, v29, v31
M v[148:151], a[80:83], v[52:55], v[148:151]
 buffer_load_dwordx4 v3, s[8:11], s21 offen offset:2048 sc1 lds
M v[152:155], a[88:91], v[48:51], v[152:155]
 v_exp_f32 v21, v67
M v[152:155], a[92:95], v[56:59], v[152:155]
 v_add_f32 v26, v18, v19
 v_cvt_pk_bf16_f32 v40, v18, v19
M v[156:159], a[92:95], v[60:63], v[156:159]
 v_exp_f32 v22, v72
M v[156:159], a[88:91], v[52:55], v[156:159]
 s_waitcnt lgkmcnt(0)
 v_add_f32 v26, v20, v26
 v_cvt_pk_bf16_f32 v41, v20, v21
M v[160:163], a[96:99], v[48:51], v[160:163]
 ds_read_b128 a[64:67], v7 offset:16384
 ds_read_b128 a[68:71], v7 offset:17408
M v[160:163], a[100:103], v[56:59], v[160:163]
 buffer_store_dwordx4 a[148:151], v7, s[8:11], s3 offen offset:1024 sc1
M v[164:167], a[100:103], v[60:63], v[164:167]
 v_exp_f32 v23, v73
M v[164:167], a[96:99], v[52:55], v[164:167]
 ds_read_b128 a[72:75], v7 offset:18432
 ds_read_b128 a[76:79], v7 offset:19456
M v[168:171], a[104:107], v[48:51], v[168:171]
 buffer_load_dwordx4 v3, s[8:11], s21 offen offset:3072 sc1 lds
M v[168:171], a[108:111], v[56:59], v[168:171]
 v_add_f32 v26, v21, v26
 v_add_f32 v26, v22, v26
M v[172:175], a[108:111], v[60:63], v[172:175]
 s_add_u32 m0, s28, 102400
 ds_read_b128 a[80:83], v7 offset:20480
 ds_read_b128 a[84:87], v7 offset:21504
M v[172:175], a[104:107], v[52:55], v[172:175]
 buffer_load_dwordx4 v4, s[8:11], s21 offen offset:0 sc1 lds
M v[176:179], a[112:115], v[48:51], v[176:179]
 v_exp_f32 v24, v74
M v[176:179], a[116:119], v[56:59], v[176:179]
 ds_read_b128 a[88:91], v7 offset:22528
 ds_read_b128 a[92:95], v7 offset:23552
M v[180:183], a[116:119], v[60:63], v[180:183]
 v_exp_f32 v25, v75
M v[180:183], a[112:115], v[52:55], v[180:183]
 buffer_load_dwordx4 v4, s[8:11], s21 offen offset:1024 sc1 lds
M v[184:187], a[120:123], v[48:51], v[184:187]
 v_cvt_pk_bf16_f32 v42, v22, v23
 v_add_f32 v26, v23, v26
M v[184:187], a[124:127], v[56:59], v[184:187]
 v_exp_f32 v18, v68
M v[188:191], a[124:127], v[60:63], v[188:191]
 v_add_f32 v26, v24, v26
 v_cvt_pk_bf16_f32 v43, v24, v25
M v[188:191], a[120:123], v[52:55], v[188:191]
 s_waitcnt lgkmcnt(0)
 v_add_f32 v26, v25, v26
M v[192:195], a[64:67], v[48:51], v[192:195]
 ds_read_b128 a[96:99], v7 offset:24576
 ds_read_b128 a[100:103], v7 offset:25600
M v[192:195], a[68:71], v[56:59], v[192:195]
 buffer_store_dwordx4 a[152:155], v7, s[8:11], s3 offen offset:2048 sc1
M v[196:199], a[68:71], v[60:63], v[196:199]
 v_exp_f32 v19, v69
M v[196:199], a[64:67], v[52:55], v[196:199]
 ds_read_b128 a[104:107], v7 offset:26624
 ds_read_b128 a[108:111], v7 offset:27648
M v[200:203], a[72:75], v[48:51], v[200:203]
 buffer_load_dwordx4 v4, s[8:11], s21 offen offset:2048 sc1 lds
M v[200:203], a[76:79], v[56:59], v[200:203]
 v_exp_f32 v20, v70
M v[204:207], a[76:79], v[60:63], v[204:207]
 ds_read_b128 a[112:115], v7 offset:28672
 ds_read_b128 a[116:119], v7 offset:29696
M v[204:207], a[72:75], v[52:55], v[204:207]
 buffer_load_dwordx4 v4, s[8:11], s21 offen offset:3072 sc1 lds
M v[208:211], a[80:83], v[48:51], v[208:211]
 s_add_u32 s24, s23, 16777216
 v_exp_f32 v21, v71
M v[208:211], a[84:87], v[56:59], v[208:211]
 s_mov_b32 s23, s21
 ds_read_b128 a[120:123], v7 offset:30720
 ds_read_b128 a[124:127], v7 offset:31744
M v[212:215], a[84:87], v[60:63], v[212:215]
 s_add_u32 s21, s21, 32768
 v_add_f32 v27, v18, v19
 v_cvt_pk_bf16_f32 v44, v18, v19
M v[212:215], a[80:83], v[52:55], v[212:215]
 s_add_u32 s22, s22, 1
 v_add_f32 v27, v20, v27
 v_cvt_pk_bf16_f32 v45, v20, v21
M v[216:219], a[88:91], v[48:51], v[216:219]
 s_cmp_eq_u32 s22, s25
 v_exp_f32 v22, v76
M v[216:219], a[92:95], v[56:59], v[216:219]
 buffer_store_dwordx4 a[156:159], v7, s[8:11], s3 offen offset:3072 sc1
M v[220:223], a[92:95], v[60:63], v[220:223]
 s_waitcnt vmcnt(25) lgkmcnt(0)
 v_add_f32 v27, v21, v27
M v[220:223], a[88:91], v[52:55], v[220:223]
 s_barrier
M v[224:227], a[96:99], v[48:51], v[224:227]
 s_cselect_b32 s21, s26, s21
 ds_read_b128 a[64:67], v7 offset:32768
 ds_read_b128 a[68:71], v7 offset:33792
M v[224:227], a[100:103], v[56:59], v[224:227]
 s_cmp_eq_u32 s22, s43
 v_exp_f32 v23, v77
M v[228:231], a[100:103], v[60:63], v[228:231]
 s_cselect_b32 s21, s4, s21
 v_add_f32 v27, v22, v27
 v_cvt_pk_bf16_f32 v46, v22, v23
M v[228:231], a[96:99], v[52:55], v[228:231]
 s_cmp_eq_u32 s22, s6
 ds_read_b128 a[72:75], v7 offset:34816
 ds_read_b128 a[76:79], v7 offset:35840
M v[232:235], a[104:107], v[48:51], v[232:235]
 s_cselect_b32 s21, s7, s21
 v_exp_f32 v24, v78
M v[232:235], a[108:111], v[56:59], v[232:235]
 v_add_f32 v27, v23, v27
M v[236:239], a[108:111], v[60:63], v[236:239]
 ds_read_b128 a[80:83], v7 offset:36864
 ds_read_b128 a[84:87], v7 offset:37888
M v[236:239], a[104:107], v[52:55], v[236:239]
 v_exp_f32 v25, v79
M v[240:243], a[112:115], v[48:51], v[240:243]
 v_add_f32 v27, v24, v27
 v_cvt_pk_bf16_f32 v47, v24, v25
M v[240:243], a[116:119], v[56:59], v[240:243]
 ds_read_b128 a[88:91], v7 offset:38912
 ds_read_b128 a[92:95], v7 offset:39936
M v[244:247], a[116:119], v[60:63], v[244:247]
 v_add_f32 v27, v25, v27
M v[244:247], a[112:115], v[52:55], v[244:247]
M v[248:251], a[120:123], v[48:51], v[248:251]
M v[248:251], a[124:127], v[56:59], v[248:251]
M v[252:255], a[124:127], v[60:63], v[252:255]
 s_waitcnt lgkmcnt(0)
M v[252:255], a[120:123], v[52:55], v[252:255]
M v[96:99], a[64:67], a[0:3], v[32:35]
 s_add_u32 m0, s28, 0
 ds_read_b128 a[96:99], v7 offset:40960
M v[96:99], a[68:71], a[4:7], v[96:99]
 ds_read_b128 a[100:103], v7 offset:41984
M v[96:99], a[72:75], a[8:11], v[96:99]
 buffer_load_dword v6, v9, s[8:11], s46 offen sc1
M v[96:99], a[76:79], a[12:15], v[96:99]
 s_cmp_eq_u32 s20, 0
 ds_read_b128 a[104:107], v7 offset:43008
M v[96:99], a[80:83], a[16:19], v[96:99]
 s_cselect_b64 s[64:65], s[16:17], 0
 ds_read_b128 a[108:111], v7 offset:44032
M v[96:99], a[84:87], a[20:23], v[96:99]
 buffer_load_dwordx4 v3, s[8:11], s24 offen offset:0 sc1 lds
M v[96:99], a[88:91], a[24:27], v[96:99]
 s_cselect_b64 s[66:67], s[18:19], 0
 ds_read_b128 a[112:115], v7 offset:45056
M v[96:99], a[92:95], a[28:31], v[96:99]
 s_cselect_b64 s[68:69], s[48:49], 0
 ds_read_b128 a[116:119], v7 offset:46080
M v[100:103], a[92:95], a[60:63], v[36:39]
 buffer_load_dwordx4 v3, s[8:11], s24 offen offset:1024 sc1 lds
M v[100:103], a[88:91], a[56:59], v[100:103]
 s_cselect_b64 s[70:71], s[50:51], 0
 ds_read_b128 a[120:123], v7 offset:47104
M v[100:103], a[84:87], a[52:55], v[100:103]
 s_cmp_lt_u32 s20, 1
 ds_read_b128 a[124:127], v7 offset:48128
M v[100:103], a[80:83], a[48:51], v[100:103]
 s_cselect_b64 s[78:79], -1, 0
 v_exp_f32 v18, v80
M v[100:103], a[76:79], a[44:47], v[100:103]
 buffer_load_dwordx4 v3, s[8:11], s24 offen offset:2048 sc1 lds
M v[100:103], a[72:75], a[40:43], v[100:103]
 s_cmp_eq_u32 s20, 1
 v_exp_f32 v19, v81
M v[100:103], a[68:71], a[36:39], v[100:103]
 s_cselect_b64 s[72:73], s[16:17], s[78:79]
 v_exp_f32 v20, v82
M v[100:103], a[64:67], a[32:35], v[100:103]
 s_waitcnt lgkmcnt(0)
 v_exp_f32 v21, v83
M v[104:107], a[96:99], a[0:3], v[32:35]
 s_cselect_b64 s[74:75], s[18:19], s[78:79]
 ds_read_b128 a[64:67], v7 offset:49152
 v_add_f32 v26, v18, v26
M v[104:107], a[100:103], a[4:7], v[104:107]
 s_cselect_b64 s[76:77], s[48:49], s[78:79]
 ds_read_b128 a[68:71], v7 offset:50176
 v_cvt_pk_bf16_f32 v56, v18, v19
M v[104:107], a[104:107], a[8:11], v[104:107]
 buffer_load_dwordx4 v3, s[8:11], s24 offen offset:3072 sc1 lds
M v[104:107], a[108:111], a[12:15], v[104:107]
 s_cselect_b64 s[78:79], s[50:51], s[78:79]
 ds_read_b128 a[72:75], v7 offset:51200
 v_add_f32 v26, v19, v26
M v[104:107], a[112:115], a[16:19], v[104:107]
 s_add_u32 s3, s29, 0
 ds_read_b128 a[76:79], v7 offset:52224
 v_add_f32 v26, v20, v26
M v[104:107], a[116:119], a[20:23], v[104:107]
 buffer_store_dwordx4 a[192:195], v7, s[8:11], s3 offen sc1
M v[104:107], a[120:123], a[24:27], v[104:107]
 s_add_u32 m0, s28, 4096
 ds_read_b128 a[80:83], v7 offset:53248
 v_cvt_pk_bf16_f32 v57, v20, v21
M v[104:107], a[124:127], a[28:31], v[104:107]
 ds_read_b128 a[84:87], v7 offset:54272
 v_add_f32 v26, v21, v26
M v[108:111], a[124:127], a[60:63], v[36:39]
 buffer_load_dwordx4 v4, s[8:11], s24 offen offset:0 sc1 lds
M v[108:111], a[120:123], a[56:59], v[108:111]
 ds_read_b128 a[88:91], v7 offset:55296
M v[108:111], a[116:119], a[52:55], v[108:111]
 ds_read_b128 a[92:95], v7 offset:56320
M v[108:111], a[112:115], a[48:51], v[108:111]
 v_exp_f32 v22, v88
M v[108:111], a[108:111], a[44:47], v[108:111]
 buffer_load_dwordx4 v4, s[8:11], s24 offen offset:1024 sc1 lds
M v[108:111], a[104:107], a[40:43], v[108:111]
 v_exp_f32 v23, v89
M v[108:111], a[100:103], a[36:39], v[108:111]
 v_exp_f32 v24, v90
M v[108:111], a[96:99], a[32:35], v[108:111]
 s_waitcnt lgkmcnt(0)
 v_exp_f32 v25, v91
M v[112:115], a[64:67], a[0:3], v[32:35]
 s_add_u32 s3, s29, 32768
 ds_read_b128 a[96:99], v7 offset:57344
 v_add_f32 v26, v22, v26
M v[112:115], a[68:71], a[4:7], v[112:115]
 ds_read_b128 a[100:103], v7 offset:58368
 v_cvt_pk_bf16_f32 v58, v22, v23
M v[112:115], a[72:75], a[8:11], v[112:115]
 buffer_load_dwordx4 v4, s[8:11], s24 offen offset:2048 sc1 lds
M v[112:115], a[76:79], a[12:15], v[112:115]
 ds_read_b128 a[104:107], v7 offset:59392
 v_add_f32 v26, v23, v26
M v[112:115], a[80:83], a[16:19], v[112:115]
 ds_read_b128 a[108:111], v7 offset:60416
 v_add_f32 v26, v24, v26
M v[112:115], a[84:87], a[20:23], v[112:115]
 buffer_store_dwordx4 a[196:199], v7, s[8:11], s3 offen sc1
M v[112:115], a[88:91], a[24:27], v[112:115]
 ds_read_b128 a[112:115], v7 offset:61440
 v_cvt_pk_bf16_f32 v59, v24, v25
M v[112:115], a[92:95], a[28:31], v[112:115]
 ds_read_b128 a[116:119], v7 offset:62464
 v_add_f32 v26, v25, v26
M v[116:119], a[92:95], a[60:63], v[36:39]
 buffer_load_dwordx4 v4, s[8:11], s24 offen offset:3072 sc1 lds
M v[116:119], a[88:91], a[56:59], v[116:119]
 ds_read_b128 a[120:123], v7 offset:63488
M v[116:119], a[84:87], a[52:55], v[116:119]
 ds_read_b128 a[124:127], v7 offset:64512
M v[116:119], a[80:83], a[48:51], v[116:119]
 v_exp_f32 v18, v84
M v[116:119], a[76:79], a[44:47], v[116:119]
 v_exp_f32 v19, v85
M v[116:119], a[72:75], a[40:43], v[116:119]
 v_exp_f32 v20, v86
M v[116:119], a[68:71], a[36:39], v[116:119]
 s_waitcnt vmcnt(24) lgkmcnt(0)
 v_exp_f32 v21, v87
M v[116:119], a[64:67], a[32:35], v[116:119]
 s_barrier
M v[120:123], a[96:99], a[0:3], v[32:35]
 ds_read_b128 a[64:67], v2 offset:0
 v_add_f32 v27, v18, v27
M v[120:123], a[100:103], a[4:7], v[120:123]
 ds_read_b128 a[68:71], v2 offset:1024
 v_cvt_pk_bf16_f32 v60, v18, v19
M v[120:123], a[104:107], a[8:11], v[120:123]
 v_exp_f32 v22, v92
M v[120:123], a[108:111], a[12:15], v[120:123]
 ds_read_b128 a[72:75], v2 offset:2048
 v_add_f32 v27, v19, v27
M v[120:123], a[112:115], a[16:19], v[120:123]
 ds_read_b128 a[76:79], v2 offset:3072
 v_add_f32 v27, v20, v27
M v[120:123], a[116:119], a[20:23], v[120:123]
 v_exp_f32 v23, v93
M v[120:123], a[120:123], a[24:27], v[120:123]
 ds_read_b128 a[80:83], v2 offset:4096
 v_cvt_pk_bf16_f32 v61, v20, v21
M v[120:123], a[124:127], a[28:31], v[120:123]
 ds_read_b128 a[84:87], v2 offset:5120
 v_add_f32 v27, v21, v27
M v[124:127], a[124:127], a[60:63], v[36:39]
 v_exp_f32 v24, v94
M v[124:127], a[120:123], a[56:59], v[124:127]
 ds_read_b128 a[88:91], v2 offset:6144
 v_add_f32 v27, v22, v27
M v[124:127], a[116:119], a[52:55], v[124:127]
 ds_read_b128 a[92:95], v2 offset:7168
 v_cvt_pk_bf16_f32 v62, v22, v23
M v[124:127], a[112:115], a[48:51], v[124:127]
 v_exp_f32 v25, v95
M v[124:127], a[108:111], a[44:47], v[124:127]
 v_add_f32 v27, v23, v27
 v_add_f32 v27, v24, v27
M v[124:127], a[104:107], a[40:43], v[124:127]
 v_cvt_pk_bf16_f32 v63, v24, v25
 v_add_f32 v27, v25, v27
M v[124:127], a[100:103], a[36:39], v[124:127]
 s_waitcnt lgkmcnt(0)
M v[124:127], a[96:99], a[32:35], v[124:127]
 v_max_f32 v10, v26, v27
 v_cmp_lt_f32 vcc, s31, v10
 s_nop 0
 s_cbranch_vccnz L_st12
L_rt12:
M v[128:131], a[64:67], v[40:43], v[128:131]
 s_add_u32 m0, s28, 32768
 ds_read_b128 a[96:99], v2 offset:8192
 v_add_f32 v30, v26, v30
M v[128:131], a[68:71], v[56:59], v[128:131]
 ds_read_b128 a[100:103], v2 offset:9216
 v_add_f32 v31, v27, v31
M v[132:135], a[68:71], v[60:63], v[132:135]
 buffer_load_dwordx4 v3, s[8:11], s21 offen offset:0 sc1 lds
M v[132:135], a[64:67], v[44:47], v[132:135]
 s_add_u32 s3, s29, 65536
 ds_read_b128 a[104:107], v2 offset:10240
M v[136:139], a[72:75], v[40:43], v[136:139]
 ds_read_b128 a[108:111], v2 offset:11264
M v[136:139], a[76:79], v[56:59], v[136:139]
 buffer_load_dwordx4 v3, s[8:11], s21 offen offset:1024 sc1 lds
M v[140:143], a[76:79], v[60:63], v[140:143]
 ds_read_b128 a[112:115], v2 offset:12288
M v[140:143], a[72:75], v[44:47], v[140:143]
 ds_read_b128 a[116:119], v2 offset:13312
M v[144:147], a[80:83], v[40:43], v[144:147]
 buffer_store_dwordx4 a[200:203], v7, s[8:11], s3 offen sc1
M v[144:147], a[84:87], v[56:59], v[144:147]
 ds_read_b128 a[120:123], v2 offset:14336
M v[148:151], a[84:87], v[60:63], v[148:151]
 ds_read_b128 a[124:127], v2 offset:15360
M v[148:151], a[80:83], v[44:47], v[148:151]
 buffer_load_dwordx4 v3, s[8:11], s21 offen offset:2048 sc1 lds
M v[152:155], a[88:91], v[40:43], v[152:155]
 v_exp_f32 v18, v96
M v[152:155], a[92:95], v[56:59], v[152:155]
 v_exp_f32 v19, v97
M v[156:159], a[92:95], v[60:63], v[156:159]
 buffer_load_dwordx4 v3, s[8:11], s21 offen offset:3072 sc1 lds
M v[156:159], a[88:91], v[44:47], v[156:159]
 s_waitcnt lgkmcnt(0)
 v_exp_f32 v20, v98
M v[160:163], a[96:99], v[40:43], v[160:163]
 ds_read_b128 a[64:67], v2 offset:16384
 v_add_f32 v28, v18, v19
M v[160:163], a[100:103], v[56:59], v[160:163]
 s_add_u32 m0, s28, 36864
 ds_read_b128 a[68:71], v2 offset:17408
 v_cvt_pk_bf16_f32 v48, v18, v19
M v[164:167], a[100:103], v[60:63], v[164:167]
 buffer_load_dwordx4 v4, s[8:11], s21 offen offset:0 sc1 lds
M v[164:167], a[96:99], v[44:47], v[164:167]
 ds_read_b128 a[72:75], v2 offset:18432
M v[168:171], a[104:107], v[40:43], v[168:171]
 ds_read_b128 a[76:79], v2 offset:19456
M v[168:171], a[108:111], v[56:59], v[168:171]
 v_exp_f32 v21, v99
M v[172:175], a[108:111], v[60:63], v[172:175]
 ds_read_b128 a[80:83], v2 offset:20480
 v_add_f32 v28, v20, v28
M v[172:175], a[104:107], v[44:47], v[172:175]
 s_add_u32 s3, s29, 98304
 ds_read_b128 a[84:87], v2 offset:21504
 v_cvt_pk_bf16_f32 v49, v20, v21
M v[176:179], a[112:115], v[40:43], v[176:179]
 buffer_load_dwordx4 v4, s[8:11], s21 offen offset:1024 sc1 lds
M v[176:179], a[116:119], v[56:59], v[176:179]
 ds_read_b128 a[88:91], v2 offset:22528
 v_add_f32 v28, v21, v28
M v[180:183], a[116:119], v[60:63], v[180:183]
 ds_read_b128 a[92:95], v2 offset:23552
M v[180:183], a[112:115], v[44:47], v[180:183]
 buffer_load_dwordx4 v4, s[8:11], s21 offen offset:2048 sc1 lds
M v[184:187], a[120:123], v[40:43], v[184:187]
 buffer_store_dwordx4 a[204:207], v7, s[8:11], s3 offen sc1
M v[184:187], a[124:127], v[56:59], v[184:187]
 v_exp_f32 v22, v104
M v[188:191], a[124:127], v[60:63], v[188:191]
 v_exp_f32 v23, v105
M v[188:191], a[120:123], v[44:47], v[188:191]
 s_waitcnt lgkmcnt(0)
 v_exp_f32 v24, v106
M v[192:195], a[64:67], v[40:43], v[192:195]
 ds_read_b128 a[96:99], v2 offset:24576
 v_add_f32 v28, v22, v28
M v[192:195], a[68:71], v[56:59], v[192:195]
 ds_read_b128 a[100:103], v2 offset:25600
 v_cvt_pk_bf16_f32 v50, v22, v23
M v[196:199], a[68:71], v[60:63], v[196:199]
 buffer_load_dwordx4 v4, s[8:11], s21 offen offset:3072 sc1 lds
M v[196:199], a[64:67], v[44:47], v[196:199]
 s_add_u32 s24, s23, 16777216
 ds_read_b128 a[104:107], v2 offset:26624
 v_add_f32 v28, v23, v28
M v[200:203], a[72:75], v[40:43], v[200:203]
 s_mov_b32 s23, s21
 ds_read_b128 a[108:111], v2 offset:27648
M v[200:203], a[76:79], v[56:59], v[200:203]
 s_add_u32 s21, s21, 32768
 v_exp_f32 v25, v107
M v[204:207], a[76:79], v[60:63], v[204:207]
 s_add_u32 s22, s22, 1
 ds_read_b128 a[112:115], v2 offset:28672
 v_add_f32 v28, v24, v28
M v[204:207], a[72:75], v[44:47], v[204:207]
 s_cmp_eq_u32 s22, s25
 ds_read_b128 a[116:119], v2 offset:29696
 v_cvt_pk_bf16_f32 v51, v24, v25
M v[208:211], a[80:83], v[40:43], v[208:211]
 s_cselect_b32 s21, s26, s21
 v_exp_f32 v18, v100
M v[208:211], a[84:87], v[56:59], v[208:211]
 s_cmp_eq_u32 s22, s43
 ds_read_b128 a[120:123], v2 offset:30720
 v_add_f32 v28, v25, v28
M v[212:215], a[84:87], v[60:63], v[212:215]
 s_cselect_b32 s21, s4, s21
 ds_read_b128 a[124:127], v2 offset:31744
M v[212:215], a[80:83], v[44:47], v[212:215]
 s_cmp_eq_u32 s22, s6
 v_exp_f32 v19, v101
M v[216:219], a[88:91], v[40:43], v[216:219]
 s_cselect_b32 s21, s7, s21
 v_exp_f32 v20, v102
M v[216:219], a[92:95], v[56:59], v[216:219]
 v_exp_f32 v21, v103
M v[220:223], a[92:95], v[60:63], v[220:223]
 s_waitcnt vmcnt(21) lgkmcnt(0)
 v_exp_f32 v22, v108
M v[220:223], a[88:91], v[44:47], v[220:223]
 s_barrier
M v[224:227], a[96:99], v[40:43], v[224:227]
 ds_read_b128 a[64:67], v2 offset:32768
 v_add_f32 v29, v18, v19
M v[224:227], a[100:103], v[56:59], v[224:227]
 ds_read_b128 a[68:71], v2 offset:33792
 v_mov_b32 v17, 4
M v[228:231], a[100:103], v[60:63], v[228:231]
 s_waitcnt vmcnt(20)
 v_cmp_gt_u32 vcc, 3, v6
 v_cvt_pk_bf16_f32 v52, v18, v19
M v[228:231], a[96:99], v[44:47], v[228:231]
 ds_read_b128 a[72:75], v2 offset:34816
 v_add_f32 v29, v20, v29
M v[232:235], a[104:107], v[40:43], v[232:235]
 ds_read_b128 a[76:79], v2 offset:35840
 v_cvt_pk_bf16_f32 v53, v20, v21
M v[232:235], a[108:111], v[56:59], v[232:235]
 s_cbranch_vccnz L_f4s
L_f4r:
 v_exp_f32 v23, v109
M v[236:239], a[108:111], v[60:63], v[236:239]
 ds_read_b128 a[80:83], v2 offset:36864
 v_add_f32 v29, v21, v29
M v[236:239], a[104:107], v[44:47], v[236:239]
 ds_read_b128 a[84:87], v2 offset:37888
 v_add_f32 v29, v22, v29
M v[240:243], a[112:115], v[40:43], v[240:243]
 buffer_store_dword v17, v1, s[8:11], s45 offen sc1
M v[240:243], a[116:119], v[56:59], v[240:243]
 ds_read_b128 a[88:91], v2 offset:38912
 v_cvt_pk_bf16_f32 v54, v22, v23
M v[244:247], a[116:119], v[60:63], v[244:247]
 ds_read_b128 a[92:95], v2 offset:39936
 v_add_f32 v29, v23, v29
M v[244:247], a[112:115], v[44:47], v[244:247]
 v_exp_f32 v24, v110
M v[248:251], a[120:123], v[40:43], v[248:251]
 v_exp_f32 v25, v111
M v[248:251], a[124:127], v[56:59], v[248:251]
 v_add_f32 v29, v24, v29
 v_cvt_pk_bf16_f32 v55, v24, v25
M v[252:255], a[124:127], v[60:63], v[252:255]
 s_waitcnt lgkmcnt(0)
 v_add_f32 v29, v25, v29
M v[252:255], a[120:123], v[44:47], v[252:255]
M v[64:67], a[64:67], a[0:3], v[32:35]
 s_add_u32 m0, s28, 65536
 ds_read_b128 a[96:99], v2 offset:40960
M v[64:67], a[68:71], a[4:7], v[64:67]
 ds_read_b128 a[100:103], v2 offset:41984
M v[64:67], a[72:75], a[8:11], v[64:67]
 buffer_load_dwordx4 v3, s[8:11], s24 offen offset:0 sc1 lds
M v[64:67], a[76:79], a[12:15], v[64:67]
 s_cmp_lt_u32 s20, 2
 ds_read_b128 a[104:107], v2 offset:43008
M v[64:67], a[80:83], a[16:19], v[64:67]
 s_cselect_b64 s[86:87], -1, 0
 ds_read_b128 a[108:111], v2 offset:44032
M v[64:67], a[84:87], a[20:23], v[64:67]
 s_cmp_eq_u32 s20, 2
 v_exp_f32 v18, v112
M v[64:67], a[88:91], a[24:27], v[64:67]
 s_cselect_b64 s[80:81], s[16:17], s[86:87]
 ds_read_b128 a[112:115], v2 offset:45056
M v[64:67], a[92:95], a[28:31], v[64:67]
 s_cselect_b64 s[82:83], s[18:19], s[86:87]
 ds_read_b128 a[116:119], v2 offset:46080
M v[68:71], a[92:95], a[60:63], v[36:39]
 buffer_load_dwordx4 v3, s[8:11], s24 offen offset:1024 sc1 lds
M v[68:71], a[88:91], a[56:59], v[68:71]
 s_cselect_b64 s[84:85], s[48:49], s[86:87]
 ds_read_b128 a[120:123], v2 offset:47104
M v[68:71], a[84:87], a[52:55], v[68:71]
 s_cselect_b64 s[86:87], s[50:51], s[86:87]
 ds_read_b128 a[124:127], v2 offset:48128
M v[68:71], a[80:83], a[48:51], v[68:71]
 s_cmp_eq_u32 s20, 3
 v_exp_f32 v19, v113
M v[68:71], a[76:79], a[44:47], v[68:71]
 buffer_load_dwordx4 v3, s[8:11], s24 offen offset:2048 sc1 lds
M v[68:71], a[72:75], a[40:43], v[68:71]
 s_cselect_b64 s[88:89], s[16:17], -1
 v_exp_f32 v20, v114
M v[68:71], a[68:71], a[36:39], v[68:71]
 s_cselect_b64 s[90:91], s[18:19], -1
 v_exp_f32 v21, v115
M v[68:71], a[64:67], a[32:35], v[68:71]
 s_waitcnt lgkmcnt(0)
 v_exp_f32 v22, v120
M v[72:75], a[96:99], a[0:3], v[32:35]
 s_cselect_b64 s[92:93], s[48:49], -1
 ds_read_b128 a[64:67], v2 offset:49152
 v_add_f32 v28, v18, v28
M v[72:75], a[100:103], a[4:7], v[72:75]
 s_cselect_b64 s[94:95], s[50:51], -1
 ds_read_b128 a[68:71], v2 offset:50176
 v_cvt_pk_bf16_f32 v56, v18, v19
M v[72:75], a[104:107], a[8:11], v[72:75]
 buffer_load_dwordx4 v3, s[8:11], s24 offen offset:3072 sc1 lds
M v[72:75], a[108:111], a[12:15], v[72:75]
 s_add_u32 s3, s29, 131072
 ds_read_b128 a[72:75], v2 offset:51200
 v_add_f32 v28, v19, v28
M v[72:75], a[112:115], a[16:19], v[72:75]
 ds_read_b128 a[76:79], v2 offset:52224
 v_add_f32 v28, v20, v28
M v[72:75], a[116:119], a[20:23], v[72:75]
 buffer_store_dwordx4 a[208:211], v7, s[8:11], s3 offen sc1
M v[72:75], a[120:123], a[24:27], v[72:75]
 s_add_u32 m0, s28, 69632
 ds_read_b128 a[80:83], v2 offset:53248
 v_cvt_pk_bf16_f32 v57, v20, v21
M v[72:75], a[124:127], a[28:31], v[72:75]
 ds_read_b128 a[84:87], v2 offset:54272
 v_add_f32 v28, v21, v28
M v[76:79], a[124:127], a[60:63], v[36:39]
 buffer_load_dwordx4 v4, s[8:11], s24 offen offset:0 sc1 lds
M v[76:79], a[120:123], a[56:59], v[76:79]
 ds_read_b128 a[88:91], v2 offset:55296
M v[76:79], a[116:119], a[52:55], v[76:79]
 ds_read_b128 a[92:95], v2 offset:56320
M v[76:79], a[112:115], a[48:51], v[76:79]
 v_exp_f32 v23, v121
M v[76:79], a[108:111], a[44:47], v[76:79]
 buffer_load_dwordx4 v4, s[8:11], s24 offen offset:1024 sc1 lds
M v[76:79], a[104:107], a[40:43], v[76:79]
 v_exp_f32 v24, v122
M v[76:79], a[100:103], a[36:39], v[76:79]
 s_add_u32 s3, s29, 163840
 v_exp_f32 v25, v123
M v[76:79], a[96:99], a[32:35], v[76:79]
 s_waitcnt lgkmcnt(0)
 v_exp_f32 v18, v116
M v[80:83], a[64:67], a[0:3], v[32:35]
 ds_read_b128 a[96:99], v2 offset:57344
 v_add_f32 v28, v22, v28
M v[80:83], a[68:71], a[4:7], v[80:83]
 ds_read_b128 a[100:103], v2 offset:58368
 v_cvt_pk_bf16_f32 v58, v22, v23
M v[80:83], a[72:75], a[8:11], v[80:83]
 buffer_load_dwordx4 v4, s[8:11], s24 offen offset:2048 sc1 lds
M v[80:83], a[76:79], a[12:15], v[80:83]
 ds_read_b128 a[104:107], v2 offset:59392
 v_add_f32 v28, v23, v28
M v[80:83], a[80:83], a[16:19], v[80:83]
 ds_read_b128 a[108:111], v2 offset:60416
 v_add_f32 v28, v24, v28
M v[80:83], a[84:87], a[20:23], v[80:83]
 buffer_store_dwordx4 a[212:215], v7, s[8:11], s3 offen sc1
M v[80:83], a[88:91], a[24:27], v[80:83]
 ds_read_b128 a[112:115], v2 offset:61440
 v_cvt_pk_bf16_f32 v59, v24, v25
M v[80:83], a[92:95], a[28:31], v[80:83]
 ds_read_b128 a[116:119], v2 offset:62464
 v_add_f32 v28, v25, v28
M v[84:87], a[92:95], a[60:63], v[36:39]
 buffer_load_dwordx4 v4, s[8:11], s24 offen offset:3072 sc1 lds
M v[84:87], a[88:91], a[56:59], v[84:87]
 ds_read_b128 a[120:123], v2 offset:63488
M v[84:87], a[84:87], a[52:55], v[84:87]
 ds_read_b128 a[124:127], v2 offset:64512
M v[84:87], a[80:83], a[48:51], v[84:87]
 v_exp_f32 v19, v117
M v[84:87], a[76:79], a[44:47], v[84:87]
 v_exp_f32 v20, v118
M v[84:87], a[72:75], a[40:43], v[84:87]
 v_exp_f32 v21, v119
M v[84:87], a[68:71], a[36:39], v[84:87]
 s_waitcnt vmcnt(21) lgkmcnt(0)
 v_exp_f32 v22, v124
M v[84:87], a[64:67], a[32:35], v[84:87]
 s_barrier
M v[88:91], a[96:99], a[0:3], v[32:35]
 ds_read_b128 a[64:67], v7 offset:0
 v_add_f32 v29, v18, v29
M v[88:91], a[100:103], a[4:7], v[88:91]
 ds_read_b128 a[68:71], v7 offset:1024
 v_cvt_pk_bf16_f32 v60, v18, v19
M v[88:91], a[104:107], a[8:11], v[88:91]
 v_exp_f32 v23, v125
M v[88:91], a[108:111], a[12:15], v[88:91]
 ds_read_b128 a[72:75], v7 offset:2048
 v_add_f32 v29, v19, v29
M v[88:91], a[112:115], a[16:19], v[88:91]
 ds_read_b128 a[76:79], v7 offset:3072
 v_add_f32 v29, v20, v29
M v[88:91], a[116:119], a[20:23], v[88:91]
 v_exp_f32 v24, v126
M v[88:91], a[120:123], a[24:27], v[88:91]
 ds_read_b128 a[80:83], v7 offset:4096
 v_cvt_pk_bf16_f32 v61, v20, v21
M v[88:91], a[124:127], a[28:31], v[88:91]
 ds_read_b128 a[84:87], v7 offset:5120
 v_add_f32 v29, v21, v29
M v[92:95], a[124:127], a[60:63], v[36:39]
 v_exp_f32 v25, v127
M v[92:95], a[120:123], a[56:59], v[92:95]
 ds_read_b128 a[88:91], v7 offset:6144
 v_add_f32 v29, v22, v29
M v[92:95], a[116:119], a[52:55], v[92:95]
 ds_read_b128 a[92:95], v7 offset:7168
 v_cvt_pk_bf16_f32 v62, v22, v23
M v[92:95], a[112:115], a[48:51], v[92:95]
 v_add_f32 v29, v23, v29
 v_add_f32 v29, v24, v29
M v[92:95], a[108:111], a[44:47], v[92:95]
 v_cvt_pk_bf16_f32 v63, v24, v25
 v_add_f32 v29, v25, v29
M v[92:95], a[104:107], a[40:43], v[92:95]
M v[92:95], a[100:103], a[36:39], v[92:95]
 s_waitcnt lgkmcnt(0)
M v[92:95], a[96:99], a[32:35], v[92:95]
 v_max_f32 v10, v28, v29
 v_cmp_lt_f32 vcc, s31, v10
 s_nop 0
 s_cbranch_vccnz L_st13
L_rt13:
M v[128:131], a[64:67], v[48:51], v[128:131]
 s_add_u32 m0, s28, 98304
 ds_read_b128 a[96:99], v7 offset:8192
 v_add_f32 v30, v28, v30
M v[128:131], a[68:71], v[56:59], v[128:131]
 s_add_u32 s3, s29, 196608
 ds_read_b128 a[100:103], v7 offset:9216
 v_add_f32 v31, v29, v31
M v[132:135], a[68:71], v[60:63], v[132:135]
 buffer_load_dwordx4 v3, s[8:11], s21 offen offset:0 sc1 lds
M v[132:135], a[64:67], v[52:55], v[132:135]
 ds_read_b128 a[104:107], v7 offset:10240
M v[136:139], a[72:75], v[48:51], v[136:139]
 ds_read_b128 a[108:111], v7 offset:11264
M v[136:139], a[76:79], v[56:59], v[136:139]
 buffer_load_dwordx4 v3, s[8:11], s21 offen offset:1024 sc1 lds
M v[140:143], a[76:79], v[60:63], v[140:143]
 ds_read_b128 a[112:115], v7 offset:12288
M v[140:143], a[72:75], v[52:55], v[140:143]
 ds_read_b128 a[116:119], v7 offset:13312
M v[144:147], a[80:83], v[48:51], v[144:147]
 buffer_store_dwordx4 a[216:219], v7, s[8:11], s3 offen sc1
M v[144:147], a[84:87], v[56:59], v[144:147]
 ds_read_b128 a[120:123], v7 offset:14336
M v[148:151], a[84:87], v[60:63], v[148:151]
 ds_read_b128 a[124:127], v7 offset:15360
M v[148:151], a[80:83], v[52:55], v[148:151]
 buffer_load_dwordx4 v3, s[8:11], s21 offen offset:2048 sc1 lds
M v[152:155], a[88:91], v[48:51], v[152:155]
 v_exp_f32 v18, v64
M v[152:155], a[92:95], v[56:59], v[152:155]
 v_exp_f32 v19, v65
M v[156:159], a[92:95], v[60:63], v[156:159]
 buffer_load_dwordx4 v3, s[8:11], s21 offen offset:3072 sc1 lds
M v[156:159], a[88:91], v[52:55], v[156:159]
 s_waitcnt lgkmcnt(0)
 v_exp_f32 v20, v66
M v[160:163], a[96:99], v[48:51], v[160:163]
 ds_read_b128 a[64:67], v7 offset:16384
 v_add_f32 v26, v18, v19
M v[160:163], a[100:103], v[56:59], v[160:163]
 s_add_u32 m0, s28, 102400
 ds_read_b128 a[68:71], v7 offset:17408
 v_cvt_pk_bf16_f32 v40, v18, v19
M v[164:167], a[100:103], v[60:63], v[164:167]
 buffer_load_dwordx4 v4, s[8:11], s21 offen offset:0 sc1 lds
M v[164:167], a[96:99], v[52:55], v[164:167]
 ds_read_b128 a[72:75], v7 offset:18432
M v[168:171], a[104:107], v[48:51], v[168:171]
 ds_read_b128 a[76:79], v7 offset:19456
M v[168:171], a[108:111], v[56:59], v[168:171]
 v_exp_f32 v21, v67
M v[172:175], a[108:111], v[60:63], v[172:175]
 ds_read_b128 a[80:83], v7 offset:20480
 v_add_f32 v26, v20, v26
M v[172:175], a[104:107], v[52:55], v[172:175]
 ds_read_b128 a[84:87], v7 offset:21504
 v_cvt_pk_bf16_f32 v41, v20, v21
M v[176:179], a[112:115], v[48:51], v[176:179]
 buffer_load_dwordx4 v4, s[8:11], s21 offen offset:1024 sc1 lds
M v[176:179], a[116:119], v[56:59], v[176:179]
 ds_read_b128 a[88:91], v7 offset:22528
 v_add_f32 v26, v21, v26
M v[180:183], a[116:119], v[60:63], v[180:183]
 ds_read_b128 a[92:95], v7 offset:23552
M v[180:183], a[112:115], v[52:55], v[180:183]
 buffer_load_dwordx4 v4, s[8:11], s21 offen offset:2048 sc1 lds
M v[184:187], a[120:123], v[48:51], v[184:187]
 v_exp_f32 v22, v72
M v[184:187], a[124:127], v[56:59], v[184:187]
 v_exp_f32 v23, v73
M v[188:191], a[124:127], v[60:63], v[188:191]
 v_exp_f32 v24, v74
M v[188:191], a[120:123], v[52:55], v[188:191]
 s_waitcnt lgkmcnt(0)
 v_exp_f32 v25, v75
M v[192:195], a[64:67], v[48:51], v[192:195]
 ds_read_b128 a[96:99], v7 offset:24576
 v_add_f32 v26, v22, v26
M v[192:195], a[68:71], v[56:59], v[192:195]
 ds_read_b128 a[100:103], v7 offset:25600
 v_cvt_pk_bf16_f32 v42, v22, v23
M v[196:199], a[68:71], v[60:63], v[196:199]
 buffer_load_dwordx4 v4, s[8:11], s21 offen offset:3072 sc1 lds
M v[196:199], a[64:67], v[52:55], v[196:199]
 s_add_u32 s24, s23, 16777216
 ds_read_b128 a[104:107], v7 offset:26624
 v_add_f32 v26, v23, v26
M v[200:203], a[72:75], v[48:51], v[200:203]
 s_mov_b32 s23, s21
 ds_read_b128 a[108:111], v7 offset:27648
 v_add_f32 v26, v24, v26
M v[200:203], a[76:79], v[56:59], v[200:203]
 s_add_u32 s21, s21, 32768
 v_exp_f32 v18, v68
M v[204:207], a[76:79], v[60:63], v[204:207]
 s_add_u32 s22, s22, 1
 ds_read_b128 a[112:115], v7 offset:28672
 v_cvt_pk_bf16_f32 v43, v24, v25
M v[204:207], a[72:75], v[52:55], v[204:207]
 s_cmp_eq_u32 s22, s25
 ds_read_b128 a[116:119], v7 offset:29696
 v_add_f32 v26, v25, v26
M v[208:211], a[80:83], v[48:51], v[208:211]
 s_cselect_b32 s21, s26, s21
 v_exp_f32 v19, v69
M v[208:211], a[84:87], v[56:59], v[208:211]
 s_cmp_eq_u32 s22, s43
 ds_read_b128 a[120:123], v7 offset:30720
 v_add_f32 v27, v18, v19
M v[212:215], a[84:87], v[60:63], v[212:215]
 s_cselect_b32 s21, s4, s21
 ds_read_b128 a[124:127], v7 offset:31744
 v_cvt_pk_bf16_f32 v44, v18, v19
M v[212:215], a[80:83], v[52:55], v[212:215]
 s_cmp_eq_u32 s22, s6
 v_exp_f32 v20, v70
M v[216:219], a[88:91], v[48:51], v[216:219]
 s_cselect_b32 s21, s7, s21
 v_exp_f32 v21, v71
M v[216:219], a[92:95], v[56:59], v[216:219]
 v_exp_f32 v22, v76
M v[220:223], a[92:95], v[60:63], v[220:223]
 s_waitcnt vmcnt(20) lgkmcnt(0)
 v_add_f32 v27, v20, v27
 v_cvt_pk_bf16_f32 v45, v20, v21
M v[220:223], a[88:91], v[52:55], v[220:223]
 s_barrier
M v[224:227], a[96:99], v[48:51], v[224:227]
 ds_read_b128 a[64:67], v7 offset:32768
 v_add_f32 v27, v21, v27
M v[224:227], a[100:103], v[56:59], v[224:227]
 ds_read_b128 a[68:71], v7 offset:33792
M v[228:231], a[100:103], v[60:63], v[228:231]
 v_exp_f32 v23, v77
M v[228:231], a[96:99], v[52:55], v[228:231]
 ds_read_b128 a[72:75], v7 offset:34816
 v_add_f32 v27, v22, v27
M v[232:235], a[104:107], v[48:51], v[232:235]
 ds_read_b128 a[76:79], v7 offset:35840
 v_cvt_pk_bf16_f32 v46, v22, v23
M v[232:235], a[108:111], v[56:59], v[232:235]
 v_exp_f32 v24, v78
M v[236:239], a[108:111], v[60:63], v[236:239]
 ds_read_b128 a[80:83], v7 offset:36864
 v_add_f32 v27, v23, v27
M v[236:239], a[104:107], v[52:55], v[236:239]
 ds_read_b128 a[84:87], v7 offset:37888
M v[240:243], a[112:115], v[48:51], v[240:243]
 v_exp_f32 v25, v79
M v[240:243], a[116:119], v[56:59], v[240:243]
 ds_read_b128 a[88:91], v7 offset:38912
 v_add_f32 v27, v24, v27
M v[244:247], a[116:119], v[60:63], v[244:247]
 ds_read_b128 a[92:95], v7 offset:39936
 v_cvt_pk_bf16_f32 v47, v24, v25
M v[244:247], a[112:115], v[52:55], v[244:247]
 v_add_f32 v27, v25, v27
M v[248:251], a[120:123], v[48:51], v[248:251]
M v[248:251], a[124:127], v[56:59], v[248:251]
M v[252:255], a[124:127], v[60:63], v[252:255]
 s_waitcnt lgkmcnt(0)
M v[252:255], a[120:123], v[52:55], v[252:255]
 s_branch L_loop_mid
L_zs0:
 s_mov_b32 s64, 65536
L_zs0_l:
 s_sleep 2
 buffer_load_dword v17, v16, s[12:15], 0 offen offset:64 sc1
 s_sub_u32 s64, s64, 1
 s_cbranch_scc1 L_zs0_x
 s_waitcnt vmcnt(0)
 v_cmp_ne_u32 vcc, 1, v17
 s_nop 0
 s_cbranch_vccnz L_zs0_l
L_zs0_x:
 s_waitcnt vmcnt(0)
 s_branch L_zr0
L_zs1:
 s_mov_b32 s64, 65536
L_zs1_l:
 s_sleep 2
 buffer_load_dword v17, v16, s[12:15], 0 offen offset:64 sc1
 s_sub_u32 s64, s64, 1
 s_cbranch_scc1 L_zs1_x
 s_waitcnt vmcnt(0)
 v_cmp_ne_u32 vcc, 1, v17
 s_nop 0
 s_cbranch_vccnz L_zs1_l
L_zs1_x:
 s_waitcnt vmcnt(0)
 s_branch L_zr1
L_hs:
 s_mov_b32 s91, 65536
L_hs_l:
 buffer_load_dwordx4 v[16:19], v7, s[8:11], s67 offen offset:0 sc1
 buffer_load_dwordx4 v[20:23], v7, s[8:11], s67 offen offset:1024 sc1
 s_waitcnt vmcnt(0)
 s_sub_u32 s91, s91, 1
 s_cbranch_scc1 L_hr
 v_min3_u32 v28, v16, v17, v18
 v_min3_u32 v28, v28, v19, v20
 v_min3_u32 v28, v28, v21, v22
 v_min_u32 v28, v28, v23
 v_cmp_eq_u32 vcc, 0, v28
 s_nop 0
 s_cbranch_vccnz L_hs_l
 s_branch L_hr
L_f1s04:
 s_mov_b32 s91, 65536
L_f1s04_l:
 s_sleep 2
 buffer_load_dword v24, v13, s[8:11], s46 offen sc1
 s_sub_u32 s91, s91, 1
 s_cbranch_scc1 L_f1s04_x
 s_waitcnt vmcnt(0)
 v_cmp_eq_u32 vcc, 0, v24
 s_nop 0
 s_cbranch_vccnz L_f1s04_l
L_f1s04_x:
 s_waitcnt vmcnt(0)
 s_branch L_f1r04
L_f1s05:
 s_mov_b32 s91, 65536
L_f1s05_l:
 s_sleep 2
 buffer_load_dword v24, v9, s[8:11], s46 offen sc1
 s_sub_u32 s91, s91, 1
 s_cbranch_scc1 L_f1s05_x
 s_waitcnt vmcnt(0)
 v_cmp_eq_u32 vcc, 0, v24
 s_nop 0
 s_cbranch_vccnz L_f1s05_l
L_f1s05_x:
 s_waitcnt vmcnt(0)
 s_branch L_f1r05
L_f1s14:
 s_mov_b32 s91, 65536
L_f1s14_l:
 s_sleep 2
 buffer_load_dword v24, v13, s[8:11], s46 offen sc1
 s_sub_u32 s91, s91, 1
 s_cbranch_scc1 L_f1s14_x
 s_waitcnt vmcnt(0)
 v_cmp_eq_u32 vcc, 0, v24
 s_nop 0
 s_cbranch_vccnz L_f1s14_l
L_f1s14_x:
 s_waitcnt vmcnt(0)
 s_branch L_f1r14
L_f1s15:
 s_mov_b32 s91, 65536
L_f1s15_l:
 s_sleep 2
 buffer_load_dword v24, v9, s[8:11], s46 offen sc1
 s_sub_u32 s91, s91, 1
 s_cbranch_scc1 L_f1s15_x
 s_waitcnt vmcnt(0)
 v_cmp_eq_u32 vcc, 0, v24
 s_nop 0
 s_cbranch_vccnz L_f1s15_l
L_f1s15_x:
 s_waitcnt vmcnt(0)
 s_branch L_f1r15
.p2align 6
L_loop_top:
M v[64:67], a[64:67], a[0:3], v[32:35]
 s_add_u32 m0, s28, 65536
 ds_read_b128 a[96:99], v2 offset:40960
M v[64:67], a[68:71], a[4:7], v[64:67]
 ds_read_b128 a[100:103], v2 offset:41984
M v[64:67], a[72:75], a[8:11], v[64:67]
 buffer_load_dword a240, v0, s[60:63], 0 offen offset:0
M v[64:67], a[76:79], a[12:15], v[64:67]
 ds_read_b128 a[104:107], v2 offset:43008
M v[64:67], a[80:83], a[16:19], v[64:67]
 ds_read_b128 a[108:111], v2 offset:44032
M v[64:67], a[84:87], a[20:23], v[64:67]
 buffer_load_dwordx4 v3, s[8:11], s24 offen offset:0 sc1 lds
M v[64:67], a[88:91], a[24:27], v[64:67]
 ds_read_b128 a[112:115], v2 offset:45056
M v[64:67], a[92:95], a[28:31], v[64:67]
 ds_read_b128 a[116:119], v2 offset:46080
M v[68:71], a[92:95], a[60:63], v[36:39]
 buffer_load_dwordx4 v3, s[8:11], s24 offen offset:1024 sc1 lds
M v[68:71], a[88:91], a[56:59], v[68:71]
 ds_read_b128 a[120:123], v2 offset:47104
M v[68:71], a[84:87], a[52:55], v[68:71]
 ds_read_b128 a[124:127], v2 offset:48128
M v[68:71], a[80:83], a[48:51], v[68:71]
 v_exp_f32 v18, v112
M v[68:71], a[76:79], a[44:47], v[68:71]
 buffer_load_dwordx4 v3, s[8:11], s24 offen offset:2048 sc1 lds
M v[68:71], a[72:75], a[40:43], v[68:71]
 v_exp_f32 v19, v113
M v[68:71], a[68:71], a[36:39], v[68:71]
 v_exp_f32 v20, v114
M v[68:71], a[64:67], a[32:35], v[68:71]
 s_waitcnt lgkmcnt(0)
 v_exp_f32 v21, v115
M v[72:75], a[96:99], a[0:3], v[32:35]
 ds_read_b128 a[64:67], v2 offset:49152
 v_add_f32 v28, v18, v28
M v[72:75], a[100:103], a[4:7], v[72:75]
 ds_read_b128 a[68:71], v2 offset:50176
 v_cvt_pk_bf16_f32 v56, v18, v19
M v[72:75], a[104:107], a[8:11], v[72:75]
 buffer_load_dwordx4 v3, s[8:11], s24 offen offset:3072 sc1 lds
M v[72:75], a[108:111], a[12:15], v[72:75]
 ds_read_b128 a[72:75], v2 offset:51200
 v_add_f32 v28, v19, v28
M v[72:75], a[112:115], a[16:19], v[72:75]
 ds_read_b128 a[76:79], v2 offset:52224
 v_add_f32 v28, v20, v28
M v[72:75], a[116:119], a[20:23], v[72:75]
 v_exp_f32 v22, v120
M v[72:75], a[120:123], a[24:27], v[72:75]
 s_add_u32 m0, s28, 69632
 ds_read_b128 a[80:83], v2 offset:53248
 v_cvt_pk_bf16_f32 v57, v20, v21
M v[72:75], a[124:127], a[28:31], v[72:75]
 ds_read_b128 a[84:87], v2 offset:54272
 v_add_f32 v28, v21, v28
M v[76:79], a[124:127], a[60:63], v[36:39]
 buffer_load_dwordx4 v4, s[8:11], s24 offen offset:0 sc1 lds
M v[76:79], a[120:123], a[56:59], v[76:79]
 ds_read_b128 a[88:91], v2 offset:55296
M v[76:79], a[116:119], a[52:55], v[76:79]
 ds_read_b128 a[92:95], v2 offset:56320
M v[76:79], a[112:115], a[48:51], v[76:79]
 v_exp_f32 v23, v121
M v[76:79], a[108:111], a[44:47], v[76:79]
 buffer_load_dwordx4 v4, s[8:11], s24 offen offset:1024 sc1 lds
M v[76:79], a[104:107], a[40:43], v[76:79]
 v_exp_f32 v24, v122
M v[76:79], a[100:103], a[36:39], v[76:79]
 v_exp_f32 v25, v123
M v[76:79], a[96:99], a[32:35], v[76:79]
 s_waitcnt lgkmcnt(0)
 v_exp_f32 v18, v116
M v[80:83], a[64:67], a[0:3], v[32:35]
 ds_read_b128 a[96:99], v2 offset:57344
 v_add_f32 v28, v22, v28
M v[80:83], a[68:71], a[4:7], v[80:83]
 ds_read_b128 a[100:103], v2 offset:58368
 v_cvt_pk_bf16_f32 v58, v22, v23
M v[80:83], a[72:75], a[8:11], v[80:83]
 buffer_load_dwordx4 v4, s[8:11], s24 offen offset:2048 sc1 lds
M v[80:83], a[76:79], a[12:15], v[80:83]
 ds_read_b128 a[104:107], v2 offset:59392
 v_add_f32 v28, v23, v28
M v[80:83], a[80:83], a[16:19], v[80:83]
 ds_read_b128 a[108:111], v2 offset:60416
 v_add_f32 v28, v24, v28
M v[80:83], a[84:87], a[20:23], v[80:83]
 v_exp_f32 v19, v117
M v[80:83], a[88:91], a[24:27], v[80:83]
 ds_read_b128 a[112:115], v2 offset:61440
 v_cvt_pk_bf16_f32 v59, v24, v25
M v[80:83], a[92:95], a[28:31], v[80:83]
 ds_read_b128 a[116:119], v2 offset:62464
 v_add_f32 v28, v25, v28
M v[84:87], a[92:95], a[60:63], v[36:39]
 buffer_load_dwordx4 v4, s[8:11], s24 offen offset:3072 sc1 lds
M v[84:87], a[88:91], a[56:59], v[84:87]
 ds_read_b128 a[120:123], v2 offset:63488
 v_add_f32 v29, v18, v29
M v[84:87], a[84:87], a[52:55], v[84:87]
 ds_read_b128 a[124:127], v2 offset:64512
 v_cvt_pk_bf16_f32 v60, v18, v19
M v[84:87], a[80:83], a[48:51], v[84:87]
 v_exp_f32 v20, v118
M v[84:87], a[76:79], a[44:47], v[84:87]
 v_exp_f32 v21, v119
M v[84:87], a[72:75], a[40:43], v[84:87]
 v_exp_f32 v22, v124
M v[84:87], a[68:71], a[36:39], v[84:87]
 s_waitcnt vmcnt(17) lgkmcnt(0)
 v_exp_f32 v23, v125
M v[84:87], a[64:67], a[32:35], v[84:87]
 s_barrier
M v[88:91], a[96:99], a[0:3], v[32:35]
 ds_read_b128 a[64:67], v7 offset:0
 v_add_f32 v29, v19, v29
M v[88:91], a[100:103], a[4:7], v[88:91]
 ds_read_b128 a[68:71], v7 offset:1024
 v_add_f32 v29, v20, v29
M v[88:91], a[104:107], a[8:11], v[88:91]
 v_exp_f32 v24, v126
M v[88:91], a[108:111], a[12:15], v[88:91]
 ds_read_b128 a[72:75], v7 offset:2048
 v_cvt_pk_bf16_f32 v61, v20, v21
M v[88:91], a[112:115], a[16:19], v[88:91]
 ds_read_b128 a[76:79], v7 offset:3072
 v_add_f32 v29, v21, v29
M v[88:91], a[116:119], a[20:23], v[88:91]
 v_exp_f32 v25, v127
M v[88:91], a[120:123], a[24:27], v[88:91]
 ds_read_b128 a[80:83], v7 offset:4096
 v_add_f32 v29, v22, v29
M v[88:91], a[124:127], a[28:31], v[88:91]
 ds_read_b128 a[84:87], v7 offset:5120
 v_cvt_pk_bf16_f32 v62, v22, v23
M v[92:95], a[124:127], a[60:63], v[36:39]
 v_add_f32 v29, v23, v29
 v_add_f32 v29, v24, v29
M v[92:95], a[120:123], a[56:59], v[92:95]
 ds_read_b128 a[88:91], v7 offset:6144
 v_cvt_pk_bf16_f32 v63, v24, v25
M v[92:95], a[116:119], a[52:55], v[92:95]
 ds_read_b128 a[92:95], v7 offset:7168
 v_add_f32 v29, v25, v29
M v[92:95], a[112:115], a[48:51], v[92:95]
 v_max_f32 v10, v28, v29
M v[92:95], a[108:111], a[44:47], v[92:95]
 v_cmp_lt_f32 vcc, s31, v10
M v[92:95], a[104:107], a[40:43], v[92:95]
M v[92:95], a[100:103], a[36:39], v[92:95]
 s_waitcnt lgkmcnt(0)
M v[92:95], a[96:99], a[32:35], v[92:95]
 s_cbranch_vccnz L_st1
L_rt1:
M v[128:131], a[64:67], v[48:51], v[128:131]
 s_add_u32 m0, s28, 98304
 ds_read_b128 a[96:99], v7 offset:8192
 v_add_f32 v30, v28, v30
M v[128:131], a[68:71], v[56:59], v[128:131]
 ds_read_b128 a[100:103], v7 offset:9216
 v_add_f32 v31, v29, v31
M v[132:135], a[68:71], v[60:63], v[132:135]
 buffer_load_dwordx4 v3, s[8:11], s21 offen offset:0 sc1 lds
M v[132:135], a[64:67], v[52:55], v[132:135]
 ds_read_b128 a[104:107], v7 offset:10240
M v[136:139], a[72:75], v[48:51], v[136:139]
 ds_read_b128 a[108:111], v7 offset:11264
M v[136:139], a[76:79], v[56:59], v[136:139]
 buffer_load_dwordx4 v3, s[8:11], s21 offen offset:1024 sc1 lds
M v[140:143], a[76:79], v[60:63], v[140:143]
 ds_read_b128 a[112:115], v7 offset:12288
M v[140:143], a[72:75], v[52:55], v[140:143]
 ds_read_b128 a[116:119], v7 offset:13312
M v[144:147], a[80:83], v[48:51], v[144:147]
 v_exp_f32 v18, v64
M v[144:147], a[84:87], v[56:59], v[144:147]
 ds_read_b128 a[120:123], v7 offset:14336
M v[148:151], a[84:87], v[60:63], v[148:151]
 ds_read_b128 a[124:127], v7 offset:15360
M v[148:151], a[80:83], v[52:55], v[148:151]
 buffer_load_dwordx4 v3, s[8:11], s21 offen offset:2048 sc1 lds
M v[152:155], a[88:91], v[48:51], v[152:155]
 v_exp_f32 v19, v65
M v[152:155], a[92:95], v[56:59], v[152:155]
 v_exp_f32 v20, v66
M v[156:159], a[92:95], v[60:63], v[156:159]
 buffer_load_dwordx4 v3, s[8:11], s21 offen offset:3072 sc1 lds
M v[156:159], a[88:91], v[52:55], v[156:159]
 s_waitcnt lgkmcnt(0)
 v_exp_f32 v21, v67
M v[160:163], a[96:99], v[48:51], v[160:163]
 ds_read_b128 a[64:67], v7 offset:16384
 v_add_f32 v26, v18, v19
M v[160:163], a[100:103], v[56:59], v[160:163]
 s_add_u32 m0, s28, 102400
 ds_read_b128 a[68:71], v7 offset:17408
 v_cvt_pk_bf16_f32 v40, v18, v19
M v[164:167], a[100:103], v[60:63], v[164:167]
 buffer_load_dwordx4 v4, s[8:11], s21 offen offset:0 sc1 lds
M v[164:167], a[96:99], v[52:55], v[164:167]
 ds_read_b128 a[72:75], v7 offset:18432
 v_add_f32 v26, v20, v26
M v[168:171], a[104:107], v[48:51], v[168:171]
 ds_read_b128 a[76:79], v7 offset:19456
 v_cvt_pk_bf16_f32 v41, v20, v21
M v[168:171], a[108:111], v[56:59], v[168:171]
 v_exp_f32 v22, v72
M v[172:175], a[108:111], v[60:63], v[172:175]
 ds_read_b128 a[80:83], v7 offset:20480
 v_add_f32 v26, v21, v26
M v[172:175], a[104:107], v[52:55], v[172:175]
 ds_read_b128 a[84:87], v7 offset:21504
M v[176:179], a[112:115], v[48:51], v[176:179]
 buffer_load_dwordx4 v4, s[8:11], s21 offen offset:1024 sc1 lds
M v[176:179], a[116:119], v[56:59], v[176:179]
 ds_read_b128 a[88:91], v7 offset:22528
M v[180:183], a[116:119], v[60:63], v[180:183]
 ds_read_b128 a[92:95], v7 offset:23552
M v[180:183], a[112:115], v[52:55], v[180:183]
 buffer_load_dwordx4 v4, s[8:11], s21 offen offset:2048 sc1 lds
M v[184:187], a[120:123], v[48:51], v[184:187]
 v_exp_f32 v23, v73
M v[184:187], a[124:127], v[56:59], v[184:187]
 v_exp_f32 v24, v74
M v[188:191], a[124:127], v[60:63], v[188:191]
 v_exp_f32 v25, v75
M v[188:191], a[120:123], v[52:55], v[188:191]
 s_waitcnt lgkmcnt(0)
 v_exp_f32 v18, v68
M v[192:195], a[64:67], v[48:51], v[192:195]
 ds_read_b128 a[96:99], v7 offset:24576
 v_add_f32 v26, v22, v26
M v[192:195], a[68:71], v[56:59], v[192:195]
 ds_read_b128 a[100:103], v7 offset:25600
 v_cvt_pk_bf16_f32 v42, v22, v23
M v[196:199], a[68:71], v[60:63], v[196:199]
 buffer_load_dwordx4 v4, s[8:11], s21 offen offset:3072 sc1 lds
M v[196:199], a[64:67], v[52:55], v[196:199]
 s_add_u32 s24, s23, 16777216
 ds_read_b128 a[104:107], v7 offset:26624
 v_add_f32 v26, v23, v26
M v[200:203], a[72:75], v[48:51], v[200:203]
 s_mov_b32 s23, s21
 ds_read_b128 a[108:111], v7 offset:27648
 v_add_f32 v26, v24, v26
M v[200:203], a[76:79], v[56:59], v[200:203]
 s_add_u32 s21, s21, 32768
 v_exp_f32 v19, v69
M v[204:207], a[76:79], v[60:63], v[204:207]
 s_add_u32 s22, s22, 1
 ds_read_b128 a[112:115], v7 offset:28672
 v_cvt_pk_bf16_f32 v43, v24, v25
M v[204:207], a[72:75], v[52:55], v[204:207]
 s_cmp_eq_u32 s22, s25
 ds_read_b128 a[116:119], v7 offset:29696
 v_add_f32 v26, v25, v26
M v[208:211], a[80:83], v[48:51], v[208:211]
 s_cselect_b32 s21, s26, s21
 v_exp_f32 v20, v70
M v[208:211], a[84:87], v[56:59], v[208:211]
 s_cmp_eq_u32 s22, s43
 ds_read_b128 a[120:123], v7 offset:30720
 v_add_f32 v27, v18, v19
M v[212:215], a[84:87], v[60:63], v[212:215]
 s_cselect_b32 s21, s4, s21
 ds_read_b128 a[124:127], v7 offset:31744
 v_cvt_pk_bf16_f32 v44, v18, v19
M v[212:215], a[80:83], v[52:55], v[212:215]
 s_cmp_eq_u32 s22, s6
 v_exp_f32 v21, v71
M v[216:219], a[88:91], v[48:51], v[216:219]
 s_cselect_b32 s21, s7, s21
 v_exp_f32 v22, v76
M v[216:219], a[92:95], v[56:59], v[216:219]
 v_add_f32 v27, v20, v27
 v_cvt_pk_bf16_f32 v45, v20, v21
M v[220:223], a[92:95], v[60:63], v[220:223]
 s_waitcnt vmcnt(17) lgkmcnt(0)
 v_add_f32 v27, v21, v27
M v[220:223], a[88:91], v[52:55], v[220:223]
 s_barrier
M v[224:227], a[96:99], v[48:51], v[224:227]
 ds_read_b128 a[64:67], v7 offset:32768
M v[224:227], a[100:103], v[56:59], v[224:227]
 ds_read_b128 a[68:71], v7 offset:33792
M v[228:231], a[100:103], v[60:63], v[228:231]
 v_exp_f32 v23, v77
M v[228:231], a[96:99], v[52:55], v[228:231]
 ds_read_b128 a[72:75], v7 offset:34816
 v_add_f32 v27, v22, v27
M v[232:235], a[104:107], v[48:51], v[232:235]
 ds_read_b128 a[76:79], v7 offset:35840
 v_cvt_pk_bf16_f32 v46, v22, v23
M v[232:235], a[108:111], v[56:59], v[232:235]
 v_exp_f32 v24, v78
M v[236:239], a[108:111], v[60:63], v[236:239]
 ds_read_b128 a[80:83], v7 offset:36864
 v_add_f32 v27, v23, v27
M v[236:239], a[104:107], v[52:55], v[236:239]
 ds_read_b128 a[84:87], v7 offset:37888
M v[240:243], a[112:115], v[48:51], v[240:243]
 v_exp_f32 v25, v79
M v[240:243], a[116:119], v[56:59], v[240:243]
 ds_read_b128 a[88:91], v7 offset:38912
 v_add_f32 v27, v24, v27
M v[244:247], a[116:119], v[60:63], v[244:247]
 ds_read_b128 a[92:95], v7 offset:39936
 v_cvt_pk_bf16_f32 v47, v24, v25
M v[244:247], a[112:115], v[52:55], v[244:247]
 v_add_f32 v27, v25, v27
M v[248:251], a[120:123], v[48:51], v[248:251]
M v[248:251], a[124:127], v[56:59], v[248:251]
M v[252:255], a[124:127], v[60:63], v[252:255]
 s_waitcnt lgkmcnt(0)
M v[252:255], a[120:123], v[52:55], v[252:255]
L_loop_mid:
M v[96:99], a[64:67], a[0:3], v[32:35]
 s_and_b32 s39, s54, 15
 ds_read_b128 a[96:99], v7 offset:40960
M v[96:99], a[68:71], a[4:7], v[96:99]
 s_cbranch_scc1 L_fll
L_fllr:
 ds_read_b128 a[100:103], v7 offset:41984
M v[96:99], a[72:75], a[8:11], v[96:99]
 s_lshr_b32 s54, s54, 4
 v_exp_f32 v18, v80
M v[96:99], a[76:79], a[12:15], v[96:99]
 s_add_u32 m0, s28, 0
 ds_read_b128 a[104:107], v7 offset:43008
M v[96:99], a[80:83], a[16:19], v[96:99]
 ds_read_b128 a[108:111], v7 offset:44032
M v[96:99], a[84:87], a[20:23], v[96:99]
 buffer_load_dwordx4 v3, s[8:11], s24 offen offset:0 sc1 lds
M v[96:99], a[88:91], a[24:27], v[96:99]
 ds_read_b128 a[112:115], v7 offset:45056
M v[96:99], a[92:95], a[28:31], v[96:99]
 ds_read_b128 a[116:119], v7 offset:46080
M v[100:103], a[92:95], a[60:63], v[36:39]
 v_exp_f32 v19, v81
M v[100:103], a[88:91], a[56:59], v[100:103]
 ds_read_b128 a[120:123], v7 offset:47104
 v_add_f32 v26, v18, v26
M v[100:103], a[84:87], a[52:55], v[100:103]
 ds_read_b128 a[124:127], v7 offset:48128
 v_cvt_pk_bf16_f32 v56, v18, v19
M v[100:103], a[80:83], a[48:51], v[100:103]
 buffer_load_dwordx4 v3, s[8:11], s24 offen offset:1024 sc1 lds
M v[100:103], a[76:79], a[44:47], v[100:103]
 v_exp_f32 v20, v82
M v[100:103], a[72:75], a[40:43], v[100:103]
 v_exp_f32 v21, v83
M v[100:103], a[68:71], a[36:39], v[100:103]
 buffer_load_dwordx4 v3, s[8:11], s24 offen offset:2048 sc1 lds
M v[100:103], a[64:67], a[32:35], v[100:103]
 s_waitcnt lgkmcnt(0)
 v_exp_f32 v22, v88
M v[104:107], a[96:99], a[0:3], v[32:35]
 ds_read_b128 a[64:67], v7 offset:49152
 v_add_f32 v26, v19, v26
M v[104:107], a[100:103], a[4:7], v[104:107]
 ds_read_b128 a[68:71], v7 offset:50176
 v_add_f32 v26, v20, v26
M v[104:107], a[104:107], a[8:11], v[104:107]
 v_exp_f32 v23, v89
M v[104:107], a[108:111], a[12:15], v[104:107]
 ds_read_b128 a[72:75], v7 offset:51200
 v_cvt_pk_bf16_f32 v57, v20, v21
M v[104:107], a[112:115], a[16:19], v[104:107]
 ds_read_b128 a[76:79], v7 offset:52224
 v_add_f32 v26, v21, v26
M v[104:107], a[116:119], a[20:23], v[104:107]
 buffer_load_dwordx4 v3, s[8:11], s24 offen offset:3072 sc1 lds
M v[104:107], a[120:123], a[24:27], v[104:107]
 ds_read_b128 a[80:83], v7 offset:53248
 v_add_f32 v26, v22, v26
M v[104:107], a[124:127], a[28:31], v[104:107]
 s_add_u32 m0, s28, 4096
 ds_read_b128 a[84:87], v7 offset:54272
 v_cvt_pk_bf16_f32 v58, v22, v23
M v[108:111], a[124:127], a[60:63], v[36:39]
 buffer_load_dwordx4 v4, s[8:11], s24 offen offset:0 sc1 lds
M v[108:111], a[120:123], a[56:59], v[108:111]
 ds_read_b128 a[88:91], v7 offset:55296
 v_add_f32 v26, v23, v26
M v[108:111], a[116:119], a[52:55], v[108:111]
 ds_read_b128 a[92:95], v7 offset:56320
M v[108:111], a[112:115], a[48:51], v[108:111]
 v_exp_f32 v24, v90
M v[108:111], a[108:111], a[44:47], v[108:111]
 v_exp_f32 v25, v91
M v[108:111], a[104:107], a[40:43], v[108:111]
 buffer_load_dwordx4 v4, s[8:11], s24 offen offset:1024 sc1 lds
M v[108:111], a[100:103], a[36:39], v[108:111]
 v_exp_f32 v18, v84
M v[108:111], a[96:99], a[32:35], v[108:111]
 s_waitcnt lgkmcnt(0)
 v_exp_f32 v19, v85
M v[112:115], a[64:67], a[0:3], v[32:35]
 ds_read_b128 a[96:99], v7 offset:57344
 v_add_f32 v26, v24, v26
M v[112:115], a[68:71], a[4:7], v[112:115]
 ds_read_b128 a[100:103], v7 offset:58368
 v_cvt_pk_bf16_f32 v59, v24, v25
M v[112:115], a[72:75], a[8:11], v[112:115]
 buffer_load_dwordx4 v4, s[8:11], s24 offen offset:2048 sc1 lds
M v[112:115], a[76:79], a[12:15], v[112:115]
 ds_read_b128 a[104:107], v7 offset:59392
 v_add_f32 v26, v25, v26
M v[112:115], a[80:83], a[16:19], v[112:115]
 ds_read_b128 a[108:111], v7 offset:60416
 v_add_f32 v27, v18, v27
M v[112:115], a[84:87], a[20:23], v[112:115]
 v_exp_f32 v20, v86
M v[112:115], a[88:91], a[24:27], v[112:115]
 ds_read_b128 a[112:115], v7 offset:61440
 v_cvt_pk_bf16_f32 v60, v18, v19
M v[112:115], a[92:95], a[28:31], v[112:115]
 ds_read_b128 a[116:119], v7 offset:62464
 v_add_f32 v27, v19, v27
M v[116:119], a[92:95], a[60:63], v[36:39]
 buffer_load_dwordx4 v4, s[8:11], s24 offen offset:3072 sc1 lds
M v[116:119], a[88:91], a[56:59], v[116:119]
 ds_read_b128 a[120:123], v7 offset:63488
M v[116:119], a[84:87], a[52:55], v[116:119]
 ds_read_b128 a[124:127], v7 offset:64512
M v[116:119], a[80:83], a[48:51], v[116:119]
 v_exp_f32 v21, v87
M v[116:119], a[76:79], a[44:47], v[116:119]
 v_exp_f32 v22, v92
M v[116:119], a[72:75], a[40:43], v[116:119]
 v_exp_f32 v23, v93
M v[116:119], a[68:71], a[36:39], v[116:119]
 s_waitcnt vmcnt(16) lgkmcnt(0)
 v_add_f32 v27, v20, v27
 v_cvt_pk_bf16_f32 v61, v20, v21
M v[116:119], a[64:67], a[32:35], v[116:119]
 s_barrier
M v[120:123], a[96:99], a[0:3], v[32:35]
 ds_read_b128 a[64:67], v2 offset:0
 v_add_f32 v27, v21, v27
M v[120:123], a[100:103], a[4:7], v[120:123]
 ds_read_b128 a[68:71], v2 offset:1024
 v_add_f32 v27, v22, v27
M v[120:123], a[104:107], a[8:11], v[120:123]
 v_exp_f32 v24, v94
M v[120:123], a[108:111], a[12:15], v[120:123]
 ds_read_b128 a[72:75], v2 offset:2048
 v_cvt_pk_bf16_f32 v62, v22, v23
M v[120:123], a[112:115], a[16:19], v[120:123]
 ds_read_b128 a[76:79], v2 offset:3072
 v_add_f32 v27, v23, v27
M v[120:123], a[116:119], a[20:23], v[120:123]
 v_exp_f32 v25, v95
M v[120:123], a[120:123], a[24:27], v[120:123]
 ds_read_b128 a[80:83], v2 offset:4096
 v_add_f32 v27, v24, v27
M v[120:123], a[124:127], a[28:31], v[120:123]
 ds_read_b128 a[84:87], v2 offset:5120
 v_cvt_pk_bf16_f32 v63, v24, v25
M v[124:127], a[124:127], a[60:63], v[36:39]
 v_add_f32 v27, v25, v27
M v[124:127], a[120:123], a[56:59], v[124:127]
 ds_read_b128 a[88:91], v2 offset:6144
M v[124:127], a[116:119], a[52:55], v[124:127]
 ds_read_b128 a[92:95], v2 offset:7168
 v_max_f32 v10, v26, v27
M v[124:127], a[112:115], a[48:51], v[124:127]
 v_cmp_lt_f32 vcc, s31, v10
M v[124:127], a[108:111], a[44:47], v[124:127]
M v[124:127], a[104:107], a[40:43], v[124:127]
M v[124:127], a[100:103], a[36:39], v[124:127]
 s_waitcnt lgkmcnt(0)
M v[124:127], a[96:99], a[32:35], v[124:127]
 s_cbranch_vccnz L_st0
L_rt0:
M v[128:131], a[64:67], v[40:43], v[128:131]
 s_add_u32 m0, s28, 32768
 ds_read_b128 a[96:99], v2 offset:8192
 v_add_f32 v30, v26, v30
M v[128:131], a[68:71], v[56:59], v[128:131]
 ds_read_b128 a[100:103], v2 offset:9216
 v_add_f32 v31, v27, v31
M v[132:135], a[68:71], v[60:63], v[132:135]
 buffer_load_dwordx4 v3, s[8:11], s21 offen offset:0 sc1 lds
M v[132:135], a[64:67], v[44:47], v[132:135]
 ds_read_b128 a[104:107], v2 offset:10240
M v[136:139], a[72:75], v[40:43], v[136:139]
 ds_read_b128 a[108:111], v2 offset:11264
M v[136:139], a[76:79], v[56:59], v[136:139]
 buffer_load_dwordx4 v3, s[8:11], s21 offen offset:1024 sc1 lds
M v[140:143], a[76:79], v[60:63], v[140:143]
 ds_read_b128 a[112:115], v2 offset:12288
M v[140:143], a[72:75], v[44:47], v[140:143]
 ds_read_b128 a[116:119], v2 offset:13312
M v[144:147], a[80:83], v[40:43], v[144:147]
 v_exp_f32 v18, v96
M v[144:147], a[84:87], v[56:59], v[144:147]
 ds_read_b128 a[120:123], v2 offset:14336
M v[148:151], a[84:87], v[60:63], v[148:151]
 ds_read_b128 a[124:127], v2 offset:15360
M v[148:151], a[80:83], v[44:47], v[148:151]
 buffer_load_dwordx4 v3, s[8:11], s21 offen offset:2048 sc1 lds
M v[152:155], a[88:91], v[40:43], v[152:155]
 v_exp_f32 v19, v97
M v[152:155], a[92:95], v[56:59], v[152:155]
 v_exp_f32 v20, v98
M v[156:159], a[92:95], v[60:63], v[156:159]
 buffer_load_dwordx4 v3, s[8:11], s21 offen offset:3072 sc1 lds
M v[156:159], a[88:91], v[44:47], v[156:159]
 s_waitcnt lgkmcnt(0)
 v_exp_f32 v21, v99
M v[160:163], a[96:99], v[40:43], v[160:163]
 ds_read_b128 a[64:67], v2 offset:16384
 v_add_f32 v28, v18, v19
M v[160:163], a[100:103], v[56:59], v[160:163]
 s_add_u32 m0, s28, 36864
 ds_read_b128 a[68:71], v2 offset:17408
 v_cvt_pk_bf16_f32 v48, v18, v19
M v[164:167], a[100:103], v[60:63], v[164:167]
 buffer_load_dwordx4 v4, s[8:11], s21 offen offset:0 sc1 lds
M v[164:167], a[96:99], v[44:47], v[164:167]
 ds_read_b128 a[72:75], v2 offset:18432
 v_add_f32 v28, v20, v28
M v[168:171], a[104:107], v[40:43], v[168:171]
 ds_read_b128 a[76:79], v2 offset:19456
 v_cvt_pk_bf16_f32 v49, v20, v21
M v[168:171], a[108:111], v[56:59], v[168:171]
 v_exp_f32 v22, v104
M v[172:175], a[108:111], v[60:63], v[172:175]
 ds_read_b128 a[80:83], v2 offset:20480
 v_add_f32 v28, v21, v28
M v[172:175], a[104:107], v[44:47], v[172:175]
 ds_read_b128 a[84:87], v2 offset:21504
M v[176:179], a[112:115], v[40:43], v[176:179]
 buffer_load_dwordx4 v4, s[8:11], s21 offen offset:1024 sc1 lds
M v[176:179], a[116:119], v[56:59], v[176:179]
 ds_read_b128 a[88:91], v2 offset:22528
M v[180:183], a[116:119], v[60:63], v[180:183]
 ds_read_b128 a[92:95], v2 offset:23552
M v[180:183], a[112:115], v[44:47], v[180:183]
 buffer_load_dwordx4 v4, s[8:11], s21 offen offset:2048 sc1 lds
M v[184:187], a[120:123], v[40:43], v[184:187]
 v_exp_f32 v23, v105
M v[184:187], a[124:127], v[56:59], v[184:187]
 v_exp_f32 v24, v106
M v[188:191], a[124:127], v[60:63], v[188:191]
 v_exp_f32 v25, v107
M v[188:191], a[120:123], v[44:47], v[188:191]
 s_waitcnt lgkmcnt(0)
 v_exp_f32 v18, v100
M v[192:195], a[64:67], v[40:43], v[192:195]
 ds_read_b128 a[96:99], v2 offset:24576
 v_add_f32 v28, v22, v28
M v[192:195], a[68:71], v[56:59], v[192:195]
 ds_read_b128 a[100:103], v2 offset:25600
 v_cvt_pk_bf16_f32 v50, v22, v23
M v[196:199], a[68:71], v[60:63], v[196:199]
 buffer_load_dwordx4 v4, s[8:11], s21 offen offset:3072 sc1 lds
M v[196:199], a[64:67], v[44:47], v[196:199]
 s_add_u32 s24, s23, 16777216
 ds_read_b128 a[104:107], v2 offset:26624
 v_add_f32 v28, v23, v28
M v[200:203], a[72:75], v[40:43], v[200:203]
 s_mov_b32 s23, s21
 ds_read_b128 a[108:111], v2 offset:27648
 v_add_f32 v28, v24, v28
M v[200:203], a[76:79], v[56:59], v[200:203]
 s_add_u32 s21, s21, 32768
 v_exp_f32 v19, v101
M v[204:207], a[76:79], v[60:63], v[204:207]
 s_add_u32 s22, s22, 1
 ds_read_b128 a[112:115], v2 offset:28672
 v_cvt_pk_bf16_f32 v51, v24, v25
M v[204:207], a[72:75], v[44:47], v[204:207]
 s_cmp_eq_u32 s22, s25
 ds_read_b128 a[116:119], v2 offset:29696
 v_add_f32 v28, v25, v28
M v[208:211], a[80:83], v[40:43], v[208:211]
 s_cselect_b32 s21, s26, s21
 v_exp_f32 v20, v102
M v[208:211], a[84:87], v[56:59], v[208:211]
 s_cmp_eq_u32 s22, s43
 ds_read_b128 a[120:123], v2 offset:30720
 v_add_f32 v29, v18, v19
M v[212:215], a[84:87], v[60:63], v[212:215]
 s_cselect_b32 s21, s4, s21
 ds_read_b128 a[124:127], v2 offset:31744
 v_cvt_pk_bf16_f32 v52, v18, v19
M v[212:215], a[80:83], v[44:47], v[212:215]
 s_cmp_eq_u32 s22, s6
 v_exp_f32 v21, v103
M v[216:219], a[88:91], v[40:43], v[216:219]
 s_cselect_b32 s21, s7, s21
 v_exp_f32 v22, v108
M v[216:219], a[92:95], v[56:59], v[216:219]
 v_add_f32 v29, v20, v29
 v_cvt_pk_bf16_f32 v53, v20, v21
M v[220:223], a[92:95], v[60:63], v[220:223]
 s_waitcnt vmcnt(16) lgkmcnt(0)
 v_exp_f32 v23, v109
M v[220:223], a[88:91], v[44:47], v[220:223]
 s_barrier
M v[224:227], a[96:99], v[40:43], v[224:227]
 ds_read_b128 a[64:67], v2 offset:32768
 v_add_f32 v29, v21, v29
M v[224:227], a[100:103], v[56:59], v[224:227]
 ds_read_b128 a[68:71], v2 offset:33792
 v_add_f32 v29, v22, v29
M v[228:231], a[100:103], v[60:63], v[228:231]
 v_cmp_gt_u32 vcc, s39, v6
 v_cvt_pk_bf16_f32 v54, v22, v23
M v[228:231], a[96:99], v[44:47], v[228:231]
 ds_read_b128 a[72:75], v2 offset:34816
 v_add_f32 v29, v23, v29
M v[232:235], a[104:107], v[40:43], v[232:235]
 ds_read_b128 a[76:79], v2 offset:35840
M v[232:235], a[108:111], v[56:59], v[232:235]
 s_cbranch_vccnz L_fls0
L_flr0:
 v_exp_f32 v24, v110
M v[236:239], a[108:111], v[60:63], v[236:239]
 s_and_b32 s3, s5, 15
 ds_read_b128 a[80:83], v2 offset:36864
M v[236:239], a[104:107], v[44:47], v[236:239]
 s_cbranch_scc1 L_pub3
L_pub3r:
 ds_read_b128 a[84:87], v2 offset:37888
M v[240:243], a[112:115], v[40:43], v[240:243]
 s_lshr_b32 s5, s5, 4
 v_exp_f32 v25, v111
M v[240:243], a[116:119], v[56:59], v[240:243]
 ds_read_b128 a[88:91], v2 offset:38912
 v_add_f32 v29, v24, v29
M v[244:247], a[116:119], v[60:63], v[244:247]
 ds_read_b128 a[92:95], v2 offset:39936
 v_cvt_pk_bf16_f32 v55, v24, v25
M v[244:247], a[112:115], v[44:47], v[244:247]
 v_add_f32 v29, v25, v29
M v[248:251], a[120:123], v[40:43], v[248:251]
 s_sub_u32 s27, s27, 1
M v[248:251], a[124:127], v[56:59], v[248:251]
 s_cmp_lg_u32 s27, 0
M v[252:255], a[124:127], v[60:63], v[252:255]
 s_waitcnt lgkmcnt(0)
M v[252:255], a[120:123], v[44:47], v[252:255]
 s_cbranch_scc1 L_loop_top
L_p1:
 s_cmp_eq_u32 s40, 0
 s_cbranch_scc1 L_final_h
 s_cmp_ge_u32 s42, 10
 s_cbranch_scc1 L_p1c
 v_cndmask_b32 v64, v32, v8, s[64:65]
 v_cndmask_b32 v65, v32, v8, s[66:67]
 v_cndmask_b32 v66, v32, v8, s[68:69]
 v_cndmask_b32 v67, v32, v8, s[70:71]
 s_nop 1
M v[64:67], a[64:67], a[0:3], v[64:67]
 s_add_u32 m0, s28, 65536
 ds_read_b128 a[96:99], v2 offset:40960
 v_cndmask_b32 v72, v32, v8, s[72:73]
M v[64:67], a[68:71], a[4:7], v[64:67]
 ds_read_b128 a[100:103], v2 offset:41984
 v_cndmask_b32 v73, v32, v8, s[74:75]
M v[64:67], a[72:75], a[8:11], v[64:67]
 buffer_load_dwordx4 v3, s[8:11], s24 offen offset:0 sc1 lds
M v[64:67], a[76:79], a[12:15], v[64:67]
 ds_read_b128 a[104:107], v2 offset:43008
 v_cndmask_b32 v74, v32, v8, s[76:77]
M v[64:67], a[80:83], a[16:19], v[64:67]
 ds_read_b128 a[108:111], v2 offset:44032
 v_cndmask_b32 v75, v32, v8, s[78:79]
M v[64:67], a[84:87], a[20:23], v[64:67]
 v_exp_f32 v18, v112
M v[64:67], a[88:91], a[24:27], v[64:67]
 ds_read_b128 a[112:115], v2 offset:45056
M v[64:67], a[92:95], a[28:31], v[64:67]
 ds_read_b128 a[116:119], v2 offset:46080
M v[68:71], a[92:95], a[60:63], v[36:39]
 buffer_load_dwordx4 v3, s[8:11], s24 offen offset:1024 sc1 lds
M v[68:71], a[88:91], a[56:59], v[68:71]
 ds_read_b128 a[120:123], v2 offset:47104
M v[68:71], a[84:87], a[52:55], v[68:71]
 ds_read_b128 a[124:127], v2 offset:48128
M v[68:71], a[80:83], a[48:51], v[68:71]
 v_exp_f32 v19, v113
M v[68:71], a[76:79], a[44:47], v[68:71]
 buffer_load_dwordx4 v3, s[8:11], s24 offen offset:2048 sc1 lds
M v[68:71], a[72:75], a[40:43], v[68:71]
 v_exp_f32 v20, v114
M v[68:71], a[68:71], a[36:39], v[68:71]
 v_exp_f32 v21, v115
M v[68:71], a[64:67], a[32:35], v[68:71]
 s_waitcnt lgkmcnt(0)
 v_exp_f32 v22, v120
M v[72:75], a[96:99], a[0:3], v[72:75]
 ds_read_b128 a[64:67], v2 offset:49152
 v_cndmask_b32 v80, v32, v8, s[80:81]
M v[72:75], a[100:103], a[4:7], v[72:75]
 ds_read_b128 a[68:71], v2 offset:50176
 v_cndmask_b32 v81, v32, v8, s[82:83]
M v[72:75], a[104:107], a[8:11], v[72:75]
 buffer_load_dwordx4 v3, s[8:11], s24 offen offset:3072 sc1 lds
M v[72:75], a[108:111], a[12:15], v[72:75]
 ds_read_b128 a[72:75], v2 offset:51200
 v_cndmask_b32 v82, v32, v8, s[84:85]
M v[72:75], a[112:115], a[16:19], v[72:75]
 ds_read_b128 a[76:79], v2 offset:52224
 v_cndmask_b32 v83, v32, v8, s[86:87]
M v[72:75], a[116:119], a[20:23], v[72:75]
 v_exp_f32 v23, v121
M v[72:75], a[120:123], a[24:27], v[72:75]
 s_add_u32 m0, s28, 69632
 ds_read_b128 a[80:83], v2 offset:53248
 v_add_f32 v28, v18, v28
M v[72:75], a[124:127], a[28:31], v[72:75]
 ds_read_b128 a[84:87], v2 offset:54272
 v_cvt_pk_bf16_f32 v56, v18, v19
M v[76:79], a[124:127], a[60:63], v[36:39]
 buffer_load_dwordx4 v4, s[8:11], s24 offen offset:0 sc1 lds
M v[76:79], a[120:123], a[56:59], v[76:79]
 ds_read_b128 a[88:91], v2 offset:55296
 v_add_f32 v28, v19, v28
M v[76:79], a[116:119], a[52:55], v[76:79]
 ds_read_b128 a[92:95], v2 offset:56320
 v_add_f32 v28, v20, v28
M v[76:79], a[112:115], a[48:51], v[76:79]
 v_exp_f32 v24, v122
M v[76:79], a[108:111], a[44:47], v[76:79]
 buffer_load_dwordx4 v4, s[8:11], s24 offen offset:1024 sc1 lds
M v[76:79], a[104:107], a[40:43], v[76:79]
 v_exp_f32 v25, v123
M v[76:79], a[100:103], a[36:39], v[76:79]
 v_exp_f32 v18, v116
M v[76:79], a[96:99], a[32:35], v[76:79]
 s_waitcnt lgkmcnt(0)
 v_exp_f32 v19, v117
M v[80:83], a[64:67], a[0:3], v[80:83]
 ds_read_b128 a[96:99], v2 offset:57344
 v_cndmask_b32 v88, v32, v8, s[88:89]
M v[80:83], a[68:71], a[4:7], v[80:83]
 ds_read_b128 a[100:103], v2 offset:58368
 v_cndmask_b32 v89, v32, v8, s[90:91]
M v[80:83], a[72:75], a[8:11], v[80:83]
 buffer_load_dwordx4 v4, s[8:11], s24 offen offset:2048 sc1 lds
M v[80:83], a[76:79], a[12:15], v[80:83]
 ds_read_b128 a[104:107], v2 offset:59392
 v_cndmask_b32 v90, v32, v8, s[92:93]
M v[80:83], a[80:83], a[16:19], v[80:83]
 ds_read_b128 a[108:111], v2 offset:60416
 v_cndmask_b32 v91, v32, v8, s[94:95]
M v[80:83], a[84:87], a[20:23], v[80:83]
 v_cvt_pk_bf16_f32 v57, v20, v21
 v_add_f32 v28, v21, v28
M v[80:83], a[88:91], a[24:27], v[80:83]
 ds_read_b128 a[112:115], v2 offset:61440
 v_add_f32 v28, v22, v28
M v[80:83], a[92:95], a[28:31], v[80:83]
 ds_read_b128 a[116:119], v2 offset:62464
 v_cvt_pk_bf16_f32 v58, v22, v23
M v[84:87], a[92:95], a[60:63], v[36:39]
 buffer_load_dwordx4 v4, s[8:11], s24 offen offset:3072 sc1 lds
M v[84:87], a[88:91], a[56:59], v[84:87]
 ds_read_b128 a[120:123], v2 offset:63488
 v_add_f32 v28, v23, v28
M v[84:87], a[84:87], a[52:55], v[84:87]
 ds_read_b128 a[124:127], v2 offset:64512
 v_add_f32 v28, v24, v28
M v[84:87], a[80:83], a[48:51], v[84:87]
 v_exp_f32 v20, v118
M v[84:87], a[76:79], a[44:47], v[84:87]
 v_exp_f32 v21, v119
M v[84:87], a[72:75], a[40:43], v[84:87]
 v_exp_f32 v22, v124
M v[84:87], a[68:71], a[36:39], v[84:87]
 s_waitcnt vmcnt(16) lgkmcnt(0)
 v_exp_f32 v23, v125
M v[84:87], a[64:67], a[32:35], v[84:87]
 s_barrier
M v[88:91], a[96:99], a[0:3], v[88:91]
 ds_read_b128 a[64:67], v7 offset:0
 v_cvt_pk_bf16_f32 v59, v24, v25
M v[88:91], a[100:103], a[4:7], v[88:91]
 ds_read_b128 a[68:71], v7 offset:1024
 v_add_f32 v28, v25, v28
M v[88:91], a[104:107], a[8:11], v[88:91]
 v_exp_f32 v24, v126
M v[88:91], a[108:111], a[12:15], v[88:91]
 ds_read_b128 a[72:75], v7 offset:2048
 v_add_f32 v29, v18, v29
M v[88:91], a[112:115], a[16:19], v[88:91]
 ds_read_b128 a[76:79], v7 offset:3072
 v_cvt_pk_bf16_f32 v60, v18, v19
M v[88:91], a[116:119], a[20:23], v[88:91]
 v_exp_f32 v25, v127
M v[88:91], a[120:123], a[24:27], v[88:91]
 ds_read_b128 a[80:83], v7 offset:4096
 v_add_f32 v29, v19, v29
M v[88:91], a[124:127], a[28:31], v[88:91]
 ds_read_b128 a[84:87], v7 offset:5120
 v_add_f32 v29, v20, v29
M v[92:95], a[124:127], a[60:63], v[36:39]
 v_cvt_pk_bf16_f32 v61, v20, v21
 v_add_f32 v29, v21, v29
M v[92:95], a[120:123], a[56:59], v[92:95]
 ds_read_b128 a[88:91], v7 offset:6144
 v_add_f32 v29, v22, v29
M v[92:95], a[116:119], a[52:55], v[92:95]
 ds_read_b128 a[92:95], v7 offset:7168
 v_cvt_pk_bf16_f32 v62, v22, v23
M v[92:95], a[112:115], a[48:51], v[92:95]
 v_add_f32 v29, v23, v29
 v_add_f32 v29, v24, v29
M v[92:95], a[108:111], a[44:47], v[92:95]
 v_cvt_pk_bf16_f32 v63, v24, v25
 v_add_f32 v29, v25, v29
M v[92:95], a[104:107], a[40:43], v[92:95]
M v[92:95], a[100:103], a[36:39], v[92:95]
 s_waitcnt lgkmcnt(0)
M v[92:95], a[96:99], a[32:35], v[92:95]
 v_max_f32 v10, v28, v29
 v_cmp_lt_f32 vcc, s31, v10
 s_nop 0
 s_cbranch_vccnz L_st5
L_rt5:
M v[128:131], a[64:67], v[48:51], v[128:131]
 s_add_u32 m0, s28, 98304
 ds_read_b128 a[96:99], v7 offset:8192
 v_add_f32 v30, v28, v30
M v[128:131], a[68:71], v[56:59], v[128:131]
 ds_read_b128 a[100:103], v7 offset:9216
 v_add_f32 v31, v29, v31
M v[132:135], a[68:71], v[60:63], v[132:135]
 buffer_load_dwordx4 v3, s[8:11], s21 offen offset:0 sc1 lds
M v[132:135], a[64:67], v[52:55], v[132:135]
 s_cmp_eq_u32 s20, 3
 ds_read_b128 a[104:107], v7 offset:10240
M v[136:139], a[72:75], v[48:51], v[136:139]
 s_cselect_b64 s[64:65], s[16:17], 0
 ds_read_b128 a[108:111], v7 offset:11264
M v[136:139], a[76:79], v[56:59], v[136:139]
 buffer_load_dwordx4 v3, s[8:11], s21 offen offset:1024 sc1 lds
M v[140:143], a[76:79], v[60:63], v[140:143]
 s_cselect_b64 s[66:67], s[18:19], 0
 ds_read_b128 a[112:115], v7 offset:12288
M v[140:143], a[72:75], v[52:55], v[140:143]
 s_cselect_b64 s[68:69], s[48:49], 0
 ds_read_b128 a[116:119], v7 offset:13312
M v[144:147], a[80:83], v[48:51], v[144:147]
 s_cselect_b64 s[70:71], s[50:51], 0
 v_exp_f32 v18, v64
M v[144:147], a[84:87], v[56:59], v[144:147]
 s_cmp_gt_u32 s20, 2
 ds_read_b128 a[120:123], v7 offset:14336
M v[148:151], a[84:87], v[60:63], v[148:151]
 s_cselect_b64 s[78:79], -1, 0
 ds_read_b128 a[124:127], v7 offset:15360
M v[148:151], a[80:83], v[52:55], v[148:151]
 buffer_load_dwordx4 v3, s[8:11], s21 offen offset:2048 sc1 lds
M v[152:155], a[88:91], v[48:51], v[152:155]
 v_exp_f32 v19, v65
M v[152:155], a[92:95], v[56:59], v[152:155]
 v_exp_f32 v20, v66
M v[156:159], a[92:95], v[60:63], v[156:159]
 buffer_load_dwordx4 v3, s[8:11], s21 offen offset:3072 sc1 lds
M v[156:159], a[88:91], v[52:55], v[156:159]
 s_waitcnt lgkmcnt(0)
 v_exp_f32 v21, v67
M v[160:163], a[96:99], v[48:51], v[160:163]
 ds_read_b128 a[64:67], v7 offset:16384
 v_add_f32 v26, v18, v19
M v[160:163], a[100:103], v[56:59], v[160:163]
 s_add_u32 m0, s28, 102400
 ds_read_b128 a[68:71], v7 offset:17408
 v_cvt_pk_bf16_f32 v40, v18, v19
M v[164:167], a[100:103], v[60:63], v[164:167]
 buffer_load_dwordx4 v4, s[8:11], s21 offen offset:0 sc1 lds
M v[164:167], a[96:99], v[52:55], v[164:167]
 s_cmp_eq_u32 s20, 2
 ds_read_b128 a[72:75], v7 offset:18432
 v_add_f32 v26, v20, v26
M v[168:171], a[104:107], v[48:51], v[168:171]
 s_cselect_b64 s[72:73], s[16:17], s[78:79]
 ds_read_b128 a[76:79], v7 offset:19456
 v_cvt_pk_bf16_f32 v41, v20, v21
M v[168:171], a[108:111], v[56:59], v[168:171]
 s_cselect_b64 s[74:75], s[18:19], s[78:79]
 v_exp_f32 v22, v72
M v[172:175], a[108:111], v[60:63], v[172:175]
 s_cselect_b64 s[76:77], s[48:49], s[78:79]
 ds_read_b128 a[80:83], v7 offset:20480
 v_add_f32 v26, v21, v26
M v[172:175], a[104:107], v[52:55], v[172:175]
 s_cselect_b64 s[78:79], s[50:51], s[78:79]
 ds_read_b128 a[84:87], v7 offset:21504
M v[176:179], a[112:115], v[48:51], v[176:179]
 buffer_load_dwordx4 v4, s[8:11], s21 offen offset:1024 sc1 lds
M v[176:179], a[116:119], v[56:59], v[176:179]
 s_cmp_gt_u32 s20, 1
 ds_read_b128 a[88:91], v7 offset:22528
M v[180:183], a[116:119], v[60:63], v[180:183]
 s_cselect_b64 s[86:87], -1, 0
 ds_read_b128 a[92:95], v7 offset:23552
M v[180:183], a[112:115], v[52:55], v[180:183]
 buffer_load_dwordx4 v4, s[8:11], s21 offen offset:2048 sc1 lds
M v[184:187], a[120:123], v[48:51], v[184:187]
 s_cmp_eq_u32 s20, 1
 v_exp_f32 v23, v73
M v[184:187], a[124:127], v[56:59], v[184:187]
 s_cselect_b64 s[80:81], s[16:17], s[86:87]
 v_exp_f32 v24, v74
M v[188:191], a[124:127], v[60:63], v[188:191]
 s_cselect_b64 s[82:83], s[18:19], s[86:87]
 v_exp_f32 v25, v75
M v[188:191], a[120:123], v[52:55], v[188:191]
 s_waitcnt lgkmcnt(0)
 v_exp_f32 v18, v68
M v[192:195], a[64:67], v[48:51], v[192:195]
 s_cselect_b64 s[84:85], s[48:49], s[86:87]
 ds_read_b128 a[96:99], v7 offset:24576
 v_add_f32 v26, v22, v26
M v[192:195], a[68:71], v[56:59], v[192:195]
 s_cselect_b64 s[86:87], s[50:51], s[86:87]
 ds_read_b128 a[100:103], v7 offset:25600
 v_cvt_pk_bf16_f32 v42, v22, v23
M v[196:199], a[68:71], v[60:63], v[196:199]
 buffer_load_dwordx4 v4, s[8:11], s21 offen offset:3072 sc1 lds
M v[196:199], a[64:67], v[52:55], v[196:199]
 s_add_u32 s24, s23, 16777216
 ds_read_b128 a[104:107], v7 offset:26624
 v_add_f32 v26, v23, v26
M v[200:203], a[72:75], v[48:51], v[200:203]
 s_mov_b32 s23, s21
 ds_read_b128 a[108:111], v7 offset:27648
 v_add_f32 v26, v24, v26
M v[200:203], a[76:79], v[56:59], v[200:203]
 s_add_u32 s21, s21, 32768
 v_exp_f32 v19, v69
M v[204:207], a[76:79], v[60:63], v[204:207]
 s_add_u32 s22, s22, 1
 ds_read_b128 a[112:115], v7 offset:28672
 v_cvt_pk_bf16_f32 v43, v24, v25
M v[204:207], a[72:75], v[52:55], v[204:207]
 s_cmp_eq_u32 s22, s25
 ds_read_b128 a[116:119], v7 offset:29696
 v_add_f32 v26, v25, v26
M v[208:211], a[80:83], v[48:51], v[208:211]
 s_cselect_b32 s21, s26, s21
 v_exp_f32 v20, v70
M v[208:211], a[84:87], v[56:59], v[208:211]
 s_cmp_eq_u32 s22, s43
 ds_read_b128 a[120:123], v7 offset:30720
 v_add_f32 v27, v18, v19
M v[212:215], a[84:87], v[60:63], v[212:215]
 s_cselect_b32 s21, s4, s21
 ds_read_b128 a[124:127], v7 offset:31744
 v_cvt_pk_bf16_f32 v44, v18, v19
M v[212:215], a[80:83], v[52:55], v[212:215]
 s_cmp_eq_u32 s22, s6
 v_exp_f32 v21, v71
M v[216:219], a[88:91], v[48:51], v[216:219]
 s_cselect_b32 s21, s7, s21
 v_exp_f32 v22, v76
M v[216:219], a[92:95], v[56:59], v[216:219]
 s_cmp_eq_u32 s20, 0
 v_exp_f32 v23, v77
M v[220:223], a[92:95], v[60:63], v[220:223]
 s_waitcnt vmcnt(16) lgkmcnt(0)
 v_exp_f32 v24, v78
M v[220:223], a[88:91], v[52:55], v[220:223]
 s_barrier
M v[224:227], a[96:99], v[48:51], v[224:227]
 s_cselect_b64 s[88:89], s[16:17], -1
 ds_read_b128 a[64:67], v7 offset:32768
 v_add_f32 v27, v20, v27
M v[224:227], a[100:103], v[56:59], v[224:227]
 s_cselect_b64 s[90:91], s[18:19], -1
 ds_read_b128 a[68:71], v7 offset:33792
 v_cvt_pk_bf16_f32 v45, v20, v21
M v[228:231], a[100:103], v[60:63], v[228:231]
 buffer_load_dword v5, off, s[8:11], s47 sc1
M v[228:231], a[96:99], v[52:55], v[228:231]
 s_cselect_b64 s[92:93], s[48:49], -1
 ds_read_b128 a[72:75], v7 offset:34816
 v_add_f32 v27, v21, v27
M v[232:235], a[104:107], v[48:51], v[232:235]
 s_cselect_b64 s[94:95], s[50:51], -1
 ds_read_b128 a[76:79], v7 offset:35840
 v_add_f32 v27, v22, v27
M v[232:235], a[108:111], v[56:59], v[232:235]
 v_cndmask_b32 v100, v36, v8, s[64:65]
 v_cndmask_b32 v101, v36, v8, s[66:67]
M v[236:239], a[108:111], v[60:63], v[236:239]
 ds_read_b128 a[80:83], v7 offset:36864
 v_cndmask_b32 v102, v36, v8, s[68:69]
M v[236:239], a[104:107], v[52:55], v[236:239]
 ds_read_b128 a[84:87], v7 offset:37888
 v_cndmask_b32 v103, v36, v8, s[70:71]
M v[240:243], a[112:115], v[48:51], v[240:243]
 v_cndmask_b32 v108, v36, v8, s[72:73]
 v_cndmask_b32 v109, v36, v8, s[74:75]
M v[240:243], a[116:119], v[56:59], v[240:243]
 ds_read_b128 a[88:91], v7 offset:38912
 v_cndmask_b32 v110, v36, v8, s[76:77]
M v[244:247], a[116:119], v[60:63], v[244:247]
 ds_read_b128 a[92:95], v7 offset:39936
 v_cndmask_b32 v111, v36, v8, s[78:79]
M v[244:247], a[112:115], v[52:55], v[244:247]
 v_cndmask_b32 v116, v36, v8, s[80:81]
 v_cndmask_b32 v117, v36, v8, s[82:83]
M v[248:251], a[120:123], v[48:51], v[248:251]
 v_cndmask_b32 v118, v36, v8, s[84:85]
 v_cndmask_b32 v119, v36, v8, s[86:87]
M v[248:251], a[124:127], v[56:59], v[248:251]
 v_cndmask_b32 v124, v36, v8, s[88:89]
 v_cndmask_b32 v125, v36, v8, s[90:91]
M v[252:255], a[124:127], v[60:63], v[252:255]
 s_waitcnt lgkmcnt(0)
 v_cndmask_b32 v126, v36, v8, s[92:93]
 v_cndmask_b32 v127, v36, v8, s[94:95]
M v[252:255], a[120:123], v[52:55], v[252:255]
 v_exp_f32 v25, v79
 v_cvt_pk_bf16_f32 v46, v22, v23
 v_add_f32 v27, v23, v27
 v_add_f32 v27, v24, v27
 v_cvt_pk_bf16_f32 v47, v24, v25
 v_add_f32 v27, v25, v27
L_p2:
M v[100:103], a[64:67], a[32:35], v[100:103]
 ds_read_b128 a[96:99], v7 offset:40960
 ds_read_b128 a[100:103], v7 offset:41984
 v_exp_f32 v18, v80
M v[100:103], a[68:71], a[36:39], v[100:103]
 ds_read_b128 a[104:107], v7 offset:43008
 v_exp_f32 v19, v81
M v[100:103], a[72:75], a[40:43], v[100:103]
 ds_read_b128 a[108:111], v7 offset:44032
 ds_read_b128 a[112:115], v7 offset:45056
 v_exp_f32 v20, v82
 v_add_f32 v26, v18, v26
M v[100:103], a[76:79], a[44:47], v[100:103]
 ds_read_b128 a[116:119], v7 offset:46080
 v_cvt_pk_bf16_f32 v56, v18, v19
 v_exp_f32 v21, v83
M v[100:103], a[80:83], a[48:51], v[100:103]
 s_add_u32 m0, s28, 0
 ds_read_b128 a[120:123], v7 offset:47104
 ds_read_b128 a[124:127], v7 offset:48128
 v_add_f32 v26, v19, v26
M v[100:103], a[84:87], a[52:55], v[100:103]
 buffer_load_dwordx4 v3, s[8:11], s24 offen offset:0 sc1 lds
M v[100:103], a[88:91], a[56:59], v[100:103]
 ds_read_b128 a[128:131], v7 offset:49152
 ds_read_b128 a[132:135], v7 offset:50176
 v_exp_f32 v22, v88
 v_add_f32 v26, v20, v26
 v_cvt_pk_bf16_f32 v57, v20, v21
M v[100:103], a[92:95], a[60:63], v[100:103]
 s_waitcnt lgkmcnt(2)
 ds_read_b128 a[136:139], v7 offset:51200
 v_exp_f32 v23, v89
 v_add_f32 v26, v21, v26
M v[108:111], a[124:127], a[60:63], v[108:111]
 ds_read_b128 a[140:143], v7 offset:52224
 ds_read_b128 a[144:147], v7 offset:53248
 v_exp_f32 v24, v90
M v[108:111], a[120:123], a[56:59], v[108:111]
 buffer_load_dwordx4 v3, s[8:11], s24 offen offset:1024 sc1 lds
M v[108:111], a[116:119], a[52:55], v[108:111]
 ds_read_b128 a[148:151], v7 offset:54272
 ds_read_b128 a[152:155], v7 offset:55296
 v_add_f32 v26, v22, v26
 v_cvt_pk_bf16_f32 v58, v22, v23
M v[108:111], a[112:115], a[48:51], v[108:111]
 ds_read_b128 a[156:159], v7 offset:56320
 v_exp_f32 v25, v91
 v_add_f32 v26, v23, v26
M v[108:111], a[108:111], a[44:47], v[108:111]
 ds_read_b128 a[160:163], v7 offset:57344
 ds_read_b128 a[164:167], v7 offset:58368
 v_exp_f32 v18, v84
M v[108:111], a[104:107], a[40:43], v[108:111]
 buffer_load_dwordx4 v3, s[8:11], s24 offen offset:2048 sc1 lds
M v[108:111], a[100:103], a[36:39], v[108:111]
 ds_read_b128 a[168:171], v7 offset:59392
 ds_read_b128 a[172:175], v7 offset:60416
 v_add_f32 v26, v24, v26
 v_cvt_pk_bf16_f32 v59, v24, v25
M v[108:111], a[96:99], a[32:35], v[108:111]
 s_waitcnt lgkmcnt(4)
 ds_read_b128 a[176:179], v7 offset:61440
 v_exp_f32 v19, v85
 v_add_f32 v26, v25, v26
M v[116:119], a[128:131], a[32:35], v[116:119]
 ds_read_b128 a[180:183], v7 offset:62464
 ds_read_b128 a[184:187], v7 offset:63488
 v_exp_f32 v20, v86
M v[116:119], a[132:135], a[36:39], v[116:119]
 ds_read_b128 a[188:191], v7 offset:64512
 v_add_f32 v27, v18, v27
 v_cvt_pk_bf16_f32 v60, v18, v19
M v[116:119], a[136:139], a[40:43], v[116:119]
 buffer_load_dwordx4 v3, s[8:11], s24 offen offset:3072 sc1 lds
M v[116:119], a[140:143], a[44:47], v[116:119]
 s_add_u32 m0, s28, 4096
 v_exp_f32 v21, v87
 v_add_f32 v27, v19, v27
 v_exp_f32 v22, v92
M v[116:119], a[144:147], a[48:51], v[116:119]
 buffer_load_dwordx4 v4, s[8:11], s24 offen offset:0 sc1 lds
M v[116:119], a[148:151], a[52:55], v[116:119]
 s_waitcnt vmcnt(14) lgkmcnt(0)
 v_add_f32 v27, v20, v27
 v_cvt_pk_bf16_f32 v61, v20, v21
 v_exp_f32 v23, v93
 v_add_f32 v27, v21, v27
M v[116:119], a[152:155], a[56:59], v[116:119]
 s_barrier
M v[116:119], a[156:159], a[60:63], v[116:119]
 ds_read_b128 a[64:67], v2 offset:0
 ds_read_b128 a[68:71], v2 offset:1024
 v_exp_f32 v24, v94
M v[124:127], a[188:191], a[60:63], v[124:127]
 ds_read_b128 a[72:75], v2 offset:2048
 v_add_f32 v27, v22, v27
 v_cvt_pk_bf16_f32 v62, v22, v23
M v[124:127], a[184:187], a[56:59], v[124:127]
 ds_read_b128 a[76:79], v2 offset:3072
 ds_read_b128 a[80:83], v2 offset:4096
 v_exp_f32 v25, v95
 v_add_f32 v27, v23, v27
M v[124:127], a[180:183], a[52:55], v[124:127]
 ds_read_b128 a[84:87], v2 offset:5120
 v_add_f32 v27, v24, v27
 v_cvt_pk_bf16_f32 v63, v24, v25
 v_add_f32 v27, v25, v27
M v[124:127], a[176:179], a[48:51], v[124:127]
 ds_read_b128 a[88:91], v2 offset:6144
 ds_read_b128 a[92:95], v2 offset:7168
 v_max_f32 v10, v26, v27
 v_cmp_lt_f32 vcc, s31, v10
M v[124:127], a[172:175], a[44:47], v[124:127]
 buffer_load_dwordx4 v4, s[8:11], s24 offen offset:1024 sc1 lds
M v[124:127], a[168:171], a[40:43], v[124:127]
 buffer_load_dwordx4 v4, s[8:11], s24 offen offset:2048 sc1 lds
M v[124:127], a[164:167], a[36:39], v[124:127]
 buffer_load_dwordx4 v4, s[8:11], s24 offen offset:3072 sc1 lds
M v[124:127], a[160:163], a[32:35], v[124:127]
 s_waitcnt lgkmcnt(0)
 s_cbranch_vccnz L_st6
L_rt6:
 s_cmp_le_u32 s42, 5
 s_cbranch_scc1 L_p3k
L_p3o:
M v[128:131], a[64:67], v[40:43], v[128:131]
 s_add_u32 m0, s28, 32768
 ds_read_b128 a[96:99], v2 offset:8192
 v_add_f32 v30, v26, v30
M v[128:131], a[68:71], v[56:59], v[128:131]
 ds_read_b128 a[100:103], v2 offset:9216
 v_add_f32 v31, v27, v31
M v[132:135], a[68:71], v[60:63], v[132:135]
 buffer_load_dwordx4 v3, s[8:11], s21 offen offset:0 sc1 lds
M v[132:135], a[64:67], v[44:47], v[132:135]
 ds_read_b128 a[104:107], v2 offset:10240
M v[136:139], a[72:75], v[40:43], v[136:139]
 ds_read_b128 a[108:111], v2 offset:11264
M v[136:139], a[76:79], v[56:59], v[136:139]
 buffer_load_dwordx4 v3, s[8:11], s21 offen offset:1024 sc1 lds
M v[140:143], a[76:79], v[60:63], v[140:143]
 ds_read_b128 a[112:115], v2 offset:12288
M v[140:143], a[72:75], v[44:47], v[140:143]
 ds_read_b128 a[116:119], v2 offset:13312
M v[144:147], a[80:83], v[40:43], v[144:147]
 v_exp_f32 v18, v100
M v[144:147], a[84:87], v[56:59], v[144:147]
 ds_read_b128 a[120:123], v2 offset:14336
M v[148:151], a[84:87], v[60:63], v[148:151]
 ds_read_b128 a[124:127], v2 offset:15360
M v[148:151], a[80:83], v[44:47], v[148:151]
 buffer_load_dwordx4 v3, s[8:11], s21 offen offset:2048 sc1 lds
M v[152:155], a[88:91], v[40:43], v[152:155]
 v_exp_f32 v19, v101
M v[152:155], a[92:95], v[56:59], v[152:155]
 v_exp_f32 v20, v102
M v[156:159], a[92:95], v[60:63], v[156:159]
 buffer_load_dwordx4 v3, s[8:11], s21 offen offset:3072 sc1 lds
M v[156:159], a[88:91], v[44:47], v[156:159]
 s_waitcnt lgkmcnt(0)
 v_exp_f32 v21, v103
M v[160:163], a[96:99], v[40:43], v[160:163]
 ds_read_b128 a[64:67], v2 offset:16384
 v_add_f32 v29, v18, v19
M v[160:163], a[100:103], v[56:59], v[160:163]
 s_add_u32 m0, s28, 36864
 ds_read_b128 a[68:71], v2 offset:17408
 v_cvt_pk_bf16_f32 v52, v18, v19
M v[164:167], a[100:103], v[60:63], v[164:167]
 buffer_load_dwordx4 v4, s[8:11], s21 offen offset:0 sc1 lds
M v[164:167], a[96:99], v[44:47], v[164:167]
 ds_read_b128 a[72:75], v2 offset:18432
 v_add_f32 v29, v20, v29
M v[168:171], a[104:107], v[40:43], v[168:171]
 ds_read_b128 a[76:79], v2 offset:19456
 v_cvt_pk_bf16_f32 v53, v20, v21
M v[168:171], a[108:111], v[56:59], v[168:171]
 v_exp_f32 v22, v108
M v[172:175], a[108:111], v[60:63], v[172:175]
 ds_read_b128 a[80:83], v2 offset:20480
 v_add_f32 v29, v21, v29
M v[172:175], a[104:107], v[44:47], v[172:175]
 ds_read_b128 a[84:87], v2 offset:21504
M v[176:179], a[112:115], v[40:43], v[176:179]
 buffer_load_dwordx4 v4, s[8:11], s21 offen offset:1024 sc1 lds
M v[176:179], a[116:119], v[56:59], v[176:179]
 ds_read_b128 a[88:91], v2 offset:22528
M v[180:183], a[116:119], v[60:63], v[180:183]
 ds_read_b128 a[92:95], v2 offset:23552
M v[180:183], a[112:115], v[44:47], v[180:183]
 buffer_load_dwordx4 v4, s[8:11], s21 offen offset:2048 sc1 lds
M v[184:187], a[120:123], v[40:43], v[184:187]
 v_exp_f32 v23, v109
M v[184:187], a[124:127], v[56:59], v[184:187]
 v_exp_f32 v24, v110
M v[188:191], a[124:127], v[60:63], v[188:191]
 v_exp_f32 v25, v111
M v[188:191], a[120:123], v[44:47], v[188:191]
 s_waitcnt lgkmcnt(0)
 v_exp_f32 v18, v116
M v[192:195], a[64:67], v[40:43], v[192:195]
 ds_read_b128 a[96:99], v2 offset:24576
 v_add_f32 v29, v22, v29
M v[192:195], a[68:71], v[56:59], v[192:195]
 ds_read_b128 a[100:103], v2 offset:25600
 v_cvt_pk_bf16_f32 v54, v22, v23
M v[196:199], a[68:71], v[60:63], v[196:199]
 buffer_load_dwordx4 v4, s[8:11], s21 offen offset:3072 sc1 lds
M v[196:199], a[64:67], v[44:47], v[196:199]
 s_add_u32 s24, s23, 16777216
 ds_read_b128 a[104:107], v2 offset:26624
 v_add_f32 v29, v23, v29
M v[200:203], a[72:75], v[40:43], v[200:203]
 s_mov_b32 s23, s21
 ds_read_b128 a[108:111], v2 offset:27648
 v_add_f32 v29, v24, v29
M v[200:203], a[76:79], v[56:59], v[200:203]
 s_add_u32 s21, s21, 32768
 v_exp_f32 v19, v117
M v[204:207], a[76:79], v[60:63], v[204:207]
 s_add_u32 s22, s22, 1
 ds_read_b128 a[112:115], v2 offset:28672
 v_cvt_pk_bf16_f32 v55, v24, v25
M v[204:207], a[72:75], v[44:47], v[204:207]
 s_cmp_eq_u32 s22, s25
 ds_read_b128 a[116:119], v2 offset:29696
 v_add_f32 v29, v25, v29
M v[208:211], a[80:83], v[40:43], v[208:211]
 s_cselect_b32 s21, s26, s21
 v_exp_f32 v20, v118
M v[208:211], a[84:87], v[56:59], v[208:211]
 s_cmp_eq_u32 s22, s43
 ds_read_b128 a[120:123], v2 offset:30720
 v_add_f32 v29, v18, v29
M v[212:215], a[84:87], v[60:63], v[212:215]
 s_cselect_b32 s21, s4, s21
 ds_read_b128 a[124:127], v2 offset:31744
 v_cvt_pk_bf16_f32 v48, v18, v19
M v[212:215], a[80:83], v[44:47], v[212:215]
 s_cmp_eq_u32 s22, s6
 v_exp_f32 v21, v119
M v[216:219], a[88:91], v[40:43], v[216:219]
 s_cselect_b32 s21, s7, s21
 v_exp_f32 v22, v124
M v[216:219], a[92:95], v[56:59], v[216:219]
 v_exp_f32 v23, v125
M v[220:223], a[92:95], v[60:63], v[220:223]
 s_waitcnt vmcnt(8) lgkmcnt(0)
 v_add_f32 v29, v19, v29
 v_add_f32 v29, v20, v29
M v[220:223], a[88:91], v[44:47], v[220:223]
 s_barrier
M v[224:227], a[96:99], v[40:43], v[224:227]
 ds_read_b128 a[64:67], v7 offset:0
 v_cvt_pk_bf16_f32 v49, v20, v21
M v[224:227], a[100:103], v[56:59], v[224:227]
 ds_read_b128 a[68:71], v7 offset:1024
 v_add_f32 v29, v21, v29
M v[228:231], a[100:103], v[60:63], v[228:231]
 v_exp_f32 v24, v126
M v[228:231], a[96:99], v[44:47], v[228:231]
 ds_read_b128 a[72:75], v7 offset:2048
 v_add_f32 v29, v22, v29
M v[232:235], a[104:107], v[40:43], v[232:235]
 ds_read_b128 a[76:79], v7 offset:3072
 v_cvt_pk_bf16_f32 v50, v22, v23
M v[232:235], a[108:111], v[56:59], v[232:235]
 v_exp_f32 v25, v127
M v[236:239], a[108:111], v[60:63], v[236:239]
 ds_read_b128 a[80:83], v7 offset:4096
 v_add_f32 v29, v23, v29
M v[236:239], a[104:107], v[44:47], v[236:239]
 ds_read_b128 a[84:87], v7 offset:5120
 v_add_f32 v29, v24, v29
M v[240:243], a[112:115], v[40:43], v[240:243]
 v_cvt_pk_bf16_f32 v51, v24, v25
 v_add_f32 v29, v25, v29
M v[240:243], a[116:119], v[56:59], v[240:243]
 ds_read_b128 a[88:91], v7 offset:6144
M v[244:247], a[116:119], v[60:63], v[244:247]
 ds_read_b128 a[92:95], v7 offset:7168
M v[244:247], a[112:115], v[44:47], v[244:247]
 v_cmp_lt_f32 vcc, s31, v29
M v[248:251], a[120:123], v[40:43], v[248:251]
M v[248:251], a[124:127], v[56:59], v[248:251]
M v[252:255], a[124:127], v[60:63], v[252:255]
 s_waitcnt lgkmcnt(0)
M v[252:255], a[120:123], v[44:47], v[252:255]
 s_cbranch_vccnz L_st2
L_rt2:
L_pBo:
M v[132:135], a[64:67], v[52:55], v[132:135]
 ds_read_b128 a[96:99], v7 offset:8192
 ds_read_b128 a[100:103], v7 offset:9216
M v[132:135], a[68:71], v[48:51], v[132:135]
 ds_read_b128 a[104:107], v7 offset:10240
 v_cvt_pk_bf16_f32 v128, v128, v129
 v_cvt_pk_bf16_f32 v129, v130, v131
M v[140:143], a[76:79], v[48:51], v[140:143]
 ds_read_b128 a[108:111], v7 offset:11264
 ds_read_b128 a[112:115], v7 offset:12288
 v_cvt_pk_bf16_f32 v130, v136, v137
M v[140:143], a[72:75], v[52:55], v[140:143]
 ds_read_b128 a[116:119], v7 offset:13312
 v_cvt_pk_bf16_f32 v131, v138, v139
 v_cvt_pk_bf16_f32 v144, v144, v145
M v[148:151], a[80:83], v[52:55], v[148:151]
 s_add_u32 m0, s28, 65536
 ds_read_b128 a[120:123], v7 offset:14336
 ds_read_b128 a[124:127], v7 offset:15360
M v[148:151], a[84:87], v[48:51], v[148:151]
 buffer_load_dwordx4 v3, s[8:11], s38 offen offset:0 sc1 lds
M v[156:159], a[92:95], v[48:51], v[156:159]
 ds_read_b128 a[128:131], v7 offset:16384
 ds_read_b128 a[132:135], v7 offset:17408
 v_cvt_pk_bf16_f32 v145, v146, v147
M v[156:159], a[88:91], v[52:55], v[156:159]
 s_waitcnt lgkmcnt(2)
 ds_read_b128 a[136:139], v7 offset:18432
 v_cvt_pk_bf16_f32 v146, v152, v153
 v_cvt_pk_bf16_f32 v147, v154, v155
M v[164:167], a[96:99], v[52:55], v[164:167]
 ds_read_b128 a[140:143], v7 offset:19456
 ds_read_b128 a[144:147], v7 offset:20480
 v_cvt_pk_bf16_f32 v160, v160, v161
M v[164:167], a[100:103], v[48:51], v[164:167]
 buffer_load_dwordx4 v3, s[8:11], s38 offen offset:1024 sc1 lds
M v[172:175], a[108:111], v[48:51], v[172:175]
 ds_read_b128 a[148:151], v7 offset:21504
 ds_read_b128 a[152:155], v7 offset:22528
 v_cvt_pk_bf16_f32 v161, v162, v163
M v[172:175], a[104:107], v[52:55], v[172:175]
 ds_read_b128 a[156:159], v7 offset:23552
 v_cvt_pk_bf16_f32 v162, v168, v169
 v_cvt_pk_bf16_f32 v163, v170, v171
M v[180:183], a[112:115], v[52:55], v[180:183]
 ds_read_b128 a[160:163], v7 offset:24576
 ds_read_b128 a[164:167], v7 offset:25600
 v_cvt_pk_bf16_f32 v176, v176, v177
M v[180:183], a[116:119], v[48:51], v[180:183]
 buffer_load_dwordx4 v3, s[8:11], s38 offen offset:2048 sc1 lds
M v[188:191], a[124:127], v[48:51], v[188:191]
 ds_read_b128 a[168:171], v7 offset:26624
 ds_read_b128 a[172:175], v7 offset:27648
 v_cvt_pk_bf16_f32 v177, v178, v179
M v[188:191], a[120:123], v[52:55], v[188:191]
 s_waitcnt lgkmcnt(4)
 ds_read_b128 a[176:179], v7 offset:28672
 v_cvt_pk_bf16_f32 v178, v184, v185
M v[196:199], a[128:131], v[52:55], v[196:199]
 ds_read_b128 a[180:183], v7 offset:29696
 ds_read_b128 a[184:187], v7 offset:30720
 v_cvt_pk_bf16_f32 v179, v186, v187
M v[196:199], a[132:135], v[48:51], v[196:199]
 ds_read_b128 a[188:191], v7 offset:31744
 v_cvt_pk_bf16_f32 v192, v192, v193
 v_cvt_pk_bf16_f32 v193, v194, v195
M v[204:207], a[140:143], v[48:51], v[204:207]
 buffer_load_dwordx4 v3, s[8:11], s38 offen offset:3072 sc1 lds
M v[204:207], a[136:139], v[52:55], v[204:207]
 s_add_u32 m0, s28, 69632
 v_cvt_pk_bf16_f32 v194, v200, v201
 v_cvt_pk_bf16_f32 v195, v202, v203
 v_cvt_pk_bf16_f32 v208, v208, v209
M v[212:215], a[144:147], v[52:55], v[212:215]
 buffer_load_dwordx4 v4, s[8:11], s38 offen offset:0 sc1 lds
M v[212:215], a[148:151], v[48:51], v[212:215]
 s_waitcnt lgkmcnt(0)
 v_cvt_pk_bf16_f32 v209, v210, v211
 v_cvt_pk_bf16_f32 v210, v216, v217
 v_cvt_pk_bf16_f32 v211, v218, v219
M v[220:223], a[156:159], v[48:51], v[220:223]
 s_barrier
M v[220:223], a[152:155], v[52:55], v[220:223]
 ds_read_b128 a[64:67], v2 offset:32768
 ds_read_b128 a[68:71], v2 offset:33792
 v_cvt_pk_bf16_f32 v224, v224, v225
M v[228:231], a[160:163], v[52:55], v[228:231]
 ds_read_b128 a[72:75], v2 offset:34816
 v_cvt_pk_bf16_f32 v225, v226, v227
 v_cvt_pk_bf16_f32 v226, v232, v233
M v[228:231], a[164:167], v[48:51], v[228:231]
 ds_read_b128 a[76:79], v2 offset:35840
 ds_read_b128 a[80:83], v2 offset:36864
M v[236:239], a[172:175], v[48:51], v[236:239]
 ds_read_b128 a[84:87], v2 offset:37888
 v_cvt_pk_bf16_f32 v227, v234, v235
 v_cvt_pk_bf16_f32 v240, v240, v241
M v[236:239], a[168:171], v[52:55], v[236:239]
 ds_read_b128 a[88:91], v2 offset:38912
 ds_read_b128 a[92:95], v2 offset:39936
 v_cvt_pk_bf16_f32 v241, v242, v243
M v[244:247], a[176:179], v[52:55], v[244:247]
 buffer_load_dwordx4 v4, s[8:11], s38 offen offset:1024 sc1 lds
M v[244:247], a[180:183], v[48:51], v[244:247]
 buffer_load_dwordx4 v4, s[8:11], s38 offen offset:2048 sc1 lds
M v[252:255], a[188:191], v[48:51], v[252:255]
 buffer_load_dwordx4 v4, s[8:11], s38 offen offset:3072 sc1 lds
M v[252:255], a[184:187], v[52:55], v[252:255]
 s_waitcnt lgkmcnt(0)
 s_add_u32 s38, s38, 32768
 v_cvt_pk_bf16_f32 v242, v248, v249
 v_cvt_pk_bf16_f32 v243, v250, v251
 s_branch L_op1
L_p1c:
 v_cndmask_b32 v64, v32, v8, s[64:65]
 v_cndmask_b32 v65, v32, v8, s[66:67]
 v_cndmask_b32 v66, v32, v8, s[68:69]
 v_cndmask_b32 v67, v32, v8, s[70:71]
 s_nop 1
M v[64:67], a[64:67], a[0:3], v[64:67]
 s_add_u32 m0, s28, 65536
 ds_read_b128 a[96:99], v2 offset:40960
 ds_read_b128 a[100:103], v2 offset:41984
M v[64:67], a[68:71], a[4:7], v[64:67]
 buffer_load_dwordx4 v3, s[8:11], s24 offen offset:0 sc1 lds
M v[64:67], a[72:75], a[8:11], v[64:67]
 v_exp_f32 v18, v112
M v[64:67], a[76:79], a[12:15], v[64:67]
 ds_read_b128 a[104:107], v2 offset:43008
 ds_read_b128 a[108:111], v2 offset:44032
M v[64:67], a[80:83], a[16:19], v[64:67]
 buffer_load_dwordx4 v[14:17], v7, s[8:11], s52 offen sc1
M v[64:67], a[84:87], a[20:23], v[64:67]
 s_cmp_eq_u32 s20, 3
 v_exp_f32 v19, v113
M v[64:67], a[88:91], a[24:27], v[64:67]
 s_cselect_b64 s[64:65], s[16:17], 0
 ds_read_b128 a[112:115], v2 offset:45056
 ds_read_b128 a[116:119], v2 offset:46080
M v[64:67], a[92:95], a[28:31], v[64:67]
 s_cselect_b64 s[66:67], s[18:19], 0
 v_exp_f32 v20, v114
M v[68:71], a[92:95], a[60:63], v[36:39]
 s_cselect_b64 s[68:69], s[48:49], 0
 v_add_f32 v28, v18, v28
 v_cvt_pk_bf16_f32 v56, v18, v19
M v[68:71], a[88:91], a[56:59], v[68:71]
 s_cselect_b64 s[70:71], s[50:51], 0
 ds_read_b128 a[120:123], v2 offset:47104
 ds_read_b128 a[124:127], v2 offset:48128
M v[68:71], a[84:87], a[52:55], v[68:71]
 buffer_load_dwordx4 v3, s[8:11], s24 offen offset:1024 sc1 lds
M v[68:71], a[80:83], a[48:51], v[68:71]
 v_cndmask_b32 v72, v32, v8, s[72:73]
 v_cndmask_b32 v73, v32, v8, s[74:75]
M v[68:71], a[76:79], a[44:47], v[68:71]
 v_cndmask_b32 v74, v32, v8, s[76:77]
 v_cndmask_b32 v75, v32, v8, s[78:79]
M v[68:71], a[72:75], a[40:43], v[68:71]
 buffer_load_dwordx4 a[128:131], v7, s[8:11], s12 offen offset:0 sc1
M v[68:71], a[68:71], a[36:39], v[68:71]
 buffer_load_dwordx4 a[132:135], v7, s[8:11], s12 offen offset:1024 sc1
M v[68:71], a[64:67], a[32:35], v[68:71]
 s_waitcnt lgkmcnt(0)
 v_exp_f32 v21, v115
M v[72:75], a[96:99], a[0:3], v[72:75]
 ds_read_b128 a[64:67], v2 offset:49152
 ds_read_b128 a[68:71], v2 offset:50176
M v[72:75], a[100:103], a[4:7], v[72:75]
 buffer_load_dwordx4 v3, s[8:11], s24 offen offset:2048 sc1 lds
M v[72:75], a[104:107], a[8:11], v[72:75]
 v_exp_f32 v22, v120
M v[72:75], a[108:111], a[12:15], v[72:75]
 ds_read_b128 a[72:75], v2 offset:51200
 ds_read_b128 a[76:79], v2 offset:52224
M v[72:75], a[112:115], a[16:19], v[72:75]
 buffer_load_dwordx4 v3, s[8:11], s24 offen offset:3072 sc1 lds
M v[72:75], a[116:119], a[20:23], v[72:75]
 s_cmp_gt_u32 s20, 2
 v_exp_f32 v23, v121
M v[72:75], a[120:123], a[24:27], v[72:75]
 s_cselect_b64 s[78:79], -1, 0
 ds_read_b128 a[80:83], v2 offset:53248
 ds_read_b128 a[84:87], v2 offset:54272
M v[72:75], a[124:127], a[28:31], v[72:75]
 s_cmp_eq_u32 s20, 2
 v_exp_f32 v24, v122
M v[76:79], a[124:127], a[60:63], v[36:39]
 s_cselect_b64 s[72:73], s[16:17], s[78:79]
 v_exp_f32 v25, v123
M v[76:79], a[120:123], a[56:59], v[76:79]
 s_cselect_b64 s[74:75], s[18:19], s[78:79]
 ds_read_b128 a[88:91], v2 offset:55296
 ds_read_b128 a[92:95], v2 offset:56320
M v[76:79], a[116:119], a[52:55], v[76:79]
 s_cselect_b64 s[76:77], s[48:49], s[78:79]
 v_add_f32 v28, v19, v28
 v_add_f32 v28, v20, v28
M v[76:79], a[112:115], a[48:51], v[76:79]
 s_cselect_b64 s[78:79], s[50:51], s[78:79]
 v_cndmask_b32 v80, v32, v8, s[80:81]
 v_cndmask_b32 v81, v32, v8, s[82:83]
M v[76:79], a[108:111], a[44:47], v[76:79]
 s_add_u32 m0, s28, 69632
 v_cndmask_b32 v82, v32, v8, s[84:85]
 v_cndmask_b32 v83, v32, v8, s[86:87]
M v[76:79], a[104:107], a[40:43], v[76:79]
 buffer_load_dwordx4 a[136:139], v7, s[8:11], s12 offen offset:2048 sc1
M v[76:79], a[100:103], a[36:39], v[76:79]
 buffer_load_dwordx4 v4, s[8:11], s24 offen offset:0 sc1 lds
M v[76:79], a[96:99], a[32:35], v[76:79]
 s_waitcnt lgkmcnt(0)
 v_exp_f32 v18, v116
M v[80:83], a[64:67], a[0:3], v[80:83]
 ds_read_b128 a[96:99], v2 offset:57344
 ds_read_b128 a[100:103], v2 offset:58368
M v[80:83], a[68:71], a[4:7], v[80:83]
 buffer_load_dwordx4 a[140:143], v7, s[8:11], s12 offen offset:3072 sc1
M v[80:83], a[72:75], a[8:11], v[80:83]
 buffer_load_dwordx4 v4, s[8:11], s24 offen offset:1024 sc1 lds
M v[80:83], a[76:79], a[12:15], v[80:83]
 ds_read_b128 a[104:107], v2 offset:59392
 ds_read_b128 a[108:111], v2 offset:60416
M v[80:83], a[80:83], a[16:19], v[80:83]
 buffer_load_dwordx4 a[144:147], v7, s[8:11], s13 offen offset:0 sc1
M v[80:83], a[84:87], a[20:23], v[80:83]
 s_cmp_gt_u32 s20, 1
 v_exp_f32 v19, v117
M v[80:83], a[88:91], a[24:27], v[80:83]
 s_cselect_b64 s[86:87], -1, 0
 ds_read_b128 a[112:115], v2 offset:61440
 ds_read_b128 a[116:119], v2 offset:62464
M v[80:83], a[92:95], a[28:31], v[80:83]
 s_cmp_eq_u32 s20, 1
 v_cvt_pk_bf16_f32 v57, v20, v21
 v_add_f32 v28, v21, v28
M v[84:87], a[92:95], a[60:63], v[36:39]
 s_cselect_b64 s[80:81], s[16:17], s[86:87]
 v_exp_f32 v20, v118
M v[84:87], a[88:91], a[56:59], v[84:87]
 s_cselect_b64 s[82:83], s[18:19], s[86:87]
 ds_read_b128 a[120:123], v2 offset:63488
 ds_read_b128 a[124:127], v2 offset:64512
M v[84:87], a[84:87], a[52:55], v[84:87]
 s_cselect_b64 s[84:85], s[48:49], s[86:87]
 v_exp_f32 v21, v119
M v[84:87], a[80:83], a[48:51], v[84:87]
 s_cselect_b64 s[86:87], s[50:51], s[86:87]
 v_cndmask_b32 v88, v32, v8, s[88:89]
 v_cndmask_b32 v89, v32, v8, s[90:91]
M v[84:87], a[76:79], a[44:47], v[84:87]
 v_cndmask_b32 v90, v32, v8, s[92:93]
 v_cndmask_b32 v91, v32, v8, s[94:95]
M v[84:87], a[72:75], a[40:43], v[84:87]
 buffer_load_dwordx4 v4, s[8:11], s24 offen offset:2048 sc1 lds
M v[84:87], a[68:71], a[36:39], v[84:87]
 s_waitcnt vmcnt(21) lgkmcnt(0)
 v_add_f32 v28, v22, v28
 v_cvt_pk_bf16_f32 v58, v22, v23
M v[84:87], a[64:67], a[32:35], v[84:87]
 s_barrier
M v[88:91], a[96:99], a[0:3], v[88:91]
 ds_read_b128 a[64:67], v7 offset:0
 ds_read_b128 a[68:71], v7 offset:1024
M v[88:91], a[100:103], a[4:7], v[88:91]
 s_cmp_eq_u32 s20, 0
 v_add_f32 v28, v23, v28
 v_add_f32 v28, v24, v28
M v[88:91], a[104:107], a[8:11], v[88:91]
 s_cselect_b64 s[88:89], s[16:17], -1
 v_exp_f32 v22, v124
M v[88:91], a[108:111], a[12:15], v[88:91]
 s_cselect_b64 s[90:91], s[18:19], -1
 ds_read_b128 a[72:75], v7 offset:2048
 ds_read_b128 a[76:79], v7 offset:3072
M v[88:91], a[112:115], a[16:19], v[88:91]
 s_cselect_b64 s[92:93], s[48:49], -1
 v_exp_f32 v23, v125
M v[88:91], a[116:119], a[20:23], v[88:91]
 s_cselect_b64 s[94:95], s[50:51], -1
 v_cvt_pk_bf16_f32 v59, v24, v25
 v_add_f32 v28, v25, v28
M v[88:91], a[120:123], a[24:27], v[88:91]
 ds_read_b128 a[80:83], v7 offset:4096
 ds_read_b128 a[84:87], v7 offset:5120
M v[88:91], a[124:127], a[28:31], v[88:91]
 buffer_load_dwordx4 a[148:151], v7, s[8:11], s13 offen offset:1024 sc1
M v[92:95], a[124:127], a[60:63], v[36:39]
 buffer_load_dwordx4 v4, s[8:11], s24 offen offset:3072 sc1 lds
M v[92:95], a[120:123], a[56:59], v[92:95]
 ds_read_b128 a[88:91], v7 offset:6144
 ds_read_b128 a[92:95], v7 offset:7168
M v[92:95], a[116:119], a[52:55], v[92:95]
 buffer_load_dwordx4 a[152:155], v7, s[8:11], s13 offen offset:2048 sc1
M v[92:95], a[112:115], a[48:51], v[92:95]
 v_exp_f32 v24, v126
M v[92:95], a[108:111], a[44:47], v[92:95]
 buffer_load_dwordx4 a[156:159], v7, s[8:11], s13 offen offset:3072 sc1
M v[92:95], a[104:107], a[40:43], v[92:95]
 v_exp_f32 v25, v127
M v[92:95], a[100:103], a[36:39], v[92:95]
 s_waitcnt lgkmcnt(0)
 v_add_f32 v29, v18, v29
 v_cvt_pk_bf16_f32 v60, v18, v19
M v[92:95], a[96:99], a[32:35], v[92:95]
 v_add_f32 v29, v19, v29
 v_add_f32 v29, v20, v29
 v_cvt_pk_bf16_f32 v61, v20, v21
 v_add_f32 v29, v21, v29
 v_add_f32 v29, v22, v29
 v_cvt_pk_bf16_f32 v62, v22, v23
 v_add_f32 v29, v23, v29
 v_add_f32 v29, v24, v29
 v_cvt_pk_bf16_f32 v63, v24, v25
 v_add_f32 v29, v25, v29
 v_max_f32 v10, v28, v29
 v_cmp_lt_f32 vcc, s31, v10
 s_nop 0
 s_cbranch_vccnz L_st3
L_rt3:
M v[128:131], a[64:67], v[48:51], v[128:131]
 s_add_u32 m0, s28, 98304
 ds_read_b128 a[96:99], v7 offset:8192
 ds_read_b128 a[100:103], v7 offset:9216
M v[128:131], a[68:71], v[56:59], v[128:131]
 buffer_load_dwordx4 v3, s[8:11], s21 offen offset:0 sc1 lds
M v[132:135], a[68:71], v[60:63], v[132:135]
 v_exp_f32 v18, v64
M v[132:135], a[64:67], v[52:55], v[132:135]
 ds_read_b128 a[104:107], v7 offset:10240
 ds_read_b128 a[108:111], v7 offset:11264
M v[136:139], a[72:75], v[48:51], v[136:139]
 buffer_load_dwordx4 a[160:163], v7, s[8:11], s14 offen offset:0 sc1
M v[136:139], a[76:79], v[56:59], v[136:139]
 v_cndmask_b32 v100, v36, v8, s[64:65]
 v_add_f32 v30, v28, v30
M v[140:143], a[76:79], v[60:63], v[140:143]
 ds_read_b128 a[112:115], v7 offset:12288
 ds_read_b128 a[116:119], v7 offset:13312
M v[140:143], a[72:75], v[52:55], v[140:143]
 buffer_load_dwordx4 v3, s[8:11], s21 offen offset:1024 sc1 lds
M v[144:147], a[80:83], v[48:51], v[144:147]
 v_cndmask_b32 v101, v36, v8, s[66:67]
 v_add_f32 v31, v29, v31
M v[144:147], a[84:87], v[56:59], v[144:147]
 ds_read_b128 a[120:123], v7 offset:14336
 ds_read_b128 a[124:127], v7 offset:15360
M v[148:151], a[84:87], v[60:63], v[148:151]
 buffer_load_dwordx4 a[164:167], v7, s[8:11], s14 offen offset:1024 sc1
M v[148:151], a[80:83], v[52:55], v[148:151]
 v_cndmask_b32 v102, v36, v8, s[68:69]
M v[152:155], a[88:91], v[48:51], v[152:155]
 buffer_load_dwordx4 v3, s[8:11], s21 offen offset:2048 sc1 lds
M v[152:155], a[92:95], v[56:59], v[152:155]
 v_exp_f32 v19, v65
M v[156:159], a[92:95], v[60:63], v[156:159]
 buffer_load_dwordx4 a[168:171], v7, s[8:11], s14 offen offset:2048 sc1
M v[156:159], a[88:91], v[52:55], v[156:159]
 s_waitcnt lgkmcnt(0)
 v_cndmask_b32 v103, v36, v8, s[70:71]
 v_add_f32 v26, v18, v19
M v[160:163], a[96:99], v[48:51], v[160:163]
 ds_read_b128 a[64:67], v7 offset:16384
 ds_read_b128 a[68:71], v7 offset:17408
M v[160:163], a[100:103], v[56:59], v[160:163]
 buffer_load_dwordx4 v3, s[8:11], s21 offen offset:3072 sc1 lds
M v[164:167], a[100:103], v[60:63], v[164:167]
 v_cndmask_b32 v108, v36, v8, s[72:73]
 v_cvt_pk_bf16_f32 v40, v18, v19
M v[164:167], a[96:99], v[52:55], v[164:167]
 ds_read_b128 a[72:75], v7 offset:18432
 ds_read_b128 a[76:79], v7 offset:19456
M v[168:171], a[104:107], v[48:51], v[168:171]
 buffer_load_dwordx4 a[172:175], v7, s[8:11], s14 offen offset:3072 sc1
M v[168:171], a[108:111], v[56:59], v[168:171]
 v_exp_f32 v20, v66
M v[172:175], a[108:111], v[60:63], v[172:175]
 s_add_u32 m0, s28, 102400
 ds_read_b128 a[80:83], v7 offset:20480
 ds_read_b128 a[84:87], v7 offset:21504
M v[172:175], a[104:107], v[52:55], v[172:175]
 buffer_load_dwordx4 v4, s[8:11], s21 offen offset:0 sc1 lds
M v[176:179], a[112:115], v[48:51], v[176:179]
 v_cndmask_b32 v109, v36, v8, s[74:75]
M v[176:179], a[116:119], v[56:59], v[176:179]
 ds_read_b128 a[88:91], v7 offset:22528
 ds_read_b128 a[92:95], v7 offset:23552
M v[180:183], a[116:119], v[60:63], v[180:183]
 buffer_load_dwordx4 a[176:179], v7, s[8:11], s15 offen offset:0 sc1
M v[180:183], a[112:115], v[52:55], v[180:183]
 v_cndmask_b32 v110, v36, v8, s[76:77]
M v[184:187], a[120:123], v[48:51], v[184:187]
 buffer_load_dwordx4 v4, s[8:11], s21 offen offset:1024 sc1 lds
M v[184:187], a[124:127], v[56:59], v[184:187]
 v_cndmask_b32 v111, v36, v8, s[78:79]
M v[188:191], a[124:127], v[60:63], v[188:191]
 buffer_load_dwordx4 a[180:183], v7, s[8:11], s15 offen offset:1024 sc1
M v[188:191], a[120:123], v[52:55], v[188:191]
 s_waitcnt lgkmcnt(0)
 v_exp_f32 v21, v67
M v[192:195], a[64:67], v[48:51], v[192:195]
 ds_read_b128 a[96:99], v7 offset:24576
 ds_read_b128 a[100:103], v7 offset:25600
M v[192:195], a[68:71], v[56:59], v[192:195]
 buffer_load_dwordx4 v4, s[8:11], s21 offen offset:2048 sc1 lds
M v[196:199], a[68:71], v[60:63], v[196:199]
 v_cndmask_b32 v116, v36, v8, s[80:81]
 v_add_f32 v26, v20, v26
M v[196:199], a[64:67], v[52:55], v[196:199]
 ds_read_b128 a[104:107], v7 offset:26624
 ds_read_b128 a[108:111], v7 offset:27648
M v[200:203], a[72:75], v[48:51], v[200:203]
 buffer_load_dwordx4 a[184:187], v7, s[8:11], s15 offen offset:2048 sc1
M v[200:203], a[76:79], v[56:59], v[200:203]
 v_cndmask_b32 v117, v36, v8, s[82:83]
 v_cvt_pk_bf16_f32 v41, v20, v21
M v[204:207], a[76:79], v[60:63], v[204:207]
 ds_read_b128 a[112:115], v7 offset:28672
 ds_read_b128 a[116:119], v7 offset:29696
M v[204:207], a[72:75], v[52:55], v[204:207]
 buffer_load_dwordx4 v4, s[8:11], s21 offen offset:3072 sc1 lds
M v[208:211], a[80:83], v[48:51], v[208:211]
 s_add_u32 s24, s23, 16777216
 v_cndmask_b32 v118, v36, v8, s[84:85]
 v_add_f32 v26, v21, v26
M v[208:211], a[84:87], v[56:59], v[208:211]
 s_mov_b32 s23, s21
 ds_read_b128 a[120:123], v7 offset:30720
 ds_read_b128 a[124:127], v7 offset:31744
M v[212:215], a[84:87], v[60:63], v[212:215]
 buffer_load_dwordx4 a[188:191], v7, s[8:11], s15 offen offset:3072 sc1
M v[212:215], a[80:83], v[52:55], v[212:215]
 s_add_u32 s21, s21, 32768
 v_cndmask_b32 v119, v36, v8, s[86:87]
M v[216:219], a[88:91], v[48:51], v[216:219]
 s_add_u32 s22, s22, 1
 v_exp_f32 v22, v72
M v[216:219], a[92:95], v[56:59], v[216:219]
 s_cmp_eq_u32 s22, s25
 v_exp_f32 v23, v73
M v[220:223], a[92:95], v[60:63], v[220:223]
 s_waitcnt vmcnt(33) lgkmcnt(0)
 v_exp_f32 v24, v74
M v[220:223], a[88:91], v[52:55], v[220:223]
 s_barrier
M v[224:227], a[96:99], v[48:51], v[224:227]
 s_cselect_b32 s21, s26, s21
 ds_read_b128 a[64:67], v7 offset:32768
 ds_read_b128 a[68:71], v7 offset:33792
M v[224:227], a[100:103], v[56:59], v[224:227]
 s_cmp_eq_u32 s22, s43
 v_cndmask_b32 v124, v36, v8, s[88:89]
 v_add_f32 v26, v22, v26
M v[228:231], a[100:103], v[60:63], v[228:231]
 s_cselect_b32 s21, s4, s21
 v_exp_f32 v25, v75
M v[228:231], a[96:99], v[52:55], v[228:231]
 s_cmp_eq_u32 s22, s6
 ds_read_b128 a[72:75], v7 offset:34816
 ds_read_b128 a[76:79], v7 offset:35840
M v[232:235], a[104:107], v[48:51], v[232:235]
 s_cselect_b32 s21, s7, s21
 v_cndmask_b32 v125, v36, v8, s[90:91]
 v_cvt_pk_bf16_f32 v42, v22, v23
M v[232:235], a[108:111], v[56:59], v[232:235]
 v_exp_f32 v18, v68
M v[236:239], a[108:111], v[60:63], v[236:239]
 ds_read_b128 a[80:83], v7 offset:36864
 ds_read_b128 a[84:87], v7 offset:37888
M v[236:239], a[104:107], v[52:55], v[236:239]
 v_cndmask_b32 v126, v36, v8, s[92:93]
 v_add_f32 v26, v23, v26
M v[240:243], a[112:115], v[48:51], v[240:243]
 v_exp_f32 v19, v69
M v[240:243], a[116:119], v[56:59], v[240:243]
 ds_read_b128 a[88:91], v7 offset:38912
 ds_read_b128 a[92:95], v7 offset:39936
M v[244:247], a[116:119], v[60:63], v[244:247]
 v_cndmask_b32 v127, v36, v8, s[94:95]
 v_add_f32 v26, v24, v26
M v[244:247], a[112:115], v[52:55], v[244:247]
 v_exp_f32 v20, v70
M v[248:251], a[120:123], v[48:51], v[248:251]
 v_exp_f32 v21, v71
M v[248:251], a[124:127], v[56:59], v[248:251]
 v_exp_f32 v22, v76
M v[252:255], a[124:127], v[60:63], v[252:255]
 s_waitcnt lgkmcnt(0)
 v_exp_f32 v23, v77
M v[252:255], a[120:123], v[52:55], v[252:255]
 v_cvt_pk_bf16_f32 v43, v24, v25
 v_add_f32 v26, v25, v26
 v_add_f32 v27, v18, v19
 v_cvt_pk_bf16_f32 v44, v18, v19
 v_add_f32 v27, v20, v27
 v_cvt_pk_bf16_f32 v45, v20, v21
 v_add_f32 v27, v21, v27
 v_exp_f32 v24, v78
 v_add_f32 v27, v22, v27
 v_cvt_pk_bf16_f32 v46, v22, v23
 v_exp_f32 v25, v79
 v_add_f32 v27, v23, v27
 v_add_f32 v27, v24, v27
 v_cvt_pk_bf16_f32 v47, v24, v25
 v_add_f32 v27, v25, v27
 s_waitcnt vmcnt(31)
 v_cmp_neq_f32 vcc, v32, v14
 v_cmp_neq_f32 s[64:65], v36, v15
 s_nop 0
 s_or_b64 vcc, vcc, s[64:65]
 s_cbranch_vccnz L_comb
 v_add_f32 v30, v16, v30
 v_add_f32 v31, v17, v31
M v[100:103], a[64:67], a[32:35], v[100:103]
 ds_read_b128 a[96:99], v7 offset:40960
 ds_read_b128 a[100:103], v7 offset:41984
M v[100:103], a[68:71], a[36:39], v[100:103]
 ds_read_b128 a[104:107], v7 offset:43008
M v[100:103], a[72:75], a[40:43], v[100:103]
 ds_read_b128 a[108:111], v7 offset:44032
 ds_read_b128 a[112:115], v7 offset:45056
M v[100:103], a[76:79], a[44:47], v[100:103]
 ds_read_b128 a[116:119], v7 offset:46080
M v[100:103], a[80:83], a[48:51], v[100:103]
 s_add_u32 m0, s28, 0
 ds_read_b128 a[120:123], v7 offset:47104
 ds_read_b128 a[124:127], v7 offset:48128
M v[100:103], a[84:87], a[52:55], v[100:103]
 buffer_load_dwordx4 v3, s[8:11], s24 offen offset:0 sc1 lds
M v[100:103], a[88:91], a[56:59], v[100:103]
 ds_read_b128 a[0:3], v7 offset:49152
 ds_read_b128 a[4:7], v7 offset:50176
M v[100:103], a[92:95], a[60:63], v[100:103]
 s_waitcnt lgkmcnt(2)
 ds_read_b128 a[8:11], v7 offset:51200
M v[108:111], a[124:127], a[60:63], v[108:111]
 ds_read_b128 a[12:15], v7 offset:52224
 ds_read_b128 a[16:19], v7 offset:53248
M v[108:111], a[120:123], a[56:59], v[108:111]
 buffer_load_dwordx4 v3, s[8:11], s24 offen offset:1024 sc1 lds
M v[108:111], a[116:119], a[52:55], v[108:111]
 ds_read_b128 a[20:23], v7 offset:54272
 ds_read_b128 a[24:27], v7 offset:55296
M v[108:111], a[112:115], a[48:51], v[108:111]
 ds_read_b128 a[28:31], v7 offset:56320
M v[108:111], a[108:111], a[44:47], v[108:111]
 ds_read_b128 a[192:195], v7 offset:57344
 ds_read_b128 a[196:199], v7 offset:58368
M v[108:111], a[104:107], a[40:43], v[108:111]
 v_exp_f32 v18, v80
M v[108:111], a[100:103], a[36:39], v[108:111]
 ds_read_b128 a[200:203], v7 offset:59392
 ds_read_b128 a[204:207], v7 offset:60416
M v[108:111], a[96:99], a[32:35], v[108:111]
 s_waitcnt lgkmcnt(4)
 ds_read_b128 a[208:211], v7 offset:61440
M v[116:119], a[0:3], a[32:35], v[116:119]
 ds_read_b128 a[212:215], v7 offset:62464
 ds_read_b128 a[216:219], v7 offset:63488
M v[116:119], a[4:7], a[36:39], v[116:119]
 ds_read_b128 a[220:223], v7 offset:64512
M v[116:119], a[8:11], a[40:43], v[116:119]
 buffer_load_dwordx4 v3, s[8:11], s24 offen offset:2048 sc1 lds
M v[116:119], a[12:15], a[44:47], v[116:119]
 v_exp_f32 v19, v81
M v[116:119], a[16:19], a[48:51], v[116:119]
 buffer_load_dwordx4 v3, s[8:11], s24 offen offset:3072 sc1 lds
M v[116:119], a[20:23], a[52:55], v[116:119]
 v_exp_f32 v20, v82
M v[116:119], a[24:27], a[56:59], v[116:119]
 s_add_u32 m0, s28, 4096
 v_exp_f32 v21, v83
M v[116:119], a[28:31], a[60:63], v[116:119]
 s_waitcnt lgkmcnt(0)
 v_exp_f32 v22, v88
M v[124:127], a[220:223], a[60:63], v[124:127]
 buffer_load_dwordx4 v4, s[8:11], s24 offen offset:0 sc1 lds
M v[124:127], a[216:219], a[56:59], v[124:127]
 v_exp_f32 v23, v89
M v[124:127], a[212:215], a[52:55], v[124:127]
 v_exp_f32 v24, v90
M v[124:127], a[208:211], a[48:51], v[124:127]
 v_exp_f32 v25, v91
M v[124:127], a[204:207], a[44:47], v[124:127]
 v_add_f32 v26, v18, v26
 v_cvt_pk_bf16_f32 v56, v18, v19
M v[124:127], a[200:203], a[40:43], v[124:127]
 buffer_load_dwordx4 v4, s[8:11], s24 offen offset:1024 sc1 lds
M v[124:127], a[196:199], a[36:39], v[124:127]
 v_add_f32 v26, v19, v26
 v_add_f32 v26, v20, v26
M v[124:127], a[192:195], a[32:35], v[124:127]
 s_waitcnt vmcnt(22)
 v_exp_f32 v18, v84
M v[128:131], a[246:249], a[128:131], v[128:131]
 v_exp_f32 v19, v85
M v[136:139], a[244:247], a[128:131], v[136:139]
 v_cvt_pk_bf16_f32 v57, v20, v21
 v_add_f32 v26, v21, v26
M v[144:147], a[246:249], a[132:135], v[144:147]
 buffer_load_dwordx4 v4, s[8:11], s24 offen offset:2048 sc1 lds
M v[152:155], a[244:247], a[132:135], v[152:155]
 v_exp_f32 v20, v86
M v[160:163], a[246:249], a[136:139], v[160:163]
 v_add_f32 v26, v22, v26
 v_cvt_pk_bf16_f32 v58, v22, v23
M v[168:171], a[244:247], a[136:139], v[168:171]
 v_add_f32 v26, v23, v26
 v_add_f32 v26, v24, v26
M v[176:179], a[246:249], a[140:143], v[176:179]
 v_exp_f32 v21, v87
M v[184:187], a[244:247], a[140:143], v[184:187]
 buffer_load_dwordx4 v4, s[8:11], s24 offen offset:3072 sc1 lds
M v[192:195], a[246:249], a[144:147], v[192:195]
 v_cvt_pk_bf16_f32 v59, v24, v25
 v_add_f32 v26, v25, v26
M v[200:203], a[244:247], a[144:147], v[200:203]
 v_add_f32 v27, v18, v27
 v_cvt_pk_bf16_f32 v60, v18, v19
M v[208:211], a[246:249], a[148:151], v[208:211]
 v_exp_f32 v22, v92
M v[216:219], a[244:247], a[148:151], v[216:219]
 v_add_f32 v27, v19, v27
 v_add_f32 v27, v20, v27
M v[224:227], a[246:249], a[152:155], v[224:227]
 v_cvt_pk_bf16_f32 v61, v20, v21
 v_add_f32 v27, v21, v27
M v[232:235], a[244:247], a[152:155], v[232:235]
 s_waitcnt vmcnt(8)
 v_exp_f32 v23, v93
M v[240:243], a[246:249], a[156:159], v[240:243]
 v_add_f32 v27, v22, v27
 v_cvt_pk_bf16_f32 v62, v22, v23
M v[248:251], a[244:247], a[156:159], v[248:251]
 s_barrier
M v[132:135], a[246:249], a[160:163], v[132:135]
 ds_read_b128 a[64:67], v2 offset:0
 v_add_f32 v27, v23, v27
M v[140:143], a[244:247], a[160:163], v[140:143]
 ds_read_b128 a[68:71], v2 offset:1024
M v[148:151], a[246:249], a[164:167], v[148:151]
 v_exp_f32 v24, v94
M v[156:159], a[244:247], a[164:167], v[156:159]
 ds_read_b128 a[72:75], v2 offset:2048
M v[164:167], a[246:249], a[168:171], v[164:167]
 ds_read_b128 a[76:79], v2 offset:3072
M v[172:175], a[244:247], a[168:171], v[172:175]
 v_exp_f32 v25, v95
M v[180:183], a[246:249], a[172:175], v[180:183]
 ds_read_b128 a[80:83], v2 offset:4096
 v_add_f32 v27, v24, v27
M v[188:191], a[244:247], a[172:175], v[188:191]
 ds_read_b128 a[84:87], v2 offset:5120
 v_cvt_pk_bf16_f32 v63, v24, v25
M v[196:199], a[246:249], a[176:179], v[196:199]
 v_add_f32 v27, v25, v27
M v[204:207], a[244:247], a[176:179], v[204:207]
 ds_read_b128 a[88:91], v2 offset:6144
M v[212:215], a[246:249], a[180:183], v[212:215]
 ds_read_b128 a[92:95], v2 offset:7168
 v_max_f32 v10, v26, v27
M v[220:223], a[244:247], a[180:183], v[220:223]
 v_cmp_lt_f32 vcc, s31, v10
M v[228:231], a[246:249], a[184:187], v[228:231]
M v[236:239], a[244:247], a[184:187], v[236:239]
M v[244:247], a[246:249], a[188:191], v[244:247]
 s_waitcnt lgkmcnt(0)
M v[252:255], a[244:247], a[188:191], v[252:255]
 s_cbranch_vccnz L_st14
L_rt14:
 s_branch L_p3o
L_op1:
M v[64:67], a[64:67], v[128:131], 0
 ds_read_b128 a[96:99], v2 offset:40960
 ds_read_b128 a[100:103], v2 offset:41984
M v[64:67], a[68:71], v[144:147], v[64:67]
 ds_read_b128 a[104:107], v2 offset:43008
 v_cvt_pk_bf16_f32 v132, v132, v133
 v_cvt_pk_bf16_f32 v133, v134, v135
M v[64:67], a[72:75], v[160:163], v[64:67]
 ds_read_b128 a[108:111], v2 offset:44032
 ds_read_b128 a[112:115], v2 offset:45056
M v[64:67], a[76:79], v[176:179], v[64:67]
 ds_read_b128 a[116:119], v2 offset:46080
 v_cvt_pk_bf16_f32 v134, v140, v141
 v_cvt_pk_bf16_f32 v135, v142, v143
M v[64:67], a[80:83], v[192:195], v[64:67]
 s_add_u32 m0, s28, 0
 ds_read_b128 a[120:123], v2 offset:47104
 ds_read_b128 a[124:127], v2 offset:48128
M v[64:67], a[84:87], v[208:211], v[64:67]
 buffer_load_dwordx4 v3, s[8:11], s38 offen offset:0 sc1 lds
M v[64:67], a[88:91], v[224:227], v[64:67]
 ds_read_b128 a[128:131], v2 offset:49152
 ds_read_b128 a[132:135], v2 offset:50176
 v_cvt_pk_bf16_f32 v148, v148, v149
M v[64:67], a[92:95], v[240:243], v[64:67]
 s_waitcnt lgkmcnt(2)
 ds_read_b128 a[136:139], v2 offset:51200
 v_cvt_pk_bf16_f32 v149, v150, v151
M v[72:75], a[96:99], v[128:131], 0
 ds_read_b128 a[140:143], v2 offset:52224
 ds_read_b128 a[144:147], v2 offset:53248
M v[72:75], a[100:103], v[144:147], v[72:75]
 buffer_load_dwordx4 v3, s[8:11], s38 offen offset:1024 sc1 lds
M v[72:75], a[104:107], v[160:163], v[72:75]
 ds_read_b128 a[148:151], v2 offset:54272
 ds_read_b128 a[152:155], v2 offset:55296
 v_cvt_pk_bf16_f32 v150, v156, v157
M v[72:75], a[108:111], v[176:179], v[72:75]
 ds_read_b128 a[156:159], v2 offset:56320
 v_cvt_pk_bf16_f32 v151, v158, v159
M v[72:75], a[112:115], v[192:195], v[72:75]
 ds_read_b128 a[160:163], v2 offset:57344
 ds_read_b128 a[164:167], v2 offset:58368
 v_cvt_pk_bf16_f32 v164, v164, v165
M v[72:75], a[116:119], v[208:211], v[72:75]
 buffer_load_dwordx4 v3, s[8:11], s38 offen offset:2048 sc1 lds
M v[72:75], a[120:123], v[224:227], v[72:75]
 ds_read_b128 a[168:171], v2 offset:59392
 ds_read_b128 a[172:175], v2 offset:60416
M v[72:75], a[124:127], v[240:243], v[72:75]
 s_waitcnt lgkmcnt(4)
 ds_read_b128 a[176:179], v2 offset:61440
 v_cvt_pk_bf16_f32 v165, v166, v167
 v_cvt_pk_bf16_f32 v166, v172, v173
M v[80:83], a[128:131], v[128:131], 0
 ds_read_b128 a[180:183], v2 offset:62464
 ds_read_b128 a[184:187], v2 offset:63488
M v[80:83], a[132:135], v[144:147], v[80:83]
 ds_read_b128 a[188:191], v2 offset:64512
 v_cvt_pk_bf16_f32 v167, v174, v175
 v_cvt_pk_bf16_f32 v180, v180, v181
M v[80:83], a[136:139], v[160:163], v[80:83]
 buffer_load_dwordx4 v3, s[8:11], s38 offen offset:3072 sc1 lds
M v[80:83], a[140:143], v[176:179], v[80:83]
 s_add_u32 m0, s28, 4096
 v_cvt_pk_bf16_f32 v181, v182, v183
 v_cvt_pk_bf16_f32 v182, v188, v189
M v[80:83], a[144:147], v[192:195], v[80:83]
 buffer_load_dwordx4 v4, s[8:11], s38 offen offset:0 sc1 lds
M v[80:83], a[148:151], v[208:211], v[80:83]
 v_cvt_pk_bf16_f32 v183, v190, v191
 v_cvt_pk_bf16_f32 v196, v196, v197
M v[80:83], a[152:155], v[224:227], v[80:83]
 buffer_load_dwordx4 v4, s[8:11], s38 offen offset:1024 sc1 lds
M v[80:83], a[156:159], v[240:243], v[80:83]
 s_waitcnt lgkmcnt(0)
 v_cvt_pk_bf16_f32 v197, v198, v199
 v_cvt_pk_bf16_f32 v198, v204, v205
 v_cvt_pk_bf16_f32 v199, v206, v207
M v[88:91], a[160:163], v[128:131], 0
 v_cvt_pk_bf16_f32 v212, v212, v213
 v_cvt_pk_bf16_f32 v213, v214, v215
M v[88:91], a[164:167], v[144:147], v[88:91]
 v_cvt_pk_bf16_f32 v214, v220, v221
 v_cvt_pk_bf16_f32 v215, v222, v223
 v_cvt_pk_bf16_f32 v228, v228, v229
M v[88:91], a[168:171], v[160:163], v[88:91]
 buffer_load_dwordx4 v4, s[8:11], s38 offen offset:2048 sc1 lds
M v[88:91], a[172:175], v[176:179], v[88:91]
 v_cvt_pk_bf16_f32 v229, v230, v231
 v_cvt_pk_bf16_f32 v230, v236, v237
M v[88:91], a[176:179], v[192:195], v[88:91]
 v_cvt_pk_bf16_f32 v231, v238, v239
 v_cvt_pk_bf16_f32 v244, v244, v245
 v_cvt_pk_bf16_f32 v245, v246, v247
M v[88:91], a[180:183], v[208:211], v[88:91]
 buffer_load_dwordx4 v4, s[8:11], s38 offen offset:3072 sc1 lds
M v[88:91], a[184:187], v[224:227], v[88:91]
 v_cvt_pk_bf16_f32 v246, v252, v253
 v_cvt_pk_bf16_f32 v247, v254, v255
M v[88:91], a[188:191], v[240:243], v[88:91]
 s_add_u32 s38, s38, 32768
 v_add_f32 v31, v29, v31
 v_mov_b32 v10, v30
M v[68:71], a[64:67], v[132:135], 0
 s_add_u32 m0, s28, 131072
 v_mov_b32 v11, v31
 v_permlane16_swap_b32 v10, v30
M v[68:71], a[68:71], v[148:151], v[68:71]
 buffer_load_dwordx4 v3, s[8:11], s38 offen offset:0 sc1 lds
M v[68:71], a[72:75], v[164:167], v[68:71]
 v_permlane16_swap_b32 v11, v31
 v_add_f32 v30, v10, v30
M v[68:71], a[76:79], v[180:183], v[68:71]
 v_add_f32 v31, v11, v31
 v_mov_b32 v10, v30
M v[68:71], a[80:83], v[196:199], v[68:71]
 buffer_load_dwordx4 v3, s[8:11], s38 offen offset:1024 sc1 lds
M v[68:71], a[84:87], v[212:215], v[68:71]
 v_mov_b32 v11, v31
 v_permlane32_swap_b32 v10, v30
M v[68:71], a[88:91], v[228:231], v[68:71]
 v_permlane32_swap_b32 v11, v31
 v_add_f32 v30, v10, v30
M v[68:71], a[92:95], v[244:247], v[68:71]
 v_add_f32 v31, v11, v31
M v[76:79], a[96:99], v[132:135], 0
 buffer_load_dwordx4 v3, s[8:11], s38 offen offset:2048 sc1 lds
M v[76:79], a[100:103], v[148:151], v[76:79]
 v_rcp_f32 v5, v30
M v[76:79], a[104:107], v[164:167], v[76:79]
 v_rcp_f32 v6, v31
M v[76:79], a[108:111], v[180:183], v[76:79]
 buffer_load_dwordx4 v3, s[8:11], s38 offen offset:3072 sc1 lds
M v[76:79], a[112:115], v[196:199], v[76:79]
M v[76:79], a[116:119], v[212:215], v[76:79]
M v[76:79], a[120:123], v[228:231], v[76:79]
 s_waitcnt vmcnt(20)
M v[76:79], a[124:127], v[244:247], v[76:79]
 s_barrier
M v[84:87], a[128:131], v[132:135], 0
 ds_read_b128 a[64:67], v7 offset:32768
M v[84:87], a[132:135], v[148:151], v[84:87]
 s_add_u32 m0, s28, 135168
 ds_read_b128 a[68:71], v7 offset:33792
M v[84:87], a[136:139], v[164:167], v[84:87]
 buffer_load_dwordx4 v4, s[8:11], s38 offen offset:0 sc1 lds
M v[84:87], a[140:143], v[180:183], v[84:87]
 ds_read_b128 a[72:75], v7 offset:34816
M v[84:87], a[144:147], v[196:199], v[84:87]
 ds_read_b128 a[76:79], v7 offset:35840
M v[84:87], a[148:151], v[212:215], v[84:87]
 buffer_load_dwordx4 v4, s[8:11], s38 offen offset:1024 sc1 lds
M v[84:87], a[152:155], v[228:231], v[84:87]
 ds_read_b128 a[80:83], v7 offset:36864
M v[84:87], a[156:159], v[244:247], v[84:87]
 ds_read_b128 a[84:87], v7 offset:37888
M v[92:95], a[160:163], v[132:135], 0
 buffer_load_dwordx4 v4, s[8:11], s38 offen offset:2048 sc1 lds
M v[92:95], a[164:167], v[148:151], v[92:95]
 ds_read_b128 a[88:91], v7 offset:38912
M v[92:95], a[168:171], v[164:167], v[92:95]
 ds_read_b128 a[92:95], v7 offset:39936
M v[92:95], a[172:175], v[180:183], v[92:95]
 buffer_load_dwordx4 v4, s[8:11], s38 offen offset:3072 sc1 lds
M v[92:95], a[176:179], v[196:199], v[92:95]
 s_add_u32 s38, s38, 32768
M v[92:95], a[180:183], v[212:215], v[92:95]
M v[92:95], a[184:187], v[228:231], v[92:95]
 s_waitcnt lgkmcnt(0)
 s_cmp_eq_u32 s42, 6
M v[92:95], a[188:191], v[244:247], v[92:95]
 s_cbranch_scc1 L_y1
L_y1r:
M v[96:99], a[64:67], v[128:131], 0
 s_add_u32 m0, s28, 98304
 ds_read_b128 a[96:99], v7 offset:40960
M v[96:99], a[68:71], v[144:147], v[96:99]
 ds_read_b128 a[100:103], v7 offset:41984
M v[96:99], a[72:75], v[160:163], v[96:99]
 buffer_load_dwordx4 v3, s[8:11], s38 offen offset:0 sc1 lds
M v[96:99], a[76:79], v[176:179], v[96:99]
 ds_read_b128 a[104:107], v7 offset:43008
 s_add_u32 s29, s33, 0
M v[96:99], a[80:83], v[192:195], v[96:99]
 ds_read_b128 a[108:111], v7 offset:44032
 s_add_u32 s30, s33, 14336
M v[96:99], a[84:87], v[208:211], v[96:99]
 buffer_load_dwordx4 v3, s[8:11], s38 offen offset:1024 sc1 lds
M v[96:99], a[88:91], v[224:227], v[96:99]
 ds_read_b128 a[112:115], v7 offset:45056
 v_max3_f32 v32, |v64|, |v65|, |v66|
M v[96:99], a[92:95], v[240:243], v[96:99]
 ds_read_b128 a[116:119], v7 offset:46080
 v_max3_f32 v32, |v67|, |v72|, v32
M v[100:103], a[92:95], v[244:247], 0
 buffer_load_dwordx4 v3, s[8:11], s38 offen offset:2048 sc1 lds
M v[100:103], a[88:91], v[228:231], v[100:103]
 ds_read_b128 a[120:123], v7 offset:47104
 v_max3_f32 v32, |v73|, |v74|, v32
M v[100:103], a[84:87], v[212:215], v[100:103]
 ds_read_b128 a[124:127], v7 offset:48128
 v_mul_f32 v32, 2.0, v32
M v[100:103], a[80:83], v[196:199], v[100:103]
 buffer_load_dwordx4 v3, s[8:11], s38 offen offset:3072 sc1 lds
M v[100:103], a[76:79], v[180:183], v[100:103]
 s_add_u32 m0, s28, 102400
 v_mov_b32 v33, v32
 v_mov_b32 v34, v32
M v[100:103], a[72:75], v[164:167], v[100:103]
 buffer_load_dwordx4 v4, s[8:11], s38 offen offset:0 sc1 lds
M v[100:103], a[68:71], v[148:151], v[100:103]
 v_mov_b32 v35, v32
 v_mul_f32 v28, -v32, v5
M v[100:103], a[64:67], v[132:135], v[100:103]
 s_waitcnt lgkmcnt(0)
 v_mul_f32 v64, v5, v64
 v_mul_f32 v65, v5, v65
M v[104:107], a[96:99], v[128:131], 0
 ds_read_b128 a[64:67], v7 offset:49152
 v_mul_f32 v66, v5, v66
M v[104:107], a[100:103], v[144:147], v[104:107]
 ds_read_b128 a[68:71], v7 offset:50176
 v_mul_f32 v67, v5, v67
M v[104:107], a[104:107], v[160:163], v[104:107]
 buffer_load_dwordx4 v4, s[8:11], s38 offen offset:1024 sc1 lds
M v[104:107], a[108:111], v[176:179], v[104:107]
 ds_read_b128 a[72:75], v7 offset:51200
 v_mul_f32 v72, v5, v72
M v[104:107], a[112:115], v[192:195], v[104:107]
 ds_read_b128 a[76:79], v7 offset:52224
 v_mul_f32 v73, v5, v73
M v[104:107], a[116:119], v[208:211], v[104:107]
 buffer_load_dwordx4 v4, s[8:11], s38 offen offset:2048 sc1 lds
M v[104:107], a[120:123], v[224:227], v[104:107]
 ds_read_b128 a[80:83], v7 offset:53248
 v_mul_f32 v74, v5, v74
M v[104:107], a[124:127], v[240:243], v[104:107]
 ds_read_b128 a[84:87], v7 offset:54272
 v_mul_f32 v75, v5, v75
M v[108:111], a[124:127], v[244:247], 0
 buffer_load_dwordx4 v4, s[8:11], s38 offen offset:3072 sc1 lds
M v[108:111], a[120:123], v[228:231], v[108:111]
 s_add_u32 s38, s38, 32768
 ds_read_b128 a[88:91], v7 offset:55296
 v_cvt_pk_bf16_f32 v64, v64, v65
M v[108:111], a[116:119], v[212:215], v[108:111]
 ds_read_b128 a[92:95], v7 offset:56320
 v_cvt_pk_bf16_f32 v65, v66, v67
M v[108:111], a[112:115], v[196:199], v[108:111]
 v_cvt_pk_bf16_f32 v66, v72, v73
 v_cvt_pk_bf16_f32 v67, v74, v75
M v[108:111], a[108:111], v[180:183], v[108:111]
 buffer_store_dwordx4 v[64:67], v7, s[8:11], s29 offen offset:0 sc1
M v[108:111], a[104:107], v[164:167], v[108:111]
 v_max3_f32 v36, |v68|, |v69|, |v70|
 v_max3_f32 v36, |v71|, |v76|, v36
M v[108:111], a[100:103], v[148:151], v[108:111]
 v_max3_f32 v36, |v77|, |v78|, v36
 v_mul_f32 v36, 2.0, v36
M v[108:111], a[96:99], v[132:135], v[108:111]
 s_waitcnt lgkmcnt(0)
 v_mov_b32 v37, v36
 v_mov_b32 v38, v36
M v[112:115], a[64:67], v[128:131], 0
 ds_read_b128 a[96:99], v7 offset:57344
 v_mov_b32 v39, v36
M v[112:115], a[68:71], v[144:147], v[112:115]
 ds_read_b128 a[100:103], v7 offset:58368
 v_mul_f32 v29, -v36, v6
M v[112:115], a[72:75], v[160:163], v[112:115]
 v_mul_f32 v68, v6, v68
 v_mul_f32 v69, v6, v69
M v[112:115], a[76:79], v[176:179], v[112:115]
 ds_read_b128 a[104:107], v7 offset:59392
 v_mul_f32 v70, v6, v70
M v[112:115], a[80:83], v[192:195], v[112:115]
 ds_read_b128 a[108:111], v7 offset:60416
 v_mul_f32 v71, v6, v71
M v[112:115], a[84:87], v[208:211], v[112:115]
 v_mul_f32 v76, v6, v76
 v_mul_f32 v77, v6, v77
M v[112:115], a[88:91], v[224:227], v[112:115]
 ds_read_b128 a[112:115], v7 offset:61440
 v_mul_f32 v78, v6, v78
M v[112:115], a[92:95], v[240:243], v[112:115]
 ds_read_b128 a[116:119], v7 offset:62464
 v_mul_f32 v79, v6, v79
M v[116:119], a[92:95], v[244:247], 0
 v_cvt_pk_bf16_f32 v68, v68, v69
 v_cvt_pk_bf16_f32 v69, v70, v71
M v[116:119], a[88:91], v[228:231], v[116:119]
 ds_read_b128 a[120:123], v7 offset:63488
 v_cvt_pk_bf16_f32 v70, v76, v77
M v[116:119], a[84:87], v[212:215], v[116:119]
 ds_read_b128 a[124:127], v7 offset:64512
 v_cvt_pk_bf16_f32 v71, v78, v79
M v[116:119], a[80:83], v[196:199], v[116:119]
 buffer_store_dwordx4 v[68:71], v7, s[8:11], s30 offen offset:0 sc1
M v[116:119], a[76:79], v[180:183], v[116:119]
 v_mul_f32 v80, v5, v80
 v_mul_f32 v81, v5, v81
M v[116:119], a[72:75], v[164:167], v[116:119]
 v_mul_f32 v82, v5, v82
 v_mul_f32 v83, v5, v83
M v[116:119], a[68:71], v[148:151], v[116:119]
 s_waitcnt vmcnt(26) lgkmcnt(0)
 v_mul_f32 v88, v5, v88
 v_mul_f32 v89, v5, v89
M v[116:119], a[64:67], v[132:135], v[116:119]
 s_barrier
M v[120:123], a[96:99], v[128:131], 0
 ds_read_b128 a[64:67], v2 offset:0
 v_mul_f32 v90, v5, v90
M v[120:123], a[100:103], v[144:147], v[120:123]
 ds_read_b128 a[68:71], v2 offset:1024
 v_mul_f32 v91, v5, v91
M v[120:123], a[104:107], v[160:163], v[120:123]
 v_cvt_pk_bf16_f32 v80, v80, v81
 v_cvt_pk_bf16_f32 v81, v82, v83
M v[120:123], a[108:111], v[176:179], v[120:123]
 ds_read_b128 a[72:75], v2 offset:2048
 v_cvt_pk_bf16_f32 v82, v88, v89
M v[120:123], a[112:115], v[192:195], v[120:123]
 ds_read_b128 a[76:79], v2 offset:3072
 v_cvt_pk_bf16_f32 v83, v90, v91
M v[120:123], a[116:119], v[208:211], v[120:123]
 buffer_store_dwordx4 v[80:83], v7, s[8:11], s29 offen offset:1024 sc1
M v[120:123], a[120:123], v[224:227], v[120:123]
 ds_read_b128 a[80:83], v2 offset:4096
 v_mul_f32 v84, v6, v84
M v[120:123], a[124:127], v[240:243], v[120:123]
 ds_read_b128 a[84:87], v2 offset:5120
 v_mul_f32 v85, v6, v85
M v[124:127], a[124:127], v[244:247], 0
 v_mul_f32 v86, v6, v86
 v_mul_f32 v87, v6, v87
M v[124:127], a[120:123], v[228:231], v[124:127]
 ds_read_b128 a[88:91], v2 offset:6144
 v_mul_f32 v92, v6, v92
M v[124:127], a[116:119], v[212:215], v[124:127]
 ds_read_b128 a[92:95], v2 offset:7168
 v_mul_f32 v93, v6, v93
M v[124:127], a[112:115], v[196:199], v[124:127]
 v_mul_f32 v94, v6, v94
 v_mul_f32 v95, v6, v95
M v[124:127], a[108:111], v[180:183], v[124:127]
 v_cvt_pk_bf16_f32 v84, v84, v85
 v_cvt_pk_bf16_f32 v85, v86, v87
M v[124:127], a[104:107], v[164:167], v[124:127]
 v_cvt_pk_bf16_f32 v86, v92, v93
 v_cvt_pk_bf16_f32 v87, v94, v95
M v[124:127], a[100:103], v[148:151], v[124:127]
 s_waitcnt lgkmcnt(0)
M v[124:127], a[96:99], v[132:135], v[124:127]
 buffer_store_dwordx4 v[84:87], v7, s[8:11], s30 offen offset:1024 sc1
M v[64:67], a[64:67], v[128:131], v[32:35]
 s_add_u32 m0, s28, 32768
 ds_read_b128 a[96:99], v2 offset:8192
M v[64:67], a[68:71], v[144:147], v[64:67]
 ds_read_b128 a[100:103], v2 offset:9216
 s_mov_b32 s79, 104923136
M v[64:67], a[72:75], v[160:163], v[64:67]
 buffer_load_dwordx4 v3, s[8:11], s38 offen offset:0 sc1 lds
M v[64:67], a[76:79], v[176:179], v[64:67]
 ds_read_b128 a[104:107], v2 offset:10240
 s_add_u32 s29, s33, 2048
M v[64:67], a[80:83], v[192:195], v[64:67]
 ds_read_b128 a[108:111], v2 offset:11264
 s_add_u32 s30, s33, 16384
M v[64:67], a[84:87], v[208:211], v[64:67]
 buffer_load_dwordx4 v3, s[8:11], s38 offen offset:1024 sc1 lds
M v[64:67], a[88:91], v[224:227], v[64:67]
 ds_read_b128 a[112:115], v2 offset:12288
 v_mul_f32 v96, v5, v96
M v[64:67], a[92:95], v[240:243], v[64:67]
 ds_read_b128 a[116:119], v2 offset:13312
 v_mul_f32 v97, v5, v97
M v[68:71], a[92:95], v[244:247], v[36:39]
 buffer_load_dwordx4 v3, s[8:11], s38 offen offset:2048 sc1 lds
M v[68:71], a[88:91], v[228:231], v[68:71]
 ds_read_b128 a[120:123], v2 offset:14336
 v_mul_f32 v98, v5, v98
M v[68:71], a[84:87], v[212:215], v[68:71]
 ds_read_b128 a[124:127], v2 offset:15360
 v_mul_f32 v99, v5, v99
M v[68:71], a[80:83], v[196:199], v[68:71]
 buffer_load_dwordx4 v3, s[8:11], s38 offen offset:3072 sc1 lds
M v[68:71], a[76:79], v[180:183], v[68:71]
 s_add_u32 m0, s28, 36864
 v_mul_f32 v104, v5, v104
 v_mul_f32 v105, v5, v105
M v[68:71], a[72:75], v[164:167], v[68:71]
 buffer_load_dwordx4 v4, s[8:11], s38 offen offset:0 sc1 lds
M v[68:71], a[68:71], v[148:151], v[68:71]
 buffer_load_dword v24, off, s[8:11], s79 sc1
M v[68:71], a[64:67], v[132:135], v[68:71]
 s_waitcnt lgkmcnt(0)
 v_lshrrev_b32 v0, 4, v7
 v_and_b32 v14, 15, v0
M v[72:75], a[96:99], v[128:131], v[32:35]
 ds_read_b128 a[64:67], v2 offset:16384
 v_lshlrev_b32 v14, 2, v14
M v[72:75], a[100:103], v[144:147], v[72:75]
 ds_read_b128 a[68:71], v2 offset:17408
 v_lshrrev_b32 v11, 4, v0
M v[72:75], a[104:107], v[160:163], v[72:75]
 buffer_load_dwordx4 v4, s[8:11], s38 offen offset:1024 sc1 lds
M v[72:75], a[108:111], v[176:179], v[72:75]
 ds_read_b128 a[72:75], v2 offset:18432
 s_mov_b32 s52, s96
M v[72:75], a[112:115], v[192:195], v[72:75]
 s_and_b32 s53, s97, 0xffff
 ds_read_b128 a[76:79], v2 offset:19456
 s_mov_b32 s54, 1835008
M v[72:75], a[116:119], v[208:211], v[72:75]
 buffer_load_dwordx4 v4, s[8:11], s38 offen offset:2048 sc1 lds
M v[72:75], a[120:123], v[224:227], v[72:75]
 ds_read_b128 a[80:83], v2 offset:20480
 s_mov_b32 s55, 0x20000
M v[72:75], a[124:127], v[240:243], v[72:75]
 s_lshr_b32 s74, s41, 3
 ds_read_b128 a[84:87], v2 offset:21504
 s_xor_b32 s74, s74, 0
M v[76:79], a[124:127], v[244:247], v[36:39]
 buffer_load_dwordx4 v4, s[8:11], s38 offen offset:3072 sc1 lds
M v[76:79], a[120:123], v[228:231], v[76:79]
 s_add_u32 s38, s38, 32768
 ds_read_b128 a[88:91], v2 offset:22528
 s_mul_i32 s67, s74, -2
M v[76:79], a[116:119], v[212:215], v[76:79]
 s_mul_i32 s74, s74, 8
 ds_read_b128 a[92:95], v2 offset:23552
 v_mul_f32 v106, v5, v106
M v[76:79], a[112:115], v[196:199], v[76:79]
 s_add_u32 s74, s74, s20
 v_mul_f32 v107, v5, v107
 v_cvt_pk_bf16_f32 v96, v96, v97
M v[76:79], a[108:111], v[180:183], v[76:79]
 s_lshl_b32 s75, s74, 6
 v_cvt_pk_bf16_f32 v97, v98, v99
 v_cvt_pk_bf16_f32 v98, v104, v105
M v[76:79], a[104:107], v[164:167], v[76:79]
 s_add_u32 s76, s75, 256
 v_cvt_pk_bf16_f32 v99, v106, v107
M v[76:79], a[100:103], v[148:151], v[76:79]
 s_add_u32 s67, s67, 3
 v_add_u32 v43, 0x20000, v7
 s_sub_u32 s67, s67, s20
M v[76:79], a[96:99], v[132:135], v[76:79]
 s_waitcnt lgkmcnt(0)
 s_and_b32 s67, s67, 536870912
M v[80:83], a[64:67], v[128:131], v[32:35]
 s_or_b32 s76, s76, s67
 ds_read_b128 a[96:99], v2 offset:24576
 v_or_b32 v27, s67, v7
M v[80:83], a[68:71], v[144:147], v[80:83]
 ds_read_b128 a[100:103], v2 offset:25600
 v_add_u32 v27, 4096, v27
M v[80:83], a[72:75], v[160:163], v[80:83]
 buffer_store_dwordx4 v[96:99], v7, s[8:11], s29 offen offset:0 sc1
M v[80:83], a[76:79], v[176:179], v[80:83]
 ds_read_b128 a[104:107], v2 offset:26624
 v_mul_f32 v100, v6, v100
M v[80:83], a[80:83], v[192:195], v[80:83]
 ds_read_b128 a[108:111], v2 offset:27648
 v_mul_f32 v101, v6, v101
M v[80:83], a[84:87], v[208:211], v[80:83]
 v_mul_f32 v102, v6, v102
 v_mul_f32 v103, v6, v103
M v[80:83], a[88:91], v[224:227], v[80:83]
 ds_read_b128 a[112:115], v2 offset:28672
 v_mul_f32 v108, v6, v108
M v[80:83], a[92:95], v[240:243], v[80:83]
 ds_read_b128 a[116:119], v2 offset:29696
 v_mul_f32 v109, v6, v109
M v[84:87], a[92:95], v[244:247], v[36:39]
 v_mul_f32 v110, v6, v110
 v_mul_f32 v111, v6, v111
M v[84:87], a[88:91], v[228:231], v[84:87]
 ds_read_b128 a[120:123], v2 offset:30720
 v_cvt_pk_bf16_f32 v100, v100, v101
M v[84:87], a[84:87], v[212:215], v[84:87]
 ds_read_b128 a[124:127], v2 offset:31744
 v_cvt_pk_bf16_f32 v101, v102, v103
M v[84:87], a[80:83], v[196:199], v[84:87]
 v_cvt_pk_bf16_f32 v102, v108, v109
 v_cvt_pk_bf16_f32 v103, v110, v111
M v[84:87], a[76:79], v[180:183], v[84:87]
 buffer_store_dwordx4 v[100:103], v7, s[8:11], s30 offen offset:0 sc1
M v[84:87], a[72:75], v[164:167], v[84:87]
 v_mul_f32 v112, v5, v112
 v_mul_f32 v113, v5, v113
M v[84:87], a[68:71], v[148:151], v[84:87]
 s_waitcnt vmcnt(31) lgkmcnt(0)
 v_mul_f32 v114, v5, v114
 v_mul_f32 v115, v5, v115
M v[84:87], a[64:67], v[132:135], v[84:87]
 s_barrier
M v[88:91], a[96:99], v[128:131], v[32:35]
 ds_read_b128 a[64:67], v7 offset:0
 v_mul_f32 v120, v5, v120
M v[88:91], a[100:103], v[144:147], v[88:91]
 ds_read_b128 a[68:71], v7 offset:1024
 v_mul_f32 v121, v5, v121
M v[88:91], a[104:107], v[160:163], v[88:91]
 v_mul_f32 v122, v5, v122
 v_mul_f32 v123, v5, v123
M v[88:91], a[108:111], v[176:179], v[88:91]
 ds_read_b128 a[72:75], v7 offset:2048
 v_cvt_pk_bf16_f32 v112, v112, v113
M v[88:91], a[112:115], v[192:195], v[88:91]
 ds_read_b128 a[76:79], v7 offset:3072
 v_cvt_pk_bf16_f32 v113, v114, v115
M v[88:91], a[116:119], v[208:211], v[88:91]
 v_cvt_pk_bf16_f32 v114, v120, v121
 v_cvt_pk_bf16_f32 v115, v122, v123
M v[88:91], a[120:123], v[224:227], v[88:91]
 ds_read_b128 a[80:83], v7 offset:4096
M v[88:91], a[124:127], v[240:243], v[88:91]
 ds_read_b128 a[84:87], v7 offset:5120
M v[92:95], a[124:127], v[244:247], v[36:39]
 buffer_store_dwordx4 v[112:115], v7, s[8:11], s29 offen offset:1024 sc1
M v[92:95], a[120:123], v[228:231], v[92:95]
 ds_read_b128 a[88:91], v7 offset:6144
 v_mul_f32 v116, v6, v116
M v[92:95], a[116:119], v[212:215], v[92:95]
 ds_read_b128 a[92:95], v7 offset:7168
 v_mul_f32 v117, v6, v117
M v[92:95], a[112:115], v[196:199], v[92:95]
 v_mul_f32 v118, v6, v118
 v_mul_f32 v119, v6, v119
M v[92:95], a[108:111], v[180:183], v[92:95]
 v_mul_f32 v124, v6, v124
 v_mul_f32 v125, v6, v125
M v[92:95], a[104:107], v[164:167], v[92:95]
 v_mul_f32 v126, v6, v126
 v_mul_f32 v127, v6, v127
M v[92:95], a[100:103], v[148:151], v[92:95]
 s_waitcnt lgkmcnt(0)
 v_cvt_pk_bf16_f32 v116, v116, v117
 v_cvt_pk_bf16_f32 v117, v118, v119
M v[92:95], a[96:99], v[132:135], v[92:95]
 v_cvt_pk_bf16_f32 v118, v124, v125
 v_cvt_pk_bf16_f32 v119, v126, v127
 buffer_store_dwordx4 v[116:119], v7, s[8:11], s30 offen offset:1024 sc1
M v[96:99], a[64:67], v[128:131], v[32:35]
 ds_read_b128 a[96:99], v7 offset:8192
M v[96:99], a[68:71], v[144:147], v[96:99]
 ds_read_b128 a[100:103], v7 offset:9216
M v[96:99], a[72:75], v[160:163], v[96:99]
 s_sub_u32 s64, 15, s42
M v[96:99], a[76:79], v[176:179], v[96:99]
 s_min_u32 s64, s64, s42
 ds_read_b128 a[104:107], v7 offset:10240
 s_add_u32 s29, s33, 4096
M v[96:99], a[80:83], v[192:195], v[96:99]
 s_mul_i32 s45, s64, 8704
 ds_read_b128 a[108:111], v7 offset:11264
 s_add_u32 s30, s33, 18432
M v[96:99], a[84:87], v[208:211], v[96:99]
 s_lshl_b32 s64, s20, 6
 v_fma_f32 v64, v64, v5, v28
 v_fma_f32 v65, v65, v5, v28
M v[96:99], a[88:91], v[224:227], v[96:99]
 s_add_u32 s64, s64, s41
 ds_read_b128 a[112:115], v7 offset:12288
 v_fma_f32 v66, v66, v5, v28
M v[96:99], a[92:95], v[240:243], v[96:99]
 s_lshl2_add_u32 s45, s64, s45
 ds_read_b128 a[116:119], v7 offset:13312
 v_fma_f32 v67, v67, v5, v28
M v[100:103], a[92:95], v[244:247], v[36:39]
 s_add_u32 s45, s45, 104992768
 v_fma_f32 v72, v72, v5, v28
M v[100:103], a[88:91], v[228:231], v[100:103]
 s_movk_i32 s65, 1024
 ds_read_b128 a[120:123], v7 offset:14336
 v_fma_f32 v73, v73, v5, v28
M v[100:103], a[84:87], v[212:215], v[100:103]
 s_cmp_lt_u32 s42, 8
 ds_read_b128 a[124:127], v7 offset:15360
 v_fma_f32 v74, v74, v5, v28
M v[100:103], a[80:83], v[196:199], v[100:103]
 s_cselect_b32 s64, 4352, s65
 v_fma_f32 v75, v75, v5, v28
M v[100:103], a[76:79], v[180:183], v[100:103]
 s_cselect_b32 s65, 0, 64
 v_cvt_pk_bf16_f32 v64, v64, v65
M v[100:103], a[72:75], v[164:167], v[100:103]
 s_cselect_b32 s66, 32, 64
 v_cvt_pk_bf16_f32 v65, v66, v67
M v[100:103], a[68:71], v[148:151], v[100:103]
 s_add_u32 s3, s45, s64
 s_add_u32 s45, s45, s65
 v_lshrrev_b32 v42, 5, v7
M v[100:103], a[64:67], v[132:135], v[100:103]
 s_waitcnt lgkmcnt(0)
 v_mul_u32_u24 v42, 4352, v42
 v_and_b32 v41, 16, v7
M v[104:107], a[96:99], v[128:131], v[32:35]
 ds_read_b128 a[64:67], v7 offset:16384
 v_lshl_add_u32 v41, v41, 3, v42
M v[104:107], a[100:103], v[144:147], v[104:107]
 ds_read_b128 a[68:71], v7 offset:17408
 v_mov_b32 v42, 536870912
M v[104:107], a[104:107], v[160:163], v[104:107]
 v_cmp_gt_u32 vcc, s66, v7
 v_mov_b32 v40, 1
M v[104:107], a[108:111], v[176:179], v[104:107]
 s_nop 0
 ds_read_b128 a[72:75], v7 offset:18432
 v_cndmask_b32 v41, v42, v41, vcc
M v[104:107], a[112:115], v[192:195], v[104:107]
 ds_read_b128 a[76:79], v7 offset:19456
 v_cvt_pk_bf16_f32 v66, v72, v73
M v[104:107], a[116:119], v[208:211], v[104:107]
 v_cvt_pk_bf16_f32 v67, v74, v75
M v[104:107], a[120:123], v[224:227], v[104:107]
 ds_read_b128 a[80:83], v7 offset:20480
M v[104:107], a[124:127], v[240:243], v[104:107]
 ds_read_b128 a[84:87], v7 offset:21504
M v[108:111], a[124:127], v[244:247], v[36:39]
 buffer_store_dwordx4 v[64:67], v7, s[8:11], s29 offen offset:0 sc1
M v[108:111], a[120:123], v[228:231], v[108:111]
 ds_read_b128 a[88:91], v7 offset:22528
 v_fma_f32 v68, v68, v6, v29
M v[108:111], a[116:119], v[212:215], v[108:111]
 ds_read_b128 a[92:95], v7 offset:23552
 v_fma_f32 v69, v69, v6, v29
M v[108:111], a[112:115], v[196:199], v[108:111]
 v_fma_f32 v70, v70, v6, v29
 v_fma_f32 v71, v71, v6, v29
M v[108:111], a[108:111], v[180:183], v[108:111]
 v_fma_f32 v76, v76, v6, v29
 v_fma_f32 v77, v77, v6, v29
M v[108:111], a[104:107], v[164:167], v[108:111]
 v_fma_f32 v78, v78, v6, v29
 v_fma_f32 v79, v79, v6, v29
M v[108:111], a[100:103], v[148:151], v[108:111]
 v_cvt_pk_bf16_f32 v68, v68, v69
 v_cvt_pk_bf16_f32 v69, v70, v71
M v[108:111], a[96:99], v[132:135], v[108:111]
 s_waitcnt lgkmcnt(0)
 v_cvt_pk_bf16_f32 v70, v76, v77
 v_cvt_pk_bf16_f32 v71, v78, v79
M v[112:115], a[64:67], v[128:131], v[32:35]
 ds_read_b128 a[96:99], v7 offset:24576
M v[112:115], a[68:71], v[144:147], v[112:115]
 ds_read_b128 a[100:103], v7 offset:25600
M v[112:115], a[72:75], v[160:163], v[112:115]
 buffer_store_dwordx4 v[68:71], v7, s[8:11], s30 offen offset:0 sc1
M v[112:115], a[76:79], v[176:179], v[112:115]
 ds_read_b128 a[104:107], v7 offset:26624
 v_fma_f32 v80, v80, v5, v28
M v[112:115], a[80:83], v[192:195], v[112:115]
 ds_read_b128 a[108:111], v7 offset:27648
 v_fma_f32 v81, v81, v5, v28
M v[112:115], a[84:87], v[208:211], v[112:115]
 v_fma_f32 v82, v82, v5, v28
 v_fma_f32 v83, v83, v5, v28
M v[112:115], a[88:91], v[224:227], v[112:115]
 ds_read_b128 a[112:115], v7 offset:28672
 v_fma_f32 v88, v88, v5, v28
M v[112:115], a[92:95], v[240:243], v[112:115]
 ds_read_b128 a[116:119], v7 offset:29696
 v_fma_f32 v89, v89, v5, v28
M v[116:119], a[92:95], v[244:247], v[36:39]
 v_fma_f32 v90, v90, v5, v28
 v_fma_f32 v91, v91, v5, v28
M v[116:119], a[88:91], v[228:231], v[116:119]
 ds_read_b128 a[120:123], v7 offset:30720
 v_cvt_pk_bf16_f32 v80, v80, v81
M v[116:119], a[84:87], v[212:215], v[116:119]
 ds_read_b128 a[124:127], v7 offset:31744
 v_cvt_pk_bf16_f32 v81, v82, v83
M v[116:119], a[80:83], v[196:199], v[116:119]
 v_cvt_pk_bf16_f32 v82, v88, v89
 v_cvt_pk_bf16_f32 v83, v90, v91
M v[116:119], a[76:79], v[180:183], v[116:119]
 buffer_store_dwordx4 v[80:83], v7, s[8:11], s29 offen offset:1024 sc1
M v[116:119], a[72:75], v[164:167], v[116:119]
 v_fma_f32 v84, v84, v6, v29
 v_fma_f32 v85, v85, v6, v29
M v[116:119], a[68:71], v[148:151], v[116:119]
 s_waitcnt vmcnt(28) lgkmcnt(0)
 v_fma_f32 v86, v86, v6, v29
M v[116:119], a[64:67], v[132:135], v[116:119]
 s_barrier
M v[120:123], a[96:99], v[128:131], v[32:35]
 ds_read_b128 a[64:67], v43 offset:0
 v_fma_f32 v87, v87, v6, v29
M v[120:123], a[100:103], v[144:147], v[120:123]
 ds_read_b128 a[68:71], v43 offset:1024
 v_fma_f32 v92, v92, v6, v29
M v[120:123], a[104:107], v[160:163], v[120:123]
 v_fma_f32 v93, v93, v6, v29
 v_fma_f32 v94, v94, v6, v29
M v[120:123], a[108:111], v[176:179], v[120:123]
 ds_read_b128 a[72:75], v43 offset:2048
 v_fma_f32 v95, v95, v6, v29
M v[120:123], a[112:115], v[192:195], v[120:123]
 ds_read_b128 a[76:79], v43 offset:3072
 v_cvt_pk_bf16_f32 v84, v84, v85
M v[120:123], a[116:119], v[208:211], v[120:123]
 v_cvt_pk_bf16_f32 v85, v86, v87
M v[120:123], a[120:123], v[224:227], v[120:123]
 ds_read_b128 a[80:83], v43 offset:4096
 v_cvt_pk_bf16_f32 v86, v92, v93
M v[120:123], a[124:127], v[240:243], v[120:123]
 ds_read_b128 a[84:87], v43 offset:5120
 v_cvt_pk_bf16_f32 v87, v94, v95
M v[124:127], a[124:127], v[244:247], v[36:39]
 buffer_store_dwordx4 v[84:87], v7, s[8:11], s30 offen offset:1024 sc1
M v[124:127], a[120:123], v[228:231], v[124:127]
 ds_read_b128 a[88:91], v43 offset:6144
M v[124:127], a[116:119], v[212:215], v[124:127]
 ds_read_b128 a[92:95], v43 offset:7168
M v[124:127], a[112:115], v[196:199], v[124:127]
M v[124:127], a[108:111], v[180:183], v[124:127]
M v[124:127], a[104:107], v[164:167], v[124:127]
M v[124:127], a[100:103], v[148:151], v[124:127]
 s_waitcnt lgkmcnt(0)
 s_cmp_eq_u32 s42, 6
M v[124:127], a[96:99], v[132:135], v[124:127]
 s_cbranch_scc1 L_y2
L_y2r:
M v[64:67], a[64:67], v[128:131], v[32:35]
 ds_read_b128 a[96:99], v43 offset:8192
M v[64:67], a[68:71], v[144:147], v[64:67]
 ds_read_b128 a[100:103], v43 offset:9216
M v[64:67], a[72:75], v[160:163], v[64:67]
 s_waitcnt vmcnt(11)
 v_cmp_gt_u32 vcc, 1, v24
M v[64:67], a[76:79], v[176:179], v[64:67]
 s_mov_b32 s65, 104890368
 ds_read_b128 a[104:107], v43 offset:10240
 s_add_u32 s29, s33, 6144
M v[64:67], a[80:83], v[192:195], v[64:67]
 s_cbranch_vccnz L_fhs1
L_fhr1:
 ds_read_b128 a[108:111], v43 offset:11264
 s_add_u32 s30, s33, 20480
M v[64:67], a[84:87], v[208:211], v[64:67]
 buffer_load_dword v25, v14, s[8:11], s65 offen sc1
M v[64:67], a[88:91], v[224:227], v[64:67]
 ds_read_b128 a[112:115], v43 offset:12288
 v_fma_f32 v96, v96, v5, v28
M v[64:67], a[92:95], v[240:243], v[64:67]
 ds_read_b128 a[116:119], v43 offset:13312
 v_fma_f32 v97, v97, v5, v28
M v[68:71], a[92:95], v[244:247], v[36:39]
 v_fma_f32 v98, v98, v5, v28
 v_fma_f32 v99, v99, v5, v28
M v[68:71], a[88:91], v[228:231], v[68:71]
 ds_read_b128 a[120:123], v43 offset:14336
 v_fma_f32 v104, v104, v5, v28
M v[68:71], a[84:87], v[212:215], v[68:71]
 ds_read_b128 a[124:127], v43 offset:15360
 v_fma_f32 v105, v105, v5, v28
M v[68:71], a[80:83], v[196:199], v[68:71]
 v_fma_f32 v106, v106, v5, v28
 v_fma_f32 v107, v107, v5, v28
M v[68:71], a[76:79], v[180:183], v[68:71]
 v_cvt_pk_bf16_f32 v96, v96, v97
M v[68:71], a[72:75], v[164:167], v[68:71]
 v_cvt_pk_bf16_f32 v97, v98, v99
M v[68:71], a[68:71], v[148:151], v[68:71]
 v_cvt_pk_bf16_f32 v98, v104, v105
M v[68:71], a[64:67], v[132:135], v[68:71]
 s_waitcnt lgkmcnt(0)
 v_cvt_pk_bf16_f32 v99, v106, v107
M v[72:75], a[96:99], v[128:131], v[32:35]
 ds_read_b128 a[64:67], v43 offset:16384
M v[72:75], a[100:103], v[144:147], v[72:75]
 ds_read_b128 a[68:71], v43 offset:17408
M v[72:75], a[104:107], v[160:163], v[72:75]
 buffer_store_dwordx4 v[96:99], v7, s[8:11], s29 offen offset:0 sc1
M v[72:75], a[108:111], v[176:179], v[72:75]
 ds_read_b128 a[72:75], v43 offset:18432
 v_fma_f32 v100, v100, v6, v29
M v[72:75], a[112:115], v[192:195], v[72:75]
 ds_read_b128 a[76:79], v43 offset:19456
 v_fma_f32 v101, v101, v6, v29
M v[72:75], a[116:119], v[208:211], v[72:75]
 v_fma_f32 v102, v102, v6, v29
 v_fma_f32 v103, v103, v6, v29
M v[72:75], a[120:123], v[224:227], v[72:75]
 ds_read_b128 a[80:83], v43 offset:20480
 v_fma_f32 v108, v108, v6, v29
M v[72:75], a[124:127], v[240:243], v[72:75]
 ds_read_b128 a[84:87], v43 offset:21504
 v_fma_f32 v109, v109, v6, v29
M v[76:79], a[124:127], v[244:247], v[36:39]
 v_fma_f32 v110, v110, v6, v29
 v_fma_f32 v111, v111, v6, v29
M v[76:79], a[120:123], v[228:231], v[76:79]
 ds_read_b128 a[88:91], v43 offset:22528
 v_cvt_pk_bf16_f32 v100, v100, v101
M v[76:79], a[116:119], v[212:215], v[76:79]
 ds_read_b128 a[92:95], v43 offset:23552
 v_cvt_pk_bf16_f32 v101, v102, v103
M v[76:79], a[112:115], v[196:199], v[76:79]
 v_cvt_pk_bf16_f32 v102, v108, v109
M v[76:79], a[108:111], v[180:183], v[76:79]
 v_cvt_pk_bf16_f32 v103, v110, v111
M v[76:79], a[104:107], v[164:167], v[76:79]
 buffer_store_dwordx4 v[100:103], v7, s[8:11], s30 offen offset:0 sc1
M v[76:79], a[100:103], v[148:151], v[76:79]
M v[76:79], a[96:99], v[132:135], v[76:79]
 s_waitcnt lgkmcnt(0)
 v_fma_f32 v112, v112, v5, v28
M v[80:83], a[64:67], v[128:131], v[32:35]
 ds_read_b128 a[96:99], v43 offset:24576
 v_fma_f32 v113, v113, v5, v28
M v[80:83], a[68:71], v[144:147], v[80:83]
 ds_read_b128 a[100:103], v43 offset:25600
 v_fma_f32 v114, v114, v5, v28
M v[80:83], a[72:75], v[160:163], v[80:83]
 v_fma_f32 v115, v115, v5, v28
M v[80:83], a[76:79], v[176:179], v[80:83]
 ds_read_b128 a[104:107], v43 offset:26624
 v_fma_f32 v120, v120, v5, v28
M v[80:83], a[80:83], v[192:195], v[80:83]
 ds_read_b128 a[108:111], v43 offset:27648
 v_fma_f32 v121, v121, v5, v28
M v[80:83], a[84:87], v[208:211], v[80:83]
 v_fma_f32 v122, v122, v5, v28
M v[80:83], a[88:91], v[224:227], v[80:83]
 ds_read_b128 a[112:115], v43 offset:28672
 v_fma_f32 v123, v123, v5, v28
M v[80:83], a[92:95], v[240:243], v[80:83]
 ds_read_b128 a[116:119], v43 offset:29696
 v_cvt_pk_bf16_f32 v112, v112, v113
M v[84:87], a[92:95], v[244:247], v[36:39]
 v_cvt_pk_bf16_f32 v113, v114, v115
 v_cvt_pk_bf16_f32 v114, v120, v121
M v[84:87], a[88:91], v[228:231], v[84:87]
 ds_read_b128 a[120:123], v43 offset:30720
 v_cvt_pk_bf16_f32 v115, v122, v123
M v[84:87], a[84:87], v[212:215], v[84:87]
 ds_read_b128 a[124:127], v43 offset:31744
M v[84:87], a[80:83], v[196:199], v[84:87]
 buffer_store_dwordx4 v[112:115], v7, s[8:11], s29 offen offset:1024 sc1
M v[84:87], a[76:79], v[180:183], v[84:87]
 v_fma_f32 v116, v116, v6, v29
M v[84:87], a[72:75], v[164:167], v[84:87]
 v_fma_f32 v117, v117, v6, v29
M v[84:87], a[68:71], v[148:151], v[84:87]
 s_waitcnt lgkmcnt(0)
 v_fma_f32 v118, v118, v6, v29
M v[84:87], a[64:67], v[132:135], v[84:87]
 s_barrier
M v[88:91], a[96:99], v[128:131], v[32:35]
 ds_read_b128 a[64:67], v2 offset:32768
 v_fma_f32 v119, v119, v6, v29
M v[88:91], a[100:103], v[144:147], v[88:91]
 ds_read_b128 a[68:71], v2 offset:33792
 v_fma_f32 v124, v124, v6, v29
M v[88:91], a[104:107], v[160:163], v[88:91]
 v_fma_f32 v125, v125, v6, v29
 v_fma_f32 v126, v126, v6, v29
M v[88:91], a[108:111], v[176:179], v[88:91]
 ds_read_b128 a[72:75], v2 offset:34816
 v_fma_f32 v127, v127, v6, v29
M v[88:91], a[112:115], v[192:195], v[88:91]
 ds_read_b128 a[76:79], v2 offset:35840
 v_cvt_pk_bf16_f32 v116, v116, v117
M v[88:91], a[116:119], v[208:211], v[88:91]
 v_cvt_pk_bf16_f32 v117, v118, v119
M v[88:91], a[120:123], v[224:227], v[88:91]
 ds_read_b128 a[80:83], v2 offset:36864
 v_cvt_pk_bf16_f32 v118, v124, v125
M v[88:91], a[124:127], v[240:243], v[88:91]
 ds_read_b128 a[84:87], v2 offset:37888
 v_cvt_pk_bf16_f32 v119, v126, v127
M v[92:95], a[124:127], v[244:247], v[36:39]
 buffer_store_dwordx4 v[116:119], v7, s[8:11], s30 offen offset:1024 sc1
M v[92:95], a[120:123], v[228:231], v[92:95]
 ds_read_b128 a[88:91], v2 offset:38912
M v[92:95], a[116:119], v[212:215], v[92:95]
 ds_read_b128 a[92:95], v2 offset:39936
M v[92:95], a[112:115], v[196:199], v[92:95]
M v[92:95], a[108:111], v[180:183], v[92:95]
M v[92:95], a[104:107], v[164:167], v[92:95]
M v[92:95], a[100:103], v[148:151], v[92:95]
 s_waitcnt lgkmcnt(0)
M v[92:95], a[96:99], v[132:135], v[92:95]
M v[96:99], a[64:67], v[128:131], v[32:35]
 ds_read_b128 a[96:99], v2 offset:40960
M v[96:99], a[68:71], v[144:147], v[96:99]
 ds_read_b128 a[100:103], v2 offset:41984
M v[96:99], a[72:75], v[160:163], v[96:99]
M v[96:99], a[76:79], v[176:179], v[96:99]
 ds_read_b128 a[104:107], v2 offset:43008
 s_add_u32 s29, s33, 8192
M v[96:99], a[80:83], v[192:195], v[96:99]
 ds_read_b128 a[108:111], v2 offset:44032
 s_add_u32 s30, s33, 22528
M v[96:99], a[84:87], v[208:211], v[96:99]
 v_fma_f32 v64, v64, v5, v28
 v_fma_f32 v65, v65, v5, v28
M v[96:99], a[88:91], v[224:227], v[96:99]
 ds_read_b128 a[112:115], v2 offset:45056
 v_fma_f32 v66, v66, v5, v28
M v[96:99], a[92:95], v[240:243], v[96:99]
 ds_read_b128 a[116:119], v2 offset:46080
 v_fma_f32 v67, v67, v5, v28
M v[100:103], a[92:95], v[244:247], v[36:39]
 v_fma_f32 v72, v72, v5, v28
M v[100:103], a[88:91], v[228:231], v[100:103]
 ds_read_b128 a[120:123], v2 offset:47104
 v_fma_f32 v73, v73, v5, v28
M v[100:103], a[84:87], v[212:215], v[100:103]
 ds_read_b128 a[124:127], v2 offset:48128
 v_fma_f32 v74, v74, v5, v28
M v[100:103], a[80:83], v[196:199], v[100:103]
 v_fma_f32 v75, v75, v5, v28
M v[100:103], a[76:79], v[180:183], v[100:103]
 v_cvt_pk_bf16_f32 v64, v64, v65
M v[100:103], a[72:75], v[164:167], v[100:103]
 v_cvt_pk_bf16_f32 v65, v66, v67
M v[100:103], a[68:71], v[148:151], v[100:103]
 v_cvt_pk_bf16_f32 v66, v72, v73
M v[100:103], a[64:67], v[132:135], v[100:103]
 s_waitcnt lgkmcnt(0)
 v_cvt_pk_bf16_f32 v67, v74, v75
M v[104:107], a[96:99], v[128:131], v[32:35]
 ds_read_b128 a[64:67], v2 offset:49152
M v[104:107], a[100:103], v[144:147], v[104:107]
 ds_read_b128 a[68:71], v2 offset:50176
M v[104:107], a[104:107], v[160:163], v[104:107]
 buffer_store_dwordx4 v[64:67], v7, s[8:11], s29 offen offset:0 sc1
M v[104:107], a[108:111], v[176:179], v[104:107]
 ds_read_b128 a[72:75], v2 offset:51200
 v_fma_f32 v68, v68, v6, v29
M v[104:107], a[112:115], v[192:195], v[104:107]
 ds_read_b128 a[76:79], v2 offset:52224
 v_fma_f32 v69, v69, v6, v29
M v[104:107], a[116:119], v[208:211], v[104:107]
 v_fma_f32 v70, v70, v6, v29
 v_fma_f32 v71, v71, v6, v29
M v[104:107], a[120:123], v[224:227], v[104:107]
 ds_read_b128 a[80:83], v2 offset:53248
 v_fma_f32 v76, v76, v6, v29
M v[104:107], a[124:127], v[240:243], v[104:107]
 ds_read_b128 a[84:87], v2 offset:54272
 v_fma_f32 v77, v77, v6, v29
M v[108:111], a[124:127], v[244:247], v[36:39]
 v_fma_f32 v78, v78, v6, v29
 v_fma_f32 v79, v79, v6, v29
M v[108:111], a[120:123], v[228:231], v[108:111]
 ds_read_b128 a[88:91], v2 offset:55296
 v_cvt_pk_bf16_f32 v68, v68, v69
M v[108:111], a[116:119], v[212:215], v[108:111]
 ds_read_b128 a[92:95], v2 offset:56320
 v_cvt_pk_bf16_f32 v69, v70, v71
M v[108:111], a[112:115], v[196:199], v[108:111]
 v_cvt_pk_bf16_f32 v70, v76, v77
M v[108:111], a[108:111], v[180:183], v[108:111]
 v_cvt_pk_bf16_f32 v71, v78, v79
M v[108:111], a[104:107], v[164:167], v[108:111]
 buffer_store_dwordx4 v[68:71], v7, s[8:11], s30 offen offset:0 sc1
M v[108:111], a[100:103], v[148:151], v[108:111]
M v[108:111], a[96:99], v[132:135], v[108:111]
 s_waitcnt lgkmcnt(0)
 v_fma_f32 v80, v80, v5, v28
M v[112:115], a[64:67], v[128:131], v[32:35]
 ds_read_b128 a[96:99], v2 offset:57344
 v_fma_f32 v81, v81, v5, v28
M v[112:115], a[68:71], v[144:147], v[112:115]
 ds_read_b128 a[100:103], v2 offset:58368
 v_fma_f32 v82, v82, v5, v28
M v[112:115], a[72:75], v[160:163], v[112:115]
 v_fma_f32 v83, v83, v5, v28
M v[112:115], a[76:79], v[176:179], v[112:115]
 ds_read_b128 a[104:107], v2 offset:59392
 v_fma_f32 v88, v88, v5, v28
M v[112:115], a[80:83], v[192:195], v[112:115]
 ds_read_b128 a[108:111], v2 offset:60416
 v_fma_f32 v89, v89, v5, v28
M v[112:115], a[84:87], v[208:211], v[112:115]
 v_fma_f32 v90, v90, v5, v28
M v[112:115], a[88:91], v[224:227], v[112:115]
 ds_read_b128 a[112:115], v2 offset:61440
 v_fma_f32 v91, v91, v5, v28
M v[112:115], a[92:95], v[240:243], v[112:115]
 ds_read_b128 a[116:119], v2 offset:62464
 v_cvt_pk_bf16_f32 v80, v80, v81
M v[116:119], a[92:95], v[244:247], v[36:39]
 s_waitcnt vmcnt(6)
 v_readlane_b32 s84, v25, 0
 v_readlane_b32 s85, v25, 1
M v[116:119], a[88:91], v[228:231], v[116:119]
 ds_read_b128 a[120:123], v2 offset:63488
 v_mov_b32 v24, 0x3f80
M v[116:119], a[84:87], v[212:215], v[116:119]
 ds_read_b128 a[124:127], v2 offset:64512
 v_mov_b32 v25, 0x3f800000
M v[116:119], a[80:83], v[196:199], v[116:119]
 v_cvt_pk_bf16_f32 v81, v82, v83
 v_cvt_pk_bf16_f32 v82, v88, v89
M v[116:119], a[76:79], v[180:183], v[116:119]
 v_cvt_pk_bf16_f32 v83, v90, v91
M v[116:119], a[72:75], v[164:167], v[116:119]
 buffer_store_dwordx4 v[80:83], v7, s[8:11], s29 offen offset:1024 sc1
M v[116:119], a[68:71], v[148:151], v[116:119]
 s_waitcnt lgkmcnt(0)
 v_fma_f32 v84, v84, v6, v29
 v_fma_f32 v85, v85, v6, v29
M v[116:119], a[64:67], v[132:135], v[116:119]
 s_barrier
M v[120:123], a[96:99], v[128:131], v[32:35]
 ds_read_b128 a[64:67], v7 offset:32768
 v_fma_f32 v86, v86, v6, v29
M v[120:123], a[100:103], v[144:147], v[120:123]
 ds_read_b128 a[68:71], v7 offset:33792
 v_fma_f32 v87, v87, v6, v29
M v[120:123], a[104:107], v[160:163], v[120:123]
 v_fma_f32 v92, v92, v6, v29
 v_fma_f32 v93, v93, v6, v29
M v[120:123], a[108:111], v[176:179], v[120:123]
 ds_read_b128 a[72:75], v7 offset:34816
 v_fma_f32 v94, v94, v6, v29
M v[120:123], a[112:115], v[192:195], v[120:123]
 ds_read_b128 a[76:79], v7 offset:35840
 v_fma_f32 v95, v95, v6, v29
M v[120:123], a[116:119], v[208:211], v[120:123]
 s_waitcnt vmcnt(3)
 v_cvt_pk_bf16_f32 v84, v84, v85
 v_cvt_pk_bf16_f32 v85, v86, v87
M v[120:123], a[120:123], v[224:227], v[120:123]
 ds_read_b128 a[80:83], v7 offset:36864
 v_cvt_pk_bf16_f32 v86, v92, v93
M v[120:123], a[124:127], v[240:243], v[120:123]
 ds_read_b128 a[84:87], v7 offset:37888
 v_cvt_pk_bf16_f32 v87, v94, v95
M v[124:127], a[124:127], v[244:247], v[36:39]
 buffer_store_dword v40, v41, s[8:11], s45 offen sc1
M v[124:127], a[120:123], v[228:231], v[124:127]
 ds_read_b128 a[88:91], v7 offset:38912
M v[124:127], a[116:119], v[212:215], v[124:127]
 ds_read_b128 a[92:95], v7 offset:39936
M v[124:127], a[112:115], v[196:199], v[124:127]
 buffer_store_dwordx4 v[84:87], v7, s[8:11], s30 offen offset:1024 sc1
M v[124:127], a[108:111], v[180:183], v[124:127]
M v[124:127], a[104:107], v[164:167], v[124:127]
M v[124:127], a[100:103], v[148:151], v[124:127]
 s_waitcnt lgkmcnt(0)
 s_cmp_eq_u32 s42, 6
M v[124:127], a[96:99], v[132:135], v[124:127]
 s_cbranch_scc1 L_y3
L_y3r:
M v[64:67], a[64:67], v[128:131], v[32:35]
 ds_read_b128 a[96:99], v7 offset:40960
M v[64:67], a[68:71], v[144:147], v[64:67]
 ds_read_b128 a[100:103], v7 offset:41984
M v[64:67], a[72:75], v[160:163], v[64:67]
M v[64:67], a[76:79], v[176:179], v[64:67]
 ds_read_b128 a[104:107], v7 offset:43008
 s_add_u32 s29, s33, 10240
M v[64:67], a[80:83], v[192:195], v[64:67]
 ds_read_b128 a[108:111], v7 offset:44032
 s_add_u32 s30, s33, 24576
M v[64:67], a[84:87], v[208:211], v[64:67]
 v_fma_f32 v96, v96, v5, v28
 v_fma_f32 v97, v97, v5, v28
M v[64:67], a[88:91], v[224:227], v[64:67]
 ds_read_b128 a[112:115], v7 offset:45056
 v_fma_f32 v98, v98, v5, v28
M v[64:67], a[92:95], v[240:243], v[64:67]
 ds_read_b128 a[116:119], v7 offset:46080
 v_fma_f32 v99, v99, v5, v28
M v[68:71], a[92:95], v[244:247], v[36:39]
 v_fma_f32 v104, v104, v5, v28
 v_fma_f32 v105, v105, v5, v28
M v[68:71], a[88:91], v[228:231], v[68:71]
 ds_read_b128 a[120:123], v7 offset:47104
 v_fma_f32 v106, v106, v5, v28
M v[68:71], a[84:87], v[212:215], v[68:71]
 ds_read_b128 a[124:127], v7 offset:48128
 v_fma_f32 v107, v107, v5, v28
M v[68:71], a[80:83], v[196:199], v[68:71]
 v_cvt_pk_bf16_f32 v96, v96, v97
 v_cvt_pk_bf16_f32 v97, v98, v99
M v[68:71], a[76:79], v[180:183], v[68:71]
 v_cvt_pk_bf16_f32 v98, v104, v105
 v_cvt_pk_bf16_f32 v99, v106, v107
M v[68:71], a[72:75], v[164:167], v[68:71]
 buffer_store_dwordx4 v[96:99], v7, s[8:11], s29 offen offset:0 sc1
M v[68:71], a[68:71], v[148:151], v[68:71]
 v_fma_f32 v100, v100, v6, v29
 v_fma_f32 v101, v101, v6, v29
M v[68:71], a[64:67], v[132:135], v[68:71]
 s_waitcnt lgkmcnt(0)
 v_fma_f32 v102, v102, v6, v29
 v_fma_f32 v103, v103, v6, v29
M v[72:75], a[96:99], v[128:131], v[32:35]
 ds_read_b128 a[64:67], v7 offset:49152
 v_fma_f32 v108, v108, v6, v29
M v[72:75], a[100:103], v[144:147], v[72:75]
 ds_read_b128 a[68:71], v7 offset:50176
 v_fma_f32 v109, v109, v6, v29
M v[72:75], a[104:107], v[160:163], v[72:75]
 v_fma_f32 v110, v110, v6, v29
 v_fma_f32 v111, v111, v6, v29
M v[72:75], a[108:111], v[176:179], v[72:75]
 ds_read_b128 a[72:75], v7 offset:51200
 v_cvt_pk_bf16_f32 v100, v100, v101
M v[72:75], a[112:115], v[192:195], v[72:75]
 ds_read_b128 a[76:79], v7 offset:52224
 v_cvt_pk_bf16_f32 v101, v102, v103
M v[72:75], a[116:119], v[208:211], v[72:75]
 v_cvt_pk_bf16_f32 v102, v108, v109
 v_cvt_pk_bf16_f32 v103, v110, v111
M v[72:75], a[120:123], v[224:227], v[72:75]
 ds_read_b128 a[80:83], v7 offset:53248
M v[72:75], a[124:127], v[240:243], v[72:75]
 ds_read_b128 a[84:87], v7 offset:54272
M v[76:79], a[124:127], v[244:247], v[36:39]
 buffer_store_dwordx4 v[100:103], v7, s[8:11], s30 offen offset:0 sc1
M v[76:79], a[120:123], v[228:231], v[76:79]
 ds_read_b128 a[88:91], v7 offset:55296
 v_fma_f32 v112, v112, v5, v28
M v[76:79], a[116:119], v[212:215], v[76:79]
 ds_read_b128 a[92:95], v7 offset:56320
 v_fma_f32 v113, v113, v5, v28
M v[76:79], a[112:115], v[196:199], v[76:79]
 v_fma_f32 v114, v114, v5, v28
 v_fma_f32 v115, v115, v5, v28
M v[76:79], a[108:111], v[180:183], v[76:79]
 v_fma_f32 v120, v120, v5, v28
 v_fma_f32 v121, v121, v5, v28
M v[76:79], a[104:107], v[164:167], v[76:79]
 v_fma_f32 v122, v122, v5, v28
 v_fma_f32 v123, v123, v5, v28
M v[76:79], a[100:103], v[148:151], v[76:79]
 v_cvt_pk_bf16_f32 v112, v112, v113
 v_cvt_pk_bf16_f32 v113, v114, v115
M v[76:79], a[96:99], v[132:135], v[76:79]
 s_waitcnt lgkmcnt(0)
 v_cvt_pk_bf16_f32 v114, v120, v121
 v_cvt_pk_bf16_f32 v115, v122, v123
M v[80:83], a[64:67], v[128:131], v[32:35]
 ds_read_b128 a[96:99], v7 offset:57344
M v[80:83], a[68:71], v[144:147], v[80:83]
 ds_read_b128 a[100:103], v7 offset:58368
M v[80:83], a[72:75], v[160:163], v[80:83]
 buffer_store_dwordx4 v[112:115], v7, s[8:11], s29 offen offset:1024 sc1
M v[80:83], a[76:79], v[176:179], v[80:83]
 ds_read_b128 a[104:107], v7 offset:59392
 v_fma_f32 v116, v116, v6, v29
M v[80:83], a[80:83], v[192:195], v[80:83]
 ds_read_b128 a[108:111], v7 offset:60416
 v_fma_f32 v117, v117, v6, v29
M v[80:83], a[84:87], v[208:211], v[80:83]
 v_fma_f32 v118, v118, v6, v29
 v_fma_f32 v119, v119, v6, v29
M v[80:83], a[88:91], v[224:227], v[80:83]
 ds_read_b128 a[112:115], v7 offset:61440
 v_fma_f32 v124, v124, v6, v29
M v[80:83], a[92:95], v[240:243], v[80:83]
 ds_read_b128 a[116:119], v7 offset:62464
 v_fma_f32 v125, v125, v6, v29
M v[84:87], a[92:95], v[244:247], v[36:39]
 v_fma_f32 v126, v126, v6, v29
 v_fma_f32 v127, v127, v6, v29
M v[84:87], a[88:91], v[228:231], v[84:87]
 ds_read_b128 a[120:123], v7 offset:63488
 v_cvt_pk_bf16_f32 v116, v116, v117
M v[84:87], a[84:87], v[212:215], v[84:87]
 ds_read_b128 a[124:127], v7 offset:64512
 v_cvt_pk_bf16_f32 v117, v118, v119
M v[84:87], a[80:83], v[196:199], v[84:87]
 v_cvt_pk_bf16_f32 v118, v124, v125
 v_cvt_pk_bf16_f32 v119, v126, v127
M v[84:87], a[76:79], v[180:183], v[84:87]
 buffer_store_dwordx4 v[116:119], v7, s[8:11], s30 offen offset:1024 sc1
M v[84:87], a[72:75], v[164:167], v[84:87]
 s_add_u32 s29, s33, 12288
M v[84:87], a[68:71], v[148:151], v[84:87]
 s_add_u32 s30, s33, 26624
 v_fma_f32 v64, v64, v5, v28
 v_fma_f32 v65, v65, v5, v28
M v[84:87], a[64:67], v[132:135], v[84:87]
 s_waitcnt lgkmcnt(0)
 v_fma_f32 v66, v66, v5, v28
 v_fma_f32 v67, v67, v5, v28
M v[88:91], a[96:99], v[128:131], v[32:35]
 v_fma_f32 v72, v72, v5, v28
 v_fma_f32 v73, v73, v5, v28
M v[88:91], a[100:103], v[144:147], v[88:91]
 v_fma_f32 v74, v74, v5, v28
 v_fma_f32 v75, v75, v5, v28
M v[88:91], a[104:107], v[160:163], v[88:91]
 v_cvt_pk_bf16_f32 v64, v64, v65
 v_cvt_pk_bf16_f32 v65, v66, v67
M v[88:91], a[108:111], v[176:179], v[88:91]
 v_cvt_pk_bf16_f32 v66, v72, v73
 v_cvt_pk_bf16_f32 v67, v74, v75
M v[88:91], a[112:115], v[192:195], v[88:91]
 buffer_store_dwordx4 v[64:67], v7, s[8:11], s29 offen offset:0 sc1
M v[88:91], a[116:119], v[208:211], v[88:91]
 v_fma_f32 v68, v68, v6, v29
 v_fma_f32 v69, v69, v6, v29
M v[88:91], a[120:123], v[224:227], v[88:91]
 v_fma_f32 v70, v70, v6, v29
 v_fma_f32 v71, v71, v6, v29
M v[88:91], a[124:127], v[240:243], v[88:91]
 v_fma_f32 v76, v76, v6, v29
 v_fma_f32 v77, v77, v6, v29
M v[92:95], a[124:127], v[244:247], v[36:39]
 v_fma_f32 v78, v78, v6, v29
 v_fma_f32 v79, v79, v6, v29
M v[92:95], a[120:123], v[228:231], v[92:95]
 v_cvt_pk_bf16_f32 v68, v68, v69
 v_cvt_pk_bf16_f32 v69, v70, v71
M v[92:95], a[116:119], v[212:215], v[92:95]
 v_cvt_pk_bf16_f32 v70, v76, v77
 v_cvt_pk_bf16_f32 v71, v78, v79
M v[92:95], a[112:115], v[196:199], v[92:95]
 buffer_store_dwordx4 v[68:71], v7, s[8:11], s30 offen offset:0 sc1
M v[92:95], a[108:111], v[180:183], v[92:95]
M v[92:95], a[104:107], v[164:167], v[92:95]
M v[92:95], a[100:103], v[148:151], v[92:95]
M v[92:95], a[96:99], v[132:135], v[92:95]
 v_fma_f32 v80, v80, v5, v28
 v_fma_f32 v81, v81, v5, v28
 v_fma_f32 v82, v82, v5, v28
 v_fma_f32 v83, v83, v5, v28
 v_fma_f32 v88, v88, v5, v28
 v_fma_f32 v89, v89, v5, v28
 v_fma_f32 v90, v90, v5, v28
 v_fma_f32 v91, v91, v5, v28
 v_cvt_pk_bf16_f32 v80, v80, v81
 v_cvt_pk_bf16_f32 v81, v82, v83
 v_cvt_pk_bf16_f32 v82, v88, v89
 v_cvt_pk_bf16_f32 v83, v90, v91
 buffer_store_dwordx4 v[80:83], v7, s[8:11], s29 offen offset:1024 sc1
 v_fma_f32 v84, v84, v6, v29
 v_fma_f32 v85, v85, v6, v29
 v_fma_f32 v86, v86, v6, v29
 v_fma_f32 v87, v87, v6, v29
 v_fma_f32 v92, v92, v6, v29
 v_fma_f32 v93, v93, v6, v29
 v_fma_f32 v94, v94, v6, v29
 v_fma_f32 v95, v95, v6, v29
 v_cvt_pk_bf16_f32 v84, v84, v85
 v_cvt_pk_bf16_f32 v85, v86, v87
 v_cvt_pk_bf16_f32 v86, v92, v93
 v_cvt_pk_bf16_f32 v87, v94, v95
 buffer_store_dwordx4 v[84:87], v7, s[8:11], s30 offen offset:1024 sc1
 s_cmp_lt_u32 s42, 8
 s_cbranch_scc1 L_red
 s_cmp_eq_u32 s20, 3
 s_cbranch_scc1 L_vend3
 s_sub_u32 s64, 15, s42
 s_lshl_b32 s64, s64, 1
 s_lshr_b32 s65, s41, 3
 s_add_u32 s46, s64, s65
 s_mul_i32 s46, s46, 4352
 s_and_b32 s72, s41, 7
 s_lshl_b32 s66, s72, 7
 s_add_u32 s46, s46, s66
 s_add_u32 s46, s46, 104993792
 v_and_b32 v14, 15, v0
 v_lshlrev_b32 v14, 2, v14
 buffer_load_dword v9, v14, s[8:11], s46 offen sc1
 s_mul_i32 s86, s65, 3
 s_add_u32 s86, s86, s20
 s_add_u32 s86, s86, 8
 s_mul_i32 s77, s42, 1835008
 s_mul_i32 s78, s72, 14336
 s_add_u32 s77, s77, s78
 s_add_u32 s77, s77, 67108864
 s_lshl_b32 s78, s86, 10
 s_add_u32 s77, s77, s78
 s_lshl_b32 s86, s86, 6
 s_lshr_b32 s73, s72, 1
 s_sub_u32 s65, 7, s73
 s_bitcmp1_b32 s72, 0
 s_cselect_b32 s73, s65, s73
 s_lshl_b32 s73, s73, 4
 s_lshl_b32 s65, s42, 7
 s_add_u32 s73, s73, s65
 v_and_b32 v10, 15, v0
 v_add_u32 v10, s73, v10
 s_mov_b32 s64, 104857664
 v_mul_u32_u24 v12, 896, v10
 v_lshl_add_u32 v12, v11, 4, v12
 v_lshrrev_b32 v13, 4, v10
 v_lshlrev_b32 v13, 5, v13
 v_and_b32 v104, 15, v10
 v_add_lshl_u32 v13, v13, v104, 2
 buffer_load_dword v15, v13, s[8:11], s64 offen sc1
 buffer_load_dwordx4 v[16:19], v12, s[56:59], s86 offen
 v_mov_b32 v48, 0
 v_mov_b32 v49, 0
 v_mov_b32 v50, 0
 v_mov_b32 v51, 0
 v_mov_b32 v52, 0
 v_mov_b32 v53, 0
 v_mov_b32 v54, 0
 v_mov_b32 v55, 0
 s_waitcnt vmcnt(3)
 buffer_store_dword v40, v41, s[8:11], s3 offen sc1
 s_waitcnt vmcnt(3)
 v_cmp_eq_u32 vcc, 1, v9
 s_mov_b32 s91, 65536
 s_mov_b32 s69, 0
 s_and_b32 s70, vcc_lo, 0xffff
 s_or_b32 s68, s70, 0xffff0000
 s_cmp_lg_u32 s70, 0
 s_cbranch_scc1 L_vk0
 s_call_b64 s[36:37], L_rpoll
L_vk0:
 s_ff1_i32_b32 s71, s70
 s_bitset0_b32 s70, s71
 s_mul_i32 s71, s71, 114688
 s_add_u32 s12, s71, s77
 buffer_load_dwordx4 v[128:131], v7, s[8:11], s12 offen sc1
 s_cmp_lg_u32 s70, 0
 s_cbranch_scc1 L_vk1
 s_call_b64 s[36:37], L_rpoll
L_vk1:
 s_ff1_i32_b32 s71, s70
 s_bitset0_b32 s70, s71
 s_mul_i32 s71, s71, 114688
 s_add_u32 s13, s71, s77
 buffer_load_dwordx4 v[132:135], v7, s[8:11], s13 offen sc1
 s_waitcnt vmcnt(3)
 v_lshlrev_b32 v32, 16, v16
 v_and_b32 v33, 0xffff0000, v16
 v_lshlrev_b32 v34, 16, v17
 v_and_b32 v35, 0xffff0000, v17
 v_lshlrev_b32 v36, 16, v18
 v_and_b32 v37, 0xffff0000, v18
 v_lshlrev_b32 v38, 16, v19
 v_and_b32 v39, 0xffff0000, v19
 v_sub_f32 v13, 1.0, v15
 v_cmp_eq_u32 s[80:81], s84, v10
 v_cmp_eq_u32 s[82:83], s85, v10
 s_nop 0
 s_or_b64 vcc, s[80:81], s[82:83]
 s_cbranch_vccnz L_moe2
L_moe_ret2:
 v_mul_f32 v32, v13, v32
 v_mul_f32 v33, v13, v33
 v_mul_f32 v34, v13, v34
 v_mul_f32 v35, v13, v35
 v_mul_f32 v36, v13, v36
 v_mul_f32 v37, v13, v37
 v_mul_f32 v38, v13, v38
 v_mul_f32 v39, v13, v39
 s_cmp_lg_u32 s70, 0
 s_cbranch_scc1 L_vk2
 s_call_b64 s[36:37], L_rpoll
L_vk2:
 s_ff1_i32_b32 s71, s70
 s_bitset0_b32 s70, s71
 s_mul_i32 s71, s71, 114688
 s_add_u32 s14, s71, s77
 buffer_load_dwordx4 v[136:139], v7, s[8:11], s14 offen sc1
 s_cmp_lg_u32 s70, 0
 s_cbranch_scc1 L_vk3
 s_call_b64 s[36:37], L_rpoll
L_vk3:
 s_ff1_i32_b32 s71, s70
 s_bitset0_b32 s70, s71
 s_mul_i32 s71, s71, 114688
 s_add_u32 s15, s71, s77
 buffer_load_dwordx4 v[140:143], v7, s[8:11], s15 offen sc1
 s_cmp_lg_u32 s70, 0
 s_cbranch_scc1 L_vk4
 s_call_b64 s[36:37], L_rpoll
L_vk4:
 s_ff1_i32_b32 s71, s70
 s_bitset0_b32 s70, s71
 s_mul_i32 s71, s71, 114688
 s_add_u32 s16, s71, s77
 buffer_load_dwordx4 v[144:147], v7, s[8:11], s16 offen sc1
 s_cmp_lg_u32 s70, 0
 s_cbranch_scc1 L_vk5
 s_call_b64 s[36:37], L_rpoll
L_vk5:
 s_ff1_i32_b32 s71, s70
 s_bitset0_b32 s70, s71
 s_mul_i32 s71, s71, 114688
 s_add_u32 s17, s71, s77
 buffer_load_dwordx4 v[148:151], v7, s[8:11], s17 offen sc1
 s_cmp_lg_u32 s70, 0
 s_cbranch_scc1 L_vk6
 s_call_b64 s[36:37], L_rpoll
L_vk6:
 s_ff1_i32_b32 s71, s70
 s_bitset0_b32 s70, s71
 s_mul_i32 s71, s71, 114688
 s_add_u32 s18, s71, s77
 buffer_load_dwordx4 v[152:155], v7, s[8:11], s18 offen sc1
 s_cmp_lg_u32 s70, 0
 s_cbranch_scc1 L_vk7
 s_call_b64 s[36:37], L_rpoll
L_vk7:
 s_ff1_i32_b32 s71, s70
 s_bitset0_b32 s70, s71
 s_mul_i32 s71, s71, 114688
 s_add_u32 s19, s71, s77
 buffer_load_dwordx4 v[156:159], v7, s[8:11], s19 offen sc1
 s_cmp_lg_u32 s70, 0
 s_cbranch_scc1 L_vk8
 s_call_b64 s[36:37], L_rpoll
L_vk8:
 s_ff1_i32_b32 s71, s70
 s_bitset0_b32 s70, s71
 s_mul_i32 s71, s71, 114688
 s_add_u32 s21, s71, s77
 buffer_load_dwordx4 v[160:163], v7, s[8:11], s21 offen sc1
 s_cmp_lg_u32 s70, 0
 s_cbranch_scc1 L_vk9
 s_call_b64 s[36:37], L_rpoll
L_vk9:
 s_ff1_i32_b32 s71, s70
 s_bitset0_b32 s70, s71
 s_mul_i32 s71, s71, 114688
 s_add_u32 s22, s71, s77
 buffer_load_dwordx4 v[164:167], v7, s[8:11], s22 offen sc1
 s_cmp_lg_u32 s70, 0
 s_cbranch_scc1 L_vk10
 s_call_b64 s[36:37], L_rpoll
L_vk10:
 s_ff1_i32_b32 s71, s70
 s_bitset0_b32 s70, s71
 s_mul_i32 s71, s71, 114688
 s_add_u32 s23, s71, s77
 buffer_load_dwordx4 v[168:171], v7, s[8:11], s23 offen sc1
 s_cmp_lg_u32 s70, 0
 s_cbranch_scc1 L_vk11
 s_call_b64 s[36:37], L_rpoll
L_vk11:
 s_ff1_i32_b32 s71, s70
 s_bitset0_b32 s70, s71
 s_mul_i32 s71, s71, 114688
 s_add_u32 s24, s71, s77
 buffer_load_dwordx4 v[172:175], v7, s[8:11], s24 offen sc1
 s_cmp_lg_u32 s70, 0
 s_cbranch_scc1 L_vk12
 s_call_b64 s[36:37], L_rpoll
L_vk12:
 s_ff1_i32_b32 s71, s70
 s_bitset0_b32 s70, s71
 s_mul_i32 s71, s71, 114688
 s_add_u32 s48, s71, s77
 buffer_load_dwordx4 v[176:179], v7, s[8:11], s48 offen sc1
 s_cmp_lg_u32 s70, 0
 s_cbranch_scc1 L_vk13
 s_call_b64 s[36:37], L_rpoll
L_vk13:
 s_ff1_i32_b32 s71, s70
 s_bitset0_b32 s70, s71
 s_mul_i32 s71, s71, 114688
 s_add_u32 s49, s71, s77
 buffer_load_dwordx4 v[180:183], v7, s[8:11], s49 offen sc1
 s_cmp_lg_u32 s70, 0
 s_cbranch_scc1 L_vk14
 s_call_b64 s[36:37], L_rpoll
L_vk14:
 s_ff1_i32_b32 s71, s70
 s_bitset0_b32 s70, s71
 s_mul_i32 s71, s71, 114688
 s_add_u32 s50, s71, s77
 buffer_load_dwordx4 v[184:187], v7, s[8:11], s50 offen sc1
 s_cmp_lg_u32 s70, 0
 s_cbranch_scc1 L_vk15
 s_call_b64 s[36:37], L_rpoll
L_vk15:
 s_ff1_i32_b32 s71, s70
 s_bitset0_b32 s70, s71
 s_mul_i32 s71, s71, 114688
 s_add_u32 s51, s71, s77
 buffer_load_dwordx4 v[188:191], v7, s[8:11], s51 offen sc1
 s_waitcnt vmcnt(15)
 v_dot2c_f32_bf16 v48, v128, v24
 v_dot2c_f32_bf16 v49, v128, v25
 v_dot2c_f32_bf16 v50, v129, v24
 v_dot2c_f32_bf16 v51, v129, v25
 v_dot2c_f32_bf16 v52, v130, v24
 v_dot2c_f32_bf16 v53, v130, v25
 v_dot2c_f32_bf16 v54, v131, v24
 v_dot2c_f32_bf16 v55, v131, v25
 s_waitcnt vmcnt(14)
 v_dot2c_f32_bf16 v48, v132, v24
 v_dot2c_f32_bf16 v49, v132, v25
 v_dot2c_f32_bf16 v50, v133, v24
 v_dot2c_f32_bf16 v51, v133, v25
 v_dot2c_f32_bf16 v52, v134, v24
 v_dot2c_f32_bf16 v53, v134, v25
 v_dot2c_f32_bf16 v54, v135, v24
 v_dot2c_f32_bf16 v55, v135, v25
 s_waitcnt vmcnt(13)
 v_dot2c_f32_bf16 v48, v136, v24
 v_dot2c_f32_bf16 v49, v136, v25
 v_dot2c_f32_bf16 v50, v137, v24
 v_dot2c_f32_bf16 v51, v137, v25
 v_dot2c_f32_bf16 v52, v138, v24
 v_dot2c_f32_bf16 v53, v138, v25
 v_dot2c_f32_bf16 v54, v139, v24
 v_dot2c_f32_bf16 v55, v139, v25
 s_waitcnt vmcnt(12)
 v_dot2c_f32_bf16 v48, v140, v24
 v_dot2c_f32_bf16 v49, v140, v25
 v_dot2c_f32_bf16 v50, v141, v24
 v_dot2c_f32_bf16 v51, v141, v25
 v_dot2c_f32_bf16 v52, v142, v24
 v_dot2c_f32_bf16 v53, v142, v25
 v_dot2c_f32_bf16 v54, v143, v24
 v_dot2c_f32_bf16 v55, v143, v25
 s_waitcnt vmcnt(11)
 v_dot2c_f32_bf16 v48, v144, v24
 v_dot2c_f32_bf16 v49, v144, v25
 v_dot2c_f32_bf16 v50, v145, v24
 v_dot2c_f32_bf16 v51, v145, v25
 v_dot2c_f32_bf16 v52, v146, v24
 v_dot2c_f32_bf16 v53, v146, v25
 v_dot2c_f32_bf16 v54, v147, v24
 v_dot2c_f32_bf16 v55, v147, v25
 s_waitcnt vmcnt(10)
 v_dot2c_f32_bf16 v48, v148, v24
 v_dot2c_f32_bf16 v49, v148, v25
 v_dot2c_f32_bf16 v50, v149, v24
 v_dot2c_f32_bf16 v51, v149, v25
 v_dot2c_f32_bf16 v52, v150, v24
 v_dot2c_f32_bf16 v53, v150, v25
 v_dot2c_f32_bf16 v54, v151, v24
 v_dot2c_f32_bf16 v55, v151, v25
 s_waitcnt vmcnt(9)
 v_dot2c_f32_bf16 v48, v152, v24
 v_dot2c_f32_bf16 v49, v152, v25
 v_dot2c_f32_bf16 v50, v153, v24
 v_dot2c_f32_bf16 v51, v153, v25
 v_dot2c_f32_bf16 v52, v154, v24
 v_dot2c_f32_bf16 v53, v154, v25
 v_dot2c_f32_bf16 v54, v155, v24
 v_dot2c_f32_bf16 v55, v155, v25
 s_waitcnt vmcnt(8)
 v_dot2c_f32_bf16 v48, v156, v24
 v_dot2c_f32_bf16 v49, v156, v25
 v_dot2c_f32_bf16 v50, v157, v24
 v_dot2c_f32_bf16 v51, v157, v25
 v_dot2c_f32_bf16 v52, v158, v24
 v_dot2c_f32_bf16 v53, v158, v25
 v_dot2c_f32_bf16 v54, v159, v24
 v_dot2c_f32_bf16 v55, v159, v25
 s_waitcnt vmcnt(7)
 v_dot2c_f32_bf16 v48, v160, v24
 v_dot2c_f32_bf16 v49, v160, v25
 v_dot2c_f32_bf16 v50, v161, v24
 v_dot2c_f32_bf16 v51, v161, v25
 v_dot2c_f32_bf16 v52, v162, v24
 v_dot2c_f32_bf16 v53, v162, v25
 v_dot2c_f32_bf16 v54, v163, v24
 v_dot2c_f32_bf16 v55, v163, v25
 s_waitcnt vmcnt(6)
 v_dot2c_f32_bf16 v48, v164, v24
 v_dot2c_f32_bf16 v49, v164, v25
 v_dot2c_f32_bf16 v50, v165, v24
 v_dot2c_f32_bf16 v51, v165, v25
 v_dot2c_f32_bf16 v52, v166, v24
 v_dot2c_f32_bf16 v53, v166, v25
 v_dot2c_f32_bf16 v54, v167, v24
 v_dot2c_f32_bf16 v55, v167, v25
 s_waitcnt vmcnt(5)
 v_dot2c_f32_bf16 v48, v168, v24
 v_dot2c_f32_bf16 v49, v168, v25
 v_dot2c_f32_bf16 v50, v169, v24
 v_dot2c_f32_bf16 v51, v169, v25
 v_dot2c_f32_bf16 v52, v170, v24
 v_dot2c_f32_bf16 v53, v170, v25
 v_dot2c_f32_bf16 v54, v171, v24
 v_dot2c_f32_bf16 v55, v171, v25
 s_waitcnt vmcnt(4)
 v_dot2c_f32_bf16 v48, v172, v24
 v_dot2c_f32_bf16 v49, v172, v25
 v_dot2c_f32_bf16 v50, v173, v24
 v_dot2c_f32_bf16 v51, v173, v25
 v_dot2c_f32_bf16 v52, v174, v24
 v_dot2c_f32_bf16 v53, v174, v25
 v_dot2c_f32_bf16 v54, v175, v24
 v_dot2c_f32_bf16 v55, v175, v25
 s_waitcnt vmcnt(3)
 v_dot2c_f32_bf16 v48, v176, v24
 v_dot2c_f32_bf16 v49, v176, v25
 v_dot2c_f32_bf16 v50, v177, v24
 v_dot2c_f32_bf16 v51, v177, v25
 v_dot2c_f32_bf16 v52, v178, v24
 v_dot2c_f32_bf16 v53, v178, v25
 v_dot2c_f32_bf16 v54, v179, v24
 v_dot2c_f32_bf16 v55, v179, v25
 s_waitcnt vmcnt(2)
 v_dot2c_f32_bf16 v48, v180, v24
 v_dot2c_f32_bf16 v49, v180, v25
 v_dot2c_f32_bf16 v50, v181, v24
 v_dot2c_f32_bf16 v51, v181, v25
 v_dot2c_f32_bf16 v52, v182, v24
 v_dot2c_f32_bf16 v53, v182, v25
 v_dot2c_f32_bf16 v54, v183, v24
 v_dot2c_f32_bf16 v55, v183, v25
 s_waitcnt vmcnt(1)
 v_dot2c_f32_bf16 v48, v184, v24
 v_dot2c_f32_bf16 v49, v184, v25
 v_dot2c_f32_bf16 v50, v185, v24
 v_dot2c_f32_bf16 v51, v185, v25
 v_dot2c_f32_bf16 v52, v186, v24
 v_dot2c_f32_bf16 v53, v186, v25
 v_dot2c_f32_bf16 v54, v187, v24
 v_dot2c_f32_bf16 v55, v187, v25
 s_waitcnt vmcnt(0)
 v_dot2c_f32_bf16 v48, v188, v24
 v_dot2c_f32_bf16 v49, v188, v25
 v_dot2c_f32_bf16 v50, v189, v24
 v_dot2c_f32_bf16 v51, v189, v25
 v_dot2c_f32_bf16 v52, v190, v24
 v_dot2c_f32_bf16 v53, v190, v25
 v_dot2c_f32_bf16 v54, v191, v24
 v_dot2c_f32_bf16 v55, v191, v25
 s_nop 1
 v_fmac_f32 v32, v15, v48
 v_fmac_f32 v33, v15, v49
 v_fmac_f32 v34, v15, v50
 v_fmac_f32 v35, v15, v51
 v_fmac_f32 v36, v15, v52
 v_fmac_f32 v37, v15, v53
 v_fmac_f32 v38, v15, v54
 v_fmac_f32 v39, v15, v55
 v_cvt_pk_bf16_f32 v16, v32, v33
 v_cvt_pk_bf16_f32 v17, v34, v35
 v_cvt_pk_bf16_f32 v18, v36, v37
 v_cvt_pk_bf16_f32 v19, v38, v39
 buffer_store_dwordx4 v[16:19], v12, s[52:55], s86 offen sc1
L_vend:
 s_endpgm
L_vend3:
 s_waitcnt vmcnt(0)
 buffer_store_dword v40, v41, s[8:11], s3 offen sc1
 s_branch L_vend
 s_waitcnt vmcnt(0)
L_p3k:
 s_mov_b32 s72, s32
 s_add_u32 s73, s72, 4096
 s_add_u32 s74, s72, 8192
 s_add_u32 s75, s72, 12288
 s_waitcnt vmcnt(8)
 v_cmp_ne_u32 vcc, 1, v5
 s_nop 0
 s_cbranch_vccnz L_fps1
L_fpr1:
M v[128:131], a[64:67], v[40:43], v[128:131]
 ds_read_b128 a[96:99], v2 offset:8192
 ds_read_b128 a[100:103], v2 offset:9216
M v[128:131], a[68:71], v[56:59], v[128:131]
 buffer_load_dwordx4 a[0:3], v7, s[8:11], s72 offen offset:0 sc1
M v[132:135], a[68:71], v[60:63], v[132:135]
 v_exp_f32 v18, v100
M v[132:135], a[64:67], v[44:47], v[132:135]
 ds_read_b128 a[104:107], v2 offset:10240
 ds_read_b128 a[108:111], v2 offset:11264
M v[136:139], a[72:75], v[40:43], v[136:139]
 buffer_load_dwordx4 a[4:7], v7, s[8:11], s72 offen offset:1024 sc1
M v[136:139], a[76:79], v[56:59], v[136:139]
 v_exp_f32 v19, v101
M v[140:143], a[76:79], v[60:63], v[140:143]
 ds_read_b128 a[112:115], v2 offset:12288
 ds_read_b128 a[116:119], v2 offset:13312
M v[140:143], a[72:75], v[44:47], v[140:143]
 buffer_load_dwordx4 a[8:11], v7, s[8:11], s72 offen offset:2048 sc1
M v[144:147], a[80:83], v[40:43], v[144:147]
 v_exp_f32 v20, v102
M v[144:147], a[84:87], v[56:59], v[144:147]
 ds_read_b128 a[120:123], v2 offset:14336
 ds_read_b128 a[124:127], v2 offset:15360
M v[148:151], a[84:87], v[60:63], v[148:151]
 v_exp_f32 v21, v103
M v[148:151], a[80:83], v[44:47], v[148:151]
 buffer_load_dwordx4 a[12:15], v7, s[8:11], s72 offen offset:3072 sc1
M v[152:155], a[88:91], v[40:43], v[152:155]
 v_add_f32 v30, v26, v30
 v_add_f32 v31, v27, v31
M v[152:155], a[92:95], v[56:59], v[152:155]
 v_add_f32 v29, v18, v19
 v_cvt_pk_bf16_f32 v52, v18, v19
M v[156:159], a[92:95], v[60:63], v[156:159]
 v_exp_f32 v22, v108
M v[156:159], a[88:91], v[44:47], v[156:159]
 s_waitcnt lgkmcnt(0)
 v_add_f32 v29, v20, v29
 v_cvt_pk_bf16_f32 v53, v20, v21
M v[160:163], a[96:99], v[40:43], v[160:163]
 ds_read_b128 a[64:67], v2 offset:16384
 ds_read_b128 a[68:71], v2 offset:17408
M v[160:163], a[100:103], v[56:59], v[160:163]
 buffer_load_dwordx4 a[16:19], v7, s[8:11], s73 offen offset:0 sc1
M v[164:167], a[100:103], v[60:63], v[164:167]
 v_exp_f32 v23, v109
M v[164:167], a[96:99], v[44:47], v[164:167]
 ds_read_b128 a[72:75], v2 offset:18432
 ds_read_b128 a[76:79], v2 offset:19456
M v[168:171], a[104:107], v[40:43], v[168:171]
 buffer_load_dwordx4 a[20:23], v7, s[8:11], s73 offen offset:1024 sc1
M v[168:171], a[108:111], v[56:59], v[168:171]
 v_exp_f32 v24, v110
M v[172:175], a[108:111], v[60:63], v[172:175]
 ds_read_b128 a[80:83], v2 offset:20480
 ds_read_b128 a[84:87], v2 offset:21504
M v[172:175], a[104:107], v[44:47], v[172:175]
 buffer_load_dwordx4 a[24:27], v7, s[8:11], s73 offen offset:2048 sc1
M v[176:179], a[112:115], v[40:43], v[176:179]
 v_exp_f32 v25, v111
M v[176:179], a[116:119], v[56:59], v[176:179]
 ds_read_b128 a[88:91], v2 offset:22528
 ds_read_b128 a[92:95], v2 offset:23552
M v[180:183], a[116:119], v[60:63], v[180:183]
 buffer_load_dwordx4 a[28:31], v7, s[8:11], s73 offen offset:3072 sc1
M v[180:183], a[112:115], v[44:47], v[180:183]
 v_add_f32 v29, v21, v29
 v_add_f32 v29, v22, v29
M v[184:187], a[120:123], v[40:43], v[184:187]
 v_exp_f32 v18, v116
M v[184:187], a[124:127], v[56:59], v[184:187]
 v_cvt_pk_bf16_f32 v54, v22, v23
 v_add_f32 v29, v23, v29
M v[188:191], a[124:127], v[60:63], v[188:191]
 buffer_load_dwordx4 a[32:35], v7, s[8:11], s74 offen offset:0 sc1
M v[188:191], a[120:123], v[44:47], v[188:191]
 s_waitcnt lgkmcnt(0)
 v_exp_f32 v19, v117
M v[192:195], a[64:67], v[40:43], v[192:195]
 ds_read_b128 a[96:99], v2 offset:24576
 ds_read_b128 a[100:103], v2 offset:25600
M v[192:195], a[68:71], v[56:59], v[192:195]
 buffer_load_dwordx4 a[36:39], v7, s[8:11], s74 offen offset:1024 sc1
M v[196:199], a[68:71], v[60:63], v[196:199]
 v_add_f32 v29, v24, v29
 v_cvt_pk_bf16_f32 v55, v24, v25
M v[196:199], a[64:67], v[44:47], v[196:199]
 ds_read_b128 a[104:107], v2 offset:26624
 ds_read_b128 a[108:111], v2 offset:27648
M v[200:203], a[72:75], v[40:43], v[200:203]
 v_exp_f32 v20, v118
M v[200:203], a[76:79], v[56:59], v[200:203]
 buffer_load_dwordx4 a[40:43], v7, s[8:11], s74 offen offset:2048 sc1
M v[204:207], a[76:79], v[60:63], v[204:207]
 ds_read_b128 a[112:115], v2 offset:28672
 ds_read_b128 a[116:119], v2 offset:29696
M v[204:207], a[72:75], v[44:47], v[204:207]
 v_exp_f32 v21, v119
M v[208:211], a[80:83], v[40:43], v[208:211]
 v_add_f32 v29, v25, v29
 v_add_f32 v29, v18, v29
M v[208:211], a[84:87], v[56:59], v[208:211]
 ds_read_b128 a[120:123], v2 offset:30720
 ds_read_b128 a[124:127], v2 offset:31744
M v[212:215], a[84:87], v[60:63], v[212:215]
 buffer_load_dwordx4 a[44:47], v7, s[8:11], s74 offen offset:3072 sc1
M v[212:215], a[80:83], v[44:47], v[212:215]
 v_exp_f32 v22, v124
M v[216:219], a[88:91], v[40:43], v[216:219]
 v_cvt_pk_bf16_f32 v48, v18, v19
 v_add_f32 v29, v19, v29
M v[216:219], a[92:95], v[56:59], v[216:219]
 buffer_load_dwordx4 a[48:51], v7, s[8:11], s75 offen offset:0 sc1
M v[220:223], a[92:95], v[60:63], v[220:223]
 s_waitcnt vmcnt(13) lgkmcnt(0)
 v_exp_f32 v23, v125
M v[220:223], a[88:91], v[44:47], v[220:223]
 s_barrier
M v[224:227], a[96:99], v[40:43], v[224:227]
 ds_read_b128 a[64:67], v7 offset:0
 ds_read_b128 a[68:71], v7 offset:1024
M v[224:227], a[100:103], v[56:59], v[224:227]
 buffer_load_dwordx4 a[52:55], v7, s[8:11], s75 offen offset:1024 sc1
M v[228:231], a[100:103], v[60:63], v[228:231]
 v_exp_f32 v24, v126
M v[228:231], a[96:99], v[44:47], v[228:231]
 ds_read_b128 a[72:75], v7 offset:2048
 ds_read_b128 a[76:79], v7 offset:3072
M v[232:235], a[104:107], v[40:43], v[232:235]
 buffer_load_dwordx4 a[56:59], v7, s[8:11], s75 offen offset:2048 sc1
M v[232:235], a[108:111], v[56:59], v[232:235]
 v_exp_f32 v25, v127
M v[236:239], a[108:111], v[60:63], v[236:239]
 ds_read_b128 a[80:83], v7 offset:4096
 ds_read_b128 a[84:87], v7 offset:5120
M v[236:239], a[104:107], v[44:47], v[236:239]
 v_add_f32 v29, v20, v29
 v_cvt_pk_bf16_f32 v49, v20, v21
M v[240:243], a[112:115], v[40:43], v[240:243]
 buffer_load_dwordx4 a[60:63], v7, s[8:11], s75 offen offset:3072 sc1
M v[240:243], a[116:119], v[56:59], v[240:243]
 ds_read_b128 a[88:91], v7 offset:6144
 ds_read_b128 a[92:95], v7 offset:7168
M v[244:247], a[116:119], v[60:63], v[244:247]
 v_add_f32 v29, v21, v29
 v_add_f32 v29, v22, v29
M v[244:247], a[112:115], v[44:47], v[244:247]
 v_cvt_pk_bf16_f32 v50, v22, v23
 v_add_f32 v29, v23, v29
M v[248:251], a[120:123], v[40:43], v[248:251]
 v_add_f32 v29, v24, v29
 v_cvt_pk_bf16_f32 v51, v24, v25
M v[248:251], a[124:127], v[56:59], v[248:251]
 v_add_f32 v29, v25, v29
M v[252:255], a[124:127], v[60:63], v[252:255]
 s_waitcnt lgkmcnt(0)
M v[252:255], a[120:123], v[44:47], v[252:255]
 v_cmp_lt_f32 vcc, s31, v29
 s_nop 0
 s_cbranch_vccnz L_st7
L_rt7:
M v[132:135], a[64:67], v[52:55], v[132:135]
 ds_read_b128 a[96:99], v7 offset:8192
 ds_read_b128 a[100:103], v7 offset:9216
M v[132:135], a[68:71], v[48:51], v[132:135]
 ds_read_b128 a[104:107], v7 offset:10240
 v_add_f32 v31, v29, v31
M v[140:143], a[76:79], v[48:51], v[140:143]
 s_sub_u32 s27, 5, s42
 ds_read_b128 a[108:111], v7 offset:11264
 ds_read_b128 a[112:115], v7 offset:12288
M v[140:143], a[72:75], v[52:55], v[140:143]
 s_mov_b32 s40, 0
 ds_read_b128 a[116:119], v7 offset:13312
 v_mov_b32 v10, v30
M v[148:151], a[80:83], v[52:55], v[148:151]
 s_add_u32 m0, s28, 32768
 ds_read_b128 a[120:123], v7 offset:14336
 ds_read_b128 a[124:127], v7 offset:15360
M v[148:151], a[84:87], v[48:51], v[148:151]
 buffer_load_dwordx4 v3, s[8:11], s21 offen offset:0 sc1 lds
M v[156:159], a[92:95], v[48:51], v[156:159]
 ds_read_b128 a[128:131], v7 offset:16384
 ds_read_b128 a[132:135], v7 offset:17408
M v[156:159], a[88:91], v[52:55], v[156:159]
 s_waitcnt lgkmcnt(2)
 ds_read_b128 a[136:139], v7 offset:18432
 v_mov_b32 v11, v31
M v[164:167], a[96:99], v[52:55], v[164:167]
 ds_read_b128 a[140:143], v7 offset:19456
 ds_read_b128 a[144:147], v7 offset:20480
M v[164:167], a[100:103], v[48:51], v[164:167]
 buffer_load_dwordx4 v3, s[8:11], s21 offen offset:1024 sc1 lds
M v[172:175], a[108:111], v[48:51], v[172:175]
 ds_read_b128 a[148:151], v7 offset:21504
 ds_read_b128 a[152:155], v7 offset:22528
M v[172:175], a[104:107], v[52:55], v[172:175]
 ds_read_b128 a[156:159], v7 offset:23552
 v_permlane16_swap_b32 v10, v30
M v[180:183], a[112:115], v[52:55], v[180:183]
 ds_read_b128 a[160:163], v7 offset:24576
 ds_read_b128 a[164:167], v7 offset:25600
M v[180:183], a[116:119], v[48:51], v[180:183]
 buffer_load_dwordx4 v3, s[8:11], s21 offen offset:2048 sc1 lds
M v[188:191], a[124:127], v[48:51], v[188:191]
 ds_read_b128 a[168:171], v7 offset:26624
 ds_read_b128 a[172:175], v7 offset:27648
M v[188:191], a[120:123], v[52:55], v[188:191]
 s_waitcnt lgkmcnt(4)
 ds_read_b128 a[176:179], v7 offset:28672
 v_permlane16_swap_b32 v11, v31
M v[196:199], a[128:131], v[52:55], v[196:199]
 ds_read_b128 a[180:183], v7 offset:29696
 ds_read_b128 a[184:187], v7 offset:30720
M v[196:199], a[132:135], v[48:51], v[196:199]
 ds_read_b128 a[188:191], v7 offset:31744
 v_add_f32 v30, v10, v30
M v[204:207], a[140:143], v[48:51], v[204:207]
 buffer_load_dwordx4 v3, s[8:11], s21 offen offset:3072 sc1 lds
M v[204:207], a[136:139], v[52:55], v[204:207]
 s_add_u32 m0, s28, 36864
 v_add_f32 v31, v11, v31
 v_mov_b32 v10, v30
M v[212:215], a[144:147], v[52:55], v[212:215]
 buffer_load_dwordx4 v4, s[8:11], s21 offen offset:0 sc1 lds
M v[212:215], a[148:151], v[48:51], v[212:215]
 s_waitcnt lgkmcnt(0)
 v_mov_b32 v11, v31
 v_permlane32_swap_b32 v10, v30
M v[220:223], a[156:159], v[48:51], v[220:223]
 s_barrier
M v[220:223], a[152:155], v[52:55], v[220:223]
 ds_read_b128 a[64:67], v2 offset:32768
 ds_read_b128 a[68:71], v2 offset:33792
M v[228:231], a[160:163], v[52:55], v[228:231]
 ds_read_b128 a[72:75], v2 offset:34816
 v_permlane32_swap_b32 v11, v31
M v[228:231], a[164:167], v[48:51], v[228:231]
 ds_read_b128 a[76:79], v2 offset:35840
 ds_read_b128 a[80:83], v2 offset:36864
M v[236:239], a[172:175], v[48:51], v[236:239]
 ds_read_b128 a[84:87], v2 offset:37888
 v_add_f32 v30, v10, v30
M v[236:239], a[168:171], v[52:55], v[236:239]
 ds_read_b128 a[88:91], v2 offset:38912
 ds_read_b128 a[92:95], v2 offset:39936
M v[244:247], a[176:179], v[52:55], v[244:247]
 buffer_load_dwordx4 v4, s[8:11], s21 offen offset:1024 sc1 lds
M v[244:247], a[180:183], v[48:51], v[244:247]
 buffer_load_dwordx4 v4, s[8:11], s21 offen offset:2048 sc1 lds
M v[252:255], a[188:191], v[48:51], v[252:255]
 buffer_load_dwordx4 v4, s[8:11], s21 offen offset:3072 sc1 lds
M v[252:255], a[184:187], v[52:55], v[252:255]
 s_waitcnt lgkmcnt(0)
 s_add_u32 s24, s23, 16777216
 s_mov_b32 s23, s21
 s_add_u32 s21, s21, 32768
 s_add_u32 s22, s22, 1
 s_cmp_eq_u32 s22, s25
 s_cselect_b32 s21, s26, s21
 s_cmp_eq_u32 s22, s43
 s_cselect_b32 s21, s4, s21
 s_cmp_eq_u32 s22, s6
 s_cselect_b32 s21, s7, s21
 v_add_f32 v31, v11, v31
 v_rcp_f32 v5, v30
 v_rcp_f32 v6, v31
 v_accvgpr_write_b32 a192, v5
 v_accvgpr_write_b32 a193, v6
 v_mov_b32 v30, 0
 v_mov_b32 v31, 0
 v_mov_b32 v32, 0xc1800000
 v_mov_b32 v33, 0xc1800000
 v_mov_b32 v34, 0xc1800000
 v_mov_b32 v35, 0xc1800000
 v_mov_b32 v36, 0xc1800000
 v_mov_b32 v37, 0xc1800000
 v_mov_b32 v38, 0xc1800000
 v_mov_b32 v39, 0xc1800000
 s_waitcnt vmcnt(8)
M v[64:67], a[64:67], a[0:3], v[32:35]
 ds_read_b128 a[96:99], v2 offset:40960
 v_cvt_pk_bf16_f32 v128, v128, v129
M v[64:67], a[68:71], a[4:7], v[64:67]
 ds_read_b128 a[100:103], v2 offset:41984
 v_cvt_pk_bf16_f32 v129, v130, v131
M v[64:67], a[72:75], a[8:11], v[64:67]
 buffer_load_dword v6, v9, s[8:11], s46 offen sc1
M v[64:67], a[76:79], a[12:15], v[64:67]
 ds_read_b128 a[104:107], v2 offset:43008
 v_cvt_pk_bf16_f32 v130, v136, v137
M v[64:67], a[80:83], a[16:19], v[64:67]
 s_add_u32 m0, s28, 65536
 ds_read_b128 a[108:111], v2 offset:44032
 v_cvt_pk_bf16_f32 v131, v138, v139
M v[64:67], a[84:87], a[20:23], v[64:67]
 buffer_load_dwordx4 v3, s[8:11], s24 offen offset:0 sc1 lds
M v[64:67], a[88:91], a[24:27], v[64:67]
 ds_read_b128 a[112:115], v2 offset:45056
 v_accvgpr_write_b32 a128, v128
M v[64:67], a[92:95], a[28:31], v[64:67]
 ds_read_b128 a[116:119], v2 offset:46080
 v_accvgpr_write_b32 a129, v129
M v[68:71], a[92:95], a[60:63], v[36:39]
 buffer_load_dwordx4 v3, s[8:11], s24 offen offset:1024 sc1 lds
M v[68:71], a[88:91], a[56:59], v[68:71]
 ds_read_b128 a[120:123], v2 offset:47104
 v_accvgpr_write_b32 a130, v130
M v[68:71], a[84:87], a[52:55], v[68:71]
 ds_read_b128 a[124:127], v2 offset:48128
 v_accvgpr_write_b32 a131, v131
M v[68:71], a[80:83], a[48:51], v[68:71]
 v_exp_f32 v18, v64
M v[68:71], a[76:79], a[44:47], v[68:71]
 v_exp_f32 v19, v65
M v[68:71], a[72:75], a[40:43], v[68:71]
 buffer_load_dwordx4 v3, s[8:11], s24 offen offset:2048 sc1 lds
M v[68:71], a[68:71], a[36:39], v[68:71]
 v_exp_f32 v20, v66
M v[68:71], a[64:67], a[32:35], v[68:71]
 s_waitcnt lgkmcnt(0)
 v_exp_f32 v21, v67
M v[72:75], a[96:99], a[0:3], v[32:35]
 ds_read_b128 a[64:67], v2 offset:49152
 v_add_f32 v26, v18, v19
M v[72:75], a[100:103], a[4:7], v[72:75]
 ds_read_b128 a[68:71], v2 offset:50176
 v_cvt_pk_bf16_f32 v40, v18, v19
M v[72:75], a[104:107], a[8:11], v[72:75]
 buffer_load_dwordx4 v3, s[8:11], s24 offen offset:3072 sc1 lds
M v[72:75], a[108:111], a[12:15], v[72:75]
 ds_read_b128 a[72:75], v2 offset:51200
 v_add_f32 v26, v20, v26
M v[72:75], a[112:115], a[16:19], v[72:75]
 ds_read_b128 a[76:79], v2 offset:52224
 v_cvt_pk_bf16_f32 v41, v20, v21
M v[72:75], a[116:119], a[20:23], v[72:75]
 v_exp_f32 v22, v68
M v[72:75], a[120:123], a[24:27], v[72:75]
 ds_read_b128 a[80:83], v2 offset:53248
 v_add_f32 v26, v21, v26
M v[72:75], a[124:127], a[28:31], v[72:75]
 s_add_u32 m0, s28, 69632
 ds_read_b128 a[84:87], v2 offset:54272
 v_cvt_pk_bf16_f32 v132, v132, v133
M v[76:79], a[124:127], a[60:63], v[36:39]
 buffer_load_dwordx4 v4, s[8:11], s24 offen offset:0 sc1 lds
M v[76:79], a[120:123], a[56:59], v[76:79]
 ds_read_b128 a[88:91], v2 offset:55296
 v_cvt_pk_bf16_f32 v133, v134, v135
M v[76:79], a[116:119], a[52:55], v[76:79]
 ds_read_b128 a[92:95], v2 offset:56320
 v_cvt_pk_bf16_f32 v134, v140, v141
M v[76:79], a[112:115], a[48:51], v[76:79]
 v_exp_f32 v23, v69
M v[76:79], a[108:111], a[44:47], v[76:79]
 buffer_load_dwordx4 v4, s[8:11], s24 offen offset:1024 sc1 lds
M v[76:79], a[104:107], a[40:43], v[76:79]
 v_exp_f32 v24, v70
M v[76:79], a[100:103], a[36:39], v[76:79]
 v_exp_f32 v25, v71
M v[76:79], a[96:99], a[32:35], v[76:79]
 s_waitcnt lgkmcnt(0)
 v_exp_f32 v18, v72
M v[80:83], a[64:67], a[0:3], v[32:35]
 ds_read_b128 a[96:99], v2 offset:57344
 v_add_f32 v27, v22, v23
M v[80:83], a[68:71], a[4:7], v[80:83]
 ds_read_b128 a[100:103], v2 offset:58368
 v_cvt_pk_bf16_f32 v44, v22, v23
M v[80:83], a[72:75], a[8:11], v[80:83]
 buffer_load_dwordx4 v4, s[8:11], s24 offen offset:2048 sc1 lds
M v[80:83], a[76:79], a[12:15], v[80:83]
 ds_read_b128 a[104:107], v2 offset:59392
 v_add_f32 v27, v24, v27
M v[80:83], a[80:83], a[16:19], v[80:83]
 ds_read_b128 a[108:111], v2 offset:60416
 v_cvt_pk_bf16_f32 v45, v24, v25
M v[80:83], a[84:87], a[20:23], v[80:83]
 v_exp_f32 v19, v73
M v[80:83], a[88:91], a[24:27], v[80:83]
 ds_read_b128 a[112:115], v2 offset:61440
 v_add_f32 v27, v25, v27
M v[80:83], a[92:95], a[28:31], v[80:83]
 ds_read_b128 a[116:119], v2 offset:62464
 v_add_f32 v26, v18, v26
M v[84:87], a[92:95], a[60:63], v[36:39]
 s_waitcnt vmcnt(7)
 v_cmp_gt_u32 vcc, 3, v6
 v_cvt_pk_bf16_f32 v42, v18, v19
M v[84:87], a[88:91], a[56:59], v[84:87]
 ds_read_b128 a[120:123], v2 offset:63488
 v_add_f32 v26, v19, v26
M v[84:87], a[84:87], a[52:55], v[84:87]
 ds_read_b128 a[124:127], v2 offset:64512
 v_cvt_pk_bf16_f32 v135, v142, v143
M v[84:87], a[80:83], a[48:51], v[84:87]
 s_cbranch_vccnz L_f2s
L_f2r:
 v_exp_f32 v20, v74
M v[84:87], a[76:79], a[44:47], v[84:87]
 buffer_load_dwordx4 v4, s[8:11], s24 offen offset:3072 sc1 lds
M v[84:87], a[72:75], a[40:43], v[84:87]
 v_exp_f32 v21, v75
M v[84:87], a[68:71], a[36:39], v[84:87]
 s_waitcnt lgkmcnt(0)
 v_exp_f32 v22, v76
M v[84:87], a[64:67], a[32:35], v[84:87]
 s_barrier
M v[88:91], a[96:99], a[0:3], v[32:35]
 ds_read_b128 a[64:67], v7 offset:32768
 v_add_f32 v26, v20, v26
M v[88:91], a[100:103], a[4:7], v[88:91]
 ds_read_b128 a[68:71], v7 offset:33792
 v_cvt_pk_bf16_f32 v43, v20, v21
M v[88:91], a[104:107], a[8:11], v[88:91]
 v_exp_f32 v23, v77
M v[88:91], a[108:111], a[12:15], v[88:91]
 ds_read_b128 a[72:75], v7 offset:34816
 v_add_f32 v26, v21, v26
M v[88:91], a[112:115], a[16:19], v[88:91]
 ds_read_b128 a[76:79], v7 offset:35840
 v_add_f32 v27, v22, v27
M v[88:91], a[116:119], a[20:23], v[88:91]
 v_exp_f32 v24, v78
M v[88:91], a[120:123], a[24:27], v[88:91]
 ds_read_b128 a[80:83], v7 offset:36864
 v_cvt_pk_bf16_f32 v46, v22, v23
M v[88:91], a[124:127], a[28:31], v[88:91]
 ds_read_b128 a[84:87], v7 offset:37888
 v_add_f32 v27, v23, v27
M v[92:95], a[124:127], a[60:63], v[36:39]
 v_exp_f32 v25, v79
M v[92:95], a[120:123], a[56:59], v[92:95]
 ds_read_b128 a[88:91], v7 offset:38912
 v_add_f32 v27, v24, v27
M v[92:95], a[116:119], a[52:55], v[92:95]
 ds_read_b128 a[92:95], v7 offset:39936
 v_cvt_pk_bf16_f32 v47, v24, v25
M v[92:95], a[112:115], a[48:51], v[92:95]
 v_add_f32 v27, v25, v27
 v_accvgpr_write_b32 a160, v132
M v[92:95], a[108:111], a[44:47], v[92:95]
 v_accvgpr_write_b32 a161, v133
 v_accvgpr_write_b32 a162, v134
M v[92:95], a[104:107], a[40:43], v[92:95]
 v_accvgpr_write_b32 a163, v135
 v_cvt_pk_bf16_f32 v144, v144, v145
M v[92:95], a[100:103], a[36:39], v[92:95]
 s_waitcnt lgkmcnt(0)
 v_cvt_pk_bf16_f32 v145, v146, v147
 v_cvt_pk_bf16_f32 v146, v152, v153
M v[92:95], a[96:99], a[32:35], v[92:95]
 v_cvt_pk_bf16_f32 v147, v154, v155
 v_accvgpr_write_b32 a132, v144
M v[96:99], a[64:67], a[0:3], v[32:35]
 s_add_u32 m0, s28, 98304
 ds_read_b128 a[96:99], v7 offset:40960
 v_accvgpr_write_b32 a133, v145
M v[96:99], a[68:71], a[4:7], v[96:99]
 ds_read_b128 a[100:103], v7 offset:41984
 v_accvgpr_write_b32 a134, v146
M v[96:99], a[72:75], a[8:11], v[96:99]
 buffer_load_dwordx4 v3, s[8:11], s21 offen offset:0 sc1 lds
M v[96:99], a[76:79], a[12:15], v[96:99]
 ds_read_b128 a[104:107], v7 offset:43008
 v_accvgpr_write_b32 a135, v147
M v[96:99], a[80:83], a[16:19], v[96:99]
 ds_read_b128 a[108:111], v7 offset:44032
 v_cvt_pk_bf16_f32 v148, v148, v149
M v[96:99], a[84:87], a[20:23], v[96:99]
 buffer_load_dwordx4 v3, s[8:11], s21 offen offset:1024 sc1 lds
M v[96:99], a[88:91], a[24:27], v[96:99]
 ds_read_b128 a[112:115], v7 offset:45056
 v_cvt_pk_bf16_f32 v149, v150, v151
M v[96:99], a[92:95], a[28:31], v[96:99]
 ds_read_b128 a[116:119], v7 offset:46080
 v_cvt_pk_bf16_f32 v150, v156, v157
M v[100:103], a[92:95], a[60:63], v[36:39]
 v_exp_f32 v18, v80
M v[100:103], a[88:91], a[56:59], v[100:103]
 ds_read_b128 a[120:123], v7 offset:47104
 v_cvt_pk_bf16_f32 v151, v158, v159
M v[100:103], a[84:87], a[52:55], v[100:103]
 ds_read_b128 a[124:127], v7 offset:48128
 v_accvgpr_write_b32 a164, v148
M v[100:103], a[80:83], a[48:51], v[100:103]
 buffer_load_dwordx4 v3, s[8:11], s21 offen offset:2048 sc1 lds
M v[100:103], a[76:79], a[44:47], v[100:103]
 v_exp_f32 v19, v81
M v[100:103], a[72:75], a[40:43], v[100:103]
 v_exp_f32 v20, v82
M v[100:103], a[68:71], a[36:39], v[100:103]
 v_exp_f32 v21, v83
M v[100:103], a[64:67], a[32:35], v[100:103]
 s_waitcnt lgkmcnt(0)
 v_exp_f32 v22, v88
M v[104:107], a[96:99], a[0:3], v[32:35]
 ds_read_b128 a[64:67], v7 offset:49152
 v_add_f32 v26, v18, v26
M v[104:107], a[100:103], a[4:7], v[104:107]
 ds_read_b128 a[68:71], v7 offset:50176
 v_cvt_pk_bf16_f32 v56, v18, v19
M v[104:107], a[104:107], a[8:11], v[104:107]
 buffer_load_dwordx4 v3, s[8:11], s21 offen offset:3072 sc1 lds
M v[104:107], a[108:111], a[12:15], v[104:107]
 s_add_u32 m0, s28, 102400
 ds_read_b128 a[72:75], v7 offset:51200
 v_add_f32 v26, v19, v26
M v[104:107], a[112:115], a[16:19], v[104:107]
 ds_read_b128 a[76:79], v7 offset:52224
 v_add_f32 v26, v20, v26
M v[104:107], a[116:119], a[20:23], v[104:107]
 buffer_load_dwordx4 v4, s[8:11], s21 offen offset:0 sc1 lds
M v[104:107], a[120:123], a[24:27], v[104:107]
 ds_read_b128 a[80:83], v7 offset:53248
 v_cvt_pk_bf16_f32 v57, v20, v21
M v[104:107], a[124:127], a[28:31], v[104:107]
 ds_read_b128 a[84:87], v7 offset:54272
 v_add_f32 v26, v21, v26
M v[108:111], a[124:127], a[60:63], v[36:39]
 v_exp_f32 v23, v89
M v[108:111], a[120:123], a[56:59], v[108:111]
 ds_read_b128 a[88:91], v7 offset:55296
 v_add_f32 v26, v22, v26
M v[108:111], a[116:119], a[52:55], v[108:111]
 ds_read_b128 a[92:95], v7 offset:56320
 v_cvt_pk_bf16_f32 v58, v22, v23
M v[108:111], a[112:115], a[48:51], v[108:111]
 buffer_load_dwordx4 v4, s[8:11], s21 offen offset:1024 sc1 lds
M v[108:111], a[108:111], a[44:47], v[108:111]
 v_exp_f32 v24, v90
M v[108:111], a[104:107], a[40:43], v[108:111]
 v_exp_f32 v25, v91
M v[108:111], a[100:103], a[36:39], v[108:111]
 buffer_load_dwordx4 v4, s[8:11], s21 offen offset:2048 sc1 lds
M v[108:111], a[96:99], a[32:35], v[108:111]
 s_waitcnt lgkmcnt(0)
 v_exp_f32 v18, v84
M v[112:115], a[64:67], a[0:3], v[32:35]
 ds_read_b128 a[96:99], v7 offset:57344
 v_add_f32 v26, v23, v26
M v[112:115], a[68:71], a[4:7], v[112:115]
 ds_read_b128 a[100:103], v7 offset:58368
 v_add_f32 v26, v24, v26
M v[112:115], a[72:75], a[8:11], v[112:115]
 v_exp_f32 v19, v85
M v[112:115], a[76:79], a[12:15], v[112:115]
 ds_read_b128 a[104:107], v7 offset:59392
 v_cvt_pk_bf16_f32 v59, v24, v25
M v[112:115], a[80:83], a[16:19], v[112:115]
 ds_read_b128 a[108:111], v7 offset:60416
 v_add_f32 v26, v25, v26
M v[112:115], a[84:87], a[20:23], v[112:115]
 buffer_load_dwordx4 v4, s[8:11], s21 offen offset:3072 sc1 lds
M v[112:115], a[88:91], a[24:27], v[112:115]
 s_add_u32 s24, s23, 16777216
 ds_read_b128 a[112:115], v7 offset:61440
 v_add_f32 v27, v18, v27
M v[112:115], a[92:95], a[28:31], v[112:115]
 s_mov_b32 s23, s21
 ds_read_b128 a[116:119], v7 offset:62464
 v_cvt_pk_bf16_f32 v60, v18, v19
M v[116:119], a[92:95], a[60:63], v[36:39]
 s_add_u32 s21, s21, 32768
 v_exp_f32 v20, v86
M v[116:119], a[88:91], a[56:59], v[116:119]
 s_add_u32 s22, s22, 1
 ds_read_b128 a[120:123], v7 offset:63488
 v_add_f32 v27, v19, v27
M v[116:119], a[84:87], a[52:55], v[116:119]
 s_cmp_eq_u32 s22, s25
 ds_read_b128 a[124:127], v7 offset:64512
 v_accvgpr_write_b32 a165, v149
M v[116:119], a[80:83], a[48:51], v[116:119]
 s_cselect_b32 s21, s26, s21
 v_exp_f32 v21, v87
M v[116:119], a[76:79], a[44:47], v[116:119]
 s_cmp_eq_u32 s22, s43
 v_exp_f32 v22, v92
M v[116:119], a[72:75], a[40:43], v[116:119]
 s_cselect_b32 s21, s4, s21
 v_exp_f32 v23, v93
M v[116:119], a[68:71], a[36:39], v[116:119]
 s_waitcnt vmcnt(8) lgkmcnt(0)
 v_add_f32 v27, v20, v27
 v_cvt_pk_bf16_f32 v61, v20, v21
M v[116:119], a[64:67], a[32:35], v[116:119]
 s_barrier
M v[120:123], a[96:99], a[0:3], v[32:35]
 s_cmp_eq_u32 s22, s6
 ds_read_b128 a[64:67], v2 offset:0
 v_add_f32 v27, v21, v27
M v[120:123], a[100:103], a[4:7], v[120:123]
 s_cselect_b32 s21, s7, s21
 ds_read_b128 a[68:71], v2 offset:1024
 v_add_f32 v27, v22, v27
M v[120:123], a[104:107], a[8:11], v[120:123]
 v_exp_f32 v24, v94
M v[120:123], a[108:111], a[12:15], v[120:123]
 ds_read_b128 a[72:75], v2 offset:2048
 v_cvt_pk_bf16_f32 v62, v22, v23
M v[120:123], a[112:115], a[16:19], v[120:123]
 ds_read_b128 a[76:79], v2 offset:3072
 v_add_f32 v27, v23, v27
M v[120:123], a[116:119], a[20:23], v[120:123]
 v_exp_f32 v25, v95
M v[120:123], a[120:123], a[24:27], v[120:123]
 ds_read_b128 a[80:83], v2 offset:4096
 v_add_f32 v27, v24, v27
M v[120:123], a[124:127], a[28:31], v[120:123]
 ds_read_b128 a[84:87], v2 offset:5120
 v_cvt_pk_bf16_f32 v63, v24, v25
M v[124:127], a[124:127], a[60:63], v[36:39]
 v_add_f32 v27, v25, v27
 v_accvgpr_write_b32 a166, v150
M v[124:127], a[120:123], a[56:59], v[124:127]
 ds_read_b128 a[88:91], v2 offset:6144
 v_max_f32 v10, v26, v27
M v[124:127], a[116:119], a[52:55], v[124:127]
 ds_read_b128 a[92:95], v2 offset:7168
 v_min_f32 v11, v26, v27
M v[124:127], a[112:115], a[48:51], v[124:127]
 v_cmp_lt_f32 s[36:37], s31, v10
 v_accvgpr_write_b32 a167, v151
M v[124:127], a[108:111], a[44:47], v[124:127]
 v_cmp_gt_f32 vcc, s55, v11
 v_cvt_pk_bf16_f32 v160, v160, v161
M v[124:127], a[104:107], a[40:43], v[124:127]
 v_cvt_pk_bf16_f32 v161, v162, v163
 v_cvt_pk_bf16_f32 v162, v168, v169
M v[124:127], a[100:103], a[36:39], v[124:127]
 s_waitcnt lgkmcnt(0)
 s_or_b64 vcc, vcc, s[36:37]
M v[124:127], a[96:99], a[32:35], v[124:127]
 s_cbranch_vccnz L_st11
L_rt11:
 v_cvt_pk_bf16_f32 v163, v170, v171
 v_accvgpr_write_b32 a136, v160
 v_accvgpr_write_b32 a137, v161
 v_accvgpr_write_b32 a138, v162
 v_accvgpr_write_b32 a139, v163
 v_cvt_pk_bf16_f32 v164, v164, v165
 v_cvt_pk_bf16_f32 v165, v166, v167
 v_cvt_pk_bf16_f32 v166, v172, v173
 v_cvt_pk_bf16_f32 v167, v174, v175
 v_accvgpr_write_b32 a168, v164
 v_accvgpr_write_b32 a169, v165
 v_accvgpr_write_b32 a170, v166
 v_accvgpr_write_b32 a171, v167
 v_cvt_pk_bf16_f32 v176, v176, v177
 v_cvt_pk_bf16_f32 v177, v178, v179
 v_cvt_pk_bf16_f32 v178, v184, v185
 v_cvt_pk_bf16_f32 v179, v186, v187
 v_accvgpr_write_b32 a140, v176
 v_accvgpr_write_b32 a141, v177
 v_accvgpr_write_b32 a142, v178
 v_accvgpr_write_b32 a143, v179
 v_cvt_pk_bf16_f32 v180, v180, v181
 v_cvt_pk_bf16_f32 v181, v182, v183
 v_cvt_pk_bf16_f32 v182, v188, v189
 v_cvt_pk_bf16_f32 v183, v190, v191
 v_accvgpr_write_b32 a172, v180
 v_accvgpr_write_b32 a173, v181
 v_accvgpr_write_b32 a174, v182
 v_accvgpr_write_b32 a175, v183
 v_cvt_pk_bf16_f32 v192, v192, v193
 v_cvt_pk_bf16_f32 v193, v194, v195
 v_cvt_pk_bf16_f32 v194, v200, v201
 v_cvt_pk_bf16_f32 v195, v202, v203
 v_accvgpr_write_b32 a144, v192
 v_accvgpr_write_b32 a145, v193
 v_accvgpr_write_b32 a146, v194
 v_accvgpr_write_b32 a147, v195
 v_cvt_pk_bf16_f32 v196, v196, v197
 v_cvt_pk_bf16_f32 v197, v198, v199
 v_cvt_pk_bf16_f32 v198, v204, v205
 v_cvt_pk_bf16_f32 v199, v206, v207
 v_accvgpr_write_b32 a176, v196
 v_accvgpr_write_b32 a177, v197
 v_accvgpr_write_b32 a178, v198
 v_accvgpr_write_b32 a179, v199
 v_cvt_pk_bf16_f32 v208, v208, v209
 v_cvt_pk_bf16_f32 v209, v210, v211
 v_cvt_pk_bf16_f32 v210, v216, v217
 v_cvt_pk_bf16_f32 v211, v218, v219
 v_accvgpr_write_b32 a148, v208
 v_accvgpr_write_b32 a149, v209
 v_accvgpr_write_b32 a150, v210
 v_accvgpr_write_b32 a151, v211
 v_cvt_pk_bf16_f32 v212, v212, v213
 v_cvt_pk_bf16_f32 v213, v214, v215
 v_cvt_pk_bf16_f32 v214, v220, v221
 v_cvt_pk_bf16_f32 v215, v222, v223
 v_accvgpr_write_b32 a180, v212
 v_accvgpr_write_b32 a181, v213
 v_accvgpr_write_b32 a182, v214
 v_accvgpr_write_b32 a183, v215
 v_cvt_pk_bf16_f32 v224, v224, v225
 v_cvt_pk_bf16_f32 v225, v226, v227
 v_cvt_pk_bf16_f32 v226, v232, v233
 v_cvt_pk_bf16_f32 v227, v234, v235
 v_accvgpr_write_b32 a152, v224
 v_accvgpr_write_b32 a153, v225
 v_accvgpr_write_b32 a154, v226
 v_accvgpr_write_b32 a155, v227
 v_cvt_pk_bf16_f32 v228, v228, v229
 v_cvt_pk_bf16_f32 v229, v230, v231
 v_cvt_pk_bf16_f32 v230, v236, v237
 v_cvt_pk_bf16_f32 v231, v238, v239
 v_accvgpr_write_b32 a184, v228
 v_accvgpr_write_b32 a185, v229
 v_accvgpr_write_b32 a186, v230
 v_accvgpr_write_b32 a187, v231
M v[128:131], a[64:67], v[40:43], 0
 s_add_u32 m0, s28, 0
 ds_read_b128 a[96:99], v2 offset:8192
 ds_read_b128 a[100:103], v2 offset:9216
M v[128:131], a[68:71], v[56:59], v[128:131]
 buffer_load_dwordx4 v3, s[8:11], s24 offen offset:0 sc1 lds
M v[132:135], a[68:71], v[60:63], 0
 v_cvt_pk_bf16_f32 v240, v240, v241
 v_cvt_pk_bf16_f32 v241, v242, v243
M v[132:135], a[64:67], v[44:47], v[132:135]
 ds_read_b128 a[104:107], v2 offset:10240
 ds_read_b128 a[108:111], v2 offset:11264
M v[136:139], a[72:75], v[40:43], 0
 buffer_load_dwordx4 v3, s[8:11], s24 offen offset:1024 sc1 lds
M v[136:139], a[76:79], v[56:59], v[136:139]
 v_cvt_pk_bf16_f32 v242, v248, v249
 v_cvt_pk_bf16_f32 v243, v250, v251
M v[140:143], a[76:79], v[60:63], 0
 ds_read_b128 a[112:115], v2 offset:12288
 ds_read_b128 a[116:119], v2 offset:13312
M v[140:143], a[72:75], v[44:47], v[140:143]
 buffer_load_dwordx4 v3, s[8:11], s24 offen offset:2048 sc1 lds
M v[144:147], a[80:83], v[40:43], 0
 v_accvgpr_write_b32 a156, v240
 v_accvgpr_write_b32 a157, v241
M v[144:147], a[84:87], v[56:59], v[144:147]
 ds_read_b128 a[120:123], v2 offset:14336
 ds_read_b128 a[124:127], v2 offset:15360
M v[148:151], a[84:87], v[60:63], 0
 buffer_load_dwordx4 v3, s[8:11], s24 offen offset:3072 sc1 lds
M v[148:151], a[80:83], v[44:47], v[148:151]
 s_add_u32 m0, s28, 4096
 v_accvgpr_write_b32 a158, v242
 v_accvgpr_write_b32 a159, v243
M v[152:155], a[88:91], v[40:43], 0
 buffer_load_dwordx4 v4, s[8:11], s24 offen offset:0 sc1 lds
M v[152:155], a[92:95], v[56:59], v[152:155]
 v_cvt_pk_bf16_f32 v244, v244, v245
 v_cvt_pk_bf16_f32 v245, v246, v247
M v[156:159], a[92:95], v[60:63], 0
 v_cvt_pk_bf16_f32 v246, v252, v253
 v_cvt_pk_bf16_f32 v247, v254, v255
M v[156:159], a[88:91], v[44:47], v[156:159]
 s_waitcnt lgkmcnt(0)
 v_accvgpr_write_b32 a188, v244
 v_accvgpr_write_b32 a189, v245
M v[160:163], a[96:99], v[40:43], 0
 ds_read_b128 a[64:67], v2 offset:16384
 ds_read_b128 a[68:71], v2 offset:17408
M v[160:163], a[100:103], v[56:59], v[160:163]
 buffer_load_dwordx4 v4, s[8:11], s24 offen offset:1024 sc1 lds
M v[164:167], a[100:103], v[60:63], 0
 v_accvgpr_write_b32 a190, v246
 v_accvgpr_write_b32 a191, v247
M v[164:167], a[96:99], v[44:47], v[164:167]
 ds_read_b128 a[72:75], v2 offset:18432
 ds_read_b128 a[76:79], v2 offset:19456
M v[168:171], a[104:107], v[40:43], 0
 buffer_load_dwordx4 v4, s[8:11], s24 offen offset:2048 sc1 lds
M v[168:171], a[108:111], v[56:59], v[168:171]
 v_exp_f32 v18, v96
M v[172:175], a[108:111], v[60:63], 0
 ds_read_b128 a[80:83], v2 offset:20480
 ds_read_b128 a[84:87], v2 offset:21504
M v[172:175], a[104:107], v[44:47], v[172:175]
 buffer_load_dwordx4 v4, s[8:11], s24 offen offset:3072 sc1 lds
M v[176:179], a[112:115], v[40:43], 0
 v_exp_f32 v19, v97
M v[176:179], a[116:119], v[56:59], v[176:179]
 s_add_u32 m0, s28, 32768
 ds_read_b128 a[88:91], v2 offset:22528
 ds_read_b128 a[92:95], v2 offset:23552
M v[180:183], a[116:119], v[60:63], 0
 buffer_load_dwordx4 v3, s[8:11], s21 offen offset:0 sc1 lds
M v[180:183], a[112:115], v[44:47], v[180:183]
 v_exp_f32 v20, v98
M v[184:187], a[120:123], v[40:43], 0
 buffer_load_dwordx4 v3, s[8:11], s21 offen offset:1024 sc1 lds
M v[184:187], a[124:127], v[56:59], v[184:187]
 v_exp_f32 v21, v99
M v[188:191], a[124:127], v[60:63], 0
 buffer_load_dwordx4 v3, s[8:11], s21 offen offset:2048 sc1 lds
M v[188:191], a[120:123], v[44:47], v[188:191]
 s_waitcnt lgkmcnt(0)
 v_exp_f32 v22, v104
M v[192:195], a[64:67], v[40:43], 0
 ds_read_b128 a[96:99], v2 offset:24576
 ds_read_b128 a[100:103], v2 offset:25600
M v[192:195], a[68:71], v[56:59], v[192:195]
 buffer_load_dwordx4 v3, s[8:11], s21 offen offset:3072 sc1 lds
M v[196:199], a[68:71], v[60:63], 0
 v_exp_f32 v23, v105
M v[196:199], a[64:67], v[44:47], v[196:199]
 s_add_u32 m0, s28, 36864
 ds_read_b128 a[104:107], v2 offset:26624
 ds_read_b128 a[108:111], v2 offset:27648
M v[200:203], a[72:75], v[40:43], 0
 buffer_load_dwordx4 v4, s[8:11], s21 offen offset:0 sc1 lds
M v[200:203], a[76:79], v[56:59], v[200:203]
 v_add_f32 v30, v26, v30
 v_add_f32 v31, v27, v31
M v[204:207], a[76:79], v[60:63], 0
 ds_read_b128 a[112:115], v2 offset:28672
 ds_read_b128 a[116:119], v2 offset:29696
M v[204:207], a[72:75], v[44:47], v[204:207]
 buffer_load_dwordx4 v4, s[8:11], s21 offen offset:1024 sc1 lds
M v[208:211], a[80:83], v[40:43], 0
 v_exp_f32 v24, v106
M v[208:211], a[84:87], v[56:59], v[208:211]
 ds_read_b128 a[120:123], v2 offset:30720
 ds_read_b128 a[124:127], v2 offset:31744
M v[212:215], a[84:87], v[60:63], 0
 buffer_load_dwordx4 v4, s[8:11], s21 offen offset:2048 sc1 lds
M v[212:215], a[80:83], v[44:47], v[212:215]
 v_exp_f32 v25, v107
M v[216:219], a[88:91], v[40:43], 0
 v_add_f32 v28, v18, v19
 v_cvt_pk_bf16_f32 v48, v18, v19
M v[216:219], a[92:95], v[56:59], v[216:219]
 buffer_load_dwordx4 v4, s[8:11], s21 offen offset:3072 sc1 lds
M v[220:223], a[92:95], v[60:63], 0
 s_waitcnt vmcnt(16) lgkmcnt(0)
 s_add_u32 s24, s23, 16777216
 s_mov_b32 s23, s21
M v[220:223], a[88:91], v[44:47], v[220:223]
 s_barrier
M v[224:227], a[96:99], v[40:43], 0
 ds_read_b128 a[64:67], v2 offset:32768
 ds_read_b128 a[68:71], v2 offset:33792
M v[224:227], a[100:103], v[56:59], v[224:227]
 s_add_u32 s21, s21, 32768
 v_add_f32 v28, v20, v28
M v[228:231], a[100:103], v[60:63], 0
 s_add_u32 s22, s22, 1
 v_exp_f32 v18, v100
M v[228:231], a[96:99], v[44:47], v[228:231]
 s_cmp_eq_u32 s22, s25
 ds_read_b128 a[72:75], v2 offset:34816
 ds_read_b128 a[76:79], v2 offset:35840
M v[232:235], a[104:107], v[40:43], 0
 s_cselect_b32 s21, s26, s21
 v_exp_f32 v19, v101
M v[232:235], a[108:111], v[56:59], v[232:235]
 s_cmp_eq_u32 s22, s43
 v_cvt_pk_bf16_f32 v49, v20, v21
 v_add_f32 v28, v21, v28
M v[236:239], a[108:111], v[60:63], 0
 s_cselect_b32 s21, s4, s21
 ds_read_b128 a[80:83], v2 offset:36864
 ds_read_b128 a[84:87], v2 offset:37888
M v[236:239], a[104:107], v[44:47], v[236:239]
 s_cmp_eq_u32 s22, s6
 v_exp_f32 v20, v102
M v[240:243], a[112:115], v[40:43], 0
 s_cselect_b32 s21, s7, s21
 v_exp_f32 v21, v103
M v[240:243], a[116:119], v[56:59], v[240:243]
 ds_read_b128 a[88:91], v2 offset:38912
 ds_read_b128 a[92:95], v2 offset:39936
M v[244:247], a[116:119], v[60:63], 0
 v_add_f32 v28, v22, v28
 v_cvt_pk_bf16_f32 v50, v22, v23
M v[244:247], a[112:115], v[44:47], v[244:247]
 v_add_f32 v28, v23, v28
 v_add_f32 v28, v24, v28
M v[248:251], a[120:123], v[40:43], 0
 v_exp_f32 v22, v108
M v[248:251], a[124:127], v[56:59], v[248:251]
 s_cmp_lg_u32 s27, 0
 v_exp_f32 v23, v109
M v[252:255], a[124:127], v[60:63], 0
 s_waitcnt lgkmcnt(0)
 v_cvt_pk_bf16_f32 v51, v24, v25
 v_add_f32 v28, v25, v28
M v[252:255], a[120:123], v[44:47], v[252:255]
 v_exp_f32 v24, v110
 v_add_f32 v29, v18, v19
 v_cvt_pk_bf16_f32 v52, v18, v19
 v_add_f32 v29, v20, v29
 v_cvt_pk_bf16_f32 v53, v20, v21
 v_add_f32 v29, v21, v29
 v_exp_f32 v25, v111
 v_add_f32 v29, v22, v29
 v_cvt_pk_bf16_f32 v54, v22, v23
 v_add_f32 v29, v23, v29
 v_add_f32 v29, v24, v29
 v_cvt_pk_bf16_f32 v55, v24, v25
 v_add_f32 v29, v25, v29
 s_cbranch_scc1 L_loop_top
L_final_h:
 s_waitcnt vmcnt(8)
 s_barrier
 ds_read_b128 a[64:67], v7 offset:0
 ds_read_b128 a[68:71], v7 offset:1024
 ds_read_b128 a[72:75], v7 offset:2048
 ds_read_b128 a[76:79], v7 offset:3072
 ds_read_b128 a[80:83], v7 offset:4096
 ds_read_b128 a[84:87], v7 offset:5120
 ds_read_b128 a[88:91], v7 offset:6144
 ds_read_b128 a[92:95], v7 offset:7168
 s_add_u32 m0, s28, 65536
 v_exp_f32 v18, v112
 buffer_load_dwordx4 v3, s[8:11], s38 offen offset:0 sc1 lds
 v_exp_f32 v19, v113
 v_exp_f32 v20, v114
 v_add_f32 v28, v18, v28
 v_cvt_pk_bf16_f32 v56, v18, v19
 buffer_load_dwordx4 v3, s[8:11], s38 offen offset:1024 sc1 lds
 v_exp_f32 v21, v115
 v_add_f32 v28, v19, v28
 v_exp_f32 v22, v120
 v_add_f32 v28, v20, v28
 v_cvt_pk_bf16_f32 v57, v20, v21
 buffer_load_dwordx4 v3, s[8:11], s38 offen offset:2048 sc1 lds
 v_exp_f32 v23, v121
 v_add_f32 v28, v21, v28
 v_exp_f32 v24, v122
 v_add_f32 v28, v22, v28
 v_cvt_pk_bf16_f32 v58, v22, v23
 buffer_load_dwordx4 v3, s[8:11], s38 offen offset:3072 sc1 lds
 v_exp_f32 v25, v123
 v_add_f32 v28, v23, v28
 v_exp_f32 v18, v116
 v_add_f32 v28, v24, v28
 s_add_u32 m0, s28, 69632
 v_cvt_pk_bf16_f32 v59, v24, v25
 buffer_load_dwordx4 v4, s[8:11], s38 offen offset:0 sc1 lds
 v_exp_f32 v19, v117
 v_add_f32 v28, v25, v28
 v_exp_f32 v20, v118
 v_add_f32 v29, v18, v29
 v_cvt_pk_bf16_f32 v60, v18, v19
 buffer_load_dwordx4 v4, s[8:11], s38 offen offset:1024 sc1 lds
 v_exp_f32 v21, v119
 v_add_f32 v29, v19, v29
 v_exp_f32 v22, v124
 v_add_f32 v29, v20, v29
 v_cvt_pk_bf16_f32 v61, v20, v21
 buffer_load_dwordx4 v4, s[8:11], s38 offen offset:2048 sc1 lds
 v_exp_f32 v23, v125
 v_add_f32 v29, v21, v29
 v_exp_f32 v24, v126
 v_add_f32 v29, v22, v29
 v_cvt_pk_bf16_f32 v62, v22, v23
 buffer_load_dwordx4 v4, s[8:11], s38 offen offset:3072 sc1 lds
 s_add_u32 s38, s38, 32768
 v_exp_f32 v25, v127
 v_add_f32 v29, v23, v29
 v_add_f32 v29, v24, v29
 v_cvt_pk_bf16_f32 v63, v24, v25
 v_add_f32 v29, v25, v29
 v_max_f32 v10, v28, v29
 v_cmp_lt_f32 vcc, s31, v10
 s_nop 0
 s_cbranch_vccnz L_st4
L_rt4:
 v_add_f32 v30, v28, v30
 v_add_f32 v31, v29, v31
 v_mov_b32 v12, v32
 v_mov_b32 v13, v36
 v_mov_b32 v14, v30
 v_mov_b32 v15, v31
 buffer_store_dwordx4 v[12:15], v7, s[8:11], s52 offen sc1
 s_waitcnt lgkmcnt(0)
M v[128:131], a[64:67], v[48:51], v[128:131]
 ds_read_b128 a[96:99], v7 offset:8192
M v[128:131], a[68:71], v[56:59], v[128:131]
 ds_read_b128 a[100:103], v7 offset:9216
M v[132:135], a[68:71], v[60:63], v[132:135]
M v[132:135], a[64:67], v[52:55], v[132:135]
 ds_read_b128 a[104:107], v7 offset:10240
M v[136:139], a[72:75], v[48:51], v[136:139]
 ds_read_b128 a[108:111], v7 offset:11264
M v[136:139], a[76:79], v[56:59], v[136:139]
M v[140:143], a[76:79], v[60:63], v[140:143]
 ds_read_b128 a[112:115], v7 offset:12288
M v[140:143], a[72:75], v[52:55], v[140:143]
 ds_read_b128 a[116:119], v7 offset:13312
M v[144:147], a[80:83], v[48:51], v[144:147]
M v[144:147], a[84:87], v[56:59], v[144:147]
 ds_read_b128 a[120:123], v7 offset:14336
 v_cvt_pk_bf16_f32 v128, v128, v129
M v[148:151], a[84:87], v[60:63], v[148:151]
 ds_read_b128 a[124:127], v7 offset:15360
 v_cvt_pk_bf16_f32 v129, v130, v131
M v[148:151], a[80:83], v[52:55], v[148:151]
 v_cvt_pk_bf16_f32 v130, v136, v137
 v_cvt_pk_bf16_f32 v131, v138, v139
M v[152:155], a[88:91], v[48:51], v[152:155]
 buffer_store_dwordx4 v[128:131], v7, s[8:11], s12 offen offset:0 sc1
M v[152:155], a[92:95], v[56:59], v[152:155]
 v_cvt_pk_bf16_f32 v132, v132, v133
 v_cvt_pk_bf16_f32 v133, v134, v135
M v[156:159], a[92:95], v[60:63], v[156:159]
 v_cvt_pk_bf16_f32 v134, v140, v141
 v_cvt_pk_bf16_f32 v135, v142, v143
M v[156:159], a[88:91], v[52:55], v[156:159]
 s_waitcnt lgkmcnt(0)
M v[160:163], a[96:99], v[48:51], v[160:163]
 ds_read_b128 a[64:67], v7 offset:16384
M v[160:163], a[100:103], v[56:59], v[160:163]
 ds_read_b128 a[68:71], v7 offset:17408
M v[164:167], a[100:103], v[60:63], v[164:167]
 buffer_store_dwordx4 v[132:135], v7, s[8:11], s14 offen offset:0 sc1
M v[164:167], a[96:99], v[52:55], v[164:167]
 ds_read_b128 a[72:75], v7 offset:18432
 v_cvt_pk_bf16_f32 v144, v144, v145
M v[168:171], a[104:107], v[48:51], v[168:171]
 ds_read_b128 a[76:79], v7 offset:19456
 v_cvt_pk_bf16_f32 v145, v146, v147
M v[168:171], a[108:111], v[56:59], v[168:171]
 v_cvt_pk_bf16_f32 v146, v152, v153
 v_cvt_pk_bf16_f32 v147, v154, v155
M v[172:175], a[108:111], v[60:63], v[172:175]
 ds_read_b128 a[80:83], v7 offset:20480
M v[172:175], a[104:107], v[52:55], v[172:175]
 ds_read_b128 a[84:87], v7 offset:21504
M v[176:179], a[112:115], v[48:51], v[176:179]
 buffer_store_dwordx4 v[144:147], v7, s[8:11], s12 offen offset:1024 sc1
M v[176:179], a[116:119], v[56:59], v[176:179]
 ds_read_b128 a[88:91], v7 offset:22528
 v_cvt_pk_bf16_f32 v148, v148, v149
M v[180:183], a[116:119], v[60:63], v[180:183]
 ds_read_b128 a[92:95], v7 offset:23552
 v_cvt_pk_bf16_f32 v149, v150, v151
M v[180:183], a[112:115], v[52:55], v[180:183]
 v_cvt_pk_bf16_f32 v150, v156, v157
 v_cvt_pk_bf16_f32 v151, v158, v159
M v[184:187], a[120:123], v[48:51], v[184:187]
 buffer_store_dwordx4 v[148:151], v7, s[8:11], s14 offen offset:1024 sc1
M v[184:187], a[124:127], v[56:59], v[184:187]
 v_cvt_pk_bf16_f32 v160, v160, v161
 v_cvt_pk_bf16_f32 v161, v162, v163
M v[188:191], a[124:127], v[60:63], v[188:191]
 v_cvt_pk_bf16_f32 v162, v168, v169
 v_cvt_pk_bf16_f32 v163, v170, v171
M v[188:191], a[120:123], v[52:55], v[188:191]
 s_waitcnt lgkmcnt(0)
M v[192:195], a[64:67], v[48:51], v[192:195]
 ds_read_b128 a[96:99], v7 offset:24576
M v[192:195], a[68:71], v[56:59], v[192:195]
 ds_read_b128 a[100:103], v7 offset:25600
M v[196:199], a[68:71], v[60:63], v[196:199]
 buffer_store_dwordx4 v[160:163], v7, s[8:11], s12 offen offset:2048 sc1
M v[196:199], a[64:67], v[52:55], v[196:199]
 ds_read_b128 a[104:107], v7 offset:26624
 v_cvt_pk_bf16_f32 v164, v164, v165
M v[200:203], a[72:75], v[48:51], v[200:203]
 ds_read_b128 a[108:111], v7 offset:27648
 v_cvt_pk_bf16_f32 v165, v166, v167
M v[200:203], a[76:79], v[56:59], v[200:203]
 v_cvt_pk_bf16_f32 v166, v172, v173
 v_cvt_pk_bf16_f32 v167, v174, v175
M v[204:207], a[76:79], v[60:63], v[204:207]
 ds_read_b128 a[112:115], v7 offset:28672
M v[204:207], a[72:75], v[52:55], v[204:207]
 ds_read_b128 a[116:119], v7 offset:29696
M v[208:211], a[80:83], v[48:51], v[208:211]
 buffer_store_dwordx4 v[164:167], v7, s[8:11], s14 offen offset:2048 sc1
M v[208:211], a[84:87], v[56:59], v[208:211]
 ds_read_b128 a[120:123], v7 offset:30720
 v_cvt_pk_bf16_f32 v176, v176, v177
M v[212:215], a[84:87], v[60:63], v[212:215]
 ds_read_b128 a[124:127], v7 offset:31744
 v_cvt_pk_bf16_f32 v177, v178, v179
M v[212:215], a[80:83], v[52:55], v[212:215]
 v_cvt_pk_bf16_f32 v178, v184, v185
 v_cvt_pk_bf16_f32 v179, v186, v187
M v[216:219], a[88:91], v[48:51], v[216:219]
 buffer_store_dwordx4 v[176:179], v7, s[8:11], s12 offen offset:3072 sc1
M v[216:219], a[92:95], v[56:59], v[216:219]
 v_cvt_pk_bf16_f32 v180, v180, v181
 v_cvt_pk_bf16_f32 v181, v182, v183
M v[220:223], a[92:95], v[60:63], v[220:223]
 s_waitcnt lgkmcnt(0)
 v_cvt_pk_bf16_f32 v182, v188, v189
 v_cvt_pk_bf16_f32 v183, v190, v191
M v[220:223], a[88:91], v[52:55], v[220:223]
 s_barrier
M v[224:227], a[96:99], v[48:51], v[224:227]
 ds_read_b128 a[64:67], v2 offset:32768
M v[224:227], a[100:103], v[56:59], v[224:227]
 ds_read_b128 a[68:71], v2 offset:33792
M v[228:231], a[100:103], v[60:63], v[228:231]
 buffer_store_dwordx4 v[180:183], v7, s[8:11], s14 offen offset:3072 sc1
M v[228:231], a[96:99], v[52:55], v[228:231]
 ds_read_b128 a[72:75], v2 offset:34816
 v_cvt_pk_bf16_f32 v192, v192, v193
M v[232:235], a[104:107], v[48:51], v[232:235]
 ds_read_b128 a[76:79], v2 offset:35840
 v_cvt_pk_bf16_f32 v193, v194, v195
M v[232:235], a[108:111], v[56:59], v[232:235]
 v_cvt_pk_bf16_f32 v194, v200, v201
 v_cvt_pk_bf16_f32 v195, v202, v203
M v[236:239], a[108:111], v[60:63], v[236:239]
 ds_read_b128 a[80:83], v2 offset:36864
M v[236:239], a[104:107], v[52:55], v[236:239]
 ds_read_b128 a[84:87], v2 offset:37888
M v[240:243], a[112:115], v[48:51], v[240:243]
 buffer_store_dwordx4 v[192:195], v7, s[8:11], s13 offen offset:0 sc1
M v[240:243], a[116:119], v[56:59], v[240:243]
 ds_read_b128 a[88:91], v2 offset:38912
 v_cvt_pk_bf16_f32 v196, v196, v197
M v[244:247], a[116:119], v[60:63], v[244:247]
 ds_read_b128 a[92:95], v2 offset:39936
 v_cvt_pk_bf16_f32 v197, v198, v199
M v[244:247], a[112:115], v[52:55], v[244:247]
 v_cvt_pk_bf16_f32 v198, v204, v205
 v_cvt_pk_bf16_f32 v199, v206, v207
M v[248:251], a[120:123], v[48:51], v[248:251]
 buffer_store_dwordx4 v[196:199], v7, s[8:11], s15 offen offset:0 sc1
M v[248:251], a[124:127], v[56:59], v[248:251]
 v_cvt_pk_bf16_f32 v208, v208, v209
 v_cvt_pk_bf16_f32 v209, v210, v211
M v[252:255], a[124:127], v[60:63], v[252:255]
 s_waitcnt lgkmcnt(0)
 v_cvt_pk_bf16_f32 v210, v216, v217
 v_cvt_pk_bf16_f32 v211, v218, v219
M v[252:255], a[120:123], v[52:55], v[252:255]
 buffer_store_dwordx4 v[208:211], v7, s[8:11], s13 offen offset:1024 sc1
 v_cvt_pk_bf16_f32 v212, v212, v213
 v_cvt_pk_bf16_f32 v213, v214, v215
 v_cvt_pk_bf16_f32 v214, v220, v221
 v_cvt_pk_bf16_f32 v215, v222, v223
 buffer_store_dwordx4 v[212:215], v7, s[8:11], s15 offen offset:1024 sc1
 v_cvt_pk_bf16_f32 v224, v224, v225
 v_cvt_pk_bf16_f32 v225, v226, v227
 v_cvt_pk_bf16_f32 v226, v232, v233
 v_cvt_pk_bf16_f32 v227, v234, v235
 buffer_store_dwordx4 v[224:227], v7, s[8:11], s13 offen offset:2048 sc1
 v_cvt_pk_bf16_f32 v228, v228, v229
 v_cvt_pk_bf16_f32 v229, v230, v231
 v_cvt_pk_bf16_f32 v230, v236, v237
 v_cvt_pk_bf16_f32 v231, v238, v239
 buffer_store_dwordx4 v[228:231], v7, s[8:11], s15 offen offset:2048 sc1
 v_cvt_pk_bf16_f32 v240, v240, v241
 v_cvt_pk_bf16_f32 v241, v242, v243
 v_cvt_pk_bf16_f32 v242, v248, v249
 v_cvt_pk_bf16_f32 v243, v250, v251
 buffer_store_dwordx4 v[240:243], v7, s[8:11], s13 offen offset:3072 sc1
 v_cvt_pk_bf16_f32 v244, v244, v245
 v_cvt_pk_bf16_f32 v245, v246, v247
 v_cvt_pk_bf16_f32 v246, v252, v253
 v_cvt_pk_bf16_f32 v247, v254, v255
 buffer_store_dwordx4 v[244:247], v7, s[8:11], s15 offen offset:3072 sc1
M v[64:67], a[64:67], a[128:131], 0
 ds_read_b128 a[96:99], v2 offset:40960
M v[64:67], a[68:71], a[132:135], v[64:67]
 s_add_u32 m0, s28, 0
 ds_read_b128 a[100:103], v2 offset:41984
M v[64:67], a[72:75], a[136:139], v[64:67]
 buffer_load_dwordx4 v3, s[8:11], s38 offen offset:0 sc1 lds
M v[64:67], a[76:79], a[140:143], v[64:67]
 ds_read_b128 a[104:107], v2 offset:43008
 v_accvgpr_read_b32 v5, a192
M v[64:67], a[80:83], a[144:147], v[64:67]
 ds_read_b128 a[108:111], v2 offset:44032
 v_accvgpr_read_b32 v6, a193
M v[64:67], a[84:87], a[148:151], v[64:67]
 buffer_load_dwordx4 v3, s[8:11], s38 offen offset:1024 sc1 lds
M v[64:67], a[88:91], a[152:155], v[64:67]
 ds_read_b128 a[112:115], v2 offset:45056
M v[64:67], a[92:95], a[156:159], v[64:67]
 ds_read_b128 a[116:119], v2 offset:46080
M v[68:71], a[92:95], a[188:191], 0
 buffer_load_dwordx4 v3, s[8:11], s38 offen offset:2048 sc1 lds
M v[68:71], a[88:91], a[184:187], v[68:71]
 ds_read_b128 a[120:123], v2 offset:47104
M v[68:71], a[84:87], a[180:183], v[68:71]
 ds_read_b128 a[124:127], v2 offset:48128
M v[68:71], a[80:83], a[176:179], v[68:71]
M v[68:71], a[76:79], a[172:175], v[68:71]
 buffer_load_dwordx4 v3, s[8:11], s38 offen offset:3072 sc1 lds
M v[68:71], a[72:75], a[168:171], v[68:71]
M v[68:71], a[68:71], a[164:167], v[68:71]
M v[68:71], a[64:67], a[160:163], v[68:71]
 s_waitcnt lgkmcnt(0)
M v[72:75], a[96:99], a[128:131], 0
 ds_read_b128 a[64:67], v2 offset:49152
M v[72:75], a[100:103], a[132:135], v[72:75]
 s_add_u32 m0, s28, 4096
 ds_read_b128 a[68:71], v2 offset:50176
M v[72:75], a[104:107], a[136:139], v[72:75]
 buffer_load_dwordx4 v4, s[8:11], s38 offen offset:0 sc1 lds
M v[72:75], a[108:111], a[140:143], v[72:75]
 ds_read_b128 a[72:75], v2 offset:51200
M v[72:75], a[112:115], a[144:147], v[72:75]
 ds_read_b128 a[76:79], v2 offset:52224
M v[72:75], a[116:119], a[148:151], v[72:75]
 buffer_load_dwordx4 v4, s[8:11], s38 offen offset:1024 sc1 lds
M v[72:75], a[120:123], a[152:155], v[72:75]
 ds_read_b128 a[80:83], v2 offset:53248
M v[72:75], a[124:127], a[156:159], v[72:75]
 ds_read_b128 a[84:87], v2 offset:54272
M v[76:79], a[124:127], a[188:191], 0
 buffer_load_dwordx4 v4, s[8:11], s38 offen offset:2048 sc1 lds
M v[76:79], a[120:123], a[184:187], v[76:79]
 ds_read_b128 a[88:91], v2 offset:55296
M v[76:79], a[116:119], a[180:183], v[76:79]
 ds_read_b128 a[92:95], v2 offset:56320
M v[76:79], a[112:115], a[176:179], v[76:79]
 buffer_load_dwordx4 v4, s[8:11], s38 offen offset:3072 sc1 lds
M v[76:79], a[108:111], a[172:175], v[76:79]
M v[76:79], a[104:107], a[168:171], v[76:79]
M v[76:79], a[100:103], a[164:167], v[76:79]
M v[76:79], a[96:99], a[160:163], v[76:79]
 s_waitcnt lgkmcnt(0)
M v[80:83], a[64:67], a[128:131], 0
 s_add_u32 s38, s38, 32768
 ds_read_b128 a[96:99], v2 offset:57344
M v[80:83], a[68:71], a[132:135], v[80:83]
 s_add_u32 m0, s28, 131072
 ds_read_b128 a[100:103], v2 offset:58368
M v[80:83], a[72:75], a[136:139], v[80:83]
 buffer_load_dwordx4 v3, s[8:11], s38 offen offset:0 sc1 lds
M v[80:83], a[76:79], a[140:143], v[80:83]
 ds_read_b128 a[104:107], v2 offset:59392
M v[80:83], a[80:83], a[144:147], v[80:83]
 ds_read_b128 a[108:111], v2 offset:60416
M v[80:83], a[84:87], a[148:151], v[80:83]
 buffer_load_dwordx4 v3, s[8:11], s38 offen offset:1024 sc1 lds
M v[80:83], a[88:91], a[152:155], v[80:83]
 ds_read_b128 a[112:115], v2 offset:61440
M v[80:83], a[92:95], a[156:159], v[80:83]
 ds_read_b128 a[116:119], v2 offset:62464
M v[84:87], a[92:95], a[188:191], 0
 buffer_load_dwordx4 v3, s[8:11], s38 offen offset:2048 sc1 lds
M v[84:87], a[88:91], a[184:187], v[84:87]
 ds_read_b128 a[120:123], v2 offset:63488
M v[84:87], a[84:87], a[180:183], v[84:87]
 ds_read_b128 a[124:127], v2 offset:64512
M v[84:87], a[80:83], a[176:179], v[84:87]
 buffer_load_dwordx4 v3, s[8:11], s38 offen offset:3072 sc1 lds
M v[84:87], a[76:79], a[172:175], v[84:87]
M v[84:87], a[72:75], a[168:171], v[84:87]
M v[84:87], a[68:71], a[164:167], v[84:87]
 s_waitcnt vmcnt(12) lgkmcnt(0)
M v[84:87], a[64:67], a[160:163], v[84:87]
 s_barrier
M v[88:91], a[96:99], a[128:131], 0
 s_xor_b32 s47, s47, 64
 ds_read_b128 a[64:67], v7 offset:32768
M v[88:91], a[100:103], a[132:135], v[88:91]
 ds_read_b128 a[68:71], v7 offset:33792
 v_mov_b32 v18, 1
M v[88:91], a[104:107], a[136:139], v[88:91]
 buffer_store_dword v18, v1, s[8:11], s47 offen sc1
M v[88:91], a[108:111], a[140:143], v[88:91]
 ds_read_b128 a[72:75], v7 offset:34816
M v[88:91], a[112:115], a[144:147], v[88:91]
 s_add_u32 m0, s28, 135168
 ds_read_b128 a[76:79], v7 offset:35840
M v[88:91], a[116:119], a[148:151], v[88:91]
 buffer_load_dwordx4 v4, s[8:11], s38 offen offset:0 sc1 lds
M v[88:91], a[120:123], a[152:155], v[88:91]
 ds_read_b128 a[80:83], v7 offset:36864
M v[88:91], a[124:127], a[156:159], v[88:91]
 ds_read_b128 a[84:87], v7 offset:37888
M v[92:95], a[124:127], a[188:191], 0
 buffer_load_dwordx4 v4, s[8:11], s38 offen offset:1024 sc1 lds
M v[92:95], a[120:123], a[184:187], v[92:95]
 ds_read_b128 a[88:91], v7 offset:38912
M v[92:95], a[116:119], a[180:183], v[92:95]
 ds_read_b128 a[92:95], v7 offset:39936
M v[92:95], a[112:115], a[176:179], v[92:95]
 buffer_load_dwordx4 v4, s[8:11], s38 offen offset:2048 sc1 lds
M v[92:95], a[108:111], a[172:175], v[92:95]
M v[92:95], a[104:107], a[168:171], v[92:95]
 buffer_load_dwordx4 v4, s[8:11], s38 offen offset:3072 sc1 lds
M v[92:95], a[100:103], a[164:167], v[92:95]
 s_waitcnt lgkmcnt(0)
M v[92:95], a[96:99], a[160:163], v[92:95]
 s_add_u32 s38, s38, 32768
M v[96:99], a[64:67], a[128:131], 0
 s_add_u32 m0, s28, 98304
 ds_read_b128 a[96:99], v7 offset:40960
M v[96:99], a[68:71], a[132:135], v[96:99]
 ds_read_b128 a[100:103], v7 offset:41984
M v[96:99], a[72:75], a[136:139], v[96:99]
 buffer_load_dwordx4 v3, s[8:11], s38 offen offset:0 sc1 lds
M v[96:99], a[76:79], a[140:143], v[96:99]
 ds_read_b128 a[104:107], v7 offset:43008
 s_add_u32 s29, s33, 0
M v[96:99], a[80:83], a[144:147], v[96:99]
 ds_read_b128 a[108:111], v7 offset:44032
 s_add_u32 s30, s33, 14336
M v[96:99], a[84:87], a[148:151], v[96:99]
 buffer_load_dwordx4 v3, s[8:11], s38 offen offset:1024 sc1 lds
M v[96:99], a[88:91], a[152:155], v[96:99]
 ds_read_b128 a[112:115], v7 offset:45056
 v_max3_f32 v32, |v64|, |v65|, |v66|
M v[96:99], a[92:95], a[156:159], v[96:99]
 ds_read_b128 a[116:119], v7 offset:46080
 v_max3_f32 v32, |v67|, |v72|, v32
M v[100:103], a[92:95], a[188:191], 0
 buffer_load_dwordx4 v3, s[8:11], s38 offen offset:2048 sc1 lds
M v[100:103], a[88:91], a[184:187], v[100:103]
 ds_read_b128 a[120:123], v7 offset:47104
 v_max3_f32 v32, |v73|, |v74|, v32
M v[100:103], a[84:87], a[180:183], v[100:103]
 ds_read_b128 a[124:127], v7 offset:48128
 v_mul_f32 v32, 2.0, v32
M v[100:103], a[80:83], a[176:179], v[100:103]
 buffer_load_dwordx4 v3, s[8:11], s38 offen offset:3072 sc1 lds
M v[100:103], a[76:79], a[172:175], v[100:103]
 s_add_u32 m0, s28, 102400
 v_mov_b32 v33, v32
 v_mov_b32 v34, v32
M v[100:103], a[72:75], a[168:171], v[100:103]
 buffer_load_dwordx4 v4, s[8:11], s38 offen offset:0 sc1 lds
M v[100:103], a[68:71], a[164:167], v[100:103]
 v_mov_b32 v35, v32
 v_mul_f32 v28, -v32, v5
M v[100:103], a[64:67], a[160:163], v[100:103]
 s_waitcnt lgkmcnt(0)
 v_mul_f32 v64, v5, v64
 v_mul_f32 v65, v5, v65
M v[104:107], a[96:99], a[128:131], 0
 ds_read_b128 a[64:67], v7 offset:49152
 v_mul_f32 v66, v5, v66
M v[104:107], a[100:103], a[132:135], v[104:107]
 ds_read_b128 a[68:71], v7 offset:50176
 v_mul_f32 v67, v5, v67
M v[104:107], a[104:107], a[136:139], v[104:107]
 buffer_load_dwordx4 v4, s[8:11], s38 offen offset:1024 sc1 lds
M v[104:107], a[108:111], a[140:143], v[104:107]
 ds_read_b128 a[72:75], v7 offset:51200
 v_mul_f32 v72, v5, v72
M v[104:107], a[112:115], a[144:147], v[104:107]
 ds_read_b128 a[76:79], v7 offset:52224
 v_mul_f32 v73, v5, v73
M v[104:107], a[116:119], a[148:151], v[104:107]
 buffer_load_dwordx4 v4, s[8:11], s38 offen offset:2048 sc1 lds
M v[104:107], a[120:123], a[152:155], v[104:107]
 ds_read_b128 a[80:83], v7 offset:53248
 v_mul_f32 v74, v5, v74
M v[104:107], a[124:127], a[156:159], v[104:107]
 ds_read_b128 a[84:87], v7 offset:54272
 v_mul_f32 v75, v5, v75
M v[108:111], a[124:127], a[188:191], 0
 buffer_load_dwordx4 v4, s[8:11], s38 offen offset:3072 sc1 lds
M v[108:111], a[120:123], a[184:187], v[108:111]
 s_add_u32 s38, s38, 32768
 ds_read_b128 a[88:91], v7 offset:55296
 v_cvt_pk_bf16_f32 v64, v64, v65
M v[108:111], a[116:119], a[180:183], v[108:111]
 ds_read_b128 a[92:95], v7 offset:56320
 v_cvt_pk_bf16_f32 v65, v66, v67
M v[108:111], a[112:115], a[176:179], v[108:111]
 v_cvt_pk_bf16_f32 v66, v72, v73
 v_cvt_pk_bf16_f32 v67, v74, v75
M v[108:111], a[108:111], a[172:175], v[108:111]
 buffer_store_dwordx4 v[64:67], v7, s[8:11], s29 offen offset:0 sc1
M v[108:111], a[104:107], a[168:171], v[108:111]
 v_max3_f32 v36, |v68|, |v69|, |v70|
 v_max3_f32 v36, |v71|, |v76|, v36
M v[108:111], a[100:103], a[164:167], v[108:111]
 v_max3_f32 v36, |v77|, |v78|, v36
 v_mul_f32 v36, 2.0, v36
M v[108:111], a[96:99], a[160:163], v[108:111]
 s_waitcnt lgkmcnt(0)
 v_mov_b32 v37, v36
 v_mov_b32 v38, v36
M v[112:115], a[64:67], a[128:131], 0
 ds_read_b128 a[96:99], v7 offset:57344
 v_mov_b32 v39, v36
M v[112:115], a[68:71], a[132:135], v[112:115]
 ds_read_b128 a[100:103], v7 offset:58368
 v_mul_f32 v29, -v36, v6
M v[112:115], a[72:75], a[136:139], v[112:115]
 v_mul_f32 v68, v6, v68
 v_mul_f32 v69, v6, v69
M v[112:115], a[76:79], a[140:143], v[112:115]
 ds_read_b128 a[104:107], v7 offset:59392
 v_mul_f32 v70, v6, v70
M v[112:115], a[80:83], a[144:147], v[112:115]
 ds_read_b128 a[108:111], v7 offset:60416
 v_mul_f32 v71, v6, v71
M v[112:115], a[84:87], a[148:151], v[112:115]
 v_mul_f32 v76, v6, v76
 v_mul_f32 v77, v6, v77
M v[112:115], a[88:91], a[152:155], v[112:115]
 ds_read_b128 a[112:115], v7 offset:61440
 v_mul_f32 v78, v6, v78
M v[112:115], a[92:95], a[156:159], v[112:115]
 ds_read_b128 a[116:119], v7 offset:62464
 v_mul_f32 v79, v6, v79
M v[116:119], a[92:95], a[188:191], 0
 v_cvt_pk_bf16_f32 v68, v68, v69
 v_cvt_pk_bf16_f32 v69, v70, v71
M v[116:119], a[88:91], a[184:187], v[116:119]
 ds_read_b128 a[120:123], v7 offset:63488
 v_cvt_pk_bf16_f32 v70, v76, v77
M v[116:119], a[84:87], a[180:183], v[116:119]
 ds_read_b128 a[124:127], v7 offset:64512
 v_cvt_pk_bf16_f32 v71, v78, v79
M v[116:119], a[80:83], a[176:179], v[116:119]
 buffer_store_dwordx4 v[68:71], v7, s[8:11], s30 offen offset:0 sc1
M v[116:119], a[76:79], a[172:175], v[116:119]
 v_mul_f32 v80, v5, v80
 v_mul_f32 v81, v5, v81
M v[116:119], a[72:75], a[168:171], v[116:119]
 v_mul_f32 v82, v5, v82
 v_mul_f32 v83, v5, v83
M v[116:119], a[68:71], a[164:167], v[116:119]
 s_waitcnt lgkmcnt(0)
 v_mul_f32 v88, v5, v88
 v_mul_f32 v89, v5, v89
M v[116:119], a[64:67], a[160:163], v[116:119]
 s_barrier
M v[120:123], a[96:99], a[128:131], 0
 ds_read_b128 a[64:67], v2 offset:0
 v_mul_f32 v90, v5, v90
M v[120:123], a[100:103], a[132:135], v[120:123]
 ds_read_b128 a[68:71], v2 offset:1024
 v_mul_f32 v91, v5, v91
M v[120:123], a[104:107], a[136:139], v[120:123]
 v_cvt_pk_bf16_f32 v80, v80, v81
 v_cvt_pk_bf16_f32 v81, v82, v83
M v[120:123], a[108:111], a[140:143], v[120:123]
 ds_read_b128 a[72:75], v2 offset:2048
 v_cvt_pk_bf16_f32 v82, v88, v89
M v[120:123], a[112:115], a[144:147], v[120:123]
 ds_read_b128 a[76:79], v2 offset:3072
 v_cvt_pk_bf16_f32 v83, v90, v91
M v[120:123], a[116:119], a[148:151], v[120:123]
 buffer_store_dwordx4 v[80:83], v7, s[8:11], s29 offen offset:1024 sc1
M v[120:123], a[120:123], a[152:155], v[120:123]
 ds_read_b128 a[80:83], v2 offset:4096
 v_mul_f32 v84, v6, v84
M v[120:123], a[124:127], a[156:159], v[120:123]
 ds_read_b128 a[84:87], v2 offset:5120
 v_mul_f32 v85, v6, v85
M v[124:127], a[124:127], a[188:191], 0
 v_mul_f32 v86, v6, v86
 v_mul_f32 v87, v6, v87
M v[124:127], a[120:123], a[184:187], v[124:127]
 ds_read_b128 a[88:91], v2 offset:6144
 v_mul_f32 v92, v6, v92
M v[124:127], a[116:119], a[180:183], v[124:127]
 ds_read_b128 a[92:95], v2 offset:7168
 v_mul_f32 v93, v6, v93
M v[124:127], a[112:115], a[176:179], v[124:127]
 v_mul_f32 v94, v6, v94
 v_mul_f32 v95, v6, v95
M v[124:127], a[108:111], a[172:175], v[124:127]
 v_cvt_pk_bf16_f32 v84, v84, v85
 v_cvt_pk_bf16_f32 v85, v86, v87
M v[124:127], a[104:107], a[168:171], v[124:127]
 v_cvt_pk_bf16_f32 v86, v92, v93
 v_cvt_pk_bf16_f32 v87, v94, v95
M v[124:127], a[100:103], a[164:167], v[124:127]
 s_waitcnt lgkmcnt(0)
M v[124:127], a[96:99], a[160:163], v[124:127]
 buffer_store_dwordx4 v[84:87], v7, s[8:11], s30 offen offset:1024 sc1
M v[64:67], a[64:67], a[128:131], v[32:35]
 s_add_u32 m0, s28, 32768
 ds_read_b128 a[96:99], v2 offset:8192
M v[64:67], a[68:71], a[132:135], v[64:67]
 ds_read_b128 a[100:103], v2 offset:9216
 s_mov_b32 s79, 104923136
M v[64:67], a[72:75], a[136:139], v[64:67]
 buffer_load_dwordx4 v3, s[8:11], s38 offen offset:0 sc1 lds
M v[64:67], a[76:79], a[140:143], v[64:67]
 ds_read_b128 a[104:107], v2 offset:10240
 s_add_u32 s29, s33, 2048
M v[64:67], a[80:83], a[144:147], v[64:67]
 ds_read_b128 a[108:111], v2 offset:11264
 s_add_u32 s30, s33, 16384
M v[64:67], a[84:87], a[148:151], v[64:67]
 buffer_load_dwordx4 v3, s[8:11], s38 offen offset:1024 sc1 lds
M v[64:67], a[88:91], a[152:155], v[64:67]
 ds_read_b128 a[112:115], v2 offset:12288
 v_mul_f32 v96, v5, v96
M v[64:67], a[92:95], a[156:159], v[64:67]
 ds_read_b128 a[116:119], v2 offset:13312
 v_mul_f32 v97, v5, v97
M v[68:71], a[92:95], a[188:191], v[36:39]
 buffer_load_dwordx4 v3, s[8:11], s38 offen offset:2048 sc1 lds
M v[68:71], a[88:91], a[184:187], v[68:71]
 ds_read_b128 a[120:123], v2 offset:14336
 v_mul_f32 v98, v5, v98
M v[68:71], a[84:87], a[180:183], v[68:71]
 ds_read_b128 a[124:127], v2 offset:15360
 v_mul_f32 v99, v5, v99
M v[68:71], a[80:83], a[176:179], v[68:71]
 buffer_load_dwordx4 v3, s[8:11], s38 offen offset:3072 sc1 lds
M v[68:71], a[76:79], a[172:175], v[68:71]
 s_add_u32 m0, s28, 36864
 v_mul_f32 v104, v5, v104
 v_mul_f32 v105, v5, v105
M v[68:71], a[72:75], a[168:171], v[68:71]
 buffer_load_dwordx4 v4, s[8:11], s38 offen offset:0 sc1 lds
M v[68:71], a[68:71], a[164:167], v[68:71]
 buffer_load_dword v24, off, s[8:11], s79 sc1
M v[68:71], a[64:67], a[160:163], v[68:71]
 s_waitcnt lgkmcnt(0)
 v_lshrrev_b32 v0, 4, v7
 v_and_b32 v14, 15, v0
M v[72:75], a[96:99], a[128:131], v[32:35]
 ds_read_b128 a[64:67], v2 offset:16384
 v_lshlrev_b32 v14, 2, v14
M v[72:75], a[100:103], a[132:135], v[72:75]
 ds_read_b128 a[68:71], v2 offset:17408
 v_lshrrev_b32 v11, 4, v0
M v[72:75], a[104:107], a[136:139], v[72:75]
 buffer_load_dwordx4 v4, s[8:11], s38 offen offset:1024 sc1 lds
M v[72:75], a[108:111], a[140:143], v[72:75]
 ds_read_b128 a[72:75], v2 offset:18432
 s_mov_b32 s52, s96
M v[72:75], a[112:115], a[144:147], v[72:75]
 s_and_b32 s53, s97, 0xffff
 ds_read_b128 a[76:79], v2 offset:19456
 s_mov_b32 s54, 1835008
M v[72:75], a[116:119], a[148:151], v[72:75]
 buffer_load_dwordx4 v4, s[8:11], s38 offen offset:2048 sc1 lds
M v[72:75], a[120:123], a[152:155], v[72:75]
 ds_read_b128 a[80:83], v2 offset:20480
 s_mov_b32 s55, 0x20000
M v[72:75], a[124:127], a[156:159], v[72:75]
 s_lshr_b32 s74, s41, 3
 ds_read_b128 a[84:87], v2 offset:21504
 s_xor_b32 s74, s74, 0
M v[76:79], a[124:127], a[188:191], v[36:39]
 buffer_load_dwordx4 v4, s[8:11], s38 offen offset:3072 sc1 lds
M v[76:79], a[120:123], a[184:187], v[76:79]
 s_add_u32 s38, s38, 32768
 ds_read_b128 a[88:91], v2 offset:22528
 s_mul_i32 s67, s74, -2
M v[76:79], a[116:119], a[180:183], v[76:79]
 s_mul_i32 s74, s74, 8
 ds_read_b128 a[92:95], v2 offset:23552
 v_mul_f32 v106, v5, v106
M v[76:79], a[112:115], a[176:179], v[76:79]
 s_add_u32 s74, s74, s20
 v_mul_f32 v107, v5, v107
 v_cvt_pk_bf16_f32 v96, v96, v97
M v[76:79], a[108:111], a[172:175], v[76:79]
 s_lshl_b32 s75, s74, 6
 v_cvt_pk_bf16_f32 v97, v98, v99
 v_cvt_pk_bf16_f32 v98, v104, v105
M v[76:79], a[104:107], a[168:171], v[76:79]
 s_add_u32 s76, s75, 256
 v_cvt_pk_bf16_f32 v99, v106, v107
M v[76:79], a[100:103], a[164:167], v[76:79]
 s_add_u32 s67, s67, 3
 v_add_u32 v43, 0x20000, v7
 s_sub_u32 s67, s67, s20
M v[76:79], a[96:99], a[160:163], v[76:79]
 s_waitcnt lgkmcnt(0)
 s_and_b32 s67, s67, 536870912
M v[80:83], a[64:67], a[128:131], v[32:35]
 s_or_b32 s76, s76, s67
 ds_read_b128 a[96:99], v2 offset:24576
 v_or_b32 v27, s67, v7
M v[80:83], a[68:71], a[132:135], v[80:83]
 ds_read_b128 a[100:103], v2 offset:25600
 v_add_u32 v27, 4096, v27
M v[80:83], a[72:75], a[136:139], v[80:83]
 buffer_store_dwordx4 v[96:99], v7, s[8:11], s29 offen offset:0 sc1
M v[80:83], a[76:79], a[140:143], v[80:83]
 ds_read_b128 a[104:107], v2 offset:26624
 v_mul_f32 v100, v6, v100
M v[80:83], a[80:83], a[144:147], v[80:83]
 ds_read_b128 a[108:111], v2 offset:27648
 v_mul_f32 v101, v6, v101
M v[80:83], a[84:87], a[148:151], v[80:83]
 v_mul_f32 v102, v6, v102
 v_mul_f32 v103, v6, v103
M v[80:83], a[88:91], a[152:155], v[80:83]
 ds_read_b128 a[112:115], v2 offset:28672
 v_mul_f32 v108, v6, v108
M v[80:83], a[92:95], a[156:159], v[80:83]
 ds_read_b128 a[116:119], v2 offset:29696
 v_mul_f32 v109, v6, v109
M v[84:87], a[92:95], a[188:191], v[36:39]
 v_mul_f32 v110, v6, v110
 v_mul_f32 v111, v6, v111
M v[84:87], a[88:91], a[184:187], v[84:87]
 ds_read_b128 a[120:123], v2 offset:30720
 v_cvt_pk_bf16_f32 v100, v100, v101
M v[84:87], a[84:87], a[180:183], v[84:87]
 ds_read_b128 a[124:127], v2 offset:31744
 v_cvt_pk_bf16_f32 v101, v102, v103
M v[84:87], a[80:83], a[176:179], v[84:87]
 v_cvt_pk_bf16_f32 v102, v108, v109
 v_cvt_pk_bf16_f32 v103, v110, v111
M v[84:87], a[76:79], a[172:175], v[84:87]
 buffer_store_dwordx4 v[100:103], v7, s[8:11], s30 offen offset:0 sc1
M v[84:87], a[72:75], a[168:171], v[84:87]
 v_mul_f32 v112, v5, v112
 v_mul_f32 v113, v5, v113
M v[84:87], a[68:71], a[164:167], v[84:87]
 s_waitcnt vmcnt(32) lgkmcnt(0)
 v_mul_f32 v114, v5, v114
 v_mul_f32 v115, v5, v115
M v[84:87], a[64:67], a[160:163], v[84:87]
 s_barrier
M v[88:91], a[96:99], a[128:131], v[32:35]
 ds_read_b128 a[64:67], v7 offset:0
 v_mul_f32 v120, v5, v120
M v[88:91], a[100:103], a[132:135], v[88:91]
 ds_read_b128 a[68:71], v7 offset:1024
 v_mul_f32 v121, v5, v121
M v[88:91], a[104:107], a[136:139], v[88:91]
 v_mul_f32 v122, v5, v122
 v_mul_f32 v123, v5, v123
M v[88:91], a[108:111], a[140:143], v[88:91]
 ds_read_b128 a[72:75], v7 offset:2048
 v_cvt_pk_bf16_f32 v112, v112, v113
M v[88:91], a[112:115], a[144:147], v[88:91]
 ds_read_b128 a[76:79], v7 offset:3072
 v_cvt_pk_bf16_f32 v113, v114, v115
M v[88:91], a[116:119], a[148:151], v[88:91]
 v_cvt_pk_bf16_f32 v114, v120, v121
 v_cvt_pk_bf16_f32 v115, v122, v123
M v[88:91], a[120:123], a[152:155], v[88:91]
 ds_read_b128 a[80:83], v7 offset:4096
M v[88:91], a[124:127], a[156:159], v[88:91]
 ds_read_b128 a[84:87], v7 offset:5120
M v[92:95], a[124:127], a[188:191], v[36:39]
 buffer_store_dwordx4 v[112:115], v7, s[8:11], s29 offen offset:1024 sc1
M v[92:95], a[120:123], a[184:187], v[92:95]
 ds_read_b128 a[88:91], v7 offset:6144
 v_mul_f32 v116, v6, v116
M v[92:95], a[116:119], a[180:183], v[92:95]
 ds_read_b128 a[92:95], v7 offset:7168
 v_mul_f32 v117, v6, v117
M v[92:95], a[112:115], a[176:179], v[92:95]
 v_mul_f32 v118, v6, v118
 v_mul_f32 v119, v6, v119
M v[92:95], a[108:111], a[172:175], v[92:95]
 v_mul_f32 v124, v6, v124
 v_mul_f32 v125, v6, v125
M v[92:95], a[104:107], a[168:171], v[92:95]
 v_mul_f32 v126, v6, v126
 v_mul_f32 v127, v6, v127
M v[92:95], a[100:103], a[164:167], v[92:95]
 s_waitcnt lgkmcnt(0)
 v_cvt_pk_bf16_f32 v116, v116, v117
 v_cvt_pk_bf16_f32 v117, v118, v119
M v[92:95], a[96:99], a[160:163], v[92:95]
 v_cvt_pk_bf16_f32 v118, v124, v125
 v_cvt_pk_bf16_f32 v119, v126, v127
 buffer_store_dwordx4 v[116:119], v7, s[8:11], s30 offen offset:1024 sc1
M v[96:99], a[64:67], a[128:131], v[32:35]
 ds_read_b128 a[96:99], v7 offset:8192
M v[96:99], a[68:71], a[132:135], v[96:99]
 ds_read_b128 a[100:103], v7 offset:9216
M v[96:99], a[72:75], a[136:139], v[96:99]
 s_sub_u32 s64, 15, s42
M v[96:99], a[76:79], a[140:143], v[96:99]
 s_min_u32 s64, s64, s42
 ds_read_b128 a[104:107], v7 offset:10240
 s_add_u32 s29, s33, 4096
M v[96:99], a[80:83], a[144:147], v[96:99]
 s_mul_i32 s45, s64, 8704
 ds_read_b128 a[108:111], v7 offset:11264
 s_add_u32 s30, s33, 18432
M v[96:99], a[84:87], a[148:151], v[96:99]
 s_lshl_b32 s64, s20, 6
 v_fma_f32 v64, v64, v5, v28
 v_fma_f32 v65, v65, v5, v28
M v[96:99], a[88:91], a[152:155], v[96:99]
 s_add_u32 s64, s64, s41
 ds_read_b128 a[112:115], v7 offset:12288
 v_fma_f32 v66, v66, v5, v28
M v[96:99], a[92:95], a[156:159], v[96:99]
 s_lshl2_add_u32 s45, s64, s45
 ds_read_b128 a[116:119], v7 offset:13312
 v_fma_f32 v67, v67, v5, v28
M v[100:103], a[92:95], a[188:191], v[36:39]
 s_add_u32 s45, s45, 104992768
 v_fma_f32 v72, v72, v5, v28
M v[100:103], a[88:91], a[184:187], v[100:103]
 s_movk_i32 s65, 1024
 ds_read_b128 a[120:123], v7 offset:14336
 v_fma_f32 v73, v73, v5, v28
M v[100:103], a[84:87], a[180:183], v[100:103]
 s_cmp_lt_u32 s42, 8
 ds_read_b128 a[124:127], v7 offset:15360
 v_fma_f32 v74, v74, v5, v28
M v[100:103], a[80:83], a[176:179], v[100:103]
 s_cselect_b32 s64, 4352, s65
 v_fma_f32 v75, v75, v5, v28
M v[100:103], a[76:79], a[172:175], v[100:103]
 s_cselect_b32 s65, 0, 64
 v_cvt_pk_bf16_f32 v64, v64, v65
M v[100:103], a[72:75], a[168:171], v[100:103]
 s_cselect_b32 s66, 32, 64
 v_cvt_pk_bf16_f32 v65, v66, v67
M v[100:103], a[68:71], a[164:167], v[100:103]
 s_add_u32 s3, s45, s64
 s_add_u32 s45, s45, s65
 v_lshrrev_b32 v42, 5, v7
M v[100:103], a[64:67], a[160:163], v[100:103]
 s_waitcnt lgkmcnt(0)
 v_mul_u32_u24 v42, 4352, v42
 v_and_b32 v41, 16, v7
M v[104:107], a[96:99], a[128:131], v[32:35]
 ds_read_b128 a[64:67], v7 offset:16384
 v_lshl_add_u32 v41, v41, 3, v42
M v[104:107], a[100:103], a[132:135], v[104:107]
 ds_read_b128 a[68:71], v7 offset:17408
 v_mov_b32 v42, 536870912
M v[104:107], a[104:107], a[136:139], v[104:107]
 v_cmp_gt_u32 vcc, s66, v7
 v_mov_b32 v40, 1
M v[104:107], a[108:111], a[140:143], v[104:107]
 s_nop 0
 ds_read_b128 a[72:75], v7 offset:18432
 v_cndmask_b32 v41, v42, v41, vcc
M v[104:107], a[112:115], a[144:147], v[104:107]
 ds_read_b128 a[76:79], v7 offset:19456
 v_cvt_pk_bf16_f32 v66, v72, v73
M v[104:107], a[116:119], a[148:151], v[104:107]
 v_cvt_pk_bf16_f32 v67, v74, v75
M v[104:107], a[120:123], a[152:155], v[104:107]
 ds_read_b128 a[80:83], v7 offset:20480
M v[104:107], a[124:127], a[156:159], v[104:107]
 ds_read_b128 a[84:87], v7 offset:21504
M v[108:111], a[124:127], a[188:191], v[36:39]
 buffer_store_dwordx4 v[64:67], v7, s[8:11], s29 offen offset:0 sc1
M v[108:111], a[120:123], a[184:187], v[108:111]
 ds_read_b128 a[88:91], v7 offset:22528
 v_fma_f32 v68, v68, v6, v29
M v[108:111], a[116:119], a[180:183], v[108:111]
 ds_read_b128 a[92:95], v7 offset:23552
 v_fma_f32 v69, v69, v6, v29
M v[108:111], a[112:115], a[176:179], v[108:111]
 v_fma_f32 v70, v70, v6, v29
 v_fma_f32 v71, v71, v6, v29
M v[108:111], a[108:111], a[172:175], v[108:111]
 v_fma_f32 v76, v76, v6, v29
 v_fma_f32 v77, v77, v6, v29
M v[108:111], a[104:107], a[168:171], v[108:111]
 v_fma_f32 v78, v78, v6, v29
 v_fma_f32 v79, v79, v6, v29
M v[108:111], a[100:103], a[164:167], v[108:111]
 v_cvt_pk_bf16_f32 v68, v68, v69
 v_cvt_pk_bf16_f32 v69, v70, v71
M v[108:111], a[96:99], a[160:163], v[108:111]
 s_waitcnt lgkmcnt(0)
 v_cvt_pk_bf16_f32 v70, v76, v77
 v_cvt_pk_bf16_f32 v71, v78, v79
M v[112:115], a[64:67], a[128:131], v[32:35]
 ds_read_b128 a[96:99], v7 offset:24576
M v[112:115], a[68:71], a[132:135], v[112:115]
 ds_read_b128 a[100:103], v7 offset:25600
M v[112:115], a[72:75], a[136:139], v[112:115]
 buffer_store_dwordx4 v[68:71], v7, s[8:11], s30 offen offset:0 sc1
M v[112:115], a[76:79], a[140:143], v[112:115]
 ds_read_b128 a[104:107], v7 offset:26624
 v_fma_f32 v80, v80, v5, v28
M v[112:115], a[80:83], a[144:147], v[112:115]
 ds_read_b128 a[108:111], v7 offset:27648
 v_fma_f32 v81, v81, v5, v28
M v[112:115], a[84:87], a[148:151], v[112:115]
 v_fma_f32 v82, v82, v5, v28
 v_fma_f32 v83, v83, v5, v28
M v[112:115], a[88:91], a[152:155], v[112:115]
 ds_read_b128 a[112:115], v7 offset:28672
 v_fma_f32 v88, v88, v5, v28
M v[112:115], a[92:95], a[156:159], v[112:115]
 ds_read_b128 a[116:119], v7 offset:29696
 v_fma_f32 v89, v89, v5, v28
M v[116:119], a[92:95], a[188:191], v[36:39]
 v_fma_f32 v90, v90, v5, v28
 v_fma_f32 v91, v91, v5, v28
M v[116:119], a[88:91], a[184:187], v[116:119]
 ds_read_b128 a[120:123], v7 offset:30720
 v_cvt_pk_bf16_f32 v80, v80, v81
M v[116:119], a[84:87], a[180:183], v[116:119]
 ds_read_b128 a[124:127], v7 offset:31744
 v_cvt_pk_bf16_f32 v81, v82, v83
M v[116:119], a[80:83], a[176:179], v[116:119]
 v_cvt_pk_bf16_f32 v82, v88, v89
 v_cvt_pk_bf16_f32 v83, v90, v91
M v[116:119], a[76:79], a[172:175], v[116:119]
 buffer_store_dwordx4 v[80:83], v7, s[8:11], s29 offen offset:1024 sc1
M v[116:119], a[72:75], a[168:171], v[116:119]
 v_fma_f32 v84, v84, v6, v29
 v_fma_f32 v85, v85, v6, v29
M v[116:119], a[68:71], a[164:167], v[116:119]
 s_waitcnt vmcnt(28) lgkmcnt(0)
 v_fma_f32 v86, v86, v6, v29
M v[116:119], a[64:67], a[160:163], v[116:119]
 s_barrier
M v[120:123], a[96:99], a[128:131], v[32:35]
 ds_read_b128 a[64:67], v43 offset:0
 v_fma_f32 v87, v87, v6, v29
M v[120:123], a[100:103], a[132:135], v[120:123]
 ds_read_b128 a[68:71], v43 offset:1024
 v_fma_f32 v92, v92, v6, v29
M v[120:123], a[104:107], a[136:139], v[120:123]
 v_fma_f32 v93, v93, v6, v29
 v_fma_f32 v94, v94, v6, v29
M v[120:123], a[108:111], a[140:143], v[120:123]
 ds_read_b128 a[72:75], v43 offset:2048
 v_fma_f32 v95, v95, v6, v29
M v[120:123], a[112:115], a[144:147], v[120:123]
 ds_read_b128 a[76:79], v43 offset:3072
 v_cvt_pk_bf16_f32 v84, v84, v85
M v[120:123], a[116:119], a[148:151], v[120:123]
 v_cvt_pk_bf16_f32 v85, v86, v87
M v[120:123], a[120:123], a[152:155], v[120:123]
 ds_read_b128 a[80:83], v43 offset:4096
 v_cvt_pk_bf16_f32 v86, v92, v93
M v[120:123], a[124:127], a[156:159], v[120:123]
 ds_read_b128 a[84:87], v43 offset:5120
 v_cvt_pk_bf16_f32 v87, v94, v95
M v[124:127], a[124:127], a[188:191], v[36:39]
 buffer_store_dwordx4 v[84:87], v7, s[8:11], s30 offen offset:1024 sc1
M v[124:127], a[120:123], a[184:187], v[124:127]
 ds_read_b128 a[88:91], v43 offset:6144
M v[124:127], a[116:119], a[180:183], v[124:127]
 ds_read_b128 a[92:95], v43 offset:7168
M v[124:127], a[112:115], a[176:179], v[124:127]
M v[124:127], a[108:111], a[172:175], v[124:127]
M v[124:127], a[104:107], a[168:171], v[124:127]
M v[124:127], a[100:103], a[164:167], v[124:127]
 s_waitcnt lgkmcnt(0)
M v[124:127], a[96:99], a[160:163], v[124:127]
M v[64:67], a[64:67], a[128:131], v[32:35]
 ds_read_b128 a[96:99], v43 offset:8192
M v[64:67], a[68:71], a[132:135], v[64:67]
 ds_read_b128 a[100:103], v43 offset:9216
M v[64:67], a[72:75], a[136:139], v[64:67]
 s_waitcnt vmcnt(11)
 v_cmp_gt_u32 vcc, 1, v24
M v[64:67], a[76:79], a[140:143], v[64:67]
 s_mov_b32 s65, 104890368
 ds_read_b128 a[104:107], v43 offset:10240
 s_add_u32 s29, s33, 6144
M v[64:67], a[80:83], a[144:147], v[64:67]
 s_cbranch_vccnz L_fhs0
L_fhr0:
 ds_read_b128 a[108:111], v43 offset:11264
 s_add_u32 s30, s33, 20480
M v[64:67], a[84:87], a[148:151], v[64:67]
 buffer_load_dword v25, v14, s[8:11], s65 offen sc1
M v[64:67], a[88:91], a[152:155], v[64:67]
 ds_read_b128 a[112:115], v43 offset:12288
 v_fma_f32 v96, v96, v5, v28
M v[64:67], a[92:95], a[156:159], v[64:67]
 ds_read_b128 a[116:119], v43 offset:13312
 v_fma_f32 v97, v97, v5, v28
M v[68:71], a[92:95], a[188:191], v[36:39]
 v_fma_f32 v98, v98, v5, v28
 v_fma_f32 v99, v99, v5, v28
M v[68:71], a[88:91], a[184:187], v[68:71]
 ds_read_b128 a[120:123], v43 offset:14336
 v_fma_f32 v104, v104, v5, v28
M v[68:71], a[84:87], a[180:183], v[68:71]
 ds_read_b128 a[124:127], v43 offset:15360
 v_fma_f32 v105, v105, v5, v28
M v[68:71], a[80:83], a[176:179], v[68:71]
 v_fma_f32 v106, v106, v5, v28
 v_fma_f32 v107, v107, v5, v28
M v[68:71], a[76:79], a[172:175], v[68:71]
 v_cvt_pk_bf16_f32 v96, v96, v97
M v[68:71], a[72:75], a[168:171], v[68:71]
 v_cvt_pk_bf16_f32 v97, v98, v99
M v[68:71], a[68:71], a[164:167], v[68:71]
 v_cvt_pk_bf16_f32 v98, v104, v105
M v[68:71], a[64:67], a[160:163], v[68:71]
 s_waitcnt lgkmcnt(0)
 v_cvt_pk_bf16_f32 v99, v106, v107
M v[72:75], a[96:99], a[128:131], v[32:35]
 ds_read_b128 a[64:67], v43 offset:16384
M v[72:75], a[100:103], a[132:135], v[72:75]
 ds_read_b128 a[68:71], v43 offset:17408
M v[72:75], a[104:107], a[136:139], v[72:75]
 buffer_store_dwordx4 v[96:99], v7, s[8:11], s29 offen offset:0 sc1
M v[72:75], a[108:111], a[140:143], v[72:75]
 ds_read_b128 a[72:75], v43 offset:18432
 v_fma_f32 v100, v100, v6, v29
M v[72:75], a[112:115], a[144:147], v[72:75]
 ds_read_b128 a[76:79], v43 offset:19456
 v_fma_f32 v101, v101, v6, v29
M v[72:75], a[116:119], a[148:151], v[72:75]
 v_fma_f32 v102, v102, v6, v29
 v_fma_f32 v103, v103, v6, v29
M v[72:75], a[120:123], a[152:155], v[72:75]
 ds_read_b128 a[80:83], v43 offset:20480
 v_fma_f32 v108, v108, v6, v29
M v[72:75], a[124:127], a[156:159], v[72:75]
 ds_read_b128 a[84:87], v43 offset:21504
 v_fma_f32 v109, v109, v6, v29
M v[76:79], a[124:127], a[188:191], v[36:39]
 v_fma_f32 v110, v110, v6, v29
 v_fma_f32 v111, v111, v6, v29
M v[76:79], a[120:123], a[184:187], v[76:79]
 ds_read_b128 a[88:91], v43 offset:22528
 v_cvt_pk_bf16_f32 v100, v100, v101
M v[76:79], a[116:119], a[180:183], v[76:79]
 ds_read_b128 a[92:95], v43 offset:23552
 v_cvt_pk_bf16_f32 v101, v102, v103
M v[76:79], a[112:115], a[176:179], v[76:79]
 v_cvt_pk_bf16_f32 v102, v108, v109
M v[76:79], a[108:111], a[172:175], v[76:79]
 v_cvt_pk_bf16_f32 v103, v110, v111
M v[76:79], a[104:107], a[168:171], v[76:79]
 buffer_store_dwordx4 v[100:103], v7, s[8:11], s30 offen offset:0 sc1
M v[76:79], a[100:103], a[164:167], v[76:79]
M v[76:79], a[96:99], a[160:163], v[76:79]
 s_waitcnt lgkmcnt(0)
 v_fma_f32 v112, v112, v5, v28
M v[80:83], a[64:67], a[128:131], v[32:35]
 ds_read_b128 a[96:99], v43 offset:24576
 v_fma_f32 v113, v113, v5, v28
M v[80:83], a[68:71], a[132:135], v[80:83]
 ds_read_b128 a[100:103], v43 offset:25600
 v_fma_f32 v114, v114, v5, v28
M v[80:83], a[72:75], a[136:139], v[80:83]
 v_fma_f32 v115, v115, v5, v28
M v[80:83], a[76:79], a[140:143], v[80:83]
 ds_read_b128 a[104:107], v43 offset:26624
 v_fma_f32 v120, v120, v5, v28
M v[80:83], a[80:83], a[144:147], v[80:83]
 ds_read_b128 a[108:111], v43 offset:27648
 v_fma_f32 v121, v121, v5, v28
M v[80:83], a[84:87], a[148:151], v[80:83]
 v_fma_f32 v122, v122, v5, v28
M v[80:83], a[88:91], a[152:155], v[80:83]
 ds_read_b128 a[112:115], v43 offset:28672
 v_fma_f32 v123, v123, v5, v28
M v[80:83], a[92:95], a[156:159], v[80:83]
 ds_read_b128 a[116:119], v43 offset:29696
 v_cvt_pk_bf16_f32 v112, v112, v113
M v[84:87], a[92:95], a[188:191], v[36:39]
 v_cvt_pk_bf16_f32 v113, v114, v115
 v_cvt_pk_bf16_f32 v114, v120, v121
M v[84:87], a[88:91], a[184:187], v[84:87]
 ds_read_b128 a[120:123], v43 offset:30720
 v_cvt_pk_bf16_f32 v115, v122, v123
M v[84:87], a[84:87], a[180:183], v[84:87]
 ds_read_b128 a[124:127], v43 offset:31744
M v[84:87], a[80:83], a[176:179], v[84:87]
 buffer_store_dwordx4 v[112:115], v7, s[8:11], s29 offen offset:1024 sc1
M v[84:87], a[76:79], a[172:175], v[84:87]
 v_fma_f32 v116, v116, v6, v29
M v[84:87], a[72:75], a[168:171], v[84:87]
 v_fma_f32 v117, v117, v6, v29
M v[84:87], a[68:71], a[164:167], v[84:87]
 s_waitcnt lgkmcnt(0)
 v_fma_f32 v118, v118, v6, v29
M v[84:87], a[64:67], a[160:163], v[84:87]
 s_barrier
M v[88:91], a[96:99], a[128:131], v[32:35]
 ds_read_b128 a[64:67], v2 offset:32768
 v_fma_f32 v119, v119, v6, v29
M v[88:91], a[100:103], a[132:135], v[88:91]
 ds_read_b128 a[68:71], v2 offset:33792
 v_fma_f32 v124, v124, v6, v29
M v[88:91], a[104:107], a[136:139], v[88:91]
 v_fma_f32 v125, v125, v6, v29
 v_fma_f32 v126, v126, v6, v29
M v[88:91], a[108:111], a[140:143], v[88:91]
 ds_read_b128 a[72:75], v2 offset:34816
 v_fma_f32 v127, v127, v6, v29
M v[88:91], a[112:115], a[144:147], v[88:91]
 ds_read_b128 a[76:79], v2 offset:35840
 v_cvt_pk_bf16_f32 v116, v116, v117
M v[88:91], a[116:119], a[148:151], v[88:91]
 v_cvt_pk_bf16_f32 v117, v118, v119
M v[88:91], a[120:123], a[152:155], v[88:91]
 ds_read_b128 a[80:83], v2 offset:36864
 v_cvt_pk_bf16_f32 v118, v124, v125
M v[88:91], a[124:127], a[156:159], v[88:91]
 ds_read_b128 a[84:87], v2 offset:37888
 v_cvt_pk_bf16_f32 v119, v126, v127
M v[92:95], a[124:127], a[188:191], v[36:39]
 buffer_store_dwordx4 v[116:119], v7, s[8:11], s30 offen offset:1024 sc1
M v[92:95], a[120:123], a[184:187], v[92:95]
 ds_read_b128 a[88:91], v2 offset:38912
M v[92:95], a[116:119], a[180:183], v[92:95]
 ds_read_b128 a[92:95], v2 offset:39936
M v[92:95], a[112:115], a[176:179], v[92:95]
M v[92:95], a[108:111], a[172:175], v[92:95]
M v[92:95], a[104:107], a[168:171], v[92:95]
M v[92:95], a[100:103], a[164:167], v[92:95]
 s_waitcnt lgkmcnt(0)
M v[92:95], a[96:99], a[160:163], v[92:95]
M v[96:99], a[64:67], a[128:131], v[32:35]
 ds_read_b128 a[96:99], v2 offset:40960
M v[96:99], a[68:71], a[132:135], v[96:99]
 ds_read_b128 a[100:103], v2 offset:41984
M v[96:99], a[72:75], a[136:139], v[96:99]
M v[96:99], a[76:79], a[140:143], v[96:99]
 ds_read_b128 a[104:107], v2 offset:43008
 s_add_u32 s29, s33, 8192
M v[96:99], a[80:83], a[144:147], v[96:99]
 ds_read_b128 a[108:111], v2 offset:44032
 s_add_u32 s30, s33, 22528
M v[96:99], a[84:87], a[148:151], v[96:99]
 v_fma_f32 v64, v64, v5, v28
 v_fma_f32 v65, v65, v5, v28
M v[96:99], a[88:91], a[152:155], v[96:99]
 ds_read_b128 a[112:115], v2 offset:45056
 v_fma_f32 v66, v66, v5, v28
M v[96:99], a[92:95], a[156:159], v[96:99]
 ds_read_b128 a[116:119], v2 offset:46080
 v_fma_f32 v67, v67, v5, v28
M v[100:103], a[92:95], a[188:191], v[36:39]
 v_fma_f32 v72, v72, v5, v28
M v[100:103], a[88:91], a[184:187], v[100:103]
 ds_read_b128 a[120:123], v2 offset:47104
 v_fma_f32 v73, v73, v5, v28
M v[100:103], a[84:87], a[180:183], v[100:103]
 ds_read_b128 a[124:127], v2 offset:48128
 v_fma_f32 v74, v74, v5, v28
M v[100:103], a[80:83], a[176:179], v[100:103]
 v_fma_f32 v75, v75, v5, v28
M v[100:103], a[76:79], a[172:175], v[100:103]
 v_cvt_pk_bf16_f32 v64, v64, v65
M v[100:103], a[72:75], a[168:171], v[100:103]
 v_cvt_pk_bf16_f32 v65, v66, v67
M v[100:103], a[68:71], a[164:167], v[100:103]
 v_cvt_pk_bf16_f32 v66, v72, v73
M v[100:103], a[64:67], a[160:163], v[100:103]
 s_waitcnt lgkmcnt(0)
 v_cvt_pk_bf16_f32 v67, v74, v75
M v[104:107], a[96:99], a[128:131], v[32:35]
 ds_read_b128 a[64:67], v2 offset:49152
M v[104:107], a[100:103], a[132:135], v[104:107]
 ds_read_b128 a[68:71], v2 offset:50176
M v[104:107], a[104:107], a[136:139], v[104:107]
 buffer_store_dwordx4 v[64:67], v7, s[8:11], s29 offen offset:0 sc1
M v[104:107], a[108:111], a[140:143], v[104:107]
 ds_read_b128 a[72:75], v2 offset:51200
 v_fma_f32 v68, v68, v6, v29
M v[104:107], a[112:115], a[144:147], v[104:107]
 ds_read_b128 a[76:79], v2 offset:52224
 v_fma_f32 v69, v69, v6, v29
M v[104:107], a[116:119], a[148:151], v[104:107]
 v_fma_f32 v70, v70, v6, v29
 v_fma_f32 v71, v71, v6, v29
M v[104:107], a[120:123], a[152:155], v[104:107]
 ds_read_b128 a[80:83], v2 offset:53248
 v_fma_f32 v76, v76, v6, v29
M v[104:107], a[124:127], a[156:159], v[104:107]
 ds_read_b128 a[84:87], v2 offset:54272
 v_fma_f32 v77, v77, v6, v29
M v[108:111], a[124:127], a[188:191], v[36:39]
 v_fma_f32 v78, v78, v6, v29
 v_fma_f32 v79, v79, v6, v29
M v[108:111], a[120:123], a[184:187], v[108:111]
 ds_read_b128 a[88:91], v2 offset:55296
 v_cvt_pk_bf16_f32 v68, v68, v69
M v[108:111], a[116:119], a[180:183], v[108:111]
 ds_read_b128 a[92:95], v2 offset:56320
 v_cvt_pk_bf16_f32 v69, v70, v71
M v[108:111], a[112:115], a[176:179], v[108:111]
 v_cvt_pk_bf16_f32 v70, v76, v77
M v[108:111], a[108:111], a[172:175], v[108:111]
 v_cvt_pk_bf16_f32 v71, v78, v79
M v[108:111], a[104:107], a[168:171], v[108:111]
 buffer_store_dwordx4 v[68:71], v7, s[8:11], s30 offen offset:0 sc1
M v[108:111], a[100:103], a[164:167], v[108:111]
M v[108:111], a[96:99], a[160:163], v[108:111]
 s_waitcnt lgkmcnt(0)
 v_fma_f32 v80, v80, v5, v28
M v[112:115], a[64:67], a[128:131], v[32:35]
 ds_read_b128 a[96:99], v2 offset:57344
 v_fma_f32 v81, v81, v5, v28
M v[112:115], a[68:71], a[132:135], v[112:115]
 ds_read_b128 a[100:103], v2 offset:58368
 v_fma_f32 v82, v82, v5, v28
M v[112:115], a[72:75], a[136:139], v[112:115]
 v_fma_f32 v83, v83, v5, v28
M v[112:115], a[76:79], a[140:143], v[112:115]
 ds_read_b128 a[104:107], v2 offset:59392
 v_fma_f32 v88, v88, v5, v28
M v[112:115], a[80:83], a[144:147], v[112:115]
 ds_read_b128 a[108:111], v2 offset:60416
 v_fma_f32 v89, v89, v5, v28
M v[112:115], a[84:87], a[148:151], v[112:115]
 v_fma_f32 v90, v90, v5, v28
M v[112:115], a[88:91], a[152:155], v[112:115]
 ds_read_b128 a[112:115], v2 offset:61440
 v_fma_f32 v91, v91, v5, v28
M v[112:115], a[92:95], a[156:159], v[112:115]
 ds_read_b128 a[116:119], v2 offset:62464
 v_cvt_pk_bf16_f32 v80, v80, v81
M v[116:119], a[92:95], a[188:191], v[36:39]
 s_waitcnt vmcnt(6)
 v_readlane_b32 s84, v25, 0
 v_readlane_b32 s85, v25, 1
M v[116:119], a[88:91], a[184:187], v[116:119]
 ds_read_b128 a[120:123], v2 offset:63488
 v_mov_b32 v24, 0x3f80
M v[116:119], a[84:87], a[180:183], v[116:119]
 ds_read_b128 a[124:127], v2 offset:64512
 v_mov_b32 v25, 0x3f800000
M v[116:119], a[80:83], a[176:179], v[116:119]
 v_cvt_pk_bf16_f32 v81, v82, v83
 v_cvt_pk_bf16_f32 v82, v88, v89
M v[116:119], a[76:79], a[172:175], v[116:119]
 v_cvt_pk_bf16_f32 v83, v90, v91
M v[116:119], a[72:75], a[168:171], v[116:119]
 buffer_store_dwordx4 v[80:83], v7, s[8:11], s29 offen offset:1024 sc1
M v[116:119], a[68:71], a[164:167], v[116:119]
 s_waitcnt lgkmcnt(0)
 v_fma_f32 v84, v84, v6, v29
 v_fma_f32 v85, v85, v6, v29
M v[116:119], a[64:67], a[160:163], v[116:119]
 s_barrier
M v[120:123], a[96:99], a[128:131], v[32:35]
 ds_read_b128 a[64:67], v7 offset:32768
 v_fma_f32 v86, v86, v6, v29
M v[120:123], a[100:103], a[132:135], v[120:123]
 ds_read_b128 a[68:71], v7 offset:33792
 v_fma_f32 v87, v87, v6, v29
M v[120:123], a[104:107], a[136:139], v[120:123]
 v_fma_f32 v92, v92, v6, v29
 v_fma_f32 v93, v93, v6, v29
M v[120:123], a[108:111], a[140:143], v[120:123]
 ds_read_b128 a[72:75], v7 offset:34816
 v_fma_f32 v94, v94, v6, v29
M v[120:123], a[112:115], a[144:147], v[120:123]
 ds_read_b128 a[76:79], v7 offset:35840
 v_fma_f32 v95, v95, v6, v29
M v[120:123], a[116:119], a[148:151], v[120:123]
 s_waitcnt vmcnt(3)
 v_cvt_pk_bf16_f32 v84, v84, v85
 v_cvt_pk_bf16_f32 v85, v86, v87
M v[120:123], a[120:123], a[152:155], v[120:123]
 ds_read_b128 a[80:83], v7 offset:36864
 v_cvt_pk_bf16_f32 v86, v92, v93
M v[120:123], a[124:127], a[156:159], v[120:123]
 ds_read_b128 a[84:87], v7 offset:37888
 v_cvt_pk_bf16_f32 v87, v94, v95
M v[124:127], a[124:127], a[188:191], v[36:39]
 buffer_store_dword v40, v41, s[8:11], s45 offen sc1
M v[124:127], a[120:123], a[184:187], v[124:127]
 ds_read_b128 a[88:91], v7 offset:38912
M v[124:127], a[116:119], a[180:183], v[124:127]
 ds_read_b128 a[92:95], v7 offset:39936
M v[124:127], a[112:115], a[176:179], v[124:127]
 buffer_store_dwordx4 v[84:87], v7, s[8:11], s30 offen offset:1024 sc1
M v[124:127], a[108:111], a[172:175], v[124:127]
M v[124:127], a[104:107], a[168:171], v[124:127]
M v[124:127], a[100:103], a[164:167], v[124:127]
 s_waitcnt lgkmcnt(0)
M v[124:127], a[96:99], a[160:163], v[124:127]
M v[64:67], a[64:67], a[128:131], v[32:35]
 ds_read_b128 a[96:99], v7 offset:40960
M v[64:67], a[68:71], a[132:135], v[64:67]
 ds_read_b128 a[100:103], v7 offset:41984
M v[64:67], a[72:75], a[136:139], v[64:67]
M v[64:67], a[76:79], a[140:143], v[64:67]
 ds_read_b128 a[104:107], v7 offset:43008
 s_add_u32 s29, s33, 10240
M v[64:67], a[80:83], a[144:147], v[64:67]
 ds_read_b128 a[108:111], v7 offset:44032
 s_add_u32 s30, s33, 24576
M v[64:67], a[84:87], a[148:151], v[64:67]
 v_fma_f32 v96, v96, v5, v28
 v_fma_f32 v97, v97, v5, v28
M v[64:67], a[88:91], a[152:155], v[64:67]
 ds_read_b128 a[112:115], v7 offset:45056
 v_fma_f32 v98, v98, v5, v28
M v[64:67], a[92:95], a[156:159], v[64:67]
 ds_read_b128 a[116:119], v7 offset:46080
 v_fma_f32 v99, v99, v5, v28
M v[68:71], a[92:95], a[188:191], v[36:39]
 v_fma_f32 v104, v104, v5, v28
 v_fma_f32 v105, v105, v5, v28
M v[68:71], a[88:91], a[184:187], v[68:71]
 ds_read_b128 a[120:123], v7 offset:47104
 v_fma_f32 v106, v106, v5, v28
M v[68:71], a[84:87], a[180:183], v[68:71]
 ds_read_b128 a[124:127], v7 offset:48128
 v_fma_f32 v107, v107, v5, v28
M v[68:71], a[80:83], a[176:179], v[68:71]
 v_cvt_pk_bf16_f32 v96, v96, v97
 v_cvt_pk_bf16_f32 v97, v98, v99
M v[68:71], a[76:79], a[172:175], v[68:71]
 v_cvt_pk_bf16_f32 v98, v104, v105
 v_cvt_pk_bf16_f32 v99, v106, v107
M v[68:71], a[72:75], a[168:171], v[68:71]
 buffer_store_dwordx4 v[96:99], v7, s[8:11], s29 offen offset:0 sc1
M v[68:71], a[68:71], a[164:167], v[68:71]
 v_fma_f32 v100, v100, v6, v29
 v_fma_f32 v101, v101, v6, v29
M v[68:71], a[64:67], a[160:163], v[68:71]
 s_waitcnt lgkmcnt(0)
 v_fma_f32 v102, v102, v6, v29
 v_fma_f32 v103, v103, v6, v29
M v[72:75], a[96:99], a[128:131], v[32:35]
 ds_read_b128 a[64:67], v7 offset:49152
 v_fma_f32 v108, v108, v6, v29
M v[72:75], a[100:103], a[132:135], v[72:75]
 ds_read_b128 a[68:71], v7 offset:50176
 v_fma_f32 v109, v109, v6, v29
M v[72:75], a[104:107], a[136:139], v[72:75]
 v_fma_f32 v110, v110, v6, v29
 v_fma_f32 v111, v111, v6, v29
M v[72:75], a[108:111], a[140:143], v[72:75]
 ds_read_b128 a[72:75], v7 offset:51200
 v_cvt_pk_bf16_f32 v100, v100, v101
M v[72:75], a[112:115], a[144:147], v[72:75]
 ds_read_b128 a[76:79], v7 offset:52224
 v_cvt_pk_bf16_f32 v101, v102, v103
M v[72:75], a[116:119], a[148:151], v[72:75]
 v_cvt_pk_bf16_f32 v102, v108, v109
 v_cvt_pk_bf16_f32 v103, v110, v111
M v[72:75], a[120:123], a[152:155], v[72:75]
 ds_read_b128 a[80:83], v7 offset:53248
M v[72:75], a[124:127], a[156:159], v[72:75]
 ds_read_b128 a[84:87], v7 offset:54272
M v[76:79], a[124:127], a[188:191], v[36:39]
 buffer_store_dwordx4 v[100:103], v7, s[8:11], s30 offen offset:0 sc1
M v[76:79], a[120:123], a[184:187], v[76:79]
 ds_read_b128 a[88:91], v7 offset:55296
 v_fma_f32 v112, v112, v5, v28
M v[76:79], a[116:119], a[180:183], v[76:79]
 ds_read_b128 a[92:95], v7 offset:56320
 v_fma_f32 v113, v113, v5, v28
M v[76:79], a[112:115], a[176:179], v[76:79]
 v_fma_f32 v114, v114, v5, v28
 v_fma_f32 v115, v115, v5, v28
M v[76:79], a[108:111], a[172:175], v[76:79]
 v_fma_f32 v120, v120, v5, v28
 v_fma_f32 v121, v121, v5, v28
M v[76:79], a[104:107], a[168:171], v[76:79]
 v_fma_f32 v122, v122, v5, v28
 v_fma_f32 v123, v123, v5, v28
M v[76:79], a[100:103], a[164:167], v[76:79]
 v_cvt_pk_bf16_f32 v112, v112, v113
 v_cvt_pk_bf16_f32 v113, v114, v115
M v[76:79], a[96:99], a[160:163], v[76:79]
 s_waitcnt lgkmcnt(0)
 v_cvt_pk_bf16_f32 v114, v120, v121
 v_cvt_pk_bf16_f32 v115, v122, v123
M v[80:83], a[64:67], a[128:131], v[32:35]
 ds_read_b128 a[96:99], v7 offset:57344
M v[80:83], a[68:71], a[132:135], v[80:83]
 ds_read_b128 a[100:103], v7 offset:58368
M v[80:83], a[72:75], a[136:139], v[80:83]
 buffer_store_dwordx4 v[112:115], v7, s[8:11], s29 offen offset:1024 sc1
M v[80:83], a[76:79], a[140:143], v[80:83]
 ds_read_b128 a[104:107], v7 offset:59392
 v_fma_f32 v116, v116, v6, v29
M v[80:83], a[80:83], a[144:147], v[80:83]
 ds_read_b128 a[108:111], v7 offset:60416
 v_fma_f32 v117, v117, v6, v29
M v[80:83], a[84:87], a[148:151], v[80:83]
 v_fma_f32 v118, v118, v6, v29
 v_fma_f32 v119, v119, v6, v29
M v[80:83], a[88:91], a[152:155], v[80:83]
 ds_read_b128 a[112:115], v7 offset:61440
 v_fma_f32 v124, v124, v6, v29
M v[80:83], a[92:95], a[156:159], v[80:83]
 ds_read_b128 a[116:119], v7 offset:62464
 v_fma_f32 v125, v125, v6, v29
M v[84:87], a[92:95], a[188:191], v[36:39]
 v_fma_f32 v126, v126, v6, v29
 v_fma_f32 v127, v127, v6, v29
M v[84:87], a[88:91], a[184:187], v[84:87]
 ds_read_b128 a[120:123], v7 offset:63488
 v_cvt_pk_bf16_f32 v116, v116, v117
M v[84:87], a[84:87], a[180:183], v[84:87]
 ds_read_b128 a[124:127], v7 offset:64512
 v_cvt_pk_bf16_f32 v117, v118, v119
M v[84:87], a[80:83], a[176:179], v[84:87]
 v_cvt_pk_bf16_f32 v118, v124, v125
 v_cvt_pk_bf16_f32 v119, v126, v127
M v[84:87], a[76:79], a[172:175], v[84:87]
 buffer_store_dwordx4 v[116:119], v7, s[8:11], s30 offen offset:1024 sc1
M v[84:87], a[72:75], a[168:171], v[84:87]
 s_add_u32 s29, s33, 12288
M v[84:87], a[68:71], a[164:167], v[84:87]
 s_add_u32 s30, s33, 26624
 v_fma_f32 v64, v64, v5, v28
 v_fma_f32 v65, v65, v5, v28
M v[84:87], a[64:67], a[160:163], v[84:87]
 s_waitcnt lgkmcnt(0)
 v_fma_f32 v66, v66, v5, v28
 v_fma_f32 v67, v67, v5, v28
M v[88:91], a[96:99], a[128:131], v[32:35]
 v_fma_f32 v72, v72, v5, v28
 v_fma_f32 v73, v73, v5, v28
M v[88:91], a[100:103], a[132:135], v[88:91]
 v_fma_f32 v74, v74, v5, v28
 v_fma_f32 v75, v75, v5, v28
M v[88:91], a[104:107], a[136:139], v[88:91]
 v_cvt_pk_bf16_f32 v64, v64, v65
 v_cvt_pk_bf16_f32 v65, v66, v67
M v[88:91], a[108:111], a[140:143], v[88:91]
 v_cvt_pk_bf16_f32 v66, v72, v73
 v_cvt_pk_bf16_f32 v67, v74, v75
M v[88:91], a[112:115], a[144:147], v[88:91]
 buffer_store_dwordx4 v[64:67], v7, s[8:11], s29 offen offset:0 sc1
M v[88:91], a[116:119], a[148:151], v[88:91]
 v_fma_f32 v68, v68, v6, v29
 v_fma_f32 v69, v69, v6, v29
M v[88:91], a[120:123], a[152:155], v[88:91]
 v_fma_f32 v70, v70, v6, v29
 v_fma_f32 v71, v71, v6, v29
M v[88:91], a[124:127], a[156:159], v[88:91]
 v_fma_f32 v76, v76, v6, v29
 v_fma_f32 v77, v77, v6, v29
M v[92:95], a[124:127], a[188:191], v[36:39]
 v_fma_f32 v78, v78, v6, v29
 v_fma_f32 v79, v79, v6, v29
M v[92:95], a[120:123], a[184:187], v[92:95]
 v_cvt_pk_bf16_f32 v68, v68, v69
 v_cvt_pk_bf16_f32 v69, v70, v71
M v[92:95], a[116:119], a[180:183], v[92:95]
 v_cvt_pk_bf16_f32 v70, v76, v77
 v_cvt_pk_bf16_f32 v71, v78, v79
M v[92:95], a[112:115], a[176:179], v[92:95]
 buffer_store_dwordx4 v[68:71], v7, s[8:11], s30 offen offset:0 sc1
M v[92:95], a[108:111], a[172:175], v[92:95]
M v[92:95], a[104:107], a[168:171], v[92:95]
M v[92:95], a[100:103], a[164:167], v[92:95]
M v[92:95], a[96:99], a[160:163], v[92:95]
 v_fma_f32 v80, v80, v5, v28
 v_fma_f32 v81, v81, v5, v28
 v_fma_f32 v82, v82, v5, v28
 v_fma_f32 v83, v83, v5, v28
 v_fma_f32 v88, v88, v5, v28
 v_fma_f32 v89, v89, v5, v28
 v_fma_f32 v90, v90, v5, v28
 v_fma_f32 v91, v91, v5, v28
 v_cvt_pk_bf16_f32 v80, v80, v81
 v_cvt_pk_bf16_f32 v81, v82, v83
 v_cvt_pk_bf16_f32 v82, v88, v89
 v_cvt_pk_bf16_f32 v83, v90, v91
 buffer_store_dwordx4 v[80:83], v7, s[8:11], s29 offen offset:1024 sc1
 v_fma_f32 v84, v84, v6, v29
 v_fma_f32 v85, v85, v6, v29
 v_fma_f32 v86, v86, v6, v29
 v_fma_f32 v87, v87, v6, v29
 v_fma_f32 v92, v92, v6, v29
 v_fma_f32 v93, v93, v6, v29
 v_fma_f32 v94, v94, v6, v29
 v_fma_f32 v95, v95, v6, v29
 v_cvt_pk_bf16_f32 v84, v84, v85
 v_cvt_pk_bf16_f32 v85, v86, v87
 v_cvt_pk_bf16_f32 v86, v92, v93
 v_cvt_pk_bf16_f32 v87, v94, v95
 buffer_store_dwordx4 v[84:87], v7, s[8:11], s30 offen offset:1024 sc1
L_red:
 s_lshl_b32 s64, s42, 1
 s_lshr_b32 s65, s41, 3
 s_add_u32 s46, s64, s65
 s_mul_i32 s46, s46, 4352
 s_and_b32 s72, s41, 7
 s_lshl_b32 s66, s72, 7
 s_add_u32 s46, s46, s66
 s_add_u32 s46, s46, 104992768
 v_and_b32 v14, 31, v0
 v_lshlrev_b32 v14, 2, v14
 buffer_load_dword v9, v14, s[8:11], s46 offen sc1
 s_mul_i32 s86, s65, 4
 s_add_u32 s86, s86, s20
 s_mul_i32 s77, s42, 1835008
 s_mul_i32 s78, s72, 14336
 s_add_u32 s77, s77, s78
 s_add_u32 s77, s77, 67108864
 s_sub_u32 s64, 15, s64
 s_sub_u32 s78, s64, 1
 s_mul_i32 s78, s78, 1835008
 s_add_u32 s78, s78, s77
 s_lshl_b32 s66, s86, 10
 s_add_u32 s78, s78, s66
 s_lshl_b32 s66, s74, 10
 s_add_u32 s77, s77, s66
 s_lshl_b32 s66, s64, 7
 s_lshl_b32 s86, s86, 6
 s_lshr_b32 s73, s72, 1
 s_sub_u32 s65, 7, s73
 s_bitcmp1_b32 s72, 0
 s_cselect_b32 s73, s65, s73
 s_lshl_b32 s73, s73, 4
 s_lshl_b32 s65, s42, 7
 s_add_u32 s73, s73, s65
 v_and_b32 v10, 15, v0
 v_add_u32 v10, s73, v10
 v_add_u32 v29, s66, v10
 s_mov_b32 s64, 104857664
 v_mul_u32_u24 v12, 896, v10
 v_lshl_add_u32 v12, v11, 4, v12
 v_lshrrev_b32 v13, 4, v10
 v_lshlrev_b32 v13, 5, v13
 v_and_b32 v104, 15, v10
 v_add_lshl_u32 v13, v13, v104, 2
 buffer_load_dword v15, v13, s[8:11], s64 offen sc1
 buffer_load_dwordx4 v[16:19], v12, s[56:59], s75 offen
 buffer_load_dwordx4 v[20:23], v12, s[56:59], s76 offen
 v_mov_b32 v48, 0
 v_mov_b32 v49, 0
 v_mov_b32 v50, 0
 v_mov_b32 v51, 0
 v_mov_b32 v52, 0
 v_mov_b32 v53, 0
 v_mov_b32 v54, 0
 v_mov_b32 v55, 0
 v_mov_b32 v56, 0
 v_mov_b32 v57, 0
 v_mov_b32 v58, 0
 v_mov_b32 v59, 0
 v_mov_b32 v60, 0
 v_mov_b32 v61, 0
 v_mov_b32 v62, 0
 v_mov_b32 v63, 0
 v_mul_u32_u24 v28, 896, v29
 v_lshl_add_u32 v28, v11, 4, v28
 v_lshrrev_b32 v13, 4, v29
 v_lshlrev_b32 v13, 5, v13
 v_and_b32 v104, 15, v29
 v_add_lshl_u32 v13, v13, v104, 2
 buffer_load_dword v26, v13, s[8:11], s64 offen sc1
 buffer_load_dwordx4 v[96:99], v28, s[56:59], s86 offen
 v_mov_b32 v64, 0
 v_mov_b32 v65, 0
 v_mov_b32 v66, 0
 v_mov_b32 v67, 0
 v_mov_b32 v68, 0
 v_mov_b32 v69, 0
 v_mov_b32 v70, 0
 v_mov_b32 v71, 0
 s_waitcnt vmcnt(6)
 buffer_store_dword v40, v41, s[8:11], s3 offen sc1
 s_waitcnt vmcnt(6)
 v_cmp_eq_u32 vcc, 1, v9
 s_mov_b32 s91, 65536
 s_mov_b32 s69, 0
 s_mov_b32 s70, vcc_lo
 s_mov_b32 s68, vcc_lo
 s_cmp_lg_u32 s70, 0
 s_cbranch_scc1 L_rk0
 s_call_b64 s[36:37], L_rpoll
L_rk0:
 s_ff1_i32_b32 s71, s70
 s_bitset0_b32 s70, s71
 s_cmp_ge_u32 s71, 16
 s_cselect_b32 s72, s78, s77
 s_cselect_b32 s73, 0x1, 0
 s_cselect_b32 s87, 536870912, 0
 s_mul_i32 s71, s71, 114688
 s_add_u32 s71, s71, s72
 buffer_load_dwordx4 v[128:131], v7, s[8:11], s71 offen sc1
 s_or_b32 s69, s69, s73
 s_or_b32 s71, s71, s87
 buffer_load_dwordx4 v[132:135], v27, s[8:11], s71 offen sc1
 s_cmp_lg_u32 s70, 0
 s_cbranch_scc1 L_rk1
 s_call_b64 s[36:37], L_rpoll
L_rk1:
 s_ff1_i32_b32 s71, s70
 s_bitset0_b32 s70, s71
 s_cmp_ge_u32 s71, 16
 s_cselect_b32 s72, s78, s77
 s_cselect_b32 s73, 0x2, 0
 s_cselect_b32 s87, 536870912, 0
 s_mul_i32 s71, s71, 114688
 s_add_u32 s71, s71, s72
 buffer_load_dwordx4 v[136:139], v7, s[8:11], s71 offen sc1
 s_or_b32 s69, s69, s73
 s_or_b32 s71, s71, s87
 buffer_load_dwordx4 v[140:143], v27, s[8:11], s71 offen sc1
 s_waitcnt vmcnt(8)
 v_lshlrev_b32 v32, 16, v16
 v_and_b32 v33, 0xffff0000, v16
 v_lshlrev_b32 v34, 16, v17
 v_and_b32 v35, 0xffff0000, v17
 v_lshlrev_b32 v36, 16, v18
 v_and_b32 v37, 0xffff0000, v18
 v_lshlrev_b32 v38, 16, v19
 v_and_b32 v39, 0xffff0000, v19
 s_waitcnt vmcnt(7)
 v_lshlrev_b32 v40, 16, v20
 v_and_b32 v41, 0xffff0000, v20
 v_lshlrev_b32 v42, 16, v21
 v_and_b32 v43, 0xffff0000, v21
 v_lshlrev_b32 v44, 16, v22
 v_and_b32 v45, 0xffff0000, v22
 v_lshlrev_b32 v46, 16, v23
 v_and_b32 v47, 0xffff0000, v23
 v_sub_f32 v13, 1.0, v15
 v_cmp_eq_u32 s[80:81], s84, v10
 v_cmp_eq_u32 s[82:83], s85, v10
 s_nop 0
 s_or_b64 vcc, s[80:81], s[82:83]
 s_cbranch_vccnz L_moe0
L_moe_ret0:
 v_mul_f32 v32, v13, v32
 v_mul_f32 v33, v13, v33
 v_mul_f32 v34, v13, v34
 v_mul_f32 v35, v13, v35
 v_mul_f32 v36, v13, v36
 v_mul_f32 v37, v13, v37
 v_mul_f32 v38, v13, v38
 v_mul_f32 v39, v13, v39
 v_mul_f32 v40, v13, v40
 v_mul_f32 v41, v13, v41
 v_mul_f32 v42, v13, v42
 v_mul_f32 v43, v13, v43
 v_mul_f32 v44, v13, v44
 v_mul_f32 v45, v13, v45
 v_mul_f32 v46, v13, v46
 v_mul_f32 v47, v13, v47
 s_cmp_lg_u32 s70, 0
 s_cbranch_scc1 L_rk2
 s_call_b64 s[36:37], L_rpoll
L_rk2:
 s_ff1_i32_b32 s71, s70
 s_bitset0_b32 s70, s71
 s_cmp_ge_u32 s71, 16
 s_cselect_b32 s72, s78, s77
 s_cselect_b32 s73, 0x4, 0
 s_cselect_b32 s87, 536870912, 0
 s_mul_i32 s71, s71, 114688
 s_add_u32 s71, s71, s72
 buffer_load_dwordx4 v[144:147], v7, s[8:11], s71 offen sc1
 s_or_b32 s69, s69, s73
 s_or_b32 s71, s71, s87
 buffer_load_dwordx4 v[148:151], v27, s[8:11], s71 offen sc1
 s_waitcnt vmcnt(7)
 v_lshlrev_b32 v80, 16, v96
 v_and_b32 v81, 0xffff0000, v96
 v_lshlrev_b32 v82, 16, v97
 v_and_b32 v83, 0xffff0000, v97
 v_lshlrev_b32 v84, 16, v98
 v_and_b32 v85, 0xffff0000, v98
 v_lshlrev_b32 v86, 16, v99
 v_and_b32 v87, 0xffff0000, v99
 v_sub_f32 v13, 1.0, v26
 v_cmp_eq_u32 s[80:81], s84, v29
 v_cmp_eq_u32 s[82:83], s85, v29
 s_nop 0
 s_or_b64 vcc, s[80:81], s[82:83]
 s_cbranch_vccnz L_moe1
L_moe_ret1:
 v_mul_f32 v80, v13, v80
 v_mul_f32 v81, v13, v81
 v_mul_f32 v82, v13, v82
 v_mul_f32 v83, v13, v83
 v_mul_f32 v84, v13, v84
 v_mul_f32 v85, v13, v85
 v_mul_f32 v86, v13, v86
 v_mul_f32 v87, v13, v87
 s_cmp_lg_u32 s70, 0
 s_cbranch_scc1 L_rk3
 s_call_b64 s[36:37], L_rpoll
L_rk3:
 s_ff1_i32_b32 s71, s70
 s_bitset0_b32 s70, s71
 s_cmp_ge_u32 s71, 16
 s_cselect_b32 s72, s78, s77
 s_cselect_b32 s73, 0x8, 0
 s_cselect_b32 s87, 536870912, 0
 s_mul_i32 s71, s71, 114688
 s_add_u32 s71, s71, s72
 buffer_load_dwordx4 v[152:155], v7, s[8:11], s71 offen sc1
 s_or_b32 s69, s69, s73
 s_or_b32 s71, s71, s87
 buffer_load_dwordx4 v[156:159], v27, s[8:11], s71 offen sc1
 s_cmp_lg_u32 s70, 0
 s_cbranch_scc1 L_rk4
 s_call_b64 s[36:37], L_rpoll
L_rk4:
 s_ff1_i32_b32 s71, s70
 s_bitset0_b32 s70, s71
 s_cmp_ge_u32 s71, 16
 s_cselect_b32 s72, s78, s77
 s_cselect_b32 s73, 0x10, 0
 s_cselect_b32 s87, 536870912, 0
 s_mul_i32 s71, s71, 114688
 s_add_u32 s71, s71, s72
 buffer_load_dwordx4 v[160:163], v7, s[8:11], s71 offen sc1
 s_or_b32 s69, s69, s73
 s_or_b32 s71, s71, s87
 buffer_load_dwordx4 v[164:167], v27, s[8:11], s71 offen sc1
 s_cmp_lg_u32 s70, 0
 s_cbranch_scc1 L_rk5
 s_call_b64 s[36:37], L_rpoll
L_rk5:
 s_ff1_i32_b32 s71, s70
 s_bitset0_b32 s70, s71
 s_cmp_ge_u32 s71, 16
 s_cselect_b32 s72, s78, s77
 s_cselect_b32 s73, 0x20, 0
 s_cselect_b32 s87, 536870912, 0
 s_mul_i32 s71, s71, 114688
 s_add_u32 s71, s71, s72
 buffer_load_dwordx4 v[168:171], v7, s[8:11], s71 offen sc1
 s_or_b32 s69, s69, s73
 s_or_b32 s71, s71, s87
 buffer_load_dwordx4 v[172:175], v27, s[8:11], s71 offen sc1
 s_cmp_lg_u32 s70, 0
 s_cbranch_scc1 L_rk6
 s_call_b64 s[36:37], L_rpoll
L_rk6:
 s_ff1_i32_b32 s71, s70
 s_bitset0_b32 s70, s71
 s_cmp_ge_u32 s71, 16
 s_cselect_b32 s72, s78, s77
 s_cselect_b32 s73, 0x40, 0
 s_cselect_b32 s87, 536870912, 0
 s_mul_i32 s71, s71, 114688
 s_add_u32 s71, s71, s72
 buffer_load_dwordx4 v[176:179], v7, s[8:11], s71 offen sc1
 s_or_b32 s69, s69, s73
 s_or_b32 s71, s71, s87
 buffer_load_dwordx4 v[180:183], v27, s[8:11], s71 offen sc1
 s_cmp_lg_u32 s70, 0
 s_cbranch_scc1 L_rk7
 s_call_b64 s[36:37], L_rpoll
L_rk7:
 s_ff1_i32_b32 s71, s70
 s_bitset0_b32 s70, s71
 s_cmp_ge_u32 s71, 16
 s_cselect_b32 s72, s78, s77
 s_cselect_b32 s73, 0x80, 0
 s_cselect_b32 s87, 536870912, 0
 s_mul_i32 s71, s71, 114688
 s_add_u32 s71, s71, s72
 buffer_load_dwordx4 v[184:187], v7, s[8:11], s71 offen sc1
 s_or_b32 s69, s69, s73
 s_or_b32 s71, s71, s87
 buffer_load_dwordx4 v[188:191], v27, s[8:11], s71 offen sc1
 s_cmp_lg_u32 s70, 0
 s_cbranch_scc1 L_rk8
 s_call_b64 s[36:37], L_rpoll
L_rk8:
 s_ff1_i32_b32 s71, s70
 s_bitset0_b32 s70, s71
 s_cmp_ge_u32 s71, 16
 s_cselect_b32 s72, s78, s77
 s_cselect_b32 s73, 0x100, 0
 s_cselect_b32 s87, 536870912, 0
 s_mul_i32 s71, s71, 114688
 s_add_u32 s71, s71, s72
 buffer_load_dwordx4 v[192:195], v7, s[8:11], s71 offen sc1
 s_or_b32 s69, s69, s73
 s_or_b32 s71, s71, s87
 buffer_load_dwordx4 v[196:199], v27, s[8:11], s71 offen sc1
 s_waitcnt vmcnt(16)
 s_bitcmp1_b32 s69, 0
 s_cbranch_scc1 L_rx0
 v_dot2c_f32_bf16 v48, v128, v24
 v_dot2c_f32_bf16 v49, v128, v25
 v_dot2c_f32_bf16 v50, v129, v24
 v_dot2c_f32_bf16 v51, v129, v25
 v_dot2c_f32_bf16 v52, v130, v24
 v_dot2c_f32_bf16 v53, v130, v25
 v_dot2c_f32_bf16 v54, v131, v24
 v_dot2c_f32_bf16 v55, v131, v25
 v_dot2c_f32_bf16 v56, v132, v24
 v_dot2c_f32_bf16 v57, v132, v25
 v_dot2c_f32_bf16 v58, v133, v24
 v_dot2c_f32_bf16 v59, v133, v25
 v_dot2c_f32_bf16 v60, v134, v24
 v_dot2c_f32_bf16 v61, v134, v25
 v_dot2c_f32_bf16 v62, v135, v24
 v_dot2c_f32_bf16 v63, v135, v25
L_ry0:
 s_cmp_lg_u32 s70, 0
 s_cbranch_scc1 L_rk9
 s_call_b64 s[36:37], L_rpoll
L_rk9:
 s_ff1_i32_b32 s71, s70
 s_bitset0_b32 s70, s71
 s_cmp_ge_u32 s71, 16
 s_cselect_b32 s72, s78, s77
 s_cselect_b32 s73, 0x200, 0
 s_cselect_b32 s87, 536870912, 0
 s_mul_i32 s71, s71, 114688
 s_add_u32 s71, s71, s72
 buffer_load_dwordx4 v[200:203], v7, s[8:11], s71 offen sc1
 s_or_b32 s69, s69, s73
 s_or_b32 s71, s71, s87
 buffer_load_dwordx4 v[204:207], v27, s[8:11], s71 offen sc1
 s_waitcnt vmcnt(16)
 s_bitcmp1_b32 s69, 1
 s_cbranch_scc1 L_rx1
 v_dot2c_f32_bf16 v48, v136, v24
 v_dot2c_f32_bf16 v49, v136, v25
 v_dot2c_f32_bf16 v50, v137, v24
 v_dot2c_f32_bf16 v51, v137, v25
 v_dot2c_f32_bf16 v52, v138, v24
 v_dot2c_f32_bf16 v53, v138, v25
 v_dot2c_f32_bf16 v54, v139, v24
 v_dot2c_f32_bf16 v55, v139, v25
 v_dot2c_f32_bf16 v56, v140, v24
 v_dot2c_f32_bf16 v57, v140, v25
 v_dot2c_f32_bf16 v58, v141, v24
 v_dot2c_f32_bf16 v59, v141, v25
 v_dot2c_f32_bf16 v60, v142, v24
 v_dot2c_f32_bf16 v61, v142, v25
 v_dot2c_f32_bf16 v62, v143, v24
 v_dot2c_f32_bf16 v63, v143, v25
L_ry1:
 s_cmp_lg_u32 s70, 0
 s_cbranch_scc1 L_rk10
 s_call_b64 s[36:37], L_rpoll
L_rk10:
 s_ff1_i32_b32 s71, s70
 s_bitset0_b32 s70, s71
 s_cmp_ge_u32 s71, 16
 s_cselect_b32 s72, s78, s77
 s_cselect_b32 s73, 0x400, 0
 s_cselect_b32 s87, 536870912, 0
 s_mul_i32 s71, s71, 114688
 s_add_u32 s71, s71, s72
 buffer_load_dwordx4 v[208:211], v7, s[8:11], s71 offen sc1
 s_or_b32 s69, s69, s73
 s_or_b32 s71, s71, s87
 buffer_load_dwordx4 v[212:215], v27, s[8:11], s71 offen sc1
 s_waitcnt vmcnt(16)
 s_bitcmp1_b32 s69, 2
 s_cbranch_scc1 L_rx2
 v_dot2c_f32_bf16 v48, v144, v24
 v_dot2c_f32_bf16 v49, v144, v25
 v_dot2c_f32_bf16 v50, v145, v24
 v_dot2c_f32_bf16 v51, v145, v25
 v_dot2c_f32_bf16 v52, v146, v24
 v_dot2c_f32_bf16 v53, v146, v25
 v_dot2c_f32_bf16 v54, v147, v24
 v_dot2c_f32_bf16 v55, v147, v25
 v_dot2c_f32_bf16 v56, v148, v24
 v_dot2c_f32_bf16 v57, v148, v25
 v_dot2c_f32_bf16 v58, v149, v24
 v_dot2c_f32_bf16 v59, v149, v25
 v_dot2c_f32_bf16 v60, v150, v24
 v_dot2c_f32_bf16 v61, v150, v25
 v_dot2c_f32_bf16 v62, v151, v24
 v_dot2c_f32_bf16 v63, v151, v25
L_ry2:
 s_cmp_lg_u32 s70, 0
 s_cbranch_scc1 L_rk11
 s_call_b64 s[36:37], L_rpoll
L_rk11:
 s_ff1_i32_b32 s71, s70
 s_bitset0_b32 s70, s71
 s_cmp_ge_u32 s71, 16
 s_cselect_b32 s72, s78, s77
 s_cselect_b32 s73, 0x800, 0
 s_cselect_b32 s87, 536870912, 0
 s_mul_i32 s71, s71, 114688
 s_add_u32 s71, s71, s72
 buffer_load_dwordx4 v[216:219], v7, s[8:11], s71 offen sc1
 s_or_b32 s69, s69, s73
 s_or_b32 s71, s71, s87
 buffer_load_dwordx4 v[220:223], v27, s[8:11], s71 offen sc1
 s_waitcnt vmcnt(16)
 s_bitcmp1_b32 s69, 3
 s_cbranch_scc1 L_rx3
 v_dot2c_f32_bf16 v48, v152, v24
 v_dot2c_f32_bf16 v49, v152, v25
 v_dot2c_f32_bf16 v50, v153, v24
 v_dot2c_f32_bf16 v51, v153, v25
 v_dot2c_f32_bf16 v52, v154, v24
 v_dot2c_f32_bf16 v53, v154, v25
 v_dot2c_f32_bf16 v54, v155, v24
 v_dot2c_f32_bf16 v55, v155, v25
 v_dot2c_f32_bf16 v56, v156, v24
 v_dot2c_f32_bf16 v57, v156, v25
 v_dot2c_f32_bf16 v58, v157, v24
 v_dot2c_f32_bf16 v59, v157, v25
 v_dot2c_f32_bf16 v60, v158, v24
 v_dot2c_f32_bf16 v61, v158, v25
 v_dot2c_f32_bf16 v62, v159, v24
 v_dot2c_f32_bf16 v63, v159, v25
L_ry3:
 s_cmp_lg_u32 s70, 0
 s_cbranch_scc1 L_rk12
 s_call_b64 s[36:37], L_rpoll
L_rk12:
 s_ff1_i32_b32 s71, s70
 s_bitset0_b32 s70, s71
 s_cmp_ge_u32 s71, 16
 s_cselect_b32 s72, s78, s77
 s_cselect_b32 s73, 0x1000, 0
 s_cselect_b32 s87, 536870912, 0
 s_mul_i32 s71, s71, 114688
 s_add_u32 s71, s71, s72
 buffer_load_dwordx4 v[224:227], v7, s[8:11], s71 offen sc1
 s_or_b32 s69, s69, s73
 s_or_b32 s71, s71, s87
 buffer_load_dwordx4 v[228:231], v27, s[8:11], s71 offen sc1
 s_waitcnt vmcnt(16)
 s_bitcmp1_b32 s69, 4
 s_cbranch_scc1 L_rx4
 v_dot2c_f32_bf16 v48, v160, v24
 v_dot2c_f32_bf16 v49, v160, v25
 v_dot2c_f32_bf16 v50, v161, v24
 v_dot2c_f32_bf16 v51, v161, v25
 v_dot2c_f32_bf16 v52, v162, v24
 v_dot2c_f32_bf16 v53, v162, v25
 v_dot2c_f32_bf16 v54, v163, v24
 v_dot2c_f32_bf16 v55, v163, v25
 v_dot2c_f32_bf16 v56, v164, v24
 v_dot2c_f32_bf16 v57, v164, v25
 v_dot2c_f32_bf16 v58, v165, v24
 v_dot2c_f32_bf16 v59, v165, v25
 v_dot2c_f32_bf16 v60, v166, v24
 v_dot2c_f32_bf16 v61, v166, v25
 v_dot2c_f32_bf16 v62, v167, v24
 v_dot2c_f32_bf16 v63, v167, v25
L_ry4:
 s_cmp_lg_u32 s70, 0
 s_cbranch_scc1 L_rk13
 s_call_b64 s[36:37], L_rpoll
L_rk13:
 s_ff1_i32_b32 s71, s70
 s_bitset0_b32 s70, s71
 s_cmp_ge_u32 s71, 16
 s_cselect_b32 s72, s78, s77
 s_cselect_b32 s73, 0x2000, 0
 s_cselect_b32 s87, 536870912, 0
 s_mul_i32 s71, s71, 114688
 s_add_u32 s71, s71, s72
 buffer_load_dwordx4 v[232:235], v7, s[8:11], s71 offen sc1
 s_or_b32 s69, s69, s73
 s_or_b32 s71, s71, s87
 buffer_load_dwordx4 v[236:239], v27, s[8:11], s71 offen sc1
 s_waitcnt vmcnt(16)
 s_bitcmp1_b32 s69, 5
 s_cbranch_scc1 L_rx5
 v_dot2c_f32_bf16 v48, v168, v24
 v_dot2c_f32_bf16 v49, v168, v25
 v_dot2c_f32_bf16 v50, v169, v24
 v_dot2c_f32_bf16 v51, v169, v25
 v_dot2c_f32_bf16 v52, v170, v24
 v_dot2c_f32_bf16 v53, v170, v25
 v_dot2c_f32_bf16 v54, v171, v24
 v_dot2c_f32_bf16 v55, v171, v25
 v_dot2c_f32_bf16 v56, v172, v24
 v_dot2c_f32_bf16 v57, v172, v25
 v_dot2c_f32_bf16 v58, v173, v24
 v_dot2c_f32_bf16 v59, v173, v25
 v_dot2c_f32_bf16 v60, v174, v24
 v_dot2c_f32_bf16 v61, v174, v25
 v_dot2c_f32_bf16 v62, v175, v24
 v_dot2c_f32_bf16 v63, v175, v25
L_ry5:
 s_cmp_lg_u32 s70, 0
 s_cbranch_scc1 L_rk14
 s_call_b64 s[36:37], L_rpoll
L_rk14:
 s_ff1_i32_b32 s71, s70
 s_bitset0_b32 s70, s71
 s_cmp_ge_u32 s71, 16
 s_cselect_b32 s72, s78, s77
 s_cselect_b32 s73, 0x4000, 0
 s_cselect_b32 s87, 536870912, 0
 s_mul_i32 s71, s71, 114688
 s_add_u32 s71, s71, s72
 buffer_load_dwordx4 v[240:243], v7, s[8:11], s71 offen sc1
 s_or_b32 s69, s69, s73
 s_or_b32 s71, s71, s87
 buffer_load_dwordx4 v[244:247], v27, s[8:11], s71 offen sc1
 s_waitcnt vmcnt(16)
 s_bitcmp1_b32 s69, 6
 s_cbranch_scc1 L_rx6
 v_dot2c_f32_bf16 v48, v176, v24
 v_dot2c_f32_bf16 v49, v176, v25
 v_dot2c_f32_bf16 v50, v177, v24
 v_dot2c_f32_bf16 v51, v177, v25
 v_dot2c_f32_bf16 v52, v178, v24
 v_dot2c_f32_bf16 v53, v178, v25
 v_dot2c_f32_bf16 v54, v179, v24
 v_dot2c_f32_bf16 v55, v179, v25
 v_dot2c_f32_bf16 v56, v180, v24
 v_dot2c_f32_bf16 v57, v180, v25
 v_dot2c_f32_bf16 v58, v181, v24
 v_dot2c_f32_bf16 v59, v181, v25
 v_dot2c_f32_bf16 v60, v182, v24
 v_dot2c_f32_bf16 v61, v182, v25
 v_dot2c_f32_bf16 v62, v183, v24
 v_dot2c_f32_bf16 v63, v183, v25
L_ry6:
 s_cmp_lg_u32 s70, 0
 s_cbranch_scc1 L_rk15
 s_call_b64 s[36:37], L_rpoll
L_rk15:
 s_ff1_i32_b32 s71, s70
 s_bitset0_b32 s70, s71
 s_cmp_ge_u32 s71, 16
 s_cselect_b32 s72, s78, s77
 s_cselect_b32 s73, 0x8000, 0
 s_cselect_b32 s87, 536870912, 0
 s_mul_i32 s71, s71, 114688
 s_add_u32 s71, s71, s72
 buffer_load_dwordx4 v[248:251], v7, s[8:11], s71 offen sc1
 s_or_b32 s69, s69, s73
 s_or_b32 s71, s71, s87
 buffer_load_dwordx4 v[252:255], v27, s[8:11], s71 offen sc1
 s_waitcnt vmcnt(16)
 s_bitcmp1_b32 s69, 7
 s_cbranch_scc1 L_rx7
 v_dot2c_f32_bf16 v48, v184, v24
 v_dot2c_f32_bf16 v49, v184, v25
 v_dot2c_f32_bf16 v50, v185, v24
 v_dot2c_f32_bf16 v51, v185, v25
 v_dot2c_f32_bf16 v52, v186, v24
 v_dot2c_f32_bf16 v53, v186, v25
 v_dot2c_f32_bf16 v54, v187, v24
 v_dot2c_f32_bf16 v55, v187, v25
 v_dot2c_f32_bf16 v56, v188, v24
 v_dot2c_f32_bf16 v57, v188, v25
 v_dot2c_f32_bf16 v58, v189, v24
 v_dot2c_f32_bf16 v59, v189, v25
 v_dot2c_f32_bf16 v60, v190, v24
 v_dot2c_f32_bf16 v61, v190, v25
 v_dot2c_f32_bf16 v62, v191, v24
 v_dot2c_f32_bf16 v63, v191, v25
L_ry7:
 s_cmp_lg_u32 s70, 0
 s_cbranch_scc1 L_rk16
 s_call_b64 s[36:37], L_rpoll
L_rk16:
 s_ff1_i32_b32 s71, s70
 s_bitset0_b32 s70, s71
 s_cmp_ge_u32 s71, 16
 s_cselect_b32 s72, s78, s77
 s_cselect_b32 s73, 0x10000, 0
 s_cselect_b32 s87, 536870912, 0
 s_mul_i32 s71, s71, 114688
 s_add_u32 s71, s71, s72
 buffer_load_dwordx4 v[128:131], v7, s[8:11], s71 offen sc1
 s_or_b32 s69, s69, s73
 s_or_b32 s71, s71, s87
 buffer_load_dwordx4 v[132:135], v27, s[8:11], s71 offen sc1
 s_waitcnt vmcnt(16)
 s_bitcmp1_b32 s69, 8
 s_cbranch_scc1 L_rx8
 v_dot2c_f32_bf16 v48, v192, v24
 v_dot2c_f32_bf16 v49, v192, v25
 v_dot2c_f32_bf16 v50, v193, v24
 v_dot2c_f32_bf16 v51, v193, v25
 v_dot2c_f32_bf16 v52, v194, v24
 v_dot2c_f32_bf16 v53, v194, v25
 v_dot2c_f32_bf16 v54, v195, v24
 v_dot2c_f32_bf16 v55, v195, v25
 v_dot2c_f32_bf16 v56, v196, v24
 v_dot2c_f32_bf16 v57, v196, v25
 v_dot2c_f32_bf16 v58, v197, v24
 v_dot2c_f32_bf16 v59, v197, v25
 v_dot2c_f32_bf16 v60, v198, v24
 v_dot2c_f32_bf16 v61, v198, v25
 v_dot2c_f32_bf16 v62, v199, v24
 v_dot2c_f32_bf16 v63, v199, v25
L_ry8:
 s_cmp_lg_u32 s70, 0
 s_cbranch_scc1 L_rk17
 s_call_b64 s[36:37], L_rpoll
L_rk17:
 s_ff1_i32_b32 s71, s70
 s_bitset0_b32 s70, s71
 s_cmp_ge_u32 s71, 16
 s_cselect_b32 s72, s78, s77
 s_cselect_b32 s73, 0x20000, 0
 s_cselect_b32 s87, 536870912, 0
 s_mul_i32 s71, s71, 114688
 s_add_u32 s71, s71, s72
 buffer_load_dwordx4 v[136:139], v7, s[8:11], s71 offen sc1
 s_or_b32 s69, s69, s73
 s_or_b32 s71, s71, s87
 buffer_load_dwordx4 v[140:143], v27, s[8:11], s71 offen sc1
 s_waitcnt vmcnt(16)
 s_bitcmp1_b32 s69, 9
 s_cbranch_scc1 L_rx9
 v_dot2c_f32_bf16 v48, v200, v24
 v_dot2c_f32_bf16 v49, v200, v25
 v_dot2c_f32_bf16 v50, v201, v24
 v_dot2c_f32_bf16 v51, v201, v25
 v_dot2c_f32_bf16 v52, v202, v24
 v_dot2c_f32_bf16 v53, v202, v25
 v_dot2c_f32_bf16 v54, v203, v24
 v_dot2c_f32_bf16 v55, v203, v25
 v_dot2c_f32_bf16 v56, v204, v24
 v_dot2c_f32_bf16 v57, v204, v25
 v_dot2c_f32_bf16 v58, v205, v24
 v_dot2c_f32_bf16 v59, v205, v25
 v_dot2c_f32_bf16 v60, v206, v24
 v_dot2c_f32_bf16 v61, v206, v25
 v_dot2c_f32_bf16 v62, v207, v24
 v_dot2c_f32_bf16 v63, v207, v25
L_ry9:
 s_cmp_lg_u32 s70, 0
 s_cbranch_scc1 L_rk18
 s_call_b64 s[36:37], L_rpoll
L_rk18:
 s_ff1_i32_b32 s71, s70
 s_bitset0_b32 s70, s71
 s_cmp_ge_u32 s71, 16
 s_cselect_b32 s72, s78, s77
 s_cselect_b32 s73, 0x40000, 0
 s_cselect_b32 s87, 536870912, 0
 s_mul_i32 s71, s71, 114688
 s_add_u32 s71, s71, s72
 buffer_load_dwordx4 v[144:147], v7, s[8:11], s71 offen sc1
 s_or_b32 s69, s69, s73
 s_or_b32 s71, s71, s87
 buffer_load_dwordx4 v[148:151], v27, s[8:11], s71 offen sc1
 s_waitcnt vmcnt(16)
 s_bitcmp1_b32 s69, 10
 s_cbranch_scc1 L_rx10
 v_dot2c_f32_bf16 v48, v208, v24
 v_dot2c_f32_bf16 v49, v208, v25
 v_dot2c_f32_bf16 v50, v209, v24
 v_dot2c_f32_bf16 v51, v209, v25
 v_dot2c_f32_bf16 v52, v210, v24
 v_dot2c_f32_bf16 v53, v210, v25
 v_dot2c_f32_bf16 v54, v211, v24
 v_dot2c_f32_bf16 v55, v211, v25
 v_dot2c_f32_bf16 v56, v212, v24
 v_dot2c_f32_bf16 v57, v212, v25
 v_dot2c_f32_bf16 v58, v213, v24
 v_dot2c_f32_bf16 v59, v213, v25
 v_dot2c_f32_bf16 v60, v214, v24
 v_dot2c_f32_bf16 v61, v214, v25
 v_dot2c_f32_bf16 v62, v215, v24
 v_dot2c_f32_bf16 v63, v215, v25
L_ry10:
 s_cmp_lg_u32 s70, 0
 s_cbranch_scc1 L_rk19
 s_call_b64 s[36:37], L_rpoll
L_rk19:
 s_ff1_i32_b32 s71, s70
 s_bitset0_b32 s70, s71
 s_cmp_ge_u32 s71, 16
 s_cselect_b32 s72, s78, s77
 s_cselect_b32 s73, 0x80000, 0
 s_cselect_b32 s87, 536870912, 0
 s_mul_i32 s71, s71, 114688
 s_add_u32 s71, s71, s72
 buffer_load_dwordx4 v[152:155], v7, s[8:11], s71 offen sc1
 s_or_b32 s69, s69, s73
 s_or_b32 s71, s71, s87
 buffer_load_dwordx4 v[156:159], v27, s[8:11], s71 offen sc1
 s_waitcnt vmcnt(16)
 s_bitcmp1_b32 s69, 11
 s_cbranch_scc1 L_rx11
 v_dot2c_f32_bf16 v48, v216, v24
 v_dot2c_f32_bf16 v49, v216, v25
 v_dot2c_f32_bf16 v50, v217, v24
 v_dot2c_f32_bf16 v51, v217, v25
 v_dot2c_f32_bf16 v52, v218, v24
 v_dot2c_f32_bf16 v53, v218, v25
 v_dot2c_f32_bf16 v54, v219, v24
 v_dot2c_f32_bf16 v55, v219, v25
 v_dot2c_f32_bf16 v56, v220, v24
 v_dot2c_f32_bf16 v57, v220, v25
 v_dot2c_f32_bf16 v58, v221, v24
 v_dot2c_f32_bf16 v59, v221, v25
 v_dot2c_f32_bf16 v60, v222, v24
 v_dot2c_f32_bf16 v61, v222, v25
 v_dot2c_f32_bf16 v62, v223, v24
 v_dot2c_f32_bf16 v63, v223, v25
L_ry11:
 s_cmp_lg_u32 s70, 0
 s_cbranch_scc1 L_rk20
 s_call_b64 s[36:37], L_rpoll
L_rk20:
 s_ff1_i32_b32 s71, s70
 s_bitset0_b32 s70, s71
 s_cmp_ge_u32 s71, 16
 s_cselect_b32 s72, s78, s77
 s_cselect_b32 s73, 0x100000, 0
 s_cselect_b32 s87, 536870912, 0
 s_mul_i32 s71, s71, 114688
 s_add_u32 s71, s71, s72
 buffer_load_dwordx4 v[160:163], v7, s[8:11], s71 offen sc1
 s_or_b32 s69, s69, s73
 s_or_b32 s71, s71, s87
 buffer_load_dwordx4 v[164:167], v27, s[8:11], s71 offen sc1
 s_waitcnt vmcnt(16)
 s_bitcmp1_b32 s69, 12
 s_cbranch_scc1 L_rx12
 v_dot2c_f32_bf16 v48, v224, v24
 v_dot2c_f32_bf16 v49, v224, v25
 v_dot2c_f32_bf16 v50, v225, v24
 v_dot2c_f32_bf16 v51, v225, v25
 v_dot2c_f32_bf16 v52, v226, v24
 v_dot2c_f32_bf16 v53, v226, v25
 v_dot2c_f32_bf16 v54, v227, v24
 v_dot2c_f32_bf16 v55, v227, v25
 v_dot2c_f32_bf16 v56, v228, v24
 v_dot2c_f32_bf16 v57, v228, v25
 v_dot2c_f32_bf16 v58, v229, v24
 v_dot2c_f32_bf16 v59, v229, v25
 v_dot2c_f32_bf16 v60, v230, v24
 v_dot2c_f32_bf16 v61, v230, v25
 v_dot2c_f32_bf16 v62, v231, v24
 v_dot2c_f32_bf16 v63, v231, v25
L_ry12:
 s_cmp_lg_u32 s70, 0
 s_cbranch_scc1 L_rk21
 s_call_b64 s[36:37], L_rpoll
L_rk21:
 s_ff1_i32_b32 s71, s70
 s_bitset0_b32 s70, s71
 s_cmp_ge_u32 s71, 16
 s_cselect_b32 s72, s78, s77
 s_cselect_b32 s73, 0x200000, 0
 s_cselect_b32 s87, 536870912, 0
 s_mul_i32 s71, s71, 114688
 s_add_u32 s71, s71, s72
 buffer_load_dwordx4 v[168:171], v7, s[8:11], s71 offen sc1
 s_or_b32 s69, s69, s73
 s_or_b32 s71, s71, s87
 buffer_load_dwordx4 v[172:175], v27, s[8:11], s71 offen sc1
 s_waitcnt vmcnt(16)
 s_bitcmp1_b32 s69, 13
 s_cbranch_scc1 L_rx13
 v_dot2c_f32_bf16 v48, v232, v24
 v_dot2c_f32_bf16 v49, v232, v25
 v_dot2c_f32_bf16 v50, v233, v24
 v_dot2c_f32_bf16 v51, v233, v25
 v_dot2c_f32_bf16 v52, v234, v24
 v_dot2c_f32_bf16 v53, v234, v25
 v_dot2c_f32_bf16 v54, v235, v24
 v_dot2c_f32_bf16 v55, v235, v25
 v_dot2c_f32_bf16 v56, v236, v24
 v_dot2c_f32_bf16 v57, v236, v25
 v_dot2c_f32_bf16 v58, v237, v24
 v_dot2c_f32_bf16 v59, v237, v25
 v_dot2c_f32_bf16 v60, v238, v24
 v_dot2c_f32_bf16 v61, v238, v25
 v_dot2c_f32_bf16 v62, v239, v24
 v_dot2c_f32_bf16 v63, v239, v25
L_ry13:
 s_cmp_lg_u32 s70, 0
 s_cbranch_scc1 L_rk22
 s_call_b64 s[36:37], L_rpoll
L_rk22:
 s_ff1_i32_b32 s71, s70
 s_bitset0_b32 s70, s71
 s_cmp_ge_u32 s71, 16
 s_cselect_b32 s72, s78, s77
 s_cselect_b32 s73, 0x400000, 0
 s_cselect_b32 s87, 536870912, 0
 s_mul_i32 s71, s71, 114688
 s_add_u32 s71, s71, s72
 buffer_load_dwordx4 v[176:179], v7, s[8:11], s71 offen sc1
 s_or_b32 s69, s69, s73
 s_or_b32 s71, s71, s87
 buffer_load_dwordx4 v[180:183], v27, s[8:11], s71 offen sc1
 s_waitcnt vmcnt(16)
 s_bitcmp1_b32 s69, 14
 s_cbranch_scc1 L_rx14
 v_dot2c_f32_bf16 v48, v240, v24
 v_dot2c_f32_bf16 v49, v240, v25
 v_dot2c_f32_bf16 v50, v241, v24
 v_dot2c_f32_bf16 v51, v241, v25
 v_dot2c_f32_bf16 v52, v242, v24
 v_dot2c_f32_bf16 v53, v242, v25
 v_dot2c_f32_bf16 v54, v243, v24
 v_dot2c_f32_bf16 v55, v243, v25
 v_dot2c_f32_bf16 v56, v244, v24
 v_dot2c_f32_bf16 v57, v244, v25
 v_dot2c_f32_bf16 v58, v245, v24
 v_dot2c_f32_bf16 v59, v245, v25
 v_dot2c_f32_bf16 v60, v246, v24
 v_dot2c_f32_bf16 v61, v246, v25
 v_dot2c_f32_bf16 v62, v247, v24
 v_dot2c_f32_bf16 v63, v247, v25
L_ry14:
 s_cmp_lg_u32 s70, 0
 s_cbranch_scc1 L_rk23
 s_call_b64 s[36:37], L_rpoll
L_rk23:
 s_ff1_i32_b32 s71, s70
 s_bitset0_b32 s70, s71
 s_cmp_ge_u32 s71, 16
 s_cselect_b32 s72, s78, s77
 s_cselect_b32 s73, 0x800000, 0
 s_cselect_b32 s87, 536870912, 0
 s_mul_i32 s71, s71, 114688
 s_add_u32 s71, s71, s72
 buffer_load_dwordx4 v[184:187], v7, s[8:11], s71 offen sc1
 s_or_b32 s69, s69, s73
 s_or_b32 s71, s71, s87
 buffer_load_dwordx4 v[188:191], v27, s[8:11], s71 offen sc1
 s_waitcnt vmcnt(16)
 s_bitcmp1_b32 s69, 15
 s_cbranch_scc1 L_rx15
 v_dot2c_f32_bf16 v48, v248, v24
 v_dot2c_f32_bf16 v49, v248, v25
 v_dot2c_f32_bf16 v50, v249, v24
 v_dot2c_f32_bf16 v51, v249, v25
 v_dot2c_f32_bf16 v52, v250, v24
 v_dot2c_f32_bf16 v53, v250, v25
 v_dot2c_f32_bf16 v54, v251, v24
 v_dot2c_f32_bf16 v55, v251, v25
 v_dot2c_f32_bf16 v56, v252, v24
 v_dot2c_f32_bf16 v57, v252, v25
 v_dot2c_f32_bf16 v58, v253, v24
 v_dot2c_f32_bf16 v59, v253, v25
 v_dot2c_f32_bf16 v60, v254, v24
 v_dot2c_f32_bf16 v61, v254, v25
 v_dot2c_f32_bf16 v62, v255, v24
 v_dot2c_f32_bf16 v63, v255, v25
L_ry15:
 s_cmp_lg_u32 s70, 0
 s_cbranch_scc1 L_rk24
 s_call_b64 s[36:37], L_rpoll
L_rk24:
 s_ff1_i32_b32 s71, s70
 s_bitset0_b32 s70, s71
 s_cmp_ge_u32 s71, 16
 s_cselect_b32 s72, s78, s77
 s_cselect_b32 s73, 0x1000000, 0
 s_cselect_b32 s87, 536870912, 0
 s_mul_i32 s71, s71, 114688
 s_add_u32 s71, s71, s72
 buffer_load_dwordx4 v[192:195], v7, s[8:11], s71 offen sc1
 s_or_b32 s69, s69, s73
 s_or_b32 s71, s71, s87
 buffer_load_dwordx4 v[196:199], v27, s[8:11], s71 offen sc1
 s_waitcnt vmcnt(16)
 s_bitcmp0_b32 s69, 16
 s_cbranch_scc1 L_rx16
 v_dot2c_f32_bf16 v64, v128, v24
 v_dot2c_f32_bf16 v65, v128, v25
 v_dot2c_f32_bf16 v66, v129, v24
 v_dot2c_f32_bf16 v67, v129, v25
 v_dot2c_f32_bf16 v68, v130, v24
 v_dot2c_f32_bf16 v69, v130, v25
 v_dot2c_f32_bf16 v70, v131, v24
 v_dot2c_f32_bf16 v71, v131, v25
L_ry16:
 s_cmp_lg_u32 s70, 0
 s_cbranch_scc1 L_rk25
 s_call_b64 s[36:37], L_rpoll
L_rk25:
 s_ff1_i32_b32 s71, s70
 s_bitset0_b32 s70, s71
 s_cmp_ge_u32 s71, 16
 s_cselect_b32 s72, s78, s77
 s_cselect_b32 s73, 0x2000000, 0
 s_cselect_b32 s87, 536870912, 0
 s_mul_i32 s71, s71, 114688
 s_add_u32 s71, s71, s72
 buffer_load_dwordx4 v[200:203], v7, s[8:11], s71 offen sc1
 s_or_b32 s69, s69, s73
 s_or_b32 s71, s71, s87
 buffer_load_dwordx4 v[204:207], v27, s[8:11], s71 offen sc1
 s_waitcnt vmcnt(16)
 s_bitcmp0_b32 s69, 17
 s_cbranch_scc1 L_rx17
 v_dot2c_f32_bf16 v64, v136, v24
 v_dot2c_f32_bf16 v65, v136, v25
 v_dot2c_f32_bf16 v66, v137, v24
 v_dot2c_f32_bf16 v67, v137, v25
 v_dot2c_f32_bf16 v68, v138, v24
 v_dot2c_f32_bf16 v69, v138, v25
 v_dot2c_f32_bf16 v70, v139, v24
 v_dot2c_f32_bf16 v71, v139, v25
L_ry17:
 s_cmp_lg_u32 s70, 0
 s_cbranch_scc1 L_rk26
 s_call_b64 s[36:37], L_rpoll
L_rk26:
 s_ff1_i32_b32 s71, s70
 s_bitset0_b32 s70, s71
 s_cmp_ge_u32 s71, 16
 s_cselect_b32 s72, s78, s77
 s_cselect_b32 s73, 0x4000000, 0
 s_cselect_b32 s87, 536870912, 0
 s_mul_i32 s71, s71, 114688
 s_add_u32 s71, s71, s72
 buffer_load_dwordx4 v[208:211], v7, s[8:11], s71 offen sc1
 s_or_b32 s69, s69, s73
 s_or_b32 s71, s71, s87
 buffer_load_dwordx4 v[212:215], v27, s[8:11], s71 offen sc1
 s_waitcnt vmcnt(16)
 s_bitcmp0_b32 s69, 18
 s_cbranch_scc1 L_rx18
 v_dot2c_f32_bf16 v64, v144, v24
 v_dot2c_f32_bf16 v65, v144, v25
 v_dot2c_f32_bf16 v66, v145, v24
 v_dot2c_f32_bf16 v67, v145, v25
 v_dot2c_f32_bf16 v68, v146, v24
 v_dot2c_f32_bf16 v69, v146, v25
 v_dot2c_f32_bf16 v70, v147, v24
 v_dot2c_f32_bf16 v71, v147, v25
L_ry18:
 s_cmp_lg_u32 s70, 0
 s_cbranch_scc1 L_rk27
 s_call_b64 s[36:37], L_rpoll
L_rk27:
 s_ff1_i32_b32 s71, s70
 s_bitset0_b32 s70, s71
 s_cmp_ge_u32 s71, 16
 s_cselect_b32 s72, s78, s77
 s_cselect_b32 s73, 0x8000000, 0
 s_cselect_b32 s87, 536870912, 0
 s_mul_i32 s71, s71, 114688
 s_add_u32 s71, s71, s72
 buffer_load_dwordx4 v[216:219], v7, s[8:11], s71 offen sc1
 s_or_b32 s69, s69, s73
 s_or_b32 s71, s71, s87
 buffer_load_dwordx4 v[220:223], v27, s[8:11], s71 offen sc1
 s_waitcnt vmcnt(16)
 s_bitcmp0_b32 s69, 19
 s_cbranch_scc1 L_rx19
 v_dot2c_f32_bf16 v64, v152, v24
 v_dot2c_f32_bf16 v65, v152, v25
 v_dot2c_f32_bf16 v66, v153, v24
 v_dot2c_f32_bf16 v67, v153, v25
 v_dot2c_f32_bf16 v68, v154, v24
 v_dot2c_f32_bf16 v69, v154, v25
 v_dot2c_f32_bf16 v70, v155, v24
 v_dot2c_f32_bf16 v71, v155, v25
L_ry19:
 s_and_b32 s71, s69, 0xfffff
 s_bcnt1_i32_b32 s71, s71
 s_cmp_eq_u32 s71, 4
 s_cselect_b32 s66, 1, 0
 s_cbranch_scc0 L_rne
 v_fmac_f32 v32, v15, v48
 v_fmac_f32 v33, v15, v49
 v_fmac_f32 v34, v15, v50
 v_fmac_f32 v35, v15, v51
 v_fmac_f32 v36, v15, v52
 v_fmac_f32 v37, v15, v53
 v_fmac_f32 v38, v15, v54
 v_fmac_f32 v39, v15, v55
 v_cvt_pk_bf16_f32 v16, v32, v33
 v_cvt_pk_bf16_f32 v17, v34, v35
 v_cvt_pk_bf16_f32 v18, v36, v37
 v_cvt_pk_bf16_f32 v19, v38, v39
 buffer_store_dwordx4 v[16:19], v12, s[52:55], s75 offen sc1
 v_fmac_f32 v40, v15, v56
 v_fmac_f32 v41, v15, v57
 v_fmac_f32 v42, v15, v58
 v_fmac_f32 v43, v15, v59
 v_fmac_f32 v44, v15, v60
 v_fmac_f32 v45, v15, v61
 v_fmac_f32 v46, v15, v62
 v_fmac_f32 v47, v15, v63
 v_cvt_pk_bf16_f32 v20, v40, v41
 v_cvt_pk_bf16_f32 v21, v42, v43
 v_cvt_pk_bf16_f32 v22, v44, v45
 v_cvt_pk_bf16_f32 v23, v46, v47
 buffer_store_dwordx4 v[20:23], v12, s[52:55], s76 offen sc1
L_rne:
 s_cmp_lg_u32 s70, 0
 s_cbranch_scc1 L_rk28
 s_call_b64 s[36:37], L_rpoll
L_rk28:
 s_ff1_i32_b32 s71, s70
 s_bitset0_b32 s70, s71
 s_cmp_ge_u32 s71, 16
 s_cselect_b32 s72, s78, s77
 s_cselect_b32 s73, 0x10000000, 0
 s_cselect_b32 s87, 536870912, 0
 s_mul_i32 s71, s71, 114688
 s_add_u32 s71, s71, s72
 buffer_load_dwordx4 v[224:227], v7, s[8:11], s71 offen sc1
 s_or_b32 s69, s69, s73
 s_or_b32 s71, s71, s87
 buffer_load_dwordx4 v[228:231], v27, s[8:11], s71 offen sc1
 s_waitcnt vmcnt(16)
 s_bitcmp0_b32 s69, 20
 s_cbranch_scc1 L_rx20
 v_dot2c_f32_bf16 v64, v160, v24
 v_dot2c_f32_bf16 v65, v160, v25
 v_dot2c_f32_bf16 v66, v161, v24
 v_dot2c_f32_bf16 v67, v161, v25
 v_dot2c_f32_bf16 v68, v162, v24
 v_dot2c_f32_bf16 v69, v162, v25
 v_dot2c_f32_bf16 v70, v163, v24
 v_dot2c_f32_bf16 v71, v163, v25
L_ry20:
 s_cmp_lg_u32 s70, 0
 s_cbranch_scc1 L_rk29
 s_call_b64 s[36:37], L_rpoll
L_rk29:
 s_ff1_i32_b32 s71, s70
 s_bitset0_b32 s70, s71
 s_cmp_ge_u32 s71, 16
 s_cselect_b32 s72, s78, s77
 s_cselect_b32 s73, 0x20000000, 0
 s_cselect_b32 s87, 536870912, 0
 s_mul_i32 s71, s71, 114688
 s_add_u32 s71, s71, s72
 buffer_load_dwordx4 v[232:235], v7, s[8:11], s71 offen sc1
 s_or_b32 s69, s69, s73
 s_or_b32 s71, s71, s87
 buffer_load_dwordx4 v[236:239], v27, s[8:11], s71 offen sc1
 s_waitcnt vmcnt(16)
 s_bitcmp0_b32 s69, 21
 s_cbranch_scc1 L_rx21
 v_dot2c_f32_bf16 v64, v168, v24
 v_dot2c_f32_bf16 v65, v168, v25
 v_dot2c_f32_bf16 v66, v169, v24
 v_dot2c_f32_bf16 v67, v169, v25
 v_dot2c_f32_bf16 v68, v170, v24
 v_dot2c_f32_bf16 v69, v170, v25
 v_dot2c_f32_bf16 v70, v171, v24
 v_dot2c_f32_bf16 v71, v171, v25
L_ry21:
 s_cmp_lg_u32 s70, 0
 s_cbranch_scc1 L_rk30
 s_call_b64 s[36:37], L_rpoll
L_rk30:
 s_ff1_i32_b32 s71, s70
 s_bitset0_b32 s70, s71
 s_cmp_ge_u32 s71, 16
 s_cselect_b32 s72, s78, s77
 s_cselect_b32 s73, 0x40000000, 0
 s_cselect_b32 s87, 536870912, 0
 s_mul_i32 s71, s71, 114688
 s_add_u32 s71, s71, s72
 buffer_load_dwordx4 v[240:243], v7, s[8:11], s71 offen sc1
 s_or_b32 s69, s69, s73
 s_or_b32 s71, s71, s87
 buffer_load_dwordx4 v[244:247], v27, s[8:11], s71 offen sc1
 s_waitcnt vmcnt(16)
 s_bitcmp0_b32 s69, 22
 s_cbranch_scc1 L_rx22
 v_dot2c_f32_bf16 v64, v176, v24
 v_dot2c_f32_bf16 v65, v176, v25
 v_dot2c_f32_bf16 v66, v177, v24
 v_dot2c_f32_bf16 v67, v177, v25
 v_dot2c_f32_bf16 v68, v178, v24
 v_dot2c_f32_bf16 v69, v178, v25
 v_dot2c_f32_bf16 v70, v179, v24
 v_dot2c_f32_bf16 v71, v179, v25
L_ry22:
 s_cmp_lg_u32 s70, 0
 s_cbranch_scc1 L_rk31
 s_call_b64 s[36:37], L_rpoll
L_rk31:
 s_ff1_i32_b32 s71, s70
 s_bitset0_b32 s70, s71
 s_cmp_ge_u32 s71, 16
 s_cselect_b32 s72, s78, s77
 s_cselect_b32 s73, 0x80000000, 0
 s_cselect_b32 s87, 536870912, 0
 s_mul_i32 s71, s71, 114688
 s_add_u32 s71, s71, s72
 buffer_load_dwordx4 v[248:251], v7, s[8:11], s71 offen sc1
 s_or_b32 s69, s69, s73
 s_or_b32 s71, s71, s87
 buffer_load_dwordx4 v[252:255], v27, s[8:11], s71 offen sc1
 s_waitcnt vmcnt(16)
 s_bitcmp0_b32 s69, 23
 s_cbranch_scc1 L_rx23
 v_dot2c_f32_bf16 v64, v184, v24
 v_dot2c_f32_bf16 v65, v184, v25
 v_dot2c_f32_bf16 v66, v185, v24
 v_dot2c_f32_bf16 v67, v185, v25
 v_dot2c_f32_bf16 v68, v186, v24
 v_dot2c_f32_bf16 v69, v186, v25
 v_dot2c_f32_bf16 v70, v187, v24
 v_dot2c_f32_bf16 v71, v187, v25
L_ry23:
 s_waitcnt vmcnt(14)
 s_bitcmp0_b32 s69, 24
 s_cbranch_scc1 L_rx24
 v_dot2c_f32_bf16 v64, v192, v24
 v_dot2c_f32_bf16 v65, v192, v25
 v_dot2c_f32_bf16 v66, v193, v24
 v_dot2c_f32_bf16 v67, v193, v25
 v_dot2c_f32_bf16 v68, v194, v24
 v_dot2c_f32_bf16 v69, v194, v25
 v_dot2c_f32_bf16 v70, v195, v24
 v_dot2c_f32_bf16 v71, v195, v25
L_ry24:
 s_waitcnt vmcnt(12)
 s_bitcmp0_b32 s69, 25
 s_cbranch_scc1 L_rx25
 v_dot2c_f32_bf16 v64, v200, v24
 v_dot2c_f32_bf16 v65, v200, v25
 v_dot2c_f32_bf16 v66, v201, v24
 v_dot2c_f32_bf16 v67, v201, v25
 v_dot2c_f32_bf16 v68, v202, v24
 v_dot2c_f32_bf16 v69, v202, v25
 v_dot2c_f32_bf16 v70, v203, v24
 v_dot2c_f32_bf16 v71, v203, v25
L_ry25:
 s_waitcnt vmcnt(10)
 s_bitcmp0_b32 s69, 26
 s_cbranch_scc1 L_rx26
 v_dot2c_f32_bf16 v64, v208, v24
 v_dot2c_f32_bf16 v65, v208, v25
 v_dot2c_f32_bf16 v66, v209, v24
 v_dot2c_f32_bf16 v67, v209, v25
 v_dot2c_f32_bf16 v68, v210, v24
 v_dot2c_f32_bf16 v69, v210, v25
 v_dot2c_f32_bf16 v70, v211, v24
 v_dot2c_f32_bf16 v71, v211, v25
L_ry26:
 s_waitcnt vmcnt(8)
 s_bitcmp0_b32 s69, 27
 s_cbranch_scc1 L_rx27
 v_dot2c_f32_bf16 v64, v216, v24
 v_dot2c_f32_bf16 v65, v216, v25
 v_dot2c_f32_bf16 v66, v217, v24
 v_dot2c_f32_bf16 v67, v217, v25
 v_dot2c_f32_bf16 v68, v218, v24
 v_dot2c_f32_bf16 v69, v218, v25
 v_dot2c_f32_bf16 v70, v219, v24
 v_dot2c_f32_bf16 v71, v219, v25
L_ry27:
 s_waitcnt vmcnt(6)
 s_bitcmp0_b32 s69, 28
 s_cbranch_scc1 L_rx28
 v_dot2c_f32_bf16 v64, v224, v24
 v_dot2c_f32_bf16 v65, v224, v25
 v_dot2c_f32_bf16 v66, v225, v24
 v_dot2c_f32_bf16 v67, v225, v25
 v_dot2c_f32_bf16 v68, v226, v24
 v_dot2c_f32_bf16 v69, v226, v25
 v_dot2c_f32_bf16 v70, v227, v24
 v_dot2c_f32_bf16 v71, v227, v25
L_ry28:
 s_waitcnt vmcnt(4)
 s_bitcmp0_b32 s69, 29
 s_cbranch_scc1 L_rx29
 v_dot2c_f32_bf16 v64, v232, v24
 v_dot2c_f32_bf16 v65, v232, v25
 v_dot2c_f32_bf16 v66, v233, v24
 v_dot2c_f32_bf16 v67, v233, v25
 v_dot2c_f32_bf16 v68, v234, v24
 v_dot2c_f32_bf16 v69, v234, v25
 v_dot2c_f32_bf16 v70, v235, v24
 v_dot2c_f32_bf16 v71, v235, v25
L_ry29:
 s_waitcnt vmcnt(2)
 s_bitcmp0_b32 s69, 30
 s_cbranch_scc1 L_rx30
 v_dot2c_f32_bf16 v64, v240, v24
 v_dot2c_f32_bf16 v65, v240, v25
 v_dot2c_f32_bf16 v66, v241, v24
 v_dot2c_f32_bf16 v67, v241, v25
 v_dot2c_f32_bf16 v68, v242, v24
 v_dot2c_f32_bf16 v69, v242, v25
 v_dot2c_f32_bf16 v70, v243, v24
 v_dot2c_f32_bf16 v71, v243, v25
L_ry30:
 s_waitcnt vmcnt(0)
 s_bitcmp0_b32 s69, 31
 s_cbranch_scc1 L_rx31
 v_dot2c_f32_bf16 v64, v248, v24
 v_dot2c_f32_bf16 v65, v248, v25
 v_dot2c_f32_bf16 v66, v249, v24
 v_dot2c_f32_bf16 v67, v249, v25
 v_dot2c_f32_bf16 v68, v250, v24
 v_dot2c_f32_bf16 v69, v250, v25
 v_dot2c_f32_bf16 v70, v251, v24
 v_dot2c_f32_bf16 v71, v251, v25
L_ry31:
 s_nop 1
 v_fmac_f32 v80, v26, v64
 v_fmac_f32 v81, v26, v65
 v_fmac_f32 v82, v26, v66
 v_fmac_f32 v83, v26, v67
 v_fmac_f32 v84, v26, v68
 v_fmac_f32 v85, v26, v69
 v_fmac_f32 v86, v26, v70
 v_fmac_f32 v87, v26, v71
 v_cvt_pk_bf16_f32 v96, v80, v81
 v_cvt_pk_bf16_f32 v97, v82, v83
 v_cvt_pk_bf16_f32 v98, v84, v85
 v_cvt_pk_bf16_f32 v99, v86, v87
 buffer_store_dwordx4 v[96:99], v28, s[52:55], s86 offen sc1
 s_cmp_eq_u32 s66, 1
 s_cbranch_scc1 L_rdone
 v_fmac_f32 v32, v15, v48
 v_fmac_f32 v33, v15, v49
 v_fmac_f32 v34, v15, v50
 v_fmac_f32 v35, v15, v51
 v_fmac_f32 v36, v15, v52
 v_fmac_f32 v37, v15, v53
 v_fmac_f32 v38, v15, v54
 v_fmac_f32 v39, v15, v55
 v_cvt_pk_bf16_f32 v16, v32, v33
 v_cvt_pk_bf16_f32 v17, v34, v35
 v_cvt_pk_bf16_f32 v18, v36, v37
 v_cvt_pk_bf16_f32 v19, v38, v39
 buffer_store_dwordx4 v[16:19], v12, s[52:55], s75 offen sc1
 v_fmac_f32 v40, v15, v56
 v_fmac_f32 v41, v15, v57
 v_fmac_f32 v42, v15, v58
 v_fmac_f32 v43, v15, v59
 v_fmac_f32 v44, v15, v60
 v_fmac_f32 v45, v15, v61
 v_fmac_f32 v46, v15, v62
 v_fmac_f32 v47, v15, v63
 v_cvt_pk_bf16_f32 v20, v40, v41
 v_cvt_pk_bf16_f32 v21, v42, v43
 v_cvt_pk_bf16_f32 v22, v44, v45
 v_cvt_pk_bf16_f32 v23, v46, v47
 buffer_store_dwordx4 v[20:23], v12, s[52:55], s76 offen sc1
L_rdone:
 s_endpgm
L_rx0:
 v_dot2c_f32_bf16 v64, v128, v24
 v_dot2c_f32_bf16 v65, v128, v25
 v_dot2c_f32_bf16 v66, v129, v24
 v_dot2c_f32_bf16 v67, v129, v25
 v_dot2c_f32_bf16 v68, v130, v24
 v_dot2c_f32_bf16 v69, v130, v25
 v_dot2c_f32_bf16 v70, v131, v24
 v_dot2c_f32_bf16 v71, v131, v25
 s_branch L_ry0
L_rx1:
 v_dot2c_f32_bf16 v64, v136, v24
 v_dot2c_f32_bf16 v65, v136, v25
 v_dot2c_f32_bf16 v66, v137, v24
 v_dot2c_f32_bf16 v67, v137, v25
 v_dot2c_f32_bf16 v68, v138, v24
 v_dot2c_f32_bf16 v69, v138, v25
 v_dot2c_f32_bf16 v70, v139, v24
 v_dot2c_f32_bf16 v71, v139, v25
 s_branch L_ry1
L_rx2:
 v_dot2c_f32_bf16 v64, v144, v24
 v_dot2c_f32_bf16 v65, v144, v25
 v_dot2c_f32_bf16 v66, v145, v24
 v_dot2c_f32_bf16 v67, v145, v25
 v_dot2c_f32_bf16 v68, v146, v24
 v_dot2c_f32_bf16 v69, v146, v25
 v_dot2c_f32_bf16 v70, v147, v24
 v_dot2c_f32_bf16 v71, v147, v25
 s_branch L_ry2
L_rx3:
 v_dot2c_f32_bf16 v64, v152, v24
 v_dot2c_f32_bf16 v65, v152, v25
 v_dot2c_f32_bf16 v66, v153, v24
 v_dot2c_f32_bf16 v67, v153, v25
 v_dot2c_f32_bf16 v68, v154, v24
 v_dot2c_f32_bf16 v69, v154, v25
 v_dot2c_f32_bf16 v70, v155, v24
 v_dot2c_f32_bf16 v71, v155, v25
 s_branch L_ry3
L_rx4:
 v_dot2c_f32_bf16 v64, v160, v24
 v_dot2c_f32_bf16 v65, v160, v25
 v_dot2c_f32_bf16 v66, v161, v24
 v_dot2c_f32_bf16 v67, v161, v25
 v_dot2c_f32_bf16 v68, v162, v24
 v_dot2c_f32_bf16 v69, v162, v25
 v_dot2c_f32_bf16 v70, v163, v24
 v_dot2c_f32_bf16 v71, v163, v25
 s_branch L_ry4
L_rx5:
 v_dot2c_f32_bf16 v64, v168, v24
 v_dot2c_f32_bf16 v65, v168, v25
 v_dot2c_f32_bf16 v66, v169, v24
 v_dot2c_f32_bf16 v67, v169, v25
 v_dot2c_f32_bf16 v68, v170, v24
 v_dot2c_f32_bf16 v69, v170, v25
 v_dot2c_f32_bf16 v70, v171, v24
 v_dot2c_f32_bf16 v71, v171, v25
 s_branch L_ry5
L_rx6:
 v_dot2c_f32_bf16 v64, v176, v24
 v_dot2c_f32_bf16 v65, v176, v25
 v_dot2c_f32_bf16 v66, v177, v24
 v_dot2c_f32_bf16 v67, v177, v25
 v_dot2c_f32_bf16 v68, v178, v24
 v_dot2c_f32_bf16 v69, v178, v25
 v_dot2c_f32_bf16 v70, v179, v24
 v_dot2c_f32_bf16 v71, v179, v25
 s_branch L_ry6
L_rx7:
 v_dot2c_f32_bf16 v64, v184, v24
 v_dot2c_f32_bf16 v65, v184, v25
 v_dot2c_f32_bf16 v66, v185, v24
 v_dot2c_f32_bf16 v67, v185, v25
 v_dot2c_f32_bf16 v68, v186, v24
 v_dot2c_f32_bf16 v69, v186, v25
 v_dot2c_f32_bf16 v70, v187, v24
 v_dot2c_f32_bf16 v71, v187, v25
 s_branch L_ry7
L_rx8:
 v_dot2c_f32_bf16 v64, v192, v24
 v_dot2c_f32_bf16 v65, v192, v25
 v_dot2c_f32_bf16 v66, v193, v24
 v_dot2c_f32_bf16 v67, v193, v25
 v_dot2c_f32_bf16 v68, v194, v24
 v_dot2c_f32_bf16 v69, v194, v25
 v_dot2c_f32_bf16 v70, v195, v24
 v_dot2c_f32_bf16 v71, v195, v25
 s_branch L_ry8
L_rx9:
 v_dot2c_f32_bf16 v64, v200, v24
 v_dot2c_f32_bf16 v65, v200, v25
 v_dot2c_f32_bf16 v66, v201, v24
 v_dot2c_f32_bf16 v67, v201, v25
 v_dot2c_f32_bf16 v68, v202, v24
 v_dot2c_f32_bf16 v69, v202, v25
 v_dot2c_f32_bf16 v70, v203, v24
 v_dot2c_f32_bf16 v71, v203, v25
 s_branch L_ry9
L_rx10:
 v_dot2c_f32_bf16 v64, v208, v24
 v_dot2c_f32_bf16 v65, v208, v25
 v_dot2c_f32_bf16 v66, v209, v24
 v_dot2c_f32_bf16 v67, v209, v25
 v_dot2c_f32_bf16 v68, v210, v24
 v_dot2c_f32_bf16 v69, v210, v25
 v_dot2c_f32_bf16 v70, v211, v24
 v_dot2c_f32_bf16 v71, v211, v25
 s_branch L_ry10
L_rx11:
 v_dot2c_f32_bf16 v64, v216, v24
 v_dot2c_f32_bf16 v65, v216, v25
 v_dot2c_f32_bf16 v66, v217, v24
 v_dot2c_f32_bf16 v67, v217, v25
 v_dot2c_f32_bf16 v68, v218, v24
 v_dot2c_f32_bf16 v69, v218, v25
 v_dot2c_f32_bf16 v70, v219, v24
 v_dot2c_f32_bf16 v71, v219, v25
 s_branch L_ry11
L_rx12:
 v_dot2c_f32_bf16 v64, v224, v24
 v_dot2c_f32_bf16 v65, v224, v25
 v_dot2c_f32_bf16 v66, v225, v24
 v_dot2c_f32_bf16 v67, v225, v25
 v_dot2c_f32_bf16 v68, v226, v24
 v_dot2c_f32_bf16 v69, v226, v25
 v_dot2c_f32_bf16 v70, v227, v24
 v_dot2c_f32_bf16 v71, v227, v25
 s_branch L_ry12
L_rx13:
 v_dot2c_f32_bf16 v64, v232, v24
 v_dot2c_f32_bf16 v65, v232, v25
 v_dot2c_f32_bf16 v66, v233, v24
 v_dot2c_f32_bf16 v67, v233, v25
 v_dot2c_f32_bf16 v68, v234, v24
 v_dot2c_f32_bf16 v69, v234, v25
 v_dot2c_f32_bf16 v70, v235, v24
 v_dot2c_f32_bf16 v71, v235, v25
 s_branch L_ry13
L_rx14:
 v_dot2c_f32_bf16 v64, v240, v24
 v_dot2c_f32_bf16 v65, v240, v25
 v_dot2c_f32_bf16 v66, v241, v24
 v_dot2c_f32_bf16 v67, v241, v25
 v_dot2c_f32_bf16 v68, v242, v24
 v_dot2c_f32_bf16 v69, v242, v25
 v_dot2c_f32_bf16 v70, v243, v24
 v_dot2c_f32_bf16 v71, v243, v25
 s_branch L_ry14
L_rx15:
 v_dot2c_f32_bf16 v64, v248, v24
 v_dot2c_f32_bf16 v65, v248, v25
 v_dot2c_f32_bf16 v66, v249, v24
 v_dot2c_f32_bf16 v67, v249, v25
 v_dot2c_f32_bf16 v68, v250, v24
 v_dot2c_f32_bf16 v69, v250, v25
 v_dot2c_f32_bf16 v70, v251, v24
 v_dot2c_f32_bf16 v71, v251, v25
 s_branch L_ry15
L_rx16:
 v_dot2c_f32_bf16 v48, v128, v24
 v_dot2c_f32_bf16 v49, v128, v25
 v_dot2c_f32_bf16 v50, v129, v24
 v_dot2c_f32_bf16 v51, v129, v25
 v_dot2c_f32_bf16 v52, v130, v24
 v_dot2c_f32_bf16 v53, v130, v25
 v_dot2c_f32_bf16 v54, v131, v24
 v_dot2c_f32_bf16 v55, v131, v25
 v_dot2c_f32_bf16 v56, v132, v24
 v_dot2c_f32_bf16 v57, v132, v25
 v_dot2c_f32_bf16 v58, v133, v24
 v_dot2c_f32_bf16 v59, v133, v25
 v_dot2c_f32_bf16 v60, v134, v24
 v_dot2c_f32_bf16 v61, v134, v25
 v_dot2c_f32_bf16 v62, v135, v24
 v_dot2c_f32_bf16 v63, v135, v25
 s_branch L_ry16
L_rx17:
 v_dot2c_f32_bf16 v48, v136, v24
 v_dot2c_f32_bf16 v49, v136, v25
 v_dot2c_f32_bf16 v50, v137, v24
 v_dot2c_f32_bf16 v51, v137, v25
 v_dot2c_f32_bf16 v52, v138, v24
 v_dot2c_f32_bf16 v53, v138, v25
 v_dot2c_f32_bf16 v54, v139, v24
 v_dot2c_f32_bf16 v55, v139, v25
 v_dot2c_f32_bf16 v56, v140, v24
 v_dot2c_f32_bf16 v57, v140, v25
 v_dot2c_f32_bf16 v58, v141, v24
 v_dot2c_f32_bf16 v59, v141, v25
 v_dot2c_f32_bf16 v60, v142, v24
 v_dot2c_f32_bf16 v61, v142, v25
 v_dot2c_f32_bf16 v62, v143, v24
 v_dot2c_f32_bf16 v63, v143, v25
 s_branch L_ry17
L_rx18:
 v_dot2c_f32_bf16 v48, v144, v24
 v_dot2c_f32_bf16 v49, v144, v25
 v_dot2c_f32_bf16 v50, v145, v24
 v_dot2c_f32_bf16 v51, v145, v25
 v_dot2c_f32_bf16 v52, v146, v24
 v_dot2c_f32_bf16 v53, v146, v25
 v_dot2c_f32_bf16 v54, v147, v24
 v_dot2c_f32_bf16 v55, v147, v25
 v_dot2c_f32_bf16 v56, v148, v24
 v_dot2c_f32_bf16 v57, v148, v25
 v_dot2c_f32_bf16 v58, v149, v24
 v_dot2c_f32_bf16 v59, v149, v25
 v_dot2c_f32_bf16 v60, v150, v24
 v_dot2c_f32_bf16 v61, v150, v25
 v_dot2c_f32_bf16 v62, v151, v24
 v_dot2c_f32_bf16 v63, v151, v25
 s_branch L_ry18
L_rx19:
 v_dot2c_f32_bf16 v48, v152, v24
 v_dot2c_f32_bf16 v49, v152, v25
 v_dot2c_f32_bf16 v50, v153, v24
 v_dot2c_f32_bf16 v51, v153, v25
 v_dot2c_f32_bf16 v52, v154, v24
 v_dot2c_f32_bf16 v53, v154, v25
 v_dot2c_f32_bf16 v54, v155, v24
 v_dot2c_f32_bf16 v55, v155, v25
 v_dot2c_f32_bf16 v56, v156, v24
 v_dot2c_f32_bf16 v57, v156, v25
 v_dot2c_f32_bf16 v58, v157, v24
 v_dot2c_f32_bf16 v59, v157, v25
 v_dot2c_f32_bf16 v60, v158, v24
 v_dot2c_f32_bf16 v61, v158, v25
 v_dot2c_f32_bf16 v62, v159, v24
 v_dot2c_f32_bf16 v63, v159, v25
 s_branch L_ry19
L_rx20:
 v_dot2c_f32_bf16 v48, v160, v24
 v_dot2c_f32_bf16 v49, v160, v25
 v_dot2c_f32_bf16 v50, v161, v24
 v_dot2c_f32_bf16 v51, v161, v25
 v_dot2c_f32_bf16 v52, v162, v24
 v_dot2c_f32_bf16 v53, v162, v25
 v_dot2c_f32_bf16 v54, v163, v24
 v_dot2c_f32_bf16 v55, v163, v25
 v_dot2c_f32_bf16 v56, v164, v24
 v_dot2c_f32_bf16 v57, v164, v25
 v_dot2c_f32_bf16 v58, v165, v24
 v_dot2c_f32_bf16 v59, v165, v25
 v_dot2c_f32_bf16 v60, v166, v24
 v_dot2c_f32_bf16 v61, v166, v25
 v_dot2c_f32_bf16 v62, v167, v24
 v_dot2c_f32_bf16 v63, v167, v25
 s_branch L_ry20
L_rx21:
 v_dot2c_f32_bf16 v48, v168, v24
 v_dot2c_f32_bf16 v49, v168, v25
 v_dot2c_f32_bf16 v50, v169, v24
 v_dot2c_f32_bf16 v51, v169, v25
 v_dot2c_f32_bf16 v52, v170, v24
 v_dot2c_f32_bf16 v53, v170, v25
 v_dot2c_f32_bf16 v54, v171, v24
 v_dot2c_f32_bf16 v55, v171, v25
 v_dot2c_f32_bf16 v56, v172, v24
 v_dot2c_f32_bf16 v57, v172, v25
 v_dot2c_f32_bf16 v58, v173, v24
 v_dot2c_f32_bf16 v59, v173, v25
 v_dot2c_f32_bf16 v60, v174, v24
 v_dot2c_f32_bf16 v61, v174, v25
 v_dot2c_f32_bf16 v62, v175, v24
 v_dot2c_f32_bf16 v63, v175, v25
 s_branch L_ry21
L_rx22:
 v_dot2c_f32_bf16 v48, v176, v24
 v_dot2c_f32_bf16 v49, v176, v25
 v_dot2c_f32_bf16 v50, v177, v24
 v_dot2c_f32_bf16 v51, v177, v25
 v_dot2c_f32_bf16 v52, v178, v24
 v_dot2c_f32_bf16 v53, v178, v25
 v_dot2c_f32_bf16 v54, v179, v24
 v_dot2c_f32_bf16 v55, v179, v25
 v_dot2c_f32_bf16 v56, v180, v24
 v_dot2c_f32_bf16 v57, v180, v25
 v_dot2c_f32_bf16 v58, v181, v24
 v_dot2c_f32_bf16 v59, v181, v25
 v_dot2c_f32_bf16 v60, v182, v24
 v_dot2c_f32_bf16 v61, v182, v25
 v_dot2c_f32_bf16 v62, v183, v24
 v_dot2c_f32_bf16 v63, v183, v25
 s_branch L_ry22
L_rx23:
 v_dot2c_f32_bf16 v48, v184, v24
 v_dot2c_f32_bf16 v49, v184, v25
 v_dot2c_f32_bf16 v50, v185, v24
 v_dot2c_f32_bf16 v51, v185, v25
 v_dot2c_f32_bf16 v52, v186, v24
 v_dot2c_f32_bf16 v53, v186, v25
 v_dot2c_f32_bf16 v54, v187, v24
 v_dot2c_f32_bf16 v55, v187, v25
 v_dot2c_f32_bf16 v56, v188, v24
 v_dot2c_f32_bf16 v57, v188, v25
 v_dot2c_f32_bf16 v58, v189, v24
 v_dot2c_f32_bf16 v59, v189, v25
 v_dot2c_f32_bf16 v60, v190, v24
 v_dot2c_f32_bf16 v61, v190, v25
 v_dot2c_f32_bf16 v62, v191, v24
 v_dot2c_f32_bf16 v63, v191, v25
 s_branch L_ry23
L_rx24:
 v_dot2c_f32_bf16 v48, v192, v24
 v_dot2c_f32_bf16 v49, v192, v25
 v_dot2c_f32_bf16 v50, v193, v24
 v_dot2c_f32_bf16 v51, v193, v25
 v_dot2c_f32_bf16 v52, v194, v24
 v_dot2c_f32_bf16 v53, v194, v25
 v_dot2c_f32_bf16 v54, v195, v24
 v_dot2c_f32_bf16 v55, v195, v25
 v_dot2c_f32_bf16 v56, v196, v24
 v_dot2c_f32_bf16 v57, v196, v25
 v_dot2c_f32_bf16 v58, v197, v24
 v_dot2c_f32_bf16 v59, v197, v25
 v_dot2c_f32_bf16 v60, v198, v24
 v_dot2c_f32_bf16 v61, v198, v25
 v_dot2c_f32_bf16 v62, v199, v24
 v_dot2c_f32_bf16 v63, v199, v25
 s_branch L_ry24
L_rx25:
 v_dot2c_f32_bf16 v48, v200, v24
 v_dot2c_f32_bf16 v49, v200, v25
 v_dot2c_f32_bf16 v50, v201, v24
 v_dot2c_f32_bf16 v51, v201, v25
 v_dot2c_f32_bf16 v52, v202, v24
 v_dot2c_f32_bf16 v53, v202, v25
 v_dot2c_f32_bf16 v54, v203, v24
 v_dot2c_f32_bf16 v55, v203, v25
 v_dot2c_f32_bf16 v56, v204, v24
 v_dot2c_f32_bf16 v57, v204, v25
 v_dot2c_f32_bf16 v58, v205, v24
 v_dot2c_f32_bf16 v59, v205, v25
 v_dot2c_f32_bf16 v60, v206, v24
 v_dot2c_f32_bf16 v61, v206, v25
 v_dot2c_f32_bf16 v62, v207, v24
 v_dot2c_f32_bf16 v63, v207, v25
 s_branch L_ry25
L_rx26:
 v_dot2c_f32_bf16 v48, v208, v24
 v_dot2c_f32_bf16 v49, v208, v25
 v_dot2c_f32_bf16 v50, v209, v24
 v_dot2c_f32_bf16 v51, v209, v25
 v_dot2c_f32_bf16 v52, v210, v24
 v_dot2c_f32_bf16 v53, v210, v25
 v_dot2c_f32_bf16 v54, v211, v24
 v_dot2c_f32_bf16 v55, v211, v25
 v_dot2c_f32_bf16 v56, v212, v24
 v_dot2c_f32_bf16 v57, v212, v25
 v_dot2c_f32_bf16 v58, v213, v24
 v_dot2c_f32_bf16 v59, v213, v25
 v_dot2c_f32_bf16 v60, v214, v24
 v_dot2c_f32_bf16 v61, v214, v25
 v_dot2c_f32_bf16 v62, v215, v24
 v_dot2c_f32_bf16 v63, v215, v25
 s_branch L_ry26
L_rx27:
 v_dot2c_f32_bf16 v48, v216, v24
 v_dot2c_f32_bf16 v49, v216, v25
 v_dot2c_f32_bf16 v50, v217, v24
 v_dot2c_f32_bf16 v51, v217, v25
 v_dot2c_f32_bf16 v52, v218, v24
 v_dot2c_f32_bf16 v53, v218, v25
 v_dot2c_f32_bf16 v54, v219, v24
 v_dot2c_f32_bf16 v55, v219, v25
 v_dot2c_f32_bf16 v56, v220, v24
 v_dot2c_f32_bf16 v57, v220, v25
 v_dot2c_f32_bf16 v58, v221, v24
 v_dot2c_f32_bf16 v59, v221, v25
 v_dot2c_f32_bf16 v60, v222, v24
 v_dot2c_f32_bf16 v61, v222, v25
 v_dot2c_f32_bf16 v62, v223, v24
 v_dot2c_f32_bf16 v63, v223, v25
 s_branch L_ry27
L_rx28:
 v_dot2c_f32_bf16 v48, v224, v24
 v_dot2c_f32_bf16 v49, v224, v25
 v_dot2c_f32_bf16 v50, v225, v24
 v_dot2c_f32_bf16 v51, v225, v25
 v_dot2c_f32_bf16 v52, v226, v24
 v_dot2c_f32_bf16 v53, v226, v25
 v_dot2c_f32_bf16 v54, v227, v24
 v_dot2c_f32_bf16 v55, v227, v25
 v_dot2c_f32_bf16 v56, v228, v24
 v_dot2c_f32_bf16 v57, v228, v25
 v_dot2c_f32_bf16 v58, v229, v24
 v_dot2c_f32_bf16 v59, v229, v25
 v_dot2c_f32_bf16 v60, v230, v24
 v_dot2c_f32_bf16 v61, v230, v25
 v_dot2c_f32_bf16 v62, v231, v24
 v_dot2c_f32_bf16 v63, v231, v25
 s_branch L_ry28
L_rx29:
 v_dot2c_f32_bf16 v48, v232, v24
 v_dot2c_f32_bf16 v49, v232, v25
 v_dot2c_f32_bf16 v50, v233, v24
 v_dot2c_f32_bf16 v51, v233, v25
 v_dot2c_f32_bf16 v52, v234, v24
 v_dot2c_f32_bf16 v53, v234, v25
 v_dot2c_f32_bf16 v54, v235, v24
 v_dot2c_f32_bf16 v55, v235, v25
 v_dot2c_f32_bf16 v56, v236, v24
 v_dot2c_f32_bf16 v57, v236, v25
 v_dot2c_f32_bf16 v58, v237, v24
 v_dot2c_f32_bf16 v59, v237, v25
 v_dot2c_f32_bf16 v60, v238, v24
 v_dot2c_f32_bf16 v61, v238, v25
 v_dot2c_f32_bf16 v62, v239, v24
 v_dot2c_f32_bf16 v63, v239, v25
 s_branch L_ry29
L_rx30:
 v_dot2c_f32_bf16 v48, v240, v24
 v_dot2c_f32_bf16 v49, v240, v25
 v_dot2c_f32_bf16 v50, v241, v24
 v_dot2c_f32_bf16 v51, v241, v25
 v_dot2c_f32_bf16 v52, v242, v24
 v_dot2c_f32_bf16 v53, v242, v25
 v_dot2c_f32_bf16 v54, v243, v24
 v_dot2c_f32_bf16 v55, v243, v25
 v_dot2c_f32_bf16 v56, v244, v24
 v_dot2c_f32_bf16 v57, v244, v25
 v_dot2c_f32_bf16 v58, v245, v24
 v_dot2c_f32_bf16 v59, v245, v25
 v_dot2c_f32_bf16 v60, v246, v24
 v_dot2c_f32_bf16 v61, v246, v25
 v_dot2c_f32_bf16 v62, v247, v24
 v_dot2c_f32_bf16 v63, v247, v25
 s_branch L_ry30
L_rx31:
 v_dot2c_f32_bf16 v48, v248, v24
 v_dot2c_f32_bf16 v49, v248, v25
 v_dot2c_f32_bf16 v50, v249, v24
 v_dot2c_f32_bf16 v51, v249, v25
 v_dot2c_f32_bf16 v52, v250, v24
 v_dot2c_f32_bf16 v53, v250, v25
 v_dot2c_f32_bf16 v54, v251, v24
 v_dot2c_f32_bf16 v55, v251, v25
 v_dot2c_f32_bf16 v56, v252, v24
 v_dot2c_f32_bf16 v57, v252, v25
 v_dot2c_f32_bf16 v58, v253, v24
 v_dot2c_f32_bf16 v59, v253, v25
 v_dot2c_f32_bf16 v60, v254, v24
 v_dot2c_f32_bf16 v61, v254, v25
 v_dot2c_f32_bf16 v62, v255, v24
 v_dot2c_f32_bf16 v63, v255, v25
 s_branch L_ry31
L_rpoll0:
 s_sleep 1
L_rpoll:
 buffer_load_dword v9, v14, s[8:11], s46 offen sc1
 s_waitcnt vmcnt(0)
 v_cmp_eq_u32 vcc, 1, v9
 s_sub_u32 s91, s91, 1
 s_cselect_b32 s70, -1, 0
 s_or_b32 s70, s70, vcc_lo
 s_andn2_b32 s70, s70, s68
 s_cbranch_scc0 L_rpoll0
 s_or_b32 s68, s68, s70
 s_setpc_b64 s[36:37]
L_comb:
 buffer_load_dwordx4 v[14:17], v7, s[8:11], s52 offen sc1
 s_waitcnt vmcnt(0)
 s_nop 7
 v_sub_f32 v10, v32, v14
 v_sub_f32 v11, v36, v15
 v_max_f32 v10, 0, v10
 v_max_f32 v11, 0, v11
 v_sub_f32 v100, v100, v11
 v_sub_f32 v101, v101, v11
 v_sub_f32 v102, v102, v11
 v_sub_f32 v103, v103, v11
 v_sub_f32 v108, v108, v11
 v_sub_f32 v109, v109, v11
 v_sub_f32 v110, v110, v11
 v_sub_f32 v111, v111, v11
 v_sub_f32 v116, v116, v11
 v_sub_f32 v117, v117, v11
 v_sub_f32 v118, v118, v11
 v_sub_f32 v119, v119, v11
 v_sub_f32 v124, v124, v11
 v_sub_f32 v125, v125, v11
 v_sub_f32 v126, v126, v11
 v_sub_f32 v127, v127, v11
 v_sub_f32 v64, v64, v10
 v_sub_f32 v65, v65, v10
 v_sub_f32 v66, v66, v10
 v_sub_f32 v67, v67, v10
 v_sub_f32 v68, v68, v11
 v_sub_f32 v69, v69, v11
 v_sub_f32 v70, v70, v11
 v_sub_f32 v71, v71, v11
 v_sub_f32 v72, v72, v10
 v_sub_f32 v73, v73, v10
 v_sub_f32 v74, v74, v10
 v_sub_f32 v75, v75, v10
 v_sub_f32 v76, v76, v11
 v_sub_f32 v77, v77, v11
 v_sub_f32 v78, v78, v11
 v_sub_f32 v79, v79, v11
 v_sub_f32 v80, v80, v10
 v_sub_f32 v81, v81, v10
 v_sub_f32 v82, v82, v10
 v_sub_f32 v83, v83, v10
 v_sub_f32 v84, v84, v11
 v_sub_f32 v85, v85, v11
 v_sub_f32 v86, v86, v11
 v_sub_f32 v87, v87, v11
 v_sub_f32 v88, v88, v10
 v_sub_f32 v89, v89, v10
 v_sub_f32 v90, v90, v10
 v_sub_f32 v91, v91, v10
 v_sub_f32 v92, v92, v11
 v_sub_f32 v93, v93, v11
 v_sub_f32 v94, v94, v11
 v_sub_f32 v95, v95, v11
 v_sub_f32 v32, v32, v10
 v_sub_f32 v33, v33, v10
 v_sub_f32 v34, v34, v10
 v_sub_f32 v35, v35, v10
 v_sub_f32 v36, v36, v11
 v_sub_f32 v37, v37, v11
 v_sub_f32 v38, v38, v11
 v_sub_f32 v39, v39, v11
 v_exp_f32 v12, -v10
 v_exp_f32 v13, -v11
 v_mul_f32 v30, v12, v30
 v_mul_f32 v31, v13, v31
 v_mul_f32 v128, v12, v128
 v_mul_f32 v129, v12, v129
 v_mul_f32 v130, v12, v130
 v_mul_f32 v131, v12, v131
 v_mul_f32 v132, v13, v132
 v_mul_f32 v133, v13, v133
 v_mul_f32 v134, v13, v134
 v_mul_f32 v135, v13, v135
 v_mul_f32 v136, v12, v136
 v_mul_f32 v137, v12, v137
 v_mul_f32 v138, v12, v138
 v_mul_f32 v139, v12, v139
 v_mul_f32 v140, v13, v140
 v_mul_f32 v141, v13, v141
 v_mul_f32 v142, v13, v142
 v_mul_f32 v143, v13, v143
 v_mul_f32 v144, v12, v144
 v_mul_f32 v145, v12, v145
 v_mul_f32 v146, v12, v146
 v_mul_f32 v147, v12, v147
 v_mul_f32 v148, v13, v148
 v_mul_f32 v149, v13, v149
 v_mul_f32 v150, v13, v150
 v_mul_f32 v151, v13, v151
 v_mul_f32 v152, v12, v152
 v_mul_f32 v153, v12, v153
 v_mul_f32 v154, v12, v154
 v_mul_f32 v155, v12, v155
 v_mul_f32 v156, v13, v156
 v_mul_f32 v157, v13, v157
 v_mul_f32 v158, v13, v158
 v_mul_f32 v159, v13, v159
 v_mul_f32 v160, v12, v160
 v_mul_f32 v161, v12, v161
 v_mul_f32 v162, v12, v162
 v_mul_f32 v163, v12, v163
 v_mul_f32 v164, v13, v164
 v_mul_f32 v165, v13, v165
 v_mul_f32 v166, v13, v166
 v_mul_f32 v167, v13, v167
 v_mul_f32 v168, v12, v168
 v_mul_f32 v169, v12, v169
 v_mul_f32 v170, v12, v170
 v_mul_f32 v171, v12, v171
 v_mul_f32 v172, v13, v172
 v_mul_f32 v173, v13, v173
 v_mul_f32 v174, v13, v174
 v_mul_f32 v175, v13, v175
 v_mul_f32 v176, v12, v176
 v_mul_f32 v177, v12, v177
 v_mul_f32 v178, v12, v178
 v_mul_f32 v179, v12, v179
 v_mul_f32 v180, v13, v180
 v_mul_f32 v181, v13, v181
 v_mul_f32 v182, v13, v182
 v_mul_f32 v183, v13, v183
 v_mul_f32 v184, v12, v184
 v_mul_f32 v185, v12, v185
 v_mul_f32 v186, v12, v186
 v_mul_f32 v187, v12, v187
 v_mul_f32 v188, v13, v188
 v_mul_f32 v189, v13, v189
 v_mul_f32 v190, v13, v190
 v_mul_f32 v191, v13, v191
 v_mul_f32 v192, v12, v192
 v_mul_f32 v193, v12, v193
 v_mul_f32 v194, v12, v194
 v_mul_f32 v195, v12, v195
 v_mul_f32 v196, v13, v196
 v_mul_f32 v197, v13, v197
 v_mul_f32 v198, v13, v198
 v_mul_f32 v199, v13, v199
 v_mul_f32 v200, v12, v200
 v_mul_f32 v201, v12, v201
 v_mul_f32 v202, v12, v202
 v_mul_f32 v203, v12, v203
 v_mul_f32 v204, v13, v204
 v_mul_f32 v205, v13, v205
 v_mul_f32 v206, v13, v206
 v_mul_f32 v207, v13, v207
 v_mul_f32 v208, v12, v208
 v_mul_f32 v209, v12, v209
 v_mul_f32 v210, v12, v210
 v_mul_f32 v211, v12, v211
 v_mul_f32 v212, v13, v212
 v_mul_f32 v213, v13, v213
 v_mul_f32 v214, v13, v214
 v_mul_f32 v215, v13, v215
 v_mul_f32 v216, v12, v216
 v_mul_f32 v217, v12, v217
 v_mul_f32 v218, v12, v218
 v_mul_f32 v219, v12, v219
 v_mul_f32 v220, v13, v220
 v_mul_f32 v221, v13, v221
 v_mul_f32 v222, v13, v222
 v_mul_f32 v223, v13, v223
 v_mul_f32 v224, v12, v224
 v_mul_f32 v225, v12, v225
 v_mul_f32 v226, v12, v226
 v_mul_f32 v227, v12, v227
 v_mul_f32 v228, v13, v228
 v_mul_f32 v229, v13, v229
 v_mul_f32 v230, v13, v230
 v_mul_f32 v231, v13, v231
 v_mul_f32 v232, v12, v232
 v_mul_f32 v233, v12, v233
 v_mul_f32 v234, v12, v234
 v_mul_f32 v235, v12, v235
 v_mul_f32 v236, v13, v236
 v_mul_f32 v237, v13, v237
 v_mul_f32 v238, v13, v238
 v_mul_f32 v239, v13, v239
 v_mul_f32 v240, v12, v240
 v_mul_f32 v241, v12, v241
 v_mul_f32 v242, v12, v242
 v_mul_f32 v243, v12, v243
 v_mul_f32 v244, v13, v244
 v_mul_f32 v245, v13, v245
 v_mul_f32 v246, v13, v246
 v_mul_f32 v247, v13, v247
 v_mul_f32 v248, v12, v248
 v_mul_f32 v249, v12, v249
 v_mul_f32 v250, v12, v250
 v_mul_f32 v251, v12, v251
 v_mul_f32 v252, v13, v252
 v_mul_f32 v253, v13, v253
 v_mul_f32 v254, v13, v254
 v_mul_f32 v255, v13, v255
 v_exp_f32 v18, v64
 v_exp_f32 v19, v65
 v_exp_f32 v20, v66
 v_add_f32 v26, v18, v19
 v_cvt_pk_bf16_f32 v40, v18, v19
 v_exp_f32 v21, v67
 v_exp_f32 v22, v72
 v_add_f32 v26, v20, v26
 v_cvt_pk_bf16_f32 v41, v20, v21
 v_exp_f32 v23, v73
 v_add_f32 v26, v21, v26
 v_exp_f32 v24, v74
 v_add_f32 v26, v22, v26
 v_cvt_pk_bf16_f32 v42, v22, v23
 v_exp_f32 v25, v75
 v_add_f32 v26, v23, v26
 v_exp_f32 v18, v68
 v_add_f32 v26, v24, v26
 v_cvt_pk_bf16_f32 v43, v24, v25
 v_exp_f32 v19, v69
 v_add_f32 v26, v25, v26
 v_exp_f32 v20, v70
 v_add_f32 v27, v18, v19
 v_cvt_pk_bf16_f32 v44, v18, v19
 v_exp_f32 v21, v71
 v_exp_f32 v22, v76
 v_add_f32 v27, v20, v27
 v_cvt_pk_bf16_f32 v45, v20, v21
 v_exp_f32 v23, v77
 v_add_f32 v27, v21, v27
 v_exp_f32 v24, v78
 v_add_f32 v27, v22, v27
 v_cvt_pk_bf16_f32 v46, v22, v23
 v_exp_f32 v25, v79
 v_add_f32 v27, v23, v27
 v_add_f32 v27, v24, v27
 v_cvt_pk_bf16_f32 v47, v24, v25
 v_add_f32 v27, v25, v27
 v_sub_f32 v10, v32, v14
 v_sub_f32 v11, v36, v15
 v_cvt_i32_f32 v10, v10
 v_cvt_i32_f32 v11, v11
 v_ldexp_f32 v10, 1.0, v10
 v_ldexp_f32 v11, 1.0, v11
 v_and_b32 v10, 0xffff0000, v10
 v_and_b32 v11, 0xffff0000, v11
 v_fmac_f32 v30, v10, v16
 v_fmac_f32 v31, v11, v17
 v_lshrrev_b32 v12, 16, v10
 v_lshrrev_b32 v13, 16, v11
 v_accvgpr_read_b32 v18, a128
 v_dot2c_f32_bf16 v128, v18, v12
 v_dot2c_f32_bf16 v129, v18, v10
 v_accvgpr_read_b32 v19, a129
 v_dot2c_f32_bf16 v130, v19, v12
 v_dot2c_f32_bf16 v131, v19, v10
 v_accvgpr_read_b32 v20, a130
 v_dot2c_f32_bf16 v136, v20, v12
 v_dot2c_f32_bf16 v137, v20, v10
 v_accvgpr_read_b32 v21, a131
 v_dot2c_f32_bf16 v138, v21, v12
 v_dot2c_f32_bf16 v139, v21, v10
 v_accvgpr_read_b32 v22, a132
 v_dot2c_f32_bf16 v144, v22, v12
 v_dot2c_f32_bf16 v145, v22, v10
 v_accvgpr_read_b32 v23, a133
 v_dot2c_f32_bf16 v146, v23, v12
 v_dot2c_f32_bf16 v147, v23, v10
 v_accvgpr_read_b32 v24, a134
 v_dot2c_f32_bf16 v152, v24, v12
 v_dot2c_f32_bf16 v153, v24, v10
 v_accvgpr_read_b32 v25, a135
 v_dot2c_f32_bf16 v154, v25, v12
 v_dot2c_f32_bf16 v155, v25, v10
 v_accvgpr_read_b32 v18, a136
 v_dot2c_f32_bf16 v160, v18, v12
 v_dot2c_f32_bf16 v161, v18, v10
 v_accvgpr_read_b32 v19, a137
 v_dot2c_f32_bf16 v162, v19, v12
 v_dot2c_f32_bf16 v163, v19, v10
 v_accvgpr_read_b32 v20, a138
 v_dot2c_f32_bf16 v168, v20, v12
 v_dot2c_f32_bf16 v169, v20, v10
 v_accvgpr_read_b32 v21, a139
 v_dot2c_f32_bf16 v170, v21, v12
 v_dot2c_f32_bf16 v171, v21, v10
 v_accvgpr_read_b32 v22, a140
 v_dot2c_f32_bf16 v176, v22, v12
 v_dot2c_f32_bf16 v177, v22, v10
 v_accvgpr_read_b32 v23, a141
 v_dot2c_f32_bf16 v178, v23, v12
 v_dot2c_f32_bf16 v179, v23, v10
 v_accvgpr_read_b32 v24, a142
 v_dot2c_f32_bf16 v184, v24, v12
 v_dot2c_f32_bf16 v185, v24, v10
 v_accvgpr_read_b32 v25, a143
 v_dot2c_f32_bf16 v186, v25, v12
 v_dot2c_f32_bf16 v187, v25, v10
 v_accvgpr_read_b32 v18, a144
 v_dot2c_f32_bf16 v192, v18, v12
 v_dot2c_f32_bf16 v193, v18, v10
 v_accvgpr_read_b32 v19, a145
 v_dot2c_f32_bf16 v194, v19, v12
 v_dot2c_f32_bf16 v195, v19, v10
 v_accvgpr_read_b32 v20, a146
 v_dot2c_f32_bf16 v200, v20, v12
 v_dot2c_f32_bf16 v201, v20, v10
 v_accvgpr_read_b32 v21, a147
 v_dot2c_f32_bf16 v202, v21, v12
 v_dot2c_f32_bf16 v203, v21, v10
 v_accvgpr_read_b32 v22, a148
 v_dot2c_f32_bf16 v208, v22, v12
 v_dot2c_f32_bf16 v209, v22, v10
 v_accvgpr_read_b32 v23, a149
 v_dot2c_f32_bf16 v210, v23, v12
 v_dot2c_f32_bf16 v211, v23, v10
 v_accvgpr_read_b32 v24, a150
 v_dot2c_f32_bf16 v216, v24, v12
 v_dot2c_f32_bf16 v217, v24, v10
 v_accvgpr_read_b32 v25, a151
 v_dot2c_f32_bf16 v218, v25, v12
 v_dot2c_f32_bf16 v219, v25, v10
 v_accvgpr_read_b32 v18, a152
 v_dot2c_f32_bf16 v224, v18, v12
 v_dot2c_f32_bf16 v225, v18, v10
 v_accvgpr_read_b32 v19, a153
 v_dot2c_f32_bf16 v226, v19, v12
 v_dot2c_f32_bf16 v227, v19, v10
 v_accvgpr_read_b32 v20, a154
 v_dot2c_f32_bf16 v232, v20, v12
 v_dot2c_f32_bf16 v233, v20, v10
 v_accvgpr_read_b32 v21, a155
 v_dot2c_f32_bf16 v234, v21, v12
 v_dot2c_f32_bf16 v235, v21, v10
 v_accvgpr_read_b32 v22, a156
 v_dot2c_f32_bf16 v240, v22, v12
 v_dot2c_f32_bf16 v241, v22, v10
 v_accvgpr_read_b32 v23, a157
 v_dot2c_f32_bf16 v242, v23, v12
 v_dot2c_f32_bf16 v243, v23, v10
 v_accvgpr_read_b32 v24, a158
 v_dot2c_f32_bf16 v248, v24, v12
 v_dot2c_f32_bf16 v249, v24, v10
 v_accvgpr_read_b32 v25, a159
 v_dot2c_f32_bf16 v250, v25, v12
 v_dot2c_f32_bf16 v251, v25, v10
 v_accvgpr_read_b32 v18, a160
 v_dot2c_f32_bf16 v132, v18, v13
 v_dot2c_f32_bf16 v133, v18, v11
 v_accvgpr_read_b32 v19, a161
 v_dot2c_f32_bf16 v134, v19, v13
 v_dot2c_f32_bf16 v135, v19, v11
 v_accvgpr_read_b32 v20, a162
 v_dot2c_f32_bf16 v140, v20, v13
 v_dot2c_f32_bf16 v141, v20, v11
 v_accvgpr_read_b32 v21, a163
 v_dot2c_f32_bf16 v142, v21, v13
 v_dot2c_f32_bf16 v143, v21, v11
 v_accvgpr_read_b32 v22, a164
 v_dot2c_f32_bf16 v148, v22, v13
 v_dot2c_f32_bf16 v149, v22, v11
 v_accvgpr_read_b32 v23, a165
 v_dot2c_f32_bf16 v150, v23, v13
 v_dot2c_f32_bf16 v151, v23, v11
 v_accvgpr_read_b32 v24, a166
 v_dot2c_f32_bf16 v156, v24, v13
 v_dot2c_f32_bf16 v157, v24, v11
 v_accvgpr_read_b32 v25, a167
 v_dot2c_f32_bf16 v158, v25, v13
 v_dot2c_f32_bf16 v159, v25, v11
 v_accvgpr_read_b32 v18, a168
 v_dot2c_f32_bf16 v164, v18, v13
 v_dot2c_f32_bf16 v165, v18, v11
 v_accvgpr_read_b32 v19, a169
 v_dot2c_f32_bf16 v166, v19, v13
 v_dot2c_f32_bf16 v167, v19, v11
 v_accvgpr_read_b32 v20, a170
 v_dot2c_f32_bf16 v172, v20, v13
 v_dot2c_f32_bf16 v173, v20, v11
 v_accvgpr_read_b32 v21, a171
 v_dot2c_f32_bf16 v174, v21, v13
 v_dot2c_f32_bf16 v175, v21, v11
 v_accvgpr_read_b32 v22, a172
 v_dot2c_f32_bf16 v180, v22, v13
 v_dot2c_f32_bf16 v181, v22, v11
 v_accvgpr_read_b32 v23, a173
 v_dot2c_f32_bf16 v182, v23, v13
 v_dot2c_f32_bf16 v183, v23, v11
 v_accvgpr_read_b32 v24, a174
 v_dot2c_f32_bf16 v188, v24, v13
 v_dot2c_f32_bf16 v189, v24, v11
 v_accvgpr_read_b32 v25, a175
 v_dot2c_f32_bf16 v190, v25, v13
 v_dot2c_f32_bf16 v191, v25, v11
 v_accvgpr_read_b32 v18, a176
 v_dot2c_f32_bf16 v196, v18, v13
 v_dot2c_f32_bf16 v197, v18, v11
 v_accvgpr_read_b32 v19, a177
 v_dot2c_f32_bf16 v198, v19, v13
 v_dot2c_f32_bf16 v199, v19, v11
 v_accvgpr_read_b32 v20, a178
 v_dot2c_f32_bf16 v204, v20, v13
 v_dot2c_f32_bf16 v205, v20, v11
 v_accvgpr_read_b32 v21, a179
 v_dot2c_f32_bf16 v206, v21, v13
 v_dot2c_f32_bf16 v207, v21, v11
 v_accvgpr_read_b32 v22, a180
 v_dot2c_f32_bf16 v212, v22, v13
 v_dot2c_f32_bf16 v213, v22, v11
 v_accvgpr_read_b32 v23, a181
 v_dot2c_f32_bf16 v214, v23, v13
 v_dot2c_f32_bf16 v215, v23, v11
 v_accvgpr_read_b32 v24, a182
 v_dot2c_f32_bf16 v220, v24, v13
 v_dot2c_f32_bf16 v221, v24, v11
 v_accvgpr_read_b32 v25, a183
 v_dot2c_f32_bf16 v222, v25, v13
 v_dot2c_f32_bf16 v223, v25, v11
 v_accvgpr_read_b32 v18, a184
 v_dot2c_f32_bf16 v228, v18, v13
 v_dot2c_f32_bf16 v229, v18, v11
 v_accvgpr_read_b32 v19, a185
 v_dot2c_f32_bf16 v230, v19, v13
 v_dot2c_f32_bf16 v231, v19, v11
 v_accvgpr_read_b32 v20, a186
 v_dot2c_f32_bf16 v236, v20, v13
 v_dot2c_f32_bf16 v237, v20, v11
 v_accvgpr_read_b32 v21, a187
 v_dot2c_f32_bf16 v238, v21, v13
 v_dot2c_f32_bf16 v239, v21, v11
 v_accvgpr_read_b32 v22, a188
 v_dot2c_f32_bf16 v244, v22, v13
 v_dot2c_f32_bf16 v245, v22, v11
 v_accvgpr_read_b32 v23, a189
 v_dot2c_f32_bf16 v246, v23, v13
 v_dot2c_f32_bf16 v247, v23, v11
 v_accvgpr_read_b32 v24, a190
 v_dot2c_f32_bf16 v252, v24, v13
 v_dot2c_f32_bf16 v253, v24, v11
 v_accvgpr_read_b32 v25, a191
 v_dot2c_f32_bf16 v254, v25, v13
 v_dot2c_f32_bf16 v255, v25, v11
 s_nop 3
 s_branch L_p2
L_st0:
 s_call_b64 s[36:37], L_slow0
 s_branch L_rt0
L_st1:
 s_call_b64 s[36:37], L_slow1
 s_branch L_rt1
L_st2:
 s_call_b64 s[36:37], L_slowB
 s_branch L_rt2
L_st3:
 s_call_b64 s[36:37], L_slow1
 s_branch L_rt3
L_st4:
 s_call_b64 s[36:37], L_slow1n
 s_branch L_rt4
L_st5:
 s_call_b64 s[36:37], L_slow1
 s_branch L_rt5
L_st6:
 s_call_b64 s[36:37], L_slow0B
 s_branch L_rt6
L_st7:
 s_call_b64 s[36:37], L_slowB
 s_branch L_rt7
L_st8:
 s_call_b64 s[36:37], L_slowf
 s_branch L_rt8
L_st9:
 s_call_b64 s[36:37], L_slow1
 s_branch L_rt9
L_st10:
 s_call_b64 s[36:37], L_slowf
 s_branch L_rt10
L_st11:
 s_call_b64 s[36:37], L_slowf
 s_branch L_rt11
L_st14:
 s_call_b64 s[36:37], L_slow0B
 s_branch L_rt14
L_st12:
 s_call_b64 s[36:37], L_slow0
 s_branch L_rt12
L_st13:
 s_call_b64 s[36:37], L_slow1
 s_branch L_rt13
L_slow0:
 s_nop 7
 s_nop 3
 v_max3_f32 v10, v64, v65, v66
 v_max3_f32 v10, v67, v72, v10
 v_max3_f32 v10, v73, v74, v10
 v_max3_f32 v10, v75, v80, v10
 v_max3_f32 v10, v81, v82, v10
 v_max3_f32 v10, v83, v88, v10
 v_max3_f32 v10, v89, v90, v10
 v_max_f32 v10, v91, v10
 v_max3_f32 v11, v68, v69, v70
 v_max3_f32 v11, v71, v76, v11
 v_max3_f32 v11, v77, v78, v11
 v_max3_f32 v11, v79, v84, v11
 v_max3_f32 v11, v85, v86, v11
 v_max3_f32 v11, v87, v92, v11
 v_max3_f32 v11, v93, v94, v11
 v_max_f32 v11, v95, v11
 v_mov_b32 v12, v10
 v_mov_b32 v13, v11
 s_nop 0
 v_permlane16_swap_b32 v12, v10
 v_permlane16_swap_b32 v13, v11
 v_max_f32 v10, v12, v10
 v_max_f32 v11, v13, v11
 v_mov_b32 v12, v10
 v_mov_b32 v13, v11
 s_nop 0
 v_permlane32_swap_b32 v12, v10
 v_permlane32_swap_b32 v13, v11
 v_max_f32 v10, v12, v10
 v_max_f32 v11, v13, v11
 v_ceil_f32 v10, v10
 v_ceil_f32 v11, v11
 v_max_f32 v10, 0, v10
 v_max_f32 v11, 0, v11
 v_sub_f32 v64, v64, v10
 v_sub_f32 v65, v65, v10
 v_sub_f32 v66, v66, v10
 v_sub_f32 v67, v67, v10
 v_sub_f32 v68, v68, v11
 v_sub_f32 v69, v69, v11
 v_sub_f32 v70, v70, v11
 v_sub_f32 v71, v71, v11
 v_sub_f32 v72, v72, v10
 v_sub_f32 v73, v73, v10
 v_sub_f32 v74, v74, v10
 v_sub_f32 v75, v75, v10
 v_sub_f32 v76, v76, v11
 v_sub_f32 v77, v77, v11
 v_sub_f32 v78, v78, v11
 v_sub_f32 v79, v79, v11
 v_sub_f32 v80, v80, v10
 v_sub_f32 v81, v81, v10
 v_sub_f32 v82, v82, v10
 v_sub_f32 v83, v83, v10
 v_sub_f32 v84, v84, v11
 v_sub_f32 v85, v85, v11
 v_sub_f32 v86, v86, v11
 v_sub_f32 v87, v87, v11
 v_sub_f32 v88, v88, v10
 v_sub_f32 v89, v89, v10
 v_sub_f32 v90, v90, v10
 v_sub_f32 v91, v91, v10
 v_sub_f32 v92, v92, v11
 v_sub_f32 v93, v93, v11
 v_sub_f32 v94, v94, v11
 v_sub_f32 v95, v95, v11
 v_sub_f32 v96, v96, v10
 v_sub_f32 v97, v97, v10
 v_sub_f32 v98, v98, v10
 v_sub_f32 v99, v99, v10
 v_sub_f32 v100, v100, v11
 v_sub_f32 v101, v101, v11
 v_sub_f32 v102, v102, v11
 v_sub_f32 v103, v103, v11
 v_sub_f32 v104, v104, v10
 v_sub_f32 v105, v105, v10
 v_sub_f32 v106, v106, v10
 v_sub_f32 v107, v107, v10
 v_sub_f32 v108, v108, v11
 v_sub_f32 v109, v109, v11
 v_sub_f32 v110, v110, v11
 v_sub_f32 v111, v111, v11
 v_sub_f32 v112, v112, v10
 v_sub_f32 v113, v113, v10
 v_sub_f32 v114, v114, v10
 v_sub_f32 v115, v115, v10
 v_sub_f32 v116, v116, v11
 v_sub_f32 v117, v117, v11
 v_sub_f32 v118, v118, v11
 v_sub_f32 v119, v119, v11
 v_sub_f32 v120, v120, v10
 v_sub_f32 v121, v121, v10
 v_sub_f32 v122, v122, v10
 v_sub_f32 v123, v123, v10
 v_sub_f32 v124, v124, v11
 v_sub_f32 v125, v125, v11
 v_sub_f32 v126, v126, v11
 v_sub_f32 v127, v127, v11
 v_sub_f32 v32, v32, v10
 v_sub_f32 v33, v33, v10
 v_sub_f32 v34, v34, v10
 v_sub_f32 v35, v35, v10
 v_sub_f32 v36, v36, v11
 v_sub_f32 v37, v37, v11
 v_sub_f32 v38, v38, v11
 v_sub_f32 v39, v39, v11
 v_exp_f32 v12, -v10
 v_exp_f32 v13, -v11
 v_mul_f32 v30, v12, v30
 v_mul_f32 v31, v13, v31
 v_mul_f32 v128, v12, v128
 v_mul_f32 v129, v12, v129
 v_mul_f32 v130, v12, v130
 v_mul_f32 v131, v12, v131
 v_mul_f32 v132, v13, v132
 v_mul_f32 v133, v13, v133
 v_mul_f32 v134, v13, v134
 v_mul_f32 v135, v13, v135
 v_mul_f32 v136, v12, v136
 v_mul_f32 v137, v12, v137
 v_mul_f32 v138, v12, v138
 v_mul_f32 v139, v12, v139
 v_mul_f32 v140, v13, v140
 v_mul_f32 v141, v13, v141
 v_mul_f32 v142, v13, v142
 v_mul_f32 v143, v13, v143
 v_mul_f32 v144, v12, v144
 v_mul_f32 v145, v12, v145
 v_mul_f32 v146, v12, v146
 v_mul_f32 v147, v12, v147
 v_mul_f32 v148, v13, v148
 v_mul_f32 v149, v13, v149
 v_mul_f32 v150, v13, v150
 v_mul_f32 v151, v13, v151
 v_mul_f32 v152, v12, v152
 v_mul_f32 v153, v12, v153
 v_mul_f32 v154, v12, v154
 v_mul_f32 v155, v12, v155
 v_mul_f32 v156, v13, v156
 v_mul_f32 v157, v13, v157
 v_mul_f32 v158, v13, v158
 v_mul_f32 v159, v13, v159
 v_mul_f32 v160, v12, v160
 v_mul_f32 v161, v12, v161
 v_mul_f32 v162, v12, v162
 v_mul_f32 v163, v12, v163
 v_mul_f32 v164, v13, v164
 v_mul_f32 v165, v13, v165
 v_mul_f32 v166, v13, v166
 v_mul_f32 v167, v13, v167
 v_mul_f32 v168, v12, v168
 v_mul_f32 v169, v12, v169
 v_mul_f32 v170, v12, v170
 v_mul_f32 v171, v12, v171
 v_mul_f32 v172, v13, v172
 v_mul_f32 v173, v13, v173
 v_mul_f32 v174, v13, v174
 v_mul_f32 v175, v13, v175
 v_mul_f32 v176, v12, v176
 v_mul_f32 v177, v12, v177
 v_mul_f32 v178, v12, v178
 v_mul_f32 v179, v12, v179
 v_mul_f32 v180, v13, v180
 v_mul_f32 v181, v13, v181
 v_mul_f32 v182, v13, v182
 v_mul_f32 v183, v13, v183
 v_mul_f32 v184, v12, v184
 v_mul_f32 v185, v12, v185
 v_mul_f32 v186, v12, v186
 v_mul_f32 v187, v12, v187
 v_mul_f32 v188, v13, v188
 v_mul_f32 v189, v13, v189
 v_mul_f32 v190, v13, v190
 v_mul_f32 v191, v13, v191
 v_mul_f32 v192, v12, v192
 v_mul_f32 v193, v12, v193
 v_mul_f32 v194, v12, v194
 v_mul_f32 v195, v12, v195
 v_mul_f32 v196, v13, v196
 v_mul_f32 v197, v13, v197
 v_mul_f32 v198, v13, v198
 v_mul_f32 v199, v13, v199
 v_mul_f32 v200, v12, v200
 v_mul_f32 v201, v12, v201
 v_mul_f32 v202, v12, v202
 v_mul_f32 v203, v12, v203
 v_mul_f32 v204, v13, v204
 v_mul_f32 v205, v13, v205
 v_mul_f32 v206, v13, v206
 v_mul_f32 v207, v13, v207
 v_mul_f32 v208, v12, v208
 v_mul_f32 v209, v12, v209
 v_mul_f32 v210, v12, v210
 v_mul_f32 v211, v12, v211
 v_mul_f32 v212, v13, v212
 v_mul_f32 v213, v13, v213
 v_mul_f32 v214, v13, v214
 v_mul_f32 v215, v13, v215
 v_mul_f32 v216, v12, v216
 v_mul_f32 v217, v12, v217
 v_mul_f32 v218, v12, v218
 v_mul_f32 v219, v12, v219
 v_mul_f32 v220, v13, v220
 v_mul_f32 v221, v13, v221
 v_mul_f32 v222, v13, v222
 v_mul_f32 v223, v13, v223
 v_mul_f32 v224, v12, v224
 v_mul_f32 v225, v12, v225
 v_mul_f32 v226, v12, v226
 v_mul_f32 v227, v12, v227
 v_mul_f32 v228, v13, v228
 v_mul_f32 v229, v13, v229
 v_mul_f32 v230, v13, v230
 v_mul_f32 v231, v13, v231
 v_mul_f32 v232, v12, v232
 v_mul_f32 v233, v12, v233
 v_mul_f32 v234, v12, v234
 v_mul_f32 v235, v12, v235
 v_mul_f32 v236, v13, v236
 v_mul_f32 v237, v13, v237
 v_mul_f32 v238, v13, v238
 v_mul_f32 v239, v13, v239
 v_mul_f32 v240, v12, v240
 v_mul_f32 v241, v12, v241
 v_mul_f32 v242, v12, v242
 v_mul_f32 v243, v12, v243
 v_mul_f32 v244, v13, v244
 v_mul_f32 v245, v13, v245
 v_mul_f32 v246, v13, v246
 v_mul_f32 v247, v13, v247
 v_mul_f32 v248, v12, v248
 v_mul_f32 v249, v12, v249
 v_mul_f32 v250, v12, v250
 v_mul_f32 v251, v12, v251
 v_mul_f32 v252, v13, v252
 v_mul_f32 v253, v13, v253
 v_mul_f32 v254, v13, v254
 v_mul_f32 v255, v13, v255
 v_exp_f32 v18, v64
 v_exp_f32 v19, v65
 v_exp_f32 v20, v66
 v_add_f32 v26, v18, v19
 v_cvt_pk_bf16_f32 v40, v18, v19
 v_exp_f32 v21, v67
 v_exp_f32 v22, v72
 v_add_f32 v26, v20, v26
 v_cvt_pk_bf16_f32 v41, v20, v21
 v_exp_f32 v23, v73
 v_add_f32 v26, v21, v26
 v_exp_f32 v24, v74
 v_add_f32 v26, v22, v26
 v_cvt_pk_bf16_f32 v42, v22, v23
 v_exp_f32 v25, v75
 v_add_f32 v26, v23, v26
 v_exp_f32 v18, v68
 v_add_f32 v26, v24, v26
 v_cvt_pk_bf16_f32 v43, v24, v25
 v_exp_f32 v19, v69
 v_add_f32 v26, v25, v26
 v_exp_f32 v20, v70
 v_add_f32 v27, v18, v19
 v_cvt_pk_bf16_f32 v44, v18, v19
 v_exp_f32 v21, v71
 v_exp_f32 v22, v76
 v_add_f32 v27, v20, v27
 v_cvt_pk_bf16_f32 v45, v20, v21
 v_exp_f32 v23, v77
 v_add_f32 v27, v21, v27
 v_exp_f32 v24, v78
 v_add_f32 v27, v22, v27
 v_cvt_pk_bf16_f32 v46, v22, v23
 v_exp_f32 v25, v79
 v_add_f32 v27, v23, v27
 v_add_f32 v27, v24, v27
 v_cvt_pk_bf16_f32 v47, v24, v25
 v_add_f32 v27, v25, v27
 v_exp_f32 v18, v80
 v_exp_f32 v19, v81
 v_exp_f32 v20, v82
 v_add_f32 v26, v18, v26
 v_cvt_pk_bf16_f32 v56, v18, v19
 v_exp_f32 v21, v83
 v_add_f32 v26, v19, v26
 v_exp_f32 v22, v88
 v_add_f32 v26, v20, v26
 v_cvt_pk_bf16_f32 v57, v20, v21
 v_exp_f32 v23, v89
 v_add_f32 v26, v21, v26
 v_exp_f32 v24, v90
 v_add_f32 v26, v22, v26
 v_cvt_pk_bf16_f32 v58, v22, v23
 v_exp_f32 v25, v91
 v_add_f32 v26, v23, v26
 v_exp_f32 v18, v84
 v_add_f32 v26, v24, v26
 v_cvt_pk_bf16_f32 v59, v24, v25
 v_exp_f32 v19, v85
 v_add_f32 v26, v25, v26
 v_exp_f32 v20, v86
 v_add_f32 v27, v18, v27
 v_cvt_pk_bf16_f32 v60, v18, v19
 v_exp_f32 v21, v87
 v_add_f32 v27, v19, v27
 v_exp_f32 v22, v92
 v_add_f32 v27, v20, v27
 v_cvt_pk_bf16_f32 v61, v20, v21
 v_exp_f32 v23, v93
 v_add_f32 v27, v21, v27
 v_exp_f32 v24, v94
 v_add_f32 v27, v22, v27
 v_cvt_pk_bf16_f32 v62, v22, v23
 v_exp_f32 v25, v95
 v_add_f32 v27, v23, v27
 v_add_f32 v27, v24, v27
 v_cvt_pk_bf16_f32 v63, v24, v25
 v_add_f32 v27, v25, v27
 s_nop 3
 s_setpc_b64 s[36:37]
L_slow1:
 s_nop 7
 s_nop 3
 v_max3_f32 v10, v96, v97, v98
 v_max3_f32 v10, v99, v104, v10
 v_max3_f32 v10, v105, v106, v10
 v_max3_f32 v10, v107, v112, v10
 v_max3_f32 v10, v113, v114, v10
 v_max3_f32 v10, v115, v120, v10
 v_max3_f32 v10, v121, v122, v10
 v_max_f32 v10, v123, v10
 v_max3_f32 v11, v100, v101, v102
 v_max3_f32 v11, v103, v108, v11
 v_max3_f32 v11, v109, v110, v11
 v_max3_f32 v11, v111, v116, v11
 v_max3_f32 v11, v117, v118, v11
 v_max3_f32 v11, v119, v124, v11
 v_max3_f32 v11, v125, v126, v11
 v_max_f32 v11, v127, v11
 v_mov_b32 v12, v10
 v_mov_b32 v13, v11
 s_nop 0
 v_permlane16_swap_b32 v12, v10
 v_permlane16_swap_b32 v13, v11
 v_max_f32 v10, v12, v10
 v_max_f32 v11, v13, v11
 v_mov_b32 v12, v10
 v_mov_b32 v13, v11
 s_nop 0
 v_permlane32_swap_b32 v12, v10
 v_permlane32_swap_b32 v13, v11
 v_max_f32 v10, v12, v10
 v_max_f32 v11, v13, v11
 v_ceil_f32 v10, v10
 v_ceil_f32 v11, v11
 v_max_f32 v10, 0, v10
 v_max_f32 v11, 0, v11
 v_sub_f32 v96, v96, v10
 v_sub_f32 v97, v97, v10
 v_sub_f32 v98, v98, v10
 v_sub_f32 v99, v99, v10
 v_sub_f32 v100, v100, v11
 v_sub_f32 v101, v101, v11
 v_sub_f32 v102, v102, v11
 v_sub_f32 v103, v103, v11
 v_sub_f32 v104, v104, v10
 v_sub_f32 v105, v105, v10
 v_sub_f32 v106, v106, v10
 v_sub_f32 v107, v107, v10
 v_sub_f32 v108, v108, v11
 v_sub_f32 v109, v109, v11
 v_sub_f32 v110, v110, v11
 v_sub_f32 v111, v111, v11
 v_sub_f32 v112, v112, v10
 v_sub_f32 v113, v113, v10
 v_sub_f32 v114, v114, v10
 v_sub_f32 v115, v115, v10
 v_sub_f32 v116, v116, v11
 v_sub_f32 v117, v117, v11
 v_sub_f32 v118, v118, v11
 v_sub_f32 v119, v119, v11
 v_sub_f32 v120, v120, v10
 v_sub_f32 v121, v121, v10
 v_sub_f32 v122, v122, v10
 v_sub_f32 v123, v123, v10
 v_sub_f32 v124, v124, v11
 v_sub_f32 v125, v125, v11
 v_sub_f32 v126, v126, v11
 v_sub_f32 v127, v127, v11
 v_sub_f32 v64, v64, v10
 v_sub_f32 v65, v65, v10
 v_sub_f32 v66, v66, v10
 v_sub_f32 v67, v67, v10
 v_sub_f32 v68, v68, v11
 v_sub_f32 v69, v69, v11
 v_sub_f32 v70, v70, v11
 v_sub_f32 v71, v71, v11
 v_sub_f32 v72, v72, v10
 v_sub_f32 v73, v73, v10
 v_sub_f32 v74, v74, v10
 v_sub_f32 v75, v75, v10
 v_sub_f32 v76, v76, v11
 v_sub_f32 v77, v77, v11
 v_sub_f32 v78, v78, v11
 v_sub_f32 v79, v79, v11
 v_sub_f32 v80, v80, v10
 v_sub_f32 v81, v81, v10
 v_sub_f32 v82, v82, v10
 v_sub_f32 v83, v83, v10
 v_sub_f32 v84, v84, v11
 v_sub_f32 v85, v85, v11
 v_sub_f32 v86, v86, v11
 v_sub_f32 v87, v87, v11
 v_sub_f32 v88, v88, v10
 v_sub_f32 v89, v89, v10
 v_sub_f32 v90, v90, v10
 v_sub_f32 v91, v91, v10
 v_sub_f32 v92, v92, v11
 v_sub_f32 v93, v93, v11
 v_sub_f32 v94, v94, v11
 v_sub_f32 v95, v95, v11
 v_sub_f32 v32, v32, v10
 v_sub_f32 v33, v33, v10
 v_sub_f32 v34, v34, v10
 v_sub_f32 v35, v35, v10
 v_sub_f32 v36, v36, v11
 v_sub_f32 v37, v37, v11
 v_sub_f32 v38, v38, v11
 v_sub_f32 v39, v39, v11
 v_exp_f32 v12, -v10
 v_exp_f32 v13, -v11
 v_mul_f32 v30, v12, v30
 v_mul_f32 v31, v13, v31
 v_mul_f32 v128, v12, v128
 v_mul_f32 v129, v12, v129
 v_mul_f32 v130, v12, v130
 v_mul_f32 v131, v12, v131
 v_mul_f32 v132, v13, v132
 v_mul_f32 v133, v13, v133
 v_mul_f32 v134, v13, v134
 v_mul_f32 v135, v13, v135
 v_mul_f32 v136, v12, v136
 v_mul_f32 v137, v12, v137
 v_mul_f32 v138, v12, v138
 v_mul_f32 v139, v12, v139
 v_mul_f32 v140, v13, v140
 v_mul_f32 v141, v13, v141
 v_mul_f32 v142, v13, v142
 v_mul_f32 v143, v13, v143
 v_mul_f32 v144, v12, v144
 v_mul_f32 v145, v12, v145
 v_mul_f32 v146, v12, v146
 v_mul_f32 v147, v12, v147
 v_mul_f32 v148, v13, v148
 v_mul_f32 v149, v13, v149
 v_mul_f32 v150, v13, v150
 v_mul_f32 v151, v13, v151
 v_mul_f32 v152, v12, v152
 v_mul_f32 v153, v12, v153
 v_mul_f32 v154, v12, v154
 v_mul_f32 v155, v12, v155
 v_mul_f32 v156, v13, v156
 v_mul_f32 v157, v13, v157
 v_mul_f32 v158, v13, v158
 v_mul_f32 v159, v13, v159
 v_mul_f32 v160, v12, v160
 v_mul_f32 v161, v12, v161
 v_mul_f32 v162, v12, v162
 v_mul_f32 v163, v12, v163
 v_mul_f32 v164, v13, v164
 v_mul_f32 v165, v13, v165
 v_mul_f32 v166, v13, v166
 v_mul_f32 v167, v13, v167
 v_mul_f32 v168, v12, v168
 v_mul_f32 v169, v12, v169
 v_mul_f32 v170, v12, v170
 v_mul_f32 v171, v12, v171
 v_mul_f32 v172, v13, v172
 v_mul_f32 v173, v13, v173
 v_mul_f32 v174, v13, v174
 v_mul_f32 v175, v13, v175
 v_mul_f32 v176, v12, v176
 v_mul_f32 v177, v12, v177
 v_mul_f32 v178, v12, v178
 v_mul_f32 v179, v12, v179
 v_mul_f32 v180, v13, v180
 v_mul_f32 v181, v13, v181
 v_mul_f32 v182, v13, v182
 v_mul_f32 v183, v13, v183
 v_mul_f32 v184, v12, v184
 v_mul_f32 v185, v12, v185
 v_mul_f32 v186, v12, v186
 v_mul_f32 v187, v12, v187
 v_mul_f32 v188, v13, v188
 v_mul_f32 v189, v13, v189
 v_mul_f32 v190, v13, v190
 v_mul_f32 v191, v13, v191
 v_mul_f32 v192, v12, v192
 v_mul_f32 v193, v12, v193
 v_mul_f32 v194, v12, v194
 v_mul_f32 v195, v12, v195
 v_mul_f32 v196, v13, v196
 v_mul_f32 v197, v13, v197
 v_mul_f32 v198, v13, v198
 v_mul_f32 v199, v13, v199
 v_mul_f32 v200, v12, v200
 v_mul_f32 v201, v12, v201
 v_mul_f32 v202, v12, v202
 v_mul_f32 v203, v12, v203
 v_mul_f32 v204, v13, v204
 v_mul_f32 v205, v13, v205
 v_mul_f32 v206, v13, v206
 v_mul_f32 v207, v13, v207
 v_mul_f32 v208, v12, v208
 v_mul_f32 v209, v12, v209
 v_mul_f32 v210, v12, v210
 v_mul_f32 v211, v12, v211
 v_mul_f32 v212, v13, v212
 v_mul_f32 v213, v13, v213
 v_mul_f32 v214, v13, v214
 v_mul_f32 v215, v13, v215
 v_mul_f32 v216, v12, v216
 v_mul_f32 v217, v12, v217
 v_mul_f32 v218, v12, v218
 v_mul_f32 v219, v12, v219
 v_mul_f32 v220, v13, v220
 v_mul_f32 v221, v13, v221
 v_mul_f32 v222, v13, v222
 v_mul_f32 v223, v13, v223
 v_mul_f32 v224, v12, v224
 v_mul_f32 v225, v12, v225
 v_mul_f32 v226, v12, v226
 v_mul_f32 v227, v12, v227
 v_mul_f32 v228, v13, v228
 v_mul_f32 v229, v13, v229
 v_mul_f32 v230, v13, v230
 v_mul_f32 v231, v13, v231
 v_mul_f32 v232, v12, v232
 v_mul_f32 v233, v12, v233
 v_mul_f32 v234, v12, v234
 v_mul_f32 v235, v12, v235
 v_mul_f32 v236, v13, v236
 v_mul_f32 v237, v13, v237
 v_mul_f32 v238, v13, v238
 v_mul_f32 v239, v13, v239
 v_mul_f32 v240, v12, v240
 v_mul_f32 v241, v12, v241
 v_mul_f32 v242, v12, v242
 v_mul_f32 v243, v12, v243
 v_mul_f32 v244, v13, v244
 v_mul_f32 v245, v13, v245
 v_mul_f32 v246, v13, v246
 v_mul_f32 v247, v13, v247
 v_mul_f32 v248, v12, v248
 v_mul_f32 v249, v12, v249
 v_mul_f32 v250, v12, v250
 v_mul_f32 v251, v12, v251
 v_mul_f32 v252, v13, v252
 v_mul_f32 v253, v13, v253
 v_mul_f32 v254, v13, v254
 v_mul_f32 v255, v13, v255
 v_exp_f32 v18, v96
 v_exp_f32 v19, v97
 v_exp_f32 v20, v98
 v_add_f32 v28, v18, v19
 v_cvt_pk_bf16_f32 v48, v18, v19
 v_exp_f32 v21, v99
 v_exp_f32 v22, v104
 v_add_f32 v28, v20, v28
 v_cvt_pk_bf16_f32 v49, v20, v21
 v_exp_f32 v23, v105
 v_add_f32 v28, v21, v28
 v_exp_f32 v24, v106
 v_add_f32 v28, v22, v28
 v_cvt_pk_bf16_f32 v50, v22, v23
 v_exp_f32 v25, v107
 v_add_f32 v28, v23, v28
 v_exp_f32 v18, v100
 v_add_f32 v28, v24, v28
 v_cvt_pk_bf16_f32 v51, v24, v25
 v_exp_f32 v19, v101
 v_add_f32 v28, v25, v28
 v_exp_f32 v20, v102
 v_add_f32 v29, v18, v19
 v_cvt_pk_bf16_f32 v52, v18, v19
 v_exp_f32 v21, v103
 v_exp_f32 v22, v108
 v_add_f32 v29, v20, v29
 v_cvt_pk_bf16_f32 v53, v20, v21
 v_exp_f32 v23, v109
 v_add_f32 v29, v21, v29
 v_exp_f32 v24, v110
 v_add_f32 v29, v22, v29
 v_cvt_pk_bf16_f32 v54, v22, v23
 v_exp_f32 v25, v111
 v_add_f32 v29, v23, v29
 v_add_f32 v29, v24, v29
 v_cvt_pk_bf16_f32 v55, v24, v25
 v_add_f32 v29, v25, v29
 v_exp_f32 v18, v112
 v_exp_f32 v19, v113
 v_exp_f32 v20, v114
 v_add_f32 v28, v18, v28
 v_cvt_pk_bf16_f32 v56, v18, v19
 v_exp_f32 v21, v115
 v_add_f32 v28, v19, v28
 v_exp_f32 v22, v120
 v_add_f32 v28, v20, v28
 v_cvt_pk_bf16_f32 v57, v20, v21
 v_exp_f32 v23, v121
 v_add_f32 v28, v21, v28
 v_exp_f32 v24, v122
 v_add_f32 v28, v22, v28
 v_cvt_pk_bf16_f32 v58, v22, v23
 v_exp_f32 v25, v123
 v_add_f32 v28, v23, v28
 v_exp_f32 v18, v116
 v_add_f32 v28, v24, v28
 v_cvt_pk_bf16_f32 v59, v24, v25
 v_exp_f32 v19, v117
 v_add_f32 v28, v25, v28
 v_exp_f32 v20, v118
 v_add_f32 v29, v18, v29
 v_cvt_pk_bf16_f32 v60, v18, v19
 v_exp_f32 v21, v119
 v_add_f32 v29, v19, v29
 v_exp_f32 v22, v124
 v_add_f32 v29, v20, v29
 v_cvt_pk_bf16_f32 v61, v20, v21
 v_exp_f32 v23, v125
 v_add_f32 v29, v21, v29
 v_exp_f32 v24, v126
 v_add_f32 v29, v22, v29
 v_cvt_pk_bf16_f32 v62, v22, v23
 v_exp_f32 v25, v127
 v_add_f32 v29, v23, v29
 v_add_f32 v29, v24, v29
 v_cvt_pk_bf16_f32 v63, v24, v25
 v_add_f32 v29, v25, v29
 s_nop 3
 s_setpc_b64 s[36:37]
L_slow1n:
 s_nop 7
 s_nop 3
 v_max3_f32 v10, v96, v97, v98
 v_max3_f32 v10, v99, v104, v10
 v_max3_f32 v10, v105, v106, v10
 v_max3_f32 v10, v107, v112, v10
 v_max3_f32 v10, v113, v114, v10
 v_max3_f32 v10, v115, v120, v10
 v_max3_f32 v10, v121, v122, v10
 v_max_f32 v10, v123, v10
 v_max3_f32 v11, v100, v101, v102
 v_max3_f32 v11, v103, v108, v11
 v_max3_f32 v11, v109, v110, v11
 v_max3_f32 v11, v111, v116, v11
 v_max3_f32 v11, v117, v118, v11
 v_max3_f32 v11, v119, v124, v11
 v_max3_f32 v11, v125, v126, v11
 v_max_f32 v11, v127, v11
 v_mov_b32 v12, v10
 v_mov_b32 v13, v11
 s_nop 0
 v_permlane16_swap_b32 v12, v10
 v_permlane16_swap_b32 v13, v11
 v_max_f32 v10, v12, v10
 v_max_f32 v11, v13, v11
 v_mov_b32 v12, v10
 v_mov_b32 v13, v11
 s_nop 0
 v_permlane32_swap_b32 v12, v10
 v_permlane32_swap_b32 v13, v11
 v_max_f32 v10, v12, v10
 v_max_f32 v11, v13, v11
 v_ceil_f32 v10, v10
 v_ceil_f32 v11, v11
 v_max_f32 v10, 0, v10
 v_max_f32 v11, 0, v11
 v_sub_f32 v96, v96, v10
 v_sub_f32 v97, v97, v10
 v_sub_f32 v98, v98, v10
 v_sub_f32 v99, v99, v10
 v_sub_f32 v100, v100, v11
 v_sub_f32 v101, v101, v11
 v_sub_f32 v102, v102, v11
 v_sub_f32 v103, v103, v11
 v_sub_f32 v104, v104, v10
 v_sub_f32 v105, v105, v10
 v_sub_f32 v106, v106, v10
 v_sub_f32 v107, v107, v10
 v_sub_f32 v108, v108, v11
 v_sub_f32 v109, v109, v11
 v_sub_f32 v110, v110, v11
 v_sub_f32 v111, v111, v11
 v_sub_f32 v112, v112, v10
 v_sub_f32 v113, v113, v10
 v_sub_f32 v114, v114, v10
 v_sub_f32 v115, v115, v10
 v_sub_f32 v116, v116, v11
 v_sub_f32 v117, v117, v11
 v_sub_f32 v118, v118, v11
 v_sub_f32 v119, v119, v11
 v_sub_f32 v120, v120, v10
 v_sub_f32 v121, v121, v10
 v_sub_f32 v122, v122, v10
 v_sub_f32 v123, v123, v10
 v_sub_f32 v124, v124, v11
 v_sub_f32 v125, v125, v11
 v_sub_f32 v126, v126, v11
 v_sub_f32 v127, v127, v11
 v_sub_f32 v32, v32, v10
 v_sub_f32 v33, v33, v10
 v_sub_f32 v34, v34, v10
 v_sub_f32 v35, v35, v10
 v_sub_f32 v36, v36, v11
 v_sub_f32 v37, v37, v11
 v_sub_f32 v38, v38, v11
 v_sub_f32 v39, v39, v11
 v_exp_f32 v12, -v10
 v_exp_f32 v13, -v11
 v_mul_f32 v30, v12, v30
 v_mul_f32 v31, v13, v31
 v_mul_f32 v128, v12, v128
 v_mul_f32 v129, v12, v129
 v_mul_f32 v130, v12, v130
 v_mul_f32 v131, v12, v131
 v_mul_f32 v132, v13, v132
 v_mul_f32 v133, v13, v133
 v_mul_f32 v134, v13, v134
 v_mul_f32 v135, v13, v135
 v_mul_f32 v136, v12, v136
 v_mul_f32 v137, v12, v137
 v_mul_f32 v138, v12, v138
 v_mul_f32 v139, v12, v139
 v_mul_f32 v140, v13, v140
 v_mul_f32 v141, v13, v141
 v_mul_f32 v142, v13, v142
 v_mul_f32 v143, v13, v143
 v_mul_f32 v144, v12, v144
 v_mul_f32 v145, v12, v145
 v_mul_f32 v146, v12, v146
 v_mul_f32 v147, v12, v147
 v_mul_f32 v148, v13, v148
 v_mul_f32 v149, v13, v149
 v_mul_f32 v150, v13, v150
 v_mul_f32 v151, v13, v151
 v_mul_f32 v152, v12, v152
 v_mul_f32 v153, v12, v153
 v_mul_f32 v154, v12, v154
 v_mul_f32 v155, v12, v155
 v_mul_f32 v156, v13, v156
 v_mul_f32 v157, v13, v157
 v_mul_f32 v158, v13, v158
 v_mul_f32 v159, v13, v159
 v_mul_f32 v160, v12, v160
 v_mul_f32 v161, v12, v161
 v_mul_f32 v162, v12, v162
 v_mul_f32 v163, v12, v163
 v_mul_f32 v164, v13, v164
 v_mul_f32 v165, v13, v165
 v_mul_f32 v166, v13, v166
 v_mul_f32 v167, v13, v167
 v_mul_f32 v168, v12, v168
 v_mul_f32 v169, v12, v169
 v_mul_f32 v170, v12, v170
 v_mul_f32 v171, v12, v171
 v_mul_f32 v172, v13, v172
 v_mul_f32 v173, v13, v173
 v_mul_f32 v174, v13, v174
 v_mul_f32 v175, v13, v175
 v_mul_f32 v176, v12, v176
 v_mul_f32 v177, v12, v177
 v_mul_f32 v178, v12, v178
 v_mul_f32 v179, v12, v179
 v_mul_f32 v180, v13, v180
 v_mul_f32 v181, v13, v181
 v_mul_f32 v182, v13, v182
 v_mul_f32 v183, v13, v183
 v_mul_f32 v184, v12, v184
 v_mul_f32 v185, v12, v185
 v_mul_f32 v186, v12, v186
 v_mul_f32 v187, v12, v187
 v_mul_f32 v188, v13, v188
 v_mul_f32 v189, v13, v189
 v_mul_f32 v190, v13, v190
 v_mul_f32 v191, v13, v191
 v_mul_f32 v192, v12, v192
 v_mul_f32 v193, v12, v193
 v_mul_f32 v194, v12, v194
 v_mul_f32 v195, v12, v195
 v_mul_f32 v196, v13, v196
 v_mul_f32 v197, v13, v197
 v_mul_f32 v198, v13, v198
 v_mul_f32 v199, v13, v199
 v_mul_f32 v200, v12, v200
 v_mul_f32 v201, v12, v201
 v_mul_f32 v202, v12, v202
 v_mul_f32 v203, v12, v203
 v_mul_f32 v204, v13, v204
 v_mul_f32 v205, v13, v205
 v_mul_f32 v206, v13, v206
 v_mul_f32 v207, v13, v207
 v_mul_f32 v208, v12, v208
 v_mul_f32 v209, v12, v209
 v_mul_f32 v210, v12, v210
 v_mul_f32 v211, v12, v211
 v_mul_f32 v212, v13, v212
 v_mul_f32 v213, v13, v213
 v_mul_f32 v214, v13, v214
 v_mul_f32 v215, v13, v215
 v_mul_f32 v216, v12, v216
 v_mul_f32 v217, v12, v217
 v_mul_f32 v218, v12, v218
 v_mul_f32 v219, v12, v219
 v_mul_f32 v220, v13, v220
 v_mul_f32 v221, v13, v221
 v_mul_f32 v222, v13, v222
 v_mul_f32 v223, v13, v223
 v_mul_f32 v224, v12, v224
 v_mul_f32 v225, v12, v225
 v_mul_f32 v226, v12, v226
 v_mul_f32 v227, v12, v227
 v_mul_f32 v228, v13, v228
 v_mul_f32 v229, v13, v229
 v_mul_f32 v230, v13, v230
 v_mul_f32 v231, v13, v231
 v_mul_f32 v232, v12, v232
 v_mul_f32 v233, v12, v233
 v_mul_f32 v234, v12, v234
 v_mul_f32 v235, v12, v235
 v_mul_f32 v236, v13, v236
 v_mul_f32 v237, v13, v237
 v_mul_f32 v238, v13, v238
 v_mul_f32 v239, v13, v239
 v_mul_f32 v240, v12, v240
 v_mul_f32 v241, v12, v241
 v_mul_f32 v242, v12, v242
 v_mul_f32 v243, v12, v243
 v_mul_f32 v244, v13, v244
 v_mul_f32 v245, v13, v245
 v_mul_f32 v246, v13, v246
 v_mul_f32 v247, v13, v247
 v_mul_f32 v248, v12, v248
 v_mul_f32 v249, v12, v249
 v_mul_f32 v250, v12, v250
 v_mul_f32 v251, v12, v251
 v_mul_f32 v252, v13, v252
 v_mul_f32 v253, v13, v253
 v_mul_f32 v254, v13, v254
 v_mul_f32 v255, v13, v255
 v_exp_f32 v18, v96
 v_exp_f32 v19, v97
 v_exp_f32 v20, v98
 v_add_f32 v28, v18, v19
 v_cvt_pk_bf16_f32 v48, v18, v19
 v_exp_f32 v21, v99
 v_exp_f32 v22, v104
 v_add_f32 v28, v20, v28
 v_cvt_pk_bf16_f32 v49, v20, v21
 v_exp_f32 v23, v105
 v_add_f32 v28, v21, v28
 v_exp_f32 v24, v106
 v_add_f32 v28, v22, v28
 v_cvt_pk_bf16_f32 v50, v22, v23
 v_exp_f32 v25, v107
 v_add_f32 v28, v23, v28
 v_exp_f32 v18, v100
 v_add_f32 v28, v24, v28
 v_cvt_pk_bf16_f32 v51, v24, v25
 v_exp_f32 v19, v101
 v_add_f32 v28, v25, v28
 v_exp_f32 v20, v102
 v_add_f32 v29, v18, v19
 v_cvt_pk_bf16_f32 v52, v18, v19
 v_exp_f32 v21, v103
 v_exp_f32 v22, v108
 v_add_f32 v29, v20, v29
 v_cvt_pk_bf16_f32 v53, v20, v21
 v_exp_f32 v23, v109
 v_add_f32 v29, v21, v29
 v_exp_f32 v24, v110
 v_add_f32 v29, v22, v29
 v_cvt_pk_bf16_f32 v54, v22, v23
 v_exp_f32 v25, v111
 v_add_f32 v29, v23, v29
 v_add_f32 v29, v24, v29
 v_cvt_pk_bf16_f32 v55, v24, v25
 v_add_f32 v29, v25, v29
 v_exp_f32 v18, v112
 v_exp_f32 v19, v113
 v_exp_f32 v20, v114
 v_add_f32 v28, v18, v28
 v_cvt_pk_bf16_f32 v56, v18, v19
 v_exp_f32 v21, v115
 v_add_f32 v28, v19, v28
 v_exp_f32 v22, v120
 v_add_f32 v28, v20, v28
 v_cvt_pk_bf16_f32 v57, v20, v21
 v_exp_f32 v23, v121
 v_add_f32 v28, v21, v28
 v_exp_f32 v24, v122
 v_add_f32 v28, v22, v28
 v_cvt_pk_bf16_f32 v58, v22, v23
 v_exp_f32 v25, v123
 v_add_f32 v28, v23, v28
 v_exp_f32 v18, v116
 v_add_f32 v28, v24, v28
 v_cvt_pk_bf16_f32 v59, v24, v25
 v_exp_f32 v19, v117
 v_add_f32 v28, v25, v28
 v_exp_f32 v20, v118
 v_add_f32 v29, v18, v29
 v_cvt_pk_bf16_f32 v60, v18, v19
 v_exp_f32 v21, v119
 v_add_f32 v29, v19, v29
 v_exp_f32 v22, v124
 v_add_f32 v29, v20, v29
 v_cvt_pk_bf16_f32 v61, v20, v21
 v_exp_f32 v23, v125
 v_add_f32 v29, v21, v29
 v_exp_f32 v24, v126
 v_add_f32 v29, v22, v29
 v_cvt_pk_bf16_f32 v62, v22, v23
 v_exp_f32 v25, v127
 v_add_f32 v29, v23, v29
 v_add_f32 v29, v24, v29
 v_cvt_pk_bf16_f32 v63, v24, v25
 v_add_f32 v29, v25, v29
 s_nop 3
 s_setpc_b64 s[36:37]
L_slow0B:
 s_nop 7
 s_nop 3
 v_max3_f32 v10, v64, v65, v66
 v_max3_f32 v10, v67, v72, v10
 v_max3_f32 v10, v73, v74, v10
 v_max3_f32 v10, v75, v80, v10
 v_max3_f32 v10, v81, v82, v10
 v_max3_f32 v10, v83, v88, v10
 v_max3_f32 v10, v89, v90, v10
 v_max_f32 v10, v91, v10
 v_max3_f32 v11, v68, v69, v70
 v_max3_f32 v11, v71, v76, v11
 v_max3_f32 v11, v77, v78, v11
 v_max3_f32 v11, v79, v84, v11
 v_max3_f32 v11, v85, v86, v11
 v_max3_f32 v11, v87, v92, v11
 v_max3_f32 v11, v93, v94, v11
 v_max_f32 v11, v95, v11
 v_mov_b32 v12, v10
 v_mov_b32 v13, v11
 s_nop 0
 v_permlane16_swap_b32 v12, v10
 v_permlane16_swap_b32 v13, v11
 v_max_f32 v10, v12, v10
 v_max_f32 v11, v13, v11
 v_mov_b32 v12, v10
 v_mov_b32 v13, v11
 s_nop 0
 v_permlane32_swap_b32 v12, v10
 v_permlane32_swap_b32 v13, v11
 v_max_f32 v10, v12, v10
 v_max_f32 v11, v13, v11
 v_ceil_f32 v10, v10
 v_ceil_f32 v11, v11
 v_max_f32 v10, 0, v10
 v_max_f32 v11, 0, v11
 v_sub_f32 v64, v64, v10
 v_sub_f32 v65, v65, v10
 v_sub_f32 v66, v66, v10
 v_sub_f32 v67, v67, v10
 v_sub_f32 v68, v68, v11
 v_sub_f32 v69, v69, v11
 v_sub_f32 v70, v70, v11
 v_sub_f32 v71, v71, v11
 v_sub_f32 v72, v72, v10
 v_sub_f32 v73, v73, v10
 v_sub_f32 v74, v74, v10
 v_sub_f32 v75, v75, v10
 v_sub_f32 v76, v76, v11
 v_sub_f32 v77, v77, v11
 v_sub_f32 v78, v78, v11
 v_sub_f32 v79, v79, v11
 v_sub_f32 v80, v80, v10
 v_sub_f32 v81, v81, v10
 v_sub_f32 v82, v82, v10
 v_sub_f32 v83, v83, v10
 v_sub_f32 v84, v84, v11
 v_sub_f32 v85, v85, v11
 v_sub_f32 v86, v86, v11
 v_sub_f32 v87, v87, v11
 v_sub_f32 v88, v88, v10
 v_sub_f32 v89, v89, v10
 v_sub_f32 v90, v90, v10
 v_sub_f32 v91, v91, v10
 v_sub_f32 v92, v92, v11
 v_sub_f32 v93, v93, v11
 v_sub_f32 v94, v94, v11
 v_sub_f32 v95, v95, v11
 v_sub_f32 v100, v100, v11
 v_sub_f32 v101, v101, v11
 v_sub_f32 v102, v102, v11
 v_sub_f32 v103, v103, v11
 v_sub_f32 v108, v108, v11
 v_sub_f32 v109, v109, v11
 v_sub_f32 v110, v110, v11
 v_sub_f32 v111, v111, v11
 v_sub_f32 v116, v116, v11
 v_sub_f32 v117, v117, v11
 v_sub_f32 v118, v118, v11
 v_sub_f32 v119, v119, v11
 v_sub_f32 v124, v124, v11
 v_sub_f32 v125, v125, v11
 v_sub_f32 v126, v126, v11
 v_sub_f32 v127, v127, v11
 v_sub_f32 v32, v32, v10
 v_sub_f32 v33, v33, v10
 v_sub_f32 v34, v34, v10
 v_sub_f32 v35, v35, v10
 v_sub_f32 v36, v36, v11
 v_sub_f32 v37, v37, v11
 v_sub_f32 v38, v38, v11
 v_sub_f32 v39, v39, v11
 v_exp_f32 v12, -v10
 v_exp_f32 v13, -v11
 v_mul_f32 v30, v12, v30
 v_mul_f32 v31, v13, v31
 v_mul_f32 v128, v12, v128
 v_mul_f32 v129, v12, v129
 v_mul_f32 v130, v12, v130
 v_mul_f32 v131, v12, v131
 v_mul_f32 v132, v13, v132
 v_mul_f32 v133, v13, v133
 v_mul_f32 v134, v13, v134
 v_mul_f32 v135, v13, v135
 v_mul_f32 v136, v12, v136
 v_mul_f32 v137, v12, v137
 v_mul_f32 v138, v12, v138
 v_mul_f32 v139, v12, v139
 v_mul_f32 v140, v13, v140
 v_mul_f32 v141, v13, v141
 v_mul_f32 v142, v13, v142
 v_mul_f32 v143, v13, v143
 v_mul_f32 v144, v12, v144
 v_mul_f32 v145, v12, v145
 v_mul_f32 v146, v12, v146
 v_mul_f32 v147, v12, v147
 v_mul_f32 v148, v13, v148
 v_mul_f32 v149, v13, v149
 v_mul_f32 v150, v13, v150
 v_mul_f32 v151, v13, v151
 v_mul_f32 v152, v12, v152
 v_mul_f32 v153, v12, v153
 v_mul_f32 v154, v12, v154
 v_mul_f32 v155, v12, v155
 v_mul_f32 v156, v13, v156
 v_mul_f32 v157, v13, v157
 v_mul_f32 v158, v13, v158
 v_mul_f32 v159, v13, v159
 v_mul_f32 v160, v12, v160
 v_mul_f32 v161, v12, v161
 v_mul_f32 v162, v12, v162
 v_mul_f32 v163, v12, v163
 v_mul_f32 v164, v13, v164
 v_mul_f32 v165, v13, v165
 v_mul_f32 v166, v13, v166
 v_mul_f32 v167, v13, v167
 v_mul_f32 v168, v12, v168
 v_mul_f32 v169, v12, v169
 v_mul_f32 v170, v12, v170
 v_mul_f32 v171, v12, v171
 v_mul_f32 v172, v13, v172
 v_mul_f32 v173, v13, v173
 v_mul_f32 v174, v13, v174
 v_mul_f32 v175, v13, v175
 v_mul_f32 v176, v12, v176
 v_mul_f32 v177, v12, v177
 v_mul_f32 v178, v12, v178
 v_mul_f32 v179, v12, v179
 v_mul_f32 v180, v13, v180
 v_mul_f32 v181, v13, v181
 v_mul_f32 v182, v13, v182
 v_mul_f32 v183, v13, v183
 v_mul_f32 v184, v12, v184
 v_mul_f32 v185, v12, v185
 v_mul_f32 v186, v12, v186
 v_mul_f32 v187, v12, v187
 v_mul_f32 v188, v13, v188
 v_mul_f32 v189, v13, v189
 v_mul_f32 v190, v13, v190
 v_mul_f32 v191, v13, v191
 v_mul_f32 v192, v12, v192
 v_mul_f32 v193, v12, v193
 v_mul_f32 v194, v12, v194
 v_mul_f32 v195, v12, v195
 v_mul_f32 v196, v13, v196
 v_mul_f32 v197, v13, v197
 v_mul_f32 v198, v13, v198
 v_mul_f32 v199, v13, v199
 v_mul_f32 v200, v12, v200
 v_mul_f32 v201, v12, v201
 v_mul_f32 v202, v12, v202
 v_mul_f32 v203, v12, v203
 v_mul_f32 v204, v13, v204
 v_mul_f32 v205, v13, v205
 v_mul_f32 v206, v13, v206
 v_mul_f32 v207, v13, v207
 v_mul_f32 v208, v12, v208
 v_mul_f32 v209, v12, v209
 v_mul_f32 v210, v12, v210
 v_mul_f32 v211, v12, v211
 v_mul_f32 v212, v13, v212
 v_mul_f32 v213, v13, v213
 v_mul_f32 v214, v13, v214
 v_mul_f32 v215, v13, v215
 v_mul_f32 v216, v12, v216
 v_mul_f32 v217, v12, v217
 v_mul_f32 v218, v12, v218
 v_mul_f32 v219, v12, v219
 v_mul_f32 v220, v13, v220
 v_mul_f32 v221, v13, v221
 v_mul_f32 v222, v13, v222
 v_mul_f32 v223, v13, v223
 v_mul_f32 v224, v12, v224
 v_mul_f32 v225, v12, v225
 v_mul_f32 v226, v12, v226
 v_mul_f32 v227, v12, v227
 v_mul_f32 v228, v13, v228
 v_mul_f32 v229, v13, v229
 v_mul_f32 v230, v13, v230
 v_mul_f32 v231, v13, v231
 v_mul_f32 v232, v12, v232
 v_mul_f32 v233, v12, v233
 v_mul_f32 v234, v12, v234
 v_mul_f32 v235, v12, v235
 v_mul_f32 v236, v13, v236
 v_mul_f32 v237, v13, v237
 v_mul_f32 v238, v13, v238
 v_mul_f32 v239, v13, v239
 v_mul_f32 v240, v12, v240
 v_mul_f32 v241, v12, v241
 v_mul_f32 v242, v12, v242
 v_mul_f32 v243, v12, v243
 v_mul_f32 v244, v13, v244
 v_mul_f32 v245, v13, v245
 v_mul_f32 v246, v13, v246
 v_mul_f32 v247, v13, v247
 v_mul_f32 v248, v12, v248
 v_mul_f32 v249, v12, v249
 v_mul_f32 v250, v12, v250
 v_mul_f32 v251, v12, v251
 v_mul_f32 v252, v13, v252
 v_mul_f32 v253, v13, v253
 v_mul_f32 v254, v13, v254
 v_mul_f32 v255, v13, v255
 v_exp_f32 v18, v64
 v_exp_f32 v19, v65
 v_exp_f32 v20, v66
 v_add_f32 v26, v18, v19
 v_cvt_pk_bf16_f32 v40, v18, v19
 v_exp_f32 v21, v67
 v_exp_f32 v22, v72
 v_add_f32 v26, v20, v26
 v_cvt_pk_bf16_f32 v41, v20, v21
 v_exp_f32 v23, v73
 v_add_f32 v26, v21, v26
 v_exp_f32 v24, v74
 v_add_f32 v26, v22, v26
 v_cvt_pk_bf16_f32 v42, v22, v23
 v_exp_f32 v25, v75
 v_add_f32 v26, v23, v26
 v_exp_f32 v18, v68
 v_add_f32 v26, v24, v26
 v_cvt_pk_bf16_f32 v43, v24, v25
 v_exp_f32 v19, v69
 v_add_f32 v26, v25, v26
 v_exp_f32 v20, v70
 v_add_f32 v27, v18, v19
 v_cvt_pk_bf16_f32 v44, v18, v19
 v_exp_f32 v21, v71
 v_exp_f32 v22, v76
 v_add_f32 v27, v20, v27
 v_cvt_pk_bf16_f32 v45, v20, v21
 v_exp_f32 v23, v77
 v_add_f32 v27, v21, v27
 v_exp_f32 v24, v78
 v_add_f32 v27, v22, v27
 v_cvt_pk_bf16_f32 v46, v22, v23
 v_exp_f32 v25, v79
 v_add_f32 v27, v23, v27
 v_add_f32 v27, v24, v27
 v_cvt_pk_bf16_f32 v47, v24, v25
 v_add_f32 v27, v25, v27
 v_exp_f32 v18, v80
 v_exp_f32 v19, v81
 v_exp_f32 v20, v82
 v_add_f32 v26, v18, v26
 v_cvt_pk_bf16_f32 v56, v18, v19
 v_exp_f32 v21, v83
 v_add_f32 v26, v19, v26
 v_exp_f32 v22, v88
 v_add_f32 v26, v20, v26
 v_cvt_pk_bf16_f32 v57, v20, v21
 v_exp_f32 v23, v89
 v_add_f32 v26, v21, v26
 v_exp_f32 v24, v90
 v_add_f32 v26, v22, v26
 v_cvt_pk_bf16_f32 v58, v22, v23
 v_exp_f32 v25, v91
 v_add_f32 v26, v23, v26
 v_exp_f32 v18, v84
 v_add_f32 v26, v24, v26
 v_cvt_pk_bf16_f32 v59, v24, v25
 v_exp_f32 v19, v85
 v_add_f32 v26, v25, v26
 v_exp_f32 v20, v86
 v_add_f32 v27, v18, v27
 v_cvt_pk_bf16_f32 v60, v18, v19
 v_exp_f32 v21, v87
 v_add_f32 v27, v19, v27
 v_exp_f32 v22, v92
 v_add_f32 v27, v20, v27
 v_cvt_pk_bf16_f32 v61, v20, v21
 v_exp_f32 v23, v93
 v_add_f32 v27, v21, v27
 v_exp_f32 v24, v94
 v_add_f32 v27, v22, v27
 v_cvt_pk_bf16_f32 v62, v22, v23
 v_exp_f32 v25, v95
 v_add_f32 v27, v23, v27
 v_add_f32 v27, v24, v27
 v_cvt_pk_bf16_f32 v63, v24, v25
 v_add_f32 v27, v25, v27
 s_nop 3
 s_setpc_b64 s[36:37]
L_slowB:
 s_nop 7
 s_nop 3
 v_max3_f32 v11, v100, v101, v102
 v_max3_f32 v11, v103, v108, v11
 v_max3_f32 v11, v109, v110, v11
 v_max3_f32 v11, v111, v116, v11
 v_max3_f32 v11, v117, v118, v11
 v_max3_f32 v11, v119, v124, v11
 v_max3_f32 v11, v125, v126, v11
 v_max_f32 v11, v127, v11
 v_mov_b32 v13, v11
 s_nop 1
 v_permlane16_swap_b32 v13, v11
 v_max_f32 v11, v13, v11
 v_mov_b32 v13, v11
 s_nop 1
 v_permlane32_swap_b32 v13, v11
 v_max_f32 v11, v13, v11
 v_ceil_f32 v11, v11
 v_max_f32 v11, 0, v11
 v_sub_f32 v100, v100, v11
 v_sub_f32 v101, v101, v11
 v_sub_f32 v102, v102, v11
 v_sub_f32 v103, v103, v11
 v_sub_f32 v108, v108, v11
 v_sub_f32 v109, v109, v11
 v_sub_f32 v110, v110, v11
 v_sub_f32 v111, v111, v11
 v_sub_f32 v116, v116, v11
 v_sub_f32 v117, v117, v11
 v_sub_f32 v118, v118, v11
 v_sub_f32 v119, v119, v11
 v_sub_f32 v124, v124, v11
 v_sub_f32 v125, v125, v11
 v_sub_f32 v126, v126, v11
 v_sub_f32 v127, v127, v11
 v_sub_f32 v36, v36, v11
 v_sub_f32 v37, v37, v11
 v_sub_f32 v38, v38, v11
 v_sub_f32 v39, v39, v11
 v_exp_f32 v13, -v11
 s_nop 0
 v_mul_f32 v31, v13, v31
 v_mul_f32 v132, v13, v132
 v_mul_f32 v133, v13, v133
 v_mul_f32 v134, v13, v134
 v_mul_f32 v135, v13, v135
 v_mul_f32 v140, v13, v140
 v_mul_f32 v141, v13, v141
 v_mul_f32 v142, v13, v142
 v_mul_f32 v143, v13, v143
 v_mul_f32 v148, v13, v148
 v_mul_f32 v149, v13, v149
 v_mul_f32 v150, v13, v150
 v_mul_f32 v151, v13, v151
 v_mul_f32 v156, v13, v156
 v_mul_f32 v157, v13, v157
 v_mul_f32 v158, v13, v158
 v_mul_f32 v159, v13, v159
 v_mul_f32 v164, v13, v164
 v_mul_f32 v165, v13, v165
 v_mul_f32 v166, v13, v166
 v_mul_f32 v167, v13, v167
 v_mul_f32 v172, v13, v172
 v_mul_f32 v173, v13, v173
 v_mul_f32 v174, v13, v174
 v_mul_f32 v175, v13, v175
 v_mul_f32 v180, v13, v180
 v_mul_f32 v181, v13, v181
 v_mul_f32 v182, v13, v182
 v_mul_f32 v183, v13, v183
 v_mul_f32 v188, v13, v188
 v_mul_f32 v189, v13, v189
 v_mul_f32 v190, v13, v190
 v_mul_f32 v191, v13, v191
 v_mul_f32 v196, v13, v196
 v_mul_f32 v197, v13, v197
 v_mul_f32 v198, v13, v198
 v_mul_f32 v199, v13, v199
 v_mul_f32 v204, v13, v204
 v_mul_f32 v205, v13, v205
 v_mul_f32 v206, v13, v206
 v_mul_f32 v207, v13, v207
 v_mul_f32 v212, v13, v212
 v_mul_f32 v213, v13, v213
 v_mul_f32 v214, v13, v214
 v_mul_f32 v215, v13, v215
 v_mul_f32 v220, v13, v220
 v_mul_f32 v221, v13, v221
 v_mul_f32 v222, v13, v222
 v_mul_f32 v223, v13, v223
 v_mul_f32 v228, v13, v228
 v_mul_f32 v229, v13, v229
 v_mul_f32 v230, v13, v230
 v_mul_f32 v231, v13, v231
 v_mul_f32 v236, v13, v236
 v_mul_f32 v237, v13, v237
 v_mul_f32 v238, v13, v238
 v_mul_f32 v239, v13, v239
 v_mul_f32 v244, v13, v244
 v_mul_f32 v245, v13, v245
 v_mul_f32 v246, v13, v246
 v_mul_f32 v247, v13, v247
 v_mul_f32 v252, v13, v252
 v_mul_f32 v253, v13, v253
 v_mul_f32 v254, v13, v254
 v_mul_f32 v255, v13, v255
 v_exp_f32 v18, v100
 v_exp_f32 v19, v101
 v_exp_f32 v20, v102
 v_add_f32 v29, v18, v19
 v_cvt_pk_bf16_f32 v52, v18, v19
 v_exp_f32 v21, v103
 v_exp_f32 v22, v108
 v_add_f32 v29, v20, v29
 v_cvt_pk_bf16_f32 v53, v20, v21
 v_exp_f32 v23, v109
 v_add_f32 v29, v21, v29
 v_exp_f32 v24, v110
 v_add_f32 v29, v22, v29
 v_cvt_pk_bf16_f32 v54, v22, v23
 v_exp_f32 v25, v111
 v_add_f32 v29, v23, v29
 v_exp_f32 v18, v116
 v_add_f32 v29, v24, v29
 v_cvt_pk_bf16_f32 v55, v24, v25
 v_exp_f32 v19, v117
 v_add_f32 v29, v25, v29
 v_exp_f32 v20, v118
 v_add_f32 v29, v18, v29
 v_cvt_pk_bf16_f32 v48, v18, v19
 v_exp_f32 v21, v119
 v_add_f32 v29, v19, v29
 v_exp_f32 v22, v124
 v_add_f32 v29, v20, v29
 v_cvt_pk_bf16_f32 v49, v20, v21
 v_exp_f32 v23, v125
 v_add_f32 v29, v21, v29
 v_exp_f32 v24, v126
 v_add_f32 v29, v22, v29
 v_cvt_pk_bf16_f32 v50, v22, v23
 v_exp_f32 v25, v127
 v_add_f32 v29, v23, v29
 v_add_f32 v29, v24, v29
 v_cvt_pk_bf16_f32 v51, v24, v25
 v_add_f32 v29, v25, v29
 s_nop 3
 s_setpc_b64 s[36:37]
L_slowf:
 s_nop 7
 s_nop 3
 v_max3_f32 v10, v64, v65, v66
 v_max3_f32 v10, v67, v72, v10
 v_max3_f32 v10, v73, v74, v10
 v_max3_f32 v10, v75, v80, v10
 v_max3_f32 v10, v81, v82, v10
 v_max3_f32 v10, v83, v88, v10
 v_max3_f32 v10, v89, v90, v10
 v_max_f32 v10, v91, v10
 v_max3_f32 v11, v68, v69, v70
 v_max3_f32 v11, v71, v76, v11
 v_max3_f32 v11, v77, v78, v11
 v_max3_f32 v11, v79, v84, v11
 v_max3_f32 v11, v85, v86, v11
 v_max3_f32 v11, v87, v92, v11
 v_max3_f32 v11, v93, v94, v11
 v_max_f32 v11, v95, v11
 v_mov_b32 v12, v10
 v_mov_b32 v13, v11
 s_nop 0
 v_permlane16_swap_b32 v12, v10
 v_permlane16_swap_b32 v13, v11
 v_max_f32 v10, v12, v10
 v_max_f32 v11, v13, v11
 v_mov_b32 v12, v10
 v_mov_b32 v13, v11
 s_nop 0
 v_permlane32_swap_b32 v12, v10
 v_permlane32_swap_b32 v13, v11
 v_max_f32 v10, v12, v10
 v_max_f32 v11, v13, v11
 v_ceil_f32 v10, v10
 v_ceil_f32 v11, v11
 v_sub_f32 v64, v64, v10
 v_sub_f32 v65, v65, v10
 v_sub_f32 v66, v66, v10
 v_sub_f32 v67, v67, v10
 v_sub_f32 v68, v68, v11
 v_sub_f32 v69, v69, v11
 v_sub_f32 v70, v70, v11
 v_sub_f32 v71, v71, v11
 v_sub_f32 v72, v72, v10
 v_sub_f32 v73, v73, v10
 v_sub_f32 v74, v74, v10
 v_sub_f32 v75, v75, v10
 v_sub_f32 v76, v76, v11
 v_sub_f32 v77, v77, v11
 v_sub_f32 v78, v78, v11
 v_sub_f32 v79, v79, v11
 v_sub_f32 v80, v80, v10
 v_sub_f32 v81, v81, v10
 v_sub_f32 v82, v82, v10
 v_sub_f32 v83, v83, v10
 v_sub_f32 v84, v84, v11
 v_sub_f32 v85, v85, v11
 v_sub_f32 v86, v86, v11
 v_sub_f32 v87, v87, v11
 v_sub_f32 v88, v88, v10
 v_sub_f32 v89, v89, v10
 v_sub_f32 v90, v90, v10
 v_sub_f32 v91, v91, v10
 v_sub_f32 v92, v92, v11
 v_sub_f32 v93, v93, v11
 v_sub_f32 v94, v94, v11
 v_sub_f32 v95, v95, v11
 v_sub_f32 v96, v96, v10
 v_sub_f32 v97, v97, v10
 v_sub_f32 v98, v98, v10
 v_sub_f32 v99, v99, v10
 v_sub_f32 v100, v100, v11
 v_sub_f32 v101, v101, v11
 v_sub_f32 v102, v102, v11
 v_sub_f32 v103, v103, v11
 v_sub_f32 v104, v104, v10
 v_sub_f32 v105, v105, v10
 v_sub_f32 v106, v106, v10
 v_sub_f32 v107, v107, v10
 v_sub_f32 v108, v108, v11
 v_sub_f32 v109, v109, v11
 v_sub_f32 v110, v110, v11
 v_sub_f32 v111, v111, v11
 v_sub_f32 v112, v112, v10
 v_sub_f32 v113, v113, v10
 v_sub_f32 v114, v114, v10
 v_sub_f32 v115, v115, v10
 v_sub_f32 v116, v116, v11
 v_sub_f32 v117, v117, v11
 v_sub_f32 v118, v118, v11
 v_sub_f32 v119, v119, v11
 v_sub_f32 v120, v120, v10
 v_sub_f32 v121, v121, v10
 v_sub_f32 v122, v122, v10
 v_sub_f32 v123, v123, v10
 v_sub_f32 v124, v124, v11
 v_sub_f32 v125, v125, v11
 v_sub_f32 v126, v126, v11
 v_sub_f32 v127, v127, v11
 v_sub_f32 v32, v32, v10
 v_sub_f32 v33, v33, v10
 v_sub_f32 v34, v34, v10
 v_sub_f32 v35, v35, v10
 v_sub_f32 v36, v36, v11
 v_sub_f32 v37, v37, v11
 v_sub_f32 v38, v38, v11
 v_sub_f32 v39, v39, v11
 v_exp_f32 v18, v64
 v_exp_f32 v19, v65
 v_exp_f32 v20, v66
 v_add_f32 v26, v18, v19
 v_cvt_pk_bf16_f32 v40, v18, v19
 v_exp_f32 v21, v67
 v_exp_f32 v22, v72
 v_add_f32 v26, v20, v26
 v_cvt_pk_bf16_f32 v41, v20, v21
 v_exp_f32 v23, v73
 v_add_f32 v26, v21, v26
 v_exp_f32 v24, v74
 v_add_f32 v26, v22, v26
 v_cvt_pk_bf16_f32 v42, v22, v23
 v_exp_f32 v25, v75
 v_add_f32 v26, v23, v26
 v_exp_f32 v18, v68
 v_add_f32 v26, v24, v26
 v_cvt_pk_bf16_f32 v43, v24, v25
 v_exp_f32 v19, v69
 v_add_f32 v26, v25, v26
 v_exp_f32 v20, v70
 v_add_f32 v27, v18, v19
 v_cvt_pk_bf16_f32 v44, v18, v19
 v_exp_f32 v21, v71
 v_exp_f32 v22, v76
 v_add_f32 v27, v20, v27
 v_cvt_pk_bf16_f32 v45, v20, v21
 v_exp_f32 v23, v77
 v_add_f32 v27, v21, v27
 v_exp_f32 v24, v78
 v_add_f32 v27, v22, v27
 v_cvt_pk_bf16_f32 v46, v22, v23
 v_exp_f32 v25, v79
 v_add_f32 v27, v23, v27
 v_add_f32 v27, v24, v27
 v_cvt_pk_bf16_f32 v47, v24, v25
 v_add_f32 v27, v25, v27
 v_exp_f32 v18, v80
 v_exp_f32 v19, v81
 v_exp_f32 v20, v82
 v_add_f32 v26, v18, v26
 v_cvt_pk_bf16_f32 v56, v18, v19
 v_exp_f32 v21, v83
 v_add_f32 v26, v19, v26
 v_exp_f32 v22, v88
 v_add_f32 v26, v20, v26
 v_cvt_pk_bf16_f32 v57, v20, v21
 v_exp_f32 v23, v89
 v_add_f32 v26, v21, v26
 v_exp_f32 v24, v90
 v_add_f32 v26, v22, v26
 v_cvt_pk_bf16_f32 v58, v22, v23
 v_exp_f32 v25, v91
 v_add_f32 v26, v23, v26
 v_exp_f32 v18, v84
 v_add_f32 v26, v24, v26
 v_cvt_pk_bf16_f32 v59, v24, v25
 v_exp_f32 v19, v85
 v_add_f32 v26, v25, v26
 v_exp_f32 v20, v86
 v_add_f32 v27, v18, v27
 v_cvt_pk_bf16_f32 v60, v18, v19
 v_exp_f32 v21, v87
 v_add_f32 v27, v19, v27
 v_exp_f32 v22, v92
 v_add_f32 v27, v20, v27
 v_cvt_pk_bf16_f32 v61, v20, v21
 v_exp_f32 v23, v93
 v_add_f32 v27, v21, v27
 v_exp_f32 v24, v94
 v_add_f32 v27, v22, v27
 v_cvt_pk_bf16_f32 v62, v22, v23
 v_exp_f32 v25, v95
 v_add_f32 v27, v23, v27
 v_add_f32 v27, v24, v27
 v_cvt_pk_bf16_f32 v63, v24, v25
 v_add_f32 v27, v25, v27
 s_nop 3
 s_setpc_b64 s[36:37]
L_moe0:
 s_lshl_b32 s88, s75, 1
 s_call_b64 s[36:37], L_moe
 v_add_f32 v32, v108, v32
 v_add_f32 v33, v109, v33
 v_add_f32 v34, v110, v34
 v_add_f32 v35, v111, v35
 v_add_f32 v36, v112, v36
 v_add_f32 v37, v113, v37
 v_add_f32 v38, v114, v38
 v_add_f32 v39, v115, v39
 v_add_f32 v40, v116, v40
 v_add_f32 v41, v117, v41
 v_add_f32 v42, v118, v42
 v_add_f32 v43, v119, v43
 v_add_f32 v44, v120, v44
 v_add_f32 v45, v121, v45
 v_add_f32 v46, v122, v46
 v_add_f32 v47, v123, v47
 s_mov_b64 exec, -1
 s_branch L_moe_ret0
L_moe1:
 s_lshl_b32 s88, s86, 1
 s_call_b64 s[36:37], L_moe
 v_add_f32 v80, v108, v80
 v_add_f32 v81, v109, v81
 v_add_f32 v82, v110, v82
 v_add_f32 v83, v111, v83
 v_add_f32 v84, v112, v84
 v_add_f32 v85, v113, v85
 v_add_f32 v86, v114, v86
 v_add_f32 v87, v115, v87
 s_mov_b64 exec, -1
 s_branch L_moe_ret1
L_moe2:
 s_lshl_b32 s88, s86, 1
 s_call_b64 s[36:37], L_moe
 v_add_f32 v32, v108, v32
 v_add_f32 v33, v109, v33
 v_add_f32 v34, v110, v34
 v_add_f32 v35, v111, v35
 v_add_f32 v36, v112, v36
 v_add_f32 v37, v113, v37
 v_add_f32 v38, v114, v38
 v_add_f32 v39, v115, v39
 s_mov_b64 exec, -1
 s_branch L_moe_ret2
L_moe:
 v_min_u32 v104, 27, v0
 v_lshlrev_b32 v104, 2, v104
 s_mov_b32 s64, 105062912
 s_mov_b32 s65, 65536
 s_mov_b32 exec_lo, 0xffffffff
 s_mov_b32 exec_hi, 0xffffffff
L_pfy:
 buffer_load_dword v105, v104, s[8:11], s64 offen sc1
 s_sub_u32 s65, s65, 1
 s_cbranch_scc1 L_pfy_x
 s_waitcnt vmcnt(0)
 v_cmp_ne_u32 vcc, 1, v105
 s_nop 0
 s_cbranch_vccz L_pfy_x
 s_sleep 2
 s_branch L_pfy
L_pfy_x:
 s_waitcnt vmcnt(0)
 s_mov_b64 exec, -1
 s_or_b64 exec, s[80:81], s[82:83]
 v_mov_b32 v104, 1792
 v_cndmask_b32 v104, v104, 0, s[80:81]
 v_lshl_add_u32 v104, v11, 5, v104
 s_add_u32 s88, s88, 104898560
 buffer_load_dwordx4 v[108:111], v104, s[8:11], s88 offen sc1
 buffer_load_dwordx4 v[112:115], v104, s[8:11], s88 offen offset:16 sc1
 buffer_load_dwordx4 v[116:119], v104, s[8:11], s88 offen offset:512 sc1
 buffer_load_dwordx4 v[120:123], v104, s[8:11], s88 offen offset:528 sc1
 s_waitcnt vmcnt(0)
 s_setpc_b64 s[36:37]
L_y1:
 s_lshl_b32 s89, s41, 1
 s_add_u32 s89, s89, s20
 s_cmp_ge_u32 s20, 2
 s_cselect_b32 s89, 28, s89
 s_cmp_ge_u32 s89, 28
 s_cbranch_scc1 L_y1r
 v_lshrrev_b32 v50, 4, v7
 v_lshrrev_b32 v51, 3, v50
 v_mul_u32_u24 v51, 4352, v51
 v_and_b32 v52, 7, v50
 v_lshl_add_u32 v51, v52, 7, v51
 s_mov_b32 s90, 104923136
 s_mov_b32 s88, 104957952
 s_mov_b32 s91, 65536
L_yp:
 buffer_load_dword v52, v51, s[8:11], s90 offen sc1
 buffer_load_dword v53, v51, s[8:11], s88 offen sc1
 s_waitcnt vmcnt(0)
 v_min_u32 v52, v52, v53
 v_cmp_gt_u32 vcc, 4, v52
 s_sub_u32 s91, s91, 1
 s_cbranch_scc1 L_ypx
 s_cbranch_vccnz L_yp
L_ypx:
 s_cmp_lt_u32 s89, 14
 s_cselect_b32 s90, 8, 12
 s_add_u32 s90, s90, 104890368
 buffer_load_dword v53, off, s[8:11], s90 sc1
 v_lshrrev_b32 v51, 3, v50
 v_mul_u32_u24 v51, 3584, v51
 v_and_b32 v52, 7, v50
 v_lshl_add_u32 v51, v52, 4, v51
 s_lshl_b32 s88, s89, 7
 s_add_u32 s90, s88, 104898560
 s_add_u32 s88, s88, 105906176
 buffer_load_dwordx4 v[136:139], v51, s[8:11], s88 offen sc1
 s_add_u32 s88, s88, 28672
 buffer_load_dwordx4 v[140:143], v51, s[8:11], s88 offen sc1
 s_add_u32 s88, s88, 28672
 buffer_load_dwordx4 v[152:155], v51, s[8:11], s88 offen sc1
 s_add_u32 s88, s88, 28672
 buffer_load_dwordx4 v[156:159], v51, s[8:11], s88 offen sc1
 s_add_u32 s88, s88, 28672
 buffer_load_dwordx4 v[168:171], v51, s[8:11], s88 offen sc1
 s_add_u32 s88, s88, 28672
 buffer_load_dwordx4 v[172:175], v51, s[8:11], s88 offen sc1
 s_add_u32 s88, s88, 28672
 buffer_load_dwordx4 v[184:187], v51, s[8:11], s88 offen sc1
 s_add_u32 s88, s88, 28672
 buffer_load_dwordx4 v[188:191], v51, s[8:11], s88 offen sc1
 s_add_u32 s88, s88, 28672
 buffer_load_dwordx4 v[200:203], v51, s[8:11], s88 offen sc1
 s_add_u32 s88, s88, 28672
 buffer_load_dwordx4 v[204:207], v51, s[8:11], s88 offen sc1
 s_add_u32 s88, s88, 28672
 buffer_load_dwordx4 v[216:219], v51, s[8:11], s88 offen sc1
 s_add_u32 s88, s88, 28672
 buffer_load_dwordx4 v[220:223], v51, s[8:11], s88 offen sc1
 s_add_u32 s88, s88, 28672
 buffer_load_dwordx4 v[232:235], v51, s[8:11], s88 offen sc1
 s_add_u32 s88, s88, 28672
 buffer_load_dwordx4 v[236:239], v51, s[8:11], s88 offen sc1
 s_add_u32 s88, s88, 28672
 s_branch L_y1r
L_y2:
 s_cmp_ge_u32 s89, 28
 s_cbranch_scc1 L_y2r
 s_waitcnt vmcnt(24)
 s_waitcnt vmcnt(12)
 v_add_f32 v136, v140, v136
 v_add_f32 v137, v141, v137
 v_add_f32 v138, v142, v138
 v_add_f32 v139, v143, v139
 s_waitcnt vmcnt(11)
 v_add_f32 v136, v152, v136
 v_add_f32 v137, v153, v137
 v_add_f32 v138, v154, v138
 v_add_f32 v139, v155, v139
 s_waitcnt vmcnt(10)
 v_add_f32 v136, v156, v136
 v_add_f32 v137, v157, v137
 v_add_f32 v138, v158, v138
 v_add_f32 v139, v159, v139
 s_waitcnt vmcnt(9)
 v_add_f32 v136, v168, v136
 v_add_f32 v137, v169, v137
 v_add_f32 v138, v170, v138
 v_add_f32 v139, v171, v139
 s_waitcnt vmcnt(8)
 v_add_f32 v136, v172, v136
 v_add_f32 v137, v173, v137
 v_add_f32 v138, v174, v138
 v_add_f32 v139, v175, v139
 s_waitcnt vmcnt(7)
 v_add_f32 v136, v184, v136
 v_add_f32 v137, v185, v137
 v_add_f32 v138, v186, v138
 v_add_f32 v139, v187, v139
 s_waitcnt vmcnt(6)
 v_add_f32 v136, v188, v136
 v_add_f32 v137, v189, v137
 v_add_f32 v138, v190, v138
 v_add_f32 v139, v191, v139
 s_waitcnt vmcnt(5)
 v_add_f32 v136, v200, v136
 v_add_f32 v137, v201, v137
 v_add_f32 v138, v202, v138
 v_add_f32 v139, v203, v139
 s_waitcnt vmcnt(4)
 v_add_f32 v136, v204, v136
 v_add_f32 v137, v205, v137
 v_add_f32 v138, v206, v138
 v_add_f32 v139, v207, v139
 s_waitcnt vmcnt(3)
 v_add_f32 v136, v216, v136
 v_add_f32 v137, v217, v137
 v_add_f32 v138, v218, v138
 v_add_f32 v139, v219, v139
 s_waitcnt vmcnt(2)
 v_add_f32 v136, v220, v136
 v_add_f32 v137, v221, v137
 v_add_f32 v138, v222, v138
 v_add_f32 v139, v223, v139
 s_waitcnt vmcnt(1)
 v_add_f32 v136, v232, v136
 v_add_f32 v137, v233, v137
 v_add_f32 v138, v234, v138
 v_add_f32 v139, v235, v139
 s_waitcnt vmcnt(0)
 v_add_f32 v136, v236, v136
 v_add_f32 v137, v237, v137
 v_add_f32 v138, v238, v138
 v_add_f32 v139, v239, v139
 v_add_f32 v136, v136, v136 row_ror:8 row_mask:0xf bank_mask:0xf
 v_add_f32 v137, v137, v137 row_ror:8 row_mask:0xf bank_mask:0xf
 v_add_f32 v138, v138, v138 row_ror:8 row_mask:0xf bank_mask:0xf
 v_add_f32 v139, v139, v139 row_ror:8 row_mask:0xf bank_mask:0xf
 v_mov_b32 v140, v136
 v_mov_b32 v141, v137
 v_mov_b32 v142, v138
 v_mov_b32 v143, v139
 v_permlane16_swap_b32 v140, v136
 v_permlane16_swap_b32 v141, v137
 v_permlane16_swap_b32 v142, v138
 v_permlane16_swap_b32 v143, v139
 v_add_f32 v136, v140, v136
 v_add_f32 v137, v141, v137
 v_add_f32 v138, v142, v138
 v_add_f32 v139, v143, v139
 v_mov_b32 v140, v136
 v_mov_b32 v141, v137
 v_mov_b32 v142, v138
 v_mov_b32 v143, v139
 v_permlane32_swap_b32 v140, v136
 v_permlane32_swap_b32 v141, v137
 v_permlane32_swap_b32 v142, v138
 v_permlane32_swap_b32 v143, v139
 v_add_f32 v136, v140, v136
 v_add_f32 v137, v141, v137
 v_add_f32 v138, v142, v138
 v_add_f32 v139, v143, v139
 v_cvt_pk_bf16_f32 v51, v136, v137
 v_lshlrev_b32 v136, 16, v51
 v_and_b32 v137, 0xffff0000, v51
 v_cvt_pk_bf16_f32 v51, v138, v139
 v_lshlrev_b32 v138, 16, v51
 v_and_b32 v139, 0xffff0000, v51
 v_mul_f32 v136, v53, v136
 v_mul_f32 v137, v53, v137
 v_mul_f32 v138, v53, v138
 v_mul_f32 v139, v53, v139
 v_cvt_pk_bf16_f32 v51, v136, v137
 v_lshlrev_b32 v136, 16, v51
 v_and_b32 v137, 0xffff0000, v51
 v_cvt_pk_bf16_f32 v51, v138, v139
 v_lshlrev_b32 v138, 16, v51
 v_and_b32 v139, 0xffff0000, v51
 s_mov_b64 exec, 0xff
 buffer_store_dwordx4 v[136:139], v7, s[8:11], s90 offen sc1
 s_mov_b64 exec, -1
 s_branch L_y2r
L_y3:
 s_cmp_ge_u32 s89, 28
 s_cbranch_scc1 L_y3r
 v_mov_b32 v52, 1
 s_lshl_b32 s89, s89, 2
 s_add_u32 s89, s89, 105062912
 s_mov_b64 exec, 1
 s_waitcnt vmcnt(5)
 buffer_store_dword v52, off, s[8:11], s89 sc1
 s_mov_b64 exec, -1
 s_branch L_y3r
L_fll:
 s_cmp_lg_u32 s39, 15
 s_cbranch_scc1 L_fll1
 v_mov_b32 v9, 0
 s_mov_b32 s46, s47
 s_mov_b32 s39, 1
L_fll1:
 buffer_load_dword v6, v9, s[8:11], s46 offen sc1
 s_branch L_fllr
L_pub3:
 v_mov_b32 v17, s3
 buffer_store_dword v17, v1, s[8:11], s45 offen sc1
 s_branch L_pub3r
L_fhs0:
 s_mov_b32 s91, 65536
L_fhs0_l:
 s_sleep 2
 buffer_load_dword v24, off, s[8:11], s79 sc1
 s_sub_u32 s91, s91, 1
 s_cbranch_scc1 L_fhs0_x
 s_waitcnt vmcnt(0)
 v_cmp_gt_u32 vcc, 1, v24
 s_nop 0
 s_cbranch_vccnz L_fhs0_l
L_fhs0_x:
 s_waitcnt vmcnt(0)
 s_branch L_fhr0
L_fhs1:
 s_mov_b32 s91, 65536
L_fhs1_l:
 s_sleep 2
 buffer_load_dword v24, off, s[8:11], s79 sc1
 s_sub_u32 s91, s91, 1
 s_cbranch_scc1 L_fhs1_x
 s_waitcnt vmcnt(0)
 v_cmp_gt_u32 vcc, 1, v24
 s_nop 0
 s_cbranch_vccnz L_fhs1_l
L_fhs1_x:
 s_waitcnt vmcnt(0)
 s_branch L_fhr1
L_fps1:
 s_mov_b32 s53, 65536
L_fps1_l:
 s_sleep 2
 buffer_load_dword v5, off, s[8:11], s47 sc1
 s_sub_u32 s53, s53, 1
 s_cbranch_scc1 L_fps1_x
 s_waitcnt vmcnt(0)
 v_cmp_ne_u32 vcc, 1, v5
 s_nop 0
 s_cbranch_vccnz L_fps1_l
L_fps1_x:
 s_waitcnt vmcnt(0)
 s_branch L_fpr1
L_f4s:
 s_mov_b32 s53, 65536
L_f4s_l:
 s_sleep 2
 buffer_load_dword v6, v9, s[8:11], s46 offen sc1
 s_sub_u32 s53, s53, 1
 s_cbranch_scc1 L_f4s_x
 s_waitcnt vmcnt(0)
 v_cmp_gt_u32 vcc, 3, v6
 s_nop 0
 s_cbranch_vccnz L_f4s_l
L_f4s_x:
 s_waitcnt vmcnt(0)
 s_branch L_f4r
L_f2s:
 s_mov_b32 s53, 65536
L_f2s_l:
 s_sleep 2
 buffer_load_dword v6, v9, s[8:11], s46 offen sc1
 s_sub_u32 s53, s53, 1
 s_cbranch_scc1 L_f2s_x
 s_waitcnt vmcnt(0)
 v_cmp_gt_u32 vcc, 3, v6
 s_nop 0
 s_cbranch_vccnz L_f2s_l
L_f2s_x:
 s_waitcnt vmcnt(0)
 s_branch L_f2r
L_fls0:
 s_mov_b32 s53, 65536
L_fls0_l:
 s_sleep 2
 buffer_load_dword v6, v9, s[8:11], s46 offen sc1
 s_sub_u32 s53, s53, 1
 s_cbranch_scc1 L_fls0_x
 s_waitcnt vmcnt(0)
 v_cmp_gt_u32 vcc, s39, v6
 s_nop 0
 s_cbranch_vccnz L_fls0_l
L_fls0_x:
 s_waitcnt vmcnt(0)
 s_branch L_flr0
L_code_end:
.section .rodata,"a"
.p2align 6
.amdhsa_kernel gated_mix__compressed_kv_cla__moe_arch_mod__prompt_kernel
  .amdhsa_next_free_vgpr 512
  .amdhsa_next_free_sgpr 102
  .amdhsa_accum_offset 256
  .amdhsa_group_segment_fixed_size 0
  .amdhsa_kernarg_size 120
  .amdhsa_user_sgpr_count 2
  .amdhsa_user_sgpr_kernarg_segment_ptr 1
  .amdhsa_system_sgpr_workgroup_id_x 1
  .amdhsa_float_denorm_mode_32 3
.end_amdhsa_kernel
```

```asm
; @launch grid=(256,1,1) block=(256,1,1) lds=163840
.amdgcn_target "amdgcn-amd-amdhsa--gfx950"
.text
.macro M d, a, b, c
v_mfma_f32_16x16x32_bf16 \d, \a, \b, \c
.endm
.globl gated_mix__compressed_kv_cla__moe_arch_mod__prompt_kernel
.p2align 8
.type gated_mix__compressed_kv_cla__moe_arch_mod__prompt_kernel,@function
gated_mix__compressed_kv_cla__moe_arch_mod__prompt_kernel:
 s_cmp_lt_u32 s2, 256
 s_cbranch_scc1 L_go
 s_endpgm
L_go:
 s_load_dwordx8 s[80:87], s[0:1], 0
 s_load_dwordx4 s[88:91], s[0:1], 32
 s_load_dwordx2 s[92:93], s[0:1], 56
 s_load_dwordx2 s[30:31], s[0:1], 88
 s_load_dwordx4 s[4:7], s[0:1], 104
 v_lshrrev_b32 v24, 6, v0
 v_and_b32 v0, 63, v0
 v_readfirstlane_b32 s20, v24
 s_getpc_b64 s[76:77]
L_pc0:
 s_and_b32 s77, s77, 0xffff
 s_mov_b32 s78, L_code_end-L_pc0
 s_mov_b32 s79, 0x20000
 s_lshr_b32 s64, s2, 3
 s_lshl_b32 s64, s64, 2
 s_add_u32 s64, s64, s20
 s_lshl_b32 s95, s64, 11
 v_lshl_add_u32 v29, v0, 7, s95
 v_and_b32 v28, 48, v0
 v_lshl_add_u32 v28, v28, 24, v29
 buffer_load_dword a240, v28, s[76:79], 0 offen offset:0
 s_and_b32 s41, s2, 7
 s_lshr_b32 s42, s2, 3
 s_lshr_b32 s64, s42, 4
 s_lshl_b32 s64, s64, 3
 s_add_u32 s41, s41, s64
 s_and_b32 s42, s42, 15
 s_lshr_b32 s45, s42, 3
 s_xor_b32 s45, s45, 1
 s_mov_b32 s44, 0
 v_accvgpr_write_b32 a250, 0
 v_accvgpr_write_b32 a251, 0
 v_and_b32 v24, 15, v0
 v_lshrrev_b32 v25, 4, v0
 v_lshlrev_b32 v7, 4, v0
 s_and_b32 s65, s20, 1
 s_lshr_b32 s66, s20, 1
 v_or_b32 v28, 0, v25
 v_lshlrev_b32 v28, 1, v28
 v_xor_b32 v28, v28, v24
 v_lshrrev_b32 v29, 3, v28
 v_lshlrev_b32 v29, 8, v29
 v_and_b32 v28, 7, v28
 v_lshl_add_u32 v28, v28, 4, v29
 v_lshl_add_u32 v28, v25, 13, v28
 s_lshl_b32 s64, s20, 17
 s_add_u32 s64, s64, 0
 v_add_u32 v8, s64, v28
 v_add_u32 v9, 31744, v8
 v_or_b32 v28, 4, v25
 v_lshlrev_b32 v28, 1, v28
 v_xor_b32 v28, v28, v24
 v_lshrrev_b32 v29, 3, v28
 v_lshlrev_b32 v29, 8, v29
 v_and_b32 v28, 7, v28
 v_lshl_add_u32 v28, v28, 4, v29
 v_lshl_add_u32 v28, v25, 13, v28
 s_lshl_b32 s64, s20, 17
 s_add_u32 s64, s64, 63488
 v_add_u32 v10, s64, v28
 v_add_u32 v11, 31744, v10
 v_add_u32 v28, 0, v25
 v_and_b32 v29, 7, v0
 v_xor_b32 v28, v28, v29
 v_lshlrev_b32 v28, 4, v28
 v_lshrrev_b32 v29, 3, v0
 v_lshl_add_u32 v30, v29, 11, v28
 s_lshl_b32 s64, s66, 19
 s_lshl_b32 s67, s65, 20
 s_add_u32 s64, s64, s67
 s_add_u32 s64, s64, 0
 v_add_u32 v12, s64, v30
 v_add_u32 v14, 30720, v12
 v_add_u32 v28, 4, v25
 v_and_b32 v29, 7, v0
 v_xor_b32 v28, v28, v29
 v_lshlrev_b32 v28, 4, v28
 v_lshrrev_b32 v29, 3, v0
 v_lshl_add_u32 v30, v29, 11, v28
 s_lshl_b32 s64, s66, 19
 s_lshl_b32 s67, s65, 20
 s_add_u32 s64, s64, s67
 s_add_u32 s64, s64, 15360
 v_add_u32 v13, s64, v30
 v_add_u32 v15, 30720, v13
 s_mov_b32 s21, 0
 s_mov_b32 s22, 0
 s_lshl_b32 s23, s20, 12
 s_add_u32 s24, s23, 65536
 s_lshl_b32 s74, s41, 9
 s_sub_u32 s18, 8388608, s74
 s_mov_b32 s19, 0x20000
 s_and_b32 s75, s42, 7
 s_lshl_b32 s75, s75, 16
 s_sub_u32 s50, 4194304, s75
 s_mov_b32 s51, 0x20000
 s_mov_b32 m0, s23
 s_cmp_eq_u32 s45, 0
 s_waitcnt lgkmcnt(0)
 s_cselect_b64 s[72:73], s[86:87], s[88:89]
 s_add_u32 s16, s72, s74
 s_addc_u32 s17, s73, 0
 s_and_b32 s17, s17, 0xffff
 buffer_load_dwordx4 v8, s[16:19], s21 offen offset:0  nt lds
 buffer_load_dwordx4 v9, s[16:19], s21 offen offset:1024  nt lds
 buffer_load_dwordx4 v10, s[16:19], s21 offen offset:2048  nt lds
 buffer_load_dwordx4 v11, s[16:19], s21 offen offset:3072  nt lds
 s_add_u32 s21, s21, 128
 s_add_u32 s48, s82, s75
 s_addc_u32 s49, s83, 0
 s_and_b32 s49, s49, 0xffff
 s_add_u32 m0, s24, 0
 s_nop 0
 buffer_load_dwordx4 v12, s[48:51], s22 offen offset:0   lds
 buffer_load_dwordx4 v13, s[48:51], s22 offen offset:1024   lds
 buffer_load_dwordx4 v14, s[48:51], s22 offen offset:2048   lds
 buffer_load_dwordx4 v15, s[48:51], s22 offen offset:3072   lds
 s_add_u32 s22, s22, 2097152
 s_add_u32 m0, s23, 16384
 s_nop 0
 buffer_load_dwordx4 v8, s[16:19], s21 offen offset:0  nt lds
 buffer_load_dwordx4 v9, s[16:19], s21 offen offset:1024  nt lds
 buffer_load_dwordx4 v10, s[16:19], s21 offen offset:2048  nt lds
 buffer_load_dwordx4 v11, s[16:19], s21 offen offset:3072  nt lds
 s_add_u32 s21, s21, 524160
 v_lshrrev_b32 v26, 2, v24
 v_and_b32 v28, 1, v25
 v_lshl_or_b32 v28, v28, 2, v26
 v_lshl_add_u32 v29, v25, 3, v26
 v_lshlrev_b32 v29, 8, v29
 v_and_b32 v30, 3, v0
 v_lshl_add_u32 v29, v30, 3, v29
 s_lshl_b32 s64, s65, 2
 s_add_u32 s64, s64, 0
 v_xor_b32 v30, s64, v28
 v_lshl_add_u32 v1, v30, 5, v29
 s_lshl_b32 s64, s65, 2
 s_add_u32 s64, s64, 1
 v_xor_b32 v30, s64, v28
 v_lshl_add_u32 v2, v30, 5, v29
 s_lshl_b32 s64, s65, 2
 s_add_u32 s64, s64, 2
 v_xor_b32 v30, s64, v28
 v_lshl_add_u32 v3, v30, 5, v29
 s_lshl_b32 s64, s65, 2
 s_add_u32 s64, s64, 3
 v_xor_b32 v30, s64, v28
 v_lshl_add_u32 v4, v30, 5, v29
 v_add_u32 v28, 0, v25
 v_lshrrev_b32 v29, 1, v24
 v_xor_b32 v28, v28, v29
 v_lshlrev_b32 v28, 4, v28
 v_lshl_add_u32 v28, v24, 7, v28
 s_lshl_b32 s64, s66, 13
 s_add_u32 s64, s64, 65536
 v_add_u32 v5, s64, v28
 v_add_u32 v28, 4, v25
 v_lshrrev_b32 v29, 1, v24
 v_xor_b32 v28, v28, v29
 v_lshlrev_b32 v28, 4, v28
 v_lshl_add_u32 v28, v24, 7, v28
 s_lshl_b32 s64, s66, 13
 s_add_u32 s64, s64, 65536
 v_add_u32 v6, s64, v28
 s_lshl_b32 s64, s2, 2
 s_add_u32 s64, s64, s20
 s_lshl_b32 s64, s64, 12
 v_lshrrev_b32 v28, 2, v0
 v_and_b32 v29, 3, v0
 v_lshlrev_b32 v29, 7, v29
 v_lshl_add_u32 v28, v28, 11, v29
 v_add_u32 v24, s64, v28
 v_and_b32 v28, 56, v0
 v_lshl_add_u32 v24, v28, 24, v24
 s_mov_b32 s32, s82
 s_and_b32 s33, s83, 0xffff
 s_mov_b32 s34, 4194304
 s_mov_b32 s35, 0x20000
 s_mov_b32 s56, s80
 s_and_b32 s57, s81, 0xffff
 s_mov_b32 s58, 1835008
 s_mov_b32 s59, 0x20000
 s_mov_b32 s60, s92
 s_and_b32 s61, s93, 0xffff
 s_mov_b32 s62, 896
 s_mov_b32 s63, 0x20000
 s_mov_b32 s68, s30
 s_and_b32 s69, s31, 0xffff
 s_mov_b32 s70, 896
 s_mov_b32 s71, 0x20000
 s_mov_b32 s8, s6
 s_and_b32 s9, s7, 0xffff
 s_mov_b32 s10, 268435456
 s_mov_b32 s11, 0x20000
 s_mov_b32 s12, s4
 s_and_b32 s13, s5, 0xffff
 s_mov_b32 s14, 256
 s_mov_b32 s15, 0x20000
 s_add_u32 s72, s84, s74
 s_addc_u32 s73, s85, 0
 s_sub_u32 s75, 3670016, s74
 s_mov_b32 s52, s72
 s_and_b32 s53, s73, 0xffff
 s_mov_b32 s54, s75
 s_mov_b32 s55, 0x20000
 s_mov_b32 s5, 0x3db8aa3b
 s_mov_b32 s28, 0
 s_mul_i32 s29, s42, 114688
 s_lshl_b32 s72, s45, 24
 s_lshl_b32 s73, s41, 20
 s_add_u32 s72, s72, s73
 s_bfe_u32 s64, s42, 0x20001
 s_lshl_b32 s64, s64, 15
 s_add_u32 s72, s72, s64
 s_lshl_b32 s64, s66, 17
 s_add_u32 s72, s72, s64
 s_and_b32 s67, s42, 1
 s_cmp_eq_u32 s45, 0
 s_cselect_b32 s64, 12, 14
 s_cselect_b32 s75, 14, 10
 s_lshl_b32 s67, s67, s75
 s_add_u32 s72, s72, s67
 s_lshl_b32 s64, s65, s64
 s_add_u32 s93, s72, s64
 s_load_dwordx4 s[80:83], s[0:1], 64
 s_load_dwordx2 s[84:85], s[0:1], 80
 s_load_dwordx2 s[96:97], s[0:1], 96
 s_cmp_lt_u32 s42, 8
 s_cbranch_scc0 L_kv1
L_kv0:
 s_lshl_b32 s64, s42, 4
 s_add_u32 s64, s64, s41
 s_lshl_b32 s64, s64, 2
 s_add_u32 s64, s64, s20
 s_cmp_lt_u32 s64, 41
 s_cselect_b32 s39, 0, 536870912
 s_min_u32 s64, s64, 41
 s_lshl_b32 s38, s64, 2
 s_max_u32 s67, s64, 8
 s_sub_u32 s67, s67, 8
 s_mul_i32 s67, s67, 3328
 s_lshl_b32 s64, s64, 10
 s_add_u32 s64, s64, s67
 s_add_u32 s73, s64, 104914944
 v_or_b32 v64, s39, v7
 v_mov_b32 v68, 0
 v_mov_b32 v69, 0
 v_mov_b32 v70, 0
 v_mov_b32 v71, 0
 s_lshl_b32 s30, s41, 3
 s_add_u32 s30, s30, s42
 s_lshl_b32 s64, s30, 2
 s_add_u32 s64, s64, s20
 s_mul_i32 s72, s64, 3584
 v_mov_b32 v32, 536870912
 v_cmp_gt_u32 vcc, 56, v0
 s_lshl_b32 s67, s64, 2
 s_nop 0
 v_cndmask_b32 v32, v32, v7, vcc
 buffer_load_dwordx4 v[40:43], v32, s[56:59], s72 offen offset:0
 buffer_load_dwordx4 v[44:47], v32, s[56:59], s72 offen offset:896
 buffer_load_dwordx4 v[48:51], v32, s[56:59], s72 offen offset:1792
 buffer_load_dwordx4 v[52:55], v32, s[56:59], s72 offen offset:2688
 buffer_load_dwordx4 v[56:59], v32, s[60:63], 0 offen
 buffer_load_dwordx4 v[60:63], v32, s[68:71], 0 offen
 buffer_store_dwordx4 v[68:71], v64, s[8:11], s73 offen offset:0 sc1
 buffer_store_dwordx4 v[68:71], v64, s[8:11], s73 offen offset:1024 sc1
 buffer_store_dwordx4 v[68:71], v64, s[8:11], s73 offen offset:2048 sc1
 s_waitcnt vmcnt(13) lgkmcnt(0)
 s_barrier
 ds_read_b128 a[160:163], v5 offset:0
 ds_read_b128 a[164:167], v6 offset:0
 ds_read_b64_tr_b16 a[32:33], v1 offset:0
 ds_read_b64_tr_b16 a[34:35], v1 offset:1024
 ds_read_b64_tr_b16 a[36:37], v1 offset:8192
 ds_read_b64_tr_b16 a[38:39], v1 offset:9216
 ds_read_b64_tr_b16 a[40:41], v2 offset:0
 ds_read_b64_tr_b16 a[42:43], v2 offset:1024
 ds_read_b64_tr_b16 a[44:45], v2 offset:8192
 ds_read_b64_tr_b16 a[46:47], v2 offset:9216
 ds_read_b128 a[168:171], v5 offset:2048
 ds_read_b128 a[172:175], v6 offset:2048
 ds_read_b64_tr_b16 a[48:49], v3 offset:0
 ds_read_b64_tr_b16 a[50:51], v3 offset:1024
 ds_read_b64_tr_b16 a[52:53], v3 offset:8192
 ds_read_b64_tr_b16 a[54:55], v3 offset:9216
 ds_read_b64_tr_b16 a[56:57], v4 offset:0
 ds_read_b64_tr_b16 a[58:59], v4 offset:1024
 ds_read_b64_tr_b16 a[60:61], v4 offset:8192
 ds_read_b64_tr_b16 a[62:63], v4 offset:9216
 ds_read_b128 a[176:179], v5 offset:4096
 ds_read_b128 a[180:183], v6 offset:4096
 ds_read_b128 a[184:187], v5 offset:6144
 ds_read_b128 a[188:191], v6 offset:6144
 s_add_u32 m0, s24, 16384
 s_nop 0
 buffer_load_dwordx4 v12, s[48:51], s22 offen offset:0   lds
 buffer_load_dwordx4 v13, s[48:51], s22 offen offset:1024   lds
 buffer_load_dwordx4 v14, s[48:51], s22 offen offset:2048   lds
 buffer_load_dwordx4 v15, s[48:51], s22 offen offset:3072   lds
 s_sub_u32 s22, s22, 2097024
 s_add_u32 m0, s23, 32768
 s_nop 0
 buffer_load_dwordx4 v8, s[16:19], s21 offen offset:0  nt lds
 buffer_load_dwordx4 v9, s[16:19], s21 offen offset:1024  nt lds
 buffer_load_dwordx4 v10, s[16:19], s21 offen offset:2048  nt lds
 buffer_load_dwordx4 v11, s[16:19], s21 offen offset:3072  nt lds
 s_add_u32 s21, s21, 128
 v_mov_b32 v72, 0
 v_mov_b32 v73, 0
 v_mov_b32 v74, 0
 v_mov_b32 v75, 0
 v_mov_b32 v76, 0
 v_mov_b32 v77, 0
 v_mov_b32 v78, 0
 v_mov_b32 v79, 0
 s_waitcnt vmcnt(12)
 v_dot2c_f32_bf16 v72, v40, v56
 v_dot2c_f32_bf16 v73, v44, v56
 v_dot2c_f32_bf16 v74, v48, v56
 v_dot2c_f32_bf16 v75, v52, v56
 s_waitcnt vmcnt(11)
 v_dot2c_f32_bf16 v76, v40, v60
 v_dot2c_f32_bf16 v77, v44, v60
 v_dot2c_f32_bf16 v78, v48, v60
 v_dot2c_f32_bf16 v79, v52, v60
 v_dot2c_f32_bf16 v72, v41, v57
 v_dot2c_f32_bf16 v73, v45, v57
 v_dot2c_f32_bf16 v74, v49, v57
 v_dot2c_f32_bf16 v75, v53, v57
 v_dot2c_f32_bf16 v76, v41, v61
 v_dot2c_f32_bf16 v77, v45, v61
 v_dot2c_f32_bf16 v78, v49, v61
 v_dot2c_f32_bf16 v79, v53, v61
 v_dot2c_f32_bf16 v72, v42, v58
 v_dot2c_f32_bf16 v73, v46, v58
 v_dot2c_f32_bf16 v74, v50, v58
 v_dot2c_f32_bf16 v75, v54, v58
 v_dot2c_f32_bf16 v76, v42, v62
 v_dot2c_f32_bf16 v77, v46, v62
 v_dot2c_f32_bf16 v78, v50, v62
 v_dot2c_f32_bf16 v79, v54, v62
 v_dot2c_f32_bf16 v72, v43, v59
 v_dot2c_f32_bf16 v73, v47, v59
 v_dot2c_f32_bf16 v74, v51, v59
 v_dot2c_f32_bf16 v75, v55, v59
 v_dot2c_f32_bf16 v76, v43, v63
 v_dot2c_f32_bf16 v77, v47, v63
 v_dot2c_f32_bf16 v78, v51, v63
 v_dot2c_f32_bf16 v79, v55, v63
 v_permlane32_swap_b32 v72, v74
 v_permlane32_swap_b32 v73, v75
 v_permlane32_swap_b32 v76, v78
 v_permlane32_swap_b32 v77, v79
 v_add_f32 v72, v72, v74
 v_add_f32 v73, v73, v75
 v_add_f32 v76, v76, v78
 v_add_f32 v77, v77, v79
 v_lshrrev_b32 v80, 4, v0
 v_permlane16_swap_b32 v72, v73
 v_permlane16_swap_b32 v76, v77
 v_add_f32 v72, v72, v73
 v_add_f32 v76, v76, v77
 v_add_u32 v81, s67, v80
 v_add_f32 v72, v72, v72 row_ror:8 row_mask:0xf bank_mask:0xf
 v_add_f32 v76, v76, v76 row_ror:8 row_mask:0xf bank_mask:0xf
 s_nop 0
 v_add_f32 v72, v72, v72 row_ror:4 row_mask:0xf bank_mask:0xf
 v_add_f32 v76, v76, v76 row_ror:4 row_mask:0xf bank_mask:0xf
 s_nop 0
 v_add_f32 v72, v72, v72 row_ror:2 row_mask:0xf bank_mask:0xf
 v_add_f32 v76, v76, v76 row_ror:2 row_mask:0xf bank_mask:0xf
 s_nop 0
 v_add_f32 v72, v72, v72 row_ror:1 row_mask:0xf bank_mask:0xf
 v_add_f32 v76, v76, v76 row_ror:1 row_mask:0xf bank_mask:0xf
 v_ashrrev_i32 v82, 31, v72
 v_or_b32 v82, 0x80000000, v82
 v_xor_b32 v82, v82, v72
 v_and_b32 v82, 0xfffff800, v82
 v_sub_u32 v81, 2047, v81
 v_or_b32 v82, v82, v81
 v_max_u32 v82, 1, v82
 v_mul_f32 v77, 0xbfb8aa3b, v76
 v_exp_f32 v77, v77
 s_nop 0
 v_add_f32 v77, 1.0, v77
 v_rcp_f32 v76, v77
 s_lshl_b32 s72, s20, 4
 s_add_u32 s72, s72, 163584
 v_lshl_add_u32 v80, v80, 2, s72
 ds_write_b32 v80, v82
 ds_write_b32 v80, v72 offset:64
 ds_write_b32 v80, v76 offset:128
 s_waitcnt lgkmcnt(15)
M a[0:3], a[160:163], a[32:35], 0
M a[0:3], a[164:167], a[36:39], a[0:3]
M a[4:7], a[164:167], a[44:47], 0
M a[4:7], a[160:163], a[40:43], a[4:7]
 s_waitcnt lgkmcnt(11)
M a[8:11], a[160:163], a[48:51], 0
M a[8:11], a[164:167], a[52:55], a[8:11]
 s_waitcnt lgkmcnt(7)
M a[12:15], a[164:167], a[60:63], 0
 s_add_u32 m0, s23, 49152
M a[12:15], a[160:163], a[56:59], a[12:15]
 buffer_load_dwordx4 v8, s[16:19], s21 offen offset:0  nt lds
M v[32:35], a[168:171], a[32:35], 0
 buffer_load_dwordx4 v9, s[16:19], s21 offen offset:1024  nt lds
M v[32:35], a[172:175], a[36:39], v[32:35]
M v[36:39], a[172:175], a[44:47], 0
 buffer_load_dwordx4 v10, s[16:19], s21 offen offset:2048  nt lds
M v[36:39], a[168:171], a[40:43], v[36:39]
M v[40:43], a[168:171], a[48:51], 0
 buffer_load_dwordx4 v11, s[16:19], s21 offen offset:3072  nt lds
M v[40:43], a[172:175], a[52:55], v[40:43]
 s_add_u32 s21, s21, 524160
M v[44:47], a[172:175], a[60:63], 0
 s_waitcnt lgkmcnt(0)
M v[44:47], a[168:171], a[56:59], v[44:47]
 s_barrier
M v[64:67], a[176:179], a[32:35], 0
 s_add_u32 m0, s24, 32768
 ds_read_b64_tr_b16 a[64:65], v1 offset:16384
 ds_read_b64_tr_b16 a[66:67], v1 offset:17408
M v[64:67], a[180:183], a[36:39], v[64:67]
 ds_read_b64_tr_b16 a[68:69], v1 offset:24576
 ds_read_b64_tr_b16 a[70:71], v1 offset:25600
M v[68:71], a[180:183], a[44:47], 0
 buffer_load_dwordx4 v12, s[48:51], s22 offen offset:0   lds
M v[68:71], a[176:179], a[40:43], v[68:71]
 ds_read_b64_tr_b16 a[72:73], v2 offset:16384
 ds_read_b64_tr_b16 a[74:75], v2 offset:17408
M v[72:75], a[176:179], a[48:51], 0
 ds_read_b64_tr_b16 a[76:77], v2 offset:24576
 ds_read_b64_tr_b16 a[78:79], v2 offset:25600
M v[72:75], a[180:183], a[52:55], v[72:75]
 buffer_load_dwordx4 v13, s[48:51], s22 offen offset:1024   lds
M v[76:79], a[180:183], a[60:63], 0
 ds_read_b64_tr_b16 a[80:81], v3 offset:16384
 ds_read_b64_tr_b16 a[82:83], v3 offset:17408
M v[76:79], a[176:179], a[56:59], v[76:79]
 ds_read_b64_tr_b16 a[84:85], v3 offset:24576
 ds_read_b64_tr_b16 a[86:87], v3 offset:25600
M v[96:99], a[184:187], a[32:35], 0
 buffer_load_dwordx4 v14, s[48:51], s22 offen offset:2048   lds
M v[96:99], a[188:191], a[36:39], v[96:99]
 ds_read_b64_tr_b16 a[88:89], v4 offset:16384
 ds_read_b64_tr_b16 a[90:91], v4 offset:17408
M v[100:103], a[188:191], a[44:47], 0
 ds_read_b64_tr_b16 a[92:93], v4 offset:24576
 ds_read_b64_tr_b16 a[94:95], v4 offset:25600
M v[100:103], a[184:187], a[40:43], v[100:103]
 buffer_load_dwordx4 v15, s[48:51], s22 offen offset:3072   lds
M v[104:107], a[184:187], a[48:51], 0
 s_add_u32 s22, s22, 2097152
 v_max3_f32 v20, |v32|, |v33|, |v34|
 v_max3_f32 v20, |v35|, |v36|, v20
M v[104:107], a[188:191], a[52:55], v[104:107]
 v_max3_f32 v20, |v37|, |v38|, v20
 v_max3_f32 v21, |v64|, |v65|, |v66|
M v[108:111], a[188:191], a[60:63], 0
 s_add_u32 m0, s23, 0
 v_max3_f32 v21, |v67|, |v68|, v21
 v_max3_f32 v21, |v69|, |v70|, v21
M v[108:111], a[184:187], a[56:59], v[108:111]
 s_waitcnt lgkmcnt(0)
 v_min_f32 v20, v20, v21
 v_mul_f32 v20, 0x41000000, v20
M a[16:19], a[160:163], a[64:67], 0
 buffer_load_dwordx4 v8, s[16:19], s21 offen offset:0  nt lds
M a[16:19], a[164:167], a[68:71], a[16:19]
 v_mov_b32 v21, v20
 v_mov_b32 v22, v20
M a[20:23], a[164:167], a[76:79], 0
 buffer_load_dwordx4 v9, s[16:19], s21 offen offset:1024  nt lds
M a[20:23], a[160:163], a[72:75], a[20:23]
 v_mov_b32 v23, v20
 v_accvgpr_write_b32 a241, v20
M a[24:27], a[160:163], a[80:83], 0
M a[24:27], a[164:167], a[84:87], a[24:27]
M a[28:31], a[164:167], a[92:95], 0
 buffer_load_dwordx4 v10, s[16:19], s21 offen offset:2048  nt lds
M a[28:31], a[160:163], a[88:91], a[28:31]
M v[48:51], a[168:171], a[64:67], v[20:23]
M v[48:51], a[172:175], a[68:71], v[48:51]
 buffer_load_dwordx4 v11, s[16:19], s21 offen offset:3072  nt lds
M v[52:55], a[172:175], a[76:79], v[20:23]
 s_add_u32 s21, s21, 128
M v[52:55], a[168:171], a[72:75], v[52:55]
M v[56:59], a[168:171], a[80:83], v[20:23]
M v[56:59], a[172:175], a[84:87], v[56:59]
M v[60:63], a[172:175], a[92:95], v[20:23]
 s_waitcnt vmcnt(12)
M v[60:63], a[168:171], a[88:91], v[60:63]
 s_barrier
M v[80:83], a[176:179], a[64:67], v[20:23]
 s_add_u32 m0, s24, 49152
 ds_read_b128 a[160:163], v5 offset:16384
 ds_read_b128 a[164:167], v6 offset:16384
M v[80:83], a[180:183], a[68:71], v[80:83]
 buffer_load_dwordx4 v12, s[48:51], s22 offen offset:0   lds
M v[84:87], a[180:183], a[76:79], v[20:23]
 ds_read_b64_tr_b16 a[96:97], v1 offset:32768
 ds_read_b64_tr_b16 a[98:99], v1 offset:33792
M v[84:87], a[176:179], a[72:75], v[84:87]
M v[88:91], a[176:179], a[80:83], v[20:23]
 buffer_load_dwordx4 v13, s[48:51], s22 offen offset:1024   lds
M v[88:91], a[180:183], a[84:87], v[88:91]
 ds_read_b64_tr_b16 a[100:101], v1 offset:40960
 ds_read_b64_tr_b16 a[102:103], v1 offset:41984
M v[92:95], a[180:183], a[92:95], v[20:23]
M v[92:95], a[176:179], a[88:91], v[92:95]
M v[112:115], a[184:187], a[64:67], v[20:23]
 ds_read_b64_tr_b16 a[104:105], v2 offset:32768
 ds_read_b64_tr_b16 a[106:107], v2 offset:33792
M v[112:115], a[188:191], a[68:71], v[112:115]
 buffer_load_dwordx4 v14, s[48:51], s22 offen offset:2048   lds
M v[116:119], a[188:191], a[76:79], v[20:23]
M v[116:119], a[184:187], a[72:75], v[116:119]
 ds_read_b64_tr_b16 a[108:109], v2 offset:40960
 ds_read_b64_tr_b16 a[110:111], v2 offset:41984
M v[120:123], a[184:187], a[80:83], v[20:23]
 buffer_load_dwordx4 v15, s[48:51], s22 offen offset:3072   lds
M v[120:123], a[188:191], a[84:87], v[120:123]
 s_waitcnt lgkmcnt(8)
M v[124:127], a[188:191], a[92:95], v[20:23]
 s_sub_u32 s22, s22, 2097024
M v[124:127], a[184:187], a[88:91], v[124:127]
 s_add_u32 m0, s23, 16384
 ds_read_b64_tr_b16 a[112:113], v3 offset:32768
 ds_read_b64_tr_b16 a[114:115], v3 offset:33792
M v[128:131], a[160:163], a[32:35], v[20:23]
 ds_read_b128 a[168:171], v5 offset:18432
 ds_read_b128 a[172:175], v6 offset:18432
M v[128:131], a[164:167], a[36:39], v[128:131]
 buffer_load_dwordx4 v8, s[16:19], s21 offen offset:0  nt lds
M v[132:135], a[164:167], a[44:47], v[20:23]
 ds_read_b64_tr_b16 a[116:117], v3 offset:40960
 ds_read_b64_tr_b16 a[118:119], v3 offset:41984
M v[132:135], a[160:163], a[40:43], v[132:135]
 buffer_load_dwordx4 v9, s[16:19], s21 offen offset:1024  nt lds
M v[136:139], a[160:163], a[48:51], v[20:23]
M v[136:139], a[164:167], a[52:55], v[136:139]
 ds_read_b64_tr_b16 a[120:121], v4 offset:32768
 ds_read_b64_tr_b16 a[122:123], v4 offset:33792
M v[140:143], a[164:167], a[60:63], v[20:23]
 buffer_load_dwordx4 v10, s[16:19], s21 offen offset:2048  nt lds
M v[140:143], a[160:163], a[56:59], v[140:143]
M v[144:147], a[160:163], a[64:67], v[20:23]
 ds_read_b64_tr_b16 a[124:125], v4 offset:40960
 ds_read_b64_tr_b16 a[126:127], v4 offset:41984
M v[144:147], a[164:167], a[68:71], v[144:147]
 buffer_load_dwordx4 v11, s[16:19], s21 offen offset:3072  nt lds
M v[148:151], a[164:167], a[76:79], v[20:23]
 s_add_u32 s21, s21, 524160
M v[148:151], a[160:163], a[72:75], v[148:151]
M v[152:155], a[160:163], a[80:83], v[20:23]
M v[152:155], a[164:167], a[84:87], v[152:155]
 s_waitcnt lgkmcnt(6)
M v[156:159], a[164:167], a[92:95], v[20:23]
 s_waitcnt vmcnt(16) lgkmcnt(0)
M v[156:159], a[160:163], a[88:91], v[156:159]
 s_barrier
M v[160:163], a[168:171], a[32:35], v[20:23]
 s_add_u32 m0, s24, 0
 ds_read_b128 a[160:163], v5 offset:20480
 ds_read_b128 a[164:167], v6 offset:20480
M v[160:163], a[172:175], a[36:39], v[160:163]
 buffer_load_dwordx4 v12, s[48:51], s22 offen offset:0   lds
M v[164:167], a[172:175], a[44:47], v[20:23]
 ds_read_b64_tr_b16 a[128:129], v1 offset:49152
 ds_read_b64_tr_b16 a[130:131], v1 offset:50176
M v[164:167], a[168:171], a[40:43], v[164:167]
M v[168:171], a[168:171], a[48:51], v[20:23]
 buffer_load_dwordx4 v13, s[48:51], s22 offen offset:1024   lds
M v[168:171], a[172:175], a[52:55], v[168:171]
 ds_read_b64_tr_b16 a[132:133], v1 offset:57344
 ds_read_b64_tr_b16 a[134:135], v1 offset:58368
M v[172:175], a[172:175], a[60:63], v[20:23]
M v[172:175], a[168:171], a[56:59], v[172:175]
M v[176:179], a[168:171], a[64:67], v[20:23]
 ds_read_b64_tr_b16 a[136:137], v2 offset:49152
 ds_read_b64_tr_b16 a[138:139], v2 offset:50176
M v[176:179], a[172:175], a[68:71], v[176:179]
 buffer_load_dwordx4 v14, s[48:51], s22 offen offset:2048   lds
M v[180:183], a[172:175], a[76:79], v[20:23]
M v[180:183], a[168:171], a[72:75], v[180:183]
 ds_read_b64_tr_b16 a[140:141], v2 offset:57344
 ds_read_b64_tr_b16 a[142:143], v2 offset:58368
M v[184:187], a[168:171], a[80:83], v[20:23]
 buffer_load_dwordx4 v15, s[48:51], s22 offen offset:3072   lds
M v[184:187], a[172:175], a[84:87], v[184:187]
 s_waitcnt lgkmcnt(8)
M v[188:191], a[172:175], a[92:95], v[20:23]
 s_add_u32 s22, s22, 2097152
M v[188:191], a[168:171], a[88:91], v[188:191]
 s_add_u32 m0, s23, 32768
 ds_read_b64_tr_b16 a[144:145], v3 offset:49152
 ds_read_b64_tr_b16 a[146:147], v3 offset:50176
M v[192:195], a[160:163], a[32:35], v[20:23]
 ds_read_b128 a[168:171], v5 offset:22528
 ds_read_b128 a[172:175], v6 offset:22528
M v[192:195], a[164:167], a[36:39], v[192:195]
 buffer_load_dwordx4 v8, s[16:19], s21 offen offset:0  nt lds
M v[196:199], a[164:167], a[44:47], v[20:23]
 ds_read_b64_tr_b16 a[148:149], v3 offset:57344
 ds_read_b64_tr_b16 a[150:151], v3 offset:58368
M v[196:199], a[160:163], a[40:43], v[196:199]
 buffer_load_dwordx4 v9, s[16:19], s21 offen offset:1024  nt lds
M v[200:203], a[160:163], a[48:51], v[20:23]
M v[200:203], a[164:167], a[52:55], v[200:203]
 ds_read_b64_tr_b16 a[152:153], v4 offset:49152
 ds_read_b64_tr_b16 a[154:155], v4 offset:50176
M v[204:207], a[164:167], a[60:63], v[20:23]
 buffer_load_dwordx4 v10, s[16:19], s21 offen offset:2048  nt lds
M v[204:207], a[160:163], a[56:59], v[204:207]
M v[208:211], a[160:163], a[64:67], v[20:23]
 ds_read_b64_tr_b16 a[156:157], v4 offset:57344
 ds_read_b64_tr_b16 a[158:159], v4 offset:58368
M v[208:211], a[164:167], a[68:71], v[208:211]
 buffer_load_dwordx4 v11, s[16:19], s21 offen offset:3072  nt lds
M v[212:215], a[164:167], a[76:79], v[20:23]
 s_add_u32 s21, s21, 128
M v[212:215], a[160:163], a[72:75], v[212:215]
M v[216:219], a[160:163], a[80:83], v[20:23]
M v[216:219], a[164:167], a[84:87], v[216:219]
 s_waitcnt lgkmcnt(6)
M v[220:223], a[164:167], a[92:95], v[20:23]
 s_waitcnt vmcnt(16) lgkmcnt(0)
M v[220:223], a[160:163], a[88:91], v[220:223]
 s_barrier
M v[224:227], a[168:171], a[32:35], v[20:23]
 ds_read_b128 a[160:163], v5 offset:32768
 ds_read_b128 a[164:167], v6 offset:32768
M v[224:227], a[172:175], a[36:39], v[224:227]
 buffer_load_dword a240, v24, s[32:35], 0 offen offset:512
M v[228:231], a[172:175], a[44:47], v[20:23]
M v[228:231], a[168:171], a[40:43], v[228:231]
M v[232:235], a[168:171], a[48:51], v[20:23]
M v[232:235], a[172:175], a[52:55], v[232:235]
M v[236:239], a[172:175], a[60:63], v[20:23]
M v[236:239], a[168:171], a[56:59], v[236:239]
M v[240:243], a[168:171], a[64:67], v[20:23]
M v[240:243], a[172:175], a[68:71], v[240:243]
M v[244:247], a[172:175], a[76:79], v[20:23]
M v[244:247], a[168:171], a[72:75], v[244:247]
M v[248:251], a[168:171], a[80:83], v[20:23]
M v[248:251], a[172:175], a[84:87], v[248:251]
 s_waitcnt lgkmcnt(0)
M v[252:255], a[172:175], a[92:95], v[20:23]
M v[252:255], a[168:171], a[88:91], v[252:255]
M a[0:3], a[160:163], a[96:99], a[0:3]
 ds_read_b128 a[168:171], v5 offset:34816
 ds_read_b128 a[172:175], v6 offset:34816
M a[0:3], a[164:167], a[100:103], a[0:3]
 ds_read_b64_tr_b16 a[32:33], v1 offset:0
 ds_read_b64_tr_b16 a[34:35], v1 offset:1024
M a[4:7], a[164:167], a[108:111], a[4:7]
 s_add_u32 m0, s24, 16384
M a[4:7], a[160:163], a[104:107], a[4:7]
 buffer_load_dwordx4 v12, s[48:51], s22 offen offset:0   lds
M a[8:11], a[160:163], a[112:115], a[8:11]
M a[8:11], a[164:167], a[116:119], a[8:11]
M a[12:15], a[164:167], a[124:127], a[12:15]
 ds_read_b64_tr_b16 a[36:37], v1 offset:8192
 ds_read_b64_tr_b16 a[38:39], v1 offset:9216
M a[12:15], a[160:163], a[120:123], a[12:15]
M a[16:19], a[160:163], a[128:131], a[16:19]
 buffer_load_dwordx4 v13, s[48:51], s22 offen offset:1024   lds
M a[16:19], a[164:167], a[132:135], a[16:19]
M a[20:23], a[164:167], a[140:143], a[20:23]
M a[20:23], a[160:163], a[136:139], a[20:23]
 ds_read_b64_tr_b16 a[40:41], v2 offset:0
 ds_read_b64_tr_b16 a[42:43], v2 offset:1024
M a[24:27], a[160:163], a[144:147], a[24:27]
M a[24:27], a[164:167], a[148:151], a[24:27]
 s_waitcnt lgkmcnt(6)
M a[28:31], a[164:167], a[156:159], a[28:31]
 buffer_load_dwordx4 v14, s[48:51], s22 offen offset:2048   lds
M a[28:31], a[160:163], a[152:155], a[28:31]
M v[32:35], a[168:171], a[96:99], v[32:35]
 ds_read_b128 a[160:163], v5 offset:36864
 ds_read_b128 a[164:167], v6 offset:36864
M v[32:35], a[172:175], a[100:103], v[32:35]
 ds_read_b64_tr_b16 a[44:45], v2 offset:8192
 ds_read_b64_tr_b16 a[46:47], v2 offset:9216
M v[36:39], a[172:175], a[108:111], v[36:39]
 buffer_load_dwordx4 v15, s[48:51], s22 offen offset:3072   lds
M v[36:39], a[168:171], a[104:107], v[36:39]
 s_sub_u32 s22, s22, 2097024
M v[40:43], a[168:171], a[112:115], v[40:43]
M v[40:43], a[172:175], a[116:119], v[40:43]
 ds_read_b64_tr_b16 a[48:49], v3 offset:0
 ds_read_b64_tr_b16 a[50:51], v3 offset:1024
M v[44:47], a[172:175], a[124:127], v[44:47]
 s_add_u32 m0, s23, 49152
M v[44:47], a[168:171], a[120:123], v[44:47]
 buffer_load_dwordx4 v8, s[16:19], s21 offen offset:0  nt lds
M v[48:51], a[168:171], a[128:131], v[48:51]
M v[48:51], a[172:175], a[132:135], v[48:51]
M v[52:55], a[172:175], a[140:143], v[52:55]
 ds_read_b64_tr_b16 a[52:53], v3 offset:8192
 ds_read_b64_tr_b16 a[54:55], v3 offset:9216
M v[52:55], a[168:171], a[136:139], v[52:55]
M v[56:59], a[168:171], a[144:147], v[56:59]
 buffer_load_dwordx4 v9, s[16:19], s21 offen offset:1024  nt lds
M v[56:59], a[172:175], a[148:151], v[56:59]
 s_waitcnt lgkmcnt(6)
M v[60:63], a[172:175], a[156:159], v[60:63]
M v[60:63], a[168:171], a[152:155], v[60:63]
 ds_read_b64_tr_b16 a[56:57], v4 offset:0
 ds_read_b64_tr_b16 a[58:59], v4 offset:1024
M v[64:67], a[160:163], a[96:99], v[64:67]
 ds_read_b128 a[168:171], v5 offset:38912
 ds_read_b128 a[172:175], v6 offset:38912
M v[64:67], a[164:167], a[100:103], v[64:67]
 buffer_load_dwordx4 v10, s[16:19], s21 offen offset:2048  nt lds
M v[68:71], a[164:167], a[108:111], v[68:71]
M v[68:71], a[160:163], a[104:107], v[68:71]
M v[72:75], a[160:163], a[112:115], v[72:75]
 ds_read_b64_tr_b16 a[60:61], v4 offset:8192
 ds_read_b64_tr_b16 a[62:63], v4 offset:9216
M v[72:75], a[164:167], a[116:119], v[72:75]
M v[76:79], a[164:167], a[124:127], v[76:79]
 buffer_load_dwordx4 v11, s[16:19], s21 offen offset:3072  nt lds
M v[76:79], a[160:163], a[120:123], v[76:79]
 s_add_u32 s21, s21, 524160
M v[80:83], a[160:163], a[128:131], v[80:83]
M v[80:83], a[164:167], a[132:135], v[80:83]
M v[84:87], a[164:167], a[140:143], v[84:87]
M v[84:87], a[160:163], a[136:139], v[84:87]
M v[88:91], a[160:163], a[144:147], v[88:91]
M v[88:91], a[164:167], a[148:151], v[88:91]
 s_waitcnt lgkmcnt(2)
M v[92:95], a[164:167], a[156:159], v[92:95]
 s_waitcnt vmcnt(17) lgkmcnt(0)
M v[92:95], a[160:163], a[152:155], v[92:95]
 s_barrier
M v[96:99], a[168:171], a[96:99], v[96:99]
 ds_read_b128 a[160:163], v5 offset:49152
 ds_read_b128 a[164:167], v6 offset:49152
M v[96:99], a[172:175], a[100:103], v[96:99]
M v[100:103], a[172:175], a[108:111], v[100:103]
 s_add_u32 m0, s24, 32768
 ds_read_b64_tr_b16 a[64:65], v1 offset:16384
 ds_read_b64_tr_b16 a[66:67], v1 offset:17408
M v[100:103], a[168:171], a[104:107], v[100:103]
 buffer_load_dwordx4 v12, s[48:51], s22 offen offset:0   lds
M v[104:107], a[168:171], a[112:115], v[104:107]
M v[104:107], a[172:175], a[116:119], v[104:107]
M v[108:111], a[172:175], a[124:127], v[108:111]
M v[108:111], a[168:171], a[120:123], v[108:111]
M v[112:115], a[168:171], a[128:131], v[112:115]
M v[112:115], a[172:175], a[132:135], v[112:115]
 ds_read_b64_tr_b16 a[68:69], v1 offset:24576
 ds_read_b64_tr_b16 a[70:71], v1 offset:25600
M v[116:119], a[172:175], a[140:143], v[116:119]
 buffer_load_dwordx4 v13, s[48:51], s22 offen offset:1024   lds
M v[116:119], a[168:171], a[136:139], v[116:119]
M v[120:123], a[168:171], a[144:147], v[120:123]
M v[120:123], a[172:175], a[148:151], v[120:123]
 s_waitcnt lgkmcnt(4)
M v[124:127], a[172:175], a[156:159], v[124:127]
M v[124:127], a[168:171], a[152:155], v[124:127]
M v[128:131], a[160:163], a[96:99], v[128:131]
 ds_read_b128 a[168:171], v5 offset:51200
 ds_read_b128 a[172:175], v6 offset:51200
M v[128:131], a[164:167], a[100:103], v[128:131]
 ds_read_b64_tr_b16 a[72:73], v2 offset:16384
 ds_read_b64_tr_b16 a[74:75], v2 offset:17408
M v[132:135], a[164:167], a[108:111], v[132:135]
 buffer_load_dwordx4 v14, s[48:51], s22 offen offset:2048   lds
M v[132:135], a[160:163], a[104:107], v[132:135]
M v[136:139], a[160:163], a[112:115], v[136:139]
M v[136:139], a[164:167], a[116:119], v[136:139]
M v[140:143], a[164:167], a[124:127], v[140:143]
M v[140:143], a[160:163], a[120:123], v[140:143]
 ds_read_b64_tr_b16 a[76:77], v2 offset:24576
 ds_read_b64_tr_b16 a[78:79], v2 offset:25600
M v[144:147], a[160:163], a[128:131], v[144:147]
 buffer_load_dwordx4 v15, s[48:51], s22 offen offset:3072   lds
M v[144:147], a[164:167], a[132:135], v[144:147]
 s_add_u32 s22, s22, 2097152
M v[148:151], a[164:167], a[140:143], v[148:151]
M v[148:151], a[160:163], a[136:139], v[148:151]
M v[152:155], a[160:163], a[144:147], v[152:155]
M v[152:155], a[164:167], a[148:151], v[152:155]
 s_waitcnt lgkmcnt(4)
M v[156:159], a[164:167], a[156:159], v[156:159]
 s_add_u32 m0, s23, 0
 ds_read_b64_tr_b16 a[80:81], v3 offset:16384
 ds_read_b64_tr_b16 a[82:83], v3 offset:17408
M v[156:159], a[160:163], a[152:155], v[156:159]
 buffer_load_dwordx4 v8, s[16:19], s21 offen offset:0  nt lds
M v[160:163], a[168:171], a[96:99], v[160:163]
 ds_read_b128 a[160:163], v5 offset:53248
 ds_read_b128 a[164:167], v6 offset:53248
M v[160:163], a[172:175], a[100:103], v[160:163]
M v[164:167], a[172:175], a[108:111], v[164:167]
M v[164:167], a[168:171], a[104:107], v[164:167]
M v[168:171], a[168:171], a[112:115], v[168:171]
M v[168:171], a[172:175], a[116:119], v[168:171]
 ds_read_b64_tr_b16 a[84:85], v3 offset:24576
 ds_read_b64_tr_b16 a[86:87], v3 offset:25600
M v[172:175], a[172:175], a[124:127], v[172:175]
 buffer_load_dwordx4 v9, s[16:19], s21 offen offset:1024  nt lds
M v[172:175], a[168:171], a[120:123], v[172:175]
M v[176:179], a[168:171], a[128:131], v[176:179]
M v[176:179], a[172:175], a[132:135], v[176:179]
M v[180:183], a[172:175], a[140:143], v[180:183]
M v[180:183], a[168:171], a[136:139], v[180:183]
M v[184:187], a[168:171], a[144:147], v[184:187]
 ds_read_b64_tr_b16 a[88:89], v4 offset:16384
 ds_read_b64_tr_b16 a[90:91], v4 offset:17408
M v[184:187], a[172:175], a[148:151], v[184:187]
 s_waitcnt lgkmcnt(4)
M v[188:191], a[172:175], a[156:159], v[188:191]
 buffer_load_dwordx4 v10, s[16:19], s21 offen offset:2048  nt lds
M v[188:191], a[168:171], a[152:155], v[188:191]
M v[192:195], a[160:163], a[96:99], v[192:195]
 ds_read_b128 a[168:171], v5 offset:55296
 ds_read_b128 a[172:175], v6 offset:55296
M v[192:195], a[164:167], a[100:103], v[192:195]
M v[196:199], a[164:167], a[108:111], v[196:199]
M v[196:199], a[160:163], a[104:107], v[196:199]
 ds_read_b64_tr_b16 a[92:93], v4 offset:24576
 ds_read_b64_tr_b16 a[94:95], v4 offset:25600
M v[200:203], a[160:163], a[112:115], v[200:203]
 buffer_load_dwordx4 v11, s[16:19], s21 offen offset:3072  nt lds
M v[200:203], a[164:167], a[116:119], v[200:203]
 s_add_u32 s21, s21, 128
M v[204:207], a[164:167], a[124:127], v[204:207]
M v[204:207], a[160:163], a[120:123], v[204:207]
M v[208:211], a[160:163], a[128:131], v[208:211]
M v[208:211], a[164:167], a[132:135], v[208:211]
M v[212:215], a[164:167], a[140:143], v[212:215]
M v[212:215], a[160:163], a[136:139], v[212:215]
M v[216:219], a[160:163], a[144:147], v[216:219]
M v[216:219], a[164:167], a[148:151], v[216:219]
 s_waitcnt lgkmcnt(2)
M v[220:223], a[164:167], a[156:159], v[220:223]
 s_waitcnt vmcnt(17) lgkmcnt(0)
M v[220:223], a[160:163], a[152:155], v[220:223]
 s_barrier
M v[224:227], a[168:171], a[96:99], v[224:227]
 ds_read_b128 a[160:163], v5 offset:0
 ds_read_b128 a[164:167], v6 offset:0
M v[224:227], a[172:175], a[100:103], v[224:227]
 v_min_u32 v16, 1, v0
 v_lshlrev_b32 v16, 29, v16
M v[228:231], a[172:175], a[108:111], v[228:231]
 v_or_b32 v16, s39, v16
 v_mov_b32 v17, 1
M v[228:231], a[168:171], a[104:107], v[228:231]
M v[232:235], a[168:171], a[112:115], v[232:235]
 buffer_store_dword v17, v16, s[12:15], s38 offen offset:64 sc1
M v[232:235], a[172:175], a[116:119], v[232:235]
M v[236:239], a[172:175], a[124:127], v[236:239]
M v[236:239], a[168:171], a[120:123], v[236:239]
M v[240:243], a[168:171], a[128:131], v[240:243]
M v[240:243], a[172:175], a[132:135], v[240:243]
M v[244:247], a[172:175], a[140:143], v[244:247]
M v[244:247], a[168:171], a[136:139], v[244:247]
M v[248:251], a[168:171], a[144:147], v[248:251]
M v[248:251], a[172:175], a[148:151], v[248:251]
 s_waitcnt lgkmcnt(0)
M v[252:255], a[172:175], a[156:159], v[252:255]
M v[252:255], a[168:171], a[152:155], v[252:255]
M a[0:3], a[160:163], a[32:35], a[0:3]
 ds_read_b128 a[168:171], v5 offset:2048
 ds_read_b128 a[172:175], v6 offset:2048
M a[0:3], a[164:167], a[36:39], a[0:3]
 ds_read_b64_tr_b16 a[96:97], v1 offset:32768
 ds_read_b64_tr_b16 a[98:99], v1 offset:33792
M a[4:7], a[164:167], a[44:47], a[4:7]
 s_add_u32 m0, s24, 49152
M a[4:7], a[160:163], a[40:43], a[4:7]
 buffer_load_dwordx4 v12, s[48:51], s22 offen offset:0   lds
M a[8:11], a[160:163], a[48:51], a[8:11]
 v_and_b32 v20, 31, v0
M a[8:11], a[164:167], a[52:55], a[8:11]
 v_lshlrev_b32 v20, 2, v20
M a[12:15], a[164:167], a[60:63], a[12:15]
 ds_read_b64_tr_b16 a[100:101], v1 offset:40960
 ds_read_b64_tr_b16 a[102:103], v1 offset:41984
M a[12:15], a[160:163], a[56:59], a[12:15]
 v_add_u32 v21, 163584, v20
M a[16:19], a[160:163], a[64:67], a[16:19]
 buffer_load_dwordx4 v13, s[48:51], s22 offen offset:1024   lds
M a[16:19], a[164:167], a[68:71], a[16:19]
 ds_read_b32 v19, v21
M a[20:23], a[164:167], a[76:79], a[20:23]
 ds_read_b32 v21, v21 offset:64
M a[20:23], a[160:163], a[72:75], a[20:23]
 s_min_u32 s64, s20, 1
 ds_read_b64_tr_b16 a[104:105], v2 offset:32768
 ds_read_b64_tr_b16 a[106:107], v2 offset:33792
M a[24:27], a[160:163], a[80:83], a[24:27]
 s_lshl_b32 s64, s64, 29
 v_and_b32 v22, 32, v0
M a[24:27], a[164:167], a[84:87], a[24:27]
 s_waitcnt lgkmcnt(8)
 v_lshl_or_b32 v20, v22, 24, v20
M a[28:31], a[164:167], a[92:95], a[28:31]
 buffer_load_dwordx4 v14, s[48:51], s22 offen offset:2048   lds
M a[28:31], a[160:163], a[88:91], a[28:31]
 v_or_b32 v20, s64, v20
M v[32:35], a[168:171], a[32:35], v[32:35]
 ds_read_b128 a[160:163], v5 offset:4096
 ds_read_b128 a[164:167], v6 offset:4096
M v[32:35], a[172:175], a[36:39], v[32:35]
 ds_read_b64_tr_b16 a[108:109], v2 offset:40960
 ds_read_b64_tr_b16 a[110:111], v2 offset:41984
M v[36:39], a[172:175], a[44:47], v[36:39]
 buffer_load_dwordx4 v15, s[48:51], s22 offen offset:3072   lds
M v[36:39], a[168:171], a[40:43], v[36:39]
 s_sub_u32 s22, s22, 2097024
 v_and_b32 v22, 16, v0
M v[40:43], a[168:171], a[48:51], v[40:43]
 v_lshl_or_b32 v18, v22, 25, v20
M v[40:43], a[172:175], a[52:55], v[40:43]
 s_lshl_b32 s72, s30, 7
 ds_read_b64_tr_b16 a[112:113], v3 offset:32768
 ds_read_b64_tr_b16 a[114:115], v3 offset:33792
M v[44:47], a[172:175], a[60:63], v[44:47]
 s_add_u32 m0, s23, 16384
 s_add_u32 s72, s72, 104857600
M v[44:47], a[168:171], a[56:59], v[44:47]
 buffer_load_dwordx4 v8, s[16:19], s21 offen offset:0  nt lds
M v[48:51], a[168:171], a[64:67], v[48:51]
M v[48:51], a[172:175], a[68:71], v[48:51]
M v[52:55], a[172:175], a[76:79], v[52:55]
 ds_read_b64_tr_b16 a[116:117], v3 offset:40960
 ds_read_b64_tr_b16 a[118:119], v3 offset:41984
M v[52:55], a[168:171], a[72:75], v[52:55]
M v[56:59], a[168:171], a[80:83], v[56:59]
 buffer_load_dwordx4 v9, s[16:19], s21 offen offset:1024  nt lds
M v[56:59], a[172:175], a[84:87], v[56:59]
 s_waitcnt lgkmcnt(6)
M v[60:63], a[172:175], a[92:95], v[60:63]
 buffer_store_dword v21, v20, s[8:11], s72 offen sc1
M v[60:63], a[168:171], a[88:91], v[60:63]
 ds_read_b64_tr_b16 a[120:121], v4 offset:32768
 ds_read_b64_tr_b16 a[122:123], v4 offset:33792
M v[64:67], a[160:163], a[32:35], v[64:67]
 ds_read_b128 a[168:171], v5 offset:6144
 ds_read_b128 a[172:175], v6 offset:6144
M v[64:67], a[164:167], a[36:39], v[64:67]
 buffer_load_dwordx4 v10, s[16:19], s21 offen offset:2048  nt lds
M v[68:71], a[164:167], a[44:47], v[68:71]
M v[68:71], a[160:163], a[40:43], v[68:71]
M v[72:75], a[160:163], a[48:51], v[72:75]
 ds_read_b64_tr_b16 a[124:125], v4 offset:40960
 ds_read_b64_tr_b16 a[126:127], v4 offset:41984
M v[72:75], a[164:167], a[52:55], v[72:75]
M v[76:79], a[164:167], a[60:63], v[76:79]
 buffer_load_dwordx4 v11, s[16:19], s21 offen offset:3072  nt lds
M v[76:79], a[160:163], a[56:59], v[76:79]
 s_add_u32 s21, s21, 524160
M v[80:83], a[160:163], a[64:67], v[80:83]
M v[80:83], a[164:167], a[68:71], v[80:83]
M v[84:87], a[164:167], a[76:79], v[84:87]
M v[84:87], a[160:163], a[72:75], v[84:87]
 s_and_b32 s86, s41, 7
M v[88:91], a[160:163], a[80:83], v[88:91]
 s_mul_i32 s86, s86, 14
 s_lshr_b32 s64, s41, 3
 s_mul_i32 s64, s64, 7
M v[88:91], a[164:167], a[84:87], v[88:91]
 s_waitcnt lgkmcnt(2)
 s_add_u32 s86, s86, s64
 s_min_u32 s64, s42, 6
M v[92:95], a[164:167], a[92:95], v[92:95]
 s_waitcnt vmcnt(18) lgkmcnt(0)
 s_add_u32 s86, s86, s64
 s_sub_u32 s64, 6, s42
M v[92:95], a[160:163], a[88:91], v[92:95]
 s_barrier
M v[96:99], a[168:171], a[32:35], v[96:99]
 ds_read_b128 a[160:163], v5 offset:16384
 ds_read_b128 a[164:167], v6 offset:16384
M v[96:99], a[172:175], a[36:39], v[96:99]
 s_and_b32 s88, s64, 536870912
 s_mul_i32 s87, s20, 7168
M v[100:103], a[172:175], a[44:47], v[100:103]
 s_add_u32 m0, s24, 0
 ds_read_b64_tr_b16 a[128:129], v1 offset:49152
 ds_read_b64_tr_b16 a[130:131], v1 offset:50176
M v[100:103], a[168:171], a[40:43], v[100:103]
 buffer_load_dwordx4 v12, s[48:51], s22 offen offset:0   lds
M v[104:107], a[168:171], a[48:51], v[104:107]
 s_add_u32 s87, s87, 131072
M v[104:107], a[172:175], a[52:55], v[104:107]
 s_cmp_lt_u32 s20, 2
M v[108:111], a[172:175], a[60:63], v[108:111]
 s_cselect_b64 s[72:73], s[80:81], s[82:83]
M v[108:111], a[168:171], a[56:59], v[108:111]
 s_mov_b32 s60, s72
M v[112:115], a[168:171], a[64:67], v[112:115]
 s_and_b32 s61, s73, 0xffff
M v[112:115], a[172:175], a[68:71], v[112:115]
 s_mov_b32 s62, 1605632
 ds_read_b64_tr_b16 a[132:133], v1 offset:57344
 ds_read_b64_tr_b16 a[134:135], v1 offset:58368
M v[116:119], a[172:175], a[76:79], v[116:119]
 buffer_load_dwordx4 v13, s[48:51], s22 offen offset:1024   lds
M v[116:119], a[168:171], a[72:75], v[116:119]
 s_mov_b32 s63, 0x20000
M v[120:123], a[168:171], a[80:83], v[120:123]
 s_mov_b32 s68, s84
 s_and_b32 s69, s85, 0xffff
 s_mov_b32 s70, 1605632
M v[120:123], a[172:175], a[84:87], v[120:123]
 s_waitcnt lgkmcnt(4)
 s_mov_b32 s71, 0x20000
M v[124:127], a[172:175], a[92:95], v[124:127]
 s_lshl_b32 s89, s86, 5
 s_and_b32 s64, s20, 1
 s_mul_i32 s64, s64, 802816
M v[124:127], a[168:171], a[88:91], v[124:127]
 buffer_load_dwordx4 v14, s[48:51], s22 offen offset:2048   lds
M v[128:131], a[160:163], a[32:35], v[128:131]
 ds_read_b128 a[168:171], v5 offset:18432
 ds_read_b128 a[172:175], v6 offset:18432
M v[128:131], a[164:167], a[36:39], v[128:131]
 ds_read_b64_tr_b16 a[136:137], v2 offset:49152
 ds_read_b64_tr_b16 a[138:139], v2 offset:50176
M v[132:135], a[164:167], a[44:47], v[132:135]
 s_add_u32 s89, s89, s64
 v_lshrrev_b32 v28, 1, v0
M v[132:135], a[160:163], a[40:43], v[132:135]
 v_mul_u32_u24 v28, 3584, v28
 v_and_b32 v29, 1, v0
M v[136:139], a[160:163], a[48:51], v[136:139]
 v_lshl_add_u32 v25, v29, 4, v28
 v_or_b32 v25, s88, v25
M v[136:139], a[164:167], a[52:55], v[136:139]
M v[140:143], a[164:167], a[60:63], v[140:143]
 buffer_load_dwordx4 v15, s[48:51], s22 offen offset:3072   lds
M v[140:143], a[160:163], a[56:59], v[140:143]
 s_add_u32 s22, s22, 2097152
 ds_read_b64_tr_b16 a[140:141], v2 offset:57344
 ds_read_b64_tr_b16 a[142:143], v2 offset:58368
M v[144:147], a[160:163], a[64:67], v[144:147]
M v[144:147], a[164:167], a[68:71], v[144:147]
M v[148:151], a[164:167], a[76:79], v[148:151]
M v[148:151], a[160:163], a[72:75], v[148:151]
 s_add_u32 m0, s23, 32768
M v[152:155], a[160:163], a[80:83], v[152:155]
 buffer_load_dwordx4 v8, s[16:19], s21 offen offset:0  nt lds
M v[152:155], a[164:167], a[84:87], v[152:155]
 s_waitcnt lgkmcnt(4)
M v[156:159], a[164:167], a[92:95], v[156:159]
 ds_read_b64_tr_b16 a[144:145], v3 offset:49152
 ds_read_b64_tr_b16 a[146:147], v3 offset:50176
M v[156:159], a[160:163], a[88:91], v[156:159]
M v[160:163], a[168:171], a[32:35], v[160:163]
 ds_read_b128 a[160:163], v5 offset:20480
 ds_read_b128 a[164:167], v6 offset:20480
M v[160:163], a[172:175], a[36:39], v[160:163]
M v[164:167], a[172:175], a[44:47], v[164:167]
 buffer_load_dwordx4 v9, s[16:19], s21 offen offset:1024  nt lds
M v[164:167], a[168:171], a[40:43], v[164:167]
M v[168:171], a[168:171], a[48:51], v[168:171]
M v[168:171], a[172:175], a[52:55], v[168:171]
 ds_read_b64_tr_b16 a[148:149], v3 offset:57344
 ds_read_b64_tr_b16 a[150:151], v3 offset:58368
M v[172:175], a[172:175], a[60:63], v[172:175]
M v[172:175], a[168:171], a[56:59], v[172:175]
M v[176:179], a[168:171], a[64:67], v[176:179]
M v[176:179], a[172:175], a[68:71], v[176:179]
 buffer_load_dwordx4 v10, s[16:19], s21 offen offset:2048  nt lds
M v[180:183], a[172:175], a[76:79], v[180:183]
M v[180:183], a[168:171], a[72:75], v[180:183]
M v[184:187], a[168:171], a[80:83], v[184:187]
 ds_read_b64_tr_b16 a[152:153], v4 offset:49152
 ds_read_b64_tr_b16 a[154:155], v4 offset:50176
M v[184:187], a[172:175], a[84:87], v[184:187]
 s_waitcnt lgkmcnt(4)
M v[188:191], a[172:175], a[92:95], v[188:191]
M v[188:191], a[168:171], a[88:91], v[188:191]
 buffer_load_dwordx4 v11, s[16:19], s21 offen offset:3072  nt lds
M v[192:195], a[160:163], a[32:35], v[192:195]
 s_add_u32 s21, s21, 128
 ds_read_b128 a[168:171], v5 offset:22528
 ds_read_b128 a[172:175], v6 offset:22528
M v[192:195], a[164:167], a[36:39], v[192:195]
M v[196:199], a[164:167], a[44:47], v[196:199]
M v[196:199], a[160:163], a[40:43], v[196:199]
 ds_read_b64_tr_b16 a[156:157], v4 offset:57344
 ds_read_b64_tr_b16 a[158:159], v4 offset:58368
M v[200:203], a[160:163], a[48:51], v[200:203]
 s_add_u32 m0, s87, 0
M v[200:203], a[164:167], a[52:55], v[200:203]
 buffer_load_dwordx4 v25, s[60:63], s89 offen offset:0 nt lds
M v[204:207], a[164:167], a[60:63], v[204:207]
 s_add_u32 s89, s89, 114688
M v[204:207], a[160:163], a[56:59], v[204:207]
M v[208:211], a[160:163], a[64:67], v[208:211]
M v[208:211], a[164:167], a[68:71], v[208:211]
M v[212:215], a[164:167], a[76:79], v[212:215]
M v[212:215], a[160:163], a[72:75], v[212:215]
M v[216:219], a[160:163], a[80:83], v[216:219]
M v[216:219], a[164:167], a[84:87], v[216:219]
 s_waitcnt lgkmcnt(2)
M v[220:223], a[164:167], a[92:95], v[220:223]
 s_waitcnt vmcnt(19) lgkmcnt(0)
M v[220:223], a[160:163], a[88:91], v[220:223]
 s_barrier
M v[224:227], a[168:171], a[32:35], v[224:227]
 ds_read_b128 a[160:163], v5 offset:32768
 ds_read_b128 a[164:167], v6 offset:32768
M v[224:227], a[172:175], a[36:39], v[224:227]
M v[228:231], a[172:175], a[44:47], v[228:231]
M v[228:231], a[168:171], a[40:43], v[228:231]
M v[232:235], a[168:171], a[48:51], v[232:235]
M v[232:235], a[172:175], a[52:55], v[232:235]
M v[236:239], a[172:175], a[60:63], v[236:239]
M v[236:239], a[168:171], a[56:59], v[236:239]
M v[240:243], a[168:171], a[64:67], v[240:243]
M v[240:243], a[172:175], a[68:71], v[240:243]
M v[244:247], a[172:175], a[76:79], v[244:247]
M v[244:247], a[168:171], a[72:75], v[244:247]
M v[248:251], a[168:171], a[80:83], v[248:251]
M v[248:251], a[172:175], a[84:87], v[248:251]
 s_waitcnt lgkmcnt(0)
M v[252:255], a[172:175], a[92:95], v[252:255]
M v[252:255], a[168:171], a[88:91], v[252:255]
M a[0:3], a[160:163], a[96:99], a[0:3]
 ds_read_b128 a[168:171], v5 offset:34816
 ds_read_b128 a[172:175], v6 offset:34816
M a[0:3], a[164:167], a[100:103], a[0:3]
 ds_read_b64_tr_b16 a[32:33], v1 offset:0
 ds_read_b64_tr_b16 a[34:35], v1 offset:1024
M a[4:7], a[164:167], a[108:111], a[4:7]
 s_add_u32 m0, s24, 16384
M a[4:7], a[160:163], a[104:107], a[4:7]
 buffer_load_dwordx4 v12, s[48:51], s22 offen offset:0   lds
M a[8:11], a[160:163], a[112:115], a[8:11]
M a[8:11], a[164:167], a[116:119], a[8:11]
M a[12:15], a[164:167], a[124:127], a[12:15]
 ds_read_b64_tr_b16 a[36:37], v1 offset:8192
 ds_read_b64_tr_b16 a[38:39], v1 offset:9216
M a[12:15], a[160:163], a[120:123], a[12:15]
M a[16:19], a[160:163], a[128:131], a[16:19]
 buffer_load_dwordx4 v13, s[48:51], s22 offen offset:1024   lds
M a[16:19], a[164:167], a[132:135], a[16:19]
M a[20:23], a[164:167], a[140:143], a[20:23]
M a[20:23], a[160:163], a[136:139], a[20:23]
 ds_read_b64_tr_b16 a[40:41], v2 offset:0
 ds_read_b64_tr_b16 a[42:43], v2 offset:1024
M a[24:27], a[160:163], a[144:147], a[24:27]
M a[24:27], a[164:167], a[148:151], a[24:27]
 s_waitcnt lgkmcnt(6)
M a[28:31], a[164:167], a[156:159], a[28:31]
 buffer_load_dwordx4 v14, s[48:51], s22 offen offset:2048   lds
M a[28:31], a[160:163], a[152:155], a[28:31]
M v[32:35], a[168:171], a[96:99], v[32:35]
 ds_read_b128 a[160:163], v5 offset:36864
 ds_read_b128 a[164:167], v6 offset:36864
M v[32:35], a[172:175], a[100:103], v[32:35]
 ds_read_b64_tr_b16 a[44:45], v2 offset:8192
 ds_read_b64_tr_b16 a[46:47], v2 offset:9216
M v[36:39], a[172:175], a[108:111], v[36:39]
 buffer_load_dwordx4 v15, s[48:51], s22 offen offset:3072   lds
M v[36:39], a[168:171], a[104:107], v[36:39]
 s_sub_u32 s22, s22, 2097024
M v[40:43], a[168:171], a[112:115], v[40:43]
M v[40:43], a[172:175], a[116:119], v[40:43]
 ds_read_b64_tr_b16 a[48:49], v3 offset:0
 ds_read_b64_tr_b16 a[50:51], v3 offset:1024
M v[44:47], a[172:175], a[124:127], v[44:47]
 s_add_u32 m0, s23, 49152
M v[44:47], a[168:171], a[120:123], v[44:47]
 buffer_load_dwordx4 v8, s[16:19], s21 offen offset:0  nt lds
M v[48:51], a[168:171], a[128:131], v[48:51]
M v[48:51], a[172:175], a[132:135], v[48:51]
M v[52:55], a[172:175], a[140:143], v[52:55]
 ds_read_b64_tr_b16 a[52:53], v3 offset:8192
 ds_read_b64_tr_b16 a[54:55], v3 offset:9216
M v[52:55], a[168:171], a[136:139], v[52:55]
M v[56:59], a[168:171], a[144:147], v[56:59]
 buffer_load_dwordx4 v9, s[16:19], s21 offen offset:1024  nt lds
M v[56:59], a[172:175], a[148:151], v[56:59]
 s_waitcnt lgkmcnt(6)
M v[60:63], a[172:175], a[156:159], v[60:63]
M v[60:63], a[168:171], a[152:155], v[60:63]
 ds_read_b64_tr_b16 a[56:57], v4 offset:0
 ds_read_b64_tr_b16 a[58:59], v4 offset:1024
M v[64:67], a[160:163], a[96:99], v[64:67]
 ds_read_b128 a[168:171], v5 offset:38912
 ds_read_b128 a[172:175], v6 offset:38912
M v[64:67], a[164:167], a[100:103], v[64:67]
 buffer_load_dwordx4 v10, s[16:19], s21 offen offset:2048  nt lds
M v[68:71], a[164:167], a[108:111], v[68:71]
M v[68:71], a[160:163], a[104:107], v[68:71]
M v[72:75], a[160:163], a[112:115], v[72:75]
 ds_read_b64_tr_b16 a[60:61], v4 offset:8192
 ds_read_b64_tr_b16 a[62:63], v4 offset:9216
M v[72:75], a[164:167], a[116:119], v[72:75]
M v[76:79], a[164:167], a[124:127], v[76:79]
 buffer_load_dwordx4 v11, s[16:19], s21 offen offset:3072  nt lds
M v[76:79], a[160:163], a[120:123], v[76:79]
 s_add_u32 s21, s21, 524160
M v[80:83], a[160:163], a[128:131], v[80:83]
M v[80:83], a[164:167], a[132:135], v[80:83]
M v[84:87], a[164:167], a[140:143], v[84:87]
M v[84:87], a[160:163], a[136:139], v[84:87]
M v[88:91], a[160:163], a[144:147], v[88:91]
M v[88:91], a[164:167], a[148:151], v[88:91]
 s_waitcnt lgkmcnt(2)
M v[92:95], a[164:167], a[156:159], v[92:95]
 s_waitcnt vmcnt(17) lgkmcnt(0)
M v[92:95], a[160:163], a[152:155], v[92:95]
 s_barrier
M v[96:99], a[168:171], a[96:99], v[96:99]
 ds_read_b128 a[160:163], v5 offset:49152
 ds_read_b128 a[164:167], v6 offset:49152
M v[96:99], a[172:175], a[100:103], v[96:99]
M v[100:103], a[172:175], a[108:111], v[100:103]
 s_add_u32 m0, s24, 32768
 ds_read_b64_tr_b16 a[64:65], v1 offset:16384
 ds_read_b64_tr_b16 a[66:67], v1 offset:17408
M v[100:103], a[168:171], a[104:107], v[100:103]
 buffer_load_dwordx4 v12, s[48:51], s22 offen offset:0   lds
M v[104:107], a[168:171], a[112:115], v[104:107]
 v_min_u32 v16, 40, v0
 v_lshlrev_b32 v16, 2, v16
M v[104:107], a[172:175], a[116:119], v[104:107]
 buffer_load_dword v17, v16, s[12:15], 0 offen offset:64 sc1
M v[108:111], a[172:175], a[124:127], v[108:111]
M v[108:111], a[168:171], a[120:123], v[108:111]
M v[112:115], a[168:171], a[128:131], v[112:115]
M v[112:115], a[172:175], a[132:135], v[112:115]
 ds_read_b64_tr_b16 a[68:69], v1 offset:24576
 ds_read_b64_tr_b16 a[70:71], v1 offset:25600
M v[116:119], a[172:175], a[140:143], v[116:119]
 buffer_load_dwordx4 v13, s[48:51], s22 offen offset:1024   lds
M v[116:119], a[168:171], a[136:139], v[116:119]
M v[120:123], a[168:171], a[144:147], v[120:123]
M v[120:123], a[172:175], a[148:151], v[120:123]
 s_waitcnt lgkmcnt(4)
M v[124:127], a[172:175], a[156:159], v[124:127]
M v[124:127], a[168:171], a[152:155], v[124:127]
 buffer_load_dwordx4 v14, s[48:51], s22 offen offset:2048   lds
M v[128:131], a[160:163], a[96:99], v[128:131]
 ds_read_b128 a[168:171], v5 offset:51200
 ds_read_b128 a[172:175], v6 offset:51200
M v[128:131], a[164:167], a[100:103], v[128:131]
 ds_read_b64_tr_b16 a[72:73], v2 offset:16384
 ds_read_b64_tr_b16 a[74:75], v2 offset:17408
M v[132:135], a[164:167], a[108:111], v[132:135]
M v[132:135], a[160:163], a[104:107], v[132:135]
M v[136:139], a[160:163], a[112:115], v[136:139]
M v[136:139], a[164:167], a[116:119], v[136:139]
M v[140:143], a[164:167], a[124:127], v[140:143]
 buffer_load_dwordx4 v15, s[48:51], s22 offen offset:3072   lds
M v[140:143], a[160:163], a[120:123], v[140:143]
 s_add_u32 s22, s22, 2097152
 ds_read_b64_tr_b16 a[76:77], v2 offset:24576
 ds_read_b64_tr_b16 a[78:79], v2 offset:25600
M v[144:147], a[160:163], a[128:131], v[144:147]
M v[144:147], a[164:167], a[132:135], v[144:147]
M v[148:151], a[164:167], a[140:143], v[148:151]
M v[148:151], a[160:163], a[136:139], v[148:151]
 s_add_u32 m0, s23, 0
M v[152:155], a[160:163], a[144:147], v[152:155]
 buffer_load_dwordx4 v8, s[16:19], s21 offen offset:0  nt lds
M v[152:155], a[164:167], a[148:151], v[152:155]
 s_waitcnt lgkmcnt(4)
M v[156:159], a[164:167], a[156:159], v[156:159]
 ds_read_b64_tr_b16 a[80:81], v3 offset:16384
 ds_read_b64_tr_b16 a[82:83], v3 offset:17408
M v[156:159], a[160:163], a[152:155], v[156:159]
M v[160:163], a[168:171], a[96:99], v[160:163]
 ds_read_b128 a[160:163], v5 offset:53248
 ds_read_b128 a[164:167], v6 offset:53248
M v[160:163], a[172:175], a[100:103], v[160:163]
M v[164:167], a[172:175], a[108:111], v[164:167]
 buffer_load_dwordx4 v9, s[16:19], s21 offen offset:1024  nt lds
M v[164:167], a[168:171], a[104:107], v[164:167]
M v[168:171], a[168:171], a[112:115], v[168:171]
M v[168:171], a[172:175], a[116:119], v[168:171]
 ds_read_b64_tr_b16 a[84:85], v3 offset:24576
 ds_read_b64_tr_b16 a[86:87], v3 offset:25600
M v[172:175], a[172:175], a[124:127], v[172:175]
M v[172:175], a[168:171], a[120:123], v[172:175]
M v[176:179], a[168:171], a[128:131], v[176:179]
M v[176:179], a[172:175], a[132:135], v[176:179]
 buffer_load_dwordx4 v10, s[16:19], s21 offen offset:2048  nt lds
M v[180:183], a[172:175], a[140:143], v[180:183]
M v[180:183], a[168:171], a[136:139], v[180:183]
M v[184:187], a[168:171], a[144:147], v[184:187]
 ds_read_b64_tr_b16 a[88:89], v4 offset:16384
 ds_read_b64_tr_b16 a[90:91], v4 offset:17408
M v[184:187], a[172:175], a[148:151], v[184:187]
 s_waitcnt lgkmcnt(4)
M v[188:191], a[172:175], a[156:159], v[188:191]
M v[188:191], a[168:171], a[152:155], v[188:191]
 buffer_load_dwordx4 v11, s[16:19], s21 offen offset:3072  nt lds
M v[192:195], a[160:163], a[96:99], v[192:195]
 s_add_u32 s21, s21, 128
 ds_read_b128 a[168:171], v5 offset:55296
 ds_read_b128 a[172:175], v6 offset:55296
M v[192:195], a[164:167], a[100:103], v[192:195]
M v[196:199], a[164:167], a[108:111], v[196:199]
M v[196:199], a[160:163], a[104:107], v[196:199]
 ds_read_b64_tr_b16 a[92:93], v4 offset:24576
 ds_read_b64_tr_b16 a[94:95], v4 offset:25600
M v[200:203], a[160:163], a[112:115], v[200:203]
 s_add_u32 m0, s87, 1024
M v[200:203], a[164:167], a[116:119], v[200:203]
 buffer_load_dwordx4 v25, s[60:63], s89 offen offset:0 nt lds
M v[204:207], a[164:167], a[124:127], v[204:207]
 s_add_u32 s89, s89, 114688
M v[204:207], a[160:163], a[120:123], v[204:207]
M v[208:211], a[160:163], a[128:131], v[208:211]
M v[208:211], a[164:167], a[132:135], v[208:211]
M v[212:215], a[164:167], a[140:143], v[212:215]
M v[212:215], a[160:163], a[136:139], v[212:215]
M v[216:219], a[160:163], a[144:147], v[216:219]
M v[216:219], a[164:167], a[148:151], v[216:219]
 s_waitcnt lgkmcnt(2)
M v[220:223], a[164:167], a[156:159], v[220:223]
 s_waitcnt vmcnt(19) lgkmcnt(0)
M v[220:223], a[160:163], a[152:155], v[220:223]
 s_barrier
M v[224:227], a[168:171], a[96:99], v[224:227]
 ds_read_b128 a[160:163], v5 offset:0
 ds_read_b128 a[164:167], v6 offset:0
M v[224:227], a[172:175], a[100:103], v[224:227]
M v[228:231], a[172:175], a[108:111], v[228:231]
M v[228:231], a[168:171], a[104:107], v[228:231]
M v[232:235], a[168:171], a[112:115], v[232:235]
M v[232:235], a[172:175], a[116:119], v[232:235]
M v[236:239], a[172:175], a[124:127], v[236:239]
M v[236:239], a[168:171], a[120:123], v[236:239]
M v[240:243], a[168:171], a[128:131], v[240:243]
M v[240:243], a[172:175], a[132:135], v[240:243]
M v[244:247], a[172:175], a[140:143], v[244:247]
M v[244:247], a[168:171], a[136:139], v[244:247]
M v[248:251], a[168:171], a[144:147], v[248:251]
M v[248:251], a[172:175], a[148:151], v[248:251]
 s_waitcnt lgkmcnt(0)
M v[252:255], a[172:175], a[156:159], v[252:255]
M v[252:255], a[168:171], a[152:155], v[252:255]
M a[0:3], a[160:163], a[32:35], a[0:3]
 ds_read_b128 a[168:171], v5 offset:2048
 ds_read_b128 a[172:175], v6 offset:2048
M a[0:3], a[164:167], a[36:39], a[0:3]
 ds_read_b64_tr_b16 a[96:97], v1 offset:32768
 ds_read_b64_tr_b16 a[98:99], v1 offset:33792
M a[4:7], a[164:167], a[44:47], a[4:7]
 s_add_u32 m0, s24, 49152
M a[4:7], a[160:163], a[40:43], a[4:7]
 buffer_load_dwordx4 v12, s[48:51], s22 offen offset:0   lds
M a[8:11], a[160:163], a[48:51], a[8:11]
M a[8:11], a[164:167], a[52:55], a[8:11]
M a[12:15], a[164:167], a[60:63], a[12:15]
 ds_read_b64_tr_b16 a[100:101], v1 offset:40960
 ds_read_b64_tr_b16 a[102:103], v1 offset:41984
M a[12:15], a[160:163], a[56:59], a[12:15]
M a[16:19], a[160:163], a[64:67], a[16:19]
 buffer_load_dwordx4 v13, s[48:51], s22 offen offset:1024   lds
M a[16:19], a[164:167], a[68:71], a[16:19]
M a[20:23], a[164:167], a[76:79], a[20:23]
M a[20:23], a[160:163], a[72:75], a[20:23]
 ds_read_b64_tr_b16 a[104:105], v2 offset:32768
 ds_read_b64_tr_b16 a[106:107], v2 offset:33792
M a[24:27], a[160:163], a[80:83], a[24:27]
M a[24:27], a[164:167], a[84:87], a[24:27]
 s_waitcnt lgkmcnt(6)
M a[28:31], a[164:167], a[92:95], a[28:31]
 buffer_load_dwordx4 v14, s[48:51], s22 offen offset:2048   lds
M a[28:31], a[160:163], a[88:91], a[28:31]
M v[32:35], a[168:171], a[32:35], v[32:35]
 ds_read_b128 a[160:163], v5 offset:4096
 ds_read_b128 a[164:167], v6 offset:4096
M v[32:35], a[172:175], a[36:39], v[32:35]
 ds_read_b64_tr_b16 a[108:109], v2 offset:40960
 ds_read_b64_tr_b16 a[110:111], v2 offset:41984
M v[36:39], a[172:175], a[44:47], v[36:39]
 buffer_load_dwordx4 v15, s[48:51], s22 offen offset:3072   lds
M v[36:39], a[168:171], a[40:43], v[36:39]
 s_sub_u32 s22, s22, 2097024
M v[40:43], a[168:171], a[48:51], v[40:43]
M v[40:43], a[172:175], a[52:55], v[40:43]
 ds_read_b64_tr_b16 a[112:113], v3 offset:32768
 ds_read_b64_tr_b16 a[114:115], v3 offset:33792
M v[44:47], a[172:175], a[60:63], v[44:47]
 s_add_u32 m0, s23, 16384
M v[44:47], a[168:171], a[56:59], v[44:47]
 buffer_load_dwordx4 v8, s[16:19], s21 offen offset:0  nt lds
M v[48:51], a[168:171], a[64:67], v[48:51]
M v[48:51], a[172:175], a[68:71], v[48:51]
M v[52:55], a[172:175], a[76:79], v[52:55]
 ds_read_b64_tr_b16 a[116:117], v3 offset:40960
 ds_read_b64_tr_b16 a[118:119], v3 offset:41984
M v[52:55], a[168:171], a[72:75], v[52:55]
M v[56:59], a[168:171], a[80:83], v[56:59]
 buffer_load_dwordx4 v9, s[16:19], s21 offen offset:1024  nt lds
M v[56:59], a[172:175], a[84:87], v[56:59]
 s_waitcnt lgkmcnt(6)
M v[60:63], a[172:175], a[92:95], v[60:63]
M v[60:63], a[168:171], a[88:91], v[60:63]
 ds_read_b64_tr_b16 a[120:121], v4 offset:32768
 ds_read_b64_tr_b16 a[122:123], v4 offset:33792
M v[64:67], a[160:163], a[32:35], v[64:67]
 ds_read_b128 a[168:171], v5 offset:6144
 ds_read_b128 a[172:175], v6 offset:6144
M v[64:67], a[164:167], a[36:39], v[64:67]
 buffer_load_dwordx4 v10, s[16:19], s21 offen offset:2048  nt lds
M v[68:71], a[164:167], a[44:47], v[68:71]
M v[68:71], a[160:163], a[40:43], v[68:71]
M v[72:75], a[160:163], a[48:51], v[72:75]
 ds_read_b64_tr_b16 a[124:125], v4 offset:40960
 ds_read_b64_tr_b16 a[126:127], v4 offset:41984
M v[72:75], a[164:167], a[52:55], v[72:75]
M v[76:79], a[164:167], a[60:63], v[76:79]
 buffer_load_dwordx4 v11, s[16:19], s21 offen offset:3072  nt lds
M v[76:79], a[160:163], a[56:59], v[76:79]
 s_add_u32 s21, s21, 524160
M v[80:83], a[160:163], a[64:67], v[80:83]
M v[80:83], a[164:167], a[68:71], v[80:83]
M v[84:87], a[164:167], a[76:79], v[84:87]
M v[84:87], a[160:163], a[72:75], v[84:87]
M v[88:91], a[160:163], a[80:83], v[88:91]
M v[88:91], a[164:167], a[84:87], v[88:91]
 s_waitcnt lgkmcnt(2)
M v[92:95], a[164:167], a[92:95], v[92:95]
 s_waitcnt vmcnt(18) lgkmcnt(0)
M v[92:95], a[160:163], a[88:91], v[92:95]
 s_barrier
M v[96:99], a[168:171], a[32:35], v[96:99]
 ds_read_b128 a[160:163], v5 offset:16384
 ds_read_b128 a[164:167], v6 offset:16384
M v[96:99], a[172:175], a[36:39], v[96:99]
M v[100:103], a[172:175], a[44:47], v[100:103]
 s_add_u32 m0, s24, 0
 ds_read_b64_tr_b16 a[128:129], v1 offset:49152
 ds_read_b64_tr_b16 a[130:131], v1 offset:50176
M v[100:103], a[168:171], a[40:43], v[100:103]
 buffer_load_dwordx4 v12, s[48:51], s22 offen offset:0   lds
M v[104:107], a[168:171], a[48:51], v[104:107]
M v[104:107], a[172:175], a[52:55], v[104:107]
M v[108:111], a[172:175], a[60:63], v[108:111]
M v[108:111], a[168:171], a[56:59], v[108:111]
M v[112:115], a[168:171], a[64:67], v[112:115]
M v[112:115], a[172:175], a[68:71], v[112:115]
 ds_read_b64_tr_b16 a[132:133], v1 offset:57344
 ds_read_b64_tr_b16 a[134:135], v1 offset:58368
M v[116:119], a[172:175], a[76:79], v[116:119]
 buffer_load_dwordx4 v13, s[48:51], s22 offen offset:1024   lds
M v[116:119], a[168:171], a[72:75], v[116:119]
M v[120:123], a[168:171], a[80:83], v[120:123]
M v[120:123], a[172:175], a[84:87], v[120:123]
 s_waitcnt lgkmcnt(4)
M v[124:127], a[172:175], a[92:95], v[124:127]
M v[124:127], a[168:171], a[88:91], v[124:127]
 buffer_load_dwordx4 v14, s[48:51], s22 offen offset:2048   lds
M v[128:131], a[160:163], a[32:35], v[128:131]
 ds_read_b128 a[168:171], v5 offset:18432
 ds_read_b128 a[172:175], v6 offset:18432
M v[128:131], a[164:167], a[36:39], v[128:131]
 ds_read_b64_tr_b16 a[136:137], v2 offset:49152
 ds_read_b64_tr_b16 a[138:139], v2 offset:50176
M v[132:135], a[164:167], a[44:47], v[132:135]
M v[132:135], a[160:163], a[40:43], v[132:135]
M v[136:139], a[160:163], a[48:51], v[136:139]
M v[136:139], a[164:167], a[52:55], v[136:139]
M v[140:143], a[164:167], a[60:63], v[140:143]
 buffer_load_dwordx4 v15, s[48:51], s22 offen offset:3072   lds
M v[140:143], a[160:163], a[56:59], v[140:143]
 s_add_u32 s22, s22, 2097152
 ds_read_b64_tr_b16 a[140:141], v2 offset:57344
 ds_read_b64_tr_b16 a[142:143], v2 offset:58368
M v[144:147], a[160:163], a[64:67], v[144:147]
M v[144:147], a[164:167], a[68:71], v[144:147]
M v[148:151], a[164:167], a[76:79], v[148:151]
M v[148:151], a[160:163], a[72:75], v[148:151]
 s_add_u32 m0, s23, 32768
M v[152:155], a[160:163], a[80:83], v[152:155]
 buffer_load_dwordx4 v8, s[16:19], s21 offen offset:0  nt lds
M v[152:155], a[164:167], a[84:87], v[152:155]
 s_waitcnt lgkmcnt(4)
M v[156:159], a[164:167], a[92:95], v[156:159]
 ds_read_b64_tr_b16 a[144:145], v3 offset:49152
 ds_read_b64_tr_b16 a[146:147], v3 offset:50176
M v[156:159], a[160:163], a[88:91], v[156:159]
M v[160:163], a[168:171], a[32:35], v[160:163]
 ds_read_b128 a[160:163], v5 offset:20480
 ds_read_b128 a[164:167], v6 offset:20480
M v[160:163], a[172:175], a[36:39], v[160:163]
M v[164:167], a[172:175], a[44:47], v[164:167]
 buffer_load_dwordx4 v9, s[16:19], s21 offen offset:1024  nt lds
M v[164:167], a[168:171], a[40:43], v[164:167]
M v[168:171], a[168:171], a[48:51], v[168:171]
M v[168:171], a[172:175], a[52:55], v[168:171]
 ds_read_b64_tr_b16 a[148:149], v3 offset:57344
 ds_read_b64_tr_b16 a[150:151], v3 offset:58368
M v[172:175], a[172:175], a[60:63], v[172:175]
M v[172:175], a[168:171], a[56:59], v[172:175]
M v[176:179], a[168:171], a[64:67], v[176:179]
M v[176:179], a[172:175], a[68:71], v[176:179]
 buffer_load_dwordx4 v10, s[16:19], s21 offen offset:2048  nt lds
M v[180:183], a[172:175], a[76:79], v[180:183]
M v[180:183], a[168:171], a[72:75], v[180:183]
M v[184:187], a[168:171], a[80:83], v[184:187]
 ds_read_b64_tr_b16 a[152:153], v4 offset:49152
 ds_read_b64_tr_b16 a[154:155], v4 offset:50176
M v[184:187], a[172:175], a[84:87], v[184:187]
 s_waitcnt lgkmcnt(4)
M v[188:191], a[172:175], a[92:95], v[188:191]
M v[188:191], a[168:171], a[88:91], v[188:191]
 buffer_load_dwordx4 v11, s[16:19], s21 offen offset:3072  nt lds
M v[192:195], a[160:163], a[32:35], v[192:195]
 s_add_u32 s21, s21, 128
 ds_read_b128 a[168:171], v5 offset:22528
 ds_read_b128 a[172:175], v6 offset:22528
M v[192:195], a[164:167], a[36:39], v[192:195]
M v[196:199], a[164:167], a[44:47], v[196:199]
M v[196:199], a[160:163], a[40:43], v[196:199]
 ds_read_b64_tr_b16 a[156:157], v4 offset:57344
 ds_read_b64_tr_b16 a[158:159], v4 offset:58368
M v[200:203], a[160:163], a[48:51], v[200:203]
 s_add_u32 m0, s87, 2048
M v[200:203], a[164:167], a[52:55], v[200:203]
 buffer_load_dwordx4 v25, s[60:63], s89 offen offset:0 nt lds
M v[204:207], a[164:167], a[60:63], v[204:207]
 s_add_u32 s89, s89, 114688
M v[204:207], a[160:163], a[56:59], v[204:207]
M v[208:211], a[160:163], a[64:67], v[208:211]
M v[208:211], a[164:167], a[68:71], v[208:211]
M v[212:215], a[164:167], a[76:79], v[212:215]
M v[212:215], a[160:163], a[72:75], v[212:215]
M v[216:219], a[160:163], a[80:83], v[216:219]
M v[216:219], a[164:167], a[84:87], v[216:219]
 s_waitcnt lgkmcnt(2)
M v[220:223], a[164:167], a[92:95], v[220:223]
 s_waitcnt vmcnt(18) lgkmcnt(0)
M v[220:223], a[160:163], a[88:91], v[220:223]
 s_barrier
M v[224:227], a[168:171], a[32:35], v[224:227]
 ds_read_b128 a[160:163], v5 offset:32768
 ds_read_b128 a[164:167], v6 offset:32768
M v[224:227], a[172:175], a[36:39], v[224:227]
 v_cmp_ne_u32 vcc, 1, v17
M v[228:231], a[172:175], a[44:47], v[228:231]
 s_nop 0
M v[228:231], a[168:171], a[40:43], v[228:231]
 s_cbranch_vccnz L_zs0
L_zr0:
M v[232:235], a[168:171], a[48:51], v[232:235]
 buffer_load_dword a240, v24, s[32:35], 0 offen offset:1024
M v[232:235], a[172:175], a[52:55], v[232:235]
 s_lshl_b32 s72, s30, 6
M v[236:239], a[172:175], a[60:63], v[236:239]
 s_add_u32 s72, s72, 104914944
M v[236:239], a[168:171], a[56:59], v[236:239]
M v[240:243], a[168:171], a[64:67], v[240:243]
 buffer_store_dword v19, v18, s[8:11], s72 offen sc1
M v[240:243], a[172:175], a[68:71], v[240:243]
M v[244:247], a[172:175], a[76:79], v[244:247]
M v[244:247], a[168:171], a[72:75], v[244:247]
M v[248:251], a[168:171], a[80:83], v[248:251]
M v[248:251], a[172:175], a[84:87], v[248:251]
 s_waitcnt lgkmcnt(0)
M v[252:255], a[172:175], a[92:95], v[252:255]
M v[252:255], a[168:171], a[88:91], v[252:255]
M a[0:3], a[160:163], a[96:99], a[0:3]
 ds_read_b128 a[168:171], v5 offset:34816
 ds_read_b128 a[172:175], v6 offset:34816
M a[0:3], a[164:167], a[100:103], a[0:3]
 ds_read_b64_tr_b16 a[32:33], v1 offset:0
 ds_read_b64_tr_b16 a[34:35], v1 offset:1024
M a[4:7], a[164:167], a[108:111], a[4:7]
 s_add_u32 m0, s24, 16384
M a[4:7], a[160:163], a[104:107], a[4:7]
 buffer_load_dwordx4 v12, s[48:51], s22 offen offset:0   lds
M a[8:11], a[160:163], a[112:115], a[8:11]
M a[8:11], a[164:167], a[116:119], a[8:11]
M a[12:15], a[164:167], a[124:127], a[12:15]
 ds_read_b64_tr_b16 a[36:37], v1 offset:8192
 ds_read_b64_tr_b16 a[38:39], v1 offset:9216
M a[12:15], a[160:163], a[120:123], a[12:15]
M a[16:19], a[160:163], a[128:131], a[16:19]
 buffer_load_dwordx4 v13, s[48:51], s22 offen offset:1024   lds
M a[16:19], a[164:167], a[132:135], a[16:19]
M a[20:23], a[164:167], a[140:143], a[20:23]
M a[20:23], a[160:163], a[136:139], a[20:23]
 ds_read_b64_tr_b16 a[40:41], v2 offset:0
 ds_read_b64_tr_b16 a[42:43], v2 offset:1024
M a[24:27], a[160:163], a[144:147], a[24:27]
M a[24:27], a[164:167], a[148:151], a[24:27]
 s_waitcnt lgkmcnt(6)
M a[28:31], a[164:167], a[156:159], a[28:31]
 buffer_load_dwordx4 v14, s[48:51], s22 offen offset:2048   lds
M a[28:31], a[160:163], a[152:155], a[28:31]
M v[32:35], a[168:171], a[96:99], v[32:35]
 ds_read_b128 a[160:163], v5 offset:36864
 ds_read_b128 a[164:167], v6 offset:36864
M v[32:35], a[172:175], a[100:103], v[32:35]
 ds_read_b64_tr_b16 a[44:45], v2 offset:8192
 ds_read_b64_tr_b16 a[46:47], v2 offset:9216
M v[36:39], a[172:175], a[108:111], v[36:39]
 buffer_load_dwordx4 v15, s[48:51], s22 offen offset:3072   lds
M v[36:39], a[168:171], a[104:107], v[36:39]
 s_sub_u32 s22, s22, 2097024
M v[40:43], a[168:171], a[112:115], v[40:43]
M v[40:43], a[172:175], a[116:119], v[40:43]
 ds_read_b64_tr_b16 a[48:49], v3 offset:0
 ds_read_b64_tr_b16 a[50:51], v3 offset:1024
M v[44:47], a[172:175], a[124:127], v[44:47]
 s_add_u32 m0, s23, 49152
M v[44:47], a[168:171], a[120:123], v[44:47]
 buffer_load_dwordx4 v8, s[16:19], s21 offen offset:0  nt lds
M v[48:51], a[168:171], a[128:131], v[48:51]
M v[48:51], a[172:175], a[132:135], v[48:51]
M v[52:55], a[172:175], a[140:143], v[52:55]
 ds_read_b64_tr_b16 a[52:53], v3 offset:8192
 ds_read_b64_tr_b16 a[54:55], v3 offset:9216
M v[52:55], a[168:171], a[136:139], v[52:55]
M v[56:59], a[168:171], a[144:147], v[56:59]
 buffer_load_dwordx4 v9, s[16:19], s21 offen offset:1024  nt lds
M v[56:59], a[172:175], a[148:151], v[56:59]
 s_waitcnt lgkmcnt(6)
M v[60:63], a[172:175], a[156:159], v[60:63]
M v[60:63], a[168:171], a[152:155], v[60:63]
 ds_read_b64_tr_b16 a[56:57], v4 offset:0
 ds_read_b64_tr_b16 a[58:59], v4 offset:1024
M v[64:67], a[160:163], a[96:99], v[64:67]
 ds_read_b128 a[168:171], v5 offset:38912
 ds_read_b128 a[172:175], v6 offset:38912
M v[64:67], a[164:167], a[100:103], v[64:67]
 buffer_load_dwordx4 v10, s[16:19], s21 offen offset:2048  nt lds
M v[68:71], a[164:167], a[108:111], v[68:71]
M v[68:71], a[160:163], a[104:107], v[68:71]
M v[72:75], a[160:163], a[112:115], v[72:75]
 ds_read_b64_tr_b16 a[60:61], v4 offset:8192
 ds_read_b64_tr_b16 a[62:63], v4 offset:9216
M v[72:75], a[164:167], a[116:119], v[72:75]
M v[76:79], a[164:167], a[124:127], v[76:79]
 buffer_load_dwordx4 v11, s[16:19], s21 offen offset:3072  nt lds
M v[76:79], a[160:163], a[120:123], v[76:79]
 s_add_u32 s21, s21, 524160
M v[80:83], a[160:163], a[128:131], v[80:83]
M v[80:83], a[164:167], a[132:135], v[80:83]
M v[84:87], a[164:167], a[140:143], v[84:87]
M v[84:87], a[160:163], a[136:139], v[84:87]
M v[88:91], a[160:163], a[144:147], v[88:91]
M v[88:91], a[164:167], a[148:151], v[88:91]
 s_waitcnt lgkmcnt(2)
M v[92:95], a[164:167], a[156:159], v[92:95]
 s_waitcnt vmcnt(19) lgkmcnt(0)
M v[92:95], a[160:163], a[152:155], v[92:95]
 s_barrier
M v[96:99], a[168:171], a[96:99], v[96:99]
 ds_read_b128 a[160:163], v5 offset:49152
 ds_read_b128 a[164:167], v6 offset:49152
M v[96:99], a[172:175], a[100:103], v[96:99]
M v[100:103], a[172:175], a[108:111], v[100:103]
 s_add_u32 m0, s24, 32768
 ds_read_b64_tr_b16 a[64:65], v1 offset:16384
 ds_read_b64_tr_b16 a[66:67], v1 offset:17408
M v[100:103], a[168:171], a[104:107], v[100:103]
 buffer_load_dwordx4 v12, s[48:51], s22 offen offset:0   lds
M v[104:107], a[168:171], a[112:115], v[104:107]
M v[104:107], a[172:175], a[116:119], v[104:107]
M v[108:111], a[172:175], a[124:127], v[108:111]
M v[108:111], a[168:171], a[120:123], v[108:111]
M v[112:115], a[168:171], a[128:131], v[112:115]
M v[112:115], a[172:175], a[132:135], v[112:115]
 ds_read_b64_tr_b16 a[68:69], v1 offset:24576
 ds_read_b64_tr_b16 a[70:71], v1 offset:25600
M v[116:119], a[172:175], a[140:143], v[116:119]
 buffer_load_dwordx4 v13, s[48:51], s22 offen offset:1024   lds
M v[116:119], a[168:171], a[136:139], v[116:119]
M v[120:123], a[168:171], a[144:147], v[120:123]
M v[120:123], a[172:175], a[148:151], v[120:123]
 s_waitcnt lgkmcnt(4)
M v[124:127], a[172:175], a[156:159], v[124:127]
M v[124:127], a[168:171], a[152:155], v[124:127]
 buffer_load_dwordx4 v14, s[48:51], s22 offen offset:2048   lds
M v[128:131], a[160:163], a[96:99], v[128:131]
 ds_read_b128 a[168:171], v5 offset:51200
 ds_read_b128 a[172:175], v6 offset:51200
M v[128:131], a[164:167], a[100:103], v[128:131]
 ds_read_b64_tr_b16 a[72:73], v2 offset:16384
 ds_read_b64_tr_b16 a[74:75], v2 offset:17408
M v[132:135], a[164:167], a[108:111], v[132:135]
M v[132:135], a[160:163], a[104:107], v[132:135]
M v[136:139], a[160:163], a[112:115], v[136:139]
M v[136:139], a[164:167], a[116:119], v[136:139]
M v[140:143], a[164:167], a[124:127], v[140:143]
 buffer_load_dwordx4 v15, s[48:51], s22 offen offset:3072   lds
M v[140:143], a[160:163], a[120:123], v[140:143]
 s_add_u32 s22, s22, 2097152
 ds_read_b64_tr_b16 a[76:77], v2 offset:24576
 ds_read_b64_tr_b16 a[78:79], v2 offset:25600
M v[144:147], a[160:163], a[128:131], v[144:147]
M v[144:147], a[164:167], a[132:135], v[144:147]
M v[148:151], a[164:167], a[140:143], v[148:151]
M v[148:151], a[160:163], a[136:139], v[148:151]
 s_add_u32 m0, s23, 0
M v[152:155], a[160:163], a[144:147], v[152:155]
 buffer_load_dwordx4 v8, s[16:19], s21 offen offset:0  nt lds
M v[152:155], a[164:167], a[148:151], v[152:155]
 s_waitcnt lgkmcnt(4)
M v[156:159], a[164:167], a[156:159], v[156:159]
 ds_read_b64_tr_b16 a[80:81], v3 offset:16384
 ds_read_b64_tr_b16 a[82:83], v3 offset:17408
M v[156:159], a[160:163], a[152:155], v[156:159]
M v[160:163], a[168:171], a[96:99], v[160:163]
 ds_read_b128 a[160:163], v5 offset:53248
 ds_read_b128 a[164:167], v6 offset:53248
M v[160:163], a[172:175], a[100:103], v[160:163]
M v[164:167], a[172:175], a[108:111], v[164:167]
 buffer_load_dwordx4 v9, s[16:19], s21 offen offset:1024  nt lds
M v[164:167], a[168:171], a[104:107], v[164:167]
M v[168:171], a[168:171], a[112:115], v[168:171]
M v[168:171], a[172:175], a[116:119], v[168:171]
 ds_read_b64_tr_b16 a[84:85], v3 offset:24576
 ds_read_b64_tr_b16 a[86:87], v3 offset:25600
M v[172:175], a[172:175], a[124:127], v[172:175]
M v[172:175], a[168:171], a[120:123], v[172:175]
M v[176:179], a[168:171], a[128:131], v[176:179]
M v[176:179], a[172:175], a[132:135], v[176:179]
 buffer_load_dwordx4 v10, s[16:19], s21 offen offset:2048  nt lds
M v[180:183], a[172:175], a[140:143], v[180:183]
M v[180:183], a[168:171], a[136:139], v[180:183]
M v[184:187], a[168:171], a[144:147], v[184:187]
 ds_read_b64_tr_b16 a[88:89], v4 offset:16384
 ds_read_b64_tr_b16 a[90:91], v4 offset:17408
M v[184:187], a[172:175], a[148:151], v[184:187]
 s_waitcnt lgkmcnt(4)
M v[188:191], a[172:175], a[156:159], v[188:191]
M v[188:191], a[168:171], a[152:155], v[188:191]
 buffer_load_dwordx4 v11, s[16:19], s21 offen offset:3072  nt lds
M v[192:195], a[160:163], a[96:99], v[192:195]
 s_add_u32 s21, s21, 128
 ds_read_b128 a[168:171], v5 offset:55296
 ds_read_b128 a[172:175], v6 offset:55296
M v[192:195], a[164:167], a[100:103], v[192:195]
M v[196:199], a[164:167], a[108:111], v[196:199]
M v[196:199], a[160:163], a[104:107], v[196:199]
 ds_read_b64_tr_b16 a[92:93], v4 offset:24576
 ds_read_b64_tr_b16 a[94:95], v4 offset:25600
M v[200:203], a[160:163], a[112:115], v[200:203]
 s_add_u32 m0, s87, 3072
M v[200:203], a[164:167], a[116:119], v[200:203]
 buffer_load_dwordx4 v25, s[60:63], s89 offen offset:0 nt lds
M v[204:207], a[164:167], a[124:127], v[204:207]
 s_add_u32 s89, s89, 114688
M v[204:207], a[160:163], a[120:123], v[204:207]
M v[208:211], a[160:163], a[128:131], v[208:211]
M v[208:211], a[164:167], a[132:135], v[208:211]
M v[212:215], a[164:167], a[140:143], v[212:215]
M v[212:215], a[160:163], a[136:139], v[212:215]
M v[216:219], a[160:163], a[144:147], v[216:219]
M v[216:219], a[164:167], a[148:151], v[216:219]
 s_waitcnt lgkmcnt(2)
M v[220:223], a[164:167], a[156:159], v[220:223]
 s_waitcnt vmcnt(20) lgkmcnt(0)
M v[220:223], a[160:163], a[152:155], v[220:223]
 s_barrier
M v[224:227], a[168:171], a[96:99], v[224:227]
 ds_read_b128 a[160:163], v5 offset:0
 ds_read_b128 a[164:167], v6 offset:0
M v[224:227], a[172:175], a[100:103], v[224:227]
M v[228:231], a[172:175], a[108:111], v[228:231]
M v[228:231], a[168:171], a[104:107], v[228:231]
M v[232:235], a[168:171], a[112:115], v[232:235]
M v[232:235], a[172:175], a[116:119], v[232:235]
M v[236:239], a[172:175], a[124:127], v[236:239]
M v[236:239], a[168:171], a[120:123], v[236:239]
M v[240:243], a[168:171], a[128:131], v[240:243]
M v[240:243], a[172:175], a[132:135], v[240:243]
M v[244:247], a[172:175], a[140:143], v[244:247]
M v[244:247], a[168:171], a[136:139], v[244:247]
M v[248:251], a[168:171], a[144:147], v[248:251]
M v[248:251], a[172:175], a[148:151], v[248:251]
 s_waitcnt lgkmcnt(0)
M v[252:255], a[172:175], a[156:159], v[252:255]
M v[252:255], a[168:171], a[152:155], v[252:255]
M a[0:3], a[160:163], a[32:35], a[0:3]
 ds_read_b128 a[168:171], v5 offset:2048
 ds_read_b128 a[172:175], v6 offset:2048
M a[0:3], a[164:167], a[36:39], a[0:3]
 ds_read_b64_tr_b16 a[96:97], v1 offset:32768
 ds_read_b64_tr_b16 a[98:99], v1 offset:33792
M a[4:7], a[164:167], a[44:47], a[4:7]
 s_add_u32 m0, s24, 49152
M a[4:7], a[160:163], a[40:43], a[4:7]
 buffer_load_dwordx4 v12, s[48:51], s22 offen offset:0   lds
M a[8:11], a[160:163], a[48:51], a[8:11]
M a[8:11], a[164:167], a[52:55], a[8:11]
M a[12:15], a[164:167], a[60:63], a[12:15]
 ds_read_b64_tr_b16 a[100:101], v1 offset:40960
 ds_read_b64_tr_b16 a[102:103], v1 offset:41984
M a[12:15], a[160:163], a[56:59], a[12:15]
M a[16:19], a[160:163], a[64:67], a[16:19]
 buffer_load_dwordx4 v13, s[48:51], s22 offen offset:1024   lds
M a[16:19], a[164:167], a[68:71], a[16:19]
M a[20:23], a[164:167], a[76:79], a[20:23]
M a[20:23], a[160:163], a[72:75], a[20:23]
 ds_read_b64_tr_b16 a[104:105], v2 offset:32768
 ds_read_b64_tr_b16 a[106:107], v2 offset:33792
M a[24:27], a[160:163], a[80:83], a[24:27]
M a[24:27], a[164:167], a[84:87], a[24:27]
 s_waitcnt lgkmcnt(6)
M a[28:31], a[164:167], a[92:95], a[28:31]
 buffer_load_dwordx4 v14, s[48:51], s22 offen offset:2048   lds
M a[28:31], a[160:163], a[88:91], a[28:31]
M v[32:35], a[168:171], a[32:35], v[32:35]
 ds_read_b128 a[160:163], v5 offset:4096
 ds_read_b128 a[164:167], v6 offset:4096
M v[32:35], a[172:175], a[36:39], v[32:35]
 ds_read_b64_tr_b16 a[108:109], v2 offset:40960
 ds_read_b64_tr_b16 a[110:111], v2 offset:41984
M v[36:39], a[172:175], a[44:47], v[36:39]
 buffer_load_dwordx4 v15, s[48:51], s22 offen offset:3072   lds
M v[36:39], a[168:171], a[40:43], v[36:39]
 s_sub_u32 s22, s22, 2097024
M v[40:43], a[168:171], a[48:51], v[40:43]
M v[40:43], a[172:175], a[52:55], v[40:43]
 ds_read_b64_tr_b16 a[112:113], v3 offset:32768
 ds_read_b64_tr_b16 a[114:115], v3 offset:33792
M v[44:47], a[172:175], a[60:63], v[44:47]
 s_add_u32 m0, s23, 16384
M v[44:47], a[168:171], a[56:59], v[44:47]
 buffer_load_dwordx4 v8, s[16:19], s21 offen offset:0  nt lds
M v[48:51], a[168:171], a[64:67], v[48:51]
M v[48:51], a[172:175], a[68:71], v[48:51]
M v[52:55], a[172:175], a[76:79], v[52:55]
 ds_read_b64_tr_b16 a[116:117], v3 offset:40960
 ds_read_b64_tr_b16 a[118:119], v3 offset:41984
M v[52:55], a[168:171], a[72:75], v[52:55]
M v[56:59], a[168:171], a[80:83], v[56:59]
 buffer_load_dwordx4 v9, s[16:19], s21 offen offset:1024  nt lds
M v[56:59], a[172:175], a[84:87], v[56:59]
 s_waitcnt lgkmcnt(6)
M v[60:63], a[172:175], a[92:95], v[60:63]
M v[60:63], a[168:171], a[88:91], v[60:63]
 ds_read_b64_tr_b16 a[120:121], v4 offset:32768
 ds_read_b64_tr_b16 a[122:123], v4 offset:33792
M v[64:67], a[160:163], a[32:35], v[64:67]
 ds_read_b128 a[168:171], v5 offset:6144
 ds_read_b128 a[172:175], v6 offset:6144
M v[64:67], a[164:167], a[36:39], v[64:67]
 buffer_load_dwordx4 v10, s[16:19], s21 offen offset:2048  nt lds
M v[68:71], a[164:167], a[44:47], v[68:71]
M v[68:71], a[160:163], a[40:43], v[68:71]
M v[72:75], a[160:163], a[48:51], v[72:75]
 ds_read_b64_tr_b16 a[124:125], v4 offset:40960
 ds_read_b64_tr_b16 a[126:127], v4 offset:41984
M v[72:75], a[164:167], a[52:55], v[72:75]
M v[76:79], a[164:167], a[60:63], v[76:79]
 buffer_load_dwordx4 v11, s[16:19], s21 offen offset:3072  nt lds
M v[76:79], a[160:163], a[56:59], v[76:79]
 s_add_u32 s21, s21, 524160
M v[80:83], a[160:163], a[64:67], v[80:83]
M v[80:83], a[164:167], a[68:71], v[80:83]
M v[84:87], a[164:167], a[76:79], v[84:87]
M v[84:87], a[160:163], a[72:75], v[84:87]
M v[88:91], a[160:163], a[80:83], v[88:91]
M v[88:91], a[164:167], a[84:87], v[88:91]
 s_waitcnt lgkmcnt(2)
M v[92:95], a[164:167], a[92:95], v[92:95]
 s_waitcnt vmcnt(17) lgkmcnt(0)
M v[92:95], a[160:163], a[88:91], v[92:95]
 s_barrier
M v[96:99], a[168:171], a[32:35], v[96:99]
 ds_read_b128 a[160:163], v5 offset:16384
 ds_read_b128 a[164:167], v6 offset:16384
M v[96:99], a[172:175], a[36:39], v[96:99]
M v[100:103], a[172:175], a[44:47], v[100:103]
 s_add_u32 m0, s24, 0
 ds_read_b64_tr_b16 a[128:129], v1 offset:49152
 ds_read_b64_tr_b16 a[130:131], v1 offset:50176
M v[100:103], a[168:171], a[40:43], v[100:103]
 buffer_load_dwordx4 v12, s[48:51], s22 offen offset:0   lds
M v[104:107], a[168:171], a[48:51], v[104:107]
M v[104:107], a[172:175], a[52:55], v[104:107]
M v[108:111], a[172:175], a[60:63], v[108:111]
M v[108:111], a[168:171], a[56:59], v[108:111]
M v[112:115], a[168:171], a[64:67], v[112:115]
M v[112:115], a[172:175], a[68:71], v[112:115]
 ds_read_b64_tr_b16 a[132:133], v1 offset:57344
 ds_read_b64_tr_b16 a[134:135], v1 offset:58368
M v[116:119], a[172:175], a[76:79], v[116:119]
 buffer_load_dwordx4 v13, s[48:51], s22 offen offset:1024   lds
M v[116:119], a[168:171], a[72:75], v[116:119]
M v[120:123], a[168:171], a[80:83], v[120:123]
M v[120:123], a[172:175], a[84:87], v[120:123]
 s_waitcnt lgkmcnt(4)
M v[124:127], a[172:175], a[92:95], v[124:127]
M v[124:127], a[168:171], a[88:91], v[124:127]
 buffer_load_dwordx4 v14, s[48:51], s22 offen offset:2048   lds
M v[128:131], a[160:163], a[32:35], v[128:131]
 ds_read_b128 a[168:171], v5 offset:18432
 ds_read_b128 a[172:175], v6 offset:18432
M v[128:131], a[164:167], a[36:39], v[128:131]
 ds_read_b64_tr_b16 a[136:137], v2 offset:49152
 ds_read_b64_tr_b16 a[138:139], v2 offset:50176
M v[132:135], a[164:167], a[44:47], v[132:135]
M v[132:135], a[160:163], a[40:43], v[132:135]
M v[136:139], a[160:163], a[48:51], v[136:139]
M v[136:139], a[164:167], a[52:55], v[136:139]
M v[140:143], a[164:167], a[60:63], v[140:143]
 buffer_load_dwordx4 v15, s[48:51], s22 offen offset:3072   lds
M v[140:143], a[160:163], a[56:59], v[140:143]
 s_add_u32 s22, s22, 2097152
 ds_read_b64_tr_b16 a[140:141], v2 offset:57344
 ds_read_b64_tr_b16 a[142:143], v2 offset:58368
M v[144:147], a[160:163], a[64:67], v[144:147]
M v[144:147], a[164:167], a[68:71], v[144:147]
M v[148:151], a[164:167], a[76:79], v[148:151]
M v[148:151], a[160:163], a[72:75], v[148:151]
 s_add_u32 m0, s23, 32768
M v[152:155], a[160:163], a[80:83], v[152:155]
 buffer_load_dwordx4 v8, s[16:19], s21 offen offset:0  nt lds
M v[152:155], a[164:167], a[84:87], v[152:155]
 s_waitcnt lgkmcnt(4)
M v[156:159], a[164:167], a[92:95], v[156:159]
 ds_read_b64_tr_b16 a[144:145], v3 offset:49152
 ds_read_b64_tr_b16 a[146:147], v3 offset:50176
M v[156:159], a[160:163], a[88:91], v[156:159]
M v[160:163], a[168:171], a[32:35], v[160:163]
 ds_read_b128 a[160:163], v5 offset:20480
 ds_read_b128 a[164:167], v6 offset:20480
M v[160:163], a[172:175], a[36:39], v[160:163]
M v[164:167], a[172:175], a[44:47], v[164:167]
 buffer_load_dwordx4 v9, s[16:19], s21 offen offset:1024  nt lds
M v[164:167], a[168:171], a[40:43], v[164:167]
M v[168:171], a[168:171], a[48:51], v[168:171]
M v[168:171], a[172:175], a[52:55], v[168:171]
 ds_read_b64_tr_b16 a[148:149], v3 offset:57344
 ds_read_b64_tr_b16 a[150:151], v3 offset:58368
M v[172:175], a[172:175], a[60:63], v[172:175]
M v[172:175], a[168:171], a[56:59], v[172:175]
M v[176:179], a[168:171], a[64:67], v[176:179]
M v[176:179], a[172:175], a[68:71], v[176:179]
 buffer_load_dwordx4 v10, s[16:19], s21 offen offset:2048  nt lds
M v[180:183], a[172:175], a[76:79], v[180:183]
M v[180:183], a[168:171], a[72:75], v[180:183]
M v[184:187], a[168:171], a[80:83], v[184:187]
 ds_read_b64_tr_b16 a[152:153], v4 offset:49152
 ds_read_b64_tr_b16 a[154:155], v4 offset:50176
M v[184:187], a[172:175], a[84:87], v[184:187]
 s_waitcnt lgkmcnt(4)
M v[188:191], a[172:175], a[92:95], v[188:191]
M v[188:191], a[168:171], a[88:91], v[188:191]
 buffer_load_dwordx4 v11, s[16:19], s21 offen offset:3072  nt lds
M v[192:195], a[160:163], a[32:35], v[192:195]
 s_add_u32 s21, s21, 128
 ds_read_b128 a[168:171], v5 offset:22528
 ds_read_b128 a[172:175], v6 offset:22528
M v[192:195], a[164:167], a[36:39], v[192:195]
M v[196:199], a[164:167], a[44:47], v[196:199]
M v[196:199], a[160:163], a[40:43], v[196:199]
 ds_read_b64_tr_b16 a[156:157], v4 offset:57344
 ds_read_b64_tr_b16 a[158:159], v4 offset:58368
M v[200:203], a[160:163], a[48:51], v[200:203]
 s_add_u32 m0, s87, 4096
M v[200:203], a[164:167], a[52:55], v[200:203]
 buffer_load_dwordx4 v25, s[60:63], s89 offen offset:0 nt lds
M v[204:207], a[164:167], a[60:63], v[204:207]
 s_add_u32 s89, s89, 114688
M v[204:207], a[160:163], a[56:59], v[204:207]
M v[208:211], a[160:163], a[64:67], v[208:211]
M v[208:211], a[164:167], a[68:71], v[208:211]
M v[212:215], a[164:167], a[76:79], v[212:215]
M v[212:215], a[160:163], a[72:75], v[212:215]
M v[216:219], a[160:163], a[80:83], v[216:219]
M v[216:219], a[164:167], a[84:87], v[216:219]
 s_waitcnt lgkmcnt(2)
M v[220:223], a[164:167], a[92:95], v[220:223]
 s_waitcnt vmcnt(18) lgkmcnt(0)
M v[220:223], a[160:163], a[88:91], v[220:223]
 s_barrier
M v[224:227], a[168:171], a[32:35], v[224:227]
 ds_read_b128 a[160:163], v5 offset:32768
 ds_read_b128 a[164:167], v6 offset:32768
M v[224:227], a[172:175], a[36:39], v[224:227]
 v_and_b32 v26, 48, v0
 v_lshlrev_b32 v26, 17, v26
M v[228:231], a[172:175], a[44:47], v[228:231]
 v_or_b32 v26, v26, v0
 v_lshl_add_u32 v26, v26, 7, s95
M v[228:231], a[168:171], a[40:43], v[228:231]
 buffer_load_dword a240, v26, s[76:79], 0 offen offset:0
M v[232:235], a[168:171], a[48:51], v[232:235]
M v[232:235], a[172:175], a[52:55], v[232:235]
M v[236:239], a[172:175], a[60:63], v[236:239]
M v[236:239], a[168:171], a[56:59], v[236:239]
M v[240:243], a[168:171], a[64:67], v[240:243]
M v[240:243], a[172:175], a[68:71], v[240:243]
M v[244:247], a[172:175], a[76:79], v[244:247]
M v[244:247], a[168:171], a[72:75], v[244:247]
M v[248:251], a[168:171], a[80:83], v[248:251]
M v[248:251], a[172:175], a[84:87], v[248:251]
 s_waitcnt lgkmcnt(0)
M v[252:255], a[172:175], a[92:95], v[252:255]
M v[252:255], a[168:171], a[88:91], v[252:255]
M a[0:3], a[160:163], a[96:99], a[0:3]
 ds_read_b128 a[168:171], v5 offset:34816
 ds_read_b128 a[172:175], v6 offset:34816
M a[0:3], a[164:167], a[100:103], a[0:3]
 ds_read_b64_tr_b16 a[32:33], v1 offset:0
 ds_read_b64_tr_b16 a[34:35], v1 offset:1024
M a[4:7], a[164:167], a[108:111], a[4:7]
 s_add_u32 m0, s24, 16384
M a[4:7], a[160:163], a[104:107], a[4:7]
 buffer_load_dwordx4 v12, s[48:51], s22 offen offset:0   lds
M a[8:11], a[160:163], a[112:115], a[8:11]
M a[8:11], a[164:167], a[116:119], a[8:11]
 s_lshl_b32 s67, s20, 11
M a[12:15], a[164:167], a[124:127], a[12:15]
 s_add_u32 s67, s67, 104914944
 ds_read_b64_tr_b16 a[36:37], v1 offset:8192
 ds_read_b64_tr_b16 a[38:39], v1 offset:9216
M a[12:15], a[160:163], a[120:123], a[12:15]
M a[16:19], a[160:163], a[128:131], a[16:19]
 buffer_load_dwordx4 v13, s[48:51], s22 offen offset:1024   lds
M a[16:19], a[164:167], a[132:135], a[16:19]
M a[20:23], a[164:167], a[140:143], a[20:23]
 buffer_load_dwordx4 v[16:19], v7, s[8:11], s67 offen offset:0 sc1
M a[20:23], a[160:163], a[136:139], a[20:23]
 ds_read_b64_tr_b16 a[40:41], v2 offset:0
 ds_read_b64_tr_b16 a[42:43], v2 offset:1024
M a[24:27], a[160:163], a[144:147], a[24:27]
 buffer_load_dwordx4 v[20:23], v7, s[8:11], s67 offen offset:1024 sc1
M a[24:27], a[164:167], a[148:151], a[24:27]
 s_waitcnt lgkmcnt(6)
M a[28:31], a[164:167], a[156:159], a[28:31]
 buffer_load_dwordx4 v14, s[48:51], s22 offen offset:2048   lds
M a[28:31], a[160:163], a[152:155], a[28:31]
M v[32:35], a[168:171], a[96:99], v[32:35]
 ds_read_b128 a[160:163], v5 offset:36864
 ds_read_b128 a[164:167], v6 offset:36864
M v[32:35], a[172:175], a[100:103], v[32:35]
 ds_read_b64_tr_b16 a[44:45], v2 offset:8192
 ds_read_b64_tr_b16 a[46:47], v2 offset:9216
M v[36:39], a[172:175], a[108:111], v[36:39]
 buffer_load_dwordx4 v15, s[48:51], s22 offen offset:3072   lds
M v[36:39], a[168:171], a[104:107], v[36:39]
 s_sub_u32 s22, s22, 2097024
M v[40:43], a[168:171], a[112:115], v[40:43]
M v[40:43], a[172:175], a[116:119], v[40:43]
 ds_read_b64_tr_b16 a[48:49], v3 offset:0
 ds_read_b64_tr_b16 a[50:51], v3 offset:1024
M v[44:47], a[172:175], a[124:127], v[44:47]
 s_add_u32 m0, s23, 49152
M v[44:47], a[168:171], a[120:123], v[44:47]
 buffer_load_dwordx4 v8, s[16:19], s21 offen offset:0  nt lds
M v[48:51], a[168:171], a[128:131], v[48:51]
M v[48:51], a[172:175], a[132:135], v[48:51]
M v[52:55], a[172:175], a[140:143], v[52:55]
 ds_read_b64_tr_b16 a[52:53], v3 offset:8192
 ds_read_b64_tr_b16 a[54:55], v3 offset:9216
M v[52:55], a[168:171], a[136:139], v[52:55]
M v[56:59], a[168:171], a[144:147], v[56:59]
 buffer_load_dwordx4 v9, s[16:19], s21 offen offset:1024  nt lds
M v[56:59], a[172:175], a[148:151], v[56:59]
 s_waitcnt lgkmcnt(6)
M v[60:63], a[172:175], a[156:159], v[60:63]
M v[60:63], a[168:171], a[152:155], v[60:63]
 ds_read_b64_tr_b16 a[56:57], v4 offset:0
 ds_read_b64_tr_b16 a[58:59], v4 offset:1024
M v[64:67], a[160:163], a[96:99], v[64:67]
 ds_read_b128 a[168:171], v5 offset:38912
 ds_read_b128 a[172:175], v6 offset:38912
M v[64:67], a[164:167], a[100:103], v[64:67]
 buffer_load_dwordx4 v10, s[16:19], s21 offen offset:2048  nt lds
M v[68:71], a[164:167], a[108:111], v[68:71]
M v[68:71], a[160:163], a[104:107], v[68:71]
M v[72:75], a[160:163], a[112:115], v[72:75]
 ds_read_b64_tr_b16 a[60:61], v4 offset:8192
 ds_read_b64_tr_b16 a[62:63], v4 offset:9216
M v[72:75], a[164:167], a[116:119], v[72:75]
M v[76:79], a[164:167], a[124:127], v[76:79]
 buffer_load_dwordx4 v11, s[16:19], s21 offen offset:3072  nt lds
M v[76:79], a[160:163], a[120:123], v[76:79]
 s_add_u32 s21, s21, 524160
M v[80:83], a[160:163], a[128:131], v[80:83]
M v[80:83], a[164:167], a[132:135], v[80:83]
M v[84:87], a[164:167], a[140:143], v[84:87]
M v[84:87], a[160:163], a[136:139], v[84:87]
M v[88:91], a[160:163], a[144:147], v[88:91]
M v[88:91], a[164:167], a[148:151], v[88:91]
 s_waitcnt lgkmcnt(2)
M v[92:95], a[164:167], a[156:159], v[92:95]
 s_waitcnt vmcnt(20) lgkmcnt(0)
M v[92:95], a[160:163], a[152:155], v[92:95]
 s_barrier
M v[96:99], a[168:171], a[96:99], v[96:99]
 ds_read_b128 a[160:163], v5 offset:49152
 ds_read_b128 a[164:167], v6 offset:49152
M v[96:99], a[172:175], a[100:103], v[96:99]
M v[100:103], a[172:175], a[108:111], v[100:103]
 s_add_u32 m0, s24, 32768
 ds_read_b64_tr_b16 a[64:65], v1 offset:16384
 ds_read_b64_tr_b16 a[66:67], v1 offset:17408
M v[100:103], a[168:171], a[104:107], v[100:103]
 buffer_load_dwordx4 v12, s[48:51], s22 offen offset:0   lds
M v[104:107], a[168:171], a[112:115], v[104:107]
M v[104:107], a[172:175], a[116:119], v[104:107]
M v[108:111], a[172:175], a[124:127], v[108:111]
M v[108:111], a[168:171], a[120:123], v[108:111]
M v[112:115], a[168:171], a[128:131], v[112:115]
M v[112:115], a[172:175], a[132:135], v[112:115]
 ds_read_b64_tr_b16 a[68:69], v1 offset:24576
 ds_read_b64_tr_b16 a[70:71], v1 offset:25600
M v[116:119], a[172:175], a[140:143], v[116:119]
 buffer_load_dwordx4 v13, s[48:51], s22 offen offset:1024   lds
M v[116:119], a[168:171], a[136:139], v[116:119]
M v[120:123], a[168:171], a[144:147], v[120:123]
M v[120:123], a[172:175], a[148:151], v[120:123]
 s_waitcnt lgkmcnt(4)
M v[124:127], a[172:175], a[156:159], v[124:127]
M v[124:127], a[168:171], a[152:155], v[124:127]
 buffer_load_dwordx4 v14, s[48:51], s22 offen offset:2048   lds
M v[128:131], a[160:163], a[96:99], v[128:131]
 ds_read_b128 a[168:171], v5 offset:51200
 ds_read_b128 a[172:175], v6 offset:51200
M v[128:131], a[164:167], a[100:103], v[128:131]
 ds_read_b64_tr_b16 a[72:73], v2 offset:16384
 ds_read_b64_tr_b16 a[74:75], v2 offset:17408
M v[132:135], a[164:167], a[108:111], v[132:135]
M v[132:135], a[160:163], a[104:107], v[132:135]
M v[136:139], a[160:163], a[112:115], v[136:139]
M v[136:139], a[164:167], a[116:119], v[136:139]
M v[140:143], a[164:167], a[124:127], v[140:143]
 buffer_load_dwordx4 v15, s[48:51], s22 offen offset:3072   lds
M v[140:143], a[160:163], a[120:123], v[140:143]
 s_add_u32 s22, s22, 2097152
 ds_read_b64_tr_b16 a[76:77], v2 offset:24576
 ds_read_b64_tr_b16 a[78:79], v2 offset:25600
M v[144:147], a[160:163], a[128:131], v[144:147]
M v[144:147], a[164:167], a[132:135], v[144:147]
M v[148:151], a[164:167], a[140:143], v[148:151]
M v[148:151], a[160:163], a[136:139], v[148:151]
 s_add_u32 m0, s23, 0
M v[152:155], a[160:163], a[144:147], v[152:155]
 buffer_load_dwordx4 v8, s[16:19], s21 offen offset:0  nt lds
M v[152:155], a[164:167], a[148:151], v[152:155]
 s_waitcnt lgkmcnt(4)
M v[156:159], a[164:167], a[156:159], v[156:159]
 ds_read_b64_tr_b16 a[80:81], v3 offset:16384
 ds_read_b64_tr_b16 a[82:83], v3 offset:17408
M v[156:159], a[160:163], a[152:155], v[156:159]
M v[160:163], a[168:171], a[96:99], v[160:163]
 ds_read_b128 a[160:163], v5 offset:53248
 ds_read_b128 a[164:167], v6 offset:53248
M v[160:163], a[172:175], a[100:103], v[160:163]
M v[164:167], a[172:175], a[108:111], v[164:167]
 buffer_load_dwordx4 v9, s[16:19], s21 offen offset:1024  nt lds
M v[164:167], a[168:171], a[104:107], v[164:167]
M v[168:171], a[168:171], a[112:115], v[168:171]
M v[168:171], a[172:175], a[116:119], v[168:171]
 ds_read_b64_tr_b16 a[84:85], v3 offset:24576
 ds_read_b64_tr_b16 a[86:87], v3 offset:25600
M v[172:175], a[172:175], a[124:127], v[172:175]
M v[172:175], a[168:171], a[120:123], v[172:175]
M v[176:179], a[168:171], a[128:131], v[176:179]
M v[176:179], a[172:175], a[132:135], v[176:179]
 buffer_load_dwordx4 v10, s[16:19], s21 offen offset:2048  nt lds
M v[180:183], a[172:175], a[140:143], v[180:183]
M v[180:183], a[168:171], a[136:139], v[180:183]
M v[184:187], a[168:171], a[144:147], v[184:187]
 ds_read_b64_tr_b16 a[88:89], v4 offset:16384
 ds_read_b64_tr_b16 a[90:91], v4 offset:17408
M v[184:187], a[172:175], a[148:151], v[184:187]
 s_waitcnt lgkmcnt(4)
M v[188:191], a[172:175], a[156:159], v[188:191]
M v[188:191], a[168:171], a[152:155], v[188:191]
 buffer_load_dwordx4 v11, s[16:19], s21 offen offset:3072  nt lds
M v[192:195], a[160:163], a[96:99], v[192:195]
 s_add_u32 s21, s21, 128
 ds_read_b128 a[168:171], v5 offset:55296
 ds_read_b128 a[172:175], v6 offset:55296
M v[192:195], a[164:167], a[100:103], v[192:195]
M v[196:199], a[164:167], a[108:111], v[196:199]
M v[196:199], a[160:163], a[104:107], v[196:199]
 ds_read_b64_tr_b16 a[92:93], v4 offset:24576
 ds_read_b64_tr_b16 a[94:95], v4 offset:25600
M v[200:203], a[160:163], a[112:115], v[200:203]
 s_add_u32 m0, s87, 5120
M v[200:203], a[164:167], a[116:119], v[200:203]
 buffer_load_dwordx4 v25, s[60:63], s89 offen offset:0 nt lds
M v[204:207], a[164:167], a[124:127], v[204:207]
 s_add_u32 s89, s89, 114688
M v[204:207], a[160:163], a[120:123], v[204:207]
M v[208:211], a[160:163], a[128:131], v[208:211]
M v[208:211], a[164:167], a[132:135], v[208:211]
M v[212:215], a[164:167], a[140:143], v[212:215]
M v[212:215], a[160:163], a[136:139], v[212:215]
M v[216:219], a[160:163], a[144:147], v[216:219]
M v[216:219], a[164:167], a[148:151], v[216:219]
 s_waitcnt lgkmcnt(2)
M v[220:223], a[164:167], a[156:159], v[220:223]
 s_waitcnt vmcnt(21) lgkmcnt(0)
M v[220:223], a[160:163], a[152:155], v[220:223]
 s_barrier
M v[224:227], a[168:171], a[96:99], v[224:227]
 ds_read_b128 a[160:163], v5 offset:0
 ds_read_b128 a[164:167], v6 offset:0
M v[224:227], a[172:175], a[100:103], v[224:227]
M v[228:231], a[172:175], a[108:111], v[228:231]
M v[228:231], a[168:171], a[104:107], v[228:231]
M v[232:235], a[168:171], a[112:115], v[232:235]
M v[232:235], a[172:175], a[116:119], v[232:235]
M v[236:239], a[172:175], a[124:127], v[236:239]
M v[236:239], a[168:171], a[120:123], v[236:239]
M v[240:243], a[168:171], a[128:131], v[240:243]
M v[240:243], a[172:175], a[132:135], v[240:243]
M v[244:247], a[172:175], a[140:143], v[244:247]
M v[244:247], a[168:171], a[136:139], v[244:247]
M v[248:251], a[168:171], a[144:147], v[248:251]
M v[248:251], a[172:175], a[148:151], v[248:251]
 s_waitcnt lgkmcnt(0)
M v[252:255], a[172:175], a[156:159], v[252:255]
M v[252:255], a[168:171], a[152:155], v[252:255]
M a[0:3], a[160:163], a[32:35], a[0:3]
 ds_read_b128 a[168:171], v5 offset:2048
 ds_read_b128 a[172:175], v6 offset:2048
M a[0:3], a[164:167], a[36:39], a[0:3]
 ds_read_b64_tr_b16 a[96:97], v1 offset:32768
 ds_read_b64_tr_b16 a[98:99], v1 offset:33792
M a[4:7], a[164:167], a[44:47], a[4:7]
 s_add_u32 m0, s24, 49152
M a[4:7], a[160:163], a[40:43], a[4:7]
 buffer_load_dwordx4 v12, s[48:51], s22 offen offset:0   lds
M a[8:11], a[160:163], a[48:51], a[8:11]
M a[8:11], a[164:167], a[52:55], a[8:11]
M a[12:15], a[164:167], a[60:63], a[12:15]
 ds_read_b64_tr_b16 a[100:101], v1 offset:40960
 ds_read_b64_tr_b16 a[102:103], v1 offset:41984
M a[12:15], a[160:163], a[56:59], a[12:15]
M a[16:19], a[160:163], a[64:67], a[16:19]
 buffer_load_dwordx4 v13, s[48:51], s22 offen offset:1024   lds
M a[16:19], a[164:167], a[68:71], a[16:19]
M a[20:23], a[164:167], a[76:79], a[20:23]
 s_waitcnt vmcnt(18)
 v_min3_u32 v28, v16, v17, v18
M a[20:23], a[160:163], a[72:75], a[20:23]
 ds_read_b64_tr_b16 a[104:105], v2 offset:32768
 ds_read_b64_tr_b16 a[106:107], v2 offset:33792
M a[24:27], a[160:163], a[80:83], a[24:27]
 s_waitcnt vmcnt(17)
 v_min3_u32 v28, v28, v19, v20
M a[24:27], a[164:167], a[84:87], a[24:27]
 s_waitcnt lgkmcnt(6)
 v_min3_u32 v28, v28, v21, v22
M a[28:31], a[164:167], a[92:95], a[28:31]
 buffer_load_dwordx4 v14, s[48:51], s22 offen offset:2048   lds
M a[28:31], a[160:163], a[88:91], a[28:31]
 v_min_u32 v28, v28, v23
M v[32:35], a[168:171], a[32:35], v[32:35]
 ds_read_b128 a[160:163], v5 offset:4096
 ds_read_b128 a[164:167], v6 offset:4096
M v[32:35], a[172:175], a[36:39], v[32:35]
 ds_read_b64_tr_b16 a[108:109], v2 offset:40960
 ds_read_b64_tr_b16 a[110:111], v2 offset:41984
M v[36:39], a[172:175], a[44:47], v[36:39]
 buffer_load_dwordx4 v15, s[48:51], s22 offen offset:3072   lds
M v[36:39], a[168:171], a[40:43], v[36:39]
 s_sub_u32 s22, s22, 2097024
 v_cmp_eq_u32 vcc, 0, v28
M v[40:43], a[168:171], a[48:51], v[40:43]
 s_nop 0
M v[40:43], a[172:175], a[52:55], v[40:43]
 s_cbranch_vccnz L_hs
L_hr:
 ds_read_b64_tr_b16 a[112:113], v3 offset:32768
 ds_read_b64_tr_b16 a[114:115], v3 offset:33792
M v[44:47], a[172:175], a[60:63], v[44:47]
 s_add_u32 m0, s23, 16384
 v_max_u32 v28, v16, v17
M v[44:47], a[168:171], a[56:59], v[44:47]
 buffer_load_dwordx4 v8, s[16:19], s21 offen offset:0  nt lds
M v[48:51], a[168:171], a[64:67], v[48:51]
 v_min_u32 v29, v16, v17
M v[48:51], a[172:175], a[68:71], v[48:51]
 v_med3_u32 v29, v28, v29, v18
M v[52:55], a[172:175], a[76:79], v[52:55]
 ds_read_b64_tr_b16 a[116:117], v3 offset:40960
 ds_read_b64_tr_b16 a[118:119], v3 offset:41984
M v[52:55], a[168:171], a[72:75], v[52:55]
 v_max_u32 v28, v28, v18
M v[56:59], a[168:171], a[80:83], v[56:59]
 buffer_load_dwordx4 v9, s[16:19], s21 offen offset:1024  nt lds
M v[56:59], a[172:175], a[84:87], v[56:59]
 s_waitcnt lgkmcnt(6)
 v_med3_u32 v29, v28, v29, v19
M v[60:63], a[172:175], a[92:95], v[60:63]
 v_max_u32 v28, v28, v19
M v[60:63], a[168:171], a[88:91], v[60:63]
 ds_read_b64_tr_b16 a[120:121], v4 offset:32768
 ds_read_b64_tr_b16 a[122:123], v4 offset:33792
M v[64:67], a[160:163], a[32:35], v[64:67]
 ds_read_b128 a[168:171], v5 offset:6144
 ds_read_b128 a[172:175], v6 offset:6144
M v[64:67], a[164:167], a[36:39], v[64:67]
 buffer_load_dwordx4 v10, s[16:19], s21 offen offset:2048  nt lds
M v[68:71], a[164:167], a[44:47], v[68:71]
 v_med3_u32 v29, v28, v29, v20
M v[68:71], a[160:163], a[40:43], v[68:71]
 v_max_u32 v28, v28, v20
M v[72:75], a[160:163], a[48:51], v[72:75]
 ds_read_b64_tr_b16 a[124:125], v4 offset:40960
 ds_read_b64_tr_b16 a[126:127], v4 offset:41984
M v[72:75], a[164:167], a[52:55], v[72:75]
 v_med3_u32 v29, v28, v29, v21
M v[76:79], a[164:167], a[60:63], v[76:79]
 buffer_load_dwordx4 v11, s[16:19], s21 offen offset:3072  nt lds
M v[76:79], a[160:163], a[56:59], v[76:79]
 s_add_u32 s21, s21, 524160
 v_max_u32 v28, v28, v21
M v[80:83], a[160:163], a[64:67], v[80:83]
 v_med3_u32 v29, v28, v29, v22
M v[80:83], a[164:167], a[68:71], v[80:83]
 v_max_u32 v28, v28, v22
M v[84:87], a[164:167], a[76:79], v[84:87]
 v_med3_u32 v29, v28, v29, v23
M v[84:87], a[160:163], a[72:75], v[84:87]
 v_max_u32 v28, v28, v23
M v[88:91], a[160:163], a[80:83], v[88:91]
 s_nop 0
 v_mov_b32 v30, v28 row_ror:8 row_mask:0xf bank_mask:0xf
M v[88:91], a[164:167], a[84:87], v[88:91]
 s_waitcnt lgkmcnt(2)
 v_mov_b32 v31, v29 row_ror:8 row_mask:0xf bank_mask:0xf
M v[92:95], a[164:167], a[92:95], v[92:95]
 s_waitcnt vmcnt(17) lgkmcnt(0)
 v_min_u32 v16, v28, v30
M v[92:95], a[160:163], a[88:91], v[92:95]
 s_barrier
M v[96:99], a[168:171], a[32:35], v[96:99]
 ds_read_b128 a[160:163], v5 offset:16384
 ds_read_b128 a[164:167], v6 offset:16384
M v[96:99], a[172:175], a[36:39], v[96:99]
 v_max_u32 v28, v28, v30
M v[100:103], a[172:175], a[44:47], v[100:103]
 s_add_u32 m0, s24, 0
 ds_read_b64_tr_b16 a[128:129], v1 offset:49152
 ds_read_b64_tr_b16 a[130:131], v1 offset:50176
M v[100:103], a[168:171], a[40:43], v[100:103]
 buffer_load_dwordx4 v12, s[48:51], s22 offen offset:0   lds
M v[104:107], a[168:171], a[48:51], v[104:107]
 v_max3_u32 v29, v29, v31, v16
M v[104:107], a[172:175], a[52:55], v[104:107]
 v_mov_b32 v30, v28 row_ror:4 row_mask:0xf bank_mask:0xf
M v[108:111], a[172:175], a[60:63], v[108:111]
 v_mov_b32 v31, v29 row_ror:4 row_mask:0xf bank_mask:0xf
M v[108:111], a[168:171], a[56:59], v[108:111]
 v_min_u32 v16, v28, v30
M v[112:115], a[168:171], a[64:67], v[112:115]
 v_max_u32 v28, v28, v30
M v[112:115], a[172:175], a[68:71], v[112:115]
 ds_read_b64_tr_b16 a[132:133], v1 offset:57344
 ds_read_b64_tr_b16 a[134:135], v1 offset:58368
M v[116:119], a[172:175], a[76:79], v[116:119]
 buffer_load_dwordx4 v13, s[48:51], s22 offen offset:1024   lds
M v[116:119], a[168:171], a[72:75], v[116:119]
 v_max3_u32 v29, v29, v31, v16
M v[120:123], a[168:171], a[80:83], v[120:123]
 v_mov_b32 v30, v28 row_ror:2 row_mask:0xf bank_mask:0xf
M v[120:123], a[172:175], a[84:87], v[120:123]
 s_waitcnt lgkmcnt(4)
 v_mov_b32 v31, v29 row_ror:2 row_mask:0xf bank_mask:0xf
M v[124:127], a[172:175], a[92:95], v[124:127]
 v_min_u32 v16, v28, v30
M v[124:127], a[168:171], a[88:91], v[124:127]
 buffer_load_dwordx4 v14, s[48:51], s22 offen offset:2048   lds
M v[128:131], a[160:163], a[32:35], v[128:131]
 ds_read_b128 a[168:171], v5 offset:18432
 ds_read_b128 a[172:175], v6 offset:18432
M v[128:131], a[164:167], a[36:39], v[128:131]
 ds_read_b64_tr_b16 a[136:137], v2 offset:49152
 ds_read_b64_tr_b16 a[138:139], v2 offset:50176
M v[132:135], a[164:167], a[44:47], v[132:135]
 v_max_u32 v28, v28, v30
M v[132:135], a[160:163], a[40:43], v[132:135]
 v_max3_u32 v29, v29, v31, v16
M v[136:139], a[160:163], a[48:51], v[136:139]
 v_mov_b32 v30, v28 row_ror:1 row_mask:0xf bank_mask:0xf
M v[136:139], a[164:167], a[52:55], v[136:139]
 v_mov_b32 v31, v29 row_ror:1 row_mask:0xf bank_mask:0xf
M v[140:143], a[164:167], a[60:63], v[140:143]
 buffer_load_dwordx4 v15, s[48:51], s22 offen offset:3072   lds
M v[140:143], a[160:163], a[56:59], v[140:143]
 s_add_u32 s22, s22, 2097152
 ds_read_b64_tr_b16 a[140:141], v2 offset:57344
 ds_read_b64_tr_b16 a[142:143], v2 offset:58368
M v[144:147], a[160:163], a[64:67], v[144:147]
 v_min_u32 v16, v28, v30
M v[144:147], a[164:167], a[68:71], v[144:147]
 v_max_u32 v28, v28, v30
M v[148:151], a[164:167], a[76:79], v[148:151]
 v_max3_u32 v29, v29, v31, v16
M v[148:151], a[160:163], a[72:75], v[148:151]
 s_add_u32 m0, s23, 32768
 v_mov_b32 v30, v28
M v[152:155], a[160:163], a[80:83], v[152:155]
 buffer_load_dwordx4 v8, s[16:19], s21 offen offset:0  nt lds
M v[152:155], a[164:167], a[84:87], v[152:155]
 s_waitcnt lgkmcnt(4)
 v_mov_b32 v31, v29
M v[156:159], a[164:167], a[92:95], v[156:159]
 ds_read_b64_tr_b16 a[144:145], v3 offset:49152
 ds_read_b64_tr_b16 a[146:147], v3 offset:50176
M v[156:159], a[160:163], a[88:91], v[156:159]
 v_permlane16_swap_b32 v30, v28
M v[160:163], a[168:171], a[32:35], v[160:163]
 ds_read_b128 a[160:163], v5 offset:20480
 ds_read_b128 a[164:167], v6 offset:20480
M v[160:163], a[172:175], a[36:39], v[160:163]
 v_permlane16_swap_b32 v31, v29
M v[164:167], a[172:175], a[44:47], v[164:167]
 buffer_load_dwordx4 v9, s[16:19], s21 offen offset:1024  nt lds
M v[164:167], a[168:171], a[40:43], v[164:167]
 v_min_u32 v16, v28, v30
M v[168:171], a[168:171], a[48:51], v[168:171]
 v_max_u32 v28, v28, v30
M v[168:171], a[172:175], a[52:55], v[168:171]
 ds_read_b64_tr_b16 a[148:149], v3 offset:57344
 ds_read_b64_tr_b16 a[150:151], v3 offset:58368
M v[172:175], a[172:175], a[60:63], v[172:175]
 v_max3_u32 v29, v29, v31, v16
M v[172:175], a[168:171], a[56:59], v[172:175]
 v_mov_b32 v30, v28
M v[176:179], a[168:171], a[64:67], v[176:179]
 v_mov_b32 v31, v29
M v[176:179], a[172:175], a[68:71], v[176:179]
 buffer_load_dwordx4 v10, s[16:19], s21 offen offset:2048  nt lds
M v[180:183], a[172:175], a[76:79], v[180:183]
 v_permlane32_swap_b32 v30, v28
M v[180:183], a[168:171], a[72:75], v[180:183]
 v_permlane32_swap_b32 v31, v29
M v[184:187], a[168:171], a[80:83], v[184:187]
 ds_read_b64_tr_b16 a[152:153], v4 offset:49152
 ds_read_b64_tr_b16 a[154:155], v4 offset:50176
M v[184:187], a[172:175], a[84:87], v[184:187]
 s_waitcnt lgkmcnt(4)
 v_min_u32 v16, v28, v30
M v[188:191], a[172:175], a[92:95], v[188:191]
 v_max_u32 v28, v28, v30
M v[188:191], a[168:171], a[88:91], v[188:191]
 buffer_load_dwordx4 v11, s[16:19], s21 offen offset:3072  nt lds
M v[192:195], a[160:163], a[32:35], v[192:195]
 s_add_u32 s21, s21, 128
 ds_read_b128 a[168:171], v5 offset:22528
 ds_read_b128 a[172:175], v6 offset:22528
M v[192:195], a[164:167], a[36:39], v[192:195]
 v_max3_u32 v29, v29, v31, v16
M v[196:199], a[164:167], a[44:47], v[196:199]
 s_lshl_b32 s64, s20, 3
M v[196:199], a[160:163], a[40:43], v[196:199]
 s_add_u32 s64, s64, 159744
 ds_read_b64_tr_b16 a[156:157], v4 offset:57344
 ds_read_b64_tr_b16 a[158:159], v4 offset:58368
M v[200:203], a[160:163], a[48:51], v[200:203]
 s_add_u32 m0, s87, 6144
 v_mov_b32 v16, s64
M v[200:203], a[164:167], a[52:55], v[200:203]
 buffer_load_dwordx4 v25, s[60:63], s89 offen offset:0 nt lds
M v[204:207], a[164:167], a[60:63], v[204:207]
 s_add_u32 s89, s89, 114688
 ds_write_b64 v16, v[28:29]
M v[204:207], a[160:163], a[56:59], v[204:207]
M v[208:211], a[160:163], a[64:67], v[208:211]
M v[208:211], a[164:167], a[68:71], v[208:211]
M v[212:215], a[164:167], a[76:79], v[212:215]
M v[212:215], a[160:163], a[72:75], v[212:215]
M v[216:219], a[160:163], a[80:83], v[216:219]
M v[216:219], a[164:167], a[84:87], v[216:219]
 s_waitcnt lgkmcnt(3)
M v[220:223], a[164:167], a[92:95], v[220:223]
 s_waitcnt vmcnt(18) lgkmcnt(0)
M v[220:223], a[160:163], a[88:91], v[220:223]
 s_barrier
M v[224:227], a[168:171], a[32:35], v[224:227]
 ds_read_b128 a[160:163], v5 offset:32768
 ds_read_b128 a[164:167], v6 offset:32768
M v[224:227], a[172:175], a[36:39], v[224:227]
 buffer_load_dword a240, v24, s[32:35], 0 offen offset:1536
M v[228:231], a[172:175], a[44:47], v[228:231]
M v[228:231], a[168:171], a[40:43], v[228:231]
M v[232:235], a[168:171], a[48:51], v[232:235]
M v[232:235], a[172:175], a[52:55], v[232:235]
M v[236:239], a[172:175], a[60:63], v[236:239]
M v[236:239], a[168:171], a[56:59], v[236:239]
M v[240:243], a[168:171], a[64:67], v[240:243]
M v[240:243], a[172:175], a[68:71], v[240:243]
M v[244:247], a[172:175], a[76:79], v[244:247]
M v[244:247], a[168:171], a[72:75], v[244:247]
M v[248:251], a[168:171], a[80:83], v[248:251]
M v[248:251], a[172:175], a[84:87], v[248:251]
 s_waitcnt lgkmcnt(0)
M v[252:255], a[172:175], a[92:95], v[252:255]
M v[252:255], a[168:171], a[88:91], v[252:255]
M a[0:3], a[160:163], a[96:99], a[0:3]
 ds_read_b128 a[168:171], v5 offset:34816
 ds_read_b128 a[172:175], v6 offset:34816
M a[0:3], a[164:167], a[100:103], a[0:3]
 ds_read_b64_tr_b16 a[32:33], v1 offset:0
 ds_read_b64_tr_b16 a[34:35], v1 offset:1024
M a[4:7], a[164:167], a[108:111], a[4:7]
 s_add_u32 m0, s24, 16384
M a[4:7], a[160:163], a[104:107], a[4:7]
 buffer_load_dwordx4 v12, s[48:51], s22 offen offset:0   lds
M a[8:11], a[160:163], a[112:115], a[8:11]
 v_mov_b32 v28, 159744
M a[8:11], a[164:167], a[116:119], a[8:11]
 ds_read_b128 v[16:19], v28
M a[12:15], a[164:167], a[124:127], a[12:15]
 ds_read_b64_tr_b16 a[36:37], v1 offset:8192
 ds_read_b64_tr_b16 a[38:39], v1 offset:9216
M a[12:15], a[160:163], a[120:123], a[12:15]
 ds_read_b128 v[20:23], v28 offset:16
M a[16:19], a[160:163], a[128:131], a[16:19]
 buffer_load_dwordx4 v13, s[48:51], s22 offen offset:1024   lds
M a[16:19], a[164:167], a[132:135], a[16:19]
M a[20:23], a[164:167], a[140:143], a[20:23]
M a[20:23], a[160:163], a[136:139], a[20:23]
 ds_read_b64_tr_b16 a[40:41], v2 offset:0
 ds_read_b64_tr_b16 a[42:43], v2 offset:1024
M a[24:27], a[160:163], a[144:147], a[24:27]
M a[24:27], a[164:167], a[148:151], a[24:27]
 s_waitcnt lgkmcnt(8)
M a[28:31], a[164:167], a[156:159], a[28:31]
 buffer_load_dwordx4 v14, s[48:51], s22 offen offset:2048   lds
M a[28:31], a[160:163], a[152:155], a[28:31]
M v[32:35], a[168:171], a[96:99], v[32:35]
 ds_read_b128 a[160:163], v5 offset:36864
 ds_read_b128 a[164:167], v6 offset:36864
M v[32:35], a[172:175], a[100:103], v[32:35]
 ds_read_b64_tr_b16 a[44:45], v2 offset:8192
 ds_read_b64_tr_b16 a[46:47], v2 offset:9216
M v[36:39], a[172:175], a[108:111], v[36:39]
 buffer_load_dwordx4 v15, s[48:51], s22 offen offset:3072   lds
M v[36:39], a[168:171], a[104:107], v[36:39]
 s_sub_u32 s22, s22, 2097024
 s_waitcnt lgkmcnt(9)
 v_min_u32 v28, v16, v18
M v[40:43], a[168:171], a[112:115], v[40:43]
 v_max_u32 v16, v16, v18
M v[40:43], a[172:175], a[116:119], v[40:43]
 ds_read_b64_tr_b16 a[48:49], v3 offset:0
 ds_read_b64_tr_b16 a[50:51], v3 offset:1024
M v[44:47], a[172:175], a[124:127], v[44:47]
 s_add_u32 m0, s23, 49152
 v_max3_u32 v17, v17, v19, v28
M v[44:47], a[168:171], a[120:123], v[44:47]
 buffer_load_dwordx4 v8, s[16:19], s21 offen offset:0  nt lds
M v[48:51], a[168:171], a[128:131], v[48:51]
 s_waitcnt lgkmcnt(8)
 v_min_u32 v29, v20, v22
M v[48:51], a[172:175], a[132:135], v[48:51]
 v_max_u32 v20, v20, v22
M v[52:55], a[172:175], a[140:143], v[52:55]
 ds_read_b64_tr_b16 a[52:53], v3 offset:8192
 ds_read_b64_tr_b16 a[54:55], v3 offset:9216
M v[52:55], a[168:171], a[136:139], v[52:55]
 v_max3_u32 v21, v21, v23, v29
M v[56:59], a[168:171], a[144:147], v[56:59]
 buffer_load_dwordx4 v9, s[16:19], s21 offen offset:1024  nt lds
M v[56:59], a[172:175], a[148:151], v[56:59]
 s_waitcnt lgkmcnt(6)
 v_min_u32 v28, v16, v20
M v[60:63], a[172:175], a[156:159], v[60:63]
 v_max_u32 v16, v16, v20
M v[60:63], a[168:171], a[152:155], v[60:63]
 ds_read_b64_tr_b16 a[56:57], v4 offset:0
 ds_read_b64_tr_b16 a[58:59], v4 offset:1024
M v[64:67], a[160:163], a[96:99], v[64:67]
 ds_read_b128 a[168:171], v5 offset:38912
 ds_read_b128 a[172:175], v6 offset:38912
M v[64:67], a[164:167], a[100:103], v[64:67]
 buffer_load_dwordx4 v10, s[16:19], s21 offen offset:2048  nt lds
M v[68:71], a[164:167], a[108:111], v[68:71]
 v_max3_u32 v17, v17, v21, v28
M v[68:71], a[160:163], a[104:107], v[68:71]
 v_and_b32 v28, 1, v0
M v[72:75], a[160:163], a[112:115], v[72:75]
 ds_read_b64_tr_b16 a[60:61], v4 offset:8192
 ds_read_b64_tr_b16 a[62:63], v4 offset:9216
M v[72:75], a[164:167], a[116:119], v[72:75]
 v_cmp_eq_u32 vcc, 0, v28
M v[76:79], a[164:167], a[124:127], v[76:79]
 buffer_load_dwordx4 v11, s[16:19], s21 offen offset:3072  nt lds
M v[76:79], a[160:163], a[120:123], v[76:79]
 s_add_u32 s21, s21, 524160
 s_and_b32 s64, s20, 1
M v[80:83], a[160:163], a[128:131], v[80:83]
 s_mul_i32 s64, s64, 448
 v_cndmask_b32 v24, v17, v16, vcc
M v[80:83], a[164:167], a[132:135], v[80:83]
 v_and_b32 v24, 0x7ff, v24
M v[84:87], a[164:167], a[140:143], v[84:87]
 v_sub_u32 v24, 2047, v24
M v[84:87], a[160:163], a[136:139], v[84:87]
 v_mul_u32_u24 v28, 896, v24
M v[88:91], a[160:163], a[144:147], v[88:91]
 v_lshrrev_b32 v29, 4, v0
M v[88:91], a[164:167], a[148:151], v[88:91]
 s_waitcnt lgkmcnt(2)
 v_lshl_add_u32 v28, v29, 4, v28
M v[92:95], a[164:167], a[156:159], v[92:95]
 s_waitcnt vmcnt(18) lgkmcnt(0)
 v_bfe_u32 v30, v0, 1, 3
M v[92:95], a[160:163], a[152:155], v[92:95]
 s_barrier
M v[96:99], a[168:171], a[96:99], v[96:99]
 ds_read_b128 a[160:163], v5 offset:49152
 ds_read_b128 a[164:167], v6 offset:49152
M v[96:99], a[172:175], a[100:103], v[96:99]
 v_lshl_or_b32 v28, v30, 26, v28
M v[100:103], a[172:175], a[108:111], v[100:103]
 s_add_u32 m0, s24, 32768
 ds_read_b64_tr_b16 a[64:65], v1 offset:16384
 ds_read_b64_tr_b16 a[66:67], v1 offset:17408
M v[100:103], a[168:171], a[104:107], v[100:103]
 buffer_load_dwordx4 v12, s[48:51], s22 offen offset:0   lds
M v[104:107], a[168:171], a[112:115], v[104:107]
M v[104:107], a[172:175], a[116:119], v[104:107]
M v[108:111], a[172:175], a[124:127], v[108:111]
 buffer_load_dwordx4 a[208:211], v28, s[56:59], s64 offen offset:0
M v[108:111], a[168:171], a[120:123], v[108:111]
M v[112:115], a[168:171], a[128:131], v[112:115]
 buffer_load_dwordx4 a[212:215], v28, s[56:59], s64 offen offset:64
M v[112:115], a[172:175], a[132:135], v[112:115]
 ds_read_b64_tr_b16 a[68:69], v1 offset:24576
 ds_read_b64_tr_b16 a[70:71], v1 offset:25600
M v[116:119], a[172:175], a[140:143], v[116:119]
 buffer_load_dwordx4 v13, s[48:51], s22 offen offset:1024   lds
M v[116:119], a[168:171], a[136:139], v[116:119]
M v[120:123], a[168:171], a[144:147], v[120:123]
M v[120:123], a[172:175], a[148:151], v[120:123]
 s_waitcnt lgkmcnt(4)
M v[124:127], a[172:175], a[156:159], v[124:127]
 buffer_load_dwordx4 a[216:219], v28, s[56:59], s64 offen offset:128
M v[124:127], a[168:171], a[152:155], v[124:127]
M v[128:131], a[160:163], a[96:99], v[128:131]
 ds_read_b128 a[168:171], v5 offset:51200
 ds_read_b128 a[172:175], v6 offset:51200
M v[128:131], a[164:167], a[100:103], v[128:131]
 ds_read_b64_tr_b16 a[72:73], v2 offset:16384
 ds_read_b64_tr_b16 a[74:75], v2 offset:17408
M v[132:135], a[164:167], a[108:111], v[132:135]
 buffer_load_dwordx4 v14, s[48:51], s22 offen offset:2048   lds
M v[132:135], a[160:163], a[104:107], v[132:135]
M v[136:139], a[160:163], a[112:115], v[136:139]
 buffer_load_dwordx4 a[220:223], v28, s[56:59], s64 offen offset:192
M v[136:139], a[164:167], a[116:119], v[136:139]
M v[140:143], a[164:167], a[124:127], v[140:143]
 buffer_load_dwordx4 a[224:227], v28, s[56:59], s64 offen offset:256
M v[140:143], a[160:163], a[120:123], v[140:143]
 ds_read_b64_tr_b16 a[76:77], v2 offset:24576
 ds_read_b64_tr_b16 a[78:79], v2 offset:25600
M v[144:147], a[160:163], a[128:131], v[144:147]
 buffer_load_dwordx4 v15, s[48:51], s22 offen offset:3072   lds
M v[144:147], a[164:167], a[132:135], v[144:147]
 s_add_u32 s22, s22, 2097152
M v[148:151], a[164:167], a[140:143], v[148:151]
M v[148:151], a[160:163], a[136:139], v[148:151]
 buffer_load_dwordx4 a[228:231], v28, s[56:59], s64 offen offset:320
M v[152:155], a[160:163], a[144:147], v[152:155]
M v[152:155], a[164:167], a[148:151], v[152:155]
 s_waitcnt lgkmcnt(4)
M v[156:159], a[164:167], a[156:159], v[156:159]
 s_add_u32 m0, s23, 0
 ds_read_b64_tr_b16 a[80:81], v3 offset:16384
 ds_read_b64_tr_b16 a[82:83], v3 offset:17408
M v[156:159], a[160:163], a[152:155], v[156:159]
 buffer_load_dwordx4 v8, s[16:19], s21 offen offset:0  nt lds
M v[160:163], a[168:171], a[96:99], v[160:163]
 ds_read_b128 a[160:163], v5 offset:53248
 ds_read_b128 a[164:167], v6 offset:53248
M v[160:163], a[172:175], a[100:103], v[160:163]
 buffer_load_dwordx4 a[232:235], v28, s[56:59], s64 offen offset:384
M v[164:167], a[172:175], a[108:111], v[164:167]
 v_lshrrev_b32 v28, 4, v24
M v[164:167], a[168:171], a[104:107], v[164:167]
 v_lshlrev_b32 v28, 5, v28
M v[168:171], a[168:171], a[112:115], v[168:171]
 v_and_b32 v30, 15, v24
M v[168:171], a[172:175], a[116:119], v[168:171]
 ds_read_b64_tr_b16 a[84:85], v3 offset:24576
 ds_read_b64_tr_b16 a[86:87], v3 offset:25600
M v[172:175], a[172:175], a[124:127], v[172:175]
 buffer_load_dwordx4 v9, s[16:19], s21 offen offset:1024  nt lds
M v[172:175], a[168:171], a[120:123], v[172:175]
 v_add_lshl_u32 v28, v28, v30, 2
M v[176:179], a[168:171], a[128:131], v[176:179]
 v_lshrrev_b32 v30, 1, v0
M v[176:179], a[172:175], a[132:135], v[176:179]
 v_min_u32 v30, 1, v30
M v[180:183], a[172:175], a[140:143], v[180:183]
 v_lshl_or_b32 v28, v30, 29, v28
M v[180:183], a[168:171], a[136:139], v[180:183]
 s_mov_b32 s64, 104857600
M v[184:187], a[168:171], a[144:147], v[184:187]
 ds_read_b64_tr_b16 a[88:89], v4 offset:16384
 ds_read_b64_tr_b16 a[90:91], v4 offset:17408
M v[184:187], a[172:175], a[148:151], v[184:187]
 s_waitcnt lgkmcnt(4)
M v[188:191], a[172:175], a[156:159], v[188:191]
 buffer_load_dwordx4 v10, s[16:19], s21 offen offset:2048  nt lds
M v[188:191], a[168:171], a[152:155], v[188:191]
 buffer_load_dword v23, v28, s[8:11], s64 offen sc1
M v[192:195], a[160:163], a[96:99], v[192:195]
 ds_read_b128 a[168:171], v5 offset:55296
 ds_read_b128 a[172:175], v6 offset:55296
M v[192:195], a[164:167], a[100:103], v[192:195]
 v_bfe_u32 v28, v0, 2, 2
M v[196:199], a[164:167], a[108:111], v[196:199]
 v_lshl_add_u32 v28, v29, 3, v28
M v[196:199], a[160:163], a[104:107], v[196:199]
 ds_read_b64_tr_b16 a[92:93], v4 offset:24576
 ds_read_b64_tr_b16 a[94:95], v4 offset:25600
M v[200:203], a[160:163], a[112:115], v[200:203]
 buffer_load_dwordx4 v11, s[16:19], s21 offen offset:3072  nt lds
M v[200:203], a[164:167], a[116:119], v[200:203]
 s_add_u32 s21, s21, 128
 v_lshlrev_b32 v28, 5, v28
M v[204:207], a[164:167], a[124:127], v[204:207]
 v_and_b32 v30, 3, v0
M v[204:207], a[160:163], a[120:123], v[204:207]
 v_lshl_add_u32 v28, v30, 3, v28
M v[208:211], a[160:163], a[128:131], v[208:211]
 v_add_u32 v22, s87, v28
M v[208:211], a[164:167], a[132:135], v[208:211]
M v[212:215], a[164:167], a[140:143], v[212:215]
M v[212:215], a[160:163], a[136:139], v[212:215]
M v[216:219], a[160:163], a[144:147], v[216:219]
M v[216:219], a[164:167], a[148:151], v[216:219]
 s_waitcnt lgkmcnt(2)
M v[220:223], a[164:167], a[156:159], v[220:223]
 s_waitcnt vmcnt(26) lgkmcnt(0)
M v[220:223], a[160:163], a[152:155], v[220:223]
 s_barrier
M v[224:227], a[168:171], a[96:99], v[224:227]
 ds_read_b128 a[160:163], v5 offset:0
 ds_read_b128 a[164:167], v6 offset:0
M v[224:227], a[172:175], a[100:103], v[224:227]
M v[228:231], a[172:175], a[108:111], v[228:231]
M v[228:231], a[168:171], a[104:107], v[228:231]
M v[232:235], a[168:171], a[112:115], v[232:235]
M v[232:235], a[172:175], a[116:119], v[232:235]
M v[236:239], a[172:175], a[124:127], v[236:239]
M v[236:239], a[168:171], a[120:123], v[236:239]
M v[240:243], a[168:171], a[128:131], v[240:243]
M v[240:243], a[172:175], a[132:135], v[240:243]
M v[244:247], a[172:175], a[140:143], v[244:247]
M v[244:247], a[168:171], a[136:139], v[244:247]
M v[248:251], a[168:171], a[144:147], v[248:251]
M v[248:251], a[172:175], a[148:151], v[248:251]
 s_waitcnt lgkmcnt(0)
M v[252:255], a[172:175], a[156:159], v[252:255]
M v[252:255], a[168:171], a[152:155], v[252:255]
M a[0:3], a[160:163], a[32:35], a[0:3]
 ds_read_b128 a[168:171], v5 offset:2048
 ds_read_b128 a[172:175], v6 offset:2048
M a[0:3], a[164:167], a[36:39], a[0:3]
 ds_read_b64_tr_b16 a[96:97], v1 offset:32768
 ds_read_b64_tr_b16 a[98:99], v1 offset:33792
M a[4:7], a[164:167], a[44:47], a[4:7]
 s_add_u32 m0, s24, 49152
M a[4:7], a[160:163], a[40:43], a[4:7]
 buffer_load_dwordx4 v12, s[48:51], s22 offen offset:0   lds
M a[8:11], a[160:163], a[48:51], a[8:11]
M a[8:11], a[164:167], a[52:55], a[8:11]
M a[12:15], a[164:167], a[60:63], a[12:15]
 ds_read_b64_tr_b16 a[100:101], v1 offset:40960
 ds_read_b64_tr_b16 a[102:103], v1 offset:41984
M a[12:15], a[160:163], a[56:59], a[12:15]
M a[16:19], a[160:163], a[64:67], a[16:19]
 buffer_load_dwordx4 v13, s[48:51], s22 offen offset:1024   lds
M a[16:19], a[164:167], a[68:71], a[16:19]
M a[20:23], a[164:167], a[76:79], a[20:23]
M a[20:23], a[160:163], a[72:75], a[20:23]
 ds_read_b64_tr_b16 a[104:105], v2 offset:32768
 ds_read_b64_tr_b16 a[106:107], v2 offset:33792
M a[24:27], a[160:163], a[80:83], a[24:27]
M a[24:27], a[164:167], a[84:87], a[24:27]
 s_waitcnt lgkmcnt(6)
M a[28:31], a[164:167], a[92:95], a[28:31]
 buffer_load_dwordx4 v14, s[48:51], s22 offen offset:2048   lds
M a[28:31], a[160:163], a[88:91], a[28:31]
M v[32:35], a[168:171], a[32:35], v[32:35]
 ds_read_b128 a[160:163], v5 offset:4096
 ds_read_b128 a[164:167], v6 offset:4096
M v[32:35], a[172:175], a[36:39], v[32:35]
 ds_read_b64_tr_b16 a[108:109], v2 offset:40960
 ds_read_b64_tr_b16 a[110:111], v2 offset:41984
M v[36:39], a[172:175], a[44:47], v[36:39]
 buffer_load_dwordx4 v15, s[48:51], s22 offen offset:3072   lds
M v[36:39], a[168:171], a[40:43], v[36:39]
 s_sub_u32 s22, s22, 2097024
M v[40:43], a[168:171], a[48:51], v[40:43]
M v[40:43], a[172:175], a[52:55], v[40:43]
 ds_read_b64_tr_b16 a[112:113], v3 offset:32768
 ds_read_b64_tr_b16 a[114:115], v3 offset:33792
M v[44:47], a[172:175], a[60:63], v[44:47]
 s_add_u32 m0, s23, 16384
M v[44:47], a[168:171], a[56:59], v[44:47]
 buffer_load_dwordx4 v8, s[16:19], s21 offen offset:0  nt lds
M v[48:51], a[168:171], a[64:67], v[48:51]
M v[48:51], a[172:175], a[68:71], v[48:51]
M v[52:55], a[172:175], a[76:79], v[52:55]
 ds_read_b64_tr_b16 a[116:117], v3 offset:40960
 ds_read_b64_tr_b16 a[118:119], v3 offset:41984
M v[52:55], a[168:171], a[72:75], v[52:55]
M v[56:59], a[168:171], a[80:83], v[56:59]
 buffer_load_dwordx4 v9, s[16:19], s21 offen offset:1024  nt lds
M v[56:59], a[172:175], a[84:87], v[56:59]
 s_waitcnt lgkmcnt(6)
M v[60:63], a[172:175], a[92:95], v[60:63]
M v[60:63], a[168:171], a[88:91], v[60:63]
 ds_read_b64_tr_b16 a[120:121], v4 offset:32768
 ds_read_b64_tr_b16 a[122:123], v4 offset:33792
M v[64:67], a[160:163], a[32:35], v[64:67]
 ds_read_b128 a[168:171], v5 offset:6144
 ds_read_b128 a[172:175], v6 offset:6144
M v[64:67], a[164:167], a[36:39], v[64:67]
 buffer_load_dwordx4 v10, s[16:19], s21 offen offset:2048  nt lds
M v[68:71], a[164:167], a[44:47], v[68:71]
M v[68:71], a[160:163], a[40:43], v[68:71]
M v[72:75], a[160:163], a[48:51], v[72:75]
 ds_read_b64_tr_b16 a[124:125], v4 offset:40960
 ds_read_b64_tr_b16 a[126:127], v4 offset:41984
M v[72:75], a[164:167], a[52:55], v[72:75]
M v[76:79], a[164:167], a[60:63], v[76:79]
 buffer_load_dwordx4 v11, s[16:19], s21 offen offset:3072  nt lds
M v[76:79], a[160:163], a[56:59], v[76:79]
 s_add_u32 s21, s21, 524160
M v[80:83], a[160:163], a[64:67], v[80:83]
M v[80:83], a[164:167], a[68:71], v[80:83]
M v[84:87], a[164:167], a[76:79], v[84:87]
M v[84:87], a[160:163], a[72:75], v[84:87]
M v[88:91], a[160:163], a[80:83], v[88:91]
M v[88:91], a[164:167], a[84:87], v[88:91]
 s_waitcnt lgkmcnt(2)
M v[92:95], a[164:167], a[92:95], v[92:95]
 s_waitcnt vmcnt(24) lgkmcnt(0)
M v[92:95], a[160:163], a[88:91], v[92:95]
 s_barrier
M v[96:99], a[168:171], a[32:35], v[96:99]
 ds_read_b128 a[160:163], v5 offset:16384
 ds_read_b128 a[164:167], v6 offset:16384
M v[96:99], a[172:175], a[36:39], v[96:99]
M v[100:103], a[172:175], a[44:47], v[100:103]
 s_add_u32 m0, s24, 0
 ds_read_b64_tr_b16 a[128:129], v1 offset:49152
 ds_read_b64_tr_b16 a[130:131], v1 offset:50176
M v[100:103], a[168:171], a[40:43], v[100:103]
 buffer_load_dwordx4 v12, s[48:51], s22 offen offset:0   lds
M v[104:107], a[168:171], a[48:51], v[104:107]
 ds_read_b64_tr_b16 a[176:177], v22 offset:0
M v[104:107], a[172:175], a[52:55], v[104:107]
 ds_read_b64_tr_b16 a[178:179], v22 offset:128
 ds_read_b64_tr_b16 a[180:181], v22 offset:1024
M v[108:111], a[172:175], a[60:63], v[108:111]
 ds_read_b64_tr_b16 a[182:183], v22 offset:1152
M v[108:111], a[168:171], a[56:59], v[108:111]
 ds_read_b64_tr_b16 a[184:185], v22 offset:2048
 ds_read_b64_tr_b16 a[186:187], v22 offset:2176
M v[112:115], a[168:171], a[64:67], v[112:115]
 ds_read_b64_tr_b16 a[188:189], v22 offset:3072
M v[112:115], a[172:175], a[68:71], v[112:115]
 ds_read_b64_tr_b16 a[132:133], v1 offset:57344
 ds_read_b64_tr_b16 a[134:135], v1 offset:58368
M v[116:119], a[172:175], a[76:79], v[116:119]
 buffer_load_dwordx4 v13, s[48:51], s22 offen offset:1024   lds
M v[116:119], a[168:171], a[72:75], v[116:119]
 ds_read_b64_tr_b16 a[190:191], v22 offset:3200
M v[120:123], a[168:171], a[80:83], v[120:123]
M v[120:123], a[172:175], a[84:87], v[120:123]
 s_waitcnt lgkmcnt(12)
M v[124:127], a[172:175], a[92:95], v[124:127]
M v[124:127], a[168:171], a[88:91], v[124:127]
M v[128:131], a[160:163], a[32:35], v[128:131]
 ds_read_b128 a[168:171], v5 offset:18432
 ds_read_b128 a[172:175], v6 offset:18432
M v[128:131], a[164:167], a[36:39], v[128:131]
 ds_read_b64_tr_b16 a[136:137], v2 offset:49152
 ds_read_b64_tr_b16 a[138:139], v2 offset:50176
M v[132:135], a[164:167], a[44:47], v[132:135]
 buffer_load_dwordx4 v14, s[48:51], s22 offen offset:2048   lds
M v[132:135], a[160:163], a[40:43], v[132:135]
M v[136:139], a[160:163], a[48:51], v[136:139]
M v[136:139], a[164:167], a[52:55], v[136:139]
M v[140:143], a[164:167], a[60:63], v[140:143]
M v[140:143], a[160:163], a[56:59], v[140:143]
 ds_read_b64_tr_b16 a[140:141], v2 offset:57344
 ds_read_b64_tr_b16 a[142:143], v2 offset:58368
M v[144:147], a[160:163], a[64:67], v[144:147]
 buffer_load_dwordx4 v15, s[48:51], s22 offen offset:3072   lds
M v[144:147], a[164:167], a[68:71], v[144:147]
 s_add_u32 s22, s22, 2097152
M v[148:151], a[164:167], a[76:79], v[148:151]
M v[148:151], a[160:163], a[72:75], v[148:151]
M v[152:155], a[160:163], a[80:83], v[152:155]
M v[152:155], a[164:167], a[84:87], v[152:155]
 s_waitcnt lgkmcnt(4)
M v[156:159], a[164:167], a[92:95], v[156:159]
 s_add_u32 m0, s23, 32768
 ds_read_b64_tr_b16 a[144:145], v3 offset:49152
 ds_read_b64_tr_b16 a[146:147], v3 offset:50176
M v[156:159], a[160:163], a[88:91], v[156:159]
 buffer_load_dwordx4 v8, s[16:19], s21 offen offset:0  nt lds
 s_waitcnt vmcnt(27)
M v[16:19], a[176:179], a[208:211], 0
 s_waitcnt vmcnt(26)
M v[16:19], a[180:183], a[212:215], v[16:19]
 s_waitcnt vmcnt(24)
M v[16:19], a[184:187], a[216:219], v[16:19]
 s_waitcnt vmcnt(22)
M v[16:19], a[188:191], a[220:223], v[16:19]
M v[160:163], a[168:171], a[32:35], v[160:163]
 ds_read_b128 a[160:163], v5 offset:20480
 ds_read_b128 a[164:167], v6 offset:20480
M v[160:163], a[172:175], a[36:39], v[160:163]
 ds_read_b64_tr_b16 a[176:177], v22 offset:4096
M v[164:167], a[172:175], a[44:47], v[164:167]
 ds_read_b64_tr_b16 a[178:179], v22 offset:4224
 ds_read_b64_tr_b16 a[180:181], v22 offset:5120
M v[164:167], a[168:171], a[40:43], v[164:167]
 ds_read_b64_tr_b16 a[182:183], v22 offset:5248
M v[168:171], a[168:171], a[48:51], v[168:171]
 ds_read_b64_tr_b16 a[184:185], v22 offset:6144
M v[168:171], a[172:175], a[52:55], v[168:171]
 ds_read_b64_tr_b16 a[148:149], v3 offset:57344
 ds_read_b64_tr_b16 a[150:151], v3 offset:58368
M v[172:175], a[172:175], a[60:63], v[172:175]
 buffer_load_dwordx4 v9, s[16:19], s21 offen offset:1024  nt lds
M v[172:175], a[168:171], a[56:59], v[172:175]
 ds_read_b64_tr_b16 a[186:187], v22 offset:6272
M v[176:179], a[168:171], a[64:67], v[176:179]
M v[176:179], a[172:175], a[68:71], v[176:179]
M v[180:183], a[172:175], a[76:79], v[180:183]
M v[180:183], a[168:171], a[72:75], v[180:183]
M v[184:187], a[168:171], a[80:83], v[184:187]
 ds_read_b64_tr_b16 a[152:153], v4 offset:49152
 ds_read_b64_tr_b16 a[154:155], v4 offset:50176
M v[184:187], a[172:175], a[84:87], v[184:187]
 s_waitcnt lgkmcnt(10)
M v[188:191], a[172:175], a[92:95], v[188:191]
 buffer_load_dwordx4 v10, s[16:19], s21 offen offset:2048  nt lds
M v[188:191], a[168:171], a[88:91], v[188:191]
M v[192:195], a[160:163], a[32:35], v[192:195]
 ds_read_b128 a[168:171], v5 offset:22528
 ds_read_b128 a[172:175], v6 offset:22528
M v[192:195], a[164:167], a[36:39], v[192:195]
M v[196:199], a[164:167], a[44:47], v[196:199]
M v[196:199], a[160:163], a[40:43], v[196:199]
 ds_read_b64_tr_b16 a[156:157], v4 offset:57344
 ds_read_b64_tr_b16 a[158:159], v4 offset:58368
M v[200:203], a[160:163], a[48:51], v[200:203]
 buffer_load_dwordx4 v11, s[16:19], s21 offen offset:3072  nt lds
M v[200:203], a[164:167], a[52:55], v[200:203]
 s_add_u32 s21, s21, 128
M v[204:207], a[164:167], a[60:63], v[204:207]
M v[204:207], a[160:163], a[56:59], v[204:207]
M v[208:211], a[160:163], a[64:67], v[208:211]
M v[208:211], a[164:167], a[68:71], v[208:211]
M v[212:215], a[164:167], a[76:79], v[212:215]
M v[212:215], a[160:163], a[72:75], v[212:215]
M v[216:219], a[160:163], a[80:83], v[216:219]
M v[216:219], a[164:167], a[84:87], v[216:219]
 s_waitcnt lgkmcnt(2)
M v[220:223], a[164:167], a[92:95], v[220:223]
 s_waitcnt vmcnt(16) lgkmcnt(0)
M v[220:223], a[160:163], a[88:91], v[220:223]
 s_barrier
M v[16:19], a[176:179], a[224:227], v[16:19]
M v[16:19], a[180:183], a[228:231], v[16:19]
M v[16:19], a[184:187], a[232:235], v[16:19]
M v[224:227], a[168:171], a[32:35], v[224:227]
 ds_read_b128 a[160:163], v5 offset:32768
 ds_read_b128 a[164:167], v6 offset:32768
M v[224:227], a[172:175], a[36:39], v[224:227]
M v[228:231], a[172:175], a[44:47], v[228:231]
M v[228:231], a[168:171], a[40:43], v[228:231]
M v[232:235], a[168:171], a[48:51], v[232:235]
M v[232:235], a[172:175], a[52:55], v[232:235]
M v[236:239], a[172:175], a[60:63], v[236:239]
M v[236:239], a[168:171], a[56:59], v[236:239]
M v[240:243], a[168:171], a[64:67], v[240:243]
M v[240:243], a[172:175], a[68:71], v[240:243]
M v[244:247], a[172:175], a[76:79], v[244:247]
M v[244:247], a[168:171], a[72:75], v[244:247]
M v[248:251], a[168:171], a[80:83], v[248:251]
M v[248:251], a[172:175], a[84:87], v[248:251]
 s_waitcnt lgkmcnt(0)
M v[252:255], a[172:175], a[92:95], v[252:255]
M v[252:255], a[168:171], a[88:91], v[252:255]
M a[0:3], a[160:163], a[96:99], a[0:3]
 ds_read_b128 a[168:171], v5 offset:34816
 ds_read_b128 a[172:175], v6 offset:34816
M a[0:3], a[164:167], a[100:103], a[0:3]
 ds_read_b64_tr_b16 a[32:33], v1 offset:0
 ds_read_b64_tr_b16 a[34:35], v1 offset:1024
M a[4:7], a[164:167], a[108:111], a[4:7]
 s_add_u32 m0, s24, 16384
M a[4:7], a[160:163], a[104:107], a[4:7]
 buffer_load_dwordx4 v12, s[48:51], s22 offen offset:0   lds
M a[8:11], a[160:163], a[112:115], a[8:11]
M a[8:11], a[164:167], a[116:119], a[8:11]
 s_lshl_b32 s64, s20, 10
M a[12:15], a[164:167], a[124:127], a[12:15]
 s_add_u32 s64, s64, 159744
 ds_read_b64_tr_b16 a[36:37], v1 offset:8192
 ds_read_b64_tr_b16 a[38:39], v1 offset:9216
M a[12:15], a[160:163], a[120:123], a[12:15]
 v_add_u32 v21, s64, v7
 ds_write_b128 v21, v[16:19]
M a[16:19], a[160:163], a[128:131], a[16:19]
 buffer_load_dwordx4 v13, s[48:51], s22 offen offset:1024   lds
M a[16:19], a[164:167], a[132:135], a[16:19]
 s_mul_i32 s67, s86, 14336
M a[20:23], a[164:167], a[140:143], a[20:23]
 s_mul_i32 s64, s20, 224
M a[20:23], a[160:163], a[136:139], a[20:23]
 s_add_u32 s67, s67, s64
 ds_read_b64_tr_b16 a[40:41], v2 offset:0
 ds_read_b64_tr_b16 a[42:43], v2 offset:1024
M a[24:27], a[160:163], a[144:147], a[24:27]
 v_lshrrev_b32 v28, 4, v0
 v_mul_u32_u24 v28, 896, v28
M a[24:27], a[164:167], a[148:151], a[24:27]
 s_waitcnt lgkmcnt(7)
 v_and_b32 v29, 15, v0
 v_lshl_add_u32 v28, v29, 4, v28
M a[28:31], a[164:167], a[156:159], a[28:31]
 buffer_load_dwordx4 v14, s[48:51], s22 offen offset:2048   lds
M a[28:31], a[160:163], a[152:155], a[28:31]
 v_mov_b32 v30, 536870912
 v_cmp_gt_u32 vcc, 14, v29
M v[32:35], a[168:171], a[96:99], v[32:35]
 s_nop 0
 ds_read_b128 a[160:163], v5 offset:36864
 ds_read_b128 a[164:167], v6 offset:36864
M v[32:35], a[172:175], a[100:103], v[32:35]
 s_nop 0
 ds_read_b64_tr_b16 a[44:45], v2 offset:8192
 ds_read_b64_tr_b16 a[46:47], v2 offset:9216
M v[36:39], a[172:175], a[108:111], v[36:39]
 buffer_load_dwordx4 v15, s[48:51], s22 offen offset:3072   lds
M v[36:39], a[168:171], a[104:107], v[36:39]
 s_sub_u32 s22, s22, 2097024
 v_cndmask_b32 v28, v30, v28, vcc
 v_add_u32 v29, 2560, v28
M v[40:43], a[168:171], a[112:115], v[40:43]
 v_add_u32 v30, 5120, v28
 v_add_u32 v31, 7680, v28
M v[40:43], a[172:175], a[116:119], v[40:43]
 ds_read_b64_tr_b16 a[48:49], v3 offset:0
 ds_read_b64_tr_b16 a[50:51], v3 offset:1024
M v[44:47], a[172:175], a[124:127], v[44:47]
 s_add_u32 m0, s23, 49152
M v[44:47], a[168:171], a[120:123], v[44:47]
 buffer_load_dwordx4 v8, s[16:19], s21 offen offset:0  nt lds
M v[48:51], a[168:171], a[128:131], v[48:51]
M v[48:51], a[172:175], a[132:135], v[48:51]
M v[52:55], a[172:175], a[140:143], v[52:55]
 ds_read_b64_tr_b16 a[52:53], v3 offset:8192
 ds_read_b64_tr_b16 a[54:55], v3 offset:9216
M v[52:55], a[168:171], a[136:139], v[52:55]
M v[56:59], a[168:171], a[144:147], v[56:59]
 buffer_load_dwordx4 v9, s[16:19], s21 offen offset:1024  nt lds
M v[56:59], a[172:175], a[148:151], v[56:59]
 s_waitcnt lgkmcnt(6)
M v[60:63], a[172:175], a[156:159], v[60:63]
M v[60:63], a[168:171], a[152:155], v[60:63]
 ds_read_b64_tr_b16 a[56:57], v4 offset:0
 ds_read_b64_tr_b16 a[58:59], v4 offset:1024
M v[64:67], a[160:163], a[96:99], v[64:67]
 ds_read_b128 a[168:171], v5 offset:38912
 ds_read_b128 a[172:175], v6 offset:38912
M v[64:67], a[164:167], a[100:103], v[64:67]
 buffer_load_dwordx4 v10, s[16:19], s21 offen offset:2048  nt lds
M v[68:71], a[164:167], a[108:111], v[68:71]
M v[68:71], a[160:163], a[104:107], v[68:71]
M v[72:75], a[160:163], a[112:115], v[72:75]
 ds_read_b64_tr_b16 a[60:61], v4 offset:8192
 ds_read_b64_tr_b16 a[62:63], v4 offset:9216
M v[72:75], a[164:167], a[116:119], v[72:75]
M v[76:79], a[164:167], a[124:127], v[76:79]
 buffer_load_dwordx4 v11, s[16:19], s21 offen offset:3072  nt lds
M v[76:79], a[160:163], a[120:123], v[76:79]
 s_add_u32 s21, s21, 524160
M v[80:83], a[160:163], a[128:131], v[80:83]
M v[80:83], a[164:167], a[132:135], v[80:83]
M v[84:87], a[164:167], a[140:143], v[84:87]
M v[84:87], a[160:163], a[136:139], v[84:87]
M v[88:91], a[160:163], a[144:147], v[88:91]
M v[88:91], a[164:167], a[148:151], v[88:91]
 s_waitcnt lgkmcnt(2)
M v[92:95], a[164:167], a[156:159], v[92:95]
 s_waitcnt vmcnt(16) lgkmcnt(0)
M v[92:95], a[160:163], a[152:155], v[92:95]
 s_barrier
M v[96:99], a[168:171], a[96:99], v[96:99]
 ds_read_b128 a[160:163], v5 offset:49152
 ds_read_b128 a[164:167], v6 offset:49152
M v[96:99], a[172:175], a[100:103], v[96:99]
M v[100:103], a[172:175], a[108:111], v[100:103]
 s_add_u32 m0, s24, 32768
 ds_read_b64_tr_b16 a[64:65], v1 offset:16384
 ds_read_b64_tr_b16 a[66:67], v1 offset:17408
M v[100:103], a[168:171], a[104:107], v[100:103]
 buffer_load_dwordx4 v12, s[48:51], s22 offen offset:0   lds
M v[104:107], a[168:171], a[112:115], v[104:107]
M v[104:107], a[172:175], a[116:119], v[104:107]
M v[108:111], a[172:175], a[124:127], v[108:111]
M v[108:111], a[168:171], a[120:123], v[108:111]
 buffer_load_dwordx4 v13, s[48:51], s22 offen offset:1024   lds
M v[112:115], a[168:171], a[128:131], v[112:115]
M v[112:115], a[172:175], a[132:135], v[112:115]
 ds_read_b64_tr_b16 a[68:69], v1 offset:24576
 ds_read_b64_tr_b16 a[70:71], v1 offset:25600
M v[116:119], a[172:175], a[140:143], v[116:119]
M v[116:119], a[168:171], a[136:139], v[116:119]
M v[120:123], a[168:171], a[144:147], v[120:123]
 buffer_load_dwordx4 v14, s[48:51], s22 offen offset:2048   lds
M v[120:123], a[172:175], a[148:151], v[120:123]
 s_waitcnt lgkmcnt(4)
M v[124:127], a[172:175], a[156:159], v[124:127]
M v[124:127], a[168:171], a[152:155], v[124:127]
M v[128:131], a[160:163], a[96:99], v[128:131]
 ds_read_b128 a[168:171], v5 offset:51200
 ds_read_b128 a[172:175], v6 offset:51200
M v[128:131], a[164:167], a[100:103], v[128:131]
 ds_read_b64_tr_b16 a[72:73], v2 offset:16384
 ds_read_b64_tr_b16 a[74:75], v2 offset:17408
M v[132:135], a[164:167], a[108:111], v[132:135]
 buffer_load_dwordx4 v15, s[48:51], s22 offen offset:3072   lds
M v[132:135], a[160:163], a[104:107], v[132:135]
 s_add_u32 s22, s22, 2097152
M v[136:139], a[160:163], a[112:115], v[136:139]
M v[136:139], a[164:167], a[116:119], v[136:139]
 s_add_u32 m0, s23, 0
M v[140:143], a[164:167], a[124:127], v[140:143]
 buffer_load_dwordx4 v8, s[16:19], s21 offen offset:0  nt lds
M v[140:143], a[160:163], a[120:123], v[140:143]
 ds_read_b64_tr_b16 a[76:77], v2 offset:24576
 ds_read_b64_tr_b16 a[78:79], v2 offset:25600
M v[144:147], a[160:163], a[128:131], v[144:147]
M v[144:147], a[164:167], a[132:135], v[144:147]
M v[148:151], a[164:167], a[140:143], v[148:151]
 buffer_load_dwordx4 v9, s[16:19], s21 offen offset:1024  nt lds
M v[148:151], a[160:163], a[136:139], v[148:151]
M v[152:155], a[160:163], a[144:147], v[152:155]
M v[152:155], a[164:167], a[148:151], v[152:155]
 s_waitcnt lgkmcnt(4)
M v[156:159], a[164:167], a[156:159], v[156:159]
 ds_read_b64_tr_b16 a[80:81], v3 offset:16384
 ds_read_b64_tr_b16 a[82:83], v3 offset:17408
M v[156:159], a[160:163], a[152:155], v[156:159]
 buffer_load_dwordx4 v10, s[16:19], s21 offen offset:2048  nt lds
M v[160:163], a[168:171], a[96:99], v[160:163]
 ds_read_b128 a[160:163], v5 offset:53248
 ds_read_b128 a[164:167], v6 offset:53248
M v[160:163], a[172:175], a[100:103], v[160:163]
M v[164:167], a[172:175], a[108:111], v[164:167]
M v[164:167], a[168:171], a[104:107], v[164:167]
M v[168:171], a[168:171], a[112:115], v[168:171]
 buffer_load_dwordx4 v11, s[16:19], s21 offen offset:3072  nt lds
M v[168:171], a[172:175], a[116:119], v[168:171]
 s_add_u32 s21, s21, 128
 ds_read_b64_tr_b16 a[84:85], v3 offset:24576
 ds_read_b64_tr_b16 a[86:87], v3 offset:25600
M v[172:175], a[172:175], a[124:127], v[172:175]
M v[172:175], a[168:171], a[120:123], v[172:175]
M v[176:179], a[168:171], a[128:131], v[176:179]
 s_add_u32 m0, s87, 0
M v[176:179], a[172:175], a[132:135], v[176:179]
 buffer_load_dwordx4 v28, s[68:71], s67 offen offset:0 nt lds
M v[180:183], a[172:175], a[140:143], v[180:183]
M v[180:183], a[168:171], a[136:139], v[180:183]
M v[184:187], a[168:171], a[144:147], v[184:187]
 ds_read_b64_tr_b16 a[88:89], v4 offset:16384
 ds_read_b64_tr_b16 a[90:91], v4 offset:17408
M v[184:187], a[172:175], a[148:151], v[184:187]
 s_waitcnt lgkmcnt(4)
M v[188:191], a[172:175], a[156:159], v[188:191]
 buffer_load_dwordx4 v29, s[68:71], s67 offen offset:1024 nt lds
M v[188:191], a[168:171], a[152:155], v[188:191]
M v[192:195], a[160:163], a[96:99], v[192:195]
 ds_read_b128 a[168:171], v5 offset:55296
 ds_read_b128 a[172:175], v6 offset:55296
M v[192:195], a[164:167], a[100:103], v[192:195]
M v[196:199], a[164:167], a[108:111], v[196:199]
 buffer_load_dwordx4 v30, s[68:71], s67 offen offset:2048 nt lds
M v[196:199], a[160:163], a[104:107], v[196:199]
 ds_read_b64_tr_b16 a[92:93], v4 offset:24576
 ds_read_b64_tr_b16 a[94:95], v4 offset:25600
M v[200:203], a[160:163], a[112:115], v[200:203]
M v[200:203], a[164:167], a[116:119], v[200:203]
M v[204:207], a[164:167], a[124:127], v[204:207]
M v[204:207], a[160:163], a[120:123], v[204:207]
 buffer_load_dwordx4 v31, s[68:71], s67 offen offset:3072 nt lds
M v[208:211], a[160:163], a[128:131], v[208:211]
 s_add_u32 s67, s67, 0
M v[208:211], a[164:167], a[132:135], v[208:211]
M v[212:215], a[164:167], a[140:143], v[212:215]
M v[212:215], a[160:163], a[136:139], v[212:215]
M v[216:219], a[160:163], a[144:147], v[216:219]
M v[216:219], a[164:167], a[148:151], v[216:219]
 s_waitcnt lgkmcnt(2)
M v[220:223], a[164:167], a[156:159], v[220:223]
 s_waitcnt vmcnt(20) lgkmcnt(0)
M v[220:223], a[160:163], a[152:155], v[220:223]
 s_barrier
M v[224:227], a[168:171], a[96:99], v[224:227]
 ds_read_b128 a[160:163], v5 offset:0
 ds_read_b128 a[164:167], v6 offset:0
M v[224:227], a[172:175], a[100:103], v[224:227]
M v[228:231], a[172:175], a[108:111], v[228:231]
M v[228:231], a[168:171], a[104:107], v[228:231]
M v[232:235], a[168:171], a[112:115], v[232:235]
M v[232:235], a[172:175], a[116:119], v[232:235]
M v[236:239], a[172:175], a[124:127], v[236:239]
M v[236:239], a[168:171], a[120:123], v[236:239]
M v[240:243], a[168:171], a[128:131], v[240:243]
M v[240:243], a[172:175], a[132:135], v[240:243]
M v[244:247], a[172:175], a[140:143], v[244:247]
M v[244:247], a[168:171], a[136:139], v[244:247]
M v[248:251], a[168:171], a[144:147], v[248:251]
M v[248:251], a[172:175], a[148:151], v[248:251]
 s_waitcnt lgkmcnt(0)
M v[252:255], a[172:175], a[156:159], v[252:255]
M v[252:255], a[168:171], a[152:155], v[252:255]
M a[0:3], a[160:163], a[32:35], a[0:3]
 ds_read_b128 a[168:171], v5 offset:2048
 ds_read_b128 a[172:175], v6 offset:2048
M a[0:3], a[164:167], a[36:39], a[0:3]
 ds_read_b64_tr_b16 a[96:97], v1 offset:32768
 ds_read_b64_tr_b16 a[98:99], v1 offset:33792
M a[4:7], a[164:167], a[44:47], a[4:7]
 s_add_u32 m0, s24, 49152
 v_cvt_pk_bf16_f32 v23, v23, v23
 v_accvgpr_read_b32 v27, a241
M a[4:7], a[160:163], a[40:43], a[4:7]
 buffer_load_dwordx4 v12, s[48:51], s22 offen offset:0   lds
M a[8:11], a[160:163], a[48:51], a[8:11]
 v_and_b32 v23, 0xffff0000, v23
M a[8:11], a[164:167], a[52:55], a[8:11]
 v_mul_f32 v22, 0xbfb8aa3b, v23
M a[12:15], a[164:167], a[60:63], a[12:15]
 ds_read_b64_tr_b16 a[100:101], v1 offset:40960
 ds_read_b64_tr_b16 a[102:103], v1 offset:41984
M a[12:15], a[160:163], a[56:59], a[12:15]
 v_exp_f32 v22, v22
M a[16:19], a[160:163], a[64:67], a[16:19]
 buffer_load_dwordx4 v13, s[48:51], s22 offen offset:1024   lds
M a[16:19], a[164:167], a[68:71], a[16:19]
 v_add_f32 v22, 1.0, v22
M a[20:23], a[164:167], a[76:79], a[20:23]
 v_rcp_f32 v23, v22
M a[20:23], a[160:163], a[72:75], a[20:23]
 s_or_b32 s64, s86, s20
 ds_read_b64_tr_b16 a[104:105], v2 offset:32768
 ds_read_b64_tr_b16 a[106:107], v2 offset:33792
M a[24:27], a[160:163], a[80:83], a[24:27]
 s_min_u32 s64, s64, 1
 s_lshl_b32 s64, s64, 29
 v_lshrrev_b32 v22, 1, v0
M a[24:27], a[164:167], a[84:87], a[24:27]
 s_waitcnt lgkmcnt(6)
 v_min_u32 v22, 1, v22
M a[28:31], a[164:167], a[92:95], a[28:31]
 buffer_load_dwordx4 v14, s[48:51], s22 offen offset:2048   lds
M a[28:31], a[160:163], a[88:91], a[28:31]
 v_lshlrev_b32 v22, 29, v22
M v[32:35], a[168:171], a[32:35], v[32:35]
 ds_read_b128 a[160:163], v5 offset:4096
 ds_read_b128 a[164:167], v6 offset:4096
M v[32:35], a[172:175], a[36:39], v[32:35]
 ds_read_b64_tr_b16 a[108:109], v2 offset:40960
 ds_read_b64_tr_b16 a[110:111], v2 offset:41984
M v[36:39], a[172:175], a[44:47], v[36:39]
 buffer_load_dwordx4 v15, s[48:51], s22 offen offset:3072   lds
M v[36:39], a[168:171], a[40:43], v[36:39]
 s_sub_u32 s22, s22, 2097024
 v_lshl_or_b32 v22, v0, 2, v22
M v[40:43], a[168:171], a[48:51], v[40:43]
 v_or_b32 v22, s64, v22
M v[40:43], a[172:175], a[52:55], v[40:43]
 ds_read_b64_tr_b16 a[112:113], v3 offset:32768
 ds_read_b64_tr_b16 a[114:115], v3 offset:33792
M v[44:47], a[172:175], a[60:63], v[44:47]
 s_add_u32 m0, s23, 16384
 v_cvt_pk_bf16_f32 v23, v23, v23
M v[44:47], a[168:171], a[56:59], v[44:47]
 buffer_load_dwordx4 v8, s[16:19], s21 offen offset:0  nt lds
M v[48:51], a[168:171], a[64:67], v[48:51]
 v_and_b32 v23, 0xffff0000, v23
M v[48:51], a[172:175], a[68:71], v[48:51]
 s_mov_b32 s64, 104890368
M v[52:55], a[172:175], a[76:79], v[52:55]
 ds_read_b64_tr_b16 a[116:117], v3 offset:40960
 ds_read_b64_tr_b16 a[118:119], v3 offset:41984
M v[52:55], a[168:171], a[72:75], v[52:55]
 buffer_store_dword v24, v22, s[8:11], s64 offen sc1
M v[56:59], a[168:171], a[80:83], v[56:59]
 buffer_load_dwordx4 v9, s[16:19], s21 offen offset:1024  nt lds
M v[56:59], a[172:175], a[84:87], v[56:59]
 s_waitcnt lgkmcnt(6)
M v[60:63], a[172:175], a[92:95], v[60:63]
 buffer_store_dword v23, v22, s[8:11], s64 offen offset:8 sc1
M v[60:63], a[168:171], a[88:91], v[60:63]
 ds_read_b64_tr_b16 a[120:121], v4 offset:32768
 ds_read_b64_tr_b16 a[122:123], v4 offset:33792
M v[64:67], a[160:163], a[32:35], v[64:67]
 ds_read_b128 a[168:171], v5 offset:6144
 ds_read_b128 a[172:175], v6 offset:6144
M v[64:67], a[164:167], a[36:39], v[64:67]
 buffer_load_dwordx4 v10, s[16:19], s21 offen offset:2048  nt lds
M v[68:71], a[164:167], a[44:47], v[68:71]
 v_add_u32 v25, 159744, v7
M v[68:71], a[160:163], a[40:43], v[68:71]
 ds_read_b128 v[16:19], v25
M v[72:75], a[160:163], a[48:51], v[72:75]
 ds_read_b64_tr_b16 a[124:125], v4 offset:40960
 ds_read_b64_tr_b16 a[126:127], v4 offset:41984
M v[72:75], a[164:167], a[52:55], v[72:75]
 ds_read_b128 v[28:31], v25 offset:1024
 v_sub_f32 v48, v48, v27
M v[76:79], a[164:167], a[60:63], v[76:79]
 buffer_load_dwordx4 v11, s[16:19], s21 offen offset:3072  nt lds
M v[76:79], a[160:163], a[56:59], v[76:79]
 s_add_u32 s21, s21, 524160
 ds_read_b128 v[20:23], v25 offset:2048
 v_sub_f32 v49, v49, v27
M v[80:83], a[160:163], a[64:67], v[80:83]
 v_sub_f32 v50, v50, v27
 v_sub_f32 v51, v51, v27
M v[80:83], a[164:167], a[68:71], v[80:83]
 v_sub_f32 v52, v52, v27
 v_sub_f32 v53, v53, v27
M v[84:87], a[164:167], a[76:79], v[84:87]
 v_sub_f32 v54, v54, v27
 v_sub_f32 v55, v55, v27
M v[84:87], a[160:163], a[72:75], v[84:87]
 v_sub_f32 v56, v56, v27
 v_sub_f32 v57, v57, v27
M v[88:91], a[160:163], a[80:83], v[88:91]
 v_sub_f32 v58, v58, v27
 v_sub_f32 v59, v59, v27
M v[88:91], a[164:167], a[84:87], v[88:91]
 s_waitcnt lgkmcnt(5)
 v_sub_f32 v60, v60, v27
 v_sub_f32 v61, v61, v27
M v[92:95], a[164:167], a[92:95], v[92:95]
 s_waitcnt vmcnt(22) lgkmcnt(0)
 v_sub_f32 v62, v62, v27
 v_sub_f32 v63, v63, v27
M v[92:95], a[160:163], a[88:91], v[92:95]
 s_barrier
M v[96:99], a[168:171], a[32:35], v[96:99]
 ds_read_b128 a[160:163], v5 offset:16384
 ds_read_b128 a[164:167], v6 offset:16384
M v[96:99], a[172:175], a[36:39], v[96:99]
 v_add_f32 v16, v28, v16
M v[100:103], a[172:175], a[44:47], v[100:103]
 s_add_u32 m0, s24, 0
 ds_read_b64_tr_b16 a[128:129], v1 offset:49152
 ds_read_b64_tr_b16 a[130:131], v1 offset:50176
M v[100:103], a[168:171], a[40:43], v[100:103]
 buffer_load_dwordx4 v12, s[48:51], s22 offen offset:0   lds
M v[104:107], a[168:171], a[48:51], v[104:107]
 v_add_f32 v17, v29, v17
 v_sub_f32 v80, v80, v27
M v[104:107], a[172:175], a[52:55], v[104:107]
 v_add_f32 v18, v30, v18
 v_sub_f32 v81, v81, v27
M v[108:111], a[172:175], a[60:63], v[108:111]
 v_add_f32 v19, v31, v19
 v_sub_f32 v82, v82, v27
M v[108:111], a[168:171], a[56:59], v[108:111]
 ds_read_b128 v[28:31], v25 offset:3072
 v_sub_f32 v83, v83, v27
M v[112:115], a[168:171], a[64:67], v[112:115]
 v_cvt_pk_bf16_f32 v25, v16, v17
 v_sub_f32 v84, v84, v27
M v[112:115], a[172:175], a[68:71], v[112:115]
 ds_read_b64_tr_b16 a[132:133], v1 offset:57344
 ds_read_b64_tr_b16 a[134:135], v1 offset:58368
M v[116:119], a[172:175], a[76:79], v[116:119]
 buffer_load_dwordx4 v13, s[48:51], s22 offen offset:1024   lds
M v[116:119], a[168:171], a[72:75], v[116:119]
 v_lshlrev_b32 v16, 16, v25
 v_sub_f32 v85, v85, v27
M v[120:123], a[168:171], a[80:83], v[120:123]
 v_and_b32 v17, 0xffff0000, v25
 v_sub_f32 v86, v86, v27
M v[120:123], a[172:175], a[84:87], v[120:123]
 s_waitcnt lgkmcnt(5)
 v_cvt_pk_bf16_f32 v25, v18, v19
 v_sub_f32 v87, v87, v27
M v[124:127], a[172:175], a[92:95], v[124:127]
 v_lshlrev_b32 v18, 16, v25
 v_sub_f32 v88, v88, v27
M v[124:127], a[168:171], a[88:91], v[124:127]
 v_and_b32 v19, 0xffff0000, v25
 v_sub_f32 v89, v89, v27
M v[128:131], a[160:163], a[32:35], v[128:131]
 ds_read_b128 a[168:171], v5 offset:18432
 ds_read_b128 a[172:175], v6 offset:18432
M v[128:131], a[164:167], a[36:39], v[128:131]
 ds_read_b64_tr_b16 a[136:137], v2 offset:49152
 ds_read_b64_tr_b16 a[138:139], v2 offset:50176
M v[132:135], a[164:167], a[44:47], v[132:135]
 buffer_load_dwordx4 v14, s[48:51], s22 offen offset:2048   lds
M v[132:135], a[160:163], a[40:43], v[132:135]
 s_waitcnt lgkmcnt(6)
 v_add_f32 v20, v28, v20
 v_sub_f32 v90, v90, v27
M v[136:139], a[160:163], a[48:51], v[136:139]
 v_add_f32 v21, v29, v21
 v_sub_f32 v91, v91, v27
M v[136:139], a[164:167], a[52:55], v[136:139]
 v_add_f32 v22, v30, v22
 v_sub_f32 v92, v92, v27
M v[140:143], a[164:167], a[60:63], v[140:143]
 v_add_f32 v23, v31, v23
 v_sub_f32 v93, v93, v27
M v[140:143], a[160:163], a[56:59], v[140:143]
 ds_read_b64_tr_b16 a[140:141], v2 offset:57344
 ds_read_b64_tr_b16 a[142:143], v2 offset:58368
M v[144:147], a[160:163], a[64:67], v[144:147]
 buffer_load_dwordx4 v15, s[48:51], s22 offen offset:3072   lds
M v[144:147], a[164:167], a[68:71], v[144:147]
 s_add_u32 s22, s22, 2097152
 v_mul_f32 v28, 0xbfb8aa3b, v16
 v_sub_f32 v94, v94, v27
M v[148:151], a[164:167], a[76:79], v[148:151]
 v_mul_f32 v29, 0xbfb8aa3b, v17
 v_sub_f32 v95, v95, v27
M v[148:151], a[160:163], a[72:75], v[148:151]
 v_mul_f32 v30, 0xbfb8aa3b, v18
 v_sub_f32 v112, v112, v27
M v[152:155], a[160:163], a[80:83], v[152:155]
 v_mul_f32 v31, 0xbfb8aa3b, v19
 v_sub_f32 v113, v113, v27
M v[152:155], a[164:167], a[84:87], v[152:155]
 s_waitcnt lgkmcnt(4)
 v_exp_f32 v28, v28
M v[156:159], a[164:167], a[92:95], v[156:159]
 s_add_u32 m0, s23, 32768
 ds_read_b64_tr_b16 a[144:145], v3 offset:49152
 ds_read_b64_tr_b16 a[146:147], v3 offset:50176
M v[156:159], a[160:163], a[88:91], v[156:159]
 buffer_load_dwordx4 v8, s[16:19], s21 offen offset:0  nt lds
M v[160:163], a[168:171], a[32:35], v[160:163]
 ds_read_b128 a[160:163], v5 offset:20480
 ds_read_b128 a[164:167], v6 offset:20480
M v[160:163], a[172:175], a[36:39], v[160:163]
 v_exp_f32 v29, v29
M v[164:167], a[172:175], a[44:47], v[164:167]
 v_exp_f32 v30, v30
M v[164:167], a[168:171], a[40:43], v[164:167]
 v_exp_f32 v31, v31
M v[168:171], a[168:171], a[48:51], v[168:171]
 v_cvt_pk_bf16_f32 v25, v20, v21
 v_sub_f32 v114, v114, v27
M v[168:171], a[172:175], a[52:55], v[168:171]
 ds_read_b64_tr_b16 a[148:149], v3 offset:57344
 ds_read_b64_tr_b16 a[150:151], v3 offset:58368
M v[172:175], a[172:175], a[60:63], v[172:175]
 buffer_load_dwordx4 v9, s[16:19], s21 offen offset:1024  nt lds
M v[172:175], a[168:171], a[56:59], v[172:175]
 v_lshlrev_b32 v20, 16, v25
 v_sub_f32 v115, v115, v27
M v[176:179], a[168:171], a[64:67], v[176:179]
 v_and_b32 v21, 0xffff0000, v25
 v_sub_f32 v116, v116, v27
M v[176:179], a[172:175], a[68:71], v[176:179]
 v_cvt_pk_bf16_f32 v25, v22, v23
 v_sub_f32 v117, v117, v27
M v[180:183], a[172:175], a[76:79], v[180:183]
 v_lshlrev_b32 v22, 16, v25
 v_sub_f32 v118, v118, v27
M v[180:183], a[168:171], a[72:75], v[180:183]
 v_and_b32 v23, 0xffff0000, v25
 v_sub_f32 v119, v119, v27
M v[184:187], a[168:171], a[80:83], v[184:187]
 ds_read_b64_tr_b16 a[152:153], v4 offset:49152
 ds_read_b64_tr_b16 a[154:155], v4 offset:50176
M v[184:187], a[172:175], a[84:87], v[184:187]
 s_waitcnt lgkmcnt(4)
 v_add_f32 v28, 1.0, v28
 v_sub_f32 v120, v120, v27
M v[188:191], a[172:175], a[92:95], v[188:191]
 buffer_load_dwordx4 v10, s[16:19], s21 offen offset:2048  nt lds
M v[188:191], a[168:171], a[88:91], v[188:191]
 v_add_f32 v29, 1.0, v29
 v_sub_f32 v121, v121, v27
M v[192:195], a[160:163], a[32:35], v[192:195]
 ds_read_b128 a[168:171], v5 offset:22528
 ds_read_b128 a[172:175], v6 offset:22528
M v[192:195], a[164:167], a[36:39], v[192:195]
 v_add_f32 v30, 1.0, v30
 v_sub_f32 v122, v122, v27
M v[196:199], a[164:167], a[44:47], v[196:199]
 v_add_f32 v31, 1.0, v31
 v_sub_f32 v123, v123, v27
M v[196:199], a[160:163], a[40:43], v[196:199]
 ds_read_b64_tr_b16 a[156:157], v4 offset:57344
 ds_read_b64_tr_b16 a[158:159], v4 offset:58368
M v[200:203], a[160:163], a[48:51], v[200:203]
 buffer_load_dwordx4 v11, s[16:19], s21 offen offset:3072  nt lds
M v[200:203], a[164:167], a[52:55], v[200:203]
 s_add_u32 s21, s21, 128
 v_rcp_f32 v28, v28
M v[204:207], a[164:167], a[60:63], v[204:207]
 v_rcp_f32 v29, v29
M v[204:207], a[160:163], a[56:59], v[204:207]
 v_rcp_f32 v30, v30
M v[208:211], a[160:163], a[64:67], v[208:211]
 v_rcp_f32 v31, v31
M v[208:211], a[164:167], a[68:71], v[208:211]
 v_mul_f32 v16, v28, v16
 v_sub_f32 v124, v124, v27
M v[212:215], a[164:167], a[76:79], v[212:215]
 v_mul_f32 v17, v29, v17
 v_sub_f32 v125, v125, v27
M v[212:215], a[160:163], a[72:75], v[212:215]
 v_mul_f32 v18, v30, v18
 v_sub_f32 v126, v126, v27
M v[216:219], a[160:163], a[80:83], v[216:219]
 v_mul_f32 v19, v31, v19
 v_sub_f32 v127, v127, v27
M v[216:219], a[164:167], a[84:87], v[216:219]
 s_waitcnt lgkmcnt(2)
 v_cvt_pk_bf16_f32 v25, v16, v17
 v_sub_f32 v128, v128, v27
M v[220:223], a[164:167], a[92:95], v[220:223]
 s_waitcnt vmcnt(22) lgkmcnt(0)
 v_lshlrev_b32 v16, 16, v25
 v_sub_f32 v129, v129, v27
M v[220:223], a[160:163], a[88:91], v[220:223]
 s_barrier
M v[224:227], a[168:171], a[32:35], v[224:227]
 ds_read_b128 a[160:163], v5 offset:32768
 ds_read_b128 a[164:167], v6 offset:32768
M v[224:227], a[172:175], a[36:39], v[224:227]
 v_and_b32 v17, 0xffff0000, v25
 v_sub_f32 v130, v130, v27
M v[228:231], a[172:175], a[44:47], v[228:231]
 v_cvt_pk_bf16_f32 v25, v18, v19
 v_sub_f32 v131, v131, v27
M v[228:231], a[168:171], a[40:43], v[228:231]
 v_lshlrev_b32 v18, 16, v25
 v_sub_f32 v132, v132, v27
M v[232:235], a[168:171], a[48:51], v[232:235]
 v_and_b32 v19, 0xffff0000, v25
 v_sub_f32 v133, v133, v27
M v[232:235], a[172:175], a[52:55], v[232:235]
 v_mul_f32 v16, v20, v16
 v_sub_f32 v134, v134, v27
M v[236:239], a[172:175], a[60:63], v[236:239]
 v_mul_f32 v17, v21, v17
 v_sub_f32 v135, v135, v27
M v[236:239], a[168:171], a[56:59], v[236:239]
 v_mul_f32 v18, v22, v18
 v_sub_f32 v136, v136, v27
M v[240:243], a[168:171], a[64:67], v[240:243]
 v_mul_f32 v19, v23, v19
 v_sub_f32 v137, v137, v27
M v[240:243], a[172:175], a[68:71], v[240:243]
 v_cvt_pk_bf16_f32 v16, v16, v17
 v_sub_f32 v138, v138, v27
M v[244:247], a[172:175], a[76:79], v[244:247]
 v_cvt_pk_bf16_f32 v17, v18, v19
 v_sub_f32 v139, v139, v27
M v[244:247], a[168:171], a[72:75], v[244:247]
 v_sub_f32 v140, v140, v27
 v_sub_f32 v141, v141, v27
M v[248:251], a[168:171], a[80:83], v[248:251]
 v_sub_f32 v142, v142, v27
 v_sub_f32 v143, v143, v27
M v[248:251], a[172:175], a[84:87], v[248:251]
 s_waitcnt lgkmcnt(0)
 v_sub_f32 v144, v144, v27
 v_sub_f32 v145, v145, v27
M v[252:255], a[172:175], a[92:95], v[252:255]
 v_sub_f32 v146, v146, v27
 v_sub_f32 v147, v147, v27
M v[252:255], a[168:171], a[88:91], v[252:255]
 v_sub_f32 v148, v148, v27
 v_sub_f32 v149, v149, v27
M a[0:3], a[160:163], a[96:99], a[0:3]
 ds_read_b128 a[168:171], v5 offset:34816
 ds_read_b128 a[172:175], v6 offset:34816
M a[0:3], a[164:167], a[100:103], a[0:3]
 ds_read_b64_tr_b16 a[32:33], v1 offset:0
 ds_read_b64_tr_b16 a[34:35], v1 offset:1024
M a[4:7], a[164:167], a[108:111], a[4:7]
 s_add_u32 m0, s24, 16384
 v_lshrrev_b32 v28, 2, v0
 v_lshlrev_b32 v28, 8, v28
M a[4:7], a[160:163], a[104:107], a[4:7]
 buffer_load_dwordx4 v12, s[48:51], s22 offen offset:0   lds
M a[8:11], a[160:163], a[112:115], a[8:11]
 v_and_b32 v29, 3, v0
 v_lshl_add_u32 v28, v29, 3, v28
M a[8:11], a[164:167], a[116:119], a[8:11]
 v_add_u32 v28, s87, v28
 v_sub_f32 v150, v150, v27
M a[12:15], a[164:167], a[124:127], a[12:15]
 s_waitcnt vmcnt(19)
 ds_read_b64_tr_b16 a[36:37], v1 offset:8192
 ds_read_b64_tr_b16 a[38:39], v1 offset:9216
M a[12:15], a[160:163], a[120:123], a[12:15]
 ds_read_b64_tr_b16 a[176:177], v28 offset:0
 v_sub_f32 v151, v151, v27
M a[16:19], a[160:163], a[128:131], a[16:19]
 buffer_load_dwordx4 v13, s[48:51], s22 offen offset:1024   lds
M a[16:19], a[164:167], a[132:135], a[16:19]
 ds_read_b64_tr_b16 a[178:179], v28 offset:32
 ds_read_b64_tr_b16 a[180:181], v28 offset:64
M a[20:23], a[164:167], a[140:143], a[20:23]
 ds_read_b64_tr_b16 a[182:183], v28 offset:96
 v_sub_f32 v152, v152, v27
M a[20:23], a[160:163], a[136:139], a[20:23]
 ds_read_b64_tr_b16 a[40:41], v2 offset:0
 ds_read_b64_tr_b16 a[42:43], v2 offset:1024
M a[24:27], a[160:163], a[144:147], a[24:27]
 ds_read_b64_tr_b16 a[184:185], v28 offset:128
 v_sub_f32 v153, v153, v27
M a[24:27], a[164:167], a[148:151], a[24:27]
 s_waitcnt lgkmcnt(11)
 ds_read_b64_tr_b16 a[186:187], v28 offset:160
 ds_read_b64_tr_b16 a[188:189], v28 offset:192
M a[28:31], a[164:167], a[156:159], a[28:31]
 buffer_load_dwordx4 v14, s[48:51], s22 offen offset:2048   lds
M a[28:31], a[160:163], a[152:155], a[28:31]
 v_sub_f32 v154, v154, v27
 v_sub_f32 v155, v155, v27
M v[32:35], a[168:171], a[96:99], v[32:35]
 ds_read_b128 a[160:163], v5 offset:36864
 ds_read_b128 a[164:167], v6 offset:36864
M v[32:35], a[172:175], a[100:103], v[32:35]
 ds_read_b64_tr_b16 a[44:45], v2 offset:8192
 ds_read_b64_tr_b16 a[46:47], v2 offset:9216
M v[36:39], a[172:175], a[108:111], v[36:39]
 buffer_load_dwordx4 v15, s[48:51], s22 offen offset:3072   lds
M v[36:39], a[168:171], a[104:107], v[36:39]
 s_sub_u32 s22, s22, 2097024
 v_sub_f32 v156, v156, v27
 v_sub_f32 v157, v157, v27
M v[40:43], a[168:171], a[112:115], v[40:43]
 v_sub_f32 v158, v158, v27
 v_sub_f32 v159, v159, v27
M v[40:43], a[172:175], a[116:119], v[40:43]
 ds_read_b64_tr_b16 a[48:49], v3 offset:0
 ds_read_b64_tr_b16 a[50:51], v3 offset:1024
M v[44:47], a[172:175], a[124:127], v[44:47]
 s_add_u32 m0, s23, 49152
M v[44:47], a[168:171], a[120:123], v[44:47]
 buffer_load_dwordx4 v8, s[16:19], s21 offen offset:0  nt lds
M v[48:51], a[168:171], a[128:131], v[48:51]
M v[48:51], a[172:175], a[132:135], v[48:51]
M v[52:55], a[172:175], a[140:143], v[52:55]
 ds_read_b64_tr_b16 a[52:53], v3 offset:8192
 ds_read_b64_tr_b16 a[54:55], v3 offset:9216
M v[52:55], a[168:171], a[136:139], v[52:55]
M v[56:59], a[168:171], a[144:147], v[56:59]
 buffer_load_dwordx4 v9, s[16:19], s21 offen offset:1024  nt lds
M v[56:59], a[172:175], a[148:151], v[56:59]
 s_waitcnt lgkmcnt(6)
M v[60:63], a[172:175], a[156:159], v[60:63]
M v[60:63], a[168:171], a[152:155], v[60:63]
 ds_read_b64_tr_b16 a[56:57], v4 offset:0
 ds_read_b64_tr_b16 a[58:59], v4 offset:1024
M v[64:67], a[160:163], a[96:99], v[64:67]
 ds_read_b128 a[168:171], v5 offset:38912
 ds_read_b128 a[172:175], v6 offset:38912
M v[64:67], a[164:167], a[100:103], v[64:67]
 buffer_load_dwordx4 v10, s[16:19], s21 offen offset:2048  nt lds
M v[68:71], a[164:167], a[108:111], v[68:71]
M v[68:71], a[160:163], a[104:107], v[68:71]
M v[72:75], a[160:163], a[112:115], v[72:75]
 ds_read_b64_tr_b16 a[60:61], v4 offset:8192
 ds_read_b64_tr_b16 a[62:63], v4 offset:9216
M v[72:75], a[164:167], a[116:119], v[72:75]
M v[76:79], a[164:167], a[124:127], v[76:79]
 buffer_load_dwordx4 v11, s[16:19], s21 offen offset:3072  nt lds
M v[76:79], a[160:163], a[120:123], v[76:79]
 s_add_u32 s21, s21, 524160
M v[80:83], a[160:163], a[128:131], v[80:83]
M v[80:83], a[164:167], a[132:135], v[80:83]
M v[84:87], a[164:167], a[140:143], v[84:87]
M v[84:87], a[160:163], a[136:139], v[84:87]
M v[88:91], a[160:163], a[144:147], v[88:91]
M v[88:91], a[164:167], a[148:151], v[88:91]
 s_waitcnt lgkmcnt(2)
M v[92:95], a[164:167], a[156:159], v[92:95]
 s_waitcnt vmcnt(16) lgkmcnt(0)
M v[92:95], a[160:163], a[152:155], v[92:95]
 s_barrier
 v_mfma_f32_16x16x16_bf16 a[208:211], a[176:177], v[16:17], 0
 v_mfma_f32_16x16x16_bf16 a[212:215], a[178:179], v[16:17], 0
 v_mfma_f32_16x16x16_bf16 a[216:219], a[180:181], v[16:17], 0
 v_mfma_f32_16x16x16_bf16 a[220:223], a[182:183], v[16:17], 0
 v_mfma_f32_16x16x16_bf16 a[224:227], a[184:185], v[16:17], 0
 v_mfma_f32_16x16x16_bf16 a[228:231], a[186:187], v[16:17], 0
 v_mfma_f32_16x16x16_bf16 a[232:235], a[188:189], v[16:17], 0
M v[96:99], a[168:171], a[96:99], v[96:99]
 ds_read_b128 a[160:163], v5 offset:49152
 ds_read_b128 a[164:167], v6 offset:49152
M v[96:99], a[172:175], a[100:103], v[96:99]
M v[100:103], a[172:175], a[108:111], v[100:103]
 s_add_u32 m0, s24, 32768
 ds_read_b64_tr_b16 a[64:65], v1 offset:16384
 ds_read_b64_tr_b16 a[66:67], v1 offset:17408
M v[100:103], a[168:171], a[104:107], v[100:103]
 buffer_load_dwordx4 v12, s[48:51], s22 offen offset:0   lds
M v[104:107], a[168:171], a[112:115], v[104:107]
M v[104:107], a[172:175], a[116:119], v[104:107]
M v[108:111], a[172:175], a[124:127], v[108:111]
M v[108:111], a[168:171], a[120:123], v[108:111]
M v[112:115], a[168:171], a[128:131], v[112:115]
M v[112:115], a[172:175], a[132:135], v[112:115]
 ds_read_b64_tr_b16 a[68:69], v1 offset:24576
 ds_read_b64_tr_b16 a[70:71], v1 offset:25600
M v[116:119], a[172:175], a[140:143], v[116:119]
 buffer_load_dwordx4 v13, s[48:51], s22 offen offset:1024   lds
M v[116:119], a[168:171], a[136:139], v[116:119]
M v[120:123], a[168:171], a[144:147], v[120:123]
M v[120:123], a[172:175], a[148:151], v[120:123]
 s_waitcnt lgkmcnt(4)
M v[124:127], a[172:175], a[156:159], v[124:127]
M v[124:127], a[168:171], a[152:155], v[124:127]
M v[128:131], a[160:163], a[96:99], v[128:131]
 ds_read_b128 a[168:171], v5 offset:51200
 ds_read_b128 a[172:175], v6 offset:51200
M v[128:131], a[164:167], a[100:103], v[128:131]
 ds_read_b64_tr_b16 a[72:73], v2 offset:16384
 ds_read_b64_tr_b16 a[74:75], v2 offset:17408
M v[132:135], a[164:167], a[108:111], v[132:135]
 buffer_load_dwordx4 v14, s[48:51], s22 offen offset:2048   lds
M v[132:135], a[160:163], a[104:107], v[132:135]
M v[136:139], a[160:163], a[112:115], v[136:139]
M v[136:139], a[164:167], a[116:119], v[136:139]
M v[140:143], a[164:167], a[124:127], v[140:143]
M v[140:143], a[160:163], a[120:123], v[140:143]
 ds_read_b64_tr_b16 a[76:77], v2 offset:24576
 ds_read_b64_tr_b16 a[78:79], v2 offset:25600
M v[144:147], a[160:163], a[128:131], v[144:147]
 buffer_load_dwordx4 v15, s[48:51], s22 offen offset:3072   lds
M v[144:147], a[164:167], a[132:135], v[144:147]
 s_add_u32 s22, s22, 2097152
M v[148:151], a[164:167], a[140:143], v[148:151]
M v[148:151], a[160:163], a[136:139], v[148:151]
M v[152:155], a[160:163], a[144:147], v[152:155]
M v[152:155], a[164:167], a[148:151], v[152:155]
 s_waitcnt lgkmcnt(4)
M v[156:159], a[164:167], a[156:159], v[156:159]
 s_add_u32 m0, s23, 0
 ds_read_b64_tr_b16 a[80:81], v3 offset:16384
 ds_read_b64_tr_b16 a[82:83], v3 offset:17408
M v[156:159], a[160:163], a[152:155], v[156:159]
 buffer_load_dwordx4 v8, s[52:55], s28 offen offset:0   lds
M v[160:163], a[168:171], a[96:99], v[160:163]
 ds_read_b128 a[160:163], v5 offset:53248
 ds_read_b128 a[164:167], v6 offset:53248
M v[160:163], a[172:175], a[100:103], v[160:163]
M v[164:167], a[172:175], a[108:111], v[164:167]
M v[164:167], a[168:171], a[104:107], v[164:167]
M v[168:171], a[168:171], a[112:115], v[168:171]
M v[168:171], a[172:175], a[116:119], v[168:171]
 ds_read_b64_tr_b16 a[84:85], v3 offset:24576
 ds_read_b64_tr_b16 a[86:87], v3 offset:25600
M v[172:175], a[172:175], a[124:127], v[172:175]
 buffer_load_dwordx4 v9, s[52:55], s28 offen offset:1024   lds
M v[172:175], a[168:171], a[120:123], v[172:175]
M v[176:179], a[168:171], a[128:131], v[176:179]
M v[176:179], a[172:175], a[132:135], v[176:179]
M v[180:183], a[172:175], a[140:143], v[180:183]
M v[180:183], a[168:171], a[136:139], v[180:183]
M v[184:187], a[168:171], a[144:147], v[184:187]
 ds_read_b64_tr_b16 a[88:89], v4 offset:16384
 ds_read_b64_tr_b16 a[90:91], v4 offset:17408
M v[184:187], a[172:175], a[148:151], v[184:187]
 s_waitcnt lgkmcnt(4)
M v[188:191], a[172:175], a[156:159], v[188:191]
 buffer_load_dwordx4 v10, s[52:55], s28 offen offset:2048   lds
M v[188:191], a[168:171], a[152:155], v[188:191]
M v[192:195], a[160:163], a[96:99], v[192:195]
 ds_read_b128 a[168:171], v5 offset:55296
 ds_read_b128 a[172:175], v6 offset:55296
M v[192:195], a[164:167], a[100:103], v[192:195]
M v[196:199], a[164:167], a[108:111], v[196:199]
M v[196:199], a[160:163], a[104:107], v[196:199]
 ds_read_b64_tr_b16 a[92:93], v4 offset:24576
 ds_read_b64_tr_b16 a[94:95], v4 offset:25600
M v[200:203], a[160:163], a[112:115], v[200:203]
 buffer_load_dwordx4 v11, s[52:55], s28 offen offset:3072   lds
M v[200:203], a[164:167], a[116:119], v[200:203]
 s_add_u32 s28, s28, 128
 v_sub_f32 v160, v160, v27
 v_sub_f32 v161, v161, v27
M v[204:207], a[164:167], a[124:127], v[204:207]
 v_sub_f32 v162, v162, v27
 v_sub_f32 v163, v163, v27
M v[204:207], a[160:163], a[120:123], v[204:207]
 v_sub_f32 v164, v164, v27
 v_sub_f32 v165, v165, v27
M v[208:211], a[160:163], a[128:131], v[208:211]
 v_sub_f32 v166, v166, v27
 v_sub_f32 v167, v167, v27
M v[208:211], a[164:167], a[132:135], v[208:211]
 v_sub_f32 v168, v168, v27
 v_sub_f32 v169, v169, v27
M v[212:215], a[164:167], a[140:143], v[212:215]
 v_sub_f32 v170, v170, v27
 v_sub_f32 v171, v171, v27
M v[212:215], a[160:163], a[136:139], v[212:215]
 v_sub_f32 v172, v172, v27
 v_sub_f32 v173, v173, v27
M v[216:219], a[160:163], a[144:147], v[216:219]
 v_sub_f32 v174, v174, v27
 v_sub_f32 v175, v175, v27
M v[216:219], a[164:167], a[148:151], v[216:219]
 s_waitcnt lgkmcnt(2)
 v_sub_f32 v176, v176, v27
 v_sub_f32 v177, v177, v27
M v[220:223], a[164:167], a[156:159], v[220:223]
 s_waitcnt vmcnt(16) lgkmcnt(0)
 v_sub_f32 v178, v178, v27
 v_sub_f32 v179, v179, v27
M v[220:223], a[160:163], a[152:155], v[220:223]
 s_barrier
M v[224:227], a[168:171], a[96:99], v[224:227]
 ds_read_b128 a[160:163], v5 offset:0
 ds_read_b128 a[164:167], v6 offset:0
M v[224:227], a[172:175], a[100:103], v[224:227]
 v_and_b32 v26, 48, v0
 v_lshlrev_b32 v26, 17, v26
M v[228:231], a[172:175], a[108:111], v[228:231]
 v_or_b32 v26, v26, v0
 v_lshl_add_u32 v26, v26, 7, s95
M v[228:231], a[168:171], a[104:107], v[228:231]
 buffer_load_dword a240, v26, s[76:79], 0 offen offset:0
M v[232:235], a[168:171], a[112:115], v[232:235]
 v_sub_f32 v180, v180, v27
 v_sub_f32 v181, v181, v27
M v[232:235], a[172:175], a[116:119], v[232:235]
 v_sub_f32 v182, v182, v27
 v_sub_f32 v183, v183, v27
M v[236:239], a[172:175], a[124:127], v[236:239]
 v_sub_f32 v184, v184, v27
 v_sub_f32 v185, v185, v27
M v[236:239], a[168:171], a[120:123], v[236:239]
 v_sub_f32 v186, v186, v27
 v_sub_f32 v187, v187, v27
M v[240:243], a[168:171], a[128:131], v[240:243]
 v_sub_f32 v188, v188, v27
 v_sub_f32 v189, v189, v27
M v[240:243], a[172:175], a[132:135], v[240:243]
 v_sub_f32 v190, v190, v27
 v_sub_f32 v191, v191, v27
M v[244:247], a[172:175], a[140:143], v[244:247]
 v_sub_f32 v192, v192, v27
 v_sub_f32 v193, v193, v27
M v[244:247], a[168:171], a[136:139], v[244:247]
 v_sub_f32 v194, v194, v27
 v_sub_f32 v195, v195, v27
M v[248:251], a[168:171], a[144:147], v[248:251]
 v_sub_f32 v196, v196, v27
 v_sub_f32 v197, v197, v27
M v[248:251], a[172:175], a[148:151], v[248:251]
 s_waitcnt lgkmcnt(0)
 v_sub_f32 v198, v198, v27
 v_sub_f32 v199, v199, v27
M v[252:255], a[172:175], a[156:159], v[252:255]
 v_sub_f32 v200, v200, v27
 v_sub_f32 v201, v201, v27
M v[252:255], a[168:171], a[152:155], v[252:255]
 v_sub_f32 v202, v202, v27
 v_sub_f32 v203, v203, v27
M a[0:3], a[160:163], a[32:35], a[0:3]
 ds_read_b128 a[168:171], v5 offset:2048
 ds_read_b128 a[172:175], v6 offset:2048
M a[0:3], a[164:167], a[36:39], a[0:3]
 ds_read_b64_tr_b16 a[96:97], v1 offset:32768
 ds_read_b64_tr_b16 a[98:99], v1 offset:33792
M a[4:7], a[164:167], a[44:47], a[4:7]
 s_add_u32 m0, s24, 49152
 v_lshrrev_b32 v28, 4, v0
 v_add_u32 v28, 0, v28
M a[4:7], a[160:163], a[40:43], a[4:7]
 buffer_load_dwordx4 v12, s[48:51], s22 offen offset:0   lds
M a[8:11], a[160:163], a[48:51], a[8:11]
 v_and_b32 v29, 7, v0
 v_xor_b32 v28, v28, v29
M a[8:11], a[164:167], a[52:55], a[8:11]
 v_lshlrev_b32 v28, 4, v28
 v_lshrrev_b32 v29, 3, v0
M a[12:15], a[164:167], a[60:63], a[12:15]
 ds_read_b64_tr_b16 a[100:101], v1 offset:40960
 ds_read_b64_tr_b16 a[102:103], v1 offset:41984
M a[12:15], a[160:163], a[56:59], a[12:15]
 buffer_load_dwordx4 v13, s[48:51], s22 offen offset:1024   lds
M a[16:19], a[160:163], a[64:67], a[16:19]
 v_mul_u32_u24 v29, 896, v29
 s_mul_i32 s64, s20, 28672
M a[16:19], a[164:167], a[68:71], a[16:19]
 buffer_load_dwordx4 v14, s[48:51], s22 offen offset:2048   lds
M a[20:23], a[164:167], a[76:79], a[20:23]
 s_add_u32 s64, s64, 0
 v_add3_u32 v16, v29, v28, s64
M a[20:23], a[160:163], a[72:75], a[20:23]
 ds_read_b64_tr_b16 a[104:105], v2 offset:32768
 ds_read_b64_tr_b16 a[106:107], v2 offset:33792
M a[24:27], a[160:163], a[80:83], a[24:27]
 v_add_u32 v18, 12288, v16
 v_lshrrev_b32 v28, 4, v0
M a[24:27], a[164:167], a[84:87], a[24:27]
 s_waitcnt lgkmcnt(6)
 v_add_u32 v28, 4, v28
 v_and_b32 v29, 7, v0
M a[28:31], a[164:167], a[92:95], a[28:31]
 buffer_load_dwordx4 v15, s[48:51], s22 offen offset:3072   lds
M a[28:31], a[160:163], a[88:91], a[28:31]
 s_sub_u32 s22, s22, 2097024
 v_xor_b32 v28, v28, v29
 v_lshlrev_b32 v28, 4, v28
M v[32:35], a[168:171], a[32:35], v[32:35]
 s_add_u32 m0, s23, 16384
 ds_read_b128 a[160:163], v5 offset:4096
 ds_read_b128 a[164:167], v6 offset:4096
M v[32:35], a[172:175], a[36:39], v[32:35]
 ds_read_b64_tr_b16 a[108:109], v2 offset:40960
 ds_read_b64_tr_b16 a[110:111], v2 offset:41984
M v[36:39], a[172:175], a[44:47], v[36:39]
 buffer_load_dwordx4 v8, s[52:55], s28 offen offset:0   lds
M v[36:39], a[168:171], a[40:43], v[36:39]
 v_lshrrev_b32 v29, 3, v0
 v_mul_u32_u24 v29, 896, v29
M v[40:43], a[168:171], a[48:51], v[40:43]
 buffer_load_dwordx4 v9, s[52:55], s28 offen offset:1024   lds
M v[40:43], a[172:175], a[52:55], v[40:43]
 ds_read_b64_tr_b16 a[112:113], v3 offset:32768
 ds_read_b64_tr_b16 a[114:115], v3 offset:33792
M v[44:47], a[172:175], a[60:63], v[44:47]
 s_mul_i32 s64, s20, 28672
 s_add_u32 s64, s64, 6144
M v[44:47], a[168:171], a[56:59], v[44:47]
 buffer_load_dwordx4 v10, s[52:55], s28 offen offset:2048   lds
M v[48:51], a[168:171], a[64:67], v[48:51]
 v_add3_u32 v17, v29, v28, s64
 v_add_u32 v19, 12288, v17
M v[48:51], a[172:175], a[68:71], v[48:51]
 v_add_u32 v20, 0x20000, v1
 v_add_u32 v21, 0x20000, v2
M v[52:55], a[172:175], a[76:79], v[52:55]
 ds_read_b64_tr_b16 a[116:117], v3 offset:40960
 ds_read_b64_tr_b16 a[118:119], v3 offset:41984
M v[52:55], a[168:171], a[72:75], v[52:55]
 buffer_load_dwordx4 v11, s[52:55], s28 offen offset:3072   lds
M v[56:59], a[168:171], a[80:83], v[56:59]
 s_add_u32 s28, s28, 1048448
 v_add_u32 v22, 0x20000, v3
 v_add_u32 v23, 0x20000, v4
M v[56:59], a[172:175], a[84:87], v[56:59]
 s_waitcnt lgkmcnt(6)
 v_sub_f32 v204, v204, v27
 v_sub_f32 v205, v205, v27
M v[60:63], a[172:175], a[92:95], v[60:63]
 s_add_u32 m0, s23, 131072
 v_sub_f32 v206, v206, v27
 v_sub_f32 v207, v207, v27
M v[60:63], a[168:171], a[88:91], v[60:63]
 ds_read_b64_tr_b16 a[120:121], v4 offset:32768
 ds_read_b64_tr_b16 a[122:123], v4 offset:33792
M v[64:67], a[160:163], a[32:35], v[64:67]
 ds_read_b128 a[168:171], v5 offset:6144
 ds_read_b128 a[172:175], v6 offset:6144
M v[64:67], a[164:167], a[36:39], v[64:67]
 buffer_load_dwordx4 v8, s[52:55], s28 offen offset:0   lds
M v[68:71], a[164:167], a[44:47], v[68:71]
 buffer_load_dwordx4 v9, s[52:55], s28 offen offset:1024   lds
M v[68:71], a[160:163], a[40:43], v[68:71]
 v_sub_f32 v208, v208, v27
 v_sub_f32 v209, v209, v27
M v[72:75], a[160:163], a[48:51], v[72:75]
 ds_read_b64_tr_b16 a[124:125], v4 offset:40960
 ds_read_b64_tr_b16 a[126:127], v4 offset:41984
M v[72:75], a[164:167], a[52:55], v[72:75]
 buffer_load_dwordx4 v10, s[52:55], s28 offen offset:2048   lds
M v[76:79], a[164:167], a[60:63], v[76:79]
 v_sub_f32 v210, v210, v27
 v_sub_f32 v211, v211, v27
M v[76:79], a[160:163], a[56:59], v[76:79]
 v_sub_f32 v212, v212, v27
 v_sub_f32 v213, v213, v27
M v[80:83], a[160:163], a[64:67], v[80:83]
 buffer_load_dwordx4 v11, s[52:55], s28 offen offset:3072   lds
M v[80:83], a[164:167], a[68:71], v[80:83]
 s_sub_u32 s28, s28, 524288
 v_sub_f32 v214, v214, v27
 v_sub_f32 v215, v215, v27
M v[84:87], a[164:167], a[76:79], v[84:87]
 v_sub_f32 v216, v216, v27
 v_sub_f32 v217, v217, v27
M v[84:87], a[160:163], a[72:75], v[84:87]
 v_sub_f32 v218, v218, v27
 v_sub_f32 v219, v219, v27
M v[88:91], a[160:163], a[80:83], v[88:91]
 v_sub_f32 v220, v220, v27
 v_sub_f32 v221, v221, v27
M v[88:91], a[164:167], a[84:87], v[88:91]
 s_waitcnt lgkmcnt(2)
 v_sub_f32 v222, v222, v27
 v_sub_f32 v223, v223, v27
M v[92:95], a[164:167], a[92:95], v[92:95]
 s_waitcnt vmcnt(21) lgkmcnt(0)
 v_sub_f32 v224, v224, v27
 v_sub_f32 v225, v225, v27
M v[92:95], a[160:163], a[88:91], v[92:95]
 s_barrier
M v[96:99], a[168:171], a[32:35], v[96:99]
 ds_read_b128 a[160:163], v5 offset:16384
 ds_read_b128 a[164:167], v6 offset:16384
M v[96:99], a[172:175], a[36:39], v[96:99]
 v_sub_f32 v226, v226, v27
 v_sub_f32 v227, v227, v27
M v[100:103], a[172:175], a[44:47], v[100:103]
 s_add_u32 m0, s24, 0
 ds_read_b64_tr_b16 a[128:129], v1 offset:49152
 ds_read_b64_tr_b16 a[130:131], v1 offset:50176
M v[100:103], a[168:171], a[40:43], v[100:103]
 buffer_load_dwordx4 v16, s[56:59], s29 offen offset:0   lds
M v[104:107], a[168:171], a[48:51], v[104:107]
 s_mul_i32 s72, s41, 4352
 v_sub_f32 v228, v228, v27
M v[104:107], a[172:175], a[52:55], v[104:107]
 s_add_u32 s46, s72, 104923136
 v_sub_f32 v229, v229, v27
 v_sub_f32 v230, v230, v27
M v[108:111], a[172:175], a[60:63], v[108:111]
 s_lshl_b32 s45, s42, 7
 s_add_u32 s45, s45, s46
 s_sub_u32 s66, 15, s42
M v[108:111], a[168:171], a[56:59], v[108:111]
 buffer_load_dwordx4 v17, s[56:59], s29 offen offset:1024   lds
M v[112:115], a[168:171], a[64:67], v[112:115]
 s_min_u32 s66, s66, s42
 v_sub_f32 v231, v231, v27
M v[112:115], a[172:175], a[68:71], v[112:115]
 s_lshl_b32 s47, s66, 7
 ds_read_b64_tr_b16 a[132:133], v1 offset:57344
 ds_read_b64_tr_b16 a[134:135], v1 offset:58368
M v[116:119], a[172:175], a[76:79], v[116:119]
 s_add_u32 s47, s47, s46
 v_sub_f32 v232, v232, v27
 v_sub_f32 v233, v233, v27
M v[116:119], a[168:171], a[72:75], v[116:119]
 s_add_u32 s47, s47, 2112
 s_lshl2_add_u32 s47, s20, s47
 s_lshl_b32 s65, s41, 3
M v[120:123], a[168:171], a[80:83], v[120:123]
 buffer_load_dwordx4 v18, s[56:59], s29 offen offset:2048   lds
M v[120:123], a[172:175], a[84:87], v[120:123]
 s_waitcnt lgkmcnt(4)
 s_add_u32 s65, s65, s66
 v_sub_f32 v234, v234, v27
M v[124:127], a[172:175], a[92:95], v[124:127]
 s_mul_i32 s34, s65, 73728
 v_sub_f32 v235, v235, v27
 v_sub_f32 v236, v236, v27
M v[124:127], a[168:171], a[88:91], v[124:127]
 s_add_u32 s34, s34, 50331648
 v_sub_f32 v237, v237, v27
 v_sub_f32 v238, v238, v27
M v[128:131], a[160:163], a[32:35], v[128:131]
 s_lshl_b32 s65, s42, 4
 ds_read_b128 a[168:171], v5 offset:18432
 ds_read_b128 a[172:175], v6 offset:18432
M v[128:131], a[164:167], a[36:39], v[128:131]
 s_add_u32 s65, s65, s41
 ds_read_b64_tr_b16 a[136:137], v2 offset:49152
 ds_read_b64_tr_b16 a[138:139], v2 offset:50176
M v[132:135], a[164:167], a[44:47], v[132:135]
 buffer_load_dwordx4 v19, s[56:59], s29 offen offset:3072   lds
M v[132:135], a[160:163], a[40:43], v[132:135]
 s_add_u32 s29, s29, 128
 s_mul_i32 s33, s65, 114688
 v_sub_f32 v239, v239, v27
M v[136:139], a[160:163], a[48:51], v[136:139]
 s_mul_i32 s65, s20, 28672
 s_add_u32 s33, s33, s65
 s_add_u32 s33, s33, 67108864
M v[136:139], a[164:167], a[52:55], v[136:139]
 s_add_u32 m0, s23, 32768
 s_sub_u32 s65, 15, s66
 s_lshl_b32 s65, s65, 16
M v[140:143], a[164:167], a[60:63], v[140:143]
 buffer_load_dwordx4 v8, s[52:55], s28 offen offset:0   lds
M v[140:143], a[160:163], a[56:59], v[140:143]
 ds_read_b64_tr_b16 a[140:141], v2 offset:57344
 ds_read_b64_tr_b16 a[142:143], v2 offset:58368
M v[144:147], a[160:163], a[64:67], v[144:147]
 s_lshl_b32 s64, s41, 20
 v_sub_f32 v240, v240, v27
M v[144:147], a[164:167], a[68:71], v[144:147]
 s_add_u32 s32, s64, s65
 s_lshl_b32 s65, s20, 14
 s_add_u32 s32, s32, s65
M v[148:151], a[164:167], a[76:79], v[148:151]
 buffer_load_dwordx4 v9, s[52:55], s28 offen offset:1024   lds
M v[148:151], a[160:163], a[72:75], v[148:151]
 s_add_u32 s32, s32, 33554432
 v_sub_f32 v241, v241, v27
M v[152:155], a[160:163], a[80:83], v[152:155]
 s_mov_b32 s31, 0x53800000
 s_mov_b32 s40, 1
 s_sub_u32 s64, s42, 10
M v[152:155], a[164:167], a[84:87], v[152:155]
 s_waitcnt lgkmcnt(4)
 s_and_b32 s35, s64, 536870912
 v_sub_f32 v242, v242, v27
M v[156:159], a[164:167], a[92:95], v[156:159]
 ds_read_b64_tr_b16 a[144:145], v3 offset:49152
 ds_read_b64_tr_b16 a[146:147], v3 offset:50176
M v[156:159], a[160:163], a[88:91], v[156:159]
 buffer_load_dwordx4 v10, s[52:55], s28 offen offset:2048   lds
M v[160:163], a[168:171], a[32:35], v[160:163]
 ds_read_b128 a[160:163], v5 offset:20480
 ds_read_b128 a[164:167], v6 offset:20480
M v[160:163], a[172:175], a[36:39], v[160:163]
 v_sub_f32 v243, v243, v27
 v_sub_f32 v244, v244, v27
M v[164:167], a[172:175], a[44:47], v[164:167]
 v_sub_f32 v245, v245, v27
 v_sub_f32 v246, v246, v27
M v[164:167], a[168:171], a[40:43], v[164:167]
 v_sub_f32 v247, v247, v27
 v_sub_f32 v248, v248, v27
M v[168:171], a[168:171], a[48:51], v[168:171]
 buffer_load_dwordx4 v11, s[52:55], s28 offen offset:3072   lds
M v[168:171], a[172:175], a[52:55], v[168:171]
 s_add_u32 s28, s28, 524416
 ds_read_b64_tr_b16 a[148:149], v3 offset:57344
 ds_read_b64_tr_b16 a[150:151], v3 offset:58368
M v[172:175], a[172:175], a[60:63], v[172:175]
 v_sub_f32 v249, v249, v27
 v_sub_f32 v250, v250, v27
M v[172:175], a[168:171], a[56:59], v[172:175]
 v_sub_f32 v251, v251, v27
 v_sub_f32 v252, v252, v27
M v[176:179], a[168:171], a[64:67], v[176:179]
 s_add_u32 m0, s23, 147456
 v_sub_f32 v253, v253, v27
 v_sub_f32 v254, v254, v27
M v[176:179], a[172:175], a[68:71], v[176:179]
 buffer_load_dwordx4 v8, s[52:55], s28 offen offset:0   lds
M v[180:183], a[172:175], a[76:79], v[180:183]
 v_sub_f32 v255, v255, v27
M v[180:183], a[168:171], a[72:75], v[180:183]
M v[184:187], a[168:171], a[80:83], v[184:187]
 ds_read_b64_tr_b16 a[152:153], v4 offset:49152
 ds_read_b64_tr_b16 a[154:155], v4 offset:50176
M v[184:187], a[172:175], a[84:87], v[184:187]
 s_waitcnt lgkmcnt(4)
M v[188:191], a[172:175], a[92:95], v[188:191]
 buffer_load_dwordx4 v9, s[52:55], s28 offen offset:1024   lds
M v[188:191], a[168:171], a[88:91], v[188:191]
M v[192:195], a[160:163], a[32:35], v[192:195]
 ds_read_b128 a[168:171], v5 offset:22528
 ds_read_b128 a[172:175], v6 offset:22528
M v[192:195], a[164:167], a[36:39], v[192:195]
M v[196:199], a[164:167], a[44:47], v[196:199]
 buffer_load_dwordx4 v10, s[52:55], s28 offen offset:2048   lds
M v[196:199], a[160:163], a[40:43], v[196:199]
 ds_read_b64_tr_b16 a[156:157], v4 offset:57344
 ds_read_b64_tr_b16 a[158:159], v4 offset:58368
M v[200:203], a[160:163], a[48:51], v[200:203]
M v[200:203], a[164:167], a[52:55], v[200:203]
M v[204:207], a[164:167], a[60:63], v[204:207]
M v[204:207], a[160:163], a[56:59], v[204:207]
 buffer_load_dwordx4 v11, s[52:55], s28 offen offset:3072   lds
M v[208:211], a[160:163], a[64:67], v[208:211]
 s_sub_u32 s28, s28, 524288
M v[208:211], a[164:167], a[68:71], v[208:211]
M v[212:215], a[164:167], a[76:79], v[212:215]
M v[212:215], a[160:163], a[72:75], v[212:215]
M v[216:219], a[160:163], a[80:83], v[216:219]
M v[216:219], a[164:167], a[84:87], v[216:219]
 s_waitcnt lgkmcnt(2)
M v[220:223], a[164:167], a[92:95], v[220:223]
 s_waitcnt vmcnt(25) lgkmcnt(0)
M v[220:223], a[160:163], a[88:91], v[220:223]
 s_barrier
M v[224:227], a[168:171], a[32:35], v[224:227]
 ds_read_b128 a[160:163], v5 offset:32768
 ds_read_b128 a[164:167], v6 offset:32768
M v[224:227], a[172:175], a[36:39], v[224:227]
M v[228:231], a[172:175], a[44:47], v[228:231]
M v[228:231], a[168:171], a[40:43], v[228:231]
M v[232:235], a[168:171], a[48:51], v[232:235]
M v[232:235], a[172:175], a[52:55], v[232:235]
M v[236:239], a[172:175], a[60:63], v[236:239]
M v[236:239], a[168:171], a[56:59], v[236:239]
M v[240:243], a[168:171], a[64:67], v[240:243]
M v[240:243], a[172:175], a[68:71], v[240:243]
M v[244:247], a[172:175], a[76:79], v[244:247]
M v[244:247], a[168:171], a[72:75], v[244:247]
M v[248:251], a[168:171], a[80:83], v[248:251]
M v[248:251], a[172:175], a[84:87], v[248:251]
 s_waitcnt lgkmcnt(0)
M v[252:255], a[172:175], a[92:95], v[252:255]
M v[252:255], a[168:171], a[88:91], v[252:255]
M a[0:3], a[160:163], a[96:99], a[0:3]
 ds_read_b128 a[168:171], v5 offset:34816
 ds_read_b128 a[172:175], v6 offset:34816
M a[0:3], a[164:167], a[100:103], a[0:3]
 ds_read_b64_tr_b16 a[32:33], v1 offset:0
 ds_read_b64_tr_b16 a[34:35], v1 offset:1024
M a[4:7], a[164:167], a[108:111], a[4:7]
 s_add_u32 m0, s24, 16384
M a[4:7], a[160:163], a[104:107], a[4:7]
 buffer_load_dwordx4 v16, s[56:59], s29 offen offset:0   lds
M a[8:11], a[160:163], a[112:115], a[8:11]
M a[8:11], a[164:167], a[116:119], a[8:11]
M a[12:15], a[164:167], a[124:127], a[12:15]
 ds_read_b64_tr_b16 a[36:37], v1 offset:8192
 ds_read_b64_tr_b16 a[38:39], v1 offset:9216
M a[12:15], a[160:163], a[120:123], a[12:15]
M a[16:19], a[160:163], a[128:131], a[16:19]
 buffer_load_dwordx4 v17, s[56:59], s29 offen offset:1024   lds
M a[16:19], a[164:167], a[132:135], a[16:19]
M a[20:23], a[164:167], a[140:143], a[20:23]
M a[20:23], a[160:163], a[136:139], a[20:23]
 ds_read_b64_tr_b16 a[40:41], v2 offset:0
 ds_read_b64_tr_b16 a[42:43], v2 offset:1024
M a[24:27], a[160:163], a[144:147], a[24:27]
M a[24:27], a[164:167], a[148:151], a[24:27]
 s_waitcnt lgkmcnt(6)
 buffer_load_dwordx4 v18, s[56:59], s29 offen offset:2048   lds
M a[28:31], a[164:167], a[156:159], a[28:31]
M a[28:31], a[160:163], a[152:155], a[28:31]
M v[32:35], a[168:171], a[96:99], v[32:35]
 ds_read_b128 a[160:163], v5 offset:36864
 ds_read_b128 a[164:167], v6 offset:36864
M v[32:35], a[172:175], a[100:103], v[32:35]
 ds_read_b64_tr_b16 a[44:45], v2 offset:8192
 ds_read_b64_tr_b16 a[46:47], v2 offset:9216
M v[36:39], a[172:175], a[108:111], v[36:39]
 buffer_load_dwordx4 v19, s[56:59], s29 offen offset:3072   lds
M v[36:39], a[168:171], a[104:107], v[36:39]
 s_add_u32 s29, s29, 128
M v[40:43], a[168:171], a[112:115], v[40:43]
M v[40:43], a[172:175], a[116:119], v[40:43]
 ds_read_b64_tr_b16 a[48:49], v3 offset:0
 ds_read_b64_tr_b16 a[50:51], v3 offset:1024
M v[44:47], a[172:175], a[124:127], v[44:47]
 s_add_u32 m0, s23, 49152
 v_accvgpr_read_b32 v24, a0
 v_accvgpr_read_b32 v25, a1
M v[44:47], a[168:171], a[120:123], v[44:47]
 buffer_load_dwordx4 v8, s[52:55], s28 offen offset:0   lds
M v[48:51], a[168:171], a[128:131], v[48:51]
 v_accvgpr_read_b32 v26, a2
 v_accvgpr_read_b32 v27, a3
M v[48:51], a[172:175], a[132:135], v[48:51]
 v_cvt_pk_bf16_f32 v24, v24, v25
 v_cvt_pk_bf16_f32 v25, v26, v27
M v[52:55], a[172:175], a[140:143], v[52:55]
 ds_read_b64_tr_b16 a[52:53], v3 offset:8192
 ds_read_b64_tr_b16 a[54:55], v3 offset:9216
M v[52:55], a[168:171], a[136:139], v[52:55]
 v_cvt_pk_bf16_f32 v26, v32, v33
 v_cvt_pk_bf16_f32 v27, v34, v35
M v[56:59], a[168:171], a[144:147], v[56:59]
 s_add_u32 s3, s93, 0
 buffer_load_dwordx4 v9, s[52:55], s28 offen offset:1024   lds
M v[56:59], a[172:175], a[148:151], v[56:59]
 s_waitcnt lgkmcnt(6)
M v[60:63], a[172:175], a[156:159], v[60:63]
 buffer_store_dwordx4 v[24:27], v7, s[8:11], s3 offen offset:0 sc1
M v[60:63], a[168:171], a[152:155], v[60:63]
 ds_read_b64_tr_b16 a[56:57], v4 offset:0
 ds_read_b64_tr_b16 a[58:59], v4 offset:1024
M v[64:67], a[160:163], a[96:99], v[64:67]
 ds_read_b128 a[168:171], v5 offset:38912
 ds_read_b128 a[172:175], v6 offset:38912
M v[64:67], a[164:167], a[100:103], v[64:67]
 buffer_load_dwordx4 v10, s[52:55], s28 offen offset:2048   lds
M v[68:71], a[164:167], a[108:111], v[68:71]
 v_accvgpr_read_b32 v24, a4
 v_accvgpr_read_b32 v25, a5
M v[68:71], a[160:163], a[104:107], v[68:71]
 v_accvgpr_read_b32 v26, a6
 v_accvgpr_read_b32 v27, a7
M v[72:75], a[160:163], a[112:115], v[72:75]
 ds_read_b64_tr_b16 a[60:61], v4 offset:8192
 ds_read_b64_tr_b16 a[62:63], v4 offset:9216
M v[72:75], a[164:167], a[116:119], v[72:75]
 v_cvt_pk_bf16_f32 v24, v24, v25
 v_cvt_pk_bf16_f32 v25, v26, v27
M v[76:79], a[164:167], a[124:127], v[76:79]
 buffer_load_dwordx4 v11, s[52:55], s28 offen offset:3072   lds
M v[76:79], a[160:163], a[120:123], v[76:79]
 s_add_u32 s28, s28, 1048448
 v_cvt_pk_bf16_f32 v26, v36, v37
 v_cvt_pk_bf16_f32 v27, v38, v39
M v[80:83], a[160:163], a[128:131], v[80:83]
M v[80:83], a[164:167], a[132:135], v[80:83]
M v[84:87], a[164:167], a[140:143], v[84:87]
 buffer_store_dwordx4 v[24:27], v7, s[8:11], s3 offen offset:2048 sc1
M v[84:87], a[160:163], a[136:139], v[84:87]
M v[88:91], a[160:163], a[144:147], v[88:91]
M v[88:91], a[164:167], a[148:151], v[88:91]
 s_waitcnt lgkmcnt(2)
M v[92:95], a[164:167], a[156:159], v[92:95]
 s_waitcnt vmcnt(26) lgkmcnt(0)
 v_accvgpr_read_b32 v24, a8
 v_accvgpr_read_b32 v25, a9
M v[92:95], a[160:163], a[152:155], v[92:95]
 s_barrier
M v[96:99], a[168:171], a[96:99], v[96:99]
 ds_read_b128 a[160:163], v5 offset:49152
 ds_read_b128 a[164:167], v6 offset:49152
M v[96:99], a[172:175], a[100:103], v[96:99]
 v_accvgpr_read_b32 v26, a10
 v_accvgpr_read_b32 v27, a11
M v[100:103], a[172:175], a[108:111], v[100:103]
 s_add_u32 m0, s24, 32768
 ds_read_b64_tr_b16 a[64:65], v1 offset:16384
 ds_read_b64_tr_b16 a[66:67], v1 offset:17408
M v[100:103], a[168:171], a[104:107], v[100:103]
 buffer_load_dwordx4 v16, s[56:59], s29 offen offset:0   lds
M v[104:107], a[168:171], a[112:115], v[104:107]
 v_cvt_pk_bf16_f32 v24, v24, v25
 v_cvt_pk_bf16_f32 v25, v26, v27
M v[104:107], a[172:175], a[116:119], v[104:107]
 v_cvt_pk_bf16_f32 v26, v40, v41
 v_cvt_pk_bf16_f32 v27, v42, v43
M v[108:111], a[172:175], a[124:127], v[108:111]
 s_add_u32 s3, s93, 4096
 buffer_store_dwordx4 v[24:27], v7, s[8:11], s3 offen offset:0 sc1
M v[108:111], a[168:171], a[120:123], v[108:111]
 v_cvt_pk_bf16_f32 v64, v64, v65
 v_cvt_pk_bf16_f32 v65, v66, v67
M v[112:115], a[168:171], a[128:131], v[112:115]
 v_cvt_pk_bf16_f32 v66, v96, v97
 v_cvt_pk_bf16_f32 v67, v98, v99
M v[112:115], a[172:175], a[132:135], v[112:115]
 ds_read_b64_tr_b16 a[68:69], v1 offset:24576
 ds_read_b64_tr_b16 a[70:71], v1 offset:25600
M v[116:119], a[172:175], a[140:143], v[116:119]
 buffer_load_dwordx4 v17, s[56:59], s29 offen offset:1024   lds
M v[116:119], a[168:171], a[136:139], v[116:119]
 v_accvgpr_read_b32 v24, a12
 v_accvgpr_read_b32 v25, a13
M v[120:123], a[168:171], a[144:147], v[120:123]
 v_accvgpr_read_b32 v26, a14
 v_accvgpr_read_b32 v27, a15
M v[120:123], a[172:175], a[148:151], v[120:123]
 s_waitcnt lgkmcnt(4)
 v_cvt_pk_bf16_f32 v24, v24, v25
 v_cvt_pk_bf16_f32 v25, v26, v27
M v[124:127], a[172:175], a[156:159], v[124:127]
 v_cvt_pk_bf16_f32 v26, v44, v45
 v_cvt_pk_bf16_f32 v27, v46, v47
M v[124:127], a[168:171], a[152:155], v[124:127]
 buffer_store_dwordx4 v[24:27], v7, s[8:11], s3 offen offset:2048 sc1
M v[128:131], a[160:163], a[96:99], v[128:131]
 ds_read_b128 a[168:171], v5 offset:51200
 ds_read_b128 a[172:175], v6 offset:51200
M v[128:131], a[164:167], a[100:103], v[128:131]
 ds_read_b64_tr_b16 a[72:73], v2 offset:16384
 ds_read_b64_tr_b16 a[74:75], v2 offset:17408
M v[132:135], a[164:167], a[108:111], v[132:135]
 buffer_load_dwordx4 v18, s[56:59], s29 offen offset:2048   lds
M v[132:135], a[160:163], a[104:107], v[132:135]
 v_cvt_pk_bf16_f32 v68, v68, v69
 v_cvt_pk_bf16_f32 v69, v70, v71
M v[136:139], a[160:163], a[112:115], v[136:139]
 v_cvt_pk_bf16_f32 v70, v100, v101
 v_cvt_pk_bf16_f32 v71, v102, v103
M v[136:139], a[164:167], a[116:119], v[136:139]
 v_cvt_pk_bf16_f32 v72, v72, v73
 v_cvt_pk_bf16_f32 v73, v74, v75
M v[140:143], a[164:167], a[124:127], v[140:143]
 v_accvgpr_read_b32 v24, a16
 v_accvgpr_read_b32 v25, a17
M v[140:143], a[160:163], a[120:123], v[140:143]
 ds_read_b64_tr_b16 a[76:77], v2 offset:24576
 ds_read_b64_tr_b16 a[78:79], v2 offset:25600
M v[144:147], a[160:163], a[128:131], v[144:147]
 buffer_load_dwordx4 v19, s[56:59], s29 offen offset:3072   lds
M v[144:147], a[164:167], a[132:135], v[144:147]
 s_add_u32 s29, s29, 128
 v_accvgpr_read_b32 v26, a18
 v_accvgpr_read_b32 v27, a19
M v[148:151], a[164:167], a[140:143], v[148:151]
 v_cvt_pk_bf16_f32 v24, v24, v25
 v_cvt_pk_bf16_f32 v25, v26, v27
M v[148:151], a[160:163], a[136:139], v[148:151]
 v_cvt_pk_bf16_f32 v26, v48, v49
 v_cvt_pk_bf16_f32 v27, v50, v51
M v[152:155], a[160:163], a[144:147], v[152:155]
 s_add_u32 s3, s93, 8192
 buffer_store_dwordx4 v[24:27], v7, s[8:11], s3 offen offset:0 sc1
M v[152:155], a[164:167], a[148:151], v[152:155]
 s_waitcnt lgkmcnt(4)
 v_cvt_pk_bf16_f32 v74, v104, v105
 v_cvt_pk_bf16_f32 v75, v106, v107
M v[156:159], a[164:167], a[156:159], v[156:159]
 s_add_u32 m0, s23, 0
 ds_read_b64_tr_b16 a[80:81], v3 offset:16384
 ds_read_b64_tr_b16 a[82:83], v3 offset:17408
M v[156:159], a[160:163], a[152:155], v[156:159]
 buffer_load_dwordx4 v8, s[52:55], s28 offen offset:0   lds
M v[160:163], a[168:171], a[96:99], v[160:163]
 ds_read_b128 a[160:163], v5 offset:53248
 ds_read_b128 a[164:167], v6 offset:53248
M v[160:163], a[172:175], a[100:103], v[160:163]
 v_cvt_pk_bf16_f32 v76, v76, v77
 v_cvt_pk_bf16_f32 v77, v78, v79
M v[164:167], a[172:175], a[108:111], v[164:167]
 v_accvgpr_read_b32 v24, a20
 v_accvgpr_read_b32 v25, a21
M v[164:167], a[168:171], a[104:107], v[164:167]
 v_accvgpr_read_b32 v26, a22
 v_accvgpr_read_b32 v27, a23
M v[168:171], a[168:171], a[112:115], v[168:171]
 v_cvt_pk_bf16_f32 v24, v24, v25
 v_cvt_pk_bf16_f32 v25, v26, v27
M v[168:171], a[172:175], a[116:119], v[168:171]
 ds_read_b64_tr_b16 a[84:85], v3 offset:24576
 ds_read_b64_tr_b16 a[86:87], v3 offset:25600
M v[172:175], a[172:175], a[124:127], v[172:175]
 buffer_load_dwordx4 v9, s[52:55], s28 offen offset:1024   lds
M v[172:175], a[168:171], a[120:123], v[172:175]
 v_cvt_pk_bf16_f32 v26, v52, v53
 v_cvt_pk_bf16_f32 v27, v54, v55
M v[176:179], a[168:171], a[128:131], v[176:179]
 v_cvt_pk_bf16_f32 v78, v108, v109
 v_cvt_pk_bf16_f32 v79, v110, v111
M v[176:179], a[172:175], a[132:135], v[176:179]
 buffer_store_dwordx4 v[24:27], v7, s[8:11], s3 offen offset:2048 sc1
M v[180:183], a[172:175], a[140:143], v[180:183]
 v_cvt_pk_bf16_f32 v80, v80, v81
 v_cvt_pk_bf16_f32 v81, v82, v83
M v[180:183], a[168:171], a[136:139], v[180:183]
 v_cvt_pk_bf16_f32 v82, v112, v113
 v_cvt_pk_bf16_f32 v83, v114, v115
M v[184:187], a[168:171], a[144:147], v[184:187]
 ds_read_b64_tr_b16 a[88:89], v4 offset:16384
 ds_read_b64_tr_b16 a[90:91], v4 offset:17408
M v[184:187], a[172:175], a[148:151], v[184:187]
 s_waitcnt lgkmcnt(4)
 buffer_load_dwordx4 v10, s[52:55], s28 offen offset:2048   lds
M v[188:191], a[172:175], a[156:159], v[188:191]
 v_accvgpr_read_b32 v24, a24
 v_accvgpr_read_b32 v25, a25
M v[188:191], a[168:171], a[152:155], v[188:191]
 v_accvgpr_read_b32 v26, a26
 v_accvgpr_read_b32 v27, a27
M v[192:195], a[160:163], a[96:99], v[192:195]
 ds_read_b128 a[168:171], v5 offset:55296
 ds_read_b128 a[172:175], v6 offset:55296
M v[192:195], a[164:167], a[100:103], v[192:195]
 v_cvt_pk_bf16_f32 v24, v24, v25
 v_cvt_pk_bf16_f32 v25, v26, v27
M v[196:199], a[164:167], a[108:111], v[196:199]
 v_cvt_pk_bf16_f32 v26, v56, v57
 v_cvt_pk_bf16_f32 v27, v58, v59
M v[196:199], a[160:163], a[104:107], v[196:199]
 s_add_u32 s3, s93, 12288
 ds_read_b64_tr_b16 a[92:93], v4 offset:24576
 ds_read_b64_tr_b16 a[94:95], v4 offset:25600
M v[200:203], a[160:163], a[112:115], v[200:203]
 buffer_load_dwordx4 v11, s[52:55], s28 offen offset:3072   lds
M v[200:203], a[164:167], a[116:119], v[200:203]
 s_add_u32 s28, s28, 128
 v_cvt_pk_bf16_f32 v84, v84, v85
 v_cvt_pk_bf16_f32 v85, v86, v87
M v[204:207], a[164:167], a[124:127], v[204:207]
 v_cvt_pk_bf16_f32 v86, v116, v117
 v_cvt_pk_bf16_f32 v87, v118, v119
M v[204:207], a[160:163], a[120:123], v[204:207]
 v_cvt_pk_bf16_f32 v88, v88, v89
 v_cvt_pk_bf16_f32 v89, v90, v91
M v[208:211], a[160:163], a[128:131], v[208:211]
 buffer_store_dwordx4 v[24:27], v7, s[8:11], s3 offen offset:0 sc1
M v[208:211], a[164:167], a[132:135], v[208:211]
 v_cvt_pk_bf16_f32 v90, v120, v121
 v_cvt_pk_bf16_f32 v91, v122, v123
M v[212:215], a[164:167], a[140:143], v[212:215]
 v_accvgpr_read_b32 v24, a28
 v_accvgpr_read_b32 v25, a29
M v[212:215], a[160:163], a[136:139], v[212:215]
 v_accvgpr_read_b32 v26, a30
 v_accvgpr_read_b32 v27, a31
M v[216:219], a[160:163], a[144:147], v[216:219]
 v_cvt_pk_bf16_f32 v24, v24, v25
 v_cvt_pk_bf16_f32 v25, v26, v27
M v[216:219], a[164:167], a[148:151], v[216:219]
 s_waitcnt lgkmcnt(2)
 v_cvt_pk_bf16_f32 v26, v60, v61
 v_cvt_pk_bf16_f32 v27, v62, v63
M v[220:223], a[164:167], a[156:159], v[220:223]
 s_waitcnt vmcnt(27) lgkmcnt(0)
 buffer_store_dwordx4 v[24:27], v7, s[8:11], s3 offen offset:2048 sc1
M v[220:223], a[160:163], a[152:155], v[220:223]
 s_barrier
M v[224:227], a[168:171], a[96:99], v[224:227]
 ds_read_b128 a[160:163], v5 offset:0
 ds_read_b128 a[164:167], v6 offset:0
M v[224:227], a[172:175], a[100:103], v[224:227]
 v_cvt_pk_bf16_f32 v92, v92, v93
 v_cvt_pk_bf16_f32 v93, v94, v95
M v[228:231], a[172:175], a[108:111], v[228:231]
 v_cvt_pk_bf16_f32 v94, v124, v125
 v_cvt_pk_bf16_f32 v95, v126, v127
M v[228:231], a[168:171], a[104:107], v[228:231]
 v_cvt_pk_bf16_f32 v128, v128, v129
 v_cvt_pk_bf16_f32 v129, v130, v131
M v[232:235], a[168:171], a[112:115], v[232:235]
 v_cvt_pk_bf16_f32 v130, v160, v161
 v_cvt_pk_bf16_f32 v131, v162, v163
M v[232:235], a[172:175], a[116:119], v[232:235]
 v_cvt_pk_bf16_f32 v132, v132, v133
 v_cvt_pk_bf16_f32 v133, v134, v135
M v[236:239], a[172:175], a[124:127], v[236:239]
 v_cvt_pk_bf16_f32 v134, v164, v165
 v_cvt_pk_bf16_f32 v135, v166, v167
M v[236:239], a[168:171], a[120:123], v[236:239]
 v_cvt_pk_bf16_f32 v136, v136, v137
 v_cvt_pk_bf16_f32 v137, v138, v139
M v[240:243], a[168:171], a[128:131], v[240:243]
 v_cvt_pk_bf16_f32 v138, v168, v169
 v_cvt_pk_bf16_f32 v139, v170, v171
M v[240:243], a[172:175], a[132:135], v[240:243]
 v_cvt_pk_bf16_f32 v140, v140, v141
 v_cvt_pk_bf16_f32 v141, v142, v143
M v[244:247], a[172:175], a[140:143], v[244:247]
 v_cvt_pk_bf16_f32 v142, v172, v173
 v_cvt_pk_bf16_f32 v143, v174, v175
M v[244:247], a[168:171], a[136:139], v[244:247]
 v_cvt_pk_bf16_f32 v144, v144, v145
 v_cvt_pk_bf16_f32 v145, v146, v147
M v[248:251], a[168:171], a[144:147], v[248:251]
 v_cvt_pk_bf16_f32 v146, v176, v177
 v_cvt_pk_bf16_f32 v147, v178, v179
M v[248:251], a[172:175], a[148:151], v[248:251]
 s_waitcnt lgkmcnt(0)
 v_cvt_pk_bf16_f32 v148, v148, v149
 v_cvt_pk_bf16_f32 v149, v150, v151
M v[252:255], a[172:175], a[156:159], v[252:255]
 v_cvt_pk_bf16_f32 v150, v180, v181
 v_cvt_pk_bf16_f32 v151, v182, v183
M v[252:255], a[168:171], a[152:155], v[252:255]
 v_cvt_pk_bf16_f32 v152, v152, v153
 v_cvt_pk_bf16_f32 v153, v154, v155
M v[32:35], a[32:35], a[160:163], 0
 s_add_u32 m0, s23, 16384
 ds_read_b128 a[168:171], v5 offset:2048
 ds_read_b128 a[172:175], v6 offset:2048
M v[32:35], a[36:39], a[164:167], v[32:35]
 ds_read_b64_tr_b16 a[96:97], v1 offset:32768
 ds_read_b64_tr_b16 a[98:99], v1 offset:33792
M v[36:39], a[44:47], a[164:167], 0
 buffer_load_dwordx4 v8, s[52:55], s28 offen offset:0   lds
M v[36:39], a[40:43], a[160:163], v[36:39]
 v_cvt_pk_bf16_f32 v154, v184, v185
 v_cvt_pk_bf16_f32 v155, v186, v187
M v[40:43], a[48:51], a[160:163], 0
 ds_read_b64_tr_b16 a[100:101], v1 offset:40960
 ds_read_b64_tr_b16 a[102:103], v1 offset:41984
M v[40:43], a[52:55], a[164:167], v[40:43]
 buffer_load_dwordx4 v9, s[52:55], s28 offen offset:1024   lds
M v[44:47], a[60:63], a[164:167], 0
 v_cvt_pk_bf16_f32 v156, v156, v157
 v_cvt_pk_bf16_f32 v157, v158, v159
M v[44:47], a[56:59], a[160:163], v[44:47]
 ds_read_b64_tr_b16 a[104:105], v2 offset:32768
 ds_read_b64_tr_b16 a[106:107], v2 offset:33792
M v[48:51], a[64:67], a[160:163], 0
 v_cvt_pk_bf16_f32 v158, v188, v189
 v_cvt_pk_bf16_f32 v159, v190, v191
M v[48:51], a[68:71], a[164:167], v[48:51]
 v_cvt_pk_bf16_f32 v192, v192, v193
 v_cvt_pk_bf16_f32 v193, v194, v195
M v[52:55], a[76:79], a[164:167], 0
 ds_read_b64_tr_b16 a[108:109], v2 offset:40960
 ds_read_b64_tr_b16 a[110:111], v2 offset:41984
M v[52:55], a[72:75], a[160:163], v[52:55]
 buffer_load_dwordx4 v10, s[52:55], s28 offen offset:2048   lds
M v[56:59], a[80:83], a[160:163], 0
 v_cvt_pk_bf16_f32 v194, v224, v225
 v_cvt_pk_bf16_f32 v195, v226, v227
M v[56:59], a[84:87], a[164:167], v[56:59]
 s_waitcnt lgkmcnt(8)
 ds_read_b64_tr_b16 a[112:113], v3 offset:32768
 ds_read_b64_tr_b16 a[114:115], v3 offset:33792
M v[60:63], a[92:95], a[164:167], 0
 v_cvt_pk_bf16_f32 v196, v196, v197
 v_cvt_pk_bf16_f32 v197, v198, v199
M v[60:63], a[88:91], a[160:163], v[60:63]
 buffer_load_dwordx4 v11, s[52:55], s28 offen offset:3072   lds
M v[96:99], a[32:35], a[168:171], 0
 s_add_u32 s28, s28, 524160
 ds_read_b128 a[160:163], v5 offset:4096
 ds_read_b128 a[164:167], v6 offset:4096
M v[96:99], a[36:39], a[172:175], v[96:99]
 ds_read_b64_tr_b16 a[116:117], v3 offset:40960
 ds_read_b64_tr_b16 a[118:119], v3 offset:41984
M v[100:103], a[44:47], a[172:175], 0
 v_cvt_pk_bf16_f32 v198, v228, v229
 v_cvt_pk_bf16_f32 v199, v230, v231
M v[100:103], a[40:43], a[168:171], v[100:103]
 s_add_u32 m0, s24, 49152
 ds_read_b64_tr_b16 a[120:121], v4 offset:32768
 ds_read_b64_tr_b16 a[122:123], v4 offset:33792
M v[104:107], a[48:51], a[168:171], 0
 buffer_load_dwordx4 v16, s[56:59], s29 offen offset:0   lds
M v[104:107], a[52:55], a[172:175], v[104:107]
 v_cvt_pk_bf16_f32 v200, v200, v201
 v_cvt_pk_bf16_f32 v201, v202, v203
M v[108:111], a[60:63], a[172:175], 0
 ds_read_b64_tr_b16 a[124:125], v4 offset:40960
 ds_read_b64_tr_b16 a[126:127], v4 offset:41984
M v[108:111], a[56:59], a[168:171], v[108:111]
 v_cvt_pk_bf16_f32 v202, v232, v233
 v_cvt_pk_bf16_f32 v203, v234, v235
M v[112:115], a[64:67], a[168:171], 0
 v_cvt_pk_bf16_f32 v204, v204, v205
 v_cvt_pk_bf16_f32 v205, v206, v207
M v[112:115], a[68:71], a[172:175], v[112:115]
 buffer_load_dwordx4 v17, s[56:59], s29 offen offset:1024   lds
M v[116:119], a[76:79], a[172:175], 0
 v_cvt_pk_bf16_f32 v206, v236, v237
 v_cvt_pk_bf16_f32 v207, v238, v239
M v[116:119], a[72:75], a[168:171], v[116:119]
 v_cvt_pk_bf16_f32 v208, v208, v209
 v_cvt_pk_bf16_f32 v209, v210, v211
M v[120:123], a[80:83], a[168:171], 0
 v_cvt_pk_bf16_f32 v210, v240, v241
 v_cvt_pk_bf16_f32 v211, v242, v243
M v[120:123], a[84:87], a[172:175], v[120:123]
 s_waitcnt lgkmcnt(6)
 v_cvt_pk_bf16_f32 v212, v212, v213
 v_cvt_pk_bf16_f32 v213, v214, v215
M v[124:127], a[92:95], a[172:175], 0
 s_waitcnt vmcnt(21) lgkmcnt(0)
 buffer_load_dwordx4 v18, s[56:59], s29 offen offset:2048   lds
M v[124:127], a[88:91], a[168:171], v[124:127]
 s_barrier
M v[160:163], a[32:35], a[160:163], 0
 ds_read_b128 a[168:171], v5 offset:6144
 ds_read_b128 a[172:175], v6 offset:6144
M v[160:163], a[36:39], a[164:167], v[160:163]
 ds_read_b64_tr_b16 a[128:129], v1 offset:49152
 ds_read_b64_tr_b16 a[130:131], v1 offset:50176
M v[164:167], a[44:47], a[164:167], 0
 v_cvt_pk_bf16_f32 v214, v244, v245
 v_cvt_pk_bf16_f32 v215, v246, v247
M v[164:167], a[40:43], a[160:163], v[164:167]
 buffer_load_dwordx4 v19, s[56:59], s29 offen offset:3072   lds
M v[168:171], a[48:51], a[160:163], 0
 s_add_u32 s29, s29, 128
 ds_read_b64_tr_b16 a[132:133], v1 offset:57344
 ds_read_b64_tr_b16 a[134:135], v1 offset:58368
M v[168:171], a[52:55], a[164:167], v[168:171]
 v_cvt_pk_bf16_f32 v216, v216, v217
 v_cvt_pk_bf16_f32 v217, v218, v219
M v[172:175], a[60:63], a[164:167], 0
 v_cvt_pk_bf16_f32 v218, v248, v249
 v_cvt_pk_bf16_f32 v219, v250, v251
M v[172:175], a[56:59], a[160:163], v[172:175]
 s_add_u32 m0, s23, 32768
 ds_read_b64_tr_b16 a[136:137], v2 offset:49152
 ds_read_b64_tr_b16 a[138:139], v2 offset:50176
M v[176:179], a[64:67], a[160:163], 0
 buffer_load_dwordx4 v8, s[52:55], s28 offen offset:0   lds
M v[176:179], a[68:71], a[164:167], v[176:179]
 v_cvt_pk_bf16_f32 v220, v220, v221
 v_cvt_pk_bf16_f32 v221, v222, v223
M v[180:183], a[76:79], a[164:167], 0
 ds_read_b64_tr_b16 a[140:141], v2 offset:57344
 ds_read_b64_tr_b16 a[142:143], v2 offset:58368
M v[180:183], a[72:75], a[160:163], v[180:183]
 v_cvt_pk_bf16_f32 v222, v252, v253
 v_cvt_pk_bf16_f32 v223, v254, v255
M v[184:187], a[80:83], a[160:163], 0
 s_add_u32 s3, s93, 262144
 v_mov_b32 v12, 1
 v_or_b32 v15, s20, v0
M v[184:187], a[84:87], a[164:167], v[184:187]
 s_waitcnt lgkmcnt(8)
 ds_read_b64_tr_b16 a[144:145], v3 offset:49152
 ds_read_b64_tr_b16 a[146:147], v3 offset:50176
M v[188:191], a[92:95], a[164:167], 0
 buffer_load_dwordx4 v9, s[52:55], s28 offen offset:1024   lds
M v[188:191], a[88:91], a[160:163], v[188:191]
 v_min_u32 v15, 1, v15
 v_lshlrev_b32 v15, 29, v15
M v[224:227], a[32:35], a[168:171], 0
 ds_read_b128 a[160:163], v5 offset:16384
 ds_read_b128 a[164:167], v6 offset:16384
M v[224:227], a[36:39], a[172:175], v[224:227]
 ds_read_b64_tr_b16 a[148:149], v3 offset:57344
 ds_read_b64_tr_b16 a[150:151], v3 offset:58368
M v[228:231], a[44:47], a[172:175], 0
 buffer_load_dwordx4 v10, s[52:55], s28 offen offset:2048   lds
M v[228:231], a[40:43], a[168:171], v[228:231]
 ds_read_b64_tr_b16 a[152:153], v4 offset:49152
 ds_read_b64_tr_b16 a[154:155], v4 offset:50176
M v[232:235], a[48:51], a[168:171], 0
 buffer_store_dwordx4 v[64:67], v7, s[8:11], s3 offen offset:0 sc1
M v[232:235], a[52:55], a[172:175], v[232:235]
M v[236:239], a[60:63], a[172:175], 0
 ds_read_b64_tr_b16 a[156:157], v4 offset:57344
 ds_read_b64_tr_b16 a[158:159], v4 offset:58368
M v[236:239], a[56:59], a[168:171], v[236:239]
 buffer_load_dwordx4 v11, s[52:55], s28 offen offset:3072   lds
M v[240:243], a[64:67], a[168:171], 0
 s_add_u32 s28, s28, 128
M v[240:243], a[68:71], a[172:175], v[240:243]
 buffer_store_dwordx4 v[68:71], v7, s[8:11], s3 offen offset:2048 sc1
M v[244:247], a[76:79], a[172:175], 0
M v[244:247], a[72:75], a[168:171], v[244:247]
M v[248:251], a[80:83], a[168:171], 0
M v[248:251], a[84:87], a[172:175], v[248:251]
 s_waitcnt lgkmcnt(6)
M v[252:255], a[92:95], a[172:175], 0
 s_waitcnt vmcnt(14) lgkmcnt(0)
M v[252:255], a[88:91], a[168:171], v[252:255]
 s_barrier
M v[32:35], a[96:99], a[160:163], v[32:35]
 s_add_u32 m0, s23, 49152
 ds_read_b128 a[168:171], v5 offset:18432
 ds_read_b128 a[172:175], v6 offset:18432
M v[32:35], a[100:103], a[164:167], v[32:35]
 ds_read_b64_tr_b16 a[32:33], v20 offset:0
 ds_read_b64_tr_b16 a[34:35], v20 offset:1024
M v[36:39], a[108:111], a[164:167], v[36:39]
 s_mov_b32 s39, 1347
 buffer_load_dwordx4 v8, s[52:55], s28 offen offset:0   lds
M v[36:39], a[104:107], a[160:163], v[36:39]
 s_cmp_lt_u32 s42, 2
 buffer_store_dword v12, v15, s[8:11], s45 offen sc1
M v[40:43], a[112:115], a[160:163], v[40:43]
 s_cselect_b32 s39, 1284, s39
 ds_read_b64_tr_b16 a[36:37], v20 offset:8192
 ds_read_b64_tr_b16 a[38:39], v20 offset:9216
M v[40:43], a[116:119], a[164:167], v[40:43]
 s_lshl_b32 s64, s20, 14
 buffer_load_dwordx4 v9, s[52:55], s28 offen offset:1024   lds
M v[44:47], a[124:127], a[164:167], v[44:47]
 s_add_u32 s12, s64, s34
 s_add_u32 s3, s93, 266240
M v[44:47], a[120:123], a[160:163], v[44:47]
 s_add_u32 s13, s12, 4096
 ds_read_b64_tr_b16 a[40:41], v21 offset:0
 ds_read_b64_tr_b16 a[42:43], v21 offset:1024
M v[48:51], a[128:131], a[160:163], v[48:51]
 s_add_u32 s14, s12, 8192
 buffer_store_dwordx4 v[72:75], v7, s[8:11], s3 offen offset:0 sc1
M v[48:51], a[132:135], a[164:167], v[48:51]
 s_add_u32 s15, s12, 12288
M v[52:55], a[140:143], a[164:167], v[52:55]
 ds_read_b64_tr_b16 a[44:45], v21 offset:8192
 ds_read_b64_tr_b16 a[46:47], v21 offset:9216
M v[52:55], a[136:139], a[160:163], v[52:55]
 buffer_load_dwordx4 v10, s[52:55], s28 offen offset:2048   lds
M v[56:59], a[144:147], a[160:163], v[56:59]
M v[56:59], a[148:151], a[164:167], v[56:59]
 s_waitcnt lgkmcnt(8)
 ds_read_b64_tr_b16 a[48:49], v22 offset:0
 ds_read_b64_tr_b16 a[50:51], v22 offset:1024
M v[60:63], a[156:159], a[164:167], v[60:63]
M v[60:63], a[152:155], a[160:163], v[60:63]
 buffer_load_dwordx4 v11, s[52:55], s28 offen offset:3072   lds
M v[96:99], a[96:99], a[168:171], v[96:99]
 s_add_u32 s28, s28, 524160
 ds_read_b128 a[160:163], v5 offset:20480
 ds_read_b128 a[164:167], v6 offset:20480
M v[96:99], a[100:103], a[172:175], v[96:99]
 ds_read_b64_tr_b16 a[52:53], v22 offset:8192
 ds_read_b64_tr_b16 a[54:55], v22 offset:9216
M v[100:103], a[108:111], a[172:175], v[100:103]
M v[100:103], a[104:107], a[168:171], v[100:103]
 s_add_u32 m0, s24, 0
 ds_read_b64_tr_b16 a[56:57], v23 offset:0
 ds_read_b64_tr_b16 a[58:59], v23 offset:1024
M v[104:107], a[112:115], a[168:171], v[104:107]
 buffer_load_dwordx4 v16, s[56:59], s29 offen offset:0   lds
M v[104:107], a[116:119], a[172:175], v[104:107]
M v[108:111], a[124:127], a[172:175], v[108:111]
 ds_read_b64_tr_b16 a[60:61], v23 offset:8192
 ds_read_b64_tr_b16 a[62:63], v23 offset:9216
M v[108:111], a[120:123], a[168:171], v[108:111]
M v[112:115], a[128:131], a[168:171], v[112:115]
M v[112:115], a[132:135], a[172:175], v[112:115]
 buffer_load_dwordx4 v17, s[56:59], s29 offen offset:1024   lds
M v[116:119], a[140:143], a[172:175], v[116:119]
M v[116:119], a[136:139], a[168:171], v[116:119]
M v[120:123], a[144:147], a[168:171], v[120:123]
M v[120:123], a[148:151], a[172:175], v[120:123]
 s_waitcnt lgkmcnt(6)
M v[124:127], a[156:159], a[172:175], v[124:127]
 s_waitcnt lgkmcnt(0)
 buffer_load_dwordx4 v18, s[56:59], s29 offen offset:2048   lds
M v[124:127], a[152:155], a[168:171], v[124:127]
 s_barrier
M v[160:163], a[96:99], a[160:163], v[160:163]
 ds_read_b128 a[168:171], v5 offset:22528
 ds_read_b128 a[172:175], v6 offset:22528
M v[160:163], a[100:103], a[164:167], v[160:163]
 ds_read_b64_tr_b16 a[64:65], v20 offset:16384
 ds_read_b64_tr_b16 a[66:67], v20 offset:17408
M v[164:167], a[108:111], a[164:167], v[164:167]
M v[164:167], a[104:107], a[160:163], v[164:167]
 buffer_load_dwordx4 v19, s[56:59], s29 offen offset:3072   lds
M v[168:171], a[112:115], a[160:163], v[168:171]
 s_add_u32 s29, s29, 128
 ds_read_b64_tr_b16 a[68:69], v20 offset:24576
 ds_read_b64_tr_b16 a[70:71], v20 offset:25600
M v[168:171], a[116:119], a[164:167], v[168:171]
 buffer_store_dwordx4 v[76:79], v7, s[8:11], s3 offen offset:2048 sc1
M v[172:175], a[124:127], a[164:167], v[172:175]
M v[172:175], a[120:123], a[160:163], v[172:175]
 s_add_u32 m0, s23, 131072
 ds_read_b64_tr_b16 a[72:73], v21 offset:16384
 ds_read_b64_tr_b16 a[74:75], v21 offset:17408
M v[176:179], a[128:131], a[160:163], v[176:179]
 buffer_load_dwordx4 v8, s[52:55], s28 offen offset:0   lds
M v[176:179], a[132:135], a[164:167], v[176:179]
M v[180:183], a[140:143], a[164:167], v[180:183]
 ds_read_b64_tr_b16 a[76:77], v21 offset:24576
 ds_read_b64_tr_b16 a[78:79], v21 offset:25600
M v[180:183], a[136:139], a[160:163], v[180:183]
M v[184:187], a[144:147], a[160:163], v[184:187]
M v[184:187], a[148:151], a[164:167], v[184:187]
 s_waitcnt lgkmcnt(8)
 ds_read_b64_tr_b16 a[80:81], v22 offset:16384
 ds_read_b64_tr_b16 a[82:83], v22 offset:17408
M v[188:191], a[156:159], a[164:167], v[188:191]
 buffer_load_dwordx4 v9, s[52:55], s28 offen offset:1024   lds
M v[188:191], a[152:155], a[160:163], v[188:191]
M v[224:227], a[96:99], a[168:171], v[224:227]
 ds_read_b128 a[160:163], v5 offset:32768
 ds_read_b128 a[164:167], v6 offset:32768
M v[224:227], a[100:103], a[172:175], v[224:227]
 ds_read_b64_tr_b16 a[84:85], v22 offset:24576
 ds_read_b64_tr_b16 a[86:87], v22 offset:25600
M v[228:231], a[108:111], a[172:175], v[228:231]
 buffer_load_dwordx4 v10, s[52:55], s28 offen offset:2048   lds
M v[228:231], a[104:107], a[168:171], v[228:231]
 ds_read_b64_tr_b16 a[88:89], v23 offset:16384
 ds_read_b64_tr_b16 a[90:91], v23 offset:17408
M v[232:235], a[112:115], a[168:171], v[232:235]
M v[232:235], a[116:119], a[172:175], v[232:235]
M v[236:239], a[124:127], a[172:175], v[236:239]
 ds_read_b64_tr_b16 a[92:93], v23 offset:24576
 ds_read_b64_tr_b16 a[94:95], v23 offset:25600
M v[236:239], a[120:123], a[168:171], v[236:239]
 buffer_load_dwordx4 v11, s[52:55], s28 offen offset:3072   lds
M v[240:243], a[128:131], a[168:171], v[240:243]
 s_add_u32 s28, s28, 128
M v[240:243], a[132:135], a[172:175], v[240:243]
M v[244:247], a[140:143], a[172:175], v[244:247]
M v[244:247], a[136:139], a[168:171], v[244:247]
M v[248:251], a[144:147], a[168:171], v[248:251]
M v[248:251], a[148:151], a[172:175], v[248:251]
 s_waitcnt lgkmcnt(6)
M v[252:255], a[156:159], a[172:175], v[252:255]
 s_waitcnt lgkmcnt(0)
M v[252:255], a[152:155], a[168:171], v[252:255]
 s_barrier
M v[32:35], a[32:35], a[160:163], v[32:35]
 s_add_u32 m0, s23, 147456
 ds_read_b128 a[168:171], v5 offset:34816
 ds_read_b128 a[172:175], v6 offset:34816
M v[32:35], a[36:39], a[164:167], v[32:35]
 ds_read_b64_tr_b16 a[96:97], v1 offset:0
 ds_read_b64_tr_b16 a[98:99], v1 offset:1024
M v[36:39], a[44:47], a[164:167], v[36:39]
 buffer_load_dwordx4 v8, s[52:55], s28 offen offset:0   lds
M v[36:39], a[40:43], a[160:163], v[36:39]
 v_and_b32 v29, 15, v0
 v_mul_u32_u24 v30, 1792, v29
M v[40:43], a[48:51], a[160:163], v[40:43]
 s_add_u32 s3, s93, 270336
 ds_read_b64_tr_b16 a[100:101], v1 offset:8192
 ds_read_b64_tr_b16 a[102:103], v1 offset:9216
M v[40:43], a[52:55], a[164:167], v[40:43]
 buffer_load_dwordx4 v9, s[52:55], s28 offen offset:1024   lds
M v[44:47], a[60:63], a[164:167], v[44:47]
 v_lshrrev_b32 v31, 4, v0
 v_lshl_add_u32 v30, v31, 4, v30
M v[44:47], a[56:59], a[160:163], v[44:47]
 ds_read_b64_tr_b16 a[104:105], v2 offset:0
 ds_read_b64_tr_b16 a[106:107], v2 offset:1024
M v[48:51], a[64:67], a[160:163], v[48:51]
 v_lshrrev_b32 v29, 1, v29
 v_min_u32 v29, 1, v29
M v[48:51], a[68:71], a[164:167], v[48:51]
 v_lshl_or_b32 v30, v29, 29, v30
 v_or_b32 v30, s88, v30
M v[52:55], a[76:79], a[164:167], v[52:55]
 s_mul_i32 s89, s86, 3584
 ds_read_b64_tr_b16 a[108:109], v2 offset:8192
 ds_read_b64_tr_b16 a[110:111], v2 offset:9216
M v[52:55], a[72:75], a[160:163], v[52:55]
 s_mul_i32 s64, s20, 448
 buffer_load_dwordx4 v10, s[52:55], s28 offen offset:2048   lds
M v[56:59], a[80:83], a[160:163], v[56:59]
 s_add_u32 s89, s89, s64
 s_add_u32 s89, s89, 105906176
M v[56:59], a[84:87], a[164:167], v[56:59]
 s_waitcnt lgkmcnt(8)
 ds_read_b64_tr_b16 a[112:113], v3 offset:0
 ds_read_b64_tr_b16 a[114:115], v3 offset:1024
M v[60:63], a[92:95], a[164:167], v[60:63]
 buffer_store_dwordx4 v[80:83], v7, s[8:11], s3 offen offset:0 sc1
M v[60:63], a[88:91], a[160:163], v[60:63]
 buffer_load_dwordx4 v11, s[52:55], s28 offen offset:3072   lds
M v[96:99], a[32:35], a[168:171], v[96:99]
 s_add_u32 s28, s28, 524160
 ds_read_b128 a[160:163], v5 offset:36864
 ds_read_b128 a[164:167], v6 offset:36864
M v[96:99], a[36:39], a[172:175], v[96:99]
 ds_read_b64_tr_b16 a[116:117], v3 offset:8192
 ds_read_b64_tr_b16 a[118:119], v3 offset:9216
M v[100:103], a[44:47], a[172:175], v[100:103]
M v[100:103], a[40:43], a[168:171], v[100:103]
 s_add_u32 m0, s24, 16384
 ds_read_b64_tr_b16 a[120:121], v4 offset:0
 ds_read_b64_tr_b16 a[122:123], v4 offset:1024
M v[104:107], a[48:51], a[168:171], v[104:107]
 buffer_load_dwordx4 v16, s[56:59], s29 offen offset:0   lds
M v[104:107], a[52:55], a[172:175], v[104:107]
M v[108:111], a[60:63], a[172:175], v[108:111]
 ds_read_b64_tr_b16 a[124:125], v4 offset:8192
 ds_read_b64_tr_b16 a[126:127], v4 offset:9216
M v[108:111], a[56:59], a[168:171], v[108:111]
M v[112:115], a[64:67], a[168:171], v[112:115]
M v[112:115], a[68:71], a[172:175], v[112:115]
 buffer_load_dwordx4 v17, s[56:59], s29 offen offset:1024   lds
M v[116:119], a[76:79], a[172:175], v[116:119]
M v[116:119], a[72:75], a[168:171], v[116:119]
M v[120:123], a[80:83], a[168:171], v[120:123]
M v[120:123], a[84:87], a[172:175], v[120:123]
 s_waitcnt lgkmcnt(6)
M v[124:127], a[92:95], a[172:175], v[124:127]
 s_waitcnt vmcnt(28) lgkmcnt(0)
 buffer_load_dwordx4 v18, s[56:59], s29 offen offset:2048   lds
M v[124:127], a[88:91], a[168:171], v[124:127]
 s_barrier
M v[160:163], a[32:35], a[160:163], v[160:163]
 ds_read_b128 a[168:171], v5 offset:38912
 ds_read_b128 a[172:175], v6 offset:38912
M v[160:163], a[36:39], a[164:167], v[160:163]
 ds_read_b64_tr_b16 a[128:129], v1 offset:16384
 ds_read_b64_tr_b16 a[130:131], v1 offset:17408
M v[164:167], a[44:47], a[164:167], v[164:167]
M v[164:167], a[40:43], a[160:163], v[164:167]
 buffer_load_dwordx4 v19, s[56:59], s29 offen offset:3072   lds
M v[168:171], a[48:51], a[160:163], v[168:171]
 s_add_u32 s29, s29, 128
 ds_read_b64_tr_b16 a[132:133], v1 offset:24576
 ds_read_b64_tr_b16 a[134:135], v1 offset:25600
M v[168:171], a[52:55], a[164:167], v[168:171]
 buffer_store_dwordx4 v[84:87], v7, s[8:11], s3 offen offset:2048 sc1
M v[172:175], a[60:63], a[164:167], v[172:175]
M v[172:175], a[56:59], a[160:163], v[172:175]
 s_add_u32 m0, s23, 0
 ds_read_b64_tr_b16 a[136:137], v2 offset:16384
 ds_read_b64_tr_b16 a[138:139], v2 offset:17408
M v[176:179], a[64:67], a[160:163], v[176:179]
 buffer_load_dwordx4 v8, s[52:55], s28 offen offset:0   lds
M v[176:179], a[68:71], a[164:167], v[176:179]
M v[180:183], a[76:79], a[164:167], v[180:183]
 ds_read_b64_tr_b16 a[140:141], v2 offset:24576
 ds_read_b64_tr_b16 a[142:143], v2 offset:25600
M v[180:183], a[72:75], a[160:163], v[180:183]
M v[184:187], a[80:83], a[160:163], v[184:187]
M v[184:187], a[84:87], a[164:167], v[184:187]
 s_waitcnt lgkmcnt(8)
 ds_read_b64_tr_b16 a[144:145], v3 offset:16384
 ds_read_b64_tr_b16 a[146:147], v3 offset:17408
M v[188:191], a[92:95], a[164:167], v[188:191]
 buffer_load_dwordx4 v9, s[52:55], s28 offen offset:1024   lds
M v[188:191], a[88:91], a[160:163], v[188:191]
M v[224:227], a[32:35], a[168:171], v[224:227]
 ds_read_b128 a[160:163], v5 offset:49152
 ds_read_b128 a[164:167], v6 offset:49152
M v[224:227], a[36:39], a[172:175], v[224:227]
 ds_read_b64_tr_b16 a[148:149], v3 offset:24576
 ds_read_b64_tr_b16 a[150:151], v3 offset:25600
M v[228:231], a[44:47], a[172:175], v[228:231]
 buffer_load_dwordx4 v10, s[52:55], s28 offen offset:2048   lds
M v[228:231], a[40:43], a[168:171], v[228:231]
 ds_read_b64_tr_b16 a[152:153], v4 offset:16384
 ds_read_b64_tr_b16 a[154:155], v4 offset:17408
M v[232:235], a[48:51], a[168:171], v[232:235]
M v[232:235], a[52:55], a[172:175], v[232:235]
M v[236:239], a[60:63], a[172:175], v[236:239]
 ds_read_b64_tr_b16 a[156:157], v4 offset:24576
 ds_read_b64_tr_b16 a[158:159], v4 offset:25600
M v[236:239], a[56:59], a[168:171], v[236:239]
 buffer_load_dwordx4 v11, s[52:55], s28 offen offset:3072   lds
M v[240:243], a[64:67], a[168:171], v[240:243]
 s_add_u32 s28, s28, 128
M v[240:243], a[68:71], a[172:175], v[240:243]
M v[244:247], a[76:79], a[172:175], v[244:247]
M v[244:247], a[72:75], a[168:171], v[244:247]
M v[248:251], a[80:83], a[168:171], v[248:251]
M v[248:251], a[84:87], a[172:175], v[248:251]
 s_waitcnt lgkmcnt(6)
M v[252:255], a[92:95], a[172:175], v[252:255]
 s_waitcnt vmcnt(30) lgkmcnt(0)
M v[252:255], a[88:91], a[168:171], v[252:255]
 s_barrier
M v[32:35], a[96:99], a[160:163], v[32:35]
 s_add_u32 m0, s23, 16384
 ds_read_b128 a[168:171], v5 offset:51200
 ds_read_b128 a[172:175], v6 offset:51200
M v[32:35], a[100:103], a[164:167], v[32:35]
 ds_read_b64_tr_b16 a[32:33], v1 offset:32768
 ds_read_b64_tr_b16 a[34:35], v1 offset:33792
M v[36:39], a[108:111], a[164:167], v[36:39]
 buffer_load_dwordx4 v8, s[52:55], s28 offen offset:0   lds
M v[36:39], a[104:107], a[160:163], v[36:39]
 v_min_u32 v25, 15, v0
 v_lshlrev_b32 v25, 7, v25
M v[40:43], a[112:115], a[160:163], v[40:43]
 s_add_u32 s3, s93, 274432
 ds_read_b64_tr_b16 a[36:37], v1 offset:40960
 ds_read_b64_tr_b16 a[38:39], v1 offset:41984
M v[40:43], a[116:119], a[164:167], v[40:43]
 v_max_u32 v13, 1024, v25
M v[44:47], a[124:127], a[164:167], v[44:47]
 buffer_store_dwordx4 v[88:91], v7, s[8:11], s3 offen offset:0 sc1
M v[44:47], a[120:123], a[160:163], v[44:47]
 ds_read_b64_tr_b16 a[40:41], v2 offset:32768
 ds_read_b64_tr_b16 a[42:43], v2 offset:33792
M v[48:51], a[128:131], a[160:163], v[48:51]
 buffer_load_dwordx4 v9, s[52:55], s28 offen offset:1024   lds
M v[48:51], a[132:135], a[164:167], v[48:51]
M v[52:55], a[140:143], a[164:167], v[52:55]
 ds_read_b64_tr_b16 a[44:45], v2 offset:40960
 ds_read_b64_tr_b16 a[46:47], v2 offset:41984
M v[52:55], a[136:139], a[160:163], v[52:55]
M v[56:59], a[144:147], a[160:163], v[56:59]
M v[56:59], a[148:151], a[164:167], v[56:59]
 s_waitcnt lgkmcnt(8)
 ds_read_b64_tr_b16 a[48:49], v3 offset:32768
 ds_read_b64_tr_b16 a[50:51], v3 offset:33792
M v[60:63], a[156:159], a[164:167], v[60:63]
 buffer_load_dwordx4 v10, s[52:55], s28 offen offset:2048   lds
M v[60:63], a[152:155], a[160:163], v[60:63]
M v[96:99], a[96:99], a[168:171], v[96:99]
 ds_read_b128 a[160:163], v5 offset:53248
 ds_read_b128 a[164:167], v6 offset:53248
M v[96:99], a[100:103], a[172:175], v[96:99]
 ds_read_b64_tr_b16 a[52:53], v3 offset:40960
 ds_read_b64_tr_b16 a[54:55], v3 offset:41984
M v[100:103], a[108:111], a[172:175], v[100:103]
 buffer_store_dwordx4 v[92:95], v7, s[8:11], s3 offen offset:2048 sc1
M v[100:103], a[104:107], a[168:171], v[100:103]
 ds_read_b64_tr_b16 a[56:57], v4 offset:32768
 ds_read_b64_tr_b16 a[58:59], v4 offset:33792
M v[104:107], a[112:115], a[168:171], v[104:107]
M v[104:107], a[116:119], a[172:175], v[104:107]
 buffer_load_dwordx4 v11, s[52:55], s28 offen offset:3072   lds
M v[108:111], a[124:127], a[172:175], v[108:111]
 s_add_u32 s28, s28, 524160
 ds_read_b64_tr_b16 a[60:61], v4 offset:40960
 ds_read_b64_tr_b16 a[62:63], v4 offset:41984
M v[108:111], a[120:123], a[168:171], v[108:111]
M v[112:115], a[128:131], a[168:171], v[112:115]
M v[112:115], a[132:135], a[172:175], v[112:115]
M v[116:119], a[140:143], a[172:175], v[116:119]
M v[116:119], a[136:139], a[168:171], v[116:119]
M v[120:123], a[144:147], a[168:171], v[120:123]
M v[120:123], a[148:151], a[172:175], v[120:123]
 s_waitcnt lgkmcnt(6)
M v[124:127], a[156:159], a[172:175], v[124:127]
 s_waitcnt vmcnt(25) lgkmcnt(0)
M v[124:127], a[152:155], a[168:171], v[124:127]
 s_barrier
M v[160:163], a[96:99], a[160:163], v[160:163]
 ds_read_b128 a[168:171], v5 offset:55296
 ds_read_b128 a[172:175], v6 offset:55296
M v[160:163], a[100:103], a[164:167], v[160:163]
 ds_read_b64_tr_b16 a[64:65], v1 offset:49152
 ds_read_b64_tr_b16 a[66:67], v1 offset:50176
M v[164:167], a[108:111], a[164:167], v[164:167]
 buffer_store_dwordx4 a[208:211], v30, s[8:11], s89 offen offset:0 sc1
M v[164:167], a[104:107], a[160:163], v[164:167]
M v[168:171], a[112:115], a[160:163], v[168:171]
 ds_read_b64_tr_b16 a[68:69], v1 offset:57344
 ds_read_b64_tr_b16 a[70:71], v1 offset:58368
M v[168:171], a[116:119], a[164:167], v[168:171]
M v[172:175], a[124:127], a[164:167], v[172:175]
M v[172:175], a[120:123], a[160:163], v[172:175]
 ds_read_b64_tr_b16 a[72:73], v2 offset:49152
 ds_read_b64_tr_b16 a[74:75], v2 offset:50176
M v[176:179], a[128:131], a[160:163], v[176:179]
M v[176:179], a[132:135], a[164:167], v[176:179]
M v[180:183], a[140:143], a[164:167], v[180:183]
 ds_read_b64_tr_b16 a[76:77], v2 offset:57344
 ds_read_b64_tr_b16 a[78:79], v2 offset:58368
M v[180:183], a[136:139], a[160:163], v[180:183]
M v[184:187], a[144:147], a[160:163], v[184:187]
M v[184:187], a[148:151], a[164:167], v[184:187]
 s_waitcnt lgkmcnt(8)
 ds_read_b64_tr_b16 a[80:81], v3 offset:49152
 ds_read_b64_tr_b16 a[82:83], v3 offset:50176
M v[188:191], a[156:159], a[164:167], v[188:191]
 buffer_store_dwordx4 a[212:215], v30, s[8:11], s89 offen offset:64 sc1
M v[188:191], a[152:155], a[160:163], v[188:191]
M v[224:227], a[96:99], a[168:171], v[224:227]
 ds_read_b128 a[160:163], v5 offset:0
 ds_read_b128 a[164:167], v6 offset:0
M v[224:227], a[100:103], a[172:175], v[224:227]
 ds_read_b64_tr_b16 a[84:85], v3 offset:57344
 ds_read_b64_tr_b16 a[86:87], v3 offset:58368
M v[228:231], a[108:111], a[172:175], v[228:231]
M v[228:231], a[104:107], a[168:171], v[228:231]
 ds_read_b64_tr_b16 a[88:89], v4 offset:49152
 ds_read_b64_tr_b16 a[90:91], v4 offset:50176
M v[232:235], a[112:115], a[168:171], v[232:235]
M v[232:235], a[116:119], a[172:175], v[232:235]
M v[236:239], a[124:127], a[172:175], v[236:239]
 ds_read_b64_tr_b16 a[92:93], v4 offset:57344
 ds_read_b64_tr_b16 a[94:95], v4 offset:58368
M v[236:239], a[120:123], a[168:171], v[236:239]
M v[240:243], a[128:131], a[168:171], v[240:243]
M v[240:243], a[132:135], a[172:175], v[240:243]
M v[244:247], a[140:143], a[172:175], v[244:247]
M v[244:247], a[136:139], a[168:171], v[244:247]
M v[248:251], a[144:147], a[168:171], v[248:251]
M v[248:251], a[148:151], a[172:175], v[248:251]
 s_waitcnt lgkmcnt(6)
M v[252:255], a[156:159], a[172:175], v[252:255]
 s_waitcnt vmcnt(22) lgkmcnt(0)
M v[252:255], a[152:155], a[168:171], v[252:255]
 s_barrier
M v[32:35], a[32:35], a[160:163], v[32:35]
 s_add_u32 m0, s23, 32768
 ds_read_b128 a[168:171], v5 offset:2048
 ds_read_b128 a[172:175], v6 offset:2048
M v[32:35], a[36:39], a[164:167], v[32:35]
 ds_read_b64_tr_b16 a[96:97], v20 offset:0
 ds_read_b64_tr_b16 a[98:99], v20 offset:1024
M v[36:39], a[44:47], a[164:167], v[36:39]
 buffer_load_dwordx4 v16, s[56:59], s29 offen offset:0   lds
M v[36:39], a[40:43], a[160:163], v[36:39]
 buffer_store_dwordx4 a[216:219], v30, s[8:11], s89 offen offset:128 sc1
M v[40:43], a[48:51], a[160:163], v[40:43]
 ds_read_b64_tr_b16 a[100:101], v20 offset:8192
 ds_read_b64_tr_b16 a[102:103], v20 offset:9216
M v[40:43], a[52:55], a[164:167], v[40:43]
 buffer_load_dwordx4 v17, s[56:59], s29 offen offset:1024   lds
M v[44:47], a[60:63], a[164:167], v[44:47]
M v[44:47], a[56:59], a[160:163], v[44:47]
 ds_read_b64_tr_b16 a[104:105], v21 offset:0
 ds_read_b64_tr_b16 a[106:107], v21 offset:1024
M v[48:51], a[64:67], a[160:163], v[48:51]
M v[48:51], a[68:71], a[164:167], v[48:51]
 buffer_load_dwordx4 v18, s[56:59], s29 offen offset:2048   lds
M v[52:55], a[76:79], a[164:167], v[52:55]
 ds_read_b64_tr_b16 a[108:109], v21 offset:8192
 ds_read_b64_tr_b16 a[110:111], v21 offset:9216
M v[52:55], a[72:75], a[160:163], v[52:55]
 buffer_store_dwordx4 a[220:223], v30, s[8:11], s89 offen offset:192 sc1
M v[56:59], a[80:83], a[160:163], v[56:59]
M v[56:59], a[84:87], a[164:167], v[56:59]
 s_waitcnt lgkmcnt(8)
 ds_read_b64_tr_b16 a[112:113], v22 offset:0
 ds_read_b64_tr_b16 a[114:115], v22 offset:1024
M v[60:63], a[92:95], a[164:167], v[60:63]
 buffer_load_dwordx4 v19, s[56:59], s29 offen offset:3072   lds
M v[60:63], a[88:91], a[160:163], v[60:63]
 s_add_u32 s29, s29, 128
M v[96:99], a[32:35], a[168:171], v[96:99]
 ds_read_b128 a[160:163], v5 offset:4096
 ds_read_b128 a[164:167], v6 offset:4096
M v[96:99], a[36:39], a[172:175], v[96:99]
 ds_read_b64_tr_b16 a[116:117], v22 offset:8192
 ds_read_b64_tr_b16 a[118:119], v22 offset:9216
M v[100:103], a[44:47], a[172:175], v[100:103]
 s_lshl_b32 s28, s20, 13
 buffer_store_dwordx4 a[224:227], v30, s[8:11], s89 offen offset:256 sc1
M v[100:103], a[40:43], a[168:171], v[100:103]
 s_lshl_b32 s21, s41, 20
 ds_read_b64_tr_b16 a[120:121], v23 offset:0
 ds_read_b64_tr_b16 a[122:123], v23 offset:1024
M v[104:107], a[48:51], a[168:171], v[104:107]
 s_mov_b32 s22, 0
M v[104:107], a[52:55], a[172:175], v[104:107]
 s_lshl_b32 s7, s41, 18
M v[108:111], a[60:63], a[172:175], v[108:111]
 s_add_u32 s7, s7, 100663296
 ds_read_b64_tr_b16 a[124:125], v23 offset:8192
 ds_read_b64_tr_b16 a[126:127], v23 offset:9216
M v[108:111], a[56:59], a[168:171], v[108:111]
 s_add_u32 s38, s7, 65536
 buffer_store_dwordx4 a[228:231], v30, s[8:11], s89 offen offset:320 sc1
M v[112:115], a[64:67], a[168:171], v[112:115]
 s_sub_u32 s27, s42, 1
M v[112:115], a[68:71], a[172:175], v[112:115]
 s_mov_b32 s43, 32767
M v[116:119], a[76:79], a[172:175], v[116:119]
 s_mov_b32 s4, 0
 buffer_load_dword v24, v13, s[8:11], s46 offen sc1
M v[116:119], a[72:75], a[168:171], v[116:119]
 s_add_u32 s26, s21, 655360
 buffer_store_dwordx4 a[232:235], v30, s[8:11], s89 offen offset:384 sc1
M v[120:123], a[80:83], a[168:171], v[120:123]
 s_lshl_b32 s64, s42, 1
 s_add_u32 s65, s64, 4
 s_add_u32 s64, s64, 2
M v[120:123], a[84:87], a[172:175], v[120:123]
 s_waitcnt lgkmcnt(6)
 s_add_u32 s3, s93, 524288
M v[124:127], a[92:95], a[172:175], v[124:127]
 s_waitcnt vmcnt(23) lgkmcnt(0)
M v[124:127], a[88:91], a[168:171], v[124:127]
 s_barrier
M v[160:163], a[32:35], a[160:163], v[160:163]
 s_cmp_le_u32 s42, 5
 ds_read_b128 a[168:171], v5 offset:6144
 ds_read_b128 a[172:175], v6 offset:6144
M v[160:163], a[36:39], a[164:167], v[160:163]
 s_cselect_b32 s25, s65, 32767
 ds_read_b64_tr_b16 a[128:129], v20 offset:16384
 ds_read_b64_tr_b16 a[130:131], v20 offset:17408
M v[164:167], a[44:47], a[164:167], v[164:167]
 s_cselect_b32 s6, 14, s64
 buffer_store_dwordx4 v[128:131], v7, s[8:11], s3 offen offset:0 sc1
M v[164:167], a[40:43], a[160:163], v[164:167]
 s_mov_b32 s23, 0
M v[168:171], a[48:51], a[160:163], v[168:171]
 ds_read_b64_tr_b16 a[132:133], v20 offset:24576
 ds_read_b64_tr_b16 a[134:135], v20 offset:25600
M v[168:171], a[52:55], a[164:167], v[168:171]
M v[172:175], a[60:63], a[164:167], v[172:175]
 buffer_store_dwordx4 v[132:135], v7, s[8:11], s3 offen offset:2048 sc1
M v[172:175], a[56:59], a[160:163], v[172:175]
 s_add_u32 s3, s93, 528384
 ds_read_b64_tr_b16 a[136:137], v21 offset:16384
 ds_read_b64_tr_b16 a[138:139], v21 offset:17408
M v[176:179], a[64:67], a[160:163], v[176:179]
M v[176:179], a[68:71], a[164:167], v[176:179]
M v[180:183], a[76:79], a[164:167], v[180:183]
 ds_read_b64_tr_b16 a[140:141], v21 offset:24576
 ds_read_b64_tr_b16 a[142:143], v21 offset:25600
M v[180:183], a[72:75], a[160:163], v[180:183]
 buffer_store_dwordx4 v[136:139], v7, s[8:11], s3 offen offset:0 sc1
M v[184:187], a[80:83], a[160:163], v[184:187]
M v[184:187], a[84:87], a[164:167], v[184:187]
 s_waitcnt lgkmcnt(8)
 ds_read_b64_tr_b16 a[144:145], v22 offset:16384
 ds_read_b64_tr_b16 a[146:147], v22 offset:17408
M v[188:191], a[92:95], a[164:167], v[188:191]
M v[188:191], a[88:91], a[160:163], v[188:191]
 buffer_store_dwordx4 v[140:143], v7, s[8:11], s3 offen offset:2048 sc1
M v[224:227], a[32:35], a[168:171], v[224:227]
 ds_read_b128 a[160:163], v5 offset:16384
 ds_read_b128 a[164:167], v6 offset:16384
M v[224:227], a[36:39], a[172:175], v[224:227]
 s_add_u32 s3, s93, 532480
 ds_read_b64_tr_b16 a[148:149], v22 offset:24576
 ds_read_b64_tr_b16 a[150:151], v22 offset:25600
M v[228:231], a[44:47], a[172:175], v[228:231]
M v[228:231], a[40:43], a[168:171], v[228:231]
 ds_read_b64_tr_b16 a[152:153], v23 offset:16384
 ds_read_b64_tr_b16 a[154:155], v23 offset:17408
M v[232:235], a[48:51], a[168:171], v[232:235]
 buffer_store_dwordx4 v[144:147], v7, s[8:11], s3 offen offset:0 sc1
M v[232:235], a[52:55], a[172:175], v[232:235]
M v[236:239], a[60:63], a[172:175], v[236:239]
 ds_read_b64_tr_b16 a[156:157], v23 offset:24576
 ds_read_b64_tr_b16 a[158:159], v23 offset:25600
M v[236:239], a[56:59], a[168:171], v[236:239]
M v[240:243], a[64:67], a[168:171], v[240:243]
M v[240:243], a[68:71], a[172:175], v[240:243]
M v[244:247], a[76:79], a[172:175], v[244:247]
M v[244:247], a[72:75], a[168:171], v[244:247]
M v[248:251], a[80:83], a[168:171], v[248:251]
M v[248:251], a[84:87], a[172:175], v[248:251]
 s_waitcnt lgkmcnt(6)
M v[252:255], a[92:95], a[172:175], v[252:255]
 s_waitcnt vmcnt(23) lgkmcnt(0)
M v[252:255], a[88:91], a[168:171], v[252:255]
 s_barrier
M v[32:35], a[96:99], a[160:163], v[32:35]
 ds_read_b128 a[168:171], v5 offset:18432
 ds_read_b128 a[172:175], v6 offset:18432
M v[32:35], a[100:103], a[164:167], v[32:35]
 ds_read_b64_tr_b16 a[32:33], v1 offset:0
 ds_read_b64_tr_b16 a[34:35], v1 offset:1024
M v[36:39], a[108:111], a[164:167], v[36:39]
 v_add_u32 v10, s28, v7
 v_add_u32 v11, 0x1000, v10
M v[36:39], a[104:107], a[160:163], v[36:39]
 s_waitcnt vmcnt(6)
 v_cmp_eq_u32 vcc, 0, v24
M v[40:43], a[112:115], a[160:163], v[40:43]
 s_lshl_b32 s64, s20, 10
 ds_read_b64_tr_b16 a[36:37], v1 offset:8192
 ds_read_b64_tr_b16 a[38:39], v1 offset:9216
M v[40:43], a[116:119], a[164:167], v[40:43]
 s_cbranch_vccnz L_f1s04
L_f1r04:
M v[44:47], a[124:127], a[164:167], v[44:47]
 s_add_u32 m0, s28, 98304
 s_nop 0
 buffer_load_dwordx4 v10, s[8:11], s21 offen offset:0 sc1 lds
M v[44:47], a[120:123], a[160:163], v[44:47]
 ds_read_b64_tr_b16 a[40:41], v2 offset:0
 ds_read_b64_tr_b16 a[42:43], v2 offset:1024
M v[48:51], a[128:131], a[160:163], v[48:51]
 buffer_store_dwordx4 v[148:151], v7, s[8:11], s3 offen offset:2048 sc1
M v[48:51], a[132:135], a[164:167], v[48:51]
M v[52:55], a[140:143], a[164:167], v[52:55]
 ds_read_b64_tr_b16 a[44:45], v2 offset:8192
 ds_read_b64_tr_b16 a[46:47], v2 offset:9216
M v[52:55], a[136:139], a[160:163], v[52:55]
 buffer_load_dwordx4 v10, s[8:11], s21 offen offset:1024 sc1 lds
M v[56:59], a[144:147], a[160:163], v[56:59]
M v[56:59], a[148:151], a[164:167], v[56:59]
 s_waitcnt lgkmcnt(8)
 ds_read_b64_tr_b16 a[48:49], v3 offset:0
 ds_read_b64_tr_b16 a[50:51], v3 offset:1024
M v[60:63], a[156:159], a[164:167], v[60:63]
M v[60:63], a[152:155], a[160:163], v[60:63]
 s_add_u32 s3, s93, 536576
 buffer_load_dwordx4 v10, s[8:11], s21 offen offset:2048 sc1 lds
M v[96:99], a[96:99], a[168:171], v[96:99]
 ds_read_b128 a[160:163], v5 offset:20480
 ds_read_b128 a[164:167], v6 offset:20480
M v[96:99], a[100:103], a[172:175], v[96:99]
 ds_read_b64_tr_b16 a[52:53], v3 offset:8192
 ds_read_b64_tr_b16 a[54:55], v3 offset:9216
M v[100:103], a[108:111], a[172:175], v[100:103]
 buffer_store_dwordx4 v[152:155], v7, s[8:11], s3 offen offset:0 sc1
M v[100:103], a[104:107], a[168:171], v[100:103]
 ds_read_b64_tr_b16 a[56:57], v4 offset:0
 ds_read_b64_tr_b16 a[58:59], v4 offset:1024
M v[104:107], a[112:115], a[168:171], v[104:107]
 buffer_load_dwordx4 v10, s[8:11], s21 offen offset:3072 sc1 lds
M v[104:107], a[116:119], a[172:175], v[104:107]
 s_add_u32 m0, s28, 102400
M v[108:111], a[124:127], a[172:175], v[108:111]
 ds_read_b64_tr_b16 a[60:61], v4 offset:8192
 ds_read_b64_tr_b16 a[62:63], v4 offset:9216
M v[108:111], a[120:123], a[168:171], v[108:111]
M v[112:115], a[128:131], a[168:171], v[112:115]
 buffer_load_dwordx4 v11, s[8:11], s21 offen offset:0 sc1 lds
M v[112:115], a[132:135], a[172:175], v[112:115]
M v[116:119], a[140:143], a[172:175], v[116:119]
 buffer_store_dwordx4 v[156:159], v7, s[8:11], s3 offen offset:2048 sc1
M v[116:119], a[136:139], a[168:171], v[116:119]
M v[120:123], a[144:147], a[168:171], v[120:123]
 buffer_load_dwordx4 v11, s[8:11], s21 offen offset:1024 sc1 lds
M v[120:123], a[148:151], a[172:175], v[120:123]
 s_waitcnt lgkmcnt(6)
M v[124:127], a[156:159], a[172:175], v[124:127]
 s_waitcnt lgkmcnt(0)
 buffer_load_dwordx4 v11, s[8:11], s21 offen offset:2048 sc1 lds
M v[124:127], a[152:155], a[168:171], v[124:127]
 s_barrier
M v[160:163], a[96:99], a[160:163], v[160:163]
 ds_read_b128 a[168:171], v5 offset:22528
 ds_read_b128 a[172:175], v6 offset:22528
M v[160:163], a[100:103], a[164:167], v[160:163]
 ds_read_b64_tr_b16 a[64:65], v1 offset:16384
 ds_read_b64_tr_b16 a[66:67], v1 offset:17408
M v[164:167], a[108:111], a[164:167], v[164:167]
 buffer_load_dwordx4 v11, s[8:11], s21 offen offset:3072 sc1 lds
M v[164:167], a[104:107], a[160:163], v[164:167]
 s_add_u32 s24, s23, 16777216
M v[168:171], a[112:115], a[160:163], v[168:171]
 s_mov_b32 s23, s21
 ds_read_b64_tr_b16 a[68:69], v1 offset:24576
 ds_read_b64_tr_b16 a[70:71], v1 offset:25600
M v[168:171], a[116:119], a[164:167], v[168:171]
 s_add_u32 s21, s21, 32768
 s_add_u32 s3, s93, 786432
M v[172:175], a[124:127], a[164:167], v[172:175]
 s_add_u32 s22, s22, 1
 buffer_store_dwordx4 v[192:195], v7, s[8:11], s3 offen offset:0 sc1
M v[172:175], a[120:123], a[160:163], v[172:175]
 s_cmp_eq_u32 s22, s25
 ds_read_b64_tr_b16 a[72:73], v2 offset:16384
 ds_read_b64_tr_b16 a[74:75], v2 offset:17408
M v[176:179], a[128:131], a[160:163], v[176:179]
 s_cselect_b32 s21, s26, s21
 v_subrev_u32 v5, 0x10000, v5
 v_subrev_u32 v6, 0x10000, v6
M v[176:179], a[132:135], a[164:167], v[176:179]
 s_cmp_eq_u32 s22, s43
M v[180:183], a[140:143], a[164:167], v[180:183]
 s_cselect_b32 s21, s4, s21
 ds_read_b64_tr_b16 a[76:77], v2 offset:24576
 ds_read_b64_tr_b16 a[78:79], v2 offset:25600
M v[180:183], a[136:139], a[160:163], v[180:183]
 s_cmp_eq_u32 s22, s6
M v[184:187], a[144:147], a[160:163], v[184:187]
 s_cselect_b32 s21, s7, s21
 v_mov_b32 v9, v25
 v_lshrrev_b32 v24, 4, v0
M v[184:187], a[148:151], a[164:167], v[184:187]
 s_waitcnt lgkmcnt(8)
 ds_read_b64_tr_b16 a[80:81], v3 offset:16384
 ds_read_b64_tr_b16 a[82:83], v3 offset:17408
M v[188:191], a[156:159], a[164:167], v[188:191]
 v_lshlrev_b32 v24, 2, v24
 v_and_b32 v25, 15, v0
M v[188:191], a[152:155], a[160:163], v[188:191]
 v_sub_u32 v24, v24, v25
M v[224:227], a[96:99], a[168:171], v[224:227]
 s_add_u32 s64, s64, s34
 ds_read_b128 a[160:163], v5 offset:32768
 ds_read_b128 a[164:167], v6 offset:32768
M v[224:227], a[100:103], a[172:175], v[224:227]
 s_add_u32 s52, s64, 65536
 ds_read_b64_tr_b16 a[84:85], v3 offset:24576
 ds_read_b64_tr_b16 a[86:87], v3 offset:25600
M v[228:231], a[108:111], a[172:175], v[228:231]
 s_mov_b32 s55, 0x21800000
 buffer_store_dwordx4 v[196:199], v7, s[8:11], s3 offen offset:2048 sc1
M v[228:231], a[104:107], a[168:171], v[228:231]
 s_and_b32 s65, s39, 0
 ds_read_b64_tr_b16 a[88:89], v4 offset:16384
 ds_read_b64_tr_b16 a[90:91], v4 offset:17408
M v[232:235], a[112:115], a[168:171], v[232:235]
 s_cmp_eq_u32 s20, 0
M v[232:235], a[116:119], a[172:175], v[232:235]
 s_cselect_b32 s54, s39, s65
M v[236:239], a[124:127], a[172:175], v[236:239]
 s_lshr_b32 s64, s20, 1
 ds_read_b64_tr_b16 a[92:93], v4 offset:24576
 ds_read_b64_tr_b16 a[94:95], v4 offset:25600
M v[236:239], a[120:123], a[168:171], v[236:239]
 s_lshl_b32 s64, s64, 17
M v[240:243], a[128:131], a[168:171], v[240:243]
 s_and_b32 s65, s20, 1
M v[240:243], a[132:135], a[172:175], v[240:243]
 s_lshl_b32 s65, s65, 12
M v[244:247], a[140:143], a[172:175], v[244:247]
 s_add_u32 s64, s64, s65
 v_add_u32 v14, s64, v7
 v_mov_b32 v8, 0xff800000
M v[244:247], a[136:139], a[168:171], v[244:247]
 v_cmp_lt_i32 s[16:17], 0, v24
 v_cmp_lt_i32 s[18:19], -1, v24
M v[248:251], a[144:147], a[168:171], v[248:251]
 v_cmp_lt_i32 s[48:49], -2, v24
 v_cmp_lt_i32 s[50:51], -3, v24
M v[248:251], a[148:151], a[172:175], v[248:251]
 s_waitcnt lgkmcnt(6)
M v[252:255], a[156:159], a[172:175], v[252:255]
 s_waitcnt lgkmcnt(0)
M v[252:255], a[152:155], a[168:171], v[252:255]
 s_barrier
M v[32:35], a[32:35], a[160:163], v[32:35]
 ds_read_b128 a[168:171], v5 offset:34816
 ds_read_b128 a[172:175], v6 offset:34816
M v[32:35], a[36:39], a[164:167], v[32:35]
 buffer_load_dword v24, v9, s[8:11], s46 offen sc1
M v[36:39], a[44:47], a[164:167], v[36:39]
 v_mov_b32 v1, v15
 v_add_u32 v2, 0x10000, v7
M v[36:39], a[40:43], a[160:163], v[36:39]
 v_mov_b32 v3, v10
 v_mov_b32 v4, v11
M v[40:43], a[48:51], a[160:163], v[40:43]
 s_mov_b64 s[60:61], s[76:77]
M v[40:43], a[52:55], a[164:167], v[40:43]
 s_mov_b32 s62, s78
M v[44:47], a[60:63], a[164:167], v[44:47]
 s_mov_b32 s63, 0x20000
 v_lshl_add_u32 v10, v0, 7, s95
 v_and_b32 v0, 48, v0
M v[44:47], a[56:59], a[160:163], v[44:47]
 v_lshl_add_u32 v0, v0, 24, v10
 v_mul_f32 v32, s5, v32
M v[48:51], a[64:67], a[160:163], v[48:51]
 v_mul_f32 v33, s5, v33
 v_mul_f32 v34, s5, v34
M v[48:51], a[68:71], a[164:167], v[48:51]
 v_mul_f32 v35, s5, v35
 v_mul_f32 v36, s5, v36
M v[52:55], a[76:79], a[164:167], v[52:55]
 v_mul_f32 v37, s5, v37
 v_mul_f32 v38, s5, v38
M v[52:55], a[72:75], a[160:163], v[52:55]
 v_mul_f32 v39, s5, v39
 v_cvt_pk_bf16_f32 v32, v32, v33
M v[56:59], a[80:83], a[160:163], v[56:59]
 v_cvt_pk_bf16_f32 v33, v34, v35
 v_cvt_pk_bf16_f32 v34, v36, v37
M v[56:59], a[84:87], a[164:167], v[56:59]
 s_waitcnt lgkmcnt(0)
 v_cvt_pk_bf16_f32 v35, v38, v39
 ds_write_b128 v14, v[32:35] offset:0
M v[60:63], a[92:95], a[164:167], v[60:63]
 s_add_u32 s3, s93, 790528
 buffer_store_dwordx4 v[200:203], v7, s[8:11], s3 offen offset:0 sc1
M v[60:63], a[88:91], a[160:163], v[60:63]
 v_mul_f32 v40, s5, v40
 v_mul_f32 v41, s5, v41
M v[96:99], a[32:35], a[168:171], v[96:99]
 ds_read_b128 a[160:163], v5 offset:36864
 ds_read_b128 a[164:167], v6 offset:36864
M v[96:99], a[36:39], a[172:175], v[96:99]
 v_mul_f32 v42, s5, v42
 v_mul_f32 v43, s5, v43
M v[100:103], a[44:47], a[172:175], v[100:103]
 v_mul_f32 v44, s5, v44
 v_mul_f32 v45, s5, v45
M v[100:103], a[40:43], a[168:171], v[100:103]
 v_mul_f32 v46, s5, v46
 v_mul_f32 v47, s5, v47
M v[104:107], a[48:51], a[168:171], v[104:107]
 v_cvt_pk_bf16_f32 v40, v40, v41
 v_cvt_pk_bf16_f32 v41, v42, v43
M v[104:107], a[52:55], a[172:175], v[104:107]
 v_cvt_pk_bf16_f32 v42, v44, v45
 v_cvt_pk_bf16_f32 v43, v46, v47
M v[108:111], a[60:63], a[172:175], v[108:111]
 ds_write_b128 v14, v[40:43] offset:1024
M v[108:111], a[56:59], a[168:171], v[108:111]
 buffer_store_dwordx4 v[204:207], v7, s[8:11], s3 offen offset:2048 sc1
M v[112:115], a[64:67], a[168:171], v[112:115]
 v_mul_f32 v48, s5, v48
 v_mul_f32 v49, s5, v49
M v[112:115], a[68:71], a[172:175], v[112:115]
 v_mul_f32 v50, s5, v50
 v_mul_f32 v51, s5, v51
M v[116:119], a[76:79], a[172:175], v[116:119]
 v_mul_f32 v52, s5, v52
 v_mul_f32 v53, s5, v53
M v[116:119], a[72:75], a[168:171], v[116:119]
 v_mul_f32 v54, s5, v54
 v_mul_f32 v55, s5, v55
M v[120:123], a[80:83], a[168:171], v[120:123]
 v_cvt_pk_bf16_f32 v48, v48, v49
 v_cvt_pk_bf16_f32 v49, v50, v51
M v[120:123], a[84:87], a[172:175], v[120:123]
 s_waitcnt lgkmcnt(1)
 v_cvt_pk_bf16_f32 v50, v52, v53
 v_cvt_pk_bf16_f32 v51, v54, v55
M v[124:127], a[92:95], a[172:175], v[124:127]
 ds_write_b128 v14, v[48:51] offset:2048
M v[124:127], a[88:91], a[168:171], v[124:127]
 s_add_u32 s3, s93, 794624
 buffer_store_dwordx4 v[208:211], v7, s[8:11], s3 offen offset:0 sc1
M v[160:163], a[32:35], a[160:163], v[160:163]
 ds_read_b128 a[168:171], v5 offset:38912
 ds_read_b128 a[172:175], v6 offset:38912
M v[160:163], a[36:39], a[164:167], v[160:163]
 v_mul_f32 v56, s5, v56
 v_mul_f32 v57, s5, v57
M v[164:167], a[44:47], a[164:167], v[164:167]
 v_mul_f32 v58, s5, v58
 v_mul_f32 v59, s5, v59
M v[164:167], a[40:43], a[160:163], v[164:167]
 v_mul_f32 v60, s5, v60
 v_mul_f32 v61, s5, v61
M v[168:171], a[48:51], a[160:163], v[168:171]
 v_mul_f32 v62, s5, v62
 v_mul_f32 v63, s5, v63
M v[168:171], a[52:55], a[164:167], v[168:171]
 v_cvt_pk_bf16_f32 v56, v56, v57
 v_cvt_pk_bf16_f32 v57, v58, v59
M v[172:175], a[60:63], a[164:167], v[172:175]
 v_cvt_pk_bf16_f32 v58, v60, v61
 v_cvt_pk_bf16_f32 v59, v62, v63
M v[172:175], a[56:59], a[160:163], v[172:175]
 s_waitcnt lgkmcnt(0)
 ds_write_b128 v14, v[56:59] offset:3072
M v[176:179], a[64:67], a[160:163], v[176:179]
 s_barrier
M v[176:179], a[68:71], a[164:167], v[176:179]
M v[180:183], a[76:79], a[164:167], v[180:183]
 s_add_u32 m0, s28, 32768
 s_nop 0
 buffer_load_dwordx4 v3, s[8:11], s21 offen offset:0 sc1 lds
M v[180:183], a[72:75], a[160:163], v[180:183]
M v[184:187], a[80:83], a[160:163], v[184:187]
 buffer_store_dwordx4 v[212:215], v7, s[8:11], s3 offen offset:2048 sc1
M v[184:187], a[84:87], a[164:167], v[184:187]
 v_mul_f32 v96, s5, v96
 v_mul_f32 v97, s5, v97
M v[188:191], a[92:95], a[164:167], v[188:191]
 buffer_load_dwordx4 v3, s[8:11], s21 offen offset:1024 sc1 lds
M v[188:191], a[88:91], a[160:163], v[188:191]
 v_mul_f32 v98, s5, v98
 v_mul_f32 v99, s5, v99
M v[224:227], a[32:35], a[168:171], v[224:227]
 v_mul_f32 v100, s5, v100
 v_mul_f32 v101, s5, v101
M v[224:227], a[36:39], a[172:175], v[224:227]
 v_mul_f32 v102, s5, v102
 v_mul_f32 v103, s5, v103
M v[228:231], a[44:47], a[172:175], v[228:231]
 buffer_load_dwordx4 v3, s[8:11], s21 offen offset:2048 sc1 lds
M v[228:231], a[40:43], a[168:171], v[228:231]
 v_cvt_pk_bf16_f32 v96, v96, v97
 v_cvt_pk_bf16_f32 v97, v98, v99
M v[232:235], a[48:51], a[168:171], v[232:235]
 v_cvt_pk_bf16_f32 v98, v100, v101
 v_cvt_pk_bf16_f32 v99, v102, v103
M v[232:235], a[52:55], a[172:175], v[232:235]
 ds_write_b128 v14, v[96:99] offset:8192
M v[236:239], a[60:63], a[172:175], v[236:239]
 s_add_u32 s3, s93, 798720
 buffer_load_dwordx4 v3, s[8:11], s21 offen offset:3072 sc1 lds
M v[236:239], a[56:59], a[168:171], v[236:239]
 s_add_u32 m0, s28, 36864
M v[240:243], a[64:67], a[168:171], v[240:243]
 buffer_store_dwordx4 v[216:219], v7, s[8:11], s3 offen offset:0 sc1
M v[240:243], a[68:71], a[172:175], v[240:243]
 v_mul_f32 v104, s5, v104
 v_mul_f32 v105, s5, v105
M v[244:247], a[76:79], a[172:175], v[244:247]
 buffer_load_dwordx4 v4, s[8:11], s21 offen offset:0 sc1 lds
M v[244:247], a[72:75], a[168:171], v[244:247]
 v_mul_f32 v106, s5, v106
 v_mul_f32 v107, s5, v107
M v[248:251], a[80:83], a[168:171], v[248:251]
 v_mul_f32 v108, s5, v108
 v_mul_f32 v109, s5, v109
M v[248:251], a[84:87], a[172:175], v[248:251]
 v_mul_f32 v110, s5, v110
 v_mul_f32 v111, s5, v111
M v[252:255], a[92:95], a[172:175], v[252:255]
 buffer_load_dwordx4 v4, s[8:11], s21 offen offset:1024 sc1 lds
M v[252:255], a[88:91], a[168:171], v[252:255]
 buffer_load_dwordx4 v4, s[8:11], s21 offen offset:2048 sc1 lds
 buffer_load_dwordx4 v4, s[8:11], s21 offen offset:3072 sc1 lds
 s_add_u32 s24, s23, 16777216
 s_mov_b32 s23, s21
 s_add_u32 s21, s21, 32768
 s_add_u32 s22, s22, 1
 s_cmp_eq_u32 s22, s25
 s_cselect_b32 s21, s26, s21
 s_cmp_eq_u32 s22, s43
 s_cselect_b32 s21, s4, s21
 s_cmp_eq_u32 s22, s6
 s_cselect_b32 s21, s7, s21
 v_cvt_pk_bf16_f32 v104, v104, v105
 v_cvt_pk_bf16_f32 v105, v106, v107
 v_cvt_pk_bf16_f32 v106, v108, v109
 v_cvt_pk_bf16_f32 v107, v110, v111
 ds_write_b128 v14, v[104:107] offset:9216
 buffer_store_dwordx4 v[220:223], v7, s[8:11], s3 offen offset:2048 sc1
 v_pk_mul_f32 v[112:113], v[112:113], s[4:5] op_sel:[0,1] op_sel_hi:[1,1]
 v_pk_mul_f32 v[114:115], v[114:115], s[4:5] op_sel:[0,1] op_sel_hi:[1,1]
 v_pk_mul_f32 v[116:117], v[116:117], s[4:5] op_sel:[0,1] op_sel_hi:[1,1]
 v_pk_mul_f32 v[118:119], v[118:119], s[4:5] op_sel:[0,1] op_sel_hi:[1,1]
 v_cvt_pk_bf16_f32 v112, v112, v113
 v_cvt_pk_bf16_f32 v113, v114, v115
 v_cvt_pk_bf16_f32 v114, v116, v117
 v_cvt_pk_bf16_f32 v115, v118, v119
 ds_write_b128 v14, v[112:115] offset:10240
 v_pk_mul_f32 v[120:121], v[120:121], s[4:5] op_sel:[0,1] op_sel_hi:[1,1]
 v_pk_mul_f32 v[122:123], v[122:123], s[4:5] op_sel:[0,1] op_sel_hi:[1,1]
 v_pk_mul_f32 v[124:125], v[124:125], s[4:5] op_sel:[0,1] op_sel_hi:[1,1]
 v_pk_mul_f32 v[126:127], v[126:127], s[4:5] op_sel:[0,1] op_sel_hi:[1,1]
 v_cvt_pk_bf16_f32 v120, v120, v121
 v_cvt_pk_bf16_f32 v121, v122, v123
 v_cvt_pk_bf16_f32 v122, v124, v125
 v_cvt_pk_bf16_f32 v123, v126, v127
 ds_write_b128 v14, v[120:123] offset:11264
 v_pk_mul_f32 v[160:161], v[160:161], s[4:5] op_sel:[0,1] op_sel_hi:[1,1]
 v_pk_mul_f32 v[162:163], v[162:163], s[4:5] op_sel:[0,1] op_sel_hi:[1,1]
 v_pk_mul_f32 v[164:165], v[164:165], s[4:5] op_sel:[0,1] op_sel_hi:[1,1]
 v_pk_mul_f32 v[166:167], v[166:167], s[4:5] op_sel:[0,1] op_sel_hi:[1,1]
 v_cvt_pk_bf16_f32 v160, v160, v161
 v_cvt_pk_bf16_f32 v161, v162, v163
 v_cvt_pk_bf16_f32 v162, v164, v165
 v_cvt_pk_bf16_f32 v163, v166, v167
 ds_write_b128 v14, v[160:163] offset:16384
 v_pk_mul_f32 v[168:169], v[168:169], s[4:5] op_sel:[0,1] op_sel_hi:[1,1]
 v_pk_mul_f32 v[170:171], v[170:171], s[4:5] op_sel:[0,1] op_sel_hi:[1,1]
 v_pk_mul_f32 v[172:173], v[172:173], s[4:5] op_sel:[0,1] op_sel_hi:[1,1]
 v_pk_mul_f32 v[174:175], v[174:175], s[4:5] op_sel:[0,1] op_sel_hi:[1,1]
 v_cvt_pk_bf16_f32 v168, v168, v169
 v_cvt_pk_bf16_f32 v169, v170, v171
 v_cvt_pk_bf16_f32 v170, v172, v173
 v_cvt_pk_bf16_f32 v171, v174, v175
 ds_write_b128 v14, v[168:171] offset:17408
 v_pk_mul_f32 v[176:177], v[176:177], s[4:5] op_sel:[0,1] op_sel_hi:[1,1]
 v_pk_mul_f32 v[178:179], v[178:179], s[4:5] op_sel:[0,1] op_sel_hi:[1,1]
 v_pk_mul_f32 v[180:181], v[180:181], s[4:5] op_sel:[0,1] op_sel_hi:[1,1]
 v_pk_mul_f32 v[182:183], v[182:183], s[4:5] op_sel:[0,1] op_sel_hi:[1,1]
 v_cvt_pk_bf16_f32 v176, v176, v177
 v_cvt_pk_bf16_f32 v177, v178, v179
 v_cvt_pk_bf16_f32 v178, v180, v181
 v_cvt_pk_bf16_f32 v179, v182, v183
 ds_write_b128 v14, v[176:179] offset:18432
 v_pk_mul_f32 v[184:185], v[184:185], s[4:5] op_sel:[0,1] op_sel_hi:[1,1]
 v_pk_mul_f32 v[186:187], v[186:187], s[4:5] op_sel:[0,1] op_sel_hi:[1,1]
 v_pk_mul_f32 v[188:189], v[188:189], s[4:5] op_sel:[0,1] op_sel_hi:[1,1]
 v_pk_mul_f32 v[190:191], v[190:191], s[4:5] op_sel:[0,1] op_sel_hi:[1,1]
 v_cvt_pk_bf16_f32 v184, v184, v185
 v_cvt_pk_bf16_f32 v185, v186, v187
 v_cvt_pk_bf16_f32 v186, v188, v189
 v_cvt_pk_bf16_f32 v187, v190, v191
 ds_write_b128 v14, v[184:187] offset:19456
 v_pk_mul_f32 v[224:225], v[224:225], s[4:5] op_sel:[0,1] op_sel_hi:[1,1]
 v_pk_mul_f32 v[226:227], v[226:227], s[4:5] op_sel:[0,1] op_sel_hi:[1,1]
 v_pk_mul_f32 v[228:229], v[228:229], s[4:5] op_sel:[0,1] op_sel_hi:[1,1]
 v_pk_mul_f32 v[230:231], v[230:231], s[4:5] op_sel:[0,1] op_sel_hi:[1,1]
 v_cvt_pk_bf16_f32 v224, v224, v225
 v_cvt_pk_bf16_f32 v225, v226, v227
 v_cvt_pk_bf16_f32 v226, v228, v229
 v_cvt_pk_bf16_f32 v227, v230, v231
 ds_write_b128 v14, v[224:227] offset:24576
 v_pk_mul_f32 v[232:233], v[232:233], s[4:5] op_sel:[0,1] op_sel_hi:[1,1]
 v_pk_mul_f32 v[234:235], v[234:235], s[4:5] op_sel:[0,1] op_sel_hi:[1,1]
 v_pk_mul_f32 v[236:237], v[236:237], s[4:5] op_sel:[0,1] op_sel_hi:[1,1]
 v_pk_mul_f32 v[238:239], v[238:239], s[4:5] op_sel:[0,1] op_sel_hi:[1,1]
 v_cvt_pk_bf16_f32 v232, v232, v233
 v_cvt_pk_bf16_f32 v233, v234, v235
 v_cvt_pk_bf16_f32 v234, v236, v237
 v_cvt_pk_bf16_f32 v235, v238, v239
 ds_write_b128 v14, v[232:235] offset:25600
 v_pk_mul_f32 v[240:241], v[240:241], s[4:5] op_sel:[0,1] op_sel_hi:[1,1]
 v_pk_mul_f32 v[242:243], v[242:243], s[4:5] op_sel:[0,1] op_sel_hi:[1,1]
 v_pk_mul_f32 v[244:245], v[244:245], s[4:5] op_sel:[0,1] op_sel_hi:[1,1]
 v_pk_mul_f32 v[246:247], v[246:247], s[4:5] op_sel:[0,1] op_sel_hi:[1,1]
 v_cvt_pk_bf16_f32 v240, v240, v241
 v_cvt_pk_bf16_f32 v241, v242, v243
 v_cvt_pk_bf16_f32 v242, v244, v245
 v_cvt_pk_bf16_f32 v243, v246, v247
 ds_write_b128 v14, v[240:243] offset:26624
 v_pk_mul_f32 v[248:249], v[248:249], s[4:5] op_sel:[0,1] op_sel_hi:[1,1]
 v_pk_mul_f32 v[250:251], v[250:251], s[4:5] op_sel:[0,1] op_sel_hi:[1,1]
 v_pk_mul_f32 v[252:253], v[252:253], s[4:5] op_sel:[0,1] op_sel_hi:[1,1]
 v_pk_mul_f32 v[254:255], v[254:255], s[4:5] op_sel:[0,1] op_sel_hi:[1,1]
 v_cvt_pk_bf16_f32 v248, v248, v249
 v_cvt_pk_bf16_f32 v249, v250, v251
 v_cvt_pk_bf16_f32 v250, v252, v253
 v_cvt_pk_bf16_f32 v251, v254, v255
 ds_write_b128 v14, v[248:251] offset:27648
 s_waitcnt vmcnt(17) lgkmcnt(0)
 s_barrier
 ds_read_b128 a[64:67], v2 offset:32768
 ds_read_b128 a[68:71], v2 offset:33792
 ds_read_b128 a[72:75], v2 offset:34816
 ds_read_b128 a[76:79], v2 offset:35840
 ds_read_b128 a[80:83], v2 offset:36864
 ds_read_b128 a[84:87], v2 offset:37888
 ds_read_b128 a[88:91], v2 offset:38912
 ds_read_b128 a[92:95], v2 offset:39936
 s_lshl_b32 s64, s20, 13
 s_sub_u32 s65, 155648, s64
 v_add_u32 v10, s64, v7
 v_add_u32 v11, s65, v7
 ds_read_b128 a[0:3], v10 offset:0
 ds_read_b128 a[4:7], v10 offset:1024
 ds_read_b128 a[8:11], v10 offset:2048
 ds_read_b128 a[12:15], v10 offset:3072
 ds_read_b128 a[16:19], v10 offset:4096
 ds_read_b128 a[20:23], v10 offset:5120
 ds_read_b128 a[24:27], v10 offset:6144
 ds_read_b128 a[28:31], v10 offset:7168
 ds_read_b128 a[32:35], v11 offset:0
 ds_read_b128 a[36:39], v11 offset:1024
 ds_read_b128 a[40:43], v11 offset:2048
 ds_read_b128 a[44:47], v11 offset:3072
 ds_read_b128 a[48:51], v11 offset:4096
 ds_read_b128 a[52:55], v11 offset:5120
 ds_read_b128 a[56:59], v11 offset:6144
 ds_read_b128 a[60:63], v11 offset:7168
 s_waitcnt vmcnt(14)
 v_cmp_eq_u32 vcc, 0, v24
 v_mov_b32 v17, 5
 v_or_b32 v6, s35, v7
 s_cbranch_vccnz L_f1s05
L_f1r05:
 s_mov_b32 s30, s93
 s_mov_b32 s29, s94
 s_cmp_eq_u32 s20, 0
 s_cselect_b32 s5, 0, 0
 v_mov_b32 v32, 0xc1800000
 v_mov_b32 v33, 0xc1800000
 v_mov_b32 v34, 0xc1800000
 v_mov_b32 v35, 0xc1800000
 v_mov_b32 v36, 0xc1800000
 v_mov_b32 v37, 0xc1800000
 v_mov_b32 v38, 0xc1800000
 v_mov_b32 v39, 0xc1800000
 s_waitcnt lgkmcnt(0)
M v[64:67], a[64:67], a[0:3], v[32:35]
 ds_read_b128 a[96:99], v2 offset:40960
 v_mov_b32 v30, 0
M v[64:67], a[68:71], a[4:7], v[64:67]
 s_add_u32 m0, s28, 65536
 ds_read_b128 a[100:103], v2 offset:41984
 v_mov_b32 v31, 0
M v[64:67], a[72:75], a[8:11], v[64:67]
 buffer_load_dwordx4 v3, s[8:11], s24 offen offset:0 sc1 lds
M v[64:67], a[76:79], a[12:15], v[64:67]
 ds_read_b128 a[104:107], v2 offset:43008
M v[64:67], a[80:83], a[16:19], v[64:67]
 ds_read_b128 a[108:111], v2 offset:44032
M v[64:67], a[84:87], a[20:23], v[64:67]
 buffer_load_dwordx4 v3, s[8:11], s24 offen offset:1024 sc1 lds
M v[64:67], a[88:91], a[24:27], v[64:67]
 ds_read_b128 a[112:115], v2 offset:45056
M v[64:67], a[92:95], a[28:31], v[64:67]
 ds_read_b128 a[116:119], v2 offset:46080
M v[68:71], a[92:95], a[60:63], v[36:39]
M v[68:71], a[88:91], a[56:59], v[68:71]
 ds_read_b128 a[120:123], v2 offset:47104
M v[68:71], a[84:87], a[52:55], v[68:71]
 ds_read_b128 a[124:127], v2 offset:48128
M v[68:71], a[80:83], a[48:51], v[68:71]
 buffer_load_dwordx4 v3, s[8:11], s24 offen offset:2048 sc1 lds
M v[68:71], a[76:79], a[44:47], v[68:71]
 v_exp_f32 v18, v64
M v[68:71], a[72:75], a[40:43], v[68:71]
 v_exp_f32 v19, v65
M v[68:71], a[68:71], a[36:39], v[68:71]
 v_exp_f32 v20, v66
M v[68:71], a[64:67], a[32:35], v[68:71]
 s_waitcnt lgkmcnt(0)
 v_exp_f32 v21, v67
M v[72:75], a[96:99], a[0:3], v[32:35]
 ds_read_b128 a[64:67], v2 offset:49152
 v_add_f32 v26, v18, v19
M v[72:75], a[100:103], a[4:7], v[72:75]
 ds_read_b128 a[68:71], v2 offset:50176
 v_cvt_pk_bf16_f32 v40, v18, v19
M v[72:75], a[104:107], a[8:11], v[72:75]
 buffer_load_dwordx4 v3, s[8:11], s24 offen offset:3072 sc1 lds
M v[72:75], a[108:111], a[12:15], v[72:75]
 ds_read_b128 a[72:75], v2 offset:51200
 v_add_f32 v26, v20, v26
M v[72:75], a[112:115], a[16:19], v[72:75]
 s_add_u32 m0, s28, 69632
 ds_read_b128 a[76:79], v2 offset:52224
 v_cvt_pk_bf16_f32 v41, v20, v21
M v[72:75], a[116:119], a[20:23], v[72:75]
 buffer_load_dwordx4 v4, s[8:11], s24 offen offset:0 sc1 lds
M v[72:75], a[120:123], a[24:27], v[72:75]
 ds_read_b128 a[80:83], v2 offset:53248
 v_add_f32 v26, v21, v26
M v[72:75], a[124:127], a[28:31], v[72:75]
 ds_read_b128 a[84:87], v2 offset:54272
M v[76:79], a[124:127], a[60:63], v[36:39]
 v_exp_f32 v22, v68
M v[76:79], a[120:123], a[56:59], v[76:79]
 ds_read_b128 a[88:91], v2 offset:55296
M v[76:79], a[116:119], a[52:55], v[76:79]
 ds_read_b128 a[92:95], v2 offset:56320
M v[76:79], a[112:115], a[48:51], v[76:79]
 buffer_load_dwordx4 v4, s[8:11], s24 offen offset:1024 sc1 lds
M v[76:79], a[108:111], a[44:47], v[76:79]
 v_exp_f32 v23, v69
M v[76:79], a[104:107], a[40:43], v[76:79]
 v_exp_f32 v24, v70
M v[76:79], a[100:103], a[36:39], v[76:79]
 buffer_load_dwordx4 v4, s[8:11], s24 offen offset:2048 sc1 lds
M v[76:79], a[96:99], a[32:35], v[76:79]
 s_waitcnt lgkmcnt(0)
 v_exp_f32 v25, v71
M v[80:83], a[64:67], a[0:3], v[32:35]
 ds_read_b128 a[96:99], v2 offset:57344
 v_add_f32 v27, v22, v23
M v[80:83], a[68:71], a[4:7], v[80:83]
 ds_read_b128 a[100:103], v2 offset:58368
 v_cvt_pk_bf16_f32 v44, v22, v23
M v[80:83], a[72:75], a[8:11], v[80:83]
 v_exp_f32 v18, v72
M v[80:83], a[76:79], a[12:15], v[80:83]
 ds_read_b128 a[104:107], v2 offset:59392
 v_add_f32 v27, v24, v27
M v[80:83], a[80:83], a[16:19], v[80:83]
 ds_read_b128 a[108:111], v2 offset:60416
 v_cvt_pk_bf16_f32 v45, v24, v25
M v[80:83], a[84:87], a[20:23], v[80:83]
 buffer_load_dwordx4 v4, s[8:11], s24 offen offset:3072 sc1 lds
M v[80:83], a[88:91], a[24:27], v[80:83]
 ds_read_b128 a[112:115], v2 offset:61440
 v_add_f32 v27, v25, v27
M v[80:83], a[92:95], a[28:31], v[80:83]
 ds_read_b128 a[116:119], v2 offset:62464
M v[84:87], a[92:95], a[60:63], v[36:39]
 v_exp_f32 v19, v73
M v[84:87], a[88:91], a[56:59], v[84:87]
 ds_read_b128 a[120:123], v2 offset:63488
 v_add_f32 v26, v18, v26
M v[84:87], a[84:87], a[52:55], v[84:87]
 ds_read_b128 a[124:127], v2 offset:64512
 v_cvt_pk_bf16_f32 v42, v18, v19
M v[84:87], a[80:83], a[48:51], v[84:87]
 v_exp_f32 v20, v74
M v[84:87], a[76:79], a[44:47], v[84:87]
 v_exp_f32 v21, v75
M v[84:87], a[72:75], a[40:43], v[84:87]
 v_exp_f32 v22, v76
M v[84:87], a[68:71], a[36:39], v[84:87]
 s_waitcnt vmcnt(8) lgkmcnt(0)
 v_exp_f32 v23, v77
M v[84:87], a[64:67], a[32:35], v[84:87]
 s_barrier
M v[88:91], a[96:99], a[0:3], v[32:35]
 ds_read_b128 a[64:67], v7 offset:32768
 v_add_f32 v26, v19, v26
M v[88:91], a[100:103], a[4:7], v[88:91]
 ds_read_b128 a[68:71], v7 offset:33792
 v_add_f32 v26, v20, v26
M v[88:91], a[104:107], a[8:11], v[88:91]
 buffer_store_dword v17, v1, s[8:11], s45 offen sc1
M v[88:91], a[108:111], a[12:15], v[88:91]
 ds_read_b128 a[72:75], v7 offset:34816
 v_cvt_pk_bf16_f32 v43, v20, v21
M v[88:91], a[112:115], a[16:19], v[88:91]
 ds_read_b128 a[76:79], v7 offset:35840
 v_add_f32 v26, v21, v26
M v[88:91], a[116:119], a[20:23], v[88:91]
 v_exp_f32 v24, v78
M v[88:91], a[120:123], a[24:27], v[88:91]
 ds_read_b128 a[80:83], v7 offset:36864
 v_add_f32 v27, v22, v27
M v[88:91], a[124:127], a[28:31], v[88:91]
 ds_read_b128 a[84:87], v7 offset:37888
 v_cvt_pk_bf16_f32 v46, v22, v23
M v[92:95], a[124:127], a[60:63], v[36:39]
 v_exp_f32 v25, v79
M v[92:95], a[120:123], a[56:59], v[92:95]
 ds_read_b128 a[88:91], v7 offset:38912
 v_add_f32 v27, v23, v27
M v[92:95], a[116:119], a[52:55], v[92:95]
 ds_read_b128 a[92:95], v7 offset:39936
 v_add_f32 v27, v24, v27
M v[92:95], a[112:115], a[48:51], v[92:95]
 v_cvt_pk_bf16_f32 v47, v24, v25
 v_add_f32 v27, v25, v27
M v[92:95], a[108:111], a[44:47], v[92:95]
M v[92:95], a[104:107], a[40:43], v[92:95]
M v[92:95], a[100:103], a[36:39], v[92:95]
 s_waitcnt lgkmcnt(0)
M v[92:95], a[96:99], a[32:35], v[92:95]
 s_cmp_eq_u32 s42, 0
 s_cbranch_scc1 L_j0
M v[96:99], a[64:67], a[0:3], v[32:35]
 s_add_u32 m0, s28, 98304
 ds_read_b128 a[96:99], v7 offset:40960
M v[96:99], a[68:71], a[4:7], v[96:99]
 ds_read_b128 a[100:103], v7 offset:41984
M v[96:99], a[72:75], a[8:11], v[96:99]
 buffer_load_dwordx4 v3, s[8:11], s21 offen offset:0 sc1 lds
M v[96:99], a[76:79], a[12:15], v[96:99]
 s_cmp_eq_u32 s20, 0
 ds_read_b128 a[104:107], v7 offset:43008
M v[96:99], a[80:83], a[16:19], v[96:99]
 s_cselect_b64 s[64:65], s[16:17], 0
 ds_read_b128 a[108:111], v7 offset:44032
M v[96:99], a[84:87], a[20:23], v[96:99]
 buffer_load_dwordx4 v3, s[8:11], s21 offen offset:1024 sc1 lds
M v[96:99], a[88:91], a[24:27], v[96:99]
 s_cselect_b64 s[66:67], s[18:19], 0
 ds_read_b128 a[112:115], v7 offset:45056
M v[96:99], a[92:95], a[28:31], v[96:99]
 s_cselect_b64 s[68:69], s[48:49], 0
 ds_read_b128 a[116:119], v7 offset:46080
M v[100:103], a[92:95], a[60:63], v[36:39]
 s_cselect_b64 s[70:71], s[50:51], 0
 v_exp_f32 v18, v80
M v[100:103], a[88:91], a[56:59], v[100:103]
 s_cmp_lt_u32 s20, 1
 ds_read_b128 a[120:123], v7 offset:47104
M v[100:103], a[84:87], a[52:55], v[100:103]
 s_cselect_b64 s[78:79], -1, 0
 ds_read_b128 a[124:127], v7 offset:48128
M v[100:103], a[80:83], a[48:51], v[100:103]
 buffer_load_dwordx4 v3, s[8:11], s21 offen offset:2048 sc1 lds
M v[100:103], a[76:79], a[44:47], v[100:103]
 s_cmp_eq_u32 s20, 1
 v_exp_f32 v19, v81
M v[100:103], a[72:75], a[40:43], v[100:103]
 s_cselect_b64 s[72:73], s[16:17], s[78:79]
 v_exp_f32 v20, v82
M v[100:103], a[68:71], a[36:39], v[100:103]
 s_cselect_b64 s[74:75], s[18:19], s[78:79]
 v_exp_f32 v21, v83
M v[100:103], a[64:67], a[32:35], v[100:103]
 s_waitcnt lgkmcnt(0)
 v_exp_f32 v22, v88
M v[104:107], a[96:99], a[0:3], v[32:35]
 s_cselect_b64 s[76:77], s[48:49], s[78:79]
 ds_read_b128 a[64:67], v7 offset:49152
 v_add_f32 v26, v18, v26
M v[104:107], a[100:103], a[4:7], v[104:107]
 s_cselect_b64 s[78:79], s[50:51], s[78:79]
 ds_read_b128 a[68:71], v7 offset:50176
 v_cvt_pk_bf16_f32 v56, v18, v19
M v[104:107], a[104:107], a[8:11], v[104:107]
 buffer_load_dwordx4 v3, s[8:11], s21 offen offset:3072 sc1 lds
M v[104:107], a[108:111], a[12:15], v[104:107]
 s_add_u32 m0, s28, 102400
 ds_read_b128 a[72:75], v7 offset:51200
 v_add_f32 v26, v19, v26
M v[104:107], a[112:115], a[16:19], v[104:107]
 s_cmp_lt_u32 s20, 2
 ds_read_b128 a[76:79], v7 offset:52224
 v_add_f32 v26, v20, v26
M v[104:107], a[116:119], a[20:23], v[104:107]
 buffer_load_dwordx4 v4, s[8:11], s21 offen offset:0 sc1 lds
M v[104:107], a[120:123], a[24:27], v[104:107]
 s_cselect_b64 s[86:87], -1, 0
 ds_read_b128 a[80:83], v7 offset:53248
 v_cvt_pk_bf16_f32 v57, v20, v21
M v[104:107], a[124:127], a[28:31], v[104:107]
 s_cmp_eq_u32 s20, 2
 ds_read_b128 a[84:87], v7 offset:54272
 v_add_f32 v26, v21, v26
M v[108:111], a[124:127], a[60:63], v[36:39]
 s_cselect_b64 s[80:81], s[16:17], s[86:87]
 v_exp_f32 v23, v89
M v[108:111], a[120:123], a[56:59], v[108:111]
 s_cselect_b64 s[82:83], s[18:19], s[86:87]
 ds_read_b128 a[88:91], v7 offset:55296
 v_add_f32 v26, v22, v26
M v[108:111], a[116:119], a[52:55], v[108:111]
 s_cselect_b64 s[84:85], s[48:49], s[86:87]
 ds_read_b128 a[92:95], v7 offset:56320
 v_cvt_pk_bf16_f32 v58, v22, v23
M v[108:111], a[112:115], a[48:51], v[108:111]
 buffer_load_dwordx4 v4, s[8:11], s21 offen offset:1024 sc1 lds
M v[108:111], a[108:111], a[44:47], v[108:111]
 s_cselect_b64 s[86:87], s[50:51], s[86:87]
 v_exp_f32 v24, v90
M v[108:111], a[104:107], a[40:43], v[108:111]
 s_cmp_eq_u32 s20, 3
 v_exp_f32 v25, v91
M v[108:111], a[100:103], a[36:39], v[108:111]
 buffer_load_dwordx4 v4, s[8:11], s21 offen offset:2048 sc1 lds
M v[108:111], a[96:99], a[32:35], v[108:111]
 s_waitcnt lgkmcnt(0)
 v_exp_f32 v18, v84
M v[112:115], a[64:67], a[0:3], v[32:35]
 s_cselect_b64 s[88:89], s[16:17], -1
 ds_read_b128 a[96:99], v7 offset:57344
 v_add_f32 v26, v23, v26
M v[112:115], a[68:71], a[4:7], v[112:115]
 s_cselect_b64 s[90:91], s[18:19], -1
 ds_read_b128 a[100:103], v7 offset:58368
 v_add_f32 v26, v24, v26
M v[112:115], a[72:75], a[8:11], v[112:115]
 s_cselect_b64 s[92:93], s[48:49], -1
 v_exp_f32 v19, v85
M v[112:115], a[76:79], a[12:15], v[112:115]
 s_cselect_b64 s[94:95], s[50:51], -1
 ds_read_b128 a[104:107], v7 offset:59392
 v_cvt_pk_bf16_f32 v59, v24, v25
M v[112:115], a[80:83], a[16:19], v[112:115]
 ds_read_b128 a[108:111], v7 offset:60416
 v_add_f32 v26, v25, v26
M v[112:115], a[84:87], a[20:23], v[112:115]
 buffer_load_dwordx4 v4, s[8:11], s21 offen offset:3072 sc1 lds
M v[112:115], a[88:91], a[24:27], v[112:115]
 s_add_u32 s24, s23, 16777216
 ds_read_b128 a[112:115], v7 offset:61440
 v_add_f32 v27, v18, v27
M v[112:115], a[92:95], a[28:31], v[112:115]
 s_mov_b32 s23, s21
 ds_read_b128 a[116:119], v7 offset:62464
 v_cvt_pk_bf16_f32 v60, v18, v19
M v[116:119], a[92:95], a[60:63], v[36:39]
 s_add_u32 s21, s21, 32768
 v_exp_f32 v20, v86
M v[116:119], a[88:91], a[56:59], v[116:119]
 s_add_u32 s22, s22, 1
 ds_read_b128 a[120:123], v7 offset:63488
 v_add_f32 v27, v19, v27
M v[116:119], a[84:87], a[52:55], v[116:119]
 s_cmp_eq_u32 s22, s25
 ds_read_b128 a[124:127], v7 offset:64512
M v[116:119], a[80:83], a[48:51], v[116:119]
 s_cselect_b32 s21, s26, s21
 v_exp_f32 v21, v87
M v[116:119], a[76:79], a[44:47], v[116:119]
 s_cmp_eq_u32 s22, s43
 v_exp_f32 v22, v92
M v[116:119], a[72:75], a[40:43], v[116:119]
 s_cselect_b32 s21, s4, s21
 v_exp_f32 v23, v93
M v[116:119], a[68:71], a[36:39], v[116:119]
 s_waitcnt vmcnt(9) lgkmcnt(0)
 v_add_f32 v27, v20, v27
 v_cvt_pk_bf16_f32 v61, v20, v21
M v[116:119], a[64:67], a[32:35], v[116:119]
 s_barrier
M v[120:123], a[96:99], a[0:3], v[32:35]
 s_cmp_eq_u32 s22, s6
 ds_read_b128 a[64:67], v2 offset:0
 v_add_f32 v27, v21, v27
M v[120:123], a[100:103], a[4:7], v[120:123]
 s_cselect_b32 s21, s7, s21
 ds_read_b128 a[68:71], v2 offset:1024
 v_add_f32 v27, v22, v27
M v[120:123], a[104:107], a[8:11], v[120:123]
 v_exp_f32 v24, v94
M v[120:123], a[108:111], a[12:15], v[120:123]
 ds_read_b128 a[72:75], v2 offset:2048
 v_cvt_pk_bf16_f32 v62, v22, v23
M v[120:123], a[112:115], a[16:19], v[120:123]
 ds_read_b128 a[76:79], v2 offset:3072
 v_add_f32 v27, v23, v27
M v[120:123], a[116:119], a[20:23], v[120:123]
 v_exp_f32 v25, v95
M v[120:123], a[120:123], a[24:27], v[120:123]
 ds_read_b128 a[80:83], v2 offset:4096
 v_add_f32 v27, v24, v27
M v[120:123], a[124:127], a[28:31], v[120:123]
 ds_read_b128 a[84:87], v2 offset:5120
 v_cvt_pk_bf16_f32 v63, v24, v25
M v[124:127], a[124:127], a[60:63], v[36:39]
 v_add_f32 v27, v25, v27
M v[124:127], a[120:123], a[56:59], v[124:127]
 ds_read_b128 a[88:91], v2 offset:6144
 v_max_f32 v10, v26, v27
M v[124:127], a[116:119], a[52:55], v[124:127]
 ds_read_b128 a[92:95], v2 offset:7168
 v_min_f32 v11, v26, v27
M v[124:127], a[112:115], a[48:51], v[124:127]
 v_cmp_lt_f32 s[36:37], s31, v10
M v[124:127], a[108:111], a[44:47], v[124:127]
 v_cmp_gt_f32 vcc, s55, v11
M v[124:127], a[104:107], a[40:43], v[124:127]
M v[124:127], a[100:103], a[36:39], v[124:127]
 s_waitcnt lgkmcnt(0)
 s_or_b64 vcc, vcc, s[36:37]
M v[124:127], a[96:99], a[32:35], v[124:127]
 s_cbranch_vccnz L_st10
L_rt10:
M v[128:131], a[64:67], v[40:43], 0
 s_add_u32 m0, s28, 0
 ds_read_b128 a[96:99], v2 offset:8192
 ds_read_b128 a[100:103], v2 offset:9216
M v[128:131], a[68:71], v[56:59], v[128:131]
 buffer_load_dwordx4 v3, s[8:11], s24 offen offset:0 sc1 lds
M v[132:135], a[68:71], v[60:63], 0
 v_exp_f32 v18, v96
M v[132:135], a[64:67], v[44:47], v[132:135]
 ds_read_b128 a[104:107], v2 offset:10240
 ds_read_b128 a[108:111], v2 offset:11264
M v[136:139], a[72:75], v[40:43], 0
 buffer_load_dwordx4 v3, s[8:11], s24 offen offset:1024 sc1 lds
M v[136:139], a[76:79], v[56:59], v[136:139]
 v_exp_f32 v19, v97
M v[140:143], a[76:79], v[60:63], 0
 ds_read_b128 a[112:115], v2 offset:12288
 ds_read_b128 a[116:119], v2 offset:13312
M v[140:143], a[72:75], v[44:47], v[140:143]
 buffer_load_dwordx4 v3, s[8:11], s24 offen offset:2048 sc1 lds
M v[144:147], a[80:83], v[40:43], 0
 v_exp_f32 v20, v98
M v[144:147], a[84:87], v[56:59], v[144:147]
 ds_read_b128 a[120:123], v2 offset:14336
 ds_read_b128 a[124:127], v2 offset:15360
M v[148:151], a[84:87], v[60:63], 0
 buffer_load_dwordx4 v3, s[8:11], s24 offen offset:3072 sc1 lds
M v[148:151], a[80:83], v[44:47], v[148:151]
 s_add_u32 m0, s28, 4096
 v_exp_f32 v21, v99
M v[152:155], a[88:91], v[40:43], 0
 buffer_load_dwordx4 v4, s[8:11], s24 offen offset:0 sc1 lds
M v[152:155], a[92:95], v[56:59], v[152:155]
 v_add_f32 v30, v26, v30
 v_add_f32 v31, v27, v31
M v[156:159], a[92:95], v[60:63], 0
 v_exp_f32 v22, v104
M v[156:159], a[88:91], v[44:47], v[156:159]
 s_waitcnt lgkmcnt(0)
 v_add_f32 v28, v18, v19
 v_cvt_pk_bf16_f32 v48, v18, v19
M v[160:163], a[96:99], v[40:43], 0
 ds_read_b128 a[64:67], v2 offset:16384
 ds_read_b128 a[68:71], v2 offset:17408
M v[160:163], a[100:103], v[56:59], v[160:163]
 buffer_load_dwordx4 v4, s[8:11], s24 offen offset:1024 sc1 lds
M v[164:167], a[100:103], v[60:63], 0
 v_exp_f32 v23, v105
M v[164:167], a[96:99], v[44:47], v[164:167]
 ds_read_b128 a[72:75], v2 offset:18432
 ds_read_b128 a[76:79], v2 offset:19456
M v[168:171], a[104:107], v[40:43], 0
 buffer_load_dwordx4 v4, s[8:11], s24 offen offset:2048 sc1 lds
M v[168:171], a[108:111], v[56:59], v[168:171]
 v_add_f32 v28, v20, v28
 v_cvt_pk_bf16_f32 v49, v20, v21
M v[172:175], a[108:111], v[60:63], 0
 ds_read_b128 a[80:83], v2 offset:20480
 ds_read_b128 a[84:87], v2 offset:21504
M v[172:175], a[104:107], v[44:47], v[172:175]
 buffer_load_dwordx4 v4, s[8:11], s24 offen offset:3072 sc1 lds
M v[176:179], a[112:115], v[40:43], 0
 v_exp_f32 v24, v106
M v[176:179], a[116:119], v[56:59], v[176:179]
 s_add_u32 m0, s28, 32768
 ds_read_b128 a[88:91], v2 offset:22528
 ds_read_b128 a[92:95], v2 offset:23552
M v[180:183], a[116:119], v[60:63], 0
 buffer_load_dwordx4 v3, s[8:11], s21 offen offset:0 sc1 lds
M v[180:183], a[112:115], v[44:47], v[180:183]
 v_exp_f32 v25, v107
M v[184:187], a[120:123], v[40:43], 0
 buffer_load_dwordx4 v3, s[8:11], s21 offen offset:1024 sc1 lds
M v[184:187], a[124:127], v[56:59], v[184:187]
 v_exp_f32 v18, v100
M v[188:191], a[124:127], v[60:63], 0
 buffer_load_dwordx4 v3, s[8:11], s21 offen offset:2048 sc1 lds
M v[188:191], a[120:123], v[44:47], v[188:191]
 s_waitcnt lgkmcnt(0)
 v_add_f32 v28, v21, v28
 v_add_f32 v28, v22, v28
M v[192:195], a[64:67], v[40:43], 0
 ds_read_b128 a[96:99], v2 offset:24576
 ds_read_b128 a[100:103], v2 offset:25600
M v[192:195], a[68:71], v[56:59], v[192:195]
 buffer_load_dwordx4 v3, s[8:11], s21 offen offset:3072 sc1 lds
M v[196:199], a[68:71], v[60:63], 0
 v_exp_f32 v19, v101
M v[196:199], a[64:67], v[44:47], v[196:199]
 s_add_u32 m0, s28, 36864
 ds_read_b128 a[104:107], v2 offset:26624
 ds_read_b128 a[108:111], v2 offset:27648
M v[200:203], a[72:75], v[40:43], 0
 buffer_load_dwordx4 v4, s[8:11], s21 offen offset:0 sc1 lds
M v[200:203], a[76:79], v[56:59], v[200:203]
 v_exp_f32 v20, v102
M v[204:207], a[76:79], v[60:63], 0
 ds_read_b128 a[112:115], v2 offset:28672
 ds_read_b128 a[116:119], v2 offset:29696
M v[204:207], a[72:75], v[44:47], v[204:207]
 buffer_load_dwordx4 v4, s[8:11], s21 offen offset:1024 sc1 lds
M v[208:211], a[80:83], v[40:43], 0
 v_exp_f32 v21, v103
M v[208:211], a[84:87], v[56:59], v[208:211]
 ds_read_b128 a[120:123], v2 offset:30720
 ds_read_b128 a[124:127], v2 offset:31744
M v[212:215], a[84:87], v[60:63], 0
 buffer_load_dwordx4 v4, s[8:11], s21 offen offset:2048 sc1 lds
M v[212:215], a[80:83], v[44:47], v[212:215]
 v_cvt_pk_bf16_f32 v50, v22, v23
 v_add_f32 v28, v23, v28
M v[216:219], a[88:91], v[40:43], 0
 v_exp_f32 v22, v108
M v[216:219], a[92:95], v[56:59], v[216:219]
 buffer_load_dwordx4 v4, s[8:11], s21 offen offset:3072 sc1 lds
M v[220:223], a[92:95], v[60:63], 0
 s_waitcnt vmcnt(16) lgkmcnt(0)
 s_add_u32 s24, s23, 16777216
 s_mov_b32 s23, s21
M v[220:223], a[88:91], v[44:47], v[220:223]
 s_barrier
M v[224:227], a[96:99], v[40:43], 0
 ds_read_b128 a[64:67], v2 offset:32768
 ds_read_b128 a[68:71], v2 offset:33792
M v[224:227], a[100:103], v[56:59], v[224:227]
 s_add_u32 s21, s21, 32768
 v_add_f32 v28, v24, v28
M v[228:231], a[100:103], v[60:63], 0
 s_add_u32 s22, s22, 1
 v_exp_f32 v23, v109
M v[228:231], a[96:99], v[44:47], v[228:231]
 s_cmp_eq_u32 s22, s25
 ds_read_b128 a[72:75], v2 offset:34816
 ds_read_b128 a[76:79], v2 offset:35840
M v[232:235], a[104:107], v[40:43], 0
 s_cselect_b32 s21, s26, s21
 v_cvt_pk_bf16_f32 v51, v24, v25
 v_add_f32 v28, v25, v28
M v[232:235], a[108:111], v[56:59], v[232:235]
 s_cmp_eq_u32 s22, s43
 v_exp_f32 v24, v110
M v[236:239], a[108:111], v[60:63], 0
 s_cselect_b32 s21, s4, s21
 ds_read_b128 a[80:83], v2 offset:36864
 ds_read_b128 a[84:87], v2 offset:37888
M v[236:239], a[104:107], v[44:47], v[236:239]
 s_cmp_eq_u32 s22, s6
 v_exp_f32 v25, v111
M v[240:243], a[112:115], v[40:43], 0
 s_cselect_b32 s21, s7, s21
 v_add_f32 v29, v18, v19
 v_cvt_pk_bf16_f32 v52, v18, v19
M v[240:243], a[116:119], v[56:59], v[240:243]
 ds_read_b128 a[88:91], v2 offset:38912
 ds_read_b128 a[92:95], v2 offset:39936
M v[244:247], a[116:119], v[60:63], 0
 v_add_f32 v29, v20, v29
 v_cvt_pk_bf16_f32 v53, v20, v21
M v[244:247], a[112:115], v[44:47], v[244:247]
 v_add_f32 v29, v21, v29
 v_add_f32 v29, v22, v29
M v[248:251], a[120:123], v[40:43], 0
 v_cvt_pk_bf16_f32 v54, v22, v23
 v_add_f32 v29, v23, v29
M v[248:251], a[124:127], v[56:59], v[248:251]
 s_cmp_lg_u32 s27, 0
 v_add_f32 v29, v24, v29
 v_cvt_pk_bf16_f32 v55, v24, v25
M v[252:255], a[124:127], v[60:63], 0
 s_waitcnt lgkmcnt(0)
 v_add_f32 v29, v25, v29
M v[252:255], a[120:123], v[44:47], v[252:255]
 s_cbranch_scc1 L_loop_top
 s_branch L_p1
L_j0:
 s_cmp_eq_u32 s20, 0
 s_cselect_b64 s[64:65], s[16:17], 0
 s_cselect_b64 s[66:67], s[18:19], 0
 s_cselect_b64 s[68:69], s[48:49], 0
 s_cselect_b64 s[70:71], s[50:51], 0
 s_cmp_lt_u32 s20, 1
 s_cselect_b64 s[78:79], -1, 0
 s_cmp_eq_u32 s20, 1
 s_cselect_b64 s[72:73], s[16:17], s[78:79]
 s_cselect_b64 s[74:75], s[18:19], s[78:79]
 s_cselect_b64 s[76:77], s[48:49], s[78:79]
 s_cselect_b64 s[78:79], s[50:51], s[78:79]
 s_cmp_lt_u32 s20, 2
 s_cselect_b64 s[86:87], -1, 0
 s_cmp_eq_u32 s20, 2
 s_cselect_b64 s[80:81], s[16:17], s[86:87]
 s_cselect_b64 s[82:83], s[18:19], s[86:87]
 s_cselect_b64 s[84:85], s[48:49], s[86:87]
 s_cselect_b64 s[86:87], s[50:51], s[86:87]
 s_cmp_eq_u32 s20, 3
 s_cselect_b64 s[88:89], s[16:17], -1
 s_cselect_b64 s[90:91], s[18:19], -1
 s_cselect_b64 s[92:93], s[48:49], -1
 s_cselect_b64 s[94:95], s[50:51], -1
 v_mov_b32 v56, 0
 v_mov_b32 v57, 0
 v_mov_b32 v58, 0
 v_mov_b32 v59, 0
 v_accvgpr_write_b32 a242, 0
 v_accvgpr_write_b32 a243, 0
 v_cndmask_b32 v64, v64, v8, s[64:65]
 v_cndmask_b32 v65, v65, v8, s[66:67]
 v_cndmask_b32 v66, v66, v8, s[68:69]
 v_cndmask_b32 v67, v67, v8, s[70:71]
 v_cndmask_b32 v72, v72, v8, s[72:73]
 v_cndmask_b32 v73, v73, v8, s[74:75]
 v_cndmask_b32 v74, v74, v8, s[76:77]
 v_cndmask_b32 v75, v75, v8, s[78:79]
 v_cndmask_b32 v80, v80, v8, s[80:81]
 v_cndmask_b32 v81, v81, v8, s[82:83]
 v_cndmask_b32 v82, v82, v8, s[84:85]
 v_cndmask_b32 v83, v83, v8, s[86:87]
 v_cndmask_b32 v88, v88, v8, s[88:89]
 v_cndmask_b32 v89, v89, v8, s[90:91]
 v_cndmask_b32 v90, v90, v8, s[92:93]
 v_cndmask_b32 v91, v91, v8, s[94:95]
 s_cmp_eq_u32 s20, 3
 s_cselect_b64 s[64:65], s[16:17], 0
 s_cselect_b64 s[66:67], s[18:19], 0
 s_cselect_b64 s[68:69], s[48:49], 0
 s_cselect_b64 s[70:71], s[50:51], 0
 s_cmp_gt_u32 s20, 2
 s_cselect_b64 s[78:79], -1, 0
 s_cmp_eq_u32 s20, 2
 s_cselect_b64 s[72:73], s[16:17], s[78:79]
 s_cselect_b64 s[74:75], s[18:19], s[78:79]
 s_cselect_b64 s[76:77], s[48:49], s[78:79]
 s_cselect_b64 s[78:79], s[50:51], s[78:79]
 s_cmp_gt_u32 s20, 1
 s_cselect_b64 s[86:87], -1, 0
 s_cmp_eq_u32 s20, 1
 s_cselect_b64 s[80:81], s[16:17], s[86:87]
 s_cselect_b64 s[82:83], s[18:19], s[86:87]
 s_cselect_b64 s[84:85], s[48:49], s[86:87]
 s_cselect_b64 s[86:87], s[50:51], s[86:87]
 s_cmp_eq_u32 s20, 0
 s_cselect_b64 s[88:89], s[16:17], -1
 s_cselect_b64 s[90:91], s[18:19], -1
 s_cselect_b64 s[92:93], s[48:49], -1
 s_cselect_b64 s[94:95], s[50:51], -1
 s_add_u32 m0, s28, 98304
 v_max3_f32 v10, v64, v65, v66
 buffer_load_dwordx4 v3, s[8:11], s21 offen offset:0 sc1 lds
 v_max3_f32 v10, v67, v72, v10
 v_max3_f32 v10, v73, v74, v10
 v_max3_f32 v10, v75, v80, v10
 v_max3_f32 v10, v81, v82, v10
 v_max3_f32 v10, v83, v88, v10
 v_max3_f32 v10, v89, v90, v10
 v_max_f32 v10, v91, v10
 v_max3_f32 v11, v68, v69, v70
 v_max3_f32 v11, v71, v76, v11
 v_max3_f32 v11, v77, v78, v11
 v_max3_f32 v11, v79, v84, v11
 v_mfma_f32_32x32x16_bf16 v[128:143], v[56:59], v[56:59], 0
 buffer_load_dwordx4 v3, s[8:11], s21 offen offset:1024 sc1 lds
 v_max3_f32 v11, v85, v86, v11
 v_max3_f32 v11, v87, v92, v11
 v_max3_f32 v11, v93, v94, v11
 v_max_f32 v11, v95, v11
 v_mov_b32 v12, v10
 v_mov_b32 v13, v11
 s_nop 0
 v_permlane16_swap_b32 v12, v10
 v_permlane16_swap_b32 v13, v11
 v_max_f32 v10, v12, v10
 v_max_f32 v11, v13, v11
 v_mov_b32 v12, v10
 buffer_load_dwordx4 v3, s[8:11], s21 offen offset:2048 sc1 lds
 v_mov_b32 v13, v11
 v_mfma_f32_32x32x16_bf16 v[144:159], v[56:59], v[56:59], 0
 v_permlane32_swap_b32 v12, v10
 v_permlane32_swap_b32 v13, v11
 v_max_f32 v10, v12, v10
 v_max_f32 v11, v13, v11
 v_ceil_f32 v10, v10
 v_ceil_f32 v11, v11
 v_sub_f32 v32, v32, v10
 v_sub_f32 v33, v33, v10
 v_sub_f32 v34, v34, v10
 v_sub_f32 v35, v35, v10
 buffer_load_dwordx4 v3, s[8:11], s21 offen offset:3072 sc1 lds
 v_sub_f32 v36, v36, v11
 v_sub_f32 v37, v37, v11
 v_sub_f32 v38, v38, v11
 v_mfma_f32_32x32x16_bf16 v[160:175], v[56:59], v[56:59], 0
 v_sub_f32 v39, v39, v11
 v_sub_f32 v64, v64, v10
 v_sub_f32 v65, v65, v10
 v_sub_f32 v66, v66, v10
 v_sub_f32 v67, v67, v10
 v_sub_f32 v68, v68, v11
 v_sub_f32 v69, v69, v11
 s_add_u32 m0, s28, 102400
 v_sub_f32 v70, v70, v11
 buffer_load_dwordx4 v4, s[8:11], s21 offen offset:0 sc1 lds
 v_sub_f32 v71, v71, v11
 v_sub_f32 v72, v72, v10
 v_sub_f32 v73, v73, v10
 v_sub_f32 v74, v74, v10
 v_mfma_f32_32x32x16_bf16 v[176:191], v[56:59], v[56:59], 0
 v_sub_f32 v75, v75, v10
 v_sub_f32 v76, v76, v11
 v_sub_f32 v77, v77, v11
 v_sub_f32 v78, v78, v11
 v_sub_f32 v79, v79, v11
 v_sub_f32 v80, v80, v10
 v_sub_f32 v81, v81, v10
 buffer_load_dwordx4 v4, s[8:11], s21 offen offset:1024 sc1 lds
 v_sub_f32 v82, v82, v10
 v_sub_f32 v83, v83, v10
 v_sub_f32 v84, v84, v11
 v_sub_f32 v85, v85, v11
 v_sub_f32 v86, v86, v11
 v_sub_f32 v87, v87, v11
 v_mfma_f32_32x32x16_bf16 v[192:207], v[56:59], v[56:59], 0
 v_sub_f32 v88, v88, v10
 v_sub_f32 v89, v89, v10
 v_sub_f32 v90, v90, v10
 v_sub_f32 v91, v91, v10
 v_sub_f32 v92, v92, v11
 buffer_load_dwordx4 v4, s[8:11], s21 offen offset:2048 sc1 lds
 v_sub_f32 v93, v93, v11
 v_sub_f32 v94, v94, v11
 v_sub_f32 v95, v95, v11
 v_exp_f32 v18, v64
 v_exp_f32 v19, v65
 v_exp_f32 v20, v66
 v_add_f32 v26, v18, v19
 v_cvt_pk_bf16_f32 v40, v18, v19
 v_mfma_f32_32x32x16_bf16 v[208:223], v[56:59], v[56:59], 0
 v_exp_f32 v21, v67
 v_exp_f32 v22, v72
 v_add_f32 v26, v20, v26
 buffer_load_dwordx4 v4, s[8:11], s21 offen offset:3072 sc1 lds
 v_cvt_pk_bf16_f32 v41, v20, v21
 v_exp_f32 v23, v73
 v_add_f32 v26, v21, v26
 v_exp_f32 v24, v74
 v_add_f32 v26, v22, v26
 v_cvt_pk_bf16_f32 v42, v22, v23
 v_exp_f32 v25, v75
 v_add_f32 v26, v23, v26
 v_exp_f32 v18, v68
 v_add_f32 v26, v24, v26
 v_mfma_f32_32x32x16_bf16 v[224:239], v[56:59], v[56:59], 0
 s_add_u32 s24, s23, 16777216
 s_mov_b32 s23, s21
 s_add_u32 s21, s21, 32768
 s_add_u32 s22, s22, 1
 s_cmp_eq_u32 s22, s25
 s_cselect_b32 s21, s26, s21
 s_cmp_eq_u32 s22, s43
 s_cselect_b32 s21, s4, s21
 s_cmp_eq_u32 s22, s6
 s_cselect_b32 s21, s7, s21
 v_cvt_pk_bf16_f32 v43, v24, v25
 buffer_load_dword v5, off, s[8:11], s47 sc1
 v_exp_f32 v19, v69
 v_add_f32 v26, v25, v26
 v_mfma_f32_32x32x16_bf16 v[240:255], v[56:59], v[56:59], 0
 v_exp_f32 v20, v70
 v_add_f32 v27, v18, v19
 v_cvt_pk_bf16_f32 v44, v18, v19
 v_exp_f32 v21, v71
 v_exp_f32 v22, v76
 v_add_f32 v27, v20, v27
 v_cvt_pk_bf16_f32 v45, v20, v21
 v_exp_f32 v23, v77
 v_add_f32 v27, v21, v27
 v_exp_f32 v24, v78
 v_add_f32 v27, v22, v27
 v_cvt_pk_bf16_f32 v46, v22, v23
 v_exp_f32 v25, v79
 v_add_f32 v27, v23, v27
 v_add_f32 v27, v24, v27
 v_cvt_pk_bf16_f32 v47, v24, v25
 v_add_f32 v27, v25, v27
 v_cndmask_b32 v100, v36, v8, s[64:65]
 v_cndmask_b32 v101, v36, v8, s[66:67]
 v_cndmask_b32 v102, v36, v8, s[68:69]
 v_cndmask_b32 v103, v36, v8, s[70:71]
 v_cndmask_b32 v108, v36, v8, s[72:73]
 v_cndmask_b32 v109, v36, v8, s[74:75]
 v_cndmask_b32 v110, v36, v8, s[76:77]
 v_cndmask_b32 v111, v36, v8, s[78:79]
 v_cndmask_b32 v116, v36, v8, s[80:81]
 v_cndmask_b32 v117, v36, v8, s[82:83]
 v_cndmask_b32 v118, v36, v8, s[84:85]
 v_cndmask_b32 v119, v36, v8, s[86:87]
 v_cndmask_b32 v124, v36, v8, s[88:89]
 v_cndmask_b32 v125, v36, v8, s[90:91]
 v_cndmask_b32 v126, v36, v8, s[92:93]
 v_cndmask_b32 v127, v36, v8, s[94:95]
 s_branch L_p2
L_kv1:
 s_mov_b32 s60, s90
 s_and_b32 s61, s91, 0xffff
 s_mov_b32 s62, 3670016
 s_mov_b32 s63, 0x20000
 s_waitcnt vmcnt(4) lgkmcnt(0)
 s_barrier
 ds_read_b128 a[160:163], v5 offset:0
 ds_read_b128 a[164:167], v6 offset:0
 ds_read_b64_tr_b16 a[32:33], v1 offset:0
 ds_read_b64_tr_b16 a[34:35], v1 offset:1024
 ds_read_b64_tr_b16 a[36:37], v1 offset:8192
 ds_read_b64_tr_b16 a[38:39], v1 offset:9216
 ds_read_b64_tr_b16 a[40:41], v2 offset:0
 ds_read_b64_tr_b16 a[42:43], v2 offset:1024
 ds_read_b64_tr_b16 a[44:45], v2 offset:8192
 ds_read_b64_tr_b16 a[46:47], v2 offset:9216
 ds_read_b128 a[168:171], v5 offset:2048
 ds_read_b128 a[172:175], v6 offset:2048
 ds_read_b64_tr_b16 a[48:49], v3 offset:0
 ds_read_b64_tr_b16 a[50:51], v3 offset:1024
 ds_read_b64_tr_b16 a[52:53], v3 offset:8192
 ds_read_b64_tr_b16 a[54:55], v3 offset:9216
 ds_read_b64_tr_b16 a[56:57], v4 offset:0
 ds_read_b64_tr_b16 a[58:59], v4 offset:1024
 ds_read_b64_tr_b16 a[60:61], v4 offset:8192
 ds_read_b64_tr_b16 a[62:63], v4 offset:9216
 ds_read_b128 a[176:179], v5 offset:4096
 ds_read_b128 a[180:183], v6 offset:4096
 ds_read_b128 a[184:187], v5 offset:6144
 ds_read_b128 a[188:191], v6 offset:6144
 s_add_u32 m0, s24, 16384
 s_nop 0
 buffer_load_dwordx4 v12, s[48:51], s22 offen offset:0   lds
 buffer_load_dwordx4 v13, s[48:51], s22 offen offset:1024   lds
 buffer_load_dwordx4 v14, s[48:51], s22 offen offset:2048   lds
 buffer_load_dwordx4 v15, s[48:51], s22 offen offset:3072   lds
 s_sub_u32 s22, s22, 2097024
 s_add_u32 m0, s23, 32768
 s_nop 0
 buffer_load_dwordx4 v8, s[16:19], s21 offen offset:0  nt lds
 buffer_load_dwordx4 v9, s[16:19], s21 offen offset:1024  nt lds
 buffer_load_dwordx4 v10, s[16:19], s21 offen offset:2048  nt lds
 buffer_load_dwordx4 v11, s[16:19], s21 offen offset:3072  nt lds
 s_add_u32 s21, s21, 128
 s_waitcnt lgkmcnt(15)
M a[0:3], a[32:35], a[160:163], 0
M a[0:3], a[36:39], a[164:167], a[0:3]
 s_waitcnt lgkmcnt(14)
M a[4:7], a[44:47], a[164:167], 0
M a[4:7], a[40:43], a[160:163], a[4:7]
 s_waitcnt lgkmcnt(8)
M a[8:11], a[48:51], a[160:163], 0
M a[8:11], a[52:55], a[164:167], a[8:11]
 s_waitcnt lgkmcnt(4)
M a[12:15], a[60:63], a[164:167], 0
 s_add_u32 m0, s23, 49152
M a[12:15], a[56:59], a[160:163], a[12:15]
 buffer_load_dwordx4 v8, s[16:19], s21 offen offset:0  nt lds
M v[32:35], a[32:35], a[168:171], 0
 buffer_load_dwordx4 v9, s[16:19], s21 offen offset:1024  nt lds
M v[32:35], a[36:39], a[172:175], v[32:35]
M v[36:39], a[44:47], a[172:175], 0
 buffer_load_dwordx4 v10, s[16:19], s21 offen offset:2048  nt lds
M v[36:39], a[40:43], a[168:171], v[36:39]
M v[40:43], a[48:51], a[168:171], 0
 buffer_load_dwordx4 v11, s[16:19], s21 offen offset:3072  nt lds
M v[40:43], a[52:55], a[172:175], v[40:43]
 s_add_u32 s21, s21, 524160
M v[44:47], a[60:63], a[172:175], 0
 s_waitcnt vmcnt(12) lgkmcnt(0)
M v[44:47], a[56:59], a[168:171], v[44:47]
 s_barrier
M v[64:67], a[32:35], a[176:179], 0
 s_add_u32 m0, s24, 32768
 ds_read_b64_tr_b16 a[64:65], v1 offset:16384
 ds_read_b64_tr_b16 a[66:67], v1 offset:17408
M v[64:67], a[36:39], a[180:183], v[64:67]
 ds_read_b64_tr_b16 a[68:69], v1 offset:24576
 ds_read_b64_tr_b16 a[70:71], v1 offset:25600
M v[68:71], a[44:47], a[180:183], 0
 buffer_load_dwordx4 v12, s[48:51], s22 offen offset:0   lds
M v[68:71], a[40:43], a[176:179], v[68:71]
 ds_read_b64_tr_b16 a[72:73], v2 offset:16384
 ds_read_b64_tr_b16 a[74:75], v2 offset:17408
M v[72:75], a[48:51], a[176:179], 0
 ds_read_b64_tr_b16 a[76:77], v2 offset:24576
 ds_read_b64_tr_b16 a[78:79], v2 offset:25600
M v[72:75], a[52:55], a[180:183], v[72:75]
 buffer_load_dwordx4 v13, s[48:51], s22 offen offset:1024   lds
M v[76:79], a[60:63], a[180:183], 0
 ds_read_b64_tr_b16 a[80:81], v3 offset:16384
 ds_read_b64_tr_b16 a[82:83], v3 offset:17408
M v[76:79], a[56:59], a[176:179], v[76:79]
 ds_read_b64_tr_b16 a[84:85], v3 offset:24576
 ds_read_b64_tr_b16 a[86:87], v3 offset:25600
M v[96:99], a[32:35], a[184:187], 0
 buffer_load_dwordx4 v14, s[48:51], s22 offen offset:2048   lds
M v[96:99], a[36:39], a[188:191], v[96:99]
 ds_read_b64_tr_b16 a[88:89], v4 offset:16384
 ds_read_b64_tr_b16 a[90:91], v4 offset:17408
M v[100:103], a[44:47], a[188:191], 0
 ds_read_b64_tr_b16 a[92:93], v4 offset:24576
 ds_read_b64_tr_b16 a[94:95], v4 offset:25600
M v[100:103], a[40:43], a[184:187], v[100:103]
 buffer_load_dwordx4 v15, s[48:51], s22 offen offset:3072   lds
M v[104:107], a[48:51], a[184:187], 0
 s_add_u32 s22, s22, 2097152
 v_max3_f32 v20, |v32|, |v33|, |v34|
 v_max3_f32 v20, |v35|, |v36|, v20
M v[104:107], a[52:55], a[188:191], v[104:107]
 v_max3_f32 v20, |v37|, |v38|, v20
 v_max3_f32 v21, |v64|, |v65|, |v66|
M v[108:111], a[60:63], a[188:191], 0
 s_add_u32 m0, s23, 0
 v_max3_f32 v21, |v67|, |v68|, v21
 v_max3_f32 v21, |v69|, |v70|, v21
M v[108:111], a[56:59], a[184:187], v[108:111]
 s_waitcnt lgkmcnt(0)
 v_min_f32 v20, v20, v21
 v_mul_f32 v20, 0x41000000, v20
M a[16:19], a[64:67], a[160:163], 0
 buffer_load_dwordx4 v8, s[16:19], s21 offen offset:0  nt lds
M a[16:19], a[68:71], a[164:167], a[16:19]
 v_mov_b32 v21, v20
 v_mov_b32 v22, v20
M a[20:23], a[76:79], a[164:167], 0
 buffer_load_dwordx4 v9, s[16:19], s21 offen offset:1024  nt lds
M a[20:23], a[72:75], a[160:163], a[20:23]
 v_mov_b32 v23, v20
 v_accvgpr_write_b32 a241, v20
M a[24:27], a[80:83], a[160:163], 0
M a[24:27], a[84:87], a[164:167], a[24:27]
M a[28:31], a[92:95], a[164:167], 0
 buffer_load_dwordx4 v10, s[16:19], s21 offen offset:2048  nt lds
M a[28:31], a[88:91], a[160:163], a[28:31]
M v[48:51], a[64:67], a[168:171], v[20:23]
M v[48:51], a[68:71], a[172:175], v[48:51]
 buffer_load_dwordx4 v11, s[16:19], s21 offen offset:3072  nt lds
M v[52:55], a[76:79], a[172:175], v[20:23]
 s_add_u32 s21, s21, 128
M v[52:55], a[72:75], a[168:171], v[52:55]
M v[56:59], a[80:83], a[168:171], v[20:23]
M v[56:59], a[84:87], a[172:175], v[56:59]
M v[60:63], a[92:95], a[172:175], v[20:23]
 s_waitcnt vmcnt(12)
M v[60:63], a[88:91], a[168:171], v[60:63]
 s_barrier
M v[80:83], a[64:67], a[176:179], v[20:23]
 s_add_u32 m0, s24, 49152
 ds_read_b128 a[160:163], v5 offset:16384
 ds_read_b128 a[164:167], v6 offset:16384
M v[80:83], a[68:71], a[180:183], v[80:83]
 buffer_load_dwordx4 v12, s[48:51], s22 offen offset:0   lds
M v[84:87], a[76:79], a[180:183], v[20:23]
 ds_read_b64_tr_b16 a[96:97], v1 offset:32768
 ds_read_b64_tr_b16 a[98:99], v1 offset:33792
M v[84:87], a[72:75], a[176:179], v[84:87]
M v[88:91], a[80:83], a[176:179], v[20:23]
 buffer_load_dwordx4 v13, s[48:51], s22 offen offset:1024   lds
M v[88:91], a[84:87], a[180:183], v[88:91]
 ds_read_b64_tr_b16 a[100:101], v1 offset:40960
 ds_read_b64_tr_b16 a[102:103], v1 offset:41984
M v[92:95], a[92:95], a[180:183], v[20:23]
M v[92:95], a[88:91], a[176:179], v[92:95]
M v[112:115], a[64:67], a[184:187], v[20:23]
 ds_read_b64_tr_b16 a[104:105], v2 offset:32768
 ds_read_b64_tr_b16 a[106:107], v2 offset:33792
M v[112:115], a[68:71], a[188:191], v[112:115]
 buffer_load_dwordx4 v14, s[48:51], s22 offen offset:2048   lds
M v[116:119], a[76:79], a[188:191], v[20:23]
M v[116:119], a[72:75], a[184:187], v[116:119]
 ds_read_b64_tr_b16 a[108:109], v2 offset:40960
 ds_read_b64_tr_b16 a[110:111], v2 offset:41984
M v[120:123], a[80:83], a[184:187], v[20:23]
 buffer_load_dwordx4 v15, s[48:51], s22 offen offset:3072   lds
M v[120:123], a[84:87], a[188:191], v[120:123]
 s_waitcnt lgkmcnt(8)
M v[124:127], a[92:95], a[188:191], v[20:23]
 s_sub_u32 s22, s22, 2097024
M v[124:127], a[88:91], a[184:187], v[124:127]
 s_add_u32 m0, s23, 16384
 ds_read_b64_tr_b16 a[112:113], v3 offset:32768
 ds_read_b64_tr_b16 a[114:115], v3 offset:33792
M v[128:131], a[32:35], a[160:163], v[20:23]
 ds_read_b128 a[168:171], v5 offset:18432
 ds_read_b128 a[172:175], v6 offset:18432
M v[128:131], a[36:39], a[164:167], v[128:131]
 buffer_load_dwordx4 v8, s[16:19], s21 offen offset:0  nt lds
M v[132:135], a[44:47], a[164:167], v[20:23]
 ds_read_b64_tr_b16 a[116:117], v3 offset:40960
 ds_read_b64_tr_b16 a[118:119], v3 offset:41984
M v[132:135], a[40:43], a[160:163], v[132:135]
 buffer_load_dwordx4 v9, s[16:19], s21 offen offset:1024  nt lds
M v[136:139], a[48:51], a[160:163], v[20:23]
M v[136:139], a[52:55], a[164:167], v[136:139]
 ds_read_b64_tr_b16 a[120:121], v4 offset:32768
 ds_read_b64_tr_b16 a[122:123], v4 offset:33792
M v[140:143], a[60:63], a[164:167], v[20:23]
 buffer_load_dwordx4 v10, s[16:19], s21 offen offset:2048  nt lds
M v[140:143], a[56:59], a[160:163], v[140:143]
M v[144:147], a[64:67], a[160:163], v[20:23]
 ds_read_b64_tr_b16 a[124:125], v4 offset:40960
 ds_read_b64_tr_b16 a[126:127], v4 offset:41984
M v[144:147], a[68:71], a[164:167], v[144:147]
 buffer_load_dwordx4 v11, s[16:19], s21 offen offset:3072  nt lds
M v[148:151], a[76:79], a[164:167], v[20:23]
 s_add_u32 s21, s21, 524160
M v[148:151], a[72:75], a[160:163], v[148:151]
M v[152:155], a[80:83], a[160:163], v[20:23]
M v[152:155], a[84:87], a[164:167], v[152:155]
 s_waitcnt lgkmcnt(6)
M v[156:159], a[92:95], a[164:167], v[20:23]
 s_waitcnt vmcnt(16) lgkmcnt(0)
M v[156:159], a[88:91], a[160:163], v[156:159]
 s_barrier
M v[160:163], a[32:35], a[168:171], v[20:23]
 s_add_u32 m0, s24, 0
 ds_read_b128 a[160:163], v5 offset:20480
 ds_read_b128 a[164:167], v6 offset:20480
M v[160:163], a[36:39], a[172:175], v[160:163]
 buffer_load_dwordx4 v12, s[48:51], s22 offen offset:0   lds
M v[164:167], a[44:47], a[172:175], v[20:23]
 ds_read_b64_tr_b16 a[128:129], v1 offset:49152
 ds_read_b64_tr_b16 a[130:131], v1 offset:50176
M v[164:167], a[40:43], a[168:171], v[164:167]
M v[168:171], a[48:51], a[168:171], v[20:23]
 buffer_load_dwordx4 v13, s[48:51], s22 offen offset:1024   lds
M v[168:171], a[52:55], a[172:175], v[168:171]
 ds_read_b64_tr_b16 a[132:133], v1 offset:57344
 ds_read_b64_tr_b16 a[134:135], v1 offset:58368
M v[172:175], a[60:63], a[172:175], v[20:23]
M v[172:175], a[56:59], a[168:171], v[172:175]
M v[176:179], a[64:67], a[168:171], v[20:23]
 ds_read_b64_tr_b16 a[136:137], v2 offset:49152
 ds_read_b64_tr_b16 a[138:139], v2 offset:50176
M v[176:179], a[68:71], a[172:175], v[176:179]
 buffer_load_dwordx4 v14, s[48:51], s22 offen offset:2048   lds
M v[180:183], a[76:79], a[172:175], v[20:23]
M v[180:183], a[72:75], a[168:171], v[180:183]
 ds_read_b64_tr_b16 a[140:141], v2 offset:57344
 ds_read_b64_tr_b16 a[142:143], v2 offset:58368
M v[184:187], a[80:83], a[168:171], v[20:23]
 buffer_load_dwordx4 v15, s[48:51], s22 offen offset:3072   lds
M v[184:187], a[84:87], a[172:175], v[184:187]
 s_waitcnt lgkmcnt(8)
M v[188:191], a[92:95], a[172:175], v[20:23]
 s_add_u32 s22, s22, 2097152
M v[188:191], a[88:91], a[168:171], v[188:191]
 s_add_u32 m0, s23, 32768
 ds_read_b64_tr_b16 a[144:145], v3 offset:49152
 ds_read_b64_tr_b16 a[146:147], v3 offset:50176
M v[192:195], a[32:35], a[160:163], v[20:23]
 ds_read_b128 a[168:171], v5 offset:22528
 ds_read_b128 a[172:175], v6 offset:22528
M v[192:195], a[36:39], a[164:167], v[192:195]
 buffer_load_dwordx4 v8, s[16:19], s21 offen offset:0  nt lds
M v[196:199], a[44:47], a[164:167], v[20:23]
 ds_read_b64_tr_b16 a[148:149], v3 offset:57344
 ds_read_b64_tr_b16 a[150:151], v3 offset:58368
M v[196:199], a[40:43], a[160:163], v[196:199]
 buffer_load_dwordx4 v9, s[16:19], s21 offen offset:1024  nt lds
M v[200:203], a[48:51], a[160:163], v[20:23]
M v[200:203], a[52:55], a[164:167], v[200:203]
 ds_read_b64_tr_b16 a[152:153], v4 offset:49152
 ds_read_b64_tr_b16 a[154:155], v4 offset:50176
M v[204:207], a[60:63], a[164:167], v[20:23]
 buffer_load_dwordx4 v10, s[16:19], s21 offen offset:2048  nt lds
M v[204:207], a[56:59], a[160:163], v[204:207]
M v[208:211], a[64:67], a[160:163], v[20:23]
 ds_read_b64_tr_b16 a[156:157], v4 offset:57344
 ds_read_b64_tr_b16 a[158:159], v4 offset:58368
M v[208:211], a[68:71], a[164:167], v[208:211]
 buffer_load_dwordx4 v11, s[16:19], s21 offen offset:3072  nt lds
M v[212:215], a[76:79], a[164:167], v[20:23]
 s_add_u32 s21, s21, 128
M v[212:215], a[72:75], a[160:163], v[212:215]
M v[216:219], a[80:83], a[160:163], v[20:23]
M v[216:219], a[84:87], a[164:167], v[216:219]
 s_waitcnt lgkmcnt(6)
M v[220:223], a[92:95], a[164:167], v[20:23]
 s_waitcnt vmcnt(16) lgkmcnt(0)
M v[220:223], a[88:91], a[160:163], v[220:223]
 s_barrier
M v[224:227], a[32:35], a[168:171], v[20:23]
 ds_read_b128 a[160:163], v5 offset:32768
 ds_read_b128 a[164:167], v6 offset:32768
M v[224:227], a[36:39], a[172:175], v[224:227]
 buffer_load_dword a240, v24, s[32:35], 0 offen offset:512
M v[228:231], a[44:47], a[172:175], v[20:23]
M v[228:231], a[40:43], a[168:171], v[228:231]
M v[232:235], a[48:51], a[168:171], v[20:23]
M v[232:235], a[52:55], a[172:175], v[232:235]
M v[236:239], a[60:63], a[172:175], v[20:23]
M v[236:239], a[56:59], a[168:171], v[236:239]
M v[240:243], a[64:67], a[168:171], v[20:23]
M v[240:243], a[68:71], a[172:175], v[240:243]
M v[244:247], a[76:79], a[172:175], v[20:23]
M v[244:247], a[72:75], a[168:171], v[244:247]
M v[248:251], a[80:83], a[168:171], v[20:23]
M v[248:251], a[84:87], a[172:175], v[248:251]
 s_waitcnt lgkmcnt(0)
M v[252:255], a[92:95], a[172:175], v[20:23]
M v[252:255], a[88:91], a[168:171], v[252:255]
M a[0:3], a[96:99], a[160:163], a[0:3]
 ds_read_b128 a[168:171], v5 offset:34816
 ds_read_b128 a[172:175], v6 offset:34816
M a[0:3], a[100:103], a[164:167], a[0:3]
 ds_read_b64_tr_b16 a[32:33], v1 offset:0
 ds_read_b64_tr_b16 a[34:35], v1 offset:1024
M a[4:7], a[108:111], a[164:167], a[4:7]
 s_add_u32 m0, s24, 16384
M a[4:7], a[104:107], a[160:163], a[4:7]
 buffer_load_dwordx4 v12, s[48:51], s22 offen offset:0   lds
M a[8:11], a[112:115], a[160:163], a[8:11]
M a[8:11], a[116:119], a[164:167], a[8:11]
M a[12:15], a[124:127], a[164:167], a[12:15]
 ds_read_b64_tr_b16 a[36:37], v1 offset:8192
 ds_read_b64_tr_b16 a[38:39], v1 offset:9216
M a[12:15], a[120:123], a[160:163], a[12:15]
M a[16:19], a[128:131], a[160:163], a[16:19]
 buffer_load_dwordx4 v13, s[48:51], s22 offen offset:1024   lds
M a[16:19], a[132:135], a[164:167], a[16:19]
M a[20:23], a[140:143], a[164:167], a[20:23]
M a[20:23], a[136:139], a[160:163], a[20:23]
 ds_read_b64_tr_b16 a[40:41], v2 offset:0
 ds_read_b64_tr_b16 a[42:43], v2 offset:1024
M a[24:27], a[144:147], a[160:163], a[24:27]
M a[24:27], a[148:151], a[164:167], a[24:27]
 s_waitcnt lgkmcnt(6)
M a[28:31], a[156:159], a[164:167], a[28:31]
 buffer_load_dwordx4 v14, s[48:51], s22 offen offset:2048   lds
M a[28:31], a[152:155], a[160:163], a[28:31]
M v[32:35], a[96:99], a[168:171], v[32:35]
 ds_read_b128 a[160:163], v5 offset:36864
 ds_read_b128 a[164:167], v6 offset:36864
M v[32:35], a[100:103], a[172:175], v[32:35]
 ds_read_b64_tr_b16 a[44:45], v2 offset:8192
 ds_read_b64_tr_b16 a[46:47], v2 offset:9216
M v[36:39], a[108:111], a[172:175], v[36:39]
 buffer_load_dwordx4 v15, s[48:51], s22 offen offset:3072   lds
M v[36:39], a[104:107], a[168:171], v[36:39]
 s_sub_u32 s22, s22, 2097024
M v[40:43], a[112:115], a[168:171], v[40:43]
M v[40:43], a[116:119], a[172:175], v[40:43]
 ds_read_b64_tr_b16 a[48:49], v3 offset:0
 ds_read_b64_tr_b16 a[50:51], v3 offset:1024
M v[44:47], a[124:127], a[172:175], v[44:47]
 s_add_u32 m0, s23, 49152
M v[44:47], a[120:123], a[168:171], v[44:47]
 buffer_load_dwordx4 v8, s[16:19], s21 offen offset:0  nt lds
M v[48:51], a[128:131], a[168:171], v[48:51]
M v[48:51], a[132:135], a[172:175], v[48:51]
M v[52:55], a[140:143], a[172:175], v[52:55]
 ds_read_b64_tr_b16 a[52:53], v3 offset:8192
 ds_read_b64_tr_b16 a[54:55], v3 offset:9216
M v[52:55], a[136:139], a[168:171], v[52:55]
M v[56:59], a[144:147], a[168:171], v[56:59]
 buffer_load_dwordx4 v9, s[16:19], s21 offen offset:1024  nt lds
M v[56:59], a[148:151], a[172:175], v[56:59]
 s_waitcnt lgkmcnt(6)
M v[60:63], a[156:159], a[172:175], v[60:63]
M v[60:63], a[152:155], a[168:171], v[60:63]
 ds_read_b64_tr_b16 a[56:57], v4 offset:0
 ds_read_b64_tr_b16 a[58:59], v4 offset:1024
M v[64:67], a[96:99], a[160:163], v[64:67]
 ds_read_b128 a[168:171], v5 offset:38912
 ds_read_b128 a[172:175], v6 offset:38912
M v[64:67], a[100:103], a[164:167], v[64:67]
 buffer_load_dwordx4 v10, s[16:19], s21 offen offset:2048  nt lds
M v[68:71], a[108:111], a[164:167], v[68:71]
M v[68:71], a[104:107], a[160:163], v[68:71]
M v[72:75], a[112:115], a[160:163], v[72:75]
 ds_read_b64_tr_b16 a[60:61], v4 offset:8192
 ds_read_b64_tr_b16 a[62:63], v4 offset:9216
M v[72:75], a[116:119], a[164:167], v[72:75]
M v[76:79], a[124:127], a[164:167], v[76:79]
 buffer_load_dwordx4 v11, s[16:19], s21 offen offset:3072  nt lds
M v[76:79], a[120:123], a[160:163], v[76:79]
 s_add_u32 s21, s21, 524160
M v[80:83], a[128:131], a[160:163], v[80:83]
M v[80:83], a[132:135], a[164:167], v[80:83]
M v[84:87], a[140:143], a[164:167], v[84:87]
M v[84:87], a[136:139], a[160:163], v[84:87]
M v[88:91], a[144:147], a[160:163], v[88:91]
M v[88:91], a[148:151], a[164:167], v[88:91]
 s_waitcnt lgkmcnt(2)
M v[92:95], a[156:159], a[164:167], v[92:95]
 s_waitcnt vmcnt(17) lgkmcnt(0)
M v[92:95], a[152:155], a[160:163], v[92:95]
 s_barrier
M v[96:99], a[96:99], a[168:171], v[96:99]
 ds_read_b128 a[160:163], v5 offset:49152
 ds_read_b128 a[164:167], v6 offset:49152
M v[96:99], a[100:103], a[172:175], v[96:99]
M v[100:103], a[108:111], a[172:175], v[100:103]
 s_add_u32 m0, s24, 32768
 ds_read_b64_tr_b16 a[64:65], v1 offset:16384
 ds_read_b64_tr_b16 a[66:67], v1 offset:17408
M v[100:103], a[104:107], a[168:171], v[100:103]
 buffer_load_dwordx4 v12, s[48:51], s22 offen offset:0   lds
M v[104:107], a[112:115], a[168:171], v[104:107]
M v[104:107], a[116:119], a[172:175], v[104:107]
M v[108:111], a[124:127], a[172:175], v[108:111]
M v[108:111], a[120:123], a[168:171], v[108:111]
M v[112:115], a[128:131], a[168:171], v[112:115]
M v[112:115], a[132:135], a[172:175], v[112:115]
 ds_read_b64_tr_b16 a[68:69], v1 offset:24576
 ds_read_b64_tr_b16 a[70:71], v1 offset:25600
M v[116:119], a[140:143], a[172:175], v[116:119]
 buffer_load_dwordx4 v13, s[48:51], s22 offen offset:1024   lds
M v[116:119], a[136:139], a[168:171], v[116:119]
M v[120:123], a[144:147], a[168:171], v[120:123]
M v[120:123], a[148:151], a[172:175], v[120:123]
 s_waitcnt lgkmcnt(4)
M v[124:127], a[156:159], a[172:175], v[124:127]
M v[124:127], a[152:155], a[168:171], v[124:127]
M v[128:131], a[96:99], a[160:163], v[128:131]
 ds_read_b128 a[168:171], v5 offset:51200
 ds_read_b128 a[172:175], v6 offset:51200
M v[128:131], a[100:103], a[164:167], v[128:131]
 ds_read_b64_tr_b16 a[72:73], v2 offset:16384
 ds_read_b64_tr_b16 a[74:75], v2 offset:17408
M v[132:135], a[108:111], a[164:167], v[132:135]
 buffer_load_dwordx4 v14, s[48:51], s22 offen offset:2048   lds
M v[132:135], a[104:107], a[160:163], v[132:135]
M v[136:139], a[112:115], a[160:163], v[136:139]
M v[136:139], a[116:119], a[164:167], v[136:139]
M v[140:143], a[124:127], a[164:167], v[140:143]
M v[140:143], a[120:123], a[160:163], v[140:143]
 ds_read_b64_tr_b16 a[76:77], v2 offset:24576
 ds_read_b64_tr_b16 a[78:79], v2 offset:25600
M v[144:147], a[128:131], a[160:163], v[144:147]
 buffer_load_dwordx4 v15, s[48:51], s22 offen offset:3072   lds
M v[144:147], a[132:135], a[164:167], v[144:147]
 s_add_u32 s22, s22, 2097152
M v[148:151], a[140:143], a[164:167], v[148:151]
M v[148:151], a[136:139], a[160:163], v[148:151]
M v[152:155], a[144:147], a[160:163], v[152:155]
M v[152:155], a[148:151], a[164:167], v[152:155]
 s_waitcnt lgkmcnt(4)
M v[156:159], a[156:159], a[164:167], v[156:159]
 s_add_u32 m0, s23, 0
 ds_read_b64_tr_b16 a[80:81], v3 offset:16384
 ds_read_b64_tr_b16 a[82:83], v3 offset:17408
M v[156:159], a[152:155], a[160:163], v[156:159]
 buffer_load_dwordx4 v8, s[16:19], s21 offen offset:0  nt lds
M v[160:163], a[96:99], a[168:171], v[160:163]
 ds_read_b128 a[160:163], v5 offset:53248
 ds_read_b128 a[164:167], v6 offset:53248
M v[160:163], a[100:103], a[172:175], v[160:163]
M v[164:167], a[108:111], a[172:175], v[164:167]
M v[164:167], a[104:107], a[168:171], v[164:167]
M v[168:171], a[112:115], a[168:171], v[168:171]
M v[168:171], a[116:119], a[172:175], v[168:171]
 ds_read_b64_tr_b16 a[84:85], v3 offset:24576
 ds_read_b64_tr_b16 a[86:87], v3 offset:25600
M v[172:175], a[124:127], a[172:175], v[172:175]
 buffer_load_dwordx4 v9, s[16:19], s21 offen offset:1024  nt lds
M v[172:175], a[120:123], a[168:171], v[172:175]
M v[176:179], a[128:131], a[168:171], v[176:179]
M v[176:179], a[132:135], a[172:175], v[176:179]
M v[180:183], a[140:143], a[172:175], v[180:183]
M v[180:183], a[136:139], a[168:171], v[180:183]
M v[184:187], a[144:147], a[168:171], v[184:187]
 ds_read_b64_tr_b16 a[88:89], v4 offset:16384
 ds_read_b64_tr_b16 a[90:91], v4 offset:17408
M v[184:187], a[148:151], a[172:175], v[184:187]
 s_waitcnt lgkmcnt(4)
M v[188:191], a[156:159], a[172:175], v[188:191]
 buffer_load_dwordx4 v10, s[16:19], s21 offen offset:2048  nt lds
M v[188:191], a[152:155], a[168:171], v[188:191]
M v[192:195], a[96:99], a[160:163], v[192:195]
 ds_read_b128 a[168:171], v5 offset:55296
 ds_read_b128 a[172:175], v6 offset:55296
M v[192:195], a[100:103], a[164:167], v[192:195]
M v[196:199], a[108:111], a[164:167], v[196:199]
M v[196:199], a[104:107], a[160:163], v[196:199]
 ds_read_b64_tr_b16 a[92:93], v4 offset:24576
 ds_read_b64_tr_b16 a[94:95], v4 offset:25600
M v[200:203], a[112:115], a[160:163], v[200:203]
 buffer_load_dwordx4 v11, s[16:19], s21 offen offset:3072  nt lds
M v[200:203], a[116:119], a[164:167], v[200:203]
 s_add_u32 s21, s21, 128
M v[204:207], a[124:127], a[164:167], v[204:207]
M v[204:207], a[120:123], a[160:163], v[204:207]
M v[208:211], a[128:131], a[160:163], v[208:211]
M v[208:211], a[132:135], a[164:167], v[208:211]
M v[212:215], a[140:143], a[164:167], v[212:215]
M v[212:215], a[136:139], a[160:163], v[212:215]
M v[216:219], a[144:147], a[160:163], v[216:219]
M v[216:219], a[148:151], a[164:167], v[216:219]
 s_waitcnt lgkmcnt(2)
M v[220:223], a[156:159], a[164:167], v[220:223]
 s_waitcnt vmcnt(17) lgkmcnt(0)
M v[220:223], a[152:155], a[160:163], v[220:223]
 s_barrier
M v[224:227], a[96:99], a[168:171], v[224:227]
 ds_read_b128 a[160:163], v5 offset:0
 ds_read_b128 a[164:167], v6 offset:0
M v[224:227], a[100:103], a[172:175], v[224:227]
M v[228:231], a[108:111], a[172:175], v[228:231]
M v[228:231], a[104:107], a[168:171], v[228:231]
M v[232:235], a[112:115], a[168:171], v[232:235]
M v[232:235], a[116:119], a[172:175], v[232:235]
M v[236:239], a[124:127], a[172:175], v[236:239]
M v[236:239], a[120:123], a[168:171], v[236:239]
M v[240:243], a[128:131], a[168:171], v[240:243]
M v[240:243], a[132:135], a[172:175], v[240:243]
M v[244:247], a[140:143], a[172:175], v[244:247]
M v[244:247], a[136:139], a[168:171], v[244:247]
M v[248:251], a[144:147], a[168:171], v[248:251]
M v[248:251], a[148:151], a[172:175], v[248:251]
 s_waitcnt lgkmcnt(0)
M v[252:255], a[156:159], a[172:175], v[252:255]
M v[252:255], a[152:155], a[168:171], v[252:255]
M a[0:3], a[32:35], a[160:163], a[0:3]
 ds_read_b128 a[168:171], v5 offset:2048
 ds_read_b128 a[172:175], v6 offset:2048
M a[0:3], a[36:39], a[164:167], a[0:3]
 ds_read_b64_tr_b16 a[96:97], v1 offset:32768
 ds_read_b64_tr_b16 a[98:99], v1 offset:33792
M a[4:7], a[44:47], a[164:167], a[4:7]
 s_add_u32 m0, s24, 49152
M a[4:7], a[40:43], a[160:163], a[4:7]
 buffer_load_dwordx4 v12, s[48:51], s22 offen offset:0   lds
M a[8:11], a[48:51], a[160:163], a[8:11]
M a[8:11], a[52:55], a[164:167], a[8:11]
M a[12:15], a[60:63], a[164:167], a[12:15]
 ds_read_b64_tr_b16 a[100:101], v1 offset:40960
 ds_read_b64_tr_b16 a[102:103], v1 offset:41984
M a[12:15], a[56:59], a[160:163], a[12:15]
M a[16:19], a[64:67], a[160:163], a[16:19]
 buffer_load_dwordx4 v13, s[48:51], s22 offen offset:1024   lds
M a[16:19], a[68:71], a[164:167], a[16:19]
M a[20:23], a[76:79], a[164:167], a[20:23]
 v_mov_b32 v16, 0x3f80
M a[20:23], a[72:75], a[160:163], a[20:23]
 ds_read_b64_tr_b16 a[104:105], v2 offset:32768
 ds_read_b64_tr_b16 a[106:107], v2 offset:33792
M a[24:27], a[80:83], a[160:163], a[24:27]
 v_lshrrev_b32 v17, 8, v7
M a[24:27], a[84:87], a[164:167], a[24:27]
 s_waitcnt lgkmcnt(6)
 v_bfe_u32 v18, v7, 6, 2
M a[28:31], a[92:95], a[164:167], a[28:31]
 buffer_load_dwordx4 v14, s[48:51], s22 offen offset:2048   lds
M a[28:31], a[88:91], a[160:163], a[28:31]
 v_and_b32 v19, 16, v7
M v[32:35], a[32:35], a[168:171], v[32:35]
 ds_read_b128 a[160:163], v5 offset:4096
 ds_read_b128 a[164:167], v6 offset:4096
M v[32:35], a[36:39], a[172:175], v[32:35]
 ds_read_b64_tr_b16 a[108:109], v2 offset:40960
 ds_read_b64_tr_b16 a[110:111], v2 offset:41984
M v[36:39], a[44:47], a[172:175], v[36:39]
 buffer_load_dwordx4 v15, s[48:51], s22 offen offset:3072   lds
M v[36:39], a[40:43], a[168:171], v[36:39]
 s_sub_u32 s22, s22, 2097024
 v_lshlrev_b32 v19, v19, v16
M v[40:43], a[48:51], a[168:171], v[40:43]
 v_cmp_eq_u32 vcc, v17, v18
M v[40:43], a[52:55], a[172:175], v[40:43]
 ds_read_b64_tr_b16 a[112:113], v3 offset:32768
 ds_read_b64_tr_b16 a[114:115], v3 offset:33792
M v[44:47], a[60:63], a[172:175], v[44:47]
 s_add_u32 m0, s23, 16384
 v_and_b32 v16, 32, v7
M v[44:47], a[56:59], a[168:171], v[44:47]
 buffer_load_dwordx4 v8, s[16:19], s21 offen offset:0  nt lds
M v[48:51], a[64:67], a[168:171], v[48:51]
 v_accvgpr_write_b32 a244, 0
M v[48:51], a[68:71], a[172:175], v[48:51]
 v_accvgpr_write_b32 a245, 0
M v[52:55], a[76:79], a[172:175], v[52:55]
 ds_read_b64_tr_b16 a[116:117], v3 offset:40960
 ds_read_b64_tr_b16 a[118:119], v3 offset:41984
M v[52:55], a[72:75], a[168:171], v[52:55]
 v_cndmask_b32 v19, 0, v19, vcc
M v[56:59], a[80:83], a[168:171], v[56:59]
 buffer_load_dwordx4 v9, s[16:19], s21 offen offset:1024  nt lds
M v[56:59], a[84:87], a[172:175], v[56:59]
 s_waitcnt lgkmcnt(6)
 v_cmp_eq_u32 vcc, 0, v16
M v[60:63], a[92:95], a[172:175], v[60:63]
 v_accvgpr_write_b32 a248, 0
M v[60:63], a[88:91], a[168:171], v[60:63]
 ds_read_b64_tr_b16 a[120:121], v4 offset:32768
 ds_read_b64_tr_b16 a[122:123], v4 offset:33792
M v[64:67], a[32:35], a[160:163], v[64:67]
 ds_read_b128 a[168:171], v5 offset:6144
 ds_read_b128 a[172:175], v6 offset:6144
M v[64:67], a[36:39], a[164:167], v[64:67]
 buffer_load_dwordx4 v10, s[16:19], s21 offen offset:2048  nt lds
M v[68:71], a[44:47], a[164:167], v[68:71]
 v_accvgpr_write_b32 a249, 0
M v[68:71], a[40:43], a[160:163], v[68:71]
 v_cndmask_b32 v17, 0, v19, vcc
M v[72:75], a[48:51], a[160:163], v[72:75]
 ds_read_b64_tr_b16 a[124:125], v4 offset:40960
 ds_read_b64_tr_b16 a[126:127], v4 offset:41984
M v[72:75], a[52:55], a[164:167], v[72:75]
 v_sub_u32 v18, v19, v17
M v[76:79], a[60:63], a[164:167], v[76:79]
 buffer_load_dwordx4 v11, s[16:19], s21 offen offset:3072  nt lds
M v[76:79], a[56:59], a[160:163], v[76:79]
 s_add_u32 s21, s21, 524160
 v_accvgpr_write_b32 a246, v17
M v[80:83], a[64:67], a[160:163], v[80:83]
 v_accvgpr_write_b32 a247, v18
M v[80:83], a[68:71], a[164:167], v[80:83]
M v[84:87], a[76:79], a[164:167], v[84:87]
M v[84:87], a[72:75], a[160:163], v[84:87]
M v[88:91], a[80:83], a[160:163], v[88:91]
M v[88:91], a[84:87], a[164:167], v[88:91]
 s_waitcnt lgkmcnt(2)
M v[92:95], a[92:95], a[164:167], v[92:95]
 s_waitcnt vmcnt(16) lgkmcnt(0)
M v[92:95], a[88:91], a[160:163], v[92:95]
 s_barrier
M v[96:99], a[32:35], a[168:171], v[96:99]
 ds_read_b128 a[160:163], v5 offset:16384
 ds_read_b128 a[164:167], v6 offset:16384
M v[96:99], a[36:39], a[172:175], v[96:99]
M v[100:103], a[44:47], a[172:175], v[100:103]
 s_add_u32 m0, s24, 0
 ds_read_b64_tr_b16 a[128:129], v1 offset:49152
 ds_read_b64_tr_b16 a[130:131], v1 offset:50176
M v[100:103], a[40:43], a[168:171], v[100:103]
 buffer_load_dwordx4 v12, s[48:51], s22 offen offset:0   lds
M v[104:107], a[48:51], a[168:171], v[104:107]
M v[104:107], a[52:55], a[172:175], v[104:107]
M v[108:111], a[60:63], a[172:175], v[108:111]
M v[108:111], a[56:59], a[168:171], v[108:111]
M v[112:115], a[64:67], a[168:171], v[112:115]
M v[112:115], a[68:71], a[172:175], v[112:115]
 ds_read_b64_tr_b16 a[132:133], v1 offset:57344
 ds_read_b64_tr_b16 a[134:135], v1 offset:58368
M v[116:119], a[76:79], a[172:175], v[116:119]
 buffer_load_dwordx4 v13, s[48:51], s22 offen offset:1024   lds
M v[116:119], a[72:75], a[168:171], v[116:119]
M v[120:123], a[80:83], a[168:171], v[120:123]
M v[120:123], a[84:87], a[172:175], v[120:123]
 s_waitcnt lgkmcnt(4)
M v[124:127], a[92:95], a[172:175], v[124:127]
M v[124:127], a[88:91], a[168:171], v[124:127]
M v[128:131], a[32:35], a[160:163], v[128:131]
 ds_read_b128 a[168:171], v5 offset:18432
 ds_read_b128 a[172:175], v6 offset:18432
M v[128:131], a[36:39], a[164:167], v[128:131]
 ds_read_b64_tr_b16 a[136:137], v2 offset:49152
 ds_read_b64_tr_b16 a[138:139], v2 offset:50176
M v[132:135], a[44:47], a[164:167], v[132:135]
 buffer_load_dwordx4 v14, s[48:51], s22 offen offset:2048   lds
M v[132:135], a[40:43], a[160:163], v[132:135]
M v[136:139], a[48:51], a[160:163], v[136:139]
M v[136:139], a[52:55], a[164:167], v[136:139]
M v[140:143], a[60:63], a[164:167], v[140:143]
M v[140:143], a[56:59], a[160:163], v[140:143]
 ds_read_b64_tr_b16 a[140:141], v2 offset:57344
 ds_read_b64_tr_b16 a[142:143], v2 offset:58368
M v[144:147], a[64:67], a[160:163], v[144:147]
 buffer_load_dwordx4 v15, s[48:51], s22 offen offset:3072   lds
M v[144:147], a[68:71], a[164:167], v[144:147]
 s_add_u32 s22, s22, 2097152
M v[148:151], a[76:79], a[164:167], v[148:151]
M v[148:151], a[72:75], a[160:163], v[148:151]
M v[152:155], a[80:83], a[160:163], v[152:155]
M v[152:155], a[84:87], a[164:167], v[152:155]
 s_waitcnt lgkmcnt(4)
M v[156:159], a[92:95], a[164:167], v[156:159]
 s_add_u32 m0, s23, 32768
 ds_read_b64_tr_b16 a[144:145], v3 offset:49152
 ds_read_b64_tr_b16 a[146:147], v3 offset:50176
M v[156:159], a[88:91], a[160:163], v[156:159]
 buffer_load_dwordx4 v8, s[16:19], s21 offen offset:0  nt lds
M v[160:163], a[32:35], a[168:171], v[160:163]
 ds_read_b128 a[160:163], v5 offset:20480
 ds_read_b128 a[164:167], v6 offset:20480
M v[160:163], a[36:39], a[172:175], v[160:163]
M v[164:167], a[44:47], a[172:175], v[164:167]
M v[164:167], a[40:43], a[168:171], v[164:167]
M v[168:171], a[48:51], a[168:171], v[168:171]
M v[168:171], a[52:55], a[172:175], v[168:171]
 ds_read_b64_tr_b16 a[148:149], v3 offset:57344
 ds_read_b64_tr_b16 a[150:151], v3 offset:58368
M v[172:175], a[60:63], a[172:175], v[172:175]
 buffer_load_dwordx4 v9, s[16:19], s21 offen offset:1024  nt lds
M v[172:175], a[56:59], a[168:171], v[172:175]
M v[176:179], a[64:67], a[168:171], v[176:179]
M v[176:179], a[68:71], a[172:175], v[176:179]
M v[180:183], a[76:79], a[172:175], v[180:183]
M v[180:183], a[72:75], a[168:171], v[180:183]
M v[184:187], a[80:83], a[168:171], v[184:187]
 ds_read_b64_tr_b16 a[152:153], v4 offset:49152
 ds_read_b64_tr_b16 a[154:155], v4 offset:50176
M v[184:187], a[84:87], a[172:175], v[184:187]
 s_waitcnt lgkmcnt(4)
M v[188:191], a[92:95], a[172:175], v[188:191]
 buffer_load_dwordx4 v10, s[16:19], s21 offen offset:2048  nt lds
M v[188:191], a[88:91], a[168:171], v[188:191]
M v[192:195], a[32:35], a[160:163], v[192:195]
 ds_read_b128 a[168:171], v5 offset:22528
 ds_read_b128 a[172:175], v6 offset:22528
M v[192:195], a[36:39], a[164:167], v[192:195]
M v[196:199], a[44:47], a[164:167], v[196:199]
M v[196:199], a[40:43], a[160:163], v[196:199]
 ds_read_b64_tr_b16 a[156:157], v4 offset:57344
 ds_read_b64_tr_b16 a[158:159], v4 offset:58368
M v[200:203], a[48:51], a[160:163], v[200:203]
 buffer_load_dwordx4 v11, s[16:19], s21 offen offset:3072  nt lds
M v[200:203], a[52:55], a[164:167], v[200:203]
 s_add_u32 s21, s21, 128
M v[204:207], a[60:63], a[164:167], v[204:207]
M v[204:207], a[56:59], a[160:163], v[204:207]
M v[208:211], a[64:67], a[160:163], v[208:211]
M v[208:211], a[68:71], a[164:167], v[208:211]
M v[212:215], a[76:79], a[164:167], v[212:215]
M v[212:215], a[72:75], a[160:163], v[212:215]
M v[216:219], a[80:83], a[160:163], v[216:219]
M v[216:219], a[84:87], a[164:167], v[216:219]
 s_waitcnt lgkmcnt(2)
M v[220:223], a[92:95], a[164:167], v[220:223]
 s_waitcnt vmcnt(16) lgkmcnt(0)
M v[220:223], a[88:91], a[160:163], v[220:223]
 s_barrier
M v[224:227], a[32:35], a[168:171], v[224:227]
 ds_read_b128 a[160:163], v5 offset:32768
 ds_read_b128 a[164:167], v6 offset:32768
M v[224:227], a[36:39], a[172:175], v[224:227]
M v[228:231], a[44:47], a[172:175], v[228:231]
M v[228:231], a[40:43], a[168:171], v[228:231]
M v[232:235], a[48:51], a[168:171], v[232:235]
M v[232:235], a[52:55], a[172:175], v[232:235]
M v[236:239], a[60:63], a[172:175], v[236:239]
M v[236:239], a[56:59], a[168:171], v[236:239]
M v[240:243], a[64:67], a[168:171], v[240:243]
M v[240:243], a[68:71], a[172:175], v[240:243]
M v[244:247], a[76:79], a[172:175], v[244:247]
M v[244:247], a[72:75], a[168:171], v[244:247]
M v[248:251], a[80:83], a[168:171], v[248:251]
M v[248:251], a[84:87], a[172:175], v[248:251]
 s_waitcnt lgkmcnt(0)
M v[252:255], a[92:95], a[172:175], v[252:255]
M v[252:255], a[88:91], a[168:171], v[252:255]
M a[0:3], a[96:99], a[160:163], a[0:3]
 ds_read_b128 a[168:171], v5 offset:34816
 ds_read_b128 a[172:175], v6 offset:34816
M a[0:3], a[100:103], a[164:167], a[0:3]
 ds_read_b64_tr_b16 a[32:33], v1 offset:0
 ds_read_b64_tr_b16 a[34:35], v1 offset:1024
M a[4:7], a[108:111], a[164:167], a[4:7]
 s_add_u32 m0, s24, 16384
M a[4:7], a[104:107], a[160:163], a[4:7]
 buffer_load_dwordx4 v12, s[48:51], s22 offen offset:0   lds
M a[8:11], a[112:115], a[160:163], a[8:11]
M a[8:11], a[116:119], a[164:167], a[8:11]
M a[12:15], a[124:127], a[164:167], a[12:15]
 ds_read_b64_tr_b16 a[36:37], v1 offset:8192
 ds_read_b64_tr_b16 a[38:39], v1 offset:9216
M a[12:15], a[120:123], a[160:163], a[12:15]
M a[16:19], a[128:131], a[160:163], a[16:19]
 buffer_load_dwordx4 v13, s[48:51], s22 offen offset:1024   lds
M a[16:19], a[132:135], a[164:167], a[16:19]
M a[20:23], a[140:143], a[164:167], a[20:23]
M a[20:23], a[136:139], a[160:163], a[20:23]
 ds_read_b64_tr_b16 a[40:41], v2 offset:0
 ds_read_b64_tr_b16 a[42:43], v2 offset:1024
M a[24:27], a[144:147], a[160:163], a[24:27]
M a[24:27], a[148:151], a[164:167], a[24:27]
 s_waitcnt lgkmcnt(6)
M a[28:31], a[156:159], a[164:167], a[28:31]
 buffer_load_dwordx4 v14, s[48:51], s22 offen offset:2048   lds
M a[28:31], a[152:155], a[160:163], a[28:31]
M v[32:35], a[96:99], a[168:171], v[32:35]
 ds_read_b128 a[160:163], v5 offset:36864
 ds_read_b128 a[164:167], v6 offset:36864
M v[32:35], a[100:103], a[172:175], v[32:35]
 ds_read_b64_tr_b16 a[44:45], v2 offset:8192
 ds_read_b64_tr_b16 a[46:47], v2 offset:9216
M v[36:39], a[108:111], a[172:175], v[36:39]
 buffer_load_dwordx4 v15, s[48:51], s22 offen offset:3072   lds
M v[36:39], a[104:107], a[168:171], v[36:39]
 s_sub_u32 s22, s22, 2097024
M v[40:43], a[112:115], a[168:171], v[40:43]
M v[40:43], a[116:119], a[172:175], v[40:43]
 ds_read_b64_tr_b16 a[48:49], v3 offset:0
 ds_read_b64_tr_b16 a[50:51], v3 offset:1024
M v[44:47], a[124:127], a[172:175], v[44:47]
 s_add_u32 m0, s23, 49152
M v[44:47], a[120:123], a[168:171], v[44:47]
 buffer_load_dwordx4 v8, s[16:19], s21 offen offset:0  nt lds
M v[48:51], a[128:131], a[168:171], v[48:51]
M v[48:51], a[132:135], a[172:175], v[48:51]
M v[52:55], a[140:143], a[172:175], v[52:55]
 ds_read_b64_tr_b16 a[52:53], v3 offset:8192
 ds_read_b64_tr_b16 a[54:55], v3 offset:9216
M v[52:55], a[136:139], a[168:171], v[52:55]
M v[56:59], a[144:147], a[168:171], v[56:59]
 buffer_load_dwordx4 v9, s[16:19], s21 offen offset:1024  nt lds
M v[56:59], a[148:151], a[172:175], v[56:59]
 s_waitcnt lgkmcnt(6)
M v[60:63], a[156:159], a[172:175], v[60:63]
M v[60:63], a[152:155], a[168:171], v[60:63]
 ds_read_b64_tr_b16 a[56:57], v4 offset:0
 ds_read_b64_tr_b16 a[58:59], v4 offset:1024
M v[64:67], a[96:99], a[160:163], v[64:67]
 ds_read_b128 a[168:171], v5 offset:38912
 ds_read_b128 a[172:175], v6 offset:38912
M v[64:67], a[100:103], a[164:167], v[64:67]
 buffer_load_dwordx4 v10, s[16:19], s21 offen offset:2048  nt lds
M v[68:71], a[108:111], a[164:167], v[68:71]
M v[68:71], a[104:107], a[160:163], v[68:71]
M v[72:75], a[112:115], a[160:163], v[72:75]
 ds_read_b64_tr_b16 a[60:61], v4 offset:8192
 ds_read_b64_tr_b16 a[62:63], v4 offset:9216
M v[72:75], a[116:119], a[164:167], v[72:75]
M v[76:79], a[124:127], a[164:167], v[76:79]
 buffer_load_dwordx4 v11, s[16:19], s21 offen offset:3072  nt lds
M v[76:79], a[120:123], a[160:163], v[76:79]
 s_add_u32 s21, s21, 524160
M v[80:83], a[128:131], a[160:163], v[80:83]
M v[80:83], a[132:135], a[164:167], v[80:83]
M v[84:87], a[140:143], a[164:167], v[84:87]
M v[84:87], a[136:139], a[160:163], v[84:87]
M v[88:91], a[144:147], a[160:163], v[88:91]
M v[88:91], a[148:151], a[164:167], v[88:91]
 s_waitcnt lgkmcnt(2)
M v[92:95], a[156:159], a[164:167], v[92:95]
 s_waitcnt vmcnt(16) lgkmcnt(0)
M v[92:95], a[152:155], a[160:163], v[92:95]
 s_barrier
M v[96:99], a[96:99], a[168:171], v[96:99]
 ds_read_b128 a[160:163], v5 offset:49152
 ds_read_b128 a[164:167], v6 offset:49152
M v[96:99], a[100:103], a[172:175], v[96:99]
M v[100:103], a[108:111], a[172:175], v[100:103]
 s_add_u32 m0, s24, 32768
 ds_read_b64_tr_b16 a[64:65], v1 offset:16384
 ds_read_b64_tr_b16 a[66:67], v1 offset:17408
M v[100:103], a[104:107], a[168:171], v[100:103]
 buffer_load_dwordx4 v12, s[48:51], s22 offen offset:0   lds
M v[104:107], a[112:115], a[168:171], v[104:107]
 v_min_u32 v16, 40, v0
 v_lshlrev_b32 v16, 2, v16
M v[104:107], a[116:119], a[172:175], v[104:107]
 buffer_load_dword v17, v16, s[12:15], 0 offen offset:64 sc1
M v[108:111], a[124:127], a[172:175], v[108:111]
M v[108:111], a[120:123], a[168:171], v[108:111]
M v[112:115], a[128:131], a[168:171], v[112:115]
M v[112:115], a[132:135], a[172:175], v[112:115]
 ds_read_b64_tr_b16 a[68:69], v1 offset:24576
 ds_read_b64_tr_b16 a[70:71], v1 offset:25600
M v[116:119], a[140:143], a[172:175], v[116:119]
 buffer_load_dwordx4 v13, s[48:51], s22 offen offset:1024   lds
M v[116:119], a[136:139], a[168:171], v[116:119]
M v[120:123], a[144:147], a[168:171], v[120:123]
M v[120:123], a[148:151], a[172:175], v[120:123]
 s_waitcnt lgkmcnt(4)
M v[124:127], a[156:159], a[172:175], v[124:127]
M v[124:127], a[152:155], a[168:171], v[124:127]
M v[128:131], a[96:99], a[160:163], v[128:131]
 ds_read_b128 a[168:171], v5 offset:51200
 ds_read_b128 a[172:175], v6 offset:51200
M v[128:131], a[100:103], a[164:167], v[128:131]
 ds_read_b64_tr_b16 a[72:73], v2 offset:16384
 ds_read_b64_tr_b16 a[74:75], v2 offset:17408
M v[132:135], a[108:111], a[164:167], v[132:135]
 buffer_load_dwordx4 v14, s[48:51], s22 offen offset:2048   lds
M v[132:135], a[104:107], a[160:163], v[132:135]
M v[136:139], a[112:115], a[160:163], v[136:139]
M v[136:139], a[116:119], a[164:167], v[136:139]
M v[140:143], a[124:127], a[164:167], v[140:143]
M v[140:143], a[120:123], a[160:163], v[140:143]
 ds_read_b64_tr_b16 a[76:77], v2 offset:24576
 ds_read_b64_tr_b16 a[78:79], v2 offset:25600
M v[144:147], a[128:131], a[160:163], v[144:147]
 buffer_load_dwordx4 v15, s[48:51], s22 offen offset:3072   lds
M v[144:147], a[132:135], a[164:167], v[144:147]
 s_add_u32 s22, s22, 2097152
M v[148:151], a[140:143], a[164:167], v[148:151]
M v[148:151], a[136:139], a[160:163], v[148:151]
M v[152:155], a[144:147], a[160:163], v[152:155]
M v[152:155], a[148:151], a[164:167], v[152:155]
 s_waitcnt lgkmcnt(4)
M v[156:159], a[156:159], a[164:167], v[156:159]
 s_add_u32 m0, s23, 0
 ds_read_b64_tr_b16 a[80:81], v3 offset:16384
 ds_read_b64_tr_b16 a[82:83], v3 offset:17408
M v[156:159], a[152:155], a[160:163], v[156:159]
 buffer_load_dwordx4 v8, s[16:19], s21 offen offset:0  nt lds
M v[160:163], a[96:99], a[168:171], v[160:163]
 ds_read_b128 a[160:163], v5 offset:53248
 ds_read_b128 a[164:167], v6 offset:53248
M v[160:163], a[100:103], a[172:175], v[160:163]
M v[164:167], a[108:111], a[172:175], v[164:167]
M v[164:167], a[104:107], a[168:171], v[164:167]
M v[168:171], a[112:115], a[168:171], v[168:171]
M v[168:171], a[116:119], a[172:175], v[168:171]
 ds_read_b64_tr_b16 a[84:85], v3 offset:24576
 ds_read_b64_tr_b16 a[86:87], v3 offset:25600
M v[172:175], a[124:127], a[172:175], v[172:175]
 buffer_load_dwordx4 v9, s[16:19], s21 offen offset:1024  nt lds
M v[172:175], a[120:123], a[168:171], v[172:175]
M v[176:179], a[128:131], a[168:171], v[176:179]
M v[176:179], a[132:135], a[172:175], v[176:179]
M v[180:183], a[140:143], a[172:175], v[180:183]
M v[180:183], a[136:139], a[168:171], v[180:183]
M v[184:187], a[144:147], a[168:171], v[184:187]
 ds_read_b64_tr_b16 a[88:89], v4 offset:16384
 ds_read_b64_tr_b16 a[90:91], v4 offset:17408
M v[184:187], a[148:151], a[172:175], v[184:187]
 s_waitcnt lgkmcnt(4)
M v[188:191], a[156:159], a[172:175], v[188:191]
 buffer_load_dwordx4 v10, s[16:19], s21 offen offset:2048  nt lds
M v[188:191], a[152:155], a[168:171], v[188:191]
M v[192:195], a[96:99], a[160:163], v[192:195]
 ds_read_b128 a[168:171], v5 offset:55296
 ds_read_b128 a[172:175], v6 offset:55296
M v[192:195], a[100:103], a[164:167], v[192:195]
M v[196:199], a[108:111], a[164:167], v[196:199]
M v[196:199], a[104:107], a[160:163], v[196:199]
 ds_read_b64_tr_b16 a[92:93], v4 offset:24576
 ds_read_b64_tr_b16 a[94:95], v4 offset:25600
M v[200:203], a[112:115], a[160:163], v[200:203]
 buffer_load_dwordx4 v11, s[16:19], s21 offen offset:3072  nt lds
M v[200:203], a[116:119], a[164:167], v[200:203]
 s_add_u32 s21, s21, 128
M v[204:207], a[124:127], a[164:167], v[204:207]
M v[204:207], a[120:123], a[160:163], v[204:207]
M v[208:211], a[128:131], a[160:163], v[208:211]
M v[208:211], a[132:135], a[164:167], v[208:211]
M v[212:215], a[140:143], a[164:167], v[212:215]
M v[212:215], a[136:139], a[160:163], v[212:215]
M v[216:219], a[144:147], a[160:163], v[216:219]
M v[216:219], a[148:151], a[164:167], v[216:219]
 s_waitcnt lgkmcnt(2)
M v[220:223], a[156:159], a[164:167], v[220:223]
 s_waitcnt vmcnt(17) lgkmcnt(0)
M v[220:223], a[152:155], a[160:163], v[220:223]
 s_barrier
M v[224:227], a[96:99], a[168:171], v[224:227]
 ds_read_b128 a[160:163], v5 offset:0
 ds_read_b128 a[164:167], v6 offset:0
M v[224:227], a[100:103], a[172:175], v[224:227]
M v[228:231], a[108:111], a[172:175], v[228:231]
M v[228:231], a[104:107], a[168:171], v[228:231]
M v[232:235], a[112:115], a[168:171], v[232:235]
M v[232:235], a[116:119], a[172:175], v[232:235]
M v[236:239], a[124:127], a[172:175], v[236:239]
M v[236:239], a[120:123], a[168:171], v[236:239]
M v[240:243], a[128:131], a[168:171], v[240:243]
M v[240:243], a[132:135], a[172:175], v[240:243]
M v[244:247], a[140:143], a[172:175], v[244:247]
M v[244:247], a[136:139], a[168:171], v[244:247]
M v[248:251], a[144:147], a[168:171], v[248:251]
M v[248:251], a[148:151], a[172:175], v[248:251]
 s_waitcnt lgkmcnt(0)
M v[252:255], a[156:159], a[172:175], v[252:255]
M v[252:255], a[152:155], a[168:171], v[252:255]
M a[0:3], a[32:35], a[160:163], a[0:3]
 ds_read_b128 a[168:171], v5 offset:2048
 ds_read_b128 a[172:175], v6 offset:2048
M a[0:3], a[36:39], a[164:167], a[0:3]
 ds_read_b64_tr_b16 a[96:97], v1 offset:32768
 ds_read_b64_tr_b16 a[98:99], v1 offset:33792
M a[4:7], a[44:47], a[164:167], a[4:7]
 s_add_u32 m0, s24, 49152
M a[4:7], a[40:43], a[160:163], a[4:7]
 buffer_load_dwordx4 v12, s[48:51], s22 offen offset:0   lds
M a[8:11], a[48:51], a[160:163], a[8:11]
M a[8:11], a[52:55], a[164:167], a[8:11]
M a[12:15], a[60:63], a[164:167], a[12:15]
 ds_read_b64_tr_b16 a[100:101], v1 offset:40960
 ds_read_b64_tr_b16 a[102:103], v1 offset:41984
M a[12:15], a[56:59], a[160:163], a[12:15]
M a[16:19], a[64:67], a[160:163], a[16:19]
 buffer_load_dwordx4 v13, s[48:51], s22 offen offset:1024   lds
M a[16:19], a[68:71], a[164:167], a[16:19]
M a[20:23], a[76:79], a[164:167], a[20:23]
M a[20:23], a[72:75], a[160:163], a[20:23]
 ds_read_b64_tr_b16 a[104:105], v2 offset:32768
 ds_read_b64_tr_b16 a[106:107], v2 offset:33792
M a[24:27], a[80:83], a[160:163], a[24:27]
M a[24:27], a[84:87], a[164:167], a[24:27]
 s_waitcnt lgkmcnt(6)
M a[28:31], a[92:95], a[164:167], a[28:31]
 buffer_load_dwordx4 v14, s[48:51], s22 offen offset:2048   lds
M a[28:31], a[88:91], a[160:163], a[28:31]
M v[32:35], a[32:35], a[168:171], v[32:35]
 ds_read_b128 a[160:163], v5 offset:4096
 ds_read_b128 a[164:167], v6 offset:4096
M v[32:35], a[36:39], a[172:175], v[32:35]
 ds_read_b64_tr_b16 a[108:109], v2 offset:40960
 ds_read_b64_tr_b16 a[110:111], v2 offset:41984
M v[36:39], a[44:47], a[172:175], v[36:39]
 buffer_load_dwordx4 v15, s[48:51], s22 offen offset:3072   lds
M v[36:39], a[40:43], a[168:171], v[36:39]
 s_sub_u32 s22, s22, 2097024
M v[40:43], a[48:51], a[168:171], v[40:43]
M v[40:43], a[52:55], a[172:175], v[40:43]
 ds_read_b64_tr_b16 a[112:113], v3 offset:32768
 ds_read_b64_tr_b16 a[114:115], v3 offset:33792
M v[44:47], a[60:63], a[172:175], v[44:47]
 s_add_u32 m0, s23, 16384
M v[44:47], a[56:59], a[168:171], v[44:47]
 buffer_load_dwordx4 v8, s[16:19], s21 offen offset:0  nt lds
M v[48:51], a[64:67], a[168:171], v[48:51]
M v[48:51], a[68:71], a[172:175], v[48:51]
M v[52:55], a[76:79], a[172:175], v[52:55]
 ds_read_b64_tr_b16 a[116:117], v3 offset:40960
 ds_read_b64_tr_b16 a[118:119], v3 offset:41984
M v[52:55], a[72:75], a[168:171], v[52:55]
M v[56:59], a[80:83], a[168:171], v[56:59]
 buffer_load_dwordx4 v9, s[16:19], s21 offen offset:1024  nt lds
M v[56:59], a[84:87], a[172:175], v[56:59]
 s_waitcnt lgkmcnt(6)
M v[60:63], a[92:95], a[172:175], v[60:63]
M v[60:63], a[88:91], a[168:171], v[60:63]
 ds_read_b64_tr_b16 a[120:121], v4 offset:32768
 ds_read_b64_tr_b16 a[122:123], v4 offset:33792
M v[64:67], a[32:35], a[160:163], v[64:67]
 ds_read_b128 a[168:171], v5 offset:6144
 ds_read_b128 a[172:175], v6 offset:6144
M v[64:67], a[36:39], a[164:167], v[64:67]
 buffer_load_dwordx4 v10, s[16:19], s21 offen offset:2048  nt lds
M v[68:71], a[44:47], a[164:167], v[68:71]
M v[68:71], a[40:43], a[160:163], v[68:71]
M v[72:75], a[48:51], a[160:163], v[72:75]
 ds_read_b64_tr_b16 a[124:125], v4 offset:40960
 ds_read_b64_tr_b16 a[126:127], v4 offset:41984
M v[72:75], a[52:55], a[164:167], v[72:75]
M v[76:79], a[60:63], a[164:167], v[76:79]
 buffer_load_dwordx4 v11, s[16:19], s21 offen offset:3072  nt lds
M v[76:79], a[56:59], a[160:163], v[76:79]
 s_add_u32 s21, s21, 524160
M v[80:83], a[64:67], a[160:163], v[80:83]
M v[80:83], a[68:71], a[164:167], v[80:83]
M v[84:87], a[76:79], a[164:167], v[84:87]
M v[84:87], a[72:75], a[160:163], v[84:87]
M v[88:91], a[80:83], a[160:163], v[88:91]
M v[88:91], a[84:87], a[164:167], v[88:91]
 s_waitcnt lgkmcnt(2)
M v[92:95], a[92:95], a[164:167], v[92:95]
 s_waitcnt vmcnt(17) lgkmcnt(0)
M v[92:95], a[88:91], a[160:163], v[92:95]
 s_barrier
M v[96:99], a[32:35], a[168:171], v[96:99]
 ds_read_b128 a[160:163], v5 offset:16384
 ds_read_b128 a[164:167], v6 offset:16384
M v[96:99], a[36:39], a[172:175], v[96:99]
M v[100:103], a[44:47], a[172:175], v[100:103]
 s_add_u32 m0, s24, 0
 ds_read_b64_tr_b16 a[128:129], v1 offset:49152
 ds_read_b64_tr_b16 a[130:131], v1 offset:50176
M v[100:103], a[40:43], a[168:171], v[100:103]
 buffer_load_dwordx4 v12, s[48:51], s22 offen offset:0   lds
M v[104:107], a[48:51], a[168:171], v[104:107]
M v[104:107], a[52:55], a[172:175], v[104:107]
M v[108:111], a[60:63], a[172:175], v[108:111]
M v[108:111], a[56:59], a[168:171], v[108:111]
M v[112:115], a[64:67], a[168:171], v[112:115]
M v[112:115], a[68:71], a[172:175], v[112:115]
 ds_read_b64_tr_b16 a[132:133], v1 offset:57344
 ds_read_b64_tr_b16 a[134:135], v1 offset:58368
M v[116:119], a[76:79], a[172:175], v[116:119]
 buffer_load_dwordx4 v13, s[48:51], s22 offen offset:1024   lds
M v[116:119], a[72:75], a[168:171], v[116:119]
M v[120:123], a[80:83], a[168:171], v[120:123]
M v[120:123], a[84:87], a[172:175], v[120:123]
 s_waitcnt lgkmcnt(4)
M v[124:127], a[92:95], a[172:175], v[124:127]
M v[124:127], a[88:91], a[168:171], v[124:127]
M v[128:131], a[32:35], a[160:163], v[128:131]
 ds_read_b128 a[168:171], v5 offset:18432
 ds_read_b128 a[172:175], v6 offset:18432
M v[128:131], a[36:39], a[164:167], v[128:131]
 ds_read_b64_tr_b16 a[136:137], v2 offset:49152
 ds_read_b64_tr_b16 a[138:139], v2 offset:50176
M v[132:135], a[44:47], a[164:167], v[132:135]
 buffer_load_dwordx4 v14, s[48:51], s22 offen offset:2048   lds
M v[132:135], a[40:43], a[160:163], v[132:135]
M v[136:139], a[48:51], a[160:163], v[136:139]
M v[136:139], a[52:55], a[164:167], v[136:139]
M v[140:143], a[60:63], a[164:167], v[140:143]
M v[140:143], a[56:59], a[160:163], v[140:143]
 ds_read_b64_tr_b16 a[140:141], v2 offset:57344
 ds_read_b64_tr_b16 a[142:143], v2 offset:58368
M v[144:147], a[64:67], a[160:163], v[144:147]
 buffer_load_dwordx4 v15, s[48:51], s22 offen offset:3072   lds
M v[144:147], a[68:71], a[164:167], v[144:147]
 s_add_u32 s22, s22, 2097152
M v[148:151], a[76:79], a[164:167], v[148:151]
M v[148:151], a[72:75], a[160:163], v[148:151]
M v[152:155], a[80:83], a[160:163], v[152:155]
M v[152:155], a[84:87], a[164:167], v[152:155]
 s_waitcnt lgkmcnt(4)
M v[156:159], a[92:95], a[164:167], v[156:159]
 s_add_u32 m0, s23, 32768
 ds_read_b64_tr_b16 a[144:145], v3 offset:49152
 ds_read_b64_tr_b16 a[146:147], v3 offset:50176
M v[156:159], a[88:91], a[160:163], v[156:159]
 buffer_load_dwordx4 v8, s[16:19], s21 offen offset:0  nt lds
M v[160:163], a[32:35], a[168:171], v[160:163]
 ds_read_b128 a[160:163], v5 offset:20480
 ds_read_b128 a[164:167], v6 offset:20480
M v[160:163], a[36:39], a[172:175], v[160:163]
M v[164:167], a[44:47], a[172:175], v[164:167]
M v[164:167], a[40:43], a[168:171], v[164:167]
M v[168:171], a[48:51], a[168:171], v[168:171]
M v[168:171], a[52:55], a[172:175], v[168:171]
 ds_read_b64_tr_b16 a[148:149], v3 offset:57344
 ds_read_b64_tr_b16 a[150:151], v3 offset:58368
M v[172:175], a[60:63], a[172:175], v[172:175]
 buffer_load_dwordx4 v9, s[16:19], s21 offen offset:1024  nt lds
M v[172:175], a[56:59], a[168:171], v[172:175]
M v[176:179], a[64:67], a[168:171], v[176:179]
M v[176:179], a[68:71], a[172:175], v[176:179]
M v[180:183], a[76:79], a[172:175], v[180:183]
M v[180:183], a[72:75], a[168:171], v[180:183]
M v[184:187], a[80:83], a[168:171], v[184:187]
 ds_read_b64_tr_b16 a[152:153], v4 offset:49152
 ds_read_b64_tr_b16 a[154:155], v4 offset:50176
M v[184:187], a[84:87], a[172:175], v[184:187]
 s_waitcnt lgkmcnt(4)
M v[188:191], a[92:95], a[172:175], v[188:191]
 buffer_load_dwordx4 v10, s[16:19], s21 offen offset:2048  nt lds
M v[188:191], a[88:91], a[168:171], v[188:191]
M v[192:195], a[32:35], a[160:163], v[192:195]
 ds_read_b128 a[168:171], v5 offset:22528
 ds_read_b128 a[172:175], v6 offset:22528
M v[192:195], a[36:39], a[164:167], v[192:195]
M v[196:199], a[44:47], a[164:167], v[196:199]
M v[196:199], a[40:43], a[160:163], v[196:199]
 ds_read_b64_tr_b16 a[156:157], v4 offset:57344
 ds_read_b64_tr_b16 a[158:159], v4 offset:58368
M v[200:203], a[48:51], a[160:163], v[200:203]
 buffer_load_dwordx4 v11, s[16:19], s21 offen offset:3072  nt lds
M v[200:203], a[52:55], a[164:167], v[200:203]
 s_add_u32 s21, s21, 128
M v[204:207], a[60:63], a[164:167], v[204:207]
M v[204:207], a[56:59], a[160:163], v[204:207]
M v[208:211], a[64:67], a[160:163], v[208:211]
M v[208:211], a[68:71], a[164:167], v[208:211]
M v[212:215], a[76:79], a[164:167], v[212:215]
M v[212:215], a[72:75], a[160:163], v[212:215]
M v[216:219], a[80:83], a[160:163], v[216:219]
M v[216:219], a[84:87], a[164:167], v[216:219]
 s_waitcnt lgkmcnt(2)
M v[220:223], a[92:95], a[164:167], v[220:223]
 s_waitcnt vmcnt(16) lgkmcnt(0)
M v[220:223], a[88:91], a[160:163], v[220:223]
 s_barrier
M v[224:227], a[32:35], a[168:171], v[224:227]
 ds_read_b128 a[160:163], v5 offset:32768
 ds_read_b128 a[164:167], v6 offset:32768
M v[224:227], a[36:39], a[172:175], v[224:227]
 v_cmp_ne_u32 vcc, 1, v17
M v[228:231], a[44:47], a[172:175], v[228:231]
 s_nop 0
M v[228:231], a[40:43], a[168:171], v[228:231]
 s_cbranch_vccnz L_zs1
L_zr1:
M v[232:235], a[48:51], a[168:171], v[232:235]
 buffer_load_dword a240, v24, s[32:35], 0 offen offset:1024
M v[232:235], a[52:55], a[172:175], v[232:235]
M v[236:239], a[60:63], a[172:175], v[236:239]
M v[236:239], a[56:59], a[168:171], v[236:239]
M v[240:243], a[64:67], a[168:171], v[240:243]
M v[240:243], a[68:71], a[172:175], v[240:243]
M v[244:247], a[76:79], a[172:175], v[244:247]
M v[244:247], a[72:75], a[168:171], v[244:247]
M v[248:251], a[80:83], a[168:171], v[248:251]
M v[248:251], a[84:87], a[172:175], v[248:251]
 s_waitcnt lgkmcnt(0)
M v[252:255], a[92:95], a[172:175], v[252:255]
M v[252:255], a[88:91], a[168:171], v[252:255]
M a[0:3], a[96:99], a[160:163], a[0:3]
 ds_read_b128 a[168:171], v5 offset:34816
 ds_read_b128 a[172:175], v6 offset:34816
M a[0:3], a[100:103], a[164:167], a[0:3]
 ds_read_b64_tr_b16 a[32:33], v1 offset:0
 ds_read_b64_tr_b16 a[34:35], v1 offset:1024
M a[4:7], a[108:111], a[164:167], a[4:7]
 s_add_u32 m0, s24, 16384
M a[4:7], a[104:107], a[160:163], a[4:7]
 buffer_load_dwordx4 v12, s[48:51], s22 offen offset:0   lds
M a[8:11], a[112:115], a[160:163], a[8:11]
M a[8:11], a[116:119], a[164:167], a[8:11]
M a[12:15], a[124:127], a[164:167], a[12:15]
 ds_read_b64_tr_b16 a[36:37], v1 offset:8192
 ds_read_b64_tr_b16 a[38:39], v1 offset:9216
M a[12:15], a[120:123], a[160:163], a[12:15]
M a[16:19], a[128:131], a[160:163], a[16:19]
 buffer_load_dwordx4 v13, s[48:51], s22 offen offset:1024   lds
M a[16:19], a[132:135], a[164:167], a[16:19]
M a[20:23], a[140:143], a[164:167], a[20:23]
M a[20:23], a[136:139], a[160:163], a[20:23]
 ds_read_b64_tr_b16 a[40:41], v2 offset:0
 ds_read_b64_tr_b16 a[42:43], v2 offset:1024
M a[24:27], a[144:147], a[160:163], a[24:27]
M a[24:27], a[148:151], a[164:167], a[24:27]
 s_waitcnt lgkmcnt(6)
M a[28:31], a[156:159], a[164:167], a[28:31]
 buffer_load_dwordx4 v14, s[48:51], s22 offen offset:2048   lds
M a[28:31], a[152:155], a[160:163], a[28:31]
M v[32:35], a[96:99], a[168:171], v[32:35]
 ds_read_b128 a[160:163], v5 offset:36864
 ds_read_b128 a[164:167], v6 offset:36864
M v[32:35], a[100:103], a[172:175], v[32:35]
 ds_read_b64_tr_b16 a[44:45], v2 offset:8192
 ds_read_b64_tr_b16 a[46:47], v2 offset:9216
M v[36:39], a[108:111], a[172:175], v[36:39]
 buffer_load_dwordx4 v15, s[48:51], s22 offen offset:3072   lds
M v[36:39], a[104:107], a[168:171], v[36:39]
 s_sub_u32 s22, s22, 2097024
M v[40:43], a[112:115], a[168:171], v[40:43]
M v[40:43], a[116:119], a[172:175], v[40:43]
 ds_read_b64_tr_b16 a[48:49], v3 offset:0
 ds_read_b64_tr_b16 a[50:51], v3 offset:1024
M v[44:47], a[124:127], a[172:175], v[44:47]
 s_add_u32 m0, s23, 49152
M v[44:47], a[120:123], a[168:171], v[44:47]
 buffer_load_dwordx4 v8, s[16:19], s21 offen offset:0  nt lds
M v[48:51], a[128:131], a[168:171], v[48:51]
M v[48:51], a[132:135], a[172:175], v[48:51]
M v[52:55], a[140:143], a[172:175], v[52:55]
 ds_read_b64_tr_b16 a[52:53], v3 offset:8192
 ds_read_b64_tr_b16 a[54:55], v3 offset:9216
M v[52:55], a[136:139], a[168:171], v[52:55]
M v[56:59], a[144:147], a[168:171], v[56:59]
 buffer_load_dwordx4 v9, s[16:19], s21 offen offset:1024  nt lds
M v[56:59], a[148:151], a[172:175], v[56:59]
 s_waitcnt lgkmcnt(6)
M v[60:63], a[156:159], a[172:175], v[60:63]
M v[60:63], a[152:155], a[168:171], v[60:63]
 ds_read_b64_tr_b16 a[56:57], v4 offset:0
 ds_read_b64_tr_b16 a[58:59], v4 offset:1024
M v[64:67], a[96:99], a[160:163], v[64:67]
 ds_read_b128 a[168:171], v5 offset:38912
 ds_read_b128 a[172:175], v6 offset:38912
M v[64:67], a[100:103], a[164:167], v[64:67]
 buffer_load_dwordx4 v10, s[16:19], s21 offen offset:2048  nt lds
M v[68:71], a[108:111], a[164:167], v[68:71]
M v[68:71], a[104:107], a[160:163], v[68:71]
M v[72:75], a[112:115], a[160:163], v[72:75]
 ds_read_b64_tr_b16 a[60:61], v4 offset:8192
 ds_read_b64_tr_b16 a[62:63], v4 offset:9216
M v[72:75], a[116:119], a[164:167], v[72:75]
M v[76:79], a[124:127], a[164:167], v[76:79]
 buffer_load_dwordx4 v11, s[16:19], s21 offen offset:3072  nt lds
M v[76:79], a[120:123], a[160:163], v[76:79]
 s_add_u32 s21, s21, 524160
M v[80:83], a[128:131], a[160:163], v[80:83]
M v[80:83], a[132:135], a[164:167], v[80:83]
M v[84:87], a[140:143], a[164:167], v[84:87]
M v[84:87], a[136:139], a[160:163], v[84:87]
 s_and_b32 s64, s42, 7
M v[88:91], a[144:147], a[160:163], v[88:91]
 s_lshl_b32 s72, s41, 3
 s_add_u32 s64, s64, s72
 s_lshl_b32 s64, s64, 2
M v[88:91], a[148:151], a[164:167], v[88:91]
 s_waitcnt lgkmcnt(2)
 s_add_u32 s64, s64, s20
 s_mul_i32 s67, s64, 7168
M v[92:95], a[156:159], a[164:167], v[92:95]
 s_waitcnt vmcnt(17) lgkmcnt(0)
 s_mul_i32 s86, s20, 7168
 s_add_u32 s86, s86, 131072
M v[92:95], a[152:155], a[160:163], v[92:95]
 s_barrier
M v[96:99], a[96:99], a[168:171], v[96:99]
 ds_read_b128 a[160:163], v5 offset:49152
 ds_read_b128 a[164:167], v6 offset:49152
M v[96:99], a[100:103], a[172:175], v[96:99]
M v[100:103], a[108:111], a[172:175], v[100:103]
 s_add_u32 m0, s24, 32768
 ds_read_b64_tr_b16 a[64:65], v1 offset:16384
 ds_read_b64_tr_b16 a[66:67], v1 offset:17408
M v[100:103], a[104:107], a[168:171], v[100:103]
 buffer_load_dwordx4 v12, s[48:51], s22 offen offset:0   lds
M v[104:107], a[112:115], a[168:171], v[104:107]
M v[104:107], a[116:119], a[172:175], v[104:107]
M v[108:111], a[124:127], a[172:175], v[108:111]
M v[108:111], a[120:123], a[168:171], v[108:111]
 buffer_load_dwordx4 v13, s[48:51], s22 offen offset:1024   lds
M v[112:115], a[128:131], a[168:171], v[112:115]
M v[112:115], a[132:135], a[172:175], v[112:115]
 ds_read_b64_tr_b16 a[68:69], v1 offset:24576
 ds_read_b64_tr_b16 a[70:71], v1 offset:25600
M v[116:119], a[140:143], a[172:175], v[116:119]
M v[116:119], a[136:139], a[168:171], v[116:119]
M v[120:123], a[144:147], a[168:171], v[120:123]
 buffer_load_dwordx4 v14, s[48:51], s22 offen offset:2048   lds
M v[120:123], a[148:151], a[172:175], v[120:123]
 s_waitcnt lgkmcnt(4)
M v[124:127], a[156:159], a[172:175], v[124:127]
M v[124:127], a[152:155], a[168:171], v[124:127]
M v[128:131], a[96:99], a[160:163], v[128:131]
 ds_read_b128 a[168:171], v5 offset:51200
 ds_read_b128 a[172:175], v6 offset:51200
M v[128:131], a[100:103], a[164:167], v[128:131]
 ds_read_b64_tr_b16 a[72:73], v2 offset:16384
 ds_read_b64_tr_b16 a[74:75], v2 offset:17408
M v[132:135], a[108:111], a[164:167], v[132:135]
 buffer_load_dwordx4 v15, s[48:51], s22 offen offset:3072   lds
M v[132:135], a[104:107], a[160:163], v[132:135]
 s_add_u32 s22, s22, 2097152
M v[136:139], a[112:115], a[160:163], v[136:139]
M v[136:139], a[116:119], a[164:167], v[136:139]
 s_add_u32 m0, s23, 0
M v[140:143], a[124:127], a[164:167], v[140:143]
 buffer_load_dwordx4 v8, s[16:19], s21 offen offset:0  nt lds
M v[140:143], a[120:123], a[160:163], v[140:143]
 ds_read_b64_tr_b16 a[76:77], v2 offset:24576
 ds_read_b64_tr_b16 a[78:79], v2 offset:25600
M v[144:147], a[128:131], a[160:163], v[144:147]
M v[144:147], a[132:135], a[164:167], v[144:147]
M v[148:151], a[140:143], a[164:167], v[148:151]
 buffer_load_dwordx4 v9, s[16:19], s21 offen offset:1024  nt lds
M v[148:151], a[136:139], a[160:163], v[148:151]
M v[152:155], a[144:147], a[160:163], v[152:155]
M v[152:155], a[148:151], a[164:167], v[152:155]
 s_waitcnt lgkmcnt(4)
M v[156:159], a[156:159], a[164:167], v[156:159]
 ds_read_b64_tr_b16 a[80:81], v3 offset:16384
 ds_read_b64_tr_b16 a[82:83], v3 offset:17408
M v[156:159], a[152:155], a[160:163], v[156:159]
 buffer_load_dwordx4 v10, s[16:19], s21 offen offset:2048  nt lds
M v[160:163], a[96:99], a[168:171], v[160:163]
 ds_read_b128 a[160:163], v5 offset:53248
 ds_read_b128 a[164:167], v6 offset:53248
M v[160:163], a[100:103], a[172:175], v[160:163]
M v[164:167], a[108:111], a[172:175], v[164:167]
M v[164:167], a[104:107], a[168:171], v[164:167]
M v[168:171], a[112:115], a[168:171], v[168:171]
 buffer_load_dwordx4 v11, s[16:19], s21 offen offset:3072  nt lds
M v[168:171], a[116:119], a[172:175], v[168:171]
 s_add_u32 s21, s21, 128
 ds_read_b64_tr_b16 a[84:85], v3 offset:24576
 ds_read_b64_tr_b16 a[86:87], v3 offset:25600
M v[172:175], a[124:127], a[172:175], v[172:175]
M v[172:175], a[120:123], a[168:171], v[172:175]
M v[176:179], a[128:131], a[168:171], v[176:179]
 s_add_u32 m0, s86, 0
M v[176:179], a[132:135], a[172:175], v[176:179]
 buffer_load_dwordx4 v7, s[60:63], s67 offen offset:0 nt lds
M v[180:183], a[140:143], a[172:175], v[180:183]
M v[180:183], a[136:139], a[168:171], v[180:183]
M v[184:187], a[144:147], a[168:171], v[184:187]
 ds_read_b64_tr_b16 a[88:89], v4 offset:16384
 ds_read_b64_tr_b16 a[90:91], v4 offset:17408
M v[184:187], a[148:151], a[172:175], v[184:187]
 s_waitcnt lgkmcnt(4)
M v[188:191], a[156:159], a[172:175], v[188:191]
 buffer_load_dwordx4 v7, s[60:63], s67 offen offset:1024 nt lds
M v[188:191], a[152:155], a[168:171], v[188:191]
M v[192:195], a[96:99], a[160:163], v[192:195]
 ds_read_b128 a[168:171], v5 offset:55296
 ds_read_b128 a[172:175], v6 offset:55296
M v[192:195], a[100:103], a[164:167], v[192:195]
M v[196:199], a[108:111], a[164:167], v[196:199]
 buffer_load_dwordx4 v7, s[60:63], s67 offen offset:2048 nt lds
M v[196:199], a[104:107], a[160:163], v[196:199]
 ds_read_b64_tr_b16 a[92:93], v4 offset:24576
 ds_read_b64_tr_b16 a[94:95], v4 offset:25600
M v[200:203], a[112:115], a[160:163], v[200:203]
M v[200:203], a[116:119], a[164:167], v[200:203]
M v[204:207], a[124:127], a[164:167], v[204:207]
M v[204:207], a[120:123], a[160:163], v[204:207]
 buffer_load_dwordx4 v7, s[60:63], s67 offen offset:3072 nt lds
M v[208:211], a[128:131], a[160:163], v[208:211]
 s_add_u32 s67, s67, 4096
M v[208:211], a[132:135], a[164:167], v[208:211]
M v[212:215], a[140:143], a[164:167], v[212:215]
M v[212:215], a[136:139], a[160:163], v[212:215]
M v[216:219], a[144:147], a[160:163], v[216:219]
M v[216:219], a[148:151], a[164:167], v[216:219]
 s_waitcnt lgkmcnt(2)
M v[220:223], a[156:159], a[164:167], v[220:223]
 s_waitcnt vmcnt(21) lgkmcnt(0)
M v[220:223], a[152:155], a[160:163], v[220:223]
 s_barrier
M v[224:227], a[96:99], a[168:171], v[224:227]
 ds_read_b128 a[160:163], v5 offset:0
 ds_read_b128 a[164:167], v6 offset:0
M v[224:227], a[100:103], a[172:175], v[224:227]
M v[228:231], a[108:111], a[172:175], v[228:231]
M v[228:231], a[104:107], a[168:171], v[228:231]
M v[232:235], a[112:115], a[168:171], v[232:235]
M v[232:235], a[116:119], a[172:175], v[232:235]
M v[236:239], a[124:127], a[172:175], v[236:239]
M v[236:239], a[120:123], a[168:171], v[236:239]
M v[240:243], a[128:131], a[168:171], v[240:243]
M v[240:243], a[132:135], a[172:175], v[240:243]
M v[244:247], a[140:143], a[172:175], v[244:247]
M v[244:247], a[136:139], a[168:171], v[244:247]
M v[248:251], a[144:147], a[168:171], v[248:251]
M v[248:251], a[148:151], a[172:175], v[248:251]
 s_waitcnt lgkmcnt(0)
M v[252:255], a[156:159], a[172:175], v[252:255]
M v[252:255], a[152:155], a[168:171], v[252:255]
M a[0:3], a[32:35], a[160:163], a[0:3]
 ds_read_b128 a[168:171], v5 offset:2048
 ds_read_b128 a[172:175], v6 offset:2048
M a[0:3], a[36:39], a[164:167], a[0:3]
 ds_read_b64_tr_b16 a[96:97], v1 offset:32768
 ds_read_b64_tr_b16 a[98:99], v1 offset:33792
M a[4:7], a[44:47], a[164:167], a[4:7]
 s_add_u32 m0, s24, 49152
M a[4:7], a[40:43], a[160:163], a[4:7]
 buffer_load_dwordx4 v12, s[48:51], s22 offen offset:0   lds
M a[8:11], a[48:51], a[160:163], a[8:11]
M a[8:11], a[52:55], a[164:167], a[8:11]
M a[12:15], a[60:63], a[164:167], a[12:15]
 ds_read_b64_tr_b16 a[100:101], v1 offset:40960
 ds_read_b64_tr_b16 a[102:103], v1 offset:41984
M a[12:15], a[56:59], a[160:163], a[12:15]
M a[16:19], a[64:67], a[160:163], a[16:19]
 buffer_load_dwordx4 v13, s[48:51], s22 offen offset:1024   lds
M a[16:19], a[68:71], a[164:167], a[16:19]
M a[20:23], a[76:79], a[164:167], a[20:23]
M a[20:23], a[72:75], a[160:163], a[20:23]
 ds_read_b64_tr_b16 a[104:105], v2 offset:32768
 ds_read_b64_tr_b16 a[106:107], v2 offset:33792
M a[24:27], a[80:83], a[160:163], a[24:27]
M a[24:27], a[84:87], a[164:167], a[24:27]
 s_waitcnt lgkmcnt(6)
M a[28:31], a[92:95], a[164:167], a[28:31]
 buffer_load_dwordx4 v14, s[48:51], s22 offen offset:2048   lds
M a[28:31], a[88:91], a[160:163], a[28:31]
M v[32:35], a[32:35], a[168:171], v[32:35]
 ds_read_b128 a[160:163], v5 offset:4096
 ds_read_b128 a[164:167], v6 offset:4096
M v[32:35], a[36:39], a[172:175], v[32:35]
 ds_read_b64_tr_b16 a[108:109], v2 offset:40960
 ds_read_b64_tr_b16 a[110:111], v2 offset:41984
M v[36:39], a[44:47], a[172:175], v[36:39]
 buffer_load_dwordx4 v15, s[48:51], s22 offen offset:3072   lds
M v[36:39], a[40:43], a[168:171], v[36:39]
 s_sub_u32 s22, s22, 2097024
M v[40:43], a[48:51], a[168:171], v[40:43]
M v[40:43], a[52:55], a[172:175], v[40:43]
 ds_read_b64_tr_b16 a[112:113], v3 offset:32768
 ds_read_b64_tr_b16 a[114:115], v3 offset:33792
M v[44:47], a[60:63], a[172:175], v[44:47]
 s_add_u32 m0, s23, 16384
M v[44:47], a[56:59], a[168:171], v[44:47]
 buffer_load_dwordx4 v8, s[16:19], s21 offen offset:0  nt lds
M v[48:51], a[64:67], a[168:171], v[48:51]
M v[48:51], a[68:71], a[172:175], v[48:51]
M v[52:55], a[76:79], a[172:175], v[52:55]
 ds_read_b64_tr_b16 a[116:117], v3 offset:40960
 ds_read_b64_tr_b16 a[118:119], v3 offset:41984
M v[52:55], a[72:75], a[168:171], v[52:55]
M v[56:59], a[80:83], a[168:171], v[56:59]
 buffer_load_dwordx4 v9, s[16:19], s21 offen offset:1024  nt lds
M v[56:59], a[84:87], a[172:175], v[56:59]
 s_waitcnt lgkmcnt(6)
M v[60:63], a[92:95], a[172:175], v[60:63]
M v[60:63], a[88:91], a[168:171], v[60:63]
 ds_read_b64_tr_b16 a[120:121], v4 offset:32768
 ds_read_b64_tr_b16 a[122:123], v4 offset:33792
M v[64:67], a[32:35], a[160:163], v[64:67]
 ds_read_b128 a[168:171], v5 offset:6144
 ds_read_b128 a[172:175], v6 offset:6144
M v[64:67], a[36:39], a[164:167], v[64:67]
 buffer_load_dwordx4 v10, s[16:19], s21 offen offset:2048  nt lds
M v[68:71], a[44:47], a[164:167], v[68:71]
M v[68:71], a[40:43], a[160:163], v[68:71]
M v[72:75], a[48:51], a[160:163], v[72:75]
 ds_read_b64_tr_b16 a[124:125], v4 offset:40960
 ds_read_b64_tr_b16 a[126:127], v4 offset:41984
M v[72:75], a[52:55], a[164:167], v[72:75]
M v[76:79], a[60:63], a[164:167], v[76:79]
 buffer_load_dwordx4 v11, s[16:19], s21 offen offset:3072  nt lds
M v[76:79], a[56:59], a[160:163], v[76:79]
 s_add_u32 s21, s21, 524160
M v[80:83], a[64:67], a[160:163], v[80:83]
M v[80:83], a[68:71], a[164:167], v[80:83]
M v[84:87], a[76:79], a[164:167], v[84:87]
M v[84:87], a[72:75], a[160:163], v[84:87]
M v[88:91], a[80:83], a[160:163], v[88:91]
M v[88:91], a[84:87], a[164:167], v[88:91]
 s_waitcnt lgkmcnt(2)
M v[92:95], a[92:95], a[164:167], v[92:95]
 s_waitcnt vmcnt(20) lgkmcnt(0)
M v[92:95], a[88:91], a[160:163], v[92:95]
 s_barrier
M v[96:99], a[32:35], a[168:171], v[96:99]
 ds_read_b128 a[160:163], v5 offset:16384
 ds_read_b128 a[164:167], v6 offset:16384
M v[96:99], a[36:39], a[172:175], v[96:99]
M v[100:103], a[44:47], a[172:175], v[100:103]
 s_add_u32 m0, s24, 0
 ds_read_b64_tr_b16 a[128:129], v1 offset:49152
 ds_read_b64_tr_b16 a[130:131], v1 offset:50176
M v[100:103], a[40:43], a[168:171], v[100:103]
 buffer_load_dwordx4 v12, s[48:51], s22 offen offset:0   lds
M v[104:107], a[48:51], a[168:171], v[104:107]
M v[104:107], a[52:55], a[172:175], v[104:107]
M v[108:111], a[60:63], a[172:175], v[108:111]
M v[108:111], a[56:59], a[168:171], v[108:111]
M v[112:115], a[64:67], a[168:171], v[112:115]
 buffer_load_dwordx4 v13, s[48:51], s22 offen offset:1024   lds
M v[112:115], a[68:71], a[172:175], v[112:115]
 ds_read_b64_tr_b16 a[132:133], v1 offset:57344
 ds_read_b64_tr_b16 a[134:135], v1 offset:58368
M v[116:119], a[76:79], a[172:175], v[116:119]
M v[116:119], a[72:75], a[168:171], v[116:119]
M v[120:123], a[80:83], a[168:171], v[120:123]
M v[120:123], a[84:87], a[172:175], v[120:123]
 s_waitcnt lgkmcnt(4)
M v[124:127], a[92:95], a[172:175], v[124:127]
 buffer_load_dwordx4 v14, s[48:51], s22 offen offset:2048   lds
M v[124:127], a[88:91], a[168:171], v[124:127]
M v[128:131], a[32:35], a[160:163], v[128:131]
 ds_read_b128 a[168:171], v5 offset:18432
 ds_read_b128 a[172:175], v6 offset:18432
M v[128:131], a[36:39], a[164:167], v[128:131]
 ds_read_b64_tr_b16 a[136:137], v2 offset:49152
 ds_read_b64_tr_b16 a[138:139], v2 offset:50176
M v[132:135], a[44:47], a[164:167], v[132:135]
 buffer_load_dwordx4 v15, s[48:51], s22 offen offset:3072   lds
M v[132:135], a[40:43], a[160:163], v[132:135]
 s_add_u32 s22, s22, 2097152
M v[136:139], a[48:51], a[160:163], v[136:139]
M v[136:139], a[52:55], a[164:167], v[136:139]
M v[140:143], a[60:63], a[164:167], v[140:143]
 s_add_u32 m0, s23, 32768
M v[140:143], a[56:59], a[160:163], v[140:143]
 ds_read_b64_tr_b16 a[140:141], v2 offset:57344
 ds_read_b64_tr_b16 a[142:143], v2 offset:58368
M v[144:147], a[64:67], a[160:163], v[144:147]
 buffer_load_dwordx4 v8, s[16:19], s21 offen offset:0  nt lds
M v[144:147], a[68:71], a[164:167], v[144:147]
M v[148:151], a[76:79], a[164:167], v[148:151]
M v[148:151], a[72:75], a[160:163], v[148:151]
M v[152:155], a[80:83], a[160:163], v[152:155]
 buffer_load_dwordx4 v9, s[16:19], s21 offen offset:1024  nt lds
M v[152:155], a[84:87], a[164:167], v[152:155]
 s_waitcnt lgkmcnt(4)
M v[156:159], a[92:95], a[164:167], v[156:159]
 ds_read_b64_tr_b16 a[144:145], v3 offset:49152
 ds_read_b64_tr_b16 a[146:147], v3 offset:50176
M v[156:159], a[88:91], a[160:163], v[156:159]
M v[160:163], a[32:35], a[168:171], v[160:163]
 ds_read_b128 a[160:163], v5 offset:20480
 ds_read_b128 a[164:167], v6 offset:20480
M v[160:163], a[36:39], a[172:175], v[160:163]
M v[164:167], a[44:47], a[172:175], v[164:167]
 buffer_load_dwordx4 v10, s[16:19], s21 offen offset:2048  nt lds
M v[164:167], a[40:43], a[168:171], v[164:167]
M v[168:171], a[48:51], a[168:171], v[168:171]
M v[168:171], a[52:55], a[172:175], v[168:171]
 ds_read_b64_tr_b16 a[148:149], v3 offset:57344
 ds_read_b64_tr_b16 a[150:151], v3 offset:58368
M v[172:175], a[60:63], a[172:175], v[172:175]
M v[172:175], a[56:59], a[168:171], v[172:175]
 buffer_load_dwordx4 v11, s[16:19], s21 offen offset:3072  nt lds
M v[176:179], a[64:67], a[168:171], v[176:179]
 s_add_u32 s21, s21, 128
M v[176:179], a[68:71], a[172:175], v[176:179]
M v[180:183], a[76:79], a[172:175], v[180:183]
M v[180:183], a[72:75], a[168:171], v[180:183]
 s_add_u32 m0, s86, 4096
M v[184:187], a[80:83], a[168:171], v[184:187]
 ds_read_b64_tr_b16 a[152:153], v4 offset:49152
 ds_read_b64_tr_b16 a[154:155], v4 offset:50176
M v[184:187], a[84:87], a[172:175], v[184:187]
 s_waitcnt lgkmcnt(4)
M v[188:191], a[92:95], a[172:175], v[188:191]
 buffer_load_dwordx4 v7, s[60:63], s67 offen offset:0 nt lds
M v[188:191], a[88:91], a[168:171], v[188:191]
M v[192:195], a[32:35], a[160:163], v[192:195]
 ds_read_b128 a[168:171], v5 offset:22528
 ds_read_b128 a[172:175], v6 offset:22528
M v[192:195], a[36:39], a[164:167], v[192:195]
 buffer_load_dwordx4 v7, s[60:63], s67 offen offset:1024 nt lds
M v[196:199], a[44:47], a[164:167], v[196:199]
M v[196:199], a[40:43], a[160:163], v[196:199]
 ds_read_b64_tr_b16 a[156:157], v4 offset:57344
 ds_read_b64_tr_b16 a[158:159], v4 offset:58368
M v[200:203], a[48:51], a[160:163], v[200:203]
M v[200:203], a[52:55], a[164:167], v[200:203]
M v[204:207], a[60:63], a[164:167], v[204:207]
 buffer_load_dwordx4 v7, s[60:63], s67 offen offset:2048 nt lds
M v[204:207], a[56:59], a[160:163], v[204:207]
 s_add_u32 s67, s67, 4096
M v[208:211], a[64:67], a[160:163], v[208:211]
M v[208:211], a[68:71], a[164:167], v[208:211]
M v[212:215], a[76:79], a[164:167], v[212:215]
M v[212:215], a[72:75], a[160:163], v[212:215]
M v[216:219], a[80:83], a[160:163], v[216:219]
M v[216:219], a[84:87], a[164:167], v[216:219]
 s_waitcnt lgkmcnt(2)
M v[220:223], a[92:95], a[164:167], v[220:223]
 s_waitcnt vmcnt(23) lgkmcnt(0)
M v[220:223], a[88:91], a[160:163], v[220:223]
 s_barrier
M v[224:227], a[32:35], a[168:171], v[224:227]
 ds_read_b128 a[160:163], v5 offset:32768
 ds_read_b128 a[164:167], v6 offset:32768
M v[224:227], a[36:39], a[172:175], v[224:227]
 v_and_b32 v26, 48, v0
 v_lshlrev_b32 v26, 17, v26
M v[228:231], a[44:47], a[172:175], v[228:231]
 v_or_b32 v26, v26, v0
 v_lshl_add_u32 v26, v26, 7, s95
M v[228:231], a[40:43], a[168:171], v[228:231]
 buffer_load_dword a240, v26, s[76:79], 0 offen offset:0
M v[232:235], a[48:51], a[168:171], v[232:235]
M v[232:235], a[52:55], a[172:175], v[232:235]
M v[236:239], a[60:63], a[172:175], v[236:239]
M v[236:239], a[56:59], a[168:171], v[236:239]
M v[240:243], a[64:67], a[168:171], v[240:243]
M v[240:243], a[68:71], a[172:175], v[240:243]
M v[244:247], a[76:79], a[172:175], v[244:247]
M v[244:247], a[72:75], a[168:171], v[244:247]
M v[248:251], a[80:83], a[168:171], v[248:251]
M v[248:251], a[84:87], a[172:175], v[248:251]
 s_waitcnt lgkmcnt(0)
M v[252:255], a[92:95], a[172:175], v[252:255]
M v[252:255], a[88:91], a[168:171], v[252:255]
M a[0:3], a[96:99], a[160:163], a[0:3]
 ds_read_b128 a[168:171], v5 offset:34816
 ds_read_b128 a[172:175], v6 offset:34816
M a[0:3], a[100:103], a[164:167], a[0:3]
 ds_read_b64_tr_b16 a[32:33], v1 offset:0
 ds_read_b64_tr_b16 a[34:35], v1 offset:1024
M a[4:7], a[108:111], a[164:167], a[4:7]
 s_add_u32 m0, s24, 16384
M a[4:7], a[104:107], a[160:163], a[4:7]
 buffer_load_dwordx4 v12, s[48:51], s22 offen offset:0   lds
M a[8:11], a[112:115], a[160:163], a[8:11]
M a[8:11], a[116:119], a[164:167], a[8:11]
M a[12:15], a[124:127], a[164:167], a[12:15]
 ds_read_b64_tr_b16 a[36:37], v1 offset:8192
 ds_read_b64_tr_b16 a[38:39], v1 offset:9216
M a[12:15], a[120:123], a[160:163], a[12:15]
M a[16:19], a[128:131], a[160:163], a[16:19]
 buffer_load_dwordx4 v13, s[48:51], s22 offen offset:1024   lds
M a[16:19], a[132:135], a[164:167], a[16:19]
M a[20:23], a[140:143], a[164:167], a[20:23]
M a[20:23], a[136:139], a[160:163], a[20:23]
 ds_read_b64_tr_b16 a[40:41], v2 offset:0
 ds_read_b64_tr_b16 a[42:43], v2 offset:1024
M a[24:27], a[144:147], a[160:163], a[24:27]
M a[24:27], a[148:151], a[164:167], a[24:27]
 s_waitcnt lgkmcnt(6)
M a[28:31], a[156:159], a[164:167], a[28:31]
 buffer_load_dwordx4 v14, s[48:51], s22 offen offset:2048   lds
M a[28:31], a[152:155], a[160:163], a[28:31]
M v[32:35], a[96:99], a[168:171], v[32:35]
 ds_read_b128 a[160:163], v5 offset:36864
 ds_read_b128 a[164:167], v6 offset:36864
M v[32:35], a[100:103], a[172:175], v[32:35]
 ds_read_b64_tr_b16 a[44:45], v2 offset:8192
 ds_read_b64_tr_b16 a[46:47], v2 offset:9216
M v[36:39], a[108:111], a[172:175], v[36:39]
 buffer_load_dwordx4 v15, s[48:51], s22 offen offset:3072   lds
M v[36:39], a[104:107], a[168:171], v[36:39]
 s_sub_u32 s22, s22, 2097024
M v[40:43], a[112:115], a[168:171], v[40:43]
M v[40:43], a[116:119], a[172:175], v[40:43]
 ds_read_b64_tr_b16 a[48:49], v3 offset:0
 ds_read_b64_tr_b16 a[50:51], v3 offset:1024
M v[44:47], a[124:127], a[172:175], v[44:47]
 s_add_u32 m0, s23, 49152
M v[44:47], a[120:123], a[168:171], v[44:47]
 buffer_load_dwordx4 v8, s[16:19], s21 offen offset:0  nt lds
M v[48:51], a[128:131], a[168:171], v[48:51]
M v[48:51], a[132:135], a[172:175], v[48:51]
M v[52:55], a[140:143], a[172:175], v[52:55]
 ds_read_b64_tr_b16 a[52:53], v3 offset:8192
 ds_read_b64_tr_b16 a[54:55], v3 offset:9216
M v[52:55], a[136:139], a[168:171], v[52:55]
M v[56:59], a[144:147], a[168:171], v[56:59]
 buffer_load_dwordx4 v9, s[16:19], s21 offen offset:1024  nt lds
M v[56:59], a[148:151], a[172:175], v[56:59]
 s_waitcnt lgkmcnt(6)
M v[60:63], a[156:159], a[172:175], v[60:63]
M v[60:63], a[152:155], a[168:171], v[60:63]
 ds_read_b64_tr_b16 a[56:57], v4 offset:0
 ds_read_b64_tr_b16 a[58:59], v4 offset:1024
M v[64:67], a[96:99], a[160:163], v[64:67]
 ds_read_b128 a[168:171], v5 offset:38912
 ds_read_b128 a[172:175], v6 offset:38912
M v[64:67], a[100:103], a[164:167], v[64:67]
 buffer_load_dwordx4 v10, s[16:19], s21 offen offset:2048  nt lds
M v[68:71], a[108:111], a[164:167], v[68:71]
M v[68:71], a[104:107], a[160:163], v[68:71]
M v[72:75], a[112:115], a[160:163], v[72:75]
 ds_read_b64_tr_b16 a[60:61], v4 offset:8192
 ds_read_b64_tr_b16 a[62:63], v4 offset:9216
M v[72:75], a[116:119], a[164:167], v[72:75]
M v[76:79], a[124:127], a[164:167], v[76:79]
 buffer_load_dwordx4 v11, s[16:19], s21 offen offset:3072  nt lds
M v[76:79], a[120:123], a[160:163], v[76:79]
 s_add_u32 s21, s21, 524160
M v[80:83], a[128:131], a[160:163], v[80:83]
M v[80:83], a[132:135], a[164:167], v[80:83]
M v[84:87], a[140:143], a[164:167], v[84:87]
M v[84:87], a[136:139], a[160:163], v[84:87]
M v[88:91], a[144:147], a[160:163], v[88:91]
M v[88:91], a[148:151], a[164:167], v[88:91]
 s_waitcnt lgkmcnt(2)
M v[92:95], a[156:159], a[164:167], v[92:95]
 s_waitcnt vmcnt(20) lgkmcnt(0)
M v[92:95], a[152:155], a[160:163], v[92:95]
 s_barrier
M v[96:99], a[96:99], a[168:171], v[96:99]
 ds_read_b128 a[160:163], v5 offset:49152
 ds_read_b128 a[164:167], v6 offset:49152
M v[96:99], a[100:103], a[172:175], v[96:99]
M v[100:103], a[108:111], a[172:175], v[100:103]
 s_add_u32 m0, s24, 32768
 ds_read_b64_tr_b16 a[64:65], v1 offset:16384
 ds_read_b64_tr_b16 a[66:67], v1 offset:17408
M v[100:103], a[104:107], a[168:171], v[100:103]
 buffer_load_dwordx4 v12, s[48:51], s22 offen offset:0   lds
M v[104:107], a[112:115], a[168:171], v[104:107]
M v[104:107], a[116:119], a[172:175], v[104:107]
M v[108:111], a[124:127], a[172:175], v[108:111]
M v[108:111], a[120:123], a[168:171], v[108:111]
M v[112:115], a[128:131], a[168:171], v[112:115]
M v[112:115], a[132:135], a[172:175], v[112:115]
 ds_read_b64_tr_b16 a[68:69], v1 offset:24576
 ds_read_b64_tr_b16 a[70:71], v1 offset:25600
M v[116:119], a[140:143], a[172:175], v[116:119]
 buffer_load_dwordx4 v13, s[48:51], s22 offen offset:1024   lds
M v[116:119], a[136:139], a[168:171], v[116:119]
M v[120:123], a[144:147], a[168:171], v[120:123]
M v[120:123], a[148:151], a[172:175], v[120:123]
 s_waitcnt lgkmcnt(4)
M v[124:127], a[156:159], a[172:175], v[124:127]
M v[124:127], a[152:155], a[168:171], v[124:127]
M v[128:131], a[96:99], a[160:163], v[128:131]
 ds_read_b128 a[168:171], v5 offset:51200
 ds_read_b128 a[172:175], v6 offset:51200
M v[128:131], a[100:103], a[164:167], v[128:131]
 ds_read_b64_tr_b16 a[72:73], v2 offset:16384
 ds_read_b64_tr_b16 a[74:75], v2 offset:17408
M v[132:135], a[108:111], a[164:167], v[132:135]
 buffer_load_dwordx4 v14, s[48:51], s22 offen offset:2048   lds
M v[132:135], a[104:107], a[160:163], v[132:135]
M v[136:139], a[112:115], a[160:163], v[136:139]
M v[136:139], a[116:119], a[164:167], v[136:139]
M v[140:143], a[124:127], a[164:167], v[140:143]
M v[140:143], a[120:123], a[160:163], v[140:143]
 ds_read_b64_tr_b16 a[76:77], v2 offset:24576
 ds_read_b64_tr_b16 a[78:79], v2 offset:25600
M v[144:147], a[128:131], a[160:163], v[144:147]
 buffer_load_dwordx4 v15, s[48:51], s22 offen offset:3072   lds
M v[144:147], a[132:135], a[164:167], v[144:147]
 s_add_u32 s22, s22, 2097152
M v[148:151], a[140:143], a[164:167], v[148:151]
M v[148:151], a[136:139], a[160:163], v[148:151]
M v[152:155], a[144:147], a[160:163], v[152:155]
M v[152:155], a[148:151], a[164:167], v[152:155]
 s_waitcnt lgkmcnt(4)
M v[156:159], a[156:159], a[164:167], v[156:159]
 s_add_u32 m0, s23, 0
 ds_read_b64_tr_b16 a[80:81], v3 offset:16384
 ds_read_b64_tr_b16 a[82:83], v3 offset:17408
M v[156:159], a[152:155], a[160:163], v[156:159]
 buffer_load_dwordx4 v8, s[16:19], s21 offen offset:0  nt lds
M v[160:163], a[96:99], a[168:171], v[160:163]
 ds_read_b128 a[160:163], v5 offset:53248
 ds_read_b128 a[164:167], v6 offset:53248
M v[160:163], a[100:103], a[172:175], v[160:163]
M v[164:167], a[108:111], a[172:175], v[164:167]
M v[164:167], a[104:107], a[168:171], v[164:167]
M v[168:171], a[112:115], a[168:171], v[168:171]
M v[168:171], a[116:119], a[172:175], v[168:171]
 ds_read_b64_tr_b16 a[84:85], v3 offset:24576
 ds_read_b64_tr_b16 a[86:87], v3 offset:25600
M v[172:175], a[124:127], a[172:175], v[172:175]
 buffer_load_dwordx4 v9, s[16:19], s21 offen offset:1024  nt lds
M v[172:175], a[120:123], a[168:171], v[172:175]
M v[176:179], a[128:131], a[168:171], v[176:179]
M v[176:179], a[132:135], a[172:175], v[176:179]
M v[180:183], a[140:143], a[172:175], v[180:183]
M v[180:183], a[136:139], a[168:171], v[180:183]
M v[184:187], a[144:147], a[168:171], v[184:187]
 ds_read_b64_tr_b16 a[88:89], v4 offset:16384
 ds_read_b64_tr_b16 a[90:91], v4 offset:17408
M v[184:187], a[148:151], a[172:175], v[184:187]
 s_waitcnt lgkmcnt(4)
M v[188:191], a[156:159], a[172:175], v[188:191]
 buffer_load_dwordx4 v10, s[16:19], s21 offen offset:2048  nt lds
M v[188:191], a[152:155], a[168:171], v[188:191]
M v[192:195], a[96:99], a[160:163], v[192:195]
 ds_read_b128 a[168:171], v5 offset:55296
 ds_read_b128 a[172:175], v6 offset:55296
M v[192:195], a[100:103], a[164:167], v[192:195]
M v[196:199], a[108:111], a[164:167], v[196:199]
M v[196:199], a[104:107], a[160:163], v[196:199]
 ds_read_b64_tr_b16 a[92:93], v4 offset:24576
 ds_read_b64_tr_b16 a[94:95], v4 offset:25600
M v[200:203], a[112:115], a[160:163], v[200:203]
 buffer_load_dwordx4 v11, s[16:19], s21 offen offset:3072  nt lds
M v[200:203], a[116:119], a[164:167], v[200:203]
 s_add_u32 s21, s21, 128
M v[204:207], a[124:127], a[164:167], v[204:207]
M v[204:207], a[120:123], a[160:163], v[204:207]
M v[208:211], a[128:131], a[160:163], v[208:211]
M v[208:211], a[132:135], a[164:167], v[208:211]
M v[212:215], a[140:143], a[164:167], v[212:215]
M v[212:215], a[136:139], a[160:163], v[212:215]
M v[216:219], a[144:147], a[160:163], v[216:219]
M v[216:219], a[148:151], a[164:167], v[216:219]
 s_waitcnt lgkmcnt(2)
M v[220:223], a[156:159], a[164:167], v[220:223]
 s_waitcnt vmcnt(17) lgkmcnt(0)
M v[220:223], a[152:155], a[160:163], v[220:223]
 s_barrier
M v[224:227], a[96:99], a[168:171], v[224:227]
 ds_read_b128 a[160:163], v5 offset:0
 ds_read_b128 a[164:167], v6 offset:0
M v[224:227], a[100:103], a[172:175], v[224:227]
M v[228:231], a[108:111], a[172:175], v[228:231]
M v[228:231], a[104:107], a[168:171], v[228:231]
M v[232:235], a[112:115], a[168:171], v[232:235]
M v[232:235], a[116:119], a[172:175], v[232:235]
M v[236:239], a[124:127], a[172:175], v[236:239]
M v[236:239], a[120:123], a[168:171], v[236:239]
M v[240:243], a[128:131], a[168:171], v[240:243]
M v[240:243], a[132:135], a[172:175], v[240:243]
M v[244:247], a[140:143], a[172:175], v[244:247]
M v[244:247], a[136:139], a[168:171], v[244:247]
M v[248:251], a[144:147], a[168:171], v[248:251]
M v[248:251], a[148:151], a[172:175], v[248:251]
 s_waitcnt lgkmcnt(0)
M v[252:255], a[156:159], a[172:175], v[252:255]
M v[252:255], a[152:155], a[168:171], v[252:255]
M a[0:3], a[32:35], a[160:163], a[0:3]
 ds_read_b128 a[168:171], v5 offset:2048
 ds_read_b128 a[172:175], v6 offset:2048
M a[0:3], a[36:39], a[164:167], a[0:3]
 ds_read_b64_tr_b16 a[96:97], v1 offset:32768
 ds_read_b64_tr_b16 a[98:99], v1 offset:33792
M a[4:7], a[44:47], a[164:167], a[4:7]
 s_add_u32 m0, s24, 49152
 v_lshrrev_b32 v28, 2, v0
M a[4:7], a[40:43], a[160:163], a[4:7]
 buffer_load_dwordx4 v12, s[48:51], s22 offen offset:0   lds
M a[8:11], a[48:51], a[160:163], a[8:11]
 v_mul_u32_u24 v28, 896, v28
M a[8:11], a[52:55], a[164:167], a[8:11]
M a[12:15], a[60:63], a[164:167], a[12:15]
 ds_read_b64_tr_b16 a[100:101], v1 offset:40960
 ds_read_b64_tr_b16 a[102:103], v1 offset:41984
M a[12:15], a[56:59], a[160:163], a[12:15]
 v_and_b32 v29, 3, v0
M a[16:19], a[64:67], a[160:163], a[16:19]
 buffer_load_dwordx4 v13, s[48:51], s22 offen offset:1024   lds
M a[16:19], a[68:71], a[164:167], a[16:19]
 v_lshl_add_u32 v28, v29, 4, v28
M a[20:23], a[76:79], a[164:167], a[20:23]
M a[20:23], a[72:75], a[160:163], a[20:23]
 s_lshr_b32 s64, s20, 1
 ds_read_b64_tr_b16 a[104:105], v2 offset:32768
 ds_read_b64_tr_b16 a[106:107], v2 offset:33792
M a[24:27], a[80:83], a[160:163], a[24:27]
 s_lshl_b32 s64, s64, 6
 s_and_b32 s72, s20, 1
 s_lshl_b32 s72, s72, 3
M a[24:27], a[84:87], a[164:167], a[24:27]
 s_waitcnt lgkmcnt(6)
 s_add_u32 s64, s64, s72
 s_add_u32 s64, s64, 131072
M a[28:31], a[92:95], a[164:167], a[28:31]
 buffer_load_dwordx4 v14, s[48:51], s22 offen offset:2048   lds
M a[28:31], a[88:91], a[160:163], a[28:31]
 v_add_u32 v28, s64, v28
M v[32:35], a[32:35], a[168:171], v[32:35]
 ds_read_b128 a[160:163], v5 offset:4096
 ds_read_b128 a[164:167], v6 offset:4096
M v[32:35], a[36:39], a[172:175], v[32:35]
 s_lshl_b32 s94, s41, 18
 ds_read_b64_tr_b16 a[108:109], v2 offset:40960
 ds_read_b64_tr_b16 a[110:111], v2 offset:41984
M v[36:39], a[44:47], a[172:175], v[36:39]
 buffer_load_dwordx4 v15, s[48:51], s22 offen offset:3072   lds
M v[36:39], a[40:43], a[168:171], v[36:39]
 s_sub_u32 s22, s22, 2097024
 s_and_b32 s64, s42, 7
M v[40:43], a[48:51], a[168:171], v[40:43]
 s_lshl_b32 s64, s64, 10
M v[40:43], a[52:55], a[172:175], v[40:43]
 s_add_u32 s94, s94, s64
 ds_read_b64_tr_b16 a[112:113], v3 offset:32768
 ds_read_b64_tr_b16 a[114:115], v3 offset:33792
M v[44:47], a[60:63], a[172:175], v[44:47]
 s_add_u32 m0, s23, 16384
 s_lshl_b32 s64, s20, 13
 s_add_u32 s94, s94, s64
M v[44:47], a[56:59], a[168:171], v[44:47]
 buffer_load_dwordx4 v8, s[16:19], s21 offen offset:0  nt lds
M v[48:51], a[64:67], a[168:171], v[48:51]
 s_add_u32 s94, s94, 100663296
 ds_read_b64_tr_b16 a[192:193], v28 offset:0
M v[48:51], a[68:71], a[172:175], v[48:51]
M v[52:55], a[76:79], a[172:175], v[52:55]
 ds_read_b64_tr_b16 a[116:117], v3 offset:40960
 ds_read_b64_tr_b16 a[118:119], v3 offset:41984
M v[52:55], a[72:75], a[168:171], v[52:55]
 ds_read_b64_tr_b16 a[194:195], v28 offset:14336
M v[56:59], a[80:83], a[168:171], v[56:59]
 buffer_load_dwordx4 v9, s[16:19], s21 offen offset:1024  nt lds
M v[56:59], a[84:87], a[172:175], v[56:59]
 s_waitcnt lgkmcnt(8)
 ds_read_b64_tr_b16 a[196:197], v28 offset:128
M v[60:63], a[92:95], a[172:175], v[60:63]
M v[60:63], a[88:91], a[168:171], v[60:63]
 ds_read_b64_tr_b16 a[120:121], v4 offset:32768
 ds_read_b64_tr_b16 a[122:123], v4 offset:33792
M v[64:67], a[32:35], a[160:163], v[64:67]
 ds_read_b128 a[168:171], v5 offset:6144
 ds_read_b128 a[172:175], v6 offset:6144
M v[64:67], a[36:39], a[164:167], v[64:67]
 buffer_load_dwordx4 v10, s[16:19], s21 offen offset:2048  nt lds
M v[68:71], a[44:47], a[164:167], v[68:71]
 ds_read_b64_tr_b16 a[198:199], v28 offset:14464
M v[68:71], a[40:43], a[160:163], v[68:71]
M v[72:75], a[48:51], a[160:163], v[72:75]
 ds_read_b64_tr_b16 a[124:125], v4 offset:40960
 ds_read_b64_tr_b16 a[126:127], v4 offset:41984
M v[72:75], a[52:55], a[164:167], v[72:75]
 ds_read_b64_tr_b16 a[200:201], v28 offset:256
M v[76:79], a[60:63], a[164:167], v[76:79]
 buffer_load_dwordx4 v11, s[16:19], s21 offen offset:3072  nt lds
M v[76:79], a[56:59], a[160:163], v[76:79]
 s_add_u32 s21, s21, 524160
 ds_read_b64_tr_b16 a[202:203], v28 offset:14592
M v[80:83], a[64:67], a[160:163], v[80:83]
M v[80:83], a[68:71], a[164:167], v[80:83]
 ds_read_b64_tr_b16 a[204:205], v28 offset:384
M v[84:87], a[76:79], a[164:167], v[84:87]
M v[84:87], a[72:75], a[160:163], v[84:87]
 ds_read_b64_tr_b16 a[206:207], v28 offset:14720
M v[88:91], a[80:83], a[160:163], v[88:91]
M v[88:91], a[84:87], a[164:167], v[88:91]
 s_waitcnt lgkmcnt(7)
 ds_read_b64_tr_b16 a[208:209], v28 offset:512
M v[92:95], a[92:95], a[164:167], v[92:95]
 s_waitcnt vmcnt(16) lgkmcnt(0)
M v[92:95], a[88:91], a[160:163], v[92:95]
 s_barrier
M v[96:99], a[32:35], a[168:171], v[96:99]
 ds_read_b128 a[160:163], v5 offset:16384
 ds_read_b128 a[164:167], v6 offset:16384
M v[96:99], a[36:39], a[172:175], v[96:99]
 ds_read_b64_tr_b16 a[210:211], v28 offset:14848
M v[100:103], a[44:47], a[172:175], v[100:103]
 s_add_u32 m0, s24, 0
 ds_read_b64_tr_b16 a[128:129], v1 offset:49152
 ds_read_b64_tr_b16 a[130:131], v1 offset:50176
M v[100:103], a[40:43], a[168:171], v[100:103]
 buffer_load_dwordx4 v12, s[48:51], s22 offen offset:0   lds
M v[104:107], a[48:51], a[168:171], v[104:107]
 ds_read_b64_tr_b16 a[212:213], v28 offset:640
M v[104:107], a[52:55], a[172:175], v[104:107]
M v[108:111], a[60:63], a[172:175], v[108:111]
 ds_read_b64_tr_b16 a[214:215], v28 offset:14976
M v[108:111], a[56:59], a[168:171], v[108:111]
M v[112:115], a[64:67], a[168:171], v[112:115]
 ds_read_b64_tr_b16 a[216:217], v28 offset:768
M v[112:115], a[68:71], a[172:175], v[112:115]
 ds_read_b64_tr_b16 a[132:133], v1 offset:57344
 ds_read_b64_tr_b16 a[134:135], v1 offset:58368
M v[116:119], a[76:79], a[172:175], v[116:119]
 buffer_load_dwordx4 v13, s[48:51], s22 offen offset:1024   lds
M v[116:119], a[72:75], a[168:171], v[116:119]
 ds_read_b64_tr_b16 a[218:219], v28 offset:15104
M v[120:123], a[80:83], a[168:171], v[120:123]
M v[120:123], a[84:87], a[172:175], v[120:123]
 s_waitcnt lgkmcnt(9)
M v[124:127], a[92:95], a[172:175], v[124:127]
M v[124:127], a[88:91], a[168:171], v[124:127]
M v[128:131], a[32:35], a[160:163], v[128:131]
 ds_read_b128 a[168:171], v5 offset:18432
 ds_read_b128 a[172:175], v6 offset:18432
M v[128:131], a[36:39], a[164:167], v[128:131]
 ds_read_b64_tr_b16 a[136:137], v2 offset:49152
 ds_read_b64_tr_b16 a[138:139], v2 offset:50176
M v[132:135], a[44:47], a[164:167], v[132:135]
 buffer_load_dwordx4 v14, s[48:51], s22 offen offset:2048   lds
M v[132:135], a[40:43], a[160:163], v[132:135]
M v[136:139], a[48:51], a[160:163], v[136:139]
M v[136:139], a[52:55], a[164:167], v[136:139]
M v[140:143], a[60:63], a[164:167], v[140:143]
M v[140:143], a[56:59], a[160:163], v[140:143]
 ds_read_b64_tr_b16 a[140:141], v2 offset:57344
 ds_read_b64_tr_b16 a[142:143], v2 offset:58368
M v[144:147], a[64:67], a[160:163], v[144:147]
 buffer_load_dwordx4 v15, s[48:51], s22 offen offset:3072   lds
M v[144:147], a[68:71], a[164:167], v[144:147]
 s_add_u32 s22, s22, 2097152
M v[148:151], a[76:79], a[164:167], v[148:151]
M v[148:151], a[72:75], a[160:163], v[148:151]
M v[152:155], a[80:83], a[160:163], v[152:155]
M v[152:155], a[84:87], a[164:167], v[152:155]
 s_waitcnt lgkmcnt(4)
M v[156:159], a[92:95], a[164:167], v[156:159]
 s_add_u32 m0, s23, 32768
 ds_read_b64_tr_b16 a[144:145], v3 offset:49152
 ds_read_b64_tr_b16 a[146:147], v3 offset:50176
M v[156:159], a[88:91], a[160:163], v[156:159]
 buffer_load_dwordx4 v8, s[16:19], s21 offen offset:0  nt lds
M v[160:163], a[32:35], a[168:171], v[160:163]
 ds_read_b128 a[160:163], v5 offset:20480
 ds_read_b128 a[164:167], v6 offset:20480
M v[160:163], a[36:39], a[172:175], v[160:163]
M v[164:167], a[44:47], a[172:175], v[164:167]
M v[164:167], a[40:43], a[168:171], v[164:167]
M v[168:171], a[48:51], a[168:171], v[168:171]
M v[168:171], a[52:55], a[172:175], v[168:171]
 ds_read_b64_tr_b16 a[148:149], v3 offset:57344
 ds_read_b64_tr_b16 a[150:151], v3 offset:58368
M v[172:175], a[60:63], a[172:175], v[172:175]
 buffer_load_dwordx4 v9, s[16:19], s21 offen offset:1024  nt lds
M v[172:175], a[56:59], a[168:171], v[172:175]
M v[176:179], a[64:67], a[168:171], v[176:179]
M v[176:179], a[68:71], a[172:175], v[176:179]
M v[180:183], a[76:79], a[172:175], v[180:183]
M v[180:183], a[72:75], a[168:171], v[180:183]
M v[184:187], a[80:83], a[168:171], v[184:187]
 ds_read_b64_tr_b16 a[152:153], v4 offset:49152
 ds_read_b64_tr_b16 a[154:155], v4 offset:50176
M v[184:187], a[84:87], a[172:175], v[184:187]
 s_waitcnt lgkmcnt(4)
M v[188:191], a[92:95], a[172:175], v[188:191]
 buffer_load_dwordx4 v10, s[16:19], s21 offen offset:2048  nt lds
M v[188:191], a[88:91], a[168:171], v[188:191]
M v[192:195], a[32:35], a[160:163], v[192:195]
 ds_read_b128 a[168:171], v5 offset:22528
 ds_read_b128 a[172:175], v6 offset:22528
M v[192:195], a[36:39], a[164:167], v[192:195]
M v[196:199], a[44:47], a[164:167], v[196:199]
M v[196:199], a[40:43], a[160:163], v[196:199]
 ds_read_b64_tr_b16 a[156:157], v4 offset:57344
 ds_read_b64_tr_b16 a[158:159], v4 offset:58368
M v[200:203], a[48:51], a[160:163], v[200:203]
 buffer_load_dwordx4 v11, s[16:19], s21 offen offset:3072  nt lds
M v[200:203], a[52:55], a[164:167], v[200:203]
 s_add_u32 s21, s21, 128
M v[204:207], a[60:63], a[164:167], v[204:207]
M v[204:207], a[56:59], a[160:163], v[204:207]
M v[208:211], a[64:67], a[160:163], v[208:211]
M v[208:211], a[68:71], a[164:167], v[208:211]
M v[212:215], a[76:79], a[164:167], v[212:215]
M v[212:215], a[72:75], a[160:163], v[212:215]
M v[216:219], a[80:83], a[160:163], v[216:219]
M v[216:219], a[84:87], a[164:167], v[216:219]
 s_waitcnt lgkmcnt(2)
M v[220:223], a[92:95], a[164:167], v[220:223]
 s_waitcnt vmcnt(16) lgkmcnt(0)
M v[220:223], a[88:91], a[160:163], v[220:223]
 s_barrier
M v[224:227], a[32:35], a[168:171], v[224:227]
 ds_read_b128 a[160:163], v5 offset:32768
 ds_read_b128 a[164:167], v6 offset:32768
M v[224:227], a[36:39], a[172:175], v[224:227]
 buffer_load_dword a240, v24, s[32:35], 0 offen offset:1536
M v[228:231], a[44:47], a[172:175], v[228:231]
M v[228:231], a[40:43], a[168:171], v[228:231]
M v[232:235], a[48:51], a[168:171], v[232:235]
M v[232:235], a[52:55], a[172:175], v[232:235]
M v[236:239], a[60:63], a[172:175], v[236:239]
M v[236:239], a[56:59], a[168:171], v[236:239]
M v[240:243], a[64:67], a[168:171], v[240:243]
M v[240:243], a[68:71], a[172:175], v[240:243]
M v[244:247], a[76:79], a[172:175], v[244:247]
M v[244:247], a[72:75], a[168:171], v[244:247]
M v[248:251], a[80:83], a[168:171], v[248:251]
M v[248:251], a[84:87], a[172:175], v[248:251]
 s_waitcnt lgkmcnt(0)
M v[252:255], a[92:95], a[172:175], v[252:255]
M v[252:255], a[88:91], a[168:171], v[252:255]
M a[0:3], a[96:99], a[160:163], a[0:3]
 ds_read_b128 a[168:171], v5 offset:34816
 ds_read_b128 a[172:175], v6 offset:34816
M a[0:3], a[100:103], a[164:167], a[0:3]
 ds_read_b64_tr_b16 a[32:33], v1 offset:0
 ds_read_b64_tr_b16 a[34:35], v1 offset:1024
M a[4:7], a[108:111], a[164:167], a[4:7]
 s_add_u32 m0, s24, 16384
M a[4:7], a[104:107], a[160:163], a[4:7]
 buffer_load_dwordx4 v12, s[48:51], s22 offen offset:0   lds
M a[8:11], a[112:115], a[160:163], a[8:11]
M a[8:11], a[116:119], a[164:167], a[8:11]
M a[12:15], a[124:127], a[164:167], a[12:15]
 ds_read_b64_tr_b16 a[36:37], v1 offset:8192
 ds_read_b64_tr_b16 a[38:39], v1 offset:9216
M a[12:15], a[120:123], a[160:163], a[12:15]
M a[16:19], a[128:131], a[160:163], a[16:19]
 buffer_load_dwordx4 v13, s[48:51], s22 offen offset:1024   lds
M a[16:19], a[132:135], a[164:167], a[16:19]
M a[20:23], a[140:143], a[164:167], a[20:23]
M a[20:23], a[136:139], a[160:163], a[20:23]
 ds_read_b64_tr_b16 a[40:41], v2 offset:0
 ds_read_b64_tr_b16 a[42:43], v2 offset:1024
M a[24:27], a[144:147], a[160:163], a[24:27]
M a[24:27], a[148:151], a[164:167], a[24:27]
 s_waitcnt lgkmcnt(6)
M a[28:31], a[156:159], a[164:167], a[28:31]
 buffer_load_dwordx4 v14, s[48:51], s22 offen offset:2048   lds
M a[28:31], a[152:155], a[160:163], a[28:31]
M v[32:35], a[96:99], a[168:171], v[32:35]
 ds_read_b128 a[160:163], v5 offset:36864
 ds_read_b128 a[164:167], v6 offset:36864
M v[32:35], a[100:103], a[172:175], v[32:35]
 ds_read_b64_tr_b16 a[44:45], v2 offset:8192
 ds_read_b64_tr_b16 a[46:47], v2 offset:9216
M v[36:39], a[108:111], a[172:175], v[36:39]
 buffer_load_dwordx4 v15, s[48:51], s22 offen offset:3072   lds
M v[36:39], a[104:107], a[168:171], v[36:39]
 s_sub_u32 s22, s22, 2097024
M v[40:43], a[112:115], a[168:171], v[40:43]
M v[40:43], a[116:119], a[172:175], v[40:43]
 ds_read_b64_tr_b16 a[48:49], v3 offset:0
 ds_read_b64_tr_b16 a[50:51], v3 offset:1024
M v[44:47], a[124:127], a[172:175], v[44:47]
 s_add_u32 m0, s23, 49152
M v[44:47], a[120:123], a[168:171], v[44:47]
 buffer_load_dwordx4 v8, s[16:19], s21 offen offset:0  nt lds
M v[48:51], a[128:131], a[168:171], v[48:51]
M v[48:51], a[132:135], a[172:175], v[48:51]
M v[52:55], a[140:143], a[172:175], v[52:55]
 ds_read_b64_tr_b16 a[52:53], v3 offset:8192
 ds_read_b64_tr_b16 a[54:55], v3 offset:9216
M v[52:55], a[136:139], a[168:171], v[52:55]
M v[56:59], a[144:147], a[168:171], v[56:59]
 buffer_load_dwordx4 v9, s[16:19], s21 offen offset:1024  nt lds
M v[56:59], a[148:151], a[172:175], v[56:59]
 s_waitcnt lgkmcnt(6)
M v[60:63], a[156:159], a[172:175], v[60:63]
M v[60:63], a[152:155], a[168:171], v[60:63]
 ds_read_b64_tr_b16 a[56:57], v4 offset:0
 ds_read_b64_tr_b16 a[58:59], v4 offset:1024
M v[64:67], a[96:99], a[160:163], v[64:67]
 ds_read_b128 a[168:171], v5 offset:38912
 ds_read_b128 a[172:175], v6 offset:38912
M v[64:67], a[100:103], a[164:167], v[64:67]
 buffer_load_dwordx4 v10, s[16:19], s21 offen offset:2048  nt lds
M v[68:71], a[108:111], a[164:167], v[68:71]
M v[68:71], a[104:107], a[160:163], v[68:71]
M v[72:75], a[112:115], a[160:163], v[72:75]
 ds_read_b64_tr_b16 a[60:61], v4 offset:8192
 ds_read_b64_tr_b16 a[62:63], v4 offset:9216
M v[72:75], a[116:119], a[164:167], v[72:75]
M v[76:79], a[124:127], a[164:167], v[76:79]
 buffer_load_dwordx4 v11, s[16:19], s21 offen offset:3072  nt lds
M v[76:79], a[120:123], a[160:163], v[76:79]
 s_add_u32 s21, s21, 524160
M v[80:83], a[128:131], a[160:163], v[80:83]
M v[80:83], a[132:135], a[164:167], v[80:83]
M v[84:87], a[140:143], a[164:167], v[84:87]
M v[84:87], a[136:139], a[160:163], v[84:87]
M v[88:91], a[144:147], a[160:163], v[88:91]
M v[88:91], a[148:151], a[164:167], v[88:91]
 s_waitcnt lgkmcnt(2)
M v[92:95], a[156:159], a[164:167], v[92:95]
 s_waitcnt vmcnt(17) lgkmcnt(0)
M v[92:95], a[152:155], a[160:163], v[92:95]
 s_barrier
M v[96:99], a[96:99], a[168:171], v[96:99]
 ds_read_b128 a[160:163], v5 offset:49152
 ds_read_b128 a[164:167], v6 offset:49152
M v[96:99], a[100:103], a[172:175], v[96:99]
M v[100:103], a[108:111], a[172:175], v[100:103]
 s_add_u32 m0, s24, 32768
 ds_read_b64_tr_b16 a[64:65], v1 offset:16384
 ds_read_b64_tr_b16 a[66:67], v1 offset:17408
M v[100:103], a[104:107], a[168:171], v[100:103]
 buffer_load_dwordx4 v12, s[48:51], s22 offen offset:0   lds
M v[104:107], a[112:115], a[168:171], v[104:107]
M v[104:107], a[116:119], a[172:175], v[104:107]
M v[108:111], a[124:127], a[172:175], v[108:111]
M v[108:111], a[120:123], a[168:171], v[108:111]
M v[112:115], a[128:131], a[168:171], v[112:115]
M v[112:115], a[132:135], a[172:175], v[112:115]
 ds_read_b64_tr_b16 a[68:69], v1 offset:24576
 ds_read_b64_tr_b16 a[70:71], v1 offset:25600
M v[116:119], a[140:143], a[172:175], v[116:119]
 buffer_load_dwordx4 v13, s[48:51], s22 offen offset:1024   lds
M v[116:119], a[136:139], a[168:171], v[116:119]
M v[120:123], a[144:147], a[168:171], v[120:123]
 s_and_b32 s64, s42, 7
 s_lshl_b32 s64, s64, 2
M v[120:123], a[148:151], a[172:175], v[120:123]
 s_waitcnt lgkmcnt(4)
 s_add_u32 s64, s64, s20
M v[124:127], a[156:159], a[172:175], v[124:127]
 s_mul_i32 s64, s64, 114688
 v_bfe_u32 v28, v0, 2, 2
 v_and_b32 v29, 3, v0
M v[124:127], a[152:155], a[168:171], v[124:127]
 v_lshlrev_b32 v29, 7, v29
 v_lshl_add_u32 v28, v28, 13, v29
M v[128:131], a[96:99], a[160:163], v[128:131]
 ds_read_b128 a[168:171], v5 offset:51200
 ds_read_b128 a[172:175], v6 offset:51200
M v[128:131], a[100:103], a[164:167], v[128:131]
 ds_read_b64_tr_b16 a[72:73], v2 offset:16384
 ds_read_b64_tr_b16 a[74:75], v2 offset:17408
M v[132:135], a[108:111], a[164:167], v[132:135]
 buffer_load_dwordx4 v14, s[48:51], s22 offen offset:2048   lds
M v[132:135], a[104:107], a[160:163], v[132:135]
 v_add_u32 v23, s64, v28
 v_and_b32 v28, 48, v0
M v[136:139], a[112:115], a[160:163], v[136:139]
 v_lshl_add_u32 v23, v28, 24, v23
M v[136:139], a[116:119], a[164:167], v[136:139]
M v[140:143], a[124:127], a[164:167], v[140:143]
M v[140:143], a[120:123], a[160:163], v[140:143]
 ds_read_b64_tr_b16 a[76:77], v2 offset:24576
 ds_read_b64_tr_b16 a[78:79], v2 offset:25600
M v[144:147], a[128:131], a[160:163], v[144:147]
 buffer_load_dwordx4 v15, s[48:51], s22 offen offset:3072   lds
M v[144:147], a[132:135], a[164:167], v[144:147]
 s_add_u32 s22, s22, 2097152
M v[148:151], a[140:143], a[164:167], v[148:151]
M v[148:151], a[136:139], a[160:163], v[148:151]
M v[152:155], a[144:147], a[160:163], v[152:155]
M v[152:155], a[148:151], a[164:167], v[152:155]
 s_waitcnt lgkmcnt(4)
M v[156:159], a[156:159], a[164:167], v[156:159]
 s_add_u32 m0, s23, 0
 ds_read_b64_tr_b16 a[80:81], v3 offset:16384
 ds_read_b64_tr_b16 a[82:83], v3 offset:17408
M v[156:159], a[152:155], a[160:163], v[156:159]
 buffer_load_dwordx4 v8, s[16:19], s21 offen offset:0  nt lds
M v[160:163], a[96:99], a[168:171], v[160:163]
 ds_read_b128 a[160:163], v5 offset:53248
 ds_read_b128 a[164:167], v6 offset:53248
M v[160:163], a[100:103], a[172:175], v[160:163]
M v[164:167], a[108:111], a[172:175], v[164:167]
M v[164:167], a[104:107], a[168:171], v[164:167]
M v[168:171], a[112:115], a[168:171], v[168:171]
M v[168:171], a[116:119], a[172:175], v[168:171]
 ds_read_b64_tr_b16 a[84:85], v3 offset:24576
 ds_read_b64_tr_b16 a[86:87], v3 offset:25600
M v[172:175], a[124:127], a[172:175], v[172:175]
 buffer_load_dwordx4 v9, s[16:19], s21 offen offset:1024  nt lds
M v[172:175], a[120:123], a[168:171], v[172:175]
M v[176:179], a[128:131], a[168:171], v[176:179]
M v[176:179], a[132:135], a[172:175], v[176:179]
M v[180:183], a[140:143], a[172:175], v[180:183]
M v[180:183], a[136:139], a[168:171], v[180:183]
M v[184:187], a[144:147], a[168:171], v[184:187]
 ds_read_b64_tr_b16 a[88:89], v4 offset:16384
 ds_read_b64_tr_b16 a[90:91], v4 offset:17408
M v[184:187], a[148:151], a[172:175], v[184:187]
 s_waitcnt lgkmcnt(4)
M v[188:191], a[156:159], a[172:175], v[188:191]
 buffer_load_dwordx4 v10, s[16:19], s21 offen offset:2048  nt lds
M v[188:191], a[152:155], a[168:171], v[188:191]
M v[192:195], a[96:99], a[160:163], v[192:195]
 ds_read_b128 a[168:171], v5 offset:55296
 ds_read_b128 a[172:175], v6 offset:55296
M v[192:195], a[100:103], a[164:167], v[192:195]
M v[196:199], a[108:111], a[164:167], v[196:199]
M v[196:199], a[104:107], a[160:163], v[196:199]
 ds_read_b64_tr_b16 a[92:93], v4 offset:24576
 ds_read_b64_tr_b16 a[94:95], v4 offset:25600
M v[200:203], a[112:115], a[160:163], v[200:203]
 buffer_load_dwordx4 v11, s[16:19], s21 offen offset:3072  nt lds
M v[200:203], a[116:119], a[164:167], v[200:203]
 s_add_u32 s21, s21, 128
M v[204:207], a[124:127], a[164:167], v[204:207]
M v[204:207], a[120:123], a[160:163], v[204:207]
M v[208:211], a[128:131], a[160:163], v[208:211]
M v[208:211], a[132:135], a[164:167], v[208:211]
M v[212:215], a[140:143], a[164:167], v[212:215]
M v[212:215], a[136:139], a[160:163], v[212:215]
M v[216:219], a[144:147], a[160:163], v[216:219]
M v[216:219], a[148:151], a[164:167], v[216:219]
 s_waitcnt lgkmcnt(2)
M v[220:223], a[156:159], a[164:167], v[220:223]
 s_waitcnt vmcnt(17) lgkmcnt(0)
M v[220:223], a[152:155], a[160:163], v[220:223]
 s_barrier
M v[224:227], a[96:99], a[168:171], v[224:227]
 ds_read_b128 a[160:163], v5 offset:0
 ds_read_b128 a[164:167], v6 offset:0
M v[224:227], a[100:103], a[172:175], v[224:227]
 buffer_load_dword a240, v23, s[52:55], 0 offen offset:0
M v[228:231], a[108:111], a[172:175], v[228:231]
 v_add_u32 v23, 32768, v23
M v[228:231], a[104:107], a[168:171], v[228:231]
M v[232:235], a[112:115], a[168:171], v[232:235]
M v[232:235], a[116:119], a[172:175], v[232:235]
M v[236:239], a[124:127], a[172:175], v[236:239]
M v[236:239], a[120:123], a[168:171], v[236:239]
M v[240:243], a[128:131], a[168:171], v[240:243]
M v[240:243], a[132:135], a[172:175], v[240:243]
M v[244:247], a[140:143], a[172:175], v[244:247]
M v[244:247], a[136:139], a[168:171], v[244:247]
M v[248:251], a[144:147], a[168:171], v[248:251]
M v[248:251], a[148:151], a[172:175], v[248:251]
 s_waitcnt lgkmcnt(0)
M v[252:255], a[156:159], a[172:175], v[252:255]
M v[252:255], a[152:155], a[168:171], v[252:255]
M a[0:3], a[32:35], a[160:163], a[0:3]
 ds_read_b128 a[168:171], v5 offset:2048
 ds_read_b128 a[172:175], v6 offset:2048
M a[0:3], a[36:39], a[164:167], a[0:3]
 ds_read_b64_tr_b16 a[96:97], v1 offset:32768
 ds_read_b64_tr_b16 a[98:99], v1 offset:33792
M a[4:7], a[44:47], a[164:167], a[4:7]
 s_add_u32 m0, s24, 49152
M a[4:7], a[40:43], a[160:163], a[4:7]
 buffer_load_dwordx4 v12, s[48:51], s22 offen offset:0   lds
M a[8:11], a[48:51], a[160:163], a[8:11]
M a[8:11], a[52:55], a[164:167], a[8:11]
M a[12:15], a[60:63], a[164:167], a[12:15]
 ds_read_b64_tr_b16 a[100:101], v1 offset:40960
 ds_read_b64_tr_b16 a[102:103], v1 offset:41984
M a[12:15], a[56:59], a[160:163], a[12:15]
M a[16:19], a[64:67], a[160:163], a[16:19]
 buffer_load_dwordx4 v13, s[48:51], s22 offen offset:1024   lds
M a[16:19], a[68:71], a[164:167], a[16:19]
M a[20:23], a[76:79], a[164:167], a[20:23]
M a[20:23], a[72:75], a[160:163], a[20:23]
 ds_read_b64_tr_b16 a[104:105], v2 offset:32768
 ds_read_b64_tr_b16 a[106:107], v2 offset:33792
M a[24:27], a[80:83], a[160:163], a[24:27]
M a[24:27], a[84:87], a[164:167], a[24:27]
 s_waitcnt lgkmcnt(6)
M a[28:31], a[92:95], a[164:167], a[28:31]
 buffer_load_dwordx4 v14, s[48:51], s22 offen offset:2048   lds
M a[28:31], a[88:91], a[160:163], a[28:31]
M v[32:35], a[32:35], a[168:171], v[32:35]
 ds_read_b128 a[160:163], v5 offset:4096
 ds_read_b128 a[164:167], v6 offset:4096
M v[32:35], a[36:39], a[172:175], v[32:35]
 ds_read_b64_tr_b16 a[108:109], v2 offset:40960
 ds_read_b64_tr_b16 a[110:111], v2 offset:41984
M v[36:39], a[44:47], a[172:175], v[36:39]
 buffer_load_dwordx4 v15, s[48:51], s22 offen offset:3072   lds
M v[36:39], a[40:43], a[168:171], v[36:39]
 s_sub_u32 s22, s22, 2097024
M v[40:43], a[48:51], a[168:171], v[40:43]
M v[40:43], a[52:55], a[172:175], v[40:43]
 ds_read_b64_tr_b16 a[112:113], v3 offset:32768
 ds_read_b64_tr_b16 a[114:115], v3 offset:33792
M v[44:47], a[60:63], a[172:175], v[44:47]
 s_add_u32 m0, s23, 16384
M v[44:47], a[56:59], a[168:171], v[44:47]
 buffer_load_dwordx4 v8, s[16:19], s21 offen offset:0  nt lds
M v[48:51], a[64:67], a[168:171], v[48:51]
M v[48:51], a[68:71], a[172:175], v[48:51]
M v[52:55], a[76:79], a[172:175], v[52:55]
 ds_read_b64_tr_b16 a[116:117], v3 offset:40960
 ds_read_b64_tr_b16 a[118:119], v3 offset:41984
M v[52:55], a[72:75], a[168:171], v[52:55]
M v[56:59], a[80:83], a[168:171], v[56:59]
 buffer_load_dwordx4 v9, s[16:19], s21 offen offset:1024  nt lds
M v[56:59], a[84:87], a[172:175], v[56:59]
 s_waitcnt lgkmcnt(6)
M v[60:63], a[92:95], a[172:175], v[60:63]
M v[60:63], a[88:91], a[168:171], v[60:63]
 ds_read_b64_tr_b16 a[120:121], v4 offset:32768
 ds_read_b64_tr_b16 a[122:123], v4 offset:33792
M v[64:67], a[32:35], a[160:163], v[64:67]
 ds_read_b128 a[168:171], v5 offset:6144
 ds_read_b128 a[172:175], v6 offset:6144
M v[64:67], a[36:39], a[164:167], v[64:67]
 buffer_load_dwordx4 v10, s[16:19], s21 offen offset:2048  nt lds
M v[68:71], a[44:47], a[164:167], v[68:71]
M v[68:71], a[40:43], a[160:163], v[68:71]
M v[72:75], a[48:51], a[160:163], v[72:75]
 ds_read_b64_tr_b16 a[124:125], v4 offset:40960
 ds_read_b64_tr_b16 a[126:127], v4 offset:41984
M v[72:75], a[52:55], a[164:167], v[72:75]
M v[76:79], a[60:63], a[164:167], v[76:79]
 buffer_load_dwordx4 v11, s[16:19], s21 offen offset:3072  nt lds
M v[76:79], a[56:59], a[160:163], v[76:79]
 s_add_u32 s21, s21, 524160
M v[80:83], a[64:67], a[160:163], v[80:83]
M v[80:83], a[68:71], a[164:167], v[80:83]
M v[84:87], a[76:79], a[164:167], v[84:87]
M v[84:87], a[72:75], a[160:163], v[84:87]
M v[88:91], a[80:83], a[160:163], v[88:91]
M v[88:91], a[84:87], a[164:167], v[88:91]
 s_waitcnt lgkmcnt(2)
M v[92:95], a[92:95], a[164:167], v[92:95]
 s_waitcnt vmcnt(17) lgkmcnt(0)
M v[92:95], a[88:91], a[160:163], v[92:95]
 s_barrier
M v[96:99], a[32:35], a[168:171], v[96:99]
 ds_read_b128 a[160:163], v5 offset:16384
 ds_read_b128 a[164:167], v6 offset:16384
M v[96:99], a[36:39], a[172:175], v[96:99]
M v[100:103], a[44:47], a[172:175], v[100:103]
 s_add_u32 m0, s24, 0
 ds_read_b64_tr_b16 a[128:129], v1 offset:49152
 ds_read_b64_tr_b16 a[130:131], v1 offset:50176
M v[100:103], a[40:43], a[168:171], v[100:103]
 buffer_load_dwordx4 v12, s[48:51], s22 offen offset:0   lds
M v[104:107], a[48:51], a[168:171], v[104:107]
M v[104:107], a[52:55], a[172:175], v[104:107]
M v[108:111], a[60:63], a[172:175], v[108:111]
M v[108:111], a[56:59], a[168:171], v[108:111]
M v[112:115], a[64:67], a[168:171], v[112:115]
M v[112:115], a[68:71], a[172:175], v[112:115]
 ds_read_b64_tr_b16 a[132:133], v1 offset:57344
 ds_read_b64_tr_b16 a[134:135], v1 offset:58368
M v[116:119], a[76:79], a[172:175], v[116:119]
 buffer_load_dwordx4 v13, s[48:51], s22 offen offset:1024   lds
M v[116:119], a[72:75], a[168:171], v[116:119]
M v[120:123], a[80:83], a[168:171], v[120:123]
M v[120:123], a[84:87], a[172:175], v[120:123]
 s_waitcnt lgkmcnt(4)
M v[124:127], a[92:95], a[172:175], v[124:127]
M v[124:127], a[88:91], a[168:171], v[124:127]
M v[128:131], a[32:35], a[160:163], v[128:131]
 ds_read_b128 a[168:171], v5 offset:18432
 ds_read_b128 a[172:175], v6 offset:18432
M v[128:131], a[36:39], a[164:167], v[128:131]
 ds_read_b64_tr_b16 a[136:137], v2 offset:49152
 ds_read_b64_tr_b16 a[138:139], v2 offset:50176
M v[132:135], a[44:47], a[164:167], v[132:135]
 buffer_load_dwordx4 v14, s[48:51], s22 offen offset:2048   lds
M v[132:135], a[40:43], a[160:163], v[132:135]
M v[136:139], a[48:51], a[160:163], v[136:139]
M v[136:139], a[52:55], a[164:167], v[136:139]
M v[140:143], a[60:63], a[164:167], v[140:143]
M v[140:143], a[56:59], a[160:163], v[140:143]
 ds_read_b64_tr_b16 a[140:141], v2 offset:57344
 ds_read_b64_tr_b16 a[142:143], v2 offset:58368
M v[144:147], a[64:67], a[160:163], v[144:147]
 buffer_load_dwordx4 v15, s[48:51], s22 offen offset:3072   lds
M v[144:147], a[68:71], a[164:167], v[144:147]
 s_add_u32 s22, s22, 2097152
M v[148:151], a[76:79], a[164:167], v[148:151]
M v[148:151], a[72:75], a[160:163], v[148:151]
M v[152:155], a[80:83], a[160:163], v[152:155]
M v[152:155], a[84:87], a[164:167], v[152:155]
 s_waitcnt lgkmcnt(4)
M v[156:159], a[92:95], a[164:167], v[156:159]
 s_add_u32 m0, s23, 32768
 ds_read_b64_tr_b16 a[144:145], v3 offset:49152
 ds_read_b64_tr_b16 a[146:147], v3 offset:50176
M v[156:159], a[88:91], a[160:163], v[156:159]
 buffer_load_dwordx4 v8, s[16:19], s21 offen offset:0  nt lds
M v[160:163], a[32:35], a[168:171], v[160:163]
 ds_read_b128 a[160:163], v5 offset:20480
 ds_read_b128 a[164:167], v6 offset:20480
M v[160:163], a[36:39], a[172:175], v[160:163]
M v[164:167], a[44:47], a[172:175], v[164:167]
M v[164:167], a[40:43], a[168:171], v[164:167]
M v[168:171], a[48:51], a[168:171], v[168:171]
M v[168:171], a[52:55], a[172:175], v[168:171]
 ds_read_b64_tr_b16 a[148:149], v3 offset:57344
 ds_read_b64_tr_b16 a[150:151], v3 offset:58368
M v[172:175], a[60:63], a[172:175], v[172:175]
 buffer_load_dwordx4 v9, s[16:19], s21 offen offset:1024  nt lds
M v[172:175], a[56:59], a[168:171], v[172:175]
M v[176:179], a[64:67], a[168:171], v[176:179]
M v[176:179], a[68:71], a[172:175], v[176:179]
M v[180:183], a[76:79], a[172:175], v[180:183]
M v[180:183], a[72:75], a[168:171], v[180:183]
M v[184:187], a[80:83], a[168:171], v[184:187]
 ds_read_b64_tr_b16 a[152:153], v4 offset:49152
 ds_read_b64_tr_b16 a[154:155], v4 offset:50176
M v[184:187], a[84:87], a[172:175], v[184:187]
 s_waitcnt lgkmcnt(4)
M v[188:191], a[92:95], a[172:175], v[188:191]
 buffer_load_dwordx4 v10, s[16:19], s21 offen offset:2048  nt lds
M v[188:191], a[88:91], a[168:171], v[188:191]
M v[192:195], a[32:35], a[160:163], v[192:195]
 ds_read_b128 a[168:171], v5 offset:22528
 ds_read_b128 a[172:175], v6 offset:22528
M v[192:195], a[36:39], a[164:167], v[192:195]
M v[196:199], a[44:47], a[164:167], v[196:199]
M v[196:199], a[40:43], a[160:163], v[196:199]
 ds_read_b64_tr_b16 a[156:157], v4 offset:57344
 ds_read_b64_tr_b16 a[158:159], v4 offset:58368
M v[200:203], a[48:51], a[160:163], v[200:203]
 buffer_load_dwordx4 v11, s[16:19], s21 offen offset:3072  nt lds
M v[200:203], a[52:55], a[164:167], v[200:203]
 s_add_u32 s21, s21, 128
M v[204:207], a[60:63], a[164:167], v[204:207]
M v[204:207], a[56:59], a[160:163], v[204:207]
M v[208:211], a[64:67], a[160:163], v[208:211]
M v[208:211], a[68:71], a[164:167], v[208:211]
M v[212:215], a[76:79], a[164:167], v[212:215]
M v[212:215], a[72:75], a[160:163], v[212:215]
M v[216:219], a[80:83], a[160:163], v[216:219]
M v[216:219], a[84:87], a[164:167], v[216:219]
 s_waitcnt lgkmcnt(2)
M v[220:223], a[92:95], a[164:167], v[220:223]
 s_waitcnt vmcnt(17) lgkmcnt(0)
M v[220:223], a[88:91], a[160:163], v[220:223]
 s_barrier
M v[224:227], a[32:35], a[168:171], v[224:227]
 ds_read_b128 a[160:163], v5 offset:32768
 ds_read_b128 a[164:167], v6 offset:32768
M v[224:227], a[36:39], a[172:175], v[224:227]
 buffer_load_dword a240, v23, s[52:55], 0 offen offset:0
M v[228:231], a[44:47], a[172:175], v[228:231]
 v_add_u32 v23, 32768, v23
M v[228:231], a[40:43], a[168:171], v[228:231]
M v[232:235], a[48:51], a[168:171], v[232:235]
M v[232:235], a[52:55], a[172:175], v[232:235]
M v[236:239], a[60:63], a[172:175], v[236:239]
M v[236:239], a[56:59], a[168:171], v[236:239]
M v[240:243], a[64:67], a[168:171], v[240:243]
M v[240:243], a[68:71], a[172:175], v[240:243]
M v[244:247], a[76:79], a[172:175], v[244:247]
M v[244:247], a[72:75], a[168:171], v[244:247]
M v[248:251], a[80:83], a[168:171], v[248:251]
M v[248:251], a[84:87], a[172:175], v[248:251]
 s_waitcnt lgkmcnt(0)
M v[252:255], a[92:95], a[172:175], v[252:255]
M v[252:255], a[88:91], a[168:171], v[252:255]
M a[0:3], a[96:99], a[160:163], a[0:3]
 ds_read_b128 a[168:171], v5 offset:34816
 ds_read_b128 a[172:175], v6 offset:34816
M a[0:3], a[100:103], a[164:167], a[0:3]
 ds_read_b64_tr_b16 a[32:33], v1 offset:0
 ds_read_b64_tr_b16 a[34:35], v1 offset:1024
M a[4:7], a[108:111], a[164:167], a[4:7]
 s_add_u32 m0, s24, 16384
M a[4:7], a[104:107], a[160:163], a[4:7]
 buffer_load_dwordx4 v12, s[48:51], s22 offen offset:0   lds
M a[8:11], a[112:115], a[160:163], a[8:11]
M a[8:11], a[116:119], a[164:167], a[8:11]
M a[12:15], a[124:127], a[164:167], a[12:15]
 ds_read_b64_tr_b16 a[36:37], v1 offset:8192
 ds_read_b64_tr_b16 a[38:39], v1 offset:9216
M a[12:15], a[120:123], a[160:163], a[12:15]
M a[16:19], a[128:131], a[160:163], a[16:19]
 buffer_load_dwordx4 v13, s[48:51], s22 offen offset:1024   lds
M a[16:19], a[132:135], a[164:167], a[16:19]
M a[20:23], a[140:143], a[164:167], a[20:23]
M a[20:23], a[136:139], a[160:163], a[20:23]
 ds_read_b64_tr_b16 a[40:41], v2 offset:0
 ds_read_b64_tr_b16 a[42:43], v2 offset:1024
M a[24:27], a[144:147], a[160:163], a[24:27]
M a[24:27], a[148:151], a[164:167], a[24:27]
 s_waitcnt lgkmcnt(6)
M a[28:31], a[156:159], a[164:167], a[28:31]
 buffer_load_dwordx4 v14, s[48:51], s22 offen offset:2048   lds
M a[28:31], a[152:155], a[160:163], a[28:31]
M v[32:35], a[96:99], a[168:171], v[32:35]
 ds_read_b128 a[160:163], v5 offset:36864
 ds_read_b128 a[164:167], v6 offset:36864
M v[32:35], a[100:103], a[172:175], v[32:35]
 ds_read_b64_tr_b16 a[44:45], v2 offset:8192
 ds_read_b64_tr_b16 a[46:47], v2 offset:9216
M v[36:39], a[108:111], a[172:175], v[36:39]
 buffer_load_dwordx4 v15, s[48:51], s22 offen offset:3072   lds
M v[36:39], a[104:107], a[168:171], v[36:39]
 s_sub_u32 s22, s22, 2097024
M v[40:43], a[112:115], a[168:171], v[40:43]
M v[40:43], a[116:119], a[172:175], v[40:43]
 ds_read_b64_tr_b16 a[48:49], v3 offset:0
 ds_read_b64_tr_b16 a[50:51], v3 offset:1024
M v[44:47], a[124:127], a[172:175], v[44:47]
 s_add_u32 m0, s23, 49152
M v[44:47], a[120:123], a[168:171], v[44:47]
 buffer_load_dwordx4 v8, s[16:19], s21 offen offset:0  nt lds
M v[48:51], a[128:131], a[168:171], v[48:51]
M v[48:51], a[132:135], a[172:175], v[48:51]
M v[52:55], a[140:143], a[172:175], v[52:55]
 ds_read_b64_tr_b16 a[52:53], v3 offset:8192
 ds_read_b64_tr_b16 a[54:55], v3 offset:9216
M v[52:55], a[136:139], a[168:171], v[52:55]
M v[56:59], a[144:147], a[168:171], v[56:59]
 buffer_load_dwordx4 v9, s[16:19], s21 offen offset:1024  nt lds
M v[56:59], a[148:151], a[172:175], v[56:59]
 s_waitcnt lgkmcnt(6)
M v[60:63], a[156:159], a[172:175], v[60:63]
M v[60:63], a[152:155], a[168:171], v[60:63]
 ds_read_b64_tr_b16 a[56:57], v4 offset:0
 ds_read_b64_tr_b16 a[58:59], v4 offset:1024
M v[64:67], a[96:99], a[160:163], v[64:67]
 ds_read_b128 a[168:171], v5 offset:38912
 ds_read_b128 a[172:175], v6 offset:38912
M v[64:67], a[100:103], a[164:167], v[64:67]
 buffer_load_dwordx4 v10, s[16:19], s21 offen offset:2048  nt lds
M v[68:71], a[108:111], a[164:167], v[68:71]
M v[68:71], a[104:107], a[160:163], v[68:71]
M v[72:75], a[112:115], a[160:163], v[72:75]
 ds_read_b64_tr_b16 a[60:61], v4 offset:8192
 ds_read_b64_tr_b16 a[62:63], v4 offset:9216
M v[72:75], a[116:119], a[164:167], v[72:75]
M v[76:79], a[124:127], a[164:167], v[76:79]
 buffer_load_dwordx4 v11, s[16:19], s21 offen offset:3072  nt lds
M v[76:79], a[120:123], a[160:163], v[76:79]
 s_add_u32 s21, s21, 524160
M v[80:83], a[128:131], a[160:163], v[80:83]
M v[80:83], a[132:135], a[164:167], v[80:83]
M v[84:87], a[140:143], a[164:167], v[84:87]
M v[84:87], a[136:139], a[160:163], v[84:87]
M v[88:91], a[144:147], a[160:163], v[88:91]
M v[88:91], a[148:151], a[164:167], v[88:91]
 s_waitcnt lgkmcnt(2)
M v[92:95], a[156:159], a[164:167], v[92:95]
 s_waitcnt vmcnt(17) lgkmcnt(0)
M v[92:95], a[152:155], a[160:163], v[92:95]
 s_barrier
M v[96:99], a[96:99], a[168:171], v[96:99]
 ds_read_b128 a[160:163], v5 offset:49152
 ds_read_b128 a[164:167], v6 offset:49152
M v[96:99], a[100:103], a[172:175], v[96:99]
M v[100:103], a[108:111], a[172:175], v[100:103]
 s_add_u32 m0, s24, 32768
 ds_read_b64_tr_b16 a[64:65], v1 offset:16384
 ds_read_b64_tr_b16 a[66:67], v1 offset:17408
M v[100:103], a[104:107], a[168:171], v[100:103]
 buffer_load_dwordx4 v12, s[48:51], s22 offen offset:0   lds
M v[104:107], a[112:115], a[168:171], v[104:107]
M v[104:107], a[116:119], a[172:175], v[104:107]
M v[108:111], a[124:127], a[172:175], v[108:111]
M v[108:111], a[120:123], a[168:171], v[108:111]
M v[112:115], a[128:131], a[168:171], v[112:115]
M v[112:115], a[132:135], a[172:175], v[112:115]
 ds_read_b64_tr_b16 a[68:69], v1 offset:24576
 ds_read_b64_tr_b16 a[70:71], v1 offset:25600
M v[116:119], a[140:143], a[172:175], v[116:119]
 buffer_load_dwordx4 v13, s[48:51], s22 offen offset:1024   lds
M v[116:119], a[136:139], a[168:171], v[116:119]
M v[120:123], a[144:147], a[168:171], v[120:123]
M v[120:123], a[148:151], a[172:175], v[120:123]
 s_waitcnt lgkmcnt(4)
M v[124:127], a[156:159], a[172:175], v[124:127]
M v[124:127], a[152:155], a[168:171], v[124:127]
M v[128:131], a[96:99], a[160:163], v[128:131]
 ds_read_b128 a[168:171], v5 offset:51200
 ds_read_b128 a[172:175], v6 offset:51200
M v[128:131], a[100:103], a[164:167], v[128:131]
 ds_read_b64_tr_b16 a[72:73], v2 offset:16384
 ds_read_b64_tr_b16 a[74:75], v2 offset:17408
M v[132:135], a[108:111], a[164:167], v[132:135]
 buffer_load_dwordx4 v14, s[48:51], s22 offen offset:2048   lds
M v[132:135], a[104:107], a[160:163], v[132:135]
M v[136:139], a[112:115], a[160:163], v[136:139]
M v[136:139], a[116:119], a[164:167], v[136:139]
M v[140:143], a[124:127], a[164:167], v[140:143]
M v[140:143], a[120:123], a[160:163], v[140:143]
 ds_read_b64_tr_b16 a[76:77], v2 offset:24576
 ds_read_b64_tr_b16 a[78:79], v2 offset:25600
M v[144:147], a[128:131], a[160:163], v[144:147]
 buffer_load_dwordx4 v15, s[48:51], s22 offen offset:3072   lds
M v[144:147], a[132:135], a[164:167], v[144:147]
 s_add_u32 s22, s22, 2097152
M v[148:151], a[140:143], a[164:167], v[148:151]
M v[148:151], a[136:139], a[160:163], v[148:151]
M v[152:155], a[144:147], a[160:163], v[152:155]
M v[152:155], a[148:151], a[164:167], v[152:155]
 s_waitcnt lgkmcnt(4)
M v[156:159], a[156:159], a[164:167], v[156:159]
 s_add_u32 m0, s23, 0
 ds_read_b64_tr_b16 a[80:81], v3 offset:16384
 ds_read_b64_tr_b16 a[82:83], v3 offset:17408
M v[156:159], a[152:155], a[160:163], v[156:159]
 buffer_load_dwordx4 v8, s[16:19], s21 offen offset:0  nt lds
M v[160:163], a[96:99], a[168:171], v[160:163]
 ds_read_b128 a[160:163], v5 offset:53248
 ds_read_b128 a[164:167], v6 offset:53248
M v[160:163], a[100:103], a[172:175], v[160:163]
M v[164:167], a[108:111], a[172:175], v[164:167]
M v[164:167], a[104:107], a[168:171], v[164:167]
M v[168:171], a[112:115], a[168:171], v[168:171]
M v[168:171], a[116:119], a[172:175], v[168:171]
 ds_read_b64_tr_b16 a[84:85], v3 offset:24576
 ds_read_b64_tr_b16 a[86:87], v3 offset:25600
M v[172:175], a[124:127], a[172:175], v[172:175]
 buffer_load_dwordx4 v9, s[16:19], s21 offen offset:1024  nt lds
M v[172:175], a[120:123], a[168:171], v[172:175]
M v[176:179], a[128:131], a[168:171], v[176:179]
M v[176:179], a[132:135], a[172:175], v[176:179]
M v[180:183], a[140:143], a[172:175], v[180:183]
M v[180:183], a[136:139], a[168:171], v[180:183]
M v[184:187], a[144:147], a[168:171], v[184:187]
 ds_read_b64_tr_b16 a[88:89], v4 offset:16384
 ds_read_b64_tr_b16 a[90:91], v4 offset:17408
M v[184:187], a[148:151], a[172:175], v[184:187]
 s_waitcnt lgkmcnt(4)
M v[188:191], a[156:159], a[172:175], v[188:191]
 buffer_load_dwordx4 v10, s[16:19], s21 offen offset:2048  nt lds
M v[188:191], a[152:155], a[168:171], v[188:191]
M v[192:195], a[96:99], a[160:163], v[192:195]
 ds_read_b128 a[168:171], v5 offset:55296
 ds_read_b128 a[172:175], v6 offset:55296
M v[192:195], a[100:103], a[164:167], v[192:195]
M v[196:199], a[108:111], a[164:167], v[196:199]
M v[196:199], a[104:107], a[160:163], v[196:199]
 ds_read_b64_tr_b16 a[92:93], v4 offset:24576
 ds_read_b64_tr_b16 a[94:95], v4 offset:25600
M v[200:203], a[112:115], a[160:163], v[200:203]
 buffer_load_dwordx4 v11, s[16:19], s21 offen offset:3072  nt lds
M v[200:203], a[116:119], a[164:167], v[200:203]
 s_add_u32 s21, s21, 128
M v[204:207], a[124:127], a[164:167], v[204:207]
M v[204:207], a[120:123], a[160:163], v[204:207]
M v[208:211], a[128:131], a[160:163], v[208:211]
M v[208:211], a[132:135], a[164:167], v[208:211]
M v[212:215], a[140:143], a[164:167], v[212:215]
M v[212:215], a[136:139], a[160:163], v[212:215]
M v[216:219], a[144:147], a[160:163], v[216:219]
M v[216:219], a[148:151], a[164:167], v[216:219]
 s_waitcnt lgkmcnt(2)
M v[220:223], a[156:159], a[164:167], v[220:223]
 s_waitcnt vmcnt(17) lgkmcnt(0)
M v[220:223], a[152:155], a[160:163], v[220:223]
 s_barrier
M v[224:227], a[96:99], a[168:171], v[224:227]
 ds_read_b128 a[160:163], v5 offset:0
 ds_read_b128 a[164:167], v6 offset:0
M v[224:227], a[100:103], a[172:175], v[224:227]
 buffer_load_dword a240, v23, s[52:55], 0 offen offset:0
M v[228:231], a[108:111], a[172:175], v[228:231]
 v_add_u32 v23, 16384, v23
M v[228:231], a[104:107], a[168:171], v[228:231]
M v[232:235], a[112:115], a[168:171], v[232:235]
M v[232:235], a[116:119], a[172:175], v[232:235]
M v[236:239], a[124:127], a[172:175], v[236:239]
M v[236:239], a[120:123], a[168:171], v[236:239]
M v[240:243], a[128:131], a[168:171], v[240:243]
M v[240:243], a[132:135], a[172:175], v[240:243]
M v[244:247], a[140:143], a[172:175], v[244:247]
M v[244:247], a[136:139], a[168:171], v[244:247]
M v[248:251], a[144:147], a[168:171], v[248:251]
M v[248:251], a[148:151], a[172:175], v[248:251]
 s_waitcnt lgkmcnt(0)
M v[252:255], a[156:159], a[172:175], v[252:255]
M v[252:255], a[152:155], a[168:171], v[252:255]
M a[0:3], a[32:35], a[160:163], a[0:3]
 ds_read_b128 a[168:171], v5 offset:2048
 ds_read_b128 a[172:175], v6 offset:2048
M a[0:3], a[36:39], a[164:167], a[0:3]
 ds_read_b64_tr_b16 a[96:97], v1 offset:32768
 ds_read_b64_tr_b16 a[98:99], v1 offset:33792
M a[4:7], a[44:47], a[164:167], a[4:7]
 s_add_u32 m0, s24, 49152
 v_accvgpr_read_b32 v27, a241
M a[4:7], a[40:43], a[160:163], a[4:7]
 buffer_load_dwordx4 v12, s[48:51], s22 offen offset:0   lds
M a[8:11], a[48:51], a[160:163], a[8:11]
M a[8:11], a[52:55], a[164:167], a[8:11]
M a[12:15], a[60:63], a[164:167], a[12:15]
 ds_read_b64_tr_b16 a[100:101], v1 offset:40960
 ds_read_b64_tr_b16 a[102:103], v1 offset:41984
M a[12:15], a[56:59], a[160:163], a[12:15]
M a[16:19], a[64:67], a[160:163], a[16:19]
 buffer_load_dwordx4 v13, s[48:51], s22 offen offset:1024   lds
M a[16:19], a[68:71], a[164:167], a[16:19]
M a[20:23], a[76:79], a[164:167], a[20:23]
M a[20:23], a[72:75], a[160:163], a[20:23]
 ds_read_b64_tr_b16 a[104:105], v2 offset:32768
 ds_read_b64_tr_b16 a[106:107], v2 offset:33792
M a[24:27], a[80:83], a[160:163], a[24:27]
M a[24:27], a[84:87], a[164:167], a[24:27]
 s_waitcnt lgkmcnt(6)
M a[28:31], a[92:95], a[164:167], a[28:31]
 buffer_load_dwordx4 v14, s[48:51], s22 offen offset:2048   lds
M a[28:31], a[88:91], a[160:163], a[28:31]
M v[32:35], a[32:35], a[168:171], v[32:35]
 ds_read_b128 a[160:163], v5 offset:4096
 ds_read_b128 a[164:167], v6 offset:4096
M v[32:35], a[36:39], a[172:175], v[32:35]
 ds_read_b64_tr_b16 a[108:109], v2 offset:40960
 ds_read_b64_tr_b16 a[110:111], v2 offset:41984
M v[36:39], a[44:47], a[172:175], v[36:39]
 buffer_load_dwordx4 v15, s[48:51], s22 offen offset:3072   lds
M v[36:39], a[40:43], a[168:171], v[36:39]
 s_sub_u32 s22, s22, 2097024
M v[40:43], a[48:51], a[168:171], v[40:43]
M v[40:43], a[52:55], a[172:175], v[40:43]
 ds_read_b64_tr_b16 a[112:113], v3 offset:32768
 ds_read_b64_tr_b16 a[114:115], v3 offset:33792
M v[44:47], a[60:63], a[172:175], v[44:47]
 s_add_u32 m0, s23, 16384
M v[44:47], a[56:59], a[168:171], v[44:47]
 buffer_load_dwordx4 v8, s[16:19], s21 offen offset:0  nt lds
M v[48:51], a[64:67], a[168:171], v[48:51]
M v[48:51], a[68:71], a[172:175], v[48:51]
M v[52:55], a[76:79], a[172:175], v[52:55]
 ds_read_b64_tr_b16 a[116:117], v3 offset:40960
 ds_read_b64_tr_b16 a[118:119], v3 offset:41984
M v[52:55], a[72:75], a[168:171], v[52:55]
M v[56:59], a[80:83], a[168:171], v[56:59]
 buffer_load_dwordx4 v9, s[16:19], s21 offen offset:1024  nt lds
M v[56:59], a[84:87], a[172:175], v[56:59]
 s_waitcnt lgkmcnt(6)
M v[60:63], a[92:95], a[172:175], v[60:63]
M v[60:63], a[88:91], a[168:171], v[60:63]
 ds_read_b64_tr_b16 a[120:121], v4 offset:32768
 ds_read_b64_tr_b16 a[122:123], v4 offset:33792
M v[64:67], a[32:35], a[160:163], v[64:67]
 ds_read_b128 a[168:171], v5 offset:6144
 ds_read_b128 a[172:175], v6 offset:6144
M v[64:67], a[36:39], a[164:167], v[64:67]
 buffer_load_dwordx4 v10, s[16:19], s21 offen offset:2048  nt lds
M v[68:71], a[44:47], a[164:167], v[68:71]
M v[68:71], a[40:43], a[160:163], v[68:71]
M v[72:75], a[48:51], a[160:163], v[72:75]
 ds_read_b64_tr_b16 a[124:125], v4 offset:40960
 ds_read_b64_tr_b16 a[126:127], v4 offset:41984
M v[72:75], a[52:55], a[164:167], v[72:75]
 v_sub_f32 v48, v48, v27
 v_sub_f32 v49, v49, v27
M v[76:79], a[60:63], a[164:167], v[76:79]
 buffer_load_dwordx4 v11, s[16:19], s21 offen offset:3072  nt lds
M v[76:79], a[56:59], a[160:163], v[76:79]
 s_add_u32 s21, s21, 524160
 v_sub_f32 v50, v50, v27
 v_sub_f32 v51, v51, v27
M v[80:83], a[64:67], a[160:163], v[80:83]
 v_sub_f32 v52, v52, v27
 v_sub_f32 v53, v53, v27
M v[80:83], a[68:71], a[164:167], v[80:83]
 v_sub_f32 v54, v54, v27
 v_sub_f32 v55, v55, v27
M v[84:87], a[76:79], a[164:167], v[84:87]
 v_sub_f32 v56, v56, v27
 v_sub_f32 v57, v57, v27
M v[84:87], a[72:75], a[160:163], v[84:87]
 v_sub_f32 v58, v58, v27
 v_sub_f32 v59, v59, v27
M v[88:91], a[80:83], a[160:163], v[88:91]
 v_sub_f32 v60, v60, v27
 v_sub_f32 v61, v61, v27
M v[88:91], a[84:87], a[164:167], v[88:91]
 s_waitcnt lgkmcnt(2)
 v_sub_f32 v62, v62, v27
 v_sub_f32 v63, v63, v27
M v[92:95], a[92:95], a[164:167], v[92:95]
 s_waitcnt vmcnt(17) lgkmcnt(0)
M v[92:95], a[88:91], a[160:163], v[92:95]
 s_barrier
M v[96:99], a[32:35], a[168:171], v[96:99]
 ds_read_b128 a[160:163], v5 offset:16384
 ds_read_b128 a[164:167], v6 offset:16384
M v[96:99], a[36:39], a[172:175], v[96:99]
M v[100:103], a[44:47], a[172:175], v[100:103]
 s_add_u32 m0, s24, 0
 ds_read_b64_tr_b16 a[128:129], v1 offset:49152
 ds_read_b64_tr_b16 a[130:131], v1 offset:50176
M v[100:103], a[40:43], a[168:171], v[100:103]
 buffer_load_dwordx4 v12, s[48:51], s22 offen offset:0   lds
M v[104:107], a[48:51], a[168:171], v[104:107]
 v_sub_f32 v80, v80, v27
 v_sub_f32 v81, v81, v27
M v[104:107], a[52:55], a[172:175], v[104:107]
 v_sub_f32 v82, v82, v27
 v_sub_f32 v83, v83, v27
M v[108:111], a[60:63], a[172:175], v[108:111]
 v_sub_f32 v84, v84, v27
 v_sub_f32 v85, v85, v27
M v[108:111], a[56:59], a[168:171], v[108:111]
 v_sub_f32 v86, v86, v27
 v_sub_f32 v87, v87, v27
M v[112:115], a[64:67], a[168:171], v[112:115]
 v_sub_f32 v88, v88, v27
 v_sub_f32 v89, v89, v27
M v[112:115], a[68:71], a[172:175], v[112:115]
 ds_read_b64_tr_b16 a[132:133], v1 offset:57344
 ds_read_b64_tr_b16 a[134:135], v1 offset:58368
M v[116:119], a[76:79], a[172:175], v[116:119]
 buffer_load_dwordx4 v13, s[48:51], s22 offen offset:1024   lds
M v[116:119], a[72:75], a[168:171], v[116:119]
 v_sub_f32 v90, v90, v27
 v_sub_f32 v91, v91, v27
M v[120:123], a[80:83], a[168:171], v[120:123]
 v_sub_f32 v92, v92, v27
 v_sub_f32 v93, v93, v27
M v[120:123], a[84:87], a[172:175], v[120:123]
 s_waitcnt lgkmcnt(4)
 v_sub_f32 v94, v94, v27
 v_sub_f32 v95, v95, v27
M v[124:127], a[92:95], a[172:175], v[124:127]
M v[124:127], a[88:91], a[168:171], v[124:127]
M v[128:131], a[32:35], a[160:163], v[128:131]
 ds_read_b128 a[168:171], v5 offset:18432
 ds_read_b128 a[172:175], v6 offset:18432
M v[128:131], a[36:39], a[164:167], v[128:131]
 ds_read_b64_tr_b16 a[136:137], v2 offset:49152
 ds_read_b64_tr_b16 a[138:139], v2 offset:50176
M v[132:135], a[44:47], a[164:167], v[132:135]
 buffer_load_dwordx4 v14, s[48:51], s22 offen offset:2048   lds
M v[132:135], a[40:43], a[160:163], v[132:135]
M v[136:139], a[48:51], a[160:163], v[136:139]
 v_sub_f32 v112, v112, v27
 v_sub_f32 v113, v113, v27
M v[136:139], a[52:55], a[164:167], v[136:139]
 v_sub_f32 v114, v114, v27
 v_sub_f32 v115, v115, v27
M v[140:143], a[60:63], a[164:167], v[140:143]
 v_sub_f32 v116, v116, v27
 v_sub_f32 v117, v117, v27
M v[140:143], a[56:59], a[160:163], v[140:143]
 ds_read_b64_tr_b16 a[140:141], v2 offset:57344
 ds_read_b64_tr_b16 a[142:143], v2 offset:58368
M v[144:147], a[64:67], a[160:163], v[144:147]
 buffer_load_dwordx4 v15, s[48:51], s22 offen offset:3072   lds
M v[144:147], a[68:71], a[164:167], v[144:147]
 s_add_u32 s22, s22, 2097152
 v_sub_f32 v118, v118, v27
 v_sub_f32 v119, v119, v27
M v[148:151], a[76:79], a[164:167], v[148:151]
 v_sub_f32 v120, v120, v27
 v_sub_f32 v121, v121, v27
M v[148:151], a[72:75], a[160:163], v[148:151]
 v_sub_f32 v122, v122, v27
 v_sub_f32 v123, v123, v27
M v[152:155], a[80:83], a[160:163], v[152:155]
 v_sub_f32 v124, v124, v27
 v_sub_f32 v125, v125, v27
M v[152:155], a[84:87], a[164:167], v[152:155]
 s_waitcnt lgkmcnt(4)
 v_sub_f32 v126, v126, v27
 v_sub_f32 v127, v127, v27
M v[156:159], a[92:95], a[164:167], v[156:159]
 s_add_u32 m0, s23, 32768
 ds_read_b64_tr_b16 a[144:145], v3 offset:49152
 ds_read_b64_tr_b16 a[146:147], v3 offset:50176
M v[156:159], a[88:91], a[160:163], v[156:159]
 buffer_load_dwordx4 v8, s[16:19], s21 offen offset:0  nt lds
M v[160:163], a[32:35], a[168:171], v[160:163]
 ds_read_b128 a[160:163], v5 offset:20480
 ds_read_b128 a[164:167], v6 offset:20480
M v[160:163], a[36:39], a[172:175], v[160:163]
M v[164:167], a[44:47], a[172:175], v[164:167]
M v[164:167], a[40:43], a[168:171], v[164:167]
M v[168:171], a[48:51], a[168:171], v[168:171]
 v_sub_f32 v128, v128, v27
 v_sub_f32 v129, v129, v27
M v[168:171], a[52:55], a[172:175], v[168:171]
 ds_read_b64_tr_b16 a[148:149], v3 offset:57344
 ds_read_b64_tr_b16 a[150:151], v3 offset:58368
M v[172:175], a[60:63], a[172:175], v[172:175]
 buffer_load_dwordx4 v9, s[16:19], s21 offen offset:1024  nt lds
M v[172:175], a[56:59], a[168:171], v[172:175]
 v_sub_f32 v130, v130, v27
 v_sub_f32 v131, v131, v27
M v[176:179], a[64:67], a[168:171], v[176:179]
 v_sub_f32 v132, v132, v27
 v_sub_f32 v133, v133, v27
M v[176:179], a[68:71], a[172:175], v[176:179]
 v_sub_f32 v134, v134, v27
 v_sub_f32 v135, v135, v27
M v[180:183], a[76:79], a[172:175], v[180:183]
 v_sub_f32 v136, v136, v27
 v_sub_f32 v137, v137, v27
M v[180:183], a[72:75], a[168:171], v[180:183]
 v_sub_f32 v138, v138, v27
 v_sub_f32 v139, v139, v27
M v[184:187], a[80:83], a[168:171], v[184:187]
 ds_read_b64_tr_b16 a[152:153], v4 offset:49152
 ds_read_b64_tr_b16 a[154:155], v4 offset:50176
M v[184:187], a[84:87], a[172:175], v[184:187]
 s_waitcnt lgkmcnt(4)
 v_sub_f32 v140, v140, v27
 v_sub_f32 v141, v141, v27
M v[188:191], a[92:95], a[172:175], v[188:191]
 buffer_load_dwordx4 v10, s[16:19], s21 offen offset:2048  nt lds
M v[188:191], a[88:91], a[168:171], v[188:191]
 v_sub_f32 v142, v142, v27
 v_sub_f32 v143, v143, v27
M v[192:195], a[32:35], a[160:163], v[192:195]
 ds_read_b128 a[168:171], v5 offset:22528
 ds_read_b128 a[172:175], v6 offset:22528
M v[192:195], a[36:39], a[164:167], v[192:195]
 v_sub_f32 v144, v144, v27
 v_sub_f32 v145, v145, v27
M v[196:199], a[44:47], a[164:167], v[196:199]
 v_sub_f32 v146, v146, v27
 v_sub_f32 v147, v147, v27
M v[196:199], a[40:43], a[160:163], v[196:199]
 ds_read_b64_tr_b16 a[156:157], v4 offset:57344
 ds_read_b64_tr_b16 a[158:159], v4 offset:58368
M v[200:203], a[48:51], a[160:163], v[200:203]
 buffer_load_dwordx4 v11, s[16:19], s21 offen offset:3072  nt lds
M v[200:203], a[52:55], a[164:167], v[200:203]
 s_add_u32 s21, s21, 128
 v_sub_f32 v148, v148, v27
 v_sub_f32 v149, v149, v27
M v[204:207], a[60:63], a[164:167], v[204:207]
 v_sub_f32 v150, v150, v27
 v_sub_f32 v151, v151, v27
M v[204:207], a[56:59], a[160:163], v[204:207]
 v_sub_f32 v152, v152, v27
 v_sub_f32 v153, v153, v27
M v[208:211], a[64:67], a[160:163], v[208:211]
 v_sub_f32 v154, v154, v27
 v_sub_f32 v155, v155, v27
M v[208:211], a[68:71], a[164:167], v[208:211]
 v_sub_f32 v156, v156, v27
 v_sub_f32 v157, v157, v27
M v[212:215], a[76:79], a[164:167], v[212:215]
 v_sub_f32 v158, v158, v27
 v_sub_f32 v159, v159, v27
M v[212:215], a[72:75], a[160:163], v[212:215]
M v[216:219], a[80:83], a[160:163], v[216:219]
M v[216:219], a[84:87], a[164:167], v[216:219]
 s_waitcnt lgkmcnt(2)
M v[220:223], a[92:95], a[164:167], v[220:223]
 s_waitcnt vmcnt(17) lgkmcnt(0)
M v[220:223], a[88:91], a[160:163], v[220:223]
 s_barrier
M v[224:227], a[32:35], a[168:171], v[224:227]
 ds_read_b128 a[160:163], v5 offset:32768
 ds_read_b128 a[164:167], v6 offset:32768
M v[224:227], a[36:39], a[172:175], v[224:227]
 buffer_load_dword a240, v23, s[52:55], 0 offen offset:0
M v[228:231], a[44:47], a[172:175], v[228:231]
 v_add_u32 v23, 16384, v23
M v[228:231], a[40:43], a[168:171], v[228:231]
M v[232:235], a[48:51], a[168:171], v[232:235]
M v[232:235], a[52:55], a[172:175], v[232:235]
M v[236:239], a[60:63], a[172:175], v[236:239]
M v[236:239], a[56:59], a[168:171], v[236:239]
M v[240:243], a[64:67], a[168:171], v[240:243]
M v[240:243], a[68:71], a[172:175], v[240:243]
M v[244:247], a[76:79], a[172:175], v[244:247]
M v[244:247], a[72:75], a[168:171], v[244:247]
M v[248:251], a[80:83], a[168:171], v[248:251]
M v[248:251], a[84:87], a[172:175], v[248:251]
 s_waitcnt lgkmcnt(0)
M v[252:255], a[92:95], a[172:175], v[252:255]
M v[252:255], a[88:91], a[168:171], v[252:255]
M a[0:3], a[96:99], a[160:163], a[0:3]
 ds_read_b128 a[168:171], v5 offset:34816
 ds_read_b128 a[172:175], v6 offset:34816
M a[0:3], a[100:103], a[164:167], a[0:3]
 ds_read_b64_tr_b16 a[32:33], v1 offset:0
 ds_read_b64_tr_b16 a[34:35], v1 offset:1024
M a[4:7], a[108:111], a[164:167], a[4:7]
 s_add_u32 m0, s24, 16384
M a[4:7], a[104:107], a[160:163], a[4:7]
 buffer_load_dwordx4 v12, s[48:51], s22 offen offset:0   lds
M a[8:11], a[112:115], a[160:163], a[8:11]
M a[8:11], a[116:119], a[164:167], a[8:11]
M a[12:15], a[124:127], a[164:167], a[12:15]
 ds_read_b64_tr_b16 a[36:37], v1 offset:8192
 ds_read_b64_tr_b16 a[38:39], v1 offset:9216
M a[12:15], a[120:123], a[160:163], a[12:15]
M a[16:19], a[128:131], a[160:163], a[16:19]
 buffer_load_dwordx4 v13, s[48:51], s22 offen offset:1024   lds
M a[16:19], a[132:135], a[164:167], a[16:19]
M a[20:23], a[140:143], a[164:167], a[20:23]
M a[20:23], a[136:139], a[160:163], a[20:23]
 ds_read_b64_tr_b16 a[40:41], v2 offset:0
 ds_read_b64_tr_b16 a[42:43], v2 offset:1024
M a[24:27], a[144:147], a[160:163], a[24:27]
M a[24:27], a[148:151], a[164:167], a[24:27]
 s_waitcnt lgkmcnt(6)
M a[28:31], a[156:159], a[164:167], a[28:31]
 buffer_load_dwordx4 v14, s[48:51], s22 offen offset:2048   lds
M a[28:31], a[152:155], a[160:163], a[28:31]
M v[32:35], a[96:99], a[168:171], v[32:35]
 ds_read_b128 a[160:163], v5 offset:36864
 ds_read_b128 a[164:167], v6 offset:36864
M v[32:35], a[100:103], a[172:175], v[32:35]
 ds_read_b64_tr_b16 a[44:45], v2 offset:8192
 ds_read_b64_tr_b16 a[46:47], v2 offset:9216
M v[36:39], a[108:111], a[172:175], v[36:39]
 buffer_load_dwordx4 v15, s[48:51], s22 offen offset:3072   lds
M v[36:39], a[104:107], a[168:171], v[36:39]
 s_sub_u32 s22, s22, 2097024
M v[40:43], a[112:115], a[168:171], v[40:43]
M v[40:43], a[116:119], a[172:175], v[40:43]
 ds_read_b64_tr_b16 a[48:49], v3 offset:0
 ds_read_b64_tr_b16 a[50:51], v3 offset:1024
M v[44:47], a[124:127], a[172:175], v[44:47]
 s_add_u32 m0, s23, 49152
M v[44:47], a[120:123], a[168:171], v[44:47]
 buffer_load_dwordx4 v8, s[16:19], s21 offen offset:0  nt lds
M v[48:51], a[128:131], a[168:171], v[48:51]
M v[48:51], a[132:135], a[172:175], v[48:51]
M v[52:55], a[140:143], a[172:175], v[52:55]
 ds_read_b64_tr_b16 a[52:53], v3 offset:8192
 ds_read_b64_tr_b16 a[54:55], v3 offset:9216
M v[52:55], a[136:139], a[168:171], v[52:55]
M v[56:59], a[144:147], a[168:171], v[56:59]
 buffer_load_dwordx4 v9, s[16:19], s21 offen offset:1024  nt lds
M v[56:59], a[148:151], a[172:175], v[56:59]
 s_waitcnt lgkmcnt(6)
M v[60:63], a[156:159], a[172:175], v[60:63]
M v[60:63], a[152:155], a[168:171], v[60:63]
 ds_read_b64_tr_b16 a[56:57], v4 offset:0
 ds_read_b64_tr_b16 a[58:59], v4 offset:1024
M v[64:67], a[96:99], a[160:163], v[64:67]
 ds_read_b128 a[168:171], v5 offset:38912
 ds_read_b128 a[172:175], v6 offset:38912
M v[64:67], a[100:103], a[164:167], v[64:67]
 buffer_load_dwordx4 v10, s[16:19], s21 offen offset:2048  nt lds
M v[68:71], a[108:111], a[164:167], v[68:71]
M v[68:71], a[104:107], a[160:163], v[68:71]
M v[72:75], a[112:115], a[160:163], v[72:75]
 ds_read_b64_tr_b16 a[60:61], v4 offset:8192
 ds_read_b64_tr_b16 a[62:63], v4 offset:9216
M v[72:75], a[116:119], a[164:167], v[72:75]
M v[76:79], a[124:127], a[164:167], v[76:79]
 buffer_load_dwordx4 v11, s[16:19], s21 offen offset:3072  nt lds
M v[76:79], a[120:123], a[160:163], v[76:79]
 s_add_u32 s21, s21, 524160
M v[80:83], a[128:131], a[160:163], v[80:83]
M v[80:83], a[132:135], a[164:167], v[80:83]
M v[84:87], a[140:143], a[164:167], v[84:87]
M v[84:87], a[136:139], a[160:163], v[84:87]
M v[88:91], a[144:147], a[160:163], v[88:91]
M v[88:91], a[148:151], a[164:167], v[88:91]
 s_waitcnt lgkmcnt(2)
M v[92:95], a[156:159], a[164:167], v[92:95]
 s_waitcnt vmcnt(17) lgkmcnt(0)
M v[92:95], a[152:155], a[160:163], v[92:95]
 s_barrier
M v[96:99], a[96:99], a[168:171], v[96:99]
 ds_read_b128 a[160:163], v5 offset:49152
 ds_read_b128 a[164:167], v6 offset:49152
M v[96:99], a[100:103], a[172:175], v[96:99]
M v[100:103], a[108:111], a[172:175], v[100:103]
 s_add_u32 m0, s24, 32768
 ds_read_b64_tr_b16 a[64:65], v1 offset:16384
 ds_read_b64_tr_b16 a[66:67], v1 offset:17408
M v[100:103], a[104:107], a[168:171], v[100:103]
 buffer_load_dwordx4 v12, s[48:51], s22 offen offset:0   lds
M v[104:107], a[112:115], a[168:171], v[104:107]
M v[104:107], a[116:119], a[172:175], v[104:107]
M v[108:111], a[124:127], a[172:175], v[108:111]
M v[108:111], a[120:123], a[168:171], v[108:111]
M v[112:115], a[128:131], a[168:171], v[112:115]
M v[112:115], a[132:135], a[172:175], v[112:115]
 ds_read_b64_tr_b16 a[68:69], v1 offset:24576
 ds_read_b64_tr_b16 a[70:71], v1 offset:25600
M v[116:119], a[140:143], a[172:175], v[116:119]
 buffer_load_dwordx4 v13, s[48:51], s22 offen offset:1024   lds
M v[116:119], a[136:139], a[168:171], v[116:119]
M v[120:123], a[144:147], a[168:171], v[120:123]
M v[120:123], a[148:151], a[172:175], v[120:123]
 s_waitcnt lgkmcnt(4)
M v[124:127], a[156:159], a[172:175], v[124:127]
M v[124:127], a[152:155], a[168:171], v[124:127]
M v[128:131], a[96:99], a[160:163], v[128:131]
 ds_read_b128 a[168:171], v5 offset:51200
 ds_read_b128 a[172:175], v6 offset:51200
M v[128:131], a[100:103], a[164:167], v[128:131]
 ds_read_b64_tr_b16 a[72:73], v2 offset:16384
 ds_read_b64_tr_b16 a[74:75], v2 offset:17408
M v[132:135], a[108:111], a[164:167], v[132:135]
 buffer_load_dwordx4 v14, s[48:51], s22 offen offset:2048   lds
M v[132:135], a[104:107], a[160:163], v[132:135]
M v[136:139], a[112:115], a[160:163], v[136:139]
M v[136:139], a[116:119], a[164:167], v[136:139]
M v[140:143], a[124:127], a[164:167], v[140:143]
M v[140:143], a[120:123], a[160:163], v[140:143]
 ds_read_b64_tr_b16 a[76:77], v2 offset:24576
 ds_read_b64_tr_b16 a[78:79], v2 offset:25600
M v[144:147], a[128:131], a[160:163], v[144:147]
 buffer_load_dwordx4 v15, s[48:51], s22 offen offset:3072   lds
M v[144:147], a[132:135], a[164:167], v[144:147]
 s_add_u32 s22, s22, 2097152
M v[148:151], a[140:143], a[164:167], v[148:151]
M v[148:151], a[136:139], a[160:163], v[148:151]
M v[152:155], a[144:147], a[160:163], v[152:155]
M v[152:155], a[148:151], a[164:167], v[152:155]
 s_waitcnt lgkmcnt(4)
M v[156:159], a[156:159], a[164:167], v[156:159]
 s_add_u32 m0, s23, 0
 ds_read_b64_tr_b16 a[80:81], v3 offset:16384
 ds_read_b64_tr_b16 a[82:83], v3 offset:17408
M v[156:159], a[152:155], a[160:163], v[156:159]
 buffer_load_dwordx4 v8, s[52:55], s28 offen offset:0   lds
M v[160:163], a[96:99], a[168:171], v[160:163]
 ds_read_b128 a[160:163], v5 offset:53248
 ds_read_b128 a[164:167], v6 offset:53248
M v[160:163], a[100:103], a[172:175], v[160:163]
M v[164:167], a[108:111], a[172:175], v[164:167]
M v[164:167], a[104:107], a[168:171], v[164:167]
M v[168:171], a[112:115], a[168:171], v[168:171]
M v[168:171], a[116:119], a[172:175], v[168:171]
 ds_read_b64_tr_b16 a[84:85], v3 offset:24576
 ds_read_b64_tr_b16 a[86:87], v3 offset:25600
M v[172:175], a[124:127], a[172:175], v[172:175]
 buffer_load_dwordx4 v9, s[52:55], s28 offen offset:1024   lds
M v[172:175], a[120:123], a[168:171], v[172:175]
M v[176:179], a[128:131], a[168:171], v[176:179]
M v[176:179], a[132:135], a[172:175], v[176:179]
M v[180:183], a[140:143], a[172:175], v[180:183]
M v[180:183], a[136:139], a[168:171], v[180:183]
M v[184:187], a[144:147], a[168:171], v[184:187]
 ds_read_b64_tr_b16 a[88:89], v4 offset:16384
 ds_read_b64_tr_b16 a[90:91], v4 offset:17408
M v[184:187], a[148:151], a[172:175], v[184:187]
 s_waitcnt lgkmcnt(4)
M v[188:191], a[156:159], a[172:175], v[188:191]
 buffer_load_dwordx4 v10, s[52:55], s28 offen offset:2048   lds
M v[188:191], a[152:155], a[168:171], v[188:191]
M v[192:195], a[96:99], a[160:163], v[192:195]
 ds_read_b128 a[168:171], v5 offset:55296
 ds_read_b128 a[172:175], v6 offset:55296
M v[192:195], a[100:103], a[164:167], v[192:195]
M v[196:199], a[108:111], a[164:167], v[196:199]
M v[196:199], a[104:107], a[160:163], v[196:199]
 ds_read_b64_tr_b16 a[92:93], v4 offset:24576
 ds_read_b64_tr_b16 a[94:95], v4 offset:25600
M v[200:203], a[112:115], a[160:163], v[200:203]
 buffer_load_dwordx4 v11, s[52:55], s28 offen offset:3072   lds
M v[200:203], a[116:119], a[164:167], v[200:203]
 s_add_u32 s28, s28, 128
 v_sub_f32 v160, v160, v27
 v_sub_f32 v161, v161, v27
M v[204:207], a[124:127], a[164:167], v[204:207]
 v_sub_f32 v162, v162, v27
 v_sub_f32 v163, v163, v27
M v[204:207], a[120:123], a[160:163], v[204:207]
 v_sub_f32 v164, v164, v27
 v_sub_f32 v165, v165, v27
M v[208:211], a[128:131], a[160:163], v[208:211]
 v_sub_f32 v166, v166, v27
 v_sub_f32 v167, v167, v27
M v[208:211], a[132:135], a[164:167], v[208:211]
 v_sub_f32 v168, v168, v27
 v_sub_f32 v169, v169, v27
M v[212:215], a[140:143], a[164:167], v[212:215]
 v_sub_f32 v170, v170, v27
 v_sub_f32 v171, v171, v27
M v[212:215], a[136:139], a[160:163], v[212:215]
 v_sub_f32 v172, v172, v27
 v_sub_f32 v173, v173, v27
M v[216:219], a[144:147], a[160:163], v[216:219]
 v_sub_f32 v174, v174, v27
 v_sub_f32 v175, v175, v27
M v[216:219], a[148:151], a[164:167], v[216:219]
 s_waitcnt lgkmcnt(2)
 v_sub_f32 v176, v176, v27
 v_sub_f32 v177, v177, v27
M v[220:223], a[156:159], a[164:167], v[220:223]
 s_waitcnt vmcnt(17) lgkmcnt(0)
 v_sub_f32 v178, v178, v27
 v_sub_f32 v179, v179, v27
M v[220:223], a[152:155], a[160:163], v[220:223]
 s_barrier
M v[224:227], a[96:99], a[168:171], v[224:227]
 ds_read_b128 a[160:163], v5 offset:0
 ds_read_b128 a[164:167], v6 offset:0
M v[224:227], a[100:103], a[172:175], v[224:227]
 v_and_b32 v26, 48, v0
 v_lshlrev_b32 v26, 17, v26
M v[228:231], a[108:111], a[172:175], v[228:231]
 v_or_b32 v26, v26, v0
 v_lshl_add_u32 v26, v26, 7, s95
M v[228:231], a[104:107], a[168:171], v[228:231]
 buffer_load_dword a240, v26, s[76:79], 0 offen offset:0
M v[232:235], a[112:115], a[168:171], v[232:235]
 v_sub_f32 v180, v180, v27
 v_sub_f32 v181, v181, v27
M v[232:235], a[116:119], a[172:175], v[232:235]
 v_sub_f32 v182, v182, v27
 v_sub_f32 v183, v183, v27
M v[236:239], a[124:127], a[172:175], v[236:239]
 v_sub_f32 v184, v184, v27
 v_sub_f32 v185, v185, v27
M v[236:239], a[120:123], a[168:171], v[236:239]
 v_sub_f32 v186, v186, v27
 v_sub_f32 v187, v187, v27
M v[240:243], a[128:131], a[168:171], v[240:243]
 v_sub_f32 v188, v188, v27
 v_sub_f32 v189, v189, v27
M v[240:243], a[132:135], a[172:175], v[240:243]
 v_sub_f32 v190, v190, v27
 v_sub_f32 v191, v191, v27
M v[244:247], a[140:143], a[172:175], v[244:247]
 v_sub_f32 v192, v192, v27
 v_sub_f32 v193, v193, v27
M v[244:247], a[136:139], a[168:171], v[244:247]
 v_sub_f32 v194, v194, v27
 v_sub_f32 v195, v195, v27
M v[248:251], a[144:147], a[168:171], v[248:251]
 v_sub_f32 v196, v196, v27
 v_sub_f32 v197, v197, v27
M v[248:251], a[148:151], a[172:175], v[248:251]
 s_waitcnt lgkmcnt(0)
 v_sub_f32 v198, v198, v27
 v_sub_f32 v199, v199, v27
M v[252:255], a[156:159], a[172:175], v[252:255]
 v_sub_f32 v200, v200, v27
 v_sub_f32 v201, v201, v27
M v[252:255], a[152:155], a[168:171], v[252:255]
 v_sub_f32 v202, v202, v27
 v_sub_f32 v203, v203, v27
M a[0:3], a[32:35], a[160:163], a[0:3]
 ds_read_b128 a[168:171], v5 offset:2048
 ds_read_b128 a[172:175], v6 offset:2048
M a[0:3], a[36:39], a[164:167], a[0:3]
 ds_read_b64_tr_b16 a[96:97], v1 offset:32768
 ds_read_b64_tr_b16 a[98:99], v1 offset:33792
M a[4:7], a[44:47], a[164:167], a[4:7]
 s_add_u32 m0, s24, 49152
 v_lshrrev_b32 v28, 4, v0
 v_add_u32 v28, 0, v28
M a[4:7], a[40:43], a[160:163], a[4:7]
 buffer_load_dwordx4 v12, s[48:51], s22 offen offset:0   lds
M a[8:11], a[48:51], a[160:163], a[8:11]
 v_and_b32 v29, 7, v0
 v_xor_b32 v28, v28, v29
M a[8:11], a[52:55], a[164:167], a[8:11]
 v_lshlrev_b32 v28, 4, v28
 v_lshrrev_b32 v29, 3, v0
M a[12:15], a[60:63], a[164:167], a[12:15]
 ds_read_b64_tr_b16 a[100:101], v1 offset:40960
 ds_read_b64_tr_b16 a[102:103], v1 offset:41984
M a[12:15], a[56:59], a[160:163], a[12:15]
 buffer_load_dwordx4 v13, s[48:51], s22 offen offset:1024   lds
M a[16:19], a[64:67], a[160:163], a[16:19]
 v_mul_u32_u24 v29, 896, v29
 s_mul_i32 s64, s20, 28672
M a[16:19], a[68:71], a[164:167], a[16:19]
 buffer_load_dwordx4 v14, s[48:51], s22 offen offset:2048   lds
M a[20:23], a[76:79], a[164:167], a[20:23]
 s_add_u32 s64, s64, 0
 v_add3_u32 v16, v29, v28, s64
M a[20:23], a[72:75], a[160:163], a[20:23]
 ds_read_b64_tr_b16 a[104:105], v2 offset:32768
 ds_read_b64_tr_b16 a[106:107], v2 offset:33792
M a[24:27], a[80:83], a[160:163], a[24:27]
 v_add_u32 v18, 12288, v16
 v_lshrrev_b32 v28, 4, v0
M a[24:27], a[84:87], a[164:167], a[24:27]
 s_waitcnt lgkmcnt(6)
 v_add_u32 v28, 4, v28
 v_and_b32 v29, 7, v0
M a[28:31], a[92:95], a[164:167], a[28:31]
 buffer_load_dwordx4 v15, s[48:51], s22 offen offset:3072   lds
M a[28:31], a[88:91], a[160:163], a[28:31]
 s_sub_u32 s22, s22, 2097024
 v_xor_b32 v28, v28, v29
 v_lshlrev_b32 v28, 4, v28
M v[32:35], a[32:35], a[168:171], v[32:35]
 s_add_u32 m0, s23, 16384
 ds_read_b128 a[160:163], v5 offset:4096
 ds_read_b128 a[164:167], v6 offset:4096
M v[32:35], a[36:39], a[172:175], v[32:35]
 ds_read_b64_tr_b16 a[108:109], v2 offset:40960
 ds_read_b64_tr_b16 a[110:111], v2 offset:41984
M v[36:39], a[44:47], a[172:175], v[36:39]
 buffer_load_dwordx4 v8, s[52:55], s28 offen offset:0   lds
M v[36:39], a[40:43], a[168:171], v[36:39]
 v_lshrrev_b32 v29, 3, v0
 v_mul_u32_u24 v29, 896, v29
M v[40:43], a[48:51], a[168:171], v[40:43]
 buffer_load_dwordx4 v9, s[52:55], s28 offen offset:1024   lds
M v[40:43], a[52:55], a[172:175], v[40:43]
 ds_read_b64_tr_b16 a[112:113], v3 offset:32768
 ds_read_b64_tr_b16 a[114:115], v3 offset:33792
M v[44:47], a[60:63], a[172:175], v[44:47]
 s_mul_i32 s64, s20, 28672
 s_add_u32 s64, s64, 6144
M v[44:47], a[56:59], a[168:171], v[44:47]
 buffer_load_dwordx4 v10, s[52:55], s28 offen offset:2048   lds
M v[48:51], a[64:67], a[168:171], v[48:51]
 v_add3_u32 v17, v29, v28, s64
 v_add_u32 v19, 12288, v17
M v[48:51], a[68:71], a[172:175], v[48:51]
 v_add_u32 v20, 0x20000, v1
 v_add_u32 v21, 0x20000, v2
M v[52:55], a[76:79], a[172:175], v[52:55]
 ds_read_b64_tr_b16 a[116:117], v3 offset:40960
 ds_read_b64_tr_b16 a[118:119], v3 offset:41984
M v[52:55], a[72:75], a[168:171], v[52:55]
 buffer_load_dwordx4 v11, s[52:55], s28 offen offset:3072   lds
M v[56:59], a[80:83], a[168:171], v[56:59]
 s_add_u32 s28, s28, 1048448
 v_add_u32 v22, 0x20000, v3
 v_add_u32 v23, 0x20000, v4
M v[56:59], a[84:87], a[172:175], v[56:59]
 s_waitcnt lgkmcnt(6)
 v_sub_f32 v204, v204, v27
 v_sub_f32 v205, v205, v27
M v[60:63], a[92:95], a[172:175], v[60:63]
 s_add_u32 m0, s23, 131072
 v_sub_f32 v206, v206, v27
 v_sub_f32 v207, v207, v27
M v[60:63], a[88:91], a[168:171], v[60:63]
 ds_read_b64_tr_b16 a[120:121], v4 offset:32768
 ds_read_b64_tr_b16 a[122:123], v4 offset:33792
M v[64:67], a[32:35], a[160:163], v[64:67]
 ds_read_b128 a[168:171], v5 offset:6144
 ds_read_b128 a[172:175], v6 offset:6144
M v[64:67], a[36:39], a[164:167], v[64:67]
 buffer_load_dwordx4 v8, s[52:55], s28 offen offset:0   lds
M v[68:71], a[44:47], a[164:167], v[68:71]
 buffer_load_dwordx4 v9, s[52:55], s28 offen offset:1024   lds
M v[68:71], a[40:43], a[160:163], v[68:71]
 v_sub_f32 v208, v208, v27
 v_sub_f32 v209, v209, v27
M v[72:75], a[48:51], a[160:163], v[72:75]
 ds_read_b64_tr_b16 a[124:125], v4 offset:40960
 ds_read_b64_tr_b16 a[126:127], v4 offset:41984
M v[72:75], a[52:55], a[164:167], v[72:75]
 buffer_load_dwordx4 v10, s[52:55], s28 offen offset:2048   lds
M v[76:79], a[60:63], a[164:167], v[76:79]
 v_sub_f32 v210, v210, v27
 v_sub_f32 v211, v211, v27
M v[76:79], a[56:59], a[160:163], v[76:79]
 v_sub_f32 v212, v212, v27
 v_sub_f32 v213, v213, v27
M v[80:83], a[64:67], a[160:163], v[80:83]
 buffer_load_dwordx4 v11, s[52:55], s28 offen offset:3072   lds
M v[80:83], a[68:71], a[164:167], v[80:83]
 s_sub_u32 s28, s28, 524288
 v_sub_f32 v214, v214, v27
 v_sub_f32 v215, v215, v27
M v[84:87], a[76:79], a[164:167], v[84:87]
 v_sub_f32 v216, v216, v27
 v_sub_f32 v217, v217, v27
M v[84:87], a[72:75], a[160:163], v[84:87]
 v_sub_f32 v218, v218, v27
 v_sub_f32 v219, v219, v27
M v[88:91], a[80:83], a[160:163], v[88:91]
 v_sub_f32 v220, v220, v27
 v_sub_f32 v221, v221, v27
M v[88:91], a[84:87], a[164:167], v[88:91]
 s_waitcnt lgkmcnt(2)
 v_sub_f32 v222, v222, v27
 v_sub_f32 v223, v223, v27
M v[92:95], a[92:95], a[164:167], v[92:95]
 s_waitcnt vmcnt(21) lgkmcnt(0)
 v_sub_f32 v224, v224, v27
 v_sub_f32 v225, v225, v27
M v[92:95], a[88:91], a[160:163], v[92:95]
 s_barrier
M v[96:99], a[32:35], a[168:171], v[96:99]
 ds_read_b128 a[160:163], v5 offset:16384
 ds_read_b128 a[164:167], v6 offset:16384
M v[96:99], a[36:39], a[172:175], v[96:99]
 v_sub_f32 v226, v226, v27
 v_sub_f32 v227, v227, v27
M v[100:103], a[44:47], a[172:175], v[100:103]
 s_add_u32 m0, s24, 0
 ds_read_b64_tr_b16 a[128:129], v1 offset:49152
 ds_read_b64_tr_b16 a[130:131], v1 offset:50176
M v[100:103], a[40:43], a[168:171], v[100:103]
 buffer_load_dwordx4 v16, s[56:59], s29 offen offset:0   lds
M v[104:107], a[48:51], a[168:171], v[104:107]
 s_mul_i32 s72, s41, 4352
 v_sub_f32 v228, v228, v27
M v[104:107], a[52:55], a[172:175], v[104:107]
 s_add_u32 s46, s72, 104923136
 v_sub_f32 v229, v229, v27
 v_sub_f32 v230, v230, v27
M v[108:111], a[60:63], a[172:175], v[108:111]
 s_lshl_b32 s45, s42, 7
 s_add_u32 s45, s45, s46
 s_sub_u32 s66, 15, s42
M v[108:111], a[56:59], a[168:171], v[108:111]
 buffer_load_dwordx4 v17, s[56:59], s29 offen offset:1024   lds
M v[112:115], a[64:67], a[168:171], v[112:115]
 s_min_u32 s66, s66, s42
 v_sub_f32 v231, v231, v27
M v[112:115], a[68:71], a[172:175], v[112:115]
 s_lshl_b32 s47, s66, 7
 ds_read_b64_tr_b16 a[132:133], v1 offset:57344
 ds_read_b64_tr_b16 a[134:135], v1 offset:58368
M v[116:119], a[76:79], a[172:175], v[116:119]
 s_add_u32 s47, s47, s46
 v_sub_f32 v232, v232, v27
 v_sub_f32 v233, v233, v27
M v[116:119], a[72:75], a[168:171], v[116:119]
 s_add_u32 s47, s47, 2048
 s_lshl2_add_u32 s47, s20, s47
 s_lshl_b32 s65, s41, 3
M v[120:123], a[80:83], a[168:171], v[120:123]
 buffer_load_dwordx4 v18, s[56:59], s29 offen offset:2048   lds
M v[120:123], a[84:87], a[172:175], v[120:123]
 s_waitcnt lgkmcnt(4)
 s_add_u32 s65, s65, s66
 v_sub_f32 v234, v234, v27
M v[124:127], a[92:95], a[172:175], v[124:127]
 s_mul_i32 s34, s65, 73728
 v_sub_f32 v235, v235, v27
 v_sub_f32 v236, v236, v27
M v[124:127], a[88:91], a[168:171], v[124:127]
 s_add_u32 s34, s34, 50331648
 v_sub_f32 v237, v237, v27
 v_sub_f32 v238, v238, v27
M v[128:131], a[32:35], a[160:163], v[128:131]
 s_lshl_b32 s65, s42, 4
 ds_read_b128 a[168:171], v5 offset:18432
 ds_read_b128 a[172:175], v6 offset:18432
M v[128:131], a[36:39], a[164:167], v[128:131]
 s_add_u32 s65, s65, s41
 ds_read_b64_tr_b16 a[136:137], v2 offset:49152
 ds_read_b64_tr_b16 a[138:139], v2 offset:50176
M v[132:135], a[44:47], a[164:167], v[132:135]
 buffer_load_dwordx4 v19, s[56:59], s29 offen offset:3072   lds
M v[132:135], a[40:43], a[160:163], v[132:135]
 s_add_u32 s29, s29, 128
 s_mul_i32 s33, s65, 114688
 v_sub_f32 v239, v239, v27
M v[136:139], a[48:51], a[160:163], v[136:139]
 s_mul_i32 s65, s20, 28672
 s_add_u32 s33, s33, s65
 s_add_u32 s33, s33, 67108864
M v[136:139], a[52:55], a[164:167], v[136:139]
 s_add_u32 m0, s23, 32768
 s_sub_u32 s65, 15, s66
 s_lshl_b32 s65, s65, 16
M v[140:143], a[60:63], a[164:167], v[140:143]
 buffer_load_dwordx4 v8, s[52:55], s28 offen offset:0   lds
M v[140:143], a[56:59], a[160:163], v[140:143]
 ds_read_b64_tr_b16 a[140:141], v2 offset:57344
 ds_read_b64_tr_b16 a[142:143], v2 offset:58368
M v[144:147], a[64:67], a[160:163], v[144:147]
 s_lshl_b32 s64, s41, 20
 v_sub_f32 v240, v240, v27
M v[144:147], a[68:71], a[164:167], v[144:147]
 s_add_u32 s32, s64, s65
 s_lshl_b32 s65, s20, 14
 s_add_u32 s32, s32, s65
M v[148:151], a[76:79], a[164:167], v[148:151]
 buffer_load_dwordx4 v9, s[52:55], s28 offen offset:1024   lds
M v[148:151], a[72:75], a[160:163], v[148:151]
 s_add_u32 s32, s32, 33554432
 v_sub_f32 v241, v241, v27
M v[152:155], a[80:83], a[160:163], v[152:155]
 s_mov_b32 s31, 0x53800000
 s_mov_b32 s40, 1
 s_sub_u32 s64, s42, 10
M v[152:155], a[84:87], a[164:167], v[152:155]
 s_waitcnt lgkmcnt(4)
 s_and_b32 s35, s64, 536870912
 v_sub_f32 v242, v242, v27
M v[156:159], a[92:95], a[164:167], v[156:159]
 ds_read_b64_tr_b16 a[144:145], v3 offset:49152
 ds_read_b64_tr_b16 a[146:147], v3 offset:50176
M v[156:159], a[88:91], a[160:163], v[156:159]
 buffer_load_dwordx4 v10, s[52:55], s28 offen offset:2048   lds
M v[160:163], a[32:35], a[168:171], v[160:163]
 ds_read_b128 a[160:163], v5 offset:20480
 ds_read_b128 a[164:167], v6 offset:20480
M v[160:163], a[36:39], a[172:175], v[160:163]
 v_sub_f32 v243, v243, v27
 v_sub_f32 v244, v244, v27
M v[164:167], a[44:47], a[172:175], v[164:167]
 v_sub_f32 v245, v245, v27
 v_sub_f32 v246, v246, v27
M v[164:167], a[40:43], a[168:171], v[164:167]
 v_sub_f32 v247, v247, v27
 v_sub_f32 v248, v248, v27
M v[168:171], a[48:51], a[168:171], v[168:171]
 buffer_load_dwordx4 v11, s[52:55], s28 offen offset:3072   lds
M v[168:171], a[52:55], a[172:175], v[168:171]
 s_add_u32 s28, s28, 524416
 ds_read_b64_tr_b16 a[148:149], v3 offset:57344
 ds_read_b64_tr_b16 a[150:151], v3 offset:58368
M v[172:175], a[60:63], a[172:175], v[172:175]
 v_sub_f32 v249, v249, v27
 v_sub_f32 v250, v250, v27
M v[172:175], a[56:59], a[168:171], v[172:175]
 v_sub_f32 v251, v251, v27
 v_sub_f32 v252, v252, v27
M v[176:179], a[64:67], a[168:171], v[176:179]
 s_add_u32 m0, s23, 147456
 v_sub_f32 v253, v253, v27
 v_sub_f32 v254, v254, v27
M v[176:179], a[68:71], a[172:175], v[176:179]
 buffer_load_dwordx4 v8, s[52:55], s28 offen offset:0   lds
M v[180:183], a[76:79], a[172:175], v[180:183]
 v_sub_f32 v255, v255, v27
M v[180:183], a[72:75], a[168:171], v[180:183]
M v[184:187], a[80:83], a[168:171], v[184:187]
 ds_read_b64_tr_b16 a[152:153], v4 offset:49152
 ds_read_b64_tr_b16 a[154:155], v4 offset:50176
M v[184:187], a[84:87], a[172:175], v[184:187]
 s_waitcnt lgkmcnt(4)
M v[188:191], a[92:95], a[172:175], v[188:191]
 buffer_load_dwordx4 v9, s[52:55], s28 offen offset:1024   lds
M v[188:191], a[88:91], a[168:171], v[188:191]
M v[192:195], a[32:35], a[160:163], v[192:195]
 ds_read_b128 a[168:171], v5 offset:22528
 ds_read_b128 a[172:175], v6 offset:22528
M v[192:195], a[36:39], a[164:167], v[192:195]
M v[196:199], a[44:47], a[164:167], v[196:199]
 buffer_load_dwordx4 v10, s[52:55], s28 offen offset:2048   lds
M v[196:199], a[40:43], a[160:163], v[196:199]
 ds_read_b64_tr_b16 a[156:157], v4 offset:57344
 ds_read_b64_tr_b16 a[158:159], v4 offset:58368
M v[200:203], a[48:51], a[160:163], v[200:203]
M v[200:203], a[52:55], a[164:167], v[200:203]
M v[204:207], a[60:63], a[164:167], v[204:207]
M v[204:207], a[56:59], a[160:163], v[204:207]
 buffer_load_dwordx4 v11, s[52:55], s28 offen offset:3072   lds
M v[208:211], a[64:67], a[160:163], v[208:211]
 s_sub_u32 s28, s28, 524288
M v[208:211], a[68:71], a[164:167], v[208:211]
M v[212:215], a[76:79], a[164:167], v[212:215]
M v[212:215], a[72:75], a[160:163], v[212:215]
M v[216:219], a[80:83], a[160:163], v[216:219]
M v[216:219], a[84:87], a[164:167], v[216:219]
 s_waitcnt lgkmcnt(2)
M v[220:223], a[92:95], a[164:167], v[220:223]
 s_waitcnt vmcnt(25) lgkmcnt(0)
M v[220:223], a[88:91], a[160:163], v[220:223]
 s_barrier
M v[224:227], a[32:35], a[168:171], v[224:227]
 ds_read_b128 a[160:163], v5 offset:32768
 ds_read_b128 a[164:167], v6 offset:32768
M v[224:227], a[36:39], a[172:175], v[224:227]
M v[228:231], a[44:47], a[172:175], v[228:231]
M v[228:231], a[40:43], a[168:171], v[228:231]
M v[232:235], a[48:51], a[168:171], v[232:235]
M v[232:235], a[52:55], a[172:175], v[232:235]
M v[236:239], a[60:63], a[172:175], v[236:239]
M v[236:239], a[56:59], a[168:171], v[236:239]
M v[240:243], a[64:67], a[168:171], v[240:243]
M v[240:243], a[68:71], a[172:175], v[240:243]
M v[244:247], a[76:79], a[172:175], v[244:247]
M v[244:247], a[72:75], a[168:171], v[244:247]
M v[248:251], a[80:83], a[168:171], v[248:251]
M v[248:251], a[84:87], a[172:175], v[248:251]
 s_waitcnt lgkmcnt(0)
M v[252:255], a[92:95], a[172:175], v[252:255]
M v[252:255], a[88:91], a[168:171], v[252:255]
M a[0:3], a[96:99], a[160:163], a[0:3]
 ds_read_b128 a[168:171], v5 offset:34816
 ds_read_b128 a[172:175], v6 offset:34816
M a[0:3], a[100:103], a[164:167], a[0:3]
 ds_read_b64_tr_b16 a[32:33], v1 offset:0
 ds_read_b64_tr_b16 a[34:35], v1 offset:1024
M a[4:7], a[108:111], a[164:167], a[4:7]
 s_add_u32 m0, s24, 16384
M a[4:7], a[104:107], a[160:163], a[4:7]
 buffer_load_dwordx4 v16, s[56:59], s29 offen offset:0   lds
M a[8:11], a[112:115], a[160:163], a[8:11]
M a[8:11], a[116:119], a[164:167], a[8:11]
M a[12:15], a[124:127], a[164:167], a[12:15]
 ds_read_b64_tr_b16 a[36:37], v1 offset:8192
 ds_read_b64_tr_b16 a[38:39], v1 offset:9216
M a[12:15], a[120:123], a[160:163], a[12:15]
M a[16:19], a[128:131], a[160:163], a[16:19]
 buffer_load_dwordx4 v17, s[56:59], s29 offen offset:1024   lds
M a[16:19], a[132:135], a[164:167], a[16:19]
 v_accvgpr_read_b32 v24, a0
 v_accvgpr_read_b32 v25, a1
M a[20:23], a[140:143], a[164:167], a[20:23]
 v_accvgpr_read_b32 v26, a2
 v_accvgpr_read_b32 v27, a3
M a[20:23], a[136:139], a[160:163], a[20:23]
 ds_read_b64_tr_b16 a[40:41], v2 offset:0
 ds_read_b64_tr_b16 a[42:43], v2 offset:1024
M a[24:27], a[144:147], a[160:163], a[24:27]
 v_accvgpr_read_b32 v28, a4
 v_accvgpr_read_b32 v29, a5
M a[24:27], a[148:151], a[164:167], a[24:27]
 s_waitcnt lgkmcnt(6)
 buffer_load_dwordx4 v18, s[56:59], s29 offen offset:2048   lds
M a[28:31], a[156:159], a[164:167], a[28:31]
 v_accvgpr_read_b32 v30, a6
 v_accvgpr_read_b32 v31, a7
M a[28:31], a[152:155], a[160:163], a[28:31]
 v_cvt_pk_bf16_f32 v24, v24, v25
 v_cvt_pk_bf16_f32 v25, v26, v27
M v[32:35], a[96:99], a[168:171], v[32:35]
 ds_read_b128 a[160:163], v5 offset:36864
 ds_read_b128 a[164:167], v6 offset:36864
M v[32:35], a[100:103], a[172:175], v[32:35]
 ds_read_b64_tr_b16 a[44:45], v2 offset:8192
 ds_read_b64_tr_b16 a[46:47], v2 offset:9216
M v[36:39], a[108:111], a[172:175], v[36:39]
 buffer_load_dwordx4 v19, s[56:59], s29 offen offset:3072   lds
M v[36:39], a[104:107], a[168:171], v[36:39]
 s_add_u32 s29, s29, 128
 v_cvt_pk_bf16_f32 v26, v28, v29
 v_cvt_pk_bf16_f32 v27, v30, v31
M v[40:43], a[112:115], a[168:171], v[40:43]
 s_add_u32 s3, s93, 0
 buffer_store_dwordx4 v[24:27], v7, s[8:11], s3 offen offset:0 sc1
M v[40:43], a[116:119], a[172:175], v[40:43]
 ds_read_b64_tr_b16 a[48:49], v3 offset:0
 ds_read_b64_tr_b16 a[50:51], v3 offset:1024
M v[44:47], a[124:127], a[172:175], v[44:47]
 s_add_u32 m0, s23, 49152
 v_accvgpr_read_b32 v24, a8
 v_accvgpr_read_b32 v25, a9
M v[44:47], a[120:123], a[168:171], v[44:47]
 buffer_load_dwordx4 v8, s[52:55], s28 offen offset:0   lds
M v[48:51], a[128:131], a[168:171], v[48:51]
 v_accvgpr_read_b32 v26, a10
 v_accvgpr_read_b32 v27, a11
M v[48:51], a[132:135], a[172:175], v[48:51]
 v_accvgpr_read_b32 v28, a12
 v_accvgpr_read_b32 v29, a13
M v[52:55], a[140:143], a[172:175], v[52:55]
 ds_read_b64_tr_b16 a[52:53], v3 offset:8192
 ds_read_b64_tr_b16 a[54:55], v3 offset:9216
M v[52:55], a[136:139], a[168:171], v[52:55]
 v_accvgpr_read_b32 v30, a14
 v_accvgpr_read_b32 v31, a15
M v[56:59], a[144:147], a[168:171], v[56:59]
 buffer_load_dwordx4 v9, s[52:55], s28 offen offset:1024   lds
M v[56:59], a[148:151], a[172:175], v[56:59]
 s_waitcnt lgkmcnt(6)
 v_cvt_pk_bf16_f32 v24, v24, v25
 v_cvt_pk_bf16_f32 v25, v26, v27
M v[60:63], a[156:159], a[172:175], v[60:63]
 v_cvt_pk_bf16_f32 v26, v28, v29
 v_cvt_pk_bf16_f32 v27, v30, v31
M v[60:63], a[152:155], a[168:171], v[60:63]
 ds_read_b64_tr_b16 a[56:57], v4 offset:0
 ds_read_b64_tr_b16 a[58:59], v4 offset:1024
M v[64:67], a[96:99], a[160:163], v[64:67]
 ds_read_b128 a[168:171], v5 offset:38912
 ds_read_b128 a[172:175], v6 offset:38912
M v[64:67], a[100:103], a[164:167], v[64:67]
 buffer_load_dwordx4 v10, s[52:55], s28 offen offset:2048   lds
M v[68:71], a[108:111], a[164:167], v[68:71]
M v[68:71], a[104:107], a[160:163], v[68:71]
 buffer_store_dwordx4 v[24:27], v7, s[8:11], s3 offen offset:1024 sc1
M v[72:75], a[112:115], a[160:163], v[72:75]
 ds_read_b64_tr_b16 a[60:61], v4 offset:8192
 ds_read_b64_tr_b16 a[62:63], v4 offset:9216
M v[72:75], a[116:119], a[164:167], v[72:75]
 v_accvgpr_read_b32 v24, a16
 v_accvgpr_read_b32 v25, a17
M v[76:79], a[124:127], a[164:167], v[76:79]
 buffer_load_dwordx4 v11, s[52:55], s28 offen offset:3072   lds
M v[76:79], a[120:123], a[160:163], v[76:79]
 s_add_u32 s28, s28, 1048448
 v_accvgpr_read_b32 v26, a18
 v_accvgpr_read_b32 v27, a19
M v[80:83], a[128:131], a[160:163], v[80:83]
 v_accvgpr_read_b32 v28, a20
 v_accvgpr_read_b32 v29, a21
M v[80:83], a[132:135], a[164:167], v[80:83]
 v_accvgpr_read_b32 v30, a22
 v_accvgpr_read_b32 v31, a23
M v[84:87], a[140:143], a[164:167], v[84:87]
 v_cvt_pk_bf16_f32 v24, v24, v25
 v_cvt_pk_bf16_f32 v25, v26, v27
M v[84:87], a[136:139], a[160:163], v[84:87]
 v_cvt_pk_bf16_f32 v26, v28, v29
 v_cvt_pk_bf16_f32 v27, v30, v31
M v[88:91], a[144:147], a[160:163], v[88:91]
 buffer_store_dwordx4 v[24:27], v7, s[8:11], s3 offen offset:2048 sc1
M v[88:91], a[148:151], a[164:167], v[88:91]
 s_waitcnt lgkmcnt(2)
 v_accvgpr_read_b32 v24, a24
 v_accvgpr_read_b32 v25, a25
M v[92:95], a[156:159], a[164:167], v[92:95]
 s_waitcnt vmcnt(27) lgkmcnt(0)
 v_accvgpr_read_b32 v26, a26
 v_accvgpr_read_b32 v27, a27
M v[92:95], a[152:155], a[160:163], v[92:95]
 s_barrier
M v[96:99], a[96:99], a[168:171], v[96:99]
 ds_read_b128 a[160:163], v5 offset:49152
 ds_read_b128 a[164:167], v6 offset:49152
M v[96:99], a[100:103], a[172:175], v[96:99]
 v_accvgpr_read_b32 v28, a28
 v_accvgpr_read_b32 v29, a29
M v[100:103], a[108:111], a[172:175], v[100:103]
 s_add_u32 m0, s24, 32768
 ds_read_b64_tr_b16 a[64:65], v1 offset:16384
 ds_read_b64_tr_b16 a[66:67], v1 offset:17408
M v[100:103], a[104:107], a[168:171], v[100:103]
 buffer_load_dwordx4 v16, s[56:59], s29 offen offset:0   lds
M v[104:107], a[112:115], a[168:171], v[104:107]
 v_accvgpr_read_b32 v30, a30
 v_accvgpr_read_b32 v31, a31
M v[104:107], a[116:119], a[172:175], v[104:107]
 v_cvt_pk_bf16_f32 v24, v24, v25
 v_cvt_pk_bf16_f32 v25, v26, v27
M v[108:111], a[124:127], a[172:175], v[108:111]
 v_cvt_pk_bf16_f32 v26, v28, v29
 v_cvt_pk_bf16_f32 v27, v30, v31
M v[108:111], a[120:123], a[168:171], v[108:111]
 buffer_store_dwordx4 v[24:27], v7, s[8:11], s3 offen offset:3072 sc1
M v[112:115], a[128:131], a[168:171], v[112:115]
 v_cvt_pk_bf16_f32 v32, v32, v33
 v_cvt_pk_bf16_f32 v33, v34, v35
M v[112:115], a[132:135], a[172:175], v[112:115]
 ds_read_b64_tr_b16 a[68:69], v1 offset:24576
 ds_read_b64_tr_b16 a[70:71], v1 offset:25600
M v[116:119], a[140:143], a[172:175], v[116:119]
 buffer_load_dwordx4 v17, s[56:59], s29 offen offset:1024   lds
M v[116:119], a[136:139], a[168:171], v[116:119]
 v_cvt_pk_bf16_f32 v34, v36, v37
 v_cvt_pk_bf16_f32 v35, v38, v39
M v[120:123], a[144:147], a[168:171], v[120:123]
 v_accvgpr_write_b32 a4, v32
 v_accvgpr_write_b32 a5, v33
M v[120:123], a[148:151], a[172:175], v[120:123]
 s_waitcnt lgkmcnt(4)
 v_accvgpr_write_b32 a6, v34
 v_accvgpr_write_b32 a7, v35
M v[124:127], a[156:159], a[172:175], v[124:127]
 v_cvt_pk_bf16_f32 v40, v40, v41
 v_cvt_pk_bf16_f32 v41, v42, v43
M v[124:127], a[152:155], a[168:171], v[124:127]
 v_cvt_pk_bf16_f32 v42, v44, v45
 v_cvt_pk_bf16_f32 v43, v46, v47
M v[128:131], a[96:99], a[160:163], v[128:131]
 ds_read_b128 a[168:171], v5 offset:51200
 ds_read_b128 a[172:175], v6 offset:51200
M v[128:131], a[100:103], a[164:167], v[128:131]
 ds_read_b64_tr_b16 a[72:73], v2 offset:16384
 ds_read_b64_tr_b16 a[74:75], v2 offset:17408
M v[132:135], a[108:111], a[164:167], v[132:135]
 buffer_load_dwordx4 v18, s[56:59], s29 offen offset:2048   lds
M v[132:135], a[104:107], a[160:163], v[132:135]
 v_accvgpr_write_b32 a12, v40
 v_accvgpr_write_b32 a13, v41
M v[136:139], a[112:115], a[160:163], v[136:139]
 v_accvgpr_write_b32 a14, v42
 v_accvgpr_write_b32 a15, v43
M v[136:139], a[116:119], a[164:167], v[136:139]
 v_cvt_pk_bf16_f32 v48, v48, v49
 v_cvt_pk_bf16_f32 v49, v50, v51
M v[140:143], a[124:127], a[164:167], v[140:143]
 v_cvt_pk_bf16_f32 v50, v52, v53
 v_cvt_pk_bf16_f32 v51, v54, v55
M v[140:143], a[120:123], a[160:163], v[140:143]
 ds_read_b64_tr_b16 a[76:77], v2 offset:24576
 ds_read_b64_tr_b16 a[78:79], v2 offset:25600
M v[144:147], a[128:131], a[160:163], v[144:147]
 buffer_load_dwordx4 v19, s[56:59], s29 offen offset:3072   lds
M v[144:147], a[132:135], a[164:167], v[144:147]
 s_add_u32 s29, s29, 128
 v_accvgpr_write_b32 a20, v48
 v_accvgpr_write_b32 a21, v49
M v[148:151], a[140:143], a[164:167], v[148:151]
 v_accvgpr_write_b32 a22, v50
 v_accvgpr_write_b32 a23, v51
M v[148:151], a[136:139], a[160:163], v[148:151]
 v_cvt_pk_bf16_f32 v56, v56, v57
 v_cvt_pk_bf16_f32 v57, v58, v59
M v[152:155], a[144:147], a[160:163], v[152:155]
 v_cvt_pk_bf16_f32 v58, v60, v61
 v_cvt_pk_bf16_f32 v59, v62, v63
M v[152:155], a[148:151], a[164:167], v[152:155]
 s_waitcnt lgkmcnt(4)
 v_accvgpr_write_b32 a28, v56
 v_accvgpr_write_b32 a29, v57
M v[156:159], a[156:159], a[164:167], v[156:159]
 s_add_u32 m0, s23, 0
 ds_read_b64_tr_b16 a[80:81], v3 offset:16384
 ds_read_b64_tr_b16 a[82:83], v3 offset:17408
M v[156:159], a[152:155], a[160:163], v[156:159]
 buffer_load_dwordx4 v8, s[52:55], s28 offen offset:0   lds
M v[160:163], a[96:99], a[168:171], v[160:163]
 ds_read_b128 a[160:163], v5 offset:53248
 ds_read_b128 a[164:167], v6 offset:53248
M v[160:163], a[100:103], a[172:175], v[160:163]
 v_accvgpr_write_b32 a30, v58
 v_accvgpr_write_b32 a31, v59
M v[164:167], a[108:111], a[172:175], v[164:167]
 v_cvt_pk_bf16_f32 v64, v64, v65
 v_cvt_pk_bf16_f32 v65, v66, v67
M v[164:167], a[104:107], a[168:171], v[164:167]
 v_cvt_pk_bf16_f32 v66, v68, v69
 v_cvt_pk_bf16_f32 v67, v70, v71
M v[168:171], a[112:115], a[168:171], v[168:171]
 v_cvt_pk_bf16_f32 v72, v72, v73
 v_cvt_pk_bf16_f32 v73, v74, v75
M v[168:171], a[116:119], a[172:175], v[168:171]
 ds_read_b64_tr_b16 a[84:85], v3 offset:24576
 ds_read_b64_tr_b16 a[86:87], v3 offset:25600
M v[172:175], a[124:127], a[172:175], v[172:175]
 buffer_load_dwordx4 v9, s[52:55], s28 offen offset:1024   lds
M v[172:175], a[120:123], a[168:171], v[172:175]
 v_cvt_pk_bf16_f32 v74, v76, v77
 v_cvt_pk_bf16_f32 v75, v78, v79
M v[176:179], a[128:131], a[168:171], v[176:179]
 v_cvt_pk_bf16_f32 v80, v80, v81
 v_cvt_pk_bf16_f32 v81, v82, v83
M v[176:179], a[132:135], a[172:175], v[176:179]
 v_cvt_pk_bf16_f32 v82, v84, v85
 v_cvt_pk_bf16_f32 v83, v86, v87
M v[180:183], a[140:143], a[172:175], v[180:183]
 v_cvt_pk_bf16_f32 v88, v88, v89
 v_cvt_pk_bf16_f32 v89, v90, v91
M v[180:183], a[136:139], a[168:171], v[180:183]
 v_cvt_pk_bf16_f32 v90, v92, v93
 v_cvt_pk_bf16_f32 v91, v94, v95
M v[184:187], a[144:147], a[168:171], v[184:187]
 ds_read_b64_tr_b16 a[88:89], v4 offset:16384
 ds_read_b64_tr_b16 a[90:91], v4 offset:17408
M v[184:187], a[148:151], a[172:175], v[184:187]
 s_waitcnt lgkmcnt(4)
 buffer_load_dwordx4 v10, s[52:55], s28 offen offset:2048   lds
M v[188:191], a[156:159], a[172:175], v[188:191]
 v_cvt_pk_bf16_f32 v96, v96, v97
 v_cvt_pk_bf16_f32 v97, v98, v99
M v[188:191], a[152:155], a[168:171], v[188:191]
 v_cvt_pk_bf16_f32 v98, v100, v101
 v_cvt_pk_bf16_f32 v99, v102, v103
M v[192:195], a[96:99], a[160:163], v[192:195]
 ds_read_b128 a[168:171], v5 offset:55296
 ds_read_b128 a[172:175], v6 offset:55296
M v[192:195], a[100:103], a[164:167], v[192:195]
 v_cvt_pk_bf16_f32 v104, v104, v105
 v_cvt_pk_bf16_f32 v105, v106, v107
M v[196:199], a[108:111], a[164:167], v[196:199]
 v_cvt_pk_bf16_f32 v106, v108, v109
 v_cvt_pk_bf16_f32 v107, v110, v111
M v[196:199], a[104:107], a[160:163], v[196:199]
 ds_read_b64_tr_b16 a[92:93], v4 offset:24576
 ds_read_b64_tr_b16 a[94:95], v4 offset:25600
M v[200:203], a[112:115], a[160:163], v[200:203]
 buffer_load_dwordx4 v11, s[52:55], s28 offen offset:3072   lds
M v[200:203], a[116:119], a[164:167], v[200:203]
 s_add_u32 s28, s28, 128
 v_cvt_pk_bf16_f32 v112, v112, v113
 v_cvt_pk_bf16_f32 v113, v114, v115
M v[204:207], a[124:127], a[164:167], v[204:207]
 v_cvt_pk_bf16_f32 v114, v116, v117
 v_cvt_pk_bf16_f32 v115, v118, v119
M v[204:207], a[120:123], a[160:163], v[204:207]
 v_cvt_pk_bf16_f32 v120, v120, v121
 v_cvt_pk_bf16_f32 v121, v122, v123
M v[208:211], a[128:131], a[160:163], v[208:211]
 v_cvt_pk_bf16_f32 v122, v124, v125
 v_cvt_pk_bf16_f32 v123, v126, v127
M v[208:211], a[132:135], a[164:167], v[208:211]
 v_cvt_pk_bf16_f32 v128, v128, v129
 v_cvt_pk_bf16_f32 v129, v130, v131
M v[212:215], a[140:143], a[164:167], v[212:215]
 v_cvt_pk_bf16_f32 v130, v132, v133
 v_cvt_pk_bf16_f32 v131, v134, v135
M v[212:215], a[136:139], a[160:163], v[212:215]
 v_cvt_pk_bf16_f32 v136, v136, v137
 v_cvt_pk_bf16_f32 v137, v138, v139
M v[216:219], a[144:147], a[160:163], v[216:219]
 v_cvt_pk_bf16_f32 v138, v140, v141
 v_cvt_pk_bf16_f32 v139, v142, v143
M v[216:219], a[148:151], a[164:167], v[216:219]
 s_waitcnt lgkmcnt(2)
 v_cvt_pk_bf16_f32 v144, v144, v145
 v_cvt_pk_bf16_f32 v145, v146, v147
M v[220:223], a[156:159], a[164:167], v[220:223]
 s_waitcnt vmcnt(24) lgkmcnt(0)
 v_cvt_pk_bf16_f32 v146, v148, v149
 v_cvt_pk_bf16_f32 v147, v150, v151
M v[220:223], a[152:155], a[160:163], v[220:223]
 s_barrier
M v[224:227], a[96:99], a[168:171], v[224:227]
 ds_read_b128 a[160:163], v5 offset:0
 ds_read_b128 a[164:167], v6 offset:0
M v[224:227], a[100:103], a[172:175], v[224:227]
 v_cvt_pk_bf16_f32 v152, v152, v153
 v_cvt_pk_bf16_f32 v153, v154, v155
M v[228:231], a[108:111], a[172:175], v[228:231]
 v_cvt_pk_bf16_f32 v154, v156, v157
 v_cvt_pk_bf16_f32 v155, v158, v159
M v[228:231], a[104:107], a[168:171], v[228:231]
 v_cvt_pk_bf16_f32 v160, v160, v161
 v_cvt_pk_bf16_f32 v161, v162, v163
M v[232:235], a[112:115], a[168:171], v[232:235]
 v_cvt_pk_bf16_f32 v162, v164, v165
 v_cvt_pk_bf16_f32 v163, v166, v167
M v[232:235], a[116:119], a[172:175], v[232:235]
 v_cvt_pk_bf16_f32 v168, v168, v169
 v_cvt_pk_bf16_f32 v169, v170, v171
M v[236:239], a[124:127], a[172:175], v[236:239]
 v_cvt_pk_bf16_f32 v170, v172, v173
 v_cvt_pk_bf16_f32 v171, v174, v175
M v[236:239], a[120:123], a[168:171], v[236:239]
 v_cvt_pk_bf16_f32 v176, v176, v177
 v_cvt_pk_bf16_f32 v177, v178, v179
M v[240:243], a[128:131], a[168:171], v[240:243]
 v_cvt_pk_bf16_f32 v178, v180, v181
 v_cvt_pk_bf16_f32 v179, v182, v183
M v[240:243], a[132:135], a[172:175], v[240:243]
 v_cvt_pk_bf16_f32 v184, v184, v185
 v_cvt_pk_bf16_f32 v185, v186, v187
M v[244:247], a[140:143], a[172:175], v[244:247]
 v_cvt_pk_bf16_f32 v186, v188, v189
 v_cvt_pk_bf16_f32 v187, v190, v191
M v[244:247], a[136:139], a[168:171], v[244:247]
 v_cvt_pk_bf16_f32 v192, v192, v193
 v_cvt_pk_bf16_f32 v193, v194, v195
M v[248:251], a[144:147], a[168:171], v[248:251]
 v_cvt_pk_bf16_f32 v194, v196, v197
 v_cvt_pk_bf16_f32 v195, v198, v199
M v[248:251], a[148:151], a[172:175], v[248:251]
 s_waitcnt lgkmcnt(0)
 v_cvt_pk_bf16_f32 v200, v200, v201
 v_cvt_pk_bf16_f32 v201, v202, v203
M v[252:255], a[156:159], a[172:175], v[252:255]
 v_cvt_pk_bf16_f32 v202, v204, v205
 v_cvt_pk_bf16_f32 v203, v206, v207
M v[252:255], a[152:155], a[168:171], v[252:255]
 v_cvt_pk_bf16_f32 v208, v208, v209
 v_cvt_pk_bf16_f32 v209, v210, v211
M v[32:35], a[32:35], a[160:163], 0
 s_add_u32 m0, s23, 16384
 ds_read_b128 a[168:171], v5 offset:2048
 ds_read_b128 a[172:175], v6 offset:2048
M v[32:35], a[36:39], a[164:167], v[32:35]
 ds_read_b64_tr_b16 a[96:97], v1 offset:32768
 ds_read_b64_tr_b16 a[98:99], v1 offset:33792
M v[36:39], a[44:47], a[164:167], 0
 buffer_load_dwordx4 v8, s[52:55], s28 offen offset:0   lds
M v[36:39], a[40:43], a[160:163], v[36:39]
 v_cvt_pk_bf16_f32 v210, v212, v213
 v_cvt_pk_bf16_f32 v211, v214, v215
M v[40:43], a[48:51], a[160:163], 0
 ds_read_b64_tr_b16 a[100:101], v1 offset:40960
 ds_read_b64_tr_b16 a[102:103], v1 offset:41984
M v[40:43], a[52:55], a[164:167], v[40:43]
 buffer_load_dwordx4 v9, s[52:55], s28 offen offset:1024   lds
M v[44:47], a[60:63], a[164:167], 0
 v_cvt_pk_bf16_f32 v216, v216, v217
 v_cvt_pk_bf16_f32 v217, v218, v219
M v[44:47], a[56:59], a[160:163], v[44:47]
 ds_read_b64_tr_b16 a[104:105], v2 offset:32768
 ds_read_b64_tr_b16 a[106:107], v2 offset:33792
M v[48:51], a[64:67], a[160:163], 0
 v_cvt_pk_bf16_f32 v218, v220, v221
 v_cvt_pk_bf16_f32 v219, v222, v223
M v[48:51], a[68:71], a[164:167], v[48:51]
 v_cvt_pk_bf16_f32 v224, v224, v225
 v_cvt_pk_bf16_f32 v225, v226, v227
M v[52:55], a[76:79], a[164:167], 0
 ds_read_b64_tr_b16 a[108:109], v2 offset:40960
 ds_read_b64_tr_b16 a[110:111], v2 offset:41984
M v[52:55], a[72:75], a[160:163], v[52:55]
 buffer_load_dwordx4 v10, s[52:55], s28 offen offset:2048   lds
M v[56:59], a[80:83], a[160:163], 0
 v_cvt_pk_bf16_f32 v226, v228, v229
 v_cvt_pk_bf16_f32 v227, v230, v231
M v[56:59], a[84:87], a[164:167], v[56:59]
 s_waitcnt lgkmcnt(8)
 ds_read_b64_tr_b16 a[112:113], v3 offset:32768
 ds_read_b64_tr_b16 a[114:115], v3 offset:33792
M v[60:63], a[92:95], a[164:167], 0
 v_cvt_pk_bf16_f32 v232, v232, v233
 v_cvt_pk_bf16_f32 v233, v234, v235
M v[60:63], a[88:91], a[160:163], v[60:63]
 buffer_load_dwordx4 v11, s[52:55], s28 offen offset:3072   lds
M v[68:71], a[32:35], a[168:171], 0
 s_add_u32 s28, s28, 524160
 ds_read_b128 a[160:163], v5 offset:4096
 ds_read_b128 a[164:167], v6 offset:4096
M v[68:71], a[36:39], a[172:175], v[68:71]
 ds_read_b64_tr_b16 a[116:117], v3 offset:40960
 ds_read_b64_tr_b16 a[118:119], v3 offset:41984
M v[76:79], a[44:47], a[172:175], 0
 v_cvt_pk_bf16_f32 v234, v236, v237
 v_cvt_pk_bf16_f32 v235, v238, v239
M v[76:79], a[40:43], a[168:171], v[76:79]
 s_add_u32 m0, s24, 49152
 ds_read_b64_tr_b16 a[120:121], v4 offset:32768
 ds_read_b64_tr_b16 a[122:123], v4 offset:33792
M v[84:87], a[48:51], a[168:171], 0
 buffer_load_dwordx4 v16, s[56:59], s29 offen offset:0   lds
M v[84:87], a[52:55], a[172:175], v[84:87]
 v_cvt_pk_bf16_f32 v240, v240, v241
 v_cvt_pk_bf16_f32 v241, v242, v243
M v[92:95], a[60:63], a[172:175], 0
 ds_read_b64_tr_b16 a[124:125], v4 offset:40960
 ds_read_b64_tr_b16 a[126:127], v4 offset:41984
M v[92:95], a[56:59], a[168:171], v[92:95]
 v_cvt_pk_bf16_f32 v242, v244, v245
 v_cvt_pk_bf16_f32 v243, v246, v247
M v[100:103], a[64:67], a[168:171], 0
 v_cvt_pk_bf16_f32 v248, v248, v249
 v_cvt_pk_bf16_f32 v249, v250, v251
M v[100:103], a[68:71], a[172:175], v[100:103]
 buffer_load_dwordx4 v17, s[56:59], s29 offen offset:1024   lds
M v[108:111], a[76:79], a[172:175], 0
 v_cvt_pk_bf16_f32 v250, v252, v253
 v_cvt_pk_bf16_f32 v251, v254, v255
M v[108:111], a[72:75], a[168:171], v[108:111]
 s_add_u32 s3, s93, 8192
 v_mov_b32 v12, 1
 v_or_b32 v15, s20, v0
M v[116:119], a[80:83], a[168:171], 0
 v_min_u32 v15, 1, v15
 v_lshlrev_b32 v15, 29, v15
M v[116:119], a[84:87], a[172:175], v[116:119]
 s_waitcnt lgkmcnt(6)
 buffer_store_dwordx4 a[4:7], v7, s[8:11], s3 offen offset:0 sc1
M v[124:127], a[92:95], a[172:175], 0
 s_waitcnt vmcnt(17) lgkmcnt(0)
 buffer_load_dwordx4 v18, s[56:59], s29 offen offset:2048   lds
M v[124:127], a[88:91], a[168:171], v[124:127]
 s_barrier
M v[132:135], a[32:35], a[160:163], 0
 ds_read_b128 a[168:171], v5 offset:6144
 ds_read_b128 a[172:175], v6 offset:6144
M v[132:135], a[36:39], a[164:167], v[132:135]
 ds_read_b64_tr_b16 a[128:129], v1 offset:49152
 ds_read_b64_tr_b16 a[130:131], v1 offset:50176
M v[140:143], a[44:47], a[164:167], 0
M v[140:143], a[40:43], a[160:163], v[140:143]
 buffer_load_dwordx4 v19, s[56:59], s29 offen offset:3072   lds
M v[148:151], a[48:51], a[160:163], 0
 s_add_u32 s29, s29, 128
 ds_read_b64_tr_b16 a[132:133], v1 offset:57344
 ds_read_b64_tr_b16 a[134:135], v1 offset:58368
M v[148:151], a[52:55], a[164:167], v[148:151]
 buffer_store_dwordx4 a[12:15], v7, s[8:11], s3 offen offset:1024 sc1
M v[156:159], a[60:63], a[164:167], 0
M v[156:159], a[56:59], a[160:163], v[156:159]
 s_add_u32 m0, s23, 32768
 ds_read_b64_tr_b16 a[136:137], v2 offset:49152
 ds_read_b64_tr_b16 a[138:139], v2 offset:50176
M v[164:167], a[64:67], a[160:163], 0
 buffer_load_dwordx4 v8, s[52:55], s28 offen offset:0   lds
M v[164:167], a[68:71], a[164:167], v[164:167]
M v[172:175], a[76:79], a[164:167], 0
 ds_read_b64_tr_b16 a[140:141], v2 offset:57344
 ds_read_b64_tr_b16 a[142:143], v2 offset:58368
M v[172:175], a[72:75], a[160:163], v[172:175]
M v[180:183], a[80:83], a[160:163], 0
M v[180:183], a[84:87], a[164:167], v[180:183]
 s_waitcnt lgkmcnt(8)
 ds_read_b64_tr_b16 a[144:145], v3 offset:49152
 ds_read_b64_tr_b16 a[146:147], v3 offset:50176
M v[188:191], a[92:95], a[164:167], 0
 buffer_load_dwordx4 v9, s[52:55], s28 offen offset:1024   lds
M v[188:191], a[88:91], a[160:163], v[188:191]
M v[196:199], a[32:35], a[168:171], 0
 ds_read_b128 a[160:163], v5 offset:16384
 ds_read_b128 a[164:167], v6 offset:16384
M v[196:199], a[36:39], a[172:175], v[196:199]
 ds_read_b64_tr_b16 a[148:149], v3 offset:57344
 ds_read_b64_tr_b16 a[150:151], v3 offset:58368
M v[204:207], a[44:47], a[172:175], 0
 buffer_load_dwordx4 v10, s[52:55], s28 offen offset:2048   lds
M v[204:207], a[40:43], a[168:171], v[204:207]
 ds_read_b64_tr_b16 a[152:153], v4 offset:49152
 ds_read_b64_tr_b16 a[154:155], v4 offset:50176
M v[212:215], a[48:51], a[168:171], 0
M v[212:215], a[52:55], a[172:175], v[212:215]
M v[220:223], a[60:63], a[172:175], 0
 ds_read_b64_tr_b16 a[156:157], v4 offset:57344
 ds_read_b64_tr_b16 a[158:159], v4 offset:58368
M v[220:223], a[56:59], a[168:171], v[220:223]
 buffer_load_dwordx4 v11, s[52:55], s28 offen offset:3072   lds
M v[228:231], a[64:67], a[168:171], 0
 s_add_u32 s28, s28, 128
M v[228:231], a[68:71], a[172:175], v[228:231]
M v[236:239], a[76:79], a[172:175], 0
M v[236:239], a[72:75], a[168:171], v[236:239]
M v[244:247], a[80:83], a[168:171], 0
M v[244:247], a[84:87], a[172:175], v[244:247]
 s_waitcnt lgkmcnt(6)
M v[252:255], a[92:95], a[172:175], 0
 s_waitcnt lgkmcnt(0)
M v[252:255], a[88:91], a[168:171], v[252:255]
 s_barrier
M v[32:35], a[96:99], a[160:163], v[32:35]
 s_add_u32 m0, s23, 49152
 ds_read_b128 a[168:171], v5 offset:18432
 ds_read_b128 a[172:175], v6 offset:18432
M v[32:35], a[100:103], a[164:167], v[32:35]
 ds_read_b64_tr_b16 a[32:33], v20 offset:0
 ds_read_b64_tr_b16 a[34:35], v20 offset:1024
M v[36:39], a[108:111], a[164:167], v[36:39]
 s_mov_b32 s39, 1280
 buffer_load_dwordx4 v8, s[52:55], s28 offen offset:0   lds
M v[36:39], a[104:107], a[160:163], v[36:39]
 s_cmp_ge_u32 s42, 10
M v[40:43], a[112:115], a[160:163], v[40:43]
 s_cselect_b32 s64, 0xf000000, 0
 ds_read_b64_tr_b16 a[36:37], v20 offset:8192
 ds_read_b64_tr_b16 a[38:39], v20 offset:9216
M v[40:43], a[116:119], a[164:167], v[40:43]
 s_or_b32 s39, s39, s64
 buffer_load_dwordx4 v9, s[52:55], s28 offen offset:1024   lds
M v[44:47], a[124:127], a[164:167], v[44:47]
 s_lshl_b32 s64, s20, 14
M v[44:47], a[120:123], a[160:163], v[44:47]
 s_add_u32 s12, s64, s34
 ds_read_b64_tr_b16 a[40:41], v21 offset:0
 ds_read_b64_tr_b16 a[42:43], v21 offset:1024
M v[48:51], a[128:131], a[160:163], v[48:51]
 s_add_u32 s13, s12, 4096
 buffer_store_dwordx4 a[20:23], v7, s[8:11], s3 offen offset:2048 sc1
M v[48:51], a[132:135], a[164:167], v[48:51]
 s_add_u32 s14, s12, 8192
M v[52:55], a[140:143], a[164:167], v[52:55]
 s_add_u32 s15, s12, 12288
 ds_read_b64_tr_b16 a[44:45], v21 offset:8192
 ds_read_b64_tr_b16 a[46:47], v21 offset:9216
M v[52:55], a[136:139], a[160:163], v[52:55]
 buffer_load_dwordx4 v10, s[52:55], s28 offen offset:2048   lds
M v[56:59], a[144:147], a[160:163], v[56:59]
M v[56:59], a[148:151], a[164:167], v[56:59]
 s_waitcnt lgkmcnt(8)
 ds_read_b64_tr_b16 a[48:49], v22 offset:0
 ds_read_b64_tr_b16 a[50:51], v22 offset:1024
M v[60:63], a[156:159], a[164:167], v[60:63]
M v[60:63], a[152:155], a[160:163], v[60:63]
 buffer_load_dwordx4 v11, s[52:55], s28 offen offset:3072   lds
M v[68:71], a[96:99], a[168:171], v[68:71]
 s_add_u32 s28, s28, 524160
 ds_read_b128 a[160:163], v5 offset:20480
 ds_read_b128 a[164:167], v6 offset:20480
M v[68:71], a[100:103], a[172:175], v[68:71]
 ds_read_b64_tr_b16 a[52:53], v22 offset:8192
 ds_read_b64_tr_b16 a[54:55], v22 offset:9216
M v[76:79], a[108:111], a[172:175], v[76:79]
M v[76:79], a[104:107], a[168:171], v[76:79]
 s_add_u32 m0, s24, 0
 ds_read_b64_tr_b16 a[56:57], v23 offset:0
 ds_read_b64_tr_b16 a[58:59], v23 offset:1024
M v[84:87], a[112:115], a[168:171], v[84:87]
 buffer_load_dwordx4 v16, s[56:59], s29 offen offset:0   lds
M v[84:87], a[116:119], a[172:175], v[84:87]
M v[92:95], a[124:127], a[172:175], v[92:95]
 ds_read_b64_tr_b16 a[60:61], v23 offset:8192
 ds_read_b64_tr_b16 a[62:63], v23 offset:9216
M v[92:95], a[120:123], a[168:171], v[92:95]
M v[100:103], a[128:131], a[168:171], v[100:103]
M v[100:103], a[132:135], a[172:175], v[100:103]
 buffer_load_dwordx4 v17, s[56:59], s29 offen offset:1024   lds
M v[108:111], a[140:143], a[172:175], v[108:111]
M v[108:111], a[136:139], a[168:171], v[108:111]
M v[116:119], a[144:147], a[168:171], v[116:119]
M v[116:119], a[148:151], a[172:175], v[116:119]
 s_waitcnt lgkmcnt(6)
M v[124:127], a[156:159], a[172:175], v[124:127]
 s_waitcnt vmcnt(25) lgkmcnt(0)
 buffer_load_dwordx4 v18, s[56:59], s29 offen offset:2048   lds
M v[124:127], a[152:155], a[168:171], v[124:127]
 s_barrier
M v[132:135], a[96:99], a[160:163], v[132:135]
 ds_read_b128 a[168:171], v5 offset:22528
 ds_read_b128 a[172:175], v6 offset:22528
M v[132:135], a[100:103], a[164:167], v[132:135]
 ds_read_b64_tr_b16 a[64:65], v20 offset:16384
 ds_read_b64_tr_b16 a[66:67], v20 offset:17408
M v[140:143], a[108:111], a[164:167], v[140:143]
M v[140:143], a[104:107], a[160:163], v[140:143]
 buffer_load_dwordx4 v19, s[56:59], s29 offen offset:3072   lds
M v[148:151], a[112:115], a[160:163], v[148:151]
 s_add_u32 s29, s29, 128
 ds_read_b64_tr_b16 a[68:69], v20 offset:24576
 ds_read_b64_tr_b16 a[70:71], v20 offset:25600
M v[148:151], a[116:119], a[164:167], v[148:151]
 buffer_store_dwordx4 a[28:31], v7, s[8:11], s3 offen offset:3072 sc1
M v[156:159], a[124:127], a[164:167], v[156:159]
M v[156:159], a[120:123], a[160:163], v[156:159]
 s_add_u32 m0, s23, 131072
 ds_read_b64_tr_b16 a[72:73], v21 offset:16384
 ds_read_b64_tr_b16 a[74:75], v21 offset:17408
M v[164:167], a[128:131], a[160:163], v[164:167]
 buffer_load_dwordx4 v8, s[52:55], s28 offen offset:0   lds
M v[164:167], a[132:135], a[164:167], v[164:167]
M v[172:175], a[140:143], a[164:167], v[172:175]
 ds_read_b64_tr_b16 a[76:77], v21 offset:24576
 ds_read_b64_tr_b16 a[78:79], v21 offset:25600
M v[172:175], a[136:139], a[160:163], v[172:175]
M v[180:183], a[144:147], a[160:163], v[180:183]
M v[180:183], a[148:151], a[164:167], v[180:183]
 s_waitcnt lgkmcnt(8)
 ds_read_b64_tr_b16 a[80:81], v22 offset:16384
 ds_read_b64_tr_b16 a[82:83], v22 offset:17408
M v[188:191], a[156:159], a[164:167], v[188:191]
 buffer_load_dwordx4 v9, s[52:55], s28 offen offset:1024   lds
M v[188:191], a[152:155], a[160:163], v[188:191]
M v[196:199], a[96:99], a[168:171], v[196:199]
 ds_read_b128 a[160:163], v5 offset:32768
 ds_read_b128 a[164:167], v6 offset:32768
M v[196:199], a[100:103], a[172:175], v[196:199]
 ds_read_b64_tr_b16 a[84:85], v22 offset:24576
 ds_read_b64_tr_b16 a[86:87], v22 offset:25600
M v[204:207], a[108:111], a[172:175], v[204:207]
 buffer_load_dwordx4 v10, s[52:55], s28 offen offset:2048   lds
M v[204:207], a[104:107], a[168:171], v[204:207]
 ds_read_b64_tr_b16 a[88:89], v23 offset:16384
 ds_read_b64_tr_b16 a[90:91], v23 offset:17408
M v[212:215], a[112:115], a[168:171], v[212:215]
M v[212:215], a[116:119], a[172:175], v[212:215]
M v[220:223], a[124:127], a[172:175], v[220:223]
 ds_read_b64_tr_b16 a[92:93], v23 offset:24576
 ds_read_b64_tr_b16 a[94:95], v23 offset:25600
M v[220:223], a[120:123], a[168:171], v[220:223]
 buffer_load_dwordx4 v11, s[52:55], s28 offen offset:3072   lds
M v[228:231], a[128:131], a[168:171], v[228:231]
 s_add_u32 s28, s28, 128
M v[228:231], a[132:135], a[172:175], v[228:231]
M v[236:239], a[140:143], a[172:175], v[236:239]
M v[236:239], a[136:139], a[168:171], v[236:239]
M v[244:247], a[144:147], a[168:171], v[244:247]
M v[244:247], a[148:151], a[172:175], v[244:247]
 s_waitcnt lgkmcnt(6)
M v[252:255], a[156:159], a[172:175], v[252:255]
 s_waitcnt vmcnt(28) lgkmcnt(0)
M v[252:255], a[152:155], a[168:171], v[252:255]
 s_barrier
M v[32:35], a[32:35], a[160:163], v[32:35]
 s_add_u32 m0, s23, 147456
 ds_read_b128 a[168:171], v5 offset:34816
 ds_read_b128 a[172:175], v6 offset:34816
M v[32:35], a[36:39], a[164:167], v[32:35]
 ds_read_b64_tr_b16 a[96:97], v1 offset:0
 ds_read_b64_tr_b16 a[98:99], v1 offset:1024
M v[36:39], a[44:47], a[164:167], v[36:39]
 buffer_load_dwordx4 v8, s[52:55], s28 offen offset:0   lds
M v[36:39], a[40:43], a[160:163], v[36:39]
M v[40:43], a[48:51], a[160:163], v[40:43]
 ds_read_b64_tr_b16 a[100:101], v1 offset:8192
 ds_read_b64_tr_b16 a[102:103], v1 offset:9216
M v[40:43], a[52:55], a[164:167], v[40:43]
 buffer_load_dwordx4 v9, s[52:55], s28 offen offset:1024   lds
M v[44:47], a[60:63], a[164:167], v[44:47]
M v[44:47], a[56:59], a[160:163], v[44:47]
 ds_read_b64_tr_b16 a[104:105], v2 offset:0
 ds_read_b64_tr_b16 a[106:107], v2 offset:1024
M v[48:51], a[64:67], a[160:163], v[48:51]
M v[48:51], a[68:71], a[164:167], v[48:51]
M v[52:55], a[76:79], a[164:167], v[52:55]
 ds_read_b64_tr_b16 a[108:109], v2 offset:8192
 ds_read_b64_tr_b16 a[110:111], v2 offset:9216
M v[52:55], a[72:75], a[160:163], v[52:55]
 buffer_load_dwordx4 v10, s[52:55], s28 offen offset:2048   lds
M v[56:59], a[80:83], a[160:163], v[56:59]
M v[56:59], a[84:87], a[164:167], v[56:59]
 s_waitcnt lgkmcnt(8)
 ds_read_b64_tr_b16 a[112:113], v3 offset:0
 ds_read_b64_tr_b16 a[114:115], v3 offset:1024
M v[60:63], a[92:95], a[164:167], v[60:63]
M v[60:63], a[88:91], a[160:163], v[60:63]
 buffer_load_dwordx4 v11, s[52:55], s28 offen offset:3072   lds
M v[68:71], a[32:35], a[168:171], v[68:71]
 s_add_u32 s28, s28, 524160
 ds_read_b128 a[160:163], v5 offset:36864
 ds_read_b128 a[164:167], v6 offset:36864
M v[68:71], a[36:39], a[172:175], v[68:71]
 ds_read_b64_tr_b16 a[116:117], v3 offset:8192
 ds_read_b64_tr_b16 a[118:119], v3 offset:9216
M v[76:79], a[44:47], a[172:175], v[76:79]
M v[76:79], a[40:43], a[168:171], v[76:79]
 s_add_u32 m0, s24, 16384
 ds_read_b64_tr_b16 a[120:121], v4 offset:0
 ds_read_b64_tr_b16 a[122:123], v4 offset:1024
M v[84:87], a[48:51], a[168:171], v[84:87]
 buffer_load_dwordx4 v16, s[56:59], s29 offen offset:0   lds
M v[84:87], a[52:55], a[172:175], v[84:87]
M v[92:95], a[60:63], a[172:175], v[92:95]
 ds_read_b64_tr_b16 a[124:125], v4 offset:8192
 ds_read_b64_tr_b16 a[126:127], v4 offset:9216
M v[92:95], a[56:59], a[168:171], v[92:95]
M v[100:103], a[64:67], a[168:171], v[100:103]
M v[100:103], a[68:71], a[172:175], v[100:103]
 buffer_load_dwordx4 v17, s[56:59], s29 offen offset:1024   lds
M v[108:111], a[76:79], a[172:175], v[108:111]
M v[108:111], a[72:75], a[168:171], v[108:111]
M v[116:119], a[80:83], a[168:171], v[116:119]
M v[116:119], a[84:87], a[172:175], v[116:119]
 s_waitcnt lgkmcnt(6)
M v[124:127], a[92:95], a[172:175], v[124:127]
 s_waitcnt vmcnt(25) lgkmcnt(0)
 buffer_load_dwordx4 v18, s[56:59], s29 offen offset:2048   lds
M v[124:127], a[88:91], a[168:171], v[124:127]
 s_barrier
M v[132:135], a[32:35], a[160:163], v[132:135]
 ds_read_b128 a[168:171], v5 offset:38912
 ds_read_b128 a[172:175], v6 offset:38912
M v[132:135], a[36:39], a[164:167], v[132:135]
 ds_read_b64_tr_b16 a[128:129], v1 offset:16384
 ds_read_b64_tr_b16 a[130:131], v1 offset:17408
M v[140:143], a[44:47], a[164:167], v[140:143]
M v[140:143], a[40:43], a[160:163], v[140:143]
 buffer_load_dwordx4 v19, s[56:59], s29 offen offset:3072   lds
M v[148:151], a[48:51], a[160:163], v[148:151]
 s_add_u32 s29, s29, 128
 ds_read_b64_tr_b16 a[132:133], v1 offset:24576
 ds_read_b64_tr_b16 a[134:135], v1 offset:25600
M v[148:151], a[52:55], a[164:167], v[148:151]
M v[156:159], a[60:63], a[164:167], v[156:159]
M v[156:159], a[56:59], a[160:163], v[156:159]
 s_add_u32 m0, s23, 0
 ds_read_b64_tr_b16 a[136:137], v2 offset:16384
 ds_read_b64_tr_b16 a[138:139], v2 offset:17408
M v[164:167], a[64:67], a[160:163], v[164:167]
 buffer_load_dwordx4 v8, s[52:55], s28 offen offset:0   lds
M v[164:167], a[68:71], a[164:167], v[164:167]
M v[172:175], a[76:79], a[164:167], v[172:175]
 ds_read_b64_tr_b16 a[140:141], v2 offset:24576
 ds_read_b64_tr_b16 a[142:143], v2 offset:25600
M v[172:175], a[72:75], a[160:163], v[172:175]
M v[180:183], a[80:83], a[160:163], v[180:183]
M v[180:183], a[84:87], a[164:167], v[180:183]
 s_waitcnt lgkmcnt(8)
 ds_read_b64_tr_b16 a[144:145], v3 offset:16384
 ds_read_b64_tr_b16 a[146:147], v3 offset:17408
M v[188:191], a[92:95], a[164:167], v[188:191]
 buffer_load_dwordx4 v9, s[52:55], s28 offen offset:1024   lds
M v[188:191], a[88:91], a[160:163], v[188:191]
M v[196:199], a[32:35], a[168:171], v[196:199]
 ds_read_b128 a[160:163], v5 offset:49152
 ds_read_b128 a[164:167], v6 offset:49152
M v[196:199], a[36:39], a[172:175], v[196:199]
 ds_read_b64_tr_b16 a[148:149], v3 offset:24576
 ds_read_b64_tr_b16 a[150:151], v3 offset:25600
M v[204:207], a[44:47], a[172:175], v[204:207]
 buffer_load_dwordx4 v10, s[52:55], s28 offen offset:2048   lds
M v[204:207], a[40:43], a[168:171], v[204:207]
 ds_read_b64_tr_b16 a[152:153], v4 offset:16384
 ds_read_b64_tr_b16 a[154:155], v4 offset:17408
M v[212:215], a[48:51], a[168:171], v[212:215]
M v[212:215], a[52:55], a[172:175], v[212:215]
M v[220:223], a[60:63], a[172:175], v[220:223]
 ds_read_b64_tr_b16 a[156:157], v4 offset:24576
 ds_read_b64_tr_b16 a[158:159], v4 offset:25600
M v[220:223], a[56:59], a[168:171], v[220:223]
 buffer_load_dwordx4 v11, s[52:55], s28 offen offset:3072   lds
M v[228:231], a[64:67], a[168:171], v[228:231]
 s_add_u32 s28, s28, 128
M v[228:231], a[68:71], a[172:175], v[228:231]
M v[236:239], a[76:79], a[172:175], v[236:239]
M v[236:239], a[72:75], a[168:171], v[236:239]
M v[244:247], a[80:83], a[168:171], v[244:247]
M v[244:247], a[84:87], a[172:175], v[244:247]
 s_waitcnt lgkmcnt(6)
M v[252:255], a[92:95], a[172:175], v[252:255]
 s_waitcnt vmcnt(16) lgkmcnt(0)
M v[252:255], a[88:91], a[168:171], v[252:255]
 s_barrier
M v[32:35], a[96:99], a[160:163], v[32:35]
 s_add_u32 m0, s23, 16384
 ds_read_b128 a[168:171], v5 offset:51200
 ds_read_b128 a[172:175], v6 offset:51200
M v[32:35], a[100:103], a[164:167], v[32:35]
 ds_read_b64_tr_b16 a[32:33], v1 offset:32768
 ds_read_b64_tr_b16 a[34:35], v1 offset:33792
M v[36:39], a[108:111], a[164:167], v[36:39]
 buffer_load_dwordx4 v8, s[52:55], s28 offen offset:0   lds
M v[36:39], a[104:107], a[160:163], v[36:39]
 buffer_store_dword v12, v15, s[8:11], s45 offen sc1
M v[40:43], a[112:115], a[160:163], v[40:43]
 s_add_u32 s3, s93, 262144
 ds_read_b64_tr_b16 a[36:37], v1 offset:40960
 ds_read_b64_tr_b16 a[38:39], v1 offset:41984
M v[40:43], a[116:119], a[164:167], v[40:43]
 v_min_u32 v25, 15, v0
 v_lshlrev_b32 v25, 7, v25
M v[44:47], a[124:127], a[164:167], v[44:47]
 v_max_u32 v13, 1024, v25
M v[44:47], a[120:123], a[160:163], v[44:47]
 ds_read_b64_tr_b16 a[40:41], v2 offset:32768
 ds_read_b64_tr_b16 a[42:43], v2 offset:33792
M v[48:51], a[128:131], a[160:163], v[48:51]
 buffer_load_dwordx4 v9, s[52:55], s28 offen offset:1024   lds
M v[48:51], a[132:135], a[164:167], v[48:51]
 buffer_store_dwordx4 v[64:67], v7, s[8:11], s3 offen offset:0 sc1
M v[52:55], a[140:143], a[164:167], v[52:55]
 ds_read_b64_tr_b16 a[44:45], v2 offset:40960
 ds_read_b64_tr_b16 a[46:47], v2 offset:41984
M v[52:55], a[136:139], a[160:163], v[52:55]
M v[56:59], a[144:147], a[160:163], v[56:59]
M v[56:59], a[148:151], a[164:167], v[56:59]
 s_waitcnt lgkmcnt(8)
 ds_read_b64_tr_b16 a[48:49], v3 offset:32768
 ds_read_b64_tr_b16 a[50:51], v3 offset:33792
M v[60:63], a[156:159], a[164:167], v[60:63]
 buffer_load_dwordx4 v10, s[52:55], s28 offen offset:2048   lds
M v[60:63], a[152:155], a[160:163], v[60:63]
M v[68:71], a[96:99], a[168:171], v[68:71]
 ds_read_b128 a[160:163], v5 offset:53248
 ds_read_b128 a[164:167], v6 offset:53248
M v[68:71], a[100:103], a[172:175], v[68:71]
 ds_read_b64_tr_b16 a[52:53], v3 offset:40960
 ds_read_b64_tr_b16 a[54:55], v3 offset:41984
M v[76:79], a[108:111], a[172:175], v[76:79]
 buffer_store_dwordx4 v[72:75], v7, s[8:11], s3 offen offset:1024 sc1
M v[76:79], a[104:107], a[168:171], v[76:79]
 ds_read_b64_tr_b16 a[56:57], v4 offset:32768
 ds_read_b64_tr_b16 a[58:59], v4 offset:33792
M v[84:87], a[112:115], a[168:171], v[84:87]
M v[84:87], a[116:119], a[172:175], v[84:87]
 buffer_load_dwordx4 v11, s[52:55], s28 offen offset:3072   lds
M v[92:95], a[124:127], a[172:175], v[92:95]
 s_add_u32 s28, s28, 524160
 ds_read_b64_tr_b16 a[60:61], v4 offset:40960
 ds_read_b64_tr_b16 a[62:63], v4 offset:41984
M v[92:95], a[120:123], a[168:171], v[92:95]
M v[100:103], a[128:131], a[168:171], v[100:103]
M v[100:103], a[132:135], a[172:175], v[100:103]
M v[108:111], a[140:143], a[172:175], v[108:111]
M v[108:111], a[136:139], a[168:171], v[108:111]
M v[116:119], a[144:147], a[168:171], v[116:119]
M v[116:119], a[148:151], a[172:175], v[116:119]
 s_waitcnt lgkmcnt(6)
M v[124:127], a[156:159], a[172:175], v[124:127]
 s_waitcnt lgkmcnt(0)
M v[124:127], a[152:155], a[168:171], v[124:127]
 s_barrier
M v[132:135], a[96:99], a[160:163], v[132:135]
 ds_read_b128 a[168:171], v5 offset:55296
 ds_read_b128 a[172:175], v6 offset:55296
M v[132:135], a[100:103], a[164:167], v[132:135]
 ds_read_b64_tr_b16 a[64:65], v1 offset:49152
 ds_read_b64_tr_b16 a[66:67], v1 offset:50176
M v[140:143], a[108:111], a[164:167], v[140:143]
 buffer_store_dwordx4 v[80:83], v7, s[8:11], s3 offen offset:2048 sc1
M v[140:143], a[104:107], a[160:163], v[140:143]
M v[148:151], a[112:115], a[160:163], v[148:151]
 ds_read_b64_tr_b16 a[68:69], v1 offset:57344
 ds_read_b64_tr_b16 a[70:71], v1 offset:58368
M v[148:151], a[116:119], a[164:167], v[148:151]
M v[156:159], a[124:127], a[164:167], v[156:159]
M v[156:159], a[120:123], a[160:163], v[156:159]
 ds_read_b64_tr_b16 a[72:73], v2 offset:49152
 ds_read_b64_tr_b16 a[74:75], v2 offset:50176
M v[164:167], a[128:131], a[160:163], v[164:167]
M v[164:167], a[132:135], a[164:167], v[164:167]
M v[172:175], a[140:143], a[164:167], v[172:175]
 ds_read_b64_tr_b16 a[76:77], v2 offset:57344
 ds_read_b64_tr_b16 a[78:79], v2 offset:58368
M v[172:175], a[136:139], a[160:163], v[172:175]
M v[180:183], a[144:147], a[160:163], v[180:183]
M v[180:183], a[148:151], a[164:167], v[180:183]
 s_waitcnt lgkmcnt(8)
 ds_read_b64_tr_b16 a[80:81], v3 offset:49152
 ds_read_b64_tr_b16 a[82:83], v3 offset:50176
M v[188:191], a[156:159], a[164:167], v[188:191]
 buffer_store_dwordx4 v[88:91], v7, s[8:11], s3 offen offset:3072 sc1
M v[188:191], a[152:155], a[160:163], v[188:191]
M v[196:199], a[96:99], a[168:171], v[196:199]
 ds_read_b128 a[160:163], v5 offset:0
 ds_read_b128 a[164:167], v6 offset:0
M v[196:199], a[100:103], a[172:175], v[196:199]
 ds_read_b64_tr_b16 a[84:85], v3 offset:57344
 ds_read_b64_tr_b16 a[86:87], v3 offset:58368
M v[204:207], a[108:111], a[172:175], v[204:207]
M v[204:207], a[104:107], a[168:171], v[204:207]
 ds_read_b64_tr_b16 a[88:89], v4 offset:49152
 ds_read_b64_tr_b16 a[90:91], v4 offset:50176
M v[212:215], a[112:115], a[168:171], v[212:215]
M v[212:215], a[116:119], a[172:175], v[212:215]
M v[220:223], a[124:127], a[172:175], v[220:223]
 ds_read_b64_tr_b16 a[92:93], v4 offset:57344
 ds_read_b64_tr_b16 a[94:95], v4 offset:58368
M v[220:223], a[120:123], a[168:171], v[220:223]
M v[228:231], a[128:131], a[168:171], v[228:231]
M v[228:231], a[132:135], a[172:175], v[228:231]
M v[236:239], a[140:143], a[172:175], v[236:239]
M v[236:239], a[136:139], a[168:171], v[236:239]
M v[244:247], a[144:147], a[168:171], v[244:247]
M v[244:247], a[148:151], a[172:175], v[244:247]
 s_waitcnt lgkmcnt(6)
M v[252:255], a[156:159], a[172:175], v[252:255]
 s_waitcnt vmcnt(21) lgkmcnt(0)
M v[252:255], a[152:155], a[168:171], v[252:255]
 s_barrier
M v[32:35], a[32:35], a[160:163], v[32:35]
 s_add_u32 m0, s23, 32768
 ds_read_b128 a[168:171], v5 offset:2048
 ds_read_b128 a[172:175], v6 offset:2048
M v[32:35], a[36:39], a[164:167], v[32:35]
 ds_read_b64_tr_b16 a[96:97], v20 offset:0
 ds_read_b64_tr_b16 a[98:99], v20 offset:1024
M v[36:39], a[44:47], a[164:167], v[36:39]
 buffer_load_dwordx4 v16, s[56:59], s29 offen offset:0   lds
M v[36:39], a[40:43], a[160:163], v[36:39]
M v[40:43], a[48:51], a[160:163], v[40:43]
 s_add_u32 s3, s93, 270336
 ds_read_b64_tr_b16 a[100:101], v20 offset:8192
 ds_read_b64_tr_b16 a[102:103], v20 offset:9216
M v[40:43], a[52:55], a[164:167], v[40:43]
 buffer_load_dwordx4 v17, s[56:59], s29 offen offset:1024   lds
M v[44:47], a[60:63], a[164:167], v[44:47]
 buffer_store_dwordx4 v[96:99], v7, s[8:11], s3 offen offset:0 sc1
M v[44:47], a[56:59], a[160:163], v[44:47]
 ds_read_b64_tr_b16 a[104:105], v21 offset:0
 ds_read_b64_tr_b16 a[106:107], v21 offset:1024
M v[48:51], a[64:67], a[160:163], v[48:51]
M v[48:51], a[68:71], a[164:167], v[48:51]
 buffer_load_dwordx4 v18, s[56:59], s29 offen offset:2048   lds
M v[52:55], a[76:79], a[164:167], v[52:55]
 ds_read_b64_tr_b16 a[108:109], v21 offset:8192
 ds_read_b64_tr_b16 a[110:111], v21 offset:9216
M v[52:55], a[72:75], a[160:163], v[52:55]
M v[56:59], a[80:83], a[160:163], v[56:59]
M v[56:59], a[84:87], a[164:167], v[56:59]
 s_waitcnt lgkmcnt(8)
 ds_read_b64_tr_b16 a[112:113], v22 offset:0
 ds_read_b64_tr_b16 a[114:115], v22 offset:1024
M v[60:63], a[92:95], a[164:167], v[60:63]
 buffer_load_dwordx4 v19, s[56:59], s29 offen offset:3072   lds
M v[60:63], a[88:91], a[160:163], v[60:63]
 s_add_u32 s29, s29, 128
M v[68:71], a[32:35], a[168:171], v[68:71]
 ds_read_b128 a[160:163], v5 offset:4096
 ds_read_b128 a[164:167], v6 offset:4096
M v[68:71], a[36:39], a[172:175], v[68:71]
 ds_read_b64_tr_b16 a[116:117], v22 offset:8192
 ds_read_b64_tr_b16 a[118:119], v22 offset:9216
M v[76:79], a[44:47], a[172:175], v[76:79]
 s_lshl_b32 s28, s20, 13
 buffer_store_dwordx4 v[104:107], v7, s[8:11], s3 offen offset:1024 sc1
M v[76:79], a[40:43], a[168:171], v[76:79]
 s_lshl_b32 s21, s41, 20
 ds_read_b64_tr_b16 a[120:121], v23 offset:0
 ds_read_b64_tr_b16 a[122:123], v23 offset:1024
M v[84:87], a[48:51], a[168:171], v[84:87]
 s_mov_b32 s22, 0
M v[84:87], a[52:55], a[172:175], v[84:87]
 s_lshl_b32 s7, s41, 18
M v[92:95], a[60:63], a[172:175], v[92:95]
 s_add_u32 s7, s7, 100663296
 ds_read_b64_tr_b16 a[124:125], v23 offset:8192
 ds_read_b64_tr_b16 a[126:127], v23 offset:9216
M v[92:95], a[56:59], a[168:171], v[92:95]
 s_add_u32 s38, s7, 65536
M v[100:103], a[64:67], a[168:171], v[100:103]
 s_add_u32 s64, s42, 1
M v[100:103], a[68:71], a[172:175], v[100:103]
 s_min_u32 s64, s64, 10
M v[108:111], a[76:79], a[172:175], v[108:111]
 s_sub_u32 s27, s64, 3
 buffer_load_dword v24, v13, s[8:11], s46 offen sc1
M v[108:111], a[72:75], a[168:171], v[108:111]
 s_lshl_b32 s6, s64, 1
M v[116:119], a[80:83], a[168:171], v[116:119]
 s_sub_u32 s43, s6, 2
 s_lshl_b32 s64, s42, 16
 s_add_u32 s4, s21, s64
M v[116:119], a[84:87], a[172:175], v[116:119]
 s_waitcnt lgkmcnt(6)
 s_sub_u32 s26, 1114112, s64
 s_add_u32 s26, s26, s21
M v[124:127], a[92:95], a[172:175], v[124:127]
 s_waitcnt vmcnt(20) lgkmcnt(0)
 s_lshl_b32 s64, s42, 1
 s_sub_u32 s64, 32, s64
M v[124:127], a[88:91], a[168:171], v[124:127]
 s_barrier
M v[132:135], a[32:35], a[160:163], v[132:135]
 s_cmp_ge_u32 s42, 10
 ds_read_b128 a[168:171], v5 offset:6144
 ds_read_b128 a[172:175], v6 offset:6144
M v[132:135], a[36:39], a[164:167], v[132:135]
 s_cselect_b32 s25, s64, 32767
 ds_read_b64_tr_b16 a[128:129], v20 offset:16384
 ds_read_b64_tr_b16 a[130:131], v20 offset:17408
M v[140:143], a[44:47], a[164:167], v[140:143]
 s_mov_b32 s23, 0
 buffer_store_dwordx4 v[112:115], v7, s[8:11], s3 offen offset:2048 sc1
M v[140:143], a[40:43], a[160:163], v[140:143]
M v[148:151], a[48:51], a[160:163], v[148:151]
 ds_read_b64_tr_b16 a[132:133], v20 offset:24576
 ds_read_b64_tr_b16 a[134:135], v20 offset:25600
M v[148:151], a[52:55], a[164:167], v[148:151]
M v[156:159], a[60:63], a[164:167], v[156:159]
M v[156:159], a[56:59], a[160:163], v[156:159]
 ds_read_b64_tr_b16 a[136:137], v21 offset:16384
 ds_read_b64_tr_b16 a[138:139], v21 offset:17408
M v[164:167], a[64:67], a[160:163], v[164:167]
M v[164:167], a[68:71], a[164:167], v[164:167]
M v[172:175], a[76:79], a[164:167], v[172:175]
 ds_read_b64_tr_b16 a[140:141], v21 offset:24576
 ds_read_b64_tr_b16 a[142:143], v21 offset:25600
M v[172:175], a[72:75], a[160:163], v[172:175]
M v[180:183], a[80:83], a[160:163], v[180:183]
M v[180:183], a[84:87], a[164:167], v[180:183]
 s_waitcnt lgkmcnt(8)
 ds_read_b64_tr_b16 a[144:145], v22 offset:16384
 ds_read_b64_tr_b16 a[146:147], v22 offset:17408
M v[188:191], a[92:95], a[164:167], v[188:191]
 buffer_store_dwordx4 v[120:123], v7, s[8:11], s3 offen offset:3072 sc1
M v[188:191], a[88:91], a[160:163], v[188:191]
M v[196:199], a[32:35], a[168:171], v[196:199]
 ds_read_b128 a[160:163], v5 offset:16384
 ds_read_b128 a[164:167], v6 offset:16384
M v[196:199], a[36:39], a[172:175], v[196:199]
 ds_read_b64_tr_b16 a[148:149], v22 offset:24576
 ds_read_b64_tr_b16 a[150:151], v22 offset:25600
M v[204:207], a[44:47], a[172:175], v[204:207]
M v[204:207], a[40:43], a[168:171], v[204:207]
 ds_read_b64_tr_b16 a[152:153], v23 offset:16384
 ds_read_b64_tr_b16 a[154:155], v23 offset:17408
M v[212:215], a[48:51], a[168:171], v[212:215]
M v[212:215], a[52:55], a[172:175], v[212:215]
M v[220:223], a[60:63], a[172:175], v[220:223]
 ds_read_b64_tr_b16 a[156:157], v23 offset:24576
 ds_read_b64_tr_b16 a[158:159], v23 offset:25600
M v[220:223], a[56:59], a[168:171], v[220:223]
M v[228:231], a[64:67], a[168:171], v[228:231]
M v[228:231], a[68:71], a[172:175], v[228:231]
M v[236:239], a[76:79], a[172:175], v[236:239]
M v[236:239], a[72:75], a[168:171], v[236:239]
M v[244:247], a[80:83], a[168:171], v[244:247]
M v[244:247], a[84:87], a[172:175], v[244:247]
 s_waitcnt lgkmcnt(6)
M v[252:255], a[92:95], a[172:175], v[252:255]
 s_waitcnt vmcnt(18) lgkmcnt(0)
M v[252:255], a[88:91], a[168:171], v[252:255]
 s_barrier
M v[32:35], a[96:99], a[160:163], v[32:35]
 ds_read_b128 a[168:171], v5 offset:18432
 ds_read_b128 a[172:175], v6 offset:18432
M v[32:35], a[100:103], a[164:167], v[32:35]
 ds_read_b64_tr_b16 a[32:33], v1 offset:0
 ds_read_b64_tr_b16 a[34:35], v1 offset:1024
M v[36:39], a[108:111], a[164:167], v[36:39]
 v_add_u32 v10, s28, v7
 v_add_u32 v11, 0x1000, v10
M v[36:39], a[104:107], a[160:163], v[36:39]
 s_waitcnt vmcnt(2)
 v_cmp_eq_u32 vcc, 0, v24
 s_add_u32 s3, s93, 524288
M v[40:43], a[112:115], a[160:163], v[40:43]
 s_lshl_b32 s64, s20, 10
 ds_read_b64_tr_b16 a[36:37], v1 offset:8192
 ds_read_b64_tr_b16 a[38:39], v1 offset:9216
M v[40:43], a[116:119], a[164:167], v[40:43]
 s_cbranch_vccnz L_f1s14
L_f1r14:
M v[44:47], a[124:127], a[164:167], v[44:47]
 s_add_u32 m0, s28, 98304
 s_nop 0
 buffer_load_dwordx4 v10, s[8:11], s21 offen offset:0 sc1 lds
M v[44:47], a[120:123], a[160:163], v[44:47]
 ds_read_b64_tr_b16 a[40:41], v2 offset:0
 ds_read_b64_tr_b16 a[42:43], v2 offset:1024
M v[48:51], a[128:131], a[160:163], v[48:51]
 buffer_store_dwordx4 v[128:131], v7, s[8:11], s3 offen offset:0 sc1
M v[48:51], a[132:135], a[164:167], v[48:51]
M v[52:55], a[140:143], a[164:167], v[52:55]
 ds_read_b64_tr_b16 a[44:45], v2 offset:8192
 ds_read_b64_tr_b16 a[46:47], v2 offset:9216
M v[52:55], a[136:139], a[160:163], v[52:55]
 buffer_load_dwordx4 v10, s[8:11], s21 offen offset:1024 sc1 lds
M v[56:59], a[144:147], a[160:163], v[56:59]
M v[56:59], a[148:151], a[164:167], v[56:59]
 s_waitcnt lgkmcnt(8)
 ds_read_b64_tr_b16 a[48:49], v3 offset:0
 ds_read_b64_tr_b16 a[50:51], v3 offset:1024
M v[60:63], a[156:159], a[164:167], v[60:63]
M v[60:63], a[152:155], a[160:163], v[60:63]
 buffer_load_dwordx4 v10, s[8:11], s21 offen offset:2048 sc1 lds
M v[68:71], a[96:99], a[168:171], v[68:71]
 ds_read_b128 a[160:163], v5 offset:20480
 ds_read_b128 a[164:167], v6 offset:20480
M v[68:71], a[100:103], a[172:175], v[68:71]
 ds_read_b64_tr_b16 a[52:53], v3 offset:8192
 ds_read_b64_tr_b16 a[54:55], v3 offset:9216
M v[76:79], a[108:111], a[172:175], v[76:79]
 buffer_store_dwordx4 v[136:139], v7, s[8:11], s3 offen offset:1024 sc1
M v[76:79], a[104:107], a[168:171], v[76:79]
 ds_read_b64_tr_b16 a[56:57], v4 offset:0
 ds_read_b64_tr_b16 a[58:59], v4 offset:1024
M v[84:87], a[112:115], a[168:171], v[84:87]
 buffer_load_dwordx4 v10, s[8:11], s21 offen offset:3072 sc1 lds
M v[84:87], a[116:119], a[172:175], v[84:87]
 s_add_u32 m0, s28, 102400
M v[92:95], a[124:127], a[172:175], v[92:95]
 ds_read_b64_tr_b16 a[60:61], v4 offset:8192
 ds_read_b64_tr_b16 a[62:63], v4 offset:9216
M v[92:95], a[120:123], a[168:171], v[92:95]
M v[100:103], a[128:131], a[168:171], v[100:103]
 buffer_load_dwordx4 v11, s[8:11], s21 offen offset:0 sc1 lds
M v[100:103], a[132:135], a[172:175], v[100:103]
M v[108:111], a[140:143], a[172:175], v[108:111]
M v[108:111], a[136:139], a[168:171], v[108:111]
M v[116:119], a[144:147], a[168:171], v[116:119]
 buffer_load_dwordx4 v11, s[8:11], s21 offen offset:1024 sc1 lds
M v[116:119], a[148:151], a[172:175], v[116:119]
 s_waitcnt lgkmcnt(6)
M v[124:127], a[156:159], a[172:175], v[124:127]
 s_waitcnt lgkmcnt(0)
 buffer_load_dwordx4 v11, s[8:11], s21 offen offset:2048 sc1 lds
M v[124:127], a[152:155], a[168:171], v[124:127]
 s_barrier
M v[132:135], a[96:99], a[160:163], v[132:135]
 ds_read_b128 a[168:171], v5 offset:22528
 ds_read_b128 a[172:175], v6 offset:22528
M v[132:135], a[100:103], a[164:167], v[132:135]
 ds_read_b64_tr_b16 a[64:65], v1 offset:16384
 ds_read_b64_tr_b16 a[66:67], v1 offset:17408
M v[140:143], a[108:111], a[164:167], v[140:143]
 buffer_load_dwordx4 v11, s[8:11], s21 offen offset:3072 sc1 lds
M v[140:143], a[104:107], a[160:163], v[140:143]
 s_add_u32 s24, s23, 16777216
 buffer_store_dwordx4 v[144:147], v7, s[8:11], s3 offen offset:2048 sc1
M v[148:151], a[112:115], a[160:163], v[148:151]
 s_mov_b32 s23, s21
 ds_read_b64_tr_b16 a[68:69], v1 offset:24576
 ds_read_b64_tr_b16 a[70:71], v1 offset:25600
M v[148:151], a[116:119], a[164:167], v[148:151]
 s_add_u32 s21, s21, 32768
M v[156:159], a[124:127], a[164:167], v[156:159]
 s_add_u32 s22, s22, 1
M v[156:159], a[120:123], a[160:163], v[156:159]
 s_cmp_eq_u32 s22, s25
 ds_read_b64_tr_b16 a[72:73], v2 offset:16384
 ds_read_b64_tr_b16 a[74:75], v2 offset:17408
M v[164:167], a[128:131], a[160:163], v[164:167]
 s_cselect_b32 s21, s26, s21
 v_subrev_u32 v5, 0x10000, v5
 v_subrev_u32 v6, 0x10000, v6
M v[164:167], a[132:135], a[164:167], v[164:167]
 s_cmp_eq_u32 s22, s43
M v[172:175], a[140:143], a[164:167], v[172:175]
 s_cselect_b32 s21, s4, s21
 ds_read_b64_tr_b16 a[76:77], v2 offset:24576
 ds_read_b64_tr_b16 a[78:79], v2 offset:25600
M v[172:175], a[136:139], a[160:163], v[172:175]
 s_cmp_eq_u32 s22, s6
M v[180:183], a[144:147], a[160:163], v[180:183]
 s_cselect_b32 s21, s7, s21
 v_mov_b32 v9, v25
 v_lshrrev_b32 v24, 4, v0
M v[180:183], a[148:151], a[164:167], v[180:183]
 s_waitcnt lgkmcnt(8)
 ds_read_b64_tr_b16 a[80:81], v3 offset:16384
 ds_read_b64_tr_b16 a[82:83], v3 offset:17408
M v[188:191], a[156:159], a[164:167], v[188:191]
 v_lshlrev_b32 v24, 2, v24
 v_and_b32 v25, 15, v0
M v[188:191], a[152:155], a[160:163], v[188:191]
 v_sub_u32 v24, v24, v25
M v[196:199], a[96:99], a[168:171], v[196:199]
 s_add_u32 s64, s64, s34
 ds_read_b128 a[160:163], v5 offset:32768
 ds_read_b128 a[164:167], v6 offset:32768
M v[196:199], a[100:103], a[172:175], v[196:199]
 s_add_u32 s52, s64, 65536
 ds_read_b64_tr_b16 a[84:85], v3 offset:24576
 ds_read_b64_tr_b16 a[86:87], v3 offset:25600
M v[204:207], a[108:111], a[172:175], v[204:207]
 s_mov_b32 s55, 0x21800000
 buffer_store_dwordx4 v[152:155], v7, s[8:11], s3 offen offset:3072 sc1
M v[204:207], a[104:107], a[168:171], v[204:207]
 s_and_b32 s65, s39, 0xf000000
 ds_read_b64_tr_b16 a[88:89], v4 offset:16384
 ds_read_b64_tr_b16 a[90:91], v4 offset:17408
M v[212:215], a[112:115], a[168:171], v[212:215]
 s_cmp_eq_u32 s20, 0
M v[212:215], a[116:119], a[172:175], v[212:215]
 s_cselect_b32 s54, s39, s65
M v[220:223], a[124:127], a[172:175], v[220:223]
 s_lshr_b32 s64, s20, 1
 ds_read_b64_tr_b16 a[92:93], v4 offset:24576
 ds_read_b64_tr_b16 a[94:95], v4 offset:25600
M v[220:223], a[120:123], a[168:171], v[220:223]
 s_lshl_b32 s64, s64, 17
M v[228:231], a[128:131], a[168:171], v[228:231]
 s_and_b32 s65, s20, 1
M v[228:231], a[132:135], a[172:175], v[228:231]
 s_lshl_b32 s65, s65, 12
M v[236:239], a[140:143], a[172:175], v[236:239]
 s_add_u32 s64, s64, s65
 v_add_u32 v14, s64, v7
 v_mov_b32 v8, 0xff800000
M v[236:239], a[136:139], a[168:171], v[236:239]
 v_cmp_lt_i32 s[16:17], 0, v24
 v_cmp_lt_i32 s[18:19], -1, v24
M v[244:247], a[144:147], a[168:171], v[244:247]
 v_cmp_lt_i32 s[48:49], -2, v24
 v_cmp_lt_i32 s[50:51], -3, v24
M v[244:247], a[148:151], a[172:175], v[244:247]
 s_waitcnt lgkmcnt(6)
M v[252:255], a[156:159], a[172:175], v[252:255]
 s_waitcnt lgkmcnt(0)
M v[252:255], a[152:155], a[168:171], v[252:255]
 s_barrier
M v[32:35], a[32:35], a[160:163], v[32:35]
 ds_read_b128 a[168:171], v5 offset:34816
 ds_read_b128 a[172:175], v6 offset:34816
M v[32:35], a[36:39], a[164:167], v[32:35]
 buffer_load_dword v24, v9, s[8:11], s46 offen sc1
M v[36:39], a[44:47], a[164:167], v[36:39]
 v_mov_b32 v1, v15
 v_add_u32 v2, 0x10000, v7
M v[36:39], a[40:43], a[160:163], v[36:39]
 v_mov_b32 v3, v10
 v_mov_b32 v4, v11
M v[40:43], a[48:51], a[160:163], v[40:43]
 s_mov_b64 s[60:61], s[76:77]
M v[40:43], a[52:55], a[164:167], v[40:43]
 s_mov_b32 s62, s78
M v[44:47], a[60:63], a[164:167], v[44:47]
 s_mov_b32 s63, 0x20000
 v_lshl_add_u32 v10, v0, 7, s95
 v_and_b32 v0, 48, v0
M v[44:47], a[56:59], a[160:163], v[44:47]
 v_lshl_add_u32 v0, v0, 24, v10
 v_mul_f32 v32, s5, v32
M v[48:51], a[64:67], a[160:163], v[48:51]
 v_mul_f32 v33, s5, v33
 v_mul_f32 v34, s5, v34
M v[48:51], a[68:71], a[164:167], v[48:51]
 v_mul_f32 v35, s5, v35
 v_mul_f32 v36, s5, v36
M v[52:55], a[76:79], a[164:167], v[52:55]
 v_mul_f32 v37, s5, v37
 v_mul_f32 v38, s5, v38
M v[52:55], a[72:75], a[160:163], v[52:55]
 v_mul_f32 v39, s5, v39
 v_cvt_pk_bf16_f32 v32, v32, v33
M v[56:59], a[80:83], a[160:163], v[56:59]
 v_cvt_pk_bf16_f32 v33, v34, v35
 v_cvt_pk_bf16_f32 v34, v36, v37
M v[56:59], a[84:87], a[164:167], v[56:59]
 s_waitcnt lgkmcnt(0)
 v_cvt_pk_bf16_f32 v35, v38, v39
 ds_write_b128 v14, v[32:35] offset:0
M v[60:63], a[92:95], a[164:167], v[60:63]
 s_add_u32 s3, s93, 532480
 buffer_store_dwordx4 v[160:163], v7, s[8:11], s3 offen offset:0 sc1
M v[60:63], a[88:91], a[160:163], v[60:63]
 v_mul_f32 v40, s5, v40
 v_mul_f32 v41, s5, v41
M v[68:71], a[32:35], a[168:171], v[68:71]
 ds_read_b128 a[160:163], v5 offset:36864
 ds_read_b128 a[164:167], v6 offset:36864
M v[68:71], a[36:39], a[172:175], v[68:71]
 v_mul_f32 v42, s5, v42
 v_mul_f32 v43, s5, v43
M v[76:79], a[44:47], a[172:175], v[76:79]
 v_mul_f32 v44, s5, v44
 v_mul_f32 v45, s5, v45
M v[76:79], a[40:43], a[168:171], v[76:79]
 v_mul_f32 v46, s5, v46
 v_mul_f32 v47, s5, v47
M v[84:87], a[48:51], a[168:171], v[84:87]
 v_cvt_pk_bf16_f32 v40, v40, v41
 v_cvt_pk_bf16_f32 v41, v42, v43
M v[84:87], a[52:55], a[172:175], v[84:87]
 v_cvt_pk_bf16_f32 v42, v44, v45
 v_cvt_pk_bf16_f32 v43, v46, v47
M v[92:95], a[60:63], a[172:175], v[92:95]
 ds_write_b128 v14, v[40:43] offset:1024
M v[92:95], a[56:59], a[168:171], v[92:95]
 buffer_store_dwordx4 v[168:171], v7, s[8:11], s3 offen offset:1024 sc1
M v[100:103], a[64:67], a[168:171], v[100:103]
 v_mul_f32 v48, s5, v48
 v_mul_f32 v49, s5, v49
M v[100:103], a[68:71], a[172:175], v[100:103]
 v_mul_f32 v50, s5, v50
 v_mul_f32 v51, s5, v51
M v[108:111], a[76:79], a[172:175], v[108:111]
 v_mul_f32 v52, s5, v52
 v_mul_f32 v53, s5, v53
M v[108:111], a[72:75], a[168:171], v[108:111]
 v_mul_f32 v54, s5, v54
 v_mul_f32 v55, s5, v55
M v[116:119], a[80:83], a[168:171], v[116:119]
 v_cvt_pk_bf16_f32 v48, v48, v49
 v_cvt_pk_bf16_f32 v49, v50, v51
M v[116:119], a[84:87], a[172:175], v[116:119]
 s_waitcnt lgkmcnt(1)
 v_cvt_pk_bf16_f32 v50, v52, v53
 v_cvt_pk_bf16_f32 v51, v54, v55
M v[124:127], a[92:95], a[172:175], v[124:127]
 ds_write_b128 v14, v[48:51] offset:2048
M v[124:127], a[88:91], a[168:171], v[124:127]
 buffer_store_dwordx4 v[176:179], v7, s[8:11], s3 offen offset:2048 sc1
M v[132:135], a[32:35], a[160:163], v[132:135]
 ds_read_b128 a[168:171], v5 offset:38912
 ds_read_b128 a[172:175], v6 offset:38912
M v[132:135], a[36:39], a[164:167], v[132:135]
 v_mul_f32 v56, s5, v56
 v_mul_f32 v57, s5, v57
M v[140:143], a[44:47], a[164:167], v[140:143]
 v_mul_f32 v58, s5, v58
 v_mul_f32 v59, s5, v59
M v[140:143], a[40:43], a[160:163], v[140:143]
 v_mul_f32 v60, s5, v60
 v_mul_f32 v61, s5, v61
M v[148:151], a[48:51], a[160:163], v[148:151]
 v_mul_f32 v62, s5, v62
 v_mul_f32 v63, s5, v63
M v[148:151], a[52:55], a[164:167], v[148:151]
 v_cvt_pk_bf16_f32 v56, v56, v57
 v_cvt_pk_bf16_f32 v57, v58, v59
M v[156:159], a[60:63], a[164:167], v[156:159]
 v_cvt_pk_bf16_f32 v58, v60, v61
 v_cvt_pk_bf16_f32 v59, v62, v63
M v[156:159], a[56:59], a[160:163], v[156:159]
 s_waitcnt lgkmcnt(0)
 ds_write_b128 v14, v[56:59] offset:3072
M v[164:167], a[64:67], a[160:163], v[164:167]
 s_barrier
M v[164:167], a[68:71], a[164:167], v[164:167]
M v[172:175], a[76:79], a[164:167], v[172:175]
 s_add_u32 m0, s28, 32768
 s_nop 0
 buffer_load_dwordx4 v3, s[8:11], s21 offen offset:0 sc1 lds
M v[172:175], a[72:75], a[160:163], v[172:175]
M v[180:183], a[80:83], a[160:163], v[180:183]
 buffer_store_dwordx4 v[184:187], v7, s[8:11], s3 offen offset:3072 sc1
M v[180:183], a[84:87], a[164:167], v[180:183]
 v_mul_f32 v68, s5, v68
 v_mul_f32 v69, s5, v69
M v[188:191], a[92:95], a[164:167], v[188:191]
 buffer_load_dwordx4 v3, s[8:11], s21 offen offset:1024 sc1 lds
M v[188:191], a[88:91], a[160:163], v[188:191]
 v_mul_f32 v70, s5, v70
 v_mul_f32 v71, s5, v71
M v[196:199], a[32:35], a[168:171], v[196:199]
 v_mul_f32 v76, s5, v76
 v_mul_f32 v77, s5, v77
M v[196:199], a[36:39], a[172:175], v[196:199]
 v_mul_f32 v78, s5, v78
 v_mul_f32 v79, s5, v79
M v[204:207], a[44:47], a[172:175], v[204:207]
 buffer_load_dwordx4 v3, s[8:11], s21 offen offset:2048 sc1 lds
M v[204:207], a[40:43], a[168:171], v[204:207]
 v_cvt_pk_bf16_f32 v68, v68, v69
 v_cvt_pk_bf16_f32 v69, v70, v71
M v[212:215], a[48:51], a[168:171], v[212:215]
 v_cvt_pk_bf16_f32 v70, v76, v77
 v_cvt_pk_bf16_f32 v71, v78, v79
M v[212:215], a[52:55], a[172:175], v[212:215]
 ds_write_b128 v14, v[68:71] offset:8192
 v_mul_f32 v84, s5, v84
M v[220:223], a[60:63], a[172:175], v[220:223]
 buffer_load_dwordx4 v3, s[8:11], s21 offen offset:3072 sc1 lds
M v[220:223], a[56:59], a[168:171], v[220:223]
 s_add_u32 m0, s28, 36864
 v_mul_f32 v85, s5, v85
 v_mul_f32 v86, s5, v86
M v[228:231], a[64:67], a[168:171], v[228:231]
 v_mul_f32 v87, s5, v87
 v_mul_f32 v92, s5, v92
M v[228:231], a[68:71], a[172:175], v[228:231]
 v_mul_f32 v93, s5, v93
 v_mul_f32 v94, s5, v94
M v[236:239], a[76:79], a[172:175], v[236:239]
 buffer_load_dwordx4 v4, s[8:11], s21 offen offset:0 sc1 lds
M v[236:239], a[72:75], a[168:171], v[236:239]
 v_mul_f32 v95, s5, v95
 v_cvt_pk_bf16_f32 v84, v84, v85
M v[244:247], a[80:83], a[168:171], v[244:247]
 v_cvt_pk_bf16_f32 v85, v86, v87
 v_cvt_pk_bf16_f32 v86, v92, v93
M v[244:247], a[84:87], a[172:175], v[244:247]
 v_cvt_pk_bf16_f32 v87, v94, v95
 ds_write_b128 v14, v[84:87] offset:9216
M v[252:255], a[92:95], a[172:175], v[252:255]
 buffer_load_dwordx4 v4, s[8:11], s21 offen offset:1024 sc1 lds
M v[252:255], a[88:91], a[168:171], v[252:255]
 buffer_load_dwordx4 v4, s[8:11], s21 offen offset:2048 sc1 lds
 buffer_load_dwordx4 v4, s[8:11], s21 offen offset:3072 sc1 lds
 s_add_u32 s24, s23, 16777216
 s_mov_b32 s23, s21
 s_add_u32 s21, s21, 32768
 s_add_u32 s22, s22, 1
 s_cmp_eq_u32 s22, s25
 s_cselect_b32 s21, s26, s21
 s_cmp_eq_u32 s22, s43
 s_cselect_b32 s21, s4, s21
 s_cmp_eq_u32 s22, s6
 s_cselect_b32 s21, s7, s21
 v_mul_f32 v100, s5, v100
 v_mul_f32 v101, s5, v101
 v_mul_f32 v102, s5, v102
 v_mul_f32 v103, s5, v103
 v_mul_f32 v108, s5, v108
 v_mul_f32 v109, s5, v109
 v_mul_f32 v110, s5, v110
 v_mul_f32 v111, s5, v111
 v_cvt_pk_bf16_f32 v100, v100, v101
 v_cvt_pk_bf16_f32 v101, v102, v103
 v_cvt_pk_bf16_f32 v102, v108, v109
 v_cvt_pk_bf16_f32 v103, v110, v111
 ds_write_b128 v14, v[100:103] offset:10240
 v_pk_mul_f32 v[116:117], v[116:117], s[4:5] op_sel:[0,1] op_sel_hi:[1,1]
 v_pk_mul_f32 v[118:119], v[118:119], s[4:5] op_sel:[0,1] op_sel_hi:[1,1]
 v_pk_mul_f32 v[124:125], v[124:125], s[4:5] op_sel:[0,1] op_sel_hi:[1,1]
 v_pk_mul_f32 v[126:127], v[126:127], s[4:5] op_sel:[0,1] op_sel_hi:[1,1]
 v_cvt_pk_bf16_f32 v116, v116, v117
 v_cvt_pk_bf16_f32 v117, v118, v119
 v_cvt_pk_bf16_f32 v118, v124, v125
 v_cvt_pk_bf16_f32 v119, v126, v127
 ds_write_b128 v14, v[116:119] offset:11264
 v_pk_mul_f32 v[132:133], v[132:133], s[4:5] op_sel:[0,1] op_sel_hi:[1,1]
 v_pk_mul_f32 v[134:135], v[134:135], s[4:5] op_sel:[0,1] op_sel_hi:[1,1]
 v_pk_mul_f32 v[140:141], v[140:141], s[4:5] op_sel:[0,1] op_sel_hi:[1,1]
 v_pk_mul_f32 v[142:143], v[142:143], s[4:5] op_sel:[0,1] op_sel_hi:[1,1]
 v_cvt_pk_bf16_f32 v132, v132, v133
 v_cvt_pk_bf16_f32 v133, v134, v135
 v_cvt_pk_bf16_f32 v134, v140, v141
 v_cvt_pk_bf16_f32 v135, v142, v143
 ds_write_b128 v14, v[132:135] offset:16384
 v_pk_mul_f32 v[148:149], v[148:149], s[4:5] op_sel:[0,1] op_sel_hi:[1,1]
 v_pk_mul_f32 v[150:151], v[150:151], s[4:5] op_sel:[0,1] op_sel_hi:[1,1]
 v_pk_mul_f32 v[156:157], v[156:157], s[4:5] op_sel:[0,1] op_sel_hi:[1,1]
 v_pk_mul_f32 v[158:159], v[158:159], s[4:5] op_sel:[0,1] op_sel_hi:[1,1]
 v_cvt_pk_bf16_f32 v148, v148, v149
 v_cvt_pk_bf16_f32 v149, v150, v151
 v_cvt_pk_bf16_f32 v150, v156, v157
 v_cvt_pk_bf16_f32 v151, v158, v159
 ds_write_b128 v14, v[148:151] offset:17408
 v_pk_mul_f32 v[164:165], v[164:165], s[4:5] op_sel:[0,1] op_sel_hi:[1,1]
 v_pk_mul_f32 v[166:167], v[166:167], s[4:5] op_sel:[0,1] op_sel_hi:[1,1]
 v_pk_mul_f32 v[172:173], v[172:173], s[4:5] op_sel:[0,1] op_sel_hi:[1,1]
 v_pk_mul_f32 v[174:175], v[174:175], s[4:5] op_sel:[0,1] op_sel_hi:[1,1]
 v_cvt_pk_bf16_f32 v164, v164, v165
 v_cvt_pk_bf16_f32 v165, v166, v167
 v_cvt_pk_bf16_f32 v166, v172, v173
 v_cvt_pk_bf16_f32 v167, v174, v175
 ds_write_b128 v14, v[164:167] offset:18432
 v_pk_mul_f32 v[180:181], v[180:181], s[4:5] op_sel:[0,1] op_sel_hi:[1,1]
 v_pk_mul_f32 v[182:183], v[182:183], s[4:5] op_sel:[0,1] op_sel_hi:[1,1]
 v_pk_mul_f32 v[188:189], v[188:189], s[4:5] op_sel:[0,1] op_sel_hi:[1,1]
 v_pk_mul_f32 v[190:191], v[190:191], s[4:5] op_sel:[0,1] op_sel_hi:[1,1]
 v_cvt_pk_bf16_f32 v180, v180, v181
 v_cvt_pk_bf16_f32 v181, v182, v183
 v_cvt_pk_bf16_f32 v182, v188, v189
 v_cvt_pk_bf16_f32 v183, v190, v191
 ds_write_b128 v14, v[180:183] offset:19456
 v_pk_mul_f32 v[196:197], v[196:197], s[4:5] op_sel:[0,1] op_sel_hi:[1,1]
 v_pk_mul_f32 v[198:199], v[198:199], s[4:5] op_sel:[0,1] op_sel_hi:[1,1]
 v_pk_mul_f32 v[204:205], v[204:205], s[4:5] op_sel:[0,1] op_sel_hi:[1,1]
 v_pk_mul_f32 v[206:207], v[206:207], s[4:5] op_sel:[0,1] op_sel_hi:[1,1]
 v_cvt_pk_bf16_f32 v196, v196, v197
 v_cvt_pk_bf16_f32 v197, v198, v199
 v_cvt_pk_bf16_f32 v198, v204, v205
 v_cvt_pk_bf16_f32 v199, v206, v207
 ds_write_b128 v14, v[196:199] offset:24576
 v_pk_mul_f32 v[212:213], v[212:213], s[4:5] op_sel:[0,1] op_sel_hi:[1,1]
 v_pk_mul_f32 v[214:215], v[214:215], s[4:5] op_sel:[0,1] op_sel_hi:[1,1]
 v_pk_mul_f32 v[220:221], v[220:221], s[4:5] op_sel:[0,1] op_sel_hi:[1,1]
 v_pk_mul_f32 v[222:223], v[222:223], s[4:5] op_sel:[0,1] op_sel_hi:[1,1]
 v_cvt_pk_bf16_f32 v212, v212, v213
 v_cvt_pk_bf16_f32 v213, v214, v215
 v_cvt_pk_bf16_f32 v214, v220, v221
 v_cvt_pk_bf16_f32 v215, v222, v223
 ds_write_b128 v14, v[212:215] offset:25600
 v_pk_mul_f32 v[228:229], v[228:229], s[4:5] op_sel:[0,1] op_sel_hi:[1,1]
 v_pk_mul_f32 v[230:231], v[230:231], s[4:5] op_sel:[0,1] op_sel_hi:[1,1]
 v_pk_mul_f32 v[236:237], v[236:237], s[4:5] op_sel:[0,1] op_sel_hi:[1,1]
 v_pk_mul_f32 v[238:239], v[238:239], s[4:5] op_sel:[0,1] op_sel_hi:[1,1]
 v_cvt_pk_bf16_f32 v228, v228, v229
 v_cvt_pk_bf16_f32 v229, v230, v231
 v_cvt_pk_bf16_f32 v230, v236, v237
 v_cvt_pk_bf16_f32 v231, v238, v239
 ds_write_b128 v14, v[228:231] offset:26624
 v_pk_mul_f32 v[244:245], v[244:245], s[4:5] op_sel:[0,1] op_sel_hi:[1,1]
 v_pk_mul_f32 v[246:247], v[246:247], s[4:5] op_sel:[0,1] op_sel_hi:[1,1]
 v_pk_mul_f32 v[252:253], v[252:253], s[4:5] op_sel:[0,1] op_sel_hi:[1,1]
 v_pk_mul_f32 v[254:255], v[254:255], s[4:5] op_sel:[0,1] op_sel_hi:[1,1]
 v_cvt_pk_bf16_f32 v244, v244, v245
 v_cvt_pk_bf16_f32 v245, v246, v247
 v_cvt_pk_bf16_f32 v246, v252, v253
 v_cvt_pk_bf16_f32 v247, v254, v255
 ds_write_b128 v14, v[244:247] offset:27648
 s_waitcnt vmcnt(15) lgkmcnt(0)
 s_barrier
 ds_read_b128 a[64:67], v2 offset:32768
 ds_read_b128 a[68:71], v2 offset:33792
 ds_read_b128 a[72:75], v2 offset:34816
 ds_read_b128 a[76:79], v2 offset:35840
 ds_read_b128 a[80:83], v2 offset:36864
 ds_read_b128 a[84:87], v2 offset:37888
 ds_read_b128 a[88:91], v2 offset:38912
 ds_read_b128 a[92:95], v2 offset:39936
 s_lshl_b32 s64, s20, 13
 s_sub_u32 s65, 155648, s64
 v_add_u32 v10, s64, v7
 v_add_u32 v11, s65, v7
 ds_read_b128 a[0:3], v10 offset:0
 ds_read_b128 a[4:7], v10 offset:1024
 ds_read_b128 a[8:11], v10 offset:2048
 ds_read_b128 a[12:15], v10 offset:3072
 ds_read_b128 a[16:19], v10 offset:4096
 ds_read_b128 a[20:23], v10 offset:5120
 ds_read_b128 a[24:27], v10 offset:6144
 ds_read_b128 a[28:31], v10 offset:7168
 ds_read_b128 a[32:35], v11 offset:0
 ds_read_b128 a[36:39], v11 offset:1024
 ds_read_b128 a[40:43], v11 offset:2048
 ds_read_b128 a[44:47], v11 offset:3072
 ds_read_b128 a[48:51], v11 offset:4096
 ds_read_b128 a[52:55], v11 offset:5120
 ds_read_b128 a[56:59], v11 offset:6144
 ds_read_b128 a[60:63], v11 offset:7168
 s_waitcnt vmcnt(12)
 v_cmp_eq_u32 vcc, 0, v24
 v_mov_b32 v17, 3
 v_or_b32 v6, s35, v7
 s_cbranch_vccnz L_f1s15
L_f1r15:
 s_mov_b32 s30, s93
 s_mov_b32 s29, s94
 s_cmp_eq_u32 s20, 0
 s_cselect_b32 s5, 5, 0
 v_mov_b32 v32, 0xc1800000
 v_mov_b32 v33, 0xc1800000
 v_mov_b32 v34, 0xc1800000
 v_mov_b32 v35, 0xc1800000
 v_mov_b32 v36, 0xc1800000
 v_mov_b32 v37, 0xc1800000
 v_mov_b32 v38, 0xc1800000
 v_mov_b32 v39, 0xc1800000
 s_waitcnt lgkmcnt(0)
M v[64:67], a[64:67], a[0:3], v[32:35]
 ds_read_b128 a[96:99], v2 offset:40960
 v_mov_b32 v30, 0
M v[64:67], a[68:71], a[4:7], v[64:67]
 s_add_u32 m0, s28, 65536
 ds_read_b128 a[100:103], v2 offset:41984
 v_mov_b32 v31, 0
M v[64:67], a[72:75], a[8:11], v[64:67]
 buffer_load_dwordx4 v3, s[8:11], s24 offen offset:0 sc1 lds
M v[64:67], a[76:79], a[12:15], v[64:67]
 ds_read_b128 a[104:107], v2 offset:43008
 v_accvgpr_write_b32 a128, v192
M v[64:67], a[80:83], a[16:19], v[64:67]
 ds_read_b128 a[108:111], v2 offset:44032
 v_accvgpr_write_b32 a129, v193
M v[64:67], a[84:87], a[20:23], v[64:67]
 buffer_load_dwordx4 v3, s[8:11], s24 offen offset:1024 sc1 lds
M v[64:67], a[88:91], a[24:27], v[64:67]
 ds_read_b128 a[112:115], v2 offset:45056
 v_accvgpr_write_b32 a130, v194
M v[64:67], a[92:95], a[28:31], v[64:67]
 ds_read_b128 a[116:119], v2 offset:46080
 v_accvgpr_write_b32 a131, v195
M v[68:71], a[92:95], a[60:63], v[36:39]
 v_accvgpr_write_b32 a132, v200
 v_accvgpr_write_b32 a133, v201
M v[68:71], a[88:91], a[56:59], v[68:71]
 ds_read_b128 a[120:123], v2 offset:47104
 v_accvgpr_write_b32 a134, v202
M v[68:71], a[84:87], a[52:55], v[68:71]
 ds_read_b128 a[124:127], v2 offset:48128
 v_accvgpr_write_b32 a135, v203
M v[68:71], a[80:83], a[48:51], v[68:71]
 buffer_load_dwordx4 v3, s[8:11], s24 offen offset:2048 sc1 lds
M v[68:71], a[76:79], a[44:47], v[68:71]
 v_accvgpr_write_b32 a136, v208
 v_accvgpr_write_b32 a137, v209
M v[68:71], a[72:75], a[40:43], v[68:71]
 v_accvgpr_write_b32 a138, v210
 v_accvgpr_write_b32 a139, v211
M v[68:71], a[68:71], a[36:39], v[68:71]
 v_exp_f32 v18, v64
M v[68:71], a[64:67], a[32:35], v[68:71]
 s_waitcnt lgkmcnt(0)
 v_exp_f32 v19, v65
M v[72:75], a[96:99], a[0:3], v[32:35]
 ds_read_b128 a[64:67], v2 offset:49152
 v_add_f32 v26, v18, v19
M v[72:75], a[100:103], a[4:7], v[72:75]
 ds_read_b128 a[68:71], v2 offset:50176
 v_cvt_pk_bf16_f32 v40, v18, v19
M v[72:75], a[104:107], a[8:11], v[72:75]
 buffer_load_dwordx4 v3, s[8:11], s24 offen offset:3072 sc1 lds
M v[72:75], a[108:111], a[12:15], v[72:75]
 ds_read_b128 a[72:75], v2 offset:51200
 v_accvgpr_write_b32 a140, v216
M v[72:75], a[112:115], a[16:19], v[72:75]
 s_add_u32 m0, s28, 69632
 ds_read_b128 a[76:79], v2 offset:52224
 v_accvgpr_write_b32 a141, v217
M v[72:75], a[116:119], a[20:23], v[72:75]
 buffer_load_dwordx4 v4, s[8:11], s24 offen offset:0 sc1 lds
M v[72:75], a[120:123], a[24:27], v[72:75]
 ds_read_b128 a[80:83], v2 offset:53248
 v_accvgpr_write_b32 a142, v218
M v[72:75], a[124:127], a[28:31], v[72:75]
 s_add_u32 s3, s32, 0
 ds_read_b128 a[84:87], v2 offset:54272
 v_accvgpr_write_b32 a143, v219
M v[76:79], a[124:127], a[60:63], v[36:39]
 buffer_store_dwordx4 a[0:3], v6, s[8:11], s3 offen offset:0 sc1
M v[76:79], a[120:123], a[56:59], v[76:79]
 ds_read_b128 a[88:91], v2 offset:55296
 v_accvgpr_write_b32 a144, v224
M v[76:79], a[116:119], a[52:55], v[76:79]
 ds_read_b128 a[92:95], v2 offset:56320
 v_accvgpr_write_b32 a145, v225
M v[76:79], a[112:115], a[48:51], v[76:79]
 buffer_load_dwordx4 v4, s[8:11], s24 offen offset:1024 sc1 lds
M v[76:79], a[108:111], a[44:47], v[76:79]
 v_exp_f32 v20, v66
M v[76:79], a[104:107], a[40:43], v[76:79]
 buffer_store_dwordx4 a[4:7], v6, s[8:11], s3 offen offset:1024 sc1
M v[76:79], a[100:103], a[36:39], v[76:79]
 v_exp_f32 v21, v67
M v[76:79], a[96:99], a[32:35], v[76:79]
 s_waitcnt lgkmcnt(0)
 v_exp_f32 v22, v68
M v[80:83], a[64:67], a[0:3], v[32:35]
 ds_read_b128 a[96:99], v2 offset:57344
 v_add_f32 v26, v20, v26
M v[80:83], a[68:71], a[4:7], v[80:83]
 ds_read_b128 a[100:103], v2 offset:58368
 v_cvt_pk_bf16_f32 v41, v20, v21
M v[80:83], a[72:75], a[8:11], v[80:83]
 buffer_load_dwordx4 v4, s[8:11], s24 offen offset:2048 sc1 lds
M v[80:83], a[76:79], a[12:15], v[80:83]
 ds_read_b128 a[104:107], v2 offset:59392
 v_add_f32 v26, v21, v26
M v[80:83], a[80:83], a[16:19], v[80:83]
 ds_read_b128 a[108:111], v2 offset:60416
 v_accvgpr_write_b32 a146, v226
M v[80:83], a[84:87], a[20:23], v[80:83]
 buffer_store_dwordx4 a[8:11], v6, s[8:11], s3 offen offset:2048 sc1
M v[80:83], a[88:91], a[24:27], v[80:83]
 ds_read_b128 a[112:115], v2 offset:61440
 v_accvgpr_write_b32 a147, v227
M v[80:83], a[92:95], a[28:31], v[80:83]
 ds_read_b128 a[116:119], v2 offset:62464
 v_accvgpr_write_b32 a148, v232
M v[84:87], a[92:95], a[60:63], v[36:39]
 buffer_load_dwordx4 v4, s[8:11], s24 offen offset:3072 sc1 lds
M v[84:87], a[88:91], a[56:59], v[84:87]
 ds_read_b128 a[120:123], v2 offset:63488
 v_accvgpr_write_b32 a149, v233
M v[84:87], a[84:87], a[52:55], v[84:87]
 ds_read_b128 a[124:127], v2 offset:64512
 v_accvgpr_write_b32 a150, v234
M v[84:87], a[80:83], a[48:51], v[84:87]
 buffer_store_dwordx4 a[12:15], v6, s[8:11], s3 offen offset:3072 sc1
M v[84:87], a[76:79], a[44:47], v[84:87]
 s_add_u32 s3, s32, 4096
 v_exp_f32 v23, v69
M v[84:87], a[72:75], a[40:43], v[84:87]
 buffer_store_dwordx4 a[16:19], v6, s[8:11], s3 offen offset:0 sc1
M v[84:87], a[68:71], a[36:39], v[84:87]
 s_waitcnt vmcnt(13) lgkmcnt(0)
 v_exp_f32 v24, v70
M v[84:87], a[64:67], a[32:35], v[84:87]
 s_barrier
M v[88:91], a[96:99], a[0:3], v[32:35]
 ds_read_b128 a[64:67], v7 offset:32768
 v_add_f32 v27, v22, v23
M v[88:91], a[100:103], a[4:7], v[88:91]
 ds_read_b128 a[68:71], v7 offset:33792
 v_cvt_pk_bf16_f32 v44, v22, v23
M v[88:91], a[104:107], a[8:11], v[88:91]
 buffer_store_dword v17, v1, s[8:11], s45 offen sc1
M v[88:91], a[108:111], a[12:15], v[88:91]
 ds_read_b128 a[72:75], v7 offset:34816
 v_accvgpr_write_b32 a151, v235
M v[88:91], a[112:115], a[16:19], v[88:91]
 ds_read_b128 a[76:79], v7 offset:35840
 v_accvgpr_write_b32 a152, v240
M v[88:91], a[116:119], a[20:23], v[88:91]
 buffer_store_dwordx4 a[20:23], v6, s[8:11], s3 offen offset:1024 sc1
M v[88:91], a[120:123], a[24:27], v[88:91]
 ds_read_b128 a[80:83], v7 offset:36864
 v_accvgpr_write_b32 a153, v241
M v[88:91], a[124:127], a[28:31], v[88:91]
 ds_read_b128 a[84:87], v7 offset:37888
 v_accvgpr_write_b32 a154, v242
M v[92:95], a[124:127], a[60:63], v[36:39]
 buffer_store_dwordx4 a[24:27], v6, s[8:11], s3 offen offset:2048 sc1
M v[92:95], a[120:123], a[56:59], v[92:95]
 ds_read_b128 a[88:91], v7 offset:38912
 v_accvgpr_write_b32 a155, v243
M v[92:95], a[116:119], a[52:55], v[92:95]
 ds_read_b128 a[92:95], v7 offset:39936
 v_accvgpr_write_b32 a156, v248
M v[92:95], a[112:115], a[48:51], v[92:95]
 buffer_store_dwordx4 a[28:31], v6, s[8:11], s3 offen offset:3072 sc1
M v[92:95], a[108:111], a[44:47], v[92:95]
 v_exp_f32 v25, v71
M v[92:95], a[104:107], a[40:43], v[92:95]
 v_exp_f32 v18, v72
M v[92:95], a[100:103], a[36:39], v[92:95]
 s_waitcnt lgkmcnt(0)
 v_exp_f32 v19, v73
M v[92:95], a[96:99], a[32:35], v[92:95]
 v_exp_f32 v20, v74
M v[96:99], a[64:67], a[0:3], v[32:35]
 s_add_u32 m0, s28, 98304
 ds_read_b128 a[96:99], v7 offset:40960
 ds_read_b128 a[100:103], v7 offset:41984
M v[96:99], a[68:71], a[4:7], v[96:99]
 buffer_load_dwordx4 v3, s[8:11], s21 offen offset:0 sc1 lds
M v[96:99], a[72:75], a[8:11], v[96:99]
 v_exp_f32 v21, v75
M v[96:99], a[76:79], a[12:15], v[96:99]
 s_add_u32 s3, s32, 8192
 ds_read_b128 a[104:107], v7 offset:43008
 ds_read_b128 a[108:111], v7 offset:44032
M v[96:99], a[80:83], a[16:19], v[96:99]
 buffer_store_dwordx4 a[32:35], v6, s[8:11], s3 offen offset:0 sc1
M v[96:99], a[84:87], a[20:23], v[96:99]
 v_exp_f32 v22, v76
M v[96:99], a[88:91], a[24:27], v[96:99]
 ds_read_b128 a[112:115], v7 offset:45056
 ds_read_b128 a[116:119], v7 offset:46080
M v[96:99], a[92:95], a[28:31], v[96:99]
 buffer_load_dwordx4 v3, s[8:11], s21 offen offset:1024 sc1 lds
M v[100:103], a[92:95], a[60:63], v[36:39]
 v_exp_f32 v23, v77
M v[100:103], a[88:91], a[56:59], v[100:103]
 ds_read_b128 a[120:123], v7 offset:47104
 ds_read_b128 a[124:127], v7 offset:48128
M v[100:103], a[84:87], a[52:55], v[100:103]
 buffer_store_dwordx4 a[36:39], v6, s[8:11], s3 offen offset:1024 sc1
M v[100:103], a[80:83], a[48:51], v[100:103]
 v_add_f32 v27, v24, v27
 v_cvt_pk_bf16_f32 v45, v24, v25
M v[100:103], a[76:79], a[44:47], v[100:103]
 buffer_load_dwordx4 v3, s[8:11], s21 offen offset:2048 sc1 lds
M v[100:103], a[72:75], a[40:43], v[100:103]
 v_add_f32 v27, v25, v27
 v_add_f32 v26, v18, v26
M v[100:103], a[68:71], a[36:39], v[100:103]
 v_exp_f32 v24, v78
M v[100:103], a[64:67], a[32:35], v[100:103]
 s_waitcnt lgkmcnt(0)
 v_exp_f32 v25, v79
M v[104:107], a[96:99], a[0:3], v[32:35]
 ds_read_b128 a[64:67], v7 offset:49152
 ds_read_b128 a[68:71], v7 offset:50176
M v[104:107], a[100:103], a[4:7], v[104:107]
 buffer_load_dwordx4 v3, s[8:11], s21 offen offset:3072 sc1 lds
M v[104:107], a[104:107], a[8:11], v[104:107]
 v_cvt_pk_bf16_f32 v42, v18, v19
 v_add_f32 v26, v19, v26
M v[104:107], a[108:111], a[12:15], v[104:107]
 ds_read_b128 a[72:75], v7 offset:51200
 ds_read_b128 a[76:79], v7 offset:52224
M v[104:107], a[112:115], a[16:19], v[104:107]
 buffer_store_dwordx4 a[40:43], v6, s[8:11], s3 offen offset:2048 sc1
M v[104:107], a[116:119], a[20:23], v[104:107]
 v_exp_f32 v18, v80
M v[104:107], a[120:123], a[24:27], v[104:107]
 s_add_u32 m0, s28, 102400
 ds_read_b128 a[80:83], v7 offset:53248
 ds_read_b128 a[84:87], v7 offset:54272
M v[104:107], a[124:127], a[28:31], v[104:107]
 buffer_load_dwordx4 v4, s[8:11], s21 offen offset:0 sc1 lds
M v[108:111], a[124:127], a[60:63], v[36:39]
 v_exp_f32 v19, v81
M v[108:111], a[120:123], a[56:59], v[108:111]
 ds_read_b128 a[88:91], v7 offset:55296
 ds_read_b128 a[92:95], v7 offset:56320
M v[108:111], a[116:119], a[52:55], v[108:111]
 buffer_store_dwordx4 a[44:47], v6, s[8:11], s3 offen offset:3072 sc1
M v[108:111], a[112:115], a[48:51], v[108:111]
 v_add_f32 v26, v20, v26
 v_cvt_pk_bf16_f32 v43, v20, v21
M v[108:111], a[108:111], a[44:47], v[108:111]
 buffer_load_dwordx4 v4, s[8:11], s21 offen offset:1024 sc1 lds
M v[108:111], a[104:107], a[40:43], v[108:111]
 s_add_u32 s3, s32, 12288
 v_add_f32 v26, v21, v26
 v_add_f32 v27, v22, v27
M v[108:111], a[100:103], a[36:39], v[108:111]
 buffer_store_dwordx4 a[48:51], v6, s[8:11], s3 offen offset:0 sc1
M v[108:111], a[96:99], a[32:35], v[108:111]
 s_waitcnt lgkmcnt(0)
 v_exp_f32 v20, v82
M v[112:115], a[64:67], a[0:3], v[32:35]
 ds_read_b128 a[96:99], v7 offset:57344
 ds_read_b128 a[100:103], v7 offset:58368
M v[112:115], a[68:71], a[4:7], v[112:115]
 buffer_load_dwordx4 v4, s[8:11], s21 offen offset:2048 sc1 lds
M v[112:115], a[72:75], a[8:11], v[112:115]
 v_exp_f32 v21, v83
M v[112:115], a[76:79], a[12:15], v[112:115]
 ds_read_b128 a[104:107], v7 offset:59392
 ds_read_b128 a[108:111], v7 offset:60416
M v[112:115], a[80:83], a[16:19], v[112:115]
 buffer_load_dwordx4 v4, s[8:11], s21 offen offset:3072 sc1 lds
M v[112:115], a[84:87], a[20:23], v[112:115]
 s_add_u32 s24, s23, 16777216
 v_cvt_pk_bf16_f32 v46, v22, v23
 v_add_f32 v27, v23, v27
M v[112:115], a[88:91], a[24:27], v[112:115]
 s_mov_b32 s23, s21
 ds_read_b128 a[112:115], v7 offset:61440
 ds_read_b128 a[116:119], v7 offset:62464
M v[112:115], a[92:95], a[28:31], v[112:115]
 buffer_store_dwordx4 a[52:55], v6, s[8:11], s3 offen offset:1024 sc1
M v[116:119], a[92:95], a[60:63], v[36:39]
 s_add_u32 s21, s21, 32768
 v_add_f32 v27, v24, v27
M v[116:119], a[88:91], a[56:59], v[116:119]
 s_add_u32 s22, s22, 1
 ds_read_b128 a[120:123], v7 offset:63488
 ds_read_b128 a[124:127], v7 offset:64512
M v[116:119], a[84:87], a[52:55], v[116:119]
 s_cmp_eq_u32 s22, s25
 v_exp_f32 v22, v88
M v[116:119], a[80:83], a[48:51], v[116:119]
 s_cselect_b32 s21, s26, s21
 v_exp_f32 v23, v89
M v[116:119], a[76:79], a[44:47], v[116:119]
 buffer_store_dwordx4 a[56:59], v6, s[8:11], s3 offen offset:2048 sc1
M v[116:119], a[72:75], a[40:43], v[116:119]
 s_cmp_eq_u32 s22, s43
 v_cvt_pk_bf16_f32 v47, v24, v25
 v_add_f32 v27, v25, v27
M v[116:119], a[68:71], a[36:39], v[116:119]
 s_waitcnt vmcnt(21) lgkmcnt(0)
 v_exp_f32 v24, v90
M v[116:119], a[64:67], a[32:35], v[116:119]
 s_barrier
M v[120:123], a[96:99], a[0:3], v[32:35]
 s_cselect_b32 s21, s4, s21
 ds_read_b128 a[64:67], v2 offset:0
 ds_read_b128 a[68:71], v2 offset:1024
M v[120:123], a[100:103], a[4:7], v[120:123]
 s_cmp_eq_u32 s22, s6
 v_exp_f32 v25, v91
M v[120:123], a[104:107], a[8:11], v[120:123]
 s_cselect_b32 s21, s7, s21
 v_add_f32 v26, v18, v26
 v_cvt_pk_bf16_f32 v56, v18, v19
M v[120:123], a[108:111], a[12:15], v[120:123]
 ds_read_b128 a[72:75], v2 offset:2048
 ds_read_b128 a[76:79], v2 offset:3072
M v[120:123], a[112:115], a[16:19], v[120:123]
 buffer_store_dwordx4 a[60:63], v6, s[8:11], s3 offen offset:3072 sc1
M v[120:123], a[116:119], a[20:23], v[120:123]
 v_add_f32 v26, v19, v26
 v_add_f32 v26, v20, v26
M v[120:123], a[120:123], a[24:27], v[120:123]
 ds_read_b128 a[80:83], v2 offset:4096
 ds_read_b128 a[84:87], v2 offset:5120
M v[120:123], a[124:127], a[28:31], v[120:123]
 v_exp_f32 v18, v84
M v[124:127], a[124:127], a[60:63], v[36:39]
 v_exp_f32 v19, v85
M v[124:127], a[120:123], a[56:59], v[124:127]
 ds_read_b128 a[88:91], v2 offset:6144
 ds_read_b128 a[92:95], v2 offset:7168
M v[124:127], a[116:119], a[52:55], v[124:127]
 v_cvt_pk_bf16_f32 v57, v20, v21
 v_add_f32 v26, v21, v26
M v[124:127], a[112:115], a[48:51], v[124:127]
 v_exp_f32 v20, v86
M v[124:127], a[108:111], a[44:47], v[124:127]
 v_exp_f32 v21, v87
M v[124:127], a[104:107], a[40:43], v[124:127]
 v_add_f32 v26, v22, v26
 v_cvt_pk_bf16_f32 v58, v22, v23
M v[124:127], a[100:103], a[36:39], v[124:127]
 s_waitcnt lgkmcnt(0)
 v_add_f32 v26, v23, v26
 v_add_f32 v26, v24, v26
M v[124:127], a[96:99], a[32:35], v[124:127]
 v_exp_f32 v22, v92
 v_cvt_pk_bf16_f32 v59, v24, v25
 v_add_f32 v26, v25, v26
 v_add_f32 v27, v18, v27
 v_cvt_pk_bf16_f32 v60, v18, v19
 v_add_f32 v27, v19, v27
 v_exp_f32 v23, v93
 v_add_f32 v27, v20, v27
 v_cvt_pk_bf16_f32 v61, v20, v21
 v_add_f32 v27, v21, v27
 v_exp_f32 v24, v94
 v_add_f32 v27, v22, v27
 v_cvt_pk_bf16_f32 v62, v22, v23
 v_exp_f32 v25, v95
 v_add_f32 v27, v23, v27
 v_add_f32 v27, v24, v27
 v_cvt_pk_bf16_f32 v63, v24, v25
 v_add_f32 v27, v25, v27
 v_max_f32 v10, v26, v27
 v_min_f32 v11, v26, v27
 v_cmp_lt_f32 s[36:37], s31, v10
 v_cmp_gt_f32 vcc, s55, v11
 s_nop 0
 s_or_b64 vcc, vcc, s[36:37]
 s_cbranch_vccnz L_st8
L_rt8:
M v[128:131], a[64:67], v[40:43], 0
 s_add_u32 m0, s28, 0
 ds_read_b128 a[96:99], v2 offset:8192
 ds_read_b128 a[100:103], v2 offset:9216
M v[128:131], a[68:71], v[56:59], v[128:131]
 buffer_load_dwordx4 v3, s[8:11], s24 offen offset:0 sc1 lds
M v[132:135], a[68:71], v[60:63], 0
 v_accvgpr_write_b32 a157, v249
 v_accvgpr_write_b32 a158, v250
M v[132:135], a[64:67], v[44:47], v[132:135]
 ds_read_b128 a[104:107], v2 offset:10240
 ds_read_b128 a[108:111], v2 offset:11264
M v[136:139], a[72:75], v[40:43], 0
 buffer_load_dwordx4 v3, s[8:11], s24 offen offset:1024 sc1 lds
M v[136:139], a[76:79], v[56:59], v[136:139]
 v_accvgpr_write_b32 a159, v251
 v_add_f32 v30, v26, v30
M v[140:143], a[76:79], v[60:63], 0
 ds_read_b128 a[112:115], v2 offset:12288
 ds_read_b128 a[116:119], v2 offset:13312
M v[140:143], a[72:75], v[44:47], v[140:143]
 buffer_load_dwordx4 v3, s[8:11], s24 offen offset:2048 sc1 lds
M v[144:147], a[80:83], v[40:43], 0
 v_exp_f32 v18, v96
M v[144:147], a[84:87], v[56:59], v[144:147]
 ds_read_b128 a[120:123], v2 offset:14336
 ds_read_b128 a[124:127], v2 offset:15360
M v[148:151], a[84:87], v[60:63], 0
 buffer_load_dwordx4 v3, s[8:11], s24 offen offset:3072 sc1 lds
M v[148:151], a[80:83], v[44:47], v[148:151]
 s_add_u32 m0, s28, 4096
 v_exp_f32 v19, v97
M v[152:155], a[88:91], v[40:43], 0
 buffer_load_dwordx4 v4, s[8:11], s24 offen offset:0 sc1 lds
M v[152:155], a[92:95], v[56:59], v[152:155]
 v_exp_f32 v20, v98
M v[156:159], a[92:95], v[60:63], 0
 v_exp_f32 v21, v99
M v[156:159], a[88:91], v[44:47], v[156:159]
 s_waitcnt lgkmcnt(0)
 v_exp_f32 v22, v104
M v[160:163], a[96:99], v[40:43], 0
 ds_read_b128 a[64:67], v2 offset:16384
 ds_read_b128 a[68:71], v2 offset:17408
M v[160:163], a[100:103], v[56:59], v[160:163]
 buffer_load_dwordx4 v4, s[8:11], s24 offen offset:1024 sc1 lds
M v[164:167], a[100:103], v[60:63], 0
 v_exp_f32 v23, v105
M v[164:167], a[96:99], v[44:47], v[164:167]
 ds_read_b128 a[72:75], v2 offset:18432
 ds_read_b128 a[76:79], v2 offset:19456
M v[168:171], a[104:107], v[40:43], 0
 buffer_load_dwordx4 v4, s[8:11], s24 offen offset:2048 sc1 lds
M v[168:171], a[108:111], v[56:59], v[168:171]
 v_add_f32 v31, v27, v31
 v_add_f32 v28, v18, v19
M v[172:175], a[108:111], v[60:63], 0
 ds_read_b128 a[80:83], v2 offset:20480
 ds_read_b128 a[84:87], v2 offset:21504
M v[172:175], a[104:107], v[44:47], v[172:175]
 buffer_load_dwordx4 v4, s[8:11], s24 offen offset:3072 sc1 lds
M v[176:179], a[112:115], v[40:43], 0
 v_exp_f32 v24, v106
M v[176:179], a[116:119], v[56:59], v[176:179]
 s_add_u32 m0, s28, 32768
 ds_read_b128 a[88:91], v2 offset:22528
 ds_read_b128 a[92:95], v2 offset:23552
M v[180:183], a[116:119], v[60:63], 0
 buffer_load_dwordx4 v3, s[8:11], s21 offen offset:0 sc1 lds
M v[180:183], a[112:115], v[44:47], v[180:183]
 v_exp_f32 v25, v107
M v[184:187], a[120:123], v[40:43], 0
 buffer_load_dwordx4 v3, s[8:11], s21 offen offset:1024 sc1 lds
M v[184:187], a[124:127], v[56:59], v[184:187]
 v_cvt_pk_bf16_f32 v48, v18, v19
 v_add_f32 v28, v20, v28
M v[188:191], a[124:127], v[60:63], 0
 buffer_load_dwordx4 v3, s[8:11], s21 offen offset:2048 sc1 lds
M v[188:191], a[120:123], v[44:47], v[188:191]
 s_waitcnt lgkmcnt(0)
 v_exp_f32 v18, v100
M v[192:195], a[64:67], v[40:43], 0
 ds_read_b128 a[96:99], v2 offset:24576
 ds_read_b128 a[100:103], v2 offset:25600
M v[192:195], a[68:71], v[56:59], v[192:195]
 buffer_load_dwordx4 v3, s[8:11], s21 offen offset:3072 sc1 lds
M v[196:199], a[68:71], v[60:63], 0
 v_exp_f32 v19, v101
M v[196:199], a[64:67], v[44:47], v[196:199]
 s_add_u32 m0, s28, 36864
 ds_read_b128 a[104:107], v2 offset:26624
 ds_read_b128 a[108:111], v2 offset:27648
M v[200:203], a[72:75], v[40:43], 0
 buffer_load_dwordx4 v4, s[8:11], s21 offen offset:0 sc1 lds
M v[200:203], a[76:79], v[56:59], v[200:203]
 v_cvt_pk_bf16_f32 v49, v20, v21
 v_add_f32 v28, v21, v28
M v[204:207], a[76:79], v[60:63], 0
 ds_read_b128 a[112:115], v2 offset:28672
 ds_read_b128 a[116:119], v2 offset:29696
M v[204:207], a[72:75], v[44:47], v[204:207]
 buffer_load_dwordx4 v4, s[8:11], s21 offen offset:1024 sc1 lds
M v[208:211], a[80:83], v[40:43], 0
 v_exp_f32 v20, v102
M v[208:211], a[84:87], v[56:59], v[208:211]
 ds_read_b128 a[120:123], v2 offset:30720
 ds_read_b128 a[124:127], v2 offset:31744
M v[212:215], a[84:87], v[60:63], 0
 buffer_load_dwordx4 v4, s[8:11], s21 offen offset:2048 sc1 lds
M v[212:215], a[80:83], v[44:47], v[212:215]
 v_exp_f32 v21, v103
M v[216:219], a[88:91], v[40:43], 0
 v_add_f32 v28, v22, v28
 v_cvt_pk_bf16_f32 v50, v22, v23
M v[216:219], a[92:95], v[56:59], v[216:219]
 buffer_load_dwordx4 v4, s[8:11], s21 offen offset:3072 sc1 lds
M v[220:223], a[92:95], v[60:63], 0
 s_waitcnt vmcnt(16) lgkmcnt(0)
 s_add_u32 s24, s23, 16777216
 s_mov_b32 s23, s21
M v[220:223], a[88:91], v[44:47], v[220:223]
 s_barrier
M v[224:227], a[96:99], v[40:43], 0
 ds_read_b128 a[64:67], v2 offset:32768
 ds_read_b128 a[68:71], v2 offset:33792
M v[224:227], a[100:103], v[56:59], v[224:227]
 s_xor_b32 s3, s47, 64
 v_mov_b32 v5, 1
M v[228:231], a[100:103], v[60:63], 0
 v_min_u32 v6, 1, v7
 v_lshlrev_b32 v6, 29, v6
M v[228:231], a[96:99], v[44:47], v[228:231]
 ds_read_b128 a[72:75], v2 offset:34816
 ds_read_b128 a[76:79], v2 offset:35840
M v[232:235], a[104:107], v[40:43], 0
 v_or_b32 v6, s35, v6
 s_add_u32 s21, s21, 32768
M v[232:235], a[108:111], v[56:59], v[232:235]
 buffer_store_dword v5, v6, s[8:11], s3 offen sc1
M v[236:239], a[108:111], v[60:63], 0
 ds_read_b128 a[80:83], v2 offset:36864
 ds_read_b128 a[84:87], v2 offset:37888
M v[236:239], a[104:107], v[44:47], v[236:239]
 s_add_u32 s22, s22, 1
 v_add_f32 v28, v23, v28
M v[240:243], a[112:115], v[40:43], 0
 s_cmp_eq_u32 s22, s25
 v_exp_f32 v22, v108
M v[240:243], a[116:119], v[56:59], v[240:243]
 s_cselect_b32 s21, s26, s21
 ds_read_b128 a[88:91], v2 offset:38912
 ds_read_b128 a[92:95], v2 offset:39936
M v[244:247], a[116:119], v[60:63], 0
 s_cmp_eq_u32 s22, s43
 v_exp_f32 v23, v109
M v[244:247], a[112:115], v[44:47], v[244:247]
 s_cselect_b32 s21, s4, s21
 v_add_f32 v28, v24, v28
 v_cvt_pk_bf16_f32 v51, v24, v25
M v[248:251], a[120:123], v[40:43], 0
 s_cmp_eq_u32 s22, s6
 v_add_f32 v28, v25, v28
 v_add_f32 v29, v18, v19
M v[248:251], a[124:127], v[56:59], v[248:251]
 s_cselect_b32 s21, s7, s21
 v_exp_f32 v24, v110
M v[252:255], a[124:127], v[60:63], 0
 s_waitcnt lgkmcnt(0)
 v_exp_f32 v25, v111
M v[252:255], a[120:123], v[44:47], v[252:255]
 v_cvt_pk_bf16_f32 v52, v18, v19
 v_add_f32 v29, v20, v29
 v_cvt_pk_bf16_f32 v53, v20, v21
 v_add_f32 v29, v21, v29
 v_add_f32 v29, v22, v29
 v_cvt_pk_bf16_f32 v54, v22, v23
 v_add_f32 v29, v23, v29
 v_add_f32 v29, v24, v29
 v_cvt_pk_bf16_f32 v55, v24, v25
 v_add_f32 v29, v25, v29
M v[64:67], a[64:67], a[0:3], v[32:35]
 s_add_u32 m0, s28, 65536
 ds_read_b128 a[96:99], v2 offset:40960
 ds_read_b128 a[100:103], v2 offset:41984
M v[64:67], a[68:71], a[4:7], v[64:67]
 buffer_load_dwordx4 v3, s[8:11], s24 offen offset:0 sc1 lds
M v[64:67], a[72:75], a[8:11], v[64:67]
 v_exp_f32 v18, v112
M v[64:67], a[76:79], a[12:15], v[64:67]
 s_add_u32 s3, s30, 786432
 ds_read_b128 a[104:107], v2 offset:43008
 ds_read_b128 a[108:111], v2 offset:44032
M v[64:67], a[80:83], a[16:19], v[64:67]
 buffer_store_dwordx4 a[128:131], v7, s[8:11], s3 offen offset:0 sc1
M v[64:67], a[84:87], a[20:23], v[64:67]
 v_exp_f32 v19, v113
M v[64:67], a[88:91], a[24:27], v[64:67]
 ds_read_b128 a[112:115], v2 offset:45056
 ds_read_b128 a[116:119], v2 offset:46080
M v[64:67], a[92:95], a[28:31], v[64:67]
 buffer_load_dwordx4 v3, s[8:11], s24 offen offset:1024 sc1 lds
M v[68:71], a[92:95], a[60:63], v[36:39]
 v_exp_f32 v20, v114
M v[68:71], a[88:91], a[56:59], v[68:71]
 ds_read_b128 a[120:123], v2 offset:47104
 ds_read_b128 a[124:127], v2 offset:48128
M v[68:71], a[84:87], a[52:55], v[68:71]
 v_exp_f32 v21, v115
M v[68:71], a[80:83], a[48:51], v[68:71]
 v_add_f32 v28, v18, v28
 v_cvt_pk_bf16_f32 v56, v18, v19
M v[68:71], a[76:79], a[44:47], v[68:71]
 v_add_f32 v28, v19, v28
 v_add_f32 v28, v20, v28
M v[68:71], a[72:75], a[40:43], v[68:71]
 buffer_load_dwordx4 v3, s[8:11], s24 offen offset:2048 sc1 lds
M v[68:71], a[68:71], a[36:39], v[68:71]
 v_exp_f32 v22, v120
M v[68:71], a[64:67], a[32:35], v[68:71]
 s_waitcnt lgkmcnt(0)
 v_cvt_pk_bf16_f32 v57, v20, v21
 v_add_f32 v28, v21, v28
M v[72:75], a[96:99], a[0:3], v[32:35]
 ds_read_b128 a[64:67], v2 offset:49152
 ds_read_b128 a[68:71], v2 offset:50176
M v[72:75], a[100:103], a[4:7], v[72:75]
 buffer_store_dwordx4 a[132:135], v7, s[8:11], s3 offen offset:1024 sc1
M v[72:75], a[104:107], a[8:11], v[72:75]
 v_exp_f32 v23, v121
M v[72:75], a[108:111], a[12:15], v[72:75]
 ds_read_b128 a[72:75], v2 offset:51200
 ds_read_b128 a[76:79], v2 offset:52224
M v[72:75], a[112:115], a[16:19], v[72:75]
 buffer_load_dwordx4 v3, s[8:11], s24 offen offset:3072 sc1 lds
M v[72:75], a[116:119], a[20:23], v[72:75]
 v_exp_f32 v24, v122
M v[72:75], a[120:123], a[24:27], v[72:75]
 ds_read_b128 a[80:83], v2 offset:53248
 ds_read_b128 a[84:87], v2 offset:54272
M v[72:75], a[124:127], a[28:31], v[72:75]
 v_add_f32 v28, v22, v28
 v_cvt_pk_bf16_f32 v58, v22, v23
M v[76:79], a[124:127], a[60:63], v[36:39]
 v_exp_f32 v25, v123
M v[76:79], a[120:123], a[56:59], v[76:79]
 s_add_u32 m0, s28, 69632
 ds_read_b128 a[88:91], v2 offset:55296
 ds_read_b128 a[92:95], v2 offset:56320
M v[76:79], a[116:119], a[52:55], v[76:79]
 buffer_load_dwordx4 v4, s[8:11], s24 offen offset:0 sc1 lds
M v[76:79], a[112:115], a[48:51], v[76:79]
 v_add_f32 v28, v23, v28
 v_add_f32 v28, v24, v28
M v[76:79], a[108:111], a[44:47], v[76:79]
 v_exp_f32 v18, v116
M v[76:79], a[104:107], a[40:43], v[76:79]
 v_cvt_pk_bf16_f32 v59, v24, v25
 v_add_f32 v28, v25, v28
M v[76:79], a[100:103], a[36:39], v[76:79]
M v[76:79], a[96:99], a[32:35], v[76:79]
 s_waitcnt lgkmcnt(0)
 v_exp_f32 v19, v117
M v[80:83], a[64:67], a[0:3], v[32:35]
 ds_read_b128 a[96:99], v2 offset:57344
 ds_read_b128 a[100:103], v2 offset:58368
M v[80:83], a[68:71], a[4:7], v[80:83]
 buffer_store_dwordx4 a[136:139], v7, s[8:11], s3 offen offset:2048 sc1
M v[80:83], a[72:75], a[8:11], v[80:83]
 v_add_f32 v29, v18, v29
 v_cvt_pk_bf16_f32 v60, v18, v19
M v[80:83], a[76:79], a[12:15], v[80:83]
 ds_read_b128 a[104:107], v2 offset:59392
 ds_read_b128 a[108:111], v2 offset:60416
M v[80:83], a[80:83], a[16:19], v[80:83]
 buffer_load_dwordx4 v4, s[8:11], s24 offen offset:1024 sc1 lds
M v[80:83], a[84:87], a[20:23], v[80:83]
 v_exp_f32 v20, v118
M v[80:83], a[88:91], a[24:27], v[80:83]
 ds_read_b128 a[112:115], v2 offset:61440
 ds_read_b128 a[116:119], v2 offset:62464
M v[80:83], a[92:95], a[28:31], v[80:83]
 buffer_load_dwordx4 v4, s[8:11], s24 offen offset:2048 sc1 lds
M v[84:87], a[92:95], a[60:63], v[36:39]
 v_exp_f32 v21, v119
M v[84:87], a[88:91], a[56:59], v[84:87]
 ds_read_b128 a[120:123], v2 offset:63488
 ds_read_b128 a[124:127], v2 offset:64512
M v[84:87], a[84:87], a[52:55], v[84:87]
 v_exp_f32 v22, v124
M v[84:87], a[80:83], a[48:51], v[84:87]
 buffer_load_dwordx4 v4, s[8:11], s24 offen offset:3072 sc1 lds
M v[84:87], a[76:79], a[44:47], v[84:87]
 v_add_f32 v29, v19, v29
 v_add_f32 v29, v20, v29
M v[84:87], a[72:75], a[40:43], v[84:87]
 buffer_store_dwordx4 a[140:143], v7, s[8:11], s3 offen offset:3072 sc1
M v[84:87], a[68:71], a[36:39], v[84:87]
 s_waitcnt vmcnt(21) lgkmcnt(0)
 v_exp_f32 v23, v125
M v[84:87], a[64:67], a[32:35], v[84:87]
 s_barrier
M v[88:91], a[96:99], a[0:3], v[32:35]
 ds_read_b128 a[64:67], v7 offset:0
 ds_read_b128 a[68:71], v7 offset:1024
M v[88:91], a[100:103], a[4:7], v[88:91]
 v_exp_f32 v24, v126
M v[88:91], a[104:107], a[8:11], v[88:91]
 v_cvt_pk_bf16_f32 v61, v20, v21
 v_add_f32 v29, v21, v29
M v[88:91], a[108:111], a[12:15], v[88:91]
 ds_read_b128 a[72:75], v7 offset:2048
 ds_read_b128 a[76:79], v7 offset:3072
M v[88:91], a[112:115], a[16:19], v[88:91]
 v_exp_f32 v25, v127
M v[88:91], a[116:119], a[20:23], v[88:91]
 v_add_f32 v29, v22, v29
 v_cvt_pk_bf16_f32 v62, v22, v23
M v[88:91], a[120:123], a[24:27], v[88:91]
 ds_read_b128 a[80:83], v7 offset:4096
 ds_read_b128 a[84:87], v7 offset:5120
M v[88:91], a[124:127], a[28:31], v[88:91]
 v_add_f32 v29, v23, v29
 v_add_f32 v29, v24, v29
M v[92:95], a[124:127], a[60:63], v[36:39]
 v_cvt_pk_bf16_f32 v63, v24, v25
 v_add_f32 v29, v25, v29
M v[92:95], a[120:123], a[56:59], v[92:95]
 ds_read_b128 a[88:91], v7 offset:6144
 ds_read_b128 a[92:95], v7 offset:7168
M v[92:95], a[116:119], a[52:55], v[92:95]
 v_max_f32 v10, v28, v29
M v[92:95], a[112:115], a[48:51], v[92:95]
 v_cmp_lt_f32 vcc, s31, v10
M v[92:95], a[108:111], a[44:47], v[92:95]
M v[92:95], a[104:107], a[40:43], v[92:95]
M v[92:95], a[100:103], a[36:39], v[92:95]
 s_waitcnt lgkmcnt(0)
M v[92:95], a[96:99], a[32:35], v[92:95]
 s_cbranch_vccnz L_st9
L_rt9:
M v[128:131], a[64:67], v[48:51], v[128:131]
 s_add_u32 m0, s28, 98304
 ds_read_b128 a[96:99], v7 offset:8192
 ds_read_b128 a[100:103], v7 offset:9216
M v[128:131], a[68:71], v[56:59], v[128:131]
 buffer_load_dwordx4 v3, s[8:11], s21 offen offset:0 sc1 lds
M v[132:135], a[68:71], v[60:63], v[132:135]
 v_exp_f32 v18, v64
M v[132:135], a[64:67], v[52:55], v[132:135]
 s_add_u32 s3, s30, 794624
 ds_read_b128 a[104:107], v7 offset:10240
 ds_read_b128 a[108:111], v7 offset:11264
M v[136:139], a[72:75], v[48:51], v[136:139]
 buffer_store_dwordx4 a[144:147], v7, s[8:11], s3 offen offset:0 sc1
M v[136:139], a[76:79], v[56:59], v[136:139]
 v_exp_f32 v19, v65
M v[140:143], a[76:79], v[60:63], v[140:143]
 ds_read_b128 a[112:115], v7 offset:12288
 ds_read_b128 a[116:119], v7 offset:13312
M v[140:143], a[72:75], v[52:55], v[140:143]
 buffer_load_dwordx4 v3, s[8:11], s21 offen offset:1024 sc1 lds
M v[144:147], a[80:83], v[48:51], v[144:147]
 v_exp_f32 v20, v66
M v[144:147], a[84:87], v[56:59], v[144:147]
 ds_read_b128 a[120:123], v7 offset:14336
 ds_read_b128 a[124:127], v7 offset:15360
M v[148:151], a[84:87], v[60:63], v[148:151]
 v_add_f32 v30, v28, v30
 v_add_f32 v31, v29, v31
M v[148:151], a[80:83], v[52:55], v[148:151]
 buffer_load_dwordx4 v3, s[8:11], s21 offen offset:2048 sc1 lds
M v[152:155], a[88:91], v[48:51], v[152:155]
 v_exp_f32 v21, v67
M v[152:155], a[92:95], v[56:59], v[152:155]
 v_add_f32 v26, v18, v19
 v_cvt_pk_bf16_f32 v40, v18, v19
M v[156:159], a[92:95], v[60:63], v[156:159]
 v_exp_f32 v22, v72
M v[156:159], a[88:91], v[52:55], v[156:159]
 s_waitcnt lgkmcnt(0)
 v_add_f32 v26, v20, v26
 v_cvt_pk_bf16_f32 v41, v20, v21
M v[160:163], a[96:99], v[48:51], v[160:163]
 ds_read_b128 a[64:67], v7 offset:16384
 ds_read_b128 a[68:71], v7 offset:17408
M v[160:163], a[100:103], v[56:59], v[160:163]
 buffer_store_dwordx4 a[148:151], v7, s[8:11], s3 offen offset:1024 sc1
M v[164:167], a[100:103], v[60:63], v[164:167]
 v_exp_f32 v23, v73
M v[164:167], a[96:99], v[52:55], v[164:167]
 ds_read_b128 a[72:75], v7 offset:18432
 ds_read_b128 a[76:79], v7 offset:19456
M v[168:171], a[104:107], v[48:51], v[168:171]
 buffer_load_dwordx4 v3, s[8:11], s21 offen offset:3072 sc1 lds
M v[168:171], a[108:111], v[56:59], v[168:171]
 v_add_f32 v26, v21, v26
 v_add_f32 v26, v22, v26
M v[172:175], a[108:111], v[60:63], v[172:175]
 s_add_u32 m0, s28, 102400
 ds_read_b128 a[80:83], v7 offset:20480
 ds_read_b128 a[84:87], v7 offset:21504
M v[172:175], a[104:107], v[52:55], v[172:175]
 buffer_load_dwordx4 v4, s[8:11], s21 offen offset:0 sc1 lds
M v[176:179], a[112:115], v[48:51], v[176:179]
 v_exp_f32 v24, v74
M v[176:179], a[116:119], v[56:59], v[176:179]
 ds_read_b128 a[88:91], v7 offset:22528
 ds_read_b128 a[92:95], v7 offset:23552
M v[180:183], a[116:119], v[60:63], v[180:183]
 v_exp_f32 v25, v75
M v[180:183], a[112:115], v[52:55], v[180:183]
 buffer_load_dwordx4 v4, s[8:11], s21 offen offset:1024 sc1 lds
M v[184:187], a[120:123], v[48:51], v[184:187]
 v_cvt_pk_bf16_f32 v42, v22, v23
 v_add_f32 v26, v23, v26
M v[184:187], a[124:127], v[56:59], v[184:187]
 v_exp_f32 v18, v68
M v[188:191], a[124:127], v[60:63], v[188:191]
 v_add_f32 v26, v24, v26
 v_cvt_pk_bf16_f32 v43, v24, v25
M v[188:191], a[120:123], v[52:55], v[188:191]
 s_waitcnt lgkmcnt(0)
 v_add_f32 v26, v25, v26
M v[192:195], a[64:67], v[48:51], v[192:195]
 ds_read_b128 a[96:99], v7 offset:24576
 ds_read_b128 a[100:103], v7 offset:25600
M v[192:195], a[68:71], v[56:59], v[192:195]
 buffer_store_dwordx4 a[152:155], v7, s[8:11], s3 offen offset:2048 sc1
M v[196:199], a[68:71], v[60:63], v[196:199]
 v_exp_f32 v19, v69
M v[196:199], a[64:67], v[52:55], v[196:199]
 ds_read_b128 a[104:107], v7 offset:26624
 ds_read_b128 a[108:111], v7 offset:27648
M v[200:203], a[72:75], v[48:51], v[200:203]
 buffer_load_dwordx4 v4, s[8:11], s21 offen offset:2048 sc1 lds
M v[200:203], a[76:79], v[56:59], v[200:203]
 v_exp_f32 v20, v70
M v[204:207], a[76:79], v[60:63], v[204:207]
 ds_read_b128 a[112:115], v7 offset:28672
 ds_read_b128 a[116:119], v7 offset:29696
M v[204:207], a[72:75], v[52:55], v[204:207]
 buffer_load_dwordx4 v4, s[8:11], s21 offen offset:3072 sc1 lds
M v[208:211], a[80:83], v[48:51], v[208:211]
 s_add_u32 s24, s23, 16777216
 v_exp_f32 v21, v71
M v[208:211], a[84:87], v[56:59], v[208:211]
 s_mov_b32 s23, s21
 ds_read_b128 a[120:123], v7 offset:30720
 ds_read_b128 a[124:127], v7 offset:31744
M v[212:215], a[84:87], v[60:63], v[212:215]
 s_add_u32 s21, s21, 32768
 v_add_f32 v27, v18, v19
 v_cvt_pk_bf16_f32 v44, v18, v19
M v[212:215], a[80:83], v[52:55], v[212:215]
 s_add_u32 s22, s22, 1
 v_add_f32 v27, v20, v27
 v_cvt_pk_bf16_f32 v45, v20, v21
M v[216:219], a[88:91], v[48:51], v[216:219]
 s_cmp_eq_u32 s22, s25
 v_exp_f32 v22, v76
M v[216:219], a[92:95], v[56:59], v[216:219]
 buffer_store_dwordx4 a[156:159], v7, s[8:11], s3 offen offset:3072 sc1
M v[220:223], a[92:95], v[60:63], v[220:223]
 s_waitcnt vmcnt(25) lgkmcnt(0)
 v_add_f32 v27, v21, v27
M v[220:223], a[88:91], v[52:55], v[220:223]
 s_barrier
M v[224:227], a[96:99], v[48:51], v[224:227]
 s_cselect_b32 s21, s26, s21
 ds_read_b128 a[64:67], v7 offset:32768
 ds_read_b128 a[68:71], v7 offset:33792
M v[224:227], a[100:103], v[56:59], v[224:227]
 s_cmp_eq_u32 s22, s43
 v_exp_f32 v23, v77
M v[228:231], a[100:103], v[60:63], v[228:231]
 s_cselect_b32 s21, s4, s21
 v_add_f32 v27, v22, v27
 v_cvt_pk_bf16_f32 v46, v22, v23
M v[228:231], a[96:99], v[52:55], v[228:231]
 s_cmp_eq_u32 s22, s6
 ds_read_b128 a[72:75], v7 offset:34816
 ds_read_b128 a[76:79], v7 offset:35840
M v[232:235], a[104:107], v[48:51], v[232:235]
 s_cselect_b32 s21, s7, s21
 v_exp_f32 v24, v78
M v[232:235], a[108:111], v[56:59], v[232:235]
 v_add_f32 v27, v23, v27
M v[236:239], a[108:111], v[60:63], v[236:239]
 ds_read_b128 a[80:83], v7 offset:36864
 ds_read_b128 a[84:87], v7 offset:37888
M v[236:239], a[104:107], v[52:55], v[236:239]
 v_exp_f32 v25, v79
M v[240:243], a[112:115], v[48:51], v[240:243]
 v_add_f32 v27, v24, v27
 v_cvt_pk_bf16_f32 v47, v24, v25
M v[240:243], a[116:119], v[56:59], v[240:243]
 ds_read_b128 a[88:91], v7 offset:38912
 ds_read_b128 a[92:95], v7 offset:39936
M v[244:247], a[116:119], v[60:63], v[244:247]
 v_add_f32 v27, v25, v27
M v[244:247], a[112:115], v[52:55], v[244:247]
M v[248:251], a[120:123], v[48:51], v[248:251]
M v[248:251], a[124:127], v[56:59], v[248:251]
M v[252:255], a[124:127], v[60:63], v[252:255]
 s_waitcnt lgkmcnt(0)
M v[252:255], a[120:123], v[52:55], v[252:255]
M v[96:99], a[64:67], a[0:3], v[32:35]
 s_add_u32 m0, s28, 0
 ds_read_b128 a[96:99], v7 offset:40960
M v[96:99], a[68:71], a[4:7], v[96:99]
 ds_read_b128 a[100:103], v7 offset:41984
M v[96:99], a[72:75], a[8:11], v[96:99]
 buffer_load_dword v6, v9, s[8:11], s46 offen sc1
M v[96:99], a[76:79], a[12:15], v[96:99]
 s_cmp_eq_u32 s20, 0
 ds_read_b128 a[104:107], v7 offset:43008
M v[96:99], a[80:83], a[16:19], v[96:99]
 s_cselect_b64 s[64:65], s[16:17], 0
 ds_read_b128 a[108:111], v7 offset:44032
M v[96:99], a[84:87], a[20:23], v[96:99]
 buffer_load_dwordx4 v3, s[8:11], s24 offen offset:0 sc1 lds
M v[96:99], a[88:91], a[24:27], v[96:99]
 s_cselect_b64 s[66:67], s[18:19], 0
 ds_read_b128 a[112:115], v7 offset:45056
M v[96:99], a[92:95], a[28:31], v[96:99]
 s_cselect_b64 s[68:69], s[48:49], 0
 ds_read_b128 a[116:119], v7 offset:46080
M v[100:103], a[92:95], a[60:63], v[36:39]
 buffer_load_dwordx4 v3, s[8:11], s24 offen offset:1024 sc1 lds
M v[100:103], a[88:91], a[56:59], v[100:103]
 s_cselect_b64 s[70:71], s[50:51], 0
 ds_read_b128 a[120:123], v7 offset:47104
M v[100:103], a[84:87], a[52:55], v[100:103]
 s_cmp_lt_u32 s20, 1
 ds_read_b128 a[124:127], v7 offset:48128
M v[100:103], a[80:83], a[48:51], v[100:103]
 s_cselect_b64 s[78:79], -1, 0
 v_exp_f32 v18, v80
M v[100:103], a[76:79], a[44:47], v[100:103]
 buffer_load_dwordx4 v3, s[8:11], s24 offen offset:2048 sc1 lds
M v[100:103], a[72:75], a[40:43], v[100:103]
 s_cmp_eq_u32 s20, 1
 v_exp_f32 v19, v81
M v[100:103], a[68:71], a[36:39], v[100:103]
 s_cselect_b64 s[72:73], s[16:17], s[78:79]
 v_exp_f32 v20, v82
M v[100:103], a[64:67], a[32:35], v[100:103]
 s_waitcnt lgkmcnt(0)
 v_exp_f32 v21, v83
M v[104:107], a[96:99], a[0:3], v[32:35]
 s_cselect_b64 s[74:75], s[18:19], s[78:79]
 ds_read_b128 a[64:67], v7 offset:49152
 v_add_f32 v26, v18, v26
M v[104:107], a[100:103], a[4:7], v[104:107]
 s_cselect_b64 s[76:77], s[48:49], s[78:79]
 ds_read_b128 a[68:71], v7 offset:50176
 v_cvt_pk_bf16_f32 v56, v18, v19
M v[104:107], a[104:107], a[8:11], v[104:107]
 buffer_load_dwordx4 v3, s[8:11], s24 offen offset:3072 sc1 lds
M v[104:107], a[108:111], a[12:15], v[104:107]
 s_cselect_b64 s[78:79], s[50:51], s[78:79]
 ds_read_b128 a[72:75], v7 offset:51200
 v_add_f32 v26, v19, v26
M v[104:107], a[112:115], a[16:19], v[104:107]
 s_add_u32 s3, s29, 0
 ds_read_b128 a[76:79], v7 offset:52224
 v_add_f32 v26, v20, v26
M v[104:107], a[116:119], a[20:23], v[104:107]
 buffer_store_dwordx4 a[192:195], v7, s[8:11], s3 offen sc1
M v[104:107], a[120:123], a[24:27], v[104:107]
 s_add_u32 m0, s28, 4096
 ds_read_b128 a[80:83], v7 offset:53248
 v_cvt_pk_bf16_f32 v57, v20, v21
M v[104:107], a[124:127], a[28:31], v[104:107]
 ds_read_b128 a[84:87], v7 offset:54272
 v_add_f32 v26, v21, v26
M v[108:111], a[124:127], a[60:63], v[36:39]
 buffer_load_dwordx4 v4, s[8:11], s24 offen offset:0 sc1 lds
M v[108:111], a[120:123], a[56:59], v[108:111]
 ds_read_b128 a[88:91], v7 offset:55296
M v[108:111], a[116:119], a[52:55], v[108:111]
 ds_read_b128 a[92:95], v7 offset:56320
M v[108:111], a[112:115], a[48:51], v[108:111]
 v_exp_f32 v22, v88
M v[108:111], a[108:111], a[44:47], v[108:111]
 buffer_load_dwordx4 v4, s[8:11], s24 offen offset:1024 sc1 lds
M v[108:111], a[104:107], a[40:43], v[108:111]
 v_exp_f32 v23, v89
M v[108:111], a[100:103], a[36:39], v[108:111]
 v_exp_f32 v24, v90
M v[108:111], a[96:99], a[32:35], v[108:111]
 s_waitcnt lgkmcnt(0)
 v_exp_f32 v25, v91
M v[112:115], a[64:67], a[0:3], v[32:35]
 s_add_u32 s3, s29, 32768
 ds_read_b128 a[96:99], v7 offset:57344
 v_add_f32 v26, v22, v26
M v[112:115], a[68:71], a[4:7], v[112:115]
 ds_read_b128 a[100:103], v7 offset:58368
 v_cvt_pk_bf16_f32 v58, v22, v23
M v[112:115], a[72:75], a[8:11], v[112:115]
 buffer_load_dwordx4 v4, s[8:11], s24 offen offset:2048 sc1 lds
M v[112:115], a[76:79], a[12:15], v[112:115]
 ds_read_b128 a[104:107], v7 offset:59392
 v_add_f32 v26, v23, v26
M v[112:115], a[80:83], a[16:19], v[112:115]
 ds_read_b128 a[108:111], v7 offset:60416
 v_add_f32 v26, v24, v26
M v[112:115], a[84:87], a[20:23], v[112:115]
 buffer_store_dwordx4 a[196:199], v7, s[8:11], s3 offen sc1
M v[112:115], a[88:91], a[24:27], v[112:115]
 ds_read_b128 a[112:115], v7 offset:61440
 v_cvt_pk_bf16_f32 v59, v24, v25
M v[112:115], a[92:95], a[28:31], v[112:115]
 ds_read_b128 a[116:119], v7 offset:62464
 v_add_f32 v26, v25, v26
M v[116:119], a[92:95], a[60:63], v[36:39]
 buffer_load_dwordx4 v4, s[8:11], s24 offen offset:3072 sc1 lds
M v[116:119], a[88:91], a[56:59], v[116:119]
 ds_read_b128 a[120:123], v7 offset:63488
M v[116:119], a[84:87], a[52:55], v[116:119]
 ds_read_b128 a[124:127], v7 offset:64512
M v[116:119], a[80:83], a[48:51], v[116:119]
 v_exp_f32 v18, v84
M v[116:119], a[76:79], a[44:47], v[116:119]
 v_exp_f32 v19, v85
M v[116:119], a[72:75], a[40:43], v[116:119]
 v_exp_f32 v20, v86
M v[116:119], a[68:71], a[36:39], v[116:119]
 s_waitcnt vmcnt(24) lgkmcnt(0)
 v_exp_f32 v21, v87
M v[116:119], a[64:67], a[32:35], v[116:119]
 s_barrier
M v[120:123], a[96:99], a[0:3], v[32:35]
 ds_read_b128 a[64:67], v2 offset:0
 v_add_f32 v27, v18, v27
M v[120:123], a[100:103], a[4:7], v[120:123]
 ds_read_b128 a[68:71], v2 offset:1024
 v_cvt_pk_bf16_f32 v60, v18, v19
M v[120:123], a[104:107], a[8:11], v[120:123]
 v_exp_f32 v22, v92
M v[120:123], a[108:111], a[12:15], v[120:123]
 ds_read_b128 a[72:75], v2 offset:2048
 v_add_f32 v27, v19, v27
M v[120:123], a[112:115], a[16:19], v[120:123]
 ds_read_b128 a[76:79], v2 offset:3072
 v_add_f32 v27, v20, v27
M v[120:123], a[116:119], a[20:23], v[120:123]
 v_exp_f32 v23, v93
M v[120:123], a[120:123], a[24:27], v[120:123]
 ds_read_b128 a[80:83], v2 offset:4096
 v_cvt_pk_bf16_f32 v61, v20, v21
M v[120:123], a[124:127], a[28:31], v[120:123]
 ds_read_b128 a[84:87], v2 offset:5120
 v_add_f32 v27, v21, v27
M v[124:127], a[124:127], a[60:63], v[36:39]
 v_exp_f32 v24, v94
M v[124:127], a[120:123], a[56:59], v[124:127]
 ds_read_b128 a[88:91], v2 offset:6144
 v_add_f32 v27, v22, v27
M v[124:127], a[116:119], a[52:55], v[124:127]
 ds_read_b128 a[92:95], v2 offset:7168
 v_cvt_pk_bf16_f32 v62, v22, v23
M v[124:127], a[112:115], a[48:51], v[124:127]
 v_exp_f32 v25, v95
M v[124:127], a[108:111], a[44:47], v[124:127]
 v_add_f32 v27, v23, v27
 v_add_f32 v27, v24, v27
M v[124:127], a[104:107], a[40:43], v[124:127]
 v_cvt_pk_bf16_f32 v63, v24, v25
 v_add_f32 v27, v25, v27
M v[124:127], a[100:103], a[36:39], v[124:127]
 s_waitcnt lgkmcnt(0)
M v[124:127], a[96:99], a[32:35], v[124:127]
 v_max_f32 v10, v26, v27
 v_cmp_lt_f32 vcc, s31, v10
 s_nop 0
 s_cbranch_vccnz L_st12
L_rt12:
M v[128:131], a[64:67], v[40:43], v[128:131]
 s_add_u32 m0, s28, 32768
 ds_read_b128 a[96:99], v2 offset:8192
 v_add_f32 v30, v26, v30
M v[128:131], a[68:71], v[56:59], v[128:131]
 ds_read_b128 a[100:103], v2 offset:9216
 v_add_f32 v31, v27, v31
M v[132:135], a[68:71], v[60:63], v[132:135]
 buffer_load_dwordx4 v3, s[8:11], s21 offen offset:0 sc1 lds
M v[132:135], a[64:67], v[44:47], v[132:135]
 s_add_u32 s3, s29, 65536
 ds_read_b128 a[104:107], v2 offset:10240
M v[136:139], a[72:75], v[40:43], v[136:139]
 ds_read_b128 a[108:111], v2 offset:11264
M v[136:139], a[76:79], v[56:59], v[136:139]
 buffer_load_dwordx4 v3, s[8:11], s21 offen offset:1024 sc1 lds
M v[140:143], a[76:79], v[60:63], v[140:143]
 ds_read_b128 a[112:115], v2 offset:12288
M v[140:143], a[72:75], v[44:47], v[140:143]
 ds_read_b128 a[116:119], v2 offset:13312
M v[144:147], a[80:83], v[40:43], v[144:147]
 buffer_store_dwordx4 a[200:203], v7, s[8:11], s3 offen sc1
M v[144:147], a[84:87], v[56:59], v[144:147]
 ds_read_b128 a[120:123], v2 offset:14336
M v[148:151], a[84:87], v[60:63], v[148:151]
 ds_read_b128 a[124:127], v2 offset:15360
M v[148:151], a[80:83], v[44:47], v[148:151]
 buffer_load_dwordx4 v3, s[8:11], s21 offen offset:2048 sc1 lds
M v[152:155], a[88:91], v[40:43], v[152:155]
 v_exp_f32 v18, v96
M v[152:155], a[92:95], v[56:59], v[152:155]
 v_exp_f32 v19, v97
M v[156:159], a[92:95], v[60:63], v[156:159]
 buffer_load_dwordx4 v3, s[8:11], s21 offen offset:3072 sc1 lds
M v[156:159], a[88:91], v[44:47], v[156:159]
 s_waitcnt lgkmcnt(0)
 v_exp_f32 v20, v98
M v[160:163], a[96:99], v[40:43], v[160:163]
 ds_read_b128 a[64:67], v2 offset:16384
 v_add_f32 v28, v18, v19
M v[160:163], a[100:103], v[56:59], v[160:163]
 s_add_u32 m0, s28, 36864
 ds_read_b128 a[68:71], v2 offset:17408
 v_cvt_pk_bf16_f32 v48, v18, v19
M v[164:167], a[100:103], v[60:63], v[164:167]
 buffer_load_dwordx4 v4, s[8:11], s21 offen offset:0 sc1 lds
M v[164:167], a[96:99], v[44:47], v[164:167]
 ds_read_b128 a[72:75], v2 offset:18432
M v[168:171], a[104:107], v[40:43], v[168:171]
 ds_read_b128 a[76:79], v2 offset:19456
M v[168:171], a[108:111], v[56:59], v[168:171]
 v_exp_f32 v21, v99
M v[172:175], a[108:111], v[60:63], v[172:175]
 ds_read_b128 a[80:83], v2 offset:20480
 v_add_f32 v28, v20, v28
M v[172:175], a[104:107], v[44:47], v[172:175]
 s_add_u32 s3, s29, 98304
 ds_read_b128 a[84:87], v2 offset:21504
 v_cvt_pk_bf16_f32 v49, v20, v21
M v[176:179], a[112:115], v[40:43], v[176:179]
 buffer_load_dwordx4 v4, s[8:11], s21 offen offset:1024 sc1 lds
M v[176:179], a[116:119], v[56:59], v[176:179]
 ds_read_b128 a[88:91], v2 offset:22528
 v_add_f32 v28, v21, v28
M v[180:183], a[116:119], v[60:63], v[180:183]
 ds_read_b128 a[92:95], v2 offset:23552
M v[180:183], a[112:115], v[44:47], v[180:183]
 buffer_load_dwordx4 v4, s[8:11], s21 offen offset:2048 sc1 lds
M v[184:187], a[120:123], v[40:43], v[184:187]
 buffer_store_dwordx4 a[204:207], v7, s[8:11], s3 offen sc1
M v[184:187], a[124:127], v[56:59], v[184:187]
 v_exp_f32 v22, v104
M v[188:191], a[124:127], v[60:63], v[188:191]
 v_exp_f32 v23, v105
M v[188:191], a[120:123], v[44:47], v[188:191]
 s_waitcnt lgkmcnt(0)
 v_exp_f32 v24, v106
M v[192:195], a[64:67], v[40:43], v[192:195]
 ds_read_b128 a[96:99], v2 offset:24576
 v_add_f32 v28, v22, v28
M v[192:195], a[68:71], v[56:59], v[192:195]
 ds_read_b128 a[100:103], v2 offset:25600
 v_cvt_pk_bf16_f32 v50, v22, v23
M v[196:199], a[68:71], v[60:63], v[196:199]
 buffer_load_dwordx4 v4, s[8:11], s21 offen offset:3072 sc1 lds
M v[196:199], a[64:67], v[44:47], v[196:199]
 s_add_u32 s24, s23, 16777216
 ds_read_b128 a[104:107], v2 offset:26624
 v_add_f32 v28, v23, v28
M v[200:203], a[72:75], v[40:43], v[200:203]
 s_mov_b32 s23, s21
 ds_read_b128 a[108:111], v2 offset:27648
M v[200:203], a[76:79], v[56:59], v[200:203]
 s_add_u32 s21, s21, 32768
 v_exp_f32 v25, v107
M v[204:207], a[76:79], v[60:63], v[204:207]
 s_add_u32 s22, s22, 1
 ds_read_b128 a[112:115], v2 offset:28672
 v_add_f32 v28, v24, v28
M v[204:207], a[72:75], v[44:47], v[204:207]
 s_cmp_eq_u32 s22, s25
 ds_read_b128 a[116:119], v2 offset:29696
 v_cvt_pk_bf16_f32 v51, v24, v25
M v[208:211], a[80:83], v[40:43], v[208:211]
 s_cselect_b32 s21, s26, s21
 v_exp_f32 v18, v100
M v[208:211], a[84:87], v[56:59], v[208:211]
 s_cmp_eq_u32 s22, s43
 ds_read_b128 a[120:123], v2 offset:30720
 v_add_f32 v28, v25, v28
M v[212:215], a[84:87], v[60:63], v[212:215]
 s_cselect_b32 s21, s4, s21
 ds_read_b128 a[124:127], v2 offset:31744
M v[212:215], a[80:83], v[44:47], v[212:215]
 s_cmp_eq_u32 s22, s6
 v_exp_f32 v19, v101
M v[216:219], a[88:91], v[40:43], v[216:219]
 s_cselect_b32 s21, s7, s21
 v_exp_f32 v20, v102
M v[216:219], a[92:95], v[56:59], v[216:219]
 v_exp_f32 v21, v103
M v[220:223], a[92:95], v[60:63], v[220:223]
 s_waitcnt vmcnt(21) lgkmcnt(0)
 v_exp_f32 v22, v108
M v[220:223], a[88:91], v[44:47], v[220:223]
 s_barrier
M v[224:227], a[96:99], v[40:43], v[224:227]
 ds_read_b128 a[64:67], v2 offset:32768
 v_add_f32 v29, v18, v19
M v[224:227], a[100:103], v[56:59], v[224:227]
 ds_read_b128 a[68:71], v2 offset:33792
 v_mov_b32 v17, 4
M v[228:231], a[100:103], v[60:63], v[228:231]
 s_waitcnt vmcnt(20)
 v_cmp_gt_u32 vcc, 3, v6
 v_cvt_pk_bf16_f32 v52, v18, v19
M v[228:231], a[96:99], v[44:47], v[228:231]
 ds_read_b128 a[72:75], v2 offset:34816
 v_add_f32 v29, v20, v29
M v[232:235], a[104:107], v[40:43], v[232:235]
 ds_read_b128 a[76:79], v2 offset:35840
 v_cvt_pk_bf16_f32 v53, v20, v21
M v[232:235], a[108:111], v[56:59], v[232:235]
 s_cbranch_vccnz L_f4s
L_f4r:
 v_exp_f32 v23, v109
M v[236:239], a[108:111], v[60:63], v[236:239]
 ds_read_b128 a[80:83], v2 offset:36864
 v_add_f32 v29, v21, v29
M v[236:239], a[104:107], v[44:47], v[236:239]
 ds_read_b128 a[84:87], v2 offset:37888
 v_add_f32 v29, v22, v29
M v[240:243], a[112:115], v[40:43], v[240:243]
 buffer_store_dword v17, v1, s[8:11], s45 offen sc1
M v[240:243], a[116:119], v[56:59], v[240:243]
 ds_read_b128 a[88:91], v2 offset:38912
 v_cvt_pk_bf16_f32 v54, v22, v23
M v[244:247], a[116:119], v[60:63], v[244:247]
 ds_read_b128 a[92:95], v2 offset:39936
 v_add_f32 v29, v23, v29
M v[244:247], a[112:115], v[44:47], v[244:247]
 v_exp_f32 v24, v110
M v[248:251], a[120:123], v[40:43], v[248:251]
 v_exp_f32 v25, v111
M v[248:251], a[124:127], v[56:59], v[248:251]
 v_add_f32 v29, v24, v29
 v_cvt_pk_bf16_f32 v55, v24, v25
M v[252:255], a[124:127], v[60:63], v[252:255]
 s_waitcnt lgkmcnt(0)
 v_add_f32 v29, v25, v29
M v[252:255], a[120:123], v[44:47], v[252:255]
M v[64:67], a[64:67], a[0:3], v[32:35]
 s_add_u32 m0, s28, 65536
 ds_read_b128 a[96:99], v2 offset:40960
M v[64:67], a[68:71], a[4:7], v[64:67]
 ds_read_b128 a[100:103], v2 offset:41984
M v[64:67], a[72:75], a[8:11], v[64:67]
 buffer_load_dwordx4 v3, s[8:11], s24 offen offset:0 sc1 lds
M v[64:67], a[76:79], a[12:15], v[64:67]
 s_cmp_lt_u32 s20, 2
 ds_read_b128 a[104:107], v2 offset:43008
M v[64:67], a[80:83], a[16:19], v[64:67]
 s_cselect_b64 s[86:87], -1, 0
 ds_read_b128 a[108:111], v2 offset:44032
M v[64:67], a[84:87], a[20:23], v[64:67]
 s_cmp_eq_u32 s20, 2
 v_exp_f32 v18, v112
M v[64:67], a[88:91], a[24:27], v[64:67]
 s_cselect_b64 s[80:81], s[16:17], s[86:87]
 ds_read_b128 a[112:115], v2 offset:45056
M v[64:67], a[92:95], a[28:31], v[64:67]
 s_cselect_b64 s[82:83], s[18:19], s[86:87]
 ds_read_b128 a[116:119], v2 offset:46080
M v[68:71], a[92:95], a[60:63], v[36:39]
 buffer_load_dwordx4 v3, s[8:11], s24 offen offset:1024 sc1 lds
M v[68:71], a[88:91], a[56:59], v[68:71]
 s_cselect_b64 s[84:85], s[48:49], s[86:87]
 ds_read_b128 a[120:123], v2 offset:47104
M v[68:71], a[84:87], a[52:55], v[68:71]
 s_cselect_b64 s[86:87], s[50:51], s[86:87]
 ds_read_b128 a[124:127], v2 offset:48128
M v[68:71], a[80:83], a[48:51], v[68:71]
 s_cmp_eq_u32 s20, 3
 v_exp_f32 v19, v113
M v[68:71], a[76:79], a[44:47], v[68:71]
 buffer_load_dwordx4 v3, s[8:11], s24 offen offset:2048 sc1 lds
M v[68:71], a[72:75], a[40:43], v[68:71]
 s_cselect_b64 s[88:89], s[16:17], -1
 v_exp_f32 v20, v114
M v[68:71], a[68:71], a[36:39], v[68:71]
 s_cselect_b64 s[90:91], s[18:19], -1
 v_exp_f32 v21, v115
M v[68:71], a[64:67], a[32:35], v[68:71]
 s_waitcnt lgkmcnt(0)
 v_exp_f32 v22, v120
M v[72:75], a[96:99], a[0:3], v[32:35]
 s_cselect_b64 s[92:93], s[48:49], -1
 ds_read_b128 a[64:67], v2 offset:49152
 v_add_f32 v28, v18, v28
M v[72:75], a[100:103], a[4:7], v[72:75]
 s_cselect_b64 s[94:95], s[50:51], -1
 ds_read_b128 a[68:71], v2 offset:50176
 v_cvt_pk_bf16_f32 v56, v18, v19
M v[72:75], a[104:107], a[8:11], v[72:75]
 buffer_load_dwordx4 v3, s[8:11], s24 offen offset:3072 sc1 lds
M v[72:75], a[108:111], a[12:15], v[72:75]
 s_add_u32 s3, s29, 131072
 ds_read_b128 a[72:75], v2 offset:51200
 v_add_f32 v28, v19, v28
M v[72:75], a[112:115], a[16:19], v[72:75]
 ds_read_b128 a[76:79], v2 offset:52224
 v_add_f32 v28, v20, v28
M v[72:75], a[116:119], a[20:23], v[72:75]
 buffer_store_dwordx4 a[208:211], v7, s[8:11], s3 offen sc1
M v[72:75], a[120:123], a[24:27], v[72:75]
 s_add_u32 m0, s28, 69632
 ds_read_b128 a[80:83], v2 offset:53248
 v_cvt_pk_bf16_f32 v57, v20, v21
M v[72:75], a[124:127], a[28:31], v[72:75]
 ds_read_b128 a[84:87], v2 offset:54272
 v_add_f32 v28, v21, v28
M v[76:79], a[124:127], a[60:63], v[36:39]
 buffer_load_dwordx4 v4, s[8:11], s24 offen offset:0 sc1 lds
M v[76:79], a[120:123], a[56:59], v[76:79]
 ds_read_b128 a[88:91], v2 offset:55296
M v[76:79], a[116:119], a[52:55], v[76:79]
 ds_read_b128 a[92:95], v2 offset:56320
M v[76:79], a[112:115], a[48:51], v[76:79]
 v_exp_f32 v23, v121
M v[76:79], a[108:111], a[44:47], v[76:79]
 buffer_load_dwordx4 v4, s[8:11], s24 offen offset:1024 sc1 lds
M v[76:79], a[104:107], a[40:43], v[76:79]
 v_exp_f32 v24, v122
M v[76:79], a[100:103], a[36:39], v[76:79]
 s_add_u32 s3, s29, 163840
 v_exp_f32 v25, v123
M v[76:79], a[96:99], a[32:35], v[76:79]
 s_waitcnt lgkmcnt(0)
 v_exp_f32 v18, v116
M v[80:83], a[64:67], a[0:3], v[32:35]
 ds_read_b128 a[96:99], v2 offset:57344
 v_add_f32 v28, v22, v28
M v[80:83], a[68:71], a[4:7], v[80:83]
 ds_read_b128 a[100:103], v2 offset:58368
 v_cvt_pk_bf16_f32 v58, v22, v23
M v[80:83], a[72:75], a[8:11], v[80:83]
 buffer_load_dwordx4 v4, s[8:11], s24 offen offset:2048 sc1 lds
M v[80:83], a[76:79], a[12:15], v[80:83]
 ds_read_b128 a[104:107], v2 offset:59392
 v_add_f32 v28, v23, v28
M v[80:83], a[80:83], a[16:19], v[80:83]
 ds_read_b128 a[108:111], v2 offset:60416
 v_add_f32 v28, v24, v28
M v[80:83], a[84:87], a[20:23], v[80:83]
 buffer_store_dwordx4 a[212:215], v7, s[8:11], s3 offen sc1
M v[80:83], a[88:91], a[24:27], v[80:83]
 ds_read_b128 a[112:115], v2 offset:61440
 v_cvt_pk_bf16_f32 v59, v24, v25
M v[80:83], a[92:95], a[28:31], v[80:83]
 ds_read_b128 a[116:119], v2 offset:62464
 v_add_f32 v28, v25, v28
M v[84:87], a[92:95], a[60:63], v[36:39]
 buffer_load_dwordx4 v4, s[8:11], s24 offen offset:3072 sc1 lds
M v[84:87], a[88:91], a[56:59], v[84:87]
 ds_read_b128 a[120:123], v2 offset:63488
M v[84:87], a[84:87], a[52:55], v[84:87]
 ds_read_b128 a[124:127], v2 offset:64512
M v[84:87], a[80:83], a[48:51], v[84:87]
 v_exp_f32 v19, v117
M v[84:87], a[76:79], a[44:47], v[84:87]
 v_exp_f32 v20, v118
M v[84:87], a[72:75], a[40:43], v[84:87]
 v_exp_f32 v21, v119
M v[84:87], a[68:71], a[36:39], v[84:87]
 s_waitcnt vmcnt(21) lgkmcnt(0)
 v_exp_f32 v22, v124
M v[84:87], a[64:67], a[32:35], v[84:87]
 s_barrier
M v[88:91], a[96:99], a[0:3], v[32:35]
 ds_read_b128 a[64:67], v7 offset:0
 v_add_f32 v29, v18, v29
M v[88:91], a[100:103], a[4:7], v[88:91]
 ds_read_b128 a[68:71], v7 offset:1024
 v_cvt_pk_bf16_f32 v60, v18, v19
M v[88:91], a[104:107], a[8:11], v[88:91]
 v_exp_f32 v23, v125
M v[88:91], a[108:111], a[12:15], v[88:91]
 ds_read_b128 a[72:75], v7 offset:2048
 v_add_f32 v29, v19, v29
M v[88:91], a[112:115], a[16:19], v[88:91]
 ds_read_b128 a[76:79], v7 offset:3072
 v_add_f32 v29, v20, v29
M v[88:91], a[116:119], a[20:23], v[88:91]
 v_exp_f32 v24, v126
M v[88:91], a[120:123], a[24:27], v[88:91]
 ds_read_b128 a[80:83], v7 offset:4096
 v_cvt_pk_bf16_f32 v61, v20, v21
M v[88:91], a[124:127], a[28:31], v[88:91]
 ds_read_b128 a[84:87], v7 offset:5120
 v_add_f32 v29, v21, v29
M v[92:95], a[124:127], a[60:63], v[36:39]
 v_exp_f32 v25, v127
M v[92:95], a[120:123], a[56:59], v[92:95]
 ds_read_b128 a[88:91], v7 offset:6144
 v_add_f32 v29, v22, v29
M v[92:95], a[116:119], a[52:55], v[92:95]
 ds_read_b128 a[92:95], v7 offset:7168
 v_cvt_pk_bf16_f32 v62, v22, v23
M v[92:95], a[112:115], a[48:51], v[92:95]
 v_add_f32 v29, v23, v29
 v_add_f32 v29, v24, v29
M v[92:95], a[108:111], a[44:47], v[92:95]
 v_cvt_pk_bf16_f32 v63, v24, v25
 v_add_f32 v29, v25, v29
M v[92:95], a[104:107], a[40:43], v[92:95]
M v[92:95], a[100:103], a[36:39], v[92:95]
 s_waitcnt lgkmcnt(0)
M v[92:95], a[96:99], a[32:35], v[92:95]
 v_max_f32 v10, v28, v29
 v_cmp_lt_f32 vcc, s31, v10
 s_nop 0
 s_cbranch_vccnz L_st13
L_rt13:
M v[128:131], a[64:67], v[48:51], v[128:131]
 s_add_u32 m0, s28, 98304
 ds_read_b128 a[96:99], v7 offset:8192
 v_add_f32 v30, v28, v30
M v[128:131], a[68:71], v[56:59], v[128:131]
 s_add_u32 s3, s29, 196608
 ds_read_b128 a[100:103], v7 offset:9216
 v_add_f32 v31, v29, v31
M v[132:135], a[68:71], v[60:63], v[132:135]
 buffer_load_dwordx4 v3, s[8:11], s21 offen offset:0 sc1 lds
M v[132:135], a[64:67], v[52:55], v[132:135]
 ds_read_b128 a[104:107], v7 offset:10240
M v[136:139], a[72:75], v[48:51], v[136:139]
 ds_read_b128 a[108:111], v7 offset:11264
M v[136:139], a[76:79], v[56:59], v[136:139]
 buffer_load_dwordx4 v3, s[8:11], s21 offen offset:1024 sc1 lds
M v[140:143], a[76:79], v[60:63], v[140:143]
 ds_read_b128 a[112:115], v7 offset:12288
M v[140:143], a[72:75], v[52:55], v[140:143]
 ds_read_b128 a[116:119], v7 offset:13312
M v[144:147], a[80:83], v[48:51], v[144:147]
 buffer_store_dwordx4 a[216:219], v7, s[8:11], s3 offen sc1
M v[144:147], a[84:87], v[56:59], v[144:147]
 ds_read_b128 a[120:123], v7 offset:14336
M v[148:151], a[84:87], v[60:63], v[148:151]
 ds_read_b128 a[124:127], v7 offset:15360
M v[148:151], a[80:83], v[52:55], v[148:151]
 buffer_load_dwordx4 v3, s[8:11], s21 offen offset:2048 sc1 lds
M v[152:155], a[88:91], v[48:51], v[152:155]
 v_exp_f32 v18, v64
M v[152:155], a[92:95], v[56:59], v[152:155]
 v_exp_f32 v19, v65
M v[156:159], a[92:95], v[60:63], v[156:159]
 buffer_load_dwordx4 v3, s[8:11], s21 offen offset:3072 sc1 lds
M v[156:159], a[88:91], v[52:55], v[156:159]
 s_waitcnt lgkmcnt(0)
 v_exp_f32 v20, v66
M v[160:163], a[96:99], v[48:51], v[160:163]
 ds_read_b128 a[64:67], v7 offset:16384
 v_add_f32 v26, v18, v19
M v[160:163], a[100:103], v[56:59], v[160:163]
 s_add_u32 m0, s28, 102400
 ds_read_b128 a[68:71], v7 offset:17408
 v_cvt_pk_bf16_f32 v40, v18, v19
M v[164:167], a[100:103], v[60:63], v[164:167]
 buffer_load_dwordx4 v4, s[8:11], s21 offen offset:0 sc1 lds
M v[164:167], a[96:99], v[52:55], v[164:167]
 ds_read_b128 a[72:75], v7 offset:18432
M v[168:171], a[104:107], v[48:51], v[168:171]
 ds_read_b128 a[76:79], v7 offset:19456
M v[168:171], a[108:111], v[56:59], v[168:171]
 v_exp_f32 v21, v67
M v[172:175], a[108:111], v[60:63], v[172:175]
 ds_read_b128 a[80:83], v7 offset:20480
 v_add_f32 v26, v20, v26
M v[172:175], a[104:107], v[52:55], v[172:175]
 ds_read_b128 a[84:87], v7 offset:21504
 v_cvt_pk_bf16_f32 v41, v20, v21
M v[176:179], a[112:115], v[48:51], v[176:179]
 buffer_load_dwordx4 v4, s[8:11], s21 offen offset:1024 sc1 lds
M v[176:179], a[116:119], v[56:59], v[176:179]
 ds_read_b128 a[88:91], v7 offset:22528
 v_add_f32 v26, v21, v26
M v[180:183], a[116:119], v[60:63], v[180:183]
 ds_read_b128 a[92:95], v7 offset:23552
M v[180:183], a[112:115], v[52:55], v[180:183]
 buffer_load_dwordx4 v4, s[8:11], s21 offen offset:2048 sc1 lds
M v[184:187], a[120:123], v[48:51], v[184:187]
 v_exp_f32 v22, v72
M v[184:187], a[124:127], v[56:59], v[184:187]
 v_exp_f32 v23, v73
M v[188:191], a[124:127], v[60:63], v[188:191]
 v_exp_f32 v24, v74
M v[188:191], a[120:123], v[52:55], v[188:191]
 s_waitcnt lgkmcnt(0)
 v_exp_f32 v25, v75
M v[192:195], a[64:67], v[48:51], v[192:195]
 ds_read_b128 a[96:99], v7 offset:24576
 v_add_f32 v26, v22, v26
M v[192:195], a[68:71], v[56:59], v[192:195]
 ds_read_b128 a[100:103], v7 offset:25600
 v_cvt_pk_bf16_f32 v42, v22, v23
M v[196:199], a[68:71], v[60:63], v[196:199]
 buffer_load_dwordx4 v4, s[8:11], s21 offen offset:3072 sc1 lds
M v[196:199], a[64:67], v[52:55], v[196:199]
 s_add_u32 s24, s23, 16777216
 ds_read_b128 a[104:107], v7 offset:26624
 v_add_f32 v26, v23, v26
M v[200:203], a[72:75], v[48:51], v[200:203]
 s_mov_b32 s23, s21
 ds_read_b128 a[108:111], v7 offset:27648
 v_add_f32 v26, v24, v26
M v[200:203], a[76:79], v[56:59], v[200:203]
 s_add_u32 s21, s21, 32768
 v_exp_f32 v18, v68
M v[204:207], a[76:79], v[60:63], v[204:207]
 s_add_u32 s22, s22, 1
 ds_read_b128 a[112:115], v7 offset:28672
 v_cvt_pk_bf16_f32 v43, v24, v25
M v[204:207], a[72:75], v[52:55], v[204:207]
 s_cmp_eq_u32 s22, s25
 ds_read_b128 a[116:119], v7 offset:29696
 v_add_f32 v26, v25, v26
M v[208:211], a[80:83], v[48:51], v[208:211]
 s_cselect_b32 s21, s26, s21
 v_exp_f32 v19, v69
M v[208:211], a[84:87], v[56:59], v[208:211]
 s_cmp_eq_u32 s22, s43
 ds_read_b128 a[120:123], v7 offset:30720
 v_add_f32 v27, v18, v19
M v[212:215], a[84:87], v[60:63], v[212:215]
 s_cselect_b32 s21, s4, s21
 ds_read_b128 a[124:127], v7 offset:31744
 v_cvt_pk_bf16_f32 v44, v18, v19
M v[212:215], a[80:83], v[52:55], v[212:215]
 s_cmp_eq_u32 s22, s6
 v_exp_f32 v20, v70
M v[216:219], a[88:91], v[48:51], v[216:219]
 s_cselect_b32 s21, s7, s21
 v_exp_f32 v21, v71
M v[216:219], a[92:95], v[56:59], v[216:219]
 v_exp_f32 v22, v76
M v[220:223], a[92:95], v[60:63], v[220:223]
 s_waitcnt vmcnt(20) lgkmcnt(0)
 v_add_f32 v27, v20, v27
 v_cvt_pk_bf16_f32 v45, v20, v21
M v[220:223], a[88:91], v[52:55], v[220:223]
 s_barrier
M v[224:227], a[96:99], v[48:51], v[224:227]
 ds_read_b128 a[64:67], v7 offset:32768
 v_add_f32 v27, v21, v27
M v[224:227], a[100:103], v[56:59], v[224:227]
 ds_read_b128 a[68:71], v7 offset:33792
M v[228:231], a[100:103], v[60:63], v[228:231]
 v_exp_f32 v23, v77
M v[228:231], a[96:99], v[52:55], v[228:231]
 ds_read_b128 a[72:75], v7 offset:34816
 v_add_f32 v27, v22, v27
M v[232:235], a[104:107], v[48:51], v[232:235]
 ds_read_b128 a[76:79], v7 offset:35840
 v_cvt_pk_bf16_f32 v46, v22, v23
M v[232:235], a[108:111], v[56:59], v[232:235]
 v_exp_f32 v24, v78
M v[236:239], a[108:111], v[60:63], v[236:239]
 ds_read_b128 a[80:83], v7 offset:36864
 v_add_f32 v27, v23, v27
M v[236:239], a[104:107], v[52:55], v[236:239]
 ds_read_b128 a[84:87], v7 offset:37888
M v[240:243], a[112:115], v[48:51], v[240:243]
 v_exp_f32 v25, v79
M v[240:243], a[116:119], v[56:59], v[240:243]
 ds_read_b128 a[88:91], v7 offset:38912
 v_add_f32 v27, v24, v27
M v[244:247], a[116:119], v[60:63], v[244:247]
 ds_read_b128 a[92:95], v7 offset:39936
 v_cvt_pk_bf16_f32 v47, v24, v25
M v[244:247], a[112:115], v[52:55], v[244:247]
 v_add_f32 v27, v25, v27
M v[248:251], a[120:123], v[48:51], v[248:251]
M v[248:251], a[124:127], v[56:59], v[248:251]
M v[252:255], a[124:127], v[60:63], v[252:255]
 s_waitcnt lgkmcnt(0)
M v[252:255], a[120:123], v[52:55], v[252:255]
 s_branch L_loop_mid
L_zs0:
 s_mov_b32 s64, 65536
L_zs0_l:
 s_sleep 2
 buffer_load_dword v17, v16, s[12:15], 0 offen offset:64 sc1
 s_sub_u32 s64, s64, 1
 s_cbranch_scc1 L_zs0_x
 s_waitcnt vmcnt(0)
 v_cmp_ne_u32 vcc, 1, v17
 s_nop 0
 s_cbranch_vccnz L_zs0_l
L_zs0_x:
 s_waitcnt vmcnt(0)
 s_branch L_zr0
L_zs1:
 s_mov_b32 s64, 65536
L_zs1_l:
 s_sleep 2
 buffer_load_dword v17, v16, s[12:15], 0 offen offset:64 sc1
 s_sub_u32 s64, s64, 1
 s_cbranch_scc1 L_zs1_x
 s_waitcnt vmcnt(0)
 v_cmp_ne_u32 vcc, 1, v17
 s_nop 0
 s_cbranch_vccnz L_zs1_l
L_zs1_x:
 s_waitcnt vmcnt(0)
 s_branch L_zr1
L_hs:
 s_mov_b32 s91, 65536
L_hs_l:
 buffer_load_dwordx4 v[16:19], v7, s[8:11], s67 offen offset:0 sc1
 buffer_load_dwordx4 v[20:23], v7, s[8:11], s67 offen offset:1024 sc1
 s_waitcnt vmcnt(0)
 s_sub_u32 s91, s91, 1
 s_cbranch_scc1 L_hr
 v_min3_u32 v28, v16, v17, v18
 v_min3_u32 v28, v28, v19, v20
 v_min3_u32 v28, v28, v21, v22
 v_min_u32 v28, v28, v23
 v_cmp_eq_u32 vcc, 0, v28
 s_nop 0
 s_cbranch_vccnz L_hs_l
 s_branch L_hr
L_f1s04:
 s_mov_b32 s91, 65536
L_f1s04_l:
 s_sleep 2
 buffer_load_dword v24, v13, s[8:11], s46 offen sc1
 s_sub_u32 s91, s91, 1
 s_cbranch_scc1 L_f1s04_x
 s_waitcnt vmcnt(0)
 v_cmp_eq_u32 vcc, 0, v24
 s_nop 0
 s_cbranch_vccnz L_f1s04_l
L_f1s04_x:
 s_waitcnt vmcnt(0)
 s_branch L_f1r04
L_f1s05:
 s_mov_b32 s91, 65536
L_f1s05_l:
 s_sleep 2
 buffer_load_dword v24, v9, s[8:11], s46 offen sc1
 s_sub_u32 s91, s91, 1
 s_cbranch_scc1 L_f1s05_x
 s_waitcnt vmcnt(0)
 v_cmp_eq_u32 vcc, 0, v24
 s_nop 0
 s_cbranch_vccnz L_f1s05_l
L_f1s05_x:
 s_waitcnt vmcnt(0)
 s_branch L_f1r05
L_f1s14:
 s_mov_b32 s91, 65536
L_f1s14_l:
 s_sleep 2
 buffer_load_dword v24, v13, s[8:11], s46 offen sc1
 s_sub_u32 s91, s91, 1
 s_cbranch_scc1 L_f1s14_x
 s_waitcnt vmcnt(0)
 v_cmp_eq_u32 vcc, 0, v24
 s_nop 0
 s_cbranch_vccnz L_f1s14_l
L_f1s14_x:
 s_waitcnt vmcnt(0)
 s_branch L_f1r14
L_f1s15:
 s_mov_b32 s91, 65536
L_f1s15_l:
 s_sleep 2
 buffer_load_dword v24, v9, s[8:11], s46 offen sc1
 s_sub_u32 s91, s91, 1
 s_cbranch_scc1 L_f1s15_x
 s_waitcnt vmcnt(0)
 v_cmp_eq_u32 vcc, 0, v24
 s_nop 0
 s_cbranch_vccnz L_f1s15_l
L_f1s15_x:
 s_waitcnt vmcnt(0)
 s_branch L_f1r15
.p2align 6
L_loop_top:
M v[64:67], a[64:67], a[0:3], v[32:35]
 s_add_u32 m0, s28, 65536
 ds_read_b128 a[96:99], v2 offset:40960
M v[64:67], a[68:71], a[4:7], v[64:67]
 ds_read_b128 a[100:103], v2 offset:41984
M v[64:67], a[72:75], a[8:11], v[64:67]
 buffer_load_dword a240, v0, s[60:63], 0 offen offset:0
M v[64:67], a[76:79], a[12:15], v[64:67]
 ds_read_b128 a[104:107], v2 offset:43008
M v[64:67], a[80:83], a[16:19], v[64:67]
 ds_read_b128 a[108:111], v2 offset:44032
M v[64:67], a[84:87], a[20:23], v[64:67]
 buffer_load_dwordx4 v3, s[8:11], s24 offen offset:0 sc1 lds
M v[64:67], a[88:91], a[24:27], v[64:67]
 ds_read_b128 a[112:115], v2 offset:45056
M v[64:67], a[92:95], a[28:31], v[64:67]
 ds_read_b128 a[116:119], v2 offset:46080
M v[68:71], a[92:95], a[60:63], v[36:39]
 buffer_load_dwordx4 v3, s[8:11], s24 offen offset:1024 sc1 lds
M v[68:71], a[88:91], a[56:59], v[68:71]
 ds_read_b128 a[120:123], v2 offset:47104
M v[68:71], a[84:87], a[52:55], v[68:71]
 ds_read_b128 a[124:127], v2 offset:48128
M v[68:71], a[80:83], a[48:51], v[68:71]
 v_exp_f32 v18, v112
M v[68:71], a[76:79], a[44:47], v[68:71]
 buffer_load_dwordx4 v3, s[8:11], s24 offen offset:2048 sc1 lds
M v[68:71], a[72:75], a[40:43], v[68:71]
 v_exp_f32 v19, v113
M v[68:71], a[68:71], a[36:39], v[68:71]
 v_exp_f32 v20, v114
M v[68:71], a[64:67], a[32:35], v[68:71]
 s_waitcnt lgkmcnt(0)
 v_exp_f32 v21, v115
M v[72:75], a[96:99], a[0:3], v[32:35]
 ds_read_b128 a[64:67], v2 offset:49152
 v_add_f32 v28, v18, v28
M v[72:75], a[100:103], a[4:7], v[72:75]
 ds_read_b128 a[68:71], v2 offset:50176
 v_cvt_pk_bf16_f32 v56, v18, v19
M v[72:75], a[104:107], a[8:11], v[72:75]
 buffer_load_dwordx4 v3, s[8:11], s24 offen offset:3072 sc1 lds
M v[72:75], a[108:111], a[12:15], v[72:75]
 ds_read_b128 a[72:75], v2 offset:51200
 v_add_f32 v28, v19, v28
M v[72:75], a[112:115], a[16:19], v[72:75]
 ds_read_b128 a[76:79], v2 offset:52224
 v_add_f32 v28, v20, v28
M v[72:75], a[116:119], a[20:23], v[72:75]
 v_exp_f32 v22, v120
M v[72:75], a[120:123], a[24:27], v[72:75]
 s_add_u32 m0, s28, 69632
 ds_read_b128 a[80:83], v2 offset:53248
 v_cvt_pk_bf16_f32 v57, v20, v21
M v[72:75], a[124:127], a[28:31], v[72:75]
 ds_read_b128 a[84:87], v2 offset:54272
 v_add_f32 v28, v21, v28
M v[76:79], a[124:127], a[60:63], v[36:39]
 buffer_load_dwordx4 v4, s[8:11], s24 offen offset:0 sc1 lds
M v[76:79], a[120:123], a[56:59], v[76:79]
 ds_read_b128 a[88:91], v2 offset:55296
M v[76:79], a[116:119], a[52:55], v[76:79]
 ds_read_b128 a[92:95], v2 offset:56320
M v[76:79], a[112:115], a[48:51], v[76:79]
 v_exp_f32 v23, v121
M v[76:79], a[108:111], a[44:47], v[76:79]
 buffer_load_dwordx4 v4, s[8:11], s24 offen offset:1024 sc1 lds
M v[76:79], a[104:107], a[40:43], v[76:79]
 v_exp_f32 v24, v122
M v[76:79], a[100:103], a[36:39], v[76:79]
 v_exp_f32 v25, v123
M v[76:79], a[96:99], a[32:35], v[76:79]
 s_waitcnt lgkmcnt(0)
 v_exp_f32 v18, v116
M v[80:83], a[64:67], a[0:3], v[32:35]
 ds_read_b128 a[96:99], v2 offset:57344
 v_add_f32 v28, v22, v28
M v[80:83], a[68:71], a[4:7], v[80:83]
 ds_read_b128 a[100:103], v2 offset:58368
 v_cvt_pk_bf16_f32 v58, v22, v23
M v[80:83], a[72:75], a[8:11], v[80:83]
 buffer_load_dwordx4 v4, s[8:11], s24 offen offset:2048 sc1 lds
M v[80:83], a[76:79], a[12:15], v[80:83]
 ds_read_b128 a[104:107], v2 offset:59392
 v_add_f32 v28, v23, v28
M v[80:83], a[80:83], a[16:19], v[80:83]
 ds_read_b128 a[108:111], v2 offset:60416
 v_add_f32 v28, v24, v28
M v[80:83], a[84:87], a[20:23], v[80:83]
 v_exp_f32 v19, v117
M v[80:83], a[88:91], a[24:27], v[80:83]
 ds_read_b128 a[112:115], v2 offset:61440
 v_cvt_pk_bf16_f32 v59, v24, v25
M v[80:83], a[92:95], a[28:31], v[80:83]
 ds_read_b128 a[116:119], v2 offset:62464
 v_add_f32 v28, v25, v28
M v[84:87], a[92:95], a[60:63], v[36:39]
 buffer_load_dwordx4 v4, s[8:11], s24 offen offset:3072 sc1 lds
M v[84:87], a[88:91], a[56:59], v[84:87]
 ds_read_b128 a[120:123], v2 offset:63488
 v_add_f32 v29, v18, v29
M v[84:87], a[84:87], a[52:55], v[84:87]
 ds_read_b128 a[124:127], v2 offset:64512
 v_cvt_pk_bf16_f32 v60, v18, v19
M v[84:87], a[80:83], a[48:51], v[84:87]
 v_exp_f32 v20, v118
M v[84:87], a[76:79], a[44:47], v[84:87]
 v_exp_f32 v21, v119
M v[84:87], a[72:75], a[40:43], v[84:87]
 v_exp_f32 v22, v124
M v[84:87], a[68:71], a[36:39], v[84:87]
 s_waitcnt vmcnt(17) lgkmcnt(0)
 v_exp_f32 v23, v125
M v[84:87], a[64:67], a[32:35], v[84:87]
 s_barrier
M v[88:91], a[96:99], a[0:3], v[32:35]
 ds_read_b128 a[64:67], v7 offset:0
 v_add_f32 v29, v19, v29
M v[88:91], a[100:103], a[4:7], v[88:91]
 ds_read_b128 a[68:71], v7 offset:1024
 v_add_f32 v29, v20, v29
M v[88:91], a[104:107], a[8:11], v[88:91]
 v_exp_f32 v24, v126
M v[88:91], a[108:111], a[12:15], v[88:91]
 ds_read_b128 a[72:75], v7 offset:2048
 v_cvt_pk_bf16_f32 v61, v20, v21
M v[88:91], a[112:115], a[16:19], v[88:91]
 ds_read_b128 a[76:79], v7 offset:3072
 v_add_f32 v29, v21, v29
M v[88:91], a[116:119], a[20:23], v[88:91]
 v_exp_f32 v25, v127
M v[88:91], a[120:123], a[24:27], v[88:91]
 ds_read_b128 a[80:83], v7 offset:4096
 v_add_f32 v29, v22, v29
M v[88:91], a[124:127], a[28:31], v[88:91]
 ds_read_b128 a[84:87], v7 offset:5120
 v_cvt_pk_bf16_f32 v62, v22, v23
M v[92:95], a[124:127], a[60:63], v[36:39]
 v_add_f32 v29, v23, v29
 v_add_f32 v29, v24, v29
M v[92:95], a[120:123], a[56:59], v[92:95]
 ds_read_b128 a[88:91], v7 offset:6144
 v_cvt_pk_bf16_f32 v63, v24, v25
M v[92:95], a[116:119], a[52:55], v[92:95]
 ds_read_b128 a[92:95], v7 offset:7168
 v_add_f32 v29, v25, v29
M v[92:95], a[112:115], a[48:51], v[92:95]
 v_max_f32 v10, v28, v29
M v[92:95], a[108:111], a[44:47], v[92:95]
 v_cmp_lt_f32 vcc, s31, v10
M v[92:95], a[104:107], a[40:43], v[92:95]
M v[92:95], a[100:103], a[36:39], v[92:95]
 s_waitcnt lgkmcnt(0)
M v[92:95], a[96:99], a[32:35], v[92:95]
 s_cbranch_vccnz L_st1
L_rt1:
M v[128:131], a[64:67], v[48:51], v[128:131]
 s_add_u32 m0, s28, 98304
 ds_read_b128 a[96:99], v7 offset:8192
 v_add_f32 v30, v28, v30
M v[128:131], a[68:71], v[56:59], v[128:131]
 ds_read_b128 a[100:103], v7 offset:9216
 v_add_f32 v31, v29, v31
M v[132:135], a[68:71], v[60:63], v[132:135]
 buffer_load_dwordx4 v3, s[8:11], s21 offen offset:0 sc1 lds
M v[132:135], a[64:67], v[52:55], v[132:135]
 ds_read_b128 a[104:107], v7 offset:10240
M v[136:139], a[72:75], v[48:51], v[136:139]
 ds_read_b128 a[108:111], v7 offset:11264
M v[136:139], a[76:79], v[56:59], v[136:139]
 buffer_load_dwordx4 v3, s[8:11], s21 offen offset:1024 sc1 lds
M v[140:143], a[76:79], v[60:63], v[140:143]
 ds_read_b128 a[112:115], v7 offset:12288
M v[140:143], a[72:75], v[52:55], v[140:143]
 ds_read_b128 a[116:119], v7 offset:13312
M v[144:147], a[80:83], v[48:51], v[144:147]
 v_exp_f32 v18, v64
M v[144:147], a[84:87], v[56:59], v[144:147]
 ds_read_b128 a[120:123], v7 offset:14336
M v[148:151], a[84:87], v[60:63], v[148:151]
 ds_read_b128 a[124:127], v7 offset:15360
M v[148:151], a[80:83], v[52:55], v[148:151]
 buffer_load_dwordx4 v3, s[8:11], s21 offen offset:2048 sc1 lds
M v[152:155], a[88:91], v[48:51], v[152:155]
 v_exp_f32 v19, v65
M v[152:155], a[92:95], v[56:59], v[152:155]
 v_exp_f32 v20, v66
M v[156:159], a[92:95], v[60:63], v[156:159]
 buffer_load_dwordx4 v3, s[8:11], s21 offen offset:3072 sc1 lds
M v[156:159], a[88:91], v[52:55], v[156:159]
 s_waitcnt lgkmcnt(0)
 v_exp_f32 v21, v67
M v[160:163], a[96:99], v[48:51], v[160:163]
 ds_read_b128 a[64:67], v7 offset:16384
 v_add_f32 v26, v18, v19
M v[160:163], a[100:103], v[56:59], v[160:163]
 s_add_u32 m0, s28, 102400
 ds_read_b128 a[68:71], v7 offset:17408
 v_cvt_pk_bf16_f32 v40, v18, v19
M v[164:167], a[100:103], v[60:63], v[164:167]
 buffer_load_dwordx4 v4, s[8:11], s21 offen offset:0 sc1 lds
M v[164:167], a[96:99], v[52:55], v[164:167]
 ds_read_b128 a[72:75], v7 offset:18432
 v_add_f32 v26, v20, v26
M v[168:171], a[104:107], v[48:51], v[168:171]
 ds_read_b128 a[76:79], v7 offset:19456
 v_cvt_pk_bf16_f32 v41, v20, v21
M v[168:171], a[108:111], v[56:59], v[168:171]
 v_exp_f32 v22, v72
M v[172:175], a[108:111], v[60:63], v[172:175]
 ds_read_b128 a[80:83], v7 offset:20480
 v_add_f32 v26, v21, v26
M v[172:175], a[104:107], v[52:55], v[172:175]
 ds_read_b128 a[84:87], v7 offset:21504
M v[176:179], a[112:115], v[48:51], v[176:179]
 buffer_load_dwordx4 v4, s[8:11], s21 offen offset:1024 sc1 lds
M v[176:179], a[116:119], v[56:59], v[176:179]
 ds_read_b128 a[88:91], v7 offset:22528
M v[180:183], a[116:119], v[60:63], v[180:183]
 ds_read_b128 a[92:95], v7 offset:23552
M v[180:183], a[112:115], v[52:55], v[180:183]
 buffer_load_dwordx4 v4, s[8:11], s21 offen offset:2048 sc1 lds
M v[184:187], a[120:123], v[48:51], v[184:187]
 v_exp_f32 v23, v73
M v[184:187], a[124:127], v[56:59], v[184:187]
 v_exp_f32 v24, v74
M v[188:191], a[124:127], v[60:63], v[188:191]
 v_exp_f32 v25, v75
M v[188:191], a[120:123], v[52:55], v[188:191]
 s_waitcnt lgkmcnt(0)
 v_exp_f32 v18, v68
M v[192:195], a[64:67], v[48:51], v[192:195]
 ds_read_b128 a[96:99], v7 offset:24576
 v_add_f32 v26, v22, v26
M v[192:195], a[68:71], v[56:59], v[192:195]
 ds_read_b128 a[100:103], v7 offset:25600
 v_cvt_pk_bf16_f32 v42, v22, v23
M v[196:199], a[68:71], v[60:63], v[196:199]
 buffer_load_dwordx4 v4, s[8:11], s21 offen offset:3072 sc1 lds
M v[196:199], a[64:67], v[52:55], v[196:199]
 s_add_u32 s24, s23, 16777216
 ds_read_b128 a[104:107], v7 offset:26624
 v_add_f32 v26, v23, v26
M v[200:203], a[72:75], v[48:51], v[200:203]
 s_mov_b32 s23, s21
 ds_read_b128 a[108:111], v7 offset:27648
 v_add_f32 v26, v24, v26
M v[200:203], a[76:79], v[56:59], v[200:203]
 s_add_u32 s21, s21, 32768
 v_exp_f32 v19, v69
M v[204:207], a[76:79], v[60:63], v[204:207]
 s_add_u32 s22, s22, 1
 ds_read_b128 a[112:115], v7 offset:28672
 v_cvt_pk_bf16_f32 v43, v24, v25
M v[204:207], a[72:75], v[52:55], v[204:207]
 s_cmp_eq_u32 s22, s25
 ds_read_b128 a[116:119], v7 offset:29696
 v_add_f32 v26, v25, v26
M v[208:211], a[80:83], v[48:51], v[208:211]
 s_cselect_b32 s21, s26, s21
 v_exp_f32 v20, v70
M v[208:211], a[84:87], v[56:59], v[208:211]
 s_cmp_eq_u32 s22, s43
 ds_read_b128 a[120:123], v7 offset:30720
 v_add_f32 v27, v18, v19
M v[212:215], a[84:87], v[60:63], v[212:215]
 s_cselect_b32 s21, s4, s21
 ds_read_b128 a[124:127], v7 offset:31744
 v_cvt_pk_bf16_f32 v44, v18, v19
M v[212:215], a[80:83], v[52:55], v[212:215]
 s_cmp_eq_u32 s22, s6
 v_exp_f32 v21, v71
M v[216:219], a[88:91], v[48:51], v[216:219]
 s_cselect_b32 s21, s7, s21
 v_exp_f32 v22, v76
M v[216:219], a[92:95], v[56:59], v[216:219]
 v_add_f32 v27, v20, v27
 v_cvt_pk_bf16_f32 v45, v20, v21
M v[220:223], a[92:95], v[60:63], v[220:223]
 s_waitcnt vmcnt(17) lgkmcnt(0)
 v_add_f32 v27, v21, v27
M v[220:223], a[88:91], v[52:55], v[220:223]
 s_barrier
M v[224:227], a[96:99], v[48:51], v[224:227]
 ds_read_b128 a[64:67], v7 offset:32768
M v[224:227], a[100:103], v[56:59], v[224:227]
 ds_read_b128 a[68:71], v7 offset:33792
M v[228:231], a[100:103], v[60:63], v[228:231]
 v_exp_f32 v23, v77
M v[228:231], a[96:99], v[52:55], v[228:231]
 ds_read_b128 a[72:75], v7 offset:34816
 v_add_f32 v27, v22, v27
M v[232:235], a[104:107], v[48:51], v[232:235]
 ds_read_b128 a[76:79], v7 offset:35840
 v_cvt_pk_bf16_f32 v46, v22, v23
M v[232:235], a[108:111], v[56:59], v[232:235]
 v_exp_f32 v24, v78
M v[236:239], a[108:111], v[60:63], v[236:239]
 ds_read_b128 a[80:83], v7 offset:36864
 v_add_f32 v27, v23, v27
M v[236:239], a[104:107], v[52:55], v[236:239]
 ds_read_b128 a[84:87], v7 offset:37888
M v[240:243], a[112:115], v[48:51], v[240:243]
 v_exp_f32 v25, v79
M v[240:243], a[116:119], v[56:59], v[240:243]
 ds_read_b128 a[88:91], v7 offset:38912
 v_add_f32 v27, v24, v27
M v[244:247], a[116:119], v[60:63], v[244:247]
 ds_read_b128 a[92:95], v7 offset:39936
 v_cvt_pk_bf16_f32 v47, v24, v25
M v[244:247], a[112:115], v[52:55], v[244:247]
 v_add_f32 v27, v25, v27
M v[248:251], a[120:123], v[48:51], v[248:251]
M v[248:251], a[124:127], v[56:59], v[248:251]
M v[252:255], a[124:127], v[60:63], v[252:255]
 s_waitcnt lgkmcnt(0)
M v[252:255], a[120:123], v[52:55], v[252:255]
L_loop_mid:
M v[96:99], a[64:67], a[0:3], v[32:35]
 s_and_b32 s39, s54, 15
 ds_read_b128 a[96:99], v7 offset:40960
M v[96:99], a[68:71], a[4:7], v[96:99]
 s_cbranch_scc1 L_fll
L_fllr:
 ds_read_b128 a[100:103], v7 offset:41984
M v[96:99], a[72:75], a[8:11], v[96:99]
 s_lshr_b32 s54, s54, 4
 v_exp_f32 v18, v80
M v[96:99], a[76:79], a[12:15], v[96:99]
 s_add_u32 m0, s28, 0
 ds_read_b128 a[104:107], v7 offset:43008
M v[96:99], a[80:83], a[16:19], v[96:99]
 ds_read_b128 a[108:111], v7 offset:44032
M v[96:99], a[84:87], a[20:23], v[96:99]
 buffer_load_dwordx4 v3, s[8:11], s24 offen offset:0 sc1 lds
M v[96:99], a[88:91], a[24:27], v[96:99]
 ds_read_b128 a[112:115], v7 offset:45056
M v[96:99], a[92:95], a[28:31], v[96:99]
 ds_read_b128 a[116:119], v7 offset:46080
M v[100:103], a[92:95], a[60:63], v[36:39]
 v_exp_f32 v19, v81
M v[100:103], a[88:91], a[56:59], v[100:103]
 ds_read_b128 a[120:123], v7 offset:47104
 v_add_f32 v26, v18, v26
M v[100:103], a[84:87], a[52:55], v[100:103]
 ds_read_b128 a[124:127], v7 offset:48128
 v_cvt_pk_bf16_f32 v56, v18, v19
M v[100:103], a[80:83], a[48:51], v[100:103]
 buffer_load_dwordx4 v3, s[8:11], s24 offen offset:1024 sc1 lds
M v[100:103], a[76:79], a[44:47], v[100:103]
 v_exp_f32 v20, v82
M v[100:103], a[72:75], a[40:43], v[100:103]
 v_exp_f32 v21, v83
M v[100:103], a[68:71], a[36:39], v[100:103]
 buffer_load_dwordx4 v3, s[8:11], s24 offen offset:2048 sc1 lds
M v[100:103], a[64:67], a[32:35], v[100:103]
 s_waitcnt lgkmcnt(0)
 v_exp_f32 v22, v88
M v[104:107], a[96:99], a[0:3], v[32:35]
 ds_read_b128 a[64:67], v7 offset:49152
 v_add_f32 v26, v19, v26
M v[104:107], a[100:103], a[4:7], v[104:107]
 ds_read_b128 a[68:71], v7 offset:50176
 v_add_f32 v26, v20, v26
M v[104:107], a[104:107], a[8:11], v[104:107]
 v_exp_f32 v23, v89
M v[104:107], a[108:111], a[12:15], v[104:107]
 ds_read_b128 a[72:75], v7 offset:51200
 v_cvt_pk_bf16_f32 v57, v20, v21
M v[104:107], a[112:115], a[16:19], v[104:107]
 ds_read_b128 a[76:79], v7 offset:52224
 v_add_f32 v26, v21, v26
M v[104:107], a[116:119], a[20:23], v[104:107]
 buffer_load_dwordx4 v3, s[8:11], s24 offen offset:3072 sc1 lds
M v[104:107], a[120:123], a[24:27], v[104:107]
 ds_read_b128 a[80:83], v7 offset:53248
 v_add_f32 v26, v22, v26
M v[104:107], a[124:127], a[28:31], v[104:107]
 s_add_u32 m0, s28, 4096
 ds_read_b128 a[84:87], v7 offset:54272
 v_cvt_pk_bf16_f32 v58, v22, v23
M v[108:111], a[124:127], a[60:63], v[36:39]
 buffer_load_dwordx4 v4, s[8:11], s24 offen offset:0 sc1 lds
M v[108:111], a[120:123], a[56:59], v[108:111]
 ds_read_b128 a[88:91], v7 offset:55296
 v_add_f32 v26, v23, v26
M v[108:111], a[116:119], a[52:55], v[108:111]
 ds_read_b128 a[92:95], v7 offset:56320
M v[108:111], a[112:115], a[48:51], v[108:111]
 v_exp_f32 v24, v90
M v[108:111], a[108:111], a[44:47], v[108:111]
 v_exp_f32 v25, v91
M v[108:111], a[104:107], a[40:43], v[108:111]
 buffer_load_dwordx4 v4, s[8:11], s24 offen offset:1024 sc1 lds
M v[108:111], a[100:103], a[36:39], v[108:111]
 v_exp_f32 v18, v84
M v[108:111], a[96:99], a[32:35], v[108:111]
 s_waitcnt lgkmcnt(0)
 v_exp_f32 v19, v85
M v[112:115], a[64:67], a[0:3], v[32:35]
 ds_read_b128 a[96:99], v7 offset:57344
 v_add_f32 v26, v24, v26
M v[112:115], a[68:71], a[4:7], v[112:115]
 ds_read_b128 a[100:103], v7 offset:58368
 v_cvt_pk_bf16_f32 v59, v24, v25
M v[112:115], a[72:75], a[8:11], v[112:115]
 buffer_load_dwordx4 v4, s[8:11], s24 offen offset:2048 sc1 lds
M v[112:115], a[76:79], a[12:15], v[112:115]
 ds_read_b128 a[104:107], v7 offset:59392
 v_add_f32 v26, v25, v26
M v[112:115], a[80:83], a[16:19], v[112:115]
 ds_read_b128 a[108:111], v7 offset:60416
 v_add_f32 v27, v18, v27
M v[112:115], a[84:87], a[20:23], v[112:115]
 v_exp_f32 v20, v86
M v[112:115], a[88:91], a[24:27], v[112:115]
 ds_read_b128 a[112:115], v7 offset:61440
 v_cvt_pk_bf16_f32 v60, v18, v19
M v[112:115], a[92:95], a[28:31], v[112:115]
 ds_read_b128 a[116:119], v7 offset:62464
 v_add_f32 v27, v19, v27
M v[116:119], a[92:95], a[60:63], v[36:39]
 buffer_load_dwordx4 v4, s[8:11], s24 offen offset:3072 sc1 lds
M v[116:119], a[88:91], a[56:59], v[116:119]
 ds_read_b128 a[120:123], v7 offset:63488
M v[116:119], a[84:87], a[52:55], v[116:119]
 ds_read_b128 a[124:127], v7 offset:64512
M v[116:119], a[80:83], a[48:51], v[116:119]
 v_exp_f32 v21, v87
M v[116:119], a[76:79], a[44:47], v[116:119]
 v_exp_f32 v22, v92
M v[116:119], a[72:75], a[40:43], v[116:119]
 v_exp_f32 v23, v93
M v[116:119], a[68:71], a[36:39], v[116:119]
 s_waitcnt vmcnt(16) lgkmcnt(0)
 v_add_f32 v27, v20, v27
 v_cvt_pk_bf16_f32 v61, v20, v21
M v[116:119], a[64:67], a[32:35], v[116:119]
 s_barrier
M v[120:123], a[96:99], a[0:3], v[32:35]
 ds_read_b128 a[64:67], v2 offset:0
 v_add_f32 v27, v21, v27
M v[120:123], a[100:103], a[4:7], v[120:123]
 ds_read_b128 a[68:71], v2 offset:1024
 v_add_f32 v27, v22, v27
M v[120:123], a[104:107], a[8:11], v[120:123]
 v_exp_f32 v24, v94
M v[120:123], a[108:111], a[12:15], v[120:123]
 ds_read_b128 a[72:75], v2 offset:2048
 v_cvt_pk_bf16_f32 v62, v22, v23
M v[120:123], a[112:115], a[16:19], v[120:123]
 ds_read_b128 a[76:79], v2 offset:3072
 v_add_f32 v27, v23, v27
M v[120:123], a[116:119], a[20:23], v[120:123]
 v_exp_f32 v25, v95
M v[120:123], a[120:123], a[24:27], v[120:123]
 ds_read_b128 a[80:83], v2 offset:4096
 v_add_f32 v27, v24, v27
M v[120:123], a[124:127], a[28:31], v[120:123]
 ds_read_b128 a[84:87], v2 offset:5120
 v_cvt_pk_bf16_f32 v63, v24, v25
M v[124:127], a[124:127], a[60:63], v[36:39]
 v_add_f32 v27, v25, v27
M v[124:127], a[120:123], a[56:59], v[124:127]
 ds_read_b128 a[88:91], v2 offset:6144
M v[124:127], a[116:119], a[52:55], v[124:127]
 ds_read_b128 a[92:95], v2 offset:7168
 v_max_f32 v10, v26, v27
M v[124:127], a[112:115], a[48:51], v[124:127]
 v_cmp_lt_f32 vcc, s31, v10
M v[124:127], a[108:111], a[44:47], v[124:127]
M v[124:127], a[104:107], a[40:43], v[124:127]
M v[124:127], a[100:103], a[36:39], v[124:127]
 s_waitcnt lgkmcnt(0)
M v[124:127], a[96:99], a[32:35], v[124:127]
 s_cbranch_vccnz L_st0
L_rt0:
M v[128:131], a[64:67], v[40:43], v[128:131]
 s_add_u32 m0, s28, 32768
 ds_read_b128 a[96:99], v2 offset:8192
 v_add_f32 v30, v26, v30
M v[128:131], a[68:71], v[56:59], v[128:131]
 ds_read_b128 a[100:103], v2 offset:9216
 v_add_f32 v31, v27, v31
M v[132:135], a[68:71], v[60:63], v[132:135]
 buffer_load_dwordx4 v3, s[8:11], s21 offen offset:0 sc1 lds
M v[132:135], a[64:67], v[44:47], v[132:135]
 ds_read_b128 a[104:107], v2 offset:10240
M v[136:139], a[72:75], v[40:43], v[136:139]
 ds_read_b128 a[108:111], v2 offset:11264
M v[136:139], a[76:79], v[56:59], v[136:139]
 buffer_load_dwordx4 v3, s[8:11], s21 offen offset:1024 sc1 lds
M v[140:143], a[76:79], v[60:63], v[140:143]
 ds_read_b128 a[112:115], v2 offset:12288
M v[140:143], a[72:75], v[44:47], v[140:143]
 ds_read_b128 a[116:119], v2 offset:13312
M v[144:147], a[80:83], v[40:43], v[144:147]
 v_exp_f32 v18, v96
M v[144:147], a[84:87], v[56:59], v[144:147]
 ds_read_b128 a[120:123], v2 offset:14336
M v[148:151], a[84:87], v[60:63], v[148:151]
 ds_read_b128 a[124:127], v2 offset:15360
M v[148:151], a[80:83], v[44:47], v[148:151]
 buffer_load_dwordx4 v3, s[8:11], s21 offen offset:2048 sc1 lds
M v[152:155], a[88:91], v[40:43], v[152:155]
 v_exp_f32 v19, v97
M v[152:155], a[92:95], v[56:59], v[152:155]
 v_exp_f32 v20, v98
M v[156:159], a[92:95], v[60:63], v[156:159]
 buffer_load_dwordx4 v3, s[8:11], s21 offen offset:3072 sc1 lds
M v[156:159], a[88:91], v[44:47], v[156:159]
 s_waitcnt lgkmcnt(0)
 v_exp_f32 v21, v99
M v[160:163], a[96:99], v[40:43], v[160:163]
 ds_read_b128 a[64:67], v2 offset:16384
 v_add_f32 v28, v18, v19
M v[160:163], a[100:103], v[56:59], v[160:163]
 s_add_u32 m0, s28, 36864
 ds_read_b128 a[68:71], v2 offset:17408
 v_cvt_pk_bf16_f32 v48, v18, v19
M v[164:167], a[100:103], v[60:63], v[164:167]
 buffer_load_dwordx4 v4, s[8:11], s21 offen offset:0 sc1 lds
M v[164:167], a[96:99], v[44:47], v[164:167]
 ds_read_b128 a[72:75], v2 offset:18432
 v_add_f32 v28, v20, v28
M v[168:171], a[104:107], v[40:43], v[168:171]
 ds_read_b128 a[76:79], v2 offset:19456
 v_cvt_pk_bf16_f32 v49, v20, v21
M v[168:171], a[108:111], v[56:59], v[168:171]
 v_exp_f32 v22, v104
M v[172:175], a[108:111], v[60:63], v[172:175]
 ds_read_b128 a[80:83], v2 offset:20480
 v_add_f32 v28, v21, v28
M v[172:175], a[104:107], v[44:47], v[172:175]
 ds_read_b128 a[84:87], v2 offset:21504
M v[176:179], a[112:115], v[40:43], v[176:179]
 buffer_load_dwordx4 v4, s[8:11], s21 offen offset:1024 sc1 lds
M v[176:179], a[116:119], v[56:59], v[176:179]
 ds_read_b128 a[88:91], v2 offset:22528
M v[180:183], a[116:119], v[60:63], v[180:183]
 ds_read_b128 a[92:95], v2 offset:23552
M v[180:183], a[112:115], v[44:47], v[180:183]
 buffer_load_dwordx4 v4, s[8:11], s21 offen offset:2048 sc1 lds
M v[184:187], a[120:123], v[40:43], v[184:187]
 v_exp_f32 v23, v105
M v[184:187], a[124:127], v[56:59], v[184:187]
 v_exp_f32 v24, v106
M v[188:191], a[124:127], v[60:63], v[188:191]
 v_exp_f32 v25, v107
M v[188:191], a[120:123], v[44:47], v[188:191]
 s_waitcnt lgkmcnt(0)
 v_exp_f32 v18, v100
M v[192:195], a[64:67], v[40:43], v[192:195]
 ds_read_b128 a[96:99], v2 offset:24576
 v_add_f32 v28, v22, v28
M v[192:195], a[68:71], v[56:59], v[192:195]
 ds_read_b128 a[100:103], v2 offset:25600
 v_cvt_pk_bf16_f32 v50, v22, v23
M v[196:199], a[68:71], v[60:63], v[196:199]
 buffer_load_dwordx4 v4, s[8:11], s21 offen offset:3072 sc1 lds
M v[196:199], a[64:67], v[44:47], v[196:199]
 s_add_u32 s24, s23, 16777216
 ds_read_b128 a[104:107], v2 offset:26624
 v_add_f32 v28, v23, v28
M v[200:203], a[72:75], v[40:43], v[200:203]
 s_mov_b32 s23, s21
 ds_read_b128 a[108:111], v2 offset:27648
 v_add_f32 v28, v24, v28
M v[200:203], a[76:79], v[56:59], v[200:203]
 s_add_u32 s21, s21, 32768
 v_exp_f32 v19, v101
M v[204:207], a[76:79], v[60:63], v[204:207]
 s_add_u32 s22, s22, 1
 ds_read_b128 a[112:115], v2 offset:28672
 v_cvt_pk_bf16_f32 v51, v24, v25
M v[204:207], a[72:75], v[44:47], v[204:207]
 s_cmp_eq_u32 s22, s25
 ds_read_b128 a[116:119], v2 offset:29696
 v_add_f32 v28, v25, v28
M v[208:211], a[80:83], v[40:43], v[208:211]
 s_cselect_b32 s21, s26, s21
 v_exp_f32 v20, v102
M v[208:211], a[84:87], v[56:59], v[208:211]
 s_cmp_eq_u32 s22, s43
 ds_read_b128 a[120:123], v2 offset:30720
 v_add_f32 v29, v18, v19
M v[212:215], a[84:87], v[60:63], v[212:215]
 s_cselect_b32 s21, s4, s21
 ds_read_b128 a[124:127], v2 offset:31744
 v_cvt_pk_bf16_f32 v52, v18, v19
M v[212:215], a[80:83], v[44:47], v[212:215]
 s_cmp_eq_u32 s22, s6
 v_exp_f32 v21, v103
M v[216:219], a[88:91], v[40:43], v[216:219]
 s_cselect_b32 s21, s7, s21
 v_exp_f32 v22, v108
M v[216:219], a[92:95], v[56:59], v[216:219]
 v_add_f32 v29, v20, v29
 v_cvt_pk_bf16_f32 v53, v20, v21
M v[220:223], a[92:95], v[60:63], v[220:223]
 s_waitcnt vmcnt(16) lgkmcnt(0)
 v_exp_f32 v23, v109
M v[220:223], a[88:91], v[44:47], v[220:223]
 s_barrier
M v[224:227], a[96:99], v[40:43], v[224:227]
 ds_read_b128 a[64:67], v2 offset:32768
 v_add_f32 v29, v21, v29
M v[224:227], a[100:103], v[56:59], v[224:227]
 ds_read_b128 a[68:71], v2 offset:33792
 v_add_f32 v29, v22, v29
M v[228:231], a[100:103], v[60:63], v[228:231]
 v_cmp_gt_u32 vcc, s39, v6
 v_cvt_pk_bf16_f32 v54, v22, v23
M v[228:231], a[96:99], v[44:47], v[228:231]
 ds_read_b128 a[72:75], v2 offset:34816
 v_add_f32 v29, v23, v29
M v[232:235], a[104:107], v[40:43], v[232:235]
 ds_read_b128 a[76:79], v2 offset:35840
M v[232:235], a[108:111], v[56:59], v[232:235]
 s_cbranch_vccnz L_fls0
L_flr0:
 v_exp_f32 v24, v110
M v[236:239], a[108:111], v[60:63], v[236:239]
 s_and_b32 s3, s5, 15
 ds_read_b128 a[80:83], v2 offset:36864
M v[236:239], a[104:107], v[44:47], v[236:239]
 s_cbranch_scc1 L_pub3
L_pub3r:
 ds_read_b128 a[84:87], v2 offset:37888
M v[240:243], a[112:115], v[40:43], v[240:243]
 s_lshr_b32 s5, s5, 4
 v_exp_f32 v25, v111
M v[240:243], a[116:119], v[56:59], v[240:243]
 ds_read_b128 a[88:91], v2 offset:38912
 v_add_f32 v29, v24, v29
M v[244:247], a[116:119], v[60:63], v[244:247]
 ds_read_b128 a[92:95], v2 offset:39936
 v_cvt_pk_bf16_f32 v55, v24, v25
M v[244:247], a[112:115], v[44:47], v[244:247]
 v_add_f32 v29, v25, v29
M v[248:251], a[120:123], v[40:43], v[248:251]
 s_sub_u32 s27, s27, 1
M v[248:251], a[124:127], v[56:59], v[248:251]
 s_cmp_lg_u32 s27, 0
M v[252:255], a[124:127], v[60:63], v[252:255]
 s_waitcnt lgkmcnt(0)
M v[252:255], a[120:123], v[44:47], v[252:255]
 s_cbranch_scc1 L_loop_top
L_p1:
 s_cmp_eq_u32 s40, 0
 s_cbranch_scc1 L_final_h
 s_cmp_ge_u32 s42, 10
 s_cbranch_scc1 L_p1c
 v_cndmask_b32 v64, v32, v8, s[64:65]
 v_cndmask_b32 v65, v32, v8, s[66:67]
 v_cndmask_b32 v66, v32, v8, s[68:69]
 v_cndmask_b32 v67, v32, v8, s[70:71]
 s_nop 1
M v[64:67], a[64:67], a[0:3], v[64:67]
 s_add_u32 m0, s28, 65536
 ds_read_b128 a[96:99], v2 offset:40960
 v_cndmask_b32 v72, v32, v8, s[72:73]
M v[64:67], a[68:71], a[4:7], v[64:67]
 ds_read_b128 a[100:103], v2 offset:41984
 v_cndmask_b32 v73, v32, v8, s[74:75]
M v[64:67], a[72:75], a[8:11], v[64:67]
 buffer_load_dwordx4 v3, s[8:11], s24 offen offset:0 sc1 lds
M v[64:67], a[76:79], a[12:15], v[64:67]
 ds_read_b128 a[104:107], v2 offset:43008
 v_cndmask_b32 v74, v32, v8, s[76:77]
M v[64:67], a[80:83], a[16:19], v[64:67]
 ds_read_b128 a[108:111], v2 offset:44032
 v_cndmask_b32 v75, v32, v8, s[78:79]
M v[64:67], a[84:87], a[20:23], v[64:67]
 v_exp_f32 v18, v112
M v[64:67], a[88:91], a[24:27], v[64:67]
 ds_read_b128 a[112:115], v2 offset:45056
M v[64:67], a[92:95], a[28:31], v[64:67]
 ds_read_b128 a[116:119], v2 offset:46080
M v[68:71], a[92:95], a[60:63], v[36:39]
 buffer_load_dwordx4 v3, s[8:11], s24 offen offset:1024 sc1 lds
M v[68:71], a[88:91], a[56:59], v[68:71]
 ds_read_b128 a[120:123], v2 offset:47104
M v[68:71], a[84:87], a[52:55], v[68:71]
 ds_read_b128 a[124:127], v2 offset:48128
M v[68:71], a[80:83], a[48:51], v[68:71]
 v_exp_f32 v19, v113
M v[68:71], a[76:79], a[44:47], v[68:71]
 buffer_load_dwordx4 v3, s[8:11], s24 offen offset:2048 sc1 lds
M v[68:71], a[72:75], a[40:43], v[68:71]
 v_exp_f32 v20, v114
M v[68:71], a[68:71], a[36:39], v[68:71]
 v_exp_f32 v21, v115
M v[68:71], a[64:67], a[32:35], v[68:71]
 s_waitcnt lgkmcnt(0)
 v_exp_f32 v22, v120
M v[72:75], a[96:99], a[0:3], v[72:75]
 ds_read_b128 a[64:67], v2 offset:49152
 v_cndmask_b32 v80, v32, v8, s[80:81]
M v[72:75], a[100:103], a[4:7], v[72:75]
 ds_read_b128 a[68:71], v2 offset:50176
 v_cndmask_b32 v81, v32, v8, s[82:83]
M v[72:75], a[104:107], a[8:11], v[72:75]
 buffer_load_dwordx4 v3, s[8:11], s24 offen offset:3072 sc1 lds
M v[72:75], a[108:111], a[12:15], v[72:75]
 ds_read_b128 a[72:75], v2 offset:51200
 v_cndmask_b32 v82, v32, v8, s[84:85]
M v[72:75], a[112:115], a[16:19], v[72:75]
 ds_read_b128 a[76:79], v2 offset:52224
 v_cndmask_b32 v83, v32, v8, s[86:87]
M v[72:75], a[116:119], a[20:23], v[72:75]
 v_exp_f32 v23, v121
M v[72:75], a[120:123], a[24:27], v[72:75]
 s_add_u32 m0, s28, 69632
 ds_read_b128 a[80:83], v2 offset:53248
 v_add_f32 v28, v18, v28
M v[72:75], a[124:127], a[28:31], v[72:75]
 ds_read_b128 a[84:87], v2 offset:54272
 v_cvt_pk_bf16_f32 v56, v18, v19
M v[76:79], a[124:127], a[60:63], v[36:39]
 buffer_load_dwordx4 v4, s[8:11], s24 offen offset:0 sc1 lds
M v[76:79], a[120:123], a[56:59], v[76:79]
 ds_read_b128 a[88:91], v2 offset:55296
 v_add_f32 v28, v19, v28
M v[76:79], a[116:119], a[52:55], v[76:79]
 ds_read_b128 a[92:95], v2 offset:56320
 v_add_f32 v28, v20, v28
M v[76:79], a[112:115], a[48:51], v[76:79]
 v_exp_f32 v24, v122
M v[76:79], a[108:111], a[44:47], v[76:79]
 buffer_load_dwordx4 v4, s[8:11], s24 offen offset:1024 sc1 lds
M v[76:79], a[104:107], a[40:43], v[76:79]
 v_exp_f32 v25, v123
M v[76:79], a[100:103], a[36:39], v[76:79]
 v_exp_f32 v18, v116
M v[76:79], a[96:99], a[32:35], v[76:79]
 s_waitcnt lgkmcnt(0)
 v_exp_f32 v19, v117
M v[80:83], a[64:67], a[0:3], v[80:83]
 ds_read_b128 a[96:99], v2 offset:57344
 v_cndmask_b32 v88, v32, v8, s[88:89]
M v[80:83], a[68:71], a[4:7], v[80:83]
 ds_read_b128 a[100:103], v2 offset:58368
 v_cndmask_b32 v89, v32, v8, s[90:91]
M v[80:83], a[72:75], a[8:11], v[80:83]
 buffer_load_dwordx4 v4, s[8:11], s24 offen offset:2048 sc1 lds
M v[80:83], a[76:79], a[12:15], v[80:83]
 ds_read_b128 a[104:107], v2 offset:59392
 v_cndmask_b32 v90, v32, v8, s[92:93]
M v[80:83], a[80:83], a[16:19], v[80:83]
 ds_read_b128 a[108:111], v2 offset:60416
 v_cndmask_b32 v91, v32, v8, s[94:95]
M v[80:83], a[84:87], a[20:23], v[80:83]
 v_cvt_pk_bf16_f32 v57, v20, v21
 v_add_f32 v28, v21, v28
M v[80:83], a[88:91], a[24:27], v[80:83]
 ds_read_b128 a[112:115], v2 offset:61440
 v_add_f32 v28, v22, v28
M v[80:83], a[92:95], a[28:31], v[80:83]
 ds_read_b128 a[116:119], v2 offset:62464
 v_cvt_pk_bf16_f32 v58, v22, v23
M v[84:87], a[92:95], a[60:63], v[36:39]
 buffer_load_dwordx4 v4, s[8:11], s24 offen offset:3072 sc1 lds
M v[84:87], a[88:91], a[56:59], v[84:87]
 ds_read_b128 a[120:123], v2 offset:63488
 v_add_f32 v28, v23, v28
M v[84:87], a[84:87], a[52:55], v[84:87]
 ds_read_b128 a[124:127], v2 offset:64512
 v_add_f32 v28, v24, v28
M v[84:87], a[80:83], a[48:51], v[84:87]
 v_exp_f32 v20, v118
M v[84:87], a[76:79], a[44:47], v[84:87]
 v_exp_f32 v21, v119
M v[84:87], a[72:75], a[40:43], v[84:87]
 v_exp_f32 v22, v124
M v[84:87], a[68:71], a[36:39], v[84:87]
 s_waitcnt vmcnt(16) lgkmcnt(0)
 v_exp_f32 v23, v125
M v[84:87], a[64:67], a[32:35], v[84:87]
 s_barrier
M v[88:91], a[96:99], a[0:3], v[88:91]
 ds_read_b128 a[64:67], v7 offset:0
 v_cvt_pk_bf16_f32 v59, v24, v25
M v[88:91], a[100:103], a[4:7], v[88:91]
 ds_read_b128 a[68:71], v7 offset:1024
 v_add_f32 v28, v25, v28
M v[88:91], a[104:107], a[8:11], v[88:91]
 v_exp_f32 v24, v126
M v[88:91], a[108:111], a[12:15], v[88:91]
 ds_read_b128 a[72:75], v7 offset:2048
 v_add_f32 v29, v18, v29
M v[88:91], a[112:115], a[16:19], v[88:91]
 ds_read_b128 a[76:79], v7 offset:3072
 v_cvt_pk_bf16_f32 v60, v18, v19
M v[88:91], a[116:119], a[20:23], v[88:91]
 v_exp_f32 v25, v127
M v[88:91], a[120:123], a[24:27], v[88:91]
 ds_read_b128 a[80:83], v7 offset:4096
 v_add_f32 v29, v19, v29
M v[88:91], a[124:127], a[28:31], v[88:91]
 ds_read_b128 a[84:87], v7 offset:5120
 v_add_f32 v29, v20, v29
M v[92:95], a[124:127], a[60:63], v[36:39]
 v_cvt_pk_bf16_f32 v61, v20, v21
 v_add_f32 v29, v21, v29
M v[92:95], a[120:123], a[56:59], v[92:95]
 ds_read_b128 a[88:91], v7 offset:6144
 v_add_f32 v29, v22, v29
M v[92:95], a[116:119], a[52:55], v[92:95]
 ds_read_b128 a[92:95], v7 offset:7168
 v_cvt_pk_bf16_f32 v62, v22, v23
M v[92:95], a[112:115], a[48:51], v[92:95]
 v_add_f32 v29, v23, v29
 v_add_f32 v29, v24, v29
M v[92:95], a[108:111], a[44:47], v[92:95]
 v_cvt_pk_bf16_f32 v63, v24, v25
 v_add_f32 v29, v25, v29
M v[92:95], a[104:107], a[40:43], v[92:95]
M v[92:95], a[100:103], a[36:39], v[92:95]
 s_waitcnt lgkmcnt(0)
M v[92:95], a[96:99], a[32:35], v[92:95]
 v_max_f32 v10, v28, v29
 v_cmp_lt_f32 vcc, s31, v10
 s_nop 0
 s_cbranch_vccnz L_st5
L_rt5:
M v[128:131], a[64:67], v[48:51], v[128:131]
 s_add_u32 m0, s28, 98304
 ds_read_b128 a[96:99], v7 offset:8192
 v_add_f32 v30, v28, v30
M v[128:131], a[68:71], v[56:59], v[128:131]
 ds_read_b128 a[100:103], v7 offset:9216
 v_add_f32 v31, v29, v31
M v[132:135], a[68:71], v[60:63], v[132:135]
 buffer_load_dwordx4 v3, s[8:11], s21 offen offset:0 sc1 lds
M v[132:135], a[64:67], v[52:55], v[132:135]
 s_cmp_eq_u32 s20, 3
 ds_read_b128 a[104:107], v7 offset:10240
M v[136:139], a[72:75], v[48:51], v[136:139]
 s_cselect_b64 s[64:65], s[16:17], 0
 ds_read_b128 a[108:111], v7 offset:11264
M v[136:139], a[76:79], v[56:59], v[136:139]
 buffer_load_dwordx4 v3, s[8:11], s21 offen offset:1024 sc1 lds
M v[140:143], a[76:79], v[60:63], v[140:143]
 s_cselect_b64 s[66:67], s[18:19], 0
 ds_read_b128 a[112:115], v7 offset:12288
M v[140:143], a[72:75], v[52:55], v[140:143]
 s_cselect_b64 s[68:69], s[48:49], 0
 ds_read_b128 a[116:119], v7 offset:13312
M v[144:147], a[80:83], v[48:51], v[144:147]
 s_cselect_b64 s[70:71], s[50:51], 0
 v_exp_f32 v18, v64
M v[144:147], a[84:87], v[56:59], v[144:147]
 s_cmp_gt_u32 s20, 2
 ds_read_b128 a[120:123], v7 offset:14336
M v[148:151], a[84:87], v[60:63], v[148:151]
 s_cselect_b64 s[78:79], -1, 0
 ds_read_b128 a[124:127], v7 offset:15360
M v[148:151], a[80:83], v[52:55], v[148:151]
 buffer_load_dwordx4 v3, s[8:11], s21 offen offset:2048 sc1 lds
M v[152:155], a[88:91], v[48:51], v[152:155]
 v_exp_f32 v19, v65
M v[152:155], a[92:95], v[56:59], v[152:155]
 v_exp_f32 v20, v66
M v[156:159], a[92:95], v[60:63], v[156:159]
 buffer_load_dwordx4 v3, s[8:11], s21 offen offset:3072 sc1 lds
M v[156:159], a[88:91], v[52:55], v[156:159]
 s_waitcnt lgkmcnt(0)
 v_exp_f32 v21, v67
M v[160:163], a[96:99], v[48:51], v[160:163]
 ds_read_b128 a[64:67], v7 offset:16384
 v_add_f32 v26, v18, v19
M v[160:163], a[100:103], v[56:59], v[160:163]
 s_add_u32 m0, s28, 102400
 ds_read_b128 a[68:71], v7 offset:17408
 v_cvt_pk_bf16_f32 v40, v18, v19
M v[164:167], a[100:103], v[60:63], v[164:167]
 buffer_load_dwordx4 v4, s[8:11], s21 offen offset:0 sc1 lds
M v[164:167], a[96:99], v[52:55], v[164:167]
 s_cmp_eq_u32 s20, 2
 ds_read_b128 a[72:75], v7 offset:18432
 v_add_f32 v26, v20, v26
M v[168:171], a[104:107], v[48:51], v[168:171]
 s_cselect_b64 s[72:73], s[16:17], s[78:79]
 ds_read_b128 a[76:79], v7 offset:19456
 v_cvt_pk_bf16_f32 v41, v20, v21
M v[168:171], a[108:111], v[56:59], v[168:171]
 s_cselect_b64 s[74:75], s[18:19], s[78:79]
 v_exp_f32 v22, v72
M v[172:175], a[108:111], v[60:63], v[172:175]
 s_cselect_b64 s[76:77], s[48:49], s[78:79]
 ds_read_b128 a[80:83], v7 offset:20480
 v_add_f32 v26, v21, v26
M v[172:175], a[104:107], v[52:55], v[172:175]
 s_cselect_b64 s[78:79], s[50:51], s[78:79]
 ds_read_b128 a[84:87], v7 offset:21504
M v[176:179], a[112:115], v[48:51], v[176:179]
 buffer_load_dwordx4 v4, s[8:11], s21 offen offset:1024 sc1 lds
M v[176:179], a[116:119], v[56:59], v[176:179]
 s_cmp_gt_u32 s20, 1
 ds_read_b128 a[88:91], v7 offset:22528
M v[180:183], a[116:119], v[60:63], v[180:183]
 s_cselect_b64 s[86:87], -1, 0
 ds_read_b128 a[92:95], v7 offset:23552
M v[180:183], a[112:115], v[52:55], v[180:183]
 buffer_load_dwordx4 v4, s[8:11], s21 offen offset:2048 sc1 lds
M v[184:187], a[120:123], v[48:51], v[184:187]
 s_cmp_eq_u32 s20, 1
 v_exp_f32 v23, v73
M v[184:187], a[124:127], v[56:59], v[184:187]
 s_cselect_b64 s[80:81], s[16:17], s[86:87]
 v_exp_f32 v24, v74
M v[188:191], a[124:127], v[60:63], v[188:191]
 s_cselect_b64 s[82:83], s[18:19], s[86:87]
 v_exp_f32 v25, v75
M v[188:191], a[120:123], v[52:55], v[188:191]
 s_waitcnt lgkmcnt(0)
 v_exp_f32 v18, v68
M v[192:195], a[64:67], v[48:51], v[192:195]
 s_cselect_b64 s[84:85], s[48:49], s[86:87]
 ds_read_b128 a[96:99], v7 offset:24576
 v_add_f32 v26, v22, v26
M v[192:195], a[68:71], v[56:59], v[192:195]
 s_cselect_b64 s[86:87], s[50:51], s[86:87]
 ds_read_b128 a[100:103], v7 offset:25600
 v_cvt_pk_bf16_f32 v42, v22, v23
M v[196:199], a[68:71], v[60:63], v[196:199]
 buffer_load_dwordx4 v4, s[8:11], s21 offen offset:3072 sc1 lds
M v[196:199], a[64:67], v[52:55], v[196:199]
 s_add_u32 s24, s23, 16777216
 ds_read_b128 a[104:107], v7 offset:26624
 v_add_f32 v26, v23, v26
M v[200:203], a[72:75], v[48:51], v[200:203]
 s_mov_b32 s23, s21
 ds_read_b128 a[108:111], v7 offset:27648
 v_add_f32 v26, v24, v26
M v[200:203], a[76:79], v[56:59], v[200:203]
 s_add_u32 s21, s21, 32768
 v_exp_f32 v19, v69
M v[204:207], a[76:79], v[60:63], v[204:207]
 s_add_u32 s22, s22, 1
 ds_read_b128 a[112:115], v7 offset:28672
 v_cvt_pk_bf16_f32 v43, v24, v25
M v[204:207], a[72:75], v[52:55], v[204:207]
 s_cmp_eq_u32 s22, s25
 ds_read_b128 a[116:119], v7 offset:29696
 v_add_f32 v26, v25, v26
M v[208:211], a[80:83], v[48:51], v[208:211]
 s_cselect_b32 s21, s26, s21
 v_exp_f32 v20, v70
M v[208:211], a[84:87], v[56:59], v[208:211]
 s_cmp_eq_u32 s22, s43
 ds_read_b128 a[120:123], v7 offset:30720
 v_add_f32 v27, v18, v19
M v[212:215], a[84:87], v[60:63], v[212:215]
 s_cselect_b32 s21, s4, s21
 ds_read_b128 a[124:127], v7 offset:31744
 v_cvt_pk_bf16_f32 v44, v18, v19
M v[212:215], a[80:83], v[52:55], v[212:215]
 s_cmp_eq_u32 s22, s6
 v_exp_f32 v21, v71
M v[216:219], a[88:91], v[48:51], v[216:219]
 s_cselect_b32 s21, s7, s21
 v_exp_f32 v22, v76
M v[216:219], a[92:95], v[56:59], v[216:219]
 s_cmp_eq_u32 s20, 0
 v_exp_f32 v23, v77
M v[220:223], a[92:95], v[60:63], v[220:223]
 s_waitcnt vmcnt(16) lgkmcnt(0)
 v_exp_f32 v24, v78
M v[220:223], a[88:91], v[52:55], v[220:223]
 s_barrier
M v[224:227], a[96:99], v[48:51], v[224:227]
 s_cselect_b64 s[88:89], s[16:17], -1
 ds_read_b128 a[64:67], v7 offset:32768
 v_add_f32 v27, v20, v27
M v[224:227], a[100:103], v[56:59], v[224:227]
 s_cselect_b64 s[90:91], s[18:19], -1
 ds_read_b128 a[68:71], v7 offset:33792
 v_cvt_pk_bf16_f32 v45, v20, v21
M v[228:231], a[100:103], v[60:63], v[228:231]
 buffer_load_dword v5, off, s[8:11], s47 sc1
M v[228:231], a[96:99], v[52:55], v[228:231]
 s_cselect_b64 s[92:93], s[48:49], -1
 ds_read_b128 a[72:75], v7 offset:34816
 v_add_f32 v27, v21, v27
M v[232:235], a[104:107], v[48:51], v[232:235]
 s_cselect_b64 s[94:95], s[50:51], -1
 ds_read_b128 a[76:79], v7 offset:35840
 v_add_f32 v27, v22, v27
M v[232:235], a[108:111], v[56:59], v[232:235]
 v_cndmask_b32 v100, v36, v8, s[64:65]
 v_cndmask_b32 v101, v36, v8, s[66:67]
M v[236:239], a[108:111], v[60:63], v[236:239]
 ds_read_b128 a[80:83], v7 offset:36864
 v_cndmask_b32 v102, v36, v8, s[68:69]
M v[236:239], a[104:107], v[52:55], v[236:239]
 ds_read_b128 a[84:87], v7 offset:37888
 v_cndmask_b32 v103, v36, v8, s[70:71]
M v[240:243], a[112:115], v[48:51], v[240:243]
 v_cndmask_b32 v108, v36, v8, s[72:73]
 v_cndmask_b32 v109, v36, v8, s[74:75]
M v[240:243], a[116:119], v[56:59], v[240:243]
 ds_read_b128 a[88:91], v7 offset:38912
 v_cndmask_b32 v110, v36, v8, s[76:77]
M v[244:247], a[116:119], v[60:63], v[244:247]
 ds_read_b128 a[92:95], v7 offset:39936
 v_cndmask_b32 v111, v36, v8, s[78:79]
M v[244:247], a[112:115], v[52:55], v[244:247]
 v_cndmask_b32 v116, v36, v8, s[80:81]
 v_cndmask_b32 v117, v36, v8, s[82:83]
M v[248:251], a[120:123], v[48:51], v[248:251]
 v_cndmask_b32 v118, v36, v8, s[84:85]
 v_cndmask_b32 v119, v36, v8, s[86:87]
M v[248:251], a[124:127], v[56:59], v[248:251]
 v_cndmask_b32 v124, v36, v8, s[88:89]
 v_cndmask_b32 v125, v36, v8, s[90:91]
M v[252:255], a[124:127], v[60:63], v[252:255]
 s_waitcnt lgkmcnt(0)
 v_cndmask_b32 v126, v36, v8, s[92:93]
 v_cndmask_b32 v127, v36, v8, s[94:95]
M v[252:255], a[120:123], v[52:55], v[252:255]
 v_exp_f32 v25, v79
 v_cvt_pk_bf16_f32 v46, v22, v23
 v_add_f32 v27, v23, v27
 v_add_f32 v27, v24, v27
 v_cvt_pk_bf16_f32 v47, v24, v25
 v_add_f32 v27, v25, v27
L_p2:
M v[100:103], a[64:67], a[32:35], v[100:103]
 ds_read_b128 a[96:99], v7 offset:40960
 ds_read_b128 a[100:103], v7 offset:41984
 v_exp_f32 v18, v80
M v[100:103], a[68:71], a[36:39], v[100:103]
 ds_read_b128 a[104:107], v7 offset:43008
 v_exp_f32 v19, v81
M v[100:103], a[72:75], a[40:43], v[100:103]
 ds_read_b128 a[108:111], v7 offset:44032
 ds_read_b128 a[112:115], v7 offset:45056
 v_exp_f32 v20, v82
 v_add_f32 v26, v18, v26
M v[100:103], a[76:79], a[44:47], v[100:103]
 ds_read_b128 a[116:119], v7 offset:46080
 v_cvt_pk_bf16_f32 v56, v18, v19
 v_exp_f32 v21, v83
M v[100:103], a[80:83], a[48:51], v[100:103]
 s_add_u32 m0, s28, 0
 ds_read_b128 a[120:123], v7 offset:47104
 ds_read_b128 a[124:127], v7 offset:48128
 v_add_f32 v26, v19, v26
M v[100:103], a[84:87], a[52:55], v[100:103]
 buffer_load_dwordx4 v3, s[8:11], s24 offen offset:0 sc1 lds
M v[100:103], a[88:91], a[56:59], v[100:103]
 ds_read_b128 a[128:131], v7 offset:49152
 ds_read_b128 a[132:135], v7 offset:50176
 v_exp_f32 v22, v88
 v_add_f32 v26, v20, v26
 v_cvt_pk_bf16_f32 v57, v20, v21
M v[100:103], a[92:95], a[60:63], v[100:103]
 s_waitcnt lgkmcnt(2)
 ds_read_b128 a[136:139], v7 offset:51200
 v_exp_f32 v23, v89
 v_add_f32 v26, v21, v26
M v[108:111], a[124:127], a[60:63], v[108:111]
 ds_read_b128 a[140:143], v7 offset:52224
 ds_read_b128 a[144:147], v7 offset:53248
 v_exp_f32 v24, v90
M v[108:111], a[120:123], a[56:59], v[108:111]
 buffer_load_dwordx4 v3, s[8:11], s24 offen offset:1024 sc1 lds
M v[108:111], a[116:119], a[52:55], v[108:111]
 ds_read_b128 a[148:151], v7 offset:54272
 ds_read_b128 a[152:155], v7 offset:55296
 v_add_f32 v26, v22, v26
 v_cvt_pk_bf16_f32 v58, v22, v23
M v[108:111], a[112:115], a[48:51], v[108:111]
 ds_read_b128 a[156:159], v7 offset:56320
 v_exp_f32 v25, v91
 v_add_f32 v26, v23, v26
M v[108:111], a[108:111], a[44:47], v[108:111]
 ds_read_b128 a[160:163], v7 offset:57344
 ds_read_b128 a[164:167], v7 offset:58368
 v_exp_f32 v18, v84
M v[108:111], a[104:107], a[40:43], v[108:111]
 buffer_load_dwordx4 v3, s[8:11], s24 offen offset:2048 sc1 lds
M v[108:111], a[100:103], a[36:39], v[108:111]
 ds_read_b128 a[168:171], v7 offset:59392
 ds_read_b128 a[172:175], v7 offset:60416
 v_add_f32 v26, v24, v26
 v_cvt_pk_bf16_f32 v59, v24, v25
M v[108:111], a[96:99], a[32:35], v[108:111]
 s_waitcnt lgkmcnt(4)
 ds_read_b128 a[176:179], v7 offset:61440
 v_exp_f32 v19, v85
 v_add_f32 v26, v25, v26
M v[116:119], a[128:131], a[32:35], v[116:119]
 ds_read_b128 a[180:183], v7 offset:62464
 ds_read_b128 a[184:187], v7 offset:63488
 v_exp_f32 v20, v86
M v[116:119], a[132:135], a[36:39], v[116:119]
 ds_read_b128 a[188:191], v7 offset:64512
 v_add_f32 v27, v18, v27
 v_cvt_pk_bf16_f32 v60, v18, v19
M v[116:119], a[136:139], a[40:43], v[116:119]
 buffer_load_dwordx4 v3, s[8:11], s24 offen offset:3072 sc1 lds
M v[116:119], a[140:143], a[44:47], v[116:119]
 s_add_u32 m0, s28, 4096
 v_exp_f32 v21, v87
 v_add_f32 v27, v19, v27
 v_exp_f32 v22, v92
M v[116:119], a[144:147], a[48:51], v[116:119]
 buffer_load_dwordx4 v4, s[8:11], s24 offen offset:0 sc1 lds
M v[116:119], a[148:151], a[52:55], v[116:119]
 s_waitcnt vmcnt(14) lgkmcnt(0)
 v_add_f32 v27, v20, v27
 v_cvt_pk_bf16_f32 v61, v20, v21
 v_exp_f32 v23, v93
 v_add_f32 v27, v21, v27
M v[116:119], a[152:155], a[56:59], v[116:119]
 s_barrier
M v[116:119], a[156:159], a[60:63], v[116:119]
 ds_read_b128 a[64:67], v2 offset:0
 ds_read_b128 a[68:71], v2 offset:1024
 v_exp_f32 v24, v94
M v[124:127], a[188:191], a[60:63], v[124:127]
 ds_read_b128 a[72:75], v2 offset:2048
 v_add_f32 v27, v22, v27
 v_cvt_pk_bf16_f32 v62, v22, v23
M v[124:127], a[184:187], a[56:59], v[124:127]
 ds_read_b128 a[76:79], v2 offset:3072
 ds_read_b128 a[80:83], v2 offset:4096
 v_exp_f32 v25, v95
 v_add_f32 v27, v23, v27
M v[124:127], a[180:183], a[52:55], v[124:127]
 ds_read_b128 a[84:87], v2 offset:5120
 v_add_f32 v27, v24, v27
 v_cvt_pk_bf16_f32 v63, v24, v25
 v_add_f32 v27, v25, v27
M v[124:127], a[176:179], a[48:51], v[124:127]
 ds_read_b128 a[88:91], v2 offset:6144
 ds_read_b128 a[92:95], v2 offset:7168
 v_max_f32 v10, v26, v27
 v_cmp_lt_f32 vcc, s31, v10
M v[124:127], a[172:175], a[44:47], v[124:127]
 buffer_load_dwordx4 v4, s[8:11], s24 offen offset:1024 sc1 lds
M v[124:127], a[168:171], a[40:43], v[124:127]
 buffer_load_dwordx4 v4, s[8:11], s24 offen offset:2048 sc1 lds
M v[124:127], a[164:167], a[36:39], v[124:127]
 buffer_load_dwordx4 v4, s[8:11], s24 offen offset:3072 sc1 lds
M v[124:127], a[160:163], a[32:35], v[124:127]
 s_waitcnt lgkmcnt(0)
 s_cbranch_vccnz L_st6
L_rt6:
 s_cmp_le_u32 s42, 5
 s_cbranch_scc1 L_p3k
L_p3o:
M v[128:131], a[64:67], v[40:43], v[128:131]
 s_add_u32 m0, s28, 32768
 ds_read_b128 a[96:99], v2 offset:8192
 v_add_f32 v30, v26, v30
M v[128:131], a[68:71], v[56:59], v[128:131]
 ds_read_b128 a[100:103], v2 offset:9216
 v_add_f32 v31, v27, v31
M v[132:135], a[68:71], v[60:63], v[132:135]
 buffer_load_dwordx4 v3, s[8:11], s21 offen offset:0 sc1 lds
M v[132:135], a[64:67], v[44:47], v[132:135]
 ds_read_b128 a[104:107], v2 offset:10240
M v[136:139], a[72:75], v[40:43], v[136:139]
 ds_read_b128 a[108:111], v2 offset:11264
M v[136:139], a[76:79], v[56:59], v[136:139]
 buffer_load_dwordx4 v3, s[8:11], s21 offen offset:1024 sc1 lds
M v[140:143], a[76:79], v[60:63], v[140:143]
 ds_read_b128 a[112:115], v2 offset:12288
M v[140:143], a[72:75], v[44:47], v[140:143]
 ds_read_b128 a[116:119], v2 offset:13312
M v[144:147], a[80:83], v[40:43], v[144:147]
 v_exp_f32 v18, v100
M v[144:147], a[84:87], v[56:59], v[144:147]
 ds_read_b128 a[120:123], v2 offset:14336
M v[148:151], a[84:87], v[60:63], v[148:151]
 ds_read_b128 a[124:127], v2 offset:15360
M v[148:151], a[80:83], v[44:47], v[148:151]
 buffer_load_dwordx4 v3, s[8:11], s21 offen offset:2048 sc1 lds
M v[152:155], a[88:91], v[40:43], v[152:155]
 v_exp_f32 v19, v101
M v[152:155], a[92:95], v[56:59], v[152:155]
 v_exp_f32 v20, v102
M v[156:159], a[92:95], v[60:63], v[156:159]
 buffer_load_dwordx4 v3, s[8:11], s21 offen offset:3072 sc1 lds
M v[156:159], a[88:91], v[44:47], v[156:159]
 s_waitcnt lgkmcnt(0)
 v_exp_f32 v21, v103
M v[160:163], a[96:99], v[40:43], v[160:163]
 ds_read_b128 a[64:67], v2 offset:16384
 v_add_f32 v29, v18, v19
M v[160:163], a[100:103], v[56:59], v[160:163]
 s_add_u32 m0, s28, 36864
 ds_read_b128 a[68:71], v2 offset:17408
 v_cvt_pk_bf16_f32 v52, v18, v19
M v[164:167], a[100:103], v[60:63], v[164:167]
 buffer_load_dwordx4 v4, s[8:11], s21 offen offset:0 sc1 lds
M v[164:167], a[96:99], v[44:47], v[164:167]
 ds_read_b128 a[72:75], v2 offset:18432
 v_add_f32 v29, v20, v29
M v[168:171], a[104:107], v[40:43], v[168:171]
 ds_read_b128 a[76:79], v2 offset:19456
 v_cvt_pk_bf16_f32 v53, v20, v21
M v[168:171], a[108:111], v[56:59], v[168:171]
 v_exp_f32 v22, v108
M v[172:175], a[108:111], v[60:63], v[172:175]
 ds_read_b128 a[80:83], v2 offset:20480
 v_add_f32 v29, v21, v29
M v[172:175], a[104:107], v[44:47], v[172:175]
 ds_read_b128 a[84:87], v2 offset:21504
M v[176:179], a[112:115], v[40:43], v[176:179]
 buffer_load_dwordx4 v4, s[8:11], s21 offen offset:1024 sc1 lds
M v[176:179], a[116:119], v[56:59], v[176:179]
 ds_read_b128 a[88:91], v2 offset:22528
M v[180:183], a[116:119], v[60:63], v[180:183]
 ds_read_b128 a[92:95], v2 offset:23552
M v[180:183], a[112:115], v[44:47], v[180:183]
 buffer_load_dwordx4 v4, s[8:11], s21 offen offset:2048 sc1 lds
M v[184:187], a[120:123], v[40:43], v[184:187]
 v_exp_f32 v23, v109
M v[184:187], a[124:127], v[56:59], v[184:187]
 v_exp_f32 v24, v110
M v[188:191], a[124:127], v[60:63], v[188:191]
 v_exp_f32 v25, v111
M v[188:191], a[120:123], v[44:47], v[188:191]
 s_waitcnt lgkmcnt(0)
 v_exp_f32 v18, v116
M v[192:195], a[64:67], v[40:43], v[192:195]
 ds_read_b128 a[96:99], v2 offset:24576
 v_add_f32 v29, v22, v29
M v[192:195], a[68:71], v[56:59], v[192:195]
 ds_read_b128 a[100:103], v2 offset:25600
 v_cvt_pk_bf16_f32 v54, v22, v23
M v[196:199], a[68:71], v[60:63], v[196:199]
 buffer_load_dwordx4 v4, s[8:11], s21 offen offset:3072 sc1 lds
M v[196:199], a[64:67], v[44:47], v[196:199]
 s_add_u32 s24, s23, 16777216
 ds_read_b128 a[104:107], v2 offset:26624
 v_add_f32 v29, v23, v29
M v[200:203], a[72:75], v[40:43], v[200:203]
 s_mov_b32 s23, s21
 ds_read_b128 a[108:111], v2 offset:27648
 v_add_f32 v29, v24, v29
M v[200:203], a[76:79], v[56:59], v[200:203]
 s_add_u32 s21, s21, 32768
 v_exp_f32 v19, v117
M v[204:207], a[76:79], v[60:63], v[204:207]
 s_add_u32 s22, s22, 1
 ds_read_b128 a[112:115], v2 offset:28672
 v_cvt_pk_bf16_f32 v55, v24, v25
M v[204:207], a[72:75], v[44:47], v[204:207]
 s_cmp_eq_u32 s22, s25
 ds_read_b128 a[116:119], v2 offset:29696
 v_add_f32 v29, v25, v29
M v[208:211], a[80:83], v[40:43], v[208:211]
 s_cselect_b32 s21, s26, s21
 v_exp_f32 v20, v118
M v[208:211], a[84:87], v[56:59], v[208:211]
 s_cmp_eq_u32 s22, s43
 ds_read_b128 a[120:123], v2 offset:30720
 v_add_f32 v29, v18, v29
M v[212:215], a[84:87], v[60:63], v[212:215]
 s_cselect_b32 s21, s4, s21
 ds_read_b128 a[124:127], v2 offset:31744
 v_cvt_pk_bf16_f32 v48, v18, v19
M v[212:215], a[80:83], v[44:47], v[212:215]
 s_cmp_eq_u32 s22, s6
 v_exp_f32 v21, v119
M v[216:219], a[88:91], v[40:43], v[216:219]
 s_cselect_b32 s21, s7, s21
 v_exp_f32 v22, v124
M v[216:219], a[92:95], v[56:59], v[216:219]
 v_exp_f32 v23, v125
M v[220:223], a[92:95], v[60:63], v[220:223]
 s_waitcnt vmcnt(8) lgkmcnt(0)
 v_add_f32 v29, v19, v29
 v_add_f32 v29, v20, v29
M v[220:223], a[88:91], v[44:47], v[220:223]
 s_barrier
M v[224:227], a[96:99], v[40:43], v[224:227]
 ds_read_b128 a[64:67], v7 offset:0
 v_cvt_pk_bf16_f32 v49, v20, v21
M v[224:227], a[100:103], v[56:59], v[224:227]
 ds_read_b128 a[68:71], v7 offset:1024
 v_add_f32 v29, v21, v29
M v[228:231], a[100:103], v[60:63], v[228:231]
 v_exp_f32 v24, v126
M v[228:231], a[96:99], v[44:47], v[228:231]
 ds_read_b128 a[72:75], v7 offset:2048
 v_add_f32 v29, v22, v29
M v[232:235], a[104:107], v[40:43], v[232:235]
 ds_read_b128 a[76:79], v7 offset:3072
 v_cvt_pk_bf16_f32 v50, v22, v23
M v[232:235], a[108:111], v[56:59], v[232:235]
 v_exp_f32 v25, v127
M v[236:239], a[108:111], v[60:63], v[236:239]
 ds_read_b128 a[80:83], v7 offset:4096
 v_add_f32 v29, v23, v29
M v[236:239], a[104:107], v[44:47], v[236:239]
 ds_read_b128 a[84:87], v7 offset:5120
 v_add_f32 v29, v24, v29
M v[240:243], a[112:115], v[40:43], v[240:243]
 v_cvt_pk_bf16_f32 v51, v24, v25
 v_add_f32 v29, v25, v29
M v[240:243], a[116:119], v[56:59], v[240:243]
 ds_read_b128 a[88:91], v7 offset:6144
M v[244:247], a[116:119], v[60:63], v[244:247]
 ds_read_b128 a[92:95], v7 offset:7168
M v[244:247], a[112:115], v[44:47], v[244:247]
 v_cmp_lt_f32 vcc, s31, v29
M v[248:251], a[120:123], v[40:43], v[248:251]
M v[248:251], a[124:127], v[56:59], v[248:251]
M v[252:255], a[124:127], v[60:63], v[252:255]
 s_waitcnt lgkmcnt(0)
M v[252:255], a[120:123], v[44:47], v[252:255]
 s_cbranch_vccnz L_st2
L_rt2:
L_pBo:
M v[132:135], a[64:67], v[52:55], v[132:135]
 ds_read_b128 a[96:99], v7 offset:8192
 ds_read_b128 a[100:103], v7 offset:9216
M v[132:135], a[68:71], v[48:51], v[132:135]
 ds_read_b128 a[104:107], v7 offset:10240
 v_cvt_pk_bf16_f32 v128, v128, v129
 v_cvt_pk_bf16_f32 v129, v130, v131
M v[140:143], a[76:79], v[48:51], v[140:143]
 ds_read_b128 a[108:111], v7 offset:11264
 ds_read_b128 a[112:115], v7 offset:12288
 v_cvt_pk_bf16_f32 v130, v136, v137
M v[140:143], a[72:75], v[52:55], v[140:143]
 ds_read_b128 a[116:119], v7 offset:13312
 v_cvt_pk_bf16_f32 v131, v138, v139
 v_cvt_pk_bf16_f32 v144, v144, v145
M v[148:151], a[80:83], v[52:55], v[148:151]
 s_add_u32 m0, s28, 65536
 ds_read_b128 a[120:123], v7 offset:14336
 ds_read_b128 a[124:127], v7 offset:15360
M v[148:151], a[84:87], v[48:51], v[148:151]
 buffer_load_dwordx4 v3, s[8:11], s38 offen offset:0 sc1 lds
M v[156:159], a[92:95], v[48:51], v[156:159]
 ds_read_b128 a[128:131], v7 offset:16384
 ds_read_b128 a[132:135], v7 offset:17408
 v_cvt_pk_bf16_f32 v145, v146, v147
M v[156:159], a[88:91], v[52:55], v[156:159]
 s_waitcnt lgkmcnt(2)
 ds_read_b128 a[136:139], v7 offset:18432
 v_cvt_pk_bf16_f32 v146, v152, v153
 v_cvt_pk_bf16_f32 v147, v154, v155
M v[164:167], a[96:99], v[52:55], v[164:167]
 ds_read_b128 a[140:143], v7 offset:19456
 ds_read_b128 a[144:147], v7 offset:20480
 v_cvt_pk_bf16_f32 v160, v160, v161
M v[164:167], a[100:103], v[48:51], v[164:167]
 buffer_load_dwordx4 v3, s[8:11], s38 offen offset:1024 sc1 lds
M v[172:175], a[108:111], v[48:51], v[172:175]
 ds_read_b128 a[148:151], v7 offset:21504
 ds_read_b128 a[152:155], v7 offset:22528
 v_cvt_pk_bf16_f32 v161, v162, v163
M v[172:175], a[104:107], v[52:55], v[172:175]
 ds_read_b128 a[156:159], v7 offset:23552
 v_cvt_pk_bf16_f32 v162, v168, v169
 v_cvt_pk_bf16_f32 v163, v170, v171
M v[180:183], a[112:115], v[52:55], v[180:183]
 ds_read_b128 a[160:163], v7 offset:24576
 ds_read_b128 a[164:167], v7 offset:25600
 v_cvt_pk_bf16_f32 v176, v176, v177
M v[180:183], a[116:119], v[48:51], v[180:183]
 buffer_load_dwordx4 v3, s[8:11], s38 offen offset:2048 sc1 lds
M v[188:191], a[124:127], v[48:51], v[188:191]
 ds_read_b128 a[168:171], v7 offset:26624
 ds_read_b128 a[172:175], v7 offset:27648
 v_cvt_pk_bf16_f32 v177, v178, v179
M v[188:191], a[120:123], v[52:55], v[188:191]
 s_waitcnt lgkmcnt(4)
 ds_read_b128 a[176:179], v7 offset:28672
 v_cvt_pk_bf16_f32 v178, v184, v185
M v[196:199], a[128:131], v[52:55], v[196:199]
 ds_read_b128 a[180:183], v7 offset:29696
 ds_read_b128 a[184:187], v7 offset:30720
 v_cvt_pk_bf16_f32 v179, v186, v187
M v[196:199], a[132:135], v[48:51], v[196:199]
 ds_read_b128 a[188:191], v7 offset:31744
 v_cvt_pk_bf16_f32 v192, v192, v193
 v_cvt_pk_bf16_f32 v193, v194, v195
M v[204:207], a[140:143], v[48:51], v[204:207]
 buffer_load_dwordx4 v3, s[8:11], s38 offen offset:3072 sc1 lds
M v[204:207], a[136:139], v[52:55], v[204:207]
 s_add_u32 m0, s28, 69632
 v_cvt_pk_bf16_f32 v194, v200, v201
 v_cvt_pk_bf16_f32 v195, v202, v203
 v_cvt_pk_bf16_f32 v208, v208, v209
M v[212:215], a[144:147], v[52:55], v[212:215]
 buffer_load_dwordx4 v4, s[8:11], s38 offen offset:0 sc1 lds
M v[212:215], a[148:151], v[48:51], v[212:215]
 s_waitcnt lgkmcnt(0)
 v_cvt_pk_bf16_f32 v209, v210, v211
 v_cvt_pk_bf16_f32 v210, v216, v217
 v_cvt_pk_bf16_f32 v211, v218, v219
M v[220:223], a[156:159], v[48:51], v[220:223]
 s_barrier
M v[220:223], a[152:155], v[52:55], v[220:223]
 ds_read_b128 a[64:67], v2 offset:32768
 ds_read_b128 a[68:71], v2 offset:33792
 v_cvt_pk_bf16_f32 v224, v224, v225
M v[228:231], a[160:163], v[52:55], v[228:231]
 ds_read_b128 a[72:75], v2 offset:34816
 v_cvt_pk_bf16_f32 v225, v226, v227
 v_cvt_pk_bf16_f32 v226, v232, v233
M v[228:231], a[164:167], v[48:51], v[228:231]
 ds_read_b128 a[76:79], v2 offset:35840
 ds_read_b128 a[80:83], v2 offset:36864
M v[236:239], a[172:175], v[48:51], v[236:239]
 ds_read_b128 a[84:87], v2 offset:37888
 v_cvt_pk_bf16_f32 v227, v234, v235
 v_cvt_pk_bf16_f32 v240, v240, v241
M v[236:239], a[168:171], v[52:55], v[236:239]
 ds_read_b128 a[88:91], v2 offset:38912
 ds_read_b128 a[92:95], v2 offset:39936
 v_cvt_pk_bf16_f32 v241, v242, v243
M v[244:247], a[176:179], v[52:55], v[244:247]
 buffer_load_dwordx4 v4, s[8:11], s38 offen offset:1024 sc1 lds
M v[244:247], a[180:183], v[48:51], v[244:247]
 buffer_load_dwordx4 v4, s[8:11], s38 offen offset:2048 sc1 lds
M v[252:255], a[188:191], v[48:51], v[252:255]
 buffer_load_dwordx4 v4, s[8:11], s38 offen offset:3072 sc1 lds
M v[252:255], a[184:187], v[52:55], v[252:255]
 s_waitcnt lgkmcnt(0)
 s_add_u32 s38, s38, 32768
 v_cvt_pk_bf16_f32 v242, v248, v249
 v_cvt_pk_bf16_f32 v243, v250, v251
 s_branch L_op1
L_p1c:
 v_cndmask_b32 v64, v32, v8, s[64:65]
 v_cndmask_b32 v65, v32, v8, s[66:67]
 v_cndmask_b32 v66, v32, v8, s[68:69]
 v_cndmask_b32 v67, v32, v8, s[70:71]
 s_nop 1
M v[64:67], a[64:67], a[0:3], v[64:67]
 s_add_u32 m0, s28, 65536
 ds_read_b128 a[96:99], v2 offset:40960
 ds_read_b128 a[100:103], v2 offset:41984
M v[64:67], a[68:71], a[4:7], v[64:67]
 buffer_load_dwordx4 v3, s[8:11], s24 offen offset:0 sc1 lds
M v[64:67], a[72:75], a[8:11], v[64:67]
 v_exp_f32 v18, v112
M v[64:67], a[76:79], a[12:15], v[64:67]
 ds_read_b128 a[104:107], v2 offset:43008
 ds_read_b128 a[108:111], v2 offset:44032
M v[64:67], a[80:83], a[16:19], v[64:67]
 buffer_load_dwordx4 v[14:17], v7, s[8:11], s52 offen sc1
M v[64:67], a[84:87], a[20:23], v[64:67]
 s_cmp_eq_u32 s20, 3
 v_exp_f32 v19, v113
M v[64:67], a[88:91], a[24:27], v[64:67]
 s_cselect_b64 s[64:65], s[16:17], 0
 ds_read_b128 a[112:115], v2 offset:45056
 ds_read_b128 a[116:119], v2 offset:46080
M v[64:67], a[92:95], a[28:31], v[64:67]
 s_cselect_b64 s[66:67], s[18:19], 0
 v_exp_f32 v20, v114
M v[68:71], a[92:95], a[60:63], v[36:39]
 s_cselect_b64 s[68:69], s[48:49], 0
 v_add_f32 v28, v18, v28
 v_cvt_pk_bf16_f32 v56, v18, v19
M v[68:71], a[88:91], a[56:59], v[68:71]
 s_cselect_b64 s[70:71], s[50:51], 0
 ds_read_b128 a[120:123], v2 offset:47104
 ds_read_b128 a[124:127], v2 offset:48128
M v[68:71], a[84:87], a[52:55], v[68:71]
 buffer_load_dwordx4 v3, s[8:11], s24 offen offset:1024 sc1 lds
M v[68:71], a[80:83], a[48:51], v[68:71]
 v_cndmask_b32 v72, v32, v8, s[72:73]
 v_cndmask_b32 v73, v32, v8, s[74:75]
M v[68:71], a[76:79], a[44:47], v[68:71]
 v_cndmask_b32 v74, v32, v8, s[76:77]
 v_cndmask_b32 v75, v32, v8, s[78:79]
M v[68:71], a[72:75], a[40:43], v[68:71]
 buffer_load_dwordx4 a[128:131], v7, s[8:11], s12 offen offset:0 sc1
M v[68:71], a[68:71], a[36:39], v[68:71]
 buffer_load_dwordx4 a[132:135], v7, s[8:11], s12 offen offset:1024 sc1
M v[68:71], a[64:67], a[32:35], v[68:71]
 s_waitcnt lgkmcnt(0)
 v_exp_f32 v21, v115
M v[72:75], a[96:99], a[0:3], v[72:75]
 ds_read_b128 a[64:67], v2 offset:49152
 ds_read_b128 a[68:71], v2 offset:50176
M v[72:75], a[100:103], a[4:7], v[72:75]
 buffer_load_dwordx4 v3, s[8:11], s24 offen offset:2048 sc1 lds
M v[72:75], a[104:107], a[8:11], v[72:75]
 v_exp_f32 v22, v120
M v[72:75], a[108:111], a[12:15], v[72:75]
 ds_read_b128 a[72:75], v2 offset:51200
 ds_read_b128 a[76:79], v2 offset:52224
M v[72:75], a[112:115], a[16:19], v[72:75]
 buffer_load_dwordx4 v3, s[8:11], s24 offen offset:3072 sc1 lds
M v[72:75], a[116:119], a[20:23], v[72:75]
 s_cmp_gt_u32 s20, 2
 v_exp_f32 v23, v121
M v[72:75], a[120:123], a[24:27], v[72:75]
 s_cselect_b64 s[78:79], -1, 0
 ds_read_b128 a[80:83], v2 offset:53248
 ds_read_b128 a[84:87], v2 offset:54272
M v[72:75], a[124:127], a[28:31], v[72:75]
 s_cmp_eq_u32 s20, 2
 v_exp_f32 v24, v122
M v[76:79], a[124:127], a[60:63], v[36:39]
 s_cselect_b64 s[72:73], s[16:17], s[78:79]
 v_exp_f32 v25, v123
M v[76:79], a[120:123], a[56:59], v[76:79]
 s_cselect_b64 s[74:75], s[18:19], s[78:79]
 ds_read_b128 a[88:91], v2 offset:55296
 ds_read_b128 a[92:95], v2 offset:56320
M v[76:79], a[116:119], a[52:55], v[76:79]
 s_cselect_b64 s[76:77], s[48:49], s[78:79]
 v_add_f32 v28, v19, v28
 v_add_f32 v28, v20, v28
M v[76:79], a[112:115], a[48:51], v[76:79]
 s_cselect_b64 s[78:79], s[50:51], s[78:79]
 v_cndmask_b32 v80, v32, v8, s[80:81]
 v_cndmask_b32 v81, v32, v8, s[82:83]
M v[76:79], a[108:111], a[44:47], v[76:79]
 s_add_u32 m0, s28, 69632
 v_cndmask_b32 v82, v32, v8, s[84:85]
 v_cndmask_b32 v83, v32, v8, s[86:87]
M v[76:79], a[104:107], a[40:43], v[76:79]
 buffer_load_dwordx4 a[136:139], v7, s[8:11], s12 offen offset:2048 sc1
M v[76:79], a[100:103], a[36:39], v[76:79]
 buffer_load_dwordx4 v4, s[8:11], s24 offen offset:0 sc1 lds
M v[76:79], a[96:99], a[32:35], v[76:79]
 s_waitcnt lgkmcnt(0)
 v_exp_f32 v18, v116
M v[80:83], a[64:67], a[0:3], v[80:83]
 ds_read_b128 a[96:99], v2 offset:57344
 ds_read_b128 a[100:103], v2 offset:58368
M v[80:83], a[68:71], a[4:7], v[80:83]
 buffer_load_dwordx4 a[140:143], v7, s[8:11], s12 offen offset:3072 sc1
M v[80:83], a[72:75], a[8:11], v[80:83]
 buffer_load_dwordx4 v4, s[8:11], s24 offen offset:1024 sc1 lds
M v[80:83], a[76:79], a[12:15], v[80:83]
 ds_read_b128 a[104:107], v2 offset:59392
 ds_read_b128 a[108:111], v2 offset:60416
M v[80:83], a[80:83], a[16:19], v[80:83]
 buffer_load_dwordx4 a[144:147], v7, s[8:11], s13 offen offset:0 sc1
M v[80:83], a[84:87], a[20:23], v[80:83]
 s_cmp_gt_u32 s20, 1
 v_exp_f32 v19, v117
M v[80:83], a[88:91], a[24:27], v[80:83]
 s_cselect_b64 s[86:87], -1, 0
 ds_read_b128 a[112:115], v2 offset:61440
 ds_read_b128 a[116:119], v2 offset:62464
M v[80:83], a[92:95], a[28:31], v[80:83]
 s_cmp_eq_u32 s20, 1
 v_cvt_pk_bf16_f32 v57, v20, v21
 v_add_f32 v28, v21, v28
M v[84:87], a[92:95], a[60:63], v[36:39]
 s_cselect_b64 s[80:81], s[16:17], s[86:87]
 v_exp_f32 v20, v118
M v[84:87], a[88:91], a[56:59], v[84:87]
 s_cselect_b64 s[82:83], s[18:19], s[86:87]
 ds_read_b128 a[120:123], v2 offset:63488
 ds_read_b128 a[124:127], v2 offset:64512
M v[84:87], a[84:87], a[52:55], v[84:87]
 s_cselect_b64 s[84:85], s[48:49], s[86:87]
 v_exp_f32 v21, v119
M v[84:87], a[80:83], a[48:51], v[84:87]
 s_cselect_b64 s[86:87], s[50:51], s[86:87]
 v_cndmask_b32 v88, v32, v8, s[88:89]
 v_cndmask_b32 v89, v32, v8, s[90:91]
M v[84:87], a[76:79], a[44:47], v[84:87]
 v_cndmask_b32 v90, v32, v8, s[92:93]
 v_cndmask_b32 v91, v32, v8, s[94:95]
M v[84:87], a[72:75], a[40:43], v[84:87]
 buffer_load_dwordx4 v4, s[8:11], s24 offen offset:2048 sc1 lds
M v[84:87], a[68:71], a[36:39], v[84:87]
 s_waitcnt vmcnt(21) lgkmcnt(0)
 v_add_f32 v28, v22, v28
 v_cvt_pk_bf16_f32 v58, v22, v23
M v[84:87], a[64:67], a[32:35], v[84:87]
 s_barrier
M v[88:91], a[96:99], a[0:3], v[88:91]
 ds_read_b128 a[64:67], v7 offset:0
 ds_read_b128 a[68:71], v7 offset:1024
M v[88:91], a[100:103], a[4:7], v[88:91]
 s_cmp_eq_u32 s20, 0
 v_add_f32 v28, v23, v28
 v_add_f32 v28, v24, v28
M v[88:91], a[104:107], a[8:11], v[88:91]
 s_cselect_b64 s[88:89], s[16:17], -1
 v_exp_f32 v22, v124
M v[88:91], a[108:111], a[12:15], v[88:91]
 s_cselect_b64 s[90:91], s[18:19], -1
 ds_read_b128 a[72:75], v7 offset:2048
 ds_read_b128 a[76:79], v7 offset:3072
M v[88:91], a[112:115], a[16:19], v[88:91]
 s_cselect_b64 s[92:93], s[48:49], -1
 v_exp_f32 v23, v125
M v[88:91], a[116:119], a[20:23], v[88:91]
 s_cselect_b64 s[94:95], s[50:51], -1
 v_cvt_pk_bf16_f32 v59, v24, v25
 v_add_f32 v28, v25, v28
M v[88:91], a[120:123], a[24:27], v[88:91]
 ds_read_b128 a[80:83], v7 offset:4096
 ds_read_b128 a[84:87], v7 offset:5120
M v[88:91], a[124:127], a[28:31], v[88:91]
 buffer_load_dwordx4 a[148:151], v7, s[8:11], s13 offen offset:1024 sc1
M v[92:95], a[124:127], a[60:63], v[36:39]
 buffer_load_dwordx4 v4, s[8:11], s24 offen offset:3072 sc1 lds
M v[92:95], a[120:123], a[56:59], v[92:95]
 ds_read_b128 a[88:91], v7 offset:6144
 ds_read_b128 a[92:95], v7 offset:7168
M v[92:95], a[116:119], a[52:55], v[92:95]
 buffer_load_dwordx4 a[152:155], v7, s[8:11], s13 offen offset:2048 sc1
M v[92:95], a[112:115], a[48:51], v[92:95]
 v_exp_f32 v24, v126
M v[92:95], a[108:111], a[44:47], v[92:95]
 buffer_load_dwordx4 a[156:159], v7, s[8:11], s13 offen offset:3072 sc1
M v[92:95], a[104:107], a[40:43], v[92:95]
 v_exp_f32 v25, v127
M v[92:95], a[100:103], a[36:39], v[92:95]
 s_waitcnt lgkmcnt(0)
 v_add_f32 v29, v18, v29
 v_cvt_pk_bf16_f32 v60, v18, v19
M v[92:95], a[96:99], a[32:35], v[92:95]
 v_add_f32 v29, v19, v29
 v_add_f32 v29, v20, v29
 v_cvt_pk_bf16_f32 v61, v20, v21
 v_add_f32 v29, v21, v29
 v_add_f32 v29, v22, v29
 v_cvt_pk_bf16_f32 v62, v22, v23
 v_add_f32 v29, v23, v29
 v_add_f32 v29, v24, v29
 v_cvt_pk_bf16_f32 v63, v24, v25
 v_add_f32 v29, v25, v29
 v_max_f32 v10, v28, v29
 v_cmp_lt_f32 vcc, s31, v10
 s_nop 0
 s_cbranch_vccnz L_st3
L_rt3:
M v[128:131], a[64:67], v[48:51], v[128:131]
 s_add_u32 m0, s28, 98304
 ds_read_b128 a[96:99], v7 offset:8192
 ds_read_b128 a[100:103], v7 offset:9216
M v[128:131], a[68:71], v[56:59], v[128:131]
 buffer_load_dwordx4 v3, s[8:11], s21 offen offset:0 sc1 lds
M v[132:135], a[68:71], v[60:63], v[132:135]
 v_exp_f32 v18, v64
M v[132:135], a[64:67], v[52:55], v[132:135]
 ds_read_b128 a[104:107], v7 offset:10240
 ds_read_b128 a[108:111], v7 offset:11264
M v[136:139], a[72:75], v[48:51], v[136:139]
 buffer_load_dwordx4 a[160:163], v7, s[8:11], s14 offen offset:0 sc1
M v[136:139], a[76:79], v[56:59], v[136:139]
 v_cndmask_b32 v100, v36, v8, s[64:65]
 v_add_f32 v30, v28, v30
M v[140:143], a[76:79], v[60:63], v[140:143]
 ds_read_b128 a[112:115], v7 offset:12288
 ds_read_b128 a[116:119], v7 offset:13312
M v[140:143], a[72:75], v[52:55], v[140:143]
 buffer_load_dwordx4 v3, s[8:11], s21 offen offset:1024 sc1 lds
M v[144:147], a[80:83], v[48:51], v[144:147]
 v_cndmask_b32 v101, v36, v8, s[66:67]
 v_add_f32 v31, v29, v31
M v[144:147], a[84:87], v[56:59], v[144:147]
 ds_read_b128 a[120:123], v7 offset:14336
 ds_read_b128 a[124:127], v7 offset:15360
M v[148:151], a[84:87], v[60:63], v[148:151]
 buffer_load_dwordx4 a[164:167], v7, s[8:11], s14 offen offset:1024 sc1
M v[148:151], a[80:83], v[52:55], v[148:151]
 v_cndmask_b32 v102, v36, v8, s[68:69]
M v[152:155], a[88:91], v[48:51], v[152:155]
 buffer_load_dwordx4 v3, s[8:11], s21 offen offset:2048 sc1 lds
M v[152:155], a[92:95], v[56:59], v[152:155]
 v_exp_f32 v19, v65
M v[156:159], a[92:95], v[60:63], v[156:159]
 buffer_load_dwordx4 a[168:171], v7, s[8:11], s14 offen offset:2048 sc1
M v[156:159], a[88:91], v[52:55], v[156:159]
 s_waitcnt lgkmcnt(0)
 v_cndmask_b32 v103, v36, v8, s[70:71]
 v_add_f32 v26, v18, v19
M v[160:163], a[96:99], v[48:51], v[160:163]
 ds_read_b128 a[64:67], v7 offset:16384
 ds_read_b128 a[68:71], v7 offset:17408
M v[160:163], a[100:103], v[56:59], v[160:163]
 buffer_load_dwordx4 v3, s[8:11], s21 offen offset:3072 sc1 lds
M v[164:167], a[100:103], v[60:63], v[164:167]
 v_cndmask_b32 v108, v36, v8, s[72:73]
 v_cvt_pk_bf16_f32 v40, v18, v19
M v[164:167], a[96:99], v[52:55], v[164:167]
 ds_read_b128 a[72:75], v7 offset:18432
 ds_read_b128 a[76:79], v7 offset:19456
M v[168:171], a[104:107], v[48:51], v[168:171]
 buffer_load_dwordx4 a[172:175], v7, s[8:11], s14 offen offset:3072 sc1
M v[168:171], a[108:111], v[56:59], v[168:171]
 v_exp_f32 v20, v66
M v[172:175], a[108:111], v[60:63], v[172:175]
 s_add_u32 m0, s28, 102400
 ds_read_b128 a[80:83], v7 offset:20480
 ds_read_b128 a[84:87], v7 offset:21504
M v[172:175], a[104:107], v[52:55], v[172:175]
 buffer_load_dwordx4 v4, s[8:11], s21 offen offset:0 sc1 lds
M v[176:179], a[112:115], v[48:51], v[176:179]
 v_cndmask_b32 v109, v36, v8, s[74:75]
M v[176:179], a[116:119], v[56:59], v[176:179]
 ds_read_b128 a[88:91], v7 offset:22528
 ds_read_b128 a[92:95], v7 offset:23552
M v[180:183], a[116:119], v[60:63], v[180:183]
 buffer_load_dwordx4 a[176:179], v7, s[8:11], s15 offen offset:0 sc1
M v[180:183], a[112:115], v[52:55], v[180:183]
 v_cndmask_b32 v110, v36, v8, s[76:77]
M v[184:187], a[120:123], v[48:51], v[184:187]
 buffer_load_dwordx4 v4, s[8:11], s21 offen offset:1024 sc1 lds
M v[184:187], a[124:127], v[56:59], v[184:187]
 v_cndmask_b32 v111, v36, v8, s[78:79]
M v[188:191], a[124:127], v[60:63], v[188:191]
 buffer_load_dwordx4 a[180:183], v7, s[8:11], s15 offen offset:1024 sc1
M v[188:191], a[120:123], v[52:55], v[188:191]
 s_waitcnt lgkmcnt(0)
 v_exp_f32 v21, v67
M v[192:195], a[64:67], v[48:51], v[192:195]
 ds_read_b128 a[96:99], v7 offset:24576
 ds_read_b128 a[100:103], v7 offset:25600
M v[192:195], a[68:71], v[56:59], v[192:195]
 buffer_load_dwordx4 v4, s[8:11], s21 offen offset:2048 sc1 lds
M v[196:199], a[68:71], v[60:63], v[196:199]
 v_cndmask_b32 v116, v36, v8, s[80:81]
 v_add_f32 v26, v20, v26
M v[196:199], a[64:67], v[52:55], v[196:199]
 ds_read_b128 a[104:107], v7 offset:26624
 ds_read_b128 a[108:111], v7 offset:27648
M v[200:203], a[72:75], v[48:51], v[200:203]
 buffer_load_dwordx4 a[184:187], v7, s[8:11], s15 offen offset:2048 sc1
M v[200:203], a[76:79], v[56:59], v[200:203]
 v_cndmask_b32 v117, v36, v8, s[82:83]
 v_cvt_pk_bf16_f32 v41, v20, v21
M v[204:207], a[76:79], v[60:63], v[204:207]
 ds_read_b128 a[112:115], v7 offset:28672
 ds_read_b128 a[116:119], v7 offset:29696
M v[204:207], a[72:75], v[52:55], v[204:207]
 buffer_load_dwordx4 v4, s[8:11], s21 offen offset:3072 sc1 lds
M v[208:211], a[80:83], v[48:51], v[208:211]
 s_add_u32 s24, s23, 16777216
 v_cndmask_b32 v118, v36, v8, s[84:85]
 v_add_f32 v26, v21, v26
M v[208:211], a[84:87], v[56:59], v[208:211]
 s_mov_b32 s23, s21
 ds_read_b128 a[120:123], v7 offset:30720
 ds_read_b128 a[124:127], v7 offset:31744
M v[212:215], a[84:87], v[60:63], v[212:215]
 buffer_load_dwordx4 a[188:191], v7, s[8:11], s15 offen offset:3072 sc1
M v[212:215], a[80:83], v[52:55], v[212:215]
 s_add_u32 s21, s21, 32768
 v_cndmask_b32 v119, v36, v8, s[86:87]
M v[216:219], a[88:91], v[48:51], v[216:219]
 s_add_u32 s22, s22, 1
 v_exp_f32 v22, v72
M v[216:219], a[92:95], v[56:59], v[216:219]
 s_cmp_eq_u32 s22, s25
 v_exp_f32 v23, v73
M v[220:223], a[92:95], v[60:63], v[220:223]
 s_waitcnt vmcnt(33) lgkmcnt(0)
 v_exp_f32 v24, v74
M v[220:223], a[88:91], v[52:55], v[220:223]
 s_barrier
M v[224:227], a[96:99], v[48:51], v[224:227]
 s_cselect_b32 s21, s26, s21
 ds_read_b128 a[64:67], v7 offset:32768
 ds_read_b128 a[68:71], v7 offset:33792
M v[224:227], a[100:103], v[56:59], v[224:227]
 s_cmp_eq_u32 s22, s43
 v_cndmask_b32 v124, v36, v8, s[88:89]
 v_add_f32 v26, v22, v26
M v[228:231], a[100:103], v[60:63], v[228:231]
 s_cselect_b32 s21, s4, s21
 v_exp_f32 v25, v75
M v[228:231], a[96:99], v[52:55], v[228:231]
 s_cmp_eq_u32 s22, s6
 ds_read_b128 a[72:75], v7 offset:34816
 ds_read_b128 a[76:79], v7 offset:35840
M v[232:235], a[104:107], v[48:51], v[232:235]
 s_cselect_b32 s21, s7, s21
 v_cndmask_b32 v125, v36, v8, s[90:91]
 v_cvt_pk_bf16_f32 v42, v22, v23
M v[232:235], a[108:111], v[56:59], v[232:235]
 v_exp_f32 v18, v68
M v[236:239], a[108:111], v[60:63], v[236:239]
 ds_read_b128 a[80:83], v7 offset:36864
 ds_read_b128 a[84:87], v7 offset:37888
M v[236:239], a[104:107], v[52:55], v[236:239]
 v_cndmask_b32 v126, v36, v8, s[92:93]
 v_add_f32 v26, v23, v26
M v[240:243], a[112:115], v[48:51], v[240:243]
 v_exp_f32 v19, v69
M v[240:243], a[116:119], v[56:59], v[240:243]
 ds_read_b128 a[88:91], v7 offset:38912
 ds_read_b128 a[92:95], v7 offset:39936
M v[244:247], a[116:119], v[60:63], v[244:247]
 v_cndmask_b32 v127, v36, v8, s[94:95]
 v_add_f32 v26, v24, v26
M v[244:247], a[112:115], v[52:55], v[244:247]
 v_exp_f32 v20, v70
M v[248:251], a[120:123], v[48:51], v[248:251]
 v_exp_f32 v21, v71
M v[248:251], a[124:127], v[56:59], v[248:251]
 v_exp_f32 v22, v76
M v[252:255], a[124:127], v[60:63], v[252:255]
 s_waitcnt lgkmcnt(0)
 v_exp_f32 v23, v77
M v[252:255], a[120:123], v[52:55], v[252:255]
 v_cvt_pk_bf16_f32 v43, v24, v25
 v_add_f32 v26, v25, v26
 v_add_f32 v27, v18, v19
 v_cvt_pk_bf16_f32 v44, v18, v19
 v_add_f32 v27, v20, v27
 v_cvt_pk_bf16_f32 v45, v20, v21
 v_add_f32 v27, v21, v27
 v_exp_f32 v24, v78
 v_add_f32 v27, v22, v27
 v_cvt_pk_bf16_f32 v46, v22, v23
 v_exp_f32 v25, v79
 v_add_f32 v27, v23, v27
 v_add_f32 v27, v24, v27
 v_cvt_pk_bf16_f32 v47, v24, v25
 v_add_f32 v27, v25, v27
 s_waitcnt vmcnt(31)
 v_cmp_neq_f32 vcc, v32, v14
 v_cmp_neq_f32 s[64:65], v36, v15
 s_nop 0
 s_or_b64 vcc, vcc, s[64:65]
 s_cbranch_vccnz L_comb
 v_add_f32 v30, v16, v30
 v_add_f32 v31, v17, v31
M v[100:103], a[64:67], a[32:35], v[100:103]
 ds_read_b128 a[96:99], v7 offset:40960
 ds_read_b128 a[100:103], v7 offset:41984
M v[100:103], a[68:71], a[36:39], v[100:103]
 ds_read_b128 a[104:107], v7 offset:43008
M v[100:103], a[72:75], a[40:43], v[100:103]
 ds_read_b128 a[108:111], v7 offset:44032
 ds_read_b128 a[112:115], v7 offset:45056
M v[100:103], a[76:79], a[44:47], v[100:103]
 ds_read_b128 a[116:119], v7 offset:46080
M v[100:103], a[80:83], a[48:51], v[100:103]
 s_add_u32 m0, s28, 0
 ds_read_b128 a[120:123], v7 offset:47104
 ds_read_b128 a[124:127], v7 offset:48128
M v[100:103], a[84:87], a[52:55], v[100:103]
 buffer_load_dwordx4 v3, s[8:11], s24 offen offset:0 sc1 lds
M v[100:103], a[88:91], a[56:59], v[100:103]
 ds_read_b128 a[0:3], v7 offset:49152
 ds_read_b128 a[4:7], v7 offset:50176
M v[100:103], a[92:95], a[60:63], v[100:103]
 s_waitcnt lgkmcnt(2)
 ds_read_b128 a[8:11], v7 offset:51200
M v[108:111], a[124:127], a[60:63], v[108:111]
 ds_read_b128 a[12:15], v7 offset:52224
 ds_read_b128 a[16:19], v7 offset:53248
M v[108:111], a[120:123], a[56:59], v[108:111]
 buffer_load_dwordx4 v3, s[8:11], s24 offen offset:1024 sc1 lds
M v[108:111], a[116:119], a[52:55], v[108:111]
 ds_read_b128 a[20:23], v7 offset:54272
 ds_read_b128 a[24:27], v7 offset:55296
M v[108:111], a[112:115], a[48:51], v[108:111]
 ds_read_b128 a[28:31], v7 offset:56320
M v[108:111], a[108:111], a[44:47], v[108:111]
 ds_read_b128 a[192:195], v7 offset:57344
 ds_read_b128 a[196:199], v7 offset:58368
M v[108:111], a[104:107], a[40:43], v[108:111]
 v_exp_f32 v18, v80
M v[108:111], a[100:103], a[36:39], v[108:111]
 ds_read_b128 a[200:203], v7 offset:59392
 ds_read_b128 a[204:207], v7 offset:60416
M v[108:111], a[96:99], a[32:35], v[108:111]
 s_waitcnt lgkmcnt(4)
 ds_read_b128 a[208:211], v7 offset:61440
M v[116:119], a[0:3], a[32:35], v[116:119]
 ds_read_b128 a[212:215], v7 offset:62464
 ds_read_b128 a[216:219], v7 offset:63488
M v[116:119], a[4:7], a[36:39], v[116:119]
 ds_read_b128 a[220:223], v7 offset:64512
M v[116:119], a[8:11], a[40:43], v[116:119]
 buffer_load_dwordx4 v3, s[8:11], s24 offen offset:2048 sc1 lds
M v[116:119], a[12:15], a[44:47], v[116:119]
 v_exp_f32 v19, v81
M v[116:119], a[16:19], a[48:51], v[116:119]
 buffer_load_dwordx4 v3, s[8:11], s24 offen offset:3072 sc1 lds
M v[116:119], a[20:23], a[52:55], v[116:119]
 v_exp_f32 v20, v82
M v[116:119], a[24:27], a[56:59], v[116:119]
 s_add_u32 m0, s28, 4096
 v_exp_f32 v21, v83
M v[116:119], a[28:31], a[60:63], v[116:119]
 s_waitcnt lgkmcnt(0)
 v_exp_f32 v22, v88
M v[124:127], a[220:223], a[60:63], v[124:127]
 buffer_load_dwordx4 v4, s[8:11], s24 offen offset:0 sc1 lds
M v[124:127], a[216:219], a[56:59], v[124:127]
 v_exp_f32 v23, v89
M v[124:127], a[212:215], a[52:55], v[124:127]
 v_exp_f32 v24, v90
M v[124:127], a[208:211], a[48:51], v[124:127]
 v_exp_f32 v25, v91
M v[124:127], a[204:207], a[44:47], v[124:127]
 v_add_f32 v26, v18, v26
 v_cvt_pk_bf16_f32 v56, v18, v19
M v[124:127], a[200:203], a[40:43], v[124:127]
 buffer_load_dwordx4 v4, s[8:11], s24 offen offset:1024 sc1 lds
M v[124:127], a[196:199], a[36:39], v[124:127]
 v_add_f32 v26, v19, v26
 v_add_f32 v26, v20, v26
M v[124:127], a[192:195], a[32:35], v[124:127]
 s_waitcnt vmcnt(22)
 v_exp_f32 v18, v84
M v[128:131], a[246:249], a[128:131], v[128:131]
 v_exp_f32 v19, v85
M v[136:139], a[244:247], a[128:131], v[136:139]
 v_cvt_pk_bf16_f32 v57, v20, v21
 v_add_f32 v26, v21, v26
M v[144:147], a[246:249], a[132:135], v[144:147]
 buffer_load_dwordx4 v4, s[8:11], s24 offen offset:2048 sc1 lds
M v[152:155], a[244:247], a[132:135], v[152:155]
 v_exp_f32 v20, v86
M v[160:163], a[246:249], a[136:139], v[160:163]
 v_add_f32 v26, v22, v26
 v_cvt_pk_bf16_f32 v58, v22, v23
M v[168:171], a[244:247], a[136:139], v[168:171]
 v_add_f32 v26, v23, v26
 v_add_f32 v26, v24, v26
M v[176:179], a[246:249], a[140:143], v[176:179]
 v_exp_f32 v21, v87
M v[184:187], a[244:247], a[140:143], v[184:187]
 buffer_load_dwordx4 v4, s[8:11], s24 offen offset:3072 sc1 lds
M v[192:195], a[246:249], a[144:147], v[192:195]
 v_cvt_pk_bf16_f32 v59, v24, v25
 v_add_f32 v26, v25, v26
M v[200:203], a[244:247], a[144:147], v[200:203]
 v_add_f32 v27, v18, v27
 v_cvt_pk_bf16_f32 v60, v18, v19
M v[208:211], a[246:249], a[148:151], v[208:211]
 v_exp_f32 v22, v92
M v[216:219], a[244:247], a[148:151], v[216:219]
 v_add_f32 v27, v19, v27
 v_add_f32 v27, v20, v27
M v[224:227], a[246:249], a[152:155], v[224:227]
 v_cvt_pk_bf16_f32 v61, v20, v21
 v_add_f32 v27, v21, v27
M v[232:235], a[244:247], a[152:155], v[232:235]
 s_waitcnt vmcnt(8)
 v_exp_f32 v23, v93
M v[240:243], a[246:249], a[156:159], v[240:243]
 v_add_f32 v27, v22, v27
 v_cvt_pk_bf16_f32 v62, v22, v23
M v[248:251], a[244:247], a[156:159], v[248:251]
 s_barrier
M v[132:135], a[246:249], a[160:163], v[132:135]
 ds_read_b128 a[64:67], v2 offset:0
 v_add_f32 v27, v23, v27
M v[140:143], a[244:247], a[160:163], v[140:143]
 ds_read_b128 a[68:71], v2 offset:1024
M v[148:151], a[246:249], a[164:167], v[148:151]
 v_exp_f32 v24, v94
M v[156:159], a[244:247], a[164:167], v[156:159]
 ds_read_b128 a[72:75], v2 offset:2048
M v[164:167], a[246:249], a[168:171], v[164:167]
 ds_read_b128 a[76:79], v2 offset:3072
M v[172:175], a[244:247], a[168:171], v[172:175]
 v_exp_f32 v25, v95
M v[180:183], a[246:249], a[172:175], v[180:183]
 ds_read_b128 a[80:83], v2 offset:4096
 v_add_f32 v27, v24, v27
M v[188:191], a[244:247], a[172:175], v[188:191]
 ds_read_b128 a[84:87], v2 offset:5120
 v_cvt_pk_bf16_f32 v63, v24, v25
M v[196:199], a[246:249], a[176:179], v[196:199]
 v_add_f32 v27, v25, v27
M v[204:207], a[244:247], a[176:179], v[204:207]
 ds_read_b128 a[88:91], v2 offset:6144
M v[212:215], a[246:249], a[180:183], v[212:215]
 ds_read_b128 a[92:95], v2 offset:7168
 v_max_f32 v10, v26, v27
M v[220:223], a[244:247], a[180:183], v[220:223]
 v_cmp_lt_f32 vcc, s31, v10
M v[228:231], a[246:249], a[184:187], v[228:231]
M v[236:239], a[244:247], a[184:187], v[236:239]
M v[244:247], a[246:249], a[188:191], v[244:247]
 s_waitcnt lgkmcnt(0)
M v[252:255], a[244:247], a[188:191], v[252:255]
 s_cbranch_vccnz L_st14
L_rt14:
 s_branch L_p3o
L_op1:
M v[64:67], a[64:67], v[128:131], 0
 ds_read_b128 a[96:99], v2 offset:40960
 ds_read_b128 a[100:103], v2 offset:41984
M v[64:67], a[68:71], v[144:147], v[64:67]
 ds_read_b128 a[104:107], v2 offset:43008
 v_cvt_pk_bf16_f32 v132, v132, v133
 v_cvt_pk_bf16_f32 v133, v134, v135
M v[64:67], a[72:75], v[160:163], v[64:67]
 ds_read_b128 a[108:111], v2 offset:44032
 ds_read_b128 a[112:115], v2 offset:45056
M v[64:67], a[76:79], v[176:179], v[64:67]
 ds_read_b128 a[116:119], v2 offset:46080
 v_cvt_pk_bf16_f32 v134, v140, v141
 v_cvt_pk_bf16_f32 v135, v142, v143
M v[64:67], a[80:83], v[192:195], v[64:67]
 s_add_u32 m0, s28, 0
 ds_read_b128 a[120:123], v2 offset:47104
 ds_read_b128 a[124:127], v2 offset:48128
M v[64:67], a[84:87], v[208:211], v[64:67]
 buffer_load_dwordx4 v3, s[8:11], s38 offen offset:0 sc1 lds
M v[64:67], a[88:91], v[224:227], v[64:67]
 ds_read_b128 a[128:131], v2 offset:49152
 ds_read_b128 a[132:135], v2 offset:50176
 v_cvt_pk_bf16_f32 v148, v148, v149
M v[64:67], a[92:95], v[240:243], v[64:67]
 s_waitcnt lgkmcnt(2)
 ds_read_b128 a[136:139], v2 offset:51200
 v_cvt_pk_bf16_f32 v149, v150, v151
M v[72:75], a[96:99], v[128:131], 0
 ds_read_b128 a[140:143], v2 offset:52224
 ds_read_b128 a[144:147], v2 offset:53248
M v[72:75], a[100:103], v[144:147], v[72:75]
 buffer_load_dwordx4 v3, s[8:11], s38 offen offset:1024 sc1 lds
M v[72:75], a[104:107], v[160:163], v[72:75]
 ds_read_b128 a[148:151], v2 offset:54272
 ds_read_b128 a[152:155], v2 offset:55296
 v_cvt_pk_bf16_f32 v150, v156, v157
M v[72:75], a[108:111], v[176:179], v[72:75]
 ds_read_b128 a[156:159], v2 offset:56320
 v_cvt_pk_bf16_f32 v151, v158, v159
M v[72:75], a[112:115], v[192:195], v[72:75]
 ds_read_b128 a[160:163], v2 offset:57344
 ds_read_b128 a[164:167], v2 offset:58368
 v_cvt_pk_bf16_f32 v164, v164, v165
M v[72:75], a[116:119], v[208:211], v[72:75]
 buffer_load_dwordx4 v3, s[8:11], s38 offen offset:2048 sc1 lds
M v[72:75], a[120:123], v[224:227], v[72:75]
 ds_read_b128 a[168:171], v2 offset:59392
 ds_read_b128 a[172:175], v2 offset:60416
M v[72:75], a[124:127], v[240:243], v[72:75]
 s_waitcnt lgkmcnt(4)
 ds_read_b128 a[176:179], v2 offset:61440
 v_cvt_pk_bf16_f32 v165, v166, v167
 v_cvt_pk_bf16_f32 v166, v172, v173
M v[80:83], a[128:131], v[128:131], 0
 ds_read_b128 a[180:183], v2 offset:62464
 ds_read_b128 a[184:187], v2 offset:63488
M v[80:83], a[132:135], v[144:147], v[80:83]
 ds_read_b128 a[188:191], v2 offset:64512
 v_cvt_pk_bf16_f32 v167, v174, v175
 v_cvt_pk_bf16_f32 v180, v180, v181
M v[80:83], a[136:139], v[160:163], v[80:83]
 buffer_load_dwordx4 v3, s[8:11], s38 offen offset:3072 sc1 lds
M v[80:83], a[140:143], v[176:179], v[80:83]
 s_add_u32 m0, s28, 4096
 v_cvt_pk_bf16_f32 v181, v182, v183
 v_cvt_pk_bf16_f32 v182, v188, v189
M v[80:83], a[144:147], v[192:195], v[80:83]
 buffer_load_dwordx4 v4, s[8:11], s38 offen offset:0 sc1 lds
M v[80:83], a[148:151], v[208:211], v[80:83]
 v_cvt_pk_bf16_f32 v183, v190, v191
 v_cvt_pk_bf16_f32 v196, v196, v197
M v[80:83], a[152:155], v[224:227], v[80:83]
 buffer_load_dwordx4 v4, s[8:11], s38 offen offset:1024 sc1 lds
M v[80:83], a[156:159], v[240:243], v[80:83]
 s_waitcnt lgkmcnt(0)
 v_cvt_pk_bf16_f32 v197, v198, v199
 v_cvt_pk_bf16_f32 v198, v204, v205
 v_cvt_pk_bf16_f32 v199, v206, v207
M v[88:91], a[160:163], v[128:131], 0
 v_cvt_pk_bf16_f32 v212, v212, v213
 v_cvt_pk_bf16_f32 v213, v214, v215
M v[88:91], a[164:167], v[144:147], v[88:91]
 v_cvt_pk_bf16_f32 v214, v220, v221
 v_cvt_pk_bf16_f32 v215, v222, v223
 v_cvt_pk_bf16_f32 v228, v228, v229
M v[88:91], a[168:171], v[160:163], v[88:91]
 buffer_load_dwordx4 v4, s[8:11], s38 offen offset:2048 sc1 lds
M v[88:91], a[172:175], v[176:179], v[88:91]
 v_cvt_pk_bf16_f32 v229, v230, v231
 v_cvt_pk_bf16_f32 v230, v236, v237
M v[88:91], a[176:179], v[192:195], v[88:91]
 v_cvt_pk_bf16_f32 v231, v238, v239
 v_cvt_pk_bf16_f32 v244, v244, v245
 v_cvt_pk_bf16_f32 v245, v246, v247
M v[88:91], a[180:183], v[208:211], v[88:91]
 buffer_load_dwordx4 v4, s[8:11], s38 offen offset:3072 sc1 lds
M v[88:91], a[184:187], v[224:227], v[88:91]
 v_cvt_pk_bf16_f32 v246, v252, v253
 v_cvt_pk_bf16_f32 v247, v254, v255
M v[88:91], a[188:191], v[240:243], v[88:91]
 s_add_u32 s38, s38, 32768
 v_add_f32 v31, v29, v31
 v_mov_b32 v10, v30
M v[68:71], a[64:67], v[132:135], 0
 s_add_u32 m0, s28, 131072
 v_mov_b32 v11, v31
 v_permlane16_swap_b32 v10, v30
M v[68:71], a[68:71], v[148:151], v[68:71]
 buffer_load_dwordx4 v3, s[8:11], s38 offen offset:0 sc1 lds
M v[68:71], a[72:75], v[164:167], v[68:71]
 v_permlane16_swap_b32 v11, v31
 v_add_f32 v30, v10, v30
M v[68:71], a[76:79], v[180:183], v[68:71]
 v_add_f32 v31, v11, v31
 v_mov_b32 v10, v30
M v[68:71], a[80:83], v[196:199], v[68:71]
 buffer_load_dwordx4 v3, s[8:11], s38 offen offset:1024 sc1 lds
M v[68:71], a[84:87], v[212:215], v[68:71]
 v_mov_b32 v11, v31
 v_permlane32_swap_b32 v10, v30
M v[68:71], a[88:91], v[228:231], v[68:71]
 v_permlane32_swap_b32 v11, v31
 v_add_f32 v30, v10, v30
M v[68:71], a[92:95], v[244:247], v[68:71]
 v_add_f32 v31, v11, v31
M v[76:79], a[96:99], v[132:135], 0
 buffer_load_dwordx4 v3, s[8:11], s38 offen offset:2048 sc1 lds
M v[76:79], a[100:103], v[148:151], v[76:79]
 v_rcp_f32 v5, v30
M v[76:79], a[104:107], v[164:167], v[76:79]
 v_rcp_f32 v6, v31
M v[76:79], a[108:111], v[180:183], v[76:79]
 buffer_load_dwordx4 v3, s[8:11], s38 offen offset:3072 sc1 lds
M v[76:79], a[112:115], v[196:199], v[76:79]
M v[76:79], a[116:119], v[212:215], v[76:79]
M v[76:79], a[120:123], v[228:231], v[76:79]
 s_waitcnt vmcnt(20)
M v[76:79], a[124:127], v[244:247], v[76:79]
 s_barrier
M v[84:87], a[128:131], v[132:135], 0
 ds_read_b128 a[64:67], v7 offset:32768
M v[84:87], a[132:135], v[148:151], v[84:87]
 s_add_u32 m0, s28, 135168
 ds_read_b128 a[68:71], v7 offset:33792
M v[84:87], a[136:139], v[164:167], v[84:87]
 buffer_load_dwordx4 v4, s[8:11], s38 offen offset:0 sc1 lds
M v[84:87], a[140:143], v[180:183], v[84:87]
 ds_read_b128 a[72:75], v7 offset:34816
M v[84:87], a[144:147], v[196:199], v[84:87]
 ds_read_b128 a[76:79], v7 offset:35840
M v[84:87], a[148:151], v[212:215], v[84:87]
 buffer_load_dwordx4 v4, s[8:11], s38 offen offset:1024 sc1 lds
M v[84:87], a[152:155], v[228:231], v[84:87]
 ds_read_b128 a[80:83], v7 offset:36864
M v[84:87], a[156:159], v[244:247], v[84:87]
 ds_read_b128 a[84:87], v7 offset:37888
M v[92:95], a[160:163], v[132:135], 0
 buffer_load_dwordx4 v4, s[8:11], s38 offen offset:2048 sc1 lds
M v[92:95], a[164:167], v[148:151], v[92:95]
 ds_read_b128 a[88:91], v7 offset:38912
M v[92:95], a[168:171], v[164:167], v[92:95]
 ds_read_b128 a[92:95], v7 offset:39936
M v[92:95], a[172:175], v[180:183], v[92:95]
 buffer_load_dwordx4 v4, s[8:11], s38 offen offset:3072 sc1 lds
M v[92:95], a[176:179], v[196:199], v[92:95]
 s_add_u32 s38, s38, 32768
M v[92:95], a[180:183], v[212:215], v[92:95]
M v[92:95], a[184:187], v[228:231], v[92:95]
 s_waitcnt lgkmcnt(0)
 s_cmp_eq_u32 s42, 6
M v[92:95], a[188:191], v[244:247], v[92:95]
 s_cbranch_scc1 L_y1
L_y1r:
M v[96:99], a[64:67], v[128:131], 0
 s_add_u32 m0, s28, 98304
 ds_read_b128 a[96:99], v7 offset:40960
M v[96:99], a[68:71], v[144:147], v[96:99]
 ds_read_b128 a[100:103], v7 offset:41984
M v[96:99], a[72:75], v[160:163], v[96:99]
 buffer_load_dwordx4 v3, s[8:11], s38 offen offset:0 sc1 lds
M v[96:99], a[76:79], v[176:179], v[96:99]
 ds_read_b128 a[104:107], v7 offset:43008
 s_add_u32 s29, s33, 0
M v[96:99], a[80:83], v[192:195], v[96:99]
 ds_read_b128 a[108:111], v7 offset:44032
 s_add_u32 s30, s33, 14336
M v[96:99], a[84:87], v[208:211], v[96:99]
 buffer_load_dwordx4 v3, s[8:11], s38 offen offset:1024 sc1 lds
M v[96:99], a[88:91], v[224:227], v[96:99]
 ds_read_b128 a[112:115], v7 offset:45056
 v_max3_f32 v32, |v64|, |v65|, |v66|
M v[96:99], a[92:95], v[240:243], v[96:99]
 ds_read_b128 a[116:119], v7 offset:46080
 v_max3_f32 v32, |v67|, |v72|, v32
M v[100:103], a[92:95], v[244:247], 0
 buffer_load_dwordx4 v3, s[8:11], s38 offen offset:2048 sc1 lds
M v[100:103], a[88:91], v[228:231], v[100:103]
 ds_read_b128 a[120:123], v7 offset:47104
 v_max3_f32 v32, |v73|, |v74|, v32
M v[100:103], a[84:87], v[212:215], v[100:103]
 ds_read_b128 a[124:127], v7 offset:48128
 v_mul_f32 v32, 2.0, v32
M v[100:103], a[80:83], v[196:199], v[100:103]
 buffer_load_dwordx4 v3, s[8:11], s38 offen offset:3072 sc1 lds
M v[100:103], a[76:79], v[180:183], v[100:103]
 s_add_u32 m0, s28, 102400
 v_mov_b32 v33, v32
 v_mov_b32 v34, v32
M v[100:103], a[72:75], v[164:167], v[100:103]
 buffer_load_dwordx4 v4, s[8:11], s38 offen offset:0 sc1 lds
M v[100:103], a[68:71], v[148:151], v[100:103]
 v_mov_b32 v35, v32
 v_mul_f32 v28, -v32, v5
M v[100:103], a[64:67], v[132:135], v[100:103]
 s_waitcnt lgkmcnt(0)
 v_mul_f32 v64, v5, v64
 v_mul_f32 v65, v5, v65
M v[104:107], a[96:99], v[128:131], 0
 ds_read_b128 a[64:67], v7 offset:49152
 v_mul_f32 v66, v5, v66
M v[104:107], a[100:103], v[144:147], v[104:107]
 ds_read_b128 a[68:71], v7 offset:50176
 v_mul_f32 v67, v5, v67
M v[104:107], a[104:107], v[160:163], v[104:107]
 buffer_load_dwordx4 v4, s[8:11], s38 offen offset:1024 sc1 lds
M v[104:107], a[108:111], v[176:179], v[104:107]
 ds_read_b128 a[72:75], v7 offset:51200
 v_mul_f32 v72, v5, v72
M v[104:107], a[112:115], v[192:195], v[104:107]
 ds_read_b128 a[76:79], v7 offset:52224
 v_mul_f32 v73, v5, v73
M v[104:107], a[116:119], v[208:211], v[104:107]
 buffer_load_dwordx4 v4, s[8:11], s38 offen offset:2048 sc1 lds
M v[104:107], a[120:123], v[224:227], v[104:107]
 ds_read_b128 a[80:83], v7 offset:53248
 v_mul_f32 v74, v5, v74
M v[104:107], a[124:127], v[240:243], v[104:107]
 ds_read_b128 a[84:87], v7 offset:54272
 v_mul_f32 v75, v5, v75
M v[108:111], a[124:127], v[244:247], 0
 buffer_load_dwordx4 v4, s[8:11], s38 offen offset:3072 sc1 lds
M v[108:111], a[120:123], v[228:231], v[108:111]
 s_add_u32 s38, s38, 32768
 ds_read_b128 a[88:91], v7 offset:55296
 v_cvt_pk_bf16_f32 v64, v64, v65
M v[108:111], a[116:119], v[212:215], v[108:111]
 ds_read_b128 a[92:95], v7 offset:56320
 v_cvt_pk_bf16_f32 v65, v66, v67
M v[108:111], a[112:115], v[196:199], v[108:111]
 v_cvt_pk_bf16_f32 v66, v72, v73
 v_cvt_pk_bf16_f32 v67, v74, v75
M v[108:111], a[108:111], v[180:183], v[108:111]
 buffer_store_dwordx4 v[64:67], v7, s[8:11], s29 offen offset:0 sc1
M v[108:111], a[104:107], v[164:167], v[108:111]
 v_max3_f32 v36, |v68|, |v69|, |v70|
 v_max3_f32 v36, |v71|, |v76|, v36
M v[108:111], a[100:103], v[148:151], v[108:111]
 v_max3_f32 v36, |v77|, |v78|, v36
 v_mul_f32 v36, 2.0, v36
M v[108:111], a[96:99], v[132:135], v[108:111]
 s_waitcnt lgkmcnt(0)
 v_mov_b32 v37, v36
 v_mov_b32 v38, v36
M v[112:115], a[64:67], v[128:131], 0
 ds_read_b128 a[96:99], v7 offset:57344
 v_mov_b32 v39, v36
M v[112:115], a[68:71], v[144:147], v[112:115]
 ds_read_b128 a[100:103], v7 offset:58368
 v_mul_f32 v29, -v36, v6
M v[112:115], a[72:75], v[160:163], v[112:115]
 v_mul_f32 v68, v6, v68
 v_mul_f32 v69, v6, v69
M v[112:115], a[76:79], v[176:179], v[112:115]
 ds_read_b128 a[104:107], v7 offset:59392
 v_mul_f32 v70, v6, v70
M v[112:115], a[80:83], v[192:195], v[112:115]
 ds_read_b128 a[108:111], v7 offset:60416
 v_mul_f32 v71, v6, v71
M v[112:115], a[84:87], v[208:211], v[112:115]
 v_mul_f32 v76, v6, v76
 v_mul_f32 v77, v6, v77
M v[112:115], a[88:91], v[224:227], v[112:115]
 ds_read_b128 a[112:115], v7 offset:61440
 v_mul_f32 v78, v6, v78
M v[112:115], a[92:95], v[240:243], v[112:115]
 ds_read_b128 a[116:119], v7 offset:62464
 v_mul_f32 v79, v6, v79
M v[116:119], a[92:95], v[244:247], 0
 v_cvt_pk_bf16_f32 v68, v68, v69
 v_cvt_pk_bf16_f32 v69, v70, v71
M v[116:119], a[88:91], v[228:231], v[116:119]
 ds_read_b128 a[120:123], v7 offset:63488
 v_cvt_pk_bf16_f32 v70, v76, v77
M v[116:119], a[84:87], v[212:215], v[116:119]
 ds_read_b128 a[124:127], v7 offset:64512
 v_cvt_pk_bf16_f32 v71, v78, v79
M v[116:119], a[80:83], v[196:199], v[116:119]
 buffer_store_dwordx4 v[68:71], v7, s[8:11], s30 offen offset:0 sc1
M v[116:119], a[76:79], v[180:183], v[116:119]
 v_mul_f32 v80, v5, v80
 v_mul_f32 v81, v5, v81
M v[116:119], a[72:75], v[164:167], v[116:119]
 v_mul_f32 v82, v5, v82
 v_mul_f32 v83, v5, v83
M v[116:119], a[68:71], v[148:151], v[116:119]
 s_waitcnt vmcnt(26) lgkmcnt(0)
 v_mul_f32 v88, v5, v88
 v_mul_f32 v89, v5, v89
M v[116:119], a[64:67], v[132:135], v[116:119]
 s_barrier
M v[120:123], a[96:99], v[128:131], 0
 ds_read_b128 a[64:67], v2 offset:0
 v_mul_f32 v90, v5, v90
M v[120:123], a[100:103], v[144:147], v[120:123]
 ds_read_b128 a[68:71], v2 offset:1024
 v_mul_f32 v91, v5, v91
M v[120:123], a[104:107], v[160:163], v[120:123]
 v_cvt_pk_bf16_f32 v80, v80, v81
 v_cvt_pk_bf16_f32 v81, v82, v83
M v[120:123], a[108:111], v[176:179], v[120:123]
 ds_read_b128 a[72:75], v2 offset:2048
 v_cvt_pk_bf16_f32 v82, v88, v89
M v[120:123], a[112:115], v[192:195], v[120:123]
 ds_read_b128 a[76:79], v2 offset:3072
 v_cvt_pk_bf16_f32 v83, v90, v91
M v[120:123], a[116:119], v[208:211], v[120:123]
 buffer_store_dwordx4 v[80:83], v7, s[8:11], s29 offen offset:1024 sc1
M v[120:123], a[120:123], v[224:227], v[120:123]
 ds_read_b128 a[80:83], v2 offset:4096
 v_mul_f32 v84, v6, v84
M v[120:123], a[124:127], v[240:243], v[120:123]
 ds_read_b128 a[84:87], v2 offset:5120
 v_mul_f32 v85, v6, v85
M v[124:127], a[124:127], v[244:247], 0
 v_mul_f32 v86, v6, v86
 v_mul_f32 v87, v6, v87
M v[124:127], a[120:123], v[228:231], v[124:127]
 ds_read_b128 a[88:91], v2 offset:6144
 v_mul_f32 v92, v6, v92
M v[124:127], a[116:119], v[212:215], v[124:127]
 ds_read_b128 a[92:95], v2 offset:7168
 v_mul_f32 v93, v6, v93
M v[124:127], a[112:115], v[196:199], v[124:127]
 v_mul_f32 v94, v6, v94
 v_mul_f32 v95, v6, v95
M v[124:127], a[108:111], v[180:183], v[124:127]
 v_cvt_pk_bf16_f32 v84, v84, v85
 v_cvt_pk_bf16_f32 v85, v86, v87
M v[124:127], a[104:107], v[164:167], v[124:127]
 v_cvt_pk_bf16_f32 v86, v92, v93
 v_cvt_pk_bf16_f32 v87, v94, v95
M v[124:127], a[100:103], v[148:151], v[124:127]
 s_waitcnt lgkmcnt(0)
M v[124:127], a[96:99], v[132:135], v[124:127]
 buffer_store_dwordx4 v[84:87], v7, s[8:11], s30 offen offset:1024 sc1
M v[64:67], a[64:67], v[128:131], v[32:35]
 s_add_u32 m0, s28, 32768
 ds_read_b128 a[96:99], v2 offset:8192
M v[64:67], a[68:71], v[144:147], v[64:67]
 ds_read_b128 a[100:103], v2 offset:9216
 s_mov_b32 s79, 104923136
M v[64:67], a[72:75], v[160:163], v[64:67]
 buffer_load_dwordx4 v3, s[8:11], s38 offen offset:0 sc1 lds
M v[64:67], a[76:79], v[176:179], v[64:67]
 ds_read_b128 a[104:107], v2 offset:10240
 s_add_u32 s29, s33, 2048
M v[64:67], a[80:83], v[192:195], v[64:67]
 ds_read_b128 a[108:111], v2 offset:11264
 s_add_u32 s30, s33, 16384
M v[64:67], a[84:87], v[208:211], v[64:67]
 buffer_load_dwordx4 v3, s[8:11], s38 offen offset:1024 sc1 lds
M v[64:67], a[88:91], v[224:227], v[64:67]
 ds_read_b128 a[112:115], v2 offset:12288
 v_mul_f32 v96, v5, v96
M v[64:67], a[92:95], v[240:243], v[64:67]
 ds_read_b128 a[116:119], v2 offset:13312
 v_mul_f32 v97, v5, v97
M v[68:71], a[92:95], v[244:247], v[36:39]
 buffer_load_dwordx4 v3, s[8:11], s38 offen offset:2048 sc1 lds
M v[68:71], a[88:91], v[228:231], v[68:71]
 ds_read_b128 a[120:123], v2 offset:14336
 v_mul_f32 v98, v5, v98
M v[68:71], a[84:87], v[212:215], v[68:71]
 ds_read_b128 a[124:127], v2 offset:15360
 v_mul_f32 v99, v5, v99
M v[68:71], a[80:83], v[196:199], v[68:71]
 buffer_load_dwordx4 v3, s[8:11], s38 offen offset:3072 sc1 lds
M v[68:71], a[76:79], v[180:183], v[68:71]
 s_add_u32 m0, s28, 36864
 v_mul_f32 v104, v5, v104
 v_mul_f32 v105, v5, v105
M v[68:71], a[72:75], v[164:167], v[68:71]
 buffer_load_dwordx4 v4, s[8:11], s38 offen offset:0 sc1 lds
M v[68:71], a[68:71], v[148:151], v[68:71]
 buffer_load_dword v24, off, s[8:11], s79 sc1
M v[68:71], a[64:67], v[132:135], v[68:71]
 s_waitcnt lgkmcnt(0)
 v_lshrrev_b32 v0, 4, v7
 v_and_b32 v14, 15, v0
M v[72:75], a[96:99], v[128:131], v[32:35]
 ds_read_b128 a[64:67], v2 offset:16384
 v_lshlrev_b32 v14, 2, v14
M v[72:75], a[100:103], v[144:147], v[72:75]
 ds_read_b128 a[68:71], v2 offset:17408
 v_lshrrev_b32 v11, 4, v0
M v[72:75], a[104:107], v[160:163], v[72:75]
 buffer_load_dwordx4 v4, s[8:11], s38 offen offset:1024 sc1 lds
M v[72:75], a[108:111], v[176:179], v[72:75]
 ds_read_b128 a[72:75], v2 offset:18432
 s_mov_b32 s52, s96
M v[72:75], a[112:115], v[192:195], v[72:75]
 s_and_b32 s53, s97, 0xffff
 ds_read_b128 a[76:79], v2 offset:19456
 s_mov_b32 s54, 1835008
M v[72:75], a[116:119], v[208:211], v[72:75]
 buffer_load_dwordx4 v4, s[8:11], s38 offen offset:2048 sc1 lds
M v[72:75], a[120:123], v[224:227], v[72:75]
 ds_read_b128 a[80:83], v2 offset:20480
 s_mov_b32 s55, 0x20000
M v[72:75], a[124:127], v[240:243], v[72:75]
 s_lshr_b32 s74, s41, 3
 ds_read_b128 a[84:87], v2 offset:21504
 s_xor_b32 s74, s74, 0
M v[76:79], a[124:127], v[244:247], v[36:39]
 buffer_load_dwordx4 v4, s[8:11], s38 offen offset:3072 sc1 lds
M v[76:79], a[120:123], v[228:231], v[76:79]
 s_add_u32 s38, s38, 32768
 ds_read_b128 a[88:91], v2 offset:22528
 s_mul_i32 s67, s74, -2
M v[76:79], a[116:119], v[212:215], v[76:79]
 s_mul_i32 s74, s74, 8
 ds_read_b128 a[92:95], v2 offset:23552
 v_mul_f32 v106, v5, v106
M v[76:79], a[112:115], v[196:199], v[76:79]
 s_add_u32 s74, s74, s20
 v_mul_f32 v107, v5, v107
 v_cvt_pk_bf16_f32 v96, v96, v97
M v[76:79], a[108:111], v[180:183], v[76:79]
 s_lshl_b32 s75, s74, 6
 v_cvt_pk_bf16_f32 v97, v98, v99
 v_cvt_pk_bf16_f32 v98, v104, v105
M v[76:79], a[104:107], v[164:167], v[76:79]
 s_add_u32 s76, s75, 256
 v_cvt_pk_bf16_f32 v99, v106, v107
M v[76:79], a[100:103], v[148:151], v[76:79]
 s_add_u32 s67, s67, 3
 v_add_u32 v43, 0x20000, v7
 s_sub_u32 s67, s67, s20
M v[76:79], a[96:99], v[132:135], v[76:79]
 s_waitcnt lgkmcnt(0)
 s_and_b32 s67, s67, 536870912
M v[80:83], a[64:67], v[128:131], v[32:35]
 s_or_b32 s76, s76, s67
 ds_read_b128 a[96:99], v2 offset:24576
 v_or_b32 v27, s67, v7
M v[80:83], a[68:71], v[144:147], v[80:83]
 ds_read_b128 a[100:103], v2 offset:25600
 v_add_u32 v27, 4096, v27
M v[80:83], a[72:75], v[160:163], v[80:83]
 buffer_store_dwordx4 v[96:99], v7, s[8:11], s29 offen offset:0 sc1
M v[80:83], a[76:79], v[176:179], v[80:83]
 ds_read_b128 a[104:107], v2 offset:26624
 v_mul_f32 v100, v6, v100
M v[80:83], a[80:83], v[192:195], v[80:83]
 ds_read_b128 a[108:111], v2 offset:27648
 v_mul_f32 v101, v6, v101
M v[80:83], a[84:87], v[208:211], v[80:83]
 v_mul_f32 v102, v6, v102
 v_mul_f32 v103, v6, v103
M v[80:83], a[88:91], v[224:227], v[80:83]
 ds_read_b128 a[112:115], v2 offset:28672
 v_mul_f32 v108, v6, v108
M v[80:83], a[92:95], v[240:243], v[80:83]
 ds_read_b128 a[116:119], v2 offset:29696
 v_mul_f32 v109, v6, v109
M v[84:87], a[92:95], v[244:247], v[36:39]
 v_mul_f32 v110, v6, v110
 v_mul_f32 v111, v6, v111
M v[84:87], a[88:91], v[228:231], v[84:87]
 ds_read_b128 a[120:123], v2 offset:30720
 v_cvt_pk_bf16_f32 v100, v100, v101
M v[84:87], a[84:87], v[212:215], v[84:87]
 ds_read_b128 a[124:127], v2 offset:31744
 v_cvt_pk_bf16_f32 v101, v102, v103
M v[84:87], a[80:83], v[196:199], v[84:87]
 v_cvt_pk_bf16_f32 v102, v108, v109
 v_cvt_pk_bf16_f32 v103, v110, v111
M v[84:87], a[76:79], v[180:183], v[84:87]
 buffer_store_dwordx4 v[100:103], v7, s[8:11], s30 offen offset:0 sc1
M v[84:87], a[72:75], v[164:167], v[84:87]
 v_mul_f32 v112, v5, v112
 v_mul_f32 v113, v5, v113
M v[84:87], a[68:71], v[148:151], v[84:87]
 s_waitcnt vmcnt(31) lgkmcnt(0)
 v_mul_f32 v114, v5, v114
 v_mul_f32 v115, v5, v115
M v[84:87], a[64:67], v[132:135], v[84:87]
 s_barrier
M v[88:91], a[96:99], v[128:131], v[32:35]
 ds_read_b128 a[64:67], v7 offset:0
 v_mul_f32 v120, v5, v120
M v[88:91], a[100:103], v[144:147], v[88:91]
 ds_read_b128 a[68:71], v7 offset:1024
 v_mul_f32 v121, v5, v121
M v[88:91], a[104:107], v[160:163], v[88:91]
 v_mul_f32 v122, v5, v122
 v_mul_f32 v123, v5, v123
M v[88:91], a[108:111], v[176:179], v[88:91]
 ds_read_b128 a[72:75], v7 offset:2048
 v_cvt_pk_bf16_f32 v112, v112, v113
M v[88:91], a[112:115], v[192:195], v[88:91]
 ds_read_b128 a[76:79], v7 offset:3072
 v_cvt_pk_bf16_f32 v113, v114, v115
M v[88:91], a[116:119], v[208:211], v[88:91]
 v_cvt_pk_bf16_f32 v114, v120, v121
 v_cvt_pk_bf16_f32 v115, v122, v123
M v[88:91], a[120:123], v[224:227], v[88:91]
 ds_read_b128 a[80:83], v7 offset:4096
M v[88:91], a[124:127], v[240:243], v[88:91]
 ds_read_b128 a[84:87], v7 offset:5120
M v[92:95], a[124:127], v[244:247], v[36:39]
 buffer_store_dwordx4 v[112:115], v7, s[8:11], s29 offen offset:1024 sc1
M v[92:95], a[120:123], v[228:231], v[92:95]
 ds_read_b128 a[88:91], v7 offset:6144
 v_mul_f32 v116, v6, v116
M v[92:95], a[116:119], v[212:215], v[92:95]
 ds_read_b128 a[92:95], v7 offset:7168
 v_mul_f32 v117, v6, v117
M v[92:95], a[112:115], v[196:199], v[92:95]
 v_mul_f32 v118, v6, v118
 v_mul_f32 v119, v6, v119
M v[92:95], a[108:111], v[180:183], v[92:95]
 v_mul_f32 v124, v6, v124
 v_mul_f32 v125, v6, v125
M v[92:95], a[104:107], v[164:167], v[92:95]
 v_mul_f32 v126, v6, v126
 v_mul_f32 v127, v6, v127
M v[92:95], a[100:103], v[148:151], v[92:95]
 s_waitcnt lgkmcnt(0)
 v_cvt_pk_bf16_f32 v116, v116, v117
 v_cvt_pk_bf16_f32 v117, v118, v119
M v[92:95], a[96:99], v[132:135], v[92:95]
 v_cvt_pk_bf16_f32 v118, v124, v125
 v_cvt_pk_bf16_f32 v119, v126, v127
 buffer_store_dwordx4 v[116:119], v7, s[8:11], s30 offen offset:1024 sc1
M v[96:99], a[64:67], v[128:131], v[32:35]
 ds_read_b128 a[96:99], v7 offset:8192
M v[96:99], a[68:71], v[144:147], v[96:99]
 ds_read_b128 a[100:103], v7 offset:9216
M v[96:99], a[72:75], v[160:163], v[96:99]
 s_sub_u32 s64, 15, s42
M v[96:99], a[76:79], v[176:179], v[96:99]
 s_min_u32 s64, s64, s42
 ds_read_b128 a[104:107], v7 offset:10240
 s_add_u32 s29, s33, 4096
M v[96:99], a[80:83], v[192:195], v[96:99]
 s_mul_i32 s45, s64, 8704
 ds_read_b128 a[108:111], v7 offset:11264
 s_add_u32 s30, s33, 18432
M v[96:99], a[84:87], v[208:211], v[96:99]
 s_lshl_b32 s64, s20, 6
 v_fma_f32 v64, v64, v5, v28
 v_fma_f32 v65, v65, v5, v28
M v[96:99], a[88:91], v[224:227], v[96:99]
 s_add_u32 s64, s64, s41
 ds_read_b128 a[112:115], v7 offset:12288
 v_fma_f32 v66, v66, v5, v28
M v[96:99], a[92:95], v[240:243], v[96:99]
 s_lshl2_add_u32 s45, s64, s45
 ds_read_b128 a[116:119], v7 offset:13312
 v_fma_f32 v67, v67, v5, v28
M v[100:103], a[92:95], v[244:247], v[36:39]
 s_add_u32 s45, s45, 104992768
 v_fma_f32 v72, v72, v5, v28
M v[100:103], a[88:91], v[228:231], v[100:103]
 s_movk_i32 s65, 1024
 ds_read_b128 a[120:123], v7 offset:14336
 v_fma_f32 v73, v73, v5, v28
M v[100:103], a[84:87], v[212:215], v[100:103]
 s_cmp_lt_u32 s42, 8
 ds_read_b128 a[124:127], v7 offset:15360
 v_fma_f32 v74, v74, v5, v28
M v[100:103], a[80:83], v[196:199], v[100:103]
 s_cselect_b32 s64, 4352, s65
 v_fma_f32 v75, v75, v5, v28
M v[100:103], a[76:79], v[180:183], v[100:103]
 s_cselect_b32 s65, 0, 64
 v_cvt_pk_bf16_f32 v64, v64, v65
M v[100:103], a[72:75], v[164:167], v[100:103]
 s_cselect_b32 s66, 32, 64
 v_cvt_pk_bf16_f32 v65, v66, v67
M v[100:103], a[68:71], v[148:151], v[100:103]
 s_add_u32 s3, s45, s64
 s_add_u32 s45, s45, s65
 v_lshrrev_b32 v42, 5, v7
M v[100:103], a[64:67], v[132:135], v[100:103]
 s_waitcnt lgkmcnt(0)
 v_mul_u32_u24 v42, 4352, v42
 v_and_b32 v41, 16, v7
M v[104:107], a[96:99], v[128:131], v[32:35]
 ds_read_b128 a[64:67], v7 offset:16384
 v_lshl_add_u32 v41, v41, 3, v42
M v[104:107], a[100:103], v[144:147], v[104:107]
 ds_read_b128 a[68:71], v7 offset:17408
 v_mov_b32 v42, 536870912
M v[104:107], a[104:107], v[160:163], v[104:107]
 v_cmp_gt_u32 vcc, s66, v7
 v_mov_b32 v40, 1
M v[104:107], a[108:111], v[176:179], v[104:107]
 s_nop 0
 ds_read_b128 a[72:75], v7 offset:18432
 v_cndmask_b32 v41, v42, v41, vcc
M v[104:107], a[112:115], v[192:195], v[104:107]
 ds_read_b128 a[76:79], v7 offset:19456
 v_cvt_pk_bf16_f32 v66, v72, v73
M v[104:107], a[116:119], v[208:211], v[104:107]
 v_cvt_pk_bf16_f32 v67, v74, v75
M v[104:107], a[120:123], v[224:227], v[104:107]
 ds_read_b128 a[80:83], v7 offset:20480
M v[104:107], a[124:127], v[240:243], v[104:107]
 ds_read_b128 a[84:87], v7 offset:21504
M v[108:111], a[124:127], v[244:247], v[36:39]
 buffer_store_dwordx4 v[64:67], v7, s[8:11], s29 offen offset:0 sc1
M v[108:111], a[120:123], v[228:231], v[108:111]
 ds_read_b128 a[88:91], v7 offset:22528
 v_fma_f32 v68, v68, v6, v29
M v[108:111], a[116:119], v[212:215], v[108:111]
 ds_read_b128 a[92:95], v7 offset:23552
 v_fma_f32 v69, v69, v6, v29
M v[108:111], a[112:115], v[196:199], v[108:111]
 v_fma_f32 v70, v70, v6, v29
 v_fma_f32 v71, v71, v6, v29
M v[108:111], a[108:111], v[180:183], v[108:111]
 v_fma_f32 v76, v76, v6, v29
 v_fma_f32 v77, v77, v6, v29
M v[108:111], a[104:107], v[164:167], v[108:111]
 v_fma_f32 v78, v78, v6, v29
 v_fma_f32 v79, v79, v6, v29
M v[108:111], a[100:103], v[148:151], v[108:111]
 v_cvt_pk_bf16_f32 v68, v68, v69
 v_cvt_pk_bf16_f32 v69, v70, v71
M v[108:111], a[96:99], v[132:135], v[108:111]
 s_waitcnt lgkmcnt(0)
 v_cvt_pk_bf16_f32 v70, v76, v77
 v_cvt_pk_bf16_f32 v71, v78, v79
M v[112:115], a[64:67], v[128:131], v[32:35]
 ds_read_b128 a[96:99], v7 offset:24576
M v[112:115], a[68:71], v[144:147], v[112:115]
 ds_read_b128 a[100:103], v7 offset:25600
M v[112:115], a[72:75], v[160:163], v[112:115]
 buffer_store_dwordx4 v[68:71], v7, s[8:11], s30 offen offset:0 sc1
M v[112:115], a[76:79], v[176:179], v[112:115]
 ds_read_b128 a[104:107], v7 offset:26624
 v_fma_f32 v80, v80, v5, v28
M v[112:115], a[80:83], v[192:195], v[112:115]
 ds_read_b128 a[108:111], v7 offset:27648
 v_fma_f32 v81, v81, v5, v28
M v[112:115], a[84:87], v[208:211], v[112:115]
 v_fma_f32 v82, v82, v5, v28
 v_fma_f32 v83, v83, v5, v28
M v[112:115], a[88:91], v[224:227], v[112:115]
 ds_read_b128 a[112:115], v7 offset:28672
 v_fma_f32 v88, v88, v5, v28
M v[112:115], a[92:95], v[240:243], v[112:115]
 ds_read_b128 a[116:119], v7 offset:29696
 v_fma_f32 v89, v89, v5, v28
M v[116:119], a[92:95], v[244:247], v[36:39]
 v_fma_f32 v90, v90, v5, v28
 v_fma_f32 v91, v91, v5, v28
M v[116:119], a[88:91], v[228:231], v[116:119]
 ds_read_b128 a[120:123], v7 offset:30720
 v_cvt_pk_bf16_f32 v80, v80, v81
M v[116:119], a[84:87], v[212:215], v[116:119]
 ds_read_b128 a[124:127], v7 offset:31744
 v_cvt_pk_bf16_f32 v81, v82, v83
M v[116:119], a[80:83], v[196:199], v[116:119]
 v_cvt_pk_bf16_f32 v82, v88, v89
 v_cvt_pk_bf16_f32 v83, v90, v91
M v[116:119], a[76:79], v[180:183], v[116:119]
 buffer_store_dwordx4 v[80:83], v7, s[8:11], s29 offen offset:1024 sc1
M v[116:119], a[72:75], v[164:167], v[116:119]
 v_fma_f32 v84, v84, v6, v29
 v_fma_f32 v85, v85, v6, v29
M v[116:119], a[68:71], v[148:151], v[116:119]
 s_waitcnt vmcnt(28) lgkmcnt(0)
 v_fma_f32 v86, v86, v6, v29
M v[116:119], a[64:67], v[132:135], v[116:119]
 s_barrier
M v[120:123], a[96:99], v[128:131], v[32:35]
 ds_read_b128 a[64:67], v43 offset:0
 v_fma_f32 v87, v87, v6, v29
M v[120:123], a[100:103], v[144:147], v[120:123]
 ds_read_b128 a[68:71], v43 offset:1024
 v_fma_f32 v92, v92, v6, v29
M v[120:123], a[104:107], v[160:163], v[120:123]
 v_fma_f32 v93, v93, v6, v29
 v_fma_f32 v94, v94, v6, v29
M v[120:123], a[108:111], v[176:179], v[120:123]
 ds_read_b128 a[72:75], v43 offset:2048
 v_fma_f32 v95, v95, v6, v29
M v[120:123], a[112:115], v[192:195], v[120:123]
 ds_read_b128 a[76:79], v43 offset:3072
 v_cvt_pk_bf16_f32 v84, v84, v85
M v[120:123], a[116:119], v[208:211], v[120:123]
 v_cvt_pk_bf16_f32 v85, v86, v87
M v[120:123], a[120:123], v[224:227], v[120:123]
 ds_read_b128 a[80:83], v43 offset:4096
 v_cvt_pk_bf16_f32 v86, v92, v93
M v[120:123], a[124:127], v[240:243], v[120:123]
 ds_read_b128 a[84:87], v43 offset:5120
 v_cvt_pk_bf16_f32 v87, v94, v95
M v[124:127], a[124:127], v[244:247], v[36:39]
 buffer_store_dwordx4 v[84:87], v7, s[8:11], s30 offen offset:1024 sc1
M v[124:127], a[120:123], v[228:231], v[124:127]
 ds_read_b128 a[88:91], v43 offset:6144
M v[124:127], a[116:119], v[212:215], v[124:127]
 ds_read_b128 a[92:95], v43 offset:7168
M v[124:127], a[112:115], v[196:199], v[124:127]
M v[124:127], a[108:111], v[180:183], v[124:127]
M v[124:127], a[104:107], v[164:167], v[124:127]
M v[124:127], a[100:103], v[148:151], v[124:127]
 s_waitcnt lgkmcnt(0)
 s_cmp_eq_u32 s42, 6
M v[124:127], a[96:99], v[132:135], v[124:127]
 s_cbranch_scc1 L_y2
L_y2r:
M v[64:67], a[64:67], v[128:131], v[32:35]
 ds_read_b128 a[96:99], v43 offset:8192
M v[64:67], a[68:71], v[144:147], v[64:67]
 ds_read_b128 a[100:103], v43 offset:9216
M v[64:67], a[72:75], v[160:163], v[64:67]
 s_waitcnt vmcnt(11)
 v_cmp_gt_u32 vcc, 1, v24
M v[64:67], a[76:79], v[176:179], v[64:67]
 s_mov_b32 s65, 104890368
 ds_read_b128 a[104:107], v43 offset:10240
 s_add_u32 s29, s33, 6144
M v[64:67], a[80:83], v[192:195], v[64:67]
 s_cbranch_vccnz L_fhs1
L_fhr1:
 ds_read_b128 a[108:111], v43 offset:11264
 s_add_u32 s30, s33, 20480
M v[64:67], a[84:87], v[208:211], v[64:67]
 buffer_load_dword v25, v14, s[8:11], s65 offen sc1
M v[64:67], a[88:91], v[224:227], v[64:67]
 ds_read_b128 a[112:115], v43 offset:12288
 v_fma_f32 v96, v96, v5, v28
M v[64:67], a[92:95], v[240:243], v[64:67]
 ds_read_b128 a[116:119], v43 offset:13312
 v_fma_f32 v97, v97, v5, v28
M v[68:71], a[92:95], v[244:247], v[36:39]
 v_fma_f32 v98, v98, v5, v28
 v_fma_f32 v99, v99, v5, v28
M v[68:71], a[88:91], v[228:231], v[68:71]
 ds_read_b128 a[120:123], v43 offset:14336
 v_fma_f32 v104, v104, v5, v28
M v[68:71], a[84:87], v[212:215], v[68:71]
 ds_read_b128 a[124:127], v43 offset:15360
 v_fma_f32 v105, v105, v5, v28
M v[68:71], a[80:83], v[196:199], v[68:71]
 v_fma_f32 v106, v106, v5, v28
 v_fma_f32 v107, v107, v5, v28
M v[68:71], a[76:79], v[180:183], v[68:71]
 v_cvt_pk_bf16_f32 v96, v96, v97
M v[68:71], a[72:75], v[164:167], v[68:71]
 v_cvt_pk_bf16_f32 v97, v98, v99
M v[68:71], a[68:71], v[148:151], v[68:71]
 v_cvt_pk_bf16_f32 v98, v104, v105
M v[68:71], a[64:67], v[132:135], v[68:71]
 s_waitcnt lgkmcnt(0)
 v_cvt_pk_bf16_f32 v99, v106, v107
M v[72:75], a[96:99], v[128:131], v[32:35]
 ds_read_b128 a[64:67], v43 offset:16384
M v[72:75], a[100:103], v[144:147], v[72:75]
 ds_read_b128 a[68:71], v43 offset:17408
M v[72:75], a[104:107], v[160:163], v[72:75]
 buffer_store_dwordx4 v[96:99], v7, s[8:11], s29 offen offset:0 sc1
M v[72:75], a[108:111], v[176:179], v[72:75]
 ds_read_b128 a[72:75], v43 offset:18432
 v_fma_f32 v100, v100, v6, v29
M v[72:75], a[112:115], v[192:195], v[72:75]
 ds_read_b128 a[76:79], v43 offset:19456
 v_fma_f32 v101, v101, v6, v29
M v[72:75], a[116:119], v[208:211], v[72:75]
 v_fma_f32 v102, v102, v6, v29
 v_fma_f32 v103, v103, v6, v29
M v[72:75], a[120:123], v[224:227], v[72:75]
 ds_read_b128 a[80:83], v43 offset:20480
 v_fma_f32 v108, v108, v6, v29
M v[72:75], a[124:127], v[240:243], v[72:75]
 ds_read_b128 a[84:87], v43 offset:21504
 v_fma_f32 v109, v109, v6, v29
M v[76:79], a[124:127], v[244:247], v[36:39]
 v_fma_f32 v110, v110, v6, v29
 v_fma_f32 v111, v111, v6, v29
M v[76:79], a[120:123], v[228:231], v[76:79]
 ds_read_b128 a[88:91], v43 offset:22528
 v_cvt_pk_bf16_f32 v100, v100, v101
M v[76:79], a[116:119], v[212:215], v[76:79]
 ds_read_b128 a[92:95], v43 offset:23552
 v_cvt_pk_bf16_f32 v101, v102, v103
M v[76:79], a[112:115], v[196:199], v[76:79]
 v_cvt_pk_bf16_f32 v102, v108, v109
M v[76:79], a[108:111], v[180:183], v[76:79]
 v_cvt_pk_bf16_f32 v103, v110, v111
M v[76:79], a[104:107], v[164:167], v[76:79]
 buffer_store_dwordx4 v[100:103], v7, s[8:11], s30 offen offset:0 sc1
M v[76:79], a[100:103], v[148:151], v[76:79]
M v[76:79], a[96:99], v[132:135], v[76:79]
 s_waitcnt lgkmcnt(0)
 v_fma_f32 v112, v112, v5, v28
M v[80:83], a[64:67], v[128:131], v[32:35]
 ds_read_b128 a[96:99], v43 offset:24576
 v_fma_f32 v113, v113, v5, v28
M v[80:83], a[68:71], v[144:147], v[80:83]
 ds_read_b128 a[100:103], v43 offset:25600
 v_fma_f32 v114, v114, v5, v28
M v[80:83], a[72:75], v[160:163], v[80:83]
 v_fma_f32 v115, v115, v5, v28
M v[80:83], a[76:79], v[176:179], v[80:83]
 ds_read_b128 a[104:107], v43 offset:26624
 v_fma_f32 v120, v120, v5, v28
M v[80:83], a[80:83], v[192:195], v[80:83]
 ds_read_b128 a[108:111], v43 offset:27648
 v_fma_f32 v121, v121, v5, v28
M v[80:83], a[84:87], v[208:211], v[80:83]
 v_fma_f32 v122, v122, v5, v28
M v[80:83], a[88:91], v[224:227], v[80:83]
 ds_read_b128 a[112:115], v43 offset:28672
 v_fma_f32 v123, v123, v5, v28
M v[80:83], a[92:95], v[240:243], v[80:83]
 ds_read_b128 a[116:119], v43 offset:29696
 v_cvt_pk_bf16_f32 v112, v112, v113
M v[84:87], a[92:95], v[244:247], v[36:39]
 v_cvt_pk_bf16_f32 v113, v114, v115
 v_cvt_pk_bf16_f32 v114, v120, v121
M v[84:87], a[88:91], v[228:231], v[84:87]
 ds_read_b128 a[120:123], v43 offset:30720
 v_cvt_pk_bf16_f32 v115, v122, v123
M v[84:87], a[84:87], v[212:215], v[84:87]
 ds_read_b128 a[124:127], v43 offset:31744
M v[84:87], a[80:83], v[196:199], v[84:87]
 buffer_store_dwordx4 v[112:115], v7, s[8:11], s29 offen offset:1024 sc1
M v[84:87], a[76:79], v[180:183], v[84:87]
 v_fma_f32 v116, v116, v6, v29
M v[84:87], a[72:75], v[164:167], v[84:87]
 v_fma_f32 v117, v117, v6, v29
M v[84:87], a[68:71], v[148:151], v[84:87]
 s_waitcnt lgkmcnt(0)
 v_fma_f32 v118, v118, v6, v29
M v[84:87], a[64:67], v[132:135], v[84:87]
 s_barrier
M v[88:91], a[96:99], v[128:131], v[32:35]
 ds_read_b128 a[64:67], v2 offset:32768
 v_fma_f32 v119, v119, v6, v29
M v[88:91], a[100:103], v[144:147], v[88:91]
 ds_read_b128 a[68:71], v2 offset:33792
 v_fma_f32 v124, v124, v6, v29
M v[88:91], a[104:107], v[160:163], v[88:91]
 v_fma_f32 v125, v125, v6, v29
 v_fma_f32 v126, v126, v6, v29
M v[88:91], a[108:111], v[176:179], v[88:91]
 ds_read_b128 a[72:75], v2 offset:34816
 v_fma_f32 v127, v127, v6, v29
M v[88:91], a[112:115], v[192:195], v[88:91]
 ds_read_b128 a[76:79], v2 offset:35840
 v_cvt_pk_bf16_f32 v116, v116, v117
M v[88:91], a[116:119], v[208:211], v[88:91]
 v_cvt_pk_bf16_f32 v117, v118, v119
M v[88:91], a[120:123], v[224:227], v[88:91]
 ds_read_b128 a[80:83], v2 offset:36864
 v_cvt_pk_bf16_f32 v118, v124, v125
M v[88:91], a[124:127], v[240:243], v[88:91]
 ds_read_b128 a[84:87], v2 offset:37888
 v_cvt_pk_bf16_f32 v119, v126, v127
M v[92:95], a[124:127], v[244:247], v[36:39]
 buffer_store_dwordx4 v[116:119], v7, s[8:11], s30 offen offset:1024 sc1
M v[92:95], a[120:123], v[228:231], v[92:95]
 ds_read_b128 a[88:91], v2 offset:38912
M v[92:95], a[116:119], v[212:215], v[92:95]
 ds_read_b128 a[92:95], v2 offset:39936
M v[92:95], a[112:115], v[196:199], v[92:95]
M v[92:95], a[108:111], v[180:183], v[92:95]
M v[92:95], a[104:107], v[164:167], v[92:95]
M v[92:95], a[100:103], v[148:151], v[92:95]
 s_waitcnt lgkmcnt(0)
M v[92:95], a[96:99], v[132:135], v[92:95]
M v[96:99], a[64:67], v[128:131], v[32:35]
 ds_read_b128 a[96:99], v2 offset:40960
M v[96:99], a[68:71], v[144:147], v[96:99]
 ds_read_b128 a[100:103], v2 offset:41984
M v[96:99], a[72:75], v[160:163], v[96:99]
M v[96:99], a[76:79], v[176:179], v[96:99]
 ds_read_b128 a[104:107], v2 offset:43008
 s_add_u32 s29, s33, 8192
M v[96:99], a[80:83], v[192:195], v[96:99]
 ds_read_b128 a[108:111], v2 offset:44032
 s_add_u32 s30, s33, 22528
M v[96:99], a[84:87], v[208:211], v[96:99]
 v_fma_f32 v64, v64, v5, v28
 v_fma_f32 v65, v65, v5, v28
M v[96:99], a[88:91], v[224:227], v[96:99]
 ds_read_b128 a[112:115], v2 offset:45056
 v_fma_f32 v66, v66, v5, v28
M v[96:99], a[92:95], v[240:243], v[96:99]
 ds_read_b128 a[116:119], v2 offset:46080
 v_fma_f32 v67, v67, v5, v28
M v[100:103], a[92:95], v[244:247], v[36:39]
 v_fma_f32 v72, v72, v5, v28
M v[100:103], a[88:91], v[228:231], v[100:103]
 ds_read_b128 a[120:123], v2 offset:47104
 v_fma_f32 v73, v73, v5, v28
M v[100:103], a[84:87], v[212:215], v[100:103]
 ds_read_b128 a[124:127], v2 offset:48128
 v_fma_f32 v74, v74, v5, v28
M v[100:103], a[80:83], v[196:199], v[100:103]
 v_fma_f32 v75, v75, v5, v28
M v[100:103], a[76:79], v[180:183], v[100:103]
 v_cvt_pk_bf16_f32 v64, v64, v65
M v[100:103], a[72:75], v[164:167], v[100:103]
 v_cvt_pk_bf16_f32 v65, v66, v67
M v[100:103], a[68:71], v[148:151], v[100:103]
 v_cvt_pk_bf16_f32 v66, v72, v73
M v[100:103], a[64:67], v[132:135], v[100:103]
 s_waitcnt lgkmcnt(0)
 v_cvt_pk_bf16_f32 v67, v74, v75
M v[104:107], a[96:99], v[128:131], v[32:35]
 ds_read_b128 a[64:67], v2 offset:49152
M v[104:107], a[100:103], v[144:147], v[104:107]
 ds_read_b128 a[68:71], v2 offset:50176
M v[104:107], a[104:107], v[160:163], v[104:107]
 buffer_store_dwordx4 v[64:67], v7, s[8:11], s29 offen offset:0 sc1
M v[104:107], a[108:111], v[176:179], v[104:107]
 ds_read_b128 a[72:75], v2 offset:51200
 v_fma_f32 v68, v68, v6, v29
M v[104:107], a[112:115], v[192:195], v[104:107]
 ds_read_b128 a[76:79], v2 offset:52224
 v_fma_f32 v69, v69, v6, v29
M v[104:107], a[116:119], v[208:211], v[104:107]
 v_fma_f32 v70, v70, v6, v29
 v_fma_f32 v71, v71, v6, v29
M v[104:107], a[120:123], v[224:227], v[104:107]
 ds_read_b128 a[80:83], v2 offset:53248
 v_fma_f32 v76, v76, v6, v29
M v[104:107], a[124:127], v[240:243], v[104:107]
 ds_read_b128 a[84:87], v2 offset:54272
 v_fma_f32 v77, v77, v6, v29
M v[108:111], a[124:127], v[244:247], v[36:39]
 v_fma_f32 v78, v78, v6, v29
 v_fma_f32 v79, v79, v6, v29
M v[108:111], a[120:123], v[228:231], v[108:111]
 ds_read_b128 a[88:91], v2 offset:55296
 v_cvt_pk_bf16_f32 v68, v68, v69
M v[108:111], a[116:119], v[212:215], v[108:111]
 ds_read_b128 a[92:95], v2 offset:56320
 v_cvt_pk_bf16_f32 v69, v70, v71
M v[108:111], a[112:115], v[196:199], v[108:111]
 v_cvt_pk_bf16_f32 v70, v76, v77
M v[108:111], a[108:111], v[180:183], v[108:111]
 v_cvt_pk_bf16_f32 v71, v78, v79
M v[108:111], a[104:107], v[164:167], v[108:111]
 buffer_store_dwordx4 v[68:71], v7, s[8:11], s30 offen offset:0 sc1
M v[108:111], a[100:103], v[148:151], v[108:111]
M v[108:111], a[96:99], v[132:135], v[108:111]
 s_waitcnt lgkmcnt(0)
 v_fma_f32 v80, v80, v5, v28
M v[112:115], a[64:67], v[128:131], v[32:35]
 ds_read_b128 a[96:99], v2 offset:57344
 v_fma_f32 v81, v81, v5, v28
M v[112:115], a[68:71], v[144:147], v[112:115]
 ds_read_b128 a[100:103], v2 offset:58368
 v_fma_f32 v82, v82, v5, v28
M v[112:115], a[72:75], v[160:163], v[112:115]
 v_fma_f32 v83, v83, v5, v28
M v[112:115], a[76:79], v[176:179], v[112:115]
 ds_read_b128 a[104:107], v2 offset:59392
 v_fma_f32 v88, v88, v5, v28
M v[112:115], a[80:83], v[192:195], v[112:115]
 ds_read_b128 a[108:111], v2 offset:60416
 v_fma_f32 v89, v89, v5, v28
M v[112:115], a[84:87], v[208:211], v[112:115]
 v_fma_f32 v90, v90, v5, v28
M v[112:115], a[88:91], v[224:227], v[112:115]
 ds_read_b128 a[112:115], v2 offset:61440
 v_fma_f32 v91, v91, v5, v28
M v[112:115], a[92:95], v[240:243], v[112:115]
 ds_read_b128 a[116:119], v2 offset:62464
 v_cvt_pk_bf16_f32 v80, v80, v81
M v[116:119], a[92:95], v[244:247], v[36:39]
 s_waitcnt vmcnt(6)
 v_readlane_b32 s84, v25, 0
 v_readlane_b32 s85, v25, 1
M v[116:119], a[88:91], v[228:231], v[116:119]
 ds_read_b128 a[120:123], v2 offset:63488
 v_mov_b32 v24, 0x3f80
M v[116:119], a[84:87], v[212:215], v[116:119]
 ds_read_b128 a[124:127], v2 offset:64512
 v_mov_b32 v25, 0x3f800000
M v[116:119], a[80:83], v[196:199], v[116:119]
 v_cvt_pk_bf16_f32 v81, v82, v83
 v_cvt_pk_bf16_f32 v82, v88, v89
M v[116:119], a[76:79], v[180:183], v[116:119]
 v_cvt_pk_bf16_f32 v83, v90, v91
M v[116:119], a[72:75], v[164:167], v[116:119]
 buffer_store_dwordx4 v[80:83], v7, s[8:11], s29 offen offset:1024 sc1
M v[116:119], a[68:71], v[148:151], v[116:119]
 s_waitcnt lgkmcnt(0)
 v_fma_f32 v84, v84, v6, v29
 v_fma_f32 v85, v85, v6, v29
M v[116:119], a[64:67], v[132:135], v[116:119]
 s_barrier
M v[120:123], a[96:99], v[128:131], v[32:35]
 ds_read_b128 a[64:67], v7 offset:32768
 v_fma_f32 v86, v86, v6, v29
M v[120:123], a[100:103], v[144:147], v[120:123]
 ds_read_b128 a[68:71], v7 offset:33792
 v_fma_f32 v87, v87, v6, v29
M v[120:123], a[104:107], v[160:163], v[120:123]
 v_fma_f32 v92, v92, v6, v29
 v_fma_f32 v93, v93, v6, v29
M v[120:123], a[108:111], v[176:179], v[120:123]
 ds_read_b128 a[72:75], v7 offset:34816
 v_fma_f32 v94, v94, v6, v29
M v[120:123], a[112:115], v[192:195], v[120:123]
 ds_read_b128 a[76:79], v7 offset:35840
 v_fma_f32 v95, v95, v6, v29
M v[120:123], a[116:119], v[208:211], v[120:123]
 s_waitcnt vmcnt(3)
 v_cvt_pk_bf16_f32 v84, v84, v85
 v_cvt_pk_bf16_f32 v85, v86, v87
M v[120:123], a[120:123], v[224:227], v[120:123]
 ds_read_b128 a[80:83], v7 offset:36864
 v_cvt_pk_bf16_f32 v86, v92, v93
M v[120:123], a[124:127], v[240:243], v[120:123]
 ds_read_b128 a[84:87], v7 offset:37888
 v_cvt_pk_bf16_f32 v87, v94, v95
M v[124:127], a[124:127], v[244:247], v[36:39]
 buffer_store_dword v40, v41, s[8:11], s45 offen sc1
M v[124:127], a[120:123], v[228:231], v[124:127]
 ds_read_b128 a[88:91], v7 offset:38912
M v[124:127], a[116:119], v[212:215], v[124:127]
 ds_read_b128 a[92:95], v7 offset:39936
M v[124:127], a[112:115], v[196:199], v[124:127]
 buffer_store_dwordx4 v[84:87], v7, s[8:11], s30 offen offset:1024 sc1
M v[124:127], a[108:111], v[180:183], v[124:127]
M v[124:127], a[104:107], v[164:167], v[124:127]
M v[124:127], a[100:103], v[148:151], v[124:127]
 s_waitcnt lgkmcnt(0)
 s_cmp_eq_u32 s42, 6
M v[124:127], a[96:99], v[132:135], v[124:127]
 s_cbranch_scc1 L_y3
L_y3r:
M v[64:67], a[64:67], v[128:131], v[32:35]
 ds_read_b128 a[96:99], v7 offset:40960
M v[64:67], a[68:71], v[144:147], v[64:67]
 ds_read_b128 a[100:103], v7 offset:41984
M v[64:67], a[72:75], v[160:163], v[64:67]
M v[64:67], a[76:79], v[176:179], v[64:67]
 ds_read_b128 a[104:107], v7 offset:43008
 s_add_u32 s29, s33, 10240
M v[64:67], a[80:83], v[192:195], v[64:67]
 ds_read_b128 a[108:111], v7 offset:44032
 s_add_u32 s30, s33, 24576
M v[64:67], a[84:87], v[208:211], v[64:67]
 v_fma_f32 v96, v96, v5, v28
 v_fma_f32 v97, v97, v5, v28
M v[64:67], a[88:91], v[224:227], v[64:67]
 ds_read_b128 a[112:115], v7 offset:45056
 v_fma_f32 v98, v98, v5, v28
M v[64:67], a[92:95], v[240:243], v[64:67]
 ds_read_b128 a[116:119], v7 offset:46080
 v_fma_f32 v99, v99, v5, v28
M v[68:71], a[92:95], v[244:247], v[36:39]
 v_fma_f32 v104, v104, v5, v28
 v_fma_f32 v105, v105, v5, v28
M v[68:71], a[88:91], v[228:231], v[68:71]
 ds_read_b128 a[120:123], v7 offset:47104
 v_fma_f32 v106, v106, v5, v28
M v[68:71], a[84:87], v[212:215], v[68:71]
 ds_read_b128 a[124:127], v7 offset:48128
 v_fma_f32 v107, v107, v5, v28
M v[68:71], a[80:83], v[196:199], v[68:71]
 v_cvt_pk_bf16_f32 v96, v96, v97
 v_cvt_pk_bf16_f32 v97, v98, v99
M v[68:71], a[76:79], v[180:183], v[68:71]
 v_cvt_pk_bf16_f32 v98, v104, v105
 v_cvt_pk_bf16_f32 v99, v106, v107
M v[68:71], a[72:75], v[164:167], v[68:71]
 buffer_store_dwordx4 v[96:99], v7, s[8:11], s29 offen offset:0 sc1
M v[68:71], a[68:71], v[148:151], v[68:71]
 v_fma_f32 v100, v100, v6, v29
 v_fma_f32 v101, v101, v6, v29
M v[68:71], a[64:67], v[132:135], v[68:71]
 s_waitcnt lgkmcnt(0)
 v_fma_f32 v102, v102, v6, v29
 v_fma_f32 v103, v103, v6, v29
M v[72:75], a[96:99], v[128:131], v[32:35]
 ds_read_b128 a[64:67], v7 offset:49152
 v_fma_f32 v108, v108, v6, v29
M v[72:75], a[100:103], v[144:147], v[72:75]
 ds_read_b128 a[68:71], v7 offset:50176
 v_fma_f32 v109, v109, v6, v29
M v[72:75], a[104:107], v[160:163], v[72:75]
 v_fma_f32 v110, v110, v6, v29
 v_fma_f32 v111, v111, v6, v29
M v[72:75], a[108:111], v[176:179], v[72:75]
 ds_read_b128 a[72:75], v7 offset:51200
 v_cvt_pk_bf16_f32 v100, v100, v101
M v[72:75], a[112:115], v[192:195], v[72:75]
 ds_read_b128 a[76:79], v7 offset:52224
 v_cvt_pk_bf16_f32 v101, v102, v103
M v[72:75], a[116:119], v[208:211], v[72:75]
 v_cvt_pk_bf16_f32 v102, v108, v109
 v_cvt_pk_bf16_f32 v103, v110, v111
M v[72:75], a[120:123], v[224:227], v[72:75]
 ds_read_b128 a[80:83], v7 offset:53248
M v[72:75], a[124:127], v[240:243], v[72:75]
 ds_read_b128 a[84:87], v7 offset:54272
M v[76:79], a[124:127], v[244:247], v[36:39]
 buffer_store_dwordx4 v[100:103], v7, s[8:11], s30 offen offset:0 sc1
M v[76:79], a[120:123], v[228:231], v[76:79]
 ds_read_b128 a[88:91], v7 offset:55296
 v_fma_f32 v112, v112, v5, v28
M v[76:79], a[116:119], v[212:215], v[76:79]
 ds_read_b128 a[92:95], v7 offset:56320
 v_fma_f32 v113, v113, v5, v28
M v[76:79], a[112:115], v[196:199], v[76:79]
 v_fma_f32 v114, v114, v5, v28
 v_fma_f32 v115, v115, v5, v28
M v[76:79], a[108:111], v[180:183], v[76:79]
 v_fma_f32 v120, v120, v5, v28
 v_fma_f32 v121, v121, v5, v28
M v[76:79], a[104:107], v[164:167], v[76:79]
 v_fma_f32 v122, v122, v5, v28
 v_fma_f32 v123, v123, v5, v28
M v[76:79], a[100:103], v[148:151], v[76:79]
 v_cvt_pk_bf16_f32 v112, v112, v113
 v_cvt_pk_bf16_f32 v113, v114, v115
M v[76:79], a[96:99], v[132:135], v[76:79]
 s_waitcnt lgkmcnt(0)
 v_cvt_pk_bf16_f32 v114, v120, v121
 v_cvt_pk_bf16_f32 v115, v122, v123
M v[80:83], a[64:67], v[128:131], v[32:35]
 ds_read_b128 a[96:99], v7 offset:57344
M v[80:83], a[68:71], v[144:147], v[80:83]
 ds_read_b128 a[100:103], v7 offset:58368
M v[80:83], a[72:75], v[160:163], v[80:83]
 buffer_store_dwordx4 v[112:115], v7, s[8:11], s29 offen offset:1024 sc1
M v[80:83], a[76:79], v[176:179], v[80:83]
 ds_read_b128 a[104:107], v7 offset:59392
 v_fma_f32 v116, v116, v6, v29
M v[80:83], a[80:83], v[192:195], v[80:83]
 ds_read_b128 a[108:111], v7 offset:60416
 v_fma_f32 v117, v117, v6, v29
M v[80:83], a[84:87], v[208:211], v[80:83]
 v_fma_f32 v118, v118, v6, v29
 v_fma_f32 v119, v119, v6, v29
M v[80:83], a[88:91], v[224:227], v[80:83]
 ds_read_b128 a[112:115], v7 offset:61440
 v_fma_f32 v124, v124, v6, v29
M v[80:83], a[92:95], v[240:243], v[80:83]
 ds_read_b128 a[116:119], v7 offset:62464
 v_fma_f32 v125, v125, v6, v29
M v[84:87], a[92:95], v[244:247], v[36:39]
 v_fma_f32 v126, v126, v6, v29
 v_fma_f32 v127, v127, v6, v29
M v[84:87], a[88:91], v[228:231], v[84:87]
 ds_read_b128 a[120:123], v7 offset:63488
 v_cvt_pk_bf16_f32 v116, v116, v117
M v[84:87], a[84:87], v[212:215], v[84:87]
 ds_read_b128 a[124:127], v7 offset:64512
 v_cvt_pk_bf16_f32 v117, v118, v119
M v[84:87], a[80:83], v[196:199], v[84:87]
 v_cvt_pk_bf16_f32 v118, v124, v125
 v_cvt_pk_bf16_f32 v119, v126, v127
M v[84:87], a[76:79], v[180:183], v[84:87]
 buffer_store_dwordx4 v[116:119], v7, s[8:11], s30 offen offset:1024 sc1
M v[84:87], a[72:75], v[164:167], v[84:87]
 s_add_u32 s29, s33, 12288
M v[84:87], a[68:71], v[148:151], v[84:87]
 s_add_u32 s30, s33, 26624
 v_fma_f32 v64, v64, v5, v28
 v_fma_f32 v65, v65, v5, v28
M v[84:87], a[64:67], v[132:135], v[84:87]
 s_waitcnt lgkmcnt(0)
 v_fma_f32 v66, v66, v5, v28
 v_fma_f32 v67, v67, v5, v28
M v[88:91], a[96:99], v[128:131], v[32:35]
 v_fma_f32 v72, v72, v5, v28
 v_fma_f32 v73, v73, v5, v28
M v[88:91], a[100:103], v[144:147], v[88:91]
 v_fma_f32 v74, v74, v5, v28
 v_fma_f32 v75, v75, v5, v28
M v[88:91], a[104:107], v[160:163], v[88:91]
 v_cvt_pk_bf16_f32 v64, v64, v65
 v_cvt_pk_bf16_f32 v65, v66, v67
M v[88:91], a[108:111], v[176:179], v[88:91]
 v_cvt_pk_bf16_f32 v66, v72, v73
 v_cvt_pk_bf16_f32 v67, v74, v75
M v[88:91], a[112:115], v[192:195], v[88:91]
 buffer_store_dwordx4 v[64:67], v7, s[8:11], s29 offen offset:0 sc1
M v[88:91], a[116:119], v[208:211], v[88:91]
 v_fma_f32 v68, v68, v6, v29
 v_fma_f32 v69, v69, v6, v29
M v[88:91], a[120:123], v[224:227], v[88:91]
 v_fma_f32 v70, v70, v6, v29
 v_fma_f32 v71, v71, v6, v29
M v[88:91], a[124:127], v[240:243], v[88:91]
 v_fma_f32 v76, v76, v6, v29
 v_fma_f32 v77, v77, v6, v29
M v[92:95], a[124:127], v[244:247], v[36:39]
 v_fma_f32 v78, v78, v6, v29
 v_fma_f32 v79, v79, v6, v29
M v[92:95], a[120:123], v[228:231], v[92:95]
 v_cvt_pk_bf16_f32 v68, v68, v69
 v_cvt_pk_bf16_f32 v69, v70, v71
M v[92:95], a[116:119], v[212:215], v[92:95]
 v_cvt_pk_bf16_f32 v70, v76, v77
 v_cvt_pk_bf16_f32 v71, v78, v79
M v[92:95], a[112:115], v[196:199], v[92:95]
 buffer_store_dwordx4 v[68:71], v7, s[8:11], s30 offen offset:0 sc1
M v[92:95], a[108:111], v[180:183], v[92:95]
M v[92:95], a[104:107], v[164:167], v[92:95]
M v[92:95], a[100:103], v[148:151], v[92:95]
M v[92:95], a[96:99], v[132:135], v[92:95]
 v_fma_f32 v80, v80, v5, v28
 v_fma_f32 v81, v81, v5, v28
 v_fma_f32 v82, v82, v5, v28
 v_fma_f32 v83, v83, v5, v28
 v_fma_f32 v88, v88, v5, v28
 v_fma_f32 v89, v89, v5, v28
 v_fma_f32 v90, v90, v5, v28
 v_fma_f32 v91, v91, v5, v28
 v_cvt_pk_bf16_f32 v80, v80, v81
 v_cvt_pk_bf16_f32 v81, v82, v83
 v_cvt_pk_bf16_f32 v82, v88, v89
 v_cvt_pk_bf16_f32 v83, v90, v91
 buffer_store_dwordx4 v[80:83], v7, s[8:11], s29 offen offset:1024 sc1
 v_fma_f32 v84, v84, v6, v29
 v_fma_f32 v85, v85, v6, v29
 v_fma_f32 v86, v86, v6, v29
 v_fma_f32 v87, v87, v6, v29
 v_fma_f32 v92, v92, v6, v29
 v_fma_f32 v93, v93, v6, v29
 v_fma_f32 v94, v94, v6, v29
 v_fma_f32 v95, v95, v6, v29
 v_cvt_pk_bf16_f32 v84, v84, v85
 v_cvt_pk_bf16_f32 v85, v86, v87
 v_cvt_pk_bf16_f32 v86, v92, v93
 v_cvt_pk_bf16_f32 v87, v94, v95
 buffer_store_dwordx4 v[84:87], v7, s[8:11], s30 offen offset:1024 sc1
 s_cmp_lt_u32 s42, 8
 s_cbranch_scc1 L_red
 s_cmp_eq_u32 s20, 3
 s_cbranch_scc1 L_vend3
 s_sub_u32 s64, 15, s42
 s_lshl_b32 s64, s64, 1
 s_lshr_b32 s65, s41, 3
 s_add_u32 s46, s64, s65
 s_mul_i32 s46, s46, 4352
 s_and_b32 s72, s41, 7
 s_lshl_b32 s66, s72, 7
 s_add_u32 s46, s46, s66
 s_add_u32 s46, s46, 104993792
 v_and_b32 v14, 15, v0
 v_lshlrev_b32 v14, 2, v14
 buffer_load_dword v9, v14, s[8:11], s46 offen sc1
 s_mul_i32 s86, s65, 3
 s_add_u32 s86, s86, s20
 s_add_u32 s86, s86, 8
 s_mul_i32 s77, s42, 1835008
 s_mul_i32 s78, s72, 14336
 s_add_u32 s77, s77, s78
 s_add_u32 s77, s77, 67108864
 s_lshl_b32 s78, s86, 10
 s_add_u32 s77, s77, s78
 s_lshl_b32 s86, s86, 6
 s_lshr_b32 s73, s72, 1
 s_sub_u32 s65, 7, s73
 s_bitcmp1_b32 s72, 0
 s_cselect_b32 s73, s65, s73
 s_lshl_b32 s73, s73, 4
 s_lshl_b32 s65, s42, 7
 s_add_u32 s73, s73, s65
 v_and_b32 v10, 15, v0
 v_add_u32 v10, s73, v10
 s_mov_b32 s64, 104857664
 v_mul_u32_u24 v12, 896, v10
 v_lshl_add_u32 v12, v11, 4, v12
 v_lshrrev_b32 v13, 4, v10
 v_lshlrev_b32 v13, 5, v13
 v_and_b32 v104, 15, v10
 v_add_lshl_u32 v13, v13, v104, 2
 buffer_load_dword v15, v13, s[8:11], s64 offen sc1
 buffer_load_dwordx4 v[16:19], v12, s[56:59], s86 offen
 v_mov_b32 v48, 0
 v_mov_b32 v49, 0
 v_mov_b32 v50, 0
 v_mov_b32 v51, 0
 v_mov_b32 v52, 0
 v_mov_b32 v53, 0
 v_mov_b32 v54, 0
 v_mov_b32 v55, 0
 s_waitcnt vmcnt(3)
 buffer_store_dword v40, v41, s[8:11], s3 offen sc1
 s_waitcnt vmcnt(3)
 v_cmp_eq_u32 vcc, 1, v9
 s_mov_b32 s91, 65536
 s_mov_b32 s69, 0
 s_and_b32 s70, vcc_lo, 0xffff
 s_or_b32 s68, s70, 0xffff0000
 s_cmp_lg_u32 s70, 0
 s_cbranch_scc1 L_vk0
 s_call_b64 s[36:37], L_rpoll
L_vk0:
 s_ff1_i32_b32 s71, s70
 s_bitset0_b32 s70, s71
 s_mul_i32 s71, s71, 114688
 s_add_u32 s12, s71, s77
 buffer_load_dwordx4 v[128:131], v7, s[8:11], s12 offen sc1
 s_cmp_lg_u32 s70, 0
 s_cbranch_scc1 L_vk1
 s_call_b64 s[36:37], L_rpoll
L_vk1:
 s_ff1_i32_b32 s71, s70
 s_bitset0_b32 s70, s71
 s_mul_i32 s71, s71, 114688
 s_add_u32 s13, s71, s77
 buffer_load_dwordx4 v[132:135], v7, s[8:11], s13 offen sc1
 s_waitcnt vmcnt(3)
 v_lshlrev_b32 v32, 16, v16
 v_and_b32 v33, 0xffff0000, v16
 v_lshlrev_b32 v34, 16, v17
 v_and_b32 v35, 0xffff0000, v17
 v_lshlrev_b32 v36, 16, v18
 v_and_b32 v37, 0xffff0000, v18
 v_lshlrev_b32 v38, 16, v19
 v_and_b32 v39, 0xffff0000, v19
 v_sub_f32 v13, 1.0, v15
 v_cmp_eq_u32 s[80:81], s84, v10
 v_cmp_eq_u32 s[82:83], s85, v10
 s_nop 0
 s_or_b64 vcc, s[80:81], s[82:83]
 s_cbranch_vccnz L_moe2
L_moe_ret2:
 v_mul_f32 v32, v13, v32
 v_mul_f32 v33, v13, v33
 v_mul_f32 v34, v13, v34
 v_mul_f32 v35, v13, v35
 v_mul_f32 v36, v13, v36
 v_mul_f32 v37, v13, v37
 v_mul_f32 v38, v13, v38
 v_mul_f32 v39, v13, v39
 s_cmp_lg_u32 s70, 0
 s_cbranch_scc1 L_vk2
 s_call_b64 s[36:37], L_rpoll
L_vk2:
 s_ff1_i32_b32 s71, s70
 s_bitset0_b32 s70, s71
 s_mul_i32 s71, s71, 114688
 s_add_u32 s14, s71, s77
 buffer_load_dwordx4 v[136:139], v7, s[8:11], s14 offen sc1
 s_cmp_lg_u32 s70, 0
 s_cbranch_scc1 L_vk3
 s_call_b64 s[36:37], L_rpoll
L_vk3:
 s_ff1_i32_b32 s71, s70
 s_bitset0_b32 s70, s71
 s_mul_i32 s71, s71, 114688
 s_add_u32 s15, s71, s77
 buffer_load_dwordx4 v[140:143], v7, s[8:11], s15 offen sc1
 s_cmp_lg_u32 s70, 0
 s_cbranch_scc1 L_vk4
 s_call_b64 s[36:37], L_rpoll
L_vk4:
 s_ff1_i32_b32 s71, s70
 s_bitset0_b32 s70, s71
 s_mul_i32 s71, s71, 114688
 s_add_u32 s16, s71, s77
 buffer_load_dwordx4 v[144:147], v7, s[8:11], s16 offen sc1
 s_cmp_lg_u32 s70, 0
 s_cbranch_scc1 L_vk5
 s_call_b64 s[36:37], L_rpoll
L_vk5:
 s_ff1_i32_b32 s71, s70
 s_bitset0_b32 s70, s71
 s_mul_i32 s71, s71, 114688
 s_add_u32 s17, s71, s77
 buffer_load_dwordx4 v[148:151], v7, s[8:11], s17 offen sc1
 s_cmp_lg_u32 s70, 0
 s_cbranch_scc1 L_vk6
 s_call_b64 s[36:37], L_rpoll
L_vk6:
 s_ff1_i32_b32 s71, s70
 s_bitset0_b32 s70, s71
 s_mul_i32 s71, s71, 114688
 s_add_u32 s18, s71, s77
 buffer_load_dwordx4 v[152:155], v7, s[8:11], s18 offen sc1
 s_cmp_lg_u32 s70, 0
 s_cbranch_scc1 L_vk7
 s_call_b64 s[36:37], L_rpoll
L_vk7:
 s_ff1_i32_b32 s71, s70
 s_bitset0_b32 s70, s71
 s_mul_i32 s71, s71, 114688
 s_add_u32 s19, s71, s77
 buffer_load_dwordx4 v[156:159], v7, s[8:11], s19 offen sc1
 s_cmp_lg_u32 s70, 0
 s_cbranch_scc1 L_vk8
 s_call_b64 s[36:37], L_rpoll
L_vk8:
 s_ff1_i32_b32 s71, s70
 s_bitset0_b32 s70, s71
 s_mul_i32 s71, s71, 114688
 s_add_u32 s21, s71, s77
 buffer_load_dwordx4 v[160:163], v7, s[8:11], s21 offen sc1
 s_cmp_lg_u32 s70, 0
 s_cbranch_scc1 L_vk9
 s_call_b64 s[36:37], L_rpoll
L_vk9:
 s_ff1_i32_b32 s71, s70
 s_bitset0_b32 s70, s71
 s_mul_i32 s71, s71, 114688
 s_add_u32 s22, s71, s77
 buffer_load_dwordx4 v[164:167], v7, s[8:11], s22 offen sc1
 s_cmp_lg_u32 s70, 0
 s_cbranch_scc1 L_vk10
 s_call_b64 s[36:37], L_rpoll
L_vk10:
 s_ff1_i32_b32 s71, s70
 s_bitset0_b32 s70, s71
 s_mul_i32 s71, s71, 114688
 s_add_u32 s23, s71, s77
 buffer_load_dwordx4 v[168:171], v7, s[8:11], s23 offen sc1
 s_cmp_lg_u32 s70, 0
 s_cbranch_scc1 L_vk11
 s_call_b64 s[36:37], L_rpoll
L_vk11:
 s_ff1_i32_b32 s71, s70
 s_bitset0_b32 s70, s71
 s_mul_i32 s71, s71, 114688
 s_add_u32 s24, s71, s77
 buffer_load_dwordx4 v[172:175], v7, s[8:11], s24 offen sc1
 s_cmp_lg_u32 s70, 0
 s_cbranch_scc1 L_vk12
 s_call_b64 s[36:37], L_rpoll
L_vk12:
 s_ff1_i32_b32 s71, s70
 s_bitset0_b32 s70, s71
 s_mul_i32 s71, s71, 114688
 s_add_u32 s48, s71, s77
 buffer_load_dwordx4 v[176:179], v7, s[8:11], s48 offen sc1
 s_cmp_lg_u32 s70, 0
 s_cbranch_scc1 L_vk13
 s_call_b64 s[36:37], L_rpoll
L_vk13:
 s_ff1_i32_b32 s71, s70
 s_bitset0_b32 s70, s71
 s_mul_i32 s71, s71, 114688
 s_add_u32 s49, s71, s77
 buffer_load_dwordx4 v[180:183], v7, s[8:11], s49 offen sc1
 s_cmp_lg_u32 s70, 0
 s_cbranch_scc1 L_vk14
 s_call_b64 s[36:37], L_rpoll
L_vk14:
 s_ff1_i32_b32 s71, s70
 s_bitset0_b32 s70, s71
 s_mul_i32 s71, s71, 114688
 s_add_u32 s50, s71, s77
 buffer_load_dwordx4 v[184:187], v7, s[8:11], s50 offen sc1
 s_cmp_lg_u32 s70, 0
 s_cbranch_scc1 L_vk15
 s_call_b64 s[36:37], L_rpoll
L_vk15:
 s_ff1_i32_b32 s71, s70
 s_bitset0_b32 s70, s71
 s_mul_i32 s71, s71, 114688
 s_add_u32 s51, s71, s77
 buffer_load_dwordx4 v[188:191], v7, s[8:11], s51 offen sc1
 s_waitcnt vmcnt(15)
 v_dot2c_f32_bf16 v48, v128, v24
 v_dot2c_f32_bf16 v49, v128, v25
 v_dot2c_f32_bf16 v50, v129, v24
 v_dot2c_f32_bf16 v51, v129, v25
 v_dot2c_f32_bf16 v52, v130, v24
 v_dot2c_f32_bf16 v53, v130, v25
 v_dot2c_f32_bf16 v54, v131, v24
 v_dot2c_f32_bf16 v55, v131, v25
 s_waitcnt vmcnt(14)
 v_dot2c_f32_bf16 v48, v132, v24
 v_dot2c_f32_bf16 v49, v132, v25
 v_dot2c_f32_bf16 v50, v133, v24
 v_dot2c_f32_bf16 v51, v133, v25
 v_dot2c_f32_bf16 v52, v134, v24
 v_dot2c_f32_bf16 v53, v134, v25
 v_dot2c_f32_bf16 v54, v135, v24
 v_dot2c_f32_bf16 v55, v135, v25
 s_waitcnt vmcnt(13)
 v_dot2c_f32_bf16 v48, v136, v24
 v_dot2c_f32_bf16 v49, v136, v25
 v_dot2c_f32_bf16 v50, v137, v24
 v_dot2c_f32_bf16 v51, v137, v25
 v_dot2c_f32_bf16 v52, v138, v24
 v_dot2c_f32_bf16 v53, v138, v25
 v_dot2c_f32_bf16 v54, v139, v24
 v_dot2c_f32_bf16 v55, v139, v25
 s_waitcnt vmcnt(12)
 v_dot2c_f32_bf16 v48, v140, v24
 v_dot2c_f32_bf16 v49, v140, v25
 v_dot2c_f32_bf16 v50, v141, v24
 v_dot2c_f32_bf16 v51, v141, v25
 v_dot2c_f32_bf16 v52, v142, v24
 v_dot2c_f32_bf16 v53, v142, v25
 v_dot2c_f32_bf16 v54, v143, v24
 v_dot2c_f32_bf16 v55, v143, v25
 s_waitcnt vmcnt(11)
 v_dot2c_f32_bf16 v48, v144, v24
 v_dot2c_f32_bf16 v49, v144, v25
 v_dot2c_f32_bf16 v50, v145, v24
 v_dot2c_f32_bf16 v51, v145, v25
 v_dot2c_f32_bf16 v52, v146, v24
 v_dot2c_f32_bf16 v53, v146, v25
 v_dot2c_f32_bf16 v54, v147, v24
 v_dot2c_f32_bf16 v55, v147, v25
 s_waitcnt vmcnt(10)
 v_dot2c_f32_bf16 v48, v148, v24
 v_dot2c_f32_bf16 v49, v148, v25
 v_dot2c_f32_bf16 v50, v149, v24
 v_dot2c_f32_bf16 v51, v149, v25
 v_dot2c_f32_bf16 v52, v150, v24
 v_dot2c_f32_bf16 v53, v150, v25
 v_dot2c_f32_bf16 v54, v151, v24
 v_dot2c_f32_bf16 v55, v151, v25
 s_waitcnt vmcnt(9)
 v_dot2c_f32_bf16 v48, v152, v24
 v_dot2c_f32_bf16 v49, v152, v25
 v_dot2c_f32_bf16 v50, v153, v24
 v_dot2c_f32_bf16 v51, v153, v25
 v_dot2c_f32_bf16 v52, v154, v24
 v_dot2c_f32_bf16 v53, v154, v25
 v_dot2c_f32_bf16 v54, v155, v24
 v_dot2c_f32_bf16 v55, v155, v25
 s_waitcnt vmcnt(8)
 v_dot2c_f32_bf16 v48, v156, v24
 v_dot2c_f32_bf16 v49, v156, v25
 v_dot2c_f32_bf16 v50, v157, v24
 v_dot2c_f32_bf16 v51, v157, v25
 v_dot2c_f32_bf16 v52, v158, v24
 v_dot2c_f32_bf16 v53, v158, v25
 v_dot2c_f32_bf16 v54, v159, v24
 v_dot2c_f32_bf16 v55, v159, v25
 s_waitcnt vmcnt(7)
 v_dot2c_f32_bf16 v48, v160, v24
 v_dot2c_f32_bf16 v49, v160, v25
 v_dot2c_f32_bf16 v50, v161, v24
 v_dot2c_f32_bf16 v51, v161, v25
 v_dot2c_f32_bf16 v52, v162, v24
 v_dot2c_f32_bf16 v53, v162, v25
 v_dot2c_f32_bf16 v54, v163, v24
 v_dot2c_f32_bf16 v55, v163, v25
 s_waitcnt vmcnt(6)
 v_dot2c_f32_bf16 v48, v164, v24
 v_dot2c_f32_bf16 v49, v164, v25
 v_dot2c_f32_bf16 v50, v165, v24
 v_dot2c_f32_bf16 v51, v165, v25
 v_dot2c_f32_bf16 v52, v166, v24
 v_dot2c_f32_bf16 v53, v166, v25
 v_dot2c_f32_bf16 v54, v167, v24
 v_dot2c_f32_bf16 v55, v167, v25
 s_waitcnt vmcnt(5)
 v_dot2c_f32_bf16 v48, v168, v24
 v_dot2c_f32_bf16 v49, v168, v25
 v_dot2c_f32_bf16 v50, v169, v24
 v_dot2c_f32_bf16 v51, v169, v25
 v_dot2c_f32_bf16 v52, v170, v24
 v_dot2c_f32_bf16 v53, v170, v25
 v_dot2c_f32_bf16 v54, v171, v24
 v_dot2c_f32_bf16 v55, v171, v25
 s_waitcnt vmcnt(4)
 v_dot2c_f32_bf16 v48, v172, v24
 v_dot2c_f32_bf16 v49, v172, v25
 v_dot2c_f32_bf16 v50, v173, v24
 v_dot2c_f32_bf16 v51, v173, v25
 v_dot2c_f32_bf16 v52, v174, v24
 v_dot2c_f32_bf16 v53, v174, v25
 v_dot2c_f32_bf16 v54, v175, v24
 v_dot2c_f32_bf16 v55, v175, v25
 s_waitcnt vmcnt(3)
 v_dot2c_f32_bf16 v48, v176, v24
 v_dot2c_f32_bf16 v49, v176, v25
 v_dot2c_f32_bf16 v50, v177, v24
 v_dot2c_f32_bf16 v51, v177, v25
 v_dot2c_f32_bf16 v52, v178, v24
 v_dot2c_f32_bf16 v53, v178, v25
 v_dot2c_f32_bf16 v54, v179, v24
 v_dot2c_f32_bf16 v55, v179, v25
 s_waitcnt vmcnt(2)
 v_dot2c_f32_bf16 v48, v180, v24
 v_dot2c_f32_bf16 v49, v180, v25
 v_dot2c_f32_bf16 v50, v181, v24
 v_dot2c_f32_bf16 v51, v181, v25
 v_dot2c_f32_bf16 v52, v182, v24
 v_dot2c_f32_bf16 v53, v182, v25
 v_dot2c_f32_bf16 v54, v183, v24
 v_dot2c_f32_bf16 v55, v183, v25
 s_waitcnt vmcnt(1)
 v_dot2c_f32_bf16 v48, v184, v24
 v_dot2c_f32_bf16 v49, v184, v25
 v_dot2c_f32_bf16 v50, v185, v24
 v_dot2c_f32_bf16 v51, v185, v25
 v_dot2c_f32_bf16 v52, v186, v24
 v_dot2c_f32_bf16 v53, v186, v25
 v_dot2c_f32_bf16 v54, v187, v24
 v_dot2c_f32_bf16 v55, v187, v25
 s_waitcnt vmcnt(0)
 v_dot2c_f32_bf16 v48, v188, v24
 v_dot2c_f32_bf16 v49, v188, v25
 v_dot2c_f32_bf16 v50, v189, v24
 v_dot2c_f32_bf16 v51, v189, v25
 v_dot2c_f32_bf16 v52, v190, v24
 v_dot2c_f32_bf16 v53, v190, v25
 v_dot2c_f32_bf16 v54, v191, v24
 v_dot2c_f32_bf16 v55, v191, v25
 s_nop 1
 v_fmac_f32 v32, v15, v48
 v_fmac_f32 v33, v15, v49
 v_fmac_f32 v34, v15, v50
 v_fmac_f32 v35, v15, v51
 v_fmac_f32 v36, v15, v52
 v_fmac_f32 v37, v15, v53
 v_fmac_f32 v38, v15, v54
 v_fmac_f32 v39, v15, v55
 v_cvt_pk_bf16_f32 v16, v32, v33
 v_cvt_pk_bf16_f32 v17, v34, v35
 v_cvt_pk_bf16_f32 v18, v36, v37
 v_cvt_pk_bf16_f32 v19, v38, v39
 buffer_store_dwordx4 v[16:19], v12, s[52:55], s86 offen sc1
L_vend:
 s_endpgm
L_vend3:
 s_waitcnt vmcnt(0)
 buffer_store_dword v40, v41, s[8:11], s3 offen sc1
 s_branch L_vend
 s_waitcnt vmcnt(0)
L_p3k:
 s_mov_b32 s72, s32
 s_add_u32 s73, s72, 4096
 s_add_u32 s74, s72, 8192
 s_add_u32 s75, s72, 12288
 s_waitcnt vmcnt(8)
 v_cmp_ne_u32 vcc, 1, v5
 s_nop 0
 s_cbranch_vccnz L_fps1
L_fpr1:
M v[128:131], a[64:67], v[40:43], v[128:131]
 ds_read_b128 a[96:99], v2 offset:8192
 ds_read_b128 a[100:103], v2 offset:9216
M v[128:131], a[68:71], v[56:59], v[128:131]
 buffer_load_dwordx4 a[0:3], v7, s[8:11], s72 offen offset:0 sc1
M v[132:135], a[68:71], v[60:63], v[132:135]
 v_exp_f32 v18, v100
M v[132:135], a[64:67], v[44:47], v[132:135]
 ds_read_b128 a[104:107], v2 offset:10240
 ds_read_b128 a[108:111], v2 offset:11264
M v[136:139], a[72:75], v[40:43], v[136:139]
 buffer_load_dwordx4 a[4:7], v7, s[8:11], s72 offen offset:1024 sc1
M v[136:139], a[76:79], v[56:59], v[136:139]
 v_exp_f32 v19, v101
M v[140:143], a[76:79], v[60:63], v[140:143]
 ds_read_b128 a[112:115], v2 offset:12288
 ds_read_b128 a[116:119], v2 offset:13312
M v[140:143], a[72:75], v[44:47], v[140:143]
 buffer_load_dwordx4 a[8:11], v7, s[8:11], s72 offen offset:2048 sc1
M v[144:147], a[80:83], v[40:43], v[144:147]
 v_exp_f32 v20, v102
M v[144:147], a[84:87], v[56:59], v[144:147]
 ds_read_b128 a[120:123], v2 offset:14336
 ds_read_b128 a[124:127], v2 offset:15360
M v[148:151], a[84:87], v[60:63], v[148:151]
 v_exp_f32 v21, v103
M v[148:151], a[80:83], v[44:47], v[148:151]
 buffer_load_dwordx4 a[12:15], v7, s[8:11], s72 offen offset:3072 sc1
M v[152:155], a[88:91], v[40:43], v[152:155]
 v_add_f32 v30, v26, v30
 v_add_f32 v31, v27, v31
M v[152:155], a[92:95], v[56:59], v[152:155]
 v_add_f32 v29, v18, v19
 v_cvt_pk_bf16_f32 v52, v18, v19
M v[156:159], a[92:95], v[60:63], v[156:159]
 v_exp_f32 v22, v108
M v[156:159], a[88:91], v[44:47], v[156:159]
 s_waitcnt lgkmcnt(0)
 v_add_f32 v29, v20, v29
 v_cvt_pk_bf16_f32 v53, v20, v21
M v[160:163], a[96:99], v[40:43], v[160:163]
 ds_read_b128 a[64:67], v2 offset:16384
 ds_read_b128 a[68:71], v2 offset:17408
M v[160:163], a[100:103], v[56:59], v[160:163]
 buffer_load_dwordx4 a[16:19], v7, s[8:11], s73 offen offset:0 sc1
M v[164:167], a[100:103], v[60:63], v[164:167]
 v_exp_f32 v23, v109
M v[164:167], a[96:99], v[44:47], v[164:167]
 ds_read_b128 a[72:75], v2 offset:18432
 ds_read_b128 a[76:79], v2 offset:19456
M v[168:171], a[104:107], v[40:43], v[168:171]
 buffer_load_dwordx4 a[20:23], v7, s[8:11], s73 offen offset:1024 sc1
M v[168:171], a[108:111], v[56:59], v[168:171]
 v_exp_f32 v24, v110
M v[172:175], a[108:111], v[60:63], v[172:175]
 ds_read_b128 a[80:83], v2 offset:20480
 ds_read_b128 a[84:87], v2 offset:21504
M v[172:175], a[104:107], v[44:47], v[172:175]
 buffer_load_dwordx4 a[24:27], v7, s[8:11], s73 offen offset:2048 sc1
M v[176:179], a[112:115], v[40:43], v[176:179]
 v_exp_f32 v25, v111
M v[176:179], a[116:119], v[56:59], v[176:179]
 ds_read_b128 a[88:91], v2 offset:22528
 ds_read_b128 a[92:95], v2 offset:23552
M v[180:183], a[116:119], v[60:63], v[180:183]
 buffer_load_dwordx4 a[28:31], v7, s[8:11], s73 offen offset:3072 sc1
M v[180:183], a[112:115], v[44:47], v[180:183]
 v_add_f32 v29, v21, v29
 v_add_f32 v29, v22, v29
M v[184:187], a[120:123], v[40:43], v[184:187]
 v_exp_f32 v18, v116
M v[184:187], a[124:127], v[56:59], v[184:187]
 v_cvt_pk_bf16_f32 v54, v22, v23
 v_add_f32 v29, v23, v29
M v[188:191], a[124:127], v[60:63], v[188:191]
 buffer_load_dwordx4 a[32:35], v7, s[8:11], s74 offen offset:0 sc1
M v[188:191], a[120:123], v[44:47], v[188:191]
 s_waitcnt lgkmcnt(0)
 v_exp_f32 v19, v117
M v[192:195], a[64:67], v[40:43], v[192:195]
 ds_read_b128 a[96:99], v2 offset:24576
 ds_read_b128 a[100:103], v2 offset:25600
M v[192:195], a[68:71], v[56:59], v[192:195]
 buffer_load_dwordx4 a[36:39], v7, s[8:11], s74 offen offset:1024 sc1
M v[196:199], a[68:71], v[60:63], v[196:199]
 v_add_f32 v29, v24, v29
 v_cvt_pk_bf16_f32 v55, v24, v25
M v[196:199], a[64:67], v[44:47], v[196:199]
 ds_read_b128 a[104:107], v2 offset:26624
 ds_read_b128 a[108:111], v2 offset:27648
M v[200:203], a[72:75], v[40:43], v[200:203]
 v_exp_f32 v20, v118
M v[200:203], a[76:79], v[56:59], v[200:203]
 buffer_load_dwordx4 a[40:43], v7, s[8:11], s74 offen offset:2048 sc1
M v[204:207], a[76:79], v[60:63], v[204:207]
 ds_read_b128 a[112:115], v2 offset:28672
 ds_read_b128 a[116:119], v2 offset:29696
M v[204:207], a[72:75], v[44:47], v[204:207]
 v_exp_f32 v21, v119
M v[208:211], a[80:83], v[40:43], v[208:211]
 v_add_f32 v29, v25, v29
 v_add_f32 v29, v18, v29
M v[208:211], a[84:87], v[56:59], v[208:211]
 ds_read_b128 a[120:123], v2 offset:30720
 ds_read_b128 a[124:127], v2 offset:31744
M v[212:215], a[84:87], v[60:63], v[212:215]
 buffer_load_dwordx4 a[44:47], v7, s[8:11], s74 offen offset:3072 sc1
M v[212:215], a[80:83], v[44:47], v[212:215]
 v_exp_f32 v22, v124
M v[216:219], a[88:91], v[40:43], v[216:219]
 v_cvt_pk_bf16_f32 v48, v18, v19
 v_add_f32 v29, v19, v29
M v[216:219], a[92:95], v[56:59], v[216:219]
 buffer_load_dwordx4 a[48:51], v7, s[8:11], s75 offen offset:0 sc1
M v[220:223], a[92:95], v[60:63], v[220:223]
 s_waitcnt vmcnt(13) lgkmcnt(0)
 v_exp_f32 v23, v125
M v[220:223], a[88:91], v[44:47], v[220:223]
 s_barrier
M v[224:227], a[96:99], v[40:43], v[224:227]
 ds_read_b128 a[64:67], v7 offset:0
 ds_read_b128 a[68:71], v7 offset:1024
M v[224:227], a[100:103], v[56:59], v[224:227]
 buffer_load_dwordx4 a[52:55], v7, s[8:11], s75 offen offset:1024 sc1
M v[228:231], a[100:103], v[60:63], v[228:231]
 v_exp_f32 v24, v126
M v[228:231], a[96:99], v[44:47], v[228:231]
 ds_read_b128 a[72:75], v7 offset:2048
 ds_read_b128 a[76:79], v7 offset:3072
M v[232:235], a[104:107], v[40:43], v[232:235]
 buffer_load_dwordx4 a[56:59], v7, s[8:11], s75 offen offset:2048 sc1
M v[232:235], a[108:111], v[56:59], v[232:235]
 v_exp_f32 v25, v127
M v[236:239], a[108:111], v[60:63], v[236:239]
 ds_read_b128 a[80:83], v7 offset:4096
 ds_read_b128 a[84:87], v7 offset:5120
M v[236:239], a[104:107], v[44:47], v[236:239]
 v_add_f32 v29, v20, v29
 v_cvt_pk_bf16_f32 v49, v20, v21
M v[240:243], a[112:115], v[40:43], v[240:243]
 buffer_load_dwordx4 a[60:63], v7, s[8:11], s75 offen offset:3072 sc1
M v[240:243], a[116:119], v[56:59], v[240:243]
 ds_read_b128 a[88:91], v7 offset:6144
 ds_read_b128 a[92:95], v7 offset:7168
M v[244:247], a[116:119], v[60:63], v[244:247]
 v_add_f32 v29, v21, v29
 v_add_f32 v29, v22, v29
M v[244:247], a[112:115], v[44:47], v[244:247]
 v_cvt_pk_bf16_f32 v50, v22, v23
 v_add_f32 v29, v23, v29
M v[248:251], a[120:123], v[40:43], v[248:251]
 v_add_f32 v29, v24, v29
 v_cvt_pk_bf16_f32 v51, v24, v25
M v[248:251], a[124:127], v[56:59], v[248:251]
 v_add_f32 v29, v25, v29
M v[252:255], a[124:127], v[60:63], v[252:255]
 s_waitcnt lgkmcnt(0)
M v[252:255], a[120:123], v[44:47], v[252:255]
 v_cmp_lt_f32 vcc, s31, v29
 s_nop 0
 s_cbranch_vccnz L_st7
L_rt7:
M v[132:135], a[64:67], v[52:55], v[132:135]
 ds_read_b128 a[96:99], v7 offset:8192
 ds_read_b128 a[100:103], v7 offset:9216
M v[132:135], a[68:71], v[48:51], v[132:135]
 ds_read_b128 a[104:107], v7 offset:10240
 v_add_f32 v31, v29, v31
M v[140:143], a[76:79], v[48:51], v[140:143]
 s_sub_u32 s27, 5, s42
 ds_read_b128 a[108:111], v7 offset:11264
 ds_read_b128 a[112:115], v7 offset:12288
M v[140:143], a[72:75], v[52:55], v[140:143]
 s_mov_b32 s40, 0
 ds_read_b128 a[116:119], v7 offset:13312
 v_mov_b32 v10, v30
M v[148:151], a[80:83], v[52:55], v[148:151]
 s_add_u32 m0, s28, 32768
 ds_read_b128 a[120:123], v7 offset:14336
 ds_read_b128 a[124:127], v7 offset:15360
M v[148:151], a[84:87], v[48:51], v[148:151]
 buffer_load_dwordx4 v3, s[8:11], s21 offen offset:0 sc1 lds
M v[156:159], a[92:95], v[48:51], v[156:159]
 ds_read_b128 a[128:131], v7 offset:16384
 ds_read_b128 a[132:135], v7 offset:17408
M v[156:159], a[88:91], v[52:55], v[156:159]
 s_waitcnt lgkmcnt(2)
 ds_read_b128 a[136:139], v7 offset:18432
 v_mov_b32 v11, v31
M v[164:167], a[96:99], v[52:55], v[164:167]
 ds_read_b128 a[140:143], v7 offset:19456
 ds_read_b128 a[144:147], v7 offset:20480
M v[164:167], a[100:103], v[48:51], v[164:167]
 buffer_load_dwordx4 v3, s[8:11], s21 offen offset:1024 sc1 lds
M v[172:175], a[108:111], v[48:51], v[172:175]
 ds_read_b128 a[148:151], v7 offset:21504
 ds_read_b128 a[152:155], v7 offset:22528
M v[172:175], a[104:107], v[52:55], v[172:175]
 ds_read_b128 a[156:159], v7 offset:23552
 v_permlane16_swap_b32 v10, v30
M v[180:183], a[112:115], v[52:55], v[180:183]
 ds_read_b128 a[160:163], v7 offset:24576
 ds_read_b128 a[164:167], v7 offset:25600
M v[180:183], a[116:119], v[48:51], v[180:183]
 buffer_load_dwordx4 v3, s[8:11], s21 offen offset:2048 sc1 lds
M v[188:191], a[124:127], v[48:51], v[188:191]
 ds_read_b128 a[168:171], v7 offset:26624
 ds_read_b128 a[172:175], v7 offset:27648
M v[188:191], a[120:123], v[52:55], v[188:191]
 s_waitcnt lgkmcnt(4)
 ds_read_b128 a[176:179], v7 offset:28672
 v_permlane16_swap_b32 v11, v31
M v[196:199], a[128:131], v[52:55], v[196:199]
 ds_read_b128 a[180:183], v7 offset:29696
 ds_read_b128 a[184:187], v7 offset:30720
M v[196:199], a[132:135], v[48:51], v[196:199]
 ds_read_b128 a[188:191], v7 offset:31744
 v_add_f32 v30, v10, v30
M v[204:207], a[140:143], v[48:51], v[204:207]
 buffer_load_dwordx4 v3, s[8:11], s21 offen offset:3072 sc1 lds
M v[204:207], a[136:139], v[52:55], v[204:207]
 s_add_u32 m0, s28, 36864
 v_add_f32 v31, v11, v31
 v_mov_b32 v10, v30
M v[212:215], a[144:147], v[52:55], v[212:215]
 buffer_load_dwordx4 v4, s[8:11], s21 offen offset:0 sc1 lds
M v[212:215], a[148:151], v[48:51], v[212:215]
 s_waitcnt lgkmcnt(0)
 v_mov_b32 v11, v31
 v_permlane32_swap_b32 v10, v30
M v[220:223], a[156:159], v[48:51], v[220:223]
 s_barrier
M v[220:223], a[152:155], v[52:55], v[220:223]
 ds_read_b128 a[64:67], v2 offset:32768
 ds_read_b128 a[68:71], v2 offset:33792
M v[228:231], a[160:163], v[52:55], v[228:231]
 ds_read_b128 a[72:75], v2 offset:34816
 v_permlane32_swap_b32 v11, v31
M v[228:231], a[164:167], v[48:51], v[228:231]
 ds_read_b128 a[76:79], v2 offset:35840
 ds_read_b128 a[80:83], v2 offset:36864
M v[236:239], a[172:175], v[48:51], v[236:239]
 ds_read_b128 a[84:87], v2 offset:37888
 v_add_f32 v30, v10, v30
M v[236:239], a[168:171], v[52:55], v[236:239]
 ds_read_b128 a[88:91], v2 offset:38912
 ds_read_b128 a[92:95], v2 offset:39936
M v[244:247], a[176:179], v[52:55], v[244:247]
 buffer_load_dwordx4 v4, s[8:11], s21 offen offset:1024 sc1 lds
M v[244:247], a[180:183], v[48:51], v[244:247]
 buffer_load_dwordx4 v4, s[8:11], s21 offen offset:2048 sc1 lds
M v[252:255], a[188:191], v[48:51], v[252:255]
 buffer_load_dwordx4 v4, s[8:11], s21 offen offset:3072 sc1 lds
M v[252:255], a[184:187], v[52:55], v[252:255]
 s_waitcnt lgkmcnt(0)
 s_add_u32 s24, s23, 16777216
 s_mov_b32 s23, s21
 s_add_u32 s21, s21, 32768
 s_add_u32 s22, s22, 1
 s_cmp_eq_u32 s22, s25
 s_cselect_b32 s21, s26, s21
 s_cmp_eq_u32 s22, s43
 s_cselect_b32 s21, s4, s21
 s_cmp_eq_u32 s22, s6
 s_cselect_b32 s21, s7, s21
 v_add_f32 v31, v11, v31
 v_rcp_f32 v5, v30
 v_rcp_f32 v6, v31
 v_accvgpr_write_b32 a192, v5
 v_accvgpr_write_b32 a193, v6
 v_mov_b32 v30, 0
 v_mov_b32 v31, 0
 v_mov_b32 v32, 0xc1800000
 v_mov_b32 v33, 0xc1800000
 v_mov_b32 v34, 0xc1800000
 v_mov_b32 v35, 0xc1800000
 v_mov_b32 v36, 0xc1800000
 v_mov_b32 v37, 0xc1800000
 v_mov_b32 v38, 0xc1800000
 v_mov_b32 v39, 0xc1800000
 s_waitcnt vmcnt(8)
M v[64:67], a[64:67], a[0:3], v[32:35]
 ds_read_b128 a[96:99], v2 offset:40960
 v_cvt_pk_bf16_f32 v128, v128, v129
M v[64:67], a[68:71], a[4:7], v[64:67]
 ds_read_b128 a[100:103], v2 offset:41984
 v_cvt_pk_bf16_f32 v129, v130, v131
M v[64:67], a[72:75], a[8:11], v[64:67]
 buffer_load_dword v6, v9, s[8:11], s46 offen sc1
M v[64:67], a[76:79], a[12:15], v[64:67]
 ds_read_b128 a[104:107], v2 offset:43008
 v_cvt_pk_bf16_f32 v130, v136, v137
M v[64:67], a[80:83], a[16:19], v[64:67]
 s_add_u32 m0, s28, 65536
 ds_read_b128 a[108:111], v2 offset:44032
 v_cvt_pk_bf16_f32 v131, v138, v139
M v[64:67], a[84:87], a[20:23], v[64:67]
 buffer_load_dwordx4 v3, s[8:11], s24 offen offset:0 sc1 lds
M v[64:67], a[88:91], a[24:27], v[64:67]
 ds_read_b128 a[112:115], v2 offset:45056
 v_accvgpr_write_b32 a128, v128
M v[64:67], a[92:95], a[28:31], v[64:67]
 ds_read_b128 a[116:119], v2 offset:46080
 v_accvgpr_write_b32 a129, v129
M v[68:71], a[92:95], a[60:63], v[36:39]
 buffer_load_dwordx4 v3, s[8:11], s24 offen offset:1024 sc1 lds
M v[68:71], a[88:91], a[56:59], v[68:71]
 ds_read_b128 a[120:123], v2 offset:47104
 v_accvgpr_write_b32 a130, v130
M v[68:71], a[84:87], a[52:55], v[68:71]
 ds_read_b128 a[124:127], v2 offset:48128
 v_accvgpr_write_b32 a131, v131
M v[68:71], a[80:83], a[48:51], v[68:71]
 v_exp_f32 v18, v64
M v[68:71], a[76:79], a[44:47], v[68:71]
 v_exp_f32 v19, v65
M v[68:71], a[72:75], a[40:43], v[68:71]
 buffer_load_dwordx4 v3, s[8:11], s24 offen offset:2048 sc1 lds
M v[68:71], a[68:71], a[36:39], v[68:71]
 v_exp_f32 v20, v66
M v[68:71], a[64:67], a[32:35], v[68:71]
 s_waitcnt lgkmcnt(0)
 v_exp_f32 v21, v67
M v[72:75], a[96:99], a[0:3], v[32:35]
 ds_read_b128 a[64:67], v2 offset:49152
 v_add_f32 v26, v18, v19
M v[72:75], a[100:103], a[4:7], v[72:75]
 ds_read_b128 a[68:71], v2 offset:50176
 v_cvt_pk_bf16_f32 v40, v18, v19
M v[72:75], a[104:107], a[8:11], v[72:75]
 buffer_load_dwordx4 v3, s[8:11], s24 offen offset:3072 sc1 lds
M v[72:75], a[108:111], a[12:15], v[72:75]
 ds_read_b128 a[72:75], v2 offset:51200
 v_add_f32 v26, v20, v26
M v[72:75], a[112:115], a[16:19], v[72:75]
 ds_read_b128 a[76:79], v2 offset:52224
 v_cvt_pk_bf16_f32 v41, v20, v21
M v[72:75], a[116:119], a[20:23], v[72:75]
 v_exp_f32 v22, v68
M v[72:75], a[120:123], a[24:27], v[72:75]
 ds_read_b128 a[80:83], v2 offset:53248
 v_add_f32 v26, v21, v26
M v[72:75], a[124:127], a[28:31], v[72:75]
 s_add_u32 m0, s28, 69632
 ds_read_b128 a[84:87], v2 offset:54272
 v_cvt_pk_bf16_f32 v132, v132, v133
M v[76:79], a[124:127], a[60:63], v[36:39]
 buffer_load_dwordx4 v4, s[8:11], s24 offen offset:0 sc1 lds
M v[76:79], a[120:123], a[56:59], v[76:79]
 ds_read_b128 a[88:91], v2 offset:55296
 v_cvt_pk_bf16_f32 v133, v134, v135
M v[76:79], a[116:119], a[52:55], v[76:79]
 ds_read_b128 a[92:95], v2 offset:56320
 v_cvt_pk_bf16_f32 v134, v140, v141
M v[76:79], a[112:115], a[48:51], v[76:79]
 v_exp_f32 v23, v69
M v[76:79], a[108:111], a[44:47], v[76:79]
 buffer_load_dwordx4 v4, s[8:11], s24 offen offset:1024 sc1 lds
M v[76:79], a[104:107], a[40:43], v[76:79]
 v_exp_f32 v24, v70
M v[76:79], a[100:103], a[36:39], v[76:79]
 v_exp_f32 v25, v71
M v[76:79], a[96:99], a[32:35], v[76:79]
 s_waitcnt lgkmcnt(0)
 v_exp_f32 v18, v72
M v[80:83], a[64:67], a[0:3], v[32:35]
 ds_read_b128 a[96:99], v2 offset:57344
 v_add_f32 v27, v22, v23
M v[80:83], a[68:71], a[4:7], v[80:83]
 ds_read_b128 a[100:103], v2 offset:58368
 v_cvt_pk_bf16_f32 v44, v22, v23
M v[80:83], a[72:75], a[8:11], v[80:83]
 buffer_load_dwordx4 v4, s[8:11], s24 offen offset:2048 sc1 lds
M v[80:83], a[76:79], a[12:15], v[80:83]
 ds_read_b128 a[104:107], v2 offset:59392
 v_add_f32 v27, v24, v27
M v[80:83], a[80:83], a[16:19], v[80:83]
 ds_read_b128 a[108:111], v2 offset:60416
 v_cvt_pk_bf16_f32 v45, v24, v25
M v[80:83], a[84:87], a[20:23], v[80:83]
 v_exp_f32 v19, v73
M v[80:83], a[88:91], a[24:27], v[80:83]
 ds_read_b128 a[112:115], v2 offset:61440
 v_add_f32 v27, v25, v27
M v[80:83], a[92:95], a[28:31], v[80:83]
 ds_read_b128 a[116:119], v2 offset:62464
 v_add_f32 v26, v18, v26
M v[84:87], a[92:95], a[60:63], v[36:39]
 s_waitcnt vmcnt(7)
 v_cmp_gt_u32 vcc, 3, v6
 v_cvt_pk_bf16_f32 v42, v18, v19
M v[84:87], a[88:91], a[56:59], v[84:87]
 ds_read_b128 a[120:123], v2 offset:63488
 v_add_f32 v26, v19, v26
M v[84:87], a[84:87], a[52:55], v[84:87]
 ds_read_b128 a[124:127], v2 offset:64512
 v_cvt_pk_bf16_f32 v135, v142, v143
M v[84:87], a[80:83], a[48:51], v[84:87]
 s_cbranch_vccnz L_f2s
L_f2r:
 v_exp_f32 v20, v74
M v[84:87], a[76:79], a[44:47], v[84:87]
 buffer_load_dwordx4 v4, s[8:11], s24 offen offset:3072 sc1 lds
M v[84:87], a[72:75], a[40:43], v[84:87]
 v_exp_f32 v21, v75
M v[84:87], a[68:71], a[36:39], v[84:87]
 s_waitcnt lgkmcnt(0)
 v_exp_f32 v22, v76
M v[84:87], a[64:67], a[32:35], v[84:87]
 s_barrier
M v[88:91], a[96:99], a[0:3], v[32:35]
 ds_read_b128 a[64:67], v7 offset:32768
 v_add_f32 v26, v20, v26
M v[88:91], a[100:103], a[4:7], v[88:91]
 ds_read_b128 a[68:71], v7 offset:33792
 v_cvt_pk_bf16_f32 v43, v20, v21
M v[88:91], a[104:107], a[8:11], v[88:91]
 v_exp_f32 v23, v77
M v[88:91], a[108:111], a[12:15], v[88:91]
 ds_read_b128 a[72:75], v7 offset:34816
 v_add_f32 v26, v21, v26
M v[88:91], a[112:115], a[16:19], v[88:91]
 ds_read_b128 a[76:79], v7 offset:35840
 v_add_f32 v27, v22, v27
M v[88:91], a[116:119], a[20:23], v[88:91]
 v_exp_f32 v24, v78
M v[88:91], a[120:123], a[24:27], v[88:91]
 ds_read_b128 a[80:83], v7 offset:36864
 v_cvt_pk_bf16_f32 v46, v22, v23
M v[88:91], a[124:127], a[28:31], v[88:91]
 ds_read_b128 a[84:87], v7 offset:37888
 v_add_f32 v27, v23, v27
M v[92:95], a[124:127], a[60:63], v[36:39]
 v_exp_f32 v25, v79
M v[92:95], a[120:123], a[56:59], v[92:95]
 ds_read_b128 a[88:91], v7 offset:38912
 v_add_f32 v27, v24, v27
M v[92:95], a[116:119], a[52:55], v[92:95]
 ds_read_b128 a[92:95], v7 offset:39936
 v_cvt_pk_bf16_f32 v47, v24, v25
M v[92:95], a[112:115], a[48:51], v[92:95]
 v_add_f32 v27, v25, v27
 v_accvgpr_write_b32 a160, v132
M v[92:95], a[108:111], a[44:47], v[92:95]
 v_accvgpr_write_b32 a161, v133
 v_accvgpr_write_b32 a162, v134
M v[92:95], a[104:107], a[40:43], v[92:95]
 v_accvgpr_write_b32 a163, v135
 v_cvt_pk_bf16_f32 v144, v144, v145
M v[92:95], a[100:103], a[36:39], v[92:95]
 s_waitcnt lgkmcnt(0)
 v_cvt_pk_bf16_f32 v145, v146, v147
 v_cvt_pk_bf16_f32 v146, v152, v153
M v[92:95], a[96:99], a[32:35], v[92:95]
 v_cvt_pk_bf16_f32 v147, v154, v155
 v_accvgpr_write_b32 a132, v144
M v[96:99], a[64:67], a[0:3], v[32:35]
 s_add_u32 m0, s28, 98304
 ds_read_b128 a[96:99], v7 offset:40960
 v_accvgpr_write_b32 a133, v145
M v[96:99], a[68:71], a[4:7], v[96:99]
 ds_read_b128 a[100:103], v7 offset:41984
 v_accvgpr_write_b32 a134, v146
M v[96:99], a[72:75], a[8:11], v[96:99]
 buffer_load_dwordx4 v3, s[8:11], s21 offen offset:0 sc1 lds
M v[96:99], a[76:79], a[12:15], v[96:99]
 ds_read_b128 a[104:107], v7 offset:43008
 v_accvgpr_write_b32 a135, v147
M v[96:99], a[80:83], a[16:19], v[96:99]
 ds_read_b128 a[108:111], v7 offset:44032
 v_cvt_pk_bf16_f32 v148, v148, v149
M v[96:99], a[84:87], a[20:23], v[96:99]
 buffer_load_dwordx4 v3, s[8:11], s21 offen offset:1024 sc1 lds
M v[96:99], a[88:91], a[24:27], v[96:99]
 ds_read_b128 a[112:115], v7 offset:45056
 v_cvt_pk_bf16_f32 v149, v150, v151
M v[96:99], a[92:95], a[28:31], v[96:99]
 ds_read_b128 a[116:119], v7 offset:46080
 v_cvt_pk_bf16_f32 v150, v156, v157
M v[100:103], a[92:95], a[60:63], v[36:39]
 v_exp_f32 v18, v80
M v[100:103], a[88:91], a[56:59], v[100:103]
 ds_read_b128 a[120:123], v7 offset:47104
 v_cvt_pk_bf16_f32 v151, v158, v159
M v[100:103], a[84:87], a[52:55], v[100:103]
 ds_read_b128 a[124:127], v7 offset:48128
 v_accvgpr_write_b32 a164, v148
M v[100:103], a[80:83], a[48:51], v[100:103]
 buffer_load_dwordx4 v3, s[8:11], s21 offen offset:2048 sc1 lds
M v[100:103], a[76:79], a[44:47], v[100:103]
 v_exp_f32 v19, v81
M v[100:103], a[72:75], a[40:43], v[100:103]
 v_exp_f32 v20, v82
M v[100:103], a[68:71], a[36:39], v[100:103]
 v_exp_f32 v21, v83
M v[100:103], a[64:67], a[32:35], v[100:103]
 s_waitcnt lgkmcnt(0)
 v_exp_f32 v22, v88
M v[104:107], a[96:99], a[0:3], v[32:35]
 ds_read_b128 a[64:67], v7 offset:49152
 v_add_f32 v26, v18, v26
M v[104:107], a[100:103], a[4:7], v[104:107]
 ds_read_b128 a[68:71], v7 offset:50176
 v_cvt_pk_bf16_f32 v56, v18, v19
M v[104:107], a[104:107], a[8:11], v[104:107]
 buffer_load_dwordx4 v3, s[8:11], s21 offen offset:3072 sc1 lds
M v[104:107], a[108:111], a[12:15], v[104:107]
 s_add_u32 m0, s28, 102400
 ds_read_b128 a[72:75], v7 offset:51200
 v_add_f32 v26, v19, v26
M v[104:107], a[112:115], a[16:19], v[104:107]
 ds_read_b128 a[76:79], v7 offset:52224
 v_add_f32 v26, v20, v26
M v[104:107], a[116:119], a[20:23], v[104:107]
 buffer_load_dwordx4 v4, s[8:11], s21 offen offset:0 sc1 lds
M v[104:107], a[120:123], a[24:27], v[104:107]
 ds_read_b128 a[80:83], v7 offset:53248
 v_cvt_pk_bf16_f32 v57, v20, v21
M v[104:107], a[124:127], a[28:31], v[104:107]
 ds_read_b128 a[84:87], v7 offset:54272
 v_add_f32 v26, v21, v26
M v[108:111], a[124:127], a[60:63], v[36:39]
 v_exp_f32 v23, v89
M v[108:111], a[120:123], a[56:59], v[108:111]
 ds_read_b128 a[88:91], v7 offset:55296
 v_add_f32 v26, v22, v26
M v[108:111], a[116:119], a[52:55], v[108:111]
 ds_read_b128 a[92:95], v7 offset:56320
 v_cvt_pk_bf16_f32 v58, v22, v23
M v[108:111], a[112:115], a[48:51], v[108:111]
 buffer_load_dwordx4 v4, s[8:11], s21 offen offset:1024 sc1 lds
M v[108:111], a[108:111], a[44:47], v[108:111]
 v_exp_f32 v24, v90
M v[108:111], a[104:107], a[40:43], v[108:111]
 v_exp_f32 v25, v91
M v[108:111], a[100:103], a[36:39], v[108:111]
 buffer_load_dwordx4 v4, s[8:11], s21 offen offset:2048 sc1 lds
M v[108:111], a[96:99], a[32:35], v[108:111]
 s_waitcnt lgkmcnt(0)
 v_exp_f32 v18, v84
M v[112:115], a[64:67], a[0:3], v[32:35]
 ds_read_b128 a[96:99], v7 offset:57344
 v_add_f32 v26, v23, v26
M v[112:115], a[68:71], a[4:7], v[112:115]
 ds_read_b128 a[100:103], v7 offset:58368
 v_add_f32 v26, v24, v26
M v[112:115], a[72:75], a[8:11], v[112:115]
 v_exp_f32 v19, v85
M v[112:115], a[76:79], a[12:15], v[112:115]
 ds_read_b128 a[104:107], v7 offset:59392
 v_cvt_pk_bf16_f32 v59, v24, v25
M v[112:115], a[80:83], a[16:19], v[112:115]
 ds_read_b128 a[108:111], v7 offset:60416
 v_add_f32 v26, v25, v26
M v[112:115], a[84:87], a[20:23], v[112:115]
 buffer_load_dwordx4 v4, s[8:11], s21 offen offset:3072 sc1 lds
M v[112:115], a[88:91], a[24:27], v[112:115]
 s_add_u32 s24, s23, 16777216
 ds_read_b128 a[112:115], v7 offset:61440
 v_add_f32 v27, v18, v27
M v[112:115], a[92:95], a[28:31], v[112:115]
 s_mov_b32 s23, s21
 ds_read_b128 a[116:119], v7 offset:62464
 v_cvt_pk_bf16_f32 v60, v18, v19
M v[116:119], a[92:95], a[60:63], v[36:39]
 s_add_u32 s21, s21, 32768
 v_exp_f32 v20, v86
M v[116:119], a[88:91], a[56:59], v[116:119]
 s_add_u32 s22, s22, 1
 ds_read_b128 a[120:123], v7 offset:63488
 v_add_f32 v27, v19, v27
M v[116:119], a[84:87], a[52:55], v[116:119]
 s_cmp_eq_u32 s22, s25
 ds_read_b128 a[124:127], v7 offset:64512
 v_accvgpr_write_b32 a165, v149
M v[116:119], a[80:83], a[48:51], v[116:119]
 s_cselect_b32 s21, s26, s21
 v_exp_f32 v21, v87
M v[116:119], a[76:79], a[44:47], v[116:119]
 s_cmp_eq_u32 s22, s43
 v_exp_f32 v22, v92
M v[116:119], a[72:75], a[40:43], v[116:119]
 s_cselect_b32 s21, s4, s21
 v_exp_f32 v23, v93
M v[116:119], a[68:71], a[36:39], v[116:119]
 s_waitcnt vmcnt(8) lgkmcnt(0)
 v_add_f32 v27, v20, v27
 v_cvt_pk_bf16_f32 v61, v20, v21
M v[116:119], a[64:67], a[32:35], v[116:119]
 s_barrier
M v[120:123], a[96:99], a[0:3], v[32:35]
 s_cmp_eq_u32 s22, s6
 ds_read_b128 a[64:67], v2 offset:0
 v_add_f32 v27, v21, v27
M v[120:123], a[100:103], a[4:7], v[120:123]
 s_cselect_b32 s21, s7, s21
 ds_read_b128 a[68:71], v2 offset:1024
 v_add_f32 v27, v22, v27
M v[120:123], a[104:107], a[8:11], v[120:123]
 v_exp_f32 v24, v94
M v[120:123], a[108:111], a[12:15], v[120:123]
 ds_read_b128 a[72:75], v2 offset:2048
 v_cvt_pk_bf16_f32 v62, v22, v23
M v[120:123], a[112:115], a[16:19], v[120:123]
 ds_read_b128 a[76:79], v2 offset:3072
 v_add_f32 v27, v23, v27
M v[120:123], a[116:119], a[20:23], v[120:123]
 v_exp_f32 v25, v95
M v[120:123], a[120:123], a[24:27], v[120:123]
 ds_read_b128 a[80:83], v2 offset:4096
 v_add_f32 v27, v24, v27
M v[120:123], a[124:127], a[28:31], v[120:123]
 ds_read_b128 a[84:87], v2 offset:5120
 v_cvt_pk_bf16_f32 v63, v24, v25
M v[124:127], a[124:127], a[60:63], v[36:39]
 v_add_f32 v27, v25, v27
 v_accvgpr_write_b32 a166, v150
M v[124:127], a[120:123], a[56:59], v[124:127]
 ds_read_b128 a[88:91], v2 offset:6144
 v_max_f32 v10, v26, v27
M v[124:127], a[116:119], a[52:55], v[124:127]
 ds_read_b128 a[92:95], v2 offset:7168
 v_min_f32 v11, v26, v27
M v[124:127], a[112:115], a[48:51], v[124:127]
 v_cmp_lt_f32 s[36:37], s31, v10
 v_accvgpr_write_b32 a167, v151
M v[124:127], a[108:111], a[44:47], v[124:127]
 v_cmp_gt_f32 vcc, s55, v11
 v_cvt_pk_bf16_f32 v160, v160, v161
M v[124:127], a[104:107], a[40:43], v[124:127]
 v_cvt_pk_bf16_f32 v161, v162, v163
 v_cvt_pk_bf16_f32 v162, v168, v169
M v[124:127], a[100:103], a[36:39], v[124:127]
 s_waitcnt lgkmcnt(0)
 s_or_b64 vcc, vcc, s[36:37]
M v[124:127], a[96:99], a[32:35], v[124:127]
 s_cbranch_vccnz L_st11
L_rt11:
 v_cvt_pk_bf16_f32 v163, v170, v171
 v_accvgpr_write_b32 a136, v160
 v_accvgpr_write_b32 a137, v161
 v_accvgpr_write_b32 a138, v162
 v_accvgpr_write_b32 a139, v163
 v_cvt_pk_bf16_f32 v164, v164, v165
 v_cvt_pk_bf16_f32 v165, v166, v167
 v_cvt_pk_bf16_f32 v166, v172, v173
 v_cvt_pk_bf16_f32 v167, v174, v175
 v_accvgpr_write_b32 a168, v164
 v_accvgpr_write_b32 a169, v165
 v_accvgpr_write_b32 a170, v166
 v_accvgpr_write_b32 a171, v167
 v_cvt_pk_bf16_f32 v176, v176, v177
 v_cvt_pk_bf16_f32 v177, v178, v179
 v_cvt_pk_bf16_f32 v178, v184, v185
 v_cvt_pk_bf16_f32 v179, v186, v187
 v_accvgpr_write_b32 a140, v176
 v_accvgpr_write_b32 a141, v177
 v_accvgpr_write_b32 a142, v178
 v_accvgpr_write_b32 a143, v179
 v_cvt_pk_bf16_f32 v180, v180, v181
 v_cvt_pk_bf16_f32 v181, v182, v183
 v_cvt_pk_bf16_f32 v182, v188, v189
 v_cvt_pk_bf16_f32 v183, v190, v191
 v_accvgpr_write_b32 a172, v180
 v_accvgpr_write_b32 a173, v181
 v_accvgpr_write_b32 a174, v182
 v_accvgpr_write_b32 a175, v183
 v_cvt_pk_bf16_f32 v192, v192, v193
 v_cvt_pk_bf16_f32 v193, v194, v195
 v_cvt_pk_bf16_f32 v194, v200, v201
 v_cvt_pk_bf16_f32 v195, v202, v203
 v_accvgpr_write_b32 a144, v192
 v_accvgpr_write_b32 a145, v193
 v_accvgpr_write_b32 a146, v194
 v_accvgpr_write_b32 a147, v195
 v_cvt_pk_bf16_f32 v196, v196, v197
 v_cvt_pk_bf16_f32 v197, v198, v199
 v_cvt_pk_bf16_f32 v198, v204, v205
 v_cvt_pk_bf16_f32 v199, v206, v207
 v_accvgpr_write_b32 a176, v196
 v_accvgpr_write_b32 a177, v197
 v_accvgpr_write_b32 a178, v198
 v_accvgpr_write_b32 a179, v199
 v_cvt_pk_bf16_f32 v208, v208, v209
 v_cvt_pk_bf16_f32 v209, v210, v211
 v_cvt_pk_bf16_f32 v210, v216, v217
 v_cvt_pk_bf16_f32 v211, v218, v219
 v_accvgpr_write_b32 a148, v208
 v_accvgpr_write_b32 a149, v209
 v_accvgpr_write_b32 a150, v210
 v_accvgpr_write_b32 a151, v211
 v_cvt_pk_bf16_f32 v212, v212, v213
 v_cvt_pk_bf16_f32 v213, v214, v215
 v_cvt_pk_bf16_f32 v214, v220, v221
 v_cvt_pk_bf16_f32 v215, v222, v223
 v_accvgpr_write_b32 a180, v212
 v_accvgpr_write_b32 a181, v213
 v_accvgpr_write_b32 a182, v214
 v_accvgpr_write_b32 a183, v215
 v_cvt_pk_bf16_f32 v224, v224, v225
 v_cvt_pk_bf16_f32 v225, v226, v227
 v_cvt_pk_bf16_f32 v226, v232, v233
 v_cvt_pk_bf16_f32 v227, v234, v235
 v_accvgpr_write_b32 a152, v224
 v_accvgpr_write_b32 a153, v225
 v_accvgpr_write_b32 a154, v226
 v_accvgpr_write_b32 a155, v227
 v_cvt_pk_bf16_f32 v228, v228, v229
 v_cvt_pk_bf16_f32 v229, v230, v231
 v_cvt_pk_bf16_f32 v230, v236, v237
 v_cvt_pk_bf16_f32 v231, v238, v239
 v_accvgpr_write_b32 a184, v228
 v_accvgpr_write_b32 a185, v229
 v_accvgpr_write_b32 a186, v230
 v_accvgpr_write_b32 a187, v231
M v[128:131], a[64:67], v[40:43], 0
 s_add_u32 m0, s28, 0
 ds_read_b128 a[96:99], v2 offset:8192
 ds_read_b128 a[100:103], v2 offset:9216
M v[128:131], a[68:71], v[56:59], v[128:131]
 buffer_load_dwordx4 v3, s[8:11], s24 offen offset:0 sc1 lds
M v[132:135], a[68:71], v[60:63], 0
 v_cvt_pk_bf16_f32 v240, v240, v241
 v_cvt_pk_bf16_f32 v241, v242, v243
M v[132:135], a[64:67], v[44:47], v[132:135]
 ds_read_b128 a[104:107], v2 offset:10240
 ds_read_b128 a[108:111], v2 offset:11264
M v[136:139], a[72:75], v[40:43], 0
 buffer_load_dwordx4 v3, s[8:11], s24 offen offset:1024 sc1 lds
M v[136:139], a[76:79], v[56:59], v[136:139]
 v_cvt_pk_bf16_f32 v242, v248, v249
 v_cvt_pk_bf16_f32 v243, v250, v251
M v[140:143], a[76:79], v[60:63], 0
 ds_read_b128 a[112:115], v2 offset:12288
 ds_read_b128 a[116:119], v2 offset:13312
M v[140:143], a[72:75], v[44:47], v[140:143]
 buffer_load_dwordx4 v3, s[8:11], s24 offen offset:2048 sc1 lds
M v[144:147], a[80:83], v[40:43], 0
 v_accvgpr_write_b32 a156, v240
 v_accvgpr_write_b32 a157, v241
M v[144:147], a[84:87], v[56:59], v[144:147]
 ds_read_b128 a[120:123], v2 offset:14336
 ds_read_b128 a[124:127], v2 offset:15360
M v[148:151], a[84:87], v[60:63], 0
 buffer_load_dwordx4 v3, s[8:11], s24 offen offset:3072 sc1 lds
M v[148:151], a[80:83], v[44:47], v[148:151]
 s_add_u32 m0, s28, 4096
 v_accvgpr_write_b32 a158, v242
 v_accvgpr_write_b32 a159, v243
M v[152:155], a[88:91], v[40:43], 0
 buffer_load_dwordx4 v4, s[8:11], s24 offen offset:0 sc1 lds
M v[152:155], a[92:95], v[56:59], v[152:155]
 v_cvt_pk_bf16_f32 v244, v244, v245
 v_cvt_pk_bf16_f32 v245, v246, v247
M v[156:159], a[92:95], v[60:63], 0
 v_cvt_pk_bf16_f32 v246, v252, v253
 v_cvt_pk_bf16_f32 v247, v254, v255
M v[156:159], a[88:91], v[44:47], v[156:159]
 s_waitcnt lgkmcnt(0)
 v_accvgpr_write_b32 a188, v244
 v_accvgpr_write_b32 a189, v245
M v[160:163], a[96:99], v[40:43], 0
 ds_read_b128 a[64:67], v2 offset:16384
 ds_read_b128 a[68:71], v2 offset:17408
M v[160:163], a[100:103], v[56:59], v[160:163]
 buffer_load_dwordx4 v4, s[8:11], s24 offen offset:1024 sc1 lds
M v[164:167], a[100:103], v[60:63], 0
 v_accvgpr_write_b32 a190, v246
 v_accvgpr_write_b32 a191, v247
M v[164:167], a[96:99], v[44:47], v[164:167]
 ds_read_b128 a[72:75], v2 offset:18432
 ds_read_b128 a[76:79], v2 offset:19456
M v[168:171], a[104:107], v[40:43], 0
 buffer_load_dwordx4 v4, s[8:11], s24 offen offset:2048 sc1 lds
M v[168:171], a[108:111], v[56:59], v[168:171]
 v_exp_f32 v18, v96
M v[172:175], a[108:111], v[60:63], 0
 ds_read_b128 a[80:83], v2 offset:20480
 ds_read_b128 a[84:87], v2 offset:21504
M v[172:175], a[104:107], v[44:47], v[172:175]
 buffer_load_dwordx4 v4, s[8:11], s24 offen offset:3072 sc1 lds
M v[176:179], a[112:115], v[40:43], 0
 v_exp_f32 v19, v97
M v[176:179], a[116:119], v[56:59], v[176:179]
 s_add_u32 m0, s28, 32768
 ds_read_b128 a[88:91], v2 offset:22528
 ds_read_b128 a[92:95], v2 offset:23552
M v[180:183], a[116:119], v[60:63], 0
 buffer_load_dwordx4 v3, s[8:11], s21 offen offset:0 sc1 lds
M v[180:183], a[112:115], v[44:47], v[180:183]
 v_exp_f32 v20, v98
M v[184:187], a[120:123], v[40:43], 0
 buffer_load_dwordx4 v3, s[8:11], s21 offen offset:1024 sc1 lds
M v[184:187], a[124:127], v[56:59], v[184:187]
 v_exp_f32 v21, v99
M v[188:191], a[124:127], v[60:63], 0
 buffer_load_dwordx4 v3, s[8:11], s21 offen offset:2048 sc1 lds
M v[188:191], a[120:123], v[44:47], v[188:191]
 s_waitcnt lgkmcnt(0)
 v_exp_f32 v22, v104
M v[192:195], a[64:67], v[40:43], 0
 ds_read_b128 a[96:99], v2 offset:24576
 ds_read_b128 a[100:103], v2 offset:25600
M v[192:195], a[68:71], v[56:59], v[192:195]
 buffer_load_dwordx4 v3, s[8:11], s21 offen offset:3072 sc1 lds
M v[196:199], a[68:71], v[60:63], 0
 v_exp_f32 v23, v105
M v[196:199], a[64:67], v[44:47], v[196:199]
 s_add_u32 m0, s28, 36864
 ds_read_b128 a[104:107], v2 offset:26624
 ds_read_b128 a[108:111], v2 offset:27648
M v[200:203], a[72:75], v[40:43], 0
 buffer_load_dwordx4 v4, s[8:11], s21 offen offset:0 sc1 lds
M v[200:203], a[76:79], v[56:59], v[200:203]
 v_add_f32 v30, v26, v30
 v_add_f32 v31, v27, v31
M v[204:207], a[76:79], v[60:63], 0
 ds_read_b128 a[112:115], v2 offset:28672
 ds_read_b128 a[116:119], v2 offset:29696
M v[204:207], a[72:75], v[44:47], v[204:207]
 buffer_load_dwordx4 v4, s[8:11], s21 offen offset:1024 sc1 lds
M v[208:211], a[80:83], v[40:43], 0
 v_exp_f32 v24, v106
M v[208:211], a[84:87], v[56:59], v[208:211]
 ds_read_b128 a[120:123], v2 offset:30720
 ds_read_b128 a[124:127], v2 offset:31744
M v[212:215], a[84:87], v[60:63], 0
 buffer_load_dwordx4 v4, s[8:11], s21 offen offset:2048 sc1 lds
M v[212:215], a[80:83], v[44:47], v[212:215]
 v_exp_f32 v25, v107
M v[216:219], a[88:91], v[40:43], 0
 v_add_f32 v28, v18, v19
 v_cvt_pk_bf16_f32 v48, v18, v19
M v[216:219], a[92:95], v[56:59], v[216:219]
 buffer_load_dwordx4 v4, s[8:11], s21 offen offset:3072 sc1 lds
M v[220:223], a[92:95], v[60:63], 0
 s_waitcnt vmcnt(16) lgkmcnt(0)
 s_add_u32 s24, s23, 16777216
 s_mov_b32 s23, s21
M v[220:223], a[88:91], v[44:47], v[220:223]
 s_barrier
M v[224:227], a[96:99], v[40:43], 0
 ds_read_b128 a[64:67], v2 offset:32768
 ds_read_b128 a[68:71], v2 offset:33792
M v[224:227], a[100:103], v[56:59], v[224:227]
 s_add_u32 s21, s21, 32768
 v_add_f32 v28, v20, v28
M v[228:231], a[100:103], v[60:63], 0
 s_add_u32 s22, s22, 1
 v_exp_f32 v18, v100
M v[228:231], a[96:99], v[44:47], v[228:231]
 s_cmp_eq_u32 s22, s25
 ds_read_b128 a[72:75], v2 offset:34816
 ds_read_b128 a[76:79], v2 offset:35840
M v[232:235], a[104:107], v[40:43], 0
 s_cselect_b32 s21, s26, s21
 v_exp_f32 v19, v101
M v[232:235], a[108:111], v[56:59], v[232:235]
 s_cmp_eq_u32 s22, s43
 v_cvt_pk_bf16_f32 v49, v20, v21
 v_add_f32 v28, v21, v28
M v[236:239], a[108:111], v[60:63], 0
 s_cselect_b32 s21, s4, s21
 ds_read_b128 a[80:83], v2 offset:36864
 ds_read_b128 a[84:87], v2 offset:37888
M v[236:239], a[104:107], v[44:47], v[236:239]
 s_cmp_eq_u32 s22, s6
 v_exp_f32 v20, v102
M v[240:243], a[112:115], v[40:43], 0
 s_cselect_b32 s21, s7, s21
 v_exp_f32 v21, v103
M v[240:243], a[116:119], v[56:59], v[240:243]
 ds_read_b128 a[88:91], v2 offset:38912
 ds_read_b128 a[92:95], v2 offset:39936
M v[244:247], a[116:119], v[60:63], 0
 v_add_f32 v28, v22, v28
 v_cvt_pk_bf16_f32 v50, v22, v23
M v[244:247], a[112:115], v[44:47], v[244:247]
 v_add_f32 v28, v23, v28
 v_add_f32 v28, v24, v28
M v[248:251], a[120:123], v[40:43], 0
 v_exp_f32 v22, v108
M v[248:251], a[124:127], v[56:59], v[248:251]
 s_cmp_lg_u32 s27, 0
 v_exp_f32 v23, v109
M v[252:255], a[124:127], v[60:63], 0
 s_waitcnt lgkmcnt(0)
 v_cvt_pk_bf16_f32 v51, v24, v25
 v_add_f32 v28, v25, v28
M v[252:255], a[120:123], v[44:47], v[252:255]
 v_exp_f32 v24, v110
 v_add_f32 v29, v18, v19
 v_cvt_pk_bf16_f32 v52, v18, v19
 v_add_f32 v29, v20, v29
 v_cvt_pk_bf16_f32 v53, v20, v21
 v_add_f32 v29, v21, v29
 v_exp_f32 v25, v111
 v_add_f32 v29, v22, v29
 v_cvt_pk_bf16_f32 v54, v22, v23
 v_add_f32 v29, v23, v29
 v_add_f32 v29, v24, v29
 v_cvt_pk_bf16_f32 v55, v24, v25
 v_add_f32 v29, v25, v29
 s_cbranch_scc1 L_loop_top
L_final_h:
 s_waitcnt vmcnt(8)
 s_barrier
 ds_read_b128 a[64:67], v7 offset:0
 ds_read_b128 a[68:71], v7 offset:1024
 ds_read_b128 a[72:75], v7 offset:2048
 ds_read_b128 a[76:79], v7 offset:3072
 ds_read_b128 a[80:83], v7 offset:4096
 ds_read_b128 a[84:87], v7 offset:5120
 ds_read_b128 a[88:91], v7 offset:6144
 ds_read_b128 a[92:95], v7 offset:7168
 s_add_u32 m0, s28, 65536
 v_exp_f32 v18, v112
 buffer_load_dwordx4 v3, s[8:11], s38 offen offset:0 sc1 lds
 v_exp_f32 v19, v113
 v_exp_f32 v20, v114
 v_add_f32 v28, v18, v28
 v_cvt_pk_bf16_f32 v56, v18, v19
 buffer_load_dwordx4 v3, s[8:11], s38 offen offset:1024 sc1 lds
 v_exp_f32 v21, v115
 v_add_f32 v28, v19, v28
 v_exp_f32 v22, v120
 v_add_f32 v28, v20, v28
 v_cvt_pk_bf16_f32 v57, v20, v21
 buffer_load_dwordx4 v3, s[8:11], s38 offen offset:2048 sc1 lds
 v_exp_f32 v23, v121
 v_add_f32 v28, v21, v28
 v_exp_f32 v24, v122
 v_add_f32 v28, v22, v28
 v_cvt_pk_bf16_f32 v58, v22, v23
 buffer_load_dwordx4 v3, s[8:11], s38 offen offset:3072 sc1 lds
 v_exp_f32 v25, v123
 v_add_f32 v28, v23, v28
 v_exp_f32 v18, v116
 v_add_f32 v28, v24, v28
 s_add_u32 m0, s28, 69632
 v_cvt_pk_bf16_f32 v59, v24, v25
 buffer_load_dwordx4 v4, s[8:11], s38 offen offset:0 sc1 lds
 v_exp_f32 v19, v117
 v_add_f32 v28, v25, v28
 v_exp_f32 v20, v118
 v_add_f32 v29, v18, v29
 v_cvt_pk_bf16_f32 v60, v18, v19
 buffer_load_dwordx4 v4, s[8:11], s38 offen offset:1024 sc1 lds
 v_exp_f32 v21, v119
 v_add_f32 v29, v19, v29
 v_exp_f32 v22, v124
 v_add_f32 v29, v20, v29
 v_cvt_pk_bf16_f32 v61, v20, v21
 buffer_load_dwordx4 v4, s[8:11], s38 offen offset:2048 sc1 lds
 v_exp_f32 v23, v125
 v_add_f32 v29, v21, v29
 v_exp_f32 v24, v126
 v_add_f32 v29, v22, v29
 v_cvt_pk_bf16_f32 v62, v22, v23
 buffer_load_dwordx4 v4, s[8:11], s38 offen offset:3072 sc1 lds
 s_add_u32 s38, s38, 32768
 v_exp_f32 v25, v127
 v_add_f32 v29, v23, v29
 v_add_f32 v29, v24, v29
 v_cvt_pk_bf16_f32 v63, v24, v25
 v_add_f32 v29, v25, v29
 v_max_f32 v10, v28, v29
 v_cmp_lt_f32 vcc, s31, v10
 s_nop 0
 s_cbranch_vccnz L_st4
L_rt4:
 v_add_f32 v30, v28, v30
 v_add_f32 v31, v29, v31
 v_mov_b32 v12, v32
 v_mov_b32 v13, v36
 v_mov_b32 v14, v30
 v_mov_b32 v15, v31
 buffer_store_dwordx4 v[12:15], v7, s[8:11], s52 offen sc1
 s_waitcnt lgkmcnt(0)
M v[128:131], a[64:67], v[48:51], v[128:131]
 ds_read_b128 a[96:99], v7 offset:8192
M v[128:131], a[68:71], v[56:59], v[128:131]
 ds_read_b128 a[100:103], v7 offset:9216
M v[132:135], a[68:71], v[60:63], v[132:135]
M v[132:135], a[64:67], v[52:55], v[132:135]
 ds_read_b128 a[104:107], v7 offset:10240
M v[136:139], a[72:75], v[48:51], v[136:139]
 ds_read_b128 a[108:111], v7 offset:11264
M v[136:139], a[76:79], v[56:59], v[136:139]
M v[140:143], a[76:79], v[60:63], v[140:143]
 ds_read_b128 a[112:115], v7 offset:12288
M v[140:143], a[72:75], v[52:55], v[140:143]
 ds_read_b128 a[116:119], v7 offset:13312
M v[144:147], a[80:83], v[48:51], v[144:147]
M v[144:147], a[84:87], v[56:59], v[144:147]
 ds_read_b128 a[120:123], v7 offset:14336
 v_cvt_pk_bf16_f32 v128, v128, v129
M v[148:151], a[84:87], v[60:63], v[148:151]
 ds_read_b128 a[124:127], v7 offset:15360
 v_cvt_pk_bf16_f32 v129, v130, v131
M v[148:151], a[80:83], v[52:55], v[148:151]
 v_cvt_pk_bf16_f32 v130, v136, v137
 v_cvt_pk_bf16_f32 v131, v138, v139
M v[152:155], a[88:91], v[48:51], v[152:155]
 buffer_store_dwordx4 v[128:131], v7, s[8:11], s12 offen offset:0 sc1
M v[152:155], a[92:95], v[56:59], v[152:155]
 v_cvt_pk_bf16_f32 v132, v132, v133
 v_cvt_pk_bf16_f32 v133, v134, v135
M v[156:159], a[92:95], v[60:63], v[156:159]
 v_cvt_pk_bf16_f32 v134, v140, v141
 v_cvt_pk_bf16_f32 v135, v142, v143
M v[156:159], a[88:91], v[52:55], v[156:159]
 s_waitcnt lgkmcnt(0)
M v[160:163], a[96:99], v[48:51], v[160:163]
 ds_read_b128 a[64:67], v7 offset:16384
M v[160:163], a[100:103], v[56:59], v[160:163]
 ds_read_b128 a[68:71], v7 offset:17408
M v[164:167], a[100:103], v[60:63], v[164:167]
 buffer_store_dwordx4 v[132:135], v7, s[8:11], s14 offen offset:0 sc1
M v[164:167], a[96:99], v[52:55], v[164:167]
 ds_read_b128 a[72:75], v7 offset:18432
 v_cvt_pk_bf16_f32 v144, v144, v145
M v[168:171], a[104:107], v[48:51], v[168:171]
 ds_read_b128 a[76:79], v7 offset:19456
 v_cvt_pk_bf16_f32 v145, v146, v147
M v[168:171], a[108:111], v[56:59], v[168:171]
 v_cvt_pk_bf16_f32 v146, v152, v153
 v_cvt_pk_bf16_f32 v147, v154, v155
M v[172:175], a[108:111], v[60:63], v[172:175]
 ds_read_b128 a[80:83], v7 offset:20480
M v[172:175], a[104:107], v[52:55], v[172:175]
 ds_read_b128 a[84:87], v7 offset:21504
M v[176:179], a[112:115], v[48:51], v[176:179]
 buffer_store_dwordx4 v[144:147], v7, s[8:11], s12 offen offset:1024 sc1
M v[176:179], a[116:119], v[56:59], v[176:179]
 ds_read_b128 a[88:91], v7 offset:22528
 v_cvt_pk_bf16_f32 v148, v148, v149
M v[180:183], a[116:119], v[60:63], v[180:183]
 ds_read_b128 a[92:95], v7 offset:23552
 v_cvt_pk_bf16_f32 v149, v150, v151
M v[180:183], a[112:115], v[52:55], v[180:183]
 v_cvt_pk_bf16_f32 v150, v156, v157
 v_cvt_pk_bf16_f32 v151, v158, v159
M v[184:187], a[120:123], v[48:51], v[184:187]
 buffer_store_dwordx4 v[148:151], v7, s[8:11], s14 offen offset:1024 sc1
M v[184:187], a[124:127], v[56:59], v[184:187]
 v_cvt_pk_bf16_f32 v160, v160, v161
 v_cvt_pk_bf16_f32 v161, v162, v163
M v[188:191], a[124:127], v[60:63], v[188:191]
 v_cvt_pk_bf16_f32 v162, v168, v169
 v_cvt_pk_bf16_f32 v163, v170, v171
M v[188:191], a[120:123], v[52:55], v[188:191]
 s_waitcnt lgkmcnt(0)
M v[192:195], a[64:67], v[48:51], v[192:195]
 ds_read_b128 a[96:99], v7 offset:24576
M v[192:195], a[68:71], v[56:59], v[192:195]
 ds_read_b128 a[100:103], v7 offset:25600
M v[196:199], a[68:71], v[60:63], v[196:199]
 buffer_store_dwordx4 v[160:163], v7, s[8:11], s12 offen offset:2048 sc1
M v[196:199], a[64:67], v[52:55], v[196:199]
 ds_read_b128 a[104:107], v7 offset:26624
 v_cvt_pk_bf16_f32 v164, v164, v165
M v[200:203], a[72:75], v[48:51], v[200:203]
 ds_read_b128 a[108:111], v7 offset:27648
 v_cvt_pk_bf16_f32 v165, v166, v167
M v[200:203], a[76:79], v[56:59], v[200:203]
 v_cvt_pk_bf16_f32 v166, v172, v173
 v_cvt_pk_bf16_f32 v167, v174, v175
M v[204:207], a[76:79], v[60:63], v[204:207]
 ds_read_b128 a[112:115], v7 offset:28672
M v[204:207], a[72:75], v[52:55], v[204:207]
 ds_read_b128 a[116:119], v7 offset:29696
M v[208:211], a[80:83], v[48:51], v[208:211]
 buffer_store_dwordx4 v[164:167], v7, s[8:11], s14 offen offset:2048 sc1
M v[208:211], a[84:87], v[56:59], v[208:211]
 ds_read_b128 a[120:123], v7 offset:30720
 v_cvt_pk_bf16_f32 v176, v176, v177
M v[212:215], a[84:87], v[60:63], v[212:215]
 ds_read_b128 a[124:127], v7 offset:31744
 v_cvt_pk_bf16_f32 v177, v178, v179
M v[212:215], a[80:83], v[52:55], v[212:215]
 v_cvt_pk_bf16_f32 v178, v184, v185
 v_cvt_pk_bf16_f32 v179, v186, v187
M v[216:219], a[88:91], v[48:51], v[216:219]
 buffer_store_dwordx4 v[176:179], v7, s[8:11], s12 offen offset:3072 sc1
M v[216:219], a[92:95], v[56:59], v[216:219]
 v_cvt_pk_bf16_f32 v180, v180, v181
 v_cvt_pk_bf16_f32 v181, v182, v183
M v[220:223], a[92:95], v[60:63], v[220:223]
 s_waitcnt lgkmcnt(0)
 v_cvt_pk_bf16_f32 v182, v188, v189
 v_cvt_pk_bf16_f32 v183, v190, v191
M v[220:223], a[88:91], v[52:55], v[220:223]
 s_barrier
M v[224:227], a[96:99], v[48:51], v[224:227]
 ds_read_b128 a[64:67], v2 offset:32768
M v[224:227], a[100:103], v[56:59], v[224:227]
 ds_read_b128 a[68:71], v2 offset:33792
M v[228:231], a[100:103], v[60:63], v[228:231]
 buffer_store_dwordx4 v[180:183], v7, s[8:11], s14 offen offset:3072 sc1
M v[228:231], a[96:99], v[52:55], v[228:231]
 ds_read_b128 a[72:75], v2 offset:34816
 v_cvt_pk_bf16_f32 v192, v192, v193
M v[232:235], a[104:107], v[48:51], v[232:235]
 ds_read_b128 a[76:79], v2 offset:35840
 v_cvt_pk_bf16_f32 v193, v194, v195
M v[232:235], a[108:111], v[56:59], v[232:235]
 v_cvt_pk_bf16_f32 v194, v200, v201
 v_cvt_pk_bf16_f32 v195, v202, v203
M v[236:239], a[108:111], v[60:63], v[236:239]
 ds_read_b128 a[80:83], v2 offset:36864
M v[236:239], a[104:107], v[52:55], v[236:239]
 ds_read_b128 a[84:87], v2 offset:37888
M v[240:243], a[112:115], v[48:51], v[240:243]
 buffer_store_dwordx4 v[192:195], v7, s[8:11], s13 offen offset:0 sc1
M v[240:243], a[116:119], v[56:59], v[240:243]
 ds_read_b128 a[88:91], v2 offset:38912
 v_cvt_pk_bf16_f32 v196, v196, v197
M v[244:247], a[116:119], v[60:63], v[244:247]
 ds_read_b128 a[92:95], v2 offset:39936
 v_cvt_pk_bf16_f32 v197, v198, v199
M v[244:247], a[112:115], v[52:55], v[244:247]
 v_cvt_pk_bf16_f32 v198, v204, v205
 v_cvt_pk_bf16_f32 v199, v206, v207
M v[248:251], a[120:123], v[48:51], v[248:251]
 buffer_store_dwordx4 v[196:199], v7, s[8:11], s15 offen offset:0 sc1
M v[248:251], a[124:127], v[56:59], v[248:251]
 v_cvt_pk_bf16_f32 v208, v208, v209
 v_cvt_pk_bf16_f32 v209, v210, v211
M v[252:255], a[124:127], v[60:63], v[252:255]
 s_waitcnt lgkmcnt(0)
 v_cvt_pk_bf16_f32 v210, v216, v217
 v_cvt_pk_bf16_f32 v211, v218, v219
M v[252:255], a[120:123], v[52:55], v[252:255]
 buffer_store_dwordx4 v[208:211], v7, s[8:11], s13 offen offset:1024 sc1
 v_cvt_pk_bf16_f32 v212, v212, v213
 v_cvt_pk_bf16_f32 v213, v214, v215
 v_cvt_pk_bf16_f32 v214, v220, v221
 v_cvt_pk_bf16_f32 v215, v222, v223
 buffer_store_dwordx4 v[212:215], v7, s[8:11], s15 offen offset:1024 sc1
 v_cvt_pk_bf16_f32 v224, v224, v225
 v_cvt_pk_bf16_f32 v225, v226, v227
 v_cvt_pk_bf16_f32 v226, v232, v233
 v_cvt_pk_bf16_f32 v227, v234, v235
 buffer_store_dwordx4 v[224:227], v7, s[8:11], s13 offen offset:2048 sc1
 v_cvt_pk_bf16_f32 v228, v228, v229
 v_cvt_pk_bf16_f32 v229, v230, v231
 v_cvt_pk_bf16_f32 v230, v236, v237
 v_cvt_pk_bf16_f32 v231, v238, v239
 buffer_store_dwordx4 v[228:231], v7, s[8:11], s15 offen offset:2048 sc1
 v_cvt_pk_bf16_f32 v240, v240, v241
 v_cvt_pk_bf16_f32 v241, v242, v243
 v_cvt_pk_bf16_f32 v242, v248, v249
 v_cvt_pk_bf16_f32 v243, v250, v251
 buffer_store_dwordx4 v[240:243], v7, s[8:11], s13 offen offset:3072 sc1
 v_cvt_pk_bf16_f32 v244, v244, v245
 v_cvt_pk_bf16_f32 v245, v246, v247
 v_cvt_pk_bf16_f32 v246, v252, v253
 v_cvt_pk_bf16_f32 v247, v254, v255
 buffer_store_dwordx4 v[244:247], v7, s[8:11], s15 offen offset:3072 sc1
M v[64:67], a[64:67], a[128:131], 0
 ds_read_b128 a[96:99], v2 offset:40960
M v[64:67], a[68:71], a[132:135], v[64:67]
 s_add_u32 m0, s28, 0
 ds_read_b128 a[100:103], v2 offset:41984
M v[64:67], a[72:75], a[136:139], v[64:67]
 buffer_load_dwordx4 v3, s[8:11], s38 offen offset:0 sc1 lds
M v[64:67], a[76:79], a[140:143], v[64:67]
 ds_read_b128 a[104:107], v2 offset:43008
 v_accvgpr_read_b32 v5, a192
M v[64:67], a[80:83], a[144:147], v[64:67]
 ds_read_b128 a[108:111], v2 offset:44032
 v_accvgpr_read_b32 v6, a193
M v[64:67], a[84:87], a[148:151], v[64:67]
 buffer_load_dwordx4 v3, s[8:11], s38 offen offset:1024 sc1 lds
M v[64:67], a[88:91], a[152:155], v[64:67]
 ds_read_b128 a[112:115], v2 offset:45056
M v[64:67], a[92:95], a[156:159], v[64:67]
 ds_read_b128 a[116:119], v2 offset:46080
M v[68:71], a[92:95], a[188:191], 0
 buffer_load_dwordx4 v3, s[8:11], s38 offen offset:2048 sc1 lds
M v[68:71], a[88:91], a[184:187], v[68:71]
 ds_read_b128 a[120:123], v2 offset:47104
M v[68:71], a[84:87], a[180:183], v[68:71]
 ds_read_b128 a[124:127], v2 offset:48128
M v[68:71], a[80:83], a[176:179], v[68:71]
M v[68:71], a[76:79], a[172:175], v[68:71]
 buffer_load_dwordx4 v3, s[8:11], s38 offen offset:3072 sc1 lds
M v[68:71], a[72:75], a[168:171], v[68:71]
M v[68:71], a[68:71], a[164:167], v[68:71]
M v[68:71], a[64:67], a[160:163], v[68:71]
 s_waitcnt lgkmcnt(0)
M v[72:75], a[96:99], a[128:131], 0
 ds_read_b128 a[64:67], v2 offset:49152
M v[72:75], a[100:103], a[132:135], v[72:75]
 s_add_u32 m0, s28, 4096
 ds_read_b128 a[68:71], v2 offset:50176
M v[72:75], a[104:107], a[136:139], v[72:75]
 buffer_load_dwordx4 v4, s[8:11], s38 offen offset:0 sc1 lds
M v[72:75], a[108:111], a[140:143], v[72:75]
 ds_read_b128 a[72:75], v2 offset:51200
M v[72:75], a[112:115], a[144:147], v[72:75]
 s_xor_b32 s47, s47, 64
 ds_read_b128 a[76:79], v2 offset:52224
M v[72:75], a[116:119], a[148:151], v[72:75]
 v_mov_b32 v18, 1
 v_min_u32 v19, 1, v7
M v[72:75], a[120:123], a[152:155], v[72:75]
 ds_read_b128 a[80:83], v2 offset:53248
 v_lshlrev_b32 v19, 29, v19
M v[72:75], a[124:127], a[156:159], v[72:75]
 s_waitcnt vmcnt(5)
 ds_read_b128 a[84:87], v2 offset:54272
M v[76:79], a[124:127], a[188:191], 0
 buffer_store_dword v18, v19, s[8:11], s47 offen sc1
M v[76:79], a[120:123], a[184:187], v[76:79]
 ds_read_b128 a[88:91], v2 offset:55296
M v[76:79], a[116:119], a[180:183], v[76:79]
 ds_read_b128 a[92:95], v2 offset:56320
M v[76:79], a[112:115], a[176:179], v[76:79]
 buffer_load_dwordx4 v4, s[8:11], s38 offen offset:1024 sc1 lds
M v[76:79], a[108:111], a[172:175], v[76:79]
M v[76:79], a[104:107], a[168:171], v[76:79]
 buffer_load_dwordx4 v4, s[8:11], s38 offen offset:2048 sc1 lds
M v[76:79], a[100:103], a[164:167], v[76:79]
M v[76:79], a[96:99], a[160:163], v[76:79]
 s_waitcnt lgkmcnt(0)
M v[80:83], a[64:67], a[128:131], 0
 ds_read_b128 a[96:99], v2 offset:57344
M v[80:83], a[68:71], a[132:135], v[80:83]
 ds_read_b128 a[100:103], v2 offset:58368
M v[80:83], a[72:75], a[136:139], v[80:83]
 buffer_load_dwordx4 v4, s[8:11], s38 offen offset:3072 sc1 lds
M v[80:83], a[76:79], a[140:143], v[80:83]
 s_add_u32 s38, s38, 32768
 ds_read_b128 a[104:107], v2 offset:59392
M v[80:83], a[80:83], a[144:147], v[80:83]
 s_add_u32 m0, s28, 131072
 ds_read_b128 a[108:111], v2 offset:60416
M v[80:83], a[84:87], a[148:151], v[80:83]
 buffer_load_dwordx4 v3, s[8:11], s38 offen offset:0 sc1 lds
M v[80:83], a[88:91], a[152:155], v[80:83]
 ds_read_b128 a[112:115], v2 offset:61440
M v[80:83], a[92:95], a[156:159], v[80:83]
 ds_read_b128 a[116:119], v2 offset:62464
M v[84:87], a[92:95], a[188:191], 0
 buffer_load_dwordx4 v3, s[8:11], s38 offen offset:1024 sc1 lds
M v[84:87], a[88:91], a[184:187], v[84:87]
 ds_read_b128 a[120:123], v2 offset:63488
M v[84:87], a[84:87], a[180:183], v[84:87]
 ds_read_b128 a[124:127], v2 offset:64512
M v[84:87], a[80:83], a[176:179], v[84:87]
 buffer_load_dwordx4 v3, s[8:11], s38 offen offset:2048 sc1 lds
M v[84:87], a[76:79], a[172:175], v[84:87]
M v[84:87], a[72:75], a[168:171], v[84:87]
 buffer_load_dwordx4 v3, s[8:11], s38 offen offset:3072 sc1 lds
M v[84:87], a[68:71], a[164:167], v[84:87]
 s_waitcnt lgkmcnt(0)
M v[84:87], a[64:67], a[160:163], v[84:87]
 s_barrier
M v[88:91], a[96:99], a[128:131], 0
 ds_read_b128 a[64:67], v7 offset:32768
M v[88:91], a[100:103], a[132:135], v[88:91]
 s_add_u32 m0, s28, 135168
 ds_read_b128 a[68:71], v7 offset:33792
M v[88:91], a[104:107], a[136:139], v[88:91]
 buffer_load_dwordx4 v4, s[8:11], s38 offen offset:0 sc1 lds
M v[88:91], a[108:111], a[140:143], v[88:91]
 ds_read_b128 a[72:75], v7 offset:34816
M v[88:91], a[112:115], a[144:147], v[88:91]
 ds_read_b128 a[76:79], v7 offset:35840
M v[88:91], a[116:119], a[148:151], v[88:91]
 buffer_load_dwordx4 v4, s[8:11], s38 offen offset:1024 sc1 lds
M v[88:91], a[120:123], a[152:155], v[88:91]
 ds_read_b128 a[80:83], v7 offset:36864
M v[88:91], a[124:127], a[156:159], v[88:91]
 ds_read_b128 a[84:87], v7 offset:37888
M v[92:95], a[124:127], a[188:191], 0
 buffer_load_dwordx4 v4, s[8:11], s38 offen offset:2048 sc1 lds
M v[92:95], a[120:123], a[184:187], v[92:95]
 ds_read_b128 a[88:91], v7 offset:38912
M v[92:95], a[116:119], a[180:183], v[92:95]
 ds_read_b128 a[92:95], v7 offset:39936
M v[92:95], a[112:115], a[176:179], v[92:95]
 buffer_load_dwordx4 v4, s[8:11], s38 offen offset:3072 sc1 lds
M v[92:95], a[108:111], a[172:175], v[92:95]
 s_add_u32 s38, s38, 32768
M v[92:95], a[104:107], a[168:171], v[92:95]
M v[92:95], a[100:103], a[164:167], v[92:95]
 s_waitcnt lgkmcnt(0)
M v[92:95], a[96:99], a[160:163], v[92:95]
M v[96:99], a[64:67], a[128:131], 0
 s_add_u32 m0, s28, 98304
 ds_read_b128 a[96:99], v7 offset:40960
M v[96:99], a[68:71], a[132:135], v[96:99]
 ds_read_b128 a[100:103], v7 offset:41984
M v[96:99], a[72:75], a[136:139], v[96:99]
 buffer_load_dwordx4 v3, s[8:11], s38 offen offset:0 sc1 lds
M v[96:99], a[76:79], a[140:143], v[96:99]
 ds_read_b128 a[104:107], v7 offset:43008
 s_add_u32 s29, s33, 0
M v[96:99], a[80:83], a[144:147], v[96:99]
 ds_read_b128 a[108:111], v7 offset:44032
 s_add_u32 s30, s33, 14336
M v[96:99], a[84:87], a[148:151], v[96:99]
 buffer_load_dwordx4 v3, s[8:11], s38 offen offset:1024 sc1 lds
M v[96:99], a[88:91], a[152:155], v[96:99]
 ds_read_b128 a[112:115], v7 offset:45056
 v_max3_f32 v32, |v64|, |v65|, |v66|
M v[96:99], a[92:95], a[156:159], v[96:99]
 ds_read_b128 a[116:119], v7 offset:46080
 v_max3_f32 v32, |v67|, |v72|, v32
M v[100:103], a[92:95], a[188:191], 0
 buffer_load_dwordx4 v3, s[8:11], s38 offen offset:2048 sc1 lds
M v[100:103], a[88:91], a[184:187], v[100:103]
 ds_read_b128 a[120:123], v7 offset:47104
 v_max3_f32 v32, |v73|, |v74|, v32
M v[100:103], a[84:87], a[180:183], v[100:103]
 ds_read_b128 a[124:127], v7 offset:48128
 v_mul_f32 v32, 2.0, v32
M v[100:103], a[80:83], a[176:179], v[100:103]
 buffer_load_dwordx4 v3, s[8:11], s38 offen offset:3072 sc1 lds
M v[100:103], a[76:79], a[172:175], v[100:103]
 s_add_u32 m0, s28, 102400
 v_mov_b32 v33, v32
 v_mov_b32 v34, v32
M v[100:103], a[72:75], a[168:171], v[100:103]
 buffer_load_dwordx4 v4, s[8:11], s38 offen offset:0 sc1 lds
M v[100:103], a[68:71], a[164:167], v[100:103]
 v_mov_b32 v35, v32
 v_mul_f32 v28, -v32, v5
M v[100:103], a[64:67], a[160:163], v[100:103]
 s_waitcnt lgkmcnt(0)
 v_mul_f32 v64, v5, v64
 v_mul_f32 v65, v5, v65
M v[104:107], a[96:99], a[128:131], 0
 ds_read_b128 a[64:67], v7 offset:49152
 v_mul_f32 v66, v5, v66
M v[104:107], a[100:103], a[132:135], v[104:107]
 ds_read_b128 a[68:71], v7 offset:50176
 v_mul_f32 v67, v5, v67
M v[104:107], a[104:107], a[136:139], v[104:107]
 buffer_load_dwordx4 v4, s[8:11], s38 offen offset:1024 sc1 lds
M v[104:107], a[108:111], a[140:143], v[104:107]
 ds_read_b128 a[72:75], v7 offset:51200
 v_mul_f32 v72, v5, v72
M v[104:107], a[112:115], a[144:147], v[104:107]
 ds_read_b128 a[76:79], v7 offset:52224
 v_mul_f32 v73, v5, v73
M v[104:107], a[116:119], a[148:151], v[104:107]
 buffer_load_dwordx4 v4, s[8:11], s38 offen offset:2048 sc1 lds
M v[104:107], a[120:123], a[152:155], v[104:107]
 ds_read_b128 a[80:83], v7 offset:53248
 v_mul_f32 v74, v5, v74
M v[104:107], a[124:127], a[156:159], v[104:107]
 ds_read_b128 a[84:87], v7 offset:54272
 v_mul_f32 v75, v5, v75
M v[108:111], a[124:127], a[188:191], 0
 buffer_load_dwordx4 v4, s[8:11], s38 offen offset:3072 sc1 lds
M v[108:111], a[120:123], a[184:187], v[108:111]
 s_add_u32 s38, s38, 32768
 ds_read_b128 a[88:91], v7 offset:55296
 v_cvt_pk_bf16_f32 v64, v64, v65
M v[108:111], a[116:119], a[180:183], v[108:111]
 ds_read_b128 a[92:95], v7 offset:56320
 v_cvt_pk_bf16_f32 v65, v66, v67
M v[108:111], a[112:115], a[176:179], v[108:111]
 v_cvt_pk_bf16_f32 v66, v72, v73
 v_cvt_pk_bf16_f32 v67, v74, v75
M v[108:111], a[108:111], a[172:175], v[108:111]
 buffer_store_dwordx4 v[64:67], v7, s[8:11], s29 offen offset:0 sc1
M v[108:111], a[104:107], a[168:171], v[108:111]
 v_max3_f32 v36, |v68|, |v69|, |v70|
 v_max3_f32 v36, |v71|, |v76|, v36
M v[108:111], a[100:103], a[164:167], v[108:111]
 v_max3_f32 v36, |v77|, |v78|, v36
 v_mul_f32 v36, 2.0, v36
M v[108:111], a[96:99], a[160:163], v[108:111]
 s_waitcnt lgkmcnt(0)
 v_mov_b32 v37, v36
 v_mov_b32 v38, v36
M v[112:115], a[64:67], a[128:131], 0
 ds_read_b128 a[96:99], v7 offset:57344
 v_mov_b32 v39, v36
M v[112:115], a[68:71], a[132:135], v[112:115]
 ds_read_b128 a[100:103], v7 offset:58368
 v_mul_f32 v29, -v36, v6
M v[112:115], a[72:75], a[136:139], v[112:115]
 v_mul_f32 v68, v6, v68
 v_mul_f32 v69, v6, v69
M v[112:115], a[76:79], a[140:143], v[112:115]
 ds_read_b128 a[104:107], v7 offset:59392
 v_mul_f32 v70, v6, v70
M v[112:115], a[80:83], a[144:147], v[112:115]
 ds_read_b128 a[108:111], v7 offset:60416
 v_mul_f32 v71, v6, v71
M v[112:115], a[84:87], a[148:151], v[112:115]
 v_mul_f32 v76, v6, v76
 v_mul_f32 v77, v6, v77
M v[112:115], a[88:91], a[152:155], v[112:115]
 ds_read_b128 a[112:115], v7 offset:61440
 v_mul_f32 v78, v6, v78
M v[112:115], a[92:95], a[156:159], v[112:115]
 ds_read_b128 a[116:119], v7 offset:62464
 v_mul_f32 v79, v6, v79
M v[116:119], a[92:95], a[188:191], 0
 v_cvt_pk_bf16_f32 v68, v68, v69
 v_cvt_pk_bf16_f32 v69, v70, v71
M v[116:119], a[88:91], a[184:187], v[116:119]
 ds_read_b128 a[120:123], v7 offset:63488
 v_cvt_pk_bf16_f32 v70, v76, v77
M v[116:119], a[84:87], a[180:183], v[116:119]
 ds_read_b128 a[124:127], v7 offset:64512
 v_cvt_pk_bf16_f32 v71, v78, v79
M v[116:119], a[80:83], a[176:179], v[116:119]
 buffer_store_dwordx4 v[68:71], v7, s[8:11], s30 offen offset:0 sc1
M v[116:119], a[76:79], a[172:175], v[116:119]
 v_mul_f32 v80, v5, v80
 v_mul_f32 v81, v5, v81
M v[116:119], a[72:75], a[168:171], v[116:119]
 v_mul_f32 v82, v5, v82
 v_mul_f32 v83, v5, v83
M v[116:119], a[68:71], a[164:167], v[116:119]
 s_waitcnt lgkmcnt(0)
 v_mul_f32 v88, v5, v88
 v_mul_f32 v89, v5, v89
M v[116:119], a[64:67], a[160:163], v[116:119]
 s_barrier
M v[120:123], a[96:99], a[128:131], 0
 ds_read_b128 a[64:67], v2 offset:0
 v_mul_f32 v90, v5, v90
M v[120:123], a[100:103], a[132:135], v[120:123]
 ds_read_b128 a[68:71], v2 offset:1024
 v_mul_f32 v91, v5, v91
M v[120:123], a[104:107], a[136:139], v[120:123]
 v_cvt_pk_bf16_f32 v80, v80, v81
 v_cvt_pk_bf16_f32 v81, v82, v83
M v[120:123], a[108:111], a[140:143], v[120:123]
 ds_read_b128 a[72:75], v2 offset:2048
 v_cvt_pk_bf16_f32 v82, v88, v89
M v[120:123], a[112:115], a[144:147], v[120:123]
 ds_read_b128 a[76:79], v2 offset:3072
 v_cvt_pk_bf16_f32 v83, v90, v91
M v[120:123], a[116:119], a[148:151], v[120:123]
 buffer_store_dwordx4 v[80:83], v7, s[8:11], s29 offen offset:1024 sc1
M v[120:123], a[120:123], a[152:155], v[120:123]
 ds_read_b128 a[80:83], v2 offset:4096
 v_mul_f32 v84, v6, v84
M v[120:123], a[124:127], a[156:159], v[120:123]
 ds_read_b128 a[84:87], v2 offset:5120
 v_mul_f32 v85, v6, v85
M v[124:127], a[124:127], a[188:191], 0
 v_mul_f32 v86, v6, v86
 v_mul_f32 v87, v6, v87
M v[124:127], a[120:123], a[184:187], v[124:127]
 ds_read_b128 a[88:91], v2 offset:6144
 v_mul_f32 v92, v6, v92
M v[124:127], a[116:119], a[180:183], v[124:127]
 ds_read_b128 a[92:95], v2 offset:7168
 v_mul_f32 v93, v6, v93
M v[124:127], a[112:115], a[176:179], v[124:127]
 v_mul_f32 v94, v6, v94
 v_mul_f32 v95, v6, v95
M v[124:127], a[108:111], a[172:175], v[124:127]
 v_cvt_pk_bf16_f32 v84, v84, v85
 v_cvt_pk_bf16_f32 v85, v86, v87
M v[124:127], a[104:107], a[168:171], v[124:127]
 v_cvt_pk_bf16_f32 v86, v92, v93
 v_cvt_pk_bf16_f32 v87, v94, v95
M v[124:127], a[100:103], a[164:167], v[124:127]
 s_waitcnt lgkmcnt(0)
M v[124:127], a[96:99], a[160:163], v[124:127]
 buffer_store_dwordx4 v[84:87], v7, s[8:11], s30 offen offset:1024 sc1
M v[64:67], a[64:67], a[128:131], v[32:35]
 s_add_u32 m0, s28, 32768
 ds_read_b128 a[96:99], v2 offset:8192
M v[64:67], a[68:71], a[132:135], v[64:67]
 ds_read_b128 a[100:103], v2 offset:9216
 s_mov_b32 s79, 104923136
M v[64:67], a[72:75], a[136:139], v[64:67]
 buffer_load_dwordx4 v3, s[8:11], s38 offen offset:0 sc1 lds
M v[64:67], a[76:79], a[140:143], v[64:67]
 ds_read_b128 a[104:107], v2 offset:10240
 s_add_u32 s29, s33, 2048
M v[64:67], a[80:83], a[144:147], v[64:67]
 ds_read_b128 a[108:111], v2 offset:11264
 s_add_u32 s30, s33, 16384
M v[64:67], a[84:87], a[148:151], v[64:67]
 buffer_load_dwordx4 v3, s[8:11], s38 offen offset:1024 sc1 lds
M v[64:67], a[88:91], a[152:155], v[64:67]
 ds_read_b128 a[112:115], v2 offset:12288
 v_mul_f32 v96, v5, v96
M v[64:67], a[92:95], a[156:159], v[64:67]
 ds_read_b128 a[116:119], v2 offset:13312
 v_mul_f32 v97, v5, v97
M v[68:71], a[92:95], a[188:191], v[36:39]
 buffer_load_dwordx4 v3, s[8:11], s38 offen offset:2048 sc1 lds
M v[68:71], a[88:91], a[184:187], v[68:71]
 ds_read_b128 a[120:123], v2 offset:14336
 v_mul_f32 v98, v5, v98
M v[68:71], a[84:87], a[180:183], v[68:71]
 ds_read_b128 a[124:127], v2 offset:15360
 v_mul_f32 v99, v5, v99
M v[68:71], a[80:83], a[176:179], v[68:71]
 buffer_load_dwordx4 v3, s[8:11], s38 offen offset:3072 sc1 lds
M v[68:71], a[76:79], a[172:175], v[68:71]
 s_add_u32 m0, s28, 36864
 v_mul_f32 v104, v5, v104
 v_mul_f32 v105, v5, v105
M v[68:71], a[72:75], a[168:171], v[68:71]
 buffer_load_dwordx4 v4, s[8:11], s38 offen offset:0 sc1 lds
M v[68:71], a[68:71], a[164:167], v[68:71]
 buffer_load_dword v24, off, s[8:11], s79 sc1
M v[68:71], a[64:67], a[160:163], v[68:71]
 s_waitcnt lgkmcnt(0)
 v_lshrrev_b32 v0, 4, v7
 v_and_b32 v14, 15, v0
M v[72:75], a[96:99], a[128:131], v[32:35]
 ds_read_b128 a[64:67], v2 offset:16384
 v_lshlrev_b32 v14, 2, v14
M v[72:75], a[100:103], a[132:135], v[72:75]
 ds_read_b128 a[68:71], v2 offset:17408
 v_lshrrev_b32 v11, 4, v0
M v[72:75], a[104:107], a[136:139], v[72:75]
 buffer_load_dwordx4 v4, s[8:11], s38 offen offset:1024 sc1 lds
M v[72:75], a[108:111], a[140:143], v[72:75]
 ds_read_b128 a[72:75], v2 offset:18432
 s_mov_b32 s52, s96
M v[72:75], a[112:115], a[144:147], v[72:75]
 s_and_b32 s53, s97, 0xffff
 ds_read_b128 a[76:79], v2 offset:19456
 s_mov_b32 s54, 1835008
M v[72:75], a[116:119], a[148:151], v[72:75]
 buffer_load_dwordx4 v4, s[8:11], s38 offen offset:2048 sc1 lds
M v[72:75], a[120:123], a[152:155], v[72:75]
 ds_read_b128 a[80:83], v2 offset:20480
 s_mov_b32 s55, 0x20000
M v[72:75], a[124:127], a[156:159], v[72:75]
 s_lshr_b32 s74, s41, 3
 ds_read_b128 a[84:87], v2 offset:21504
 s_xor_b32 s74, s74, 0
M v[76:79], a[124:127], a[188:191], v[36:39]
 buffer_load_dwordx4 v4, s[8:11], s38 offen offset:3072 sc1 lds
M v[76:79], a[120:123], a[184:187], v[76:79]
 s_add_u32 s38, s38, 32768
 ds_read_b128 a[88:91], v2 offset:22528
 s_mul_i32 s67, s74, -2
M v[76:79], a[116:119], a[180:183], v[76:79]
 s_mul_i32 s74, s74, 8
 ds_read_b128 a[92:95], v2 offset:23552
 v_mul_f32 v106, v5, v106
M v[76:79], a[112:115], a[176:179], v[76:79]
 s_add_u32 s74, s74, s20
 v_mul_f32 v107, v5, v107
 v_cvt_pk_bf16_f32 v96, v96, v97
M v[76:79], a[108:111], a[172:175], v[76:79]
 s_lshl_b32 s75, s74, 6
 v_cvt_pk_bf16_f32 v97, v98, v99
 v_cvt_pk_bf16_f32 v98, v104, v105
M v[76:79], a[104:107], a[168:171], v[76:79]
 s_add_u32 s76, s75, 256
 v_cvt_pk_bf16_f32 v99, v106, v107
M v[76:79], a[100:103], a[164:167], v[76:79]
 s_add_u32 s67, s67, 3
 v_add_u32 v43, 0x20000, v7
 s_sub_u32 s67, s67, s20
M v[76:79], a[96:99], a[160:163], v[76:79]
 s_waitcnt lgkmcnt(0)
 s_and_b32 s67, s67, 536870912
M v[80:83], a[64:67], a[128:131], v[32:35]
 s_or_b32 s76, s76, s67
 ds_read_b128 a[96:99], v2 offset:24576
 v_or_b32 v27, s67, v7
M v[80:83], a[68:71], a[132:135], v[80:83]
 ds_read_b128 a[100:103], v2 offset:25600
 v_add_u32 v27, 4096, v27
M v[80:83], a[72:75], a[136:139], v[80:83]
 buffer_store_dwordx4 v[96:99], v7, s[8:11], s29 offen offset:0 sc1
M v[80:83], a[76:79], a[140:143], v[80:83]
 ds_read_b128 a[104:107], v2 offset:26624
 v_mul_f32 v100, v6, v100
M v[80:83], a[80:83], a[144:147], v[80:83]
 ds_read_b128 a[108:111], v2 offset:27648
 v_mul_f32 v101, v6, v101
M v[80:83], a[84:87], a[148:151], v[80:83]
 v_mul_f32 v102, v6, v102
 v_mul_f32 v103, v6, v103
M v[80:83], a[88:91], a[152:155], v[80:83]
 ds_read_b128 a[112:115], v2 offset:28672
 v_mul_f32 v108, v6, v108
M v[80:83], a[92:95], a[156:159], v[80:83]
 ds_read_b128 a[116:119], v2 offset:29696
 v_mul_f32 v109, v6, v109
M v[84:87], a[92:95], a[188:191], v[36:39]
 v_mul_f32 v110, v6, v110
 v_mul_f32 v111, v6, v111
M v[84:87], a[88:91], a[184:187], v[84:87]
 ds_read_b128 a[120:123], v2 offset:30720
 v_cvt_pk_bf16_f32 v100, v100, v101
M v[84:87], a[84:87], a[180:183], v[84:87]
 ds_read_b128 a[124:127], v2 offset:31744
 v_cvt_pk_bf16_f32 v101, v102, v103
M v[84:87], a[80:83], a[176:179], v[84:87]
 v_cvt_pk_bf16_f32 v102, v108, v109
 v_cvt_pk_bf16_f32 v103, v110, v111
M v[84:87], a[76:79], a[172:175], v[84:87]
 buffer_store_dwordx4 v[100:103], v7, s[8:11], s30 offen offset:0 sc1
M v[84:87], a[72:75], a[168:171], v[84:87]
 v_mul_f32 v112, v5, v112
 v_mul_f32 v113, v5, v113
M v[84:87], a[68:71], a[164:167], v[84:87]
 s_waitcnt vmcnt(31) lgkmcnt(0)
 v_mul_f32 v114, v5, v114
 v_mul_f32 v115, v5, v115
M v[84:87], a[64:67], a[160:163], v[84:87]
 s_barrier
M v[88:91], a[96:99], a[128:131], v[32:35]
 ds_read_b128 a[64:67], v7 offset:0
 v_mul_f32 v120, v5, v120
M v[88:91], a[100:103], a[132:135], v[88:91]
 ds_read_b128 a[68:71], v7 offset:1024
 v_mul_f32 v121, v5, v121
M v[88:91], a[104:107], a[136:139], v[88:91]
 v_mul_f32 v122, v5, v122
 v_mul_f32 v123, v5, v123
M v[88:91], a[108:111], a[140:143], v[88:91]
 ds_read_b128 a[72:75], v7 offset:2048
 v_cvt_pk_bf16_f32 v112, v112, v113
M v[88:91], a[112:115], a[144:147], v[88:91]
 ds_read_b128 a[76:79], v7 offset:3072
 v_cvt_pk_bf16_f32 v113, v114, v115
M v[88:91], a[116:119], a[148:151], v[88:91]
 v_cvt_pk_bf16_f32 v114, v120, v121
 v_cvt_pk_bf16_f32 v115, v122, v123
M v[88:91], a[120:123], a[152:155], v[88:91]
 ds_read_b128 a[80:83], v7 offset:4096
M v[88:91], a[124:127], a[156:159], v[88:91]
 ds_read_b128 a[84:87], v7 offset:5120
M v[92:95], a[124:127], a[188:191], v[36:39]
 buffer_store_dwordx4 v[112:115], v7, s[8:11], s29 offen offset:1024 sc1
M v[92:95], a[120:123], a[184:187], v[92:95]
 ds_read_b128 a[88:91], v7 offset:6144
 v_mul_f32 v116, v6, v116
M v[92:95], a[116:119], a[180:183], v[92:95]
 ds_read_b128 a[92:95], v7 offset:7168
 v_mul_f32 v117, v6, v117
M v[92:95], a[112:115], a[176:179], v[92:95]
 v_mul_f32 v118, v6, v118
 v_mul_f32 v119, v6, v119
M v[92:95], a[108:111], a[172:175], v[92:95]
 v_mul_f32 v124, v6, v124
 v_mul_f32 v125, v6, v125
M v[92:95], a[104:107], a[168:171], v[92:95]
 v_mul_f32 v126, v6, v126
 v_mul_f32 v127, v6, v127
M v[92:95], a[100:103], a[164:167], v[92:95]
 s_waitcnt lgkmcnt(0)
 v_cvt_pk_bf16_f32 v116, v116, v117
 v_cvt_pk_bf16_f32 v117, v118, v119
M v[92:95], a[96:99], a[160:163], v[92:95]
 v_cvt_pk_bf16_f32 v118, v124, v125
 v_cvt_pk_bf16_f32 v119, v126, v127
 buffer_store_dwordx4 v[116:119], v7, s[8:11], s30 offen offset:1024 sc1
M v[96:99], a[64:67], a[128:131], v[32:35]
 ds_read_b128 a[96:99], v7 offset:8192
M v[96:99], a[68:71], a[132:135], v[96:99]
 ds_read_b128 a[100:103], v7 offset:9216
M v[96:99], a[72:75], a[136:139], v[96:99]
 s_sub_u32 s64, 15, s42
M v[96:99], a[76:79], a[140:143], v[96:99]
 s_min_u32 s64, s64, s42
 ds_read_b128 a[104:107], v7 offset:10240
 s_add_u32 s29, s33, 4096
M v[96:99], a[80:83], a[144:147], v[96:99]
 s_mul_i32 s45, s64, 8704
 ds_read_b128 a[108:111], v7 offset:11264
 s_add_u32 s30, s33, 18432
M v[96:99], a[84:87], a[148:151], v[96:99]
 s_lshl_b32 s64, s20, 6
 v_fma_f32 v64, v64, v5, v28
 v_fma_f32 v65, v65, v5, v28
M v[96:99], a[88:91], a[152:155], v[96:99]
 s_add_u32 s64, s64, s41
 ds_read_b128 a[112:115], v7 offset:12288
 v_fma_f32 v66, v66, v5, v28
M v[96:99], a[92:95], a[156:159], v[96:99]
 s_lshl2_add_u32 s45, s64, s45
 ds_read_b128 a[116:119], v7 offset:13312
 v_fma_f32 v67, v67, v5, v28
M v[100:103], a[92:95], a[188:191], v[36:39]
 s_add_u32 s45, s45, 104992768
 v_fma_f32 v72, v72, v5, v28
M v[100:103], a[88:91], a[184:187], v[100:103]
 s_movk_i32 s65, 1024
 ds_read_b128 a[120:123], v7 offset:14336
 v_fma_f32 v73, v73, v5, v28
M v[100:103], a[84:87], a[180:183], v[100:103]
 s_cmp_lt_u32 s42, 8
 ds_read_b128 a[124:127], v7 offset:15360
 v_fma_f32 v74, v74, v5, v28
M v[100:103], a[80:83], a[176:179], v[100:103]
 s_cselect_b32 s64, 4352, s65
 v_fma_f32 v75, v75, v5, v28
M v[100:103], a[76:79], a[172:175], v[100:103]
 s_cselect_b32 s65, 0, 64
 v_cvt_pk_bf16_f32 v64, v64, v65
M v[100:103], a[72:75], a[168:171], v[100:103]
 s_cselect_b32 s66, 32, 64
 v_cvt_pk_bf16_f32 v65, v66, v67
M v[100:103], a[68:71], a[164:167], v[100:103]
 s_add_u32 s3, s45, s64
 s_add_u32 s45, s45, s65
 v_lshrrev_b32 v42, 5, v7
M v[100:103], a[64:67], a[160:163], v[100:103]
 s_waitcnt lgkmcnt(0)
 v_mul_u32_u24 v42, 4352, v42
 v_and_b32 v41, 16, v7
M v[104:107], a[96:99], a[128:131], v[32:35]
 ds_read_b128 a[64:67], v7 offset:16384
 v_lshl_add_u32 v41, v41, 3, v42
M v[104:107], a[100:103], a[132:135], v[104:107]
 ds_read_b128 a[68:71], v7 offset:17408
 v_mov_b32 v42, 536870912
M v[104:107], a[104:107], a[136:139], v[104:107]
 v_cmp_gt_u32 vcc, s66, v7
 v_mov_b32 v40, 1
M v[104:107], a[108:111], a[140:143], v[104:107]
 s_nop 0
 ds_read_b128 a[72:75], v7 offset:18432
 v_cndmask_b32 v41, v42, v41, vcc
M v[104:107], a[112:115], a[144:147], v[104:107]
 ds_read_b128 a[76:79], v7 offset:19456
 v_cvt_pk_bf16_f32 v66, v72, v73
M v[104:107], a[116:119], a[148:151], v[104:107]
 v_cvt_pk_bf16_f32 v67, v74, v75
M v[104:107], a[120:123], a[152:155], v[104:107]
 ds_read_b128 a[80:83], v7 offset:20480
M v[104:107], a[124:127], a[156:159], v[104:107]
 ds_read_b128 a[84:87], v7 offset:21504
M v[108:111], a[124:127], a[188:191], v[36:39]
 buffer_store_dwordx4 v[64:67], v7, s[8:11], s29 offen offset:0 sc1
M v[108:111], a[120:123], a[184:187], v[108:111]
 ds_read_b128 a[88:91], v7 offset:22528
 v_fma_f32 v68, v68, v6, v29
M v[108:111], a[116:119], a[180:183], v[108:111]
 ds_read_b128 a[92:95], v7 offset:23552
 v_fma_f32 v69, v69, v6, v29
M v[108:111], a[112:115], a[176:179], v[108:111]
 v_fma_f32 v70, v70, v6, v29
 v_fma_f32 v71, v71, v6, v29
M v[108:111], a[108:111], a[172:175], v[108:111]
 v_fma_f32 v76, v76, v6, v29
 v_fma_f32 v77, v77, v6, v29
M v[108:111], a[104:107], a[168:171], v[108:111]
 v_fma_f32 v78, v78, v6, v29
 v_fma_f32 v79, v79, v6, v29
M v[108:111], a[100:103], a[164:167], v[108:111]
 v_cvt_pk_bf16_f32 v68, v68, v69
 v_cvt_pk_bf16_f32 v69, v70, v71
M v[108:111], a[96:99], a[160:163], v[108:111]
 s_waitcnt lgkmcnt(0)
 v_cvt_pk_bf16_f32 v70, v76, v77
 v_cvt_pk_bf16_f32 v71, v78, v79
M v[112:115], a[64:67], a[128:131], v[32:35]
 ds_read_b128 a[96:99], v7 offset:24576
M v[112:115], a[68:71], a[132:135], v[112:115]
 ds_read_b128 a[100:103], v7 offset:25600
M v[112:115], a[72:75], a[136:139], v[112:115]
 buffer_store_dwordx4 v[68:71], v7, s[8:11], s30 offen offset:0 sc1
M v[112:115], a[76:79], a[140:143], v[112:115]
 ds_read_b128 a[104:107], v7 offset:26624
 v_fma_f32 v80, v80, v5, v28
M v[112:115], a[80:83], a[144:147], v[112:115]
 ds_read_b128 a[108:111], v7 offset:27648
 v_fma_f32 v81, v81, v5, v28
M v[112:115], a[84:87], a[148:151], v[112:115]
 v_fma_f32 v82, v82, v5, v28
 v_fma_f32 v83, v83, v5, v28
M v[112:115], a[88:91], a[152:155], v[112:115]
 ds_read_b128 a[112:115], v7 offset:28672
 v_fma_f32 v88, v88, v5, v28
M v[112:115], a[92:95], a[156:159], v[112:115]
 ds_read_b128 a[116:119], v7 offset:29696
 v_fma_f32 v89, v89, v5, v28
M v[116:119], a[92:95], a[188:191], v[36:39]
 v_fma_f32 v90, v90, v5, v28
 v_fma_f32 v91, v91, v5, v28
M v[116:119], a[88:91], a[184:187], v[116:119]
 ds_read_b128 a[120:123], v7 offset:30720
 v_cvt_pk_bf16_f32 v80, v80, v81
M v[116:119], a[84:87], a[180:183], v[116:119]
 ds_read_b128 a[124:127], v7 offset:31744
 v_cvt_pk_bf16_f32 v81, v82, v83
M v[116:119], a[80:83], a[176:179], v[116:119]
 v_cvt_pk_bf16_f32 v82, v88, v89
 v_cvt_pk_bf16_f32 v83, v90, v91
M v[116:119], a[76:79], a[172:175], v[116:119]
 buffer_store_dwordx4 v[80:83], v7, s[8:11], s29 offen offset:1024 sc1
M v[116:119], a[72:75], a[168:171], v[116:119]
 v_fma_f32 v84, v84, v6, v29
 v_fma_f32 v85, v85, v6, v29
M v[116:119], a[68:71], a[164:167], v[116:119]
 s_waitcnt vmcnt(28) lgkmcnt(0)
 v_fma_f32 v86, v86, v6, v29
M v[116:119], a[64:67], a[160:163], v[116:119]
 s_barrier
M v[120:123], a[96:99], a[128:131], v[32:35]
 ds_read_b128 a[64:67], v43 offset:0
 v_fma_f32 v87, v87, v6, v29
M v[120:123], a[100:103], a[132:135], v[120:123]
 ds_read_b128 a[68:71], v43 offset:1024
 v_fma_f32 v92, v92, v6, v29
M v[120:123], a[104:107], a[136:139], v[120:123]
 v_fma_f32 v93, v93, v6, v29
 v_fma_f32 v94, v94, v6, v29
M v[120:123], a[108:111], a[140:143], v[120:123]
 ds_read_b128 a[72:75], v43 offset:2048
 v_fma_f32 v95, v95, v6, v29
M v[120:123], a[112:115], a[144:147], v[120:123]
 ds_read_b128 a[76:79], v43 offset:3072
 v_cvt_pk_bf16_f32 v84, v84, v85
M v[120:123], a[116:119], a[148:151], v[120:123]
 v_cvt_pk_bf16_f32 v85, v86, v87
M v[120:123], a[120:123], a[152:155], v[120:123]
 ds_read_b128 a[80:83], v43 offset:4096
 v_cvt_pk_bf16_f32 v86, v92, v93
M v[120:123], a[124:127], a[156:159], v[120:123]
 ds_read_b128 a[84:87], v43 offset:5120
 v_cvt_pk_bf16_f32 v87, v94, v95
M v[124:127], a[124:127], a[188:191], v[36:39]
 buffer_store_dwordx4 v[84:87], v7, s[8:11], s30 offen offset:1024 sc1
M v[124:127], a[120:123], a[184:187], v[124:127]
 ds_read_b128 a[88:91], v43 offset:6144
M v[124:127], a[116:119], a[180:183], v[124:127]
 ds_read_b128 a[92:95], v43 offset:7168
M v[124:127], a[112:115], a[176:179], v[124:127]
M v[124:127], a[108:111], a[172:175], v[124:127]
M v[124:127], a[104:107], a[168:171], v[124:127]
M v[124:127], a[100:103], a[164:167], v[124:127]
 s_waitcnt lgkmcnt(0)
M v[124:127], a[96:99], a[160:163], v[124:127]
M v[64:67], a[64:67], a[128:131], v[32:35]
 ds_read_b128 a[96:99], v43 offset:8192
M v[64:67], a[68:71], a[132:135], v[64:67]
 ds_read_b128 a[100:103], v43 offset:9216
M v[64:67], a[72:75], a[136:139], v[64:67]
 s_waitcnt vmcnt(11)
 v_cmp_gt_u32 vcc, 1, v24
M v[64:67], a[76:79], a[140:143], v[64:67]
 s_mov_b32 s65, 104890368
 ds_read_b128 a[104:107], v43 offset:10240
 s_add_u32 s29, s33, 6144
M v[64:67], a[80:83], a[144:147], v[64:67]
 s_cbranch_vccnz L_fhs0
L_fhr0:
 ds_read_b128 a[108:111], v43 offset:11264
 s_add_u32 s30, s33, 20480
M v[64:67], a[84:87], a[148:151], v[64:67]
 buffer_load_dword v25, v14, s[8:11], s65 offen sc1
M v[64:67], a[88:91], a[152:155], v[64:67]
 ds_read_b128 a[112:115], v43 offset:12288
 v_fma_f32 v96, v96, v5, v28
M v[64:67], a[92:95], a[156:159], v[64:67]
 ds_read_b128 a[116:119], v43 offset:13312
 v_fma_f32 v97, v97, v5, v28
M v[68:71], a[92:95], a[188:191], v[36:39]
 v_fma_f32 v98, v98, v5, v28
 v_fma_f32 v99, v99, v5, v28
M v[68:71], a[88:91], a[184:187], v[68:71]
 ds_read_b128 a[120:123], v43 offset:14336
 v_fma_f32 v104, v104, v5, v28
M v[68:71], a[84:87], a[180:183], v[68:71]
 ds_read_b128 a[124:127], v43 offset:15360
 v_fma_f32 v105, v105, v5, v28
M v[68:71], a[80:83], a[176:179], v[68:71]
 v_fma_f32 v106, v106, v5, v28
 v_fma_f32 v107, v107, v5, v28
M v[68:71], a[76:79], a[172:175], v[68:71]
 v_cvt_pk_bf16_f32 v96, v96, v97
M v[68:71], a[72:75], a[168:171], v[68:71]
 v_cvt_pk_bf16_f32 v97, v98, v99
M v[68:71], a[68:71], a[164:167], v[68:71]
 v_cvt_pk_bf16_f32 v98, v104, v105
M v[68:71], a[64:67], a[160:163], v[68:71]
 s_waitcnt lgkmcnt(0)
 v_cvt_pk_bf16_f32 v99, v106, v107
M v[72:75], a[96:99], a[128:131], v[32:35]
 ds_read_b128 a[64:67], v43 offset:16384
M v[72:75], a[100:103], a[132:135], v[72:75]
 ds_read_b128 a[68:71], v43 offset:17408
M v[72:75], a[104:107], a[136:139], v[72:75]
 buffer_store_dwordx4 v[96:99], v7, s[8:11], s29 offen offset:0 sc1
M v[72:75], a[108:111], a[140:143], v[72:75]
 ds_read_b128 a[72:75], v43 offset:18432
 v_fma_f32 v100, v100, v6, v29
M v[72:75], a[112:115], a[144:147], v[72:75]
 ds_read_b128 a[76:79], v43 offset:19456
 v_fma_f32 v101, v101, v6, v29
M v[72:75], a[116:119], a[148:151], v[72:75]
 v_fma_f32 v102, v102, v6, v29
 v_fma_f32 v103, v103, v6, v29
M v[72:75], a[120:123], a[152:155], v[72:75]
 ds_read_b128 a[80:83], v43 offset:20480
 v_fma_f32 v108, v108, v6, v29
M v[72:75], a[124:127], a[156:159], v[72:75]
 ds_read_b128 a[84:87], v43 offset:21504
 v_fma_f32 v109, v109, v6, v29
M v[76:79], a[124:127], a[188:191], v[36:39]
 v_fma_f32 v110, v110, v6, v29
 v_fma_f32 v111, v111, v6, v29
M v[76:79], a[120:123], a[184:187], v[76:79]
 ds_read_b128 a[88:91], v43 offset:22528
 v_cvt_pk_bf16_f32 v100, v100, v101
M v[76:79], a[116:119], a[180:183], v[76:79]
 ds_read_b128 a[92:95], v43 offset:23552
 v_cvt_pk_bf16_f32 v101, v102, v103
M v[76:79], a[112:115], a[176:179], v[76:79]
 v_cvt_pk_bf16_f32 v102, v108, v109
M v[76:79], a[108:111], a[172:175], v[76:79]
 v_cvt_pk_bf16_f32 v103, v110, v111
M v[76:79], a[104:107], a[168:171], v[76:79]
 buffer_store_dwordx4 v[100:103], v7, s[8:11], s30 offen offset:0 sc1
M v[76:79], a[100:103], a[164:167], v[76:79]
M v[76:79], a[96:99], a[160:163], v[76:79]
 s_waitcnt lgkmcnt(0)
 v_fma_f32 v112, v112, v5, v28
M v[80:83], a[64:67], a[128:131], v[32:35]
 ds_read_b128 a[96:99], v43 offset:24576
 v_fma_f32 v113, v113, v5, v28
M v[80:83], a[68:71], a[132:135], v[80:83]
 ds_read_b128 a[100:103], v43 offset:25600
 v_fma_f32 v114, v114, v5, v28
M v[80:83], a[72:75], a[136:139], v[80:83]
 v_fma_f32 v115, v115, v5, v28
M v[80:83], a[76:79], a[140:143], v[80:83]
 ds_read_b128 a[104:107], v43 offset:26624
 v_fma_f32 v120, v120, v5, v28
M v[80:83], a[80:83], a[144:147], v[80:83]
 ds_read_b128 a[108:111], v43 offset:27648
 v_fma_f32 v121, v121, v5, v28
M v[80:83], a[84:87], a[148:151], v[80:83]
 v_fma_f32 v122, v122, v5, v28
M v[80:83], a[88:91], a[152:155], v[80:83]
 ds_read_b128 a[112:115], v43 offset:28672
 v_fma_f32 v123, v123, v5, v28
M v[80:83], a[92:95], a[156:159], v[80:83]
 ds_read_b128 a[116:119], v43 offset:29696
 v_cvt_pk_bf16_f32 v112, v112, v113
M v[84:87], a[92:95], a[188:191], v[36:39]
 v_cvt_pk_bf16_f32 v113, v114, v115
 v_cvt_pk_bf16_f32 v114, v120, v121
M v[84:87], a[88:91], a[184:187], v[84:87]
 ds_read_b128 a[120:123], v43 offset:30720
 v_cvt_pk_bf16_f32 v115, v122, v123
M v[84:87], a[84:87], a[180:183], v[84:87]
 ds_read_b128 a[124:127], v43 offset:31744
M v[84:87], a[80:83], a[176:179], v[84:87]
 buffer_store_dwordx4 v[112:115], v7, s[8:11], s29 offen offset:1024 sc1
M v[84:87], a[76:79], a[172:175], v[84:87]
 v_fma_f32 v116, v116, v6, v29
M v[84:87], a[72:75], a[168:171], v[84:87]
 v_fma_f32 v117, v117, v6, v29
M v[84:87], a[68:71], a[164:167], v[84:87]
 s_waitcnt lgkmcnt(0)
 v_fma_f32 v118, v118, v6, v29
M v[84:87], a[64:67], a[160:163], v[84:87]
 s_barrier
M v[88:91], a[96:99], a[128:131], v[32:35]
 ds_read_b128 a[64:67], v2 offset:32768
 v_fma_f32 v119, v119, v6, v29
M v[88:91], a[100:103], a[132:135], v[88:91]
 ds_read_b128 a[68:71], v2 offset:33792
 v_fma_f32 v124, v124, v6, v29
M v[88:91], a[104:107], a[136:139], v[88:91]
 v_fma_f32 v125, v125, v6, v29
 v_fma_f32 v126, v126, v6, v29
M v[88:91], a[108:111], a[140:143], v[88:91]
 ds_read_b128 a[72:75], v2 offset:34816
 v_fma_f32 v127, v127, v6, v29
M v[88:91], a[112:115], a[144:147], v[88:91]
 ds_read_b128 a[76:79], v2 offset:35840
 v_cvt_pk_bf16_f32 v116, v116, v117
M v[88:91], a[116:119], a[148:151], v[88:91]
 v_cvt_pk_bf16_f32 v117, v118, v119
M v[88:91], a[120:123], a[152:155], v[88:91]
 ds_read_b128 a[80:83], v2 offset:36864
 v_cvt_pk_bf16_f32 v118, v124, v125
M v[88:91], a[124:127], a[156:159], v[88:91]
 ds_read_b128 a[84:87], v2 offset:37888
 v_cvt_pk_bf16_f32 v119, v126, v127
M v[92:95], a[124:127], a[188:191], v[36:39]
 buffer_store_dwordx4 v[116:119], v7, s[8:11], s30 offen offset:1024 sc1
M v[92:95], a[120:123], a[184:187], v[92:95]
 ds_read_b128 a[88:91], v2 offset:38912
M v[92:95], a[116:119], a[180:183], v[92:95]
 ds_read_b128 a[92:95], v2 offset:39936
M v[92:95], a[112:115], a[176:179], v[92:95]
M v[92:95], a[108:111], a[172:175], v[92:95]
M v[92:95], a[104:107], a[168:171], v[92:95]
M v[92:95], a[100:103], a[164:167], v[92:95]
 s_waitcnt lgkmcnt(0)
M v[92:95], a[96:99], a[160:163], v[92:95]
M v[96:99], a[64:67], a[128:131], v[32:35]
 ds_read_b128 a[96:99], v2 offset:40960
M v[96:99], a[68:71], a[132:135], v[96:99]
 ds_read_b128 a[100:103], v2 offset:41984
M v[96:99], a[72:75], a[136:139], v[96:99]
M v[96:99], a[76:79], a[140:143], v[96:99]
 ds_read_b128 a[104:107], v2 offset:43008
 s_add_u32 s29, s33, 8192
M v[96:99], a[80:83], a[144:147], v[96:99]
 ds_read_b128 a[108:111], v2 offset:44032
 s_add_u32 s30, s33, 22528
M v[96:99], a[84:87], a[148:151], v[96:99]
 v_fma_f32 v64, v64, v5, v28
 v_fma_f32 v65, v65, v5, v28
M v[96:99], a[88:91], a[152:155], v[96:99]
 ds_read_b128 a[112:115], v2 offset:45056
 v_fma_f32 v66, v66, v5, v28
M v[96:99], a[92:95], a[156:159], v[96:99]
 ds_read_b128 a[116:119], v2 offset:46080
 v_fma_f32 v67, v67, v5, v28
M v[100:103], a[92:95], a[188:191], v[36:39]
 v_fma_f32 v72, v72, v5, v28
M v[100:103], a[88:91], a[184:187], v[100:103]
 ds_read_b128 a[120:123], v2 offset:47104
 v_fma_f32 v73, v73, v5, v28
M v[100:103], a[84:87], a[180:183], v[100:103]
 ds_read_b128 a[124:127], v2 offset:48128
 v_fma_f32 v74, v74, v5, v28
M v[100:103], a[80:83], a[176:179], v[100:103]
 v_fma_f32 v75, v75, v5, v28
M v[100:103], a[76:79], a[172:175], v[100:103]
 v_cvt_pk_bf16_f32 v64, v64, v65
M v[100:103], a[72:75], a[168:171], v[100:103]
 v_cvt_pk_bf16_f32 v65, v66, v67
M v[100:103], a[68:71], a[164:167], v[100:103]
 v_cvt_pk_bf16_f32 v66, v72, v73
M v[100:103], a[64:67], a[160:163], v[100:103]
 s_waitcnt lgkmcnt(0)
 v_cvt_pk_bf16_f32 v67, v74, v75
M v[104:107], a[96:99], a[128:131], v[32:35]
 ds_read_b128 a[64:67], v2 offset:49152
M v[104:107], a[100:103], a[132:135], v[104:107]
 ds_read_b128 a[68:71], v2 offset:50176
M v[104:107], a[104:107], a[136:139], v[104:107]
 buffer_store_dwordx4 v[64:67], v7, s[8:11], s29 offen offset:0 sc1
M v[104:107], a[108:111], a[140:143], v[104:107]
 ds_read_b128 a[72:75], v2 offset:51200
 v_fma_f32 v68, v68, v6, v29
M v[104:107], a[112:115], a[144:147], v[104:107]
 ds_read_b128 a[76:79], v2 offset:52224
 v_fma_f32 v69, v69, v6, v29
M v[104:107], a[116:119], a[148:151], v[104:107]
 v_fma_f32 v70, v70, v6, v29
 v_fma_f32 v71, v71, v6, v29
M v[104:107], a[120:123], a[152:155], v[104:107]
 ds_read_b128 a[80:83], v2 offset:53248
 v_fma_f32 v76, v76, v6, v29
M v[104:107], a[124:127], a[156:159], v[104:107]
 ds_read_b128 a[84:87], v2 offset:54272
 v_fma_f32 v77, v77, v6, v29
M v[108:111], a[124:127], a[188:191], v[36:39]
 v_fma_f32 v78, v78, v6, v29
 v_fma_f32 v79, v79, v6, v29
M v[108:111], a[120:123], a[184:187], v[108:111]
 ds_read_b128 a[88:91], v2 offset:55296
 v_cvt_pk_bf16_f32 v68, v68, v69
M v[108:111], a[116:119], a[180:183], v[108:111]
 ds_read_b128 a[92:95], v2 offset:56320
 v_cvt_pk_bf16_f32 v69, v70, v71
M v[108:111], a[112:115], a[176:179], v[108:111]
 v_cvt_pk_bf16_f32 v70, v76, v77
M v[108:111], a[108:111], a[172:175], v[108:111]
 v_cvt_pk_bf16_f32 v71, v78, v79
M v[108:111], a[104:107], a[168:171], v[108:111]
 buffer_store_dwordx4 v[68:71], v7, s[8:11], s30 offen offset:0 sc1
M v[108:111], a[100:103], a[164:167], v[108:111]
M v[108:111], a[96:99], a[160:163], v[108:111]
 s_waitcnt lgkmcnt(0)
 v_fma_f32 v80, v80, v5, v28
M v[112:115], a[64:67], a[128:131], v[32:35]
 ds_read_b128 a[96:99], v2 offset:57344
 v_fma_f32 v81, v81, v5, v28
M v[112:115], a[68:71], a[132:135], v[112:115]
 ds_read_b128 a[100:103], v2 offset:58368
 v_fma_f32 v82, v82, v5, v28
M v[112:115], a[72:75], a[136:139], v[112:115]
 v_fma_f32 v83, v83, v5, v28
M v[112:115], a[76:79], a[140:143], v[112:115]
 ds_read_b128 a[104:107], v2 offset:59392
 v_fma_f32 v88, v88, v5, v28
M v[112:115], a[80:83], a[144:147], v[112:115]
 ds_read_b128 a[108:111], v2 offset:60416
 v_fma_f32 v89, v89, v5, v28
M v[112:115], a[84:87], a[148:151], v[112:115]
 v_fma_f32 v90, v90, v5, v28
M v[112:115], a[88:91], a[152:155], v[112:115]
 ds_read_b128 a[112:115], v2 offset:61440
 v_fma_f32 v91, v91, v5, v28
M v[112:115], a[92:95], a[156:159], v[112:115]
 ds_read_b128 a[116:119], v2 offset:62464
 v_cvt_pk_bf16_f32 v80, v80, v81
M v[116:119], a[92:95], a[188:191], v[36:39]
 s_waitcnt vmcnt(6)
 v_readlane_b32 s84, v25, 0
 v_readlane_b32 s85, v25, 1
M v[116:119], a[88:91], a[184:187], v[116:119]
 ds_read_b128 a[120:123], v2 offset:63488
 v_mov_b32 v24, 0x3f80
M v[116:119], a[84:87], a[180:183], v[116:119]
 ds_read_b128 a[124:127], v2 offset:64512
 v_mov_b32 v25, 0x3f800000
M v[116:119], a[80:83], a[176:179], v[116:119]
 v_cvt_pk_bf16_f32 v81, v82, v83
 v_cvt_pk_bf16_f32 v82, v88, v89
M v[116:119], a[76:79], a[172:175], v[116:119]
 v_cvt_pk_bf16_f32 v83, v90, v91
M v[116:119], a[72:75], a[168:171], v[116:119]
 buffer_store_dwordx4 v[80:83], v7, s[8:11], s29 offen offset:1024 sc1
M v[116:119], a[68:71], a[164:167], v[116:119]
 s_waitcnt lgkmcnt(0)
 v_fma_f32 v84, v84, v6, v29
 v_fma_f32 v85, v85, v6, v29
M v[116:119], a[64:67], a[160:163], v[116:119]
 s_barrier
M v[120:123], a[96:99], a[128:131], v[32:35]
 ds_read_b128 a[64:67], v7 offset:32768
 v_fma_f32 v86, v86, v6, v29
M v[120:123], a[100:103], a[132:135], v[120:123]
 ds_read_b128 a[68:71], v7 offset:33792
 v_fma_f32 v87, v87, v6, v29
M v[120:123], a[104:107], a[136:139], v[120:123]
 v_fma_f32 v92, v92, v6, v29
 v_fma_f32 v93, v93, v6, v29
M v[120:123], a[108:111], a[140:143], v[120:123]
 ds_read_b128 a[72:75], v7 offset:34816
 v_fma_f32 v94, v94, v6, v29
M v[120:123], a[112:115], a[144:147], v[120:123]
 ds_read_b128 a[76:79], v7 offset:35840
 v_fma_f32 v95, v95, v6, v29
M v[120:123], a[116:119], a[148:151], v[120:123]
 s_waitcnt vmcnt(3)
 v_cvt_pk_bf16_f32 v84, v84, v85
 v_cvt_pk_bf16_f32 v85, v86, v87
M v[120:123], a[120:123], a[152:155], v[120:123]
 ds_read_b128 a[80:83], v7 offset:36864
 v_cvt_pk_bf16_f32 v86, v92, v93
M v[120:123], a[124:127], a[156:159], v[120:123]
 ds_read_b128 a[84:87], v7 offset:37888
 v_cvt_pk_bf16_f32 v87, v94, v95
M v[124:127], a[124:127], a[188:191], v[36:39]
 buffer_store_dword v40, v41, s[8:11], s45 offen sc1
M v[124:127], a[120:123], a[184:187], v[124:127]
 ds_read_b128 a[88:91], v7 offset:38912
M v[124:127], a[116:119], a[180:183], v[124:127]
 ds_read_b128 a[92:95], v7 offset:39936
M v[124:127], a[112:115], a[176:179], v[124:127]
 buffer_store_dwordx4 v[84:87], v7, s[8:11], s30 offen offset:1024 sc1
M v[124:127], a[108:111], a[172:175], v[124:127]
M v[124:127], a[104:107], a[168:171], v[124:127]
M v[124:127], a[100:103], a[164:167], v[124:127]
 s_waitcnt lgkmcnt(0)
M v[124:127], a[96:99], a[160:163], v[124:127]
M v[64:67], a[64:67], a[128:131], v[32:35]
 ds_read_b128 a[96:99], v7 offset:40960
M v[64:67], a[68:71], a[132:135], v[64:67]
 ds_read_b128 a[100:103], v7 offset:41984
M v[64:67], a[72:75], a[136:139], v[64:67]
M v[64:67], a[76:79], a[140:143], v[64:67]
 ds_read_b128 a[104:107], v7 offset:43008
 s_add_u32 s29, s33, 10240
M v[64:67], a[80:83], a[144:147], v[64:67]
 ds_read_b128 a[108:111], v7 offset:44032
 s_add_u32 s30, s33, 24576
M v[64:67], a[84:87], a[148:151], v[64:67]
 v_fma_f32 v96, v96, v5, v28
 v_fma_f32 v97, v97, v5, v28
M v[64:67], a[88:91], a[152:155], v[64:67]
 ds_read_b128 a[112:115], v7 offset:45056
 v_fma_f32 v98, v98, v5, v28
M v[64:67], a[92:95], a[156:159], v[64:67]
 ds_read_b128 a[116:119], v7 offset:46080
 v_fma_f32 v99, v99, v5, v28
M v[68:71], a[92:95], a[188:191], v[36:39]
 v_fma_f32 v104, v104, v5, v28
 v_fma_f32 v105, v105, v5, v28
M v[68:71], a[88:91], a[184:187], v[68:71]
 ds_read_b128 a[120:123], v7 offset:47104
 v_fma_f32 v106, v106, v5, v28
M v[68:71], a[84:87], a[180:183], v[68:71]
 ds_read_b128 a[124:127], v7 offset:48128
 v_fma_f32 v107, v107, v5, v28
M v[68:71], a[80:83], a[176:179], v[68:71]
 v_cvt_pk_bf16_f32 v96, v96, v97
 v_cvt_pk_bf16_f32 v97, v98, v99
M v[68:71], a[76:79], a[172:175], v[68:71]
 v_cvt_pk_bf16_f32 v98, v104, v105
 v_cvt_pk_bf16_f32 v99, v106, v107
M v[68:71], a[72:75], a[168:171], v[68:71]
 buffer_store_dwordx4 v[96:99], v7, s[8:11], s29 offen offset:0 sc1
M v[68:71], a[68:71], a[164:167], v[68:71]
 v_fma_f32 v100, v100, v6, v29
 v_fma_f32 v101, v101, v6, v29
M v[68:71], a[64:67], a[160:163], v[68:71]
 s_waitcnt lgkmcnt(0)
 v_fma_f32 v102, v102, v6, v29
 v_fma_f32 v103, v103, v6, v29
M v[72:75], a[96:99], a[128:131], v[32:35]
 ds_read_b128 a[64:67], v7 offset:49152
 v_fma_f32 v108, v108, v6, v29
M v[72:75], a[100:103], a[132:135], v[72:75]
 ds_read_b128 a[68:71], v7 offset:50176
 v_fma_f32 v109, v109, v6, v29
M v[72:75], a[104:107], a[136:139], v[72:75]
 v_fma_f32 v110, v110, v6, v29
 v_fma_f32 v111, v111, v6, v29
M v[72:75], a[108:111], a[140:143], v[72:75]
 ds_read_b128 a[72:75], v7 offset:51200
 v_cvt_pk_bf16_f32 v100, v100, v101
M v[72:75], a[112:115], a[144:147], v[72:75]
 ds_read_b128 a[76:79], v7 offset:52224
 v_cvt_pk_bf16_f32 v101, v102, v103
M v[72:75], a[116:119], a[148:151], v[72:75]
 v_cvt_pk_bf16_f32 v102, v108, v109
 v_cvt_pk_bf16_f32 v103, v110, v111
M v[72:75], a[120:123], a[152:155], v[72:75]
 ds_read_b128 a[80:83], v7 offset:53248
M v[72:75], a[124:127], a[156:159], v[72:75]
 ds_read_b128 a[84:87], v7 offset:54272
M v[76:79], a[124:127], a[188:191], v[36:39]
 buffer_store_dwordx4 v[100:103], v7, s[8:11], s30 offen offset:0 sc1
M v[76:79], a[120:123], a[184:187], v[76:79]
 ds_read_b128 a[88:91], v7 offset:55296
 v_fma_f32 v112, v112, v5, v28
M v[76:79], a[116:119], a[180:183], v[76:79]
 ds_read_b128 a[92:95], v7 offset:56320
 v_fma_f32 v113, v113, v5, v28
M v[76:79], a[112:115], a[176:179], v[76:79]
 v_fma_f32 v114, v114, v5, v28
 v_fma_f32 v115, v115, v5, v28
M v[76:79], a[108:111], a[172:175], v[76:79]
 v_fma_f32 v120, v120, v5, v28
 v_fma_f32 v121, v121, v5, v28
M v[76:79], a[104:107], a[168:171], v[76:79]
 v_fma_f32 v122, v122, v5, v28
 v_fma_f32 v123, v123, v5, v28
M v[76:79], a[100:103], a[164:167], v[76:79]
 v_cvt_pk_bf16_f32 v112, v112, v113
 v_cvt_pk_bf16_f32 v113, v114, v115
M v[76:79], a[96:99], a[160:163], v[76:79]
 s_waitcnt lgkmcnt(0)
 v_cvt_pk_bf16_f32 v114, v120, v121
 v_cvt_pk_bf16_f32 v115, v122, v123
M v[80:83], a[64:67], a[128:131], v[32:35]
 ds_read_b128 a[96:99], v7 offset:57344
M v[80:83], a[68:71], a[132:135], v[80:83]
 ds_read_b128 a[100:103], v7 offset:58368
M v[80:83], a[72:75], a[136:139], v[80:83]
 buffer_store_dwordx4 v[112:115], v7, s[8:11], s29 offen offset:1024 sc1
M v[80:83], a[76:79], a[140:143], v[80:83]
 ds_read_b128 a[104:107], v7 offset:59392
 v_fma_f32 v116, v116, v6, v29
M v[80:83], a[80:83], a[144:147], v[80:83]
 ds_read_b128 a[108:111], v7 offset:60416
 v_fma_f32 v117, v117, v6, v29
M v[80:83], a[84:87], a[148:151], v[80:83]
 v_fma_f32 v118, v118, v6, v29
 v_fma_f32 v119, v119, v6, v29
M v[80:83], a[88:91], a[152:155], v[80:83]
 ds_read_b128 a[112:115], v7 offset:61440
 v_fma_f32 v124, v124, v6, v29
M v[80:83], a[92:95], a[156:159], v[80:83]
 ds_read_b128 a[116:119], v7 offset:62464
 v_fma_f32 v125, v125, v6, v29
M v[84:87], a[92:95], a[188:191], v[36:39]
 v_fma_f32 v126, v126, v6, v29
 v_fma_f32 v127, v127, v6, v29
M v[84:87], a[88:91], a[184:187], v[84:87]
 ds_read_b128 a[120:123], v7 offset:63488
 v_cvt_pk_bf16_f32 v116, v116, v117
M v[84:87], a[84:87], a[180:183], v[84:87]
 ds_read_b128 a[124:127], v7 offset:64512
 v_cvt_pk_bf16_f32 v117, v118, v119
M v[84:87], a[80:83], a[176:179], v[84:87]
 v_cvt_pk_bf16_f32 v118, v124, v125
 v_cvt_pk_bf16_f32 v119, v126, v127
M v[84:87], a[76:79], a[172:175], v[84:87]
 buffer_store_dwordx4 v[116:119], v7, s[8:11], s30 offen offset:1024 sc1
M v[84:87], a[72:75], a[168:171], v[84:87]
 s_add_u32 s29, s33, 12288
M v[84:87], a[68:71], a[164:167], v[84:87]
 s_add_u32 s30, s33, 26624
 v_fma_f32 v64, v64, v5, v28
 v_fma_f32 v65, v65, v5, v28
M v[84:87], a[64:67], a[160:163], v[84:87]
 s_waitcnt lgkmcnt(0)
 v_fma_f32 v66, v66, v5, v28
 v_fma_f32 v67, v67, v5, v28
M v[88:91], a[96:99], a[128:131], v[32:35]
 v_fma_f32 v72, v72, v5, v28
 v_fma_f32 v73, v73, v5, v28
M v[88:91], a[100:103], a[132:135], v[88:91]
 v_fma_f32 v74, v74, v5, v28
 v_fma_f32 v75, v75, v5, v28
M v[88:91], a[104:107], a[136:139], v[88:91]
 v_cvt_pk_bf16_f32 v64, v64, v65
 v_cvt_pk_bf16_f32 v65, v66, v67
M v[88:91], a[108:111], a[140:143], v[88:91]
 v_cvt_pk_bf16_f32 v66, v72, v73
 v_cvt_pk_bf16_f32 v67, v74, v75
M v[88:91], a[112:115], a[144:147], v[88:91]
 buffer_store_dwordx4 v[64:67], v7, s[8:11], s29 offen offset:0 sc1
M v[88:91], a[116:119], a[148:151], v[88:91]
 v_fma_f32 v68, v68, v6, v29
 v_fma_f32 v69, v69, v6, v29
M v[88:91], a[120:123], a[152:155], v[88:91]
 v_fma_f32 v70, v70, v6, v29
 v_fma_f32 v71, v71, v6, v29
M v[88:91], a[124:127], a[156:159], v[88:91]
 v_fma_f32 v76, v76, v6, v29
 v_fma_f32 v77, v77, v6, v29
M v[92:95], a[124:127], a[188:191], v[36:39]
 v_fma_f32 v78, v78, v6, v29
 v_fma_f32 v79, v79, v6, v29
M v[92:95], a[120:123], a[184:187], v[92:95]
 v_cvt_pk_bf16_f32 v68, v68, v69
 v_cvt_pk_bf16_f32 v69, v70, v71
M v[92:95], a[116:119], a[180:183], v[92:95]
 v_cvt_pk_bf16_f32 v70, v76, v77
 v_cvt_pk_bf16_f32 v71, v78, v79
M v[92:95], a[112:115], a[176:179], v[92:95]
 buffer_store_dwordx4 v[68:71], v7, s[8:11], s30 offen offset:0 sc1
M v[92:95], a[108:111], a[172:175], v[92:95]
M v[92:95], a[104:107], a[168:171], v[92:95]
M v[92:95], a[100:103], a[164:167], v[92:95]
M v[92:95], a[96:99], a[160:163], v[92:95]
 v_fma_f32 v80, v80, v5, v28
 v_fma_f32 v81, v81, v5, v28
 v_fma_f32 v82, v82, v5, v28
 v_fma_f32 v83, v83, v5, v28
 v_fma_f32 v88, v88, v5, v28
 v_fma_f32 v89, v89, v5, v28
 v_fma_f32 v90, v90, v5, v28
 v_fma_f32 v91, v91, v5, v28
 v_cvt_pk_bf16_f32 v80, v80, v81
 v_cvt_pk_bf16_f32 v81, v82, v83
 v_cvt_pk_bf16_f32 v82, v88, v89
 v_cvt_pk_bf16_f32 v83, v90, v91
 buffer_store_dwordx4 v[80:83], v7, s[8:11], s29 offen offset:1024 sc1
 v_fma_f32 v84, v84, v6, v29
 v_fma_f32 v85, v85, v6, v29
 v_fma_f32 v86, v86, v6, v29
 v_fma_f32 v87, v87, v6, v29
 v_fma_f32 v92, v92, v6, v29
 v_fma_f32 v93, v93, v6, v29
 v_fma_f32 v94, v94, v6, v29
 v_fma_f32 v95, v95, v6, v29
 v_cvt_pk_bf16_f32 v84, v84, v85
 v_cvt_pk_bf16_f32 v85, v86, v87
 v_cvt_pk_bf16_f32 v86, v92, v93
 v_cvt_pk_bf16_f32 v87, v94, v95
 buffer_store_dwordx4 v[84:87], v7, s[8:11], s30 offen offset:1024 sc1
L_red:
 s_lshl_b32 s64, s42, 1
 s_lshr_b32 s65, s41, 3
 s_add_u32 s46, s64, s65
 s_mul_i32 s46, s46, 4352
 s_and_b32 s72, s41, 7
 s_lshl_b32 s66, s72, 7
 s_add_u32 s46, s46, s66
 s_add_u32 s46, s46, 104992768
 v_and_b32 v14, 31, v0
 v_lshlrev_b32 v14, 2, v14
 buffer_load_dword v9, v14, s[8:11], s46 offen sc1
 s_mul_i32 s86, s65, 4
 s_add_u32 s86, s86, s20
 s_mul_i32 s77, s42, 1835008
 s_mul_i32 s78, s72, 14336
 s_add_u32 s77, s77, s78
 s_add_u32 s77, s77, 67108864
 s_sub_u32 s64, 15, s64
 s_sub_u32 s78, s64, 1
 s_mul_i32 s78, s78, 1835008
 s_add_u32 s78, s78, s77
 s_lshl_b32 s66, s86, 10
 s_add_u32 s78, s78, s66
 s_lshl_b32 s66, s74, 10
 s_add_u32 s77, s77, s66
 s_lshl_b32 s66, s64, 7
 s_lshl_b32 s86, s86, 6
 s_lshr_b32 s73, s72, 1
 s_sub_u32 s65, 7, s73
 s_bitcmp1_b32 s72, 0
 s_cselect_b32 s73, s65, s73
 s_lshl_b32 s73, s73, 4
 s_lshl_b32 s65, s42, 7
 s_add_u32 s73, s73, s65
 v_and_b32 v10, 15, v0
 v_add_u32 v10, s73, v10
 v_add_u32 v29, s66, v10
 s_mov_b32 s64, 104857664
 v_mul_u32_u24 v12, 896, v10
 v_lshl_add_u32 v12, v11, 4, v12
 v_lshrrev_b32 v13, 4, v10
 v_lshlrev_b32 v13, 5, v13
 v_and_b32 v104, 15, v10
 v_add_lshl_u32 v13, v13, v104, 2
 buffer_load_dword v15, v13, s[8:11], s64 offen sc1
 buffer_load_dwordx4 v[16:19], v12, s[56:59], s75 offen
 buffer_load_dwordx4 v[20:23], v12, s[56:59], s76 offen
 v_mov_b32 v48, 0
 v_mov_b32 v49, 0
 v_mov_b32 v50, 0
 v_mov_b32 v51, 0
 v_mov_b32 v52, 0
 v_mov_b32 v53, 0
 v_mov_b32 v54, 0
 v_mov_b32 v55, 0
 v_mov_b32 v56, 0
 v_mov_b32 v57, 0
 v_mov_b32 v58, 0
 v_mov_b32 v59, 0
 v_mov_b32 v60, 0
 v_mov_b32 v61, 0
 v_mov_b32 v62, 0
 v_mov_b32 v63, 0
 v_mul_u32_u24 v28, 896, v29
 v_lshl_add_u32 v28, v11, 4, v28
 v_lshrrev_b32 v13, 4, v29
 v_lshlrev_b32 v13, 5, v13
 v_and_b32 v104, 15, v29
 v_add_lshl_u32 v13, v13, v104, 2
 buffer_load_dword v26, v13, s[8:11], s64 offen sc1
 buffer_load_dwordx4 v[96:99], v28, s[56:59], s86 offen
 v_mov_b32 v64, 0
 v_mov_b32 v65, 0
 v_mov_b32 v66, 0
 v_mov_b32 v67, 0
 v_mov_b32 v68, 0
 v_mov_b32 v69, 0
 v_mov_b32 v70, 0
 v_mov_b32 v71, 0
 s_waitcnt vmcnt(6)
 buffer_store_dword v40, v41, s[8:11], s3 offen sc1
 s_waitcnt vmcnt(6)
 v_cmp_eq_u32 vcc, 1, v9
 s_mov_b32 s91, 65536
 s_mov_b32 s69, 0
 s_mov_b32 s70, vcc_lo
 s_mov_b32 s68, vcc_lo
 s_cmp_lg_u32 s70, 0
 s_cbranch_scc1 L_rk0
 s_call_b64 s[36:37], L_rpoll
L_rk0:
 s_ff1_i32_b32 s71, s70
 s_bitset0_b32 s70, s71
 s_cmp_ge_u32 s71, 16
 s_cselect_b32 s72, s78, s77
 s_cselect_b32 s73, 0x1, 0
 s_cselect_b32 s87, 536870912, 0
 s_mul_i32 s71, s71, 114688
 s_add_u32 s71, s71, s72
 buffer_load_dwordx4 v[128:131], v7, s[8:11], s71 offen sc1
 s_or_b32 s69, s69, s73
 s_or_b32 s71, s71, s87
 buffer_load_dwordx4 v[132:135], v27, s[8:11], s71 offen sc1
 s_cmp_lg_u32 s70, 0
 s_cbranch_scc1 L_rk1
 s_call_b64 s[36:37], L_rpoll
L_rk1:
 s_ff1_i32_b32 s71, s70
 s_bitset0_b32 s70, s71
 s_cmp_ge_u32 s71, 16
 s_cselect_b32 s72, s78, s77
 s_cselect_b32 s73, 0x2, 0
 s_cselect_b32 s87, 536870912, 0
 s_mul_i32 s71, s71, 114688
 s_add_u32 s71, s71, s72
 buffer_load_dwordx4 v[136:139], v7, s[8:11], s71 offen sc1
 s_or_b32 s69, s69, s73
 s_or_b32 s71, s71, s87
 buffer_load_dwordx4 v[140:143], v27, s[8:11], s71 offen sc1
 s_waitcnt vmcnt(8)
 v_lshlrev_b32 v32, 16, v16
 v_and_b32 v33, 0xffff0000, v16
 v_lshlrev_b32 v34, 16, v17
 v_and_b32 v35, 0xffff0000, v17
 v_lshlrev_b32 v36, 16, v18
 v_and_b32 v37, 0xffff0000, v18
 v_lshlrev_b32 v38, 16, v19
 v_and_b32 v39, 0xffff0000, v19
 s_waitcnt vmcnt(7)
 v_lshlrev_b32 v40, 16, v20
 v_and_b32 v41, 0xffff0000, v20
 v_lshlrev_b32 v42, 16, v21
 v_and_b32 v43, 0xffff0000, v21
 v_lshlrev_b32 v44, 16, v22
 v_and_b32 v45, 0xffff0000, v22
 v_lshlrev_b32 v46, 16, v23
 v_and_b32 v47, 0xffff0000, v23
 v_sub_f32 v13, 1.0, v15
 v_cmp_eq_u32 s[80:81], s84, v10
 v_cmp_eq_u32 s[82:83], s85, v10
 s_nop 0
 s_or_b64 vcc, s[80:81], s[82:83]
 s_cbranch_vccnz L_moe0
L_moe_ret0:
 v_mul_f32 v32, v13, v32
 v_mul_f32 v33, v13, v33
 v_mul_f32 v34, v13, v34
 v_mul_f32 v35, v13, v35
 v_mul_f32 v36, v13, v36
 v_mul_f32 v37, v13, v37
 v_mul_f32 v38, v13, v38
 v_mul_f32 v39, v13, v39
 v_mul_f32 v40, v13, v40
 v_mul_f32 v41, v13, v41
 v_mul_f32 v42, v13, v42
 v_mul_f32 v43, v13, v43
 v_mul_f32 v44, v13, v44
 v_mul_f32 v45, v13, v45
 v_mul_f32 v46, v13, v46
 v_mul_f32 v47, v13, v47
 s_cmp_lg_u32 s70, 0
 s_cbranch_scc1 L_rk2
 s_call_b64 s[36:37], L_rpoll
L_rk2:
 s_ff1_i32_b32 s71, s70
 s_bitset0_b32 s70, s71
 s_cmp_ge_u32 s71, 16
 s_cselect_b32 s72, s78, s77
 s_cselect_b32 s73, 0x4, 0
 s_cselect_b32 s87, 536870912, 0
 s_mul_i32 s71, s71, 114688
 s_add_u32 s71, s71, s72
 buffer_load_dwordx4 v[144:147], v7, s[8:11], s71 offen sc1
 s_or_b32 s69, s69, s73
 s_or_b32 s71, s71, s87
 buffer_load_dwordx4 v[148:151], v27, s[8:11], s71 offen sc1
 s_waitcnt vmcnt(7)
 v_lshlrev_b32 v80, 16, v96
 v_and_b32 v81, 0xffff0000, v96
 v_lshlrev_b32 v82, 16, v97
 v_and_b32 v83, 0xffff0000, v97
 v_lshlrev_b32 v84, 16, v98
 v_and_b32 v85, 0xffff0000, v98
 v_lshlrev_b32 v86, 16, v99
 v_and_b32 v87, 0xffff0000, v99
 v_sub_f32 v13, 1.0, v26
 v_cmp_eq_u32 s[80:81], s84, v29
 v_cmp_eq_u32 s[82:83], s85, v29
 s_nop 0
 s_or_b64 vcc, s[80:81], s[82:83]
 s_cbranch_vccnz L_moe1
L_moe_ret1:
 v_mul_f32 v80, v13, v80
 v_mul_f32 v81, v13, v81
 v_mul_f32 v82, v13, v82
 v_mul_f32 v83, v13, v83
 v_mul_f32 v84, v13, v84
 v_mul_f32 v85, v13, v85
 v_mul_f32 v86, v13, v86
 v_mul_f32 v87, v13, v87
 s_cmp_lg_u32 s70, 0
 s_cbranch_scc1 L_rk3
 s_call_b64 s[36:37], L_rpoll
L_rk3:
 s_ff1_i32_b32 s71, s70
 s_bitset0_b32 s70, s71
 s_cmp_ge_u32 s71, 16
 s_cselect_b32 s72, s78, s77
 s_cselect_b32 s73, 0x8, 0
 s_cselect_b32 s87, 536870912, 0
 s_mul_i32 s71, s71, 114688
 s_add_u32 s71, s71, s72
 buffer_load_dwordx4 v[152:155], v7, s[8:11], s71 offen sc1
 s_or_b32 s69, s69, s73
 s_or_b32 s71, s71, s87
 buffer_load_dwordx4 v[156:159], v27, s[8:11], s71 offen sc1
 s_cmp_lg_u32 s70, 0
 s_cbranch_scc1 L_rk4
 s_call_b64 s[36:37], L_rpoll
L_rk4:
 s_ff1_i32_b32 s71, s70
 s_bitset0_b32 s70, s71
 s_cmp_ge_u32 s71, 16
 s_cselect_b32 s72, s78, s77
 s_cselect_b32 s73, 0x10, 0
 s_cselect_b32 s87, 536870912, 0
 s_mul_i32 s71, s71, 114688
 s_add_u32 s71, s71, s72
 buffer_load_dwordx4 v[160:163], v7, s[8:11], s71 offen sc1
 s_or_b32 s69, s69, s73
 s_or_b32 s71, s71, s87
 buffer_load_dwordx4 v[164:167], v27, s[8:11], s71 offen sc1
 s_cmp_lg_u32 s70, 0
 s_cbranch_scc1 L_rk5
 s_call_b64 s[36:37], L_rpoll
L_rk5:
 s_ff1_i32_b32 s71, s70
 s_bitset0_b32 s70, s71
 s_cmp_ge_u32 s71, 16
 s_cselect_b32 s72, s78, s77
 s_cselect_b32 s73, 0x20, 0
 s_cselect_b32 s87, 536870912, 0
 s_mul_i32 s71, s71, 114688
 s_add_u32 s71, s71, s72
 buffer_load_dwordx4 v[168:171], v7, s[8:11], s71 offen sc1
 s_or_b32 s69, s69, s73
 s_or_b32 s71, s71, s87
 buffer_load_dwordx4 v[172:175], v27, s[8:11], s71 offen sc1
 s_cmp_lg_u32 s70, 0
 s_cbranch_scc1 L_rk6
 s_call_b64 s[36:37], L_rpoll
L_rk6:
 s_ff1_i32_b32 s71, s70
 s_bitset0_b32 s70, s71
 s_cmp_ge_u32 s71, 16
 s_cselect_b32 s72, s78, s77
 s_cselect_b32 s73, 0x40, 0
 s_cselect_b32 s87, 536870912, 0
 s_mul_i32 s71, s71, 114688
 s_add_u32 s71, s71, s72
 buffer_load_dwordx4 v[176:179], v7, s[8:11], s71 offen sc1
 s_or_b32 s69, s69, s73
 s_or_b32 s71, s71, s87
 buffer_load_dwordx4 v[180:183], v27, s[8:11], s71 offen sc1
 s_cmp_lg_u32 s70, 0
 s_cbranch_scc1 L_rk7
 s_call_b64 s[36:37], L_rpoll
L_rk7:
 s_ff1_i32_b32 s71, s70
 s_bitset0_b32 s70, s71
 s_cmp_ge_u32 s71, 16
 s_cselect_b32 s72, s78, s77
 s_cselect_b32 s73, 0x80, 0
 s_cselect_b32 s87, 536870912, 0
 s_mul_i32 s71, s71, 114688
 s_add_u32 s71, s71, s72
 buffer_load_dwordx4 v[184:187], v7, s[8:11], s71 offen sc1
 s_or_b32 s69, s69, s73
 s_or_b32 s71, s71, s87
 buffer_load_dwordx4 v[188:191], v27, s[8:11], s71 offen sc1
 s_cmp_lg_u32 s70, 0
 s_cbranch_scc1 L_rk8
 s_call_b64 s[36:37], L_rpoll
L_rk8:
 s_ff1_i32_b32 s71, s70
 s_bitset0_b32 s70, s71
 s_cmp_ge_u32 s71, 16
 s_cselect_b32 s72, s78, s77
 s_cselect_b32 s73, 0x100, 0
 s_cselect_b32 s87, 536870912, 0
 s_mul_i32 s71, s71, 114688
 s_add_u32 s71, s71, s72
 buffer_load_dwordx4 v[192:195], v7, s[8:11], s71 offen sc1
 s_or_b32 s69, s69, s73
 s_or_b32 s71, s71, s87
 buffer_load_dwordx4 v[196:199], v27, s[8:11], s71 offen sc1
 s_waitcnt vmcnt(16)
 s_bitcmp1_b32 s69, 0
 s_cbranch_scc1 L_rx0
 v_dot2c_f32_bf16 v48, v128, v24
 v_dot2c_f32_bf16 v49, v128, v25
 v_dot2c_f32_bf16 v50, v129, v24
 v_dot2c_f32_bf16 v51, v129, v25
 v_dot2c_f32_bf16 v52, v130, v24
 v_dot2c_f32_bf16 v53, v130, v25
 v_dot2c_f32_bf16 v54, v131, v24
 v_dot2c_f32_bf16 v55, v131, v25
 v_dot2c_f32_bf16 v56, v132, v24
 v_dot2c_f32_bf16 v57, v132, v25
 v_dot2c_f32_bf16 v58, v133, v24
 v_dot2c_f32_bf16 v59, v133, v25
 v_dot2c_f32_bf16 v60, v134, v24
 v_dot2c_f32_bf16 v61, v134, v25
 v_dot2c_f32_bf16 v62, v135, v24
 v_dot2c_f32_bf16 v63, v135, v25
L_ry0:
 s_cmp_lg_u32 s70, 0
 s_cbranch_scc1 L_rk9
 s_call_b64 s[36:37], L_rpoll
L_rk9:
 s_ff1_i32_b32 s71, s70
 s_bitset0_b32 s70, s71
 s_cmp_ge_u32 s71, 16
 s_cselect_b32 s72, s78, s77
 s_cselect_b32 s73, 0x200, 0
 s_cselect_b32 s87, 536870912, 0
 s_mul_i32 s71, s71, 114688
 s_add_u32 s71, s71, s72
 buffer_load_dwordx4 v[200:203], v7, s[8:11], s71 offen sc1
 s_or_b32 s69, s69, s73
 s_or_b32 s71, s71, s87
 buffer_load_dwordx4 v[204:207], v27, s[8:11], s71 offen sc1
 s_waitcnt vmcnt(16)
 s_bitcmp1_b32 s69, 1
 s_cbranch_scc1 L_rx1
 v_dot2c_f32_bf16 v48, v136, v24
 v_dot2c_f32_bf16 v49, v136, v25
 v_dot2c_f32_bf16 v50, v137, v24
 v_dot2c_f32_bf16 v51, v137, v25
 v_dot2c_f32_bf16 v52, v138, v24
 v_dot2c_f32_bf16 v53, v138, v25
 v_dot2c_f32_bf16 v54, v139, v24
 v_dot2c_f32_bf16 v55, v139, v25
 v_dot2c_f32_bf16 v56, v140, v24
 v_dot2c_f32_bf16 v57, v140, v25
 v_dot2c_f32_bf16 v58, v141, v24
 v_dot2c_f32_bf16 v59, v141, v25
 v_dot2c_f32_bf16 v60, v142, v24
 v_dot2c_f32_bf16 v61, v142, v25
 v_dot2c_f32_bf16 v62, v143, v24
 v_dot2c_f32_bf16 v63, v143, v25
L_ry1:
 s_cmp_lg_u32 s70, 0
 s_cbranch_scc1 L_rk10
 s_call_b64 s[36:37], L_rpoll
L_rk10:
 s_ff1_i32_b32 s71, s70
 s_bitset0_b32 s70, s71
 s_cmp_ge_u32 s71, 16
 s_cselect_b32 s72, s78, s77
 s_cselect_b32 s73, 0x400, 0
 s_cselect_b32 s87, 536870912, 0
 s_mul_i32 s71, s71, 114688
 s_add_u32 s71, s71, s72
 buffer_load_dwordx4 v[208:211], v7, s[8:11], s71 offen sc1
 s_or_b32 s69, s69, s73
 s_or_b32 s71, s71, s87
 buffer_load_dwordx4 v[212:215], v27, s[8:11], s71 offen sc1
 s_waitcnt vmcnt(16)
 s_bitcmp1_b32 s69, 2
 s_cbranch_scc1 L_rx2
 v_dot2c_f32_bf16 v48, v144, v24
 v_dot2c_f32_bf16 v49, v144, v25
 v_dot2c_f32_bf16 v50, v145, v24
 v_dot2c_f32_bf16 v51, v145, v25
 v_dot2c_f32_bf16 v52, v146, v24
 v_dot2c_f32_bf16 v53, v146, v25
 v_dot2c_f32_bf16 v54, v147, v24
 v_dot2c_f32_bf16 v55, v147, v25
 v_dot2c_f32_bf16 v56, v148, v24
 v_dot2c_f32_bf16 v57, v148, v25
 v_dot2c_f32_bf16 v58, v149, v24
 v_dot2c_f32_bf16 v59, v149, v25
 v_dot2c_f32_bf16 v60, v150, v24
 v_dot2c_f32_bf16 v61, v150, v25
 v_dot2c_f32_bf16 v62, v151, v24
 v_dot2c_f32_bf16 v63, v151, v25
L_ry2:
 s_cmp_lg_u32 s70, 0
 s_cbranch_scc1 L_rk11
 s_call_b64 s[36:37], L_rpoll
L_rk11:
 s_ff1_i32_b32 s71, s70
 s_bitset0_b32 s70, s71
 s_cmp_ge_u32 s71, 16
 s_cselect_b32 s72, s78, s77
 s_cselect_b32 s73, 0x800, 0
 s_cselect_b32 s87, 536870912, 0
 s_mul_i32 s71, s71, 114688
 s_add_u32 s71, s71, s72
 buffer_load_dwordx4 v[216:219], v7, s[8:11], s71 offen sc1
 s_or_b32 s69, s69, s73
 s_or_b32 s71, s71, s87
 buffer_load_dwordx4 v[220:223], v27, s[8:11], s71 offen sc1
 s_waitcnt vmcnt(16)
 s_bitcmp1_b32 s69, 3
 s_cbranch_scc1 L_rx3
 v_dot2c_f32_bf16 v48, v152, v24
 v_dot2c_f32_bf16 v49, v152, v25
 v_dot2c_f32_bf16 v50, v153, v24
 v_dot2c_f32_bf16 v51, v153, v25
 v_dot2c_f32_bf16 v52, v154, v24
 v_dot2c_f32_bf16 v53, v154, v25
 v_dot2c_f32_bf16 v54, v155, v24
 v_dot2c_f32_bf16 v55, v155, v25
 v_dot2c_f32_bf16 v56, v156, v24
 v_dot2c_f32_bf16 v57, v156, v25
 v_dot2c_f32_bf16 v58, v157, v24
 v_dot2c_f32_bf16 v59, v157, v25
 v_dot2c_f32_bf16 v60, v158, v24
 v_dot2c_f32_bf16 v61, v158, v25
 v_dot2c_f32_bf16 v62, v159, v24
 v_dot2c_f32_bf16 v63, v159, v25
L_ry3:
 s_cmp_lg_u32 s70, 0
 s_cbranch_scc1 L_rk12
 s_call_b64 s[36:37], L_rpoll
L_rk12:
 s_ff1_i32_b32 s71, s70
 s_bitset0_b32 s70, s71
 s_cmp_ge_u32 s71, 16
 s_cselect_b32 s72, s78, s77
 s_cselect_b32 s73, 0x1000, 0
 s_cselect_b32 s87, 536870912, 0
 s_mul_i32 s71, s71, 114688
 s_add_u32 s71, s71, s72
 buffer_load_dwordx4 v[224:227], v7, s[8:11], s71 offen sc1
 s_or_b32 s69, s69, s73
 s_or_b32 s71, s71, s87
 buffer_load_dwordx4 v[228:231], v27, s[8:11], s71 offen sc1
 s_waitcnt vmcnt(16)
 s_bitcmp1_b32 s69, 4
 s_cbranch_scc1 L_rx4
 v_dot2c_f32_bf16 v48, v160, v24
 v_dot2c_f32_bf16 v49, v160, v25
 v_dot2c_f32_bf16 v50, v161, v24
 v_dot2c_f32_bf16 v51, v161, v25
 v_dot2c_f32_bf16 v52, v162, v24
 v_dot2c_f32_bf16 v53, v162, v25
 v_dot2c_f32_bf16 v54, v163, v24
 v_dot2c_f32_bf16 v55, v163, v25
 v_dot2c_f32_bf16 v56, v164, v24
 v_dot2c_f32_bf16 v57, v164, v25
 v_dot2c_f32_bf16 v58, v165, v24
 v_dot2c_f32_bf16 v59, v165, v25
 v_dot2c_f32_bf16 v60, v166, v24
 v_dot2c_f32_bf16 v61, v166, v25
 v_dot2c_f32_bf16 v62, v167, v24
 v_dot2c_f32_bf16 v63, v167, v25
L_ry4:
 s_cmp_lg_u32 s70, 0
 s_cbranch_scc1 L_rk13
 s_call_b64 s[36:37], L_rpoll
L_rk13:
 s_ff1_i32_b32 s71, s70
 s_bitset0_b32 s70, s71
 s_cmp_ge_u32 s71, 16
 s_cselect_b32 s72, s78, s77
 s_cselect_b32 s73, 0x2000, 0
 s_cselect_b32 s87, 536870912, 0
 s_mul_i32 s71, s71, 114688
 s_add_u32 s71, s71, s72
 buffer_load_dwordx4 v[232:235], v7, s[8:11], s71 offen sc1
 s_or_b32 s69, s69, s73
 s_or_b32 s71, s71, s87
 buffer_load_dwordx4 v[236:239], v27, s[8:11], s71 offen sc1
 s_waitcnt vmcnt(16)
 s_bitcmp1_b32 s69, 5
 s_cbranch_scc1 L_rx5
 v_dot2c_f32_bf16 v48, v168, v24
 v_dot2c_f32_bf16 v49, v168, v25
 v_dot2c_f32_bf16 v50, v169, v24
 v_dot2c_f32_bf16 v51, v169, v25
 v_dot2c_f32_bf16 v52, v170, v24
 v_dot2c_f32_bf16 v53, v170, v25
 v_dot2c_f32_bf16 v54, v171, v24
 v_dot2c_f32_bf16 v55, v171, v25
 v_dot2c_f32_bf16 v56, v172, v24
 v_dot2c_f32_bf16 v57, v172, v25
 v_dot2c_f32_bf16 v58, v173, v24
 v_dot2c_f32_bf16 v59, v173, v25
 v_dot2c_f32_bf16 v60, v174, v24
 v_dot2c_f32_bf16 v61, v174, v25
 v_dot2c_f32_bf16 v62, v175, v24
 v_dot2c_f32_bf16 v63, v175, v25
L_ry5:
 s_cmp_lg_u32 s70, 0
 s_cbranch_scc1 L_rk14
 s_call_b64 s[36:37], L_rpoll
L_rk14:
 s_ff1_i32_b32 s71, s70
 s_bitset0_b32 s70, s71
 s_cmp_ge_u32 s71, 16
 s_cselect_b32 s72, s78, s77
 s_cselect_b32 s73, 0x4000, 0
 s_cselect_b32 s87, 536870912, 0
 s_mul_i32 s71, s71, 114688
 s_add_u32 s71, s71, s72
 buffer_load_dwordx4 v[240:243], v7, s[8:11], s71 offen sc1
 s_or_b32 s69, s69, s73
 s_or_b32 s71, s71, s87
 buffer_load_dwordx4 v[244:247], v27, s[8:11], s71 offen sc1
 s_waitcnt vmcnt(16)
 s_bitcmp1_b32 s69, 6
 s_cbranch_scc1 L_rx6
 v_dot2c_f32_bf16 v48, v176, v24
 v_dot2c_f32_bf16 v49, v176, v25
 v_dot2c_f32_bf16 v50, v177, v24
 v_dot2c_f32_bf16 v51, v177, v25
 v_dot2c_f32_bf16 v52, v178, v24
 v_dot2c_f32_bf16 v53, v178, v25
 v_dot2c_f32_bf16 v54, v179, v24
 v_dot2c_f32_bf16 v55, v179, v25
 v_dot2c_f32_bf16 v56, v180, v24
 v_dot2c_f32_bf16 v57, v180, v25
 v_dot2c_f32_bf16 v58, v181, v24
 v_dot2c_f32_bf16 v59, v181, v25
 v_dot2c_f32_bf16 v60, v182, v24
 v_dot2c_f32_bf16 v61, v182, v25
 v_dot2c_f32_bf16 v62, v183, v24
 v_dot2c_f32_bf16 v63, v183, v25
L_ry6:
 s_cmp_lg_u32 s70, 0
 s_cbranch_scc1 L_rk15
 s_call_b64 s[36:37], L_rpoll
L_rk15:
 s_ff1_i32_b32 s71, s70
 s_bitset0_b32 s70, s71
 s_cmp_ge_u32 s71, 16
 s_cselect_b32 s72, s78, s77
 s_cselect_b32 s73, 0x8000, 0
 s_cselect_b32 s87, 536870912, 0
 s_mul_i32 s71, s71, 114688
 s_add_u32 s71, s71, s72
 buffer_load_dwordx4 v[248:251], v7, s[8:11], s71 offen sc1
 s_or_b32 s69, s69, s73
 s_or_b32 s71, s71, s87
 buffer_load_dwordx4 v[252:255], v27, s[8:11], s71 offen sc1
 s_waitcnt vmcnt(16)
 s_bitcmp1_b32 s69, 7
 s_cbranch_scc1 L_rx7
 v_dot2c_f32_bf16 v48, v184, v24
 v_dot2c_f32_bf16 v49, v184, v25
 v_dot2c_f32_bf16 v50, v185, v24
 v_dot2c_f32_bf16 v51, v185, v25
 v_dot2c_f32_bf16 v52, v186, v24
 v_dot2c_f32_bf16 v53, v186, v25
 v_dot2c_f32_bf16 v54, v187, v24
 v_dot2c_f32_bf16 v55, v187, v25
 v_dot2c_f32_bf16 v56, v188, v24
 v_dot2c_f32_bf16 v57, v188, v25
 v_dot2c_f32_bf16 v58, v189, v24
 v_dot2c_f32_bf16 v59, v189, v25
 v_dot2c_f32_bf16 v60, v190, v24
 v_dot2c_f32_bf16 v61, v190, v25
 v_dot2c_f32_bf16 v62, v191, v24
 v_dot2c_f32_bf16 v63, v191, v25
L_ry7:
 s_cmp_lg_u32 s70, 0
 s_cbranch_scc1 L_rk16
 s_call_b64 s[36:37], L_rpoll
L_rk16:
 s_ff1_i32_b32 s71, s70
 s_bitset0_b32 s70, s71
 s_cmp_ge_u32 s71, 16
 s_cselect_b32 s72, s78, s77
 s_cselect_b32 s73, 0x10000, 0
 s_cselect_b32 s87, 536870912, 0
 s_mul_i32 s71, s71, 114688
 s_add_u32 s71, s71, s72
 buffer_load_dwordx4 v[128:131], v7, s[8:11], s71 offen sc1
 s_or_b32 s69, s69, s73
 s_or_b32 s71, s71, s87
 buffer_load_dwordx4 v[132:135], v27, s[8:11], s71 offen sc1
 s_waitcnt vmcnt(16)
 s_bitcmp1_b32 s69, 8
 s_cbranch_scc1 L_rx8
 v_dot2c_f32_bf16 v48, v192, v24
 v_dot2c_f32_bf16 v49, v192, v25
 v_dot2c_f32_bf16 v50, v193, v24
 v_dot2c_f32_bf16 v51, v193, v25
 v_dot2c_f32_bf16 v52, v194, v24
 v_dot2c_f32_bf16 v53, v194, v25
 v_dot2c_f32_bf16 v54, v195, v24
 v_dot2c_f32_bf16 v55, v195, v25
 v_dot2c_f32_bf16 v56, v196, v24
 v_dot2c_f32_bf16 v57, v196, v25
 v_dot2c_f32_bf16 v58, v197, v24
 v_dot2c_f32_bf16 v59, v197, v25
 v_dot2c_f32_bf16 v60, v198, v24
 v_dot2c_f32_bf16 v61, v198, v25
 v_dot2c_f32_bf16 v62, v199, v24
 v_dot2c_f32_bf16 v63, v199, v25
L_ry8:
 s_cmp_lg_u32 s70, 0
 s_cbranch_scc1 L_rk17
 s_call_b64 s[36:37], L_rpoll
L_rk17:
 s_ff1_i32_b32 s71, s70
 s_bitset0_b32 s70, s71
 s_cmp_ge_u32 s71, 16
 s_cselect_b32 s72, s78, s77
 s_cselect_b32 s73, 0x20000, 0
 s_cselect_b32 s87, 536870912, 0
 s_mul_i32 s71, s71, 114688
 s_add_u32 s71, s71, s72
 buffer_load_dwordx4 v[136:139], v7, s[8:11], s71 offen sc1
 s_or_b32 s69, s69, s73
 s_or_b32 s71, s71, s87
 buffer_load_dwordx4 v[140:143], v27, s[8:11], s71 offen sc1
 s_waitcnt vmcnt(16)
 s_bitcmp1_b32 s69, 9
 s_cbranch_scc1 L_rx9
 v_dot2c_f32_bf16 v48, v200, v24
 v_dot2c_f32_bf16 v49, v200, v25
 v_dot2c_f32_bf16 v50, v201, v24
 v_dot2c_f32_bf16 v51, v201, v25
 v_dot2c_f32_bf16 v52, v202, v24
 v_dot2c_f32_bf16 v53, v202, v25
 v_dot2c_f32_bf16 v54, v203, v24
 v_dot2c_f32_bf16 v55, v203, v25
 v_dot2c_f32_bf16 v56, v204, v24
 v_dot2c_f32_bf16 v57, v204, v25
 v_dot2c_f32_bf16 v58, v205, v24
 v_dot2c_f32_bf16 v59, v205, v25
 v_dot2c_f32_bf16 v60, v206, v24
 v_dot2c_f32_bf16 v61, v206, v25
 v_dot2c_f32_bf16 v62, v207, v24
 v_dot2c_f32_bf16 v63, v207, v25
L_ry9:
 s_cmp_lg_u32 s70, 0
 s_cbranch_scc1 L_rk18
 s_call_b64 s[36:37], L_rpoll
L_rk18:
 s_ff1_i32_b32 s71, s70
 s_bitset0_b32 s70, s71
 s_cmp_ge_u32 s71, 16
 s_cselect_b32 s72, s78, s77
 s_cselect_b32 s73, 0x40000, 0
 s_cselect_b32 s87, 536870912, 0
 s_mul_i32 s71, s71, 114688
 s_add_u32 s71, s71, s72
 buffer_load_dwordx4 v[144:147], v7, s[8:11], s71 offen sc1
 s_or_b32 s69, s69, s73
 s_or_b32 s71, s71, s87
 buffer_load_dwordx4 v[148:151], v27, s[8:11], s71 offen sc1
 s_waitcnt vmcnt(16)
 s_bitcmp1_b32 s69, 10
 s_cbranch_scc1 L_rx10
 v_dot2c_f32_bf16 v48, v208, v24
 v_dot2c_f32_bf16 v49, v208, v25
 v_dot2c_f32_bf16 v50, v209, v24
 v_dot2c_f32_bf16 v51, v209, v25
 v_dot2c_f32_bf16 v52, v210, v24
 v_dot2c_f32_bf16 v53, v210, v25
 v_dot2c_f32_bf16 v54, v211, v24
 v_dot2c_f32_bf16 v55, v211, v25
 v_dot2c_f32_bf16 v56, v212, v24
 v_dot2c_f32_bf16 v57, v212, v25
 v_dot2c_f32_bf16 v58, v213, v24
 v_dot2c_f32_bf16 v59, v213, v25
 v_dot2c_f32_bf16 v60, v214, v24
 v_dot2c_f32_bf16 v61, v214, v25
 v_dot2c_f32_bf16 v62, v215, v24
 v_dot2c_f32_bf16 v63, v215, v25
L_ry10:
 s_cmp_lg_u32 s70, 0
 s_cbranch_scc1 L_rk19
 s_call_b64 s[36:37], L_rpoll
L_rk19:
 s_ff1_i32_b32 s71, s70
 s_bitset0_b32 s70, s71
 s_cmp_ge_u32 s71, 16
 s_cselect_b32 s72, s78, s77
 s_cselect_b32 s73, 0x80000, 0
 s_cselect_b32 s87, 536870912, 0
 s_mul_i32 s71, s71, 114688
 s_add_u32 s71, s71, s72
 buffer_load_dwordx4 v[152:155], v7, s[8:11], s71 offen sc1
 s_or_b32 s69, s69, s73
 s_or_b32 s71, s71, s87
 buffer_load_dwordx4 v[156:159], v27, s[8:11], s71 offen sc1
 s_waitcnt vmcnt(16)
 s_bitcmp1_b32 s69, 11
 s_cbranch_scc1 L_rx11
 v_dot2c_f32_bf16 v48, v216, v24
 v_dot2c_f32_bf16 v49, v216, v25
 v_dot2c_f32_bf16 v50, v217, v24
 v_dot2c_f32_bf16 v51, v217, v25
 v_dot2c_f32_bf16 v52, v218, v24
 v_dot2c_f32_bf16 v53, v218, v25
 v_dot2c_f32_bf16 v54, v219, v24
 v_dot2c_f32_bf16 v55, v219, v25
 v_dot2c_f32_bf16 v56, v220, v24
 v_dot2c_f32_bf16 v57, v220, v25
 v_dot2c_f32_bf16 v58, v221, v24
 v_dot2c_f32_bf16 v59, v221, v25
 v_dot2c_f32_bf16 v60, v222, v24
 v_dot2c_f32_bf16 v61, v222, v25
 v_dot2c_f32_bf16 v62, v223, v24
 v_dot2c_f32_bf16 v63, v223, v25
L_ry11:
 s_cmp_lg_u32 s70, 0
 s_cbranch_scc1 L_rk20
 s_call_b64 s[36:37], L_rpoll
L_rk20:
 s_ff1_i32_b32 s71, s70
 s_bitset0_b32 s70, s71
 s_cmp_ge_u32 s71, 16
 s_cselect_b32 s72, s78, s77
 s_cselect_b32 s73, 0x100000, 0
 s_cselect_b32 s87, 536870912, 0
 s_mul_i32 s71, s71, 114688
 s_add_u32 s71, s71, s72
 buffer_load_dwordx4 v[160:163], v7, s[8:11], s71 offen sc1
 s_or_b32 s69, s69, s73
 s_or_b32 s71, s71, s87
 buffer_load_dwordx4 v[164:167], v27, s[8:11], s71 offen sc1
 s_waitcnt vmcnt(16)
 s_bitcmp1_b32 s69, 12
 s_cbranch_scc1 L_rx12
 v_dot2c_f32_bf16 v48, v224, v24
 v_dot2c_f32_bf16 v49, v224, v25
 v_dot2c_f32_bf16 v50, v225, v24
 v_dot2c_f32_bf16 v51, v225, v25
 v_dot2c_f32_bf16 v52, v226, v24
 v_dot2c_f32_bf16 v53, v226, v25
 v_dot2c_f32_bf16 v54, v227, v24
 v_dot2c_f32_bf16 v55, v227, v25
 v_dot2c_f32_bf16 v56, v228, v24
 v_dot2c_f32_bf16 v57, v228, v25
 v_dot2c_f32_bf16 v58, v229, v24
 v_dot2c_f32_bf16 v59, v229, v25
 v_dot2c_f32_bf16 v60, v230, v24
 v_dot2c_f32_bf16 v61, v230, v25
 v_dot2c_f32_bf16 v62, v231, v24
 v_dot2c_f32_bf16 v63, v231, v25
L_ry12:
 s_cmp_lg_u32 s70, 0
 s_cbranch_scc1 L_rk21
 s_call_b64 s[36:37], L_rpoll
L_rk21:
 s_ff1_i32_b32 s71, s70
 s_bitset0_b32 s70, s71
 s_cmp_ge_u32 s71, 16
 s_cselect_b32 s72, s78, s77
 s_cselect_b32 s73, 0x200000, 0
 s_cselect_b32 s87, 536870912, 0
 s_mul_i32 s71, s71, 114688
 s_add_u32 s71, s71, s72
 buffer_load_dwordx4 v[168:171], v7, s[8:11], s71 offen sc1
 s_or_b32 s69, s69, s73
 s_or_b32 s71, s71, s87
 buffer_load_dwordx4 v[172:175], v27, s[8:11], s71 offen sc1
 s_waitcnt vmcnt(16)
 s_bitcmp1_b32 s69, 13
 s_cbranch_scc1 L_rx13
 v_dot2c_f32_bf16 v48, v232, v24
 v_dot2c_f32_bf16 v49, v232, v25
 v_dot2c_f32_bf16 v50, v233, v24
 v_dot2c_f32_bf16 v51, v233, v25
 v_dot2c_f32_bf16 v52, v234, v24
 v_dot2c_f32_bf16 v53, v234, v25
 v_dot2c_f32_bf16 v54, v235, v24
 v_dot2c_f32_bf16 v55, v235, v25
 v_dot2c_f32_bf16 v56, v236, v24
 v_dot2c_f32_bf16 v57, v236, v25
 v_dot2c_f32_bf16 v58, v237, v24
 v_dot2c_f32_bf16 v59, v237, v25
 v_dot2c_f32_bf16 v60, v238, v24
 v_dot2c_f32_bf16 v61, v238, v25
 v_dot2c_f32_bf16 v62, v239, v24
 v_dot2c_f32_bf16 v63, v239, v25
L_ry13:
 s_cmp_lg_u32 s70, 0
 s_cbranch_scc1 L_rk22
 s_call_b64 s[36:37], L_rpoll
L_rk22:
 s_ff1_i32_b32 s71, s70
 s_bitset0_b32 s70, s71
 s_cmp_ge_u32 s71, 16
 s_cselect_b32 s72, s78, s77
 s_cselect_b32 s73, 0x400000, 0
 s_cselect_b32 s87, 536870912, 0
 s_mul_i32 s71, s71, 114688
 s_add_u32 s71, s71, s72
 buffer_load_dwordx4 v[176:179], v7, s[8:11], s71 offen sc1
 s_or_b32 s69, s69, s73
 s_or_b32 s71, s71, s87
 buffer_load_dwordx4 v[180:183], v27, s[8:11], s71 offen sc1
 s_waitcnt vmcnt(16)
 s_bitcmp1_b32 s69, 14
 s_cbranch_scc1 L_rx14
 v_dot2c_f32_bf16 v48, v240, v24
 v_dot2c_f32_bf16 v49, v240, v25
 v_dot2c_f32_bf16 v50, v241, v24
 v_dot2c_f32_bf16 v51, v241, v25
 v_dot2c_f32_bf16 v52, v242, v24
 v_dot2c_f32_bf16 v53, v242, v25
 v_dot2c_f32_bf16 v54, v243, v24
 v_dot2c_f32_bf16 v55, v243, v25
 v_dot2c_f32_bf16 v56, v244, v24
 v_dot2c_f32_bf16 v57, v244, v25
 v_dot2c_f32_bf16 v58, v245, v24
 v_dot2c_f32_bf16 v59, v245, v25
 v_dot2c_f32_bf16 v60, v246, v24
 v_dot2c_f32_bf16 v61, v246, v25
 v_dot2c_f32_bf16 v62, v247, v24
 v_dot2c_f32_bf16 v63, v247, v25
L_ry14:
 s_cmp_lg_u32 s70, 0
 s_cbranch_scc1 L_rk23
 s_call_b64 s[36:37], L_rpoll
L_rk23:
 s_ff1_i32_b32 s71, s70
 s_bitset0_b32 s70, s71
 s_cmp_ge_u32 s71, 16
 s_cselect_b32 s72, s78, s77
 s_cselect_b32 s73, 0x800000, 0
 s_cselect_b32 s87, 536870912, 0
 s_mul_i32 s71, s71, 114688
 s_add_u32 s71, s71, s72
 buffer_load_dwordx4 v[184:187], v7, s[8:11], s71 offen sc1
 s_or_b32 s69, s69, s73
 s_or_b32 s71, s71, s87
 buffer_load_dwordx4 v[188:191], v27, s[8:11], s71 offen sc1
 s_waitcnt vmcnt(16)
 s_bitcmp1_b32 s69, 15
 s_cbranch_scc1 L_rx15
 v_dot2c_f32_bf16 v48, v248, v24
 v_dot2c_f32_bf16 v49, v248, v25
 v_dot2c_f32_bf16 v50, v249, v24
 v_dot2c_f32_bf16 v51, v249, v25
 v_dot2c_f32_bf16 v52, v250, v24
 v_dot2c_f32_bf16 v53, v250, v25
 v_dot2c_f32_bf16 v54, v251, v24
 v_dot2c_f32_bf16 v55, v251, v25
 v_dot2c_f32_bf16 v56, v252, v24
 v_dot2c_f32_bf16 v57, v252, v25
 v_dot2c_f32_bf16 v58, v253, v24
 v_dot2c_f32_bf16 v59, v253, v25
 v_dot2c_f32_bf16 v60, v254, v24
 v_dot2c_f32_bf16 v61, v254, v25
 v_dot2c_f32_bf16 v62, v255, v24
 v_dot2c_f32_bf16 v63, v255, v25
L_ry15:
 s_cmp_lg_u32 s70, 0
 s_cbranch_scc1 L_rk24
 s_call_b64 s[36:37], L_rpoll
L_rk24:
 s_ff1_i32_b32 s71, s70
 s_bitset0_b32 s70, s71
 s_cmp_ge_u32 s71, 16
 s_cselect_b32 s72, s78, s77
 s_cselect_b32 s73, 0x1000000, 0
 s_cselect_b32 s87, 536870912, 0
 s_mul_i32 s71, s71, 114688
 s_add_u32 s71, s71, s72
 buffer_load_dwordx4 v[192:195], v7, s[8:11], s71 offen sc1
 s_or_b32 s69, s69, s73
 s_or_b32 s71, s71, s87
 buffer_load_dwordx4 v[196:199], v27, s[8:11], s71 offen sc1
 s_waitcnt vmcnt(16)
 s_bitcmp0_b32 s69, 16
 s_cbranch_scc1 L_rx16
 v_dot2c_f32_bf16 v64, v128, v24
 v_dot2c_f32_bf16 v65, v128, v25
 v_dot2c_f32_bf16 v66, v129, v24
 v_dot2c_f32_bf16 v67, v129, v25
 v_dot2c_f32_bf16 v68, v130, v24
 v_dot2c_f32_bf16 v69, v130, v25
 v_dot2c_f32_bf16 v70, v131, v24
 v_dot2c_f32_bf16 v71, v131, v25
L_ry16:
 s_cmp_lg_u32 s70, 0
 s_cbranch_scc1 L_rk25
 s_call_b64 s[36:37], L_rpoll
L_rk25:
 s_ff1_i32_b32 s71, s70
 s_bitset0_b32 s70, s71
 s_cmp_ge_u32 s71, 16
 s_cselect_b32 s72, s78, s77
 s_cselect_b32 s73, 0x2000000, 0
 s_cselect_b32 s87, 536870912, 0
 s_mul_i32 s71, s71, 114688
 s_add_u32 s71, s71, s72
 buffer_load_dwordx4 v[200:203], v7, s[8:11], s71 offen sc1
 s_or_b32 s69, s69, s73
 s_or_b32 s71, s71, s87
 buffer_load_dwordx4 v[204:207], v27, s[8:11], s71 offen sc1
 s_waitcnt vmcnt(16)
 s_bitcmp0_b32 s69, 17
 s_cbranch_scc1 L_rx17
 v_dot2c_f32_bf16 v64, v136, v24
 v_dot2c_f32_bf16 v65, v136, v25
 v_dot2c_f32_bf16 v66, v137, v24
 v_dot2c_f32_bf16 v67, v137, v25
 v_dot2c_f32_bf16 v68, v138, v24
 v_dot2c_f32_bf16 v69, v138, v25
 v_dot2c_f32_bf16 v70, v139, v24
 v_dot2c_f32_bf16 v71, v139, v25
L_ry17:
 s_cmp_lg_u32 s70, 0
 s_cbranch_scc1 L_rk26
 s_call_b64 s[36:37], L_rpoll
L_rk26:
 s_ff1_i32_b32 s71, s70
 s_bitset0_b32 s70, s71
 s_cmp_ge_u32 s71, 16
 s_cselect_b32 s72, s78, s77
 s_cselect_b32 s73, 0x4000000, 0
 s_cselect_b32 s87, 536870912, 0
 s_mul_i32 s71, s71, 114688
 s_add_u32 s71, s71, s72
 buffer_load_dwordx4 v[208:211], v7, s[8:11], s71 offen sc1
 s_or_b32 s69, s69, s73
 s_or_b32 s71, s71, s87
 buffer_load_dwordx4 v[212:215], v27, s[8:11], s71 offen sc1
 s_waitcnt vmcnt(16)
 s_bitcmp0_b32 s69, 18
 s_cbranch_scc1 L_rx18
 v_dot2c_f32_bf16 v64, v144, v24
 v_dot2c_f32_bf16 v65, v144, v25
 v_dot2c_f32_bf16 v66, v145, v24
 v_dot2c_f32_bf16 v67, v145, v25
 v_dot2c_f32_bf16 v68, v146, v24
 v_dot2c_f32_bf16 v69, v146, v25
 v_dot2c_f32_bf16 v70, v147, v24
 v_dot2c_f32_bf16 v71, v147, v25
L_ry18:
 s_cmp_lg_u32 s70, 0
 s_cbranch_scc1 L_rk27
 s_call_b64 s[36:37], L_rpoll
L_rk27:
 s_ff1_i32_b32 s71, s70
 s_bitset0_b32 s70, s71
 s_cmp_ge_u32 s71, 16
 s_cselect_b32 s72, s78, s77
 s_cselect_b32 s73, 0x8000000, 0
 s_cselect_b32 s87, 536870912, 0
 s_mul_i32 s71, s71, 114688
 s_add_u32 s71, s71, s72
 buffer_load_dwordx4 v[216:219], v7, s[8:11], s71 offen sc1
 s_or_b32 s69, s69, s73
 s_or_b32 s71, s71, s87
 buffer_load_dwordx4 v[220:223], v27, s[8:11], s71 offen sc1
 s_waitcnt vmcnt(16)
 s_bitcmp0_b32 s69, 19
 s_cbranch_scc1 L_rx19
 v_dot2c_f32_bf16 v64, v152, v24
 v_dot2c_f32_bf16 v65, v152, v25
 v_dot2c_f32_bf16 v66, v153, v24
 v_dot2c_f32_bf16 v67, v153, v25
 v_dot2c_f32_bf16 v68, v154, v24
 v_dot2c_f32_bf16 v69, v154, v25
 v_dot2c_f32_bf16 v70, v155, v24
 v_dot2c_f32_bf16 v71, v155, v25
L_ry19:
 s_and_b32 s71, s69, 0xfffff
 s_bcnt1_i32_b32 s71, s71
 s_cmp_eq_u32 s71, 4
 s_cselect_b32 s66, 1, 0
 s_cbranch_scc0 L_rne
 v_fmac_f32 v32, v15, v48
 v_fmac_f32 v33, v15, v49
 v_fmac_f32 v34, v15, v50
 v_fmac_f32 v35, v15, v51
 v_fmac_f32 v36, v15, v52
 v_fmac_f32 v37, v15, v53
 v_fmac_f32 v38, v15, v54
 v_fmac_f32 v39, v15, v55
 v_cvt_pk_bf16_f32 v16, v32, v33
 v_cvt_pk_bf16_f32 v17, v34, v35
 v_cvt_pk_bf16_f32 v18, v36, v37
 v_cvt_pk_bf16_f32 v19, v38, v39
 buffer_store_dwordx4 v[16:19], v12, s[52:55], s75 offen sc1
 v_fmac_f32 v40, v15, v56
 v_fmac_f32 v41, v15, v57
 v_fmac_f32 v42, v15, v58
 v_fmac_f32 v43, v15, v59
 v_fmac_f32 v44, v15, v60
 v_fmac_f32 v45, v15, v61
 v_fmac_f32 v46, v15, v62
 v_fmac_f32 v47, v15, v63
 v_cvt_pk_bf16_f32 v20, v40, v41
 v_cvt_pk_bf16_f32 v21, v42, v43
 v_cvt_pk_bf16_f32 v22, v44, v45
 v_cvt_pk_bf16_f32 v23, v46, v47
 buffer_store_dwordx4 v[20:23], v12, s[52:55], s76 offen sc1
L_rne:
 s_cmp_lg_u32 s70, 0
 s_cbranch_scc1 L_rk28
 s_call_b64 s[36:37], L_rpoll
L_rk28:
 s_ff1_i32_b32 s71, s70
 s_bitset0_b32 s70, s71
 s_cmp_ge_u32 s71, 16
 s_cselect_b32 s72, s78, s77
 s_cselect_b32 s73, 0x10000000, 0
 s_cselect_b32 s87, 536870912, 0
 s_mul_i32 s71, s71, 114688
 s_add_u32 s71, s71, s72
 buffer_load_dwordx4 v[224:227], v7, s[8:11], s71 offen sc1
 s_or_b32 s69, s69, s73
 s_or_b32 s71, s71, s87
 buffer_load_dwordx4 v[228:231], v27, s[8:11], s71 offen sc1
 s_waitcnt vmcnt(16)
 s_bitcmp0_b32 s69, 20
 s_cbranch_scc1 L_rx20
 v_dot2c_f32_bf16 v64, v160, v24
 v_dot2c_f32_bf16 v65, v160, v25
 v_dot2c_f32_bf16 v66, v161, v24
 v_dot2c_f32_bf16 v67, v161, v25
 v_dot2c_f32_bf16 v68, v162, v24
 v_dot2c_f32_bf16 v69, v162, v25
 v_dot2c_f32_bf16 v70, v163, v24
 v_dot2c_f32_bf16 v71, v163, v25
L_ry20:
 s_cmp_lg_u32 s70, 0
 s_cbranch_scc1 L_rk29
 s_call_b64 s[36:37], L_rpoll
L_rk29:
 s_ff1_i32_b32 s71, s70
 s_bitset0_b32 s70, s71
 s_cmp_ge_u32 s71, 16
 s_cselect_b32 s72, s78, s77
 s_cselect_b32 s73, 0x20000000, 0
 s_cselect_b32 s87, 536870912, 0
 s_mul_i32 s71, s71, 114688
 s_add_u32 s71, s71, s72
 buffer_load_dwordx4 v[232:235], v7, s[8:11], s71 offen sc1
 s_or_b32 s69, s69, s73
 s_or_b32 s71, s71, s87
 buffer_load_dwordx4 v[236:239], v27, s[8:11], s71 offen sc1
 s_waitcnt vmcnt(16)
 s_bitcmp0_b32 s69, 21
 s_cbranch_scc1 L_rx21
 v_dot2c_f32_bf16 v64, v168, v24
 v_dot2c_f32_bf16 v65, v168, v25
 v_dot2c_f32_bf16 v66, v169, v24
 v_dot2c_f32_bf16 v67, v169, v25
 v_dot2c_f32_bf16 v68, v170, v24
 v_dot2c_f32_bf16 v69, v170, v25
 v_dot2c_f32_bf16 v70, v171, v24
 v_dot2c_f32_bf16 v71, v171, v25
L_ry21:
 s_cmp_lg_u32 s70, 0
 s_cbranch_scc1 L_rk30
 s_call_b64 s[36:37], L_rpoll
L_rk30:
 s_ff1_i32_b32 s71, s70
 s_bitset0_b32 s70, s71
 s_cmp_ge_u32 s71, 16
 s_cselect_b32 s72, s78, s77
 s_cselect_b32 s73, 0x40000000, 0
 s_cselect_b32 s87, 536870912, 0
 s_mul_i32 s71, s71, 114688
 s_add_u32 s71, s71, s72
 buffer_load_dwordx4 v[240:243], v7, s[8:11], s71 offen sc1
 s_or_b32 s69, s69, s73
 s_or_b32 s71, s71, s87
 buffer_load_dwordx4 v[244:247], v27, s[8:11], s71 offen sc1
 s_waitcnt vmcnt(16)
 s_bitcmp0_b32 s69, 22
 s_cbranch_scc1 L_rx22
 v_dot2c_f32_bf16 v64, v176, v24
 v_dot2c_f32_bf16 v65, v176, v25
 v_dot2c_f32_bf16 v66, v177, v24
 v_dot2c_f32_bf16 v67, v177, v25
 v_dot2c_f32_bf16 v68, v178, v24
 v_dot2c_f32_bf16 v69, v178, v25
 v_dot2c_f32_bf16 v70, v179, v24
 v_dot2c_f32_bf16 v71, v179, v25
L_ry22:
 s_cmp_lg_u32 s70, 0
 s_cbranch_scc1 L_rk31
 s_call_b64 s[36:37], L_rpoll
L_rk31:
 s_ff1_i32_b32 s71, s70
 s_bitset0_b32 s70, s71
 s_cmp_ge_u32 s71, 16
 s_cselect_b32 s72, s78, s77
 s_cselect_b32 s73, 0x80000000, 0
 s_cselect_b32 s87, 536870912, 0
 s_mul_i32 s71, s71, 114688
 s_add_u32 s71, s71, s72
 buffer_load_dwordx4 v[248:251], v7, s[8:11], s71 offen sc1
 s_or_b32 s69, s69, s73
 s_or_b32 s71, s71, s87
 buffer_load_dwordx4 v[252:255], v27, s[8:11], s71 offen sc1
 s_waitcnt vmcnt(16)
 s_bitcmp0_b32 s69, 23
 s_cbranch_scc1 L_rx23
 v_dot2c_f32_bf16 v64, v184, v24
 v_dot2c_f32_bf16 v65, v184, v25
 v_dot2c_f32_bf16 v66, v185, v24
 v_dot2c_f32_bf16 v67, v185, v25
 v_dot2c_f32_bf16 v68, v186, v24
 v_dot2c_f32_bf16 v69, v186, v25
 v_dot2c_f32_bf16 v70, v187, v24
 v_dot2c_f32_bf16 v71, v187, v25
L_ry23:
 s_waitcnt vmcnt(14)
 s_bitcmp0_b32 s69, 24
 s_cbranch_scc1 L_rx24
 v_dot2c_f32_bf16 v64, v192, v24
 v_dot2c_f32_bf16 v65, v192, v25
 v_dot2c_f32_bf16 v66, v193, v24
 v_dot2c_f32_bf16 v67, v193, v25
 v_dot2c_f32_bf16 v68, v194, v24
 v_dot2c_f32_bf16 v69, v194, v25
 v_dot2c_f32_bf16 v70, v195, v24
 v_dot2c_f32_bf16 v71, v195, v25
L_ry24:
 s_waitcnt vmcnt(12)
 s_bitcmp0_b32 s69, 25
 s_cbranch_scc1 L_rx25
 v_dot2c_f32_bf16 v64, v200, v24
 v_dot2c_f32_bf16 v65, v200, v25
 v_dot2c_f32_bf16 v66, v201, v24
 v_dot2c_f32_bf16 v67, v201, v25
 v_dot2c_f32_bf16 v68, v202, v24
 v_dot2c_f32_bf16 v69, v202, v25
 v_dot2c_f32_bf16 v70, v203, v24
 v_dot2c_f32_bf16 v71, v203, v25
L_ry25:
 s_waitcnt vmcnt(10)
 s_bitcmp0_b32 s69, 26
 s_cbranch_scc1 L_rx26
 v_dot2c_f32_bf16 v64, v208, v24
 v_dot2c_f32_bf16 v65, v208, v25
 v_dot2c_f32_bf16 v66, v209, v24
 v_dot2c_f32_bf16 v67, v209, v25
 v_dot2c_f32_bf16 v68, v210, v24
 v_dot2c_f32_bf16 v69, v210, v25
 v_dot2c_f32_bf16 v70, v211, v24
 v_dot2c_f32_bf16 v71, v211, v25
L_ry26:
 s_waitcnt vmcnt(8)
 s_bitcmp0_b32 s69, 27
 s_cbranch_scc1 L_rx27
 v_dot2c_f32_bf16 v64, v216, v24
 v_dot2c_f32_bf16 v65, v216, v25
 v_dot2c_f32_bf16 v66, v217, v24
 v_dot2c_f32_bf16 v67, v217, v25
 v_dot2c_f32_bf16 v68, v218, v24
 v_dot2c_f32_bf16 v69, v218, v25
 v_dot2c_f32_bf16 v70, v219, v24
 v_dot2c_f32_bf16 v71, v219, v25
L_ry27:
 s_waitcnt vmcnt(6)
 s_bitcmp0_b32 s69, 28
 s_cbranch_scc1 L_rx28
 v_dot2c_f32_bf16 v64, v224, v24
 v_dot2c_f32_bf16 v65, v224, v25
 v_dot2c_f32_bf16 v66, v225, v24
 v_dot2c_f32_bf16 v67, v225, v25
 v_dot2c_f32_bf16 v68, v226, v24
 v_dot2c_f32_bf16 v69, v226, v25
 v_dot2c_f32_bf16 v70, v227, v24
 v_dot2c_f32_bf16 v71, v227, v25
L_ry28:
 s_waitcnt vmcnt(4)
 s_bitcmp0_b32 s69, 29
 s_cbranch_scc1 L_rx29
 v_dot2c_f32_bf16 v64, v232, v24
 v_dot2c_f32_bf16 v65, v232, v25
 v_dot2c_f32_bf16 v66, v233, v24
 v_dot2c_f32_bf16 v67, v233, v25
 v_dot2c_f32_bf16 v68, v234, v24
 v_dot2c_f32_bf16 v69, v234, v25
 v_dot2c_f32_bf16 v70, v235, v24
 v_dot2c_f32_bf16 v71, v235, v25
L_ry29:
 s_waitcnt vmcnt(2)
 s_bitcmp0_b32 s69, 30
 s_cbranch_scc1 L_rx30
 v_dot2c_f32_bf16 v64, v240, v24
 v_dot2c_f32_bf16 v65, v240, v25
 v_dot2c_f32_bf16 v66, v241, v24
 v_dot2c_f32_bf16 v67, v241, v25
 v_dot2c_f32_bf16 v68, v242, v24
 v_dot2c_f32_bf16 v69, v242, v25
 v_dot2c_f32_bf16 v70, v243, v24
 v_dot2c_f32_bf16 v71, v243, v25
L_ry30:
 s_waitcnt vmcnt(0)
 s_bitcmp0_b32 s69, 31
 s_cbranch_scc1 L_rx31
 v_dot2c_f32_bf16 v64, v248, v24
 v_dot2c_f32_bf16 v65, v248, v25
 v_dot2c_f32_bf16 v66, v249, v24
 v_dot2c_f32_bf16 v67, v249, v25
 v_dot2c_f32_bf16 v68, v250, v24
 v_dot2c_f32_bf16 v69, v250, v25
 v_dot2c_f32_bf16 v70, v251, v24
 v_dot2c_f32_bf16 v71, v251, v25
L_ry31:
 s_nop 1
 v_fmac_f32 v80, v26, v64
 v_fmac_f32 v81, v26, v65
 v_fmac_f32 v82, v26, v66
 v_fmac_f32 v83, v26, v67
 v_fmac_f32 v84, v26, v68
 v_fmac_f32 v85, v26, v69
 v_fmac_f32 v86, v26, v70
 v_fmac_f32 v87, v26, v71
 v_cvt_pk_bf16_f32 v96, v80, v81
 v_cvt_pk_bf16_f32 v97, v82, v83
 v_cvt_pk_bf16_f32 v98, v84, v85
 v_cvt_pk_bf16_f32 v99, v86, v87
 buffer_store_dwordx4 v[96:99], v28, s[52:55], s86 offen sc1
 s_cmp_eq_u32 s66, 1
 s_cbranch_scc1 L_rdone
 v_fmac_f32 v32, v15, v48
 v_fmac_f32 v33, v15, v49
 v_fmac_f32 v34, v15, v50
 v_fmac_f32 v35, v15, v51
 v_fmac_f32 v36, v15, v52
 v_fmac_f32 v37, v15, v53
 v_fmac_f32 v38, v15, v54
 v_fmac_f32 v39, v15, v55
 v_cvt_pk_bf16_f32 v16, v32, v33
 v_cvt_pk_bf16_f32 v17, v34, v35
 v_cvt_pk_bf16_f32 v18, v36, v37
 v_cvt_pk_bf16_f32 v19, v38, v39
 buffer_store_dwordx4 v[16:19], v12, s[52:55], s75 offen sc1
 v_fmac_f32 v40, v15, v56
 v_fmac_f32 v41, v15, v57
 v_fmac_f32 v42, v15, v58
 v_fmac_f32 v43, v15, v59
 v_fmac_f32 v44, v15, v60
 v_fmac_f32 v45, v15, v61
 v_fmac_f32 v46, v15, v62
 v_fmac_f32 v47, v15, v63
 v_cvt_pk_bf16_f32 v20, v40, v41
 v_cvt_pk_bf16_f32 v21, v42, v43
 v_cvt_pk_bf16_f32 v22, v44, v45
 v_cvt_pk_bf16_f32 v23, v46, v47
 buffer_store_dwordx4 v[20:23], v12, s[52:55], s76 offen sc1
L_rdone:
 s_endpgm
L_rx0:
 v_dot2c_f32_bf16 v64, v128, v24
 v_dot2c_f32_bf16 v65, v128, v25
 v_dot2c_f32_bf16 v66, v129, v24
 v_dot2c_f32_bf16 v67, v129, v25
 v_dot2c_f32_bf16 v68, v130, v24
 v_dot2c_f32_bf16 v69, v130, v25
 v_dot2c_f32_bf16 v70, v131, v24
 v_dot2c_f32_bf16 v71, v131, v25
 s_branch L_ry0
L_rx1:
 v_dot2c_f32_bf16 v64, v136, v24
 v_dot2c_f32_bf16 v65, v136, v25
 v_dot2c_f32_bf16 v66, v137, v24
 v_dot2c_f32_bf16 v67, v137, v25
 v_dot2c_f32_bf16 v68, v138, v24
 v_dot2c_f32_bf16 v69, v138, v25
 v_dot2c_f32_bf16 v70, v139, v24
 v_dot2c_f32_bf16 v71, v139, v25
 s_branch L_ry1
L_rx2:
 v_dot2c_f32_bf16 v64, v144, v24
 v_dot2c_f32_bf16 v65, v144, v25
 v_dot2c_f32_bf16 v66, v145, v24
 v_dot2c_f32_bf16 v67, v145, v25
 v_dot2c_f32_bf16 v68, v146, v24
 v_dot2c_f32_bf16 v69, v146, v25
 v_dot2c_f32_bf16 v70, v147, v24
 v_dot2c_f32_bf16 v71, v147, v25
 s_branch L_ry2
L_rx3:
 v_dot2c_f32_bf16 v64, v152, v24
 v_dot2c_f32_bf16 v65, v152, v25
 v_dot2c_f32_bf16 v66, v153, v24
 v_dot2c_f32_bf16 v67, v153, v25
 v_dot2c_f32_bf16 v68, v154, v24
 v_dot2c_f32_bf16 v69, v154, v25
 v_dot2c_f32_bf16 v70, v155, v24
 v_dot2c_f32_bf16 v71, v155, v25
 s_branch L_ry3
L_rx4:
 v_dot2c_f32_bf16 v64, v160, v24
 v_dot2c_f32_bf16 v65, v160, v25
 v_dot2c_f32_bf16 v66, v161, v24
 v_dot2c_f32_bf16 v67, v161, v25
 v_dot2c_f32_bf16 v68, v162, v24
 v_dot2c_f32_bf16 v69, v162, v25
 v_dot2c_f32_bf16 v70, v163, v24
 v_dot2c_f32_bf16 v71, v163, v25
 s_branch L_ry4
L_rx5:
 v_dot2c_f32_bf16 v64, v168, v24
 v_dot2c_f32_bf16 v65, v168, v25
 v_dot2c_f32_bf16 v66, v169, v24
 v_dot2c_f32_bf16 v67, v169, v25
 v_dot2c_f32_bf16 v68, v170, v24
 v_dot2c_f32_bf16 v69, v170, v25
 v_dot2c_f32_bf16 v70, v171, v24
 v_dot2c_f32_bf16 v71, v171, v25
 s_branch L_ry5
L_rx6:
 v_dot2c_f32_bf16 v64, v176, v24
 v_dot2c_f32_bf16 v65, v176, v25
 v_dot2c_f32_bf16 v66, v177, v24
 v_dot2c_f32_bf16 v67, v177, v25
 v_dot2c_f32_bf16 v68, v178, v24
 v_dot2c_f32_bf16 v69, v178, v25
 v_dot2c_f32_bf16 v70, v179, v24
 v_dot2c_f32_bf16 v71, v179, v25
 s_branch L_ry6
L_rx7:
 v_dot2c_f32_bf16 v64, v184, v24
 v_dot2c_f32_bf16 v65, v184, v25
 v_dot2c_f32_bf16 v66, v185, v24
 v_dot2c_f32_bf16 v67, v185, v25
 v_dot2c_f32_bf16 v68, v186, v24
 v_dot2c_f32_bf16 v69, v186, v25
 v_dot2c_f32_bf16 v70, v187, v24
 v_dot2c_f32_bf16 v71, v187, v25
 s_branch L_ry7
L_rx8:
 v_dot2c_f32_bf16 v64, v192, v24
 v_dot2c_f32_bf16 v65, v192, v25
 v_dot2c_f32_bf16 v66, v193, v24
 v_dot2c_f32_bf16 v67, v193, v25
 v_dot2c_f32_bf16 v68, v194, v24
 v_dot2c_f32_bf16 v69, v194, v25
 v_dot2c_f32_bf16 v70, v195, v24
 v_dot2c_f32_bf16 v71, v195, v25
 s_branch L_ry8
L_rx9:
 v_dot2c_f32_bf16 v64, v200, v24
 v_dot2c_f32_bf16 v65, v200, v25
 v_dot2c_f32_bf16 v66, v201, v24
 v_dot2c_f32_bf16 v67, v201, v25
 v_dot2c_f32_bf16 v68, v202, v24
 v_dot2c_f32_bf16 v69, v202, v25
 v_dot2c_f32_bf16 v70, v203, v24
 v_dot2c_f32_bf16 v71, v203, v25
 s_branch L_ry9
L_rx10:
 v_dot2c_f32_bf16 v64, v208, v24
 v_dot2c_f32_bf16 v65, v208, v25
 v_dot2c_f32_bf16 v66, v209, v24
 v_dot2c_f32_bf16 v67, v209, v25
 v_dot2c_f32_bf16 v68, v210, v24
 v_dot2c_f32_bf16 v69, v210, v25
 v_dot2c_f32_bf16 v70, v211, v24
 v_dot2c_f32_bf16 v71, v211, v25
 s_branch L_ry10
L_rx11:
 v_dot2c_f32_bf16 v64, v216, v24
 v_dot2c_f32_bf16 v65, v216, v25
 v_dot2c_f32_bf16 v66, v217, v24
 v_dot2c_f32_bf16 v67, v217, v25
 v_dot2c_f32_bf16 v68, v218, v24
 v_dot2c_f32_bf16 v69, v218, v25
 v_dot2c_f32_bf16 v70, v219, v24
 v_dot2c_f32_bf16 v71, v219, v25
 s_branch L_ry11
L_rx12:
 v_dot2c_f32_bf16 v64, v224, v24
 v_dot2c_f32_bf16 v65, v224, v25
 v_dot2c_f32_bf16 v66, v225, v24
 v_dot2c_f32_bf16 v67, v225, v25
 v_dot2c_f32_bf16 v68, v226, v24
 v_dot2c_f32_bf16 v69, v226, v25
 v_dot2c_f32_bf16 v70, v227, v24
 v_dot2c_f32_bf16 v71, v227, v25
 s_branch L_ry12
L_rx13:
 v_dot2c_f32_bf16 v64, v232, v24
 v_dot2c_f32_bf16 v65, v232, v25
 v_dot2c_f32_bf16 v66, v233, v24
 v_dot2c_f32_bf16 v67, v233, v25
 v_dot2c_f32_bf16 v68, v234, v24
 v_dot2c_f32_bf16 v69, v234, v25
 v_dot2c_f32_bf16 v70, v235, v24
 v_dot2c_f32_bf16 v71, v235, v25
 s_branch L_ry13
L_rx14:
 v_dot2c_f32_bf16 v64, v240, v24
 v_dot2c_f32_bf16 v65, v240, v25
 v_dot2c_f32_bf16 v66, v241, v24
 v_dot2c_f32_bf16 v67, v241, v25
 v_dot2c_f32_bf16 v68, v242, v24
 v_dot2c_f32_bf16 v69, v242, v25
 v_dot2c_f32_bf16 v70, v243, v24
 v_dot2c_f32_bf16 v71, v243, v25
 s_branch L_ry14
L_rx15:
 v_dot2c_f32_bf16 v64, v248, v24
 v_dot2c_f32_bf16 v65, v248, v25
 v_dot2c_f32_bf16 v66, v249, v24
 v_dot2c_f32_bf16 v67, v249, v25
 v_dot2c_f32_bf16 v68, v250, v24
 v_dot2c_f32_bf16 v69, v250, v25
 v_dot2c_f32_bf16 v70, v251, v24
 v_dot2c_f32_bf16 v71, v251, v25
 s_branch L_ry15
L_rx16:
 v_dot2c_f32_bf16 v48, v128, v24
 v_dot2c_f32_bf16 v49, v128, v25
 v_dot2c_f32_bf16 v50, v129, v24
 v_dot2c_f32_bf16 v51, v129, v25
 v_dot2c_f32_bf16 v52, v130, v24
 v_dot2c_f32_bf16 v53, v130, v25
 v_dot2c_f32_bf16 v54, v131, v24
 v_dot2c_f32_bf16 v55, v131, v25
 v_dot2c_f32_bf16 v56, v132, v24
 v_dot2c_f32_bf16 v57, v132, v25
 v_dot2c_f32_bf16 v58, v133, v24
 v_dot2c_f32_bf16 v59, v133, v25
 v_dot2c_f32_bf16 v60, v134, v24
 v_dot2c_f32_bf16 v61, v134, v25
 v_dot2c_f32_bf16 v62, v135, v24
 v_dot2c_f32_bf16 v63, v135, v25
 s_branch L_ry16
L_rx17:
 v_dot2c_f32_bf16 v48, v136, v24
 v_dot2c_f32_bf16 v49, v136, v25
 v_dot2c_f32_bf16 v50, v137, v24
 v_dot2c_f32_bf16 v51, v137, v25
 v_dot2c_f32_bf16 v52, v138, v24
 v_dot2c_f32_bf16 v53, v138, v25
 v_dot2c_f32_bf16 v54, v139, v24
 v_dot2c_f32_bf16 v55, v139, v25
 v_dot2c_f32_bf16 v56, v140, v24
 v_dot2c_f32_bf16 v57, v140, v25
 v_dot2c_f32_bf16 v58, v141, v24
 v_dot2c_f32_bf16 v59, v141, v25
 v_dot2c_f32_bf16 v60, v142, v24
 v_dot2c_f32_bf16 v61, v142, v25
 v_dot2c_f32_bf16 v62, v143, v24
 v_dot2c_f32_bf16 v63, v143, v25
 s_branch L_ry17
L_rx18:
 v_dot2c_f32_bf16 v48, v144, v24
 v_dot2c_f32_bf16 v49, v144, v25
 v_dot2c_f32_bf16 v50, v145, v24
 v_dot2c_f32_bf16 v51, v145, v25
 v_dot2c_f32_bf16 v52, v146, v24
 v_dot2c_f32_bf16 v53, v146, v25
 v_dot2c_f32_bf16 v54, v147, v24
 v_dot2c_f32_bf16 v55, v147, v25
 v_dot2c_f32_bf16 v56, v148, v24
 v_dot2c_f32_bf16 v57, v148, v25
 v_dot2c_f32_bf16 v58, v149, v24
 v_dot2c_f32_bf16 v59, v149, v25
 v_dot2c_f32_bf16 v60, v150, v24
 v_dot2c_f32_bf16 v61, v150, v25
 v_dot2c_f32_bf16 v62, v151, v24
 v_dot2c_f32_bf16 v63, v151, v25
 s_branch L_ry18
L_rx19:
 v_dot2c_f32_bf16 v48, v152, v24
 v_dot2c_f32_bf16 v49, v152, v25
 v_dot2c_f32_bf16 v50, v153, v24
 v_dot2c_f32_bf16 v51, v153, v25
 v_dot2c_f32_bf16 v52, v154, v24
 v_dot2c_f32_bf16 v53, v154, v25
 v_dot2c_f32_bf16 v54, v155, v24
 v_dot2c_f32_bf16 v55, v155, v25
 v_dot2c_f32_bf16 v56, v156, v24
 v_dot2c_f32_bf16 v57, v156, v25
 v_dot2c_f32_bf16 v58, v157, v24
 v_dot2c_f32_bf16 v59, v157, v25
 v_dot2c_f32_bf16 v60, v158, v24
 v_dot2c_f32_bf16 v61, v158, v25
 v_dot2c_f32_bf16 v62, v159, v24
 v_dot2c_f32_bf16 v63, v159, v25
 s_branch L_ry19
L_rx20:
 v_dot2c_f32_bf16 v48, v160, v24
 v_dot2c_f32_bf16 v49, v160, v25
 v_dot2c_f32_bf16 v50, v161, v24
 v_dot2c_f32_bf16 v51, v161, v25
 v_dot2c_f32_bf16 v52, v162, v24
 v_dot2c_f32_bf16 v53, v162, v25
 v_dot2c_f32_bf16 v54, v163, v24
 v_dot2c_f32_bf16 v55, v163, v25
 v_dot2c_f32_bf16 v56, v164, v24
 v_dot2c_f32_bf16 v57, v164, v25
 v_dot2c_f32_bf16 v58, v165, v24
 v_dot2c_f32_bf16 v59, v165, v25
 v_dot2c_f32_bf16 v60, v166, v24
 v_dot2c_f32_bf16 v61, v166, v25
 v_dot2c_f32_bf16 v62, v167, v24
 v_dot2c_f32_bf16 v63, v167, v25
 s_branch L_ry20
L_rx21:
 v_dot2c_f32_bf16 v48, v168, v24
 v_dot2c_f32_bf16 v49, v168, v25
 v_dot2c_f32_bf16 v50, v169, v24
 v_dot2c_f32_bf16 v51, v169, v25
 v_dot2c_f32_bf16 v52, v170, v24
 v_dot2c_f32_bf16 v53, v170, v25
 v_dot2c_f32_bf16 v54, v171, v24
 v_dot2c_f32_bf16 v55, v171, v25
 v_dot2c_f32_bf16 v56, v172, v24
 v_dot2c_f32_bf16 v57, v172, v25
 v_dot2c_f32_bf16 v58, v173, v24
 v_dot2c_f32_bf16 v59, v173, v25
 v_dot2c_f32_bf16 v60, v174, v24
 v_dot2c_f32_bf16 v61, v174, v25
 v_dot2c_f32_bf16 v62, v175, v24
 v_dot2c_f32_bf16 v63, v175, v25
 s_branch L_ry21
L_rx22:
 v_dot2c_f32_bf16 v48, v176, v24
 v_dot2c_f32_bf16 v49, v176, v25
 v_dot2c_f32_bf16 v50, v177, v24
 v_dot2c_f32_bf16 v51, v177, v25
 v_dot2c_f32_bf16 v52, v178, v24
 v_dot2c_f32_bf16 v53, v178, v25
 v_dot2c_f32_bf16 v54, v179, v24
 v_dot2c_f32_bf16 v55, v179, v25
 v_dot2c_f32_bf16 v56, v180, v24
 v_dot2c_f32_bf16 v57, v180, v25
 v_dot2c_f32_bf16 v58, v181, v24
 v_dot2c_f32_bf16 v59, v181, v25
 v_dot2c_f32_bf16 v60, v182, v24
 v_dot2c_f32_bf16 v61, v182, v25
 v_dot2c_f32_bf16 v62, v183, v24
 v_dot2c_f32_bf16 v63, v183, v25
 s_branch L_ry22
L_rx23:
 v_dot2c_f32_bf16 v48, v184, v24
 v_dot2c_f32_bf16 v49, v184, v25
 v_dot2c_f32_bf16 v50, v185, v24
 v_dot2c_f32_bf16 v51, v185, v25
 v_dot2c_f32_bf16 v52, v186, v24
 v_dot2c_f32_bf16 v53, v186, v25
 v_dot2c_f32_bf16 v54, v187, v24
 v_dot2c_f32_bf16 v55, v187, v25
 v_dot2c_f32_bf16 v56, v188, v24
 v_dot2c_f32_bf16 v57, v188, v25
 v_dot2c_f32_bf16 v58, v189, v24
 v_dot2c_f32_bf16 v59, v189, v25
 v_dot2c_f32_bf16 v60, v190, v24
 v_dot2c_f32_bf16 v61, v190, v25
 v_dot2c_f32_bf16 v62, v191, v24
 v_dot2c_f32_bf16 v63, v191, v25
 s_branch L_ry23
L_rx24:
 v_dot2c_f32_bf16 v48, v192, v24
 v_dot2c_f32_bf16 v49, v192, v25
 v_dot2c_f32_bf16 v50, v193, v24
 v_dot2c_f32_bf16 v51, v193, v25
 v_dot2c_f32_bf16 v52, v194, v24
 v_dot2c_f32_bf16 v53, v194, v25
 v_dot2c_f32_bf16 v54, v195, v24
 v_dot2c_f32_bf16 v55, v195, v25
 v_dot2c_f32_bf16 v56, v196, v24
 v_dot2c_f32_bf16 v57, v196, v25
 v_dot2c_f32_bf16 v58, v197, v24
 v_dot2c_f32_bf16 v59, v197, v25
 v_dot2c_f32_bf16 v60, v198, v24
 v_dot2c_f32_bf16 v61, v198, v25
 v_dot2c_f32_bf16 v62, v199, v24
 v_dot2c_f32_bf16 v63, v199, v25
 s_branch L_ry24
L_rx25:
 v_dot2c_f32_bf16 v48, v200, v24
 v_dot2c_f32_bf16 v49, v200, v25
 v_dot2c_f32_bf16 v50, v201, v24
 v_dot2c_f32_bf16 v51, v201, v25
 v_dot2c_f32_bf16 v52, v202, v24
 v_dot2c_f32_bf16 v53, v202, v25
 v_dot2c_f32_bf16 v54, v203, v24
 v_dot2c_f32_bf16 v55, v203, v25
 v_dot2c_f32_bf16 v56, v204, v24
 v_dot2c_f32_bf16 v57, v204, v25
 v_dot2c_f32_bf16 v58, v205, v24
 v_dot2c_f32_bf16 v59, v205, v25
 v_dot2c_f32_bf16 v60, v206, v24
 v_dot2c_f32_bf16 v61, v206, v25
 v_dot2c_f32_bf16 v62, v207, v24
 v_dot2c_f32_bf16 v63, v207, v25
 s_branch L_ry25
L_rx26:
 v_dot2c_f32_bf16 v48, v208, v24
 v_dot2c_f32_bf16 v49, v208, v25
 v_dot2c_f32_bf16 v50, v209, v24
 v_dot2c_f32_bf16 v51, v209, v25
 v_dot2c_f32_bf16 v52, v210, v24
 v_dot2c_f32_bf16 v53, v210, v25
 v_dot2c_f32_bf16 v54, v211, v24
 v_dot2c_f32_bf16 v55, v211, v25
 v_dot2c_f32_bf16 v56, v212, v24
 v_dot2c_f32_bf16 v57, v212, v25
 v_dot2c_f32_bf16 v58, v213, v24
 v_dot2c_f32_bf16 v59, v213, v25
 v_dot2c_f32_bf16 v60, v214, v24
 v_dot2c_f32_bf16 v61, v214, v25
 v_dot2c_f32_bf16 v62, v215, v24
 v_dot2c_f32_bf16 v63, v215, v25
 s_branch L_ry26
L_rx27:
 v_dot2c_f32_bf16 v48, v216, v24
 v_dot2c_f32_bf16 v49, v216, v25
 v_dot2c_f32_bf16 v50, v217, v24
 v_dot2c_f32_bf16 v51, v217, v25
 v_dot2c_f32_bf16 v52, v218, v24
 v_dot2c_f32_bf16 v53, v218, v25
 v_dot2c_f32_bf16 v54, v219, v24
 v_dot2c_f32_bf16 v55, v219, v25
 v_dot2c_f32_bf16 v56, v220, v24
 v_dot2c_f32_bf16 v57, v220, v25
 v_dot2c_f32_bf16 v58, v221, v24
 v_dot2c_f32_bf16 v59, v221, v25
 v_dot2c_f32_bf16 v60, v222, v24
 v_dot2c_f32_bf16 v61, v222, v25
 v_dot2c_f32_bf16 v62, v223, v24
 v_dot2c_f32_bf16 v63, v223, v25
 s_branch L_ry27
L_rx28:
 v_dot2c_f32_bf16 v48, v224, v24
 v_dot2c_f32_bf16 v49, v224, v25
 v_dot2c_f32_bf16 v50, v225, v24
 v_dot2c_f32_bf16 v51, v225, v25
 v_dot2c_f32_bf16 v52, v226, v24
 v_dot2c_f32_bf16 v53, v226, v25
 v_dot2c_f32_bf16 v54, v227, v24
 v_dot2c_f32_bf16 v55, v227, v25
 v_dot2c_f32_bf16 v56, v228, v24
 v_dot2c_f32_bf16 v57, v228, v25
 v_dot2c_f32_bf16 v58, v229, v24
 v_dot2c_f32_bf16 v59, v229, v25
 v_dot2c_f32_bf16 v60, v230, v24
 v_dot2c_f32_bf16 v61, v230, v25
 v_dot2c_f32_bf16 v62, v231, v24
 v_dot2c_f32_bf16 v63, v231, v25
 s_branch L_ry28
L_rx29:
 v_dot2c_f32_bf16 v48, v232, v24
 v_dot2c_f32_bf16 v49, v232, v25
 v_dot2c_f32_bf16 v50, v233, v24
 v_dot2c_f32_bf16 v51, v233, v25
 v_dot2c_f32_bf16 v52, v234, v24
 v_dot2c_f32_bf16 v53, v234, v25
 v_dot2c_f32_bf16 v54, v235, v24
 v_dot2c_f32_bf16 v55, v235, v25
 v_dot2c_f32_bf16 v56, v236, v24
 v_dot2c_f32_bf16 v57, v236, v25
 v_dot2c_f32_bf16 v58, v237, v24
 v_dot2c_f32_bf16 v59, v237, v25
 v_dot2c_f32_bf16 v60, v238, v24
 v_dot2c_f32_bf16 v61, v238, v25
 v_dot2c_f32_bf16 v62, v239, v24
 v_dot2c_f32_bf16 v63, v239, v25
 s_branch L_ry29
L_rx30:
 v_dot2c_f32_bf16 v48, v240, v24
 v_dot2c_f32_bf16 v49, v240, v25
 v_dot2c_f32_bf16 v50, v241, v24
 v_dot2c_f32_bf16 v51, v241, v25
 v_dot2c_f32_bf16 v52, v242, v24
 v_dot2c_f32_bf16 v53, v242, v25
 v_dot2c_f32_bf16 v54, v243, v24
 v_dot2c_f32_bf16 v55, v243, v25
 v_dot2c_f32_bf16 v56, v244, v24
 v_dot2c_f32_bf16 v57, v244, v25
 v_dot2c_f32_bf16 v58, v245, v24
 v_dot2c_f32_bf16 v59, v245, v25
 v_dot2c_f32_bf16 v60, v246, v24
 v_dot2c_f32_bf16 v61, v246, v25
 v_dot2c_f32_bf16 v62, v247, v24
 v_dot2c_f32_bf16 v63, v247, v25
 s_branch L_ry30
L_rx31:
 v_dot2c_f32_bf16 v48, v248, v24
 v_dot2c_f32_bf16 v49, v248, v25
 v_dot2c_f32_bf16 v50, v249, v24
 v_dot2c_f32_bf16 v51, v249, v25
 v_dot2c_f32_bf16 v52, v250, v24
 v_dot2c_f32_bf16 v53, v250, v25
 v_dot2c_f32_bf16 v54, v251, v24
 v_dot2c_f32_bf16 v55, v251, v25
 v_dot2c_f32_bf16 v56, v252, v24
 v_dot2c_f32_bf16 v57, v252, v25
 v_dot2c_f32_bf16 v58, v253, v24
 v_dot2c_f32_bf16 v59, v253, v25
 v_dot2c_f32_bf16 v60, v254, v24
 v_dot2c_f32_bf16 v61, v254, v25
 v_dot2c_f32_bf16 v62, v255, v24
 v_dot2c_f32_bf16 v63, v255, v25
 s_branch L_ry31
L_rpoll0:
 s_sleep 1
L_rpoll:
 buffer_load_dword v9, v14, s[8:11], s46 offen sc1
 s_waitcnt vmcnt(0)
 v_cmp_eq_u32 vcc, 1, v9
 s_sub_u32 s91, s91, 1
 s_cselect_b32 s70, -1, 0
 s_or_b32 s70, s70, vcc_lo
 s_andn2_b32 s70, s70, s68
 s_cbranch_scc0 L_rpoll0
 s_or_b32 s68, s68, s70
 s_setpc_b64 s[36:37]
L_comb:
 buffer_load_dwordx4 v[14:17], v7, s[8:11], s52 offen sc1
 s_waitcnt vmcnt(0)
 s_nop 7
 v_sub_f32 v10, v32, v14
 v_sub_f32 v11, v36, v15
 v_max_f32 v10, 0, v10
 v_max_f32 v11, 0, v11
 v_sub_f32 v100, v100, v11
 v_sub_f32 v101, v101, v11
 v_sub_f32 v102, v102, v11
 v_sub_f32 v103, v103, v11
 v_sub_f32 v108, v108, v11
 v_sub_f32 v109, v109, v11
 v_sub_f32 v110, v110, v11
 v_sub_f32 v111, v111, v11
 v_sub_f32 v116, v116, v11
 v_sub_f32 v117, v117, v11
 v_sub_f32 v118, v118, v11
 v_sub_f32 v119, v119, v11
 v_sub_f32 v124, v124, v11
 v_sub_f32 v125, v125, v11
 v_sub_f32 v126, v126, v11
 v_sub_f32 v127, v127, v11
 v_sub_f32 v64, v64, v10
 v_sub_f32 v65, v65, v10
 v_sub_f32 v66, v66, v10
 v_sub_f32 v67, v67, v10
 v_sub_f32 v68, v68, v11
 v_sub_f32 v69, v69, v11
 v_sub_f32 v70, v70, v11
 v_sub_f32 v71, v71, v11
 v_sub_f32 v72, v72, v10
 v_sub_f32 v73, v73, v10
 v_sub_f32 v74, v74, v10
 v_sub_f32 v75, v75, v10
 v_sub_f32 v76, v76, v11
 v_sub_f32 v77, v77, v11
 v_sub_f32 v78, v78, v11
 v_sub_f32 v79, v79, v11
 v_sub_f32 v80, v80, v10
 v_sub_f32 v81, v81, v10
 v_sub_f32 v82, v82, v10
 v_sub_f32 v83, v83, v10
 v_sub_f32 v84, v84, v11
 v_sub_f32 v85, v85, v11
 v_sub_f32 v86, v86, v11
 v_sub_f32 v87, v87, v11
 v_sub_f32 v88, v88, v10
 v_sub_f32 v89, v89, v10
 v_sub_f32 v90, v90, v10
 v_sub_f32 v91, v91, v10
 v_sub_f32 v92, v92, v11
 v_sub_f32 v93, v93, v11
 v_sub_f32 v94, v94, v11
 v_sub_f32 v95, v95, v11
 v_sub_f32 v32, v32, v10
 v_sub_f32 v33, v33, v10
 v_sub_f32 v34, v34, v10
 v_sub_f32 v35, v35, v10
 v_sub_f32 v36, v36, v11
 v_sub_f32 v37, v37, v11
 v_sub_f32 v38, v38, v11
 v_sub_f32 v39, v39, v11
 v_exp_f32 v12, -v10
 v_exp_f32 v13, -v11
 v_mul_f32 v30, v12, v30
 v_mul_f32 v31, v13, v31
 v_mul_f32 v128, v12, v128
 v_mul_f32 v129, v12, v129
 v_mul_f32 v130, v12, v130
 v_mul_f32 v131, v12, v131
 v_mul_f32 v132, v13, v132
 v_mul_f32 v133, v13, v133
 v_mul_f32 v134, v13, v134
 v_mul_f32 v135, v13, v135
 v_mul_f32 v136, v12, v136
 v_mul_f32 v137, v12, v137
 v_mul_f32 v138, v12, v138
 v_mul_f32 v139, v12, v139
 v_mul_f32 v140, v13, v140
 v_mul_f32 v141, v13, v141
 v_mul_f32 v142, v13, v142
 v_mul_f32 v143, v13, v143
 v_mul_f32 v144, v12, v144
 v_mul_f32 v145, v12, v145
 v_mul_f32 v146, v12, v146
 v_mul_f32 v147, v12, v147
 v_mul_f32 v148, v13, v148
 v_mul_f32 v149, v13, v149
 v_mul_f32 v150, v13, v150
 v_mul_f32 v151, v13, v151
 v_mul_f32 v152, v12, v152
 v_mul_f32 v153, v12, v153
 v_mul_f32 v154, v12, v154
 v_mul_f32 v155, v12, v155
 v_mul_f32 v156, v13, v156
 v_mul_f32 v157, v13, v157
 v_mul_f32 v158, v13, v158
 v_mul_f32 v159, v13, v159
 v_mul_f32 v160, v12, v160
 v_mul_f32 v161, v12, v161
 v_mul_f32 v162, v12, v162
 v_mul_f32 v163, v12, v163
 v_mul_f32 v164, v13, v164
 v_mul_f32 v165, v13, v165
 v_mul_f32 v166, v13, v166
 v_mul_f32 v167, v13, v167
 v_mul_f32 v168, v12, v168
 v_mul_f32 v169, v12, v169
 v_mul_f32 v170, v12, v170
 v_mul_f32 v171, v12, v171
 v_mul_f32 v172, v13, v172
 v_mul_f32 v173, v13, v173
 v_mul_f32 v174, v13, v174
 v_mul_f32 v175, v13, v175
 v_mul_f32 v176, v12, v176
 v_mul_f32 v177, v12, v177
 v_mul_f32 v178, v12, v178
 v_mul_f32 v179, v12, v179
 v_mul_f32 v180, v13, v180
 v_mul_f32 v181, v13, v181
 v_mul_f32 v182, v13, v182
 v_mul_f32 v183, v13, v183
 v_mul_f32 v184, v12, v184
 v_mul_f32 v185, v12, v185
 v_mul_f32 v186, v12, v186
 v_mul_f32 v187, v12, v187
 v_mul_f32 v188, v13, v188
 v_mul_f32 v189, v13, v189
 v_mul_f32 v190, v13, v190
 v_mul_f32 v191, v13, v191
 v_mul_f32 v192, v12, v192
 v_mul_f32 v193, v12, v193
 v_mul_f32 v194, v12, v194
 v_mul_f32 v195, v12, v195
 v_mul_f32 v196, v13, v196
 v_mul_f32 v197, v13, v197
 v_mul_f32 v198, v13, v198
 v_mul_f32 v199, v13, v199
 v_mul_f32 v200, v12, v200
 v_mul_f32 v201, v12, v201
 v_mul_f32 v202, v12, v202
 v_mul_f32 v203, v12, v203
 v_mul_f32 v204, v13, v204
 v_mul_f32 v205, v13, v205
 v_mul_f32 v206, v13, v206
 v_mul_f32 v207, v13, v207
 v_mul_f32 v208, v12, v208
 v_mul_f32 v209, v12, v209
 v_mul_f32 v210, v12, v210
 v_mul_f32 v211, v12, v211
 v_mul_f32 v212, v13, v212
 v_mul_f32 v213, v13, v213
 v_mul_f32 v214, v13, v214
 v_mul_f32 v215, v13, v215
 v_mul_f32 v216, v12, v216
 v_mul_f32 v217, v12, v217
 v_mul_f32 v218, v12, v218
 v_mul_f32 v219, v12, v219
 v_mul_f32 v220, v13, v220
 v_mul_f32 v221, v13, v221
 v_mul_f32 v222, v13, v222
 v_mul_f32 v223, v13, v223
 v_mul_f32 v224, v12, v224
 v_mul_f32 v225, v12, v225
 v_mul_f32 v226, v12, v226
 v_mul_f32 v227, v12, v227
 v_mul_f32 v228, v13, v228
 v_mul_f32 v229, v13, v229
 v_mul_f32 v230, v13, v230
 v_mul_f32 v231, v13, v231
 v_mul_f32 v232, v12, v232
 v_mul_f32 v233, v12, v233
 v_mul_f32 v234, v12, v234
 v_mul_f32 v235, v12, v235
 v_mul_f32 v236, v13, v236
 v_mul_f32 v237, v13, v237
 v_mul_f32 v238, v13, v238
 v_mul_f32 v239, v13, v239
 v_mul_f32 v240, v12, v240
 v_mul_f32 v241, v12, v241
 v_mul_f32 v242, v12, v242
 v_mul_f32 v243, v12, v243
 v_mul_f32 v244, v13, v244
 v_mul_f32 v245, v13, v245
 v_mul_f32 v246, v13, v246
 v_mul_f32 v247, v13, v247
 v_mul_f32 v248, v12, v248
 v_mul_f32 v249, v12, v249
 v_mul_f32 v250, v12, v250
 v_mul_f32 v251, v12, v251
 v_mul_f32 v252, v13, v252
 v_mul_f32 v253, v13, v253
 v_mul_f32 v254, v13, v254
 v_mul_f32 v255, v13, v255
 v_exp_f32 v18, v64
 v_exp_f32 v19, v65
 v_exp_f32 v20, v66
 v_add_f32 v26, v18, v19
 v_cvt_pk_bf16_f32 v40, v18, v19
 v_exp_f32 v21, v67
 v_exp_f32 v22, v72
 v_add_f32 v26, v20, v26
 v_cvt_pk_bf16_f32 v41, v20, v21
 v_exp_f32 v23, v73
 v_add_f32 v26, v21, v26
 v_exp_f32 v24, v74
 v_add_f32 v26, v22, v26
 v_cvt_pk_bf16_f32 v42, v22, v23
 v_exp_f32 v25, v75
 v_add_f32 v26, v23, v26
 v_exp_f32 v18, v68
 v_add_f32 v26, v24, v26
 v_cvt_pk_bf16_f32 v43, v24, v25
 v_exp_f32 v19, v69
 v_add_f32 v26, v25, v26
 v_exp_f32 v20, v70
 v_add_f32 v27, v18, v19
 v_cvt_pk_bf16_f32 v44, v18, v19
 v_exp_f32 v21, v71
 v_exp_f32 v22, v76
 v_add_f32 v27, v20, v27
 v_cvt_pk_bf16_f32 v45, v20, v21
 v_exp_f32 v23, v77
 v_add_f32 v27, v21, v27
 v_exp_f32 v24, v78
 v_add_f32 v27, v22, v27
 v_cvt_pk_bf16_f32 v46, v22, v23
 v_exp_f32 v25, v79
 v_add_f32 v27, v23, v27
 v_add_f32 v27, v24, v27
 v_cvt_pk_bf16_f32 v47, v24, v25
 v_add_f32 v27, v25, v27
 v_sub_f32 v10, v32, v14
 v_sub_f32 v11, v36, v15
 v_cvt_i32_f32 v10, v10
 v_cvt_i32_f32 v11, v11
 v_ldexp_f32 v10, 1.0, v10
 v_ldexp_f32 v11, 1.0, v11
 v_and_b32 v10, 0xffff0000, v10
 v_and_b32 v11, 0xffff0000, v11
 v_fmac_f32 v30, v10, v16
 v_fmac_f32 v31, v11, v17
 v_lshrrev_b32 v12, 16, v10
 v_lshrrev_b32 v13, 16, v11
 v_accvgpr_read_b32 v18, a128
 v_dot2c_f32_bf16 v128, v18, v12
 v_dot2c_f32_bf16 v129, v18, v10
 v_accvgpr_read_b32 v19, a129
 v_dot2c_f32_bf16 v130, v19, v12
 v_dot2c_f32_bf16 v131, v19, v10
 v_accvgpr_read_b32 v20, a130
 v_dot2c_f32_bf16 v136, v20, v12
 v_dot2c_f32_bf16 v137, v20, v10
 v_accvgpr_read_b32 v21, a131
 v_dot2c_f32_bf16 v138, v21, v12
 v_dot2c_f32_bf16 v139, v21, v10
 v_accvgpr_read_b32 v22, a132
 v_dot2c_f32_bf16 v144, v22, v12
 v_dot2c_f32_bf16 v145, v22, v10
 v_accvgpr_read_b32 v23, a133
 v_dot2c_f32_bf16 v146, v23, v12
 v_dot2c_f32_bf16 v147, v23, v10
 v_accvgpr_read_b32 v24, a134
 v_dot2c_f32_bf16 v152, v24, v12
 v_dot2c_f32_bf16 v153, v24, v10
 v_accvgpr_read_b32 v25, a135
 v_dot2c_f32_bf16 v154, v25, v12
 v_dot2c_f32_bf16 v155, v25, v10
 v_accvgpr_read_b32 v18, a136
 v_dot2c_f32_bf16 v160, v18, v12
 v_dot2c_f32_bf16 v161, v18, v10
 v_accvgpr_read_b32 v19, a137
 v_dot2c_f32_bf16 v162, v19, v12
 v_dot2c_f32_bf16 v163, v19, v10
 v_accvgpr_read_b32 v20, a138
 v_dot2c_f32_bf16 v168, v20, v12
 v_dot2c_f32_bf16 v169, v20, v10
 v_accvgpr_read_b32 v21, a139
 v_dot2c_f32_bf16 v170, v21, v12
 v_dot2c_f32_bf16 v171, v21, v10
 v_accvgpr_read_b32 v22, a140
 v_dot2c_f32_bf16 v176, v22, v12
 v_dot2c_f32_bf16 v177, v22, v10
 v_accvgpr_read_b32 v23, a141
 v_dot2c_f32_bf16 v178, v23, v12
 v_dot2c_f32_bf16 v179, v23, v10
 v_accvgpr_read_b32 v24, a142
 v_dot2c_f32_bf16 v184, v24, v12
 v_dot2c_f32_bf16 v185, v24, v10
 v_accvgpr_read_b32 v25, a143
 v_dot2c_f32_bf16 v186, v25, v12
 v_dot2c_f32_bf16 v187, v25, v10
 v_accvgpr_read_b32 v18, a144
 v_dot2c_f32_bf16 v192, v18, v12
 v_dot2c_f32_bf16 v193, v18, v10
 v_accvgpr_read_b32 v19, a145
 v_dot2c_f32_bf16 v194, v19, v12
 v_dot2c_f32_bf16 v195, v19, v10
 v_accvgpr_read_b32 v20, a146
 v_dot2c_f32_bf16 v200, v20, v12
 v_dot2c_f32_bf16 v201, v20, v10
 v_accvgpr_read_b32 v21, a147
 v_dot2c_f32_bf16 v202, v21, v12
 v_dot2c_f32_bf16 v203, v21, v10
 v_accvgpr_read_b32 v22, a148
 v_dot2c_f32_bf16 v208, v22, v12
 v_dot2c_f32_bf16 v209, v22, v10
 v_accvgpr_read_b32 v23, a149
 v_dot2c_f32_bf16 v210, v23, v12
 v_dot2c_f32_bf16 v211, v23, v10
 v_accvgpr_read_b32 v24, a150
 v_dot2c_f32_bf16 v216, v24, v12
 v_dot2c_f32_bf16 v217, v24, v10
 v_accvgpr_read_b32 v25, a151
 v_dot2c_f32_bf16 v218, v25, v12
 v_dot2c_f32_bf16 v219, v25, v10
 v_accvgpr_read_b32 v18, a152
 v_dot2c_f32_bf16 v224, v18, v12
 v_dot2c_f32_bf16 v225, v18, v10
 v_accvgpr_read_b32 v19, a153
 v_dot2c_f32_bf16 v226, v19, v12
 v_dot2c_f32_bf16 v227, v19, v10
 v_accvgpr_read_b32 v20, a154
 v_dot2c_f32_bf16 v232, v20, v12
 v_dot2c_f32_bf16 v233, v20, v10
 v_accvgpr_read_b32 v21, a155
 v_dot2c_f32_bf16 v234, v21, v12
 v_dot2c_f32_bf16 v235, v21, v10
 v_accvgpr_read_b32 v22, a156
 v_dot2c_f32_bf16 v240, v22, v12
 v_dot2c_f32_bf16 v241, v22, v10
 v_accvgpr_read_b32 v23, a157
 v_dot2c_f32_bf16 v242, v23, v12
 v_dot2c_f32_bf16 v243, v23, v10
 v_accvgpr_read_b32 v24, a158
 v_dot2c_f32_bf16 v248, v24, v12
 v_dot2c_f32_bf16 v249, v24, v10
 v_accvgpr_read_b32 v25, a159
 v_dot2c_f32_bf16 v250, v25, v12
 v_dot2c_f32_bf16 v251, v25, v10
 v_accvgpr_read_b32 v18, a160
 v_dot2c_f32_bf16 v132, v18, v13
 v_dot2c_f32_bf16 v133, v18, v11
 v_accvgpr_read_b32 v19, a161
 v_dot2c_f32_bf16 v134, v19, v13
 v_dot2c_f32_bf16 v135, v19, v11
 v_accvgpr_read_b32 v20, a162
 v_dot2c_f32_bf16 v140, v20, v13
 v_dot2c_f32_bf16 v141, v20, v11
 v_accvgpr_read_b32 v21, a163
 v_dot2c_f32_bf16 v142, v21, v13
 v_dot2c_f32_bf16 v143, v21, v11
 v_accvgpr_read_b32 v22, a164
 v_dot2c_f32_bf16 v148, v22, v13
 v_dot2c_f32_bf16 v149, v22, v11
 v_accvgpr_read_b32 v23, a165
 v_dot2c_f32_bf16 v150, v23, v13
 v_dot2c_f32_bf16 v151, v23, v11
 v_accvgpr_read_b32 v24, a166
 v_dot2c_f32_bf16 v156, v24, v13
 v_dot2c_f32_bf16 v157, v24, v11
 v_accvgpr_read_b32 v25, a167
 v_dot2c_f32_bf16 v158, v25, v13
 v_dot2c_f32_bf16 v159, v25, v11
 v_accvgpr_read_b32 v18, a168
 v_dot2c_f32_bf16 v164, v18, v13
 v_dot2c_f32_bf16 v165, v18, v11
 v_accvgpr_read_b32 v19, a169
 v_dot2c_f32_bf16 v166, v19, v13
 v_dot2c_f32_bf16 v167, v19, v11
 v_accvgpr_read_b32 v20, a170
 v_dot2c_f32_bf16 v172, v20, v13
 v_dot2c_f32_bf16 v173, v20, v11
 v_accvgpr_read_b32 v21, a171
 v_dot2c_f32_bf16 v174, v21, v13
 v_dot2c_f32_bf16 v175, v21, v11
 v_accvgpr_read_b32 v22, a172
 v_dot2c_f32_bf16 v180, v22, v13
 v_dot2c_f32_bf16 v181, v22, v11
 v_accvgpr_read_b32 v23, a173
 v_dot2c_f32_bf16 v182, v23, v13
 v_dot2c_f32_bf16 v183, v23, v11
 v_accvgpr_read_b32 v24, a174
 v_dot2c_f32_bf16 v188, v24, v13
 v_dot2c_f32_bf16 v189, v24, v11
 v_accvgpr_read_b32 v25, a175
 v_dot2c_f32_bf16 v190, v25, v13
 v_dot2c_f32_bf16 v191, v25, v11
 v_accvgpr_read_b32 v18, a176
 v_dot2c_f32_bf16 v196, v18, v13
 v_dot2c_f32_bf16 v197, v18, v11
 v_accvgpr_read_b32 v19, a177
 v_dot2c_f32_bf16 v198, v19, v13
 v_dot2c_f32_bf16 v199, v19, v11
 v_accvgpr_read_b32 v20, a178
 v_dot2c_f32_bf16 v204, v20, v13
 v_dot2c_f32_bf16 v205, v20, v11
 v_accvgpr_read_b32 v21, a179
 v_dot2c_f32_bf16 v206, v21, v13
 v_dot2c_f32_bf16 v207, v21, v11
 v_accvgpr_read_b32 v22, a180
 v_dot2c_f32_bf16 v212, v22, v13
 v_dot2c_f32_bf16 v213, v22, v11
 v_accvgpr_read_b32 v23, a181
 v_dot2c_f32_bf16 v214, v23, v13
 v_dot2c_f32_bf16 v215, v23, v11
 v_accvgpr_read_b32 v24, a182
 v_dot2c_f32_bf16 v220, v24, v13
 v_dot2c_f32_bf16 v221, v24, v11
 v_accvgpr_read_b32 v25, a183
 v_dot2c_f32_bf16 v222, v25, v13
 v_dot2c_f32_bf16 v223, v25, v11
 v_accvgpr_read_b32 v18, a184
 v_dot2c_f32_bf16 v228, v18, v13
 v_dot2c_f32_bf16 v229, v18, v11
 v_accvgpr_read_b32 v19, a185
 v_dot2c_f32_bf16 v230, v19, v13
 v_dot2c_f32_bf16 v231, v19, v11
 v_accvgpr_read_b32 v20, a186
 v_dot2c_f32_bf16 v236, v20, v13
 v_dot2c_f32_bf16 v237, v20, v11
 v_accvgpr_read_b32 v21, a187
 v_dot2c_f32_bf16 v238, v21, v13
 v_dot2c_f32_bf16 v239, v21, v11
 v_accvgpr_read_b32 v22, a188
 v_dot2c_f32_bf16 v244, v22, v13
 v_dot2c_f32_bf16 v245, v22, v11
 v_accvgpr_read_b32 v23, a189
 v_dot2c_f32_bf16 v246, v23, v13
 v_dot2c_f32_bf16 v247, v23, v11
 v_accvgpr_read_b32 v24, a190
 v_dot2c_f32_bf16 v252, v24, v13
 v_dot2c_f32_bf16 v253, v24, v11
 v_accvgpr_read_b32 v25, a191
 v_dot2c_f32_bf16 v254, v25, v13
 v_dot2c_f32_bf16 v255, v25, v11
 s_nop 3
 s_branch L_p2
L_st0:
 s_call_b64 s[36:37], L_slow0
 s_branch L_rt0
L_st1:
 s_call_b64 s[36:37], L_slow1
 s_branch L_rt1
L_st2:
 s_call_b64 s[36:37], L_slowB
 s_branch L_rt2
L_st3:
 s_call_b64 s[36:37], L_slow1
 s_branch L_rt3
L_st4:
 s_call_b64 s[36:37], L_slow1n
 s_branch L_rt4
L_st5:
 s_call_b64 s[36:37], L_slow1
 s_branch L_rt5
L_st6:
 s_call_b64 s[36:37], L_slow0B
 s_branch L_rt6
L_st7:
 s_call_b64 s[36:37], L_slowB
 s_branch L_rt7
L_st8:
 s_call_b64 s[36:37], L_slowf
 s_branch L_rt8
L_st9:
 s_call_b64 s[36:37], L_slow1
 s_branch L_rt9
L_st10:
 s_call_b64 s[36:37], L_slowf
 s_branch L_rt10
L_st11:
 s_call_b64 s[36:37], L_slowf
 s_branch L_rt11
L_st14:
 s_call_b64 s[36:37], L_slow0B
 s_branch L_rt14
L_st12:
 s_call_b64 s[36:37], L_slow0
 s_branch L_rt12
L_st13:
 s_call_b64 s[36:37], L_slow1
 s_branch L_rt13
L_slow0:
 s_nop 7
 s_nop 3
 v_max3_f32 v10, v64, v65, v66
 v_max3_f32 v10, v67, v72, v10
 v_max3_f32 v10, v73, v74, v10
 v_max3_f32 v10, v75, v80, v10
 v_max3_f32 v10, v81, v82, v10
 v_max3_f32 v10, v83, v88, v10
 v_max3_f32 v10, v89, v90, v10
 v_max_f32 v10, v91, v10
 v_max3_f32 v11, v68, v69, v70
 v_max3_f32 v11, v71, v76, v11
 v_max3_f32 v11, v77, v78, v11
 v_max3_f32 v11, v79, v84, v11
 v_max3_f32 v11, v85, v86, v11
 v_max3_f32 v11, v87, v92, v11
 v_max3_f32 v11, v93, v94, v11
 v_max_f32 v11, v95, v11
 v_mov_b32 v12, v10
 v_mov_b32 v13, v11
 s_nop 0
 v_permlane16_swap_b32 v12, v10
 v_permlane16_swap_b32 v13, v11
 v_max_f32 v10, v12, v10
 v_max_f32 v11, v13, v11
 v_mov_b32 v12, v10
 v_mov_b32 v13, v11
 s_nop 0
 v_permlane32_swap_b32 v12, v10
 v_permlane32_swap_b32 v13, v11
 v_max_f32 v10, v12, v10
 v_max_f32 v11, v13, v11
 v_ceil_f32 v10, v10
 v_ceil_f32 v11, v11
 v_max_f32 v10, 0, v10
 v_max_f32 v11, 0, v11
 v_sub_f32 v64, v64, v10
 v_sub_f32 v65, v65, v10
 v_sub_f32 v66, v66, v10
 v_sub_f32 v67, v67, v10
 v_sub_f32 v68, v68, v11
 v_sub_f32 v69, v69, v11
 v_sub_f32 v70, v70, v11
 v_sub_f32 v71, v71, v11
 v_sub_f32 v72, v72, v10
 v_sub_f32 v73, v73, v10
 v_sub_f32 v74, v74, v10
 v_sub_f32 v75, v75, v10
 v_sub_f32 v76, v76, v11
 v_sub_f32 v77, v77, v11
 v_sub_f32 v78, v78, v11
 v_sub_f32 v79, v79, v11
 v_sub_f32 v80, v80, v10
 v_sub_f32 v81, v81, v10
 v_sub_f32 v82, v82, v10
 v_sub_f32 v83, v83, v10
 v_sub_f32 v84, v84, v11
 v_sub_f32 v85, v85, v11
 v_sub_f32 v86, v86, v11
 v_sub_f32 v87, v87, v11
 v_sub_f32 v88, v88, v10
 v_sub_f32 v89, v89, v10
 v_sub_f32 v90, v90, v10
 v_sub_f32 v91, v91, v10
 v_sub_f32 v92, v92, v11
 v_sub_f32 v93, v93, v11
 v_sub_f32 v94, v94, v11
 v_sub_f32 v95, v95, v11
 v_sub_f32 v96, v96, v10
 v_sub_f32 v97, v97, v10
 v_sub_f32 v98, v98, v10
 v_sub_f32 v99, v99, v10
 v_sub_f32 v100, v100, v11
 v_sub_f32 v101, v101, v11
 v_sub_f32 v102, v102, v11
 v_sub_f32 v103, v103, v11
 v_sub_f32 v104, v104, v10
 v_sub_f32 v105, v105, v10
 v_sub_f32 v106, v106, v10
 v_sub_f32 v107, v107, v10
 v_sub_f32 v108, v108, v11
 v_sub_f32 v109, v109, v11
 v_sub_f32 v110, v110, v11
 v_sub_f32 v111, v111, v11
 v_sub_f32 v112, v112, v10
 v_sub_f32 v113, v113, v10
 v_sub_f32 v114, v114, v10
 v_sub_f32 v115, v115, v10
 v_sub_f32 v116, v116, v11
 v_sub_f32 v117, v117, v11
 v_sub_f32 v118, v118, v11
 v_sub_f32 v119, v119, v11
 v_sub_f32 v120, v120, v10
 v_sub_f32 v121, v121, v10
 v_sub_f32 v122, v122, v10
 v_sub_f32 v123, v123, v10
 v_sub_f32 v124, v124, v11
 v_sub_f32 v125, v125, v11
 v_sub_f32 v126, v126, v11
 v_sub_f32 v127, v127, v11
 v_sub_f32 v32, v32, v10
 v_sub_f32 v33, v33, v10
 v_sub_f32 v34, v34, v10
 v_sub_f32 v35, v35, v10
 v_sub_f32 v36, v36, v11
 v_sub_f32 v37, v37, v11
 v_sub_f32 v38, v38, v11
 v_sub_f32 v39, v39, v11
 v_exp_f32 v12, -v10
 v_exp_f32 v13, -v11
 v_mul_f32 v30, v12, v30
 v_mul_f32 v31, v13, v31
 v_mul_f32 v128, v12, v128
 v_mul_f32 v129, v12, v129
 v_mul_f32 v130, v12, v130
 v_mul_f32 v131, v12, v131
 v_mul_f32 v132, v13, v132
 v_mul_f32 v133, v13, v133
 v_mul_f32 v134, v13, v134
 v_mul_f32 v135, v13, v135
 v_mul_f32 v136, v12, v136
 v_mul_f32 v137, v12, v137
 v_mul_f32 v138, v12, v138
 v_mul_f32 v139, v12, v139
 v_mul_f32 v140, v13, v140
 v_mul_f32 v141, v13, v141
 v_mul_f32 v142, v13, v142
 v_mul_f32 v143, v13, v143
 v_mul_f32 v144, v12, v144
 v_mul_f32 v145, v12, v145
 v_mul_f32 v146, v12, v146
 v_mul_f32 v147, v12, v147
 v_mul_f32 v148, v13, v148
 v_mul_f32 v149, v13, v149
 v_mul_f32 v150, v13, v150
 v_mul_f32 v151, v13, v151
 v_mul_f32 v152, v12, v152
 v_mul_f32 v153, v12, v153
 v_mul_f32 v154, v12, v154
 v_mul_f32 v155, v12, v155
 v_mul_f32 v156, v13, v156
 v_mul_f32 v157, v13, v157
 v_mul_f32 v158, v13, v158
 v_mul_f32 v159, v13, v159
 v_mul_f32 v160, v12, v160
 v_mul_f32 v161, v12, v161
 v_mul_f32 v162, v12, v162
 v_mul_f32 v163, v12, v163
 v_mul_f32 v164, v13, v164
 v_mul_f32 v165, v13, v165
 v_mul_f32 v166, v13, v166
 v_mul_f32 v167, v13, v167
 v_mul_f32 v168, v12, v168
 v_mul_f32 v169, v12, v169
 v_mul_f32 v170, v12, v170
 v_mul_f32 v171, v12, v171
 v_mul_f32 v172, v13, v172
 v_mul_f32 v173, v13, v173
 v_mul_f32 v174, v13, v174
 v_mul_f32 v175, v13, v175
 v_mul_f32 v176, v12, v176
 v_mul_f32 v177, v12, v177
 v_mul_f32 v178, v12, v178
 v_mul_f32 v179, v12, v179
 v_mul_f32 v180, v13, v180
 v_mul_f32 v181, v13, v181
 v_mul_f32 v182, v13, v182
 v_mul_f32 v183, v13, v183
 v_mul_f32 v184, v12, v184
 v_mul_f32 v185, v12, v185
 v_mul_f32 v186, v12, v186
 v_mul_f32 v187, v12, v187
 v_mul_f32 v188, v13, v188
 v_mul_f32 v189, v13, v189
 v_mul_f32 v190, v13, v190
 v_mul_f32 v191, v13, v191
 v_mul_f32 v192, v12, v192
 v_mul_f32 v193, v12, v193
 v_mul_f32 v194, v12, v194
 v_mul_f32 v195, v12, v195
 v_mul_f32 v196, v13, v196
 v_mul_f32 v197, v13, v197
 v_mul_f32 v198, v13, v198
 v_mul_f32 v199, v13, v199
 v_mul_f32 v200, v12, v200
 v_mul_f32 v201, v12, v201
 v_mul_f32 v202, v12, v202
 v_mul_f32 v203, v12, v203
 v_mul_f32 v204, v13, v204
 v_mul_f32 v205, v13, v205
 v_mul_f32 v206, v13, v206
 v_mul_f32 v207, v13, v207
 v_mul_f32 v208, v12, v208
 v_mul_f32 v209, v12, v209
 v_mul_f32 v210, v12, v210
 v_mul_f32 v211, v12, v211
 v_mul_f32 v212, v13, v212
 v_mul_f32 v213, v13, v213
 v_mul_f32 v214, v13, v214
 v_mul_f32 v215, v13, v215
 v_mul_f32 v216, v12, v216
 v_mul_f32 v217, v12, v217
 v_mul_f32 v218, v12, v218
 v_mul_f32 v219, v12, v219
 v_mul_f32 v220, v13, v220
 v_mul_f32 v221, v13, v221
 v_mul_f32 v222, v13, v222
 v_mul_f32 v223, v13, v223
 v_mul_f32 v224, v12, v224
 v_mul_f32 v225, v12, v225
 v_mul_f32 v226, v12, v226
 v_mul_f32 v227, v12, v227
 v_mul_f32 v228, v13, v228
 v_mul_f32 v229, v13, v229
 v_mul_f32 v230, v13, v230
 v_mul_f32 v231, v13, v231
 v_mul_f32 v232, v12, v232
 v_mul_f32 v233, v12, v233
 v_mul_f32 v234, v12, v234
 v_mul_f32 v235, v12, v235
 v_mul_f32 v236, v13, v236
 v_mul_f32 v237, v13, v237
 v_mul_f32 v238, v13, v238
 v_mul_f32 v239, v13, v239
 v_mul_f32 v240, v12, v240
 v_mul_f32 v241, v12, v241
 v_mul_f32 v242, v12, v242
 v_mul_f32 v243, v12, v243
 v_mul_f32 v244, v13, v244
 v_mul_f32 v245, v13, v245
 v_mul_f32 v246, v13, v246
 v_mul_f32 v247, v13, v247
 v_mul_f32 v248, v12, v248
 v_mul_f32 v249, v12, v249
 v_mul_f32 v250, v12, v250
 v_mul_f32 v251, v12, v251
 v_mul_f32 v252, v13, v252
 v_mul_f32 v253, v13, v253
 v_mul_f32 v254, v13, v254
 v_mul_f32 v255, v13, v255
 v_exp_f32 v18, v64
 v_exp_f32 v19, v65
 v_exp_f32 v20, v66
 v_add_f32 v26, v18, v19
 v_cvt_pk_bf16_f32 v40, v18, v19
 v_exp_f32 v21, v67
 v_exp_f32 v22, v72
 v_add_f32 v26, v20, v26
 v_cvt_pk_bf16_f32 v41, v20, v21
 v_exp_f32 v23, v73
 v_add_f32 v26, v21, v26
 v_exp_f32 v24, v74
 v_add_f32 v26, v22, v26
 v_cvt_pk_bf16_f32 v42, v22, v23
 v_exp_f32 v25, v75
 v_add_f32 v26, v23, v26
 v_exp_f32 v18, v68
 v_add_f32 v26, v24, v26
 v_cvt_pk_bf16_f32 v43, v24, v25
 v_exp_f32 v19, v69
 v_add_f32 v26, v25, v26
 v_exp_f32 v20, v70
 v_add_f32 v27, v18, v19
 v_cvt_pk_bf16_f32 v44, v18, v19
 v_exp_f32 v21, v71
 v_exp_f32 v22, v76
 v_add_f32 v27, v20, v27
 v_cvt_pk_bf16_f32 v45, v20, v21
 v_exp_f32 v23, v77
 v_add_f32 v27, v21, v27
 v_exp_f32 v24, v78
 v_add_f32 v27, v22, v27
 v_cvt_pk_bf16_f32 v46, v22, v23
 v_exp_f32 v25, v79
 v_add_f32 v27, v23, v27
 v_add_f32 v27, v24, v27
 v_cvt_pk_bf16_f32 v47, v24, v25
 v_add_f32 v27, v25, v27
 v_exp_f32 v18, v80
 v_exp_f32 v19, v81
 v_exp_f32 v20, v82
 v_add_f32 v26, v18, v26
 v_cvt_pk_bf16_f32 v56, v18, v19
 v_exp_f32 v21, v83
 v_add_f32 v26, v19, v26
 v_exp_f32 v22, v88
 v_add_f32 v26, v20, v26
 v_cvt_pk_bf16_f32 v57, v20, v21
 v_exp_f32 v23, v89
 v_add_f32 v26, v21, v26
 v_exp_f32 v24, v90
 v_add_f32 v26, v22, v26
 v_cvt_pk_bf16_f32 v58, v22, v23
 v_exp_f32 v25, v91
 v_add_f32 v26, v23, v26
 v_exp_f32 v18, v84
 v_add_f32 v26, v24, v26
 v_cvt_pk_bf16_f32 v59, v24, v25
 v_exp_f32 v19, v85
 v_add_f32 v26, v25, v26
 v_exp_f32 v20, v86
 v_add_f32 v27, v18, v27
 v_cvt_pk_bf16_f32 v60, v18, v19
 v_exp_f32 v21, v87
 v_add_f32 v27, v19, v27
 v_exp_f32 v22, v92
 v_add_f32 v27, v20, v27
 v_cvt_pk_bf16_f32 v61, v20, v21
 v_exp_f32 v23, v93
 v_add_f32 v27, v21, v27
 v_exp_f32 v24, v94
 v_add_f32 v27, v22, v27
 v_cvt_pk_bf16_f32 v62, v22, v23
 v_exp_f32 v25, v95
 v_add_f32 v27, v23, v27
 v_add_f32 v27, v24, v27
 v_cvt_pk_bf16_f32 v63, v24, v25
 v_add_f32 v27, v25, v27
 s_nop 3
 s_setpc_b64 s[36:37]
L_slow1:
 s_nop 7
 s_nop 3
 v_max3_f32 v10, v96, v97, v98
 v_max3_f32 v10, v99, v104, v10
 v_max3_f32 v10, v105, v106, v10
 v_max3_f32 v10, v107, v112, v10
 v_max3_f32 v10, v113, v114, v10
 v_max3_f32 v10, v115, v120, v10
 v_max3_f32 v10, v121, v122, v10
 v_max_f32 v10, v123, v10
 v_max3_f32 v11, v100, v101, v102
 v_max3_f32 v11, v103, v108, v11
 v_max3_f32 v11, v109, v110, v11
 v_max3_f32 v11, v111, v116, v11
 v_max3_f32 v11, v117, v118, v11
 v_max3_f32 v11, v119, v124, v11
 v_max3_f32 v11, v125, v126, v11
 v_max_f32 v11, v127, v11
 v_mov_b32 v12, v10
 v_mov_b32 v13, v11
 s_nop 0
 v_permlane16_swap_b32 v12, v10
 v_permlane16_swap_b32 v13, v11
 v_max_f32 v10, v12, v10
 v_max_f32 v11, v13, v11
 v_mov_b32 v12, v10
 v_mov_b32 v13, v11
 s_nop 0
 v_permlane32_swap_b32 v12, v10
 v_permlane32_swap_b32 v13, v11
 v_max_f32 v10, v12, v10
 v_max_f32 v11, v13, v11
 v_ceil_f32 v10, v10
 v_ceil_f32 v11, v11
 v_max_f32 v10, 0, v10
 v_max_f32 v11, 0, v11
 v_sub_f32 v96, v96, v10
 v_sub_f32 v97, v97, v10
 v_sub_f32 v98, v98, v10
 v_sub_f32 v99, v99, v10
 v_sub_f32 v100, v100, v11
 v_sub_f32 v101, v101, v11
 v_sub_f32 v102, v102, v11
 v_sub_f32 v103, v103, v11
 v_sub_f32 v104, v104, v10
 v_sub_f32 v105, v105, v10
 v_sub_f32 v106, v106, v10
 v_sub_f32 v107, v107, v10
 v_sub_f32 v108, v108, v11
 v_sub_f32 v109, v109, v11
 v_sub_f32 v110, v110, v11
 v_sub_f32 v111, v111, v11
 v_sub_f32 v112, v112, v10
 v_sub_f32 v113, v113, v10
 v_sub_f32 v114, v114, v10
 v_sub_f32 v115, v115, v10
 v_sub_f32 v116, v116, v11
 v_sub_f32 v117, v117, v11
 v_sub_f32 v118, v118, v11
 v_sub_f32 v119, v119, v11
 v_sub_f32 v120, v120, v10
 v_sub_f32 v121, v121, v10
 v_sub_f32 v122, v122, v10
 v_sub_f32 v123, v123, v10
 v_sub_f32 v124, v124, v11
 v_sub_f32 v125, v125, v11
 v_sub_f32 v126, v126, v11
 v_sub_f32 v127, v127, v11
 v_sub_f32 v64, v64, v10
 v_sub_f32 v65, v65, v10
 v_sub_f32 v66, v66, v10
 v_sub_f32 v67, v67, v10
 v_sub_f32 v68, v68, v11
 v_sub_f32 v69, v69, v11
 v_sub_f32 v70, v70, v11
 v_sub_f32 v71, v71, v11
 v_sub_f32 v72, v72, v10
 v_sub_f32 v73, v73, v10
 v_sub_f32 v74, v74, v10
 v_sub_f32 v75, v75, v10
 v_sub_f32 v76, v76, v11
 v_sub_f32 v77, v77, v11
 v_sub_f32 v78, v78, v11
 v_sub_f32 v79, v79, v11
 v_sub_f32 v80, v80, v10
 v_sub_f32 v81, v81, v10
 v_sub_f32 v82, v82, v10
 v_sub_f32 v83, v83, v10
 v_sub_f32 v84, v84, v11
 v_sub_f32 v85, v85, v11
 v_sub_f32 v86, v86, v11
 v_sub_f32 v87, v87, v11
 v_sub_f32 v88, v88, v10
 v_sub_f32 v89, v89, v10
 v_sub_f32 v90, v90, v10
 v_sub_f32 v91, v91, v10
 v_sub_f32 v92, v92, v11
 v_sub_f32 v93, v93, v11
 v_sub_f32 v94, v94, v11
 v_sub_f32 v95, v95, v11
 v_sub_f32 v32, v32, v10
 v_sub_f32 v33, v33, v10
 v_sub_f32 v34, v34, v10
 v_sub_f32 v35, v35, v10
 v_sub_f32 v36, v36, v11
 v_sub_f32 v37, v37, v11
 v_sub_f32 v38, v38, v11
 v_sub_f32 v39, v39, v11
 v_exp_f32 v12, -v10
 v_exp_f32 v13, -v11
 v_mul_f32 v30, v12, v30
 v_mul_f32 v31, v13, v31
 v_mul_f32 v128, v12, v128
 v_mul_f32 v129, v12, v129
 v_mul_f32 v130, v12, v130
 v_mul_f32 v131, v12, v131
 v_mul_f32 v132, v13, v132
 v_mul_f32 v133, v13, v133
 v_mul_f32 v134, v13, v134
 v_mul_f32 v135, v13, v135
 v_mul_f32 v136, v12, v136
 v_mul_f32 v137, v12, v137
 v_mul_f32 v138, v12, v138
 v_mul_f32 v139, v12, v139
 v_mul_f32 v140, v13, v140
 v_mul_f32 v141, v13, v141
 v_mul_f32 v142, v13, v142
 v_mul_f32 v143, v13, v143
 v_mul_f32 v144, v12, v144
 v_mul_f32 v145, v12, v145
 v_mul_f32 v146, v12, v146
 v_mul_f32 v147, v12, v147
 v_mul_f32 v148, v13, v148
 v_mul_f32 v149, v13, v149
 v_mul_f32 v150, v13, v150
 v_mul_f32 v151, v13, v151
 v_mul_f32 v152, v12, v152
 v_mul_f32 v153, v12, v153
 v_mul_f32 v154, v12, v154
 v_mul_f32 v155, v12, v155
 v_mul_f32 v156, v13, v156
 v_mul_f32 v157, v13, v157
 v_mul_f32 v158, v13, v158
 v_mul_f32 v159, v13, v159
 v_mul_f32 v160, v12, v160
 v_mul_f32 v161, v12, v161
 v_mul_f32 v162, v12, v162
 v_mul_f32 v163, v12, v163
 v_mul_f32 v164, v13, v164
 v_mul_f32 v165, v13, v165
 v_mul_f32 v166, v13, v166
 v_mul_f32 v167, v13, v167
 v_mul_f32 v168, v12, v168
 v_mul_f32 v169, v12, v169
 v_mul_f32 v170, v12, v170
 v_mul_f32 v171, v12, v171
 v_mul_f32 v172, v13, v172
 v_mul_f32 v173, v13, v173
 v_mul_f32 v174, v13, v174
 v_mul_f32 v175, v13, v175
 v_mul_f32 v176, v12, v176
 v_mul_f32 v177, v12, v177
 v_mul_f32 v178, v12, v178
 v_mul_f32 v179, v12, v179
 v_mul_f32 v180, v13, v180
 v_mul_f32 v181, v13, v181
 v_mul_f32 v182, v13, v182
 v_mul_f32 v183, v13, v183
 v_mul_f32 v184, v12, v184
 v_mul_f32 v185, v12, v185
 v_mul_f32 v186, v12, v186
 v_mul_f32 v187, v12, v187
 v_mul_f32 v188, v13, v188
 v_mul_f32 v189, v13, v189
 v_mul_f32 v190, v13, v190
 v_mul_f32 v191, v13, v191
 v_mul_f32 v192, v12, v192
 v_mul_f32 v193, v12, v193
 v_mul_f32 v194, v12, v194
 v_mul_f32 v195, v12, v195
 v_mul_f32 v196, v13, v196
 v_mul_f32 v197, v13, v197
 v_mul_f32 v198, v13, v198
 v_mul_f32 v199, v13, v199
 v_mul_f32 v200, v12, v200
 v_mul_f32 v201, v12, v201
 v_mul_f32 v202, v12, v202
 v_mul_f32 v203, v12, v203
 v_mul_f32 v204, v13, v204
 v_mul_f32 v205, v13, v205
 v_mul_f32 v206, v13, v206
 v_mul_f32 v207, v13, v207
 v_mul_f32 v208, v12, v208
 v_mul_f32 v209, v12, v209
 v_mul_f32 v210, v12, v210
 v_mul_f32 v211, v12, v211
 v_mul_f32 v212, v13, v212
 v_mul_f32 v213, v13, v213
 v_mul_f32 v214, v13, v214
 v_mul_f32 v215, v13, v215
 v_mul_f32 v216, v12, v216
 v_mul_f32 v217, v12, v217
 v_mul_f32 v218, v12, v218
 v_mul_f32 v219, v12, v219
 v_mul_f32 v220, v13, v220
 v_mul_f32 v221, v13, v221
 v_mul_f32 v222, v13, v222
 v_mul_f32 v223, v13, v223
 v_mul_f32 v224, v12, v224
 v_mul_f32 v225, v12, v225
 v_mul_f32 v226, v12, v226
 v_mul_f32 v227, v12, v227
 v_mul_f32 v228, v13, v228
 v_mul_f32 v229, v13, v229
 v_mul_f32 v230, v13, v230
 v_mul_f32 v231, v13, v231
 v_mul_f32 v232, v12, v232
 v_mul_f32 v233, v12, v233
 v_mul_f32 v234, v12, v234
 v_mul_f32 v235, v12, v235
 v_mul_f32 v236, v13, v236
 v_mul_f32 v237, v13, v237
 v_mul_f32 v238, v13, v238
 v_mul_f32 v239, v13, v239
 v_mul_f32 v240, v12, v240
 v_mul_f32 v241, v12, v241
 v_mul_f32 v242, v12, v242
 v_mul_f32 v243, v12, v243
 v_mul_f32 v244, v13, v244
 v_mul_f32 v245, v13, v245
 v_mul_f32 v246, v13, v246
 v_mul_f32 v247, v13, v247
 v_mul_f32 v248, v12, v248
 v_mul_f32 v249, v12, v249
 v_mul_f32 v250, v12, v250
 v_mul_f32 v251, v12, v251
 v_mul_f32 v252, v13, v252
 v_mul_f32 v253, v13, v253
 v_mul_f32 v254, v13, v254
 v_mul_f32 v255, v13, v255
 v_exp_f32 v18, v96
 v_exp_f32 v19, v97
 v_exp_f32 v20, v98
 v_add_f32 v28, v18, v19
 v_cvt_pk_bf16_f32 v48, v18, v19
 v_exp_f32 v21, v99
 v_exp_f32 v22, v104
 v_add_f32 v28, v20, v28
 v_cvt_pk_bf16_f32 v49, v20, v21
 v_exp_f32 v23, v105
 v_add_f32 v28, v21, v28
 v_exp_f32 v24, v106
 v_add_f32 v28, v22, v28
 v_cvt_pk_bf16_f32 v50, v22, v23
 v_exp_f32 v25, v107
 v_add_f32 v28, v23, v28
 v_exp_f32 v18, v100
 v_add_f32 v28, v24, v28
 v_cvt_pk_bf16_f32 v51, v24, v25
 v_exp_f32 v19, v101
 v_add_f32 v28, v25, v28
 v_exp_f32 v20, v102
 v_add_f32 v29, v18, v19
 v_cvt_pk_bf16_f32 v52, v18, v19
 v_exp_f32 v21, v103
 v_exp_f32 v22, v108
 v_add_f32 v29, v20, v29
 v_cvt_pk_bf16_f32 v53, v20, v21
 v_exp_f32 v23, v109
 v_add_f32 v29, v21, v29
 v_exp_f32 v24, v110
 v_add_f32 v29, v22, v29
 v_cvt_pk_bf16_f32 v54, v22, v23
 v_exp_f32 v25, v111
 v_add_f32 v29, v23, v29
 v_add_f32 v29, v24, v29
 v_cvt_pk_bf16_f32 v55, v24, v25
 v_add_f32 v29, v25, v29
 v_exp_f32 v18, v112
 v_exp_f32 v19, v113
 v_exp_f32 v20, v114
 v_add_f32 v28, v18, v28
 v_cvt_pk_bf16_f32 v56, v18, v19
 v_exp_f32 v21, v115
 v_add_f32 v28, v19, v28
 v_exp_f32 v22, v120
 v_add_f32 v28, v20, v28
 v_cvt_pk_bf16_f32 v57, v20, v21
 v_exp_f32 v23, v121
 v_add_f32 v28, v21, v28
 v_exp_f32 v24, v122
 v_add_f32 v28, v22, v28
 v_cvt_pk_bf16_f32 v58, v22, v23
 v_exp_f32 v25, v123
 v_add_f32 v28, v23, v28
 v_exp_f32 v18, v116
 v_add_f32 v28, v24, v28
 v_cvt_pk_bf16_f32 v59, v24, v25
 v_exp_f32 v19, v117
 v_add_f32 v28, v25, v28
 v_exp_f32 v20, v118
 v_add_f32 v29, v18, v29
 v_cvt_pk_bf16_f32 v60, v18, v19
 v_exp_f32 v21, v119
 v_add_f32 v29, v19, v29
 v_exp_f32 v22, v124
 v_add_f32 v29, v20, v29
 v_cvt_pk_bf16_f32 v61, v20, v21
 v_exp_f32 v23, v125
 v_add_f32 v29, v21, v29
 v_exp_f32 v24, v126
 v_add_f32 v29, v22, v29
 v_cvt_pk_bf16_f32 v62, v22, v23
 v_exp_f32 v25, v127
 v_add_f32 v29, v23, v29
 v_add_f32 v29, v24, v29
 v_cvt_pk_bf16_f32 v63, v24, v25
 v_add_f32 v29, v25, v29
 s_nop 3
 s_setpc_b64 s[36:37]
L_slow1n:
 s_nop 7
 s_nop 3
 v_max3_f32 v10, v96, v97, v98
 v_max3_f32 v10, v99, v104, v10
 v_max3_f32 v10, v105, v106, v10
 v_max3_f32 v10, v107, v112, v10
 v_max3_f32 v10, v113, v114, v10
 v_max3_f32 v10, v115, v120, v10
 v_max3_f32 v10, v121, v122, v10
 v_max_f32 v10, v123, v10
 v_max3_f32 v11, v100, v101, v102
 v_max3_f32 v11, v103, v108, v11
 v_max3_f32 v11, v109, v110, v11
 v_max3_f32 v11, v111, v116, v11
 v_max3_f32 v11, v117, v118, v11
 v_max3_f32 v11, v119, v124, v11
 v_max3_f32 v11, v125, v126, v11
 v_max_f32 v11, v127, v11
 v_mov_b32 v12, v10
 v_mov_b32 v13, v11
 s_nop 0
 v_permlane16_swap_b32 v12, v10
 v_permlane16_swap_b32 v13, v11
 v_max_f32 v10, v12, v10
 v_max_f32 v11, v13, v11
 v_mov_b32 v12, v10
 v_mov_b32 v13, v11
 s_nop 0
 v_permlane32_swap_b32 v12, v10
 v_permlane32_swap_b32 v13, v11
 v_max_f32 v10, v12, v10
 v_max_f32 v11, v13, v11
 v_ceil_f32 v10, v10
 v_ceil_f32 v11, v11
 v_max_f32 v10, 0, v10
 v_max_f32 v11, 0, v11
 v_sub_f32 v96, v96, v10
 v_sub_f32 v97, v97, v10
 v_sub_f32 v98, v98, v10
 v_sub_f32 v99, v99, v10
 v_sub_f32 v100, v100, v11
 v_sub_f32 v101, v101, v11
 v_sub_f32 v102, v102, v11
 v_sub_f32 v103, v103, v11
 v_sub_f32 v104, v104, v10
 v_sub_f32 v105, v105, v10
 v_sub_f32 v106, v106, v10
 v_sub_f32 v107, v107, v10
 v_sub_f32 v108, v108, v11
 v_sub_f32 v109, v109, v11
 v_sub_f32 v110, v110, v11
 v_sub_f32 v111, v111, v11
 v_sub_f32 v112, v112, v10
 v_sub_f32 v113, v113, v10
 v_sub_f32 v114, v114, v10
 v_sub_f32 v115, v115, v10
 v_sub_f32 v116, v116, v11
 v_sub_f32 v117, v117, v11
 v_sub_f32 v118, v118, v11
 v_sub_f32 v119, v119, v11
 v_sub_f32 v120, v120, v10
 v_sub_f32 v121, v121, v10
 v_sub_f32 v122, v122, v10
 v_sub_f32 v123, v123, v10
 v_sub_f32 v124, v124, v11
 v_sub_f32 v125, v125, v11
 v_sub_f32 v126, v126, v11
 v_sub_f32 v127, v127, v11
 v_sub_f32 v32, v32, v10
 v_sub_f32 v33, v33, v10
 v_sub_f32 v34, v34, v10
 v_sub_f32 v35, v35, v10
 v_sub_f32 v36, v36, v11
 v_sub_f32 v37, v37, v11
 v_sub_f32 v38, v38, v11
 v_sub_f32 v39, v39, v11
 v_exp_f32 v12, -v10
 v_exp_f32 v13, -v11
 v_mul_f32 v30, v12, v30
 v_mul_f32 v31, v13, v31
 v_mul_f32 v128, v12, v128
 v_mul_f32 v129, v12, v129
 v_mul_f32 v130, v12, v130
 v_mul_f32 v131, v12, v131
 v_mul_f32 v132, v13, v132
 v_mul_f32 v133, v13, v133
 v_mul_f32 v134, v13, v134
 v_mul_f32 v135, v13, v135
 v_mul_f32 v136, v12, v136
 v_mul_f32 v137, v12, v137
 v_mul_f32 v138, v12, v138
 v_mul_f32 v139, v12, v139
 v_mul_f32 v140, v13, v140
 v_mul_f32 v141, v13, v141
 v_mul_f32 v142, v13, v142
 v_mul_f32 v143, v13, v143
 v_mul_f32 v144, v12, v144
 v_mul_f32 v145, v12, v145
 v_mul_f32 v146, v12, v146
 v_mul_f32 v147, v12, v147
 v_mul_f32 v148, v13, v148
 v_mul_f32 v149, v13, v149
 v_mul_f32 v150, v13, v150
 v_mul_f32 v151, v13, v151
 v_mul_f32 v152, v12, v152
 v_mul_f32 v153, v12, v153
 v_mul_f32 v154, v12, v154
 v_mul_f32 v155, v12, v155
 v_mul_f32 v156, v13, v156
 v_mul_f32 v157, v13, v157
 v_mul_f32 v158, v13, v158
 v_mul_f32 v159, v13, v159
 v_mul_f32 v160, v12, v160
 v_mul_f32 v161, v12, v161
 v_mul_f32 v162, v12, v162
 v_mul_f32 v163, v12, v163
 v_mul_f32 v164, v13, v164
 v_mul_f32 v165, v13, v165
 v_mul_f32 v166, v13, v166
 v_mul_f32 v167, v13, v167
 v_mul_f32 v168, v12, v168
 v_mul_f32 v169, v12, v169
 v_mul_f32 v170, v12, v170
 v_mul_f32 v171, v12, v171
 v_mul_f32 v172, v13, v172
 v_mul_f32 v173, v13, v173
 v_mul_f32 v174, v13, v174
 v_mul_f32 v175, v13, v175
 v_mul_f32 v176, v12, v176
 v_mul_f32 v177, v12, v177
 v_mul_f32 v178, v12, v178
 v_mul_f32 v179, v12, v179
 v_mul_f32 v180, v13, v180
 v_mul_f32 v181, v13, v181
 v_mul_f32 v182, v13, v182
 v_mul_f32 v183, v13, v183
 v_mul_f32 v184, v12, v184
 v_mul_f32 v185, v12, v185
 v_mul_f32 v186, v12, v186
 v_mul_f32 v187, v12, v187
 v_mul_f32 v188, v13, v188
 v_mul_f32 v189, v13, v189
 v_mul_f32 v190, v13, v190
 v_mul_f32 v191, v13, v191
 v_mul_f32 v192, v12, v192
 v_mul_f32 v193, v12, v193
 v_mul_f32 v194, v12, v194
 v_mul_f32 v195, v12, v195
 v_mul_f32 v196, v13, v196
 v_mul_f32 v197, v13, v197
 v_mul_f32 v198, v13, v198
 v_mul_f32 v199, v13, v199
 v_mul_f32 v200, v12, v200
 v_mul_f32 v201, v12, v201
 v_mul_f32 v202, v12, v202
 v_mul_f32 v203, v12, v203
 v_mul_f32 v204, v13, v204
 v_mul_f32 v205, v13, v205
 v_mul_f32 v206, v13, v206
 v_mul_f32 v207, v13, v207
 v_mul_f32 v208, v12, v208
 v_mul_f32 v209, v12, v209
 v_mul_f32 v210, v12, v210
 v_mul_f32 v211, v12, v211
 v_mul_f32 v212, v13, v212
 v_mul_f32 v213, v13, v213
 v_mul_f32 v214, v13, v214
 v_mul_f32 v215, v13, v215
 v_mul_f32 v216, v12, v216
 v_mul_f32 v217, v12, v217
 v_mul_f32 v218, v12, v218
 v_mul_f32 v219, v12, v219
 v_mul_f32 v220, v13, v220
 v_mul_f32 v221, v13, v221
 v_mul_f32 v222, v13, v222
 v_mul_f32 v223, v13, v223
 v_mul_f32 v224, v12, v224
 v_mul_f32 v225, v12, v225
 v_mul_f32 v226, v12, v226
 v_mul_f32 v227, v12, v227
 v_mul_f32 v228, v13, v228
 v_mul_f32 v229, v13, v229
 v_mul_f32 v230, v13, v230
 v_mul_f32 v231, v13, v231
 v_mul_f32 v232, v12, v232
 v_mul_f32 v233, v12, v233
 v_mul_f32 v234, v12, v234
 v_mul_f32 v235, v12, v235
 v_mul_f32 v236, v13, v236
 v_mul_f32 v237, v13, v237
 v_mul_f32 v238, v13, v238
 v_mul_f32 v239, v13, v239
 v_mul_f32 v240, v12, v240
 v_mul_f32 v241, v12, v241
 v_mul_f32 v242, v12, v242
 v_mul_f32 v243, v12, v243
 v_mul_f32 v244, v13, v244
 v_mul_f32 v245, v13, v245
 v_mul_f32 v246, v13, v246
 v_mul_f32 v247, v13, v247
 v_mul_f32 v248, v12, v248
 v_mul_f32 v249, v12, v249
 v_mul_f32 v250, v12, v250
 v_mul_f32 v251, v12, v251
 v_mul_f32 v252, v13, v252
 v_mul_f32 v253, v13, v253
 v_mul_f32 v254, v13, v254
 v_mul_f32 v255, v13, v255
 v_exp_f32 v18, v96
 v_exp_f32 v19, v97
 v_exp_f32 v20, v98
 v_add_f32 v28, v18, v19
 v_cvt_pk_bf16_f32 v48, v18, v19
 v_exp_f32 v21, v99
 v_exp_f32 v22, v104
 v_add_f32 v28, v20, v28
 v_cvt_pk_bf16_f32 v49, v20, v21
 v_exp_f32 v23, v105
 v_add_f32 v28, v21, v28
 v_exp_f32 v24, v106
 v_add_f32 v28, v22, v28
 v_cvt_pk_bf16_f32 v50, v22, v23
 v_exp_f32 v25, v107
 v_add_f32 v28, v23, v28
 v_exp_f32 v18, v100
 v_add_f32 v28, v24, v28
 v_cvt_pk_bf16_f32 v51, v24, v25
 v_exp_f32 v19, v101
 v_add_f32 v28, v25, v28
 v_exp_f32 v20, v102
 v_add_f32 v29, v18, v19
 v_cvt_pk_bf16_f32 v52, v18, v19
 v_exp_f32 v21, v103
 v_exp_f32 v22, v108
 v_add_f32 v29, v20, v29
 v_cvt_pk_bf16_f32 v53, v20, v21
 v_exp_f32 v23, v109
 v_add_f32 v29, v21, v29
 v_exp_f32 v24, v110
 v_add_f32 v29, v22, v29
 v_cvt_pk_bf16_f32 v54, v22, v23
 v_exp_f32 v25, v111
 v_add_f32 v29, v23, v29
 v_add_f32 v29, v24, v29
 v_cvt_pk_bf16_f32 v55, v24, v25
 v_add_f32 v29, v25, v29
 v_exp_f32 v18, v112
 v_exp_f32 v19, v113
 v_exp_f32 v20, v114
 v_add_f32 v28, v18, v28
 v_cvt_pk_bf16_f32 v56, v18, v19
 v_exp_f32 v21, v115
 v_add_f32 v28, v19, v28
 v_exp_f32 v22, v120
 v_add_f32 v28, v20, v28
 v_cvt_pk_bf16_f32 v57, v20, v21
 v_exp_f32 v23, v121
 v_add_f32 v28, v21, v28
 v_exp_f32 v24, v122
 v_add_f32 v28, v22, v28
 v_cvt_pk_bf16_f32 v58, v22, v23
 v_exp_f32 v25, v123
 v_add_f32 v28, v23, v28
 v_exp_f32 v18, v116
 v_add_f32 v28, v24, v28
 v_cvt_pk_bf16_f32 v59, v24, v25
 v_exp_f32 v19, v117
 v_add_f32 v28, v25, v28
 v_exp_f32 v20, v118
 v_add_f32 v29, v18, v29
 v_cvt_pk_bf16_f32 v60, v18, v19
 v_exp_f32 v21, v119
 v_add_f32 v29, v19, v29
 v_exp_f32 v22, v124
 v_add_f32 v29, v20, v29
 v_cvt_pk_bf16_f32 v61, v20, v21
 v_exp_f32 v23, v125
 v_add_f32 v29, v21, v29
 v_exp_f32 v24, v126
 v_add_f32 v29, v22, v29
 v_cvt_pk_bf16_f32 v62, v22, v23
 v_exp_f32 v25, v127
 v_add_f32 v29, v23, v29
 v_add_f32 v29, v24, v29
 v_cvt_pk_bf16_f32 v63, v24, v25
 v_add_f32 v29, v25, v29
 s_nop 3
 s_setpc_b64 s[36:37]
L_slow0B:
 s_nop 7
 s_nop 3
 v_max3_f32 v10, v64, v65, v66
 v_max3_f32 v10, v67, v72, v10
 v_max3_f32 v10, v73, v74, v10
 v_max3_f32 v10, v75, v80, v10
 v_max3_f32 v10, v81, v82, v10
 v_max3_f32 v10, v83, v88, v10
 v_max3_f32 v10, v89, v90, v10
 v_max_f32 v10, v91, v10
 v_max3_f32 v11, v68, v69, v70
 v_max3_f32 v11, v71, v76, v11
 v_max3_f32 v11, v77, v78, v11
 v_max3_f32 v11, v79, v84, v11
 v_max3_f32 v11, v85, v86, v11
 v_max3_f32 v11, v87, v92, v11
 v_max3_f32 v11, v93, v94, v11
 v_max_f32 v11, v95, v11
 v_mov_b32 v12, v10
 v_mov_b32 v13, v11
 s_nop 0
 v_permlane16_swap_b32 v12, v10
 v_permlane16_swap_b32 v13, v11
 v_max_f32 v10, v12, v10
 v_max_f32 v11, v13, v11
 v_mov_b32 v12, v10
 v_mov_b32 v13, v11
 s_nop 0
 v_permlane32_swap_b32 v12, v10
 v_permlane32_swap_b32 v13, v11
 v_max_f32 v10, v12, v10
 v_max_f32 v11, v13, v11
 v_ceil_f32 v10, v10
 v_ceil_f32 v11, v11
 v_max_f32 v10, 0, v10
 v_max_f32 v11, 0, v11
 v_sub_f32 v64, v64, v10
 v_sub_f32 v65, v65, v10
 v_sub_f32 v66, v66, v10
 v_sub_f32 v67, v67, v10
 v_sub_f32 v68, v68, v11
 v_sub_f32 v69, v69, v11
 v_sub_f32 v70, v70, v11
 v_sub_f32 v71, v71, v11
 v_sub_f32 v72, v72, v10
 v_sub_f32 v73, v73, v10
 v_sub_f32 v74, v74, v10
 v_sub_f32 v75, v75, v10
 v_sub_f32 v76, v76, v11
 v_sub_f32 v77, v77, v11
 v_sub_f32 v78, v78, v11
 v_sub_f32 v79, v79, v11
 v_sub_f32 v80, v80, v10
 v_sub_f32 v81, v81, v10
 v_sub_f32 v82, v82, v10
 v_sub_f32 v83, v83, v10
 v_sub_f32 v84, v84, v11
 v_sub_f32 v85, v85, v11
 v_sub_f32 v86, v86, v11
 v_sub_f32 v87, v87, v11
 v_sub_f32 v88, v88, v10
 v_sub_f32 v89, v89, v10
 v_sub_f32 v90, v90, v10
 v_sub_f32 v91, v91, v10
 v_sub_f32 v92, v92, v11
 v_sub_f32 v93, v93, v11
 v_sub_f32 v94, v94, v11
 v_sub_f32 v95, v95, v11
 v_sub_f32 v100, v100, v11
 v_sub_f32 v101, v101, v11
 v_sub_f32 v102, v102, v11
 v_sub_f32 v103, v103, v11
 v_sub_f32 v108, v108, v11
 v_sub_f32 v109, v109, v11
 v_sub_f32 v110, v110, v11
 v_sub_f32 v111, v111, v11
 v_sub_f32 v116, v116, v11
 v_sub_f32 v117, v117, v11
 v_sub_f32 v118, v118, v11
 v_sub_f32 v119, v119, v11
 v_sub_f32 v124, v124, v11
 v_sub_f32 v125, v125, v11
 v_sub_f32 v126, v126, v11
 v_sub_f32 v127, v127, v11
 v_sub_f32 v32, v32, v10
 v_sub_f32 v33, v33, v10
 v_sub_f32 v34, v34, v10
 v_sub_f32 v35, v35, v10
 v_sub_f32 v36, v36, v11
 v_sub_f32 v37, v37, v11
 v_sub_f32 v38, v38, v11
 v_sub_f32 v39, v39, v11
 v_exp_f32 v12, -v10
 v_exp_f32 v13, -v11
 v_mul_f32 v30, v12, v30
 v_mul_f32 v31, v13, v31
 v_mul_f32 v128, v12, v128
 v_mul_f32 v129, v12, v129
 v_mul_f32 v130, v12, v130
 v_mul_f32 v131, v12, v131
 v_mul_f32 v132, v13, v132
 v_mul_f32 v133, v13, v133
 v_mul_f32 v134, v13, v134
 v_mul_f32 v135, v13, v135
 v_mul_f32 v136, v12, v136
 v_mul_f32 v137, v12, v137
 v_mul_f32 v138, v12, v138
 v_mul_f32 v139, v12, v139
 v_mul_f32 v140, v13, v140
 v_mul_f32 v141, v13, v141
 v_mul_f32 v142, v13, v142
 v_mul_f32 v143, v13, v143
 v_mul_f32 v144, v12, v144
 v_mul_f32 v145, v12, v145
 v_mul_f32 v146, v12, v146
 v_mul_f32 v147, v12, v147
 v_mul_f32 v148, v13, v148
 v_mul_f32 v149, v13, v149
 v_mul_f32 v150, v13, v150
 v_mul_f32 v151, v13, v151
 v_mul_f32 v152, v12, v152
 v_mul_f32 v153, v12, v153
 v_mul_f32 v154, v12, v154
 v_mul_f32 v155, v12, v155
 v_mul_f32 v156, v13, v156
 v_mul_f32 v157, v13, v157
 v_mul_f32 v158, v13, v158
 v_mul_f32 v159, v13, v159
 v_mul_f32 v160, v12, v160
 v_mul_f32 v161, v12, v161
 v_mul_f32 v162, v12, v162
 v_mul_f32 v163, v12, v163
 v_mul_f32 v164, v13, v164
 v_mul_f32 v165, v13, v165
 v_mul_f32 v166, v13, v166
 v_mul_f32 v167, v13, v167
 v_mul_f32 v168, v12, v168
 v_mul_f32 v169, v12, v169
 v_mul_f32 v170, v12, v170
 v_mul_f32 v171, v12, v171
 v_mul_f32 v172, v13, v172
 v_mul_f32 v173, v13, v173
 v_mul_f32 v174, v13, v174
 v_mul_f32 v175, v13, v175
 v_mul_f32 v176, v12, v176
 v_mul_f32 v177, v12, v177
 v_mul_f32 v178, v12, v178
 v_mul_f32 v179, v12, v179
 v_mul_f32 v180, v13, v180
 v_mul_f32 v181, v13, v181
 v_mul_f32 v182, v13, v182
 v_mul_f32 v183, v13, v183
 v_mul_f32 v184, v12, v184
 v_mul_f32 v185, v12, v185
 v_mul_f32 v186, v12, v186
 v_mul_f32 v187, v12, v187
 v_mul_f32 v188, v13, v188
 v_mul_f32 v189, v13, v189
 v_mul_f32 v190, v13, v190
 v_mul_f32 v191, v13, v191
 v_mul_f32 v192, v12, v192
 v_mul_f32 v193, v12, v193
 v_mul_f32 v194, v12, v194
 v_mul_f32 v195, v12, v195
 v_mul_f32 v196, v13, v196
 v_mul_f32 v197, v13, v197
 v_mul_f32 v198, v13, v198
 v_mul_f32 v199, v13, v199
 v_mul_f32 v200, v12, v200
 v_mul_f32 v201, v12, v201
 v_mul_f32 v202, v12, v202
 v_mul_f32 v203, v12, v203
 v_mul_f32 v204, v13, v204
 v_mul_f32 v205, v13, v205
 v_mul_f32 v206, v13, v206
 v_mul_f32 v207, v13, v207
 v_mul_f32 v208, v12, v208
 v_mul_f32 v209, v12, v209
 v_mul_f32 v210, v12, v210
 v_mul_f32 v211, v12, v211
 v_mul_f32 v212, v13, v212
 v_mul_f32 v213, v13, v213
 v_mul_f32 v214, v13, v214
 v_mul_f32 v215, v13, v215
 v_mul_f32 v216, v12, v216
 v_mul_f32 v217, v12, v217
 v_mul_f32 v218, v12, v218
 v_mul_f32 v219, v12, v219
 v_mul_f32 v220, v13, v220
 v_mul_f32 v221, v13, v221
 v_mul_f32 v222, v13, v222
 v_mul_f32 v223, v13, v223
 v_mul_f32 v224, v12, v224
 v_mul_f32 v225, v12, v225
 v_mul_f32 v226, v12, v226
 v_mul_f32 v227, v12, v227
 v_mul_f32 v228, v13, v228
 v_mul_f32 v229, v13, v229
 v_mul_f32 v230, v13, v230
 v_mul_f32 v231, v13, v231
 v_mul_f32 v232, v12, v232
 v_mul_f32 v233, v12, v233
 v_mul_f32 v234, v12, v234
 v_mul_f32 v235, v12, v235
 v_mul_f32 v236, v13, v236
 v_mul_f32 v237, v13, v237
 v_mul_f32 v238, v13, v238
 v_mul_f32 v239, v13, v239
 v_mul_f32 v240, v12, v240
 v_mul_f32 v241, v12, v241
 v_mul_f32 v242, v12, v242
 v_mul_f32 v243, v12, v243
 v_mul_f32 v244, v13, v244
 v_mul_f32 v245, v13, v245
 v_mul_f32 v246, v13, v246
 v_mul_f32 v247, v13, v247
 v_mul_f32 v248, v12, v248
 v_mul_f32 v249, v12, v249
 v_mul_f32 v250, v12, v250
 v_mul_f32 v251, v12, v251
 v_mul_f32 v252, v13, v252
 v_mul_f32 v253, v13, v253
 v_mul_f32 v254, v13, v254
 v_mul_f32 v255, v13, v255
 v_exp_f32 v18, v64
 v_exp_f32 v19, v65
 v_exp_f32 v20, v66
 v_add_f32 v26, v18, v19
 v_cvt_pk_bf16_f32 v40, v18, v19
 v_exp_f32 v21, v67
 v_exp_f32 v22, v72
 v_add_f32 v26, v20, v26
 v_cvt_pk_bf16_f32 v41, v20, v21
 v_exp_f32 v23, v73
 v_add_f32 v26, v21, v26
 v_exp_f32 v24, v74
 v_add_f32 v26, v22, v26
 v_cvt_pk_bf16_f32 v42, v22, v23
 v_exp_f32 v25, v75
 v_add_f32 v26, v23, v26
 v_exp_f32 v18, v68
 v_add_f32 v26, v24, v26
 v_cvt_pk_bf16_f32 v43, v24, v25
 v_exp_f32 v19, v69
 v_add_f32 v26, v25, v26
 v_exp_f32 v20, v70
 v_add_f32 v27, v18, v19
 v_cvt_pk_bf16_f32 v44, v18, v19
 v_exp_f32 v21, v71
 v_exp_f32 v22, v76
 v_add_f32 v27, v20, v27
 v_cvt_pk_bf16_f32 v45, v20, v21
 v_exp_f32 v23, v77
 v_add_f32 v27, v21, v27
 v_exp_f32 v24, v78
 v_add_f32 v27, v22, v27
 v_cvt_pk_bf16_f32 v46, v22, v23
 v_exp_f32 v25, v79
 v_add_f32 v27, v23, v27
 v_add_f32 v27, v24, v27
 v_cvt_pk_bf16_f32 v47, v24, v25
 v_add_f32 v27, v25, v27
 v_exp_f32 v18, v80
 v_exp_f32 v19, v81
 v_exp_f32 v20, v82
 v_add_f32 v26, v18, v26
 v_cvt_pk_bf16_f32 v56, v18, v19
 v_exp_f32 v21, v83
 v_add_f32 v26, v19, v26
 v_exp_f32 v22, v88
 v_add_f32 v26, v20, v26
 v_cvt_pk_bf16_f32 v57, v20, v21
 v_exp_f32 v23, v89
 v_add_f32 v26, v21, v26
 v_exp_f32 v24, v90
 v_add_f32 v26, v22, v26
 v_cvt_pk_bf16_f32 v58, v22, v23
 v_exp_f32 v25, v91
 v_add_f32 v26, v23, v26
 v_exp_f32 v18, v84
 v_add_f32 v26, v24, v26
 v_cvt_pk_bf16_f32 v59, v24, v25
 v_exp_f32 v19, v85
 v_add_f32 v26, v25, v26
 v_exp_f32 v20, v86
 v_add_f32 v27, v18, v27
 v_cvt_pk_bf16_f32 v60, v18, v19
 v_exp_f32 v21, v87
 v_add_f32 v27, v19, v27
 v_exp_f32 v22, v92
 v_add_f32 v27, v20, v27
 v_cvt_pk_bf16_f32 v61, v20, v21
 v_exp_f32 v23, v93
 v_add_f32 v27, v21, v27
 v_exp_f32 v24, v94
 v_add_f32 v27, v22, v27
 v_cvt_pk_bf16_f32 v62, v22, v23
 v_exp_f32 v25, v95
 v_add_f32 v27, v23, v27
 v_add_f32 v27, v24, v27
 v_cvt_pk_bf16_f32 v63, v24, v25
 v_add_f32 v27, v25, v27
 s_nop 3
 s_setpc_b64 s[36:37]
L_slowB:
 s_nop 7
 s_nop 3
 v_max3_f32 v11, v100, v101, v102
 v_max3_f32 v11, v103, v108, v11
 v_max3_f32 v11, v109, v110, v11
 v_max3_f32 v11, v111, v116, v11
 v_max3_f32 v11, v117, v118, v11
 v_max3_f32 v11, v119, v124, v11
 v_max3_f32 v11, v125, v126, v11
 v_max_f32 v11, v127, v11
 v_mov_b32 v13, v11
 s_nop 1
 v_permlane16_swap_b32 v13, v11
 v_max_f32 v11, v13, v11
 v_mov_b32 v13, v11
 s_nop 1
 v_permlane32_swap_b32 v13, v11
 v_max_f32 v11, v13, v11
 v_ceil_f32 v11, v11
 v_max_f32 v11, 0, v11
 v_sub_f32 v100, v100, v11
 v_sub_f32 v101, v101, v11
 v_sub_f32 v102, v102, v11
 v_sub_f32 v103, v103, v11
 v_sub_f32 v108, v108, v11
 v_sub_f32 v109, v109, v11
 v_sub_f32 v110, v110, v11
 v_sub_f32 v111, v111, v11
 v_sub_f32 v116, v116, v11
 v_sub_f32 v117, v117, v11
 v_sub_f32 v118, v118, v11
 v_sub_f32 v119, v119, v11
 v_sub_f32 v124, v124, v11
 v_sub_f32 v125, v125, v11
 v_sub_f32 v126, v126, v11
 v_sub_f32 v127, v127, v11
 v_sub_f32 v36, v36, v11
 v_sub_f32 v37, v37, v11
 v_sub_f32 v38, v38, v11
 v_sub_f32 v39, v39, v11
 v_exp_f32 v13, -v11
 s_nop 0
 v_mul_f32 v31, v13, v31
 v_mul_f32 v132, v13, v132
 v_mul_f32 v133, v13, v133
 v_mul_f32 v134, v13, v134
 v_mul_f32 v135, v13, v135
 v_mul_f32 v140, v13, v140
 v_mul_f32 v141, v13, v141
 v_mul_f32 v142, v13, v142
 v_mul_f32 v143, v13, v143
 v_mul_f32 v148, v13, v148
 v_mul_f32 v149, v13, v149
 v_mul_f32 v150, v13, v150
 v_mul_f32 v151, v13, v151
 v_mul_f32 v156, v13, v156
 v_mul_f32 v157, v13, v157
 v_mul_f32 v158, v13, v158
 v_mul_f32 v159, v13, v159
 v_mul_f32 v164, v13, v164
 v_mul_f32 v165, v13, v165
 v_mul_f32 v166, v13, v166
 v_mul_f32 v167, v13, v167
 v_mul_f32 v172, v13, v172
 v_mul_f32 v173, v13, v173
 v_mul_f32 v174, v13, v174
 v_mul_f32 v175, v13, v175
 v_mul_f32 v180, v13, v180
 v_mul_f32 v181, v13, v181
 v_mul_f32 v182, v13, v182
 v_mul_f32 v183, v13, v183
 v_mul_f32 v188, v13, v188
 v_mul_f32 v189, v13, v189
 v_mul_f32 v190, v13, v190
 v_mul_f32 v191, v13, v191
 v_mul_f32 v196, v13, v196
 v_mul_f32 v197, v13, v197
 v_mul_f32 v198, v13, v198
 v_mul_f32 v199, v13, v199
 v_mul_f32 v204, v13, v204
 v_mul_f32 v205, v13, v205
 v_mul_f32 v206, v13, v206
 v_mul_f32 v207, v13, v207
 v_mul_f32 v212, v13, v212
 v_mul_f32 v213, v13, v213
 v_mul_f32 v214, v13, v214
 v_mul_f32 v215, v13, v215
 v_mul_f32 v220, v13, v220
 v_mul_f32 v221, v13, v221
 v_mul_f32 v222, v13, v222
 v_mul_f32 v223, v13, v223
 v_mul_f32 v228, v13, v228
 v_mul_f32 v229, v13, v229
 v_mul_f32 v230, v13, v230
 v_mul_f32 v231, v13, v231
 v_mul_f32 v236, v13, v236
 v_mul_f32 v237, v13, v237
 v_mul_f32 v238, v13, v238
 v_mul_f32 v239, v13, v239
 v_mul_f32 v244, v13, v244
 v_mul_f32 v245, v13, v245
 v_mul_f32 v246, v13, v246
 v_mul_f32 v247, v13, v247
 v_mul_f32 v252, v13, v252
 v_mul_f32 v253, v13, v253
 v_mul_f32 v254, v13, v254
 v_mul_f32 v255, v13, v255
 v_exp_f32 v18, v100
 v_exp_f32 v19, v101
 v_exp_f32 v20, v102
 v_add_f32 v29, v18, v19
 v_cvt_pk_bf16_f32 v52, v18, v19
 v_exp_f32 v21, v103
 v_exp_f32 v22, v108
 v_add_f32 v29, v20, v29
 v_cvt_pk_bf16_f32 v53, v20, v21
 v_exp_f32 v23, v109
 v_add_f32 v29, v21, v29
 v_exp_f32 v24, v110
 v_add_f32 v29, v22, v29
 v_cvt_pk_bf16_f32 v54, v22, v23
 v_exp_f32 v25, v111
 v_add_f32 v29, v23, v29
 v_exp_f32 v18, v116
 v_add_f32 v29, v24, v29
 v_cvt_pk_bf16_f32 v55, v24, v25
 v_exp_f32 v19, v117
 v_add_f32 v29, v25, v29
 v_exp_f32 v20, v118
 v_add_f32 v29, v18, v29
 v_cvt_pk_bf16_f32 v48, v18, v19
 v_exp_f32 v21, v119
 v_add_f32 v29, v19, v29
 v_exp_f32 v22, v124
 v_add_f32 v29, v20, v29
 v_cvt_pk_bf16_f32 v49, v20, v21
 v_exp_f32 v23, v125
 v_add_f32 v29, v21, v29
 v_exp_f32 v24, v126
 v_add_f32 v29, v22, v29
 v_cvt_pk_bf16_f32 v50, v22, v23
 v_exp_f32 v25, v127
 v_add_f32 v29, v23, v29
 v_add_f32 v29, v24, v29
 v_cvt_pk_bf16_f32 v51, v24, v25
 v_add_f32 v29, v25, v29
 s_nop 3
 s_setpc_b64 s[36:37]
L_slowf:
 s_nop 7
 s_nop 3
 v_max3_f32 v10, v64, v65, v66
 v_max3_f32 v10, v67, v72, v10
 v_max3_f32 v10, v73, v74, v10
 v_max3_f32 v10, v75, v80, v10
 v_max3_f32 v10, v81, v82, v10
 v_max3_f32 v10, v83, v88, v10
 v_max3_f32 v10, v89, v90, v10
 v_max_f32 v10, v91, v10
 v_max3_f32 v11, v68, v69, v70
 v_max3_f32 v11, v71, v76, v11
 v_max3_f32 v11, v77, v78, v11
 v_max3_f32 v11, v79, v84, v11
 v_max3_f32 v11, v85, v86, v11
 v_max3_f32 v11, v87, v92, v11
 v_max3_f32 v11, v93, v94, v11
 v_max_f32 v11, v95, v11
 v_mov_b32 v12, v10
 v_mov_b32 v13, v11
 s_nop 0
 v_permlane16_swap_b32 v12, v10
 v_permlane16_swap_b32 v13, v11
 v_max_f32 v10, v12, v10
 v_max_f32 v11, v13, v11
 v_mov_b32 v12, v10
 v_mov_b32 v13, v11
 s_nop 0
 v_permlane32_swap_b32 v12, v10
 v_permlane32_swap_b32 v13, v11
 v_max_f32 v10, v12, v10
 v_max_f32 v11, v13, v11
 v_ceil_f32 v10, v10
 v_ceil_f32 v11, v11
 v_sub_f32 v64, v64, v10
 v_sub_f32 v65, v65, v10
 v_sub_f32 v66, v66, v10
 v_sub_f32 v67, v67, v10
 v_sub_f32 v68, v68, v11
 v_sub_f32 v69, v69, v11
 v_sub_f32 v70, v70, v11
 v_sub_f32 v71, v71, v11
 v_sub_f32 v72, v72, v10
 v_sub_f32 v73, v73, v10
 v_sub_f32 v74, v74, v10
 v_sub_f32 v75, v75, v10
 v_sub_f32 v76, v76, v11
 v_sub_f32 v77, v77, v11
 v_sub_f32 v78, v78, v11
 v_sub_f32 v79, v79, v11
 v_sub_f32 v80, v80, v10
 v_sub_f32 v81, v81, v10
 v_sub_f32 v82, v82, v10
 v_sub_f32 v83, v83, v10
 v_sub_f32 v84, v84, v11
 v_sub_f32 v85, v85, v11
 v_sub_f32 v86, v86, v11
 v_sub_f32 v87, v87, v11
 v_sub_f32 v88, v88, v10
 v_sub_f32 v89, v89, v10
 v_sub_f32 v90, v90, v10
 v_sub_f32 v91, v91, v10
 v_sub_f32 v92, v92, v11
 v_sub_f32 v93, v93, v11
 v_sub_f32 v94, v94, v11
 v_sub_f32 v95, v95, v11
 v_sub_f32 v96, v96, v10
 v_sub_f32 v97, v97, v10
 v_sub_f32 v98, v98, v10
 v_sub_f32 v99, v99, v10
 v_sub_f32 v100, v100, v11
 v_sub_f32 v101, v101, v11
 v_sub_f32 v102, v102, v11
 v_sub_f32 v103, v103, v11
 v_sub_f32 v104, v104, v10
 v_sub_f32 v105, v105, v10
 v_sub_f32 v106, v106, v10
 v_sub_f32 v107, v107, v10
 v_sub_f32 v108, v108, v11
 v_sub_f32 v109, v109, v11
 v_sub_f32 v110, v110, v11
 v_sub_f32 v111, v111, v11
 v_sub_f32 v112, v112, v10
 v_sub_f32 v113, v113, v10
 v_sub_f32 v114, v114, v10
 v_sub_f32 v115, v115, v10
 v_sub_f32 v116, v116, v11
 v_sub_f32 v117, v117, v11
 v_sub_f32 v118, v118, v11
 v_sub_f32 v119, v119, v11
 v_sub_f32 v120, v120, v10
 v_sub_f32 v121, v121, v10
 v_sub_f32 v122, v122, v10
 v_sub_f32 v123, v123, v10
 v_sub_f32 v124, v124, v11
 v_sub_f32 v125, v125, v11
 v_sub_f32 v126, v126, v11
 v_sub_f32 v127, v127, v11
 v_sub_f32 v32, v32, v10
 v_sub_f32 v33, v33, v10
 v_sub_f32 v34, v34, v10
 v_sub_f32 v35, v35, v10
 v_sub_f32 v36, v36, v11
 v_sub_f32 v37, v37, v11
 v_sub_f32 v38, v38, v11
 v_sub_f32 v39, v39, v11
 v_exp_f32 v18, v64
 v_exp_f32 v19, v65
 v_exp_f32 v20, v66
 v_add_f32 v26, v18, v19
 v_cvt_pk_bf16_f32 v40, v18, v19
 v_exp_f32 v21, v67
 v_exp_f32 v22, v72
 v_add_f32 v26, v20, v26
 v_cvt_pk_bf16_f32 v41, v20, v21
 v_exp_f32 v23, v73
 v_add_f32 v26, v21, v26
 v_exp_f32 v24, v74
 v_add_f32 v26, v22, v26
 v_cvt_pk_bf16_f32 v42, v22, v23
 v_exp_f32 v25, v75
 v_add_f32 v26, v23, v26
 v_exp_f32 v18, v68
 v_add_f32 v26, v24, v26
 v_cvt_pk_bf16_f32 v43, v24, v25
 v_exp_f32 v19, v69
 v_add_f32 v26, v25, v26
 v_exp_f32 v20, v70
 v_add_f32 v27, v18, v19
 v_cvt_pk_bf16_f32 v44, v18, v19
 v_exp_f32 v21, v71
 v_exp_f32 v22, v76
 v_add_f32 v27, v20, v27
 v_cvt_pk_bf16_f32 v45, v20, v21
 v_exp_f32 v23, v77
 v_add_f32 v27, v21, v27
 v_exp_f32 v24, v78
 v_add_f32 v27, v22, v27
 v_cvt_pk_bf16_f32 v46, v22, v23
 v_exp_f32 v25, v79
 v_add_f32 v27, v23, v27
 v_add_f32 v27, v24, v27
 v_cvt_pk_bf16_f32 v47, v24, v25
 v_add_f32 v27, v25, v27
 v_exp_f32 v18, v80
 v_exp_f32 v19, v81
 v_exp_f32 v20, v82
 v_add_f32 v26, v18, v26
 v_cvt_pk_bf16_f32 v56, v18, v19
 v_exp_f32 v21, v83
 v_add_f32 v26, v19, v26
 v_exp_f32 v22, v88
 v_add_f32 v26, v20, v26
 v_cvt_pk_bf16_f32 v57, v20, v21
 v_exp_f32 v23, v89
 v_add_f32 v26, v21, v26
 v_exp_f32 v24, v90
 v_add_f32 v26, v22, v26
 v_cvt_pk_bf16_f32 v58, v22, v23
 v_exp_f32 v25, v91
 v_add_f32 v26, v23, v26
 v_exp_f32 v18, v84
 v_add_f32 v26, v24, v26
 v_cvt_pk_bf16_f32 v59, v24, v25
 v_exp_f32 v19, v85
 v_add_f32 v26, v25, v26
 v_exp_f32 v20, v86
 v_add_f32 v27, v18, v27
 v_cvt_pk_bf16_f32 v60, v18, v19
 v_exp_f32 v21, v87
 v_add_f32 v27, v19, v27
 v_exp_f32 v22, v92
 v_add_f32 v27, v20, v27
 v_cvt_pk_bf16_f32 v61, v20, v21
 v_exp_f32 v23, v93
 v_add_f32 v27, v21, v27
 v_exp_f32 v24, v94
 v_add_f32 v27, v22, v27
 v_cvt_pk_bf16_f32 v62, v22, v23
 v_exp_f32 v25, v95
 v_add_f32 v27, v23, v27
 v_add_f32 v27, v24, v27
 v_cvt_pk_bf16_f32 v63, v24, v25
 v_add_f32 v27, v25, v27
 s_nop 3
 s_setpc_b64 s[36:37]
L_moe0:
 s_lshl_b32 s88, s75, 1
 s_call_b64 s[36:37], L_moe
 v_add_f32 v32, v108, v32
 v_add_f32 v33, v109, v33
 v_add_f32 v34, v110, v34
 v_add_f32 v35, v111, v35
 v_add_f32 v36, v112, v36
 v_add_f32 v37, v113, v37
 v_add_f32 v38, v114, v38
 v_add_f32 v39, v115, v39
 v_add_f32 v40, v116, v40
 v_add_f32 v41, v117, v41
 v_add_f32 v42, v118, v42
 v_add_f32 v43, v119, v43
 v_add_f32 v44, v120, v44
 v_add_f32 v45, v121, v45
 v_add_f32 v46, v122, v46
 v_add_f32 v47, v123, v47
 s_mov_b64 exec, -1
 s_branch L_moe_ret0
L_moe1:
 s_lshl_b32 s88, s86, 1
 s_call_b64 s[36:37], L_moe
 v_add_f32 v80, v108, v80
 v_add_f32 v81, v109, v81
 v_add_f32 v82, v110, v82
 v_add_f32 v83, v111, v83
 v_add_f32 v84, v112, v84
 v_add_f32 v85, v113, v85
 v_add_f32 v86, v114, v86
 v_add_f32 v87, v115, v87
 s_mov_b64 exec, -1
 s_branch L_moe_ret1
L_moe2:
 s_lshl_b32 s88, s86, 1
 s_call_b64 s[36:37], L_moe
 v_add_f32 v32, v108, v32
 v_add_f32 v33, v109, v33
 v_add_f32 v34, v110, v34
 v_add_f32 v35, v111, v35
 v_add_f32 v36, v112, v36
 v_add_f32 v37, v113, v37
 v_add_f32 v38, v114, v38
 v_add_f32 v39, v115, v39
 s_mov_b64 exec, -1
 s_branch L_moe_ret2
L_moe:
 v_min_u32 v104, 27, v0
 v_lshlrev_b32 v104, 2, v104
 s_mov_b32 s64, 105062912
 s_mov_b32 s65, 65536
 s_mov_b32 exec_lo, 0xffffffff
 s_mov_b32 exec_hi, 0xffffffff
L_pfy:
 buffer_load_dword v105, v104, s[8:11], s64 offen sc1
 s_sub_u32 s65, s65, 1
 s_cbranch_scc1 L_pfy_x
 s_waitcnt vmcnt(0)
 v_cmp_ne_u32 vcc, 1, v105
 s_nop 0
 s_cbranch_vccz L_pfy_x
 s_sleep 2
 s_branch L_pfy
L_pfy_x:
 s_waitcnt vmcnt(0)
 s_mov_b64 exec, -1
 s_or_b64 exec, s[80:81], s[82:83]
 v_mov_b32 v104, 1792
 v_cndmask_b32 v104, v104, 0, s[80:81]
 v_lshl_add_u32 v104, v11, 5, v104
 s_add_u32 s88, s88, 104898560
 buffer_load_dwordx4 v[108:111], v104, s[8:11], s88 offen sc1
 buffer_load_dwordx4 v[112:115], v104, s[8:11], s88 offen offset:16 sc1
 buffer_load_dwordx4 v[116:119], v104, s[8:11], s88 offen offset:512 sc1
 buffer_load_dwordx4 v[120:123], v104, s[8:11], s88 offen offset:528 sc1
 s_waitcnt vmcnt(0)
 s_setpc_b64 s[36:37]
L_y1:
 s_lshl_b32 s89, s41, 1
 s_add_u32 s89, s89, s20
 s_cmp_ge_u32 s20, 2
 s_cselect_b32 s89, 28, s89
 s_cmp_ge_u32 s89, 28
 s_cbranch_scc1 L_y1r
 v_lshrrev_b32 v50, 4, v7
 v_lshrrev_b32 v51, 3, v50
 v_mul_u32_u24 v51, 4352, v51
 v_and_b32 v52, 7, v50
 v_lshl_add_u32 v51, v52, 7, v51
 s_mov_b32 s90, 104923136
 s_mov_b32 s88, 104957952
 s_mov_b32 s91, 65536
L_yp:
 buffer_load_dword v52, v51, s[8:11], s90 offen sc1
 buffer_load_dword v53, v51, s[8:11], s88 offen sc1
 s_waitcnt vmcnt(0)
 v_min_u32 v52, v52, v53
 v_cmp_gt_u32 vcc, 4, v52
 s_sub_u32 s91, s91, 1
 s_cbranch_scc1 L_ypx
 s_cbranch_vccnz L_yp
L_ypx:
 s_cmp_lt_u32 s89, 14
 s_cselect_b32 s90, 8, 12
 s_add_u32 s90, s90, 104890368
 buffer_load_dword v53, off, s[8:11], s90 sc1
 v_lshrrev_b32 v51, 3, v50
 v_mul_u32_u24 v51, 3584, v51
 v_and_b32 v52, 7, v50
 v_lshl_add_u32 v51, v52, 4, v51
 s_lshl_b32 s88, s89, 7
 s_add_u32 s90, s88, 104898560
 s_add_u32 s88, s88, 105906176
 buffer_load_dwordx4 v[136:139], v51, s[8:11], s88 offen sc1
 s_add_u32 s88, s88, 28672
 buffer_load_dwordx4 v[140:143], v51, s[8:11], s88 offen sc1
 s_add_u32 s88, s88, 28672
 buffer_load_dwordx4 v[152:155], v51, s[8:11], s88 offen sc1
 s_add_u32 s88, s88, 28672
 buffer_load_dwordx4 v[156:159], v51, s[8:11], s88 offen sc1
 s_add_u32 s88, s88, 28672
 buffer_load_dwordx4 v[168:171], v51, s[8:11], s88 offen sc1
 s_add_u32 s88, s88, 28672
 buffer_load_dwordx4 v[172:175], v51, s[8:11], s88 offen sc1
 s_add_u32 s88, s88, 28672
 buffer_load_dwordx4 v[184:187], v51, s[8:11], s88 offen sc1
 s_add_u32 s88, s88, 28672
 buffer_load_dwordx4 v[188:191], v51, s[8:11], s88 offen sc1
 s_add_u32 s88, s88, 28672
 buffer_load_dwordx4 v[200:203], v51, s[8:11], s88 offen sc1
 s_add_u32 s88, s88, 28672
 buffer_load_dwordx4 v[204:207], v51, s[8:11], s88 offen sc1
 s_add_u32 s88, s88, 28672
 buffer_load_dwordx4 v[216:219], v51, s[8:11], s88 offen sc1
 s_add_u32 s88, s88, 28672
 buffer_load_dwordx4 v[220:223], v51, s[8:11], s88 offen sc1
 s_add_u32 s88, s88, 28672
 buffer_load_dwordx4 v[232:235], v51, s[8:11], s88 offen sc1
 s_add_u32 s88, s88, 28672
 buffer_load_dwordx4 v[236:239], v51, s[8:11], s88 offen sc1
 s_add_u32 s88, s88, 28672
 s_branch L_y1r
L_y2:
 s_cmp_ge_u32 s89, 28
 s_cbranch_scc1 L_y2r
 s_waitcnt vmcnt(24)
 s_waitcnt vmcnt(12)
 v_add_f32 v136, v140, v136
 v_add_f32 v137, v141, v137
 v_add_f32 v138, v142, v138
 v_add_f32 v139, v143, v139
 s_waitcnt vmcnt(11)
 v_add_f32 v136, v152, v136
 v_add_f32 v137, v153, v137
 v_add_f32 v138, v154, v138
 v_add_f32 v139, v155, v139
 s_waitcnt vmcnt(10)
 v_add_f32 v136, v156, v136
 v_add_f32 v137, v157, v137
 v_add_f32 v138, v158, v138
 v_add_f32 v139, v159, v139
 s_waitcnt vmcnt(9)
 v_add_f32 v136, v168, v136
 v_add_f32 v137, v169, v137
 v_add_f32 v138, v170, v138
 v_add_f32 v139, v171, v139
 s_waitcnt vmcnt(8)
 v_add_f32 v136, v172, v136
 v_add_f32 v137, v173, v137
 v_add_f32 v138, v174, v138
 v_add_f32 v139, v175, v139
 s_waitcnt vmcnt(7)
 v_add_f32 v136, v184, v136
 v_add_f32 v137, v185, v137
 v_add_f32 v138, v186, v138
 v_add_f32 v139, v187, v139
 s_waitcnt vmcnt(6)
 v_add_f32 v136, v188, v136
 v_add_f32 v137, v189, v137
 v_add_f32 v138, v190, v138
 v_add_f32 v139, v191, v139
 s_waitcnt vmcnt(5)
 v_add_f32 v136, v200, v136
 v_add_f32 v137, v201, v137
 v_add_f32 v138, v202, v138
 v_add_f32 v139, v203, v139
 s_waitcnt vmcnt(4)
 v_add_f32 v136, v204, v136
 v_add_f32 v137, v205, v137
 v_add_f32 v138, v206, v138
 v_add_f32 v139, v207, v139
 s_waitcnt vmcnt(3)
 v_add_f32 v136, v216, v136
 v_add_f32 v137, v217, v137
 v_add_f32 v138, v218, v138
 v_add_f32 v139, v219, v139
 s_waitcnt vmcnt(2)
 v_add_f32 v136, v220, v136
 v_add_f32 v137, v221, v137
 v_add_f32 v138, v222, v138
 v_add_f32 v139, v223, v139
 s_waitcnt vmcnt(1)
 v_add_f32 v136, v232, v136
 v_add_f32 v137, v233, v137
 v_add_f32 v138, v234, v138
 v_add_f32 v139, v235, v139
 s_waitcnt vmcnt(0)
 v_add_f32 v136, v236, v136
 v_add_f32 v137, v237, v137
 v_add_f32 v138, v238, v138
 v_add_f32 v139, v239, v139
 v_add_f32 v136, v136, v136 row_ror:8 row_mask:0xf bank_mask:0xf
 v_add_f32 v137, v137, v137 row_ror:8 row_mask:0xf bank_mask:0xf
 v_add_f32 v138, v138, v138 row_ror:8 row_mask:0xf bank_mask:0xf
 v_add_f32 v139, v139, v139 row_ror:8 row_mask:0xf bank_mask:0xf
 v_mov_b32 v140, v136
 v_mov_b32 v141, v137
 v_mov_b32 v142, v138
 v_mov_b32 v143, v139
 v_permlane16_swap_b32 v140, v136
 v_permlane16_swap_b32 v141, v137
 v_permlane16_swap_b32 v142, v138
 v_permlane16_swap_b32 v143, v139
 v_add_f32 v136, v140, v136
 v_add_f32 v137, v141, v137
 v_add_f32 v138, v142, v138
 v_add_f32 v139, v143, v139
 v_mov_b32 v140, v136
 v_mov_b32 v141, v137
 v_mov_b32 v142, v138
 v_mov_b32 v143, v139
 v_permlane32_swap_b32 v140, v136
 v_permlane32_swap_b32 v141, v137
 v_permlane32_swap_b32 v142, v138
 v_permlane32_swap_b32 v143, v139
 v_add_f32 v136, v140, v136
 v_add_f32 v137, v141, v137
 v_add_f32 v138, v142, v138
 v_add_f32 v139, v143, v139
 v_cvt_pk_bf16_f32 v51, v136, v137
 v_lshlrev_b32 v136, 16, v51
 v_and_b32 v137, 0xffff0000, v51
 v_cvt_pk_bf16_f32 v51, v138, v139
 v_lshlrev_b32 v138, 16, v51
 v_and_b32 v139, 0xffff0000, v51
 v_mul_f32 v136, v53, v136
 v_mul_f32 v137, v53, v137
 v_mul_f32 v138, v53, v138
 v_mul_f32 v139, v53, v139
 v_cvt_pk_bf16_f32 v51, v136, v137
 v_lshlrev_b32 v136, 16, v51
 v_and_b32 v137, 0xffff0000, v51
 v_cvt_pk_bf16_f32 v51, v138, v139
 v_lshlrev_b32 v138, 16, v51
 v_and_b32 v139, 0xffff0000, v51
 s_mov_b64 exec, 0xff
 buffer_store_dwordx4 v[136:139], v7, s[8:11], s90 offen sc1
 s_mov_b64 exec, -1
 s_branch L_y2r
L_y3:
 s_cmp_ge_u32 s89, 28
 s_cbranch_scc1 L_y3r
 v_mov_b32 v52, 1
 s_lshl_b32 s89, s89, 2
 s_add_u32 s89, s89, 105062912
 s_mov_b64 exec, 1
 s_waitcnt vmcnt(5)
 buffer_store_dword v52, off, s[8:11], s89 sc1
 s_mov_b64 exec, -1
 s_branch L_y3r
L_fll:
 s_cmp_lg_u32 s39, 15
 s_cbranch_scc1 L_fll1
 v_mov_b32 v9, 0
 s_mov_b32 s46, s47
 s_mov_b32 s39, 1
L_fll1:
 buffer_load_dword v6, v9, s[8:11], s46 offen sc1
 s_branch L_fllr
L_pub3:
 v_mov_b32 v17, s3
 buffer_store_dword v17, v1, s[8:11], s45 offen sc1
 s_branch L_pub3r
L_fhs0:
 s_mov_b32 s91, 65536
L_fhs0_l:
 s_sleep 2
 buffer_load_dword v24, off, s[8:11], s79 sc1
 s_sub_u32 s91, s91, 1
 s_cbranch_scc1 L_fhs0_x
 s_waitcnt vmcnt(0)
 v_cmp_gt_u32 vcc, 1, v24
 s_nop 0
 s_cbranch_vccnz L_fhs0_l
L_fhs0_x:
 s_waitcnt vmcnt(0)
 s_branch L_fhr0
L_fhs1:
 s_mov_b32 s91, 65536
L_fhs1_l:
 s_sleep 2
 buffer_load_dword v24, off, s[8:11], s79 sc1
 s_sub_u32 s91, s91, 1
 s_cbranch_scc1 L_fhs1_x
 s_waitcnt vmcnt(0)
 v_cmp_gt_u32 vcc, 1, v24
 s_nop 0
 s_cbranch_vccnz L_fhs1_l
L_fhs1_x:
 s_waitcnt vmcnt(0)
 s_branch L_fhr1
L_fps1:
 s_mov_b32 s53, 65536
L_fps1_l:
 s_sleep 2
 buffer_load_dword v5, off, s[8:11], s47 sc1
 s_sub_u32 s53, s53, 1
 s_cbranch_scc1 L_fps1_x
 s_waitcnt vmcnt(0)
 v_cmp_ne_u32 vcc, 1, v5
 s_nop 0
 s_cbranch_vccnz L_fps1_l
L_fps1_x:
 s_waitcnt vmcnt(0)
 s_branch L_fpr1
L_f4s:
 s_mov_b32 s53, 65536
L_f4s_l:
 s_sleep 2
 buffer_load_dword v6, v9, s[8:11], s46 offen sc1
 s_sub_u32 s53, s53, 1
 s_cbranch_scc1 L_f4s_x
 s_waitcnt vmcnt(0)
 v_cmp_gt_u32 vcc, 3, v6
 s_nop 0
 s_cbranch_vccnz L_f4s_l
L_f4s_x:
 s_waitcnt vmcnt(0)
 s_branch L_f4r
L_f2s:
 s_mov_b32 s53, 65536
L_f2s_l:
 s_sleep 2
 buffer_load_dword v6, v9, s[8:11], s46 offen sc1
 s_sub_u32 s53, s53, 1
 s_cbranch_scc1 L_f2s_x
 s_waitcnt vmcnt(0)
 v_cmp_gt_u32 vcc, 3, v6
 s_nop 0
 s_cbranch_vccnz L_f2s_l
L_f2s_x:
 s_waitcnt vmcnt(0)
 s_branch L_f2r
L_fls0:
 s_mov_b32 s53, 65536
L_fls0_l:
 s_sleep 2
 buffer_load_dword v6, v9, s[8:11], s46 offen sc1
 s_sub_u32 s53, s53, 1
 s_cbranch_scc1 L_fls0_x
 s_waitcnt vmcnt(0)
 v_cmp_gt_u32 vcc, s39, v6
 s_nop 0
 s_cbranch_vccnz L_fls0_l
L_fls0_x:
 s_waitcnt vmcnt(0)
 s_branch L_flr0
L_code_end:
.section .rodata,"a"
.p2align 6
.amdhsa_kernel gated_mix__compressed_kv_cla__moe_arch_mod__prompt_kernel
  .amdhsa_next_free_vgpr 512
  .amdhsa_next_free_sgpr 102
  .amdhsa_accum_offset 256
  .amdhsa_group_segment_fixed_size 0
  .amdhsa_kernarg_size 120
  .amdhsa_user_sgpr_count 2
  .amdhsa_user_sgpr_kernarg_segment_ptr 1
  .amdhsa_system_sgpr_workgroup_id_x 1
  .amdhsa_float_denorm_mode_32 3
.end_amdhsa_kernel
```

```asm
; @launch grid=(256,1,1) block=(256,1,1) lds=163840
.amdgcn_target "amdgcn-amd-amdhsa--gfx950"
.text
.macro M d, a, b, c
v_mfma_f32_16x16x32_bf16 \d, \a, \b, \c
.endm
.globl gated_mix__compressed_kv_cla__moe_arch_mod__prompt_kernel
.p2align 8
.type gated_mix__compressed_kv_cla__moe_arch_mod__prompt_kernel,@function
gated_mix__compressed_kv_cla__moe_arch_mod__prompt_kernel:
 s_cmp_lt_u32 s2, 256
 s_cbranch_scc1 L_go
 s_endpgm
L_go:
 s_load_dwordx8 s[80:87], s[0:1], 0
 s_load_dwordx4 s[88:91], s[0:1], 32
 s_load_dwordx2 s[92:93], s[0:1], 56
 s_load_dwordx2 s[30:31], s[0:1], 88
 s_load_dwordx4 s[4:7], s[0:1], 104
 v_lshrrev_b32 v24, 6, v0
 v_and_b32 v0, 63, v0
 v_readfirstlane_b32 s20, v24
 s_getpc_b64 s[76:77]
L_pc0:
 s_and_b32 s77, s77, 0xffff
 s_mov_b32 s78, L_code_end-L_pc0
 s_mov_b32 s79, 0x20000
 s_lshr_b32 s64, s2, 3
 s_lshl_b32 s64, s64, 2
 s_add_u32 s64, s64, s20
 s_lshl_b32 s95, s64, 11
 v_lshl_add_u32 v29, v0, 7, s95
 v_and_b32 v28, 48, v0
 v_lshl_add_u32 v28, v28, 24, v29
 buffer_load_dword a240, v28, s[76:79], 0 offen offset:0
 s_and_b32 s41, s2, 7
 s_lshr_b32 s42, s2, 3
 s_lshr_b32 s64, s42, 4
 s_lshl_b32 s64, s64, 3
 s_add_u32 s41, s41, s64
 s_and_b32 s42, s42, 15
 s_lshr_b32 s45, s42, 3
 s_xor_b32 s45, s45, 1
 s_mov_b32 s44, 0
 v_accvgpr_write_b32 a250, 0
 v_accvgpr_write_b32 a251, 0
 v_and_b32 v24, 15, v0
 v_lshrrev_b32 v25, 4, v0
 v_lshlrev_b32 v7, 4, v0
 s_and_b32 s65, s20, 1
 s_lshr_b32 s66, s20, 1
 v_or_b32 v28, 0, v25
 v_lshlrev_b32 v28, 1, v28
 v_xor_b32 v28, v28, v24
 v_lshrrev_b32 v29, 3, v28
 v_lshlrev_b32 v29, 8, v29
 v_and_b32 v28, 7, v28
 v_lshl_add_u32 v28, v28, 4, v29
 v_lshl_add_u32 v28, v25, 13, v28
 s_lshl_b32 s64, s20, 17
 s_add_u32 s64, s64, 0
 v_add_u32 v8, s64, v28
 v_add_u32 v9, 31744, v8
 v_or_b32 v28, 4, v25
 v_lshlrev_b32 v28, 1, v28
 v_xor_b32 v28, v28, v24
 v_lshrrev_b32 v29, 3, v28
 v_lshlrev_b32 v29, 8, v29
 v_and_b32 v28, 7, v28
 v_lshl_add_u32 v28, v28, 4, v29
 v_lshl_add_u32 v28, v25, 13, v28
 s_lshl_b32 s64, s20, 17
 s_add_u32 s64, s64, 63488
 v_add_u32 v10, s64, v28
 v_add_u32 v11, 31744, v10
 v_add_u32 v28, 0, v25
 v_and_b32 v29, 7, v0
 v_xor_b32 v28, v28, v29
 v_lshlrev_b32 v28, 4, v28
 v_lshrrev_b32 v29, 3, v0
 v_lshl_add_u32 v30, v29, 11, v28
 s_lshl_b32 s64, s66, 19
 s_lshl_b32 s67, s65, 20
 s_add_u32 s64, s64, s67
 s_add_u32 s64, s64, 0
 v_add_u32 v12, s64, v30
 v_add_u32 v14, 30720, v12
 v_add_u32 v28, 4, v25
 v_and_b32 v29, 7, v0
 v_xor_b32 v28, v28, v29
 v_lshlrev_b32 v28, 4, v28
 v_lshrrev_b32 v29, 3, v0
 v_lshl_add_u32 v30, v29, 11, v28
 s_lshl_b32 s64, s66, 19
 s_lshl_b32 s67, s65, 20
 s_add_u32 s64, s64, s67
 s_add_u32 s64, s64, 15360
 v_add_u32 v13, s64, v30
 v_add_u32 v15, 30720, v13
 s_mov_b32 s21, 0
 s_mov_b32 s22, 0
 s_lshl_b32 s23, s20, 12
 s_add_u32 s24, s23, 65536
 s_lshl_b32 s74, s41, 9
 s_sub_u32 s18, 8388608, s74
 s_mov_b32 s19, 0x20000
 s_and_b32 s75, s42, 7
 s_lshl_b32 s75, s75, 16
 s_sub_u32 s50, 4194304, s75
 s_mov_b32 s51, 0x20000
 s_mov_b32 m0, s23
 s_cmp_eq_u32 s45, 0
 s_waitcnt lgkmcnt(0)
 s_cselect_b64 s[72:73], s[86:87], s[88:89]
 s_add_u32 s16, s72, s74
 s_addc_u32 s17, s73, 0
 s_and_b32 s17, s17, 0xffff
 buffer_load_dwordx4 v8, s[16:19], s21 offen offset:0  nt lds
 buffer_load_dwordx4 v9, s[16:19], s21 offen offset:1024  nt lds
 buffer_load_dwordx4 v10, s[16:19], s21 offen offset:2048  nt lds
 buffer_load_dwordx4 v11, s[16:19], s21 offen offset:3072  nt lds
 s_add_u32 s21, s21, 128
 s_add_u32 s48, s82, s75
 s_addc_u32 s49, s83, 0
 s_and_b32 s49, s49, 0xffff
 s_add_u32 m0, s24, 0
 s_nop 0
 buffer_load_dwordx4 v12, s[48:51], s22 offen offset:0   lds
 buffer_load_dwordx4 v13, s[48:51], s22 offen offset:1024   lds
 buffer_load_dwordx4 v14, s[48:51], s22 offen offset:2048   lds
 buffer_load_dwordx4 v15, s[48:51], s22 offen offset:3072   lds
 s_add_u32 s22, s22, 2097152
 s_add_u32 m0, s23, 16384
 s_nop 0
 buffer_load_dwordx4 v8, s[16:19], s21 offen offset:0  nt lds
 buffer_load_dwordx4 v9, s[16:19], s21 offen offset:1024  nt lds
 buffer_load_dwordx4 v10, s[16:19], s21 offen offset:2048  nt lds
 buffer_load_dwordx4 v11, s[16:19], s21 offen offset:3072  nt lds
 s_add_u32 s21, s21, 524160
 v_lshrrev_b32 v26, 2, v24
 v_and_b32 v28, 1, v25
 v_lshl_or_b32 v28, v28, 2, v26
 v_lshl_add_u32 v29, v25, 3, v26
 v_lshlrev_b32 v29, 8, v29
 v_and_b32 v30, 3, v0
 v_lshl_add_u32 v29, v30, 3, v29
 s_lshl_b32 s64, s65, 2
 s_add_u32 s64, s64, 0
 v_xor_b32 v30, s64, v28
 v_lshl_add_u32 v1, v30, 5, v29
 s_lshl_b32 s64, s65, 2
 s_add_u32 s64, s64, 1
 v_xor_b32 v30, s64, v28
 v_lshl_add_u32 v2, v30, 5, v29
 s_lshl_b32 s64, s65, 2
 s_add_u32 s64, s64, 2
 v_xor_b32 v30, s64, v28
 v_lshl_add_u32 v3, v30, 5, v29
 s_lshl_b32 s64, s65, 2
 s_add_u32 s64, s64, 3
 v_xor_b32 v30, s64, v28
 v_lshl_add_u32 v4, v30, 5, v29
 v_add_u32 v28, 0, v25
 v_lshrrev_b32 v29, 1, v24
 v_xor_b32 v28, v28, v29
 v_lshlrev_b32 v28, 4, v28
 v_lshl_add_u32 v28, v24, 7, v28
 s_lshl_b32 s64, s66, 13
 s_add_u32 s64, s64, 65536
 v_add_u32 v5, s64, v28
 v_add_u32 v28, 4, v25
 v_lshrrev_b32 v29, 1, v24
 v_xor_b32 v28, v28, v29
 v_lshlrev_b32 v28, 4, v28
 v_lshl_add_u32 v28, v24, 7, v28
 s_lshl_b32 s64, s66, 13
 s_add_u32 s64, s64, 65536
 v_add_u32 v6, s64, v28
 s_lshl_b32 s64, s2, 2
 s_add_u32 s64, s64, s20
 s_lshl_b32 s64, s64, 12
 v_lshrrev_b32 v28, 2, v0
 v_and_b32 v29, 3, v0
 v_lshlrev_b32 v29, 7, v29
 v_lshl_add_u32 v28, v28, 11, v29
 v_add_u32 v24, s64, v28
 v_and_b32 v28, 56, v0
 v_lshl_add_u32 v24, v28, 24, v24
 s_mov_b32 s32, s82
 s_and_b32 s33, s83, 0xffff
 s_mov_b32 s34, 4194304
 s_mov_b32 s35, 0x20000
 s_mov_b32 s56, s80
 s_and_b32 s57, s81, 0xffff
 s_mov_b32 s58, 1835008
 s_mov_b32 s59, 0x20000
 s_mov_b32 s60, s92
 s_and_b32 s61, s93, 0xffff
 s_mov_b32 s62, 896
 s_mov_b32 s63, 0x20000
 s_mov_b32 s68, s30
 s_and_b32 s69, s31, 0xffff
 s_mov_b32 s70, 896
 s_mov_b32 s71, 0x20000
 s_mov_b32 s8, s6
 s_and_b32 s9, s7, 0xffff
 s_mov_b32 s10, 268435456
 s_mov_b32 s11, 0x20000
 s_mov_b32 s12, s4
 s_and_b32 s13, s5, 0xffff
 s_mov_b32 s14, 256
 s_mov_b32 s15, 0x20000
 s_add_u32 s72, s84, s74
 s_addc_u32 s73, s85, 0
 s_sub_u32 s75, 3670016, s74
 s_mov_b32 s52, s72
 s_and_b32 s53, s73, 0xffff
 s_mov_b32 s54, s75
 s_mov_b32 s55, 0x20000
 s_mov_b32 s5, 0x3db8aa3b
 s_mov_b32 s28, 0
 s_mul_i32 s29, s42, 114688
 s_lshl_b32 s72, s45, 24
 s_lshl_b32 s73, s41, 20
 s_add_u32 s72, s72, s73
 s_bfe_u32 s64, s42, 0x20001
 s_lshl_b32 s64, s64, 15
 s_add_u32 s72, s72, s64
 s_lshl_b32 s64, s66, 17
 s_add_u32 s72, s72, s64
 s_and_b32 s67, s42, 1
 s_cmp_eq_u32 s45, 0
 s_cselect_b32 s64, 12, 14
 s_cselect_b32 s75, 14, 10
 s_lshl_b32 s67, s67, s75
 s_add_u32 s72, s72, s67
 s_lshl_b32 s64, s65, s64
 s_add_u32 s93, s72, s64
 s_load_dwordx4 s[80:83], s[0:1], 64
 s_load_dwordx2 s[84:85], s[0:1], 80
 s_load_dwordx2 s[96:97], s[0:1], 96
 s_cmp_lt_u32 s42, 8
 s_cbranch_scc0 L_kv1
L_kv0:
 s_lshl_b32 s64, s42, 4
 s_add_u32 s64, s64, s41
 s_lshl_b32 s64, s64, 2
 s_add_u32 s64, s64, s20
 s_cmp_lt_u32 s64, 41
 s_cselect_b32 s39, 0, 536870912
 s_min_u32 s64, s64, 41
 s_lshl_b32 s38, s64, 2
 s_max_u32 s67, s64, 8
 s_sub_u32 s67, s67, 8
 s_mul_i32 s67, s67, 3328
 s_lshl_b32 s64, s64, 10
 s_add_u32 s64, s64, s67
 s_add_u32 s73, s64, 104914944
 v_or_b32 v64, s39, v7
 v_mov_b32 v68, 0
 v_mov_b32 v69, 0
 v_mov_b32 v70, 0
 v_mov_b32 v71, 0
 s_lshl_b32 s30, s41, 3
 s_add_u32 s30, s30, s42
 s_lshl_b32 s64, s30, 2
 s_add_u32 s64, s64, s20
 s_mul_i32 s72, s64, 3584
 v_mov_b32 v32, 536870912
 v_cmp_gt_u32 vcc, 56, v0
 s_lshl_b32 s67, s64, 2
 s_nop 0
 v_cndmask_b32 v32, v32, v7, vcc
 buffer_load_dwordx4 v[40:43], v32, s[56:59], s72 offen offset:0
 buffer_load_dwordx4 v[44:47], v32, s[56:59], s72 offen offset:896
 buffer_load_dwordx4 v[48:51], v32, s[56:59], s72 offen offset:1792
 buffer_load_dwordx4 v[52:55], v32, s[56:59], s72 offen offset:2688
 buffer_load_dwordx4 v[56:59], v32, s[60:63], 0 offen
 buffer_load_dwordx4 v[60:63], v32, s[68:71], 0 offen
 buffer_store_dwordx4 v[68:71], v64, s[8:11], s73 offen offset:0 sc1
 buffer_store_dwordx4 v[68:71], v64, s[8:11], s73 offen offset:1024 sc1
 buffer_store_dwordx4 v[68:71], v64, s[8:11], s73 offen offset:2048 sc1
 s_waitcnt vmcnt(13) lgkmcnt(0)
 s_barrier
 ds_read_b128 a[160:163], v5 offset:0
 ds_read_b128 a[164:167], v6 offset:0
 ds_read_b64_tr_b16 a[32:33], v1 offset:0
 ds_read_b64_tr_b16 a[34:35], v1 offset:1024
 ds_read_b64_tr_b16 a[36:37], v1 offset:8192
 ds_read_b64_tr_b16 a[38:39], v1 offset:9216
 ds_read_b64_tr_b16 a[40:41], v2 offset:0
 ds_read_b64_tr_b16 a[42:43], v2 offset:1024
 ds_read_b64_tr_b16 a[44:45], v2 offset:8192
 ds_read_b64_tr_b16 a[46:47], v2 offset:9216
 ds_read_b128 a[168:171], v5 offset:2048
 ds_read_b128 a[172:175], v6 offset:2048
 ds_read_b64_tr_b16 a[48:49], v3 offset:0
 ds_read_b64_tr_b16 a[50:51], v3 offset:1024
 ds_read_b64_tr_b16 a[52:53], v3 offset:8192
 ds_read_b64_tr_b16 a[54:55], v3 offset:9216
 ds_read_b64_tr_b16 a[56:57], v4 offset:0
 ds_read_b64_tr_b16 a[58:59], v4 offset:1024
 ds_read_b64_tr_b16 a[60:61], v4 offset:8192
 ds_read_b64_tr_b16 a[62:63], v4 offset:9216
 ds_read_b128 a[176:179], v5 offset:4096
 ds_read_b128 a[180:183], v6 offset:4096
 ds_read_b128 a[184:187], v5 offset:6144
 ds_read_b128 a[188:191], v6 offset:6144
 s_add_u32 m0, s24, 16384
 s_nop 0
 buffer_load_dwordx4 v12, s[48:51], s22 offen offset:0   lds
 buffer_load_dwordx4 v13, s[48:51], s22 offen offset:1024   lds
 buffer_load_dwordx4 v14, s[48:51], s22 offen offset:2048   lds
 buffer_load_dwordx4 v15, s[48:51], s22 offen offset:3072   lds
 s_sub_u32 s22, s22, 2097024
 s_add_u32 m0, s23, 32768
 s_nop 0
 buffer_load_dwordx4 v8, s[16:19], s21 offen offset:0  nt lds
 buffer_load_dwordx4 v9, s[16:19], s21 offen offset:1024  nt lds
 buffer_load_dwordx4 v10, s[16:19], s21 offen offset:2048  nt lds
 buffer_load_dwordx4 v11, s[16:19], s21 offen offset:3072  nt lds
 s_add_u32 s21, s21, 128
 v_mov_b32 v72, 0
 v_mov_b32 v73, 0
 v_mov_b32 v74, 0
 v_mov_b32 v75, 0
 v_mov_b32 v76, 0
 v_mov_b32 v77, 0
 v_mov_b32 v78, 0
 v_mov_b32 v79, 0
 s_waitcnt vmcnt(12)
 v_dot2c_f32_bf16 v72, v40, v56
 v_dot2c_f32_bf16 v73, v44, v56
 v_dot2c_f32_bf16 v74, v48, v56
 v_dot2c_f32_bf16 v75, v52, v56
 s_waitcnt vmcnt(11)
 v_dot2c_f32_bf16 v76, v40, v60
 v_dot2c_f32_bf16 v77, v44, v60
 v_dot2c_f32_bf16 v78, v48, v60
 v_dot2c_f32_bf16 v79, v52, v60
 v_dot2c_f32_bf16 v72, v41, v57
 v_dot2c_f32_bf16 v73, v45, v57
 v_dot2c_f32_bf16 v74, v49, v57
 v_dot2c_f32_bf16 v75, v53, v57
 v_dot2c_f32_bf16 v76, v41, v61
 v_dot2c_f32_bf16 v77, v45, v61
 v_dot2c_f32_bf16 v78, v49, v61
 v_dot2c_f32_bf16 v79, v53, v61
 v_dot2c_f32_bf16 v72, v42, v58
 v_dot2c_f32_bf16 v73, v46, v58
 v_dot2c_f32_bf16 v74, v50, v58
 v_dot2c_f32_bf16 v75, v54, v58
 v_dot2c_f32_bf16 v76, v42, v62
 v_dot2c_f32_bf16 v77, v46, v62
 v_dot2c_f32_bf16 v78, v50, v62
 v_dot2c_f32_bf16 v79, v54, v62
 v_dot2c_f32_bf16 v72, v43, v59
 v_dot2c_f32_bf16 v73, v47, v59
 v_dot2c_f32_bf16 v74, v51, v59
 v_dot2c_f32_bf16 v75, v55, v59
 v_dot2c_f32_bf16 v76, v43, v63
 v_dot2c_f32_bf16 v77, v47, v63
 v_dot2c_f32_bf16 v78, v51, v63
 v_dot2c_f32_bf16 v79, v55, v63
 v_permlane32_swap_b32 v72, v74
 v_permlane32_swap_b32 v73, v75
 v_permlane32_swap_b32 v76, v78
 v_permlane32_swap_b32 v77, v79
 v_add_f32 v72, v72, v74
 v_add_f32 v73, v73, v75
 v_add_f32 v76, v76, v78
 v_add_f32 v77, v77, v79
 v_lshrrev_b32 v80, 4, v0
 v_permlane16_swap_b32 v72, v73
 v_permlane16_swap_b32 v76, v77
 v_add_f32 v72, v72, v73
 v_add_f32 v76, v76, v77
 v_add_u32 v81, s67, v80
 v_add_f32 v72, v72, v72 row_ror:8 row_mask:0xf bank_mask:0xf
 v_add_f32 v76, v76, v76 row_ror:8 row_mask:0xf bank_mask:0xf
 s_nop 0
 v_add_f32 v72, v72, v72 row_ror:4 row_mask:0xf bank_mask:0xf
 v_add_f32 v76, v76, v76 row_ror:4 row_mask:0xf bank_mask:0xf
 s_nop 0
 v_add_f32 v72, v72, v72 row_ror:2 row_mask:0xf bank_mask:0xf
 v_add_f32 v76, v76, v76 row_ror:2 row_mask:0xf bank_mask:0xf
 s_nop 0
 v_add_f32 v72, v72, v72 row_ror:1 row_mask:0xf bank_mask:0xf
 v_add_f32 v76, v76, v76 row_ror:1 row_mask:0xf bank_mask:0xf
 v_ashrrev_i32 v82, 31, v72
 v_or_b32 v82, 0x80000000, v82
 v_xor_b32 v82, v82, v72
 v_and_b32 v82, 0xfffff800, v82
 v_sub_u32 v81, 2047, v81
 v_or_b32 v82, v82, v81
 v_max_u32 v82, 1, v82
 v_mul_f32 v77, 0xbfb8aa3b, v76
 v_exp_f32 v77, v77
 s_nop 0
 v_add_f32 v77, 1.0, v77
 v_rcp_f32 v76, v77
 s_lshl_b32 s72, s20, 4
 s_add_u32 s72, s72, 163584
 v_lshl_add_u32 v80, v80, 2, s72
 ds_write_b32 v80, v82
 ds_write_b32 v80, v72 offset:64
 ds_write_b32 v80, v76 offset:128
 s_waitcnt lgkmcnt(15)
M a[0:3], a[160:163], a[32:35], 0
M a[0:3], a[164:167], a[36:39], a[0:3]
M a[4:7], a[164:167], a[44:47], 0
M a[4:7], a[160:163], a[40:43], a[4:7]
 s_waitcnt lgkmcnt(11)
M a[8:11], a[160:163], a[48:51], 0
M a[8:11], a[164:167], a[52:55], a[8:11]
 s_waitcnt lgkmcnt(7)
M a[12:15], a[164:167], a[60:63], 0
 s_add_u32 m0, s23, 49152
M a[12:15], a[160:163], a[56:59], a[12:15]
 buffer_load_dwordx4 v8, s[16:19], s21 offen offset:0  nt lds
M v[32:35], a[168:171], a[32:35], 0
 buffer_load_dwordx4 v9, s[16:19], s21 offen offset:1024  nt lds
M v[32:35], a[172:175], a[36:39], v[32:35]
M v[36:39], a[172:175], a[44:47], 0
 buffer_load_dwordx4 v10, s[16:19], s21 offen offset:2048  nt lds
M v[36:39], a[168:171], a[40:43], v[36:39]
M v[40:43], a[168:171], a[48:51], 0
 buffer_load_dwordx4 v11, s[16:19], s21 offen offset:3072  nt lds
M v[40:43], a[172:175], a[52:55], v[40:43]
 s_add_u32 s21, s21, 524160
M v[44:47], a[172:175], a[60:63], 0
 s_waitcnt lgkmcnt(0)
M v[44:47], a[168:171], a[56:59], v[44:47]
 s_barrier
M v[64:67], a[176:179], a[32:35], 0
 s_add_u32 m0, s24, 32768
 ds_read_b64_tr_b16 a[64:65], v1 offset:16384
 ds_read_b64_tr_b16 a[66:67], v1 offset:17408
M v[64:67], a[180:183], a[36:39], v[64:67]
 ds_read_b64_tr_b16 a[68:69], v1 offset:24576
 ds_read_b64_tr_b16 a[70:71], v1 offset:25600
M v[68:71], a[180:183], a[44:47], 0
 buffer_load_dwordx4 v12, s[48:51], s22 offen offset:0   lds
M v[68:71], a[176:179], a[40:43], v[68:71]
 ds_read_b64_tr_b16 a[72:73], v2 offset:16384
 ds_read_b64_tr_b16 a[74:75], v2 offset:17408
M v[72:75], a[176:179], a[48:51], 0
 ds_read_b64_tr_b16 a[76:77], v2 offset:24576
 ds_read_b64_tr_b16 a[78:79], v2 offset:25600
M v[72:75], a[180:183], a[52:55], v[72:75]
 buffer_load_dwordx4 v13, s[48:51], s22 offen offset:1024   lds
M v[76:79], a[180:183], a[60:63], 0
 ds_read_b64_tr_b16 a[80:81], v3 offset:16384
 ds_read_b64_tr_b16 a[82:83], v3 offset:17408
M v[76:79], a[176:179], a[56:59], v[76:79]
 ds_read_b64_tr_b16 a[84:85], v3 offset:24576
 ds_read_b64_tr_b16 a[86:87], v3 offset:25600
M v[96:99], a[184:187], a[32:35], 0
 buffer_load_dwordx4 v14, s[48:51], s22 offen offset:2048   lds
M v[96:99], a[188:191], a[36:39], v[96:99]
 ds_read_b64_tr_b16 a[88:89], v4 offset:16384
 ds_read_b64_tr_b16 a[90:91], v4 offset:17408
M v[100:103], a[188:191], a[44:47], 0
 ds_read_b64_tr_b16 a[92:93], v4 offset:24576
 ds_read_b64_tr_b16 a[94:95], v4 offset:25600
M v[100:103], a[184:187], a[40:43], v[100:103]
 buffer_load_dwordx4 v15, s[48:51], s22 offen offset:3072   lds
M v[104:107], a[184:187], a[48:51], 0
 s_add_u32 s22, s22, 2097152
 v_max3_f32 v20, |v32|, |v33|, |v34|
 v_max3_f32 v20, |v35|, |v36|, v20
M v[104:107], a[188:191], a[52:55], v[104:107]
 v_max3_f32 v20, |v37|, |v38|, v20
 v_max3_f32 v21, |v64|, |v65|, |v66|
M v[108:111], a[188:191], a[60:63], 0
 s_add_u32 m0, s23, 0
 v_max3_f32 v21, |v67|, |v68|, v21
 v_max3_f32 v21, |v69|, |v70|, v21
M v[108:111], a[184:187], a[56:59], v[108:111]
 s_waitcnt lgkmcnt(0)
 v_min_f32 v20, v20, v21
 v_mul_f32 v20, 0x41000000, v20
M a[16:19], a[160:163], a[64:67], 0
 buffer_load_dwordx4 v8, s[16:19], s21 offen offset:0  nt lds
M a[16:19], a[164:167], a[68:71], a[16:19]
 v_mov_b32 v21, v20
 v_mov_b32 v22, v20
M a[20:23], a[164:167], a[76:79], 0
 buffer_load_dwordx4 v9, s[16:19], s21 offen offset:1024  nt lds
M a[20:23], a[160:163], a[72:75], a[20:23]
 v_mov_b32 v23, v20
 v_accvgpr_write_b32 a241, v20
M a[24:27], a[160:163], a[80:83], 0
M a[24:27], a[164:167], a[84:87], a[24:27]
M a[28:31], a[164:167], a[92:95], 0
 buffer_load_dwordx4 v10, s[16:19], s21 offen offset:2048  nt lds
M a[28:31], a[160:163], a[88:91], a[28:31]
M v[48:51], a[168:171], a[64:67], v[20:23]
M v[48:51], a[172:175], a[68:71], v[48:51]
 buffer_load_dwordx4 v11, s[16:19], s21 offen offset:3072  nt lds
M v[52:55], a[172:175], a[76:79], v[20:23]
 s_add_u32 s21, s21, 128
M v[52:55], a[168:171], a[72:75], v[52:55]
M v[56:59], a[168:171], a[80:83], v[20:23]
M v[56:59], a[172:175], a[84:87], v[56:59]
M v[60:63], a[172:175], a[92:95], v[20:23]
 s_waitcnt vmcnt(12)
M v[60:63], a[168:171], a[88:91], v[60:63]
 s_barrier
M v[80:83], a[176:179], a[64:67], v[20:23]
 s_add_u32 m0, s24, 49152
 ds_read_b128 a[160:163], v5 offset:16384
 ds_read_b128 a[164:167], v6 offset:16384
M v[80:83], a[180:183], a[68:71], v[80:83]
 buffer_load_dwordx4 v12, s[48:51], s22 offen offset:0   lds
M v[84:87], a[180:183], a[76:79], v[20:23]
 ds_read_b64_tr_b16 a[96:97], v1 offset:32768
 ds_read_b64_tr_b16 a[98:99], v1 offset:33792
M v[84:87], a[176:179], a[72:75], v[84:87]
M v[88:91], a[176:179], a[80:83], v[20:23]
 buffer_load_dwordx4 v13, s[48:51], s22 offen offset:1024   lds
M v[88:91], a[180:183], a[84:87], v[88:91]
 ds_read_b64_tr_b16 a[100:101], v1 offset:40960
 ds_read_b64_tr_b16 a[102:103], v1 offset:41984
M v[92:95], a[180:183], a[92:95], v[20:23]
M v[92:95], a[176:179], a[88:91], v[92:95]
M v[112:115], a[184:187], a[64:67], v[20:23]
 ds_read_b64_tr_b16 a[104:105], v2 offset:32768
 ds_read_b64_tr_b16 a[106:107], v2 offset:33792
M v[112:115], a[188:191], a[68:71], v[112:115]
 buffer_load_dwordx4 v14, s[48:51], s22 offen offset:2048   lds
M v[116:119], a[188:191], a[76:79], v[20:23]
M v[116:119], a[184:187], a[72:75], v[116:119]
 ds_read_b64_tr_b16 a[108:109], v2 offset:40960
 ds_read_b64_tr_b16 a[110:111], v2 offset:41984
M v[120:123], a[184:187], a[80:83], v[20:23]
 buffer_load_dwordx4 v15, s[48:51], s22 offen offset:3072   lds
M v[120:123], a[188:191], a[84:87], v[120:123]
 s_waitcnt lgkmcnt(8)
M v[124:127], a[188:191], a[92:95], v[20:23]
 s_sub_u32 s22, s22, 2097024
M v[124:127], a[184:187], a[88:91], v[124:127]
 s_add_u32 m0, s23, 16384
 ds_read_b64_tr_b16 a[112:113], v3 offset:32768
 ds_read_b64_tr_b16 a[114:115], v3 offset:33792
M v[128:131], a[160:163], a[32:35], v[20:23]
 ds_read_b128 a[168:171], v5 offset:18432
 ds_read_b128 a[172:175], v6 offset:18432
M v[128:131], a[164:167], a[36:39], v[128:131]
 buffer_load_dwordx4 v8, s[16:19], s21 offen offset:0  nt lds
M v[132:135], a[164:167], a[44:47], v[20:23]
 ds_read_b64_tr_b16 a[116:117], v3 offset:40960
 ds_read_b64_tr_b16 a[118:119], v3 offset:41984
M v[132:135], a[160:163], a[40:43], v[132:135]
 buffer_load_dwordx4 v9, s[16:19], s21 offen offset:1024  nt lds
M v[136:139], a[160:163], a[48:51], v[20:23]
M v[136:139], a[164:167], a[52:55], v[136:139]
 ds_read_b64_tr_b16 a[120:121], v4 offset:32768
 ds_read_b64_tr_b16 a[122:123], v4 offset:33792
M v[140:143], a[164:167], a[60:63], v[20:23]
 buffer_load_dwordx4 v10, s[16:19], s21 offen offset:2048  nt lds
M v[140:143], a[160:163], a[56:59], v[140:143]
M v[144:147], a[160:163], a[64:67], v[20:23]
 ds_read_b64_tr_b16 a[124:125], v4 offset:40960
 ds_read_b64_tr_b16 a[126:127], v4 offset:41984
M v[144:147], a[164:167], a[68:71], v[144:147]
 buffer_load_dwordx4 v11, s[16:19], s21 offen offset:3072  nt lds
M v[148:151], a[164:167], a[76:79], v[20:23]
 s_add_u32 s21, s21, 524160
M v[148:151], a[160:163], a[72:75], v[148:151]
M v[152:155], a[160:163], a[80:83], v[20:23]
M v[152:155], a[164:167], a[84:87], v[152:155]
 s_waitcnt lgkmcnt(6)
M v[156:159], a[164:167], a[92:95], v[20:23]
 s_waitcnt vmcnt(16) lgkmcnt(0)
M v[156:159], a[160:163], a[88:91], v[156:159]
 s_barrier
M v[160:163], a[168:171], a[32:35], v[20:23]
 s_add_u32 m0, s24, 0
 ds_read_b128 a[160:163], v5 offset:20480
 ds_read_b128 a[164:167], v6 offset:20480
M v[160:163], a[172:175], a[36:39], v[160:163]
 buffer_load_dwordx4 v12, s[48:51], s22 offen offset:0   lds
M v[164:167], a[172:175], a[44:47], v[20:23]
 ds_read_b64_tr_b16 a[128:129], v1 offset:49152
 ds_read_b64_tr_b16 a[130:131], v1 offset:50176
M v[164:167], a[168:171], a[40:43], v[164:167]
M v[168:171], a[168:171], a[48:51], v[20:23]
 buffer_load_dwordx4 v13, s[48:51], s22 offen offset:1024   lds
M v[168:171], a[172:175], a[52:55], v[168:171]
 ds_read_b64_tr_b16 a[132:133], v1 offset:57344
 ds_read_b64_tr_b16 a[134:135], v1 offset:58368
M v[172:175], a[172:175], a[60:63], v[20:23]
M v[172:175], a[168:171], a[56:59], v[172:175]
M v[176:179], a[168:171], a[64:67], v[20:23]
 ds_read_b64_tr_b16 a[136:137], v2 offset:49152
 ds_read_b64_tr_b16 a[138:139], v2 offset:50176
M v[176:179], a[172:175], a[68:71], v[176:179]
 buffer_load_dwordx4 v14, s[48:51], s22 offen offset:2048   lds
M v[180:183], a[172:175], a[76:79], v[20:23]
M v[180:183], a[168:171], a[72:75], v[180:183]
 ds_read_b64_tr_b16 a[140:141], v2 offset:57344
 ds_read_b64_tr_b16 a[142:143], v2 offset:58368
M v[184:187], a[168:171], a[80:83], v[20:23]
 buffer_load_dwordx4 v15, s[48:51], s22 offen offset:3072   lds
M v[184:187], a[172:175], a[84:87], v[184:187]
 s_waitcnt lgkmcnt(8)
M v[188:191], a[172:175], a[92:95], v[20:23]
 s_add_u32 s22, s22, 2097152
M v[188:191], a[168:171], a[88:91], v[188:191]
 s_add_u32 m0, s23, 32768
 ds_read_b64_tr_b16 a[144:145], v3 offset:49152
 ds_read_b64_tr_b16 a[146:147], v3 offset:50176
M v[192:195], a[160:163], a[32:35], v[20:23]
 ds_read_b128 a[168:171], v5 offset:22528
 ds_read_b128 a[172:175], v6 offset:22528
M v[192:195], a[164:167], a[36:39], v[192:195]
 buffer_load_dwordx4 v8, s[16:19], s21 offen offset:0  nt lds
M v[196:199], a[164:167], a[44:47], v[20:23]
 ds_read_b64_tr_b16 a[148:149], v3 offset:57344
 ds_read_b64_tr_b16 a[150:151], v3 offset:58368
M v[196:199], a[160:163], a[40:43], v[196:199]
 buffer_load_dwordx4 v9, s[16:19], s21 offen offset:1024  nt lds
M v[200:203], a[160:163], a[48:51], v[20:23]
M v[200:203], a[164:167], a[52:55], v[200:203]
 ds_read_b64_tr_b16 a[152:153], v4 offset:49152
 ds_read_b64_tr_b16 a[154:155], v4 offset:50176
M v[204:207], a[164:167], a[60:63], v[20:23]
 buffer_load_dwordx4 v10, s[16:19], s21 offen offset:2048  nt lds
M v[204:207], a[160:163], a[56:59], v[204:207]
M v[208:211], a[160:163], a[64:67], v[20:23]
 ds_read_b64_tr_b16 a[156:157], v4 offset:57344
 ds_read_b64_tr_b16 a[158:159], v4 offset:58368
M v[208:211], a[164:167], a[68:71], v[208:211]
 buffer_load_dwordx4 v11, s[16:19], s21 offen offset:3072  nt lds
M v[212:215], a[164:167], a[76:79], v[20:23]
 s_add_u32 s21, s21, 128
M v[212:215], a[160:163], a[72:75], v[212:215]
M v[216:219], a[160:163], a[80:83], v[20:23]
M v[216:219], a[164:167], a[84:87], v[216:219]
 s_waitcnt lgkmcnt(6)
M v[220:223], a[164:167], a[92:95], v[20:23]
 s_waitcnt vmcnt(16) lgkmcnt(0)
M v[220:223], a[160:163], a[88:91], v[220:223]
 s_barrier
M v[224:227], a[168:171], a[32:35], v[20:23]
 ds_read_b128 a[160:163], v5 offset:32768
 ds_read_b128 a[164:167], v6 offset:32768
M v[224:227], a[172:175], a[36:39], v[224:227]
 buffer_load_dword a240, v24, s[32:35], 0 offen offset:512
M v[228:231], a[172:175], a[44:47], v[20:23]
M v[228:231], a[168:171], a[40:43], v[228:231]
M v[232:235], a[168:171], a[48:51], v[20:23]
M v[232:235], a[172:175], a[52:55], v[232:235]
M v[236:239], a[172:175], a[60:63], v[20:23]
M v[236:239], a[168:171], a[56:59], v[236:239]
M v[240:243], a[168:171], a[64:67], v[20:23]
M v[240:243], a[172:175], a[68:71], v[240:243]
M v[244:247], a[172:175], a[76:79], v[20:23]
M v[244:247], a[168:171], a[72:75], v[244:247]
M v[248:251], a[168:171], a[80:83], v[20:23]
M v[248:251], a[172:175], a[84:87], v[248:251]
 s_waitcnt lgkmcnt(0)
M v[252:255], a[172:175], a[92:95], v[20:23]
M v[252:255], a[168:171], a[88:91], v[252:255]
M a[0:3], a[160:163], a[96:99], a[0:3]
 ds_read_b128 a[168:171], v5 offset:34816
 ds_read_b128 a[172:175], v6 offset:34816
M a[0:3], a[164:167], a[100:103], a[0:3]
 ds_read_b64_tr_b16 a[32:33], v1 offset:0
 ds_read_b64_tr_b16 a[34:35], v1 offset:1024
M a[4:7], a[164:167], a[108:111], a[4:7]
 s_add_u32 m0, s24, 16384
M a[4:7], a[160:163], a[104:107], a[4:7]
 buffer_load_dwordx4 v12, s[48:51], s22 offen offset:0   lds
M a[8:11], a[160:163], a[112:115], a[8:11]
M a[8:11], a[164:167], a[116:119], a[8:11]
M a[12:15], a[164:167], a[124:127], a[12:15]
 ds_read_b64_tr_b16 a[36:37], v1 offset:8192
 ds_read_b64_tr_b16 a[38:39], v1 offset:9216
M a[12:15], a[160:163], a[120:123], a[12:15]
M a[16:19], a[160:163], a[128:131], a[16:19]
 buffer_load_dwordx4 v13, s[48:51], s22 offen offset:1024   lds
M a[16:19], a[164:167], a[132:135], a[16:19]
M a[20:23], a[164:167], a[140:143], a[20:23]
M a[20:23], a[160:163], a[136:139], a[20:23]
 ds_read_b64_tr_b16 a[40:41], v2 offset:0
 ds_read_b64_tr_b16 a[42:43], v2 offset:1024
M a[24:27], a[160:163], a[144:147], a[24:27]
M a[24:27], a[164:167], a[148:151], a[24:27]
 s_waitcnt lgkmcnt(6)
M a[28:31], a[164:167], a[156:159], a[28:31]
 buffer_load_dwordx4 v14, s[48:51], s22 offen offset:2048   lds
M a[28:31], a[160:163], a[152:155], a[28:31]
M v[60:63], a[168:171], a[152:155], v[60:63]
 ds_read_b128 a[160:163], v5 offset:36864
 ds_read_b128 a[164:167], v6 offset:36864
M v[60:63], a[172:175], a[156:159], v[60:63]
 ds_read_b64_tr_b16 a[44:45], v2 offset:8192
 ds_read_b64_tr_b16 a[46:47], v2 offset:9216
M v[56:59], a[172:175], a[148:151], v[56:59]
 buffer_load_dwordx4 v15, s[48:51], s22 offen offset:3072   lds
M v[56:59], a[168:171], a[144:147], v[56:59]
 s_sub_u32 s22, s22, 2097024
M v[52:55], a[168:171], a[136:139], v[52:55]
M v[52:55], a[172:175], a[140:143], v[52:55]
 ds_read_b64_tr_b16 a[48:49], v3 offset:0
 ds_read_b64_tr_b16 a[50:51], v3 offset:1024
M v[48:51], a[172:175], a[132:135], v[48:51]
 s_add_u32 m0, s23, 49152
M v[48:51], a[168:171], a[128:131], v[48:51]
 buffer_load_dwordx4 v8, s[16:19], s21 offen offset:0  nt lds
M v[44:47], a[168:171], a[120:123], v[44:47]
M v[44:47], a[172:175], a[124:127], v[44:47]
M v[40:43], a[172:175], a[116:119], v[40:43]
 ds_read_b64_tr_b16 a[52:53], v3 offset:8192
 ds_read_b64_tr_b16 a[54:55], v3 offset:9216
M v[40:43], a[168:171], a[112:115], v[40:43]
M v[36:39], a[168:171], a[104:107], v[36:39]
 buffer_load_dwordx4 v9, s[16:19], s21 offen offset:1024  nt lds
M v[36:39], a[172:175], a[108:111], v[36:39]
 s_waitcnt lgkmcnt(6)
M v[32:35], a[172:175], a[100:103], v[32:35]
M v[32:35], a[168:171], a[96:99], v[32:35]
 ds_read_b64_tr_b16 a[56:57], v4 offset:0
 ds_read_b64_tr_b16 a[58:59], v4 offset:1024
M v[64:67], a[160:163], a[96:99], v[64:67]
 ds_read_b128 a[168:171], v5 offset:38912
 ds_read_b128 a[172:175], v6 offset:38912
M v[64:67], a[164:167], a[100:103], v[64:67]
 buffer_load_dwordx4 v10, s[16:19], s21 offen offset:2048  nt lds
M v[68:71], a[164:167], a[108:111], v[68:71]
M v[68:71], a[160:163], a[104:107], v[68:71]
M v[72:75], a[160:163], a[112:115], v[72:75]
 ds_read_b64_tr_b16 a[60:61], v4 offset:8192
 ds_read_b64_tr_b16 a[62:63], v4 offset:9216
M v[72:75], a[164:167], a[116:119], v[72:75]
M v[76:79], a[164:167], a[124:127], v[76:79]
 buffer_load_dwordx4 v11, s[16:19], s21 offen offset:3072  nt lds
M v[76:79], a[160:163], a[120:123], v[76:79]
 s_add_u32 s21, s21, 524160
M v[80:83], a[160:163], a[128:131], v[80:83]
M v[80:83], a[164:167], a[132:135], v[80:83]
M v[84:87], a[164:167], a[140:143], v[84:87]
M v[84:87], a[160:163], a[136:139], v[84:87]
M v[88:91], a[160:163], a[144:147], v[88:91]
M v[88:91], a[164:167], a[148:151], v[88:91]
 s_waitcnt lgkmcnt(2)
M v[92:95], a[164:167], a[156:159], v[92:95]
 s_waitcnt vmcnt(17) lgkmcnt(0)
M v[92:95], a[160:163], a[152:155], v[92:95]
 s_barrier
M v[124:127], a[168:171], a[152:155], v[124:127]
 ds_read_b128 a[160:163], v5 offset:49152
 ds_read_b128 a[164:167], v6 offset:49152
M v[124:127], a[172:175], a[156:159], v[124:127]
M v[120:123], a[172:175], a[148:151], v[120:123]
 s_add_u32 m0, s24, 32768
 ds_read_b64_tr_b16 a[64:65], v1 offset:16384
 ds_read_b64_tr_b16 a[66:67], v1 offset:17408
M v[120:123], a[168:171], a[144:147], v[120:123]
 buffer_load_dwordx4 v12, s[48:51], s22 offen offset:0   lds
M v[116:119], a[168:171], a[136:139], v[116:119]
M v[116:119], a[172:175], a[140:143], v[116:119]
M v[112:115], a[172:175], a[132:135], v[112:115]
M v[112:115], a[168:171], a[128:131], v[112:115]
M v[108:111], a[168:171], a[120:123], v[108:111]
M v[108:111], a[172:175], a[124:127], v[108:111]
 ds_read_b64_tr_b16 a[68:69], v1 offset:24576
 ds_read_b64_tr_b16 a[70:71], v1 offset:25600
M v[104:107], a[172:175], a[116:119], v[104:107]
 buffer_load_dwordx4 v13, s[48:51], s22 offen offset:1024   lds
M v[104:107], a[168:171], a[112:115], v[104:107]
M v[100:103], a[168:171], a[104:107], v[100:103]
M v[100:103], a[172:175], a[108:111], v[100:103]
 s_waitcnt lgkmcnt(4)
M v[96:99], a[172:175], a[100:103], v[96:99]
M v[96:99], a[168:171], a[96:99], v[96:99]
M v[128:131], a[160:163], a[96:99], v[128:131]
 ds_read_b128 a[168:171], v5 offset:51200
 ds_read_b128 a[172:175], v6 offset:51200
M v[128:131], a[164:167], a[100:103], v[128:131]
 ds_read_b64_tr_b16 a[72:73], v2 offset:16384
 ds_read_b64_tr_b16 a[74:75], v2 offset:17408
M v[132:135], a[164:167], a[108:111], v[132:135]
 buffer_load_dwordx4 v14, s[48:51], s22 offen offset:2048   lds
M v[132:135], a[160:163], a[104:107], v[132:135]
M v[136:139], a[160:163], a[112:115], v[136:139]
M v[136:139], a[164:167], a[116:119], v[136:139]
M v[140:143], a[164:167], a[124:127], v[140:143]
M v[140:143], a[160:163], a[120:123], v[140:143]
 ds_read_b64_tr_b16 a[76:77], v2 offset:24576
 ds_read_b64_tr_b16 a[78:79], v2 offset:25600
M v[144:147], a[160:163], a[128:131], v[144:147]
 buffer_load_dwordx4 v15, s[48:51], s22 offen offset:3072   lds
M v[144:147], a[164:167], a[132:135], v[144:147]
 s_add_u32 s22, s22, 2097152
M v[148:151], a[164:167], a[140:143], v[148:151]
M v[148:151], a[160:163], a[136:139], v[148:151]
M v[152:155], a[160:163], a[144:147], v[152:155]
M v[152:155], a[164:167], a[148:151], v[152:155]
 s_waitcnt lgkmcnt(4)
M v[156:159], a[164:167], a[156:159], v[156:159]
 s_add_u32 m0, s23, 0
 ds_read_b64_tr_b16 a[80:81], v3 offset:16384
 ds_read_b64_tr_b16 a[82:83], v3 offset:17408
M v[156:159], a[160:163], a[152:155], v[156:159]
 buffer_load_dwordx4 v8, s[16:19], s21 offen offset:0  nt lds
M v[188:191], a[168:171], a[152:155], v[188:191]
 ds_read_b128 a[160:163], v5 offset:53248
 ds_read_b128 a[164:167], v6 offset:53248
M v[188:191], a[172:175], a[156:159], v[188:191]
M v[184:187], a[172:175], a[148:151], v[184:187]
M v[184:187], a[168:171], a[144:147], v[184:187]
M v[180:183], a[168:171], a[136:139], v[180:183]
M v[180:183], a[172:175], a[140:143], v[180:183]
 ds_read_b64_tr_b16 a[84:85], v3 offset:24576
 ds_read_b64_tr_b16 a[86:87], v3 offset:25600
M v[176:179], a[172:175], a[132:135], v[176:179]
 buffer_load_dwordx4 v9, s[16:19], s21 offen offset:1024  nt lds
M v[176:179], a[168:171], a[128:131], v[176:179]
M v[172:175], a[168:171], a[120:123], v[172:175]
M v[172:175], a[172:175], a[124:127], v[172:175]
M v[168:171], a[172:175], a[116:119], v[168:171]
M v[168:171], a[168:171], a[112:115], v[168:171]
M v[164:167], a[168:171], a[104:107], v[164:167]
 ds_read_b64_tr_b16 a[88:89], v4 offset:16384
 ds_read_b64_tr_b16 a[90:91], v4 offset:17408
M v[164:167], a[172:175], a[108:111], v[164:167]
 s_waitcnt lgkmcnt(4)
M v[160:163], a[172:175], a[100:103], v[160:163]
 buffer_load_dwordx4 v10, s[16:19], s21 offen offset:2048  nt lds
M v[160:163], a[168:171], a[96:99], v[160:163]
M v[192:195], a[160:163], a[96:99], v[192:195]
 ds_read_b128 a[168:171], v5 offset:55296
 ds_read_b128 a[172:175], v6 offset:55296
M v[192:195], a[164:167], a[100:103], v[192:195]
M v[196:199], a[164:167], a[108:111], v[196:199]
M v[196:199], a[160:163], a[104:107], v[196:199]
 ds_read_b64_tr_b16 a[92:93], v4 offset:24576
 ds_read_b64_tr_b16 a[94:95], v4 offset:25600
M v[200:203], a[160:163], a[112:115], v[200:203]
 buffer_load_dwordx4 v11, s[16:19], s21 offen offset:3072  nt lds
M v[200:203], a[164:167], a[116:119], v[200:203]
 s_add_u32 s21, s21, 128
M v[204:207], a[164:167], a[124:127], v[204:207]
M v[204:207], a[160:163], a[120:123], v[204:207]
M v[208:211], a[160:163], a[128:131], v[208:211]
M v[208:211], a[164:167], a[132:135], v[208:211]
M v[212:215], a[164:167], a[140:143], v[212:215]
M v[212:215], a[160:163], a[136:139], v[212:215]
M v[216:219], a[160:163], a[144:147], v[216:219]
M v[216:219], a[164:167], a[148:151], v[216:219]
 s_waitcnt lgkmcnt(2)
M v[220:223], a[164:167], a[156:159], v[220:223]
 s_waitcnt vmcnt(17) lgkmcnt(0)
M v[220:223], a[160:163], a[152:155], v[220:223]
 s_barrier
M v[252:255], a[168:171], a[152:155], v[252:255]
 ds_read_b128 a[160:163], v5 offset:0
 ds_read_b128 a[164:167], v6 offset:0
M v[252:255], a[172:175], a[156:159], v[252:255]
 v_min_u32 v16, 1, v0
 v_lshlrev_b32 v16, 29, v16
M v[248:251], a[172:175], a[148:151], v[248:251]
 v_or_b32 v16, s39, v16
 v_mov_b32 v17, 1
M v[248:251], a[168:171], a[144:147], v[248:251]
M v[244:247], a[168:171], a[136:139], v[244:247]
 buffer_store_dword v17, v16, s[12:15], s38 offen offset:64 sc1
M v[244:247], a[172:175], a[140:143], v[244:247]
M v[240:243], a[172:175], a[132:135], v[240:243]
M v[240:243], a[168:171], a[128:131], v[240:243]
M v[236:239], a[168:171], a[120:123], v[236:239]
M v[236:239], a[172:175], a[124:127], v[236:239]
M v[232:235], a[172:175], a[116:119], v[232:235]
M v[232:235], a[168:171], a[112:115], v[232:235]
M v[228:231], a[168:171], a[104:107], v[228:231]
M v[228:231], a[172:175], a[108:111], v[228:231]
 s_waitcnt lgkmcnt(0)
M v[224:227], a[172:175], a[100:103], v[224:227]
M v[224:227], a[168:171], a[96:99], v[224:227]
M a[0:3], a[160:163], a[32:35], a[0:3]
 ds_read_b128 a[168:171], v5 offset:2048
 ds_read_b128 a[172:175], v6 offset:2048
M a[0:3], a[164:167], a[36:39], a[0:3]
 ds_read_b64_tr_b16 a[96:97], v1 offset:32768
 ds_read_b64_tr_b16 a[98:99], v1 offset:33792
M a[4:7], a[164:167], a[44:47], a[4:7]
 s_add_u32 m0, s24, 49152
M a[4:7], a[160:163], a[40:43], a[4:7]
 buffer_load_dwordx4 v12, s[48:51], s22 offen offset:0   lds
M a[8:11], a[160:163], a[48:51], a[8:11]
 v_and_b32 v20, 31, v0
M a[8:11], a[164:167], a[52:55], a[8:11]
 v_lshlrev_b32 v20, 2, v20
M a[12:15], a[164:167], a[60:63], a[12:15]
 ds_read_b64_tr_b16 a[100:101], v1 offset:40960
 ds_read_b64_tr_b16 a[102:103], v1 offset:41984
M a[12:15], a[160:163], a[56:59], a[12:15]
 v_add_u32 v21, 163584, v20
M a[16:19], a[160:163], a[64:67], a[16:19]
 buffer_load_dwordx4 v13, s[48:51], s22 offen offset:1024   lds
M a[16:19], a[164:167], a[68:71], a[16:19]
 ds_read_b32 v19, v21
M a[20:23], a[164:167], a[76:79], a[20:23]
 ds_read_b32 v21, v21 offset:64
M a[20:23], a[160:163], a[72:75], a[20:23]
 s_min_u32 s64, s20, 1
 ds_read_b64_tr_b16 a[104:105], v2 offset:32768
 ds_read_b64_tr_b16 a[106:107], v2 offset:33792
M a[24:27], a[160:163], a[80:83], a[24:27]
 s_lshl_b32 s64, s64, 29
 v_and_b32 v22, 32, v0
M a[24:27], a[164:167], a[84:87], a[24:27]
 s_waitcnt lgkmcnt(8)
 v_lshl_or_b32 v20, v22, 24, v20
M a[28:31], a[164:167], a[92:95], a[28:31]
 buffer_load_dwordx4 v14, s[48:51], s22 offen offset:2048   lds
M a[28:31], a[160:163], a[88:91], a[28:31]
 v_or_b32 v20, s64, v20
M v[60:63], a[168:171], a[88:91], v[60:63]
 ds_read_b128 a[160:163], v5 offset:4096
 ds_read_b128 a[164:167], v6 offset:4096
M v[60:63], a[172:175], a[92:95], v[60:63]
 ds_read_b64_tr_b16 a[108:109], v2 offset:40960
 ds_read_b64_tr_b16 a[110:111], v2 offset:41984
M v[56:59], a[172:175], a[84:87], v[56:59]
 buffer_load_dwordx4 v15, s[48:51], s22 offen offset:3072   lds
M v[56:59], a[168:171], a[80:83], v[56:59]
 s_sub_u32 s22, s22, 2097024
 v_and_b32 v22, 16, v0
M v[52:55], a[168:171], a[72:75], v[52:55]
 v_lshl_or_b32 v18, v22, 25, v20
M v[52:55], a[172:175], a[76:79], v[52:55]
 s_lshl_b32 s72, s30, 7
 ds_read_b64_tr_b16 a[112:113], v3 offset:32768
 ds_read_b64_tr_b16 a[114:115], v3 offset:33792
M v[48:51], a[172:175], a[68:71], v[48:51]
 s_add_u32 m0, s23, 16384
 s_add_u32 s72, s72, 104857600
M v[48:51], a[168:171], a[64:67], v[48:51]
 buffer_load_dwordx4 v8, s[16:19], s21 offen offset:0  nt lds
M v[44:47], a[168:171], a[56:59], v[44:47]
M v[44:47], a[172:175], a[60:63], v[44:47]
M v[40:43], a[172:175], a[52:55], v[40:43]
 ds_read_b64_tr_b16 a[116:117], v3 offset:40960
 ds_read_b64_tr_b16 a[118:119], v3 offset:41984
M v[40:43], a[168:171], a[48:51], v[40:43]
M v[36:39], a[168:171], a[40:43], v[36:39]
 buffer_load_dwordx4 v9, s[16:19], s21 offen offset:1024  nt lds
M v[36:39], a[172:175], a[44:47], v[36:39]
 s_waitcnt lgkmcnt(6)
M v[32:35], a[172:175], a[36:39], v[32:35]
 buffer_store_dword v21, v20, s[8:11], s72 offen sc1
M v[32:35], a[168:171], a[32:35], v[32:35]
 ds_read_b64_tr_b16 a[120:121], v4 offset:32768
 ds_read_b64_tr_b16 a[122:123], v4 offset:33792
M v[64:67], a[160:163], a[32:35], v[64:67]
 ds_read_b128 a[168:171], v5 offset:6144
 ds_read_b128 a[172:175], v6 offset:6144
M v[64:67], a[164:167], a[36:39], v[64:67]
 buffer_load_dwordx4 v10, s[16:19], s21 offen offset:2048  nt lds
M v[68:71], a[164:167], a[44:47], v[68:71]
M v[68:71], a[160:163], a[40:43], v[68:71]
M v[72:75], a[160:163], a[48:51], v[72:75]
 ds_read_b64_tr_b16 a[124:125], v4 offset:40960
 ds_read_b64_tr_b16 a[126:127], v4 offset:41984
M v[72:75], a[164:167], a[52:55], v[72:75]
M v[76:79], a[164:167], a[60:63], v[76:79]
 buffer_load_dwordx4 v11, s[16:19], s21 offen offset:3072  nt lds
M v[76:79], a[160:163], a[56:59], v[76:79]
 s_add_u32 s21, s21, 524160
M v[80:83], a[160:163], a[64:67], v[80:83]
M v[80:83], a[164:167], a[68:71], v[80:83]
M v[84:87], a[164:167], a[76:79], v[84:87]
M v[84:87], a[160:163], a[72:75], v[84:87]
 s_and_b32 s86, s41, 7
M v[88:91], a[160:163], a[80:83], v[88:91]
 s_mul_i32 s86, s86, 14
 s_lshr_b32 s64, s41, 3
 s_mul_i32 s64, s64, 7
M v[88:91], a[164:167], a[84:87], v[88:91]
 s_waitcnt lgkmcnt(2)
 s_add_u32 s86, s86, s64
 s_min_u32 s64, s42, 6
M v[92:95], a[164:167], a[92:95], v[92:95]
 s_waitcnt vmcnt(18) lgkmcnt(0)
 s_add_u32 s86, s86, s64
 s_sub_u32 s64, 6, s42
M v[92:95], a[160:163], a[88:91], v[92:95]
 s_barrier
M v[124:127], a[168:171], a[88:91], v[124:127]
 ds_read_b128 a[160:163], v5 offset:16384
 ds_read_b128 a[164:167], v6 offset:16384
M v[124:127], a[172:175], a[92:95], v[124:127]
 s_and_b32 s88, s64, 536870912
 s_mul_i32 s87, s20, 7168
M v[120:123], a[172:175], a[84:87], v[120:123]
 s_add_u32 m0, s24, 0
 ds_read_b64_tr_b16 a[128:129], v1 offset:49152
 ds_read_b64_tr_b16 a[130:131], v1 offset:50176
M v[120:123], a[168:171], a[80:83], v[120:123]
 buffer_load_dwordx4 v12, s[48:51], s22 offen offset:0   lds
M v[116:119], a[168:171], a[72:75], v[116:119]
 s_add_u32 s87, s87, 131072
M v[116:119], a[172:175], a[76:79], v[116:119]
 s_cmp_lt_u32 s20, 2
M v[112:115], a[172:175], a[68:71], v[112:115]
 s_cselect_b64 s[72:73], s[80:81], s[82:83]
M v[112:115], a[168:171], a[64:67], v[112:115]
 s_mov_b32 s60, s72
M v[108:111], a[168:171], a[56:59], v[108:111]
 s_and_b32 s61, s73, 0xffff
M v[108:111], a[172:175], a[60:63], v[108:111]
 s_mov_b32 s62, 1605632
 ds_read_b64_tr_b16 a[132:133], v1 offset:57344
 ds_read_b64_tr_b16 a[134:135], v1 offset:58368
M v[104:107], a[172:175], a[52:55], v[104:107]
 buffer_load_dwordx4 v13, s[48:51], s22 offen offset:1024   lds
M v[104:107], a[168:171], a[48:51], v[104:107]
 s_mov_b32 s63, 0x20000
M v[100:103], a[168:171], a[40:43], v[100:103]
 s_mov_b32 s68, s84
 s_and_b32 s69, s85, 0xffff
 s_mov_b32 s70, 1605632
M v[100:103], a[172:175], a[44:47], v[100:103]
 s_waitcnt lgkmcnt(4)
 s_mov_b32 s71, 0x20000
M v[96:99], a[172:175], a[36:39], v[96:99]
 s_lshl_b32 s89, s86, 5
 s_and_b32 s64, s20, 1
 s_mul_i32 s64, s64, 802816
M v[96:99], a[168:171], a[32:35], v[96:99]
 buffer_load_dwordx4 v14, s[48:51], s22 offen offset:2048   lds
M v[128:131], a[160:163], a[32:35], v[128:131]
 ds_read_b128 a[168:171], v5 offset:18432
 ds_read_b128 a[172:175], v6 offset:18432
M v[128:131], a[164:167], a[36:39], v[128:131]
 ds_read_b64_tr_b16 a[136:137], v2 offset:49152
 ds_read_b64_tr_b16 a[138:139], v2 offset:50176
M v[132:135], a[164:167], a[44:47], v[132:135]
 s_add_u32 s89, s89, s64
 v_lshrrev_b32 v28, 1, v0
M v[132:135], a[160:163], a[40:43], v[132:135]
 v_mul_u32_u24 v28, 3584, v28
 v_and_b32 v29, 1, v0
M v[136:139], a[160:163], a[48:51], v[136:139]
 v_lshl_add_u32 v25, v29, 4, v28
 v_or_b32 v25, s88, v25
M v[136:139], a[164:167], a[52:55], v[136:139]
M v[140:143], a[164:167], a[60:63], v[140:143]
 buffer_load_dwordx4 v15, s[48:51], s22 offen offset:3072   lds
M v[140:143], a[160:163], a[56:59], v[140:143]
 s_add_u32 s22, s22, 2097152
 ds_read_b64_tr_b16 a[140:141], v2 offset:57344
 ds_read_b64_tr_b16 a[142:143], v2 offset:58368
M v[144:147], a[160:163], a[64:67], v[144:147]
M v[144:147], a[164:167], a[68:71], v[144:147]
M v[148:151], a[164:167], a[76:79], v[148:151]
M v[148:151], a[160:163], a[72:75], v[148:151]
 s_add_u32 m0, s23, 32768
M v[152:155], a[160:163], a[80:83], v[152:155]
 buffer_load_dwordx4 v8, s[16:19], s21 offen offset:0  nt lds
M v[152:155], a[164:167], a[84:87], v[152:155]
 s_waitcnt lgkmcnt(4)
M v[156:159], a[164:167], a[92:95], v[156:159]
 ds_read_b64_tr_b16 a[144:145], v3 offset:49152
 ds_read_b64_tr_b16 a[146:147], v3 offset:50176
M v[156:159], a[160:163], a[88:91], v[156:159]
M v[188:191], a[168:171], a[88:91], v[188:191]
 ds_read_b128 a[160:163], v5 offset:20480
 ds_read_b128 a[164:167], v6 offset:20480
M v[188:191], a[172:175], a[92:95], v[188:191]
M v[184:187], a[172:175], a[84:87], v[184:187]
 buffer_load_dwordx4 v9, s[16:19], s21 offen offset:1024  nt lds
M v[184:187], a[168:171], a[80:83], v[184:187]
M v[180:183], a[168:171], a[72:75], v[180:183]
M v[180:183], a[172:175], a[76:79], v[180:183]
 ds_read_b64_tr_b16 a[148:149], v3 offset:57344
 ds_read_b64_tr_b16 a[150:151], v3 offset:58368
M v[176:179], a[172:175], a[68:71], v[176:179]
M v[176:179], a[168:171], a[64:67], v[176:179]
M v[172:175], a[168:171], a[56:59], v[172:175]
M v[172:175], a[172:175], a[60:63], v[172:175]
 buffer_load_dwordx4 v10, s[16:19], s21 offen offset:2048  nt lds
M v[168:171], a[172:175], a[52:55], v[168:171]
M v[168:171], a[168:171], a[48:51], v[168:171]
M v[164:167], a[168:171], a[40:43], v[164:167]
 ds_read_b64_tr_b16 a[152:153], v4 offset:49152
 ds_read_b64_tr_b16 a[154:155], v4 offset:50176
M v[164:167], a[172:175], a[44:47], v[164:167]
 s_waitcnt lgkmcnt(4)
M v[160:163], a[172:175], a[36:39], v[160:163]
M v[160:163], a[168:171], a[32:35], v[160:163]
 buffer_load_dwordx4 v11, s[16:19], s21 offen offset:3072  nt lds
M v[192:195], a[160:163], a[32:35], v[192:195]
 s_add_u32 s21, s21, 128
 ds_read_b128 a[168:171], v5 offset:22528
 ds_read_b128 a[172:175], v6 offset:22528
M v[192:195], a[164:167], a[36:39], v[192:195]
M v[196:199], a[164:167], a[44:47], v[196:199]
M v[196:199], a[160:163], a[40:43], v[196:199]
 ds_read_b64_tr_b16 a[156:157], v4 offset:57344
 ds_read_b64_tr_b16 a[158:159], v4 offset:58368
M v[200:203], a[160:163], a[48:51], v[200:203]
 s_add_u32 m0, s87, 0
M v[200:203], a[164:167], a[52:55], v[200:203]
 buffer_load_dwordx4 v25, s[60:63], s89 offen offset:0 nt lds
M v[204:207], a[164:167], a[60:63], v[204:207]
 s_add_u32 s89, s89, 114688
M v[204:207], a[160:163], a[56:59], v[204:207]
M v[208:211], a[160:163], a[64:67], v[208:211]
M v[208:211], a[164:167], a[68:71], v[208:211]
M v[212:215], a[164:167], a[76:79], v[212:215]
M v[212:215], a[160:163], a[72:75], v[212:215]
M v[216:219], a[160:163], a[80:83], v[216:219]
M v[216:219], a[164:167], a[84:87], v[216:219]
 s_waitcnt lgkmcnt(2)
M v[220:223], a[164:167], a[92:95], v[220:223]
 s_waitcnt vmcnt(19) lgkmcnt(0)
M v[220:223], a[160:163], a[88:91], v[220:223]
 s_barrier
M v[252:255], a[168:171], a[88:91], v[252:255]
 ds_read_b128 a[160:163], v5 offset:32768
 ds_read_b128 a[164:167], v6 offset:32768
M v[252:255], a[172:175], a[92:95], v[252:255]
M v[248:251], a[172:175], a[84:87], v[248:251]
M v[248:251], a[168:171], a[80:83], v[248:251]
M v[244:247], a[168:171], a[72:75], v[244:247]
M v[244:247], a[172:175], a[76:79], v[244:247]
M v[240:243], a[172:175], a[68:71], v[240:243]
M v[240:243], a[168:171], a[64:67], v[240:243]
M v[236:239], a[168:171], a[56:59], v[236:239]
M v[236:239], a[172:175], a[60:63], v[236:239]
M v[232:235], a[172:175], a[52:55], v[232:235]
M v[232:235], a[168:171], a[48:51], v[232:235]
M v[228:231], a[168:171], a[40:43], v[228:231]
M v[228:231], a[172:175], a[44:47], v[228:231]
 s_waitcnt lgkmcnt(0)
M v[224:227], a[172:175], a[36:39], v[224:227]
M v[224:227], a[168:171], a[32:35], v[224:227]
M a[0:3], a[160:163], a[96:99], a[0:3]
 ds_read_b128 a[168:171], v5 offset:34816
 ds_read_b128 a[172:175], v6 offset:34816
M a[0:3], a[164:167], a[100:103], a[0:3]
 ds_read_b64_tr_b16 a[32:33], v1 offset:0
 ds_read_b64_tr_b16 a[34:35], v1 offset:1024
M a[4:7], a[164:167], a[108:111], a[4:7]
 s_add_u32 m0, s24, 16384
M a[4:7], a[160:163], a[104:107], a[4:7]
 buffer_load_dwordx4 v12, s[48:51], s22 offen offset:0   lds
M a[8:11], a[160:163], a[112:115], a[8:11]
M a[8:11], a[164:167], a[116:119], a[8:11]
M a[12:15], a[164:167], a[124:127], a[12:15]
 ds_read_b64_tr_b16 a[36:37], v1 offset:8192
 ds_read_b64_tr_b16 a[38:39], v1 offset:9216
M a[12:15], a[160:163], a[120:123], a[12:15]
M a[16:19], a[160:163], a[128:131], a[16:19]
 buffer_load_dwordx4 v13, s[48:51], s22 offen offset:1024   lds
M a[16:19], a[164:167], a[132:135], a[16:19]
M a[20:23], a[164:167], a[140:143], a[20:23]
M a[20:23], a[160:163], a[136:139], a[20:23]
 ds_read_b64_tr_b16 a[40:41], v2 offset:0
 ds_read_b64_tr_b16 a[42:43], v2 offset:1024
M a[24:27], a[160:163], a[144:147], a[24:27]
M a[24:27], a[164:167], a[148:151], a[24:27]
 s_waitcnt lgkmcnt(6)
M a[28:31], a[164:167], a[156:159], a[28:31]
 buffer_load_dwordx4 v14, s[48:51], s22 offen offset:2048   lds
M a[28:31], a[160:163], a[152:155], a[28:31]
M v[60:63], a[168:171], a[152:155], v[60:63]
 ds_read_b128 a[160:163], v5 offset:36864
 ds_read_b128 a[164:167], v6 offset:36864
M v[60:63], a[172:175], a[156:159], v[60:63]
 ds_read_b64_tr_b16 a[44:45], v2 offset:8192
 ds_read_b64_tr_b16 a[46:47], v2 offset:9216
M v[56:59], a[172:175], a[148:151], v[56:59]
 buffer_load_dwordx4 v15, s[48:51], s22 offen offset:3072   lds
M v[56:59], a[168:171], a[144:147], v[56:59]
 s_sub_u32 s22, s22, 2097024
M v[52:55], a[168:171], a[136:139], v[52:55]
M v[52:55], a[172:175], a[140:143], v[52:55]
 ds_read_b64_tr_b16 a[48:49], v3 offset:0
 ds_read_b64_tr_b16 a[50:51], v3 offset:1024
M v[48:51], a[172:175], a[132:135], v[48:51]
 s_add_u32 m0, s23, 49152
M v[48:51], a[168:171], a[128:131], v[48:51]
 buffer_load_dwordx4 v8, s[16:19], s21 offen offset:0  nt lds
M v[44:47], a[168:171], a[120:123], v[44:47]
M v[44:47], a[172:175], a[124:127], v[44:47]
M v[40:43], a[172:175], a[116:119], v[40:43]
 ds_read_b64_tr_b16 a[52:53], v3 offset:8192
 ds_read_b64_tr_b16 a[54:55], v3 offset:9216
M v[40:43], a[168:171], a[112:115], v[40:43]
M v[36:39], a[168:171], a[104:107], v[36:39]
 buffer_load_dwordx4 v9, s[16:19], s21 offen offset:1024  nt lds
M v[36:39], a[172:175], a[108:111], v[36:39]
 s_waitcnt lgkmcnt(6)
M v[32:35], a[172:175], a[100:103], v[32:35]
M v[32:35], a[168:171], a[96:99], v[32:35]
 ds_read_b64_tr_b16 a[56:57], v4 offset:0
 ds_read_b64_tr_b16 a[58:59], v4 offset:1024
M v[64:67], a[160:163], a[96:99], v[64:67]
 ds_read_b128 a[168:171], v5 offset:38912
 ds_read_b128 a[172:175], v6 offset:38912
M v[64:67], a[164:167], a[100:103], v[64:67]
 buffer_load_dwordx4 v10, s[16:19], s21 offen offset:2048  nt lds
M v[68:71], a[164:167], a[108:111], v[68:71]
M v[68:71], a[160:163], a[104:107], v[68:71]
M v[72:75], a[160:163], a[112:115], v[72:75]
 ds_read_b64_tr_b16 a[60:61], v4 offset:8192
 ds_read_b64_tr_b16 a[62:63], v4 offset:9216
M v[72:75], a[164:167], a[116:119], v[72:75]
M v[76:79], a[164:167], a[124:127], v[76:79]
 buffer_load_dwordx4 v11, s[16:19], s21 offen offset:3072  nt lds
M v[76:79], a[160:163], a[120:123], v[76:79]
 s_add_u32 s21, s21, 524160
M v[80:83], a[160:163], a[128:131], v[80:83]
M v[80:83], a[164:167], a[132:135], v[80:83]
M v[84:87], a[164:167], a[140:143], v[84:87]
M v[84:87], a[160:163], a[136:139], v[84:87]
M v[88:91], a[160:163], a[144:147], v[88:91]
M v[88:91], a[164:167], a[148:151], v[88:91]
 s_waitcnt lgkmcnt(2)
M v[92:95], a[164:167], a[156:159], v[92:95]
 s_waitcnt vmcnt(17) lgkmcnt(0)
M v[92:95], a[160:163], a[152:155], v[92:95]
 s_barrier
M v[124:127], a[168:171], a[152:155], v[124:127]
 ds_read_b128 a[160:163], v5 offset:49152
 ds_read_b128 a[164:167], v6 offset:49152
M v[124:127], a[172:175], a[156:159], v[124:127]
M v[120:123], a[172:175], a[148:151], v[120:123]
 s_add_u32 m0, s24, 32768
 ds_read_b64_tr_b16 a[64:65], v1 offset:16384
 ds_read_b64_tr_b16 a[66:67], v1 offset:17408
M v[120:123], a[168:171], a[144:147], v[120:123]
 buffer_load_dwordx4 v12, s[48:51], s22 offen offset:0   lds
M v[116:119], a[168:171], a[136:139], v[116:119]
 v_min_u32 v16, 40, v0
 v_lshlrev_b32 v16, 2, v16
M v[116:119], a[172:175], a[140:143], v[116:119]
 buffer_load_dword v17, v16, s[12:15], 0 offen offset:64 sc1
M v[112:115], a[172:175], a[132:135], v[112:115]
M v[112:115], a[168:171], a[128:131], v[112:115]
M v[108:111], a[168:171], a[120:123], v[108:111]
M v[108:111], a[172:175], a[124:127], v[108:111]
 ds_read_b64_tr_b16 a[68:69], v1 offset:24576
 ds_read_b64_tr_b16 a[70:71], v1 offset:25600
M v[104:107], a[172:175], a[116:119], v[104:107]
 buffer_load_dwordx4 v13, s[48:51], s22 offen offset:1024   lds
M v[104:107], a[168:171], a[112:115], v[104:107]
M v[100:103], a[168:171], a[104:107], v[100:103]
M v[100:103], a[172:175], a[108:111], v[100:103]
 s_waitcnt lgkmcnt(4)
M v[96:99], a[172:175], a[100:103], v[96:99]
M v[96:99], a[168:171], a[96:99], v[96:99]
 buffer_load_dwordx4 v14, s[48:51], s22 offen offset:2048   lds
M v[128:131], a[160:163], a[96:99], v[128:131]
 ds_read_b128 a[168:171], v5 offset:51200
 ds_read_b128 a[172:175], v6 offset:51200
M v[128:131], a[164:167], a[100:103], v[128:131]
 ds_read_b64_tr_b16 a[72:73], v2 offset:16384
 ds_read_b64_tr_b16 a[74:75], v2 offset:17408
M v[132:135], a[164:167], a[108:111], v[132:135]
M v[132:135], a[160:163], a[104:107], v[132:135]
M v[136:139], a[160:163], a[112:115], v[136:139]
M v[136:139], a[164:167], a[116:119], v[136:139]
M v[140:143], a[164:167], a[124:127], v[140:143]
 buffer_load_dwordx4 v15, s[48:51], s22 offen offset:3072   lds
M v[140:143], a[160:163], a[120:123], v[140:143]
 s_add_u32 s22, s22, 2097152
 ds_read_b64_tr_b16 a[76:77], v2 offset:24576
 ds_read_b64_tr_b16 a[78:79], v2 offset:25600
M v[144:147], a[160:163], a[128:131], v[144:147]
M v[144:147], a[164:167], a[132:135], v[144:147]
M v[148:151], a[164:167], a[140:143], v[148:151]
M v[148:151], a[160:163], a[136:139], v[148:151]
 s_add_u32 m0, s23, 0
M v[152:155], a[160:163], a[144:147], v[152:155]
 buffer_load_dwordx4 v8, s[16:19], s21 offen offset:0  nt lds
M v[152:155], a[164:167], a[148:151], v[152:155]
 s_waitcnt lgkmcnt(4)
M v[156:159], a[164:167], a[156:159], v[156:159]
 ds_read_b64_tr_b16 a[80:81], v3 offset:16384
 ds_read_b64_tr_b16 a[82:83], v3 offset:17408
M v[156:159], a[160:163], a[152:155], v[156:159]
M v[188:191], a[168:171], a[152:155], v[188:191]
 ds_read_b128 a[160:163], v5 offset:53248
 ds_read_b128 a[164:167], v6 offset:53248
M v[188:191], a[172:175], a[156:159], v[188:191]
M v[184:187], a[172:175], a[148:151], v[184:187]
 buffer_load_dwordx4 v9, s[16:19], s21 offen offset:1024  nt lds
M v[184:187], a[168:171], a[144:147], v[184:187]
M v[180:183], a[168:171], a[136:139], v[180:183]
M v[180:183], a[172:175], a[140:143], v[180:183]
 ds_read_b64_tr_b16 a[84:85], v3 offset:24576
 ds_read_b64_tr_b16 a[86:87], v3 offset:25600
M v[176:179], a[172:175], a[132:135], v[176:179]
M v[176:179], a[168:171], a[128:131], v[176:179]
M v[172:175], a[168:171], a[120:123], v[172:175]
M v[172:175], a[172:175], a[124:127], v[172:175]
 buffer_load_dwordx4 v10, s[16:19], s21 offen offset:2048  nt lds
M v[168:171], a[172:175], a[116:119], v[168:171]
M v[168:171], a[168:171], a[112:115], v[168:171]
M v[164:167], a[168:171], a[104:107], v[164:167]
 ds_read_b64_tr_b16 a[88:89], v4 offset:16384
 ds_read_b64_tr_b16 a[90:91], v4 offset:17408
M v[164:167], a[172:175], a[108:111], v[164:167]
 s_waitcnt lgkmcnt(4)
M v[160:163], a[172:175], a[100:103], v[160:163]
M v[160:163], a[168:171], a[96:99], v[160:163]
 buffer_load_dwordx4 v11, s[16:19], s21 offen offset:3072  nt lds
M v[192:195], a[160:163], a[96:99], v[192:195]
 s_add_u32 s21, s21, 128
 ds_read_b128 a[168:171], v5 offset:55296
 ds_read_b128 a[172:175], v6 offset:55296
M v[192:195], a[164:167], a[100:103], v[192:195]
M v[196:199], a[164:167], a[108:111], v[196:199]
M v[196:199], a[160:163], a[104:107], v[196:199]
 ds_read_b64_tr_b16 a[92:93], v4 offset:24576
 ds_read_b64_tr_b16 a[94:95], v4 offset:25600
M v[200:203], a[160:163], a[112:115], v[200:203]
 s_add_u32 m0, s87, 1024
M v[200:203], a[164:167], a[116:119], v[200:203]
 buffer_load_dwordx4 v25, s[60:63], s89 offen offset:0 nt lds
M v[204:207], a[164:167], a[124:127], v[204:207]
 s_add_u32 s89, s89, 114688
M v[204:207], a[160:163], a[120:123], v[204:207]
M v[208:211], a[160:163], a[128:131], v[208:211]
M v[208:211], a[164:167], a[132:135], v[208:211]
M v[212:215], a[164:167], a[140:143], v[212:215]
M v[212:215], a[160:163], a[136:139], v[212:215]
M v[216:219], a[160:163], a[144:147], v[216:219]
M v[216:219], a[164:167], a[148:151], v[216:219]
 s_waitcnt lgkmcnt(2)
M v[220:223], a[164:167], a[156:159], v[220:223]
 s_waitcnt vmcnt(19) lgkmcnt(0)
M v[220:223], a[160:163], a[152:155], v[220:223]
 s_barrier
M v[252:255], a[168:171], a[152:155], v[252:255]
 ds_read_b128 a[160:163], v5 offset:0
 ds_read_b128 a[164:167], v6 offset:0
M v[252:255], a[172:175], a[156:159], v[252:255]
M v[248:251], a[172:175], a[148:151], v[248:251]
M v[248:251], a[168:171], a[144:147], v[248:251]
M v[244:247], a[168:171], a[136:139], v[244:247]
M v[244:247], a[172:175], a[140:143], v[244:247]
M v[240:243], a[172:175], a[132:135], v[240:243]
M v[240:243], a[168:171], a[128:131], v[240:243]
M v[236:239], a[168:171], a[120:123], v[236:239]
M v[236:239], a[172:175], a[124:127], v[236:239]
M v[232:235], a[172:175], a[116:119], v[232:235]
M v[232:235], a[168:171], a[112:115], v[232:235]
M v[228:231], a[168:171], a[104:107], v[228:231]
M v[228:231], a[172:175], a[108:111], v[228:231]
 s_waitcnt lgkmcnt(0)
M v[224:227], a[172:175], a[100:103], v[224:227]
M v[224:227], a[168:171], a[96:99], v[224:227]
M a[0:3], a[160:163], a[32:35], a[0:3]
 ds_read_b128 a[168:171], v5 offset:2048
 ds_read_b128 a[172:175], v6 offset:2048
M a[0:3], a[164:167], a[36:39], a[0:3]
 ds_read_b64_tr_b16 a[96:97], v1 offset:32768
 ds_read_b64_tr_b16 a[98:99], v1 offset:33792
M a[4:7], a[164:167], a[44:47], a[4:7]
 s_add_u32 m0, s24, 49152
M a[4:7], a[160:163], a[40:43], a[4:7]
 buffer_load_dwordx4 v12, s[48:51], s22 offen offset:0   lds
M a[8:11], a[160:163], a[48:51], a[8:11]
M a[8:11], a[164:167], a[52:55], a[8:11]
M a[12:15], a[164:167], a[60:63], a[12:15]
 ds_read_b64_tr_b16 a[100:101], v1 offset:40960
 ds_read_b64_tr_b16 a[102:103], v1 offset:41984
M a[12:15], a[160:163], a[56:59], a[12:15]
M a[16:19], a[160:163], a[64:67], a[16:19]
 buffer_load_dwordx4 v13, s[48:51], s22 offen offset:1024   lds
M a[16:19], a[164:167], a[68:71], a[16:19]
M a[20:23], a[164:167], a[76:79], a[20:23]
M a[20:23], a[160:163], a[72:75], a[20:23]
 ds_read_b64_tr_b16 a[104:105], v2 offset:32768
 ds_read_b64_tr_b16 a[106:107], v2 offset:33792
M a[24:27], a[160:163], a[80:83], a[24:27]
M a[24:27], a[164:167], a[84:87], a[24:27]
 s_waitcnt lgkmcnt(6)
M a[28:31], a[164:167], a[92:95], a[28:31]
 buffer_load_dwordx4 v14, s[48:51], s22 offen offset:2048   lds
M a[28:31], a[160:163], a[88:91], a[28:31]
M v[60:63], a[168:171], a[88:91], v[60:63]
 ds_read_b128 a[160:163], v5 offset:4096
 ds_read_b128 a[164:167], v6 offset:4096
M v[60:63], a[172:175], a[92:95], v[60:63]
 ds_read_b64_tr_b16 a[108:109], v2 offset:40960
 ds_read_b64_tr_b16 a[110:111], v2 offset:41984
M v[56:59], a[172:175], a[84:87], v[56:59]
 buffer_load_dwordx4 v15, s[48:51], s22 offen offset:3072   lds
M v[56:59], a[168:171], a[80:83], v[56:59]
 s_sub_u32 s22, s22, 2097024
M v[52:55], a[168:171], a[72:75], v[52:55]
M v[52:55], a[172:175], a[76:79], v[52:55]
 ds_read_b64_tr_b16 a[112:113], v3 offset:32768
 ds_read_b64_tr_b16 a[114:115], v3 offset:33792
M v[48:51], a[172:175], a[68:71], v[48:51]
 s_add_u32 m0, s23, 16384
M v[48:51], a[168:171], a[64:67], v[48:51]
 buffer_load_dwordx4 v8, s[16:19], s21 offen offset:0  nt lds
M v[44:47], a[168:171], a[56:59], v[44:47]
M v[44:47], a[172:175], a[60:63], v[44:47]
M v[40:43], a[172:175], a[52:55], v[40:43]
 ds_read_b64_tr_b16 a[116:117], v3 offset:40960
 ds_read_b64_tr_b16 a[118:119], v3 offset:41984
M v[40:43], a[168:171], a[48:51], v[40:43]
M v[36:39], a[168:171], a[40:43], v[36:39]
 buffer_load_dwordx4 v9, s[16:19], s21 offen offset:1024  nt lds
M v[36:39], a[172:175], a[44:47], v[36:39]
 s_waitcnt lgkmcnt(6)
M v[32:35], a[172:175], a[36:39], v[32:35]
M v[32:35], a[168:171], a[32:35], v[32:35]
 ds_read_b64_tr_b16 a[120:121], v4 offset:32768
 ds_read_b64_tr_b16 a[122:123], v4 offset:33792
M v[64:67], a[160:163], a[32:35], v[64:67]
 ds_read_b128 a[168:171], v5 offset:6144
 ds_read_b128 a[172:175], v6 offset:6144
M v[64:67], a[164:167], a[36:39], v[64:67]
 buffer_load_dwordx4 v10, s[16:19], s21 offen offset:2048  nt lds
M v[68:71], a[164:167], a[44:47], v[68:71]
M v[68:71], a[160:163], a[40:43], v[68:71]
M v[72:75], a[160:163], a[48:51], v[72:75]
 ds_read_b64_tr_b16 a[124:125], v4 offset:40960
 ds_read_b64_tr_b16 a[126:127], v4 offset:41984
M v[72:75], a[164:167], a[52:55], v[72:75]
M v[76:79], a[164:167], a[60:63], v[76:79]
 buffer_load_dwordx4 v11, s[16:19], s21 offen offset:3072  nt lds
M v[76:79], a[160:163], a[56:59], v[76:79]
 s_add_u32 s21, s21, 524160
M v[80:83], a[160:163], a[64:67], v[80:83]
M v[80:83], a[164:167], a[68:71], v[80:83]
M v[84:87], a[164:167], a[76:79], v[84:87]
M v[84:87], a[160:163], a[72:75], v[84:87]
M v[88:91], a[160:163], a[80:83], v[88:91]
M v[88:91], a[164:167], a[84:87], v[88:91]
 s_waitcnt lgkmcnt(2)
M v[92:95], a[164:167], a[92:95], v[92:95]
 s_waitcnt vmcnt(18) lgkmcnt(0)
M v[92:95], a[160:163], a[88:91], v[92:95]
 s_barrier
M v[124:127], a[168:171], a[88:91], v[124:127]
 ds_read_b128 a[160:163], v5 offset:16384
 ds_read_b128 a[164:167], v6 offset:16384
M v[124:127], a[172:175], a[92:95], v[124:127]
M v[120:123], a[172:175], a[84:87], v[120:123]
 s_add_u32 m0, s24, 0
 ds_read_b64_tr_b16 a[128:129], v1 offset:49152
 ds_read_b64_tr_b16 a[130:131], v1 offset:50176
M v[120:123], a[168:171], a[80:83], v[120:123]
 buffer_load_dwordx4 v12, s[48:51], s22 offen offset:0   lds
M v[116:119], a[168:171], a[72:75], v[116:119]
M v[116:119], a[172:175], a[76:79], v[116:119]
M v[112:115], a[172:175], a[68:71], v[112:115]
M v[112:115], a[168:171], a[64:67], v[112:115]
M v[108:111], a[168:171], a[56:59], v[108:111]
M v[108:111], a[172:175], a[60:63], v[108:111]
 ds_read_b64_tr_b16 a[132:133], v1 offset:57344
 ds_read_b64_tr_b16 a[134:135], v1 offset:58368
M v[104:107], a[172:175], a[52:55], v[104:107]
 buffer_load_dwordx4 v13, s[48:51], s22 offen offset:1024   lds
M v[104:107], a[168:171], a[48:51], v[104:107]
M v[100:103], a[168:171], a[40:43], v[100:103]
M v[100:103], a[172:175], a[44:47], v[100:103]
 s_waitcnt lgkmcnt(4)
M v[96:99], a[172:175], a[36:39], v[96:99]
M v[96:99], a[168:171], a[32:35], v[96:99]
 buffer_load_dwordx4 v14, s[48:51], s22 offen offset:2048   lds
M v[128:131], a[160:163], a[32:35], v[128:131]
 ds_read_b128 a[168:171], v5 offset:18432
 ds_read_b128 a[172:175], v6 offset:18432
M v[128:131], a[164:167], a[36:39], v[128:131]
 ds_read_b64_tr_b16 a[136:137], v2 offset:49152
 ds_read_b64_tr_b16 a[138:139], v2 offset:50176
M v[132:135], a[164:167], a[44:47], v[132:135]
M v[132:135], a[160:163], a[40:43], v[132:135]
M v[136:139], a[160:163], a[48:51], v[136:139]
M v[136:139], a[164:167], a[52:55], v[136:139]
M v[140:143], a[164:167], a[60:63], v[140:143]
 buffer_load_dwordx4 v15, s[48:51], s22 offen offset:3072   lds
M v[140:143], a[160:163], a[56:59], v[140:143]
 s_add_u32 s22, s22, 2097152
 ds_read_b64_tr_b16 a[140:141], v2 offset:57344
 ds_read_b64_tr_b16 a[142:143], v2 offset:58368
M v[144:147], a[160:163], a[64:67], v[144:147]
M v[144:147], a[164:167], a[68:71], v[144:147]
M v[148:151], a[164:167], a[76:79], v[148:151]
M v[148:151], a[160:163], a[72:75], v[148:151]
 s_add_u32 m0, s23, 32768
M v[152:155], a[160:163], a[80:83], v[152:155]
 buffer_load_dwordx4 v8, s[16:19], s21 offen offset:0  nt lds
M v[152:155], a[164:167], a[84:87], v[152:155]
 s_waitcnt lgkmcnt(4)
M v[156:159], a[164:167], a[92:95], v[156:159]
 ds_read_b64_tr_b16 a[144:145], v3 offset:49152
 ds_read_b64_tr_b16 a[146:147], v3 offset:50176
M v[156:159], a[160:163], a[88:91], v[156:159]
M v[188:191], a[168:171], a[88:91], v[188:191]
 ds_read_b128 a[160:163], v5 offset:20480
 ds_read_b128 a[164:167], v6 offset:20480
M v[188:191], a[172:175], a[92:95], v[188:191]
M v[184:187], a[172:175], a[84:87], v[184:187]
 buffer_load_dwordx4 v9, s[16:19], s21 offen offset:1024  nt lds
M v[184:187], a[168:171], a[80:83], v[184:187]
M v[180:183], a[168:171], a[72:75], v[180:183]
M v[180:183], a[172:175], a[76:79], v[180:183]
 ds_read_b64_tr_b16 a[148:149], v3 offset:57344
 ds_read_b64_tr_b16 a[150:151], v3 offset:58368
M v[176:179], a[172:175], a[68:71], v[176:179]
M v[176:179], a[168:171], a[64:67], v[176:179]
M v[172:175], a[168:171], a[56:59], v[172:175]
M v[172:175], a[172:175], a[60:63], v[172:175]
 buffer_load_dwordx4 v10, s[16:19], s21 offen offset:2048  nt lds
M v[168:171], a[172:175], a[52:55], v[168:171]
M v[168:171], a[168:171], a[48:51], v[168:171]
M v[164:167], a[168:171], a[40:43], v[164:167]
 ds_read_b64_tr_b16 a[152:153], v4 offset:49152
 ds_read_b64_tr_b16 a[154:155], v4 offset:50176
M v[164:167], a[172:175], a[44:47], v[164:167]
 s_waitcnt lgkmcnt(4)
M v[160:163], a[172:175], a[36:39], v[160:163]
M v[160:163], a[168:171], a[32:35], v[160:163]
 buffer_load_dwordx4 v11, s[16:19], s21 offen offset:3072  nt lds
M v[192:195], a[160:163], a[32:35], v[192:195]
 s_add_u32 s21, s21, 128
 ds_read_b128 a[168:171], v5 offset:22528
 ds_read_b128 a[172:175], v6 offset:22528
M v[192:195], a[164:167], a[36:39], v[192:195]
M v[196:199], a[164:167], a[44:47], v[196:199]
M v[196:199], a[160:163], a[40:43], v[196:199]
 ds_read_b64_tr_b16 a[156:157], v4 offset:57344
 ds_read_b64_tr_b16 a[158:159], v4 offset:58368
M v[200:203], a[160:163], a[48:51], v[200:203]
 s_add_u32 m0, s87, 2048
M v[200:203], a[164:167], a[52:55], v[200:203]
 buffer_load_dwordx4 v25, s[60:63], s89 offen offset:0 nt lds
M v[204:207], a[164:167], a[60:63], v[204:207]
 s_add_u32 s89, s89, 114688
M v[204:207], a[160:163], a[56:59], v[204:207]
M v[208:211], a[160:163], a[64:67], v[208:211]
M v[208:211], a[164:167], a[68:71], v[208:211]
M v[212:215], a[164:167], a[76:79], v[212:215]
M v[212:215], a[160:163], a[72:75], v[212:215]
M v[216:219], a[160:163], a[80:83], v[216:219]
M v[216:219], a[164:167], a[84:87], v[216:219]
 s_waitcnt lgkmcnt(2)
M v[220:223], a[164:167], a[92:95], v[220:223]
 s_waitcnt vmcnt(18) lgkmcnt(0)
M v[220:223], a[160:163], a[88:91], v[220:223]
 s_barrier
M v[252:255], a[168:171], a[88:91], v[252:255]
 ds_read_b128 a[160:163], v5 offset:32768
 ds_read_b128 a[164:167], v6 offset:32768
M v[252:255], a[172:175], a[92:95], v[252:255]
 v_cmp_ne_u32 vcc, 1, v17
M v[248:251], a[172:175], a[84:87], v[248:251]
 s_nop 0
M v[248:251], a[168:171], a[80:83], v[248:251]
 s_cbranch_vccnz L_zs0
L_zr0:
M v[244:247], a[168:171], a[72:75], v[244:247]
 buffer_load_dword a240, v24, s[32:35], 0 offen offset:1024
M v[244:247], a[172:175], a[76:79], v[244:247]
 s_lshl_b32 s72, s30, 6
M v[240:243], a[172:175], a[68:71], v[240:243]
 s_add_u32 s72, s72, 104914944
M v[240:243], a[168:171], a[64:67], v[240:243]
M v[236:239], a[168:171], a[56:59], v[236:239]
 buffer_store_dword v19, v18, s[8:11], s72 offen sc1
M v[236:239], a[172:175], a[60:63], v[236:239]
M v[232:235], a[172:175], a[52:55], v[232:235]
M v[232:235], a[168:171], a[48:51], v[232:235]
M v[228:231], a[168:171], a[40:43], v[228:231]
M v[228:231], a[172:175], a[44:47], v[228:231]
 s_waitcnt lgkmcnt(0)
M v[224:227], a[172:175], a[36:39], v[224:227]
M v[224:227], a[168:171], a[32:35], v[224:227]
M a[0:3], a[160:163], a[96:99], a[0:3]
 ds_read_b128 a[168:171], v5 offset:34816
 ds_read_b128 a[172:175], v6 offset:34816
M a[0:3], a[164:167], a[100:103], a[0:3]
 ds_read_b64_tr_b16 a[32:33], v1 offset:0
 ds_read_b64_tr_b16 a[34:35], v1 offset:1024
M a[4:7], a[164:167], a[108:111], a[4:7]
 s_add_u32 m0, s24, 16384
M a[4:7], a[160:163], a[104:107], a[4:7]
 buffer_load_dwordx4 v12, s[48:51], s22 offen offset:0   lds
M a[8:11], a[160:163], a[112:115], a[8:11]
M a[8:11], a[164:167], a[116:119], a[8:11]
M a[12:15], a[164:167], a[124:127], a[12:15]
 ds_read_b64_tr_b16 a[36:37], v1 offset:8192
 ds_read_b64_tr_b16 a[38:39], v1 offset:9216
M a[12:15], a[160:163], a[120:123], a[12:15]
M a[16:19], a[160:163], a[128:131], a[16:19]
 buffer_load_dwordx4 v13, s[48:51], s22 offen offset:1024   lds
M a[16:19], a[164:167], a[132:135], a[16:19]
M a[20:23], a[164:167], a[140:143], a[20:23]
M a[20:23], a[160:163], a[136:139], a[20:23]
 ds_read_b64_tr_b16 a[40:41], v2 offset:0
 ds_read_b64_tr_b16 a[42:43], v2 offset:1024
M a[24:27], a[160:163], a[144:147], a[24:27]
M a[24:27], a[164:167], a[148:151], a[24:27]
 s_waitcnt lgkmcnt(6)
M a[28:31], a[164:167], a[156:159], a[28:31]
 buffer_load_dwordx4 v14, s[48:51], s22 offen offset:2048   lds
M a[28:31], a[160:163], a[152:155], a[28:31]
M v[60:63], a[168:171], a[152:155], v[60:63]
 ds_read_b128 a[160:163], v5 offset:36864
 ds_read_b128 a[164:167], v6 offset:36864
M v[60:63], a[172:175], a[156:159], v[60:63]
 ds_read_b64_tr_b16 a[44:45], v2 offset:8192
 ds_read_b64_tr_b16 a[46:47], v2 offset:9216
M v[56:59], a[172:175], a[148:151], v[56:59]
 buffer_load_dwordx4 v15, s[48:51], s22 offen offset:3072   lds
M v[56:59], a[168:171], a[144:147], v[56:59]
 s_sub_u32 s22, s22, 2097024
M v[52:55], a[168:171], a[136:139], v[52:55]
M v[52:55], a[172:175], a[140:143], v[52:55]
 ds_read_b64_tr_b16 a[48:49], v3 offset:0
 ds_read_b64_tr_b16 a[50:51], v3 offset:1024
M v[48:51], a[172:175], a[132:135], v[48:51]
 s_add_u32 m0, s23, 49152
M v[48:51], a[168:171], a[128:131], v[48:51]
 buffer_load_dwordx4 v8, s[16:19], s21 offen offset:0  nt lds
M v[44:47], a[168:171], a[120:123], v[44:47]
M v[44:47], a[172:175], a[124:127], v[44:47]
M v[40:43], a[172:175], a[116:119], v[40:43]
 ds_read_b64_tr_b16 a[52:53], v3 offset:8192
 ds_read_b64_tr_b16 a[54:55], v3 offset:9216
M v[40:43], a[168:171], a[112:115], v[40:43]
M v[36:39], a[168:171], a[104:107], v[36:39]
 buffer_load_dwordx4 v9, s[16:19], s21 offen offset:1024  nt lds
M v[36:39], a[172:175], a[108:111], v[36:39]
 s_waitcnt lgkmcnt(6)
M v[32:35], a[172:175], a[100:103], v[32:35]
M v[32:35], a[168:171], a[96:99], v[32:35]
 ds_read_b64_tr_b16 a[56:57], v4 offset:0
 ds_read_b64_tr_b16 a[58:59], v4 offset:1024
M v[64:67], a[160:163], a[96:99], v[64:67]
 ds_read_b128 a[168:171], v5 offset:38912
 ds_read_b128 a[172:175], v6 offset:38912
M v[64:67], a[164:167], a[100:103], v[64:67]
 buffer_load_dwordx4 v10, s[16:19], s21 offen offset:2048  nt lds
M v[68:71], a[164:167], a[108:111], v[68:71]
M v[68:71], a[160:163], a[104:107], v[68:71]
M v[72:75], a[160:163], a[112:115], v[72:75]
 ds_read_b64_tr_b16 a[60:61], v4 offset:8192
 ds_read_b64_tr_b16 a[62:63], v4 offset:9216
M v[72:75], a[164:167], a[116:119], v[72:75]
M v[76:79], a[164:167], a[124:127], v[76:79]
 buffer_load_dwordx4 v11, s[16:19], s21 offen offset:3072  nt lds
M v[76:79], a[160:163], a[120:123], v[76:79]
 s_add_u32 s21, s21, 524160
M v[80:83], a[160:163], a[128:131], v[80:83]
M v[80:83], a[164:167], a[132:135], v[80:83]
M v[84:87], a[164:167], a[140:143], v[84:87]
M v[84:87], a[160:163], a[136:139], v[84:87]
M v[88:91], a[160:163], a[144:147], v[88:91]
M v[88:91], a[164:167], a[148:151], v[88:91]
 s_waitcnt lgkmcnt(2)
M v[92:95], a[164:167], a[156:159], v[92:95]
 s_waitcnt vmcnt(19) lgkmcnt(0)
M v[92:95], a[160:163], a[152:155], v[92:95]
 s_barrier
M v[124:127], a[168:171], a[152:155], v[124:127]
 ds_read_b128 a[160:163], v5 offset:49152
 ds_read_b128 a[164:167], v6 offset:49152
M v[124:127], a[172:175], a[156:159], v[124:127]
M v[120:123], a[172:175], a[148:151], v[120:123]
 s_add_u32 m0, s24, 32768
 ds_read_b64_tr_b16 a[64:65], v1 offset:16384
 ds_read_b64_tr_b16 a[66:67], v1 offset:17408
M v[120:123], a[168:171], a[144:147], v[120:123]
 buffer_load_dwordx4 v12, s[48:51], s22 offen offset:0   lds
M v[116:119], a[168:171], a[136:139], v[116:119]
M v[116:119], a[172:175], a[140:143], v[116:119]
M v[112:115], a[172:175], a[132:135], v[112:115]
M v[112:115], a[168:171], a[128:131], v[112:115]
M v[108:111], a[168:171], a[120:123], v[108:111]
M v[108:111], a[172:175], a[124:127], v[108:111]
 ds_read_b64_tr_b16 a[68:69], v1 offset:24576
 ds_read_b64_tr_b16 a[70:71], v1 offset:25600
M v[104:107], a[172:175], a[116:119], v[104:107]
 buffer_load_dwordx4 v13, s[48:51], s22 offen offset:1024   lds
M v[104:107], a[168:171], a[112:115], v[104:107]
M v[100:103], a[168:171], a[104:107], v[100:103]
M v[100:103], a[172:175], a[108:111], v[100:103]
 s_waitcnt lgkmcnt(4)
M v[96:99], a[172:175], a[100:103], v[96:99]
M v[96:99], a[168:171], a[96:99], v[96:99]
 buffer_load_dwordx4 v14, s[48:51], s22 offen offset:2048   lds
M v[128:131], a[160:163], a[96:99], v[128:131]
 ds_read_b128 a[168:171], v5 offset:51200
 ds_read_b128 a[172:175], v6 offset:51200
M v[128:131], a[164:167], a[100:103], v[128:131]
 ds_read_b64_tr_b16 a[72:73], v2 offset:16384
 ds_read_b64_tr_b16 a[74:75], v2 offset:17408
M v[132:135], a[164:167], a[108:111], v[132:135]
M v[132:135], a[160:163], a[104:107], v[132:135]
M v[136:139], a[160:163], a[112:115], v[136:139]
M v[136:139], a[164:167], a[116:119], v[136:139]
M v[140:143], a[164:167], a[124:127], v[140:143]
 buffer_load_dwordx4 v15, s[48:51], s22 offen offset:3072   lds
M v[140:143], a[160:163], a[120:123], v[140:143]
 s_add_u32 s22, s22, 2097152
 ds_read_b64_tr_b16 a[76:77], v2 offset:24576
 ds_read_b64_tr_b16 a[78:79], v2 offset:25600
M v[144:147], a[160:163], a[128:131], v[144:147]
M v[144:147], a[164:167], a[132:135], v[144:147]
M v[148:151], a[164:167], a[140:143], v[148:151]
M v[148:151], a[160:163], a[136:139], v[148:151]
 s_add_u32 m0, s23, 0
M v[152:155], a[160:163], a[144:147], v[152:155]
 buffer_load_dwordx4 v8, s[16:19], s21 offen offset:0  nt lds
M v[152:155], a[164:167], a[148:151], v[152:155]
 s_waitcnt lgkmcnt(4)
M v[156:159], a[164:167], a[156:159], v[156:159]
 ds_read_b64_tr_b16 a[80:81], v3 offset:16384
 ds_read_b64_tr_b16 a[82:83], v3 offset:17408
M v[156:159], a[160:163], a[152:155], v[156:159]
M v[188:191], a[168:171], a[152:155], v[188:191]
 ds_read_b128 a[160:163], v5 offset:53248
 ds_read_b128 a[164:167], v6 offset:53248
M v[188:191], a[172:175], a[156:159], v[188:191]
M v[184:187], a[172:175], a[148:151], v[184:187]
 buffer_load_dwordx4 v9, s[16:19], s21 offen offset:1024  nt lds
M v[184:187], a[168:171], a[144:147], v[184:187]
M v[180:183], a[168:171], a[136:139], v[180:183]
M v[180:183], a[172:175], a[140:143], v[180:183]
 ds_read_b64_tr_b16 a[84:85], v3 offset:24576
 ds_read_b64_tr_b16 a[86:87], v3 offset:25600
M v[176:179], a[172:175], a[132:135], v[176:179]
M v[176:179], a[168:171], a[128:131], v[176:179]
M v[172:175], a[168:171], a[120:123], v[172:175]
M v[172:175], a[172:175], a[124:127], v[172:175]
 buffer_load_dwordx4 v10, s[16:19], s21 offen offset:2048  nt lds
M v[168:171], a[172:175], a[116:119], v[168:171]
M v[168:171], a[168:171], a[112:115], v[168:171]
M v[164:167], a[168:171], a[104:107], v[164:167]
 ds_read_b64_tr_b16 a[88:89], v4 offset:16384
 ds_read_b64_tr_b16 a[90:91], v4 offset:17408
M v[164:167], a[172:175], a[108:111], v[164:167]
 s_waitcnt lgkmcnt(4)
M v[160:163], a[172:175], a[100:103], v[160:163]
M v[160:163], a[168:171], a[96:99], v[160:163]
 buffer_load_dwordx4 v11, s[16:19], s21 offen offset:3072  nt lds
M v[192:195], a[160:163], a[96:99], v[192:195]
 s_add_u32 s21, s21, 128
 ds_read_b128 a[168:171], v5 offset:55296
 ds_read_b128 a[172:175], v6 offset:55296
M v[192:195], a[164:167], a[100:103], v[192:195]
M v[196:199], a[164:167], a[108:111], v[196:199]
M v[196:199], a[160:163], a[104:107], v[196:199]
 ds_read_b64_tr_b16 a[92:93], v4 offset:24576
 ds_read_b64_tr_b16 a[94:95], v4 offset:25600
M v[200:203], a[160:163], a[112:115], v[200:203]
 s_add_u32 m0, s87, 3072
M v[200:203], a[164:167], a[116:119], v[200:203]
 buffer_load_dwordx4 v25, s[60:63], s89 offen offset:0 nt lds
M v[204:207], a[164:167], a[124:127], v[204:207]
 s_add_u32 s89, s89, 114688
M v[204:207], a[160:163], a[120:123], v[204:207]
M v[208:211], a[160:163], a[128:131], v[208:211]
M v[208:211], a[164:167], a[132:135], v[208:211]
M v[212:215], a[164:167], a[140:143], v[212:215]
M v[212:215], a[160:163], a[136:139], v[212:215]
M v[216:219], a[160:163], a[144:147], v[216:219]
M v[216:219], a[164:167], a[148:151], v[216:219]
 s_waitcnt lgkmcnt(2)
M v[220:223], a[164:167], a[156:159], v[220:223]
 s_waitcnt vmcnt(20) lgkmcnt(0)
M v[220:223], a[160:163], a[152:155], v[220:223]
 s_barrier
M v[252:255], a[168:171], a[152:155], v[252:255]
 ds_read_b128 a[160:163], v5 offset:0
 ds_read_b128 a[164:167], v6 offset:0
M v[252:255], a[172:175], a[156:159], v[252:255]
M v[248:251], a[172:175], a[148:151], v[248:251]
M v[248:251], a[168:171], a[144:147], v[248:251]
M v[244:247], a[168:171], a[136:139], v[244:247]
M v[244:247], a[172:175], a[140:143], v[244:247]
M v[240:243], a[172:175], a[132:135], v[240:243]
M v[240:243], a[168:171], a[128:131], v[240:243]
M v[236:239], a[168:171], a[120:123], v[236:239]
M v[236:239], a[172:175], a[124:127], v[236:239]
M v[232:235], a[172:175], a[116:119], v[232:235]
M v[232:235], a[168:171], a[112:115], v[232:235]
M v[228:231], a[168:171], a[104:107], v[228:231]
M v[228:231], a[172:175], a[108:111], v[228:231]
 s_waitcnt lgkmcnt(0)
M v[224:227], a[172:175], a[100:103], v[224:227]
M v[224:227], a[168:171], a[96:99], v[224:227]
M a[0:3], a[160:163], a[32:35], a[0:3]
 ds_read_b128 a[168:171], v5 offset:2048
 ds_read_b128 a[172:175], v6 offset:2048
M a[0:3], a[164:167], a[36:39], a[0:3]
 ds_read_b64_tr_b16 a[96:97], v1 offset:32768
 ds_read_b64_tr_b16 a[98:99], v1 offset:33792
M a[4:7], a[164:167], a[44:47], a[4:7]
 s_add_u32 m0, s24, 49152
M a[4:7], a[160:163], a[40:43], a[4:7]
 buffer_load_dwordx4 v12, s[48:51], s22 offen offset:0   lds
M a[8:11], a[160:163], a[48:51], a[8:11]
M a[8:11], a[164:167], a[52:55], a[8:11]
M a[12:15], a[164:167], a[60:63], a[12:15]
 ds_read_b64_tr_b16 a[100:101], v1 offset:40960
 ds_read_b64_tr_b16 a[102:103], v1 offset:41984
M a[12:15], a[160:163], a[56:59], a[12:15]
M a[16:19], a[160:163], a[64:67], a[16:19]
 buffer_load_dwordx4 v13, s[48:51], s22 offen offset:1024   lds
M a[16:19], a[164:167], a[68:71], a[16:19]
M a[20:23], a[164:167], a[76:79], a[20:23]
M a[20:23], a[160:163], a[72:75], a[20:23]
 ds_read_b64_tr_b16 a[104:105], v2 offset:32768
 ds_read_b64_tr_b16 a[106:107], v2 offset:33792
M a[24:27], a[160:163], a[80:83], a[24:27]
M a[24:27], a[164:167], a[84:87], a[24:27]
 s_waitcnt lgkmcnt(6)
M a[28:31], a[164:167], a[92:95], a[28:31]
 buffer_load_dwordx4 v14, s[48:51], s22 offen offset:2048   lds
M a[28:31], a[160:163], a[88:91], a[28:31]
M v[60:63], a[168:171], a[88:91], v[60:63]
 ds_read_b128 a[160:163], v5 offset:4096
 ds_read_b128 a[164:167], v6 offset:4096
M v[60:63], a[172:175], a[92:95], v[60:63]
 ds_read_b64_tr_b16 a[108:109], v2 offset:40960
 ds_read_b64_tr_b16 a[110:111], v2 offset:41984
M v[56:59], a[172:175], a[84:87], v[56:59]
 buffer_load_dwordx4 v15, s[48:51], s22 offen offset:3072   lds
M v[56:59], a[168:171], a[80:83], v[56:59]
 s_sub_u32 s22, s22, 2097024
M v[52:55], a[168:171], a[72:75], v[52:55]
M v[52:55], a[172:175], a[76:79], v[52:55]
 ds_read_b64_tr_b16 a[112:113], v3 offset:32768
 ds_read_b64_tr_b16 a[114:115], v3 offset:33792
M v[48:51], a[172:175], a[68:71], v[48:51]
 s_add_u32 m0, s23, 16384
M v[48:51], a[168:171], a[64:67], v[48:51]
 buffer_load_dwordx4 v8, s[16:19], s21 offen offset:0  nt lds
M v[44:47], a[168:171], a[56:59], v[44:47]
M v[44:47], a[172:175], a[60:63], v[44:47]
M v[40:43], a[172:175], a[52:55], v[40:43]
 ds_read_b64_tr_b16 a[116:117], v3 offset:40960
 ds_read_b64_tr_b16 a[118:119], v3 offset:41984
M v[40:43], a[168:171], a[48:51], v[40:43]
M v[36:39], a[168:171], a[40:43], v[36:39]
 buffer_load_dwordx4 v9, s[16:19], s21 offen offset:1024  nt lds
M v[36:39], a[172:175], a[44:47], v[36:39]
 s_waitcnt lgkmcnt(6)
M v[32:35], a[172:175], a[36:39], v[32:35]
M v[32:35], a[168:171], a[32:35], v[32:35]
 ds_read_b64_tr_b16 a[120:121], v4 offset:32768
 ds_read_b64_tr_b16 a[122:123], v4 offset:33792
M v[64:67], a[160:163], a[32:35], v[64:67]
 ds_read_b128 a[168:171], v5 offset:6144
 ds_read_b128 a[172:175], v6 offset:6144
M v[64:67], a[164:167], a[36:39], v[64:67]
 buffer_load_dwordx4 v10, s[16:19], s21 offen offset:2048  nt lds
M v[68:71], a[164:167], a[44:47], v[68:71]
M v[68:71], a[160:163], a[40:43], v[68:71]
M v[72:75], a[160:163], a[48:51], v[72:75]
 ds_read_b64_tr_b16 a[124:125], v4 offset:40960
 ds_read_b64_tr_b16 a[126:127], v4 offset:41984
M v[72:75], a[164:167], a[52:55], v[72:75]
M v[76:79], a[164:167], a[60:63], v[76:79]
 buffer_load_dwordx4 v11, s[16:19], s21 offen offset:3072  nt lds
M v[76:79], a[160:163], a[56:59], v[76:79]
 s_add_u32 s21, s21, 524160
M v[80:83], a[160:163], a[64:67], v[80:83]
M v[80:83], a[164:167], a[68:71], v[80:83]
M v[84:87], a[164:167], a[76:79], v[84:87]
M v[84:87], a[160:163], a[72:75], v[84:87]
M v[88:91], a[160:163], a[80:83], v[88:91]
M v[88:91], a[164:167], a[84:87], v[88:91]
 s_waitcnt lgkmcnt(2)
M v[92:95], a[164:167], a[92:95], v[92:95]
 s_waitcnt vmcnt(17) lgkmcnt(0)
M v[92:95], a[160:163], a[88:91], v[92:95]
 s_barrier
M v[124:127], a[168:171], a[88:91], v[124:127]
 ds_read_b128 a[160:163], v5 offset:16384
 ds_read_b128 a[164:167], v6 offset:16384
M v[124:127], a[172:175], a[92:95], v[124:127]
M v[120:123], a[172:175], a[84:87], v[120:123]
 s_add_u32 m0, s24, 0
 ds_read_b64_tr_b16 a[128:129], v1 offset:49152
 ds_read_b64_tr_b16 a[130:131], v1 offset:50176
M v[120:123], a[168:171], a[80:83], v[120:123]
 buffer_load_dwordx4 v12, s[48:51], s22 offen offset:0   lds
M v[116:119], a[168:171], a[72:75], v[116:119]
M v[116:119], a[172:175], a[76:79], v[116:119]
M v[112:115], a[172:175], a[68:71], v[112:115]
M v[112:115], a[168:171], a[64:67], v[112:115]
M v[108:111], a[168:171], a[56:59], v[108:111]
M v[108:111], a[172:175], a[60:63], v[108:111]
 ds_read_b64_tr_b16 a[132:133], v1 offset:57344
 ds_read_b64_tr_b16 a[134:135], v1 offset:58368
M v[104:107], a[172:175], a[52:55], v[104:107]
 buffer_load_dwordx4 v13, s[48:51], s22 offen offset:1024   lds
M v[104:107], a[168:171], a[48:51], v[104:107]
M v[100:103], a[168:171], a[40:43], v[100:103]
M v[100:103], a[172:175], a[44:47], v[100:103]
 s_waitcnt lgkmcnt(4)
M v[96:99], a[172:175], a[36:39], v[96:99]
M v[96:99], a[168:171], a[32:35], v[96:99]
 buffer_load_dwordx4 v14, s[48:51], s22 offen offset:2048   lds
M v[128:131], a[160:163], a[32:35], v[128:131]
 ds_read_b128 a[168:171], v5 offset:18432
 ds_read_b128 a[172:175], v6 offset:18432
M v[128:131], a[164:167], a[36:39], v[128:131]
 ds_read_b64_tr_b16 a[136:137], v2 offset:49152
 ds_read_b64_tr_b16 a[138:139], v2 offset:50176
M v[132:135], a[164:167], a[44:47], v[132:135]
M v[132:135], a[160:163], a[40:43], v[132:135]
M v[136:139], a[160:163], a[48:51], v[136:139]
M v[136:139], a[164:167], a[52:55], v[136:139]
M v[140:143], a[164:167], a[60:63], v[140:143]
 buffer_load_dwordx4 v15, s[48:51], s22 offen offset:3072   lds
M v[140:143], a[160:163], a[56:59], v[140:143]
 s_add_u32 s22, s22, 2097152
 ds_read_b64_tr_b16 a[140:141], v2 offset:57344
 ds_read_b64_tr_b16 a[142:143], v2 offset:58368
M v[144:147], a[160:163], a[64:67], v[144:147]
M v[144:147], a[164:167], a[68:71], v[144:147]
M v[148:151], a[164:167], a[76:79], v[148:151]
M v[148:151], a[160:163], a[72:75], v[148:151]
 s_add_u32 m0, s23, 32768
M v[152:155], a[160:163], a[80:83], v[152:155]
 buffer_load_dwordx4 v8, s[16:19], s21 offen offset:0  nt lds
M v[152:155], a[164:167], a[84:87], v[152:155]
 s_waitcnt lgkmcnt(4)
M v[156:159], a[164:167], a[92:95], v[156:159]
 ds_read_b64_tr_b16 a[144:145], v3 offset:49152
 ds_read_b64_tr_b16 a[146:147], v3 offset:50176
M v[156:159], a[160:163], a[88:91], v[156:159]
M v[188:191], a[168:171], a[88:91], v[188:191]
 ds_read_b128 a[160:163], v5 offset:20480
 ds_read_b128 a[164:167], v6 offset:20480
M v[188:191], a[172:175], a[92:95], v[188:191]
M v[184:187], a[172:175], a[84:87], v[184:187]
 buffer_load_dwordx4 v9, s[16:19], s21 offen offset:1024  nt lds
M v[184:187], a[168:171], a[80:83], v[184:187]
M v[180:183], a[168:171], a[72:75], v[180:183]
M v[180:183], a[172:175], a[76:79], v[180:183]
 ds_read_b64_tr_b16 a[148:149], v3 offset:57344
 ds_read_b64_tr_b16 a[150:151], v3 offset:58368
M v[176:179], a[172:175], a[68:71], v[176:179]
M v[176:179], a[168:171], a[64:67], v[176:179]
M v[172:175], a[168:171], a[56:59], v[172:175]
M v[172:175], a[172:175], a[60:63], v[172:175]
 buffer_load_dwordx4 v10, s[16:19], s21 offen offset:2048  nt lds
M v[168:171], a[172:175], a[52:55], v[168:171]
M v[168:171], a[168:171], a[48:51], v[168:171]
M v[164:167], a[168:171], a[40:43], v[164:167]
 ds_read_b64_tr_b16 a[152:153], v4 offset:49152
 ds_read_b64_tr_b16 a[154:155], v4 offset:50176
M v[164:167], a[172:175], a[44:47], v[164:167]
 s_waitcnt lgkmcnt(4)
M v[160:163], a[172:175], a[36:39], v[160:163]
M v[160:163], a[168:171], a[32:35], v[160:163]
 buffer_load_dwordx4 v11, s[16:19], s21 offen offset:3072  nt lds
M v[192:195], a[160:163], a[32:35], v[192:195]
 s_add_u32 s21, s21, 128
 ds_read_b128 a[168:171], v5 offset:22528
 ds_read_b128 a[172:175], v6 offset:22528
M v[192:195], a[164:167], a[36:39], v[192:195]
M v[196:199], a[164:167], a[44:47], v[196:199]
M v[196:199], a[160:163], a[40:43], v[196:199]
 ds_read_b64_tr_b16 a[156:157], v4 offset:57344
 ds_read_b64_tr_b16 a[158:159], v4 offset:58368
M v[200:203], a[160:163], a[48:51], v[200:203]
 s_add_u32 m0, s87, 4096
M v[200:203], a[164:167], a[52:55], v[200:203]
 buffer_load_dwordx4 v25, s[60:63], s89 offen offset:0 nt lds
M v[204:207], a[164:167], a[60:63], v[204:207]
 s_add_u32 s89, s89, 114688
M v[204:207], a[160:163], a[56:59], v[204:207]
M v[208:211], a[160:163], a[64:67], v[208:211]
M v[208:211], a[164:167], a[68:71], v[208:211]
M v[212:215], a[164:167], a[76:79], v[212:215]
M v[212:215], a[160:163], a[72:75], v[212:215]
M v[216:219], a[160:163], a[80:83], v[216:219]
M v[216:219], a[164:167], a[84:87], v[216:219]
 s_waitcnt lgkmcnt(2)
M v[220:223], a[164:167], a[92:95], v[220:223]
 s_waitcnt vmcnt(18) lgkmcnt(0)
M v[220:223], a[160:163], a[88:91], v[220:223]
 s_barrier
M v[252:255], a[168:171], a[88:91], v[252:255]
 ds_read_b128 a[160:163], v5 offset:32768
 ds_read_b128 a[164:167], v6 offset:32768
M v[252:255], a[172:175], a[92:95], v[252:255]
 v_and_b32 v26, 48, v0
 v_lshlrev_b32 v26, 17, v26
M v[248:251], a[172:175], a[84:87], v[248:251]
 v_or_b32 v26, v26, v0
 v_lshl_add_u32 v26, v26, 7, s95
M v[248:251], a[168:171], a[80:83], v[248:251]
 buffer_load_dword a240, v26, s[76:79], 0 offen offset:0
M v[244:247], a[168:171], a[72:75], v[244:247]
M v[244:247], a[172:175], a[76:79], v[244:247]
M v[240:243], a[172:175], a[68:71], v[240:243]
M v[240:243], a[168:171], a[64:67], v[240:243]
M v[236:239], a[168:171], a[56:59], v[236:239]
M v[236:239], a[172:175], a[60:63], v[236:239]
M v[232:235], a[172:175], a[52:55], v[232:235]
M v[232:235], a[168:171], a[48:51], v[232:235]
M v[228:231], a[168:171], a[40:43], v[228:231]
M v[228:231], a[172:175], a[44:47], v[228:231]
 s_waitcnt lgkmcnt(0)
M v[224:227], a[172:175], a[36:39], v[224:227]
M v[224:227], a[168:171], a[32:35], v[224:227]
M a[0:3], a[160:163], a[96:99], a[0:3]
 ds_read_b128 a[168:171], v5 offset:34816
 ds_read_b128 a[172:175], v6 offset:34816
M a[0:3], a[164:167], a[100:103], a[0:3]
 ds_read_b64_tr_b16 a[32:33], v1 offset:0
 ds_read_b64_tr_b16 a[34:35], v1 offset:1024
M a[4:7], a[164:167], a[108:111], a[4:7]
 s_add_u32 m0, s24, 16384
M a[4:7], a[160:163], a[104:107], a[4:7]
 buffer_load_dwordx4 v12, s[48:51], s22 offen offset:0   lds
M a[8:11], a[160:163], a[112:115], a[8:11]
M a[8:11], a[164:167], a[116:119], a[8:11]
 s_lshl_b32 s67, s20, 11
M a[12:15], a[164:167], a[124:127], a[12:15]
 s_add_u32 s67, s67, 104914944
 ds_read_b64_tr_b16 a[36:37], v1 offset:8192
 ds_read_b64_tr_b16 a[38:39], v1 offset:9216
M a[12:15], a[160:163], a[120:123], a[12:15]
M a[16:19], a[160:163], a[128:131], a[16:19]
 buffer_load_dwordx4 v13, s[48:51], s22 offen offset:1024   lds
M a[16:19], a[164:167], a[132:135], a[16:19]
M a[20:23], a[164:167], a[140:143], a[20:23]
 buffer_load_dwordx4 v[16:19], v7, s[8:11], s67 offen offset:0 sc1
M a[20:23], a[160:163], a[136:139], a[20:23]
 ds_read_b64_tr_b16 a[40:41], v2 offset:0
 ds_read_b64_tr_b16 a[42:43], v2 offset:1024
M a[24:27], a[160:163], a[144:147], a[24:27]
 buffer_load_dwordx4 v[20:23], v7, s[8:11], s67 offen offset:1024 sc1
M a[24:27], a[164:167], a[148:151], a[24:27]
 s_waitcnt lgkmcnt(6)
M a[28:31], a[164:167], a[156:159], a[28:31]
 buffer_load_dwordx4 v14, s[48:51], s22 offen offset:2048   lds
M a[28:31], a[160:163], a[152:155], a[28:31]
M v[60:63], a[168:171], a[152:155], v[60:63]
 ds_read_b128 a[160:163], v5 offset:36864
 ds_read_b128 a[164:167], v6 offset:36864
M v[60:63], a[172:175], a[156:159], v[60:63]
 ds_read_b64_tr_b16 a[44:45], v2 offset:8192
 ds_read_b64_tr_b16 a[46:47], v2 offset:9216
M v[56:59], a[172:175], a[148:151], v[56:59]
 buffer_load_dwordx4 v15, s[48:51], s22 offen offset:3072   lds
M v[56:59], a[168:171], a[144:147], v[56:59]
 s_sub_u32 s22, s22, 2097024
M v[52:55], a[168:171], a[136:139], v[52:55]
M v[52:55], a[172:175], a[140:143], v[52:55]
 ds_read_b64_tr_b16 a[48:49], v3 offset:0
 ds_read_b64_tr_b16 a[50:51], v3 offset:1024
M v[48:51], a[172:175], a[132:135], v[48:51]
 s_add_u32 m0, s23, 49152
M v[48:51], a[168:171], a[128:131], v[48:51]
 buffer_load_dwordx4 v8, s[16:19], s21 offen offset:0  nt lds
M v[44:47], a[168:171], a[120:123], v[44:47]
M v[44:47], a[172:175], a[124:127], v[44:47]
M v[40:43], a[172:175], a[116:119], v[40:43]
 ds_read_b64_tr_b16 a[52:53], v3 offset:8192
 ds_read_b64_tr_b16 a[54:55], v3 offset:9216
M v[40:43], a[168:171], a[112:115], v[40:43]
M v[36:39], a[168:171], a[104:107], v[36:39]
 buffer_load_dwordx4 v9, s[16:19], s21 offen offset:1024  nt lds
M v[36:39], a[172:175], a[108:111], v[36:39]
 s_waitcnt lgkmcnt(6)
M v[32:35], a[172:175], a[100:103], v[32:35]
M v[32:35], a[168:171], a[96:99], v[32:35]
 ds_read_b64_tr_b16 a[56:57], v4 offset:0
 ds_read_b64_tr_b16 a[58:59], v4 offset:1024
M v[64:67], a[160:163], a[96:99], v[64:67]
 ds_read_b128 a[168:171], v5 offset:38912
 ds_read_b128 a[172:175], v6 offset:38912
M v[64:67], a[164:167], a[100:103], v[64:67]
 buffer_load_dwordx4 v10, s[16:19], s21 offen offset:2048  nt lds
M v[68:71], a[164:167], a[108:111], v[68:71]
M v[68:71], a[160:163], a[104:107], v[68:71]
M v[72:75], a[160:163], a[112:115], v[72:75]
 ds_read_b64_tr_b16 a[60:61], v4 offset:8192
 ds_read_b64_tr_b16 a[62:63], v4 offset:9216
M v[72:75], a[164:167], a[116:119], v[72:75]
M v[76:79], a[164:167], a[124:127], v[76:79]
 buffer_load_dwordx4 v11, s[16:19], s21 offen offset:3072  nt lds
M v[76:79], a[160:163], a[120:123], v[76:79]
 s_add_u32 s21, s21, 524160
M v[80:83], a[160:163], a[128:131], v[80:83]
M v[80:83], a[164:167], a[132:135], v[80:83]
M v[84:87], a[164:167], a[140:143], v[84:87]
M v[84:87], a[160:163], a[136:139], v[84:87]
M v[88:91], a[160:163], a[144:147], v[88:91]
M v[88:91], a[164:167], a[148:151], v[88:91]
 s_waitcnt lgkmcnt(2)
M v[92:95], a[164:167], a[156:159], v[92:95]
 s_waitcnt vmcnt(20) lgkmcnt(0)
M v[92:95], a[160:163], a[152:155], v[92:95]
 s_barrier
M v[124:127], a[168:171], a[152:155], v[124:127]
 ds_read_b128 a[160:163], v5 offset:49152
 ds_read_b128 a[164:167], v6 offset:49152
M v[124:127], a[172:175], a[156:159], v[124:127]
M v[120:123], a[172:175], a[148:151], v[120:123]
 s_add_u32 m0, s24, 32768
 ds_read_b64_tr_b16 a[64:65], v1 offset:16384
 ds_read_b64_tr_b16 a[66:67], v1 offset:17408
M v[120:123], a[168:171], a[144:147], v[120:123]
 buffer_load_dwordx4 v12, s[48:51], s22 offen offset:0   lds
M v[116:119], a[168:171], a[136:139], v[116:119]
M v[116:119], a[172:175], a[140:143], v[116:119]
M v[112:115], a[172:175], a[132:135], v[112:115]
M v[112:115], a[168:171], a[128:131], v[112:115]
M v[108:111], a[168:171], a[120:123], v[108:111]
M v[108:111], a[172:175], a[124:127], v[108:111]
 ds_read_b64_tr_b16 a[68:69], v1 offset:24576
 ds_read_b64_tr_b16 a[70:71], v1 offset:25600
M v[104:107], a[172:175], a[116:119], v[104:107]
 buffer_load_dwordx4 v13, s[48:51], s22 offen offset:1024   lds
M v[104:107], a[168:171], a[112:115], v[104:107]
M v[100:103], a[168:171], a[104:107], v[100:103]
M v[100:103], a[172:175], a[108:111], v[100:103]
 s_waitcnt lgkmcnt(4)
M v[96:99], a[172:175], a[100:103], v[96:99]
M v[96:99], a[168:171], a[96:99], v[96:99]
 buffer_load_dwordx4 v14, s[48:51], s22 offen offset:2048   lds
M v[128:131], a[160:163], a[96:99], v[128:131]
 ds_read_b128 a[168:171], v5 offset:51200
 ds_read_b128 a[172:175], v6 offset:51200
M v[128:131], a[164:167], a[100:103], v[128:131]
 ds_read_b64_tr_b16 a[72:73], v2 offset:16384
 ds_read_b64_tr_b16 a[74:75], v2 offset:17408
M v[132:135], a[164:167], a[108:111], v[132:135]
M v[132:135], a[160:163], a[104:107], v[132:135]
M v[136:139], a[160:163], a[112:115], v[136:139]
M v[136:139], a[164:167], a[116:119], v[136:139]
M v[140:143], a[164:167], a[124:127], v[140:143]
 buffer_load_dwordx4 v15, s[48:51], s22 offen offset:3072   lds
M v[140:143], a[160:163], a[120:123], v[140:143]
 s_add_u32 s22, s22, 2097152
 ds_read_b64_tr_b16 a[76:77], v2 offset:24576
 ds_read_b64_tr_b16 a[78:79], v2 offset:25600
M v[144:147], a[160:163], a[128:131], v[144:147]
M v[144:147], a[164:167], a[132:135], v[144:147]
M v[148:151], a[164:167], a[140:143], v[148:151]
M v[148:151], a[160:163], a[136:139], v[148:151]
 s_add_u32 m0, s23, 0
M v[152:155], a[160:163], a[144:147], v[152:155]
 buffer_load_dwordx4 v8, s[16:19], s21 offen offset:0  nt lds
M v[152:155], a[164:167], a[148:151], v[152:155]
 s_waitcnt lgkmcnt(4)
M v[156:159], a[164:167], a[156:159], v[156:159]
 ds_read_b64_tr_b16 a[80:81], v3 offset:16384
 ds_read_b64_tr_b16 a[82:83], v3 offset:17408
M v[156:159], a[160:163], a[152:155], v[156:159]
M v[188:191], a[168:171], a[152:155], v[188:191]
 ds_read_b128 a[160:163], v5 offset:53248
 ds_read_b128 a[164:167], v6 offset:53248
M v[188:191], a[172:175], a[156:159], v[188:191]
M v[184:187], a[172:175], a[148:151], v[184:187]
 buffer_load_dwordx4 v9, s[16:19], s21 offen offset:1024  nt lds
M v[184:187], a[168:171], a[144:147], v[184:187]
M v[180:183], a[168:171], a[136:139], v[180:183]
M v[180:183], a[172:175], a[140:143], v[180:183]
 ds_read_b64_tr_b16 a[84:85], v3 offset:24576
 ds_read_b64_tr_b16 a[86:87], v3 offset:25600
M v[176:179], a[172:175], a[132:135], v[176:179]
M v[176:179], a[168:171], a[128:131], v[176:179]
M v[172:175], a[168:171], a[120:123], v[172:175]
M v[172:175], a[172:175], a[124:127], v[172:175]
 buffer_load_dwordx4 v10, s[16:19], s21 offen offset:2048  nt lds
M v[168:171], a[172:175], a[116:119], v[168:171]
M v[168:171], a[168:171], a[112:115], v[168:171]
M v[164:167], a[168:171], a[104:107], v[164:167]
 ds_read_b64_tr_b16 a[88:89], v4 offset:16384
 ds_read_b64_tr_b16 a[90:91], v4 offset:17408
M v[164:167], a[172:175], a[108:111], v[164:167]
 s_waitcnt lgkmcnt(4)
M v[160:163], a[172:175], a[100:103], v[160:163]
M v[160:163], a[168:171], a[96:99], v[160:163]
 buffer_load_dwordx4 v11, s[16:19], s21 offen offset:3072  nt lds
M v[192:195], a[160:163], a[96:99], v[192:195]
 s_add_u32 s21, s21, 128
 ds_read_b128 a[168:171], v5 offset:55296
 ds_read_b128 a[172:175], v6 offset:55296
M v[192:195], a[164:167], a[100:103], v[192:195]
M v[196:199], a[164:167], a[108:111], v[196:199]
M v[196:199], a[160:163], a[104:107], v[196:199]
 ds_read_b64_tr_b16 a[92:93], v4 offset:24576
 ds_read_b64_tr_b16 a[94:95], v4 offset:25600
M v[200:203], a[160:163], a[112:115], v[200:203]
 s_add_u32 m0, s87, 5120
M v[200:203], a[164:167], a[116:119], v[200:203]
 buffer_load_dwordx4 v25, s[60:63], s89 offen offset:0 nt lds
M v[204:207], a[164:167], a[124:127], v[204:207]
 s_add_u32 s89, s89, 114688
M v[204:207], a[160:163], a[120:123], v[204:207]
M v[208:211], a[160:163], a[128:131], v[208:211]
M v[208:211], a[164:167], a[132:135], v[208:211]
M v[212:215], a[164:167], a[140:143], v[212:215]
M v[212:215], a[160:163], a[136:139], v[212:215]
M v[216:219], a[160:163], a[144:147], v[216:219]
M v[216:219], a[164:167], a[148:151], v[216:219]
 s_waitcnt lgkmcnt(2)
M v[220:223], a[164:167], a[156:159], v[220:223]
 s_waitcnt vmcnt(21) lgkmcnt(0)
M v[220:223], a[160:163], a[152:155], v[220:223]
 s_barrier
M v[252:255], a[168:171], a[152:155], v[252:255]
 ds_read_b128 a[160:163], v5 offset:0
 ds_read_b128 a[164:167], v6 offset:0
M v[252:255], a[172:175], a[156:159], v[252:255]
M v[248:251], a[172:175], a[148:151], v[248:251]
M v[248:251], a[168:171], a[144:147], v[248:251]
M v[244:247], a[168:171], a[136:139], v[244:247]
M v[244:247], a[172:175], a[140:143], v[244:247]
M v[240:243], a[172:175], a[132:135], v[240:243]
M v[240:243], a[168:171], a[128:131], v[240:243]
M v[236:239], a[168:171], a[120:123], v[236:239]
M v[236:239], a[172:175], a[124:127], v[236:239]
M v[232:235], a[172:175], a[116:119], v[232:235]
M v[232:235], a[168:171], a[112:115], v[232:235]
M v[228:231], a[168:171], a[104:107], v[228:231]
M v[228:231], a[172:175], a[108:111], v[228:231]
 s_waitcnt lgkmcnt(0)
M v[224:227], a[172:175], a[100:103], v[224:227]
M v[224:227], a[168:171], a[96:99], v[224:227]
M a[0:3], a[160:163], a[32:35], a[0:3]
 ds_read_b128 a[168:171], v5 offset:2048
 ds_read_b128 a[172:175], v6 offset:2048
M a[0:3], a[164:167], a[36:39], a[0:3]
 ds_read_b64_tr_b16 a[96:97], v1 offset:32768
 ds_read_b64_tr_b16 a[98:99], v1 offset:33792
M a[4:7], a[164:167], a[44:47], a[4:7]
 s_add_u32 m0, s24, 49152
M a[4:7], a[160:163], a[40:43], a[4:7]
 buffer_load_dwordx4 v12, s[48:51], s22 offen offset:0   lds
M a[8:11], a[160:163], a[48:51], a[8:11]
M a[8:11], a[164:167], a[52:55], a[8:11]
M a[12:15], a[164:167], a[60:63], a[12:15]
 ds_read_b64_tr_b16 a[100:101], v1 offset:40960
 ds_read_b64_tr_b16 a[102:103], v1 offset:41984
M a[12:15], a[160:163], a[56:59], a[12:15]
M a[16:19], a[160:163], a[64:67], a[16:19]
 buffer_load_dwordx4 v13, s[48:51], s22 offen offset:1024   lds
M a[16:19], a[164:167], a[68:71], a[16:19]
M a[20:23], a[164:167], a[76:79], a[20:23]
 s_waitcnt vmcnt(18)
 v_min3_u32 v28, v16, v17, v18
M a[20:23], a[160:163], a[72:75], a[20:23]
 ds_read_b64_tr_b16 a[104:105], v2 offset:32768
 ds_read_b64_tr_b16 a[106:107], v2 offset:33792
M a[24:27], a[160:163], a[80:83], a[24:27]
 s_waitcnt vmcnt(17)
 v_min3_u32 v28, v28, v19, v20
M a[24:27], a[164:167], a[84:87], a[24:27]
 s_waitcnt lgkmcnt(6)
 v_min3_u32 v28, v28, v21, v22
M a[28:31], a[164:167], a[92:95], a[28:31]
 buffer_load_dwordx4 v14, s[48:51], s22 offen offset:2048   lds
M a[28:31], a[160:163], a[88:91], a[28:31]
 v_min_u32 v28, v28, v23
M v[60:63], a[168:171], a[88:91], v[60:63]
 ds_read_b128 a[160:163], v5 offset:4096
 ds_read_b128 a[164:167], v6 offset:4096
M v[60:63], a[172:175], a[92:95], v[60:63]
 ds_read_b64_tr_b16 a[108:109], v2 offset:40960
 ds_read_b64_tr_b16 a[110:111], v2 offset:41984
M v[56:59], a[172:175], a[84:87], v[56:59]
 buffer_load_dwordx4 v15, s[48:51], s22 offen offset:3072   lds
M v[56:59], a[168:171], a[80:83], v[56:59]
 s_sub_u32 s22, s22, 2097024
 v_cmp_eq_u32 vcc, 0, v28
M v[52:55], a[168:171], a[72:75], v[52:55]
 s_nop 0
M v[52:55], a[172:175], a[76:79], v[52:55]
 s_cbranch_vccnz L_hs
L_hr:
 ds_read_b64_tr_b16 a[112:113], v3 offset:32768
 ds_read_b64_tr_b16 a[114:115], v3 offset:33792
M v[48:51], a[172:175], a[68:71], v[48:51]
 s_add_u32 m0, s23, 16384
 v_max_u32 v28, v16, v17
M v[48:51], a[168:171], a[64:67], v[48:51]
 buffer_load_dwordx4 v8, s[16:19], s21 offen offset:0  nt lds
M v[44:47], a[168:171], a[56:59], v[44:47]
 v_min_u32 v29, v16, v17
M v[44:47], a[172:175], a[60:63], v[44:47]
 v_med3_u32 v29, v28, v29, v18
M v[40:43], a[172:175], a[52:55], v[40:43]
 ds_read_b64_tr_b16 a[116:117], v3 offset:40960
 ds_read_b64_tr_b16 a[118:119], v3 offset:41984
M v[40:43], a[168:171], a[48:51], v[40:43]
 v_max_u32 v28, v28, v18
M v[36:39], a[168:171], a[40:43], v[36:39]
 buffer_load_dwordx4 v9, s[16:19], s21 offen offset:1024  nt lds
M v[36:39], a[172:175], a[44:47], v[36:39]
 s_waitcnt lgkmcnt(6)
 v_med3_u32 v29, v28, v29, v19
M v[32:35], a[172:175], a[36:39], v[32:35]
 v_max_u32 v28, v28, v19
M v[32:35], a[168:171], a[32:35], v[32:35]
 ds_read_b64_tr_b16 a[120:121], v4 offset:32768
 ds_read_b64_tr_b16 a[122:123], v4 offset:33792
M v[64:67], a[160:163], a[32:35], v[64:67]
 ds_read_b128 a[168:171], v5 offset:6144
 ds_read_b128 a[172:175], v6 offset:6144
M v[64:67], a[164:167], a[36:39], v[64:67]
 buffer_load_dwordx4 v10, s[16:19], s21 offen offset:2048  nt lds
M v[68:71], a[164:167], a[44:47], v[68:71]
 v_med3_u32 v29, v28, v29, v20
M v[68:71], a[160:163], a[40:43], v[68:71]
 v_max_u32 v28, v28, v20
M v[72:75], a[160:163], a[48:51], v[72:75]
 ds_read_b64_tr_b16 a[124:125], v4 offset:40960
 ds_read_b64_tr_b16 a[126:127], v4 offset:41984
M v[72:75], a[164:167], a[52:55], v[72:75]
 v_med3_u32 v29, v28, v29, v21
M v[76:79], a[164:167], a[60:63], v[76:79]
 buffer_load_dwordx4 v11, s[16:19], s21 offen offset:3072  nt lds
M v[76:79], a[160:163], a[56:59], v[76:79]
 s_add_u32 s21, s21, 524160
 v_max_u32 v28, v28, v21
M v[80:83], a[160:163], a[64:67], v[80:83]
 v_med3_u32 v29, v28, v29, v22
M v[80:83], a[164:167], a[68:71], v[80:83]
 v_max_u32 v28, v28, v22
M v[84:87], a[164:167], a[76:79], v[84:87]
 v_med3_u32 v29, v28, v29, v23
M v[84:87], a[160:163], a[72:75], v[84:87]
 v_max_u32 v28, v28, v23
M v[88:91], a[160:163], a[80:83], v[88:91]
 s_nop 0
 v_mov_b32 v30, v28 row_ror:8 row_mask:0xf bank_mask:0xf
M v[88:91], a[164:167], a[84:87], v[88:91]
 s_waitcnt lgkmcnt(2)
 v_mov_b32 v31, v29 row_ror:8 row_mask:0xf bank_mask:0xf
M v[92:95], a[164:167], a[92:95], v[92:95]
 s_waitcnt vmcnt(17) lgkmcnt(0)
 v_min_u32 v16, v28, v30
M v[92:95], a[160:163], a[88:91], v[92:95]
 s_barrier
M v[124:127], a[168:171], a[88:91], v[124:127]
 ds_read_b128 a[160:163], v5 offset:16384
 ds_read_b128 a[164:167], v6 offset:16384
M v[124:127], a[172:175], a[92:95], v[124:127]
 v_max_u32 v28, v28, v30
M v[120:123], a[172:175], a[84:87], v[120:123]
 s_add_u32 m0, s24, 0
 ds_read_b64_tr_b16 a[128:129], v1 offset:49152
 ds_read_b64_tr_b16 a[130:131], v1 offset:50176
M v[120:123], a[168:171], a[80:83], v[120:123]
 buffer_load_dwordx4 v12, s[48:51], s22 offen offset:0   lds
M v[116:119], a[168:171], a[72:75], v[116:119]
 v_max3_u32 v29, v29, v31, v16
M v[116:119], a[172:175], a[76:79], v[116:119]
 v_mov_b32 v30, v28 row_ror:4 row_mask:0xf bank_mask:0xf
M v[112:115], a[172:175], a[68:71], v[112:115]
 v_mov_b32 v31, v29 row_ror:4 row_mask:0xf bank_mask:0xf
M v[112:115], a[168:171], a[64:67], v[112:115]
 v_min_u32 v16, v28, v30
M v[108:111], a[168:171], a[56:59], v[108:111]
 v_max_u32 v28, v28, v30
M v[108:111], a[172:175], a[60:63], v[108:111]
 ds_read_b64_tr_b16 a[132:133], v1 offset:57344
 ds_read_b64_tr_b16 a[134:135], v1 offset:58368
M v[104:107], a[172:175], a[52:55], v[104:107]
 buffer_load_dwordx4 v13, s[48:51], s22 offen offset:1024   lds
M v[104:107], a[168:171], a[48:51], v[104:107]
 v_max3_u32 v29, v29, v31, v16
M v[100:103], a[168:171], a[40:43], v[100:103]
 v_mov_b32 v30, v28 row_ror:2 row_mask:0xf bank_mask:0xf
M v[100:103], a[172:175], a[44:47], v[100:103]
 s_waitcnt lgkmcnt(4)
 v_mov_b32 v31, v29 row_ror:2 row_mask:0xf bank_mask:0xf
M v[96:99], a[172:175], a[36:39], v[96:99]
 v_min_u32 v16, v28, v30
M v[96:99], a[168:171], a[32:35], v[96:99]
 buffer_load_dwordx4 v14, s[48:51], s22 offen offset:2048   lds
M v[128:131], a[160:163], a[32:35], v[128:131]
 ds_read_b128 a[168:171], v5 offset:18432
 ds_read_b128 a[172:175], v6 offset:18432
M v[128:131], a[164:167], a[36:39], v[128:131]
 ds_read_b64_tr_b16 a[136:137], v2 offset:49152
 ds_read_b64_tr_b16 a[138:139], v2 offset:50176
M v[132:135], a[164:167], a[44:47], v[132:135]
 v_max_u32 v28, v28, v30
M v[132:135], a[160:163], a[40:43], v[132:135]
 v_max3_u32 v29, v29, v31, v16
M v[136:139], a[160:163], a[48:51], v[136:139]
 v_mov_b32 v30, v28 row_ror:1 row_mask:0xf bank_mask:0xf
M v[136:139], a[164:167], a[52:55], v[136:139]
 v_mov_b32 v31, v29 row_ror:1 row_mask:0xf bank_mask:0xf
M v[140:143], a[164:167], a[60:63], v[140:143]
 buffer_load_dwordx4 v15, s[48:51], s22 offen offset:3072   lds
M v[140:143], a[160:163], a[56:59], v[140:143]
 s_add_u32 s22, s22, 2097152
 ds_read_b64_tr_b16 a[140:141], v2 offset:57344
 ds_read_b64_tr_b16 a[142:143], v2 offset:58368
M v[144:147], a[160:163], a[64:67], v[144:147]
 v_min_u32 v16, v28, v30
M v[144:147], a[164:167], a[68:71], v[144:147]
 v_max_u32 v28, v28, v30
M v[148:151], a[164:167], a[76:79], v[148:151]
 v_max3_u32 v29, v29, v31, v16
M v[148:151], a[160:163], a[72:75], v[148:151]
 s_add_u32 m0, s23, 32768
 v_mov_b32 v30, v28
M v[152:155], a[160:163], a[80:83], v[152:155]
 buffer_load_dwordx4 v8, s[16:19], s21 offen offset:0  nt lds
M v[152:155], a[164:167], a[84:87], v[152:155]
 s_waitcnt lgkmcnt(4)
 v_mov_b32 v31, v29
M v[156:159], a[164:167], a[92:95], v[156:159]
 ds_read_b64_tr_b16 a[144:145], v3 offset:49152
 ds_read_b64_tr_b16 a[146:147], v3 offset:50176
M v[156:159], a[160:163], a[88:91], v[156:159]
 v_permlane16_swap_b32 v30, v28
M v[188:191], a[168:171], a[88:91], v[188:191]
 ds_read_b128 a[160:163], v5 offset:20480
 ds_read_b128 a[164:167], v6 offset:20480
M v[188:191], a[172:175], a[92:95], v[188:191]
 v_permlane16_swap_b32 v31, v29
M v[184:187], a[172:175], a[84:87], v[184:187]
 buffer_load_dwordx4 v9, s[16:19], s21 offen offset:1024  nt lds
M v[184:187], a[168:171], a[80:83], v[184:187]
 v_min_u32 v16, v28, v30
M v[180:183], a[168:171], a[72:75], v[180:183]
 v_max_u32 v28, v28, v30
M v[180:183], a[172:175], a[76:79], v[180:183]
 ds_read_b64_tr_b16 a[148:149], v3 offset:57344
 ds_read_b64_tr_b16 a[150:151], v3 offset:58368
M v[176:179], a[172:175], a[68:71], v[176:179]
 v_max3_u32 v29, v29, v31, v16
M v[176:179], a[168:171], a[64:67], v[176:179]
 v_mov_b32 v30, v28
M v[172:175], a[168:171], a[56:59], v[172:175]
 v_mov_b32 v31, v29
M v[172:175], a[172:175], a[60:63], v[172:175]
 buffer_load_dwordx4 v10, s[16:19], s21 offen offset:2048  nt lds
M v[168:171], a[172:175], a[52:55], v[168:171]
 v_permlane32_swap_b32 v30, v28
M v[168:171], a[168:171], a[48:51], v[168:171]
 v_permlane32_swap_b32 v31, v29
M v[164:167], a[168:171], a[40:43], v[164:167]
 ds_read_b64_tr_b16 a[152:153], v4 offset:49152
 ds_read_b64_tr_b16 a[154:155], v4 offset:50176
M v[164:167], a[172:175], a[44:47], v[164:167]
 s_waitcnt lgkmcnt(4)
 v_min_u32 v16, v28, v30
M v[160:163], a[172:175], a[36:39], v[160:163]
 v_max_u32 v28, v28, v30
M v[160:163], a[168:171], a[32:35], v[160:163]
 buffer_load_dwordx4 v11, s[16:19], s21 offen offset:3072  nt lds
M v[192:195], a[160:163], a[32:35], v[192:195]
 s_add_u32 s21, s21, 128
 ds_read_b128 a[168:171], v5 offset:22528
 ds_read_b128 a[172:175], v6 offset:22528
M v[192:195], a[164:167], a[36:39], v[192:195]
 v_max3_u32 v29, v29, v31, v16
M v[196:199], a[164:167], a[44:47], v[196:199]
 s_lshl_b32 s64, s20, 3
M v[196:199], a[160:163], a[40:43], v[196:199]
 s_add_u32 s64, s64, 159744
 ds_read_b64_tr_b16 a[156:157], v4 offset:57344
 ds_read_b64_tr_b16 a[158:159], v4 offset:58368
M v[200:203], a[160:163], a[48:51], v[200:203]
 s_add_u32 m0, s87, 6144
 v_mov_b32 v16, s64
M v[200:203], a[164:167], a[52:55], v[200:203]
 buffer_load_dwordx4 v25, s[60:63], s89 offen offset:0 nt lds
M v[204:207], a[164:167], a[60:63], v[204:207]
 s_add_u32 s89, s89, 114688
 ds_write_b64 v16, v[28:29]
M v[204:207], a[160:163], a[56:59], v[204:207]
M v[208:211], a[160:163], a[64:67], v[208:211]
M v[208:211], a[164:167], a[68:71], v[208:211]
M v[212:215], a[164:167], a[76:79], v[212:215]
M v[212:215], a[160:163], a[72:75], v[212:215]
M v[216:219], a[160:163], a[80:83], v[216:219]
M v[216:219], a[164:167], a[84:87], v[216:219]
 s_waitcnt lgkmcnt(3)
M v[220:223], a[164:167], a[92:95], v[220:223]
 s_waitcnt vmcnt(18) lgkmcnt(0)
M v[220:223], a[160:163], a[88:91], v[220:223]
 s_barrier
M v[252:255], a[168:171], a[88:91], v[252:255]
 ds_read_b128 a[160:163], v5 offset:32768
 ds_read_b128 a[164:167], v6 offset:32768
M v[252:255], a[172:175], a[92:95], v[252:255]
 buffer_load_dword a240, v24, s[32:35], 0 offen offset:1536
M v[248:251], a[172:175], a[84:87], v[248:251]
M v[248:251], a[168:171], a[80:83], v[248:251]
M v[244:247], a[168:171], a[72:75], v[244:247]
M v[244:247], a[172:175], a[76:79], v[244:247]
M v[240:243], a[172:175], a[68:71], v[240:243]
M v[240:243], a[168:171], a[64:67], v[240:243]
M v[236:239], a[168:171], a[56:59], v[236:239]
M v[236:239], a[172:175], a[60:63], v[236:239]
M v[232:235], a[172:175], a[52:55], v[232:235]
M v[232:235], a[168:171], a[48:51], v[232:235]
M v[228:231], a[168:171], a[40:43], v[228:231]
M v[228:231], a[172:175], a[44:47], v[228:231]
 s_waitcnt lgkmcnt(0)
M v[224:227], a[172:175], a[36:39], v[224:227]
M v[224:227], a[168:171], a[32:35], v[224:227]
M a[0:3], a[160:163], a[96:99], a[0:3]
 ds_read_b128 a[168:171], v5 offset:34816
 ds_read_b128 a[172:175], v6 offset:34816
M a[0:3], a[164:167], a[100:103], a[0:3]
 ds_read_b64_tr_b16 a[32:33], v1 offset:0
 ds_read_b64_tr_b16 a[34:35], v1 offset:1024
M a[4:7], a[164:167], a[108:111], a[4:7]
 s_add_u32 m0, s24, 16384
M a[4:7], a[160:163], a[104:107], a[4:7]
 buffer_load_dwordx4 v12, s[48:51], s22 offen offset:0   lds
M a[8:11], a[160:163], a[112:115], a[8:11]
 v_mov_b32 v28, 159744
M a[8:11], a[164:167], a[116:119], a[8:11]
 ds_read_b128 v[16:19], v28
M a[12:15], a[164:167], a[124:127], a[12:15]
 ds_read_b64_tr_b16 a[36:37], v1 offset:8192
 ds_read_b64_tr_b16 a[38:39], v1 offset:9216
M a[12:15], a[160:163], a[120:123], a[12:15]
 ds_read_b128 v[20:23], v28 offset:16
M a[16:19], a[160:163], a[128:131], a[16:19]
 buffer_load_dwordx4 v13, s[48:51], s22 offen offset:1024   lds
M a[16:19], a[164:167], a[132:135], a[16:19]
M a[20:23], a[164:167], a[140:143], a[20:23]
M a[20:23], a[160:163], a[136:139], a[20:23]
 ds_read_b64_tr_b16 a[40:41], v2 offset:0
 ds_read_b64_tr_b16 a[42:43], v2 offset:1024
M a[24:27], a[160:163], a[144:147], a[24:27]
M a[24:27], a[164:167], a[148:151], a[24:27]
 s_waitcnt lgkmcnt(8)
M a[28:31], a[164:167], a[156:159], a[28:31]
 buffer_load_dwordx4 v14, s[48:51], s22 offen offset:2048   lds
M a[28:31], a[160:163], a[152:155], a[28:31]
M v[60:63], a[168:171], a[152:155], v[60:63]
 ds_read_b128 a[160:163], v5 offset:36864
 ds_read_b128 a[164:167], v6 offset:36864
M v[60:63], a[172:175], a[156:159], v[60:63]
 ds_read_b64_tr_b16 a[44:45], v2 offset:8192
 ds_read_b64_tr_b16 a[46:47], v2 offset:9216
M v[56:59], a[172:175], a[148:151], v[56:59]
 buffer_load_dwordx4 v15, s[48:51], s22 offen offset:3072   lds
M v[56:59], a[168:171], a[144:147], v[56:59]
 s_sub_u32 s22, s22, 2097024
 s_waitcnt lgkmcnt(9)
 v_min_u32 v28, v16, v18
M v[52:55], a[168:171], a[136:139], v[52:55]
 v_max_u32 v16, v16, v18
M v[52:55], a[172:175], a[140:143], v[52:55]
 ds_read_b64_tr_b16 a[48:49], v3 offset:0
 ds_read_b64_tr_b16 a[50:51], v3 offset:1024
M v[48:51], a[172:175], a[132:135], v[48:51]
 s_add_u32 m0, s23, 49152
 v_max3_u32 v17, v17, v19, v28
M v[48:51], a[168:171], a[128:131], v[48:51]
 buffer_load_dwordx4 v8, s[16:19], s21 offen offset:0  nt lds
M v[44:47], a[168:171], a[120:123], v[44:47]
 s_waitcnt lgkmcnt(8)
 v_min_u32 v29, v20, v22
M v[44:47], a[172:175], a[124:127], v[44:47]
 v_max_u32 v20, v20, v22
M v[40:43], a[172:175], a[116:119], v[40:43]
 ds_read_b64_tr_b16 a[52:53], v3 offset:8192
 ds_read_b64_tr_b16 a[54:55], v3 offset:9216
M v[40:43], a[168:171], a[112:115], v[40:43]
 v_max3_u32 v21, v21, v23, v29
M v[36:39], a[168:171], a[104:107], v[36:39]
 buffer_load_dwordx4 v9, s[16:19], s21 offen offset:1024  nt lds
M v[36:39], a[172:175], a[108:111], v[36:39]
 s_waitcnt lgkmcnt(6)
 v_min_u32 v28, v16, v20
M v[32:35], a[172:175], a[100:103], v[32:35]
 v_max_u32 v16, v16, v20
M v[32:35], a[168:171], a[96:99], v[32:35]
 ds_read_b64_tr_b16 a[56:57], v4 offset:0
 ds_read_b64_tr_b16 a[58:59], v4 offset:1024
M v[64:67], a[160:163], a[96:99], v[64:67]
 ds_read_b128 a[168:171], v5 offset:38912
 ds_read_b128 a[172:175], v6 offset:38912
M v[64:67], a[164:167], a[100:103], v[64:67]
 buffer_load_dwordx4 v10, s[16:19], s21 offen offset:2048  nt lds
M v[68:71], a[164:167], a[108:111], v[68:71]
 v_max3_u32 v17, v17, v21, v28
M v[68:71], a[160:163], a[104:107], v[68:71]
 v_and_b32 v28, 1, v0
M v[72:75], a[160:163], a[112:115], v[72:75]
 ds_read_b64_tr_b16 a[60:61], v4 offset:8192
 ds_read_b64_tr_b16 a[62:63], v4 offset:9216
M v[72:75], a[164:167], a[116:119], v[72:75]
 v_cmp_eq_u32 vcc, 0, v28
M v[76:79], a[164:167], a[124:127], v[76:79]
 buffer_load_dwordx4 v11, s[16:19], s21 offen offset:3072  nt lds
M v[76:79], a[160:163], a[120:123], v[76:79]
 s_add_u32 s21, s21, 524160
 s_and_b32 s64, s20, 1
M v[80:83], a[160:163], a[128:131], v[80:83]
 s_mul_i32 s64, s64, 448
 v_cndmask_b32 v24, v17, v16, vcc
M v[80:83], a[164:167], a[132:135], v[80:83]
 v_and_b32 v24, 0x7ff, v24
M v[84:87], a[164:167], a[140:143], v[84:87]
 v_sub_u32 v24, 2047, v24
M v[84:87], a[160:163], a[136:139], v[84:87]
 v_mul_u32_u24 v28, 896, v24
M v[88:91], a[160:163], a[144:147], v[88:91]
 v_lshrrev_b32 v29, 4, v0
M v[88:91], a[164:167], a[148:151], v[88:91]
 s_waitcnt lgkmcnt(2)
 v_lshl_add_u32 v28, v29, 4, v28
M v[92:95], a[164:167], a[156:159], v[92:95]
 s_waitcnt vmcnt(18) lgkmcnt(0)
 v_bfe_u32 v30, v0, 1, 3
M v[92:95], a[160:163], a[152:155], v[92:95]
 s_barrier
M v[124:127], a[168:171], a[152:155], v[124:127]
 ds_read_b128 a[160:163], v5 offset:49152
 ds_read_b128 a[164:167], v6 offset:49152
M v[124:127], a[172:175], a[156:159], v[124:127]
 v_lshl_or_b32 v28, v30, 26, v28
M v[120:123], a[172:175], a[148:151], v[120:123]
 s_add_u32 m0, s24, 32768
 ds_read_b64_tr_b16 a[64:65], v1 offset:16384
 ds_read_b64_tr_b16 a[66:67], v1 offset:17408
M v[120:123], a[168:171], a[144:147], v[120:123]
 buffer_load_dwordx4 v12, s[48:51], s22 offen offset:0   lds
M v[116:119], a[168:171], a[136:139], v[116:119]
M v[116:119], a[172:175], a[140:143], v[116:119]
M v[112:115], a[172:175], a[132:135], v[112:115]
 buffer_load_dwordx4 a[208:211], v28, s[56:59], s64 offen offset:0
M v[112:115], a[168:171], a[128:131], v[112:115]
M v[108:111], a[168:171], a[120:123], v[108:111]
 buffer_load_dwordx4 a[212:215], v28, s[56:59], s64 offen offset:64
M v[108:111], a[172:175], a[124:127], v[108:111]
 ds_read_b64_tr_b16 a[68:69], v1 offset:24576
 ds_read_b64_tr_b16 a[70:71], v1 offset:25600
M v[104:107], a[172:175], a[116:119], v[104:107]
 buffer_load_dwordx4 v13, s[48:51], s22 offen offset:1024   lds
M v[104:107], a[168:171], a[112:115], v[104:107]
M v[100:103], a[168:171], a[104:107], v[100:103]
M v[100:103], a[172:175], a[108:111], v[100:103]
 s_waitcnt lgkmcnt(4)
M v[96:99], a[172:175], a[100:103], v[96:99]
 buffer_load_dwordx4 a[216:219], v28, s[56:59], s64 offen offset:128
M v[96:99], a[168:171], a[96:99], v[96:99]
M v[128:131], a[160:163], a[96:99], v[128:131]
 ds_read_b128 a[168:171], v5 offset:51200
 ds_read_b128 a[172:175], v6 offset:51200
M v[128:131], a[164:167], a[100:103], v[128:131]
 ds_read_b64_tr_b16 a[72:73], v2 offset:16384
 ds_read_b64_tr_b16 a[74:75], v2 offset:17408
M v[132:135], a[164:167], a[108:111], v[132:135]
 buffer_load_dwordx4 v14, s[48:51], s22 offen offset:2048   lds
M v[132:135], a[160:163], a[104:107], v[132:135]
M v[136:139], a[160:163], a[112:115], v[136:139]
 buffer_load_dwordx4 a[220:223], v28, s[56:59], s64 offen offset:192
M v[136:139], a[164:167], a[116:119], v[136:139]
M v[140:143], a[164:167], a[124:127], v[140:143]
 buffer_load_dwordx4 a[224:227], v28, s[56:59], s64 offen offset:256
M v[140:143], a[160:163], a[120:123], v[140:143]
 ds_read_b64_tr_b16 a[76:77], v2 offset:24576
 ds_read_b64_tr_b16 a[78:79], v2 offset:25600
M v[144:147], a[160:163], a[128:131], v[144:147]
 buffer_load_dwordx4 v15, s[48:51], s22 offen offset:3072   lds
M v[144:147], a[164:167], a[132:135], v[144:147]
 s_add_u32 s22, s22, 2097152
M v[148:151], a[164:167], a[140:143], v[148:151]
M v[148:151], a[160:163], a[136:139], v[148:151]
 buffer_load_dwordx4 a[228:231], v28, s[56:59], s64 offen offset:320
M v[152:155], a[160:163], a[144:147], v[152:155]
M v[152:155], a[164:167], a[148:151], v[152:155]
 s_waitcnt lgkmcnt(4)
M v[156:159], a[164:167], a[156:159], v[156:159]
 s_add_u32 m0, s23, 0
 ds_read_b64_tr_b16 a[80:81], v3 offset:16384
 ds_read_b64_tr_b16 a[82:83], v3 offset:17408
M v[156:159], a[160:163], a[152:155], v[156:159]
 buffer_load_dwordx4 v8, s[16:19], s21 offen offset:0  nt lds
M v[188:191], a[168:171], a[152:155], v[188:191]
 ds_read_b128 a[160:163], v5 offset:53248
 ds_read_b128 a[164:167], v6 offset:53248
M v[188:191], a[172:175], a[156:159], v[188:191]
 buffer_load_dwordx4 a[232:235], v28, s[56:59], s64 offen offset:384
M v[184:187], a[172:175], a[148:151], v[184:187]
 v_lshrrev_b32 v28, 4, v24
M v[184:187], a[168:171], a[144:147], v[184:187]
 v_lshlrev_b32 v28, 5, v28
M v[180:183], a[168:171], a[136:139], v[180:183]
 v_and_b32 v30, 15, v24
M v[180:183], a[172:175], a[140:143], v[180:183]
 ds_read_b64_tr_b16 a[84:85], v3 offset:24576
 ds_read_b64_tr_b16 a[86:87], v3 offset:25600
M v[176:179], a[172:175], a[132:135], v[176:179]
 buffer_load_dwordx4 v9, s[16:19], s21 offen offset:1024  nt lds
M v[176:179], a[168:171], a[128:131], v[176:179]
 v_add_lshl_u32 v28, v28, v30, 2
M v[172:175], a[168:171], a[120:123], v[172:175]
 v_lshrrev_b32 v30, 1, v0
M v[172:175], a[172:175], a[124:127], v[172:175]
 v_min_u32 v30, 1, v30
M v[168:171], a[172:175], a[116:119], v[168:171]
 v_lshl_or_b32 v28, v30, 29, v28
M v[168:171], a[168:171], a[112:115], v[168:171]
 s_mov_b32 s64, 104857600
M v[164:167], a[168:171], a[104:107], v[164:167]
 ds_read_b64_tr_b16 a[88:89], v4 offset:16384
 ds_read_b64_tr_b16 a[90:91], v4 offset:17408
M v[164:167], a[172:175], a[108:111], v[164:167]
 s_waitcnt lgkmcnt(4)
M v[160:163], a[172:175], a[100:103], v[160:163]
 buffer_load_dwordx4 v10, s[16:19], s21 offen offset:2048  nt lds
M v[160:163], a[168:171], a[96:99], v[160:163]
 buffer_load_dword v23, v28, s[8:11], s64 offen sc1
M v[192:195], a[160:163], a[96:99], v[192:195]
 ds_read_b128 a[168:171], v5 offset:55296
 ds_read_b128 a[172:175], v6 offset:55296
M v[192:195], a[164:167], a[100:103], v[192:195]
 v_bfe_u32 v28, v0, 2, 2
M v[196:199], a[164:167], a[108:111], v[196:199]
 v_lshl_add_u32 v28, v29, 3, v28
M v[196:199], a[160:163], a[104:107], v[196:199]
 ds_read_b64_tr_b16 a[92:93], v4 offset:24576
 ds_read_b64_tr_b16 a[94:95], v4 offset:25600
M v[200:203], a[160:163], a[112:115], v[200:203]
 buffer_load_dwordx4 v11, s[16:19], s21 offen offset:3072  nt lds
M v[200:203], a[164:167], a[116:119], v[200:203]
 s_add_u32 s21, s21, 128
 v_lshlrev_b32 v28, 5, v28
M v[204:207], a[164:167], a[124:127], v[204:207]
 v_and_b32 v30, 3, v0
M v[204:207], a[160:163], a[120:123], v[204:207]
 v_lshl_add_u32 v28, v30, 3, v28
M v[208:211], a[160:163], a[128:131], v[208:211]
 v_add_u32 v22, s87, v28
M v[208:211], a[164:167], a[132:135], v[208:211]
M v[212:215], a[164:167], a[140:143], v[212:215]
M v[212:215], a[160:163], a[136:139], v[212:215]
M v[216:219], a[160:163], a[144:147], v[216:219]
M v[216:219], a[164:167], a[148:151], v[216:219]
 s_waitcnt lgkmcnt(2)
M v[220:223], a[164:167], a[156:159], v[220:223]
 s_waitcnt vmcnt(26) lgkmcnt(0)
M v[220:223], a[160:163], a[152:155], v[220:223]
 s_barrier
M v[252:255], a[168:171], a[152:155], v[252:255]
 ds_read_b128 a[160:163], v5 offset:0
 ds_read_b128 a[164:167], v6 offset:0
M v[252:255], a[172:175], a[156:159], v[252:255]
M v[248:251], a[172:175], a[148:151], v[248:251]
M v[248:251], a[168:171], a[144:147], v[248:251]
M v[244:247], a[168:171], a[136:139], v[244:247]
M v[244:247], a[172:175], a[140:143], v[244:247]
M v[240:243], a[172:175], a[132:135], v[240:243]
M v[240:243], a[168:171], a[128:131], v[240:243]
M v[236:239], a[168:171], a[120:123], v[236:239]
M v[236:239], a[172:175], a[124:127], v[236:239]
M v[232:235], a[172:175], a[116:119], v[232:235]
M v[232:235], a[168:171], a[112:115], v[232:235]
M v[228:231], a[168:171], a[104:107], v[228:231]
M v[228:231], a[172:175], a[108:111], v[228:231]
 s_waitcnt lgkmcnt(0)
M v[224:227], a[172:175], a[100:103], v[224:227]
M v[224:227], a[168:171], a[96:99], v[224:227]
M a[0:3], a[160:163], a[32:35], a[0:3]
 ds_read_b128 a[168:171], v5 offset:2048
 ds_read_b128 a[172:175], v6 offset:2048
M a[0:3], a[164:167], a[36:39], a[0:3]
 ds_read_b64_tr_b16 a[96:97], v1 offset:32768
 ds_read_b64_tr_b16 a[98:99], v1 offset:33792
M a[4:7], a[164:167], a[44:47], a[4:7]
 s_add_u32 m0, s24, 49152
M a[4:7], a[160:163], a[40:43], a[4:7]
 buffer_load_dwordx4 v12, s[48:51], s22 offen offset:0   lds
M a[8:11], a[160:163], a[48:51], a[8:11]
M a[8:11], a[164:167], a[52:55], a[8:11]
M a[12:15], a[164:167], a[60:63], a[12:15]
 ds_read_b64_tr_b16 a[100:101], v1 offset:40960
 ds_read_b64_tr_b16 a[102:103], v1 offset:41984
M a[12:15], a[160:163], a[56:59], a[12:15]
M a[16:19], a[160:163], a[64:67], a[16:19]
 buffer_load_dwordx4 v13, s[48:51], s22 offen offset:1024   lds
M a[16:19], a[164:167], a[68:71], a[16:19]
M a[20:23], a[164:167], a[76:79], a[20:23]
M a[20:23], a[160:163], a[72:75], a[20:23]
 ds_read_b64_tr_b16 a[104:105], v2 offset:32768
 ds_read_b64_tr_b16 a[106:107], v2 offset:33792
M a[24:27], a[160:163], a[80:83], a[24:27]
M a[24:27], a[164:167], a[84:87], a[24:27]
 s_waitcnt lgkmcnt(6)
M a[28:31], a[164:167], a[92:95], a[28:31]
 buffer_load_dwordx4 v14, s[48:51], s22 offen offset:2048   lds
M a[28:31], a[160:163], a[88:91], a[28:31]
M v[60:63], a[168:171], a[88:91], v[60:63]
 ds_read_b128 a[160:163], v5 offset:4096
 ds_read_b128 a[164:167], v6 offset:4096
M v[60:63], a[172:175], a[92:95], v[60:63]
 ds_read_b64_tr_b16 a[108:109], v2 offset:40960
 ds_read_b64_tr_b16 a[110:111], v2 offset:41984
M v[56:59], a[172:175], a[84:87], v[56:59]
 buffer_load_dwordx4 v15, s[48:51], s22 offen offset:3072   lds
M v[56:59], a[168:171], a[80:83], v[56:59]
 s_sub_u32 s22, s22, 2097024
M v[52:55], a[168:171], a[72:75], v[52:55]
M v[52:55], a[172:175], a[76:79], v[52:55]
 ds_read_b64_tr_b16 a[112:113], v3 offset:32768
 ds_read_b64_tr_b16 a[114:115], v3 offset:33792
M v[48:51], a[172:175], a[68:71], v[48:51]
 s_add_u32 m0, s23, 16384
M v[48:51], a[168:171], a[64:67], v[48:51]
 buffer_load_dwordx4 v8, s[16:19], s21 offen offset:0  nt lds
M v[44:47], a[168:171], a[56:59], v[44:47]
M v[44:47], a[172:175], a[60:63], v[44:47]
M v[40:43], a[172:175], a[52:55], v[40:43]
 ds_read_b64_tr_b16 a[116:117], v3 offset:40960
 ds_read_b64_tr_b16 a[118:119], v3 offset:41984
M v[40:43], a[168:171], a[48:51], v[40:43]
M v[36:39], a[168:171], a[40:43], v[36:39]
 buffer_load_dwordx4 v9, s[16:19], s21 offen offset:1024  nt lds
M v[36:39], a[172:175], a[44:47], v[36:39]
 s_waitcnt lgkmcnt(6)
M v[32:35], a[172:175], a[36:39], v[32:35]
M v[32:35], a[168:171], a[32:35], v[32:35]
 ds_read_b64_tr_b16 a[120:121], v4 offset:32768
 ds_read_b64_tr_b16 a[122:123], v4 offset:33792
M v[64:67], a[160:163], a[32:35], v[64:67]
 ds_read_b128 a[168:171], v5 offset:6144
 ds_read_b128 a[172:175], v6 offset:6144
M v[64:67], a[164:167], a[36:39], v[64:67]
 buffer_load_dwordx4 v10, s[16:19], s21 offen offset:2048  nt lds
M v[68:71], a[164:167], a[44:47], v[68:71]
M v[68:71], a[160:163], a[40:43], v[68:71]
M v[72:75], a[160:163], a[48:51], v[72:75]
 ds_read_b64_tr_b16 a[124:125], v4 offset:40960
 ds_read_b64_tr_b16 a[126:127], v4 offset:41984
M v[72:75], a[164:167], a[52:55], v[72:75]
M v[76:79], a[164:167], a[60:63], v[76:79]
 buffer_load_dwordx4 v11, s[16:19], s21 offen offset:3072  nt lds
M v[76:79], a[160:163], a[56:59], v[76:79]
 s_add_u32 s21, s21, 524160
M v[80:83], a[160:163], a[64:67], v[80:83]
M v[80:83], a[164:167], a[68:71], v[80:83]
M v[84:87], a[164:167], a[76:79], v[84:87]
M v[84:87], a[160:163], a[72:75], v[84:87]
M v[88:91], a[160:163], a[80:83], v[88:91]
M v[88:91], a[164:167], a[84:87], v[88:91]
 s_waitcnt lgkmcnt(2)
M v[92:95], a[164:167], a[92:95], v[92:95]
 s_waitcnt vmcnt(24) lgkmcnt(0)
M v[92:95], a[160:163], a[88:91], v[92:95]
 s_barrier
M v[124:127], a[168:171], a[88:91], v[124:127]
 ds_read_b128 a[160:163], v5 offset:16384
 ds_read_b128 a[164:167], v6 offset:16384
M v[124:127], a[172:175], a[92:95], v[124:127]
M v[120:123], a[172:175], a[84:87], v[120:123]
 s_add_u32 m0, s24, 0
 ds_read_b64_tr_b16 a[128:129], v1 offset:49152
 ds_read_b64_tr_b16 a[130:131], v1 offset:50176
M v[120:123], a[168:171], a[80:83], v[120:123]
 buffer_load_dwordx4 v12, s[48:51], s22 offen offset:0   lds
M v[116:119], a[168:171], a[72:75], v[116:119]
 ds_read_b64_tr_b16 a[176:177], v22 offset:0
M v[116:119], a[172:175], a[76:79], v[116:119]
 ds_read_b64_tr_b16 a[178:179], v22 offset:128
 ds_read_b64_tr_b16 a[180:181], v22 offset:1024
M v[112:115], a[172:175], a[68:71], v[112:115]
 ds_read_b64_tr_b16 a[182:183], v22 offset:1152
M v[112:115], a[168:171], a[64:67], v[112:115]
 ds_read_b64_tr_b16 a[184:185], v22 offset:2048
 ds_read_b64_tr_b16 a[186:187], v22 offset:2176
M v[108:111], a[168:171], a[56:59], v[108:111]
 ds_read_b64_tr_b16 a[188:189], v22 offset:3072
M v[108:111], a[172:175], a[60:63], v[108:111]
 ds_read_b64_tr_b16 a[132:133], v1 offset:57344
 ds_read_b64_tr_b16 a[134:135], v1 offset:58368
M v[104:107], a[172:175], a[52:55], v[104:107]
 buffer_load_dwordx4 v13, s[48:51], s22 offen offset:1024   lds
M v[104:107], a[168:171], a[48:51], v[104:107]
 ds_read_b64_tr_b16 a[190:191], v22 offset:3200
M v[100:103], a[168:171], a[40:43], v[100:103]
M v[100:103], a[172:175], a[44:47], v[100:103]
 s_waitcnt lgkmcnt(12)
M v[96:99], a[172:175], a[36:39], v[96:99]
M v[96:99], a[168:171], a[32:35], v[96:99]
M v[128:131], a[160:163], a[32:35], v[128:131]
 ds_read_b128 a[168:171], v5 offset:18432
 ds_read_b128 a[172:175], v6 offset:18432
M v[128:131], a[164:167], a[36:39], v[128:131]
 ds_read_b64_tr_b16 a[136:137], v2 offset:49152
 ds_read_b64_tr_b16 a[138:139], v2 offset:50176
M v[132:135], a[164:167], a[44:47], v[132:135]
 buffer_load_dwordx4 v14, s[48:51], s22 offen offset:2048   lds
M v[132:135], a[160:163], a[40:43], v[132:135]
M v[136:139], a[160:163], a[48:51], v[136:139]
M v[136:139], a[164:167], a[52:55], v[136:139]
M v[140:143], a[164:167], a[60:63], v[140:143]
M v[140:143], a[160:163], a[56:59], v[140:143]
 ds_read_b64_tr_b16 a[140:141], v2 offset:57344
 ds_read_b64_tr_b16 a[142:143], v2 offset:58368
M v[144:147], a[160:163], a[64:67], v[144:147]
 buffer_load_dwordx4 v15, s[48:51], s22 offen offset:3072   lds
M v[144:147], a[164:167], a[68:71], v[144:147]
 s_add_u32 s22, s22, 2097152
M v[148:151], a[164:167], a[76:79], v[148:151]
M v[148:151], a[160:163], a[72:75], v[148:151]
M v[152:155], a[160:163], a[80:83], v[152:155]
M v[152:155], a[164:167], a[84:87], v[152:155]
 s_waitcnt lgkmcnt(4)
M v[156:159], a[164:167], a[92:95], v[156:159]
 s_add_u32 m0, s23, 32768
 ds_read_b64_tr_b16 a[144:145], v3 offset:49152
 ds_read_b64_tr_b16 a[146:147], v3 offset:50176
M v[156:159], a[160:163], a[88:91], v[156:159]
 buffer_load_dwordx4 v8, s[16:19], s21 offen offset:0  nt lds
 s_waitcnt vmcnt(27)
M v[16:19], a[176:179], a[208:211], 0
 s_waitcnt vmcnt(26)
M v[16:19], a[180:183], a[212:215], v[16:19]
 s_waitcnt vmcnt(24)
M v[16:19], a[184:187], a[216:219], v[16:19]
 s_waitcnt vmcnt(22)
M v[16:19], a[188:191], a[220:223], v[16:19]
M v[188:191], a[168:171], a[88:91], v[188:191]
 ds_read_b128 a[160:163], v5 offset:20480
 ds_read_b128 a[164:167], v6 offset:20480
M v[188:191], a[172:175], a[92:95], v[188:191]
 ds_read_b64_tr_b16 a[176:177], v22 offset:4096
M v[184:187], a[172:175], a[84:87], v[184:187]
 ds_read_b64_tr_b16 a[178:179], v22 offset:4224
 ds_read_b64_tr_b16 a[180:181], v22 offset:5120
M v[184:187], a[168:171], a[80:83], v[184:187]
 ds_read_b64_tr_b16 a[182:183], v22 offset:5248
M v[180:183], a[168:171], a[72:75], v[180:183]
 ds_read_b64_tr_b16 a[184:185], v22 offset:6144
M v[180:183], a[172:175], a[76:79], v[180:183]
 ds_read_b64_tr_b16 a[148:149], v3 offset:57344
 ds_read_b64_tr_b16 a[150:151], v3 offset:58368
M v[176:179], a[172:175], a[68:71], v[176:179]
 buffer_load_dwordx4 v9, s[16:19], s21 offen offset:1024  nt lds
M v[176:179], a[168:171], a[64:67], v[176:179]
 ds_read_b64_tr_b16 a[186:187], v22 offset:6272
M v[172:175], a[168:171], a[56:59], v[172:175]
M v[172:175], a[172:175], a[60:63], v[172:175]
M v[168:171], a[172:175], a[52:55], v[168:171]
M v[168:171], a[168:171], a[48:51], v[168:171]
M v[164:167], a[168:171], a[40:43], v[164:167]
 ds_read_b64_tr_b16 a[152:153], v4 offset:49152
 ds_read_b64_tr_b16 a[154:155], v4 offset:50176
M v[164:167], a[172:175], a[44:47], v[164:167]
 s_waitcnt lgkmcnt(10)
M v[160:163], a[172:175], a[36:39], v[160:163]
 buffer_load_dwordx4 v10, s[16:19], s21 offen offset:2048  nt lds
M v[160:163], a[168:171], a[32:35], v[160:163]
M v[192:195], a[160:163], a[32:35], v[192:195]
 ds_read_b128 a[168:171], v5 offset:22528
 ds_read_b128 a[172:175], v6 offset:22528
M v[192:195], a[164:167], a[36:39], v[192:195]
M v[196:199], a[164:167], a[44:47], v[196:199]
M v[196:199], a[160:163], a[40:43], v[196:199]
 ds_read_b64_tr_b16 a[156:157], v4 offset:57344
 ds_read_b64_tr_b16 a[158:159], v4 offset:58368
M v[200:203], a[160:163], a[48:51], v[200:203]
 buffer_load_dwordx4 v11, s[16:19], s21 offen offset:3072  nt lds
M v[200:203], a[164:167], a[52:55], v[200:203]
 s_add_u32 s21, s21, 128
M v[204:207], a[164:167], a[60:63], v[204:207]
M v[204:207], a[160:163], a[56:59], v[204:207]
M v[208:211], a[160:163], a[64:67], v[208:211]
M v[208:211], a[164:167], a[68:71], v[208:211]
M v[212:215], a[164:167], a[76:79], v[212:215]
M v[212:215], a[160:163], a[72:75], v[212:215]
M v[216:219], a[160:163], a[80:83], v[216:219]
M v[216:219], a[164:167], a[84:87], v[216:219]
 s_waitcnt lgkmcnt(2)
M v[220:223], a[164:167], a[92:95], v[220:223]
 s_waitcnt vmcnt(16) lgkmcnt(0)
M v[220:223], a[160:163], a[88:91], v[220:223]
 s_barrier
M v[16:19], a[176:179], a[224:227], v[16:19]
M v[16:19], a[180:183], a[228:231], v[16:19]
M v[16:19], a[184:187], a[232:235], v[16:19]
M v[252:255], a[168:171], a[88:91], v[252:255]
 ds_read_b128 a[160:163], v5 offset:32768
 ds_read_b128 a[164:167], v6 offset:32768
M v[252:255], a[172:175], a[92:95], v[252:255]
M v[248:251], a[172:175], a[84:87], v[248:251]
M v[248:251], a[168:171], a[80:83], v[248:251]
M v[244:247], a[168:171], a[72:75], v[244:247]
M v[244:247], a[172:175], a[76:79], v[244:247]
M v[240:243], a[172:175], a[68:71], v[240:243]
M v[240:243], a[168:171], a[64:67], v[240:243]
M v[236:239], a[168:171], a[56:59], v[236:239]
M v[236:239], a[172:175], a[60:63], v[236:239]
M v[232:235], a[172:175], a[52:55], v[232:235]
M v[232:235], a[168:171], a[48:51], v[232:235]
M v[228:231], a[168:171], a[40:43], v[228:231]
M v[228:231], a[172:175], a[44:47], v[228:231]
 s_waitcnt lgkmcnt(0)
M v[224:227], a[172:175], a[36:39], v[224:227]
M v[224:227], a[168:171], a[32:35], v[224:227]
M a[0:3], a[160:163], a[96:99], a[0:3]
 ds_read_b128 a[168:171], v5 offset:34816
 ds_read_b128 a[172:175], v6 offset:34816
M a[0:3], a[164:167], a[100:103], a[0:3]
 ds_read_b64_tr_b16 a[32:33], v1 offset:0
 ds_read_b64_tr_b16 a[34:35], v1 offset:1024
M a[4:7], a[164:167], a[108:111], a[4:7]
 s_add_u32 m0, s24, 16384
M a[4:7], a[160:163], a[104:107], a[4:7]
 buffer_load_dwordx4 v12, s[48:51], s22 offen offset:0   lds
M a[8:11], a[160:163], a[112:115], a[8:11]
M a[8:11], a[164:167], a[116:119], a[8:11]
 s_lshl_b32 s64, s20, 10
M a[12:15], a[164:167], a[124:127], a[12:15]
 s_add_u32 s64, s64, 159744
 ds_read_b64_tr_b16 a[36:37], v1 offset:8192
 ds_read_b64_tr_b16 a[38:39], v1 offset:9216
M a[12:15], a[160:163], a[120:123], a[12:15]
 v_add_u32 v21, s64, v7
 ds_write_b128 v21, v[16:19]
M a[16:19], a[160:163], a[128:131], a[16:19]
 buffer_load_dwordx4 v13, s[48:51], s22 offen offset:1024   lds
M a[16:19], a[164:167], a[132:135], a[16:19]
 s_mul_i32 s67, s86, 14336
M a[20:23], a[164:167], a[140:143], a[20:23]
 s_mul_i32 s64, s20, 224
M a[20:23], a[160:163], a[136:139], a[20:23]
 s_add_u32 s67, s67, s64
 ds_read_b64_tr_b16 a[40:41], v2 offset:0
 ds_read_b64_tr_b16 a[42:43], v2 offset:1024
M a[24:27], a[160:163], a[144:147], a[24:27]
 v_lshrrev_b32 v28, 4, v0
 v_mul_u32_u24 v28, 896, v28
M a[24:27], a[164:167], a[148:151], a[24:27]
 s_waitcnt lgkmcnt(7)
 v_and_b32 v29, 15, v0
 v_lshl_add_u32 v28, v29, 4, v28
M a[28:31], a[164:167], a[156:159], a[28:31]
 buffer_load_dwordx4 v14, s[48:51], s22 offen offset:2048   lds
M a[28:31], a[160:163], a[152:155], a[28:31]
 v_mov_b32 v30, 536870912
 v_cmp_gt_u32 vcc, 14, v29
M v[60:63], a[168:171], a[152:155], v[60:63]
 s_nop 0
 ds_read_b128 a[160:163], v5 offset:36864
 ds_read_b128 a[164:167], v6 offset:36864
M v[60:63], a[172:175], a[156:159], v[60:63]
 s_nop 0
 ds_read_b64_tr_b16 a[44:45], v2 offset:8192
 ds_read_b64_tr_b16 a[46:47], v2 offset:9216
M v[56:59], a[172:175], a[148:151], v[56:59]
 buffer_load_dwordx4 v15, s[48:51], s22 offen offset:3072   lds
M v[56:59], a[168:171], a[144:147], v[56:59]
 s_sub_u32 s22, s22, 2097024
 v_cndmask_b32 v28, v30, v28, vcc
 v_add_u32 v29, 2560, v28
M v[52:55], a[168:171], a[136:139], v[52:55]
 v_add_u32 v30, 5120, v28
 v_add_u32 v31, 7680, v28
M v[52:55], a[172:175], a[140:143], v[52:55]
 ds_read_b64_tr_b16 a[48:49], v3 offset:0
 ds_read_b64_tr_b16 a[50:51], v3 offset:1024
M v[48:51], a[172:175], a[132:135], v[48:51]
 s_add_u32 m0, s23, 49152
M v[48:51], a[168:171], a[128:131], v[48:51]
 buffer_load_dwordx4 v8, s[16:19], s21 offen offset:0  nt lds
M v[44:47], a[168:171], a[120:123], v[44:47]
M v[44:47], a[172:175], a[124:127], v[44:47]
M v[40:43], a[172:175], a[116:119], v[40:43]
 ds_read_b64_tr_b16 a[52:53], v3 offset:8192
 ds_read_b64_tr_b16 a[54:55], v3 offset:9216
M v[40:43], a[168:171], a[112:115], v[40:43]
M v[36:39], a[168:171], a[104:107], v[36:39]
 buffer_load_dwordx4 v9, s[16:19], s21 offen offset:1024  nt lds
M v[36:39], a[172:175], a[108:111], v[36:39]
 s_waitcnt lgkmcnt(6)
M v[32:35], a[172:175], a[100:103], v[32:35]
M v[32:35], a[168:171], a[96:99], v[32:35]
 ds_read_b64_tr_b16 a[56:57], v4 offset:0
 ds_read_b64_tr_b16 a[58:59], v4 offset:1024
M v[64:67], a[160:163], a[96:99], v[64:67]
 ds_read_b128 a[168:171], v5 offset:38912
 ds_read_b128 a[172:175], v6 offset:38912
M v[64:67], a[164:167], a[100:103], v[64:67]
 buffer_load_dwordx4 v10, s[16:19], s21 offen offset:2048  nt lds
M v[68:71], a[164:167], a[108:111], v[68:71]
M v[68:71], a[160:163], a[104:107], v[68:71]
M v[72:75], a[160:163], a[112:115], v[72:75]
 ds_read_b64_tr_b16 a[60:61], v4 offset:8192
 ds_read_b64_tr_b16 a[62:63], v4 offset:9216
M v[72:75], a[164:167], a[116:119], v[72:75]
M v[76:79], a[164:167], a[124:127], v[76:79]
 buffer_load_dwordx4 v11, s[16:19], s21 offen offset:3072  nt lds
M v[76:79], a[160:163], a[120:123], v[76:79]
 s_add_u32 s21, s21, 524160
M v[80:83], a[160:163], a[128:131], v[80:83]
M v[80:83], a[164:167], a[132:135], v[80:83]
M v[84:87], a[164:167], a[140:143], v[84:87]
M v[84:87], a[160:163], a[136:139], v[84:87]
M v[88:91], a[160:163], a[144:147], v[88:91]
M v[88:91], a[164:167], a[148:151], v[88:91]
 s_waitcnt lgkmcnt(2)
M v[92:95], a[164:167], a[156:159], v[92:95]
 s_waitcnt vmcnt(16) lgkmcnt(0)
M v[92:95], a[160:163], a[152:155], v[92:95]
 s_barrier
M v[124:127], a[168:171], a[152:155], v[124:127]
 ds_read_b128 a[160:163], v5 offset:49152
 ds_read_b128 a[164:167], v6 offset:49152
M v[124:127], a[172:175], a[156:159], v[124:127]
M v[120:123], a[172:175], a[148:151], v[120:123]
 s_add_u32 m0, s24, 32768
 ds_read_b64_tr_b16 a[64:65], v1 offset:16384
 ds_read_b64_tr_b16 a[66:67], v1 offset:17408
M v[120:123], a[168:171], a[144:147], v[120:123]
 buffer_load_dwordx4 v12, s[48:51], s22 offen offset:0   lds
M v[116:119], a[168:171], a[136:139], v[116:119]
M v[116:119], a[172:175], a[140:143], v[116:119]
M v[112:115], a[172:175], a[132:135], v[112:115]
M v[112:115], a[168:171], a[128:131], v[112:115]
 buffer_load_dwordx4 v13, s[48:51], s22 offen offset:1024   lds
M v[108:111], a[168:171], a[120:123], v[108:111]
M v[108:111], a[172:175], a[124:127], v[108:111]
 ds_read_b64_tr_b16 a[68:69], v1 offset:24576
 ds_read_b64_tr_b16 a[70:71], v1 offset:25600
M v[104:107], a[172:175], a[116:119], v[104:107]
M v[104:107], a[168:171], a[112:115], v[104:107]
M v[100:103], a[168:171], a[104:107], v[100:103]
 buffer_load_dwordx4 v14, s[48:51], s22 offen offset:2048   lds
M v[100:103], a[172:175], a[108:111], v[100:103]
 s_waitcnt lgkmcnt(4)
M v[96:99], a[172:175], a[100:103], v[96:99]
M v[96:99], a[168:171], a[96:99], v[96:99]
M v[128:131], a[160:163], a[96:99], v[128:131]
 ds_read_b128 a[168:171], v5 offset:51200
 ds_read_b128 a[172:175], v6 offset:51200
M v[128:131], a[164:167], a[100:103], v[128:131]
 ds_read_b64_tr_b16 a[72:73], v2 offset:16384
 ds_read_b64_tr_b16 a[74:75], v2 offset:17408
M v[132:135], a[164:167], a[108:111], v[132:135]
 buffer_load_dwordx4 v15, s[48:51], s22 offen offset:3072   lds
M v[132:135], a[160:163], a[104:107], v[132:135]
 s_add_u32 s22, s22, 2097152
M v[136:139], a[160:163], a[112:115], v[136:139]
M v[136:139], a[164:167], a[116:119], v[136:139]
 s_add_u32 m0, s23, 0
M v[140:143], a[164:167], a[124:127], v[140:143]
 buffer_load_dwordx4 v8, s[16:19], s21 offen offset:0  nt lds
M v[140:143], a[160:163], a[120:123], v[140:143]
 ds_read_b64_tr_b16 a[76:77], v2 offset:24576
 ds_read_b64_tr_b16 a[78:79], v2 offset:25600
M v[144:147], a[160:163], a[128:131], v[144:147]
M v[144:147], a[164:167], a[132:135], v[144:147]
M v[148:151], a[164:167], a[140:143], v[148:151]
 buffer_load_dwordx4 v9, s[16:19], s21 offen offset:1024  nt lds
M v[148:151], a[160:163], a[136:139], v[148:151]
M v[152:155], a[160:163], a[144:147], v[152:155]
M v[152:155], a[164:167], a[148:151], v[152:155]
 s_waitcnt lgkmcnt(4)
M v[156:159], a[164:167], a[156:159], v[156:159]
 ds_read_b64_tr_b16 a[80:81], v3 offset:16384
 ds_read_b64_tr_b16 a[82:83], v3 offset:17408
M v[156:159], a[160:163], a[152:155], v[156:159]
 buffer_load_dwordx4 v10, s[16:19], s21 offen offset:2048  nt lds
M v[188:191], a[168:171], a[152:155], v[188:191]
 ds_read_b128 a[160:163], v5 offset:53248
 ds_read_b128 a[164:167], v6 offset:53248
M v[188:191], a[172:175], a[156:159], v[188:191]
M v[184:187], a[172:175], a[148:151], v[184:187]
M v[184:187], a[168:171], a[144:147], v[184:187]
M v[180:183], a[168:171], a[136:139], v[180:183]
 buffer_load_dwordx4 v11, s[16:19], s21 offen offset:3072  nt lds
M v[180:183], a[172:175], a[140:143], v[180:183]
 s_add_u32 s21, s21, 128
 ds_read_b64_tr_b16 a[84:85], v3 offset:24576
 ds_read_b64_tr_b16 a[86:87], v3 offset:25600
M v[176:179], a[172:175], a[132:135], v[176:179]
M v[176:179], a[168:171], a[128:131], v[176:179]
M v[172:175], a[168:171], a[120:123], v[172:175]
 s_add_u32 m0, s87, 0
M v[172:175], a[172:175], a[124:127], v[172:175]
 buffer_load_dwordx4 v28, s[68:71], s67 offen offset:0 nt lds
M v[168:171], a[172:175], a[116:119], v[168:171]
M v[168:171], a[168:171], a[112:115], v[168:171]
M v[164:167], a[168:171], a[104:107], v[164:167]
 ds_read_b64_tr_b16 a[88:89], v4 offset:16384
 ds_read_b64_tr_b16 a[90:91], v4 offset:17408
M v[164:167], a[172:175], a[108:111], v[164:167]
 s_waitcnt lgkmcnt(4)
M v[160:163], a[172:175], a[100:103], v[160:163]
 buffer_load_dwordx4 v29, s[68:71], s67 offen offset:1024 nt lds
M v[160:163], a[168:171], a[96:99], v[160:163]
M v[192:195], a[160:163], a[96:99], v[192:195]
 ds_read_b128 a[168:171], v5 offset:55296
 ds_read_b128 a[172:175], v6 offset:55296
M v[192:195], a[164:167], a[100:103], v[192:195]
M v[196:199], a[164:167], a[108:111], v[196:199]
 buffer_load_dwordx4 v30, s[68:71], s67 offen offset:2048 nt lds
M v[196:199], a[160:163], a[104:107], v[196:199]
 ds_read_b64_tr_b16 a[92:93], v4 offset:24576
 ds_read_b64_tr_b16 a[94:95], v4 offset:25600
M v[200:203], a[160:163], a[112:115], v[200:203]
M v[200:203], a[164:167], a[116:119], v[200:203]
M v[204:207], a[164:167], a[124:127], v[204:207]
M v[204:207], a[160:163], a[120:123], v[204:207]
 buffer_load_dwordx4 v31, s[68:71], s67 offen offset:3072 nt lds
M v[208:211], a[160:163], a[128:131], v[208:211]
 s_add_u32 s67, s67, 0
M v[208:211], a[164:167], a[132:135], v[208:211]
M v[212:215], a[164:167], a[140:143], v[212:215]
M v[212:215], a[160:163], a[136:139], v[212:215]
M v[216:219], a[160:163], a[144:147], v[216:219]
M v[216:219], a[164:167], a[148:151], v[216:219]
 s_waitcnt lgkmcnt(2)
M v[220:223], a[164:167], a[156:159], v[220:223]
 s_waitcnt vmcnt(20) lgkmcnt(0)
M v[220:223], a[160:163], a[152:155], v[220:223]
 s_barrier
M v[252:255], a[168:171], a[152:155], v[252:255]
 ds_read_b128 a[160:163], v5 offset:0
 ds_read_b128 a[164:167], v6 offset:0
M v[252:255], a[172:175], a[156:159], v[252:255]
M v[248:251], a[172:175], a[148:151], v[248:251]
M v[248:251], a[168:171], a[144:147], v[248:251]
M v[244:247], a[168:171], a[136:139], v[244:247]
M v[244:247], a[172:175], a[140:143], v[244:247]
M v[240:243], a[172:175], a[132:135], v[240:243]
M v[240:243], a[168:171], a[128:131], v[240:243]
M v[236:239], a[168:171], a[120:123], v[236:239]
M v[236:239], a[172:175], a[124:127], v[236:239]
M v[232:235], a[172:175], a[116:119], v[232:235]
M v[232:235], a[168:171], a[112:115], v[232:235]
M v[228:231], a[168:171], a[104:107], v[228:231]
M v[228:231], a[172:175], a[108:111], v[228:231]
 s_waitcnt lgkmcnt(0)
M v[224:227], a[172:175], a[100:103], v[224:227]
M v[224:227], a[168:171], a[96:99], v[224:227]
M a[0:3], a[160:163], a[32:35], a[0:3]
 ds_read_b128 a[168:171], v5 offset:2048
 ds_read_b128 a[172:175], v6 offset:2048
M a[0:3], a[164:167], a[36:39], a[0:3]
 ds_read_b64_tr_b16 a[96:97], v1 offset:32768
 ds_read_b64_tr_b16 a[98:99], v1 offset:33792
M a[4:7], a[164:167], a[44:47], a[4:7]
 s_add_u32 m0, s24, 49152
 v_cvt_pk_bf16_f32 v23, v23, v23
 v_accvgpr_read_b32 v27, a241
M a[4:7], a[160:163], a[40:43], a[4:7]
 buffer_load_dwordx4 v12, s[48:51], s22 offen offset:0   lds
M a[8:11], a[160:163], a[48:51], a[8:11]
 v_and_b32 v23, 0xffff0000, v23
M a[8:11], a[164:167], a[52:55], a[8:11]
 v_mul_f32 v22, 0xbfb8aa3b, v23
M a[12:15], a[164:167], a[60:63], a[12:15]
 ds_read_b64_tr_b16 a[100:101], v1 offset:40960
 ds_read_b64_tr_b16 a[102:103], v1 offset:41984
M a[12:15], a[160:163], a[56:59], a[12:15]
 v_exp_f32 v22, v22
M a[16:19], a[160:163], a[64:67], a[16:19]
 buffer_load_dwordx4 v13, s[48:51], s22 offen offset:1024   lds
M a[16:19], a[164:167], a[68:71], a[16:19]
 v_add_f32 v22, 1.0, v22
M a[20:23], a[164:167], a[76:79], a[20:23]
 v_rcp_f32 v23, v22
M a[20:23], a[160:163], a[72:75], a[20:23]
 s_or_b32 s64, s86, s20
 ds_read_b64_tr_b16 a[104:105], v2 offset:32768
 ds_read_b64_tr_b16 a[106:107], v2 offset:33792
M a[24:27], a[160:163], a[80:83], a[24:27]
 s_min_u32 s64, s64, 1
 s_lshl_b32 s64, s64, 29
 v_lshrrev_b32 v22, 1, v0
M a[24:27], a[164:167], a[84:87], a[24:27]
 s_waitcnt lgkmcnt(6)
 v_min_u32 v22, 1, v22
M a[28:31], a[164:167], a[92:95], a[28:31]
 buffer_load_dwordx4 v14, s[48:51], s22 offen offset:2048   lds
M a[28:31], a[160:163], a[88:91], a[28:31]
 v_lshlrev_b32 v22, 29, v22
M v[60:63], a[168:171], a[88:91], v[60:63]
 ds_read_b128 a[160:163], v5 offset:4096
 ds_read_b128 a[164:167], v6 offset:4096
M v[60:63], a[172:175], a[92:95], v[60:63]
 ds_read_b64_tr_b16 a[108:109], v2 offset:40960
 ds_read_b64_tr_b16 a[110:111], v2 offset:41984
M v[56:59], a[172:175], a[84:87], v[56:59]
 buffer_load_dwordx4 v15, s[48:51], s22 offen offset:3072   lds
M v[56:59], a[168:171], a[80:83], v[56:59]
 s_sub_u32 s22, s22, 2097024
 v_lshl_or_b32 v22, v0, 2, v22
M v[52:55], a[168:171], a[72:75], v[52:55]
 v_or_b32 v22, s64, v22
M v[52:55], a[172:175], a[76:79], v[52:55]
 ds_read_b64_tr_b16 a[112:113], v3 offset:32768
 ds_read_b64_tr_b16 a[114:115], v3 offset:33792
M v[48:51], a[172:175], a[68:71], v[48:51]
 s_add_u32 m0, s23, 16384
 v_cvt_pk_bf16_f32 v23, v23, v23
M v[48:51], a[168:171], a[64:67], v[48:51]
 buffer_load_dwordx4 v8, s[16:19], s21 offen offset:0  nt lds
M v[44:47], a[168:171], a[56:59], v[44:47]
 v_and_b32 v23, 0xffff0000, v23
M v[44:47], a[172:175], a[60:63], v[44:47]
 s_mov_b32 s64, 104890368
M v[40:43], a[172:175], a[52:55], v[40:43]
 ds_read_b64_tr_b16 a[116:117], v3 offset:40960
 ds_read_b64_tr_b16 a[118:119], v3 offset:41984
M v[40:43], a[168:171], a[48:51], v[40:43]
 buffer_store_dword v24, v22, s[8:11], s64 offen sc1
M v[36:39], a[168:171], a[40:43], v[36:39]
 buffer_load_dwordx4 v9, s[16:19], s21 offen offset:1024  nt lds
M v[36:39], a[172:175], a[44:47], v[36:39]
 s_waitcnt lgkmcnt(6)
M v[32:35], a[172:175], a[36:39], v[32:35]
 buffer_store_dword v23, v22, s[8:11], s64 offen offset:8 sc1
M v[32:35], a[168:171], a[32:35], v[32:35]
 ds_read_b64_tr_b16 a[120:121], v4 offset:32768
 ds_read_b64_tr_b16 a[122:123], v4 offset:33792
M v[64:67], a[160:163], a[32:35], v[64:67]
 ds_read_b128 a[168:171], v5 offset:6144
 ds_read_b128 a[172:175], v6 offset:6144
M v[64:67], a[164:167], a[36:39], v[64:67]
 buffer_load_dwordx4 v10, s[16:19], s21 offen offset:2048  nt lds
M v[68:71], a[164:167], a[44:47], v[68:71]
 v_add_u32 v25, 159744, v7
M v[68:71], a[160:163], a[40:43], v[68:71]
 ds_read_b128 v[16:19], v25
M v[72:75], a[160:163], a[48:51], v[72:75]
 ds_read_b64_tr_b16 a[124:125], v4 offset:40960
 ds_read_b64_tr_b16 a[126:127], v4 offset:41984
M v[72:75], a[164:167], a[52:55], v[72:75]
 ds_read_b128 v[28:31], v25 offset:1024
 v_sub_f32 v48, v48, v27
M v[76:79], a[164:167], a[60:63], v[76:79]
 buffer_load_dwordx4 v11, s[16:19], s21 offen offset:3072  nt lds
M v[76:79], a[160:163], a[56:59], v[76:79]
 s_add_u32 s21, s21, 524160
 ds_read_b128 v[20:23], v25 offset:2048
 v_sub_f32 v49, v49, v27
M v[80:83], a[160:163], a[64:67], v[80:83]
 v_sub_f32 v50, v50, v27
 v_sub_f32 v51, v51, v27
M v[80:83], a[164:167], a[68:71], v[80:83]
 v_sub_f32 v52, v52, v27
 v_sub_f32 v53, v53, v27
M v[84:87], a[164:167], a[76:79], v[84:87]
 v_sub_f32 v54, v54, v27
 v_sub_f32 v55, v55, v27
M v[84:87], a[160:163], a[72:75], v[84:87]
 v_sub_f32 v56, v56, v27
 v_sub_f32 v57, v57, v27
M v[88:91], a[160:163], a[80:83], v[88:91]
 v_sub_f32 v58, v58, v27
 v_sub_f32 v59, v59, v27
M v[88:91], a[164:167], a[84:87], v[88:91]
 s_waitcnt lgkmcnt(5)
 v_sub_f32 v60, v60, v27
 v_sub_f32 v61, v61, v27
M v[92:95], a[164:167], a[92:95], v[92:95]
 s_waitcnt vmcnt(22) lgkmcnt(0)
 v_sub_f32 v62, v62, v27
 v_sub_f32 v63, v63, v27
M v[92:95], a[160:163], a[88:91], v[92:95]
 s_barrier
M v[124:127], a[168:171], a[88:91], v[124:127]
 ds_read_b128 a[160:163], v5 offset:16384
 ds_read_b128 a[164:167], v6 offset:16384
M v[124:127], a[172:175], a[92:95], v[124:127]
 v_add_f32 v16, v28, v16
M v[120:123], a[172:175], a[84:87], v[120:123]
 s_add_u32 m0, s24, 0
 ds_read_b64_tr_b16 a[128:129], v1 offset:49152
 ds_read_b64_tr_b16 a[130:131], v1 offset:50176
M v[120:123], a[168:171], a[80:83], v[120:123]
 buffer_load_dwordx4 v12, s[48:51], s22 offen offset:0   lds
M v[116:119], a[168:171], a[72:75], v[116:119]
 v_add_f32 v17, v29, v17
 v_sub_f32 v80, v80, v27
M v[116:119], a[172:175], a[76:79], v[116:119]
 v_add_f32 v18, v30, v18
 v_sub_f32 v81, v81, v27
M v[112:115], a[172:175], a[68:71], v[112:115]
 v_add_f32 v19, v31, v19
 v_sub_f32 v82, v82, v27
M v[112:115], a[168:171], a[64:67], v[112:115]
 ds_read_b128 v[28:31], v25 offset:3072
 v_sub_f32 v83, v83, v27
M v[108:111], a[168:171], a[56:59], v[108:111]
 v_cvt_pk_bf16_f32 v25, v16, v17
 v_sub_f32 v84, v84, v27
M v[108:111], a[172:175], a[60:63], v[108:111]
 ds_read_b64_tr_b16 a[132:133], v1 offset:57344
 ds_read_b64_tr_b16 a[134:135], v1 offset:58368
M v[104:107], a[172:175], a[52:55], v[104:107]
 buffer_load_dwordx4 v13, s[48:51], s22 offen offset:1024   lds
M v[104:107], a[168:171], a[48:51], v[104:107]
 v_lshlrev_b32 v16, 16, v25
 v_sub_f32 v85, v85, v27
M v[100:103], a[168:171], a[40:43], v[100:103]
 v_and_b32 v17, 0xffff0000, v25
 v_sub_f32 v86, v86, v27
M v[100:103], a[172:175], a[44:47], v[100:103]
 s_waitcnt lgkmcnt(5)
 v_cvt_pk_bf16_f32 v25, v18, v19
 v_sub_f32 v87, v87, v27
M v[96:99], a[172:175], a[36:39], v[96:99]
 v_lshlrev_b32 v18, 16, v25
 v_sub_f32 v88, v88, v27
M v[96:99], a[168:171], a[32:35], v[96:99]
 v_and_b32 v19, 0xffff0000, v25
 v_sub_f32 v89, v89, v27
M v[128:131], a[160:163], a[32:35], v[128:131]
 ds_read_b128 a[168:171], v5 offset:18432
 ds_read_b128 a[172:175], v6 offset:18432
M v[128:131], a[164:167], a[36:39], v[128:131]
 ds_read_b64_tr_b16 a[136:137], v2 offset:49152
 ds_read_b64_tr_b16 a[138:139], v2 offset:50176
M v[132:135], a[164:167], a[44:47], v[132:135]
 buffer_load_dwordx4 v14, s[48:51], s22 offen offset:2048   lds
M v[132:135], a[160:163], a[40:43], v[132:135]
 s_waitcnt lgkmcnt(6)
 v_add_f32 v20, v28, v20
 v_sub_f32 v90, v90, v27
M v[136:139], a[160:163], a[48:51], v[136:139]
 v_add_f32 v21, v29, v21
 v_sub_f32 v91, v91, v27
M v[136:139], a[164:167], a[52:55], v[136:139]
 v_add_f32 v22, v30, v22
 v_sub_f32 v92, v92, v27
M v[140:143], a[164:167], a[60:63], v[140:143]
 v_add_f32 v23, v31, v23
 v_sub_f32 v93, v93, v27
M v[140:143], a[160:163], a[56:59], v[140:143]
 ds_read_b64_tr_b16 a[140:141], v2 offset:57344
 ds_read_b64_tr_b16 a[142:143], v2 offset:58368
M v[144:147], a[160:163], a[64:67], v[144:147]
 buffer_load_dwordx4 v15, s[48:51], s22 offen offset:3072   lds
M v[144:147], a[164:167], a[68:71], v[144:147]
 s_add_u32 s22, s22, 2097152
 v_mul_f32 v28, 0xbfb8aa3b, v16
 v_sub_f32 v94, v94, v27
M v[148:151], a[164:167], a[76:79], v[148:151]
 v_mul_f32 v29, 0xbfb8aa3b, v17
 v_sub_f32 v95, v95, v27
M v[148:151], a[160:163], a[72:75], v[148:151]
 v_mul_f32 v30, 0xbfb8aa3b, v18
 v_sub_f32 v112, v112, v27
M v[152:155], a[160:163], a[80:83], v[152:155]
 v_mul_f32 v31, 0xbfb8aa3b, v19
 v_sub_f32 v113, v113, v27
M v[152:155], a[164:167], a[84:87], v[152:155]
 s_waitcnt lgkmcnt(4)
 v_exp_f32 v28, v28
M v[156:159], a[164:167], a[92:95], v[156:159]
 s_add_u32 m0, s23, 32768
 ds_read_b64_tr_b16 a[144:145], v3 offset:49152
 ds_read_b64_tr_b16 a[146:147], v3 offset:50176
M v[156:159], a[160:163], a[88:91], v[156:159]
 buffer_load_dwordx4 v8, s[16:19], s21 offen offset:0  nt lds
M v[188:191], a[168:171], a[88:91], v[188:191]
 ds_read_b128 a[160:163], v5 offset:20480
 ds_read_b128 a[164:167], v6 offset:20480
M v[188:191], a[172:175], a[92:95], v[188:191]
 v_exp_f32 v29, v29
M v[184:187], a[172:175], a[84:87], v[184:187]
 v_exp_f32 v30, v30
M v[184:187], a[168:171], a[80:83], v[184:187]
 v_exp_f32 v31, v31
M v[180:183], a[168:171], a[72:75], v[180:183]
 v_cvt_pk_bf16_f32 v25, v20, v21
 v_sub_f32 v114, v114, v27
M v[180:183], a[172:175], a[76:79], v[180:183]
 ds_read_b64_tr_b16 a[148:149], v3 offset:57344
 ds_read_b64_tr_b16 a[150:151], v3 offset:58368
M v[176:179], a[172:175], a[68:71], v[176:179]
 buffer_load_dwordx4 v9, s[16:19], s21 offen offset:1024  nt lds
M v[176:179], a[168:171], a[64:67], v[176:179]
 v_lshlrev_b32 v20, 16, v25
 v_sub_f32 v115, v115, v27
M v[172:175], a[168:171], a[56:59], v[172:175]
 v_and_b32 v21, 0xffff0000, v25
 v_sub_f32 v116, v116, v27
M v[172:175], a[172:175], a[60:63], v[172:175]
 v_cvt_pk_bf16_f32 v25, v22, v23
 v_sub_f32 v117, v117, v27
M v[168:171], a[172:175], a[52:55], v[168:171]
 v_lshlrev_b32 v22, 16, v25
 v_sub_f32 v118, v118, v27
M v[168:171], a[168:171], a[48:51], v[168:171]
 v_and_b32 v23, 0xffff0000, v25
 v_sub_f32 v119, v119, v27
M v[164:167], a[168:171], a[40:43], v[164:167]
 ds_read_b64_tr_b16 a[152:153], v4 offset:49152
 ds_read_b64_tr_b16 a[154:155], v4 offset:50176
M v[164:167], a[172:175], a[44:47], v[164:167]
 s_waitcnt lgkmcnt(4)
 v_add_f32 v28, 1.0, v28
 v_sub_f32 v120, v120, v27
M v[160:163], a[172:175], a[36:39], v[160:163]
 buffer_load_dwordx4 v10, s[16:19], s21 offen offset:2048  nt lds
M v[160:163], a[168:171], a[32:35], v[160:163]
 v_add_f32 v29, 1.0, v29
 v_sub_f32 v121, v121, v27
M v[192:195], a[160:163], a[32:35], v[192:195]
 ds_read_b128 a[168:171], v5 offset:22528
 ds_read_b128 a[172:175], v6 offset:22528
M v[192:195], a[164:167], a[36:39], v[192:195]
 v_add_f32 v30, 1.0, v30
 v_sub_f32 v122, v122, v27
M v[196:199], a[164:167], a[44:47], v[196:199]
 v_add_f32 v31, 1.0, v31
 v_sub_f32 v123, v123, v27
M v[196:199], a[160:163], a[40:43], v[196:199]
 ds_read_b64_tr_b16 a[156:157], v4 offset:57344
 ds_read_b64_tr_b16 a[158:159], v4 offset:58368
M v[200:203], a[160:163], a[48:51], v[200:203]
 buffer_load_dwordx4 v11, s[16:19], s21 offen offset:3072  nt lds
M v[200:203], a[164:167], a[52:55], v[200:203]
 s_add_u32 s21, s21, 128
 v_rcp_f32 v28, v28
M v[204:207], a[164:167], a[60:63], v[204:207]
 v_rcp_f32 v29, v29
M v[204:207], a[160:163], a[56:59], v[204:207]
 v_rcp_f32 v30, v30
M v[208:211], a[160:163], a[64:67], v[208:211]
 v_rcp_f32 v31, v31
M v[208:211], a[164:167], a[68:71], v[208:211]
 v_mul_f32 v16, v28, v16
 v_sub_f32 v124, v124, v27
M v[212:215], a[164:167], a[76:79], v[212:215]
 v_mul_f32 v17, v29, v17
 v_sub_f32 v125, v125, v27
M v[212:215], a[160:163], a[72:75], v[212:215]
 v_mul_f32 v18, v30, v18
 v_sub_f32 v126, v126, v27
M v[216:219], a[160:163], a[80:83], v[216:219]
 v_mul_f32 v19, v31, v19
 v_sub_f32 v127, v127, v27
M v[216:219], a[164:167], a[84:87], v[216:219]
 s_waitcnt lgkmcnt(2)
 v_cvt_pk_bf16_f32 v25, v16, v17
 v_sub_f32 v128, v128, v27
M v[220:223], a[164:167], a[92:95], v[220:223]
 s_waitcnt vmcnt(22) lgkmcnt(0)
 v_lshlrev_b32 v16, 16, v25
 v_sub_f32 v129, v129, v27
M v[220:223], a[160:163], a[88:91], v[220:223]
 s_barrier
M v[252:255], a[168:171], a[88:91], v[252:255]
 ds_read_b128 a[160:163], v5 offset:32768
 ds_read_b128 a[164:167], v6 offset:32768
M v[252:255], a[172:175], a[92:95], v[252:255]
 v_and_b32 v17, 0xffff0000, v25
 v_sub_f32 v130, v130, v27
M v[248:251], a[172:175], a[84:87], v[248:251]
 v_cvt_pk_bf16_f32 v25, v18, v19
 v_sub_f32 v131, v131, v27
M v[248:251], a[168:171], a[80:83], v[248:251]
 v_lshlrev_b32 v18, 16, v25
 v_sub_f32 v132, v132, v27
M v[244:247], a[168:171], a[72:75], v[244:247]
 v_and_b32 v19, 0xffff0000, v25
 v_sub_f32 v133, v133, v27
M v[244:247], a[172:175], a[76:79], v[244:247]
 v_mul_f32 v16, v20, v16
 v_sub_f32 v134, v134, v27
M v[240:243], a[172:175], a[68:71], v[240:243]
 v_mul_f32 v17, v21, v17
 v_sub_f32 v135, v135, v27
M v[240:243], a[168:171], a[64:67], v[240:243]
 v_mul_f32 v18, v22, v18
 v_sub_f32 v136, v136, v27
M v[236:239], a[168:171], a[56:59], v[236:239]
 v_mul_f32 v19, v23, v19
 v_sub_f32 v137, v137, v27
M v[236:239], a[172:175], a[60:63], v[236:239]
 v_cvt_pk_bf16_f32 v16, v16, v17
 v_sub_f32 v138, v138, v27
M v[232:235], a[172:175], a[52:55], v[232:235]
 v_cvt_pk_bf16_f32 v17, v18, v19
 v_sub_f32 v139, v139, v27
M v[232:235], a[168:171], a[48:51], v[232:235]
 v_sub_f32 v140, v140, v27
 v_sub_f32 v141, v141, v27
M v[228:231], a[168:171], a[40:43], v[228:231]
 v_sub_f32 v142, v142, v27
 v_sub_f32 v143, v143, v27
M v[228:231], a[172:175], a[44:47], v[228:231]
 s_waitcnt lgkmcnt(0)
 v_sub_f32 v144, v144, v27
 v_sub_f32 v145, v145, v27
M v[224:227], a[172:175], a[36:39], v[224:227]
 v_sub_f32 v146, v146, v27
 v_sub_f32 v147, v147, v27
M v[224:227], a[168:171], a[32:35], v[224:227]
 v_sub_f32 v148, v148, v27
 v_sub_f32 v149, v149, v27
M a[0:3], a[160:163], a[96:99], a[0:3]
 ds_read_b128 a[168:171], v5 offset:34816
 ds_read_b128 a[172:175], v6 offset:34816
M a[0:3], a[164:167], a[100:103], a[0:3]
 ds_read_b64_tr_b16 a[32:33], v1 offset:0
 ds_read_b64_tr_b16 a[34:35], v1 offset:1024
M a[4:7], a[164:167], a[108:111], a[4:7]
 s_add_u32 m0, s24, 16384
 v_lshrrev_b32 v28, 2, v0
 v_lshlrev_b32 v28, 8, v28
M a[4:7], a[160:163], a[104:107], a[4:7]
 buffer_load_dwordx4 v12, s[48:51], s22 offen offset:0   lds
M a[8:11], a[160:163], a[112:115], a[8:11]
 v_and_b32 v29, 3, v0
 v_lshl_add_u32 v28, v29, 3, v28
M a[8:11], a[164:167], a[116:119], a[8:11]
 v_add_u32 v28, s87, v28
 v_sub_f32 v150, v150, v27
M a[12:15], a[164:167], a[124:127], a[12:15]
 s_waitcnt vmcnt(19)
 ds_read_b64_tr_b16 a[36:37], v1 offset:8192
 ds_read_b64_tr_b16 a[38:39], v1 offset:9216
M a[12:15], a[160:163], a[120:123], a[12:15]
 ds_read_b64_tr_b16 a[176:177], v28 offset:0
 v_sub_f32 v151, v151, v27
M a[16:19], a[160:163], a[128:131], a[16:19]
 buffer_load_dwordx4 v13, s[48:51], s22 offen offset:1024   lds
M a[16:19], a[164:167], a[132:135], a[16:19]
 ds_read_b64_tr_b16 a[178:179], v28 offset:32
 ds_read_b64_tr_b16 a[180:181], v28 offset:64
M a[20:23], a[164:167], a[140:143], a[20:23]
 ds_read_b64_tr_b16 a[182:183], v28 offset:96
 v_sub_f32 v152, v152, v27
M a[20:23], a[160:163], a[136:139], a[20:23]
 ds_read_b64_tr_b16 a[40:41], v2 offset:0
 ds_read_b64_tr_b16 a[42:43], v2 offset:1024
M a[24:27], a[160:163], a[144:147], a[24:27]
 ds_read_b64_tr_b16 a[184:185], v28 offset:128
 v_sub_f32 v153, v153, v27
M a[24:27], a[164:167], a[148:151], a[24:27]
 s_waitcnt lgkmcnt(11)
 ds_read_b64_tr_b16 a[186:187], v28 offset:160
 ds_read_b64_tr_b16 a[188:189], v28 offset:192
M a[28:31], a[164:167], a[156:159], a[28:31]
 buffer_load_dwordx4 v14, s[48:51], s22 offen offset:2048   lds
M a[28:31], a[160:163], a[152:155], a[28:31]
 v_sub_f32 v154, v154, v27
 v_sub_f32 v155, v155, v27
M v[60:63], a[168:171], a[152:155], v[60:63]
 ds_read_b128 a[160:163], v5 offset:36864
 ds_read_b128 a[164:167], v6 offset:36864
M v[60:63], a[172:175], a[156:159], v[60:63]
 ds_read_b64_tr_b16 a[44:45], v2 offset:8192
 ds_read_b64_tr_b16 a[46:47], v2 offset:9216
M v[56:59], a[172:175], a[148:151], v[56:59]
 buffer_load_dwordx4 v15, s[48:51], s22 offen offset:3072   lds
M v[56:59], a[168:171], a[144:147], v[56:59]
 s_sub_u32 s22, s22, 2097024
 v_sub_f32 v156, v156, v27
 v_sub_f32 v157, v157, v27
M v[52:55], a[168:171], a[136:139], v[52:55]
 v_sub_f32 v158, v158, v27
 v_sub_f32 v159, v159, v27
M v[52:55], a[172:175], a[140:143], v[52:55]
 ds_read_b64_tr_b16 a[48:49], v3 offset:0
 ds_read_b64_tr_b16 a[50:51], v3 offset:1024
M v[48:51], a[172:175], a[132:135], v[48:51]
 s_add_u32 m0, s23, 49152
M v[48:51], a[168:171], a[128:131], v[48:51]
 buffer_load_dwordx4 v8, s[16:19], s21 offen offset:0  nt lds
M v[44:47], a[168:171], a[120:123], v[44:47]
M v[44:47], a[172:175], a[124:127], v[44:47]
M v[40:43], a[172:175], a[116:119], v[40:43]
 ds_read_b64_tr_b16 a[52:53], v3 offset:8192
 ds_read_b64_tr_b16 a[54:55], v3 offset:9216
M v[40:43], a[168:171], a[112:115], v[40:43]
M v[36:39], a[168:171], a[104:107], v[36:39]
 buffer_load_dwordx4 v9, s[16:19], s21 offen offset:1024  nt lds
M v[36:39], a[172:175], a[108:111], v[36:39]
 s_waitcnt lgkmcnt(6)
M v[32:35], a[172:175], a[100:103], v[32:35]
M v[32:35], a[168:171], a[96:99], v[32:35]
 ds_read_b64_tr_b16 a[56:57], v4 offset:0
 ds_read_b64_tr_b16 a[58:59], v4 offset:1024
M v[64:67], a[160:163], a[96:99], v[64:67]
 ds_read_b128 a[168:171], v5 offset:38912
 ds_read_b128 a[172:175], v6 offset:38912
M v[64:67], a[164:167], a[100:103], v[64:67]
 buffer_load_dwordx4 v10, s[16:19], s21 offen offset:2048  nt lds
M v[68:71], a[164:167], a[108:111], v[68:71]
M v[68:71], a[160:163], a[104:107], v[68:71]
M v[72:75], a[160:163], a[112:115], v[72:75]
 ds_read_b64_tr_b16 a[60:61], v4 offset:8192
 ds_read_b64_tr_b16 a[62:63], v4 offset:9216
M v[72:75], a[164:167], a[116:119], v[72:75]
M v[76:79], a[164:167], a[124:127], v[76:79]
 buffer_load_dwordx4 v11, s[16:19], s21 offen offset:3072  nt lds
M v[76:79], a[160:163], a[120:123], v[76:79]
 s_add_u32 s21, s21, 524160
M v[80:83], a[160:163], a[128:131], v[80:83]
M v[80:83], a[164:167], a[132:135], v[80:83]
M v[84:87], a[164:167], a[140:143], v[84:87]
M v[84:87], a[160:163], a[136:139], v[84:87]
M v[88:91], a[160:163], a[144:147], v[88:91]
M v[88:91], a[164:167], a[148:151], v[88:91]
 s_waitcnt lgkmcnt(2)
M v[92:95], a[164:167], a[156:159], v[92:95]
 s_waitcnt vmcnt(16) lgkmcnt(0)
M v[92:95], a[160:163], a[152:155], v[92:95]
 s_barrier
 v_mfma_f32_16x16x16_bf16 a[208:211], a[176:177], v[16:17], 0
 v_mfma_f32_16x16x16_bf16 a[212:215], a[178:179], v[16:17], 0
 v_mfma_f32_16x16x16_bf16 a[216:219], a[180:181], v[16:17], 0
 v_mfma_f32_16x16x16_bf16 a[220:223], a[182:183], v[16:17], 0
 v_mfma_f32_16x16x16_bf16 a[224:227], a[184:185], v[16:17], 0
 v_mfma_f32_16x16x16_bf16 a[228:231], a[186:187], v[16:17], 0
 v_mfma_f32_16x16x16_bf16 a[232:235], a[188:189], v[16:17], 0
M v[124:127], a[168:171], a[152:155], v[124:127]
 ds_read_b128 a[160:163], v5 offset:49152
 ds_read_b128 a[164:167], v6 offset:49152
M v[124:127], a[172:175], a[156:159], v[124:127]
M v[120:123], a[172:175], a[148:151], v[120:123]
 s_add_u32 m0, s24, 32768
 ds_read_b64_tr_b16 a[64:65], v1 offset:16384
 ds_read_b64_tr_b16 a[66:67], v1 offset:17408
M v[120:123], a[168:171], a[144:147], v[120:123]
 buffer_load_dwordx4 v12, s[48:51], s22 offen offset:0   lds
M v[116:119], a[168:171], a[136:139], v[116:119]
M v[116:119], a[172:175], a[140:143], v[116:119]
M v[112:115], a[172:175], a[132:135], v[112:115]
M v[112:115], a[168:171], a[128:131], v[112:115]
M v[108:111], a[168:171], a[120:123], v[108:111]
M v[108:111], a[172:175], a[124:127], v[108:111]
 ds_read_b64_tr_b16 a[68:69], v1 offset:24576
 ds_read_b64_tr_b16 a[70:71], v1 offset:25600
M v[104:107], a[172:175], a[116:119], v[104:107]
 buffer_load_dwordx4 v13, s[48:51], s22 offen offset:1024   lds
M v[104:107], a[168:171], a[112:115], v[104:107]
M v[100:103], a[168:171], a[104:107], v[100:103]
M v[100:103], a[172:175], a[108:111], v[100:103]
 s_waitcnt lgkmcnt(4)
M v[96:99], a[172:175], a[100:103], v[96:99]
M v[96:99], a[168:171], a[96:99], v[96:99]
M v[128:131], a[160:163], a[96:99], v[128:131]
 ds_read_b128 a[168:171], v5 offset:51200
 ds_read_b128 a[172:175], v6 offset:51200
M v[128:131], a[164:167], a[100:103], v[128:131]
 ds_read_b64_tr_b16 a[72:73], v2 offset:16384
 ds_read_b64_tr_b16 a[74:75], v2 offset:17408
M v[132:135], a[164:167], a[108:111], v[132:135]
 buffer_load_dwordx4 v14, s[48:51], s22 offen offset:2048   lds
M v[132:135], a[160:163], a[104:107], v[132:135]
M v[136:139], a[160:163], a[112:115], v[136:139]
M v[136:139], a[164:167], a[116:119], v[136:139]
M v[140:143], a[164:167], a[124:127], v[140:143]
M v[140:143], a[160:163], a[120:123], v[140:143]
 ds_read_b64_tr_b16 a[76:77], v2 offset:24576
 ds_read_b64_tr_b16 a[78:79], v2 offset:25600
M v[144:147], a[160:163], a[128:131], v[144:147]
 buffer_load_dwordx4 v15, s[48:51], s22 offen offset:3072   lds
M v[144:147], a[164:167], a[132:135], v[144:147]
 s_add_u32 s22, s22, 2097152
M v[148:151], a[164:167], a[140:143], v[148:151]
M v[148:151], a[160:163], a[136:139], v[148:151]
M v[152:155], a[160:163], a[144:147], v[152:155]
M v[152:155], a[164:167], a[148:151], v[152:155]
 s_waitcnt lgkmcnt(4)
M v[156:159], a[164:167], a[156:159], v[156:159]
 s_add_u32 m0, s23, 0
 ds_read_b64_tr_b16 a[80:81], v3 offset:16384
 ds_read_b64_tr_b16 a[82:83], v3 offset:17408
M v[156:159], a[160:163], a[152:155], v[156:159]
 buffer_load_dwordx4 v8, s[52:55], s28 offen offset:0   lds
M v[188:191], a[168:171], a[152:155], v[188:191]
 ds_read_b128 a[160:163], v5 offset:53248
 ds_read_b128 a[164:167], v6 offset:53248
M v[188:191], a[172:175], a[156:159], v[188:191]
M v[184:187], a[172:175], a[148:151], v[184:187]
M v[184:187], a[168:171], a[144:147], v[184:187]
M v[180:183], a[168:171], a[136:139], v[180:183]
M v[180:183], a[172:175], a[140:143], v[180:183]
 ds_read_b64_tr_b16 a[84:85], v3 offset:24576
 ds_read_b64_tr_b16 a[86:87], v3 offset:25600
M v[176:179], a[172:175], a[132:135], v[176:179]
 buffer_load_dwordx4 v9, s[52:55], s28 offen offset:1024   lds
M v[176:179], a[168:171], a[128:131], v[176:179]
M v[172:175], a[168:171], a[120:123], v[172:175]
M v[172:175], a[172:175], a[124:127], v[172:175]
M v[168:171], a[172:175], a[116:119], v[168:171]
M v[168:171], a[168:171], a[112:115], v[168:171]
M v[164:167], a[168:171], a[104:107], v[164:167]
 ds_read_b64_tr_b16 a[88:89], v4 offset:16384
 ds_read_b64_tr_b16 a[90:91], v4 offset:17408
M v[164:167], a[172:175], a[108:111], v[164:167]
 s_waitcnt lgkmcnt(4)
M v[160:163], a[172:175], a[100:103], v[160:163]
 buffer_load_dwordx4 v10, s[52:55], s28 offen offset:2048   lds
M v[160:163], a[168:171], a[96:99], v[160:163]
M v[192:195], a[160:163], a[96:99], v[192:195]
 ds_read_b128 a[168:171], v5 offset:55296
 ds_read_b128 a[172:175], v6 offset:55296
M v[192:195], a[164:167], a[100:103], v[192:195]
M v[196:199], a[164:167], a[108:111], v[196:199]
M v[196:199], a[160:163], a[104:107], v[196:199]
 ds_read_b64_tr_b16 a[92:93], v4 offset:24576
 ds_read_b64_tr_b16 a[94:95], v4 offset:25600
M v[200:203], a[160:163], a[112:115], v[200:203]
 buffer_load_dwordx4 v11, s[52:55], s28 offen offset:3072   lds
M v[200:203], a[164:167], a[116:119], v[200:203]
 s_add_u32 s28, s28, 128
 v_sub_f32 v160, v160, v27
 v_sub_f32 v161, v161, v27
M v[204:207], a[164:167], a[124:127], v[204:207]
 v_sub_f32 v162, v162, v27
 v_sub_f32 v163, v163, v27
M v[204:207], a[160:163], a[120:123], v[204:207]
 v_sub_f32 v164, v164, v27
 v_sub_f32 v165, v165, v27
M v[208:211], a[160:163], a[128:131], v[208:211]
 v_sub_f32 v166, v166, v27
 v_sub_f32 v167, v167, v27
M v[208:211], a[164:167], a[132:135], v[208:211]
 v_sub_f32 v168, v168, v27
 v_sub_f32 v169, v169, v27
M v[212:215], a[164:167], a[140:143], v[212:215]
 v_sub_f32 v170, v170, v27
 v_sub_f32 v171, v171, v27
M v[212:215], a[160:163], a[136:139], v[212:215]
 v_sub_f32 v172, v172, v27
 v_sub_f32 v173, v173, v27
M v[216:219], a[160:163], a[144:147], v[216:219]
 v_sub_f32 v174, v174, v27
 v_sub_f32 v175, v175, v27
M v[216:219], a[164:167], a[148:151], v[216:219]
 s_waitcnt lgkmcnt(2)
 v_sub_f32 v176, v176, v27
 v_sub_f32 v177, v177, v27
M v[220:223], a[164:167], a[156:159], v[220:223]
 s_waitcnt vmcnt(16) lgkmcnt(0)
 v_sub_f32 v178, v178, v27
 v_sub_f32 v179, v179, v27
M v[220:223], a[160:163], a[152:155], v[220:223]
 s_barrier
M v[252:255], a[168:171], a[152:155], v[252:255]
 ds_read_b128 a[160:163], v5 offset:0
 ds_read_b128 a[164:167], v6 offset:0
M v[252:255], a[172:175], a[156:159], v[252:255]
 v_and_b32 v26, 48, v0
 v_lshlrev_b32 v26, 17, v26
M v[248:251], a[172:175], a[148:151], v[248:251]
 v_or_b32 v26, v26, v0
 v_lshl_add_u32 v26, v26, 7, s95
M v[248:251], a[168:171], a[144:147], v[248:251]
 buffer_load_dword a240, v26, s[76:79], 0 offen offset:0
M v[244:247], a[168:171], a[136:139], v[244:247]
 v_sub_f32 v180, v180, v27
 v_sub_f32 v181, v181, v27
M v[244:247], a[172:175], a[140:143], v[244:247]
 v_sub_f32 v182, v182, v27
 v_sub_f32 v183, v183, v27
M v[240:243], a[172:175], a[132:135], v[240:243]
 v_sub_f32 v184, v184, v27
 v_sub_f32 v185, v185, v27
M v[240:243], a[168:171], a[128:131], v[240:243]
 v_sub_f32 v186, v186, v27
 v_sub_f32 v187, v187, v27
M v[236:239], a[168:171], a[120:123], v[236:239]
 v_sub_f32 v188, v188, v27
 v_sub_f32 v189, v189, v27
M v[236:239], a[172:175], a[124:127], v[236:239]
 v_sub_f32 v190, v190, v27
 v_sub_f32 v191, v191, v27
M v[232:235], a[172:175], a[116:119], v[232:235]
 v_sub_f32 v192, v192, v27
 v_sub_f32 v193, v193, v27
M v[232:235], a[168:171], a[112:115], v[232:235]
 v_sub_f32 v194, v194, v27
 v_sub_f32 v195, v195, v27
M v[228:231], a[168:171], a[104:107], v[228:231]
 v_sub_f32 v196, v196, v27
 v_sub_f32 v197, v197, v27
M v[228:231], a[172:175], a[108:111], v[228:231]
 s_waitcnt lgkmcnt(0)
 v_sub_f32 v198, v198, v27
 v_sub_f32 v199, v199, v27
M v[224:227], a[172:175], a[100:103], v[224:227]
 v_sub_f32 v200, v200, v27
 v_sub_f32 v201, v201, v27
M v[224:227], a[168:171], a[96:99], v[224:227]
 v_sub_f32 v202, v202, v27
 v_sub_f32 v203, v203, v27
M a[0:3], a[160:163], a[32:35], a[0:3]
 ds_read_b128 a[168:171], v5 offset:2048
 ds_read_b128 a[172:175], v6 offset:2048
M a[0:3], a[164:167], a[36:39], a[0:3]
 ds_read_b64_tr_b16 a[96:97], v1 offset:32768
 ds_read_b64_tr_b16 a[98:99], v1 offset:33792
M a[4:7], a[164:167], a[44:47], a[4:7]
 s_add_u32 m0, s24, 49152
 v_lshrrev_b32 v28, 4, v0
 v_add_u32 v28, 0, v28
M a[4:7], a[160:163], a[40:43], a[4:7]
 buffer_load_dwordx4 v12, s[48:51], s22 offen offset:0   lds
M a[8:11], a[160:163], a[48:51], a[8:11]
 v_and_b32 v29, 7, v0
 v_xor_b32 v28, v28, v29
M a[8:11], a[164:167], a[52:55], a[8:11]
 v_lshlrev_b32 v28, 4, v28
 v_lshrrev_b32 v29, 3, v0
M a[12:15], a[164:167], a[60:63], a[12:15]
 ds_read_b64_tr_b16 a[100:101], v1 offset:40960
 ds_read_b64_tr_b16 a[102:103], v1 offset:41984
M a[12:15], a[160:163], a[56:59], a[12:15]
 buffer_load_dwordx4 v13, s[48:51], s22 offen offset:1024   lds
M a[16:19], a[160:163], a[64:67], a[16:19]
 v_mul_u32_u24 v29, 896, v29
 s_mul_i32 s64, s20, 28672
M a[16:19], a[164:167], a[68:71], a[16:19]
 buffer_load_dwordx4 v14, s[48:51], s22 offen offset:2048   lds
M a[20:23], a[164:167], a[76:79], a[20:23]
 s_add_u32 s64, s64, 0
 v_add3_u32 v16, v29, v28, s64
M a[20:23], a[160:163], a[72:75], a[20:23]
 ds_read_b64_tr_b16 a[104:105], v2 offset:32768
 ds_read_b64_tr_b16 a[106:107], v2 offset:33792
M a[24:27], a[160:163], a[80:83], a[24:27]
 v_add_u32 v18, 12288, v16
 v_lshrrev_b32 v28, 4, v0
M a[24:27], a[164:167], a[84:87], a[24:27]
 s_waitcnt lgkmcnt(6)
 v_add_u32 v28, 4, v28
 v_and_b32 v29, 7, v0
M a[28:31], a[164:167], a[92:95], a[28:31]
 buffer_load_dwordx4 v15, s[48:51], s22 offen offset:3072   lds
M a[28:31], a[160:163], a[88:91], a[28:31]
 s_sub_u32 s22, s22, 2097024
 v_xor_b32 v28, v28, v29
 v_lshlrev_b32 v28, 4, v28
M v[60:63], a[168:171], a[88:91], v[60:63]
 s_add_u32 m0, s23, 16384
 ds_read_b128 a[160:163], v5 offset:4096
 ds_read_b128 a[164:167], v6 offset:4096
M v[60:63], a[172:175], a[92:95], v[60:63]
 ds_read_b64_tr_b16 a[108:109], v2 offset:40960
 ds_read_b64_tr_b16 a[110:111], v2 offset:41984
M v[56:59], a[172:175], a[84:87], v[56:59]
 buffer_load_dwordx4 v8, s[52:55], s28 offen offset:0   lds
M v[56:59], a[168:171], a[80:83], v[56:59]
 v_lshrrev_b32 v29, 3, v0
 v_mul_u32_u24 v29, 896, v29
M v[52:55], a[168:171], a[72:75], v[52:55]
 buffer_load_dwordx4 v9, s[52:55], s28 offen offset:1024   lds
M v[52:55], a[172:175], a[76:79], v[52:55]
 ds_read_b64_tr_b16 a[112:113], v3 offset:32768
 ds_read_b64_tr_b16 a[114:115], v3 offset:33792
M v[48:51], a[172:175], a[68:71], v[48:51]
 s_mul_i32 s64, s20, 28672
 s_add_u32 s64, s64, 6144
M v[48:51], a[168:171], a[64:67], v[48:51]
 buffer_load_dwordx4 v10, s[52:55], s28 offen offset:2048   lds
M v[44:47], a[168:171], a[56:59], v[44:47]
 v_add3_u32 v17, v29, v28, s64
 v_add_u32 v19, 12288, v17
M v[44:47], a[172:175], a[60:63], v[44:47]
 v_add_u32 v20, 0x20000, v1
 v_add_u32 v21, 0x20000, v2
M v[40:43], a[172:175], a[52:55], v[40:43]
 ds_read_b64_tr_b16 a[116:117], v3 offset:40960
 ds_read_b64_tr_b16 a[118:119], v3 offset:41984
M v[40:43], a[168:171], a[48:51], v[40:43]
 buffer_load_dwordx4 v11, s[52:55], s28 offen offset:3072   lds
M v[36:39], a[168:171], a[40:43], v[36:39]
 s_add_u32 s28, s28, 1048448
 v_add_u32 v22, 0x20000, v3
 v_add_u32 v23, 0x20000, v4
M v[36:39], a[172:175], a[44:47], v[36:39]
 s_waitcnt lgkmcnt(6)
 v_sub_f32 v204, v204, v27
 v_sub_f32 v205, v205, v27
M v[32:35], a[172:175], a[36:39], v[32:35]
 s_add_u32 m0, s23, 131072
 v_sub_f32 v206, v206, v27
 v_sub_f32 v207, v207, v27
M v[32:35], a[168:171], a[32:35], v[32:35]
 ds_read_b64_tr_b16 a[120:121], v4 offset:32768
 ds_read_b64_tr_b16 a[122:123], v4 offset:33792
M v[64:67], a[160:163], a[32:35], v[64:67]
 ds_read_b128 a[168:171], v5 offset:6144
 ds_read_b128 a[172:175], v6 offset:6144
M v[64:67], a[164:167], a[36:39], v[64:67]
 buffer_load_dwordx4 v8, s[52:55], s28 offen offset:0   lds
M v[68:71], a[164:167], a[44:47], v[68:71]
 buffer_load_dwordx4 v9, s[52:55], s28 offen offset:1024   lds
M v[68:71], a[160:163], a[40:43], v[68:71]
 v_sub_f32 v208, v208, v27
 v_sub_f32 v209, v209, v27
M v[72:75], a[160:163], a[48:51], v[72:75]
 ds_read_b64_tr_b16 a[124:125], v4 offset:40960
 ds_read_b64_tr_b16 a[126:127], v4 offset:41984
M v[72:75], a[164:167], a[52:55], v[72:75]
 buffer_load_dwordx4 v10, s[52:55], s28 offen offset:2048   lds
M v[76:79], a[164:167], a[60:63], v[76:79]
 v_sub_f32 v210, v210, v27
 v_sub_f32 v211, v211, v27
M v[76:79], a[160:163], a[56:59], v[76:79]
 v_sub_f32 v212, v212, v27
 v_sub_f32 v213, v213, v27
M v[80:83], a[160:163], a[64:67], v[80:83]
 buffer_load_dwordx4 v11, s[52:55], s28 offen offset:3072   lds
M v[80:83], a[164:167], a[68:71], v[80:83]
 s_sub_u32 s28, s28, 524288
 v_sub_f32 v214, v214, v27
 v_sub_f32 v215, v215, v27
M v[84:87], a[164:167], a[76:79], v[84:87]
 v_sub_f32 v216, v216, v27
 v_sub_f32 v217, v217, v27
M v[84:87], a[160:163], a[72:75], v[84:87]
 v_sub_f32 v218, v218, v27
 v_sub_f32 v219, v219, v27
M v[88:91], a[160:163], a[80:83], v[88:91]
 v_sub_f32 v220, v220, v27
 v_sub_f32 v221, v221, v27
M v[88:91], a[164:167], a[84:87], v[88:91]
 s_waitcnt lgkmcnt(2)
 v_sub_f32 v222, v222, v27
 v_sub_f32 v223, v223, v27
M v[92:95], a[164:167], a[92:95], v[92:95]
 s_waitcnt vmcnt(21) lgkmcnt(0)
 v_sub_f32 v224, v224, v27
 v_sub_f32 v225, v225, v27
M v[92:95], a[160:163], a[88:91], v[92:95]
 s_barrier
M v[124:127], a[168:171], a[88:91], v[124:127]
 ds_read_b128 a[160:163], v5 offset:16384
 ds_read_b128 a[164:167], v6 offset:16384
M v[124:127], a[172:175], a[92:95], v[124:127]
 v_sub_f32 v226, v226, v27
 v_sub_f32 v227, v227, v27
M v[120:123], a[172:175], a[84:87], v[120:123]
 s_add_u32 m0, s24, 0
 ds_read_b64_tr_b16 a[128:129], v1 offset:49152
 ds_read_b64_tr_b16 a[130:131], v1 offset:50176
M v[120:123], a[168:171], a[80:83], v[120:123]
 buffer_load_dwordx4 v16, s[56:59], s29 offen offset:0   lds
M v[116:119], a[168:171], a[72:75], v[116:119]
 s_mul_i32 s72, s41, 4352
 v_sub_f32 v228, v228, v27
M v[116:119], a[172:175], a[76:79], v[116:119]
 s_add_u32 s46, s72, 104923136
 v_sub_f32 v229, v229, v27
 v_sub_f32 v230, v230, v27
M v[112:115], a[172:175], a[68:71], v[112:115]
 s_lshl_b32 s45, s42, 7
 s_add_u32 s45, s45, s46
 s_sub_u32 s66, 15, s42
M v[112:115], a[168:171], a[64:67], v[112:115]
 buffer_load_dwordx4 v17, s[56:59], s29 offen offset:1024   lds
M v[108:111], a[168:171], a[56:59], v[108:111]
 s_min_u32 s66, s66, s42
 v_sub_f32 v231, v231, v27
M v[108:111], a[172:175], a[60:63], v[108:111]
 s_lshl_b32 s47, s66, 7
 ds_read_b64_tr_b16 a[132:133], v1 offset:57344
 ds_read_b64_tr_b16 a[134:135], v1 offset:58368
M v[104:107], a[172:175], a[52:55], v[104:107]
 s_add_u32 s47, s47, s46
 v_sub_f32 v232, v232, v27
 v_sub_f32 v233, v233, v27
M v[104:107], a[168:171], a[48:51], v[104:107]
 s_add_u32 s47, s47, 2112
 s_lshl2_add_u32 s47, s20, s47
 s_lshl_b32 s65, s41, 3
M v[100:103], a[168:171], a[40:43], v[100:103]
 buffer_load_dwordx4 v18, s[56:59], s29 offen offset:2048   lds
M v[100:103], a[172:175], a[44:47], v[100:103]
 s_waitcnt lgkmcnt(4)
 s_add_u32 s65, s65, s66
 v_sub_f32 v234, v234, v27
M v[96:99], a[172:175], a[36:39], v[96:99]
 s_mul_i32 s34, s65, 73728
 v_sub_f32 v235, v235, v27
 v_sub_f32 v236, v236, v27
M v[96:99], a[168:171], a[32:35], v[96:99]
 s_add_u32 s34, s34, 50331648
 v_sub_f32 v237, v237, v27
 v_sub_f32 v238, v238, v27
M v[128:131], a[160:163], a[32:35], v[128:131]
 s_lshl_b32 s65, s42, 4
 ds_read_b128 a[168:171], v5 offset:18432
 ds_read_b128 a[172:175], v6 offset:18432
M v[128:131], a[164:167], a[36:39], v[128:131]
 s_add_u32 s65, s65, s41
 ds_read_b64_tr_b16 a[136:137], v2 offset:49152
 ds_read_b64_tr_b16 a[138:139], v2 offset:50176
M v[132:135], a[164:167], a[44:47], v[132:135]
 buffer_load_dwordx4 v19, s[56:59], s29 offen offset:3072   lds
M v[132:135], a[160:163], a[40:43], v[132:135]
 s_add_u32 s29, s29, 128
 s_mul_i32 s33, s65, 114688
 v_sub_f32 v239, v239, v27
M v[136:139], a[160:163], a[48:51], v[136:139]
 s_mul_i32 s65, s20, 28672
 s_add_u32 s33, s33, s65
 s_add_u32 s33, s33, 67108864
M v[136:139], a[164:167], a[52:55], v[136:139]
 s_add_u32 m0, s23, 32768
 s_sub_u32 s65, 15, s66
 s_lshl_b32 s65, s65, 16
M v[140:143], a[164:167], a[60:63], v[140:143]
 buffer_load_dwordx4 v8, s[52:55], s28 offen offset:0   lds
M v[140:143], a[160:163], a[56:59], v[140:143]
 ds_read_b64_tr_b16 a[140:141], v2 offset:57344
 ds_read_b64_tr_b16 a[142:143], v2 offset:58368
M v[144:147], a[160:163], a[64:67], v[144:147]
 s_lshl_b32 s64, s41, 20
 v_sub_f32 v240, v240, v27
M v[144:147], a[164:167], a[68:71], v[144:147]
 s_add_u32 s32, s64, s65
 s_lshl_b32 s65, s20, 14
 s_add_u32 s32, s32, s65
M v[148:151], a[164:167], a[76:79], v[148:151]
 buffer_load_dwordx4 v9, s[52:55], s28 offen offset:1024   lds
M v[148:151], a[160:163], a[72:75], v[148:151]
 s_add_u32 s32, s32, 33554432
 v_sub_f32 v241, v241, v27
M v[152:155], a[160:163], a[80:83], v[152:155]
 s_mov_b32 s31, 0x53800000
 s_mov_b32 s40, 1
 s_sub_u32 s64, s42, 10
M v[152:155], a[164:167], a[84:87], v[152:155]
 s_waitcnt lgkmcnt(4)
 s_and_b32 s35, s64, 536870912
 v_sub_f32 v242, v242, v27
M v[156:159], a[164:167], a[92:95], v[156:159]
 ds_read_b64_tr_b16 a[144:145], v3 offset:49152
 ds_read_b64_tr_b16 a[146:147], v3 offset:50176
M v[156:159], a[160:163], a[88:91], v[156:159]
 buffer_load_dwordx4 v10, s[52:55], s28 offen offset:2048   lds
M v[188:191], a[168:171], a[88:91], v[188:191]
 ds_read_b128 a[160:163], v5 offset:20480
 ds_read_b128 a[164:167], v6 offset:20480
M v[188:191], a[172:175], a[92:95], v[188:191]
 v_sub_f32 v243, v243, v27
 v_sub_f32 v244, v244, v27
M v[184:187], a[172:175], a[84:87], v[184:187]
 v_sub_f32 v245, v245, v27
 v_sub_f32 v246, v246, v27
M v[184:187], a[168:171], a[80:83], v[184:187]
 v_sub_f32 v247, v247, v27
 v_sub_f32 v248, v248, v27
M v[180:183], a[168:171], a[72:75], v[180:183]
 buffer_load_dwordx4 v11, s[52:55], s28 offen offset:3072   lds
M v[180:183], a[172:175], a[76:79], v[180:183]
 s_add_u32 s28, s28, 524416
 ds_read_b64_tr_b16 a[148:149], v3 offset:57344
 ds_read_b64_tr_b16 a[150:151], v3 offset:58368
M v[176:179], a[172:175], a[68:71], v[176:179]
 v_sub_f32 v249, v249, v27
 v_sub_f32 v250, v250, v27
M v[176:179], a[168:171], a[64:67], v[176:179]
 v_sub_f32 v251, v251, v27
 v_sub_f32 v252, v252, v27
M v[172:175], a[168:171], a[56:59], v[172:175]
 s_add_u32 m0, s23, 147456
 v_sub_f32 v253, v253, v27
 v_sub_f32 v254, v254, v27
M v[172:175], a[172:175], a[60:63], v[172:175]
 buffer_load_dwordx4 v8, s[52:55], s28 offen offset:0   lds
M v[168:171], a[172:175], a[52:55], v[168:171]
 v_sub_f32 v255, v255, v27
M v[168:171], a[168:171], a[48:51], v[168:171]
M v[164:167], a[168:171], a[40:43], v[164:167]
 ds_read_b64_tr_b16 a[152:153], v4 offset:49152
 ds_read_b64_tr_b16 a[154:155], v4 offset:50176
M v[164:167], a[172:175], a[44:47], v[164:167]
 s_waitcnt lgkmcnt(4)
M v[160:163], a[172:175], a[36:39], v[160:163]
 buffer_load_dwordx4 v9, s[52:55], s28 offen offset:1024   lds
M v[160:163], a[168:171], a[32:35], v[160:163]
M v[192:195], a[160:163], a[32:35], v[192:195]
 ds_read_b128 a[168:171], v5 offset:22528
 ds_read_b128 a[172:175], v6 offset:22528
M v[192:195], a[164:167], a[36:39], v[192:195]
M v[196:199], a[164:167], a[44:47], v[196:199]
 buffer_load_dwordx4 v10, s[52:55], s28 offen offset:2048   lds
M v[196:199], a[160:163], a[40:43], v[196:199]
 ds_read_b64_tr_b16 a[156:157], v4 offset:57344
 ds_read_b64_tr_b16 a[158:159], v4 offset:58368
M v[200:203], a[160:163], a[48:51], v[200:203]
M v[200:203], a[164:167], a[52:55], v[200:203]
M v[204:207], a[164:167], a[60:63], v[204:207]
M v[204:207], a[160:163], a[56:59], v[204:207]
 buffer_load_dwordx4 v11, s[52:55], s28 offen offset:3072   lds
M v[208:211], a[160:163], a[64:67], v[208:211]
 s_sub_u32 s28, s28, 524288
M v[208:211], a[164:167], a[68:71], v[208:211]
M v[212:215], a[164:167], a[76:79], v[212:215]
M v[212:215], a[160:163], a[72:75], v[212:215]
M v[216:219], a[160:163], a[80:83], v[216:219]
M v[216:219], a[164:167], a[84:87], v[216:219]
 s_waitcnt lgkmcnt(2)
M v[220:223], a[164:167], a[92:95], v[220:223]
 s_waitcnt vmcnt(25) lgkmcnt(0)
M v[220:223], a[160:163], a[88:91], v[220:223]
 s_barrier
M v[252:255], a[168:171], a[88:91], v[252:255]
 ds_read_b128 a[160:163], v5 offset:32768
 ds_read_b128 a[164:167], v6 offset:32768
M v[252:255], a[172:175], a[92:95], v[252:255]
M v[248:251], a[172:175], a[84:87], v[248:251]
M v[248:251], a[168:171], a[80:83], v[248:251]
M v[244:247], a[168:171], a[72:75], v[244:247]
M v[244:247], a[172:175], a[76:79], v[244:247]
M v[240:243], a[172:175], a[68:71], v[240:243]
M v[240:243], a[168:171], a[64:67], v[240:243]
M v[236:239], a[168:171], a[56:59], v[236:239]
M v[236:239], a[172:175], a[60:63], v[236:239]
M v[232:235], a[172:175], a[52:55], v[232:235]
M v[232:235], a[168:171], a[48:51], v[232:235]
M v[228:231], a[168:171], a[40:43], v[228:231]
M v[228:231], a[172:175], a[44:47], v[228:231]
 s_waitcnt lgkmcnt(0)
M v[224:227], a[172:175], a[36:39], v[224:227]
M v[224:227], a[168:171], a[32:35], v[224:227]
M a[0:3], a[160:163], a[96:99], a[0:3]
 ds_read_b128 a[168:171], v5 offset:34816
 ds_read_b128 a[172:175], v6 offset:34816
M a[0:3], a[164:167], a[100:103], a[0:3]
 ds_read_b64_tr_b16 a[32:33], v1 offset:0
 ds_read_b64_tr_b16 a[34:35], v1 offset:1024
M a[4:7], a[164:167], a[108:111], a[4:7]
 s_add_u32 m0, s24, 16384
M a[4:7], a[160:163], a[104:107], a[4:7]
 buffer_load_dwordx4 v16, s[56:59], s29 offen offset:0   lds
M a[8:11], a[160:163], a[112:115], a[8:11]
M a[8:11], a[164:167], a[116:119], a[8:11]
M a[12:15], a[164:167], a[124:127], a[12:15]
 ds_read_b64_tr_b16 a[36:37], v1 offset:8192
 ds_read_b64_tr_b16 a[38:39], v1 offset:9216
M a[12:15], a[160:163], a[120:123], a[12:15]
M a[16:19], a[160:163], a[128:131], a[16:19]
 buffer_load_dwordx4 v17, s[56:59], s29 offen offset:1024   lds
M a[16:19], a[164:167], a[132:135], a[16:19]
M a[20:23], a[164:167], a[140:143], a[20:23]
M a[20:23], a[160:163], a[136:139], a[20:23]
 ds_read_b64_tr_b16 a[40:41], v2 offset:0
 ds_read_b64_tr_b16 a[42:43], v2 offset:1024
M a[24:27], a[160:163], a[144:147], a[24:27]
M a[24:27], a[164:167], a[148:151], a[24:27]
 s_waitcnt lgkmcnt(6)
 buffer_load_dwordx4 v18, s[56:59], s29 offen offset:2048   lds
M a[28:31], a[164:167], a[156:159], a[28:31]
M a[28:31], a[160:163], a[152:155], a[28:31]
M v[32:35], a[168:171], a[96:99], v[32:35]
 ds_read_b128 a[160:163], v5 offset:36864
 ds_read_b128 a[164:167], v6 offset:36864
M v[32:35], a[172:175], a[100:103], v[32:35]
 ds_read_b64_tr_b16 a[44:45], v2 offset:8192
 ds_read_b64_tr_b16 a[46:47], v2 offset:9216
M v[36:39], a[172:175], a[108:111], v[36:39]
 buffer_load_dwordx4 v19, s[56:59], s29 offen offset:3072   lds
M v[36:39], a[168:171], a[104:107], v[36:39]
 s_add_u32 s29, s29, 128
M v[40:43], a[168:171], a[112:115], v[40:43]
M v[40:43], a[172:175], a[116:119], v[40:43]
 ds_read_b64_tr_b16 a[48:49], v3 offset:0
 ds_read_b64_tr_b16 a[50:51], v3 offset:1024
M v[44:47], a[172:175], a[124:127], v[44:47]
 s_add_u32 m0, s23, 49152
 v_accvgpr_read_b32 v24, a0
 v_accvgpr_read_b32 v25, a1
M v[44:47], a[168:171], a[120:123], v[44:47]
 buffer_load_dwordx4 v8, s[52:55], s28 offen offset:0   lds
M v[48:51], a[168:171], a[128:131], v[48:51]
 v_accvgpr_read_b32 v26, a2
 v_accvgpr_read_b32 v27, a3
M v[48:51], a[172:175], a[132:135], v[48:51]
 v_cvt_pk_bf16_f32 v24, v24, v25
 v_cvt_pk_bf16_f32 v25, v26, v27
M v[52:55], a[172:175], a[140:143], v[52:55]
 ds_read_b64_tr_b16 a[52:53], v3 offset:8192
 ds_read_b64_tr_b16 a[54:55], v3 offset:9216
M v[52:55], a[168:171], a[136:139], v[52:55]
 v_cvt_pk_bf16_f32 v26, v32, v33
 v_cvt_pk_bf16_f32 v27, v34, v35
M v[56:59], a[168:171], a[144:147], v[56:59]
 s_add_u32 s3, s93, 0
 buffer_load_dwordx4 v9, s[52:55], s28 offen offset:1024   lds
M v[56:59], a[172:175], a[148:151], v[56:59]
 s_waitcnt lgkmcnt(6)
M v[60:63], a[172:175], a[156:159], v[60:63]
 buffer_store_dwordx4 v[24:27], v7, s[8:11], s3 offen offset:0 sc1
M v[60:63], a[168:171], a[152:155], v[60:63]
 ds_read_b64_tr_b16 a[56:57], v4 offset:0
 ds_read_b64_tr_b16 a[58:59], v4 offset:1024
M v[64:67], a[160:163], a[96:99], v[64:67]
 ds_read_b128 a[168:171], v5 offset:38912
 ds_read_b128 a[172:175], v6 offset:38912
M v[64:67], a[164:167], a[100:103], v[64:67]
 buffer_load_dwordx4 v10, s[52:55], s28 offen offset:2048   lds
M v[68:71], a[164:167], a[108:111], v[68:71]
 v_accvgpr_read_b32 v24, a4
 v_accvgpr_read_b32 v25, a5
M v[68:71], a[160:163], a[104:107], v[68:71]
 v_accvgpr_read_b32 v26, a6
 v_accvgpr_read_b32 v27, a7
M v[72:75], a[160:163], a[112:115], v[72:75]
 ds_read_b64_tr_b16 a[60:61], v4 offset:8192
 ds_read_b64_tr_b16 a[62:63], v4 offset:9216
M v[72:75], a[164:167], a[116:119], v[72:75]
 v_cvt_pk_bf16_f32 v24, v24, v25
 v_cvt_pk_bf16_f32 v25, v26, v27
M v[76:79], a[164:167], a[124:127], v[76:79]
 buffer_load_dwordx4 v11, s[52:55], s28 offen offset:3072   lds
M v[76:79], a[160:163], a[120:123], v[76:79]
 s_add_u32 s28, s28, 1048448
 v_cvt_pk_bf16_f32 v26, v36, v37
 v_cvt_pk_bf16_f32 v27, v38, v39
M v[80:83], a[160:163], a[128:131], v[80:83]
M v[80:83], a[164:167], a[132:135], v[80:83]
M v[84:87], a[164:167], a[140:143], v[84:87]
 buffer_store_dwordx4 v[24:27], v7, s[8:11], s3 offen offset:2048 sc1
M v[84:87], a[160:163], a[136:139], v[84:87]
M v[88:91], a[160:163], a[144:147], v[88:91]
M v[88:91], a[164:167], a[148:151], v[88:91]
 s_waitcnt lgkmcnt(2)
M v[92:95], a[164:167], a[156:159], v[92:95]
 s_waitcnt vmcnt(26) lgkmcnt(0)
 v_accvgpr_read_b32 v24, a8
 v_accvgpr_read_b32 v25, a9
M v[92:95], a[160:163], a[152:155], v[92:95]
 s_barrier
M v[96:99], a[168:171], a[96:99], v[96:99]
 ds_read_b128 a[160:163], v5 offset:49152
 ds_read_b128 a[164:167], v6 offset:49152
M v[96:99], a[172:175], a[100:103], v[96:99]
 v_accvgpr_read_b32 v26, a10
 v_accvgpr_read_b32 v27, a11
M v[100:103], a[172:175], a[108:111], v[100:103]
 s_add_u32 m0, s24, 32768
 ds_read_b64_tr_b16 a[64:65], v1 offset:16384
 ds_read_b64_tr_b16 a[66:67], v1 offset:17408
M v[100:103], a[168:171], a[104:107], v[100:103]
 buffer_load_dwordx4 v16, s[56:59], s29 offen offset:0   lds
M v[104:107], a[168:171], a[112:115], v[104:107]
 v_cvt_pk_bf16_f32 v24, v24, v25
 v_cvt_pk_bf16_f32 v25, v26, v27
M v[104:107], a[172:175], a[116:119], v[104:107]
 v_cvt_pk_bf16_f32 v26, v40, v41
 v_cvt_pk_bf16_f32 v27, v42, v43
M v[108:111], a[172:175], a[124:127], v[108:111]
 s_add_u32 s3, s93, 4096
 buffer_store_dwordx4 v[24:27], v7, s[8:11], s3 offen offset:0 sc1
M v[108:111], a[168:171], a[120:123], v[108:111]
 v_cvt_pk_bf16_f32 v64, v64, v65
 v_cvt_pk_bf16_f32 v65, v66, v67
M v[112:115], a[168:171], a[128:131], v[112:115]
 v_cvt_pk_bf16_f32 v66, v96, v97
 v_cvt_pk_bf16_f32 v67, v98, v99
M v[112:115], a[172:175], a[132:135], v[112:115]
 ds_read_b64_tr_b16 a[68:69], v1 offset:24576
 ds_read_b64_tr_b16 a[70:71], v1 offset:25600
M v[116:119], a[172:175], a[140:143], v[116:119]
 buffer_load_dwordx4 v17, s[56:59], s29 offen offset:1024   lds
M v[116:119], a[168:171], a[136:139], v[116:119]
 v_accvgpr_read_b32 v24, a12
 v_accvgpr_read_b32 v25, a13
M v[120:123], a[168:171], a[144:147], v[120:123]
 v_accvgpr_read_b32 v26, a14
 v_accvgpr_read_b32 v27, a15
M v[120:123], a[172:175], a[148:151], v[120:123]
 s_waitcnt lgkmcnt(4)
 v_cvt_pk_bf16_f32 v24, v24, v25
 v_cvt_pk_bf16_f32 v25, v26, v27
M v[124:127], a[172:175], a[156:159], v[124:127]
 v_cvt_pk_bf16_f32 v26, v44, v45
 v_cvt_pk_bf16_f32 v27, v46, v47
M v[124:127], a[168:171], a[152:155], v[124:127]
 buffer_store_dwordx4 v[24:27], v7, s[8:11], s3 offen offset:2048 sc1
M v[128:131], a[160:163], a[96:99], v[128:131]
 ds_read_b128 a[168:171], v5 offset:51200
 ds_read_b128 a[172:175], v6 offset:51200
M v[128:131], a[164:167], a[100:103], v[128:131]
 ds_read_b64_tr_b16 a[72:73], v2 offset:16384
 ds_read_b64_tr_b16 a[74:75], v2 offset:17408
M v[132:135], a[164:167], a[108:111], v[132:135]
 buffer_load_dwordx4 v18, s[56:59], s29 offen offset:2048   lds
M v[132:135], a[160:163], a[104:107], v[132:135]
 v_cvt_pk_bf16_f32 v68, v68, v69
 v_cvt_pk_bf16_f32 v69, v70, v71
M v[136:139], a[160:163], a[112:115], v[136:139]
 v_cvt_pk_bf16_f32 v70, v100, v101
 v_cvt_pk_bf16_f32 v71, v102, v103
M v[136:139], a[164:167], a[116:119], v[136:139]
 v_cvt_pk_bf16_f32 v72, v72, v73
 v_cvt_pk_bf16_f32 v73, v74, v75
M v[140:143], a[164:167], a[124:127], v[140:143]
 v_accvgpr_read_b32 v24, a16
 v_accvgpr_read_b32 v25, a17
M v[140:143], a[160:163], a[120:123], v[140:143]
 ds_read_b64_tr_b16 a[76:77], v2 offset:24576
 ds_read_b64_tr_b16 a[78:79], v2 offset:25600
M v[144:147], a[160:163], a[128:131], v[144:147]
 buffer_load_dwordx4 v19, s[56:59], s29 offen offset:3072   lds
M v[144:147], a[164:167], a[132:135], v[144:147]
 s_add_u32 s29, s29, 128
 v_accvgpr_read_b32 v26, a18
 v_accvgpr_read_b32 v27, a19
M v[148:151], a[164:167], a[140:143], v[148:151]
 v_cvt_pk_bf16_f32 v24, v24, v25
 v_cvt_pk_bf16_f32 v25, v26, v27
M v[148:151], a[160:163], a[136:139], v[148:151]
 v_cvt_pk_bf16_f32 v26, v48, v49
 v_cvt_pk_bf16_f32 v27, v50, v51
M v[152:155], a[160:163], a[144:147], v[152:155]
 s_add_u32 s3, s93, 8192
 buffer_store_dwordx4 v[24:27], v7, s[8:11], s3 offen offset:0 sc1
M v[152:155], a[164:167], a[148:151], v[152:155]
 s_waitcnt lgkmcnt(4)
 v_cvt_pk_bf16_f32 v74, v104, v105
 v_cvt_pk_bf16_f32 v75, v106, v107
M v[156:159], a[164:167], a[156:159], v[156:159]
 s_add_u32 m0, s23, 0
 ds_read_b64_tr_b16 a[80:81], v3 offset:16384
 ds_read_b64_tr_b16 a[82:83], v3 offset:17408
M v[156:159], a[160:163], a[152:155], v[156:159]
 buffer_load_dwordx4 v8, s[52:55], s28 offen offset:0   lds
M v[160:163], a[168:171], a[96:99], v[160:163]
 ds_read_b128 a[160:163], v5 offset:53248
 ds_read_b128 a[164:167], v6 offset:53248
M v[160:163], a[172:175], a[100:103], v[160:163]
 v_cvt_pk_bf16_f32 v76, v76, v77
 v_cvt_pk_bf16_f32 v77, v78, v79
M v[164:167], a[172:175], a[108:111], v[164:167]
 v_accvgpr_read_b32 v24, a20
 v_accvgpr_read_b32 v25, a21
M v[164:167], a[168:171], a[104:107], v[164:167]
 v_accvgpr_read_b32 v26, a22
 v_accvgpr_read_b32 v27, a23
M v[168:171], a[168:171], a[112:115], v[168:171]
 v_cvt_pk_bf16_f32 v24, v24, v25
 v_cvt_pk_bf16_f32 v25, v26, v27
M v[168:171], a[172:175], a[116:119], v[168:171]
 ds_read_b64_tr_b16 a[84:85], v3 offset:24576
 ds_read_b64_tr_b16 a[86:87], v3 offset:25600
M v[172:175], a[172:175], a[124:127], v[172:175]
 buffer_load_dwordx4 v9, s[52:55], s28 offen offset:1024   lds
M v[172:175], a[168:171], a[120:123], v[172:175]
 v_cvt_pk_bf16_f32 v26, v52, v53
 v_cvt_pk_bf16_f32 v27, v54, v55
M v[176:179], a[168:171], a[128:131], v[176:179]
 v_cvt_pk_bf16_f32 v78, v108, v109
 v_cvt_pk_bf16_f32 v79, v110, v111
M v[176:179], a[172:175], a[132:135], v[176:179]
 buffer_store_dwordx4 v[24:27], v7, s[8:11], s3 offen offset:2048 sc1
M v[180:183], a[172:175], a[140:143], v[180:183]
 v_cvt_pk_bf16_f32 v80, v80, v81
 v_cvt_pk_bf16_f32 v81, v82, v83
M v[180:183], a[168:171], a[136:139], v[180:183]
 v_cvt_pk_bf16_f32 v82, v112, v113
 v_cvt_pk_bf16_f32 v83, v114, v115
M v[184:187], a[168:171], a[144:147], v[184:187]
 ds_read_b64_tr_b16 a[88:89], v4 offset:16384
 ds_read_b64_tr_b16 a[90:91], v4 offset:17408
M v[184:187], a[172:175], a[148:151], v[184:187]
 s_waitcnt lgkmcnt(4)
 buffer_load_dwordx4 v10, s[52:55], s28 offen offset:2048   lds
M v[188:191], a[172:175], a[156:159], v[188:191]
 v_accvgpr_read_b32 v24, a24
 v_accvgpr_read_b32 v25, a25
M v[188:191], a[168:171], a[152:155], v[188:191]
 v_accvgpr_read_b32 v26, a26
 v_accvgpr_read_b32 v27, a27
M v[192:195], a[160:163], a[96:99], v[192:195]
 ds_read_b128 a[168:171], v5 offset:55296
 ds_read_b128 a[172:175], v6 offset:55296
M v[192:195], a[164:167], a[100:103], v[192:195]
 v_cvt_pk_bf16_f32 v24, v24, v25
 v_cvt_pk_bf16_f32 v25, v26, v27
M v[196:199], a[164:167], a[108:111], v[196:199]
 v_cvt_pk_bf16_f32 v26, v56, v57
 v_cvt_pk_bf16_f32 v27, v58, v59
M v[196:199], a[160:163], a[104:107], v[196:199]
 s_add_u32 s3, s93, 12288
 ds_read_b64_tr_b16 a[92:93], v4 offset:24576
 ds_read_b64_tr_b16 a[94:95], v4 offset:25600
M v[200:203], a[160:163], a[112:115], v[200:203]
 buffer_load_dwordx4 v11, s[52:55], s28 offen offset:3072   lds
M v[200:203], a[164:167], a[116:119], v[200:203]
 s_add_u32 s28, s28, 128
 v_cvt_pk_bf16_f32 v84, v84, v85
 v_cvt_pk_bf16_f32 v85, v86, v87
M v[204:207], a[164:167], a[124:127], v[204:207]
 v_cvt_pk_bf16_f32 v86, v116, v117
 v_cvt_pk_bf16_f32 v87, v118, v119
M v[204:207], a[160:163], a[120:123], v[204:207]
 v_cvt_pk_bf16_f32 v88, v88, v89
 v_cvt_pk_bf16_f32 v89, v90, v91
M v[208:211], a[160:163], a[128:131], v[208:211]
 buffer_store_dwordx4 v[24:27], v7, s[8:11], s3 offen offset:0 sc1
M v[208:211], a[164:167], a[132:135], v[208:211]
 v_cvt_pk_bf16_f32 v90, v120, v121
 v_cvt_pk_bf16_f32 v91, v122, v123
M v[212:215], a[164:167], a[140:143], v[212:215]
 v_accvgpr_read_b32 v24, a28
 v_accvgpr_read_b32 v25, a29
M v[212:215], a[160:163], a[136:139], v[212:215]
 v_accvgpr_read_b32 v26, a30
 v_accvgpr_read_b32 v27, a31
M v[216:219], a[160:163], a[144:147], v[216:219]
 v_cvt_pk_bf16_f32 v24, v24, v25
 v_cvt_pk_bf16_f32 v25, v26, v27
M v[216:219], a[164:167], a[148:151], v[216:219]
 s_waitcnt lgkmcnt(2)
 v_cvt_pk_bf16_f32 v26, v60, v61
 v_cvt_pk_bf16_f32 v27, v62, v63
M v[220:223], a[164:167], a[156:159], v[220:223]
 s_waitcnt vmcnt(27) lgkmcnt(0)
 buffer_store_dwordx4 v[24:27], v7, s[8:11], s3 offen offset:2048 sc1
M v[220:223], a[160:163], a[152:155], v[220:223]
 s_barrier
M v[224:227], a[168:171], a[96:99], v[224:227]
 ds_read_b128 a[160:163], v5 offset:0
 ds_read_b128 a[164:167], v6 offset:0
M v[224:227], a[172:175], a[100:103], v[224:227]
 v_cvt_pk_bf16_f32 v92, v92, v93
 v_cvt_pk_bf16_f32 v93, v94, v95
M v[228:231], a[172:175], a[108:111], v[228:231]
 v_cvt_pk_bf16_f32 v94, v124, v125
 v_cvt_pk_bf16_f32 v95, v126, v127
M v[228:231], a[168:171], a[104:107], v[228:231]
 v_cvt_pk_bf16_f32 v128, v128, v129
 v_cvt_pk_bf16_f32 v129, v130, v131
M v[232:235], a[168:171], a[112:115], v[232:235]
 v_cvt_pk_bf16_f32 v130, v160, v161
 v_cvt_pk_bf16_f32 v131, v162, v163
M v[232:235], a[172:175], a[116:119], v[232:235]
 v_cvt_pk_bf16_f32 v132, v132, v133
 v_cvt_pk_bf16_f32 v133, v134, v135
M v[236:239], a[172:175], a[124:127], v[236:239]
 v_cvt_pk_bf16_f32 v134, v164, v165
 v_cvt_pk_bf16_f32 v135, v166, v167
M v[236:239], a[168:171], a[120:123], v[236:239]
 v_cvt_pk_bf16_f32 v136, v136, v137
 v_cvt_pk_bf16_f32 v137, v138, v139
M v[240:243], a[168:171], a[128:131], v[240:243]
 v_cvt_pk_bf16_f32 v138, v168, v169
 v_cvt_pk_bf16_f32 v139, v170, v171
M v[240:243], a[172:175], a[132:135], v[240:243]
 v_cvt_pk_bf16_f32 v140, v140, v141
 v_cvt_pk_bf16_f32 v141, v142, v143
M v[244:247], a[172:175], a[140:143], v[244:247]
 v_cvt_pk_bf16_f32 v142, v172, v173
 v_cvt_pk_bf16_f32 v143, v174, v175
M v[244:247], a[168:171], a[136:139], v[244:247]
 v_cvt_pk_bf16_f32 v144, v144, v145
 v_cvt_pk_bf16_f32 v145, v146, v147
M v[248:251], a[168:171], a[144:147], v[248:251]
 v_cvt_pk_bf16_f32 v146, v176, v177
 v_cvt_pk_bf16_f32 v147, v178, v179
M v[248:251], a[172:175], a[148:151], v[248:251]
 s_waitcnt lgkmcnt(0)
 v_cvt_pk_bf16_f32 v148, v148, v149
 v_cvt_pk_bf16_f32 v149, v150, v151
M v[252:255], a[172:175], a[156:159], v[252:255]
 v_cvt_pk_bf16_f32 v150, v180, v181
 v_cvt_pk_bf16_f32 v151, v182, v183
M v[252:255], a[168:171], a[152:155], v[252:255]
 v_cvt_pk_bf16_f32 v152, v152, v153
 v_cvt_pk_bf16_f32 v153, v154, v155
M v[32:35], a[32:35], a[160:163], 0
 s_add_u32 m0, s23, 16384
 ds_read_b128 a[168:171], v5 offset:2048
 ds_read_b128 a[172:175], v6 offset:2048
M v[32:35], a[36:39], a[164:167], v[32:35]
 ds_read_b64_tr_b16 a[96:97], v1 offset:32768
 ds_read_b64_tr_b16 a[98:99], v1 offset:33792
M v[36:39], a[44:47], a[164:167], 0
 buffer_load_dwordx4 v8, s[52:55], s28 offen offset:0   lds
M v[36:39], a[40:43], a[160:163], v[36:39]
 v_cvt_pk_bf16_f32 v154, v184, v185
 v_cvt_pk_bf16_f32 v155, v186, v187
M v[40:43], a[48:51], a[160:163], 0
 ds_read_b64_tr_b16 a[100:101], v1 offset:40960
 ds_read_b64_tr_b16 a[102:103], v1 offset:41984
M v[40:43], a[52:55], a[164:167], v[40:43]
 buffer_load_dwordx4 v9, s[52:55], s28 offen offset:1024   lds
M v[44:47], a[60:63], a[164:167], 0
 v_cvt_pk_bf16_f32 v156, v156, v157
 v_cvt_pk_bf16_f32 v157, v158, v159
M v[44:47], a[56:59], a[160:163], v[44:47]
 ds_read_b64_tr_b16 a[104:105], v2 offset:32768
 ds_read_b64_tr_b16 a[106:107], v2 offset:33792
M v[48:51], a[64:67], a[160:163], 0
 v_cvt_pk_bf16_f32 v158, v188, v189
 v_cvt_pk_bf16_f32 v159, v190, v191
M v[48:51], a[68:71], a[164:167], v[48:51]
 v_cvt_pk_bf16_f32 v192, v192, v193
 v_cvt_pk_bf16_f32 v193, v194, v195
M v[52:55], a[76:79], a[164:167], 0
 ds_read_b64_tr_b16 a[108:109], v2 offset:40960
 ds_read_b64_tr_b16 a[110:111], v2 offset:41984
M v[52:55], a[72:75], a[160:163], v[52:55]
 buffer_load_dwordx4 v10, s[52:55], s28 offen offset:2048   lds
M v[56:59], a[80:83], a[160:163], 0
 v_cvt_pk_bf16_f32 v194, v224, v225
 v_cvt_pk_bf16_f32 v195, v226, v227
M v[56:59], a[84:87], a[164:167], v[56:59]
 s_waitcnt lgkmcnt(8)
 ds_read_b64_tr_b16 a[112:113], v3 offset:32768
 ds_read_b64_tr_b16 a[114:115], v3 offset:33792
M v[60:63], a[92:95], a[164:167], 0
 v_cvt_pk_bf16_f32 v196, v196, v197
 v_cvt_pk_bf16_f32 v197, v198, v199
M v[60:63], a[88:91], a[160:163], v[60:63]
 buffer_load_dwordx4 v11, s[52:55], s28 offen offset:3072   lds
M v[96:99], a[32:35], a[168:171], 0
 s_add_u32 s28, s28, 524160
 ds_read_b128 a[160:163], v5 offset:4096
 ds_read_b128 a[164:167], v6 offset:4096
M v[96:99], a[36:39], a[172:175], v[96:99]
 ds_read_b64_tr_b16 a[116:117], v3 offset:40960
 ds_read_b64_tr_b16 a[118:119], v3 offset:41984
M v[100:103], a[44:47], a[172:175], 0
 v_cvt_pk_bf16_f32 v198, v228, v229
 v_cvt_pk_bf16_f32 v199, v230, v231
M v[100:103], a[40:43], a[168:171], v[100:103]
 s_add_u32 m0, s24, 49152
 ds_read_b64_tr_b16 a[120:121], v4 offset:32768
 ds_read_b64_tr_b16 a[122:123], v4 offset:33792
M v[104:107], a[48:51], a[168:171], 0
 buffer_load_dwordx4 v16, s[56:59], s29 offen offset:0   lds
M v[104:107], a[52:55], a[172:175], v[104:107]
 v_cvt_pk_bf16_f32 v200, v200, v201
 v_cvt_pk_bf16_f32 v201, v202, v203
M v[108:111], a[60:63], a[172:175], 0
 ds_read_b64_tr_b16 a[124:125], v4 offset:40960
 ds_read_b64_tr_b16 a[126:127], v4 offset:41984
M v[108:111], a[56:59], a[168:171], v[108:111]
 v_cvt_pk_bf16_f32 v202, v232, v233
 v_cvt_pk_bf16_f32 v203, v234, v235
M v[112:115], a[64:67], a[168:171], 0
 v_cvt_pk_bf16_f32 v204, v204, v205
 v_cvt_pk_bf16_f32 v205, v206, v207
M v[112:115], a[68:71], a[172:175], v[112:115]
 buffer_load_dwordx4 v17, s[56:59], s29 offen offset:1024   lds
M v[116:119], a[76:79], a[172:175], 0
 v_cvt_pk_bf16_f32 v206, v236, v237
 v_cvt_pk_bf16_f32 v207, v238, v239
M v[116:119], a[72:75], a[168:171], v[116:119]
 v_cvt_pk_bf16_f32 v208, v208, v209
 v_cvt_pk_bf16_f32 v209, v210, v211
M v[120:123], a[80:83], a[168:171], 0
 v_cvt_pk_bf16_f32 v210, v240, v241
 v_cvt_pk_bf16_f32 v211, v242, v243
M v[120:123], a[84:87], a[172:175], v[120:123]
 s_waitcnt lgkmcnt(6)
 v_cvt_pk_bf16_f32 v212, v212, v213
 v_cvt_pk_bf16_f32 v213, v214, v215
M v[124:127], a[92:95], a[172:175], 0
 s_waitcnt vmcnt(21) lgkmcnt(0)
 buffer_load_dwordx4 v18, s[56:59], s29 offen offset:2048   lds
M v[124:127], a[88:91], a[168:171], v[124:127]
 s_barrier
M v[160:163], a[32:35], a[160:163], 0
 ds_read_b128 a[168:171], v5 offset:6144
 ds_read_b128 a[172:175], v6 offset:6144
M v[160:163], a[36:39], a[164:167], v[160:163]
 ds_read_b64_tr_b16 a[128:129], v1 offset:49152
 ds_read_b64_tr_b16 a[130:131], v1 offset:50176
M v[164:167], a[44:47], a[164:167], 0
 v_cvt_pk_bf16_f32 v214, v244, v245
 v_cvt_pk_bf16_f32 v215, v246, v247
M v[164:167], a[40:43], a[160:163], v[164:167]
 buffer_load_dwordx4 v19, s[56:59], s29 offen offset:3072   lds
M v[168:171], a[48:51], a[160:163], 0
 s_add_u32 s29, s29, 128
 ds_read_b64_tr_b16 a[132:133], v1 offset:57344
 ds_read_b64_tr_b16 a[134:135], v1 offset:58368
M v[168:171], a[52:55], a[164:167], v[168:171]
 v_cvt_pk_bf16_f32 v216, v216, v217
 v_cvt_pk_bf16_f32 v217, v218, v219
M v[172:175], a[60:63], a[164:167], 0
 v_cvt_pk_bf16_f32 v218, v248, v249
 v_cvt_pk_bf16_f32 v219, v250, v251
M v[172:175], a[56:59], a[160:163], v[172:175]
 s_add_u32 m0, s23, 32768
 ds_read_b64_tr_b16 a[136:137], v2 offset:49152
 ds_read_b64_tr_b16 a[138:139], v2 offset:50176
M v[176:179], a[64:67], a[160:163], 0
 buffer_load_dwordx4 v8, s[52:55], s28 offen offset:0   lds
M v[176:179], a[68:71], a[164:167], v[176:179]
 v_cvt_pk_bf16_f32 v220, v220, v221
 v_cvt_pk_bf16_f32 v221, v222, v223
M v[180:183], a[76:79], a[164:167], 0
 ds_read_b64_tr_b16 a[140:141], v2 offset:57344
 ds_read_b64_tr_b16 a[142:143], v2 offset:58368
M v[180:183], a[72:75], a[160:163], v[180:183]
 v_cvt_pk_bf16_f32 v222, v252, v253
 v_cvt_pk_bf16_f32 v223, v254, v255
M v[184:187], a[80:83], a[160:163], 0
 s_add_u32 s3, s93, 262144
 v_mov_b32 v12, 1
 v_or_b32 v15, s20, v0
M v[184:187], a[84:87], a[164:167], v[184:187]
 s_waitcnt lgkmcnt(8)
 ds_read_b64_tr_b16 a[144:145], v3 offset:49152
 ds_read_b64_tr_b16 a[146:147], v3 offset:50176
M v[188:191], a[92:95], a[164:167], 0
 buffer_load_dwordx4 v9, s[52:55], s28 offen offset:1024   lds
M v[188:191], a[88:91], a[160:163], v[188:191]
 v_min_u32 v15, 1, v15
 v_lshlrev_b32 v15, 29, v15
M v[224:227], a[32:35], a[168:171], 0
 ds_read_b128 a[160:163], v5 offset:16384
 ds_read_b128 a[164:167], v6 offset:16384
M v[224:227], a[36:39], a[172:175], v[224:227]
 ds_read_b64_tr_b16 a[148:149], v3 offset:57344
 ds_read_b64_tr_b16 a[150:151], v3 offset:58368
M v[228:231], a[44:47], a[172:175], 0
 buffer_load_dwordx4 v10, s[52:55], s28 offen offset:2048   lds
M v[228:231], a[40:43], a[168:171], v[228:231]
 ds_read_b64_tr_b16 a[152:153], v4 offset:49152
 ds_read_b64_tr_b16 a[154:155], v4 offset:50176
M v[232:235], a[48:51], a[168:171], 0
 buffer_store_dwordx4 v[64:67], v7, s[8:11], s3 offen offset:0 sc1
M v[232:235], a[52:55], a[172:175], v[232:235]
M v[236:239], a[60:63], a[172:175], 0
 ds_read_b64_tr_b16 a[156:157], v4 offset:57344
 ds_read_b64_tr_b16 a[158:159], v4 offset:58368
M v[236:239], a[56:59], a[168:171], v[236:239]
 buffer_load_dwordx4 v11, s[52:55], s28 offen offset:3072   lds
M v[240:243], a[64:67], a[168:171], 0
 s_add_u32 s28, s28, 128
M v[240:243], a[68:71], a[172:175], v[240:243]
 buffer_store_dwordx4 v[68:71], v7, s[8:11], s3 offen offset:2048 sc1
M v[244:247], a[76:79], a[172:175], 0
M v[244:247], a[72:75], a[168:171], v[244:247]
M v[248:251], a[80:83], a[168:171], 0
M v[248:251], a[84:87], a[172:175], v[248:251]
 s_waitcnt lgkmcnt(6)
M v[252:255], a[92:95], a[172:175], 0
 s_waitcnt vmcnt(14) lgkmcnt(0)
M v[252:255], a[88:91], a[168:171], v[252:255]
 s_barrier
M v[32:35], a[96:99], a[160:163], v[32:35]
 s_add_u32 m0, s23, 49152
 ds_read_b128 a[168:171], v5 offset:18432
 ds_read_b128 a[172:175], v6 offset:18432
M v[32:35], a[100:103], a[164:167], v[32:35]
 ds_read_b64_tr_b16 a[32:33], v20 offset:0
 ds_read_b64_tr_b16 a[34:35], v20 offset:1024
M v[36:39], a[108:111], a[164:167], v[36:39]
 s_mov_b32 s39, 1347
 buffer_load_dwordx4 v8, s[52:55], s28 offen offset:0   lds
M v[36:39], a[104:107], a[160:163], v[36:39]
 s_cmp_lt_u32 s42, 2
 buffer_store_dword v12, v15, s[8:11], s45 offen sc1
M v[40:43], a[112:115], a[160:163], v[40:43]
 s_cselect_b32 s39, 1284, s39
 ds_read_b64_tr_b16 a[36:37], v20 offset:8192
 ds_read_b64_tr_b16 a[38:39], v20 offset:9216
M v[40:43], a[116:119], a[164:167], v[40:43]
 s_lshl_b32 s64, s20, 14
 buffer_load_dwordx4 v9, s[52:55], s28 offen offset:1024   lds
M v[44:47], a[124:127], a[164:167], v[44:47]
 s_add_u32 s12, s64, s34
 s_add_u32 s3, s93, 266240
M v[44:47], a[120:123], a[160:163], v[44:47]
 s_add_u32 s13, s12, 4096
 ds_read_b64_tr_b16 a[40:41], v21 offset:0
 ds_read_b64_tr_b16 a[42:43], v21 offset:1024
M v[48:51], a[128:131], a[160:163], v[48:51]
 s_add_u32 s14, s12, 8192
 buffer_store_dwordx4 v[72:75], v7, s[8:11], s3 offen offset:0 sc1
M v[48:51], a[132:135], a[164:167], v[48:51]
 s_add_u32 s15, s12, 12288
M v[52:55], a[140:143], a[164:167], v[52:55]
 ds_read_b64_tr_b16 a[44:45], v21 offset:8192
 ds_read_b64_tr_b16 a[46:47], v21 offset:9216
M v[52:55], a[136:139], a[160:163], v[52:55]
 buffer_load_dwordx4 v10, s[52:55], s28 offen offset:2048   lds
M v[56:59], a[144:147], a[160:163], v[56:59]
M v[56:59], a[148:151], a[164:167], v[56:59]
 s_waitcnt lgkmcnt(8)
 ds_read_b64_tr_b16 a[48:49], v22 offset:0
 ds_read_b64_tr_b16 a[50:51], v22 offset:1024
M v[60:63], a[156:159], a[164:167], v[60:63]
M v[60:63], a[152:155], a[160:163], v[60:63]
 buffer_load_dwordx4 v11, s[52:55], s28 offen offset:3072   lds
M v[96:99], a[96:99], a[168:171], v[96:99]
 s_add_u32 s28, s28, 524160
 ds_read_b128 a[160:163], v5 offset:20480
 ds_read_b128 a[164:167], v6 offset:20480
M v[96:99], a[100:103], a[172:175], v[96:99]
 ds_read_b64_tr_b16 a[52:53], v22 offset:8192
 ds_read_b64_tr_b16 a[54:55], v22 offset:9216
M v[100:103], a[108:111], a[172:175], v[100:103]
M v[100:103], a[104:107], a[168:171], v[100:103]
 s_add_u32 m0, s24, 0
 ds_read_b64_tr_b16 a[56:57], v23 offset:0
 ds_read_b64_tr_b16 a[58:59], v23 offset:1024
M v[104:107], a[112:115], a[168:171], v[104:107]
 buffer_load_dwordx4 v16, s[56:59], s29 offen offset:0   lds
M v[104:107], a[116:119], a[172:175], v[104:107]
M v[108:111], a[124:127], a[172:175], v[108:111]
 ds_read_b64_tr_b16 a[60:61], v23 offset:8192
 ds_read_b64_tr_b16 a[62:63], v23 offset:9216
M v[108:111], a[120:123], a[168:171], v[108:111]
M v[112:115], a[128:131], a[168:171], v[112:115]
M v[112:115], a[132:135], a[172:175], v[112:115]
 buffer_load_dwordx4 v17, s[56:59], s29 offen offset:1024   lds
M v[116:119], a[140:143], a[172:175], v[116:119]
M v[116:119], a[136:139], a[168:171], v[116:119]
M v[120:123], a[144:147], a[168:171], v[120:123]
M v[120:123], a[148:151], a[172:175], v[120:123]
 s_waitcnt lgkmcnt(6)
M v[124:127], a[156:159], a[172:175], v[124:127]
 s_waitcnt lgkmcnt(0)
 buffer_load_dwordx4 v18, s[56:59], s29 offen offset:2048   lds
M v[124:127], a[152:155], a[168:171], v[124:127]
 s_barrier
M v[160:163], a[96:99], a[160:163], v[160:163]
 ds_read_b128 a[168:171], v5 offset:22528
 ds_read_b128 a[172:175], v6 offset:22528
M v[160:163], a[100:103], a[164:167], v[160:163]
 ds_read_b64_tr_b16 a[64:65], v20 offset:16384
 ds_read_b64_tr_b16 a[66:67], v20 offset:17408
M v[164:167], a[108:111], a[164:167], v[164:167]
M v[164:167], a[104:107], a[160:163], v[164:167]
 buffer_load_dwordx4 v19, s[56:59], s29 offen offset:3072   lds
M v[168:171], a[112:115], a[160:163], v[168:171]
 s_add_u32 s29, s29, 128
 ds_read_b64_tr_b16 a[68:69], v20 offset:24576
 ds_read_b64_tr_b16 a[70:71], v20 offset:25600
M v[168:171], a[116:119], a[164:167], v[168:171]
 buffer_store_dwordx4 v[76:79], v7, s[8:11], s3 offen offset:2048 sc1
M v[172:175], a[124:127], a[164:167], v[172:175]
M v[172:175], a[120:123], a[160:163], v[172:175]
 s_add_u32 m0, s23, 131072
 ds_read_b64_tr_b16 a[72:73], v21 offset:16384
 ds_read_b64_tr_b16 a[74:75], v21 offset:17408
M v[176:179], a[128:131], a[160:163], v[176:179]
 buffer_load_dwordx4 v8, s[52:55], s28 offen offset:0   lds
M v[176:179], a[132:135], a[164:167], v[176:179]
M v[180:183], a[140:143], a[164:167], v[180:183]
 ds_read_b64_tr_b16 a[76:77], v21 offset:24576
 ds_read_b64_tr_b16 a[78:79], v21 offset:25600
M v[180:183], a[136:139], a[160:163], v[180:183]
M v[184:187], a[144:147], a[160:163], v[184:187]
M v[184:187], a[148:151], a[164:167], v[184:187]
 s_waitcnt lgkmcnt(8)
 ds_read_b64_tr_b16 a[80:81], v22 offset:16384
 ds_read_b64_tr_b16 a[82:83], v22 offset:17408
M v[188:191], a[156:159], a[164:167], v[188:191]
 buffer_load_dwordx4 v9, s[52:55], s28 offen offset:1024   lds
M v[188:191], a[152:155], a[160:163], v[188:191]
M v[224:227], a[96:99], a[168:171], v[224:227]
 ds_read_b128 a[160:163], v5 offset:32768
 ds_read_b128 a[164:167], v6 offset:32768
M v[224:227], a[100:103], a[172:175], v[224:227]
 ds_read_b64_tr_b16 a[84:85], v22 offset:24576
 ds_read_b64_tr_b16 a[86:87], v22 offset:25600
M v[228:231], a[108:111], a[172:175], v[228:231]
 buffer_load_dwordx4 v10, s[52:55], s28 offen offset:2048   lds
M v[228:231], a[104:107], a[168:171], v[228:231]
 ds_read_b64_tr_b16 a[88:89], v23 offset:16384
 ds_read_b64_tr_b16 a[90:91], v23 offset:17408
M v[232:235], a[112:115], a[168:171], v[232:235]
M v[232:235], a[116:119], a[172:175], v[232:235]
M v[236:239], a[124:127], a[172:175], v[236:239]
 ds_read_b64_tr_b16 a[92:93], v23 offset:24576
 ds_read_b64_tr_b16 a[94:95], v23 offset:25600
M v[236:239], a[120:123], a[168:171], v[236:239]
 buffer_load_dwordx4 v11, s[52:55], s28 offen offset:3072   lds
M v[240:243], a[128:131], a[168:171], v[240:243]
 s_add_u32 s28, s28, 128
M v[240:243], a[132:135], a[172:175], v[240:243]
M v[244:247], a[140:143], a[172:175], v[244:247]
M v[244:247], a[136:139], a[168:171], v[244:247]
M v[248:251], a[144:147], a[168:171], v[248:251]
M v[248:251], a[148:151], a[172:175], v[248:251]
 s_waitcnt lgkmcnt(6)
M v[252:255], a[156:159], a[172:175], v[252:255]
 s_waitcnt lgkmcnt(0)
M v[252:255], a[152:155], a[168:171], v[252:255]
 s_barrier
M v[32:35], a[32:35], a[160:163], v[32:35]
 s_add_u32 m0, s23, 147456
 ds_read_b128 a[168:171], v5 offset:34816
 ds_read_b128 a[172:175], v6 offset:34816
M v[32:35], a[36:39], a[164:167], v[32:35]
 ds_read_b64_tr_b16 a[96:97], v1 offset:0
 ds_read_b64_tr_b16 a[98:99], v1 offset:1024
M v[36:39], a[44:47], a[164:167], v[36:39]
 buffer_load_dwordx4 v8, s[52:55], s28 offen offset:0   lds
M v[36:39], a[40:43], a[160:163], v[36:39]
 v_and_b32 v29, 15, v0
 v_mul_u32_u24 v30, 1792, v29
M v[40:43], a[48:51], a[160:163], v[40:43]
 s_add_u32 s3, s93, 270336
 ds_read_b64_tr_b16 a[100:101], v1 offset:8192
 ds_read_b64_tr_b16 a[102:103], v1 offset:9216
M v[40:43], a[52:55], a[164:167], v[40:43]
 buffer_load_dwordx4 v9, s[52:55], s28 offen offset:1024   lds
M v[44:47], a[60:63], a[164:167], v[44:47]
 v_lshrrev_b32 v31, 4, v0
 v_lshl_add_u32 v30, v31, 4, v30
M v[44:47], a[56:59], a[160:163], v[44:47]
 ds_read_b64_tr_b16 a[104:105], v2 offset:0
 ds_read_b64_tr_b16 a[106:107], v2 offset:1024
M v[48:51], a[64:67], a[160:163], v[48:51]
 v_lshrrev_b32 v29, 1, v29
 v_min_u32 v29, 1, v29
M v[48:51], a[68:71], a[164:167], v[48:51]
 v_lshl_or_b32 v30, v29, 29, v30
 v_or_b32 v30, s88, v30
M v[52:55], a[76:79], a[164:167], v[52:55]
 s_mul_i32 s89, s86, 3584
 ds_read_b64_tr_b16 a[108:109], v2 offset:8192
 ds_read_b64_tr_b16 a[110:111], v2 offset:9216
M v[52:55], a[72:75], a[160:163], v[52:55]
 s_mul_i32 s64, s20, 448
 buffer_load_dwordx4 v10, s[52:55], s28 offen offset:2048   lds
M v[56:59], a[80:83], a[160:163], v[56:59]
 s_add_u32 s89, s89, s64
 s_add_u32 s89, s89, 105906176
M v[56:59], a[84:87], a[164:167], v[56:59]
 s_waitcnt lgkmcnt(8)
 ds_read_b64_tr_b16 a[112:113], v3 offset:0
 ds_read_b64_tr_b16 a[114:115], v3 offset:1024
M v[60:63], a[92:95], a[164:167], v[60:63]
 buffer_store_dwordx4 v[80:83], v7, s[8:11], s3 offen offset:0 sc1
M v[60:63], a[88:91], a[160:163], v[60:63]
 buffer_load_dwordx4 v11, s[52:55], s28 offen offset:3072   lds
M v[96:99], a[32:35], a[168:171], v[96:99]
 s_add_u32 s28, s28, 524160
 ds_read_b128 a[160:163], v5 offset:36864
 ds_read_b128 a[164:167], v6 offset:36864
M v[96:99], a[36:39], a[172:175], v[96:99]
 ds_read_b64_tr_b16 a[116:117], v3 offset:8192
 ds_read_b64_tr_b16 a[118:119], v3 offset:9216
M v[100:103], a[44:47], a[172:175], v[100:103]
M v[100:103], a[40:43], a[168:171], v[100:103]
 s_add_u32 m0, s24, 16384
 ds_read_b64_tr_b16 a[120:121], v4 offset:0
 ds_read_b64_tr_b16 a[122:123], v4 offset:1024
M v[104:107], a[48:51], a[168:171], v[104:107]
 buffer_load_dwordx4 v16, s[56:59], s29 offen offset:0   lds
M v[104:107], a[52:55], a[172:175], v[104:107]
M v[108:111], a[60:63], a[172:175], v[108:111]
 ds_read_b64_tr_b16 a[124:125], v4 offset:8192
 ds_read_b64_tr_b16 a[126:127], v4 offset:9216
M v[108:111], a[56:59], a[168:171], v[108:111]
M v[112:115], a[64:67], a[168:171], v[112:115]
M v[112:115], a[68:71], a[172:175], v[112:115]
 buffer_load_dwordx4 v17, s[56:59], s29 offen offset:1024   lds
M v[116:119], a[76:79], a[172:175], v[116:119]
M v[116:119], a[72:75], a[168:171], v[116:119]
M v[120:123], a[80:83], a[168:171], v[120:123]
M v[120:123], a[84:87], a[172:175], v[120:123]
 s_waitcnt lgkmcnt(6)
M v[124:127], a[92:95], a[172:175], v[124:127]
 s_waitcnt vmcnt(28) lgkmcnt(0)
 buffer_load_dwordx4 v18, s[56:59], s29 offen offset:2048   lds
M v[124:127], a[88:91], a[168:171], v[124:127]
 s_barrier
M v[160:163], a[32:35], a[160:163], v[160:163]
 ds_read_b128 a[168:171], v5 offset:38912
 ds_read_b128 a[172:175], v6 offset:38912
M v[160:163], a[36:39], a[164:167], v[160:163]
 ds_read_b64_tr_b16 a[128:129], v1 offset:16384
 ds_read_b64_tr_b16 a[130:131], v1 offset:17408
M v[164:167], a[44:47], a[164:167], v[164:167]
M v[164:167], a[40:43], a[160:163], v[164:167]
 buffer_load_dwordx4 v19, s[56:59], s29 offen offset:3072   lds
M v[168:171], a[48:51], a[160:163], v[168:171]
 s_add_u32 s29, s29, 128
 ds_read_b64_tr_b16 a[132:133], v1 offset:24576
 ds_read_b64_tr_b16 a[134:135], v1 offset:25600
M v[168:171], a[52:55], a[164:167], v[168:171]
 buffer_store_dwordx4 v[84:87], v7, s[8:11], s3 offen offset:2048 sc1
M v[172:175], a[60:63], a[164:167], v[172:175]
M v[172:175], a[56:59], a[160:163], v[172:175]
 s_add_u32 m0, s23, 0
 ds_read_b64_tr_b16 a[136:137], v2 offset:16384
 ds_read_b64_tr_b16 a[138:139], v2 offset:17408
M v[176:179], a[64:67], a[160:163], v[176:179]
 buffer_load_dwordx4 v8, s[52:55], s28 offen offset:0   lds
M v[176:179], a[68:71], a[164:167], v[176:179]
M v[180:183], a[76:79], a[164:167], v[180:183]
 ds_read_b64_tr_b16 a[140:141], v2 offset:24576
 ds_read_b64_tr_b16 a[142:143], v2 offset:25600
M v[180:183], a[72:75], a[160:163], v[180:183]
M v[184:187], a[80:83], a[160:163], v[184:187]
M v[184:187], a[84:87], a[164:167], v[184:187]
 s_waitcnt lgkmcnt(8)
 ds_read_b64_tr_b16 a[144:145], v3 offset:16384
 ds_read_b64_tr_b16 a[146:147], v3 offset:17408
M v[188:191], a[92:95], a[164:167], v[188:191]
 buffer_load_dwordx4 v9, s[52:55], s28 offen offset:1024   lds
M v[188:191], a[88:91], a[160:163], v[188:191]
M v[224:227], a[32:35], a[168:171], v[224:227]
 ds_read_b128 a[160:163], v5 offset:49152
 ds_read_b128 a[164:167], v6 offset:49152
M v[224:227], a[36:39], a[172:175], v[224:227]
 ds_read_b64_tr_b16 a[148:149], v3 offset:24576
 ds_read_b64_tr_b16 a[150:151], v3 offset:25600
M v[228:231], a[44:47], a[172:175], v[228:231]
 buffer_load_dwordx4 v10, s[52:55], s28 offen offset:2048   lds
M v[228:231], a[40:43], a[168:171], v[228:231]
 ds_read_b64_tr_b16 a[152:153], v4 offset:16384
 ds_read_b64_tr_b16 a[154:155], v4 offset:17408
M v[232:235], a[48:51], a[168:171], v[232:235]
M v[232:235], a[52:55], a[172:175], v[232:235]
M v[236:239], a[60:63], a[172:175], v[236:239]
 ds_read_b64_tr_b16 a[156:157], v4 offset:24576
 ds_read_b64_tr_b16 a[158:159], v4 offset:25600
M v[236:239], a[56:59], a[168:171], v[236:239]
 buffer_load_dwordx4 v11, s[52:55], s28 offen offset:3072   lds
M v[240:243], a[64:67], a[168:171], v[240:243]
 s_add_u32 s28, s28, 128
M v[240:243], a[68:71], a[172:175], v[240:243]
M v[244:247], a[76:79], a[172:175], v[244:247]
M v[244:247], a[72:75], a[168:171], v[244:247]
M v[248:251], a[80:83], a[168:171], v[248:251]
M v[248:251], a[84:87], a[172:175], v[248:251]
 s_waitcnt lgkmcnt(6)
M v[252:255], a[92:95], a[172:175], v[252:255]
 s_waitcnt vmcnt(30) lgkmcnt(0)
M v[252:255], a[88:91], a[168:171], v[252:255]
 s_barrier
M v[32:35], a[96:99], a[160:163], v[32:35]
 s_add_u32 m0, s23, 16384
 ds_read_b128 a[168:171], v5 offset:51200
 ds_read_b128 a[172:175], v6 offset:51200
M v[32:35], a[100:103], a[164:167], v[32:35]
 ds_read_b64_tr_b16 a[32:33], v1 offset:32768
 ds_read_b64_tr_b16 a[34:35], v1 offset:33792
M v[36:39], a[108:111], a[164:167], v[36:39]
 buffer_load_dwordx4 v8, s[52:55], s28 offen offset:0   lds
M v[36:39], a[104:107], a[160:163], v[36:39]
 v_min_u32 v25, 15, v0
 v_lshlrev_b32 v25, 7, v25
M v[40:43], a[112:115], a[160:163], v[40:43]
 s_add_u32 s3, s93, 274432
 ds_read_b64_tr_b16 a[36:37], v1 offset:40960
 ds_read_b64_tr_b16 a[38:39], v1 offset:41984
M v[40:43], a[116:119], a[164:167], v[40:43]
 v_max_u32 v13, 1024, v25
M v[44:47], a[124:127], a[164:167], v[44:47]
 buffer_store_dwordx4 v[88:91], v7, s[8:11], s3 offen offset:0 sc1
M v[44:47], a[120:123], a[160:163], v[44:47]
 ds_read_b64_tr_b16 a[40:41], v2 offset:32768
 ds_read_b64_tr_b16 a[42:43], v2 offset:33792
M v[48:51], a[128:131], a[160:163], v[48:51]
 buffer_load_dwordx4 v9, s[52:55], s28 offen offset:1024   lds
M v[48:51], a[132:135], a[164:167], v[48:51]
M v[52:55], a[140:143], a[164:167], v[52:55]
 ds_read_b64_tr_b16 a[44:45], v2 offset:40960
 ds_read_b64_tr_b16 a[46:47], v2 offset:41984
M v[52:55], a[136:139], a[160:163], v[52:55]
M v[56:59], a[144:147], a[160:163], v[56:59]
M v[56:59], a[148:151], a[164:167], v[56:59]
 s_waitcnt lgkmcnt(8)
 ds_read_b64_tr_b16 a[48:49], v3 offset:32768
 ds_read_b64_tr_b16 a[50:51], v3 offset:33792
M v[60:63], a[156:159], a[164:167], v[60:63]
 buffer_load_dwordx4 v10, s[52:55], s28 offen offset:2048   lds
M v[60:63], a[152:155], a[160:163], v[60:63]
M v[96:99], a[96:99], a[168:171], v[96:99]
 ds_read_b128 a[160:163], v5 offset:53248
 ds_read_b128 a[164:167], v6 offset:53248
M v[96:99], a[100:103], a[172:175], v[96:99]
 ds_read_b64_tr_b16 a[52:53], v3 offset:40960
 ds_read_b64_tr_b16 a[54:55], v3 offset:41984
M v[100:103], a[108:111], a[172:175], v[100:103]
 buffer_store_dwordx4 v[92:95], v7, s[8:11], s3 offen offset:2048 sc1
M v[100:103], a[104:107], a[168:171], v[100:103]
 ds_read_b64_tr_b16 a[56:57], v4 offset:32768
 ds_read_b64_tr_b16 a[58:59], v4 offset:33792
M v[104:107], a[112:115], a[168:171], v[104:107]
M v[104:107], a[116:119], a[172:175], v[104:107]
 buffer_load_dwordx4 v11, s[52:55], s28 offen offset:3072   lds
M v[108:111], a[124:127], a[172:175], v[108:111]
 s_add_u32 s28, s28, 524160
 ds_read_b64_tr_b16 a[60:61], v4 offset:40960
 ds_read_b64_tr_b16 a[62:63], v4 offset:41984
M v[108:111], a[120:123], a[168:171], v[108:111]
M v[112:115], a[128:131], a[168:171], v[112:115]
M v[112:115], a[132:135], a[172:175], v[112:115]
M v[116:119], a[140:143], a[172:175], v[116:119]
M v[116:119], a[136:139], a[168:171], v[116:119]
M v[120:123], a[144:147], a[168:171], v[120:123]
M v[120:123], a[148:151], a[172:175], v[120:123]
 s_waitcnt lgkmcnt(6)
M v[124:127], a[156:159], a[172:175], v[124:127]
 s_waitcnt vmcnt(25) lgkmcnt(0)
M v[124:127], a[152:155], a[168:171], v[124:127]
 s_barrier
M v[160:163], a[96:99], a[160:163], v[160:163]
 ds_read_b128 a[168:171], v5 offset:55296
 ds_read_b128 a[172:175], v6 offset:55296
M v[160:163], a[100:103], a[164:167], v[160:163]
 ds_read_b64_tr_b16 a[64:65], v1 offset:49152
 ds_read_b64_tr_b16 a[66:67], v1 offset:50176
M v[164:167], a[108:111], a[164:167], v[164:167]
 buffer_store_dwordx4 a[208:211], v30, s[8:11], s89 offen offset:0 sc1
M v[164:167], a[104:107], a[160:163], v[164:167]
M v[168:171], a[112:115], a[160:163], v[168:171]
 ds_read_b64_tr_b16 a[68:69], v1 offset:57344
 ds_read_b64_tr_b16 a[70:71], v1 offset:58368
M v[168:171], a[116:119], a[164:167], v[168:171]
M v[172:175], a[124:127], a[164:167], v[172:175]
M v[172:175], a[120:123], a[160:163], v[172:175]
 ds_read_b64_tr_b16 a[72:73], v2 offset:49152
 ds_read_b64_tr_b16 a[74:75], v2 offset:50176
M v[176:179], a[128:131], a[160:163], v[176:179]
M v[176:179], a[132:135], a[164:167], v[176:179]
M v[180:183], a[140:143], a[164:167], v[180:183]
 ds_read_b64_tr_b16 a[76:77], v2 offset:57344
 ds_read_b64_tr_b16 a[78:79], v2 offset:58368
M v[180:183], a[136:139], a[160:163], v[180:183]
M v[184:187], a[144:147], a[160:163], v[184:187]
M v[184:187], a[148:151], a[164:167], v[184:187]
 s_waitcnt lgkmcnt(8)
 ds_read_b64_tr_b16 a[80:81], v3 offset:49152
 ds_read_b64_tr_b16 a[82:83], v3 offset:50176
M v[188:191], a[156:159], a[164:167], v[188:191]
 buffer_store_dwordx4 a[212:215], v30, s[8:11], s89 offen offset:64 sc1
M v[188:191], a[152:155], a[160:163], v[188:191]
M v[224:227], a[96:99], a[168:171], v[224:227]
 ds_read_b128 a[160:163], v5 offset:0
 ds_read_b128 a[164:167], v6 offset:0
M v[224:227], a[100:103], a[172:175], v[224:227]
 ds_read_b64_tr_b16 a[84:85], v3 offset:57344
 ds_read_b64_tr_b16 a[86:87], v3 offset:58368
M v[228:231], a[108:111], a[172:175], v[228:231]
M v[228:231], a[104:107], a[168:171], v[228:231]
 ds_read_b64_tr_b16 a[88:89], v4 offset:49152
 ds_read_b64_tr_b16 a[90:91], v4 offset:50176
M v[232:235], a[112:115], a[168:171], v[232:235]
M v[232:235], a[116:119], a[172:175], v[232:235]
M v[236:239], a[124:127], a[172:175], v[236:239]
 ds_read_b64_tr_b16 a[92:93], v4 offset:57344
 ds_read_b64_tr_b16 a[94:95], v4 offset:58368
M v[236:239], a[120:123], a[168:171], v[236:239]
M v[240:243], a[128:131], a[168:171], v[240:243]
M v[240:243], a[132:135], a[172:175], v[240:243]
M v[244:247], a[140:143], a[172:175], v[244:247]
M v[244:247], a[136:139], a[168:171], v[244:247]
M v[248:251], a[144:147], a[168:171], v[248:251]
M v[248:251], a[148:151], a[172:175], v[248:251]
 s_waitcnt lgkmcnt(6)
M v[252:255], a[156:159], a[172:175], v[252:255]
 s_waitcnt vmcnt(22) lgkmcnt(0)
M v[252:255], a[152:155], a[168:171], v[252:255]
 s_barrier
M v[32:35], a[32:35], a[160:163], v[32:35]
 s_add_u32 m0, s23, 32768
 ds_read_b128 a[168:171], v5 offset:2048
 ds_read_b128 a[172:175], v6 offset:2048
M v[32:35], a[36:39], a[164:167], v[32:35]
 ds_read_b64_tr_b16 a[96:97], v20 offset:0
 ds_read_b64_tr_b16 a[98:99], v20 offset:1024
M v[36:39], a[44:47], a[164:167], v[36:39]
 buffer_load_dwordx4 v16, s[56:59], s29 offen offset:0   lds
M v[36:39], a[40:43], a[160:163], v[36:39]
 buffer_store_dwordx4 a[216:219], v30, s[8:11], s89 offen offset:128 sc1
M v[40:43], a[48:51], a[160:163], v[40:43]
 ds_read_b64_tr_b16 a[100:101], v20 offset:8192
 ds_read_b64_tr_b16 a[102:103], v20 offset:9216
M v[40:43], a[52:55], a[164:167], v[40:43]
 buffer_load_dwordx4 v17, s[56:59], s29 offen offset:1024   lds
M v[44:47], a[60:63], a[164:167], v[44:47]
M v[44:47], a[56:59], a[160:163], v[44:47]
 ds_read_b64_tr_b16 a[104:105], v21 offset:0
 ds_read_b64_tr_b16 a[106:107], v21 offset:1024
M v[48:51], a[64:67], a[160:163], v[48:51]
M v[48:51], a[68:71], a[164:167], v[48:51]
 buffer_load_dwordx4 v18, s[56:59], s29 offen offset:2048   lds
M v[52:55], a[76:79], a[164:167], v[52:55]
 ds_read_b64_tr_b16 a[108:109], v21 offset:8192
 ds_read_b64_tr_b16 a[110:111], v21 offset:9216
M v[52:55], a[72:75], a[160:163], v[52:55]
 buffer_store_dwordx4 a[220:223], v30, s[8:11], s89 offen offset:192 sc1
M v[56:59], a[80:83], a[160:163], v[56:59]
M v[56:59], a[84:87], a[164:167], v[56:59]
 s_waitcnt lgkmcnt(8)
 ds_read_b64_tr_b16 a[112:113], v22 offset:0
 ds_read_b64_tr_b16 a[114:115], v22 offset:1024
M v[60:63], a[92:95], a[164:167], v[60:63]
 buffer_load_dwordx4 v19, s[56:59], s29 offen offset:3072   lds
M v[60:63], a[88:91], a[160:163], v[60:63]
 s_add_u32 s29, s29, 128
M v[96:99], a[32:35], a[168:171], v[96:99]
 ds_read_b128 a[160:163], v5 offset:4096
 ds_read_b128 a[164:167], v6 offset:4096
M v[96:99], a[36:39], a[172:175], v[96:99]
 ds_read_b64_tr_b16 a[116:117], v22 offset:8192
 ds_read_b64_tr_b16 a[118:119], v22 offset:9216
M v[100:103], a[44:47], a[172:175], v[100:103]
 s_lshl_b32 s28, s20, 13
 buffer_store_dwordx4 a[224:227], v30, s[8:11], s89 offen offset:256 sc1
M v[100:103], a[40:43], a[168:171], v[100:103]
 s_lshl_b32 s21, s41, 20
 ds_read_b64_tr_b16 a[120:121], v23 offset:0
 ds_read_b64_tr_b16 a[122:123], v23 offset:1024
M v[104:107], a[48:51], a[168:171], v[104:107]
 s_mov_b32 s22, 0
M v[104:107], a[52:55], a[172:175], v[104:107]
 s_lshl_b32 s7, s41, 18
M v[108:111], a[60:63], a[172:175], v[108:111]
 s_add_u32 s7, s7, 100663296
 ds_read_b64_tr_b16 a[124:125], v23 offset:8192
 ds_read_b64_tr_b16 a[126:127], v23 offset:9216
M v[108:111], a[56:59], a[168:171], v[108:111]
 s_add_u32 s38, s7, 65536
 buffer_store_dwordx4 a[228:231], v30, s[8:11], s89 offen offset:320 sc1
M v[112:115], a[64:67], a[168:171], v[112:115]
 s_sub_u32 s27, s42, 1
M v[112:115], a[68:71], a[172:175], v[112:115]
 s_mov_b32 s43, 32767
M v[116:119], a[76:79], a[172:175], v[116:119]
 s_mov_b32 s4, 0
 buffer_load_dword v24, v13, s[8:11], s46 offen sc1
M v[116:119], a[72:75], a[168:171], v[116:119]
 s_add_u32 s26, s21, 655360
 buffer_store_dwordx4 a[232:235], v30, s[8:11], s89 offen offset:384 sc1
M v[120:123], a[80:83], a[168:171], v[120:123]
 s_lshl_b32 s64, s42, 1
 s_add_u32 s65, s64, 4
 s_add_u32 s64, s64, 2
M v[120:123], a[84:87], a[172:175], v[120:123]
 s_waitcnt lgkmcnt(6)
 s_add_u32 s3, s93, 524288
M v[124:127], a[92:95], a[172:175], v[124:127]
 s_waitcnt vmcnt(23) lgkmcnt(0)
M v[124:127], a[88:91], a[168:171], v[124:127]
 s_barrier
M v[160:163], a[32:35], a[160:163], v[160:163]
 s_cmp_le_u32 s42, 5
 ds_read_b128 a[168:171], v5 offset:6144
 ds_read_b128 a[172:175], v6 offset:6144
M v[160:163], a[36:39], a[164:167], v[160:163]
 s_cselect_b32 s25, s65, 32767
 ds_read_b64_tr_b16 a[128:129], v20 offset:16384
 ds_read_b64_tr_b16 a[130:131], v20 offset:17408
M v[164:167], a[44:47], a[164:167], v[164:167]
 s_cselect_b32 s6, 14, s64
 buffer_store_dwordx4 v[128:131], v7, s[8:11], s3 offen offset:0 sc1
M v[164:167], a[40:43], a[160:163], v[164:167]
 s_mov_b32 s23, 0
M v[168:171], a[48:51], a[160:163], v[168:171]
 ds_read_b64_tr_b16 a[132:133], v20 offset:24576
 ds_read_b64_tr_b16 a[134:135], v20 offset:25600
M v[168:171], a[52:55], a[164:167], v[168:171]
M v[172:175], a[60:63], a[164:167], v[172:175]
 buffer_store_dwordx4 v[132:135], v7, s[8:11], s3 offen offset:2048 sc1
M v[172:175], a[56:59], a[160:163], v[172:175]
 s_add_u32 s3, s93, 528384
 ds_read_b64_tr_b16 a[136:137], v21 offset:16384
 ds_read_b64_tr_b16 a[138:139], v21 offset:17408
M v[176:179], a[64:67], a[160:163], v[176:179]
M v[176:179], a[68:71], a[164:167], v[176:179]
M v[180:183], a[76:79], a[164:167], v[180:183]
 ds_read_b64_tr_b16 a[140:141], v21 offset:24576
 ds_read_b64_tr_b16 a[142:143], v21 offset:25600
M v[180:183], a[72:75], a[160:163], v[180:183]
 buffer_store_dwordx4 v[136:139], v7, s[8:11], s3 offen offset:0 sc1
M v[184:187], a[80:83], a[160:163], v[184:187]
M v[184:187], a[84:87], a[164:167], v[184:187]
 s_waitcnt lgkmcnt(8)
 ds_read_b64_tr_b16 a[144:145], v22 offset:16384
 ds_read_b64_tr_b16 a[146:147], v22 offset:17408
M v[188:191], a[92:95], a[164:167], v[188:191]
M v[188:191], a[88:91], a[160:163], v[188:191]
 buffer_store_dwordx4 v[140:143], v7, s[8:11], s3 offen offset:2048 sc1
M v[224:227], a[32:35], a[168:171], v[224:227]
 ds_read_b128 a[160:163], v5 offset:16384
 ds_read_b128 a[164:167], v6 offset:16384
M v[224:227], a[36:39], a[172:175], v[224:227]
 s_add_u32 s3, s93, 532480
 ds_read_b64_tr_b16 a[148:149], v22 offset:24576
 ds_read_b64_tr_b16 a[150:151], v22 offset:25600
M v[228:231], a[44:47], a[172:175], v[228:231]
M v[228:231], a[40:43], a[168:171], v[228:231]
 ds_read_b64_tr_b16 a[152:153], v23 offset:16384
 ds_read_b64_tr_b16 a[154:155], v23 offset:17408
M v[232:235], a[48:51], a[168:171], v[232:235]
 buffer_store_dwordx4 v[144:147], v7, s[8:11], s3 offen offset:0 sc1
M v[232:235], a[52:55], a[172:175], v[232:235]
M v[236:239], a[60:63], a[172:175], v[236:239]
 ds_read_b64_tr_b16 a[156:157], v23 offset:24576
 ds_read_b64_tr_b16 a[158:159], v23 offset:25600
M v[236:239], a[56:59], a[168:171], v[236:239]
M v[240:243], a[64:67], a[168:171], v[240:243]
M v[240:243], a[68:71], a[172:175], v[240:243]
M v[244:247], a[76:79], a[172:175], v[244:247]
M v[244:247], a[72:75], a[168:171], v[244:247]
M v[248:251], a[80:83], a[168:171], v[248:251]
M v[248:251], a[84:87], a[172:175], v[248:251]
 s_waitcnt lgkmcnt(6)
M v[252:255], a[92:95], a[172:175], v[252:255]
 s_waitcnt vmcnt(23) lgkmcnt(0)
M v[252:255], a[88:91], a[168:171], v[252:255]
 s_barrier
M v[32:35], a[96:99], a[160:163], v[32:35]
 ds_read_b128 a[168:171], v5 offset:18432
 ds_read_b128 a[172:175], v6 offset:18432
M v[32:35], a[100:103], a[164:167], v[32:35]
 ds_read_b64_tr_b16 a[32:33], v1 offset:0
 ds_read_b64_tr_b16 a[34:35], v1 offset:1024
M v[36:39], a[108:111], a[164:167], v[36:39]
 v_add_u32 v10, s28, v7
 v_add_u32 v11, 0x1000, v10
M v[36:39], a[104:107], a[160:163], v[36:39]
 s_waitcnt vmcnt(6)
 v_cmp_eq_u32 vcc, 0, v24
M v[40:43], a[112:115], a[160:163], v[40:43]
 s_lshl_b32 s64, s20, 10
 ds_read_b64_tr_b16 a[36:37], v1 offset:8192
 ds_read_b64_tr_b16 a[38:39], v1 offset:9216
M v[40:43], a[116:119], a[164:167], v[40:43]
 s_cbranch_vccnz L_f1s04
L_f1r04:
M v[44:47], a[124:127], a[164:167], v[44:47]
 s_add_u32 m0, s28, 98304
 s_nop 0
 buffer_load_dwordx4 v10, s[8:11], s21 offen offset:0 sc1 lds
M v[44:47], a[120:123], a[160:163], v[44:47]
 ds_read_b64_tr_b16 a[40:41], v2 offset:0
 ds_read_b64_tr_b16 a[42:43], v2 offset:1024
M v[48:51], a[128:131], a[160:163], v[48:51]
 buffer_store_dwordx4 v[148:151], v7, s[8:11], s3 offen offset:2048 sc1
M v[48:51], a[132:135], a[164:167], v[48:51]
M v[52:55], a[140:143], a[164:167], v[52:55]
 ds_read_b64_tr_b16 a[44:45], v2 offset:8192
 ds_read_b64_tr_b16 a[46:47], v2 offset:9216
M v[52:55], a[136:139], a[160:163], v[52:55]
 buffer_load_dwordx4 v10, s[8:11], s21 offen offset:1024 sc1 lds
M v[56:59], a[144:147], a[160:163], v[56:59]
M v[56:59], a[148:151], a[164:167], v[56:59]
 s_waitcnt lgkmcnt(8)
 ds_read_b64_tr_b16 a[48:49], v3 offset:0
 ds_read_b64_tr_b16 a[50:51], v3 offset:1024
M v[60:63], a[156:159], a[164:167], v[60:63]
M v[60:63], a[152:155], a[160:163], v[60:63]
 s_add_u32 s3, s93, 536576
 buffer_load_dwordx4 v10, s[8:11], s21 offen offset:2048 sc1 lds
M v[96:99], a[96:99], a[168:171], v[96:99]
 ds_read_b128 a[160:163], v5 offset:20480
 ds_read_b128 a[164:167], v6 offset:20480
M v[96:99], a[100:103], a[172:175], v[96:99]
 ds_read_b64_tr_b16 a[52:53], v3 offset:8192
 ds_read_b64_tr_b16 a[54:55], v3 offset:9216
M v[100:103], a[108:111], a[172:175], v[100:103]
 buffer_store_dwordx4 v[152:155], v7, s[8:11], s3 offen offset:0 sc1
M v[100:103], a[104:107], a[168:171], v[100:103]
 ds_read_b64_tr_b16 a[56:57], v4 offset:0
 ds_read_b64_tr_b16 a[58:59], v4 offset:1024
M v[104:107], a[112:115], a[168:171], v[104:107]
 buffer_load_dwordx4 v10, s[8:11], s21 offen offset:3072 sc1 lds
M v[104:107], a[116:119], a[172:175], v[104:107]
 s_add_u32 m0, s28, 102400
M v[108:111], a[124:127], a[172:175], v[108:111]
 ds_read_b64_tr_b16 a[60:61], v4 offset:8192
 ds_read_b64_tr_b16 a[62:63], v4 offset:9216
M v[108:111], a[120:123], a[168:171], v[108:111]
M v[112:115], a[128:131], a[168:171], v[112:115]
 buffer_load_dwordx4 v11, s[8:11], s21 offen offset:0 sc1 lds
M v[112:115], a[132:135], a[172:175], v[112:115]
M v[116:119], a[140:143], a[172:175], v[116:119]
 buffer_store_dwordx4 v[156:159], v7, s[8:11], s3 offen offset:2048 sc1
M v[116:119], a[136:139], a[168:171], v[116:119]
M v[120:123], a[144:147], a[168:171], v[120:123]
 buffer_load_dwordx4 v11, s[8:11], s21 offen offset:1024 sc1 lds
M v[120:123], a[148:151], a[172:175], v[120:123]
 s_waitcnt lgkmcnt(6)
M v[124:127], a[156:159], a[172:175], v[124:127]
 s_waitcnt lgkmcnt(0)
 buffer_load_dwordx4 v11, s[8:11], s21 offen offset:2048 sc1 lds
M v[124:127], a[152:155], a[168:171], v[124:127]
 s_barrier
M v[160:163], a[96:99], a[160:163], v[160:163]
 ds_read_b128 a[168:171], v5 offset:22528
 ds_read_b128 a[172:175], v6 offset:22528
M v[160:163], a[100:103], a[164:167], v[160:163]
 ds_read_b64_tr_b16 a[64:65], v1 offset:16384
 ds_read_b64_tr_b16 a[66:67], v1 offset:17408
M v[164:167], a[108:111], a[164:167], v[164:167]
 buffer_load_dwordx4 v11, s[8:11], s21 offen offset:3072 sc1 lds
M v[164:167], a[104:107], a[160:163], v[164:167]
 s_add_u32 s24, s23, 16777216
M v[168:171], a[112:115], a[160:163], v[168:171]
 s_mov_b32 s23, s21
 ds_read_b64_tr_b16 a[68:69], v1 offset:24576
 ds_read_b64_tr_b16 a[70:71], v1 offset:25600
M v[168:171], a[116:119], a[164:167], v[168:171]
 s_add_u32 s21, s21, 32768
 s_add_u32 s3, s93, 786432
M v[172:175], a[124:127], a[164:167], v[172:175]
 s_add_u32 s22, s22, 1
 buffer_store_dwordx4 v[192:195], v7, s[8:11], s3 offen offset:0 sc1
M v[172:175], a[120:123], a[160:163], v[172:175]
 s_cmp_eq_u32 s22, s25
 ds_read_b64_tr_b16 a[72:73], v2 offset:16384
 ds_read_b64_tr_b16 a[74:75], v2 offset:17408
M v[176:179], a[128:131], a[160:163], v[176:179]
 s_cselect_b32 s21, s26, s21
 v_subrev_u32 v5, 0x10000, v5
 v_subrev_u32 v6, 0x10000, v6
M v[176:179], a[132:135], a[164:167], v[176:179]
 s_cmp_eq_u32 s22, s43
M v[180:183], a[140:143], a[164:167], v[180:183]
 s_cselect_b32 s21, s4, s21
 ds_read_b64_tr_b16 a[76:77], v2 offset:24576
 ds_read_b64_tr_b16 a[78:79], v2 offset:25600
M v[180:183], a[136:139], a[160:163], v[180:183]
 s_cmp_eq_u32 s22, s6
M v[184:187], a[144:147], a[160:163], v[184:187]
 s_cselect_b32 s21, s7, s21
 v_mov_b32 v9, v25
 v_lshrrev_b32 v24, 4, v0
M v[184:187], a[148:151], a[164:167], v[184:187]
 s_waitcnt lgkmcnt(8)
 ds_read_b64_tr_b16 a[80:81], v3 offset:16384
 ds_read_b64_tr_b16 a[82:83], v3 offset:17408
M v[188:191], a[156:159], a[164:167], v[188:191]
 v_lshlrev_b32 v24, 2, v24
 v_and_b32 v25, 15, v0
M v[188:191], a[152:155], a[160:163], v[188:191]
 v_sub_u32 v24, v24, v25
M v[224:227], a[96:99], a[168:171], v[224:227]
 s_add_u32 s64, s64, s34
 ds_read_b128 a[160:163], v5 offset:32768
 ds_read_b128 a[164:167], v6 offset:32768
M v[224:227], a[100:103], a[172:175], v[224:227]
 s_add_u32 s52, s64, 65536
 ds_read_b64_tr_b16 a[84:85], v3 offset:24576
 ds_read_b64_tr_b16 a[86:87], v3 offset:25600
M v[228:231], a[108:111], a[172:175], v[228:231]
 s_mov_b32 s55, 0x21800000
 buffer_store_dwordx4 v[196:199], v7, s[8:11], s3 offen offset:2048 sc1
M v[228:231], a[104:107], a[168:171], v[228:231]
 s_and_b32 s65, s39, 0
 ds_read_b64_tr_b16 a[88:89], v4 offset:16384
 ds_read_b64_tr_b16 a[90:91], v4 offset:17408
M v[232:235], a[112:115], a[168:171], v[232:235]
 s_cmp_eq_u32 s20, 0
M v[232:235], a[116:119], a[172:175], v[232:235]
 s_cselect_b32 s54, s39, s65
M v[236:239], a[124:127], a[172:175], v[236:239]
 s_lshr_b32 s64, s20, 1
 ds_read_b64_tr_b16 a[92:93], v4 offset:24576
 ds_read_b64_tr_b16 a[94:95], v4 offset:25600
M v[236:239], a[120:123], a[168:171], v[236:239]
 s_lshl_b32 s64, s64, 17
M v[240:243], a[128:131], a[168:171], v[240:243]
 s_and_b32 s65, s20, 1
M v[240:243], a[132:135], a[172:175], v[240:243]
 s_lshl_b32 s65, s65, 12
M v[244:247], a[140:143], a[172:175], v[244:247]
 s_add_u32 s64, s64, s65
 v_add_u32 v14, s64, v7
 v_mov_b32 v8, 0xff800000
M v[244:247], a[136:139], a[168:171], v[244:247]
 v_cmp_lt_i32 s[16:17], 0, v24
 v_cmp_lt_i32 s[18:19], -1, v24
M v[248:251], a[144:147], a[168:171], v[248:251]
 v_cmp_lt_i32 s[48:49], -2, v24
 v_cmp_lt_i32 s[50:51], -3, v24
M v[248:251], a[148:151], a[172:175], v[248:251]
 s_waitcnt lgkmcnt(6)
M v[252:255], a[156:159], a[172:175], v[252:255]
 s_waitcnt lgkmcnt(0)
M v[252:255], a[152:155], a[168:171], v[252:255]
 s_barrier
M v[32:35], a[32:35], a[160:163], v[32:35]
 ds_read_b128 a[168:171], v5 offset:34816
 ds_read_b128 a[172:175], v6 offset:34816
M v[32:35], a[36:39], a[164:167], v[32:35]
 buffer_load_dword v24, v9, s[8:11], s46 offen sc1
M v[36:39], a[44:47], a[164:167], v[36:39]
 v_mov_b32 v1, v15
 v_add_u32 v2, 0x10000, v7
M v[36:39], a[40:43], a[160:163], v[36:39]
 v_mov_b32 v3, v10
 v_mov_b32 v4, v11
M v[40:43], a[48:51], a[160:163], v[40:43]
 s_mov_b64 s[60:61], s[76:77]
M v[40:43], a[52:55], a[164:167], v[40:43]
 s_mov_b32 s62, s78
M v[44:47], a[60:63], a[164:167], v[44:47]
 s_mov_b32 s63, 0x20000
 v_lshl_add_u32 v10, v0, 7, s95
 v_and_b32 v0, 48, v0
M v[44:47], a[56:59], a[160:163], v[44:47]
 v_lshl_add_u32 v0, v0, 24, v10
 v_mul_f32 v32, s5, v32
M v[48:51], a[64:67], a[160:163], v[48:51]
 v_mul_f32 v33, s5, v33
 v_mul_f32 v34, s5, v34
M v[48:51], a[68:71], a[164:167], v[48:51]
 v_mul_f32 v35, s5, v35
 v_mul_f32 v36, s5, v36
M v[52:55], a[76:79], a[164:167], v[52:55]
 v_mul_f32 v37, s5, v37
 v_mul_f32 v38, s5, v38
M v[52:55], a[72:75], a[160:163], v[52:55]
 v_mul_f32 v39, s5, v39
 v_cvt_pk_bf16_f32 v32, v32, v33
M v[56:59], a[80:83], a[160:163], v[56:59]
 v_cvt_pk_bf16_f32 v33, v34, v35
 v_cvt_pk_bf16_f32 v34, v36, v37
M v[56:59], a[84:87], a[164:167], v[56:59]
 s_waitcnt lgkmcnt(0)
 v_cvt_pk_bf16_f32 v35, v38, v39
 ds_write_b128 v14, v[32:35] offset:0
M v[60:63], a[92:95], a[164:167], v[60:63]
 s_add_u32 s3, s93, 790528
 buffer_store_dwordx4 v[200:203], v7, s[8:11], s3 offen offset:0 sc1
M v[60:63], a[88:91], a[160:163], v[60:63]
 v_mul_f32 v40, s5, v40
 v_mul_f32 v41, s5, v41
M v[96:99], a[32:35], a[168:171], v[96:99]
 ds_read_b128 a[160:163], v5 offset:36864
 ds_read_b128 a[164:167], v6 offset:36864
M v[96:99], a[36:39], a[172:175], v[96:99]
 v_mul_f32 v42, s5, v42
 v_mul_f32 v43, s5, v43
M v[100:103], a[44:47], a[172:175], v[100:103]
 v_mul_f32 v44, s5, v44
 v_mul_f32 v45, s5, v45
M v[100:103], a[40:43], a[168:171], v[100:103]
 v_mul_f32 v46, s5, v46
 v_mul_f32 v47, s5, v47
M v[104:107], a[48:51], a[168:171], v[104:107]
 v_cvt_pk_bf16_f32 v40, v40, v41
 v_cvt_pk_bf16_f32 v41, v42, v43
M v[104:107], a[52:55], a[172:175], v[104:107]
 v_cvt_pk_bf16_f32 v42, v44, v45
 v_cvt_pk_bf16_f32 v43, v46, v47
M v[108:111], a[60:63], a[172:175], v[108:111]
 ds_write_b128 v14, v[40:43] offset:1024
M v[108:111], a[56:59], a[168:171], v[108:111]
 buffer_store_dwordx4 v[204:207], v7, s[8:11], s3 offen offset:2048 sc1
M v[112:115], a[64:67], a[168:171], v[112:115]
 v_mul_f32 v48, s5, v48
 v_mul_f32 v49, s5, v49
M v[112:115], a[68:71], a[172:175], v[112:115]
 v_mul_f32 v50, s5, v50
 v_mul_f32 v51, s5, v51
M v[116:119], a[76:79], a[172:175], v[116:119]
 v_mul_f32 v52, s5, v52
 v_mul_f32 v53, s5, v53
M v[116:119], a[72:75], a[168:171], v[116:119]
 v_mul_f32 v54, s5, v54
 v_mul_f32 v55, s5, v55
M v[120:123], a[80:83], a[168:171], v[120:123]
 v_cvt_pk_bf16_f32 v48, v48, v49
 v_cvt_pk_bf16_f32 v49, v50, v51
M v[120:123], a[84:87], a[172:175], v[120:123]
 s_waitcnt lgkmcnt(1)
 v_cvt_pk_bf16_f32 v50, v52, v53
 v_cvt_pk_bf16_f32 v51, v54, v55
M v[124:127], a[92:95], a[172:175], v[124:127]
 ds_write_b128 v14, v[48:51] offset:2048
M v[124:127], a[88:91], a[168:171], v[124:127]
 s_add_u32 s3, s93, 794624
 buffer_store_dwordx4 v[208:211], v7, s[8:11], s3 offen offset:0 sc1
M v[160:163], a[32:35], a[160:163], v[160:163]
 ds_read_b128 a[168:171], v5 offset:38912
 ds_read_b128 a[172:175], v6 offset:38912
M v[160:163], a[36:39], a[164:167], v[160:163]
 v_mul_f32 v56, s5, v56
 v_mul_f32 v57, s5, v57
M v[164:167], a[44:47], a[164:167], v[164:167]
 v_mul_f32 v58, s5, v58
 v_mul_f32 v59, s5, v59
M v[164:167], a[40:43], a[160:163], v[164:167]
 v_mul_f32 v60, s5, v60
 v_mul_f32 v61, s5, v61
M v[168:171], a[48:51], a[160:163], v[168:171]
 v_mul_f32 v62, s5, v62
 v_mul_f32 v63, s5, v63
M v[168:171], a[52:55], a[164:167], v[168:171]
 v_cvt_pk_bf16_f32 v56, v56, v57
 v_cvt_pk_bf16_f32 v57, v58, v59
M v[172:175], a[60:63], a[164:167], v[172:175]
 v_cvt_pk_bf16_f32 v58, v60, v61
 v_cvt_pk_bf16_f32 v59, v62, v63
M v[172:175], a[56:59], a[160:163], v[172:175]
 s_waitcnt lgkmcnt(0)
 ds_write_b128 v14, v[56:59] offset:3072
M v[176:179], a[64:67], a[160:163], v[176:179]
 s_barrier
M v[176:179], a[68:71], a[164:167], v[176:179]
M v[180:183], a[76:79], a[164:167], v[180:183]
 s_add_u32 m0, s28, 32768
 s_nop 0
 buffer_load_dwordx4 v3, s[8:11], s21 offen offset:0 sc1 lds
M v[180:183], a[72:75], a[160:163], v[180:183]
M v[184:187], a[80:83], a[160:163], v[184:187]
 buffer_store_dwordx4 v[212:215], v7, s[8:11], s3 offen offset:2048 sc1
M v[184:187], a[84:87], a[164:167], v[184:187]
 v_mul_f32 v96, s5, v96
 v_mul_f32 v97, s5, v97
M v[188:191], a[92:95], a[164:167], v[188:191]
 buffer_load_dwordx4 v3, s[8:11], s21 offen offset:1024 sc1 lds
M v[188:191], a[88:91], a[160:163], v[188:191]
 v_mul_f32 v98, s5, v98
 v_mul_f32 v99, s5, v99
M v[224:227], a[32:35], a[168:171], v[224:227]
 v_mul_f32 v100, s5, v100
 v_mul_f32 v101, s5, v101
M v[224:227], a[36:39], a[172:175], v[224:227]
 v_mul_f32 v102, s5, v102
 v_mul_f32 v103, s5, v103
M v[228:231], a[44:47], a[172:175], v[228:231]
 buffer_load_dwordx4 v3, s[8:11], s21 offen offset:2048 sc1 lds
M v[228:231], a[40:43], a[168:171], v[228:231]
 v_cvt_pk_bf16_f32 v96, v96, v97
 v_cvt_pk_bf16_f32 v97, v98, v99
M v[232:235], a[48:51], a[168:171], v[232:235]
 v_cvt_pk_bf16_f32 v98, v100, v101
 v_cvt_pk_bf16_f32 v99, v102, v103
M v[232:235], a[52:55], a[172:175], v[232:235]
 ds_write_b128 v14, v[96:99] offset:8192
M v[236:239], a[60:63], a[172:175], v[236:239]
 s_add_u32 s3, s93, 798720
 buffer_load_dwordx4 v3, s[8:11], s21 offen offset:3072 sc1 lds
M v[236:239], a[56:59], a[168:171], v[236:239]
 s_add_u32 m0, s28, 36864
M v[240:243], a[64:67], a[168:171], v[240:243]
 buffer_store_dwordx4 v[216:219], v7, s[8:11], s3 offen offset:0 sc1
M v[240:243], a[68:71], a[172:175], v[240:243]
 v_mul_f32 v104, s5, v104
 v_mul_f32 v105, s5, v105
M v[244:247], a[76:79], a[172:175], v[244:247]
 buffer_load_dwordx4 v4, s[8:11], s21 offen offset:0 sc1 lds
M v[244:247], a[72:75], a[168:171], v[244:247]
 v_mul_f32 v106, s5, v106
 v_mul_f32 v107, s5, v107
M v[248:251], a[80:83], a[168:171], v[248:251]
 v_mul_f32 v108, s5, v108
 v_mul_f32 v109, s5, v109
M v[248:251], a[84:87], a[172:175], v[248:251]
 v_mul_f32 v110, s5, v110
 v_mul_f32 v111, s5, v111
M v[252:255], a[92:95], a[172:175], v[252:255]
 buffer_load_dwordx4 v4, s[8:11], s21 offen offset:1024 sc1 lds
M v[252:255], a[88:91], a[168:171], v[252:255]
 buffer_load_dwordx4 v4, s[8:11], s21 offen offset:2048 sc1 lds
 buffer_load_dwordx4 v4, s[8:11], s21 offen offset:3072 sc1 lds
 s_add_u32 s24, s23, 16777216
 s_mov_b32 s23, s21
 s_add_u32 s21, s21, 32768
 s_add_u32 s22, s22, 1
 s_cmp_eq_u32 s22, s25
 s_cselect_b32 s21, s26, s21
 s_cmp_eq_u32 s22, s43
 s_cselect_b32 s21, s4, s21
 s_cmp_eq_u32 s22, s6
 s_cselect_b32 s21, s7, s21
 v_cvt_pk_bf16_f32 v104, v104, v105
 v_cvt_pk_bf16_f32 v105, v106, v107
 v_cvt_pk_bf16_f32 v106, v108, v109
 v_cvt_pk_bf16_f32 v107, v110, v111
 ds_write_b128 v14, v[104:107] offset:9216
 buffer_store_dwordx4 v[220:223], v7, s[8:11], s3 offen offset:2048 sc1
 v_pk_mul_f32 v[112:113], v[112:113], s[4:5] op_sel:[0,1] op_sel_hi:[1,1]
 v_pk_mul_f32 v[114:115], v[114:115], s[4:5] op_sel:[0,1] op_sel_hi:[1,1]
 v_pk_mul_f32 v[116:117], v[116:117], s[4:5] op_sel:[0,1] op_sel_hi:[1,1]
 v_pk_mul_f32 v[118:119], v[118:119], s[4:5] op_sel:[0,1] op_sel_hi:[1,1]
 v_cvt_pk_bf16_f32 v112, v112, v113
 v_cvt_pk_bf16_f32 v113, v114, v115
 v_cvt_pk_bf16_f32 v114, v116, v117
 v_cvt_pk_bf16_f32 v115, v118, v119
 ds_write_b128 v14, v[112:115] offset:10240
 v_pk_mul_f32 v[120:121], v[120:121], s[4:5] op_sel:[0,1] op_sel_hi:[1,1]
 v_pk_mul_f32 v[122:123], v[122:123], s[4:5] op_sel:[0,1] op_sel_hi:[1,1]
 v_pk_mul_f32 v[124:125], v[124:125], s[4:5] op_sel:[0,1] op_sel_hi:[1,1]
 v_pk_mul_f32 v[126:127], v[126:127], s[4:5] op_sel:[0,1] op_sel_hi:[1,1]
 v_cvt_pk_bf16_f32 v120, v120, v121
 v_cvt_pk_bf16_f32 v121, v122, v123
 v_cvt_pk_bf16_f32 v122, v124, v125
 v_cvt_pk_bf16_f32 v123, v126, v127
 ds_write_b128 v14, v[120:123] offset:11264
 v_pk_mul_f32 v[160:161], v[160:161], s[4:5] op_sel:[0,1] op_sel_hi:[1,1]
 v_pk_mul_f32 v[162:163], v[162:163], s[4:5] op_sel:[0,1] op_sel_hi:[1,1]
 v_pk_mul_f32 v[164:165], v[164:165], s[4:5] op_sel:[0,1] op_sel_hi:[1,1]
 v_pk_mul_f32 v[166:167], v[166:167], s[4:5] op_sel:[0,1] op_sel_hi:[1,1]
 v_cvt_pk_bf16_f32 v160, v160, v161
 v_cvt_pk_bf16_f32 v161, v162, v163
 v_cvt_pk_bf16_f32 v162, v164, v165
 v_cvt_pk_bf16_f32 v163, v166, v167
 ds_write_b128 v14, v[160:163] offset:16384
 v_pk_mul_f32 v[168:169], v[168:169], s[4:5] op_sel:[0,1] op_sel_hi:[1,1]
 v_pk_mul_f32 v[170:171], v[170:171], s[4:5] op_sel:[0,1] op_sel_hi:[1,1]
 v_pk_mul_f32 v[172:173], v[172:173], s[4:5] op_sel:[0,1] op_sel_hi:[1,1]
 v_pk_mul_f32 v[174:175], v[174:175], s[4:5] op_sel:[0,1] op_sel_hi:[1,1]
 v_cvt_pk_bf16_f32 v168, v168, v169
 v_cvt_pk_bf16_f32 v169, v170, v171
 v_cvt_pk_bf16_f32 v170, v172, v173
 v_cvt_pk_bf16_f32 v171, v174, v175
 ds_write_b128 v14, v[168:171] offset:17408
 v_pk_mul_f32 v[176:177], v[176:177], s[4:5] op_sel:[0,1] op_sel_hi:[1,1]
 v_pk_mul_f32 v[178:179], v[178:179], s[4:5] op_sel:[0,1] op_sel_hi:[1,1]
 v_pk_mul_f32 v[180:181], v[180:181], s[4:5] op_sel:[0,1] op_sel_hi:[1,1]
 v_pk_mul_f32 v[182:183], v[182:183], s[4:5] op_sel:[0,1] op_sel_hi:[1,1]
 v_cvt_pk_bf16_f32 v176, v176, v177
 v_cvt_pk_bf16_f32 v177, v178, v179
 v_cvt_pk_bf16_f32 v178, v180, v181
 v_cvt_pk_bf16_f32 v179, v182, v183
 ds_write_b128 v14, v[176:179] offset:18432
 v_pk_mul_f32 v[184:185], v[184:185], s[4:5] op_sel:[0,1] op_sel_hi:[1,1]
 v_pk_mul_f32 v[186:187], v[186:187], s[4:5] op_sel:[0,1] op_sel_hi:[1,1]
 v_pk_mul_f32 v[188:189], v[188:189], s[4:5] op_sel:[0,1] op_sel_hi:[1,1]
 v_pk_mul_f32 v[190:191], v[190:191], s[4:5] op_sel:[0,1] op_sel_hi:[1,1]
 v_cvt_pk_bf16_f32 v184, v184, v185
 v_cvt_pk_bf16_f32 v185, v186, v187
 v_cvt_pk_bf16_f32 v186, v188, v189
 v_cvt_pk_bf16_f32 v187, v190, v191
 ds_write_b128 v14, v[184:187] offset:19456
 v_pk_mul_f32 v[224:225], v[224:225], s[4:5] op_sel:[0,1] op_sel_hi:[1,1]
 v_pk_mul_f32 v[226:227], v[226:227], s[4:5] op_sel:[0,1] op_sel_hi:[1,1]
 v_pk_mul_f32 v[228:229], v[228:229], s[4:5] op_sel:[0,1] op_sel_hi:[1,1]
 v_pk_mul_f32 v[230:231], v[230:231], s[4:5] op_sel:[0,1] op_sel_hi:[1,1]
 v_cvt_pk_bf16_f32 v224, v224, v225
 v_cvt_pk_bf16_f32 v225, v226, v227
 v_cvt_pk_bf16_f32 v226, v228, v229
 v_cvt_pk_bf16_f32 v227, v230, v231
 ds_write_b128 v14, v[224:227] offset:24576
 v_pk_mul_f32 v[232:233], v[232:233], s[4:5] op_sel:[0,1] op_sel_hi:[1,1]
 v_pk_mul_f32 v[234:235], v[234:235], s[4:5] op_sel:[0,1] op_sel_hi:[1,1]
 v_pk_mul_f32 v[236:237], v[236:237], s[4:5] op_sel:[0,1] op_sel_hi:[1,1]
 v_pk_mul_f32 v[238:239], v[238:239], s[4:5] op_sel:[0,1] op_sel_hi:[1,1]
 v_cvt_pk_bf16_f32 v232, v232, v233
 v_cvt_pk_bf16_f32 v233, v234, v235
 v_cvt_pk_bf16_f32 v234, v236, v237
 v_cvt_pk_bf16_f32 v235, v238, v239
 ds_write_b128 v14, v[232:235] offset:25600
 v_pk_mul_f32 v[240:241], v[240:241], s[4:5] op_sel:[0,1] op_sel_hi:[1,1]
 v_pk_mul_f32 v[242:243], v[242:243], s[4:5] op_sel:[0,1] op_sel_hi:[1,1]
 v_pk_mul_f32 v[244:245], v[244:245], s[4:5] op_sel:[0,1] op_sel_hi:[1,1]
 v_pk_mul_f32 v[246:247], v[246:247], s[4:5] op_sel:[0,1] op_sel_hi:[1,1]
 v_cvt_pk_bf16_f32 v240, v240, v241
 v_cvt_pk_bf16_f32 v241, v242, v243
 v_cvt_pk_bf16_f32 v242, v244, v245
 v_cvt_pk_bf16_f32 v243, v246, v247
 ds_write_b128 v14, v[240:243] offset:26624
 v_pk_mul_f32 v[248:249], v[248:249], s[4:5] op_sel:[0,1] op_sel_hi:[1,1]
 v_pk_mul_f32 v[250:251], v[250:251], s[4:5] op_sel:[0,1] op_sel_hi:[1,1]
 v_pk_mul_f32 v[252:253], v[252:253], s[4:5] op_sel:[0,1] op_sel_hi:[1,1]
 v_pk_mul_f32 v[254:255], v[254:255], s[4:5] op_sel:[0,1] op_sel_hi:[1,1]
 v_cvt_pk_bf16_f32 v248, v248, v249
 v_cvt_pk_bf16_f32 v249, v250, v251
 v_cvt_pk_bf16_f32 v250, v252, v253
 v_cvt_pk_bf16_f32 v251, v254, v255
 ds_write_b128 v14, v[248:251] offset:27648
 s_waitcnt vmcnt(17) lgkmcnt(0)
 s_barrier
 ds_read_b128 a[64:67], v2 offset:32768
 ds_read_b128 a[68:71], v2 offset:33792
 ds_read_b128 a[72:75], v2 offset:34816
 ds_read_b128 a[76:79], v2 offset:35840
 ds_read_b128 a[80:83], v2 offset:36864
 ds_read_b128 a[84:87], v2 offset:37888
 ds_read_b128 a[88:91], v2 offset:38912
 ds_read_b128 a[92:95], v2 offset:39936
 s_lshl_b32 s64, s20, 13
 s_sub_u32 s65, 155648, s64
 v_add_u32 v10, s64, v7
 v_add_u32 v11, s65, v7
 ds_read_b128 a[0:3], v10 offset:0
 ds_read_b128 a[4:7], v10 offset:1024
 ds_read_b128 a[8:11], v10 offset:2048
 ds_read_b128 a[12:15], v10 offset:3072
 ds_read_b128 a[16:19], v10 offset:4096
 ds_read_b128 a[20:23], v10 offset:5120
 ds_read_b128 a[24:27], v10 offset:6144
 ds_read_b128 a[28:31], v10 offset:7168
 ds_read_b128 a[32:35], v11 offset:0
 ds_read_b128 a[36:39], v11 offset:1024
 ds_read_b128 a[40:43], v11 offset:2048
 ds_read_b128 a[44:47], v11 offset:3072
 ds_read_b128 a[48:51], v11 offset:4096
 ds_read_b128 a[52:55], v11 offset:5120
 ds_read_b128 a[56:59], v11 offset:6144
 ds_read_b128 a[60:63], v11 offset:7168
 s_waitcnt vmcnt(14)
 v_cmp_eq_u32 vcc, 0, v24
 v_mov_b32 v17, 5
 v_or_b32 v6, s35, v7
 s_cbranch_vccnz L_f1s05
L_f1r05:
 s_mov_b32 s30, s93
 s_mov_b32 s29, s94
 s_cmp_eq_u32 s20, 0
 s_cselect_b32 s5, 0, 0
 v_mov_b32 v32, 0xc1800000
 v_mov_b32 v33, 0xc1800000
 v_mov_b32 v34, 0xc1800000
 v_mov_b32 v35, 0xc1800000
 v_mov_b32 v36, 0xc1800000
 v_mov_b32 v37, 0xc1800000
 v_mov_b32 v38, 0xc1800000
 v_mov_b32 v39, 0xc1800000
 s_waitcnt lgkmcnt(0)
M v[64:67], a[64:67], a[0:3], v[32:35]
 ds_read_b128 a[96:99], v2 offset:40960
 v_mov_b32 v30, 0
M v[64:67], a[68:71], a[4:7], v[64:67]
 s_add_u32 m0, s28, 65536
 ds_read_b128 a[100:103], v2 offset:41984
 v_mov_b32 v31, 0
M v[64:67], a[72:75], a[8:11], v[64:67]
 buffer_load_dwordx4 v3, s[8:11], s24 offen offset:0 sc1 lds
M v[64:67], a[76:79], a[12:15], v[64:67]
 ds_read_b128 a[104:107], v2 offset:43008
M v[64:67], a[80:83], a[16:19], v[64:67]
 ds_read_b128 a[108:111], v2 offset:44032
M v[64:67], a[84:87], a[20:23], v[64:67]
 buffer_load_dwordx4 v3, s[8:11], s24 offen offset:1024 sc1 lds
M v[64:67], a[88:91], a[24:27], v[64:67]
 ds_read_b128 a[112:115], v2 offset:45056
M v[64:67], a[92:95], a[28:31], v[64:67]
 ds_read_b128 a[116:119], v2 offset:46080
M v[68:71], a[92:95], a[60:63], v[36:39]
M v[68:71], a[88:91], a[56:59], v[68:71]
 ds_read_b128 a[120:123], v2 offset:47104
M v[68:71], a[84:87], a[52:55], v[68:71]
 ds_read_b128 a[124:127], v2 offset:48128
M v[68:71], a[80:83], a[48:51], v[68:71]
 buffer_load_dwordx4 v3, s[8:11], s24 offen offset:2048 sc1 lds
M v[68:71], a[76:79], a[44:47], v[68:71]
 v_exp_f32 v18, v64
M v[68:71], a[72:75], a[40:43], v[68:71]
 v_exp_f32 v19, v65
M v[68:71], a[68:71], a[36:39], v[68:71]
 v_exp_f32 v20, v66
M v[68:71], a[64:67], a[32:35], v[68:71]
 s_waitcnt lgkmcnt(0)
 v_exp_f32 v21, v67
M v[72:75], a[96:99], a[0:3], v[32:35]
 ds_read_b128 a[64:67], v2 offset:49152
 v_add_f32 v26, v18, v19
M v[72:75], a[100:103], a[4:7], v[72:75]
 ds_read_b128 a[68:71], v2 offset:50176
 v_cvt_pk_bf16_f32 v40, v18, v19
M v[72:75], a[104:107], a[8:11], v[72:75]
 buffer_load_dwordx4 v3, s[8:11], s24 offen offset:3072 sc1 lds
M v[72:75], a[108:111], a[12:15], v[72:75]
 ds_read_b128 a[72:75], v2 offset:51200
 v_add_f32 v26, v20, v26
M v[72:75], a[112:115], a[16:19], v[72:75]
 s_add_u32 m0, s28, 69632
 ds_read_b128 a[76:79], v2 offset:52224
 v_cvt_pk_bf16_f32 v41, v20, v21
M v[72:75], a[116:119], a[20:23], v[72:75]
 buffer_load_dwordx4 v4, s[8:11], s24 offen offset:0 sc1 lds
M v[72:75], a[120:123], a[24:27], v[72:75]
 ds_read_b128 a[80:83], v2 offset:53248
 v_add_f32 v26, v21, v26
M v[72:75], a[124:127], a[28:31], v[72:75]
 ds_read_b128 a[84:87], v2 offset:54272
M v[76:79], a[124:127], a[60:63], v[36:39]
 v_exp_f32 v22, v68
M v[76:79], a[120:123], a[56:59], v[76:79]
 ds_read_b128 a[88:91], v2 offset:55296
M v[76:79], a[116:119], a[52:55], v[76:79]
 ds_read_b128 a[92:95], v2 offset:56320
M v[76:79], a[112:115], a[48:51], v[76:79]
 buffer_load_dwordx4 v4, s[8:11], s24 offen offset:1024 sc1 lds
M v[76:79], a[108:111], a[44:47], v[76:79]
 v_exp_f32 v23, v69
M v[76:79], a[104:107], a[40:43], v[76:79]
 v_exp_f32 v24, v70
M v[76:79], a[100:103], a[36:39], v[76:79]
 buffer_load_dwordx4 v4, s[8:11], s24 offen offset:2048 sc1 lds
M v[76:79], a[96:99], a[32:35], v[76:79]
 s_waitcnt lgkmcnt(0)
 v_exp_f32 v25, v71
M v[80:83], a[64:67], a[0:3], v[32:35]
 ds_read_b128 a[96:99], v2 offset:57344
 v_add_f32 v27, v22, v23
M v[80:83], a[68:71], a[4:7], v[80:83]
 ds_read_b128 a[100:103], v2 offset:58368
 v_cvt_pk_bf16_f32 v44, v22, v23
M v[80:83], a[72:75], a[8:11], v[80:83]
 v_exp_f32 v18, v72
M v[80:83], a[76:79], a[12:15], v[80:83]
 ds_read_b128 a[104:107], v2 offset:59392
 v_add_f32 v27, v24, v27
M v[80:83], a[80:83], a[16:19], v[80:83]
 ds_read_b128 a[108:111], v2 offset:60416
 v_cvt_pk_bf16_f32 v45, v24, v25
M v[80:83], a[84:87], a[20:23], v[80:83]
 buffer_load_dwordx4 v4, s[8:11], s24 offen offset:3072 sc1 lds
M v[80:83], a[88:91], a[24:27], v[80:83]
 ds_read_b128 a[112:115], v2 offset:61440
 v_add_f32 v27, v25, v27
M v[80:83], a[92:95], a[28:31], v[80:83]
 ds_read_b128 a[116:119], v2 offset:62464
M v[84:87], a[92:95], a[60:63], v[36:39]
 v_exp_f32 v19, v73
M v[84:87], a[88:91], a[56:59], v[84:87]
 ds_read_b128 a[120:123], v2 offset:63488
 v_add_f32 v26, v18, v26
M v[84:87], a[84:87], a[52:55], v[84:87]
 ds_read_b128 a[124:127], v2 offset:64512
 v_cvt_pk_bf16_f32 v42, v18, v19
M v[84:87], a[80:83], a[48:51], v[84:87]
 v_exp_f32 v20, v74
M v[84:87], a[76:79], a[44:47], v[84:87]
 v_exp_f32 v21, v75
M v[84:87], a[72:75], a[40:43], v[84:87]
 v_exp_f32 v22, v76
M v[84:87], a[68:71], a[36:39], v[84:87]
 s_waitcnt vmcnt(8) lgkmcnt(0)
 v_exp_f32 v23, v77
M v[84:87], a[64:67], a[32:35], v[84:87]
 s_barrier
M v[88:91], a[96:99], a[0:3], v[32:35]
 ds_read_b128 a[64:67], v7 offset:32768
 v_add_f32 v26, v19, v26
M v[88:91], a[100:103], a[4:7], v[88:91]
 ds_read_b128 a[68:71], v7 offset:33792
 v_add_f32 v26, v20, v26
M v[88:91], a[104:107], a[8:11], v[88:91]
 buffer_store_dword v17, v1, s[8:11], s45 offen sc1
M v[88:91], a[108:111], a[12:15], v[88:91]
 ds_read_b128 a[72:75], v7 offset:34816
 v_cvt_pk_bf16_f32 v43, v20, v21
M v[88:91], a[112:115], a[16:19], v[88:91]
 ds_read_b128 a[76:79], v7 offset:35840
 v_add_f32 v26, v21, v26
M v[88:91], a[116:119], a[20:23], v[88:91]
 v_exp_f32 v24, v78
M v[88:91], a[120:123], a[24:27], v[88:91]
 ds_read_b128 a[80:83], v7 offset:36864
 v_add_f32 v27, v22, v27
M v[88:91], a[124:127], a[28:31], v[88:91]
 ds_read_b128 a[84:87], v7 offset:37888
 v_cvt_pk_bf16_f32 v46, v22, v23
M v[92:95], a[124:127], a[60:63], v[36:39]
 v_exp_f32 v25, v79
M v[92:95], a[120:123], a[56:59], v[92:95]
 ds_read_b128 a[88:91], v7 offset:38912
 v_add_f32 v27, v23, v27
M v[92:95], a[116:119], a[52:55], v[92:95]
 ds_read_b128 a[92:95], v7 offset:39936
 v_add_f32 v27, v24, v27
M v[92:95], a[112:115], a[48:51], v[92:95]
 v_cvt_pk_bf16_f32 v47, v24, v25
 v_add_f32 v27, v25, v27
M v[92:95], a[108:111], a[44:47], v[92:95]
M v[92:95], a[104:107], a[40:43], v[92:95]
M v[92:95], a[100:103], a[36:39], v[92:95]
 s_waitcnt lgkmcnt(0)
M v[92:95], a[96:99], a[32:35], v[92:95]
 s_cmp_eq_u32 s42, 0
 s_cbranch_scc1 L_j0
M v[96:99], a[64:67], a[0:3], v[32:35]
 s_add_u32 m0, s28, 98304
 ds_read_b128 a[96:99], v7 offset:40960
M v[96:99], a[68:71], a[4:7], v[96:99]
 ds_read_b128 a[100:103], v7 offset:41984
M v[96:99], a[72:75], a[8:11], v[96:99]
 buffer_load_dwordx4 v3, s[8:11], s21 offen offset:0 sc1 lds
M v[96:99], a[76:79], a[12:15], v[96:99]
 s_cmp_eq_u32 s20, 0
 ds_read_b128 a[104:107], v7 offset:43008
M v[96:99], a[80:83], a[16:19], v[96:99]
 s_cselect_b64 s[64:65], s[16:17], 0
 ds_read_b128 a[108:111], v7 offset:44032
M v[96:99], a[84:87], a[20:23], v[96:99]
 buffer_load_dwordx4 v3, s[8:11], s21 offen offset:1024 sc1 lds
M v[96:99], a[88:91], a[24:27], v[96:99]
 s_cselect_b64 s[66:67], s[18:19], 0
 ds_read_b128 a[112:115], v7 offset:45056
M v[96:99], a[92:95], a[28:31], v[96:99]
 s_cselect_b64 s[68:69], s[48:49], 0
 ds_read_b128 a[116:119], v7 offset:46080
M v[100:103], a[92:95], a[60:63], v[36:39]
 s_cselect_b64 s[70:71], s[50:51], 0
 v_exp_f32 v18, v80
M v[100:103], a[88:91], a[56:59], v[100:103]
 s_cmp_lt_u32 s20, 1
 ds_read_b128 a[120:123], v7 offset:47104
M v[100:103], a[84:87], a[52:55], v[100:103]
 s_cselect_b64 s[78:79], -1, 0
 ds_read_b128 a[124:127], v7 offset:48128
M v[100:103], a[80:83], a[48:51], v[100:103]
 buffer_load_dwordx4 v3, s[8:11], s21 offen offset:2048 sc1 lds
M v[100:103], a[76:79], a[44:47], v[100:103]
 s_cmp_eq_u32 s20, 1
 v_exp_f32 v19, v81
M v[100:103], a[72:75], a[40:43], v[100:103]
 s_cselect_b64 s[72:73], s[16:17], s[78:79]
 v_exp_f32 v20, v82
M v[100:103], a[68:71], a[36:39], v[100:103]
 s_cselect_b64 s[74:75], s[18:19], s[78:79]
 v_exp_f32 v21, v83
M v[100:103], a[64:67], a[32:35], v[100:103]
 s_waitcnt lgkmcnt(0)
 v_exp_f32 v22, v88
M v[108:111], a[96:99], a[32:35], v[36:39]
 s_cselect_b64 s[76:77], s[48:49], s[78:79]
 ds_read_b128 a[64:67], v7 offset:49152
 v_add_f32 v26, v18, v26
M v[108:111], a[100:103], a[36:39], v[108:111]
 s_cselect_b64 s[78:79], s[50:51], s[78:79]
 ds_read_b128 a[68:71], v7 offset:50176
 v_cvt_pk_bf16_f32 v56, v18, v19
M v[108:111], a[104:107], a[40:43], v[108:111]
 buffer_load_dwordx4 v3, s[8:11], s21 offen offset:3072 sc1 lds
M v[108:111], a[108:111], a[44:47], v[108:111]
 s_add_u32 m0, s28, 102400
 ds_read_b128 a[72:75], v7 offset:51200
 v_add_f32 v26, v19, v26
M v[108:111], a[112:115], a[48:51], v[108:111]
 s_cmp_lt_u32 s20, 2
 ds_read_b128 a[76:79], v7 offset:52224
 v_add_f32 v26, v20, v26
M v[108:111], a[116:119], a[52:55], v[108:111]
 buffer_load_dwordx4 v4, s[8:11], s21 offen offset:0 sc1 lds
M v[108:111], a[120:123], a[56:59], v[108:111]
 s_cselect_b64 s[86:87], -1, 0
 ds_read_b128 a[80:83], v7 offset:53248
 v_cvt_pk_bf16_f32 v57, v20, v21
M v[108:111], a[124:127], a[60:63], v[108:111]
 s_cmp_eq_u32 s20, 2
 ds_read_b128 a[84:87], v7 offset:54272
 v_add_f32 v26, v21, v26
M v[104:107], a[124:127], a[28:31], v[32:35]
 s_cselect_b64 s[80:81], s[16:17], s[86:87]
 v_exp_f32 v23, v89
M v[104:107], a[120:123], a[24:27], v[104:107]
 s_cselect_b64 s[82:83], s[18:19], s[86:87]
 ds_read_b128 a[88:91], v7 offset:55296
 v_add_f32 v26, v22, v26
M v[104:107], a[116:119], a[20:23], v[104:107]
 s_cselect_b64 s[84:85], s[48:49], s[86:87]
 ds_read_b128 a[92:95], v7 offset:56320
 v_cvt_pk_bf16_f32 v58, v22, v23
M v[104:107], a[112:115], a[16:19], v[104:107]
 buffer_load_dwordx4 v4, s[8:11], s21 offen offset:1024 sc1 lds
M v[104:107], a[108:111], a[12:15], v[104:107]
 s_cselect_b64 s[86:87], s[50:51], s[86:87]
 v_exp_f32 v24, v90
M v[104:107], a[104:107], a[8:11], v[104:107]
 s_cmp_eq_u32 s20, 3
 v_exp_f32 v25, v91
M v[104:107], a[100:103], a[4:7], v[104:107]
 buffer_load_dwordx4 v4, s[8:11], s21 offen offset:2048 sc1 lds
M v[104:107], a[96:99], a[0:3], v[104:107]
 s_waitcnt lgkmcnt(0)
 v_exp_f32 v18, v84
M v[112:115], a[64:67], a[0:3], v[32:35]
 s_cselect_b64 s[88:89], s[16:17], -1
 ds_read_b128 a[96:99], v7 offset:57344
 v_add_f32 v26, v23, v26
M v[112:115], a[68:71], a[4:7], v[112:115]
 s_cselect_b64 s[90:91], s[18:19], -1
 ds_read_b128 a[100:103], v7 offset:58368
 v_add_f32 v26, v24, v26
M v[112:115], a[72:75], a[8:11], v[112:115]
 s_cselect_b64 s[92:93], s[48:49], -1
 v_exp_f32 v19, v85
M v[112:115], a[76:79], a[12:15], v[112:115]
 s_cselect_b64 s[94:95], s[50:51], -1
 ds_read_b128 a[104:107], v7 offset:59392
 v_cvt_pk_bf16_f32 v59, v24, v25
M v[112:115], a[80:83], a[16:19], v[112:115]
 ds_read_b128 a[108:111], v7 offset:60416
 v_add_f32 v26, v25, v26
M v[112:115], a[84:87], a[20:23], v[112:115]
 buffer_load_dwordx4 v4, s[8:11], s21 offen offset:3072 sc1 lds
M v[112:115], a[88:91], a[24:27], v[112:115]
 s_add_u32 s24, s23, 16777216
 ds_read_b128 a[112:115], v7 offset:61440
 v_add_f32 v27, v18, v27
M v[112:115], a[92:95], a[28:31], v[112:115]
 s_mov_b32 s23, s21
 ds_read_b128 a[116:119], v7 offset:62464
 v_cvt_pk_bf16_f32 v60, v18, v19
M v[116:119], a[92:95], a[60:63], v[36:39]
 s_add_u32 s21, s21, 32768
 v_exp_f32 v20, v86
M v[116:119], a[88:91], a[56:59], v[116:119]
 s_add_u32 s22, s22, 1
 ds_read_b128 a[120:123], v7 offset:63488
 v_add_f32 v27, v19, v27
M v[116:119], a[84:87], a[52:55], v[116:119]
 s_cmp_eq_u32 s22, s25
 ds_read_b128 a[124:127], v7 offset:64512
M v[116:119], a[80:83], a[48:51], v[116:119]
 s_cselect_b32 s21, s26, s21
 v_exp_f32 v21, v87
M v[116:119], a[76:79], a[44:47], v[116:119]
 s_cmp_eq_u32 s22, s43
 v_exp_f32 v22, v92
M v[116:119], a[72:75], a[40:43], v[116:119]
 s_cselect_b32 s21, s4, s21
 v_exp_f32 v23, v93
M v[116:119], a[68:71], a[36:39], v[116:119]
 s_waitcnt vmcnt(9) lgkmcnt(0)
 v_add_f32 v27, v20, v27
 v_cvt_pk_bf16_f32 v61, v20, v21
M v[116:119], a[64:67], a[32:35], v[116:119]
 s_barrier
M v[124:127], a[96:99], a[32:35], v[36:39]
 s_cmp_eq_u32 s22, s6
 ds_read_b128 a[64:67], v2 offset:0
 v_add_f32 v27, v21, v27
M v[124:127], a[100:103], a[36:39], v[124:127]
 s_cselect_b32 s21, s7, s21
 ds_read_b128 a[68:71], v2 offset:1024
 v_add_f32 v27, v22, v27
M v[124:127], a[104:107], a[40:43], v[124:127]
 v_exp_f32 v24, v94
M v[124:127], a[108:111], a[44:47], v[124:127]
 ds_read_b128 a[72:75], v2 offset:2048
 v_cvt_pk_bf16_f32 v62, v22, v23
M v[124:127], a[112:115], a[48:51], v[124:127]
 ds_read_b128 a[76:79], v2 offset:3072
 v_add_f32 v27, v23, v27
M v[124:127], a[116:119], a[52:55], v[124:127]
 v_exp_f32 v25, v95
M v[124:127], a[120:123], a[56:59], v[124:127]
 ds_read_b128 a[80:83], v2 offset:4096
 v_add_f32 v27, v24, v27
M v[124:127], a[124:127], a[60:63], v[124:127]
 ds_read_b128 a[84:87], v2 offset:5120
 v_cvt_pk_bf16_f32 v63, v24, v25
M v[120:123], a[124:127], a[28:31], v[32:35]
 v_add_f32 v27, v25, v27
M v[120:123], a[120:123], a[24:27], v[120:123]
 ds_read_b128 a[88:91], v2 offset:6144
 v_max_f32 v10, v26, v27
M v[120:123], a[116:119], a[20:23], v[120:123]
 ds_read_b128 a[92:95], v2 offset:7168
 v_min_f32 v11, v26, v27
M v[120:123], a[112:115], a[16:19], v[120:123]
 v_cmp_lt_f32 s[36:37], s31, v10
M v[120:123], a[108:111], a[12:15], v[120:123]
 v_cmp_gt_f32 vcc, s55, v11
M v[120:123], a[104:107], a[8:11], v[120:123]
M v[120:123], a[100:103], a[4:7], v[120:123]
 s_waitcnt lgkmcnt(0)
 s_or_b64 vcc, vcc, s[36:37]
M v[120:123], a[96:99], a[0:3], v[120:123]
 s_cbranch_vccnz L_st10
L_rt10:
M v[128:131], a[64:67], v[40:43], 0
 s_add_u32 m0, s28, 0
 ds_read_b128 a[96:99], v2 offset:8192
 ds_read_b128 a[100:103], v2 offset:9216
M v[128:131], a[68:71], v[56:59], v[128:131]
 buffer_load_dwordx4 v3, s[8:11], s24 offen offset:0 sc1 lds
M v[132:135], a[68:71], v[60:63], 0
 v_exp_f32 v18, v96
M v[132:135], a[64:67], v[44:47], v[132:135]
 ds_read_b128 a[104:107], v2 offset:10240
 ds_read_b128 a[108:111], v2 offset:11264
M v[140:143], a[72:75], v[44:47], 0
 buffer_load_dwordx4 v3, s[8:11], s24 offen offset:1024 sc1 lds
M v[140:143], a[76:79], v[60:63], v[140:143]
 v_exp_f32 v19, v97
M v[136:139], a[76:79], v[56:59], 0
 ds_read_b128 a[112:115], v2 offset:12288
 ds_read_b128 a[116:119], v2 offset:13312
M v[136:139], a[72:75], v[40:43], v[136:139]
 buffer_load_dwordx4 v3, s[8:11], s24 offen offset:2048 sc1 lds
M v[144:147], a[80:83], v[40:43], 0
 v_exp_f32 v20, v98
M v[144:147], a[84:87], v[56:59], v[144:147]
 ds_read_b128 a[120:123], v2 offset:14336
 ds_read_b128 a[124:127], v2 offset:15360
M v[148:151], a[84:87], v[60:63], 0
 buffer_load_dwordx4 v3, s[8:11], s24 offen offset:3072 sc1 lds
M v[148:151], a[80:83], v[44:47], v[148:151]
 s_add_u32 m0, s28, 4096
 v_exp_f32 v21, v99
M v[156:159], a[88:91], v[44:47], 0
 buffer_load_dwordx4 v4, s[8:11], s24 offen offset:0 sc1 lds
M v[156:159], a[92:95], v[60:63], v[156:159]
 v_add_f32 v30, v26, v30
 v_add_f32 v31, v27, v31
M v[152:155], a[92:95], v[56:59], 0
 v_exp_f32 v22, v104
M v[152:155], a[88:91], v[40:43], v[152:155]
 s_waitcnt lgkmcnt(0)
 v_add_f32 v28, v18, v19
 v_cvt_pk_bf16_f32 v48, v18, v19
M v[160:163], a[96:99], v[40:43], 0
 ds_read_b128 a[64:67], v2 offset:16384
 ds_read_b128 a[68:71], v2 offset:17408
M v[160:163], a[100:103], v[56:59], v[160:163]
 buffer_load_dwordx4 v4, s[8:11], s24 offen offset:1024 sc1 lds
M v[164:167], a[100:103], v[60:63], 0
 v_exp_f32 v23, v105
M v[164:167], a[96:99], v[44:47], v[164:167]
 ds_read_b128 a[72:75], v2 offset:18432
 ds_read_b128 a[76:79], v2 offset:19456
M v[172:175], a[104:107], v[44:47], 0
 buffer_load_dwordx4 v4, s[8:11], s24 offen offset:2048 sc1 lds
M v[172:175], a[108:111], v[60:63], v[172:175]
 v_add_f32 v28, v20, v28
 v_cvt_pk_bf16_f32 v49, v20, v21
M v[168:171], a[108:111], v[56:59], 0
 ds_read_b128 a[80:83], v2 offset:20480
 ds_read_b128 a[84:87], v2 offset:21504
M v[168:171], a[104:107], v[40:43], v[168:171]
 buffer_load_dwordx4 v4, s[8:11], s24 offen offset:3072 sc1 lds
M v[176:179], a[112:115], v[40:43], 0
 v_exp_f32 v24, v106
M v[176:179], a[116:119], v[56:59], v[176:179]
 s_add_u32 m0, s28, 32768
 ds_read_b128 a[88:91], v2 offset:22528
 ds_read_b128 a[92:95], v2 offset:23552
M v[180:183], a[116:119], v[60:63], 0
 buffer_load_dwordx4 v3, s[8:11], s21 offen offset:0 sc1 lds
M v[180:183], a[112:115], v[44:47], v[180:183]
 v_exp_f32 v25, v107
M v[188:191], a[120:123], v[44:47], 0
 buffer_load_dwordx4 v3, s[8:11], s21 offen offset:1024 sc1 lds
M v[188:191], a[124:127], v[60:63], v[188:191]
 v_exp_f32 v18, v100
M v[184:187], a[124:127], v[56:59], 0
 buffer_load_dwordx4 v3, s[8:11], s21 offen offset:2048 sc1 lds
M v[184:187], a[120:123], v[40:43], v[184:187]
 s_waitcnt lgkmcnt(0)
 v_add_f32 v28, v21, v28
 v_add_f32 v28, v22, v28
M v[192:195], a[64:67], v[40:43], 0
 ds_read_b128 a[96:99], v2 offset:24576
 ds_read_b128 a[100:103], v2 offset:25600
M v[192:195], a[68:71], v[56:59], v[192:195]
 buffer_load_dwordx4 v3, s[8:11], s21 offen offset:3072 sc1 lds
M v[196:199], a[68:71], v[60:63], 0
 v_exp_f32 v19, v101
M v[196:199], a[64:67], v[44:47], v[196:199]
 s_add_u32 m0, s28, 36864
 ds_read_b128 a[104:107], v2 offset:26624
 ds_read_b128 a[108:111], v2 offset:27648
M v[204:207], a[72:75], v[44:47], 0
 buffer_load_dwordx4 v4, s[8:11], s21 offen offset:0 sc1 lds
M v[204:207], a[76:79], v[60:63], v[204:207]
 v_exp_f32 v20, v102
M v[200:203], a[76:79], v[56:59], 0
 ds_read_b128 a[112:115], v2 offset:28672
 ds_read_b128 a[116:119], v2 offset:29696
M v[200:203], a[72:75], v[40:43], v[200:203]
 buffer_load_dwordx4 v4, s[8:11], s21 offen offset:1024 sc1 lds
M v[208:211], a[80:83], v[40:43], 0
 v_exp_f32 v21, v103
M v[208:211], a[84:87], v[56:59], v[208:211]
 ds_read_b128 a[120:123], v2 offset:30720
 ds_read_b128 a[124:127], v2 offset:31744
M v[212:215], a[84:87], v[60:63], 0
 buffer_load_dwordx4 v4, s[8:11], s21 offen offset:2048 sc1 lds
M v[212:215], a[80:83], v[44:47], v[212:215]
 v_cvt_pk_bf16_f32 v50, v22, v23
 v_add_f32 v28, v23, v28
M v[220:223], a[88:91], v[44:47], 0
 v_exp_f32 v22, v108
M v[220:223], a[92:95], v[60:63], v[220:223]
 buffer_load_dwordx4 v4, s[8:11], s21 offen offset:3072 sc1 lds
M v[216:219], a[92:95], v[56:59], 0
 s_waitcnt vmcnt(16) lgkmcnt(0)
 s_add_u32 s24, s23, 16777216
 s_mov_b32 s23, s21
M v[216:219], a[88:91], v[40:43], v[216:219]
 s_barrier
M v[224:227], a[96:99], v[40:43], 0
 ds_read_b128 a[64:67], v2 offset:32768
 ds_read_b128 a[68:71], v2 offset:33792
M v[224:227], a[100:103], v[56:59], v[224:227]
 s_add_u32 s21, s21, 32768
 v_add_f32 v28, v24, v28
M v[228:231], a[100:103], v[60:63], 0
 s_add_u32 s22, s22, 1
 v_exp_f32 v23, v109
M v[228:231], a[96:99], v[44:47], v[228:231]
 s_cmp_eq_u32 s22, s25
 ds_read_b128 a[72:75], v2 offset:34816
 ds_read_b128 a[76:79], v2 offset:35840
M v[236:239], a[104:107], v[44:47], 0
 s_cselect_b32 s21, s26, s21
 v_cvt_pk_bf16_f32 v51, v24, v25
 v_add_f32 v28, v25, v28
M v[236:239], a[108:111], v[60:63], v[236:239]
 s_cmp_eq_u32 s22, s43
 v_exp_f32 v24, v110
M v[232:235], a[108:111], v[56:59], 0
 s_cselect_b32 s21, s4, s21
 ds_read_b128 a[80:83], v2 offset:36864
 ds_read_b128 a[84:87], v2 offset:37888
M v[232:235], a[104:107], v[40:43], v[232:235]
 s_cmp_eq_u32 s22, s6
 v_exp_f32 v25, v111
M v[240:243], a[112:115], v[40:43], 0
 s_cselect_b32 s21, s7, s21
 v_add_f32 v29, v18, v19
 v_cvt_pk_bf16_f32 v52, v18, v19
M v[240:243], a[116:119], v[56:59], v[240:243]
 ds_read_b128 a[88:91], v2 offset:38912
 ds_read_b128 a[92:95], v2 offset:39936
M v[244:247], a[116:119], v[60:63], 0
 v_add_f32 v29, v20, v29
 v_cvt_pk_bf16_f32 v53, v20, v21
M v[244:247], a[112:115], v[44:47], v[244:247]
 v_add_f32 v29, v21, v29
 v_add_f32 v29, v22, v29
M v[252:255], a[120:123], v[44:47], 0
 v_cvt_pk_bf16_f32 v54, v22, v23
 v_add_f32 v29, v23, v29
M v[252:255], a[124:127], v[60:63], v[252:255]
 s_cmp_lg_u32 s27, 0
 v_add_f32 v29, v24, v29
 v_cvt_pk_bf16_f32 v55, v24, v25
M v[248:251], a[124:127], v[56:59], 0
 s_waitcnt lgkmcnt(0)
 v_add_f32 v29, v25, v29
M v[248:251], a[120:123], v[40:43], v[248:251]
 s_cbranch_scc1 L_loop_top
 s_branch L_p1
L_j0:
 s_cmp_eq_u32 s20, 0
 s_cselect_b64 s[64:65], s[16:17], 0
 s_cselect_b64 s[66:67], s[18:19], 0
 s_cselect_b64 s[68:69], s[48:49], 0
 s_cselect_b64 s[70:71], s[50:51], 0
 s_cmp_lt_u32 s20, 1
 s_cselect_b64 s[78:79], -1, 0
 s_cmp_eq_u32 s20, 1
 s_cselect_b64 s[72:73], s[16:17], s[78:79]
 s_cselect_b64 s[74:75], s[18:19], s[78:79]
 s_cselect_b64 s[76:77], s[48:49], s[78:79]
 s_cselect_b64 s[78:79], s[50:51], s[78:79]
 s_cmp_lt_u32 s20, 2
 s_cselect_b64 s[86:87], -1, 0
 s_cmp_eq_u32 s20, 2
 s_cselect_b64 s[80:81], s[16:17], s[86:87]
 s_cselect_b64 s[82:83], s[18:19], s[86:87]
 s_cselect_b64 s[84:85], s[48:49], s[86:87]
 s_cselect_b64 s[86:87], s[50:51], s[86:87]
 s_cmp_eq_u32 s20, 3
 s_cselect_b64 s[88:89], s[16:17], -1
 s_cselect_b64 s[90:91], s[18:19], -1
 s_cselect_b64 s[92:93], s[48:49], -1
 s_cselect_b64 s[94:95], s[50:51], -1
 v_mov_b32 v56, 0
 v_mov_b32 v57, 0
 v_mov_b32 v58, 0
 v_mov_b32 v59, 0
 v_accvgpr_write_b32 a242, 0
 v_accvgpr_write_b32 a243, 0
 v_cndmask_b32 v64, v64, v8, s[64:65]
 v_cndmask_b32 v65, v65, v8, s[66:67]
 v_cndmask_b32 v66, v66, v8, s[68:69]
 v_cndmask_b32 v67, v67, v8, s[70:71]
 v_cndmask_b32 v72, v72, v8, s[72:73]
 v_cndmask_b32 v73, v73, v8, s[74:75]
 v_cndmask_b32 v74, v74, v8, s[76:77]
 v_cndmask_b32 v75, v75, v8, s[78:79]
 v_cndmask_b32 v80, v80, v8, s[80:81]
 v_cndmask_b32 v81, v81, v8, s[82:83]
 v_cndmask_b32 v82, v82, v8, s[84:85]
 v_cndmask_b32 v83, v83, v8, s[86:87]
 v_cndmask_b32 v88, v88, v8, s[88:89]
 v_cndmask_b32 v89, v89, v8, s[90:91]
 v_cndmask_b32 v90, v90, v8, s[92:93]
 v_cndmask_b32 v91, v91, v8, s[94:95]
 s_cmp_eq_u32 s20, 3
 s_cselect_b64 s[64:65], s[16:17], 0
 s_cselect_b64 s[66:67], s[18:19], 0
 s_cselect_b64 s[68:69], s[48:49], 0
 s_cselect_b64 s[70:71], s[50:51], 0
 s_cmp_gt_u32 s20, 2
 s_cselect_b64 s[78:79], -1, 0
 s_cmp_eq_u32 s20, 2
 s_cselect_b64 s[72:73], s[16:17], s[78:79]
 s_cselect_b64 s[74:75], s[18:19], s[78:79]
 s_cselect_b64 s[76:77], s[48:49], s[78:79]
 s_cselect_b64 s[78:79], s[50:51], s[78:79]
 s_cmp_gt_u32 s20, 1
 s_cselect_b64 s[86:87], -1, 0
 s_cmp_eq_u32 s20, 1
 s_cselect_b64 s[80:81], s[16:17], s[86:87]
 s_cselect_b64 s[82:83], s[18:19], s[86:87]
 s_cselect_b64 s[84:85], s[48:49], s[86:87]
 s_cselect_b64 s[86:87], s[50:51], s[86:87]
 s_cmp_eq_u32 s20, 0
 s_cselect_b64 s[88:89], s[16:17], -1
 s_cselect_b64 s[90:91], s[18:19], -1
 s_cselect_b64 s[92:93], s[48:49], -1
 s_cselect_b64 s[94:95], s[50:51], -1
 s_add_u32 m0, s28, 98304
 v_max3_f32 v10, v64, v65, v66
 buffer_load_dwordx4 v3, s[8:11], s21 offen offset:0 sc1 lds
 v_max3_f32 v10, v67, v72, v10
 v_max3_f32 v10, v73, v74, v10
 v_max3_f32 v10, v75, v80, v10
 v_max3_f32 v10, v81, v82, v10
 v_max3_f32 v10, v83, v88, v10
 v_max3_f32 v10, v89, v90, v10
 v_max_f32 v10, v91, v10
 v_max3_f32 v11, v68, v69, v70
 v_max3_f32 v11, v71, v76, v11
 v_max3_f32 v11, v77, v78, v11
 v_max3_f32 v11, v79, v84, v11
 v_mfma_f32_32x32x16_bf16 v[128:143], v[56:59], v[56:59], 0
 buffer_load_dwordx4 v3, s[8:11], s21 offen offset:1024 sc1 lds
 v_max3_f32 v11, v85, v86, v11
 v_max3_f32 v11, v87, v92, v11
 v_max3_f32 v11, v93, v94, v11
 v_max_f32 v11, v95, v11
 v_mov_b32 v12, v10
 v_mov_b32 v13, v11
 s_nop 0
 v_permlane16_swap_b32 v12, v10
 v_permlane16_swap_b32 v13, v11
 v_max_f32 v10, v12, v10
 v_max_f32 v11, v13, v11
 v_mov_b32 v12, v10
 buffer_load_dwordx4 v3, s[8:11], s21 offen offset:2048 sc1 lds
 v_mov_b32 v13, v11
 v_mfma_f32_32x32x16_bf16 v[144:159], v[56:59], v[56:59], 0
 v_permlane32_swap_b32 v12, v10
 v_permlane32_swap_b32 v13, v11
 v_max_f32 v10, v12, v10
 v_max_f32 v11, v13, v11
 v_ceil_f32 v10, v10
 v_ceil_f32 v11, v11
 v_sub_f32 v32, v32, v10
 v_sub_f32 v33, v33, v10
 v_sub_f32 v34, v34, v10
 v_sub_f32 v35, v35, v10
 buffer_load_dwordx4 v3, s[8:11], s21 offen offset:3072 sc1 lds
 v_sub_f32 v36, v36, v11
 v_sub_f32 v37, v37, v11
 v_sub_f32 v38, v38, v11
 v_mfma_f32_32x32x16_bf16 v[160:175], v[56:59], v[56:59], 0
 v_sub_f32 v39, v39, v11
 v_sub_f32 v64, v64, v10
 v_sub_f32 v65, v65, v10
 v_sub_f32 v66, v66, v10
 v_sub_f32 v67, v67, v10
 v_sub_f32 v68, v68, v11
 v_sub_f32 v69, v69, v11
 s_add_u32 m0, s28, 102400
 v_sub_f32 v70, v70, v11
 buffer_load_dwordx4 v4, s[8:11], s21 offen offset:0 sc1 lds
 v_sub_f32 v71, v71, v11
 v_sub_f32 v72, v72, v10
 v_sub_f32 v73, v73, v10
 v_sub_f32 v74, v74, v10
 v_mfma_f32_32x32x16_bf16 v[176:191], v[56:59], v[56:59], 0
 v_sub_f32 v75, v75, v10
 v_sub_f32 v76, v76, v11
 v_sub_f32 v77, v77, v11
 v_sub_f32 v78, v78, v11
 v_sub_f32 v79, v79, v11
 v_sub_f32 v80, v80, v10
 v_sub_f32 v81, v81, v10
 buffer_load_dwordx4 v4, s[8:11], s21 offen offset:1024 sc1 lds
 v_sub_f32 v82, v82, v10
 v_sub_f32 v83, v83, v10
 v_sub_f32 v84, v84, v11
 v_sub_f32 v85, v85, v11
 v_sub_f32 v86, v86, v11
 v_sub_f32 v87, v87, v11
 v_mfma_f32_32x32x16_bf16 v[192:207], v[56:59], v[56:59], 0
 v_sub_f32 v88, v88, v10
 v_sub_f32 v89, v89, v10
 v_sub_f32 v90, v90, v10
 v_sub_f32 v91, v91, v10
 v_sub_f32 v92, v92, v11
 buffer_load_dwordx4 v4, s[8:11], s21 offen offset:2048 sc1 lds
 v_sub_f32 v93, v93, v11
 v_sub_f32 v94, v94, v11
 v_sub_f32 v95, v95, v11
 v_exp_f32 v18, v64
 v_exp_f32 v19, v65
 v_exp_f32 v20, v66
 v_add_f32 v26, v18, v19
 v_cvt_pk_bf16_f32 v40, v18, v19
 v_mfma_f32_32x32x16_bf16 v[208:223], v[56:59], v[56:59], 0
 v_exp_f32 v21, v67
 v_exp_f32 v22, v72
 v_add_f32 v26, v20, v26
 buffer_load_dwordx4 v4, s[8:11], s21 offen offset:3072 sc1 lds
 v_cvt_pk_bf16_f32 v41, v20, v21
 v_exp_f32 v23, v73
 v_add_f32 v26, v21, v26
 v_exp_f32 v24, v74
 v_add_f32 v26, v22, v26
 v_cvt_pk_bf16_f32 v42, v22, v23
 v_exp_f32 v25, v75
 v_add_f32 v26, v23, v26
 v_exp_f32 v18, v68
 v_add_f32 v26, v24, v26
 v_mfma_f32_32x32x16_bf16 v[224:239], v[56:59], v[56:59], 0
 s_add_u32 s24, s23, 16777216
 s_mov_b32 s23, s21
 s_add_u32 s21, s21, 32768
 s_add_u32 s22, s22, 1
 s_cmp_eq_u32 s22, s25
 s_cselect_b32 s21, s26, s21
 s_cmp_eq_u32 s22, s43
 s_cselect_b32 s21, s4, s21
 s_cmp_eq_u32 s22, s6
 s_cselect_b32 s21, s7, s21
 v_cvt_pk_bf16_f32 v43, v24, v25
 buffer_load_dword v5, off, s[8:11], s47 sc1
 v_exp_f32 v19, v69
 v_add_f32 v26, v25, v26
 v_mfma_f32_32x32x16_bf16 v[240:255], v[56:59], v[56:59], 0
 v_exp_f32 v20, v70
 v_add_f32 v27, v18, v19
 v_cvt_pk_bf16_f32 v44, v18, v19
 v_exp_f32 v21, v71
 v_exp_f32 v22, v76
 v_add_f32 v27, v20, v27
 v_cvt_pk_bf16_f32 v45, v20, v21
 v_exp_f32 v23, v77
 v_add_f32 v27, v21, v27
 v_exp_f32 v24, v78
 v_add_f32 v27, v22, v27
 v_cvt_pk_bf16_f32 v46, v22, v23
 v_exp_f32 v25, v79
 v_add_f32 v27, v23, v27
 v_add_f32 v27, v24, v27
 v_cvt_pk_bf16_f32 v47, v24, v25
 v_add_f32 v27, v25, v27
 v_cndmask_b32 v100, v36, v8, s[64:65]
 v_cndmask_b32 v101, v36, v8, s[66:67]
 v_cndmask_b32 v102, v36, v8, s[68:69]
 v_cndmask_b32 v103, v36, v8, s[70:71]
 v_cndmask_b32 v108, v36, v8, s[72:73]
 v_cndmask_b32 v109, v36, v8, s[74:75]
 v_cndmask_b32 v110, v36, v8, s[76:77]
 v_cndmask_b32 v111, v36, v8, s[78:79]
 v_cndmask_b32 v116, v36, v8, s[80:81]
 v_cndmask_b32 v117, v36, v8, s[82:83]
 v_cndmask_b32 v118, v36, v8, s[84:85]
 v_cndmask_b32 v119, v36, v8, s[86:87]
 v_cndmask_b32 v124, v36, v8, s[88:89]
 v_cndmask_b32 v125, v36, v8, s[90:91]
 v_cndmask_b32 v126, v36, v8, s[92:93]
 v_cndmask_b32 v127, v36, v8, s[94:95]
 s_branch L_p2
L_kv1:
 s_mov_b32 s60, s90
 s_and_b32 s61, s91, 0xffff
 s_mov_b32 s62, 3670016
 s_mov_b32 s63, 0x20000
 s_waitcnt vmcnt(4) lgkmcnt(0)
 s_barrier
 ds_read_b128 a[160:163], v5 offset:0
 ds_read_b128 a[164:167], v6 offset:0
 ds_read_b64_tr_b16 a[32:33], v1 offset:0
 ds_read_b64_tr_b16 a[34:35], v1 offset:1024
 ds_read_b64_tr_b16 a[36:37], v1 offset:8192
 ds_read_b64_tr_b16 a[38:39], v1 offset:9216
 ds_read_b64_tr_b16 a[40:41], v2 offset:0
 ds_read_b64_tr_b16 a[42:43], v2 offset:1024
 ds_read_b64_tr_b16 a[44:45], v2 offset:8192
 ds_read_b64_tr_b16 a[46:47], v2 offset:9216
 ds_read_b128 a[168:171], v5 offset:2048
 ds_read_b128 a[172:175], v6 offset:2048
 ds_read_b64_tr_b16 a[48:49], v3 offset:0
 ds_read_b64_tr_b16 a[50:51], v3 offset:1024
 ds_read_b64_tr_b16 a[52:53], v3 offset:8192
 ds_read_b64_tr_b16 a[54:55], v3 offset:9216
 ds_read_b64_tr_b16 a[56:57], v4 offset:0
 ds_read_b64_tr_b16 a[58:59], v4 offset:1024
 ds_read_b64_tr_b16 a[60:61], v4 offset:8192
 ds_read_b64_tr_b16 a[62:63], v4 offset:9216
 ds_read_b128 a[176:179], v5 offset:4096
 ds_read_b128 a[180:183], v6 offset:4096
 ds_read_b128 a[184:187], v5 offset:6144
 ds_read_b128 a[188:191], v6 offset:6144
 s_add_u32 m0, s24, 16384
 s_nop 0
 buffer_load_dwordx4 v12, s[48:51], s22 offen offset:0   lds
 buffer_load_dwordx4 v13, s[48:51], s22 offen offset:1024   lds
 buffer_load_dwordx4 v14, s[48:51], s22 offen offset:2048   lds
 buffer_load_dwordx4 v15, s[48:51], s22 offen offset:3072   lds
 s_sub_u32 s22, s22, 2097024
 s_add_u32 m0, s23, 32768
 s_nop 0
 buffer_load_dwordx4 v8, s[16:19], s21 offen offset:0  nt lds
 buffer_load_dwordx4 v9, s[16:19], s21 offen offset:1024  nt lds
 buffer_load_dwordx4 v10, s[16:19], s21 offen offset:2048  nt lds
 buffer_load_dwordx4 v11, s[16:19], s21 offen offset:3072  nt lds
 s_add_u32 s21, s21, 128
 s_waitcnt lgkmcnt(15)
M a[0:3], a[32:35], a[160:163], 0
M a[0:3], a[36:39], a[164:167], a[0:3]
 s_waitcnt lgkmcnt(14)
M a[4:7], a[44:47], a[164:167], 0
M a[4:7], a[40:43], a[160:163], a[4:7]
 s_waitcnt lgkmcnt(8)
M a[8:11], a[48:51], a[160:163], 0
M a[8:11], a[52:55], a[164:167], a[8:11]
 s_waitcnt lgkmcnt(4)
M a[12:15], a[60:63], a[164:167], 0
 s_add_u32 m0, s23, 49152
M a[12:15], a[56:59], a[160:163], a[12:15]
 buffer_load_dwordx4 v8, s[16:19], s21 offen offset:0  nt lds
M v[32:35], a[32:35], a[168:171], 0
 buffer_load_dwordx4 v9, s[16:19], s21 offen offset:1024  nt lds
M v[32:35], a[36:39], a[172:175], v[32:35]
M v[36:39], a[44:47], a[172:175], 0
 buffer_load_dwordx4 v10, s[16:19], s21 offen offset:2048  nt lds
M v[36:39], a[40:43], a[168:171], v[36:39]
M v[40:43], a[48:51], a[168:171], 0
 buffer_load_dwordx4 v11, s[16:19], s21 offen offset:3072  nt lds
M v[40:43], a[52:55], a[172:175], v[40:43]
 s_add_u32 s21, s21, 524160
M v[44:47], a[60:63], a[172:175], 0
 s_waitcnt vmcnt(12) lgkmcnt(0)
M v[44:47], a[56:59], a[168:171], v[44:47]
 s_barrier
M v[64:67], a[32:35], a[176:179], 0
 s_add_u32 m0, s24, 32768
 ds_read_b64_tr_b16 a[64:65], v1 offset:16384
 ds_read_b64_tr_b16 a[66:67], v1 offset:17408
M v[64:67], a[36:39], a[180:183], v[64:67]
 ds_read_b64_tr_b16 a[68:69], v1 offset:24576
 ds_read_b64_tr_b16 a[70:71], v1 offset:25600
M v[68:71], a[44:47], a[180:183], 0
 buffer_load_dwordx4 v12, s[48:51], s22 offen offset:0   lds
M v[68:71], a[40:43], a[176:179], v[68:71]
 ds_read_b64_tr_b16 a[72:73], v2 offset:16384
 ds_read_b64_tr_b16 a[74:75], v2 offset:17408
M v[72:75], a[48:51], a[176:179], 0
 ds_read_b64_tr_b16 a[76:77], v2 offset:24576
 ds_read_b64_tr_b16 a[78:79], v2 offset:25600
M v[72:75], a[52:55], a[180:183], v[72:75]
 buffer_load_dwordx4 v13, s[48:51], s22 offen offset:1024   lds
M v[76:79], a[60:63], a[180:183], 0
 ds_read_b64_tr_b16 a[80:81], v3 offset:16384
 ds_read_b64_tr_b16 a[82:83], v3 offset:17408
M v[76:79], a[56:59], a[176:179], v[76:79]
 ds_read_b64_tr_b16 a[84:85], v3 offset:24576
 ds_read_b64_tr_b16 a[86:87], v3 offset:25600
M v[96:99], a[32:35], a[184:187], 0
 buffer_load_dwordx4 v14, s[48:51], s22 offen offset:2048   lds
M v[96:99], a[36:39], a[188:191], v[96:99]
 ds_read_b64_tr_b16 a[88:89], v4 offset:16384
 ds_read_b64_tr_b16 a[90:91], v4 offset:17408
M v[100:103], a[44:47], a[188:191], 0
 ds_read_b64_tr_b16 a[92:93], v4 offset:24576
 ds_read_b64_tr_b16 a[94:95], v4 offset:25600
M v[100:103], a[40:43], a[184:187], v[100:103]
 buffer_load_dwordx4 v15, s[48:51], s22 offen offset:3072   lds
M v[104:107], a[48:51], a[184:187], 0
 s_add_u32 s22, s22, 2097152
 v_max3_f32 v20, |v32|, |v33|, |v34|
 v_max3_f32 v20, |v35|, |v36|, v20
M v[104:107], a[52:55], a[188:191], v[104:107]
 v_max3_f32 v20, |v37|, |v38|, v20
 v_max3_f32 v21, |v64|, |v65|, |v66|
M v[108:111], a[60:63], a[188:191], 0
 s_add_u32 m0, s23, 0
 v_max3_f32 v21, |v67|, |v68|, v21
 v_max3_f32 v21, |v69|, |v70|, v21
M v[108:111], a[56:59], a[184:187], v[108:111]
 s_waitcnt lgkmcnt(0)
 v_min_f32 v20, v20, v21
 v_mul_f32 v20, 0x41000000, v20
M a[16:19], a[64:67], a[160:163], 0
 buffer_load_dwordx4 v8, s[16:19], s21 offen offset:0  nt lds
M a[16:19], a[68:71], a[164:167], a[16:19]
 v_mov_b32 v21, v20
 v_mov_b32 v22, v20
M a[20:23], a[76:79], a[164:167], 0
 buffer_load_dwordx4 v9, s[16:19], s21 offen offset:1024  nt lds
M a[20:23], a[72:75], a[160:163], a[20:23]
 v_mov_b32 v23, v20
 v_accvgpr_write_b32 a241, v20
M a[24:27], a[80:83], a[160:163], 0
M a[24:27], a[84:87], a[164:167], a[24:27]
M a[28:31], a[92:95], a[164:167], 0
 buffer_load_dwordx4 v10, s[16:19], s21 offen offset:2048  nt lds
M a[28:31], a[88:91], a[160:163], a[28:31]
M v[48:51], a[64:67], a[168:171], v[20:23]
M v[48:51], a[68:71], a[172:175], v[48:51]
 buffer_load_dwordx4 v11, s[16:19], s21 offen offset:3072  nt lds
M v[52:55], a[76:79], a[172:175], v[20:23]
 s_add_u32 s21, s21, 128
M v[52:55], a[72:75], a[168:171], v[52:55]
M v[56:59], a[80:83], a[168:171], v[20:23]
M v[56:59], a[84:87], a[172:175], v[56:59]
M v[60:63], a[92:95], a[172:175], v[20:23]
 s_waitcnt vmcnt(12)
M v[60:63], a[88:91], a[168:171], v[60:63]
 s_barrier
M v[80:83], a[64:67], a[176:179], v[20:23]
 s_add_u32 m0, s24, 49152
 ds_read_b128 a[160:163], v5 offset:16384
 ds_read_b128 a[164:167], v6 offset:16384
M v[80:83], a[68:71], a[180:183], v[80:83]
 buffer_load_dwordx4 v12, s[48:51], s22 offen offset:0   lds
M v[84:87], a[76:79], a[180:183], v[20:23]
 ds_read_b64_tr_b16 a[96:97], v1 offset:32768
 ds_read_b64_tr_b16 a[98:99], v1 offset:33792
M v[84:87], a[72:75], a[176:179], v[84:87]
M v[88:91], a[80:83], a[176:179], v[20:23]
 buffer_load_dwordx4 v13, s[48:51], s22 offen offset:1024   lds
M v[88:91], a[84:87], a[180:183], v[88:91]
 ds_read_b64_tr_b16 a[100:101], v1 offset:40960
 ds_read_b64_tr_b16 a[102:103], v1 offset:41984
M v[92:95], a[92:95], a[180:183], v[20:23]
M v[92:95], a[88:91], a[176:179], v[92:95]
M v[112:115], a[64:67], a[184:187], v[20:23]
 ds_read_b64_tr_b16 a[104:105], v2 offset:32768
 ds_read_b64_tr_b16 a[106:107], v2 offset:33792
M v[112:115], a[68:71], a[188:191], v[112:115]
 buffer_load_dwordx4 v14, s[48:51], s22 offen offset:2048   lds
M v[116:119], a[76:79], a[188:191], v[20:23]
M v[116:119], a[72:75], a[184:187], v[116:119]
 ds_read_b64_tr_b16 a[108:109], v2 offset:40960
 ds_read_b64_tr_b16 a[110:111], v2 offset:41984
M v[120:123], a[80:83], a[184:187], v[20:23]
 buffer_load_dwordx4 v15, s[48:51], s22 offen offset:3072   lds
M v[120:123], a[84:87], a[188:191], v[120:123]
 s_waitcnt lgkmcnt(8)
M v[124:127], a[92:95], a[188:191], v[20:23]
 s_sub_u32 s22, s22, 2097024
M v[124:127], a[88:91], a[184:187], v[124:127]
 s_add_u32 m0, s23, 16384
 ds_read_b64_tr_b16 a[112:113], v3 offset:32768
 ds_read_b64_tr_b16 a[114:115], v3 offset:33792
M v[128:131], a[32:35], a[160:163], v[20:23]
 ds_read_b128 a[168:171], v5 offset:18432
 ds_read_b128 a[172:175], v6 offset:18432
M v[128:131], a[36:39], a[164:167], v[128:131]
 buffer_load_dwordx4 v8, s[16:19], s21 offen offset:0  nt lds
M v[132:135], a[44:47], a[164:167], v[20:23]
 ds_read_b64_tr_b16 a[116:117], v3 offset:40960
 ds_read_b64_tr_b16 a[118:119], v3 offset:41984
M v[132:135], a[40:43], a[160:163], v[132:135]
 buffer_load_dwordx4 v9, s[16:19], s21 offen offset:1024  nt lds
M v[136:139], a[48:51], a[160:163], v[20:23]
M v[136:139], a[52:55], a[164:167], v[136:139]
 ds_read_b64_tr_b16 a[120:121], v4 offset:32768
 ds_read_b64_tr_b16 a[122:123], v4 offset:33792
M v[140:143], a[60:63], a[164:167], v[20:23]
 buffer_load_dwordx4 v10, s[16:19], s21 offen offset:2048  nt lds
M v[140:143], a[56:59], a[160:163], v[140:143]
M v[144:147], a[64:67], a[160:163], v[20:23]
 ds_read_b64_tr_b16 a[124:125], v4 offset:40960
 ds_read_b64_tr_b16 a[126:127], v4 offset:41984
M v[144:147], a[68:71], a[164:167], v[144:147]
 buffer_load_dwordx4 v11, s[16:19], s21 offen offset:3072  nt lds
M v[148:151], a[76:79], a[164:167], v[20:23]
 s_add_u32 s21, s21, 524160
M v[148:151], a[72:75], a[160:163], v[148:151]
M v[152:155], a[80:83], a[160:163], v[20:23]
M v[152:155], a[84:87], a[164:167], v[152:155]
 s_waitcnt lgkmcnt(6)
M v[156:159], a[92:95], a[164:167], v[20:23]
 s_waitcnt vmcnt(16) lgkmcnt(0)
M v[156:159], a[88:91], a[160:163], v[156:159]
 s_barrier
M v[160:163], a[32:35], a[168:171], v[20:23]
 s_add_u32 m0, s24, 0
 ds_read_b128 a[160:163], v5 offset:20480
 ds_read_b128 a[164:167], v6 offset:20480
M v[160:163], a[36:39], a[172:175], v[160:163]
 buffer_load_dwordx4 v12, s[48:51], s22 offen offset:0   lds
M v[164:167], a[44:47], a[172:175], v[20:23]
 ds_read_b64_tr_b16 a[128:129], v1 offset:49152
 ds_read_b64_tr_b16 a[130:131], v1 offset:50176
M v[164:167], a[40:43], a[168:171], v[164:167]
M v[168:171], a[48:51], a[168:171], v[20:23]
 buffer_load_dwordx4 v13, s[48:51], s22 offen offset:1024   lds
M v[168:171], a[52:55], a[172:175], v[168:171]
 ds_read_b64_tr_b16 a[132:133], v1 offset:57344
 ds_read_b64_tr_b16 a[134:135], v1 offset:58368
M v[172:175], a[60:63], a[172:175], v[20:23]
M v[172:175], a[56:59], a[168:171], v[172:175]
M v[176:179], a[64:67], a[168:171], v[20:23]
 ds_read_b64_tr_b16 a[136:137], v2 offset:49152
 ds_read_b64_tr_b16 a[138:139], v2 offset:50176
M v[176:179], a[68:71], a[172:175], v[176:179]
 buffer_load_dwordx4 v14, s[48:51], s22 offen offset:2048   lds
M v[180:183], a[76:79], a[172:175], v[20:23]
M v[180:183], a[72:75], a[168:171], v[180:183]
 ds_read_b64_tr_b16 a[140:141], v2 offset:57344
 ds_read_b64_tr_b16 a[142:143], v2 offset:58368
M v[184:187], a[80:83], a[168:171], v[20:23]
 buffer_load_dwordx4 v15, s[48:51], s22 offen offset:3072   lds
M v[184:187], a[84:87], a[172:175], v[184:187]
 s_waitcnt lgkmcnt(8)
M v[188:191], a[92:95], a[172:175], v[20:23]
 s_add_u32 s22, s22, 2097152
M v[188:191], a[88:91], a[168:171], v[188:191]
 s_add_u32 m0, s23, 32768
 ds_read_b64_tr_b16 a[144:145], v3 offset:49152
 ds_read_b64_tr_b16 a[146:147], v3 offset:50176
M v[192:195], a[32:35], a[160:163], v[20:23]
 ds_read_b128 a[168:171], v5 offset:22528
 ds_read_b128 a[172:175], v6 offset:22528
M v[192:195], a[36:39], a[164:167], v[192:195]
 buffer_load_dwordx4 v8, s[16:19], s21 offen offset:0  nt lds
M v[196:199], a[44:47], a[164:167], v[20:23]
 ds_read_b64_tr_b16 a[148:149], v3 offset:57344
 ds_read_b64_tr_b16 a[150:151], v3 offset:58368
M v[196:199], a[40:43], a[160:163], v[196:199]
 buffer_load_dwordx4 v9, s[16:19], s21 offen offset:1024  nt lds
M v[200:203], a[48:51], a[160:163], v[20:23]
M v[200:203], a[52:55], a[164:167], v[200:203]
 ds_read_b64_tr_b16 a[152:153], v4 offset:49152
 ds_read_b64_tr_b16 a[154:155], v4 offset:50176
M v[204:207], a[60:63], a[164:167], v[20:23]
 buffer_load_dwordx4 v10, s[16:19], s21 offen offset:2048  nt lds
M v[204:207], a[56:59], a[160:163], v[204:207]
M v[208:211], a[64:67], a[160:163], v[20:23]
 ds_read_b64_tr_b16 a[156:157], v4 offset:57344
 ds_read_b64_tr_b16 a[158:159], v4 offset:58368
M v[208:211], a[68:71], a[164:167], v[208:211]
 buffer_load_dwordx4 v11, s[16:19], s21 offen offset:3072  nt lds
M v[212:215], a[76:79], a[164:167], v[20:23]
 s_add_u32 s21, s21, 128
M v[212:215], a[72:75], a[160:163], v[212:215]
M v[216:219], a[80:83], a[160:163], v[20:23]
M v[216:219], a[84:87], a[164:167], v[216:219]
 s_waitcnt lgkmcnt(6)
M v[220:223], a[92:95], a[164:167], v[20:23]
 s_waitcnt vmcnt(16) lgkmcnt(0)
M v[220:223], a[88:91], a[160:163], v[220:223]
 s_barrier
M v[224:227], a[32:35], a[168:171], v[20:23]
 ds_read_b128 a[160:163], v5 offset:32768
 ds_read_b128 a[164:167], v6 offset:32768
M v[224:227], a[36:39], a[172:175], v[224:227]
 buffer_load_dword a240, v24, s[32:35], 0 offen offset:512
M v[228:231], a[44:47], a[172:175], v[20:23]
M v[228:231], a[40:43], a[168:171], v[228:231]
M v[232:235], a[48:51], a[168:171], v[20:23]
M v[232:235], a[52:55], a[172:175], v[232:235]
M v[236:239], a[60:63], a[172:175], v[20:23]
M v[236:239], a[56:59], a[168:171], v[236:239]
M v[240:243], a[64:67], a[168:171], v[20:23]
M v[240:243], a[68:71], a[172:175], v[240:243]
M v[244:247], a[76:79], a[172:175], v[20:23]
M v[244:247], a[72:75], a[168:171], v[244:247]
M v[248:251], a[80:83], a[168:171], v[20:23]
M v[248:251], a[84:87], a[172:175], v[248:251]
 s_waitcnt lgkmcnt(0)
M v[252:255], a[92:95], a[172:175], v[20:23]
M v[252:255], a[88:91], a[168:171], v[252:255]
M a[0:3], a[96:99], a[160:163], a[0:3]
 ds_read_b128 a[168:171], v5 offset:34816
 ds_read_b128 a[172:175], v6 offset:34816
M a[0:3], a[100:103], a[164:167], a[0:3]
 ds_read_b64_tr_b16 a[32:33], v1 offset:0
 ds_read_b64_tr_b16 a[34:35], v1 offset:1024
M a[4:7], a[108:111], a[164:167], a[4:7]
 s_add_u32 m0, s24, 16384
M a[4:7], a[104:107], a[160:163], a[4:7]
 buffer_load_dwordx4 v12, s[48:51], s22 offen offset:0   lds
M a[8:11], a[112:115], a[160:163], a[8:11]
M a[8:11], a[116:119], a[164:167], a[8:11]
M a[12:15], a[124:127], a[164:167], a[12:15]
 ds_read_b64_tr_b16 a[36:37], v1 offset:8192
 ds_read_b64_tr_b16 a[38:39], v1 offset:9216
M a[12:15], a[120:123], a[160:163], a[12:15]
M a[16:19], a[128:131], a[160:163], a[16:19]
 buffer_load_dwordx4 v13, s[48:51], s22 offen offset:1024   lds
M a[16:19], a[132:135], a[164:167], a[16:19]
M a[20:23], a[140:143], a[164:167], a[20:23]
M a[20:23], a[136:139], a[160:163], a[20:23]
 ds_read_b64_tr_b16 a[40:41], v2 offset:0
 ds_read_b64_tr_b16 a[42:43], v2 offset:1024
M a[24:27], a[144:147], a[160:163], a[24:27]
M a[24:27], a[148:151], a[164:167], a[24:27]
 s_waitcnt lgkmcnt(6)
M a[28:31], a[156:159], a[164:167], a[28:31]
 buffer_load_dwordx4 v14, s[48:51], s22 offen offset:2048   lds
M a[28:31], a[152:155], a[160:163], a[28:31]
M v[60:63], a[152:155], a[168:171], v[60:63]
 ds_read_b128 a[160:163], v5 offset:36864
 ds_read_b128 a[164:167], v6 offset:36864
M v[60:63], a[156:159], a[172:175], v[60:63]
 ds_read_b64_tr_b16 a[44:45], v2 offset:8192
 ds_read_b64_tr_b16 a[46:47], v2 offset:9216
M v[56:59], a[148:151], a[172:175], v[56:59]
 buffer_load_dwordx4 v15, s[48:51], s22 offen offset:3072   lds
M v[56:59], a[144:147], a[168:171], v[56:59]
 s_sub_u32 s22, s22, 2097024
M v[52:55], a[136:139], a[168:171], v[52:55]
M v[52:55], a[140:143], a[172:175], v[52:55]
 ds_read_b64_tr_b16 a[48:49], v3 offset:0
 ds_read_b64_tr_b16 a[50:51], v3 offset:1024
M v[48:51], a[132:135], a[172:175], v[48:51]
 s_add_u32 m0, s23, 49152
M v[48:51], a[128:131], a[168:171], v[48:51]
 buffer_load_dwordx4 v8, s[16:19], s21 offen offset:0  nt lds
M v[44:47], a[120:123], a[168:171], v[44:47]
M v[44:47], a[124:127], a[172:175], v[44:47]
M v[40:43], a[116:119], a[172:175], v[40:43]
 ds_read_b64_tr_b16 a[52:53], v3 offset:8192
 ds_read_b64_tr_b16 a[54:55], v3 offset:9216
M v[40:43], a[112:115], a[168:171], v[40:43]
M v[36:39], a[104:107], a[168:171], v[36:39]
 buffer_load_dwordx4 v9, s[16:19], s21 offen offset:1024  nt lds
M v[36:39], a[108:111], a[172:175], v[36:39]
 s_waitcnt lgkmcnt(6)
M v[32:35], a[100:103], a[172:175], v[32:35]
M v[32:35], a[96:99], a[168:171], v[32:35]
 ds_read_b64_tr_b16 a[56:57], v4 offset:0
 ds_read_b64_tr_b16 a[58:59], v4 offset:1024
M v[64:67], a[96:99], a[160:163], v[64:67]
 ds_read_b128 a[168:171], v5 offset:38912
 ds_read_b128 a[172:175], v6 offset:38912
M v[64:67], a[100:103], a[164:167], v[64:67]
 buffer_load_dwordx4 v10, s[16:19], s21 offen offset:2048  nt lds
M v[68:71], a[108:111], a[164:167], v[68:71]
M v[68:71], a[104:107], a[160:163], v[68:71]
M v[72:75], a[112:115], a[160:163], v[72:75]
 ds_read_b64_tr_b16 a[60:61], v4 offset:8192
 ds_read_b64_tr_b16 a[62:63], v4 offset:9216
M v[72:75], a[116:119], a[164:167], v[72:75]
M v[76:79], a[124:127], a[164:167], v[76:79]
 buffer_load_dwordx4 v11, s[16:19], s21 offen offset:3072  nt lds
M v[76:79], a[120:123], a[160:163], v[76:79]
 s_add_u32 s21, s21, 524160
M v[80:83], a[128:131], a[160:163], v[80:83]
M v[80:83], a[132:135], a[164:167], v[80:83]
M v[84:87], a[140:143], a[164:167], v[84:87]
M v[84:87], a[136:139], a[160:163], v[84:87]
M v[88:91], a[144:147], a[160:163], v[88:91]
M v[88:91], a[148:151], a[164:167], v[88:91]
 s_waitcnt lgkmcnt(2)
M v[92:95], a[156:159], a[164:167], v[92:95]
 s_waitcnt vmcnt(17) lgkmcnt(0)
M v[92:95], a[152:155], a[160:163], v[92:95]
 s_barrier
M v[124:127], a[152:155], a[168:171], v[124:127]
 ds_read_b128 a[160:163], v5 offset:49152
 ds_read_b128 a[164:167], v6 offset:49152
M v[124:127], a[156:159], a[172:175], v[124:127]
M v[120:123], a[148:151], a[172:175], v[120:123]
 s_add_u32 m0, s24, 32768
 ds_read_b64_tr_b16 a[64:65], v1 offset:16384
 ds_read_b64_tr_b16 a[66:67], v1 offset:17408
M v[120:123], a[144:147], a[168:171], v[120:123]
 buffer_load_dwordx4 v12, s[48:51], s22 offen offset:0   lds
M v[116:119], a[136:139], a[168:171], v[116:119]
M v[116:119], a[140:143], a[172:175], v[116:119]
M v[112:115], a[132:135], a[172:175], v[112:115]
M v[112:115], a[128:131], a[168:171], v[112:115]
M v[108:111], a[120:123], a[168:171], v[108:111]
M v[108:111], a[124:127], a[172:175], v[108:111]
 ds_read_b64_tr_b16 a[68:69], v1 offset:24576
 ds_read_b64_tr_b16 a[70:71], v1 offset:25600
M v[104:107], a[116:119], a[172:175], v[104:107]
 buffer_load_dwordx4 v13, s[48:51], s22 offen offset:1024   lds
M v[104:107], a[112:115], a[168:171], v[104:107]
M v[100:103], a[104:107], a[168:171], v[100:103]
M v[100:103], a[108:111], a[172:175], v[100:103]
 s_waitcnt lgkmcnt(4)
M v[96:99], a[100:103], a[172:175], v[96:99]
M v[96:99], a[96:99], a[168:171], v[96:99]
M v[128:131], a[96:99], a[160:163], v[128:131]
 ds_read_b128 a[168:171], v5 offset:51200
 ds_read_b128 a[172:175], v6 offset:51200
M v[128:131], a[100:103], a[164:167], v[128:131]
 ds_read_b64_tr_b16 a[72:73], v2 offset:16384
 ds_read_b64_tr_b16 a[74:75], v2 offset:17408
M v[132:135], a[108:111], a[164:167], v[132:135]
 buffer_load_dwordx4 v14, s[48:51], s22 offen offset:2048   lds
M v[132:135], a[104:107], a[160:163], v[132:135]
M v[136:139], a[112:115], a[160:163], v[136:139]
M v[136:139], a[116:119], a[164:167], v[136:139]
M v[140:143], a[124:127], a[164:167], v[140:143]
M v[140:143], a[120:123], a[160:163], v[140:143]
 ds_read_b64_tr_b16 a[76:77], v2 offset:24576
 ds_read_b64_tr_b16 a[78:79], v2 offset:25600
M v[144:147], a[128:131], a[160:163], v[144:147]
 buffer_load_dwordx4 v15, s[48:51], s22 offen offset:3072   lds
M v[144:147], a[132:135], a[164:167], v[144:147]
 s_add_u32 s22, s22, 2097152
M v[148:151], a[140:143], a[164:167], v[148:151]
M v[148:151], a[136:139], a[160:163], v[148:151]
M v[152:155], a[144:147], a[160:163], v[152:155]
M v[152:155], a[148:151], a[164:167], v[152:155]
 s_waitcnt lgkmcnt(4)
M v[156:159], a[156:159], a[164:167], v[156:159]
 s_add_u32 m0, s23, 0
 ds_read_b64_tr_b16 a[80:81], v3 offset:16384
 ds_read_b64_tr_b16 a[82:83], v3 offset:17408
M v[156:159], a[152:155], a[160:163], v[156:159]
 buffer_load_dwordx4 v8, s[16:19], s21 offen offset:0  nt lds
M v[188:191], a[152:155], a[168:171], v[188:191]
 ds_read_b128 a[160:163], v5 offset:53248
 ds_read_b128 a[164:167], v6 offset:53248
M v[188:191], a[156:159], a[172:175], v[188:191]
M v[184:187], a[148:151], a[172:175], v[184:187]
M v[184:187], a[144:147], a[168:171], v[184:187]
M v[180:183], a[136:139], a[168:171], v[180:183]
M v[180:183], a[140:143], a[172:175], v[180:183]
 ds_read_b64_tr_b16 a[84:85], v3 offset:24576
 ds_read_b64_tr_b16 a[86:87], v3 offset:25600
M v[176:179], a[132:135], a[172:175], v[176:179]
 buffer_load_dwordx4 v9, s[16:19], s21 offen offset:1024  nt lds
M v[176:179], a[128:131], a[168:171], v[176:179]
M v[172:175], a[120:123], a[168:171], v[172:175]
M v[172:175], a[124:127], a[172:175], v[172:175]
M v[168:171], a[116:119], a[172:175], v[168:171]
M v[168:171], a[112:115], a[168:171], v[168:171]
M v[164:167], a[104:107], a[168:171], v[164:167]
 ds_read_b64_tr_b16 a[88:89], v4 offset:16384
 ds_read_b64_tr_b16 a[90:91], v4 offset:17408
M v[164:167], a[108:111], a[172:175], v[164:167]
 s_waitcnt lgkmcnt(4)
M v[160:163], a[100:103], a[172:175], v[160:163]
 buffer_load_dwordx4 v10, s[16:19], s21 offen offset:2048  nt lds
M v[160:163], a[96:99], a[168:171], v[160:163]
M v[192:195], a[96:99], a[160:163], v[192:195]
 ds_read_b128 a[168:171], v5 offset:55296
 ds_read_b128 a[172:175], v6 offset:55296
M v[192:195], a[100:103], a[164:167], v[192:195]
M v[196:199], a[108:111], a[164:167], v[196:199]
M v[196:199], a[104:107], a[160:163], v[196:199]
 ds_read_b64_tr_b16 a[92:93], v4 offset:24576
 ds_read_b64_tr_b16 a[94:95], v4 offset:25600
M v[200:203], a[112:115], a[160:163], v[200:203]
 buffer_load_dwordx4 v11, s[16:19], s21 offen offset:3072  nt lds
M v[200:203], a[116:119], a[164:167], v[200:203]
 s_add_u32 s21, s21, 128
M v[204:207], a[124:127], a[164:167], v[204:207]
M v[204:207], a[120:123], a[160:163], v[204:207]
M v[208:211], a[128:131], a[160:163], v[208:211]
M v[208:211], a[132:135], a[164:167], v[208:211]
M v[212:215], a[140:143], a[164:167], v[212:215]
M v[212:215], a[136:139], a[160:163], v[212:215]
M v[216:219], a[144:147], a[160:163], v[216:219]
M v[216:219], a[148:151], a[164:167], v[216:219]
 s_waitcnt lgkmcnt(2)
M v[220:223], a[156:159], a[164:167], v[220:223]
 s_waitcnt vmcnt(17) lgkmcnt(0)
M v[220:223], a[152:155], a[160:163], v[220:223]
 s_barrier
M v[252:255], a[152:155], a[168:171], v[252:255]
 ds_read_b128 a[160:163], v5 offset:0
 ds_read_b128 a[164:167], v6 offset:0
M v[252:255], a[156:159], a[172:175], v[252:255]
M v[248:251], a[148:151], a[172:175], v[248:251]
M v[248:251], a[144:147], a[168:171], v[248:251]
M v[244:247], a[136:139], a[168:171], v[244:247]
M v[244:247], a[140:143], a[172:175], v[244:247]
M v[240:243], a[132:135], a[172:175], v[240:243]
M v[240:243], a[128:131], a[168:171], v[240:243]
M v[236:239], a[120:123], a[168:171], v[236:239]
M v[236:239], a[124:127], a[172:175], v[236:239]
M v[232:235], a[116:119], a[172:175], v[232:235]
M v[232:235], a[112:115], a[168:171], v[232:235]
M v[228:231], a[104:107], a[168:171], v[228:231]
M v[228:231], a[108:111], a[172:175], v[228:231]
 s_waitcnt lgkmcnt(0)
M v[224:227], a[100:103], a[172:175], v[224:227]
M v[224:227], a[96:99], a[168:171], v[224:227]
M a[0:3], a[32:35], a[160:163], a[0:3]
 ds_read_b128 a[168:171], v5 offset:2048
 ds_read_b128 a[172:175], v6 offset:2048
M a[0:3], a[36:39], a[164:167], a[0:3]
 ds_read_b64_tr_b16 a[96:97], v1 offset:32768
 ds_read_b64_tr_b16 a[98:99], v1 offset:33792
M a[4:7], a[44:47], a[164:167], a[4:7]
 s_add_u32 m0, s24, 49152
M a[4:7], a[40:43], a[160:163], a[4:7]
 buffer_load_dwordx4 v12, s[48:51], s22 offen offset:0   lds
M a[8:11], a[48:51], a[160:163], a[8:11]
M a[8:11], a[52:55], a[164:167], a[8:11]
M a[12:15], a[60:63], a[164:167], a[12:15]
 ds_read_b64_tr_b16 a[100:101], v1 offset:40960
 ds_read_b64_tr_b16 a[102:103], v1 offset:41984
M a[12:15], a[56:59], a[160:163], a[12:15]
M a[16:19], a[64:67], a[160:163], a[16:19]
 buffer_load_dwordx4 v13, s[48:51], s22 offen offset:1024   lds
M a[16:19], a[68:71], a[164:167], a[16:19]
M a[20:23], a[76:79], a[164:167], a[20:23]
 v_mov_b32 v16, 0x3f80
M a[20:23], a[72:75], a[160:163], a[20:23]
 ds_read_b64_tr_b16 a[104:105], v2 offset:32768
 ds_read_b64_tr_b16 a[106:107], v2 offset:33792
M a[24:27], a[80:83], a[160:163], a[24:27]
 v_lshrrev_b32 v17, 8, v7
M a[24:27], a[84:87], a[164:167], a[24:27]
 s_waitcnt lgkmcnt(6)
 v_bfe_u32 v18, v7, 6, 2
M a[28:31], a[92:95], a[164:167], a[28:31]
 buffer_load_dwordx4 v14, s[48:51], s22 offen offset:2048   lds
M a[28:31], a[88:91], a[160:163], a[28:31]
 v_and_b32 v19, 16, v7
M v[60:63], a[88:91], a[168:171], v[60:63]
 ds_read_b128 a[160:163], v5 offset:4096
 ds_read_b128 a[164:167], v6 offset:4096
M v[60:63], a[92:95], a[172:175], v[60:63]
 ds_read_b64_tr_b16 a[108:109], v2 offset:40960
 ds_read_b64_tr_b16 a[110:111], v2 offset:41984
M v[56:59], a[84:87], a[172:175], v[56:59]
 buffer_load_dwordx4 v15, s[48:51], s22 offen offset:3072   lds
M v[56:59], a[80:83], a[168:171], v[56:59]
 s_sub_u32 s22, s22, 2097024
 v_lshlrev_b32 v19, v19, v16
M v[52:55], a[72:75], a[168:171], v[52:55]
 v_cmp_eq_u32 vcc, v17, v18
M v[52:55], a[76:79], a[172:175], v[52:55]
 ds_read_b64_tr_b16 a[112:113], v3 offset:32768
 ds_read_b64_tr_b16 a[114:115], v3 offset:33792
M v[48:51], a[68:71], a[172:175], v[48:51]
 s_add_u32 m0, s23, 16384
 v_and_b32 v16, 32, v7
M v[48:51], a[64:67], a[168:171], v[48:51]
 buffer_load_dwordx4 v8, s[16:19], s21 offen offset:0  nt lds
M v[44:47], a[56:59], a[168:171], v[44:47]
 v_accvgpr_write_b32 a244, 0
M v[44:47], a[60:63], a[172:175], v[44:47]
 v_accvgpr_write_b32 a245, 0
M v[40:43], a[52:55], a[172:175], v[40:43]
 ds_read_b64_tr_b16 a[116:117], v3 offset:40960
 ds_read_b64_tr_b16 a[118:119], v3 offset:41984
M v[40:43], a[48:51], a[168:171], v[40:43]
 v_cndmask_b32 v19, 0, v19, vcc
M v[36:39], a[40:43], a[168:171], v[36:39]
 buffer_load_dwordx4 v9, s[16:19], s21 offen offset:1024  nt lds
M v[36:39], a[44:47], a[172:175], v[36:39]
 s_waitcnt lgkmcnt(6)
 v_cmp_eq_u32 vcc, 0, v16
M v[32:35], a[36:39], a[172:175], v[32:35]
 v_accvgpr_write_b32 a248, 0
M v[32:35], a[32:35], a[168:171], v[32:35]
 ds_read_b64_tr_b16 a[120:121], v4 offset:32768
 ds_read_b64_tr_b16 a[122:123], v4 offset:33792
M v[64:67], a[32:35], a[160:163], v[64:67]
 ds_read_b128 a[168:171], v5 offset:6144
 ds_read_b128 a[172:175], v6 offset:6144
M v[64:67], a[36:39], a[164:167], v[64:67]
 buffer_load_dwordx4 v10, s[16:19], s21 offen offset:2048  nt lds
M v[68:71], a[44:47], a[164:167], v[68:71]
 v_accvgpr_write_b32 a249, 0
M v[68:71], a[40:43], a[160:163], v[68:71]
 v_cndmask_b32 v17, 0, v19, vcc
M v[72:75], a[48:51], a[160:163], v[72:75]
 ds_read_b64_tr_b16 a[124:125], v4 offset:40960
 ds_read_b64_tr_b16 a[126:127], v4 offset:41984
M v[72:75], a[52:55], a[164:167], v[72:75]
 v_sub_u32 v18, v19, v17
M v[76:79], a[60:63], a[164:167], v[76:79]
 buffer_load_dwordx4 v11, s[16:19], s21 offen offset:3072  nt lds
M v[76:79], a[56:59], a[160:163], v[76:79]
 s_add_u32 s21, s21, 524160
 v_accvgpr_write_b32 a246, v17
M v[80:83], a[64:67], a[160:163], v[80:83]
 v_accvgpr_write_b32 a247, v18
M v[80:83], a[68:71], a[164:167], v[80:83]
M v[84:87], a[76:79], a[164:167], v[84:87]
M v[84:87], a[72:75], a[160:163], v[84:87]
M v[88:91], a[80:83], a[160:163], v[88:91]
M v[88:91], a[84:87], a[164:167], v[88:91]
 s_waitcnt lgkmcnt(2)
M v[92:95], a[92:95], a[164:167], v[92:95]
 s_waitcnt vmcnt(16) lgkmcnt(0)
M v[92:95], a[88:91], a[160:163], v[92:95]
 s_barrier
M v[124:127], a[88:91], a[168:171], v[124:127]
 ds_read_b128 a[160:163], v5 offset:16384
 ds_read_b128 a[164:167], v6 offset:16384
M v[124:127], a[92:95], a[172:175], v[124:127]
M v[120:123], a[84:87], a[172:175], v[120:123]
 s_add_u32 m0, s24, 0
 ds_read_b64_tr_b16 a[128:129], v1 offset:49152
 ds_read_b64_tr_b16 a[130:131], v1 offset:50176
M v[120:123], a[80:83], a[168:171], v[120:123]
 buffer_load_dwordx4 v12, s[48:51], s22 offen offset:0   lds
M v[116:119], a[72:75], a[168:171], v[116:119]
M v[116:119], a[76:79], a[172:175], v[116:119]
M v[112:115], a[68:71], a[172:175], v[112:115]
M v[112:115], a[64:67], a[168:171], v[112:115]
M v[108:111], a[56:59], a[168:171], v[108:111]
M v[108:111], a[60:63], a[172:175], v[108:111]
 ds_read_b64_tr_b16 a[132:133], v1 offset:57344
 ds_read_b64_tr_b16 a[134:135], v1 offset:58368
M v[104:107], a[52:55], a[172:175], v[104:107]
 buffer_load_dwordx4 v13, s[48:51], s22 offen offset:1024   lds
M v[104:107], a[48:51], a[168:171], v[104:107]
M v[100:103], a[40:43], a[168:171], v[100:103]
M v[100:103], a[44:47], a[172:175], v[100:103]
 s_waitcnt lgkmcnt(4)
M v[96:99], a[36:39], a[172:175], v[96:99]
M v[96:99], a[32:35], a[168:171], v[96:99]
M v[128:131], a[32:35], a[160:163], v[128:131]
 ds_read_b128 a[168:171], v5 offset:18432
 ds_read_b128 a[172:175], v6 offset:18432
M v[128:131], a[36:39], a[164:167], v[128:131]
 ds_read_b64_tr_b16 a[136:137], v2 offset:49152
 ds_read_b64_tr_b16 a[138:139], v2 offset:50176
M v[132:135], a[44:47], a[164:167], v[132:135]
 buffer_load_dwordx4 v14, s[48:51], s22 offen offset:2048   lds
M v[132:135], a[40:43], a[160:163], v[132:135]
M v[136:139], a[48:51], a[160:163], v[136:139]
M v[136:139], a[52:55], a[164:167], v[136:139]
M v[140:143], a[60:63], a[164:167], v[140:143]
M v[140:143], a[56:59], a[160:163], v[140:143]
 ds_read_b64_tr_b16 a[140:141], v2 offset:57344
 ds_read_b64_tr_b16 a[142:143], v2 offset:58368
M v[144:147], a[64:67], a[160:163], v[144:147]
 buffer_load_dwordx4 v15, s[48:51], s22 offen offset:3072   lds
M v[144:147], a[68:71], a[164:167], v[144:147]
 s_add_u32 s22, s22, 2097152
M v[148:151], a[76:79], a[164:167], v[148:151]
M v[148:151], a[72:75], a[160:163], v[148:151]
M v[152:155], a[80:83], a[160:163], v[152:155]
M v[152:155], a[84:87], a[164:167], v[152:155]
 s_waitcnt lgkmcnt(4)
M v[156:159], a[92:95], a[164:167], v[156:159]
 s_add_u32 m0, s23, 32768
 ds_read_b64_tr_b16 a[144:145], v3 offset:49152
 ds_read_b64_tr_b16 a[146:147], v3 offset:50176
M v[156:159], a[88:91], a[160:163], v[156:159]
 buffer_load_dwordx4 v8, s[16:19], s21 offen offset:0  nt lds
M v[188:191], a[88:91], a[168:171], v[188:191]
 ds_read_b128 a[160:163], v5 offset:20480
 ds_read_b128 a[164:167], v6 offset:20480
M v[188:191], a[92:95], a[172:175], v[188:191]
M v[184:187], a[84:87], a[172:175], v[184:187]
M v[184:187], a[80:83], a[168:171], v[184:187]
M v[180:183], a[72:75], a[168:171], v[180:183]
M v[180:183], a[76:79], a[172:175], v[180:183]
 ds_read_b64_tr_b16 a[148:149], v3 offset:57344
 ds_read_b64_tr_b16 a[150:151], v3 offset:58368
M v[176:179], a[68:71], a[172:175], v[176:179]
 buffer_load_dwordx4 v9, s[16:19], s21 offen offset:1024  nt lds
M v[176:179], a[64:67], a[168:171], v[176:179]
M v[172:175], a[56:59], a[168:171], v[172:175]
M v[172:175], a[60:63], a[172:175], v[172:175]
M v[168:171], a[52:55], a[172:175], v[168:171]
M v[168:171], a[48:51], a[168:171], v[168:171]
M v[164:167], a[40:43], a[168:171], v[164:167]
 ds_read_b64_tr_b16 a[152:153], v4 offset:49152
 ds_read_b64_tr_b16 a[154:155], v4 offset:50176
M v[164:167], a[44:47], a[172:175], v[164:167]
 s_waitcnt lgkmcnt(4)
M v[160:163], a[36:39], a[172:175], v[160:163]
 buffer_load_dwordx4 v10, s[16:19], s21 offen offset:2048  nt lds
M v[160:163], a[32:35], a[168:171], v[160:163]
M v[192:195], a[32:35], a[160:163], v[192:195]
 ds_read_b128 a[168:171], v5 offset:22528
 ds_read_b128 a[172:175], v6 offset:22528
M v[192:195], a[36:39], a[164:167], v[192:195]
M v[196:199], a[44:47], a[164:167], v[196:199]
M v[196:199], a[40:43], a[160:163], v[196:199]
 ds_read_b64_tr_b16 a[156:157], v4 offset:57344
 ds_read_b64_tr_b16 a[158:159], v4 offset:58368
M v[200:203], a[48:51], a[160:163], v[200:203]
 buffer_load_dwordx4 v11, s[16:19], s21 offen offset:3072  nt lds
M v[200:203], a[52:55], a[164:167], v[200:203]
 s_add_u32 s21, s21, 128
M v[204:207], a[60:63], a[164:167], v[204:207]
M v[204:207], a[56:59], a[160:163], v[204:207]
M v[208:211], a[64:67], a[160:163], v[208:211]
M v[208:211], a[68:71], a[164:167], v[208:211]
M v[212:215], a[76:79], a[164:167], v[212:215]
M v[212:215], a[72:75], a[160:163], v[212:215]
M v[216:219], a[80:83], a[160:163], v[216:219]
M v[216:219], a[84:87], a[164:167], v[216:219]
 s_waitcnt lgkmcnt(2)
M v[220:223], a[92:95], a[164:167], v[220:223]
 s_waitcnt vmcnt(16) lgkmcnt(0)
M v[220:223], a[88:91], a[160:163], v[220:223]
 s_barrier
M v[252:255], a[88:91], a[168:171], v[252:255]
 ds_read_b128 a[160:163], v5 offset:32768
 ds_read_b128 a[164:167], v6 offset:32768
M v[252:255], a[92:95], a[172:175], v[252:255]
M v[248:251], a[84:87], a[172:175], v[248:251]
M v[248:251], a[80:83], a[168:171], v[248:251]
M v[244:247], a[72:75], a[168:171], v[244:247]
M v[244:247], a[76:79], a[172:175], v[244:247]
M v[240:243], a[68:71], a[172:175], v[240:243]
M v[240:243], a[64:67], a[168:171], v[240:243]
M v[236:239], a[56:59], a[168:171], v[236:239]
M v[236:239], a[60:63], a[172:175], v[236:239]
M v[232:235], a[52:55], a[172:175], v[232:235]
M v[232:235], a[48:51], a[168:171], v[232:235]
M v[228:231], a[40:43], a[168:171], v[228:231]
M v[228:231], a[44:47], a[172:175], v[228:231]
 s_waitcnt lgkmcnt(0)
M v[224:227], a[36:39], a[172:175], v[224:227]
M v[224:227], a[32:35], a[168:171], v[224:227]
M a[0:3], a[96:99], a[160:163], a[0:3]
 ds_read_b128 a[168:171], v5 offset:34816
 ds_read_b128 a[172:175], v6 offset:34816
M a[0:3], a[100:103], a[164:167], a[0:3]
 ds_read_b64_tr_b16 a[32:33], v1 offset:0
 ds_read_b64_tr_b16 a[34:35], v1 offset:1024
M a[4:7], a[108:111], a[164:167], a[4:7]
 s_add_u32 m0, s24, 16384
M a[4:7], a[104:107], a[160:163], a[4:7]
 buffer_load_dwordx4 v12, s[48:51], s22 offen offset:0   lds
M a[8:11], a[112:115], a[160:163], a[8:11]
M a[8:11], a[116:119], a[164:167], a[8:11]
M a[12:15], a[124:127], a[164:167], a[12:15]
 ds_read_b64_tr_b16 a[36:37], v1 offset:8192
 ds_read_b64_tr_b16 a[38:39], v1 offset:9216
M a[12:15], a[120:123], a[160:163], a[12:15]
M a[16:19], a[128:131], a[160:163], a[16:19]
 buffer_load_dwordx4 v13, s[48:51], s22 offen offset:1024   lds
M a[16:19], a[132:135], a[164:167], a[16:19]
M a[20:23], a[140:143], a[164:167], a[20:23]
M a[20:23], a[136:139], a[160:163], a[20:23]
 ds_read_b64_tr_b16 a[40:41], v2 offset:0
 ds_read_b64_tr_b16 a[42:43], v2 offset:1024
M a[24:27], a[144:147], a[160:163], a[24:27]
M a[24:27], a[148:151], a[164:167], a[24:27]
 s_waitcnt lgkmcnt(6)
M a[28:31], a[156:159], a[164:167], a[28:31]
 buffer_load_dwordx4 v14, s[48:51], s22 offen offset:2048   lds
M a[28:31], a[152:155], a[160:163], a[28:31]
M v[60:63], a[152:155], a[168:171], v[60:63]
 ds_read_b128 a[160:163], v5 offset:36864
 ds_read_b128 a[164:167], v6 offset:36864
M v[60:63], a[156:159], a[172:175], v[60:63]
 ds_read_b64_tr_b16 a[44:45], v2 offset:8192
 ds_read_b64_tr_b16 a[46:47], v2 offset:9216
M v[56:59], a[148:151], a[172:175], v[56:59]
 buffer_load_dwordx4 v15, s[48:51], s22 offen offset:3072   lds
M v[56:59], a[144:147], a[168:171], v[56:59]
 s_sub_u32 s22, s22, 2097024
M v[52:55], a[136:139], a[168:171], v[52:55]
M v[52:55], a[140:143], a[172:175], v[52:55]
 ds_read_b64_tr_b16 a[48:49], v3 offset:0
 ds_read_b64_tr_b16 a[50:51], v3 offset:1024
M v[48:51], a[132:135], a[172:175], v[48:51]
 s_add_u32 m0, s23, 49152
M v[48:51], a[128:131], a[168:171], v[48:51]
 buffer_load_dwordx4 v8, s[16:19], s21 offen offset:0  nt lds
M v[44:47], a[120:123], a[168:171], v[44:47]
M v[44:47], a[124:127], a[172:175], v[44:47]
M v[40:43], a[116:119], a[172:175], v[40:43]
 ds_read_b64_tr_b16 a[52:53], v3 offset:8192
 ds_read_b64_tr_b16 a[54:55], v3 offset:9216
M v[40:43], a[112:115], a[168:171], v[40:43]
M v[36:39], a[104:107], a[168:171], v[36:39]
 buffer_load_dwordx4 v9, s[16:19], s21 offen offset:1024  nt lds
M v[36:39], a[108:111], a[172:175], v[36:39]
 s_waitcnt lgkmcnt(6)
M v[32:35], a[100:103], a[172:175], v[32:35]
M v[32:35], a[96:99], a[168:171], v[32:35]
 ds_read_b64_tr_b16 a[56:57], v4 offset:0
 ds_read_b64_tr_b16 a[58:59], v4 offset:1024
M v[64:67], a[96:99], a[160:163], v[64:67]
 ds_read_b128 a[168:171], v5 offset:38912
 ds_read_b128 a[172:175], v6 offset:38912
M v[64:67], a[100:103], a[164:167], v[64:67]
 buffer_load_dwordx4 v10, s[16:19], s21 offen offset:2048  nt lds
M v[68:71], a[108:111], a[164:167], v[68:71]
M v[68:71], a[104:107], a[160:163], v[68:71]
M v[72:75], a[112:115], a[160:163], v[72:75]
 ds_read_b64_tr_b16 a[60:61], v4 offset:8192
 ds_read_b64_tr_b16 a[62:63], v4 offset:9216
M v[72:75], a[116:119], a[164:167], v[72:75]
M v[76:79], a[124:127], a[164:167], v[76:79]
 buffer_load_dwordx4 v11, s[16:19], s21 offen offset:3072  nt lds
M v[76:79], a[120:123], a[160:163], v[76:79]
 s_add_u32 s21, s21, 524160
M v[80:83], a[128:131], a[160:163], v[80:83]
M v[80:83], a[132:135], a[164:167], v[80:83]
M v[84:87], a[140:143], a[164:167], v[84:87]
M v[84:87], a[136:139], a[160:163], v[84:87]
M v[88:91], a[144:147], a[160:163], v[88:91]
M v[88:91], a[148:151], a[164:167], v[88:91]
 s_waitcnt lgkmcnt(2)
M v[92:95], a[156:159], a[164:167], v[92:95]
 s_waitcnt vmcnt(16) lgkmcnt(0)
M v[92:95], a[152:155], a[160:163], v[92:95]
 s_barrier
M v[124:127], a[152:155], a[168:171], v[124:127]
 ds_read_b128 a[160:163], v5 offset:49152
 ds_read_b128 a[164:167], v6 offset:49152
M v[124:127], a[156:159], a[172:175], v[124:127]
M v[120:123], a[148:151], a[172:175], v[120:123]
 s_add_u32 m0, s24, 32768
 ds_read_b64_tr_b16 a[64:65], v1 offset:16384
 ds_read_b64_tr_b16 a[66:67], v1 offset:17408
M v[120:123], a[144:147], a[168:171], v[120:123]
 buffer_load_dwordx4 v12, s[48:51], s22 offen offset:0   lds
M v[116:119], a[136:139], a[168:171], v[116:119]
 v_min_u32 v16, 40, v0
 v_lshlrev_b32 v16, 2, v16
M v[116:119], a[140:143], a[172:175], v[116:119]
 buffer_load_dword v17, v16, s[12:15], 0 offen offset:64 sc1
M v[112:115], a[132:135], a[172:175], v[112:115]
M v[112:115], a[128:131], a[168:171], v[112:115]
M v[108:111], a[120:123], a[168:171], v[108:111]
M v[108:111], a[124:127], a[172:175], v[108:111]
 ds_read_b64_tr_b16 a[68:69], v1 offset:24576
 ds_read_b64_tr_b16 a[70:71], v1 offset:25600
M v[104:107], a[116:119], a[172:175], v[104:107]
 buffer_load_dwordx4 v13, s[48:51], s22 offen offset:1024   lds
M v[104:107], a[112:115], a[168:171], v[104:107]
M v[100:103], a[104:107], a[168:171], v[100:103]
M v[100:103], a[108:111], a[172:175], v[100:103]
 s_waitcnt lgkmcnt(4)
M v[96:99], a[100:103], a[172:175], v[96:99]
M v[96:99], a[96:99], a[168:171], v[96:99]
M v[128:131], a[96:99], a[160:163], v[128:131]
 ds_read_b128 a[168:171], v5 offset:51200
 ds_read_b128 a[172:175], v6 offset:51200
M v[128:131], a[100:103], a[164:167], v[128:131]
 ds_read_b64_tr_b16 a[72:73], v2 offset:16384
 ds_read_b64_tr_b16 a[74:75], v2 offset:17408
M v[132:135], a[108:111], a[164:167], v[132:135]
 buffer_load_dwordx4 v14, s[48:51], s22 offen offset:2048   lds
M v[132:135], a[104:107], a[160:163], v[132:135]
M v[136:139], a[112:115], a[160:163], v[136:139]
M v[136:139], a[116:119], a[164:167], v[136:139]
M v[140:143], a[124:127], a[164:167], v[140:143]
M v[140:143], a[120:123], a[160:163], v[140:143]
 ds_read_b64_tr_b16 a[76:77], v2 offset:24576
 ds_read_b64_tr_b16 a[78:79], v2 offset:25600
M v[144:147], a[128:131], a[160:163], v[144:147]
 buffer_load_dwordx4 v15, s[48:51], s22 offen offset:3072   lds
M v[144:147], a[132:135], a[164:167], v[144:147]
 s_add_u32 s22, s22, 2097152
M v[148:151], a[140:143], a[164:167], v[148:151]
M v[148:151], a[136:139], a[160:163], v[148:151]
M v[152:155], a[144:147], a[160:163], v[152:155]
M v[152:155], a[148:151], a[164:167], v[152:155]
 s_waitcnt lgkmcnt(4)
M v[156:159], a[156:159], a[164:167], v[156:159]
 s_add_u32 m0, s23, 0
 ds_read_b64_tr_b16 a[80:81], v3 offset:16384
 ds_read_b64_tr_b16 a[82:83], v3 offset:17408
M v[156:159], a[152:155], a[160:163], v[156:159]
 buffer_load_dwordx4 v8, s[16:19], s21 offen offset:0  nt lds
M v[188:191], a[152:155], a[168:171], v[188:191]
 ds_read_b128 a[160:163], v5 offset:53248
 ds_read_b128 a[164:167], v6 offset:53248
M v[188:191], a[156:159], a[172:175], v[188:191]
M v[184:187], a[148:151], a[172:175], v[184:187]
M v[184:187], a[144:147], a[168:171], v[184:187]
M v[180:183], a[136:139], a[168:171], v[180:183]
M v[180:183], a[140:143], a[172:175], v[180:183]
 ds_read_b64_tr_b16 a[84:85], v3 offset:24576
 ds_read_b64_tr_b16 a[86:87], v3 offset:25600
M v[176:179], a[132:135], a[172:175], v[176:179]
 buffer_load_dwordx4 v9, s[16:19], s21 offen offset:1024  nt lds
M v[176:179], a[128:131], a[168:171], v[176:179]
M v[172:175], a[120:123], a[168:171], v[172:175]
M v[172:175], a[124:127], a[172:175], v[172:175]
M v[168:171], a[116:119], a[172:175], v[168:171]
M v[168:171], a[112:115], a[168:171], v[168:171]
M v[164:167], a[104:107], a[168:171], v[164:167]
 ds_read_b64_tr_b16 a[88:89], v4 offset:16384
 ds_read_b64_tr_b16 a[90:91], v4 offset:17408
M v[164:167], a[108:111], a[172:175], v[164:167]
 s_waitcnt lgkmcnt(4)
M v[160:163], a[100:103], a[172:175], v[160:163]
 buffer_load_dwordx4 v10, s[16:19], s21 offen offset:2048  nt lds
M v[160:163], a[96:99], a[168:171], v[160:163]
M v[192:195], a[96:99], a[160:163], v[192:195]
 ds_read_b128 a[168:171], v5 offset:55296
 ds_read_b128 a[172:175], v6 offset:55296
M v[192:195], a[100:103], a[164:167], v[192:195]
M v[196:199], a[108:111], a[164:167], v[196:199]
M v[196:199], a[104:107], a[160:163], v[196:199]
 ds_read_b64_tr_b16 a[92:93], v4 offset:24576
 ds_read_b64_tr_b16 a[94:95], v4 offset:25600
M v[200:203], a[112:115], a[160:163], v[200:203]
 buffer_load_dwordx4 v11, s[16:19], s21 offen offset:3072  nt lds
M v[200:203], a[116:119], a[164:167], v[200:203]
 s_add_u32 s21, s21, 128
M v[204:207], a[124:127], a[164:167], v[204:207]
M v[204:207], a[120:123], a[160:163], v[204:207]
M v[208:211], a[128:131], a[160:163], v[208:211]
M v[208:211], a[132:135], a[164:167], v[208:211]
M v[212:215], a[140:143], a[164:167], v[212:215]
M v[212:215], a[136:139], a[160:163], v[212:215]
M v[216:219], a[144:147], a[160:163], v[216:219]
M v[216:219], a[148:151], a[164:167], v[216:219]
 s_waitcnt lgkmcnt(2)
M v[220:223], a[156:159], a[164:167], v[220:223]
 s_waitcnt vmcnt(17) lgkmcnt(0)
M v[220:223], a[152:155], a[160:163], v[220:223]
 s_barrier
M v[252:255], a[152:155], a[168:171], v[252:255]
 ds_read_b128 a[160:163], v5 offset:0
 ds_read_b128 a[164:167], v6 offset:0
M v[252:255], a[156:159], a[172:175], v[252:255]
M v[248:251], a[148:151], a[172:175], v[248:251]
M v[248:251], a[144:147], a[168:171], v[248:251]
M v[244:247], a[136:139], a[168:171], v[244:247]
M v[244:247], a[140:143], a[172:175], v[244:247]
M v[240:243], a[132:135], a[172:175], v[240:243]
M v[240:243], a[128:131], a[168:171], v[240:243]
M v[236:239], a[120:123], a[168:171], v[236:239]
M v[236:239], a[124:127], a[172:175], v[236:239]
M v[232:235], a[116:119], a[172:175], v[232:235]
M v[232:235], a[112:115], a[168:171], v[232:235]
M v[228:231], a[104:107], a[168:171], v[228:231]
M v[228:231], a[108:111], a[172:175], v[228:231]
 s_waitcnt lgkmcnt(0)
M v[224:227], a[100:103], a[172:175], v[224:227]
M v[224:227], a[96:99], a[168:171], v[224:227]
M a[0:3], a[32:35], a[160:163], a[0:3]
 ds_read_b128 a[168:171], v5 offset:2048
 ds_read_b128 a[172:175], v6 offset:2048
M a[0:3], a[36:39], a[164:167], a[0:3]
 ds_read_b64_tr_b16 a[96:97], v1 offset:32768
 ds_read_b64_tr_b16 a[98:99], v1 offset:33792
M a[4:7], a[44:47], a[164:167], a[4:7]
 s_add_u32 m0, s24, 49152
M a[4:7], a[40:43], a[160:163], a[4:7]
 buffer_load_dwordx4 v12, s[48:51], s22 offen offset:0   lds
M a[8:11], a[48:51], a[160:163], a[8:11]
M a[8:11], a[52:55], a[164:167], a[8:11]
M a[12:15], a[60:63], a[164:167], a[12:15]
 ds_read_b64_tr_b16 a[100:101], v1 offset:40960
 ds_read_b64_tr_b16 a[102:103], v1 offset:41984
M a[12:15], a[56:59], a[160:163], a[12:15]
M a[16:19], a[64:67], a[160:163], a[16:19]
 buffer_load_dwordx4 v13, s[48:51], s22 offen offset:1024   lds
M a[16:19], a[68:71], a[164:167], a[16:19]
M a[20:23], a[76:79], a[164:167], a[20:23]
M a[20:23], a[72:75], a[160:163], a[20:23]
 ds_read_b64_tr_b16 a[104:105], v2 offset:32768
 ds_read_b64_tr_b16 a[106:107], v2 offset:33792
M a[24:27], a[80:83], a[160:163], a[24:27]
M a[24:27], a[84:87], a[164:167], a[24:27]
 s_waitcnt lgkmcnt(6)
M a[28:31], a[92:95], a[164:167], a[28:31]
 buffer_load_dwordx4 v14, s[48:51], s22 offen offset:2048   lds
M a[28:31], a[88:91], a[160:163], a[28:31]
M v[60:63], a[88:91], a[168:171], v[60:63]
 ds_read_b128 a[160:163], v5 offset:4096
 ds_read_b128 a[164:167], v6 offset:4096
M v[60:63], a[92:95], a[172:175], v[60:63]
 ds_read_b64_tr_b16 a[108:109], v2 offset:40960
 ds_read_b64_tr_b16 a[110:111], v2 offset:41984
M v[56:59], a[84:87], a[172:175], v[56:59]
 buffer_load_dwordx4 v15, s[48:51], s22 offen offset:3072   lds
M v[56:59], a[80:83], a[168:171], v[56:59]
 s_sub_u32 s22, s22, 2097024
M v[52:55], a[72:75], a[168:171], v[52:55]
M v[52:55], a[76:79], a[172:175], v[52:55]
 ds_read_b64_tr_b16 a[112:113], v3 offset:32768
 ds_read_b64_tr_b16 a[114:115], v3 offset:33792
M v[48:51], a[68:71], a[172:175], v[48:51]
 s_add_u32 m0, s23, 16384
M v[48:51], a[64:67], a[168:171], v[48:51]
 buffer_load_dwordx4 v8, s[16:19], s21 offen offset:0  nt lds
M v[44:47], a[56:59], a[168:171], v[44:47]
M v[44:47], a[60:63], a[172:175], v[44:47]
M v[40:43], a[52:55], a[172:175], v[40:43]
 ds_read_b64_tr_b16 a[116:117], v3 offset:40960
 ds_read_b64_tr_b16 a[118:119], v3 offset:41984
M v[40:43], a[48:51], a[168:171], v[40:43]
M v[36:39], a[40:43], a[168:171], v[36:39]
 buffer_load_dwordx4 v9, s[16:19], s21 offen offset:1024  nt lds
M v[36:39], a[44:47], a[172:175], v[36:39]
 s_waitcnt lgkmcnt(6)
M v[32:35], a[36:39], a[172:175], v[32:35]
M v[32:35], a[32:35], a[168:171], v[32:35]
 ds_read_b64_tr_b16 a[120:121], v4 offset:32768
 ds_read_b64_tr_b16 a[122:123], v4 offset:33792
M v[64:67], a[32:35], a[160:163], v[64:67]
 ds_read_b128 a[168:171], v5 offset:6144
 ds_read_b128 a[172:175], v6 offset:6144
M v[64:67], a[36:39], a[164:167], v[64:67]
 buffer_load_dwordx4 v10, s[16:19], s21 offen offset:2048  nt lds
M v[68:71], a[44:47], a[164:167], v[68:71]
M v[68:71], a[40:43], a[160:163], v[68:71]
M v[72:75], a[48:51], a[160:163], v[72:75]
 ds_read_b64_tr_b16 a[124:125], v4 offset:40960
 ds_read_b64_tr_b16 a[126:127], v4 offset:41984
M v[72:75], a[52:55], a[164:167], v[72:75]
M v[76:79], a[60:63], a[164:167], v[76:79]
 buffer_load_dwordx4 v11, s[16:19], s21 offen offset:3072  nt lds
M v[76:79], a[56:59], a[160:163], v[76:79]
 s_add_u32 s21, s21, 524160
M v[80:83], a[64:67], a[160:163], v[80:83]
M v[80:83], a[68:71], a[164:167], v[80:83]
M v[84:87], a[76:79], a[164:167], v[84:87]
M v[84:87], a[72:75], a[160:163], v[84:87]
M v[88:91], a[80:83], a[160:163], v[88:91]
M v[88:91], a[84:87], a[164:167], v[88:91]
 s_waitcnt lgkmcnt(2)
M v[92:95], a[92:95], a[164:167], v[92:95]
 s_waitcnt vmcnt(17) lgkmcnt(0)
M v[92:95], a[88:91], a[160:163], v[92:95]
 s_barrier
M v[124:127], a[88:91], a[168:171], v[124:127]
 ds_read_b128 a[160:163], v5 offset:16384
 ds_read_b128 a[164:167], v6 offset:16384
M v[124:127], a[92:95], a[172:175], v[124:127]
M v[120:123], a[84:87], a[172:175], v[120:123]
 s_add_u32 m0, s24, 0
 ds_read_b64_tr_b16 a[128:129], v1 offset:49152
 ds_read_b64_tr_b16 a[130:131], v1 offset:50176
M v[120:123], a[80:83], a[168:171], v[120:123]
 buffer_load_dwordx4 v12, s[48:51], s22 offen offset:0   lds
M v[116:119], a[72:75], a[168:171], v[116:119]
M v[116:119], a[76:79], a[172:175], v[116:119]
M v[112:115], a[68:71], a[172:175], v[112:115]
M v[112:115], a[64:67], a[168:171], v[112:115]
M v[108:111], a[56:59], a[168:171], v[108:111]
M v[108:111], a[60:63], a[172:175], v[108:111]
 ds_read_b64_tr_b16 a[132:133], v1 offset:57344
 ds_read_b64_tr_b16 a[134:135], v1 offset:58368
M v[104:107], a[52:55], a[172:175], v[104:107]
 buffer_load_dwordx4 v13, s[48:51], s22 offen offset:1024   lds
M v[104:107], a[48:51], a[168:171], v[104:107]
M v[100:103], a[40:43], a[168:171], v[100:103]
M v[100:103], a[44:47], a[172:175], v[100:103]
 s_waitcnt lgkmcnt(4)
M v[96:99], a[36:39], a[172:175], v[96:99]
M v[96:99], a[32:35], a[168:171], v[96:99]
M v[128:131], a[32:35], a[160:163], v[128:131]
 ds_read_b128 a[168:171], v5 offset:18432
 ds_read_b128 a[172:175], v6 offset:18432
M v[128:131], a[36:39], a[164:167], v[128:131]
 ds_read_b64_tr_b16 a[136:137], v2 offset:49152
 ds_read_b64_tr_b16 a[138:139], v2 offset:50176
M v[132:135], a[44:47], a[164:167], v[132:135]
 buffer_load_dwordx4 v14, s[48:51], s22 offen offset:2048   lds
M v[132:135], a[40:43], a[160:163], v[132:135]
M v[136:139], a[48:51], a[160:163], v[136:139]
M v[136:139], a[52:55], a[164:167], v[136:139]
M v[140:143], a[60:63], a[164:167], v[140:143]
M v[140:143], a[56:59], a[160:163], v[140:143]
 ds_read_b64_tr_b16 a[140:141], v2 offset:57344
 ds_read_b64_tr_b16 a[142:143], v2 offset:58368
M v[144:147], a[64:67], a[160:163], v[144:147]
 buffer_load_dwordx4 v15, s[48:51], s22 offen offset:3072   lds
M v[144:147], a[68:71], a[164:167], v[144:147]
 s_add_u32 s22, s22, 2097152
M v[148:151], a[76:79], a[164:167], v[148:151]
M v[148:151], a[72:75], a[160:163], v[148:151]
M v[152:155], a[80:83], a[160:163], v[152:155]
M v[152:155], a[84:87], a[164:167], v[152:155]
 s_waitcnt lgkmcnt(4)
M v[156:159], a[92:95], a[164:167], v[156:159]
 s_add_u32 m0, s23, 32768
 ds_read_b64_tr_b16 a[144:145], v3 offset:49152
 ds_read_b64_tr_b16 a[146:147], v3 offset:50176
M v[156:159], a[88:91], a[160:163], v[156:159]
 buffer_load_dwordx4 v8, s[16:19], s21 offen offset:0  nt lds
M v[188:191], a[88:91], a[168:171], v[188:191]
 ds_read_b128 a[160:163], v5 offset:20480
 ds_read_b128 a[164:167], v6 offset:20480
M v[188:191], a[92:95], a[172:175], v[188:191]
M v[184:187], a[84:87], a[172:175], v[184:187]
M v[184:187], a[80:83], a[168:171], v[184:187]
M v[180:183], a[72:75], a[168:171], v[180:183]
M v[180:183], a[76:79], a[172:175], v[180:183]
 ds_read_b64_tr_b16 a[148:149], v3 offset:57344
 ds_read_b64_tr_b16 a[150:151], v3 offset:58368
M v[176:179], a[68:71], a[172:175], v[176:179]
 buffer_load_dwordx4 v9, s[16:19], s21 offen offset:1024  nt lds
M v[176:179], a[64:67], a[168:171], v[176:179]
M v[172:175], a[56:59], a[168:171], v[172:175]
M v[172:175], a[60:63], a[172:175], v[172:175]
M v[168:171], a[52:55], a[172:175], v[168:171]
M v[168:171], a[48:51], a[168:171], v[168:171]
M v[164:167], a[40:43], a[168:171], v[164:167]
 ds_read_b64_tr_b16 a[152:153], v4 offset:49152
 ds_read_b64_tr_b16 a[154:155], v4 offset:50176
M v[164:167], a[44:47], a[172:175], v[164:167]
 s_waitcnt lgkmcnt(4)
M v[160:163], a[36:39], a[172:175], v[160:163]
 buffer_load_dwordx4 v10, s[16:19], s21 offen offset:2048  nt lds
M v[160:163], a[32:35], a[168:171], v[160:163]
M v[192:195], a[32:35], a[160:163], v[192:195]
 ds_read_b128 a[168:171], v5 offset:22528
 ds_read_b128 a[172:175], v6 offset:22528
M v[192:195], a[36:39], a[164:167], v[192:195]
M v[196:199], a[44:47], a[164:167], v[196:199]
M v[196:199], a[40:43], a[160:163], v[196:199]
 ds_read_b64_tr_b16 a[156:157], v4 offset:57344
 ds_read_b64_tr_b16 a[158:159], v4 offset:58368
M v[200:203], a[48:51], a[160:163], v[200:203]
 buffer_load_dwordx4 v11, s[16:19], s21 offen offset:3072  nt lds
M v[200:203], a[52:55], a[164:167], v[200:203]
 s_add_u32 s21, s21, 128
M v[204:207], a[60:63], a[164:167], v[204:207]
M v[204:207], a[56:59], a[160:163], v[204:207]
M v[208:211], a[64:67], a[160:163], v[208:211]
M v[208:211], a[68:71], a[164:167], v[208:211]
M v[212:215], a[76:79], a[164:167], v[212:215]
M v[212:215], a[72:75], a[160:163], v[212:215]
M v[216:219], a[80:83], a[160:163], v[216:219]
M v[216:219], a[84:87], a[164:167], v[216:219]
 s_waitcnt lgkmcnt(2)
M v[220:223], a[92:95], a[164:167], v[220:223]
 s_waitcnt vmcnt(16) lgkmcnt(0)
M v[220:223], a[88:91], a[160:163], v[220:223]
 s_barrier
M v[252:255], a[88:91], a[168:171], v[252:255]
 ds_read_b128 a[160:163], v5 offset:32768
 ds_read_b128 a[164:167], v6 offset:32768
M v[252:255], a[92:95], a[172:175], v[252:255]
 v_cmp_ne_u32 vcc, 1, v17
M v[248:251], a[84:87], a[172:175], v[248:251]
 s_nop 0
M v[248:251], a[80:83], a[168:171], v[248:251]
 s_cbranch_vccnz L_zs1
L_zr1:
M v[244:247], a[72:75], a[168:171], v[244:247]
 buffer_load_dword a240, v24, s[32:35], 0 offen offset:1024
M v[244:247], a[76:79], a[172:175], v[244:247]
M v[240:243], a[68:71], a[172:175], v[240:243]
M v[240:243], a[64:67], a[168:171], v[240:243]
M v[236:239], a[56:59], a[168:171], v[236:239]
M v[236:239], a[60:63], a[172:175], v[236:239]
M v[232:235], a[52:55], a[172:175], v[232:235]
M v[232:235], a[48:51], a[168:171], v[232:235]
M v[228:231], a[40:43], a[168:171], v[228:231]
M v[228:231], a[44:47], a[172:175], v[228:231]
 s_waitcnt lgkmcnt(0)
M v[224:227], a[36:39], a[172:175], v[224:227]
M v[224:227], a[32:35], a[168:171], v[224:227]
M a[0:3], a[96:99], a[160:163], a[0:3]
 ds_read_b128 a[168:171], v5 offset:34816
 ds_read_b128 a[172:175], v6 offset:34816
M a[0:3], a[100:103], a[164:167], a[0:3]
 ds_read_b64_tr_b16 a[32:33], v1 offset:0
 ds_read_b64_tr_b16 a[34:35], v1 offset:1024
M a[4:7], a[108:111], a[164:167], a[4:7]
 s_add_u32 m0, s24, 16384
M a[4:7], a[104:107], a[160:163], a[4:7]
 buffer_load_dwordx4 v12, s[48:51], s22 offen offset:0   lds
M a[8:11], a[112:115], a[160:163], a[8:11]
M a[8:11], a[116:119], a[164:167], a[8:11]
M a[12:15], a[124:127], a[164:167], a[12:15]
 ds_read_b64_tr_b16 a[36:37], v1 offset:8192
 ds_read_b64_tr_b16 a[38:39], v1 offset:9216
M a[12:15], a[120:123], a[160:163], a[12:15]
M a[16:19], a[128:131], a[160:163], a[16:19]
 buffer_load_dwordx4 v13, s[48:51], s22 offen offset:1024   lds
M a[16:19], a[132:135], a[164:167], a[16:19]
M a[20:23], a[140:143], a[164:167], a[20:23]
M a[20:23], a[136:139], a[160:163], a[20:23]
 ds_read_b64_tr_b16 a[40:41], v2 offset:0
 ds_read_b64_tr_b16 a[42:43], v2 offset:1024
M a[24:27], a[144:147], a[160:163], a[24:27]
M a[24:27], a[148:151], a[164:167], a[24:27]
 s_waitcnt lgkmcnt(6)
M a[28:31], a[156:159], a[164:167], a[28:31]
 buffer_load_dwordx4 v14, s[48:51], s22 offen offset:2048   lds
M a[28:31], a[152:155], a[160:163], a[28:31]
M v[60:63], a[152:155], a[168:171], v[60:63]
 ds_read_b128 a[160:163], v5 offset:36864
 ds_read_b128 a[164:167], v6 offset:36864
M v[60:63], a[156:159], a[172:175], v[60:63]
 ds_read_b64_tr_b16 a[44:45], v2 offset:8192
 ds_read_b64_tr_b16 a[46:47], v2 offset:9216
M v[56:59], a[148:151], a[172:175], v[56:59]
 buffer_load_dwordx4 v15, s[48:51], s22 offen offset:3072   lds
M v[56:59], a[144:147], a[168:171], v[56:59]
 s_sub_u32 s22, s22, 2097024
M v[52:55], a[136:139], a[168:171], v[52:55]
M v[52:55], a[140:143], a[172:175], v[52:55]
 ds_read_b64_tr_b16 a[48:49], v3 offset:0
 ds_read_b64_tr_b16 a[50:51], v3 offset:1024
M v[48:51], a[132:135], a[172:175], v[48:51]
 s_add_u32 m0, s23, 49152
M v[48:51], a[128:131], a[168:171], v[48:51]
 buffer_load_dwordx4 v8, s[16:19], s21 offen offset:0  nt lds
M v[44:47], a[120:123], a[168:171], v[44:47]
M v[44:47], a[124:127], a[172:175], v[44:47]
M v[40:43], a[116:119], a[172:175], v[40:43]
 ds_read_b64_tr_b16 a[52:53], v3 offset:8192
 ds_read_b64_tr_b16 a[54:55], v3 offset:9216
M v[40:43], a[112:115], a[168:171], v[40:43]
M v[36:39], a[104:107], a[168:171], v[36:39]
 buffer_load_dwordx4 v9, s[16:19], s21 offen offset:1024  nt lds
M v[36:39], a[108:111], a[172:175], v[36:39]
 s_waitcnt lgkmcnt(6)
M v[32:35], a[100:103], a[172:175], v[32:35]
M v[32:35], a[96:99], a[168:171], v[32:35]
 ds_read_b64_tr_b16 a[56:57], v4 offset:0
 ds_read_b64_tr_b16 a[58:59], v4 offset:1024
M v[64:67], a[96:99], a[160:163], v[64:67]
 ds_read_b128 a[168:171], v5 offset:38912
 ds_read_b128 a[172:175], v6 offset:38912
M v[64:67], a[100:103], a[164:167], v[64:67]
 buffer_load_dwordx4 v10, s[16:19], s21 offen offset:2048  nt lds
M v[68:71], a[108:111], a[164:167], v[68:71]
M v[68:71], a[104:107], a[160:163], v[68:71]
M v[72:75], a[112:115], a[160:163], v[72:75]
 ds_read_b64_tr_b16 a[60:61], v4 offset:8192
 ds_read_b64_tr_b16 a[62:63], v4 offset:9216
M v[72:75], a[116:119], a[164:167], v[72:75]
M v[76:79], a[124:127], a[164:167], v[76:79]
 buffer_load_dwordx4 v11, s[16:19], s21 offen offset:3072  nt lds
M v[76:79], a[120:123], a[160:163], v[76:79]
 s_add_u32 s21, s21, 524160
M v[80:83], a[128:131], a[160:163], v[80:83]
M v[80:83], a[132:135], a[164:167], v[80:83]
M v[84:87], a[140:143], a[164:167], v[84:87]
M v[84:87], a[136:139], a[160:163], v[84:87]
 s_and_b32 s64, s42, 7
M v[88:91], a[144:147], a[160:163], v[88:91]
 s_lshl_b32 s72, s41, 3
 s_add_u32 s64, s64, s72
 s_lshl_b32 s64, s64, 2
M v[88:91], a[148:151], a[164:167], v[88:91]
 s_waitcnt lgkmcnt(2)
 s_add_u32 s64, s64, s20
 s_mul_i32 s67, s64, 7168
M v[92:95], a[156:159], a[164:167], v[92:95]
 s_waitcnt vmcnt(17) lgkmcnt(0)
 s_mul_i32 s86, s20, 7168
 s_add_u32 s86, s86, 131072
M v[92:95], a[152:155], a[160:163], v[92:95]
 s_barrier
M v[124:127], a[152:155], a[168:171], v[124:127]
 ds_read_b128 a[160:163], v5 offset:49152
 ds_read_b128 a[164:167], v6 offset:49152
M v[124:127], a[156:159], a[172:175], v[124:127]
M v[120:123], a[148:151], a[172:175], v[120:123]
 s_add_u32 m0, s24, 32768
 ds_read_b64_tr_b16 a[64:65], v1 offset:16384
 ds_read_b64_tr_b16 a[66:67], v1 offset:17408
M v[120:123], a[144:147], a[168:171], v[120:123]
 buffer_load_dwordx4 v12, s[48:51], s22 offen offset:0   lds
M v[116:119], a[136:139], a[168:171], v[116:119]
M v[116:119], a[140:143], a[172:175], v[116:119]
M v[112:115], a[132:135], a[172:175], v[112:115]
M v[112:115], a[128:131], a[168:171], v[112:115]
 buffer_load_dwordx4 v13, s[48:51], s22 offen offset:1024   lds
M v[108:111], a[120:123], a[168:171], v[108:111]
M v[108:111], a[124:127], a[172:175], v[108:111]
 ds_read_b64_tr_b16 a[68:69], v1 offset:24576
 ds_read_b64_tr_b16 a[70:71], v1 offset:25600
M v[104:107], a[116:119], a[172:175], v[104:107]
M v[104:107], a[112:115], a[168:171], v[104:107]
M v[100:103], a[104:107], a[168:171], v[100:103]
 buffer_load_dwordx4 v14, s[48:51], s22 offen offset:2048   lds
M v[100:103], a[108:111], a[172:175], v[100:103]
 s_waitcnt lgkmcnt(4)
M v[96:99], a[100:103], a[172:175], v[96:99]
M v[96:99], a[96:99], a[168:171], v[96:99]
M v[128:131], a[96:99], a[160:163], v[128:131]
 ds_read_b128 a[168:171], v5 offset:51200
 ds_read_b128 a[172:175], v6 offset:51200
M v[128:131], a[100:103], a[164:167], v[128:131]
 ds_read_b64_tr_b16 a[72:73], v2 offset:16384
 ds_read_b64_tr_b16 a[74:75], v2 offset:17408
M v[132:135], a[108:111], a[164:167], v[132:135]
 buffer_load_dwordx4 v15, s[48:51], s22 offen offset:3072   lds
M v[132:135], a[104:107], a[160:163], v[132:135]
 s_add_u32 s22, s22, 2097152
M v[136:139], a[112:115], a[160:163], v[136:139]
M v[136:139], a[116:119], a[164:167], v[136:139]
 s_add_u32 m0, s23, 0
M v[140:143], a[124:127], a[164:167], v[140:143]
 buffer_load_dwordx4 v8, s[16:19], s21 offen offset:0  nt lds
M v[140:143], a[120:123], a[160:163], v[140:143]
 ds_read_b64_tr_b16 a[76:77], v2 offset:24576
 ds_read_b64_tr_b16 a[78:79], v2 offset:25600
M v[144:147], a[128:131], a[160:163], v[144:147]
M v[144:147], a[132:135], a[164:167], v[144:147]
M v[148:151], a[140:143], a[164:167], v[148:151]
 buffer_load_dwordx4 v9, s[16:19], s21 offen offset:1024  nt lds
M v[148:151], a[136:139], a[160:163], v[148:151]
M v[152:155], a[144:147], a[160:163], v[152:155]
M v[152:155], a[148:151], a[164:167], v[152:155]
 s_waitcnt lgkmcnt(4)
M v[156:159], a[156:159], a[164:167], v[156:159]
 ds_read_b64_tr_b16 a[80:81], v3 offset:16384
 ds_read_b64_tr_b16 a[82:83], v3 offset:17408
M v[156:159], a[152:155], a[160:163], v[156:159]
 buffer_load_dwordx4 v10, s[16:19], s21 offen offset:2048  nt lds
M v[188:191], a[152:155], a[168:171], v[188:191]
 ds_read_b128 a[160:163], v5 offset:53248
 ds_read_b128 a[164:167], v6 offset:53248
M v[188:191], a[156:159], a[172:175], v[188:191]
M v[184:187], a[148:151], a[172:175], v[184:187]
M v[184:187], a[144:147], a[168:171], v[184:187]
M v[180:183], a[136:139], a[168:171], v[180:183]
 buffer_load_dwordx4 v11, s[16:19], s21 offen offset:3072  nt lds
M v[180:183], a[140:143], a[172:175], v[180:183]
 s_add_u32 s21, s21, 128
 ds_read_b64_tr_b16 a[84:85], v3 offset:24576
 ds_read_b64_tr_b16 a[86:87], v3 offset:25600
M v[176:179], a[132:135], a[172:175], v[176:179]
M v[176:179], a[128:131], a[168:171], v[176:179]
M v[172:175], a[120:123], a[168:171], v[172:175]
 s_add_u32 m0, s86, 0
M v[172:175], a[124:127], a[172:175], v[172:175]
 buffer_load_dwordx4 v7, s[60:63], s67 offen offset:0 nt lds
M v[168:171], a[116:119], a[172:175], v[168:171]
M v[168:171], a[112:115], a[168:171], v[168:171]
M v[164:167], a[104:107], a[168:171], v[164:167]
 ds_read_b64_tr_b16 a[88:89], v4 offset:16384
 ds_read_b64_tr_b16 a[90:91], v4 offset:17408
M v[164:167], a[108:111], a[172:175], v[164:167]
 s_waitcnt lgkmcnt(4)
M v[160:163], a[100:103], a[172:175], v[160:163]
 buffer_load_dwordx4 v7, s[60:63], s67 offen offset:1024 nt lds
M v[160:163], a[96:99], a[168:171], v[160:163]
M v[192:195], a[96:99], a[160:163], v[192:195]
 ds_read_b128 a[168:171], v5 offset:55296
 ds_read_b128 a[172:175], v6 offset:55296
M v[192:195], a[100:103], a[164:167], v[192:195]
M v[196:199], a[108:111], a[164:167], v[196:199]
 buffer_load_dwordx4 v7, s[60:63], s67 offen offset:2048 nt lds
M v[196:199], a[104:107], a[160:163], v[196:199]
 ds_read_b64_tr_b16 a[92:93], v4 offset:24576
 ds_read_b64_tr_b16 a[94:95], v4 offset:25600
M v[200:203], a[112:115], a[160:163], v[200:203]
M v[200:203], a[116:119], a[164:167], v[200:203]
M v[204:207], a[124:127], a[164:167], v[204:207]
M v[204:207], a[120:123], a[160:163], v[204:207]
 buffer_load_dwordx4 v7, s[60:63], s67 offen offset:3072 nt lds
M v[208:211], a[128:131], a[160:163], v[208:211]
 s_add_u32 s67, s67, 4096
M v[208:211], a[132:135], a[164:167], v[208:211]
M v[212:215], a[140:143], a[164:167], v[212:215]
M v[212:215], a[136:139], a[160:163], v[212:215]
M v[216:219], a[144:147], a[160:163], v[216:219]
M v[216:219], a[148:151], a[164:167], v[216:219]
 s_waitcnt lgkmcnt(2)
M v[220:223], a[156:159], a[164:167], v[220:223]
 s_waitcnt vmcnt(21) lgkmcnt(0)
M v[220:223], a[152:155], a[160:163], v[220:223]
 s_barrier
M v[252:255], a[152:155], a[168:171], v[252:255]
 ds_read_b128 a[160:163], v5 offset:0
 ds_read_b128 a[164:167], v6 offset:0
M v[252:255], a[156:159], a[172:175], v[252:255]
M v[248:251], a[148:151], a[172:175], v[248:251]
M v[248:251], a[144:147], a[168:171], v[248:251]
M v[244:247], a[136:139], a[168:171], v[244:247]
M v[244:247], a[140:143], a[172:175], v[244:247]
M v[240:243], a[132:135], a[172:175], v[240:243]
M v[240:243], a[128:131], a[168:171], v[240:243]
M v[236:239], a[120:123], a[168:171], v[236:239]
M v[236:239], a[124:127], a[172:175], v[236:239]
M v[232:235], a[116:119], a[172:175], v[232:235]
M v[232:235], a[112:115], a[168:171], v[232:235]
M v[228:231], a[104:107], a[168:171], v[228:231]
M v[228:231], a[108:111], a[172:175], v[228:231]
 s_waitcnt lgkmcnt(0)
M v[224:227], a[100:103], a[172:175], v[224:227]
M v[224:227], a[96:99], a[168:171], v[224:227]
M a[0:3], a[32:35], a[160:163], a[0:3]
 ds_read_b128 a[168:171], v5 offset:2048
 ds_read_b128 a[172:175], v6 offset:2048
M a[0:3], a[36:39], a[164:167], a[0:3]
 ds_read_b64_tr_b16 a[96:97], v1 offset:32768
 ds_read_b64_tr_b16 a[98:99], v1 offset:33792
M a[4:7], a[44:47], a[164:167], a[4:7]
 s_add_u32 m0, s24, 49152
M a[4:7], a[40:43], a[160:163], a[4:7]
 buffer_load_dwordx4 v12, s[48:51], s22 offen offset:0   lds
M a[8:11], a[48:51], a[160:163], a[8:11]
M a[8:11], a[52:55], a[164:167], a[8:11]
M a[12:15], a[60:63], a[164:167], a[12:15]
 ds_read_b64_tr_b16 a[100:101], v1 offset:40960
 ds_read_b64_tr_b16 a[102:103], v1 offset:41984
M a[12:15], a[56:59], a[160:163], a[12:15]
M a[16:19], a[64:67], a[160:163], a[16:19]
 buffer_load_dwordx4 v13, s[48:51], s22 offen offset:1024   lds
M a[16:19], a[68:71], a[164:167], a[16:19]
M a[20:23], a[76:79], a[164:167], a[20:23]
M a[20:23], a[72:75], a[160:163], a[20:23]
 ds_read_b64_tr_b16 a[104:105], v2 offset:32768
 ds_read_b64_tr_b16 a[106:107], v2 offset:33792
M a[24:27], a[80:83], a[160:163], a[24:27]
M a[24:27], a[84:87], a[164:167], a[24:27]
 s_waitcnt lgkmcnt(6)
M a[28:31], a[92:95], a[164:167], a[28:31]
 buffer_load_dwordx4 v14, s[48:51], s22 offen offset:2048   lds
M a[28:31], a[88:91], a[160:163], a[28:31]
M v[60:63], a[88:91], a[168:171], v[60:63]
 ds_read_b128 a[160:163], v5 offset:4096
 ds_read_b128 a[164:167], v6 offset:4096
M v[60:63], a[92:95], a[172:175], v[60:63]
 ds_read_b64_tr_b16 a[108:109], v2 offset:40960
 ds_read_b64_tr_b16 a[110:111], v2 offset:41984
M v[56:59], a[84:87], a[172:175], v[56:59]
 buffer_load_dwordx4 v15, s[48:51], s22 offen offset:3072   lds
M v[56:59], a[80:83], a[168:171], v[56:59]
 s_sub_u32 s22, s22, 2097024
M v[52:55], a[72:75], a[168:171], v[52:55]
M v[52:55], a[76:79], a[172:175], v[52:55]
 ds_read_b64_tr_b16 a[112:113], v3 offset:32768
 ds_read_b64_tr_b16 a[114:115], v3 offset:33792
M v[48:51], a[68:71], a[172:175], v[48:51]
 s_add_u32 m0, s23, 16384
M v[48:51], a[64:67], a[168:171], v[48:51]
 buffer_load_dwordx4 v8, s[16:19], s21 offen offset:0  nt lds
M v[44:47], a[56:59], a[168:171], v[44:47]
M v[44:47], a[60:63], a[172:175], v[44:47]
M v[40:43], a[52:55], a[172:175], v[40:43]
 ds_read_b64_tr_b16 a[116:117], v3 offset:40960
 ds_read_b64_tr_b16 a[118:119], v3 offset:41984
M v[40:43], a[48:51], a[168:171], v[40:43]
M v[36:39], a[40:43], a[168:171], v[36:39]
 buffer_load_dwordx4 v9, s[16:19], s21 offen offset:1024  nt lds
M v[36:39], a[44:47], a[172:175], v[36:39]
 s_waitcnt lgkmcnt(6)
M v[32:35], a[36:39], a[172:175], v[32:35]
M v[32:35], a[32:35], a[168:171], v[32:35]
 ds_read_b64_tr_b16 a[120:121], v4 offset:32768
 ds_read_b64_tr_b16 a[122:123], v4 offset:33792
M v[64:67], a[32:35], a[160:163], v[64:67]
 ds_read_b128 a[168:171], v5 offset:6144
 ds_read_b128 a[172:175], v6 offset:6144
M v[64:67], a[36:39], a[164:167], v[64:67]
 buffer_load_dwordx4 v10, s[16:19], s21 offen offset:2048  nt lds
M v[68:71], a[44:47], a[164:167], v[68:71]
M v[68:71], a[40:43], a[160:163], v[68:71]
M v[72:75], a[48:51], a[160:163], v[72:75]
 ds_read_b64_tr_b16 a[124:125], v4 offset:40960
 ds_read_b64_tr_b16 a[126:127], v4 offset:41984
M v[72:75], a[52:55], a[164:167], v[72:75]
M v[76:79], a[60:63], a[164:167], v[76:79]
 buffer_load_dwordx4 v11, s[16:19], s21 offen offset:3072  nt lds
M v[76:79], a[56:59], a[160:163], v[76:79]
 s_add_u32 s21, s21, 524160
M v[80:83], a[64:67], a[160:163], v[80:83]
M v[80:83], a[68:71], a[164:167], v[80:83]
M v[84:87], a[76:79], a[164:167], v[84:87]
M v[84:87], a[72:75], a[160:163], v[84:87]
M v[88:91], a[80:83], a[160:163], v[88:91]
M v[88:91], a[84:87], a[164:167], v[88:91]
 s_waitcnt lgkmcnt(2)
M v[92:95], a[92:95], a[164:167], v[92:95]
 s_waitcnt vmcnt(20) lgkmcnt(0)
M v[92:95], a[88:91], a[160:163], v[92:95]
 s_barrier
M v[124:127], a[88:91], a[168:171], v[124:127]
 ds_read_b128 a[160:163], v5 offset:16384
 ds_read_b128 a[164:167], v6 offset:16384
M v[124:127], a[92:95], a[172:175], v[124:127]
M v[120:123], a[84:87], a[172:175], v[120:123]
 s_add_u32 m0, s24, 0
 ds_read_b64_tr_b16 a[128:129], v1 offset:49152
 ds_read_b64_tr_b16 a[130:131], v1 offset:50176
M v[120:123], a[80:83], a[168:171], v[120:123]
 buffer_load_dwordx4 v12, s[48:51], s22 offen offset:0   lds
M v[116:119], a[72:75], a[168:171], v[116:119]
M v[116:119], a[76:79], a[172:175], v[116:119]
M v[112:115], a[68:71], a[172:175], v[112:115]
M v[112:115], a[64:67], a[168:171], v[112:115]
M v[108:111], a[56:59], a[168:171], v[108:111]
 buffer_load_dwordx4 v13, s[48:51], s22 offen offset:1024   lds
M v[108:111], a[60:63], a[172:175], v[108:111]
 ds_read_b64_tr_b16 a[132:133], v1 offset:57344
 ds_read_b64_tr_b16 a[134:135], v1 offset:58368
M v[104:107], a[52:55], a[172:175], v[104:107]
M v[104:107], a[48:51], a[168:171], v[104:107]
M v[100:103], a[40:43], a[168:171], v[100:103]
M v[100:103], a[44:47], a[172:175], v[100:103]
 s_waitcnt lgkmcnt(4)
M v[96:99], a[36:39], a[172:175], v[96:99]
 buffer_load_dwordx4 v14, s[48:51], s22 offen offset:2048   lds
M v[96:99], a[32:35], a[168:171], v[96:99]
M v[128:131], a[32:35], a[160:163], v[128:131]
 ds_read_b128 a[168:171], v5 offset:18432
 ds_read_b128 a[172:175], v6 offset:18432
M v[128:131], a[36:39], a[164:167], v[128:131]
 ds_read_b64_tr_b16 a[136:137], v2 offset:49152
 ds_read_b64_tr_b16 a[138:139], v2 offset:50176
M v[132:135], a[44:47], a[164:167], v[132:135]
 buffer_load_dwordx4 v15, s[48:51], s22 offen offset:3072   lds
M v[132:135], a[40:43], a[160:163], v[132:135]
 s_add_u32 s22, s22, 2097152
M v[136:139], a[48:51], a[160:163], v[136:139]
M v[136:139], a[52:55], a[164:167], v[136:139]
M v[140:143], a[60:63], a[164:167], v[140:143]
 s_add_u32 m0, s23, 32768
M v[140:143], a[56:59], a[160:163], v[140:143]
 ds_read_b64_tr_b16 a[140:141], v2 offset:57344
 ds_read_b64_tr_b16 a[142:143], v2 offset:58368
M v[144:147], a[64:67], a[160:163], v[144:147]
 buffer_load_dwordx4 v8, s[16:19], s21 offen offset:0  nt lds
M v[144:147], a[68:71], a[164:167], v[144:147]
M v[148:151], a[76:79], a[164:167], v[148:151]
M v[148:151], a[72:75], a[160:163], v[148:151]
M v[152:155], a[80:83], a[160:163], v[152:155]
 buffer_load_dwordx4 v9, s[16:19], s21 offen offset:1024  nt lds
M v[152:155], a[84:87], a[164:167], v[152:155]
 s_waitcnt lgkmcnt(4)
M v[156:159], a[92:95], a[164:167], v[156:159]
 ds_read_b64_tr_b16 a[144:145], v3 offset:49152
 ds_read_b64_tr_b16 a[146:147], v3 offset:50176
M v[156:159], a[88:91], a[160:163], v[156:159]
M v[188:191], a[88:91], a[168:171], v[188:191]
 ds_read_b128 a[160:163], v5 offset:20480
 ds_read_b128 a[164:167], v6 offset:20480
M v[188:191], a[92:95], a[172:175], v[188:191]
M v[184:187], a[84:87], a[172:175], v[184:187]
 buffer_load_dwordx4 v10, s[16:19], s21 offen offset:2048  nt lds
M v[184:187], a[80:83], a[168:171], v[184:187]
M v[180:183], a[72:75], a[168:171], v[180:183]
M v[180:183], a[76:79], a[172:175], v[180:183]
 ds_read_b64_tr_b16 a[148:149], v3 offset:57344
 ds_read_b64_tr_b16 a[150:151], v3 offset:58368
M v[176:179], a[68:71], a[172:175], v[176:179]
M v[176:179], a[64:67], a[168:171], v[176:179]
 buffer_load_dwordx4 v11, s[16:19], s21 offen offset:3072  nt lds
M v[172:175], a[56:59], a[168:171], v[172:175]
 s_add_u32 s21, s21, 128
M v[172:175], a[60:63], a[172:175], v[172:175]
M v[168:171], a[52:55], a[172:175], v[168:171]
M v[168:171], a[48:51], a[168:171], v[168:171]
 s_add_u32 m0, s86, 4096
M v[164:167], a[40:43], a[168:171], v[164:167]
 ds_read_b64_tr_b16 a[152:153], v4 offset:49152
 ds_read_b64_tr_b16 a[154:155], v4 offset:50176
M v[164:167], a[44:47], a[172:175], v[164:167]
 s_waitcnt lgkmcnt(4)
M v[160:163], a[36:39], a[172:175], v[160:163]
 buffer_load_dwordx4 v7, s[60:63], s67 offen offset:0 nt lds
M v[160:163], a[32:35], a[168:171], v[160:163]
M v[192:195], a[32:35], a[160:163], v[192:195]
 ds_read_b128 a[168:171], v5 offset:22528
 ds_read_b128 a[172:175], v6 offset:22528
M v[192:195], a[36:39], a[164:167], v[192:195]
 buffer_load_dwordx4 v7, s[60:63], s67 offen offset:1024 nt lds
M v[196:199], a[44:47], a[164:167], v[196:199]
M v[196:199], a[40:43], a[160:163], v[196:199]
 ds_read_b64_tr_b16 a[156:157], v4 offset:57344
 ds_read_b64_tr_b16 a[158:159], v4 offset:58368
M v[200:203], a[48:51], a[160:163], v[200:203]
M v[200:203], a[52:55], a[164:167], v[200:203]
M v[204:207], a[60:63], a[164:167], v[204:207]
 buffer_load_dwordx4 v7, s[60:63], s67 offen offset:2048 nt lds
M v[204:207], a[56:59], a[160:163], v[204:207]
 s_add_u32 s67, s67, 4096
M v[208:211], a[64:67], a[160:163], v[208:211]
M v[208:211], a[68:71], a[164:167], v[208:211]
M v[212:215], a[76:79], a[164:167], v[212:215]
M v[212:215], a[72:75], a[160:163], v[212:215]
M v[216:219], a[80:83], a[160:163], v[216:219]
M v[216:219], a[84:87], a[164:167], v[216:219]
 s_waitcnt lgkmcnt(2)
M v[220:223], a[92:95], a[164:167], v[220:223]
 s_waitcnt vmcnt(23) lgkmcnt(0)
M v[220:223], a[88:91], a[160:163], v[220:223]
 s_barrier
M v[252:255], a[88:91], a[168:171], v[252:255]
 ds_read_b128 a[160:163], v5 offset:32768
 ds_read_b128 a[164:167], v6 offset:32768
M v[252:255], a[92:95], a[172:175], v[252:255]
 v_and_b32 v26, 48, v0
 v_lshlrev_b32 v26, 17, v26
M v[248:251], a[84:87], a[172:175], v[248:251]
 v_or_b32 v26, v26, v0
 v_lshl_add_u32 v26, v26, 7, s95
M v[248:251], a[80:83], a[168:171], v[248:251]
 buffer_load_dword a240, v26, s[76:79], 0 offen offset:0
M v[244:247], a[72:75], a[168:171], v[244:247]
M v[244:247], a[76:79], a[172:175], v[244:247]
M v[240:243], a[68:71], a[172:175], v[240:243]
M v[240:243], a[64:67], a[168:171], v[240:243]
M v[236:239], a[56:59], a[168:171], v[236:239]
M v[236:239], a[60:63], a[172:175], v[236:239]
M v[232:235], a[52:55], a[172:175], v[232:235]
M v[232:235], a[48:51], a[168:171], v[232:235]
M v[228:231], a[40:43], a[168:171], v[228:231]
M v[228:231], a[44:47], a[172:175], v[228:231]
 s_waitcnt lgkmcnt(0)
M v[224:227], a[36:39], a[172:175], v[224:227]
M v[224:227], a[32:35], a[168:171], v[224:227]
M a[0:3], a[96:99], a[160:163], a[0:3]
 ds_read_b128 a[168:171], v5 offset:34816
 ds_read_b128 a[172:175], v6 offset:34816
M a[0:3], a[100:103], a[164:167], a[0:3]
 ds_read_b64_tr_b16 a[32:33], v1 offset:0
 ds_read_b64_tr_b16 a[34:35], v1 offset:1024
M a[4:7], a[108:111], a[164:167], a[4:7]
 s_add_u32 m0, s24, 16384
M a[4:7], a[104:107], a[160:163], a[4:7]
 buffer_load_dwordx4 v12, s[48:51], s22 offen offset:0   lds
M a[8:11], a[112:115], a[160:163], a[8:11]
M a[8:11], a[116:119], a[164:167], a[8:11]
M a[12:15], a[124:127], a[164:167], a[12:15]
 ds_read_b64_tr_b16 a[36:37], v1 offset:8192
 ds_read_b64_tr_b16 a[38:39], v1 offset:9216
M a[12:15], a[120:123], a[160:163], a[12:15]
M a[16:19], a[128:131], a[160:163], a[16:19]
 buffer_load_dwordx4 v13, s[48:51], s22 offen offset:1024   lds
M a[16:19], a[132:135], a[164:167], a[16:19]
M a[20:23], a[140:143], a[164:167], a[20:23]
M a[20:23], a[136:139], a[160:163], a[20:23]
 ds_read_b64_tr_b16 a[40:41], v2 offset:0
 ds_read_b64_tr_b16 a[42:43], v2 offset:1024
M a[24:27], a[144:147], a[160:163], a[24:27]
M a[24:27], a[148:151], a[164:167], a[24:27]
 s_waitcnt lgkmcnt(6)
M a[28:31], a[156:159], a[164:167], a[28:31]
 buffer_load_dwordx4 v14, s[48:51], s22 offen offset:2048   lds
M a[28:31], a[152:155], a[160:163], a[28:31]
M v[60:63], a[152:155], a[168:171], v[60:63]
 ds_read_b128 a[160:163], v5 offset:36864
 ds_read_b128 a[164:167], v6 offset:36864
M v[60:63], a[156:159], a[172:175], v[60:63]
 ds_read_b64_tr_b16 a[44:45], v2 offset:8192
 ds_read_b64_tr_b16 a[46:47], v2 offset:9216
M v[56:59], a[148:151], a[172:175], v[56:59]
 buffer_load_dwordx4 v15, s[48:51], s22 offen offset:3072   lds
M v[56:59], a[144:147], a[168:171], v[56:59]
 s_sub_u32 s22, s22, 2097024
M v[52:55], a[136:139], a[168:171], v[52:55]
M v[52:55], a[140:143], a[172:175], v[52:55]
 ds_read_b64_tr_b16 a[48:49], v3 offset:0
 ds_read_b64_tr_b16 a[50:51], v3 offset:1024
M v[48:51], a[132:135], a[172:175], v[48:51]
 s_add_u32 m0, s23, 49152
M v[48:51], a[128:131], a[168:171], v[48:51]
 buffer_load_dwordx4 v8, s[16:19], s21 offen offset:0  nt lds
M v[44:47], a[120:123], a[168:171], v[44:47]
M v[44:47], a[124:127], a[172:175], v[44:47]
M v[40:43], a[116:119], a[172:175], v[40:43]
 ds_read_b64_tr_b16 a[52:53], v3 offset:8192
 ds_read_b64_tr_b16 a[54:55], v3 offset:9216
M v[40:43], a[112:115], a[168:171], v[40:43]
M v[36:39], a[104:107], a[168:171], v[36:39]
 buffer_load_dwordx4 v9, s[16:19], s21 offen offset:1024  nt lds
M v[36:39], a[108:111], a[172:175], v[36:39]
 s_waitcnt lgkmcnt(6)
M v[32:35], a[100:103], a[172:175], v[32:35]
M v[32:35], a[96:99], a[168:171], v[32:35]
 ds_read_b64_tr_b16 a[56:57], v4 offset:0
 ds_read_b64_tr_b16 a[58:59], v4 offset:1024
M v[64:67], a[96:99], a[160:163], v[64:67]
 ds_read_b128 a[168:171], v5 offset:38912
 ds_read_b128 a[172:175], v6 offset:38912
M v[64:67], a[100:103], a[164:167], v[64:67]
 buffer_load_dwordx4 v10, s[16:19], s21 offen offset:2048  nt lds
M v[68:71], a[108:111], a[164:167], v[68:71]
M v[68:71], a[104:107], a[160:163], v[68:71]
M v[72:75], a[112:115], a[160:163], v[72:75]
 ds_read_b64_tr_b16 a[60:61], v4 offset:8192
 ds_read_b64_tr_b16 a[62:63], v4 offset:9216
M v[72:75], a[116:119], a[164:167], v[72:75]
M v[76:79], a[124:127], a[164:167], v[76:79]
 buffer_load_dwordx4 v11, s[16:19], s21 offen offset:3072  nt lds
M v[76:79], a[120:123], a[160:163], v[76:79]
 s_add_u32 s21, s21, 524160
M v[80:83], a[128:131], a[160:163], v[80:83]
M v[80:83], a[132:135], a[164:167], v[80:83]
M v[84:87], a[140:143], a[164:167], v[84:87]
M v[84:87], a[136:139], a[160:163], v[84:87]
M v[88:91], a[144:147], a[160:163], v[88:91]
M v[88:91], a[148:151], a[164:167], v[88:91]
 s_waitcnt lgkmcnt(2)
M v[92:95], a[156:159], a[164:167], v[92:95]
 s_waitcnt vmcnt(20) lgkmcnt(0)
M v[92:95], a[152:155], a[160:163], v[92:95]
 s_barrier
M v[124:127], a[152:155], a[168:171], v[124:127]
 ds_read_b128 a[160:163], v5 offset:49152
 ds_read_b128 a[164:167], v6 offset:49152
M v[124:127], a[156:159], a[172:175], v[124:127]
M v[120:123], a[148:151], a[172:175], v[120:123]
 s_add_u32 m0, s24, 32768
 ds_read_b64_tr_b16 a[64:65], v1 offset:16384
 ds_read_b64_tr_b16 a[66:67], v1 offset:17408
M v[120:123], a[144:147], a[168:171], v[120:123]
 buffer_load_dwordx4 v12, s[48:51], s22 offen offset:0   lds
M v[116:119], a[136:139], a[168:171], v[116:119]
M v[116:119], a[140:143], a[172:175], v[116:119]
M v[112:115], a[132:135], a[172:175], v[112:115]
M v[112:115], a[128:131], a[168:171], v[112:115]
M v[108:111], a[120:123], a[168:171], v[108:111]
M v[108:111], a[124:127], a[172:175], v[108:111]
 ds_read_b64_tr_b16 a[68:69], v1 offset:24576
 ds_read_b64_tr_b16 a[70:71], v1 offset:25600
M v[104:107], a[116:119], a[172:175], v[104:107]
 buffer_load_dwordx4 v13, s[48:51], s22 offen offset:1024   lds
M v[104:107], a[112:115], a[168:171], v[104:107]
M v[100:103], a[104:107], a[168:171], v[100:103]
M v[100:103], a[108:111], a[172:175], v[100:103]
 s_waitcnt lgkmcnt(4)
M v[96:99], a[100:103], a[172:175], v[96:99]
M v[96:99], a[96:99], a[168:171], v[96:99]
M v[128:131], a[96:99], a[160:163], v[128:131]
 ds_read_b128 a[168:171], v5 offset:51200
 ds_read_b128 a[172:175], v6 offset:51200
M v[128:131], a[100:103], a[164:167], v[128:131]
 ds_read_b64_tr_b16 a[72:73], v2 offset:16384
 ds_read_b64_tr_b16 a[74:75], v2 offset:17408
M v[132:135], a[108:111], a[164:167], v[132:135]
 buffer_load_dwordx4 v14, s[48:51], s22 offen offset:2048   lds
M v[132:135], a[104:107], a[160:163], v[132:135]
M v[136:139], a[112:115], a[160:163], v[136:139]
M v[136:139], a[116:119], a[164:167], v[136:139]
M v[140:143], a[124:127], a[164:167], v[140:143]
M v[140:143], a[120:123], a[160:163], v[140:143]
 ds_read_b64_tr_b16 a[76:77], v2 offset:24576
 ds_read_b64_tr_b16 a[78:79], v2 offset:25600
M v[144:147], a[128:131], a[160:163], v[144:147]
 buffer_load_dwordx4 v15, s[48:51], s22 offen offset:3072   lds
M v[144:147], a[132:135], a[164:167], v[144:147]
 s_add_u32 s22, s22, 2097152
M v[148:151], a[140:143], a[164:167], v[148:151]
M v[148:151], a[136:139], a[160:163], v[148:151]
M v[152:155], a[144:147], a[160:163], v[152:155]
M v[152:155], a[148:151], a[164:167], v[152:155]
 s_waitcnt lgkmcnt(4)
M v[156:159], a[156:159], a[164:167], v[156:159]
 s_add_u32 m0, s23, 0
 ds_read_b64_tr_b16 a[80:81], v3 offset:16384
 ds_read_b64_tr_b16 a[82:83], v3 offset:17408
M v[156:159], a[152:155], a[160:163], v[156:159]
 buffer_load_dwordx4 v8, s[16:19], s21 offen offset:0  nt lds
M v[188:191], a[152:155], a[168:171], v[188:191]
 ds_read_b128 a[160:163], v5 offset:53248
 ds_read_b128 a[164:167], v6 offset:53248
M v[188:191], a[156:159], a[172:175], v[188:191]
M v[184:187], a[148:151], a[172:175], v[184:187]
M v[184:187], a[144:147], a[168:171], v[184:187]
M v[180:183], a[136:139], a[168:171], v[180:183]
M v[180:183], a[140:143], a[172:175], v[180:183]
 ds_read_b64_tr_b16 a[84:85], v3 offset:24576
 ds_read_b64_tr_b16 a[86:87], v3 offset:25600
M v[176:179], a[132:135], a[172:175], v[176:179]
 buffer_load_dwordx4 v9, s[16:19], s21 offen offset:1024  nt lds
M v[176:179], a[128:131], a[168:171], v[176:179]
M v[172:175], a[120:123], a[168:171], v[172:175]
M v[172:175], a[124:127], a[172:175], v[172:175]
M v[168:171], a[116:119], a[172:175], v[168:171]
M v[168:171], a[112:115], a[168:171], v[168:171]
M v[164:167], a[104:107], a[168:171], v[164:167]
 ds_read_b64_tr_b16 a[88:89], v4 offset:16384
 ds_read_b64_tr_b16 a[90:91], v4 offset:17408
M v[164:167], a[108:111], a[172:175], v[164:167]
 s_waitcnt lgkmcnt(4)
M v[160:163], a[100:103], a[172:175], v[160:163]
 buffer_load_dwordx4 v10, s[16:19], s21 offen offset:2048  nt lds
M v[160:163], a[96:99], a[168:171], v[160:163]
M v[192:195], a[96:99], a[160:163], v[192:195]
 ds_read_b128 a[168:171], v5 offset:55296
 ds_read_b128 a[172:175], v6 offset:55296
M v[192:195], a[100:103], a[164:167], v[192:195]
M v[196:199], a[108:111], a[164:167], v[196:199]
M v[196:199], a[104:107], a[160:163], v[196:199]
 ds_read_b64_tr_b16 a[92:93], v4 offset:24576
 ds_read_b64_tr_b16 a[94:95], v4 offset:25600
M v[200:203], a[112:115], a[160:163], v[200:203]
 buffer_load_dwordx4 v11, s[16:19], s21 offen offset:3072  nt lds
M v[200:203], a[116:119], a[164:167], v[200:203]
 s_add_u32 s21, s21, 128
M v[204:207], a[124:127], a[164:167], v[204:207]
M v[204:207], a[120:123], a[160:163], v[204:207]
M v[208:211], a[128:131], a[160:163], v[208:211]
M v[208:211], a[132:135], a[164:167], v[208:211]
M v[212:215], a[140:143], a[164:167], v[212:215]
M v[212:215], a[136:139], a[160:163], v[212:215]
M v[216:219], a[144:147], a[160:163], v[216:219]
M v[216:219], a[148:151], a[164:167], v[216:219]
 s_waitcnt lgkmcnt(2)
M v[220:223], a[156:159], a[164:167], v[220:223]
 s_waitcnt vmcnt(17) lgkmcnt(0)
M v[220:223], a[152:155], a[160:163], v[220:223]
 s_barrier
M v[252:255], a[152:155], a[168:171], v[252:255]
 ds_read_b128 a[160:163], v5 offset:0
 ds_read_b128 a[164:167], v6 offset:0
M v[252:255], a[156:159], a[172:175], v[252:255]
M v[248:251], a[148:151], a[172:175], v[248:251]
M v[248:251], a[144:147], a[168:171], v[248:251]
M v[244:247], a[136:139], a[168:171], v[244:247]
M v[244:247], a[140:143], a[172:175], v[244:247]
M v[240:243], a[132:135], a[172:175], v[240:243]
M v[240:243], a[128:131], a[168:171], v[240:243]
M v[236:239], a[120:123], a[168:171], v[236:239]
M v[236:239], a[124:127], a[172:175], v[236:239]
M v[232:235], a[116:119], a[172:175], v[232:235]
M v[232:235], a[112:115], a[168:171], v[232:235]
M v[228:231], a[104:107], a[168:171], v[228:231]
M v[228:231], a[108:111], a[172:175], v[228:231]
 s_waitcnt lgkmcnt(0)
M v[224:227], a[100:103], a[172:175], v[224:227]
M v[224:227], a[96:99], a[168:171], v[224:227]
M a[0:3], a[32:35], a[160:163], a[0:3]
 ds_read_b128 a[168:171], v5 offset:2048
 ds_read_b128 a[172:175], v6 offset:2048
M a[0:3], a[36:39], a[164:167], a[0:3]
 ds_read_b64_tr_b16 a[96:97], v1 offset:32768
 ds_read_b64_tr_b16 a[98:99], v1 offset:33792
M a[4:7], a[44:47], a[164:167], a[4:7]
 s_add_u32 m0, s24, 49152
 v_lshrrev_b32 v28, 2, v0
M a[4:7], a[40:43], a[160:163], a[4:7]
 buffer_load_dwordx4 v12, s[48:51], s22 offen offset:0   lds
M a[8:11], a[48:51], a[160:163], a[8:11]
 v_mul_u32_u24 v28, 896, v28
M a[8:11], a[52:55], a[164:167], a[8:11]
M a[12:15], a[60:63], a[164:167], a[12:15]
 ds_read_b64_tr_b16 a[100:101], v1 offset:40960
 ds_read_b64_tr_b16 a[102:103], v1 offset:41984
M a[12:15], a[56:59], a[160:163], a[12:15]
 v_and_b32 v29, 3, v0
M a[16:19], a[64:67], a[160:163], a[16:19]
 buffer_load_dwordx4 v13, s[48:51], s22 offen offset:1024   lds
M a[16:19], a[68:71], a[164:167], a[16:19]
 v_lshl_add_u32 v28, v29, 4, v28
M a[20:23], a[76:79], a[164:167], a[20:23]
M a[20:23], a[72:75], a[160:163], a[20:23]
 s_lshr_b32 s64, s20, 1
 ds_read_b64_tr_b16 a[104:105], v2 offset:32768
 ds_read_b64_tr_b16 a[106:107], v2 offset:33792
M a[24:27], a[80:83], a[160:163], a[24:27]
 s_lshl_b32 s64, s64, 6
 s_and_b32 s72, s20, 1
 s_lshl_b32 s72, s72, 3
M a[24:27], a[84:87], a[164:167], a[24:27]
 s_waitcnt lgkmcnt(6)
 s_add_u32 s64, s64, s72
 s_add_u32 s64, s64, 131072
M a[28:31], a[92:95], a[164:167], a[28:31]
 buffer_load_dwordx4 v14, s[48:51], s22 offen offset:2048   lds
M a[28:31], a[88:91], a[160:163], a[28:31]
 v_add_u32 v28, s64, v28
M v[60:63], a[88:91], a[168:171], v[60:63]
 ds_read_b128 a[160:163], v5 offset:4096
 ds_read_b128 a[164:167], v6 offset:4096
M v[60:63], a[92:95], a[172:175], v[60:63]
 s_lshl_b32 s94, s41, 18
 ds_read_b64_tr_b16 a[108:109], v2 offset:40960
 ds_read_b64_tr_b16 a[110:111], v2 offset:41984
M v[56:59], a[84:87], a[172:175], v[56:59]
 buffer_load_dwordx4 v15, s[48:51], s22 offen offset:3072   lds
M v[56:59], a[80:83], a[168:171], v[56:59]
 s_sub_u32 s22, s22, 2097024
 s_and_b32 s64, s42, 7
M v[52:55], a[72:75], a[168:171], v[52:55]
 s_lshl_b32 s64, s64, 10
M v[52:55], a[76:79], a[172:175], v[52:55]
 s_add_u32 s94, s94, s64
 ds_read_b64_tr_b16 a[112:113], v3 offset:32768
 ds_read_b64_tr_b16 a[114:115], v3 offset:33792
M v[48:51], a[68:71], a[172:175], v[48:51]
 s_add_u32 m0, s23, 16384
 s_lshl_b32 s64, s20, 13
 s_add_u32 s94, s94, s64
M v[48:51], a[64:67], a[168:171], v[48:51]
 buffer_load_dwordx4 v8, s[16:19], s21 offen offset:0  nt lds
M v[44:47], a[56:59], a[168:171], v[44:47]
 s_add_u32 s94, s94, 100663296
 ds_read_b64_tr_b16 a[192:193], v28 offset:0
M v[44:47], a[60:63], a[172:175], v[44:47]
M v[40:43], a[52:55], a[172:175], v[40:43]
 ds_read_b64_tr_b16 a[116:117], v3 offset:40960
 ds_read_b64_tr_b16 a[118:119], v3 offset:41984
M v[40:43], a[48:51], a[168:171], v[40:43]
 ds_read_b64_tr_b16 a[194:195], v28 offset:14336
M v[36:39], a[40:43], a[168:171], v[36:39]
 buffer_load_dwordx4 v9, s[16:19], s21 offen offset:1024  nt lds
M v[36:39], a[44:47], a[172:175], v[36:39]
 s_waitcnt lgkmcnt(8)
 ds_read_b64_tr_b16 a[196:197], v28 offset:128
M v[32:35], a[36:39], a[172:175], v[32:35]
M v[32:35], a[32:35], a[168:171], v[32:35]
 ds_read_b64_tr_b16 a[120:121], v4 offset:32768
 ds_read_b64_tr_b16 a[122:123], v4 offset:33792
M v[64:67], a[32:35], a[160:163], v[64:67]
 ds_read_b128 a[168:171], v5 offset:6144
 ds_read_b128 a[172:175], v6 offset:6144
M v[64:67], a[36:39], a[164:167], v[64:67]
 buffer_load_dwordx4 v10, s[16:19], s21 offen offset:2048  nt lds
M v[68:71], a[44:47], a[164:167], v[68:71]
 ds_read_b64_tr_b16 a[198:199], v28 offset:14464
M v[68:71], a[40:43], a[160:163], v[68:71]
M v[72:75], a[48:51], a[160:163], v[72:75]
 ds_read_b64_tr_b16 a[124:125], v4 offset:40960
 ds_read_b64_tr_b16 a[126:127], v4 offset:41984
M v[72:75], a[52:55], a[164:167], v[72:75]
 ds_read_b64_tr_b16 a[200:201], v28 offset:256
M v[76:79], a[60:63], a[164:167], v[76:79]
 buffer_load_dwordx4 v11, s[16:19], s21 offen offset:3072  nt lds
M v[76:79], a[56:59], a[160:163], v[76:79]
 s_add_u32 s21, s21, 524160
 ds_read_b64_tr_b16 a[202:203], v28 offset:14592
M v[80:83], a[64:67], a[160:163], v[80:83]
M v[80:83], a[68:71], a[164:167], v[80:83]
 ds_read_b64_tr_b16 a[204:205], v28 offset:384
M v[84:87], a[76:79], a[164:167], v[84:87]
M v[84:87], a[72:75], a[160:163], v[84:87]
 ds_read_b64_tr_b16 a[206:207], v28 offset:14720
M v[88:91], a[80:83], a[160:163], v[88:91]
M v[88:91], a[84:87], a[164:167], v[88:91]
 s_waitcnt lgkmcnt(7)
 ds_read_b64_tr_b16 a[208:209], v28 offset:512
M v[92:95], a[92:95], a[164:167], v[92:95]
 s_waitcnt vmcnt(16) lgkmcnt(0)
M v[92:95], a[88:91], a[160:163], v[92:95]
 s_barrier
M v[124:127], a[88:91], a[168:171], v[124:127]
 ds_read_b128 a[160:163], v5 offset:16384
 ds_read_b128 a[164:167], v6 offset:16384
M v[124:127], a[92:95], a[172:175], v[124:127]
 ds_read_b64_tr_b16 a[210:211], v28 offset:14848
M v[120:123], a[84:87], a[172:175], v[120:123]
 s_add_u32 m0, s24, 0
 ds_read_b64_tr_b16 a[128:129], v1 offset:49152
 ds_read_b64_tr_b16 a[130:131], v1 offset:50176
M v[120:123], a[80:83], a[168:171], v[120:123]
 buffer_load_dwordx4 v12, s[48:51], s22 offen offset:0   lds
M v[116:119], a[72:75], a[168:171], v[116:119]
 ds_read_b64_tr_b16 a[212:213], v28 offset:640
M v[116:119], a[76:79], a[172:175], v[116:119]
M v[112:115], a[68:71], a[172:175], v[112:115]
 ds_read_b64_tr_b16 a[214:215], v28 offset:14976
M v[112:115], a[64:67], a[168:171], v[112:115]
M v[108:111], a[56:59], a[168:171], v[108:111]
 ds_read_b64_tr_b16 a[216:217], v28 offset:768
M v[108:111], a[60:63], a[172:175], v[108:111]
 ds_read_b64_tr_b16 a[132:133], v1 offset:57344
 ds_read_b64_tr_b16 a[134:135], v1 offset:58368
M v[104:107], a[52:55], a[172:175], v[104:107]
 buffer_load_dwordx4 v13, s[48:51], s22 offen offset:1024   lds
M v[104:107], a[48:51], a[168:171], v[104:107]
 ds_read_b64_tr_b16 a[218:219], v28 offset:15104
M v[100:103], a[40:43], a[168:171], v[100:103]
M v[100:103], a[44:47], a[172:175], v[100:103]
 s_waitcnt lgkmcnt(9)
M v[96:99], a[36:39], a[172:175], v[96:99]
M v[96:99], a[32:35], a[168:171], v[96:99]
M v[128:131], a[32:35], a[160:163], v[128:131]
 ds_read_b128 a[168:171], v5 offset:18432
 ds_read_b128 a[172:175], v6 offset:18432
M v[128:131], a[36:39], a[164:167], v[128:131]
 ds_read_b64_tr_b16 a[136:137], v2 offset:49152
 ds_read_b64_tr_b16 a[138:139], v2 offset:50176
M v[132:135], a[44:47], a[164:167], v[132:135]
 buffer_load_dwordx4 v14, s[48:51], s22 offen offset:2048   lds
M v[132:135], a[40:43], a[160:163], v[132:135]
M v[136:139], a[48:51], a[160:163], v[136:139]
M v[136:139], a[52:55], a[164:167], v[136:139]
M v[140:143], a[60:63], a[164:167], v[140:143]
M v[140:143], a[56:59], a[160:163], v[140:143]
 ds_read_b64_tr_b16 a[140:141], v2 offset:57344
 ds_read_b64_tr_b16 a[142:143], v2 offset:58368
M v[144:147], a[64:67], a[160:163], v[144:147]
 buffer_load_dwordx4 v15, s[48:51], s22 offen offset:3072   lds
M v[144:147], a[68:71], a[164:167], v[144:147]
 s_add_u32 s22, s22, 2097152
M v[148:151], a[76:79], a[164:167], v[148:151]
M v[148:151], a[72:75], a[160:163], v[148:151]
M v[152:155], a[80:83], a[160:163], v[152:155]
M v[152:155], a[84:87], a[164:167], v[152:155]
 s_waitcnt lgkmcnt(4)
M v[156:159], a[92:95], a[164:167], v[156:159]
 s_add_u32 m0, s23, 32768
 ds_read_b64_tr_b16 a[144:145], v3 offset:49152
 ds_read_b64_tr_b16 a[146:147], v3 offset:50176
M v[156:159], a[88:91], a[160:163], v[156:159]
 buffer_load_dwordx4 v8, s[16:19], s21 offen offset:0  nt lds
M v[188:191], a[88:91], a[168:171], v[188:191]
 ds_read_b128 a[160:163], v5 offset:20480
 ds_read_b128 a[164:167], v6 offset:20480
M v[188:191], a[92:95], a[172:175], v[188:191]
M v[184:187], a[84:87], a[172:175], v[184:187]
M v[184:187], a[80:83], a[168:171], v[184:187]
M v[180:183], a[72:75], a[168:171], v[180:183]
M v[180:183], a[76:79], a[172:175], v[180:183]
 ds_read_b64_tr_b16 a[148:149], v3 offset:57344
 ds_read_b64_tr_b16 a[150:151], v3 offset:58368
M v[176:179], a[68:71], a[172:175], v[176:179]
 buffer_load_dwordx4 v9, s[16:19], s21 offen offset:1024  nt lds
M v[176:179], a[64:67], a[168:171], v[176:179]
M v[172:175], a[56:59], a[168:171], v[172:175]
M v[172:175], a[60:63], a[172:175], v[172:175]
M v[168:171], a[52:55], a[172:175], v[168:171]
M v[168:171], a[48:51], a[168:171], v[168:171]
M v[164:167], a[40:43], a[168:171], v[164:167]
 ds_read_b64_tr_b16 a[152:153], v4 offset:49152
 ds_read_b64_tr_b16 a[154:155], v4 offset:50176
M v[164:167], a[44:47], a[172:175], v[164:167]
 s_waitcnt lgkmcnt(4)
M v[160:163], a[36:39], a[172:175], v[160:163]
 buffer_load_dwordx4 v10, s[16:19], s21 offen offset:2048  nt lds
M v[160:163], a[32:35], a[168:171], v[160:163]
M v[192:195], a[32:35], a[160:163], v[192:195]
 ds_read_b128 a[168:171], v5 offset:22528
 ds_read_b128 a[172:175], v6 offset:22528
M v[192:195], a[36:39], a[164:167], v[192:195]
M v[196:199], a[44:47], a[164:167], v[196:199]
M v[196:199], a[40:43], a[160:163], v[196:199]
 ds_read_b64_tr_b16 a[156:157], v4 offset:57344
 ds_read_b64_tr_b16 a[158:159], v4 offset:58368
M v[200:203], a[48:51], a[160:163], v[200:203]
 buffer_load_dwordx4 v11, s[16:19], s21 offen offset:3072  nt lds
M v[200:203], a[52:55], a[164:167], v[200:203]
 s_add_u32 s21, s21, 128
M v[204:207], a[60:63], a[164:167], v[204:207]
M v[204:207], a[56:59], a[160:163], v[204:207]
M v[208:211], a[64:67], a[160:163], v[208:211]
M v[208:211], a[68:71], a[164:167], v[208:211]
M v[212:215], a[76:79], a[164:167], v[212:215]
M v[212:215], a[72:75], a[160:163], v[212:215]
M v[216:219], a[80:83], a[160:163], v[216:219]
M v[216:219], a[84:87], a[164:167], v[216:219]
 s_waitcnt lgkmcnt(2)
M v[220:223], a[92:95], a[164:167], v[220:223]
 s_waitcnt vmcnt(16) lgkmcnt(0)
M v[220:223], a[88:91], a[160:163], v[220:223]
 s_barrier
M v[252:255], a[88:91], a[168:171], v[252:255]
 ds_read_b128 a[160:163], v5 offset:32768
 ds_read_b128 a[164:167], v6 offset:32768
M v[252:255], a[92:95], a[172:175], v[252:255]
 buffer_load_dword a240, v24, s[32:35], 0 offen offset:1536
M v[248:251], a[84:87], a[172:175], v[248:251]
M v[248:251], a[80:83], a[168:171], v[248:251]
M v[244:247], a[72:75], a[168:171], v[244:247]
M v[244:247], a[76:79], a[172:175], v[244:247]
M v[240:243], a[68:71], a[172:175], v[240:243]
M v[240:243], a[64:67], a[168:171], v[240:243]
M v[236:239], a[56:59], a[168:171], v[236:239]
M v[236:239], a[60:63], a[172:175], v[236:239]
M v[232:235], a[52:55], a[172:175], v[232:235]
M v[232:235], a[48:51], a[168:171], v[232:235]
M v[228:231], a[40:43], a[168:171], v[228:231]
M v[228:231], a[44:47], a[172:175], v[228:231]
 s_waitcnt lgkmcnt(0)
M v[224:227], a[36:39], a[172:175], v[224:227]
M v[224:227], a[32:35], a[168:171], v[224:227]
M a[0:3], a[96:99], a[160:163], a[0:3]
 ds_read_b128 a[168:171], v5 offset:34816
 ds_read_b128 a[172:175], v6 offset:34816
M a[0:3], a[100:103], a[164:167], a[0:3]
 ds_read_b64_tr_b16 a[32:33], v1 offset:0
 ds_read_b64_tr_b16 a[34:35], v1 offset:1024
M a[4:7], a[108:111], a[164:167], a[4:7]
 s_add_u32 m0, s24, 16384
M a[4:7], a[104:107], a[160:163], a[4:7]
 buffer_load_dwordx4 v12, s[48:51], s22 offen offset:0   lds
M a[8:11], a[112:115], a[160:163], a[8:11]
M a[8:11], a[116:119], a[164:167], a[8:11]
M a[12:15], a[124:127], a[164:167], a[12:15]
 ds_read_b64_tr_b16 a[36:37], v1 offset:8192
 ds_read_b64_tr_b16 a[38:39], v1 offset:9216
M a[12:15], a[120:123], a[160:163], a[12:15]
M a[16:19], a[128:131], a[160:163], a[16:19]
 buffer_load_dwordx4 v13, s[48:51], s22 offen offset:1024   lds
M a[16:19], a[132:135], a[164:167], a[16:19]
M a[20:23], a[140:143], a[164:167], a[20:23]
M a[20:23], a[136:139], a[160:163], a[20:23]
 ds_read_b64_tr_b16 a[40:41], v2 offset:0
 ds_read_b64_tr_b16 a[42:43], v2 offset:1024
M a[24:27], a[144:147], a[160:163], a[24:27]
M a[24:27], a[148:151], a[164:167], a[24:27]
 s_waitcnt lgkmcnt(6)
M a[28:31], a[156:159], a[164:167], a[28:31]
 buffer_load_dwordx4 v14, s[48:51], s22 offen offset:2048   lds
M a[28:31], a[152:155], a[160:163], a[28:31]
M v[60:63], a[152:155], a[168:171], v[60:63]
 ds_read_b128 a[160:163], v5 offset:36864
 ds_read_b128 a[164:167], v6 offset:36864
M v[60:63], a[156:159], a[172:175], v[60:63]
 ds_read_b64_tr_b16 a[44:45], v2 offset:8192
 ds_read_b64_tr_b16 a[46:47], v2 offset:9216
M v[56:59], a[148:151], a[172:175], v[56:59]
 buffer_load_dwordx4 v15, s[48:51], s22 offen offset:3072   lds
M v[56:59], a[144:147], a[168:171], v[56:59]
 s_sub_u32 s22, s22, 2097024
M v[52:55], a[136:139], a[168:171], v[52:55]
M v[52:55], a[140:143], a[172:175], v[52:55]
 ds_read_b64_tr_b16 a[48:49], v3 offset:0
 ds_read_b64_tr_b16 a[50:51], v3 offset:1024
M v[48:51], a[132:135], a[172:175], v[48:51]
 s_add_u32 m0, s23, 49152
M v[48:51], a[128:131], a[168:171], v[48:51]
 buffer_load_dwordx4 v8, s[16:19], s21 offen offset:0  nt lds
M v[44:47], a[120:123], a[168:171], v[44:47]
M v[44:47], a[124:127], a[172:175], v[44:47]
M v[40:43], a[116:119], a[172:175], v[40:43]
 ds_read_b64_tr_b16 a[52:53], v3 offset:8192
 ds_read_b64_tr_b16 a[54:55], v3 offset:9216
M v[40:43], a[112:115], a[168:171], v[40:43]
M v[36:39], a[104:107], a[168:171], v[36:39]
 buffer_load_dwordx4 v9, s[16:19], s21 offen offset:1024  nt lds
M v[36:39], a[108:111], a[172:175], v[36:39]
 s_waitcnt lgkmcnt(6)
M v[32:35], a[100:103], a[172:175], v[32:35]
M v[32:35], a[96:99], a[168:171], v[32:35]
 ds_read_b64_tr_b16 a[56:57], v4 offset:0
 ds_read_b64_tr_b16 a[58:59], v4 offset:1024
M v[64:67], a[96:99], a[160:163], v[64:67]
 ds_read_b128 a[168:171], v5 offset:38912
 ds_read_b128 a[172:175], v6 offset:38912
M v[64:67], a[100:103], a[164:167], v[64:67]
 buffer_load_dwordx4 v10, s[16:19], s21 offen offset:2048  nt lds
M v[68:71], a[108:111], a[164:167], v[68:71]
M v[68:71], a[104:107], a[160:163], v[68:71]
M v[72:75], a[112:115], a[160:163], v[72:75]
 ds_read_b64_tr_b16 a[60:61], v4 offset:8192
 ds_read_b64_tr_b16 a[62:63], v4 offset:9216
M v[72:75], a[116:119], a[164:167], v[72:75]
M v[76:79], a[124:127], a[164:167], v[76:79]
 buffer_load_dwordx4 v11, s[16:19], s21 offen offset:3072  nt lds
M v[76:79], a[120:123], a[160:163], v[76:79]
 s_add_u32 s21, s21, 524160
M v[80:83], a[128:131], a[160:163], v[80:83]
M v[80:83], a[132:135], a[164:167], v[80:83]
M v[84:87], a[140:143], a[164:167], v[84:87]
M v[84:87], a[136:139], a[160:163], v[84:87]
M v[88:91], a[144:147], a[160:163], v[88:91]
M v[88:91], a[148:151], a[164:167], v[88:91]
 s_waitcnt lgkmcnt(2)
M v[92:95], a[156:159], a[164:167], v[92:95]
 s_waitcnt vmcnt(17) lgkmcnt(0)
M v[92:95], a[152:155], a[160:163], v[92:95]
 s_barrier
M v[124:127], a[152:155], a[168:171], v[124:127]
 ds_read_b128 a[160:163], v5 offset:49152
 ds_read_b128 a[164:167], v6 offset:49152
M v[124:127], a[156:159], a[172:175], v[124:127]
M v[120:123], a[148:151], a[172:175], v[120:123]
 s_add_u32 m0, s24, 32768
 ds_read_b64_tr_b16 a[64:65], v1 offset:16384
 ds_read_b64_tr_b16 a[66:67], v1 offset:17408
M v[120:123], a[144:147], a[168:171], v[120:123]
 buffer_load_dwordx4 v12, s[48:51], s22 offen offset:0   lds
M v[116:119], a[136:139], a[168:171], v[116:119]
M v[116:119], a[140:143], a[172:175], v[116:119]
M v[112:115], a[132:135], a[172:175], v[112:115]
M v[112:115], a[128:131], a[168:171], v[112:115]
M v[108:111], a[120:123], a[168:171], v[108:111]
M v[108:111], a[124:127], a[172:175], v[108:111]
 ds_read_b64_tr_b16 a[68:69], v1 offset:24576
 ds_read_b64_tr_b16 a[70:71], v1 offset:25600
M v[104:107], a[116:119], a[172:175], v[104:107]
 buffer_load_dwordx4 v13, s[48:51], s22 offen offset:1024   lds
M v[104:107], a[112:115], a[168:171], v[104:107]
M v[100:103], a[104:107], a[168:171], v[100:103]
 s_and_b32 s64, s42, 7
 s_lshl_b32 s64, s64, 2
M v[100:103], a[108:111], a[172:175], v[100:103]
 s_waitcnt lgkmcnt(4)
 s_add_u32 s64, s64, s20
M v[96:99], a[100:103], a[172:175], v[96:99]
 s_mul_i32 s64, s64, 114688
 v_bfe_u32 v28, v0, 2, 2
 v_and_b32 v29, 3, v0
M v[96:99], a[96:99], a[168:171], v[96:99]
 v_lshlrev_b32 v29, 7, v29
 v_lshl_add_u32 v28, v28, 13, v29
M v[128:131], a[96:99], a[160:163], v[128:131]
 ds_read_b128 a[168:171], v5 offset:51200
 ds_read_b128 a[172:175], v6 offset:51200
M v[128:131], a[100:103], a[164:167], v[128:131]
 ds_read_b64_tr_b16 a[72:73], v2 offset:16384
 ds_read_b64_tr_b16 a[74:75], v2 offset:17408
M v[132:135], a[108:111], a[164:167], v[132:135]
 buffer_load_dwordx4 v14, s[48:51], s22 offen offset:2048   lds
M v[132:135], a[104:107], a[160:163], v[132:135]
 v_add_u32 v23, s64, v28
 v_and_b32 v28, 48, v0
M v[136:139], a[112:115], a[160:163], v[136:139]
 v_lshl_add_u32 v23, v28, 24, v23
M v[136:139], a[116:119], a[164:167], v[136:139]
M v[140:143], a[124:127], a[164:167], v[140:143]
M v[140:143], a[120:123], a[160:163], v[140:143]
 ds_read_b64_tr_b16 a[76:77], v2 offset:24576
 ds_read_b64_tr_b16 a[78:79], v2 offset:25600
M v[144:147], a[128:131], a[160:163], v[144:147]
 buffer_load_dwordx4 v15, s[48:51], s22 offen offset:3072   lds
M v[144:147], a[132:135], a[164:167], v[144:147]
 s_add_u32 s22, s22, 2097152
M v[148:151], a[140:143], a[164:167], v[148:151]
M v[148:151], a[136:139], a[160:163], v[148:151]
M v[152:155], a[144:147], a[160:163], v[152:155]
M v[152:155], a[148:151], a[164:167], v[152:155]
 s_waitcnt lgkmcnt(4)
M v[156:159], a[156:159], a[164:167], v[156:159]
 s_add_u32 m0, s23, 0
 ds_read_b64_tr_b16 a[80:81], v3 offset:16384
 ds_read_b64_tr_b16 a[82:83], v3 offset:17408
M v[156:159], a[152:155], a[160:163], v[156:159]
 buffer_load_dwordx4 v8, s[16:19], s21 offen offset:0  nt lds
M v[188:191], a[152:155], a[168:171], v[188:191]
 ds_read_b128 a[160:163], v5 offset:53248
 ds_read_b128 a[164:167], v6 offset:53248
M v[188:191], a[156:159], a[172:175], v[188:191]
M v[184:187], a[148:151], a[172:175], v[184:187]
M v[184:187], a[144:147], a[168:171], v[184:187]
M v[180:183], a[136:139], a[168:171], v[180:183]
M v[180:183], a[140:143], a[172:175], v[180:183]
 ds_read_b64_tr_b16 a[84:85], v3 offset:24576
 ds_read_b64_tr_b16 a[86:87], v3 offset:25600
M v[176:179], a[132:135], a[172:175], v[176:179]
 buffer_load_dwordx4 v9, s[16:19], s21 offen offset:1024  nt lds
M v[176:179], a[128:131], a[168:171], v[176:179]
M v[172:175], a[120:123], a[168:171], v[172:175]
M v[172:175], a[124:127], a[172:175], v[172:175]
M v[168:171], a[116:119], a[172:175], v[168:171]
M v[168:171], a[112:115], a[168:171], v[168:171]
M v[164:167], a[104:107], a[168:171], v[164:167]
 ds_read_b64_tr_b16 a[88:89], v4 offset:16384
 ds_read_b64_tr_b16 a[90:91], v4 offset:17408
M v[164:167], a[108:111], a[172:175], v[164:167]
 s_waitcnt lgkmcnt(4)
M v[160:163], a[100:103], a[172:175], v[160:163]
 buffer_load_dwordx4 v10, s[16:19], s21 offen offset:2048  nt lds
M v[160:163], a[96:99], a[168:171], v[160:163]
M v[192:195], a[96:99], a[160:163], v[192:195]
 ds_read_b128 a[168:171], v5 offset:55296
 ds_read_b128 a[172:175], v6 offset:55296
M v[192:195], a[100:103], a[164:167], v[192:195]
M v[196:199], a[108:111], a[164:167], v[196:199]
M v[196:199], a[104:107], a[160:163], v[196:199]
 ds_read_b64_tr_b16 a[92:93], v4 offset:24576
 ds_read_b64_tr_b16 a[94:95], v4 offset:25600
M v[200:203], a[112:115], a[160:163], v[200:203]
 buffer_load_dwordx4 v11, s[16:19], s21 offen offset:3072  nt lds
M v[200:203], a[116:119], a[164:167], v[200:203]
 s_add_u32 s21, s21, 128
M v[204:207], a[124:127], a[164:167], v[204:207]
M v[204:207], a[120:123], a[160:163], v[204:207]
M v[208:211], a[128:131], a[160:163], v[208:211]
M v[208:211], a[132:135], a[164:167], v[208:211]
M v[212:215], a[140:143], a[164:167], v[212:215]
M v[212:215], a[136:139], a[160:163], v[212:215]
M v[216:219], a[144:147], a[160:163], v[216:219]
M v[216:219], a[148:151], a[164:167], v[216:219]
 s_waitcnt lgkmcnt(2)
M v[220:223], a[156:159], a[164:167], v[220:223]
 s_waitcnt vmcnt(17) lgkmcnt(0)
M v[220:223], a[152:155], a[160:163], v[220:223]
 s_barrier
M v[252:255], a[152:155], a[168:171], v[252:255]
 ds_read_b128 a[160:163], v5 offset:0
 ds_read_b128 a[164:167], v6 offset:0
M v[252:255], a[156:159], a[172:175], v[252:255]
 buffer_load_dword a240, v23, s[52:55], 0 offen offset:0
M v[248:251], a[148:151], a[172:175], v[248:251]
 v_add_u32 v23, 32768, v23
M v[248:251], a[144:147], a[168:171], v[248:251]
M v[244:247], a[136:139], a[168:171], v[244:247]
M v[244:247], a[140:143], a[172:175], v[244:247]
M v[240:243], a[132:135], a[172:175], v[240:243]
M v[240:243], a[128:131], a[168:171], v[240:243]
M v[236:239], a[120:123], a[168:171], v[236:239]
M v[236:239], a[124:127], a[172:175], v[236:239]
M v[232:235], a[116:119], a[172:175], v[232:235]
M v[232:235], a[112:115], a[168:171], v[232:235]
M v[228:231], a[104:107], a[168:171], v[228:231]
M v[228:231], a[108:111], a[172:175], v[228:231]
 s_waitcnt lgkmcnt(0)
M v[224:227], a[100:103], a[172:175], v[224:227]
M v[224:227], a[96:99], a[168:171], v[224:227]
M a[0:3], a[32:35], a[160:163], a[0:3]
 ds_read_b128 a[168:171], v5 offset:2048
 ds_read_b128 a[172:175], v6 offset:2048
M a[0:3], a[36:39], a[164:167], a[0:3]
 ds_read_b64_tr_b16 a[96:97], v1 offset:32768
 ds_read_b64_tr_b16 a[98:99], v1 offset:33792
M a[4:7], a[44:47], a[164:167], a[4:7]
 s_add_u32 m0, s24, 49152
M a[4:7], a[40:43], a[160:163], a[4:7]
 buffer_load_dwordx4 v12, s[48:51], s22 offen offset:0   lds
M a[8:11], a[48:51], a[160:163], a[8:11]
M a[8:11], a[52:55], a[164:167], a[8:11]
M a[12:15], a[60:63], a[164:167], a[12:15]
 ds_read_b64_tr_b16 a[100:101], v1 offset:40960
 ds_read_b64_tr_b16 a[102:103], v1 offset:41984
M a[12:15], a[56:59], a[160:163], a[12:15]
M a[16:19], a[64:67], a[160:163], a[16:19]
 buffer_load_dwordx4 v13, s[48:51], s22 offen offset:1024   lds
M a[16:19], a[68:71], a[164:167], a[16:19]
M a[20:23], a[76:79], a[164:167], a[20:23]
M a[20:23], a[72:75], a[160:163], a[20:23]
 ds_read_b64_tr_b16 a[104:105], v2 offset:32768
 ds_read_b64_tr_b16 a[106:107], v2 offset:33792
M a[24:27], a[80:83], a[160:163], a[24:27]
M a[24:27], a[84:87], a[164:167], a[24:27]
 s_waitcnt lgkmcnt(6)
M a[28:31], a[92:95], a[164:167], a[28:31]
 buffer_load_dwordx4 v14, s[48:51], s22 offen offset:2048   lds
M a[28:31], a[88:91], a[160:163], a[28:31]
M v[60:63], a[88:91], a[168:171], v[60:63]
 ds_read_b128 a[160:163], v5 offset:4096
 ds_read_b128 a[164:167], v6 offset:4096
M v[60:63], a[92:95], a[172:175], v[60:63]
 ds_read_b64_tr_b16 a[108:109], v2 offset:40960
 ds_read_b64_tr_b16 a[110:111], v2 offset:41984
M v[56:59], a[84:87], a[172:175], v[56:59]
 buffer_load_dwordx4 v15, s[48:51], s22 offen offset:3072   lds
M v[56:59], a[80:83], a[168:171], v[56:59]
 s_sub_u32 s22, s22, 2097024
M v[52:55], a[72:75], a[168:171], v[52:55]
M v[52:55], a[76:79], a[172:175], v[52:55]
 ds_read_b64_tr_b16 a[112:113], v3 offset:32768
 ds_read_b64_tr_b16 a[114:115], v3 offset:33792
M v[48:51], a[68:71], a[172:175], v[48:51]
 s_add_u32 m0, s23, 16384
M v[48:51], a[64:67], a[168:171], v[48:51]
 buffer_load_dwordx4 v8, s[16:19], s21 offen offset:0  nt lds
M v[44:47], a[56:59], a[168:171], v[44:47]
M v[44:47], a[60:63], a[172:175], v[44:47]
M v[40:43], a[52:55], a[172:175], v[40:43]
 ds_read_b64_tr_b16 a[116:117], v3 offset:40960
 ds_read_b64_tr_b16 a[118:119], v3 offset:41984
M v[40:43], a[48:51], a[168:171], v[40:43]
M v[36:39], a[40:43], a[168:171], v[36:39]
 buffer_load_dwordx4 v9, s[16:19], s21 offen offset:1024  nt lds
M v[36:39], a[44:47], a[172:175], v[36:39]
 s_waitcnt lgkmcnt(6)
M v[32:35], a[36:39], a[172:175], v[32:35]
M v[32:35], a[32:35], a[168:171], v[32:35]
 ds_read_b64_tr_b16 a[120:121], v4 offset:32768
 ds_read_b64_tr_b16 a[122:123], v4 offset:33792
M v[64:67], a[32:35], a[160:163], v[64:67]
 ds_read_b128 a[168:171], v5 offset:6144
 ds_read_b128 a[172:175], v6 offset:6144
M v[64:67], a[36:39], a[164:167], v[64:67]
 buffer_load_dwordx4 v10, s[16:19], s21 offen offset:2048  nt lds
M v[68:71], a[44:47], a[164:167], v[68:71]
M v[68:71], a[40:43], a[160:163], v[68:71]
M v[72:75], a[48:51], a[160:163], v[72:75]
 ds_read_b64_tr_b16 a[124:125], v4 offset:40960
 ds_read_b64_tr_b16 a[126:127], v4 offset:41984
M v[72:75], a[52:55], a[164:167], v[72:75]
M v[76:79], a[60:63], a[164:167], v[76:79]
 buffer_load_dwordx4 v11, s[16:19], s21 offen offset:3072  nt lds
M v[76:79], a[56:59], a[160:163], v[76:79]
 s_add_u32 s21, s21, 524160
M v[80:83], a[64:67], a[160:163], v[80:83]
M v[80:83], a[68:71], a[164:167], v[80:83]
M v[84:87], a[76:79], a[164:167], v[84:87]
M v[84:87], a[72:75], a[160:163], v[84:87]
M v[88:91], a[80:83], a[160:163], v[88:91]
M v[88:91], a[84:87], a[164:167], v[88:91]
 s_waitcnt lgkmcnt(2)
M v[92:95], a[92:95], a[164:167], v[92:95]
 s_waitcnt vmcnt(17) lgkmcnt(0)
M v[92:95], a[88:91], a[160:163], v[92:95]
 s_barrier
M v[124:127], a[88:91], a[168:171], v[124:127]
 ds_read_b128 a[160:163], v5 offset:16384
 ds_read_b128 a[164:167], v6 offset:16384
M v[124:127], a[92:95], a[172:175], v[124:127]
M v[120:123], a[84:87], a[172:175], v[120:123]
 s_add_u32 m0, s24, 0
 ds_read_b64_tr_b16 a[128:129], v1 offset:49152
 ds_read_b64_tr_b16 a[130:131], v1 offset:50176
M v[120:123], a[80:83], a[168:171], v[120:123]
 buffer_load_dwordx4 v12, s[48:51], s22 offen offset:0   lds
M v[116:119], a[72:75], a[168:171], v[116:119]
M v[116:119], a[76:79], a[172:175], v[116:119]
M v[112:115], a[68:71], a[172:175], v[112:115]
M v[112:115], a[64:67], a[168:171], v[112:115]
M v[108:111], a[56:59], a[168:171], v[108:111]
M v[108:111], a[60:63], a[172:175], v[108:111]
 ds_read_b64_tr_b16 a[132:133], v1 offset:57344
 ds_read_b64_tr_b16 a[134:135], v1 offset:58368
M v[104:107], a[52:55], a[172:175], v[104:107]
 buffer_load_dwordx4 v13, s[48:51], s22 offen offset:1024   lds
M v[104:107], a[48:51], a[168:171], v[104:107]
M v[100:103], a[40:43], a[168:171], v[100:103]
M v[100:103], a[44:47], a[172:175], v[100:103]
 s_waitcnt lgkmcnt(4)
M v[96:99], a[36:39], a[172:175], v[96:99]
M v[96:99], a[32:35], a[168:171], v[96:99]
M v[128:131], a[32:35], a[160:163], v[128:131]
 ds_read_b128 a[168:171], v5 offset:18432
 ds_read_b128 a[172:175], v6 offset:18432
M v[128:131], a[36:39], a[164:167], v[128:131]
 ds_read_b64_tr_b16 a[136:137], v2 offset:49152
 ds_read_b64_tr_b16 a[138:139], v2 offset:50176
M v[132:135], a[44:47], a[164:167], v[132:135]
 buffer_load_dwordx4 v14, s[48:51], s22 offen offset:2048   lds
M v[132:135], a[40:43], a[160:163], v[132:135]
M v[136:139], a[48:51], a[160:163], v[136:139]
M v[136:139], a[52:55], a[164:167], v[136:139]
M v[140:143], a[60:63], a[164:167], v[140:143]
M v[140:143], a[56:59], a[160:163], v[140:143]
 ds_read_b64_tr_b16 a[140:141], v2 offset:57344
 ds_read_b64_tr_b16 a[142:143], v2 offset:58368
M v[144:147], a[64:67], a[160:163], v[144:147]
 buffer_load_dwordx4 v15, s[48:51], s22 offen offset:3072   lds
M v[144:147], a[68:71], a[164:167], v[144:147]
 s_add_u32 s22, s22, 2097152
M v[148:151], a[76:79], a[164:167], v[148:151]
M v[148:151], a[72:75], a[160:163], v[148:151]
M v[152:155], a[80:83], a[160:163], v[152:155]
M v[152:155], a[84:87], a[164:167], v[152:155]
 s_waitcnt lgkmcnt(4)
M v[156:159], a[92:95], a[164:167], v[156:159]
 s_add_u32 m0, s23, 32768
 ds_read_b64_tr_b16 a[144:145], v3 offset:49152
 ds_read_b64_tr_b16 a[146:147], v3 offset:50176
M v[156:159], a[88:91], a[160:163], v[156:159]
 buffer_load_dwordx4 v8, s[16:19], s21 offen offset:0  nt lds
M v[188:191], a[88:91], a[168:171], v[188:191]
 ds_read_b128 a[160:163], v5 offset:20480
 ds_read_b128 a[164:167], v6 offset:20480
M v[188:191], a[92:95], a[172:175], v[188:191]
M v[184:187], a[84:87], a[172:175], v[184:187]
M v[184:187], a[80:83], a[168:171], v[184:187]
M v[180:183], a[72:75], a[168:171], v[180:183]
M v[180:183], a[76:79], a[172:175], v[180:183]
 ds_read_b64_tr_b16 a[148:149], v3 offset:57344
 ds_read_b64_tr_b16 a[150:151], v3 offset:58368
M v[176:179], a[68:71], a[172:175], v[176:179]
 buffer_load_dwordx4 v9, s[16:19], s21 offen offset:1024  nt lds
M v[176:179], a[64:67], a[168:171], v[176:179]
M v[172:175], a[56:59], a[168:171], v[172:175]
M v[172:175], a[60:63], a[172:175], v[172:175]
M v[168:171], a[52:55], a[172:175], v[168:171]
M v[168:171], a[48:51], a[168:171], v[168:171]
M v[164:167], a[40:43], a[168:171], v[164:167]
 ds_read_b64_tr_b16 a[152:153], v4 offset:49152
 ds_read_b64_tr_b16 a[154:155], v4 offset:50176
M v[164:167], a[44:47], a[172:175], v[164:167]
 s_waitcnt lgkmcnt(4)
M v[160:163], a[36:39], a[172:175], v[160:163]
 buffer_load_dwordx4 v10, s[16:19], s21 offen offset:2048  nt lds
M v[160:163], a[32:35], a[168:171], v[160:163]
M v[192:195], a[32:35], a[160:163], v[192:195]
 ds_read_b128 a[168:171], v5 offset:22528
 ds_read_b128 a[172:175], v6 offset:22528
M v[192:195], a[36:39], a[164:167], v[192:195]
M v[196:199], a[44:47], a[164:167], v[196:199]
M v[196:199], a[40:43], a[160:163], v[196:199]
 ds_read_b64_tr_b16 a[156:157], v4 offset:57344
 ds_read_b64_tr_b16 a[158:159], v4 offset:58368
M v[200:203], a[48:51], a[160:163], v[200:203]
 buffer_load_dwordx4 v11, s[16:19], s21 offen offset:3072  nt lds
M v[200:203], a[52:55], a[164:167], v[200:203]
 s_add_u32 s21, s21, 128
M v[204:207], a[60:63], a[164:167], v[204:207]
M v[204:207], a[56:59], a[160:163], v[204:207]
M v[208:211], a[64:67], a[160:163], v[208:211]
M v[208:211], a[68:71], a[164:167], v[208:211]
M v[212:215], a[76:79], a[164:167], v[212:215]
M v[212:215], a[72:75], a[160:163], v[212:215]
M v[216:219], a[80:83], a[160:163], v[216:219]
M v[216:219], a[84:87], a[164:167], v[216:219]
 s_waitcnt lgkmcnt(2)
M v[220:223], a[92:95], a[164:167], v[220:223]
 s_waitcnt vmcnt(17) lgkmcnt(0)
M v[220:223], a[88:91], a[160:163], v[220:223]
 s_barrier
M v[252:255], a[88:91], a[168:171], v[252:255]
 ds_read_b128 a[160:163], v5 offset:32768
 ds_read_b128 a[164:167], v6 offset:32768
M v[252:255], a[92:95], a[172:175], v[252:255]
 buffer_load_dword a240, v23, s[52:55], 0 offen offset:0
M v[248:251], a[84:87], a[172:175], v[248:251]
 v_add_u32 v23, 32768, v23
M v[248:251], a[80:83], a[168:171], v[248:251]
M v[244:247], a[72:75], a[168:171], v[244:247]
M v[244:247], a[76:79], a[172:175], v[244:247]
M v[240:243], a[68:71], a[172:175], v[240:243]
M v[240:243], a[64:67], a[168:171], v[240:243]
M v[236:239], a[56:59], a[168:171], v[236:239]
M v[236:239], a[60:63], a[172:175], v[236:239]
M v[232:235], a[52:55], a[172:175], v[232:235]
M v[232:235], a[48:51], a[168:171], v[232:235]
M v[228:231], a[40:43], a[168:171], v[228:231]
M v[228:231], a[44:47], a[172:175], v[228:231]
 s_waitcnt lgkmcnt(0)
M v[224:227], a[36:39], a[172:175], v[224:227]
M v[224:227], a[32:35], a[168:171], v[224:227]
M a[0:3], a[96:99], a[160:163], a[0:3]
 ds_read_b128 a[168:171], v5 offset:34816
 ds_read_b128 a[172:175], v6 offset:34816
M a[0:3], a[100:103], a[164:167], a[0:3]
 ds_read_b64_tr_b16 a[32:33], v1 offset:0
 ds_read_b64_tr_b16 a[34:35], v1 offset:1024
M a[4:7], a[108:111], a[164:167], a[4:7]
 s_add_u32 m0, s24, 16384
M a[4:7], a[104:107], a[160:163], a[4:7]
 buffer_load_dwordx4 v12, s[48:51], s22 offen offset:0   lds
M a[8:11], a[112:115], a[160:163], a[8:11]
M a[8:11], a[116:119], a[164:167], a[8:11]
M a[12:15], a[124:127], a[164:167], a[12:15]
 ds_read_b64_tr_b16 a[36:37], v1 offset:8192
 ds_read_b64_tr_b16 a[38:39], v1 offset:9216
M a[12:15], a[120:123], a[160:163], a[12:15]
M a[16:19], a[128:131], a[160:163], a[16:19]
 buffer_load_dwordx4 v13, s[48:51], s22 offen offset:1024   lds
M a[16:19], a[132:135], a[164:167], a[16:19]
M a[20:23], a[140:143], a[164:167], a[20:23]
M a[20:23], a[136:139], a[160:163], a[20:23]
 ds_read_b64_tr_b16 a[40:41], v2 offset:0
 ds_read_b64_tr_b16 a[42:43], v2 offset:1024
M a[24:27], a[144:147], a[160:163], a[24:27]
M a[24:27], a[148:151], a[164:167], a[24:27]
 s_waitcnt lgkmcnt(6)
M a[28:31], a[156:159], a[164:167], a[28:31]
 buffer_load_dwordx4 v14, s[48:51], s22 offen offset:2048   lds
M a[28:31], a[152:155], a[160:163], a[28:31]
M v[60:63], a[152:155], a[168:171], v[60:63]
 ds_read_b128 a[160:163], v5 offset:36864
 ds_read_b128 a[164:167], v6 offset:36864
M v[60:63], a[156:159], a[172:175], v[60:63]
 ds_read_b64_tr_b16 a[44:45], v2 offset:8192
 ds_read_b64_tr_b16 a[46:47], v2 offset:9216
M v[56:59], a[148:151], a[172:175], v[56:59]
 buffer_load_dwordx4 v15, s[48:51], s22 offen offset:3072   lds
M v[56:59], a[144:147], a[168:171], v[56:59]
 s_sub_u32 s22, s22, 2097024
M v[52:55], a[136:139], a[168:171], v[52:55]
M v[52:55], a[140:143], a[172:175], v[52:55]
 ds_read_b64_tr_b16 a[48:49], v3 offset:0
 ds_read_b64_tr_b16 a[50:51], v3 offset:1024
M v[48:51], a[132:135], a[172:175], v[48:51]
 s_add_u32 m0, s23, 49152
M v[48:51], a[128:131], a[168:171], v[48:51]
 buffer_load_dwordx4 v8, s[16:19], s21 offen offset:0  nt lds
M v[44:47], a[120:123], a[168:171], v[44:47]
M v[44:47], a[124:127], a[172:175], v[44:47]
M v[40:43], a[116:119], a[172:175], v[40:43]
 ds_read_b64_tr_b16 a[52:53], v3 offset:8192
 ds_read_b64_tr_b16 a[54:55], v3 offset:9216
M v[40:43], a[112:115], a[168:171], v[40:43]
M v[36:39], a[104:107], a[168:171], v[36:39]
 buffer_load_dwordx4 v9, s[16:19], s21 offen offset:1024  nt lds
M v[36:39], a[108:111], a[172:175], v[36:39]
 s_waitcnt lgkmcnt(6)
M v[32:35], a[100:103], a[172:175], v[32:35]
M v[32:35], a[96:99], a[168:171], v[32:35]
 ds_read_b64_tr_b16 a[56:57], v4 offset:0
 ds_read_b64_tr_b16 a[58:59], v4 offset:1024
M v[64:67], a[96:99], a[160:163], v[64:67]
 ds_read_b128 a[168:171], v5 offset:38912
 ds_read_b128 a[172:175], v6 offset:38912
M v[64:67], a[100:103], a[164:167], v[64:67]
 buffer_load_dwordx4 v10, s[16:19], s21 offen offset:2048  nt lds
M v[68:71], a[108:111], a[164:167], v[68:71]
M v[68:71], a[104:107], a[160:163], v[68:71]
M v[72:75], a[112:115], a[160:163], v[72:75]
 ds_read_b64_tr_b16 a[60:61], v4 offset:8192
 ds_read_b64_tr_b16 a[62:63], v4 offset:9216
M v[72:75], a[116:119], a[164:167], v[72:75]
M v[76:79], a[124:127], a[164:167], v[76:79]
 buffer_load_dwordx4 v11, s[16:19], s21 offen offset:3072  nt lds
M v[76:79], a[120:123], a[160:163], v[76:79]
 s_add_u32 s21, s21, 524160
M v[80:83], a[128:131], a[160:163], v[80:83]
M v[80:83], a[132:135], a[164:167], v[80:83]
M v[84:87], a[140:143], a[164:167], v[84:87]
M v[84:87], a[136:139], a[160:163], v[84:87]
M v[88:91], a[144:147], a[160:163], v[88:91]
M v[88:91], a[148:151], a[164:167], v[88:91]
 s_waitcnt lgkmcnt(2)
M v[92:95], a[156:159], a[164:167], v[92:95]
 s_waitcnt vmcnt(17) lgkmcnt(0)
M v[92:95], a[152:155], a[160:163], v[92:95]
 s_barrier
M v[124:127], a[152:155], a[168:171], v[124:127]
 ds_read_b128 a[160:163], v5 offset:49152
 ds_read_b128 a[164:167], v6 offset:49152
M v[124:127], a[156:159], a[172:175], v[124:127]
M v[120:123], a[148:151], a[172:175], v[120:123]
 s_add_u32 m0, s24, 32768
 ds_read_b64_tr_b16 a[64:65], v1 offset:16384
 ds_read_b64_tr_b16 a[66:67], v1 offset:17408
M v[120:123], a[144:147], a[168:171], v[120:123]
 buffer_load_dwordx4 v12, s[48:51], s22 offen offset:0   lds
M v[116:119], a[136:139], a[168:171], v[116:119]
M v[116:119], a[140:143], a[172:175], v[116:119]
M v[112:115], a[132:135], a[172:175], v[112:115]
M v[112:115], a[128:131], a[168:171], v[112:115]
M v[108:111], a[120:123], a[168:171], v[108:111]
M v[108:111], a[124:127], a[172:175], v[108:111]
 ds_read_b64_tr_b16 a[68:69], v1 offset:24576
 ds_read_b64_tr_b16 a[70:71], v1 offset:25600
M v[104:107], a[116:119], a[172:175], v[104:107]
 buffer_load_dwordx4 v13, s[48:51], s22 offen offset:1024   lds
M v[104:107], a[112:115], a[168:171], v[104:107]
M v[100:103], a[104:107], a[168:171], v[100:103]
M v[100:103], a[108:111], a[172:175], v[100:103]
 s_waitcnt lgkmcnt(4)
M v[96:99], a[100:103], a[172:175], v[96:99]
M v[96:99], a[96:99], a[168:171], v[96:99]
M v[128:131], a[96:99], a[160:163], v[128:131]
 ds_read_b128 a[168:171], v5 offset:51200
 ds_read_b128 a[172:175], v6 offset:51200
M v[128:131], a[100:103], a[164:167], v[128:131]
 ds_read_b64_tr_b16 a[72:73], v2 offset:16384
 ds_read_b64_tr_b16 a[74:75], v2 offset:17408
M v[132:135], a[108:111], a[164:167], v[132:135]
 buffer_load_dwordx4 v14, s[48:51], s22 offen offset:2048   lds
M v[132:135], a[104:107], a[160:163], v[132:135]
M v[136:139], a[112:115], a[160:163], v[136:139]
M v[136:139], a[116:119], a[164:167], v[136:139]
M v[140:143], a[124:127], a[164:167], v[140:143]
M v[140:143], a[120:123], a[160:163], v[140:143]
 ds_read_b64_tr_b16 a[76:77], v2 offset:24576
 ds_read_b64_tr_b16 a[78:79], v2 offset:25600
M v[144:147], a[128:131], a[160:163], v[144:147]
 buffer_load_dwordx4 v15, s[48:51], s22 offen offset:3072   lds
M v[144:147], a[132:135], a[164:167], v[144:147]
 s_add_u32 s22, s22, 2097152
M v[148:151], a[140:143], a[164:167], v[148:151]
M v[148:151], a[136:139], a[160:163], v[148:151]
M v[152:155], a[144:147], a[160:163], v[152:155]
M v[152:155], a[148:151], a[164:167], v[152:155]
 s_waitcnt lgkmcnt(4)
M v[156:159], a[156:159], a[164:167], v[156:159]
 s_add_u32 m0, s23, 0
 ds_read_b64_tr_b16 a[80:81], v3 offset:16384
 ds_read_b64_tr_b16 a[82:83], v3 offset:17408
M v[156:159], a[152:155], a[160:163], v[156:159]
 buffer_load_dwordx4 v8, s[16:19], s21 offen offset:0  nt lds
M v[188:191], a[152:155], a[168:171], v[188:191]
 ds_read_b128 a[160:163], v5 offset:53248
 ds_read_b128 a[164:167], v6 offset:53248
M v[188:191], a[156:159], a[172:175], v[188:191]
M v[184:187], a[148:151], a[172:175], v[184:187]
M v[184:187], a[144:147], a[168:171], v[184:187]
M v[180:183], a[136:139], a[168:171], v[180:183]
M v[180:183], a[140:143], a[172:175], v[180:183]
 ds_read_b64_tr_b16 a[84:85], v3 offset:24576
 ds_read_b64_tr_b16 a[86:87], v3 offset:25600
M v[176:179], a[132:135], a[172:175], v[176:179]
 buffer_load_dwordx4 v9, s[16:19], s21 offen offset:1024  nt lds
M v[176:179], a[128:131], a[168:171], v[176:179]
M v[172:175], a[120:123], a[168:171], v[172:175]
M v[172:175], a[124:127], a[172:175], v[172:175]
M v[168:171], a[116:119], a[172:175], v[168:171]
M v[168:171], a[112:115], a[168:171], v[168:171]
M v[164:167], a[104:107], a[168:171], v[164:167]
 ds_read_b64_tr_b16 a[88:89], v4 offset:16384
 ds_read_b64_tr_b16 a[90:91], v4 offset:17408
M v[164:167], a[108:111], a[172:175], v[164:167]
 s_waitcnt lgkmcnt(4)
M v[160:163], a[100:103], a[172:175], v[160:163]
 buffer_load_dwordx4 v10, s[16:19], s21 offen offset:2048  nt lds
M v[160:163], a[96:99], a[168:171], v[160:163]
M v[192:195], a[96:99], a[160:163], v[192:195]
 ds_read_b128 a[168:171], v5 offset:55296
 ds_read_b128 a[172:175], v6 offset:55296
M v[192:195], a[100:103], a[164:167], v[192:195]
M v[196:199], a[108:111], a[164:167], v[196:199]
M v[196:199], a[104:107], a[160:163], v[196:199]
 ds_read_b64_tr_b16 a[92:93], v4 offset:24576
 ds_read_b64_tr_b16 a[94:95], v4 offset:25600
M v[200:203], a[112:115], a[160:163], v[200:203]
 buffer_load_dwordx4 v11, s[16:19], s21 offen offset:3072  nt lds
M v[200:203], a[116:119], a[164:167], v[200:203]
 s_add_u32 s21, s21, 128
M v[204:207], a[124:127], a[164:167], v[204:207]
M v[204:207], a[120:123], a[160:163], v[204:207]
M v[208:211], a[128:131], a[160:163], v[208:211]
M v[208:211], a[132:135], a[164:167], v[208:211]
M v[212:215], a[140:143], a[164:167], v[212:215]
M v[212:215], a[136:139], a[160:163], v[212:215]
M v[216:219], a[144:147], a[160:163], v[216:219]
M v[216:219], a[148:151], a[164:167], v[216:219]
 s_waitcnt lgkmcnt(2)
M v[220:223], a[156:159], a[164:167], v[220:223]
 s_waitcnt vmcnt(17) lgkmcnt(0)
M v[220:223], a[152:155], a[160:163], v[220:223]
 s_barrier
M v[252:255], a[152:155], a[168:171], v[252:255]
 ds_read_b128 a[160:163], v5 offset:0
 ds_read_b128 a[164:167], v6 offset:0
M v[252:255], a[156:159], a[172:175], v[252:255]
 buffer_load_dword a240, v23, s[52:55], 0 offen offset:0
M v[248:251], a[148:151], a[172:175], v[248:251]
 v_add_u32 v23, 16384, v23
M v[248:251], a[144:147], a[168:171], v[248:251]
M v[244:247], a[136:139], a[168:171], v[244:247]
M v[244:247], a[140:143], a[172:175], v[244:247]
M v[240:243], a[132:135], a[172:175], v[240:243]
M v[240:243], a[128:131], a[168:171], v[240:243]
M v[236:239], a[120:123], a[168:171], v[236:239]
M v[236:239], a[124:127], a[172:175], v[236:239]
M v[232:235], a[116:119], a[172:175], v[232:235]
M v[232:235], a[112:115], a[168:171], v[232:235]
M v[228:231], a[104:107], a[168:171], v[228:231]
M v[228:231], a[108:111], a[172:175], v[228:231]
 s_waitcnt lgkmcnt(0)
M v[224:227], a[100:103], a[172:175], v[224:227]
M v[224:227], a[96:99], a[168:171], v[224:227]
M a[0:3], a[32:35], a[160:163], a[0:3]
 ds_read_b128 a[168:171], v5 offset:2048
 ds_read_b128 a[172:175], v6 offset:2048
M a[0:3], a[36:39], a[164:167], a[0:3]
 ds_read_b64_tr_b16 a[96:97], v1 offset:32768
 ds_read_b64_tr_b16 a[98:99], v1 offset:33792
M a[4:7], a[44:47], a[164:167], a[4:7]
 s_add_u32 m0, s24, 49152
 v_accvgpr_read_b32 v27, a241
M a[4:7], a[40:43], a[160:163], a[4:7]
 buffer_load_dwordx4 v12, s[48:51], s22 offen offset:0   lds
M a[8:11], a[48:51], a[160:163], a[8:11]
M a[8:11], a[52:55], a[164:167], a[8:11]
M a[12:15], a[60:63], a[164:167], a[12:15]
 ds_read_b64_tr_b16 a[100:101], v1 offset:40960
 ds_read_b64_tr_b16 a[102:103], v1 offset:41984
M a[12:15], a[56:59], a[160:163], a[12:15]
M a[16:19], a[64:67], a[160:163], a[16:19]
 buffer_load_dwordx4 v13, s[48:51], s22 offen offset:1024   lds
M a[16:19], a[68:71], a[164:167], a[16:19]
M a[20:23], a[76:79], a[164:167], a[20:23]
M a[20:23], a[72:75], a[160:163], a[20:23]
 ds_read_b64_tr_b16 a[104:105], v2 offset:32768
 ds_read_b64_tr_b16 a[106:107], v2 offset:33792
M a[24:27], a[80:83], a[160:163], a[24:27]
M a[24:27], a[84:87], a[164:167], a[24:27]
 s_waitcnt lgkmcnt(6)
M a[28:31], a[92:95], a[164:167], a[28:31]
 buffer_load_dwordx4 v14, s[48:51], s22 offen offset:2048   lds
M a[28:31], a[88:91], a[160:163], a[28:31]
M v[60:63], a[88:91], a[168:171], v[60:63]
 ds_read_b128 a[160:163], v5 offset:4096
 ds_read_b128 a[164:167], v6 offset:4096
M v[60:63], a[92:95], a[172:175], v[60:63]
 ds_read_b64_tr_b16 a[108:109], v2 offset:40960
 ds_read_b64_tr_b16 a[110:111], v2 offset:41984
M v[56:59], a[84:87], a[172:175], v[56:59]
 buffer_load_dwordx4 v15, s[48:51], s22 offen offset:3072   lds
M v[56:59], a[80:83], a[168:171], v[56:59]
 s_sub_u32 s22, s22, 2097024
M v[52:55], a[72:75], a[168:171], v[52:55]
M v[52:55], a[76:79], a[172:175], v[52:55]
 ds_read_b64_tr_b16 a[112:113], v3 offset:32768
 ds_read_b64_tr_b16 a[114:115], v3 offset:33792
M v[48:51], a[68:71], a[172:175], v[48:51]
 s_add_u32 m0, s23, 16384
M v[48:51], a[64:67], a[168:171], v[48:51]
 buffer_load_dwordx4 v8, s[16:19], s21 offen offset:0  nt lds
M v[44:47], a[56:59], a[168:171], v[44:47]
M v[44:47], a[60:63], a[172:175], v[44:47]
M v[40:43], a[52:55], a[172:175], v[40:43]
 ds_read_b64_tr_b16 a[116:117], v3 offset:40960
 ds_read_b64_tr_b16 a[118:119], v3 offset:41984
M v[40:43], a[48:51], a[168:171], v[40:43]
M v[36:39], a[40:43], a[168:171], v[36:39]
 buffer_load_dwordx4 v9, s[16:19], s21 offen offset:1024  nt lds
M v[36:39], a[44:47], a[172:175], v[36:39]
 s_waitcnt lgkmcnt(6)
M v[32:35], a[36:39], a[172:175], v[32:35]
M v[32:35], a[32:35], a[168:171], v[32:35]
 ds_read_b64_tr_b16 a[120:121], v4 offset:32768
 ds_read_b64_tr_b16 a[122:123], v4 offset:33792
M v[64:67], a[32:35], a[160:163], v[64:67]
 ds_read_b128 a[168:171], v5 offset:6144
 ds_read_b128 a[172:175], v6 offset:6144
M v[64:67], a[36:39], a[164:167], v[64:67]
 buffer_load_dwordx4 v10, s[16:19], s21 offen offset:2048  nt lds
M v[68:71], a[44:47], a[164:167], v[68:71]
M v[68:71], a[40:43], a[160:163], v[68:71]
M v[72:75], a[48:51], a[160:163], v[72:75]
 ds_read_b64_tr_b16 a[124:125], v4 offset:40960
 ds_read_b64_tr_b16 a[126:127], v4 offset:41984
M v[72:75], a[52:55], a[164:167], v[72:75]
 v_sub_f32 v48, v48, v27
 v_sub_f32 v49, v49, v27
M v[76:79], a[60:63], a[164:167], v[76:79]
 buffer_load_dwordx4 v11, s[16:19], s21 offen offset:3072  nt lds
M v[76:79], a[56:59], a[160:163], v[76:79]
 s_add_u32 s21, s21, 524160
 v_sub_f32 v50, v50, v27
 v_sub_f32 v51, v51, v27
M v[80:83], a[64:67], a[160:163], v[80:83]
 v_sub_f32 v52, v52, v27
 v_sub_f32 v53, v53, v27
M v[80:83], a[68:71], a[164:167], v[80:83]
 v_sub_f32 v54, v54, v27
 v_sub_f32 v55, v55, v27
M v[84:87], a[76:79], a[164:167], v[84:87]
 v_sub_f32 v56, v56, v27
 v_sub_f32 v57, v57, v27
M v[84:87], a[72:75], a[160:163], v[84:87]
 v_sub_f32 v58, v58, v27
 v_sub_f32 v59, v59, v27
M v[88:91], a[80:83], a[160:163], v[88:91]
 v_sub_f32 v60, v60, v27
 v_sub_f32 v61, v61, v27
M v[88:91], a[84:87], a[164:167], v[88:91]
 s_waitcnt lgkmcnt(2)
 v_sub_f32 v62, v62, v27
 v_sub_f32 v63, v63, v27
M v[92:95], a[92:95], a[164:167], v[92:95]
 s_waitcnt vmcnt(17) lgkmcnt(0)
M v[92:95], a[88:91], a[160:163], v[92:95]
 s_barrier
M v[124:127], a[88:91], a[168:171], v[124:127]
 ds_read_b128 a[160:163], v5 offset:16384
 ds_read_b128 a[164:167], v6 offset:16384
M v[124:127], a[92:95], a[172:175], v[124:127]
M v[120:123], a[84:87], a[172:175], v[120:123]
 s_add_u32 m0, s24, 0
 ds_read_b64_tr_b16 a[128:129], v1 offset:49152
 ds_read_b64_tr_b16 a[130:131], v1 offset:50176
M v[120:123], a[80:83], a[168:171], v[120:123]
 buffer_load_dwordx4 v12, s[48:51], s22 offen offset:0   lds
M v[116:119], a[72:75], a[168:171], v[116:119]
 v_sub_f32 v80, v80, v27
 v_sub_f32 v81, v81, v27
M v[116:119], a[76:79], a[172:175], v[116:119]
 v_sub_f32 v82, v82, v27
 v_sub_f32 v83, v83, v27
M v[112:115], a[68:71], a[172:175], v[112:115]
 v_sub_f32 v84, v84, v27
 v_sub_f32 v85, v85, v27
M v[112:115], a[64:67], a[168:171], v[112:115]
 v_sub_f32 v86, v86, v27
 v_sub_f32 v87, v87, v27
M v[108:111], a[56:59], a[168:171], v[108:111]
 v_sub_f32 v88, v88, v27
 v_sub_f32 v89, v89, v27
M v[108:111], a[60:63], a[172:175], v[108:111]
 ds_read_b64_tr_b16 a[132:133], v1 offset:57344
 ds_read_b64_tr_b16 a[134:135], v1 offset:58368
M v[104:107], a[52:55], a[172:175], v[104:107]
 buffer_load_dwordx4 v13, s[48:51], s22 offen offset:1024   lds
M v[104:107], a[48:51], a[168:171], v[104:107]
 v_sub_f32 v90, v90, v27
 v_sub_f32 v91, v91, v27
M v[100:103], a[40:43], a[168:171], v[100:103]
 v_sub_f32 v92, v92, v27
 v_sub_f32 v93, v93, v27
M v[100:103], a[44:47], a[172:175], v[100:103]
 s_waitcnt lgkmcnt(4)
 v_sub_f32 v94, v94, v27
 v_sub_f32 v95, v95, v27
M v[96:99], a[36:39], a[172:175], v[96:99]
M v[96:99], a[32:35], a[168:171], v[96:99]
M v[128:131], a[32:35], a[160:163], v[128:131]
 ds_read_b128 a[168:171], v5 offset:18432
 ds_read_b128 a[172:175], v6 offset:18432
M v[128:131], a[36:39], a[164:167], v[128:131]
 ds_read_b64_tr_b16 a[136:137], v2 offset:49152
 ds_read_b64_tr_b16 a[138:139], v2 offset:50176
M v[132:135], a[44:47], a[164:167], v[132:135]
 buffer_load_dwordx4 v14, s[48:51], s22 offen offset:2048   lds
M v[132:135], a[40:43], a[160:163], v[132:135]
M v[136:139], a[48:51], a[160:163], v[136:139]
 v_sub_f32 v112, v112, v27
 v_sub_f32 v113, v113, v27
M v[136:139], a[52:55], a[164:167], v[136:139]
 v_sub_f32 v114, v114, v27
 v_sub_f32 v115, v115, v27
M v[140:143], a[60:63], a[164:167], v[140:143]
 v_sub_f32 v116, v116, v27
 v_sub_f32 v117, v117, v27
M v[140:143], a[56:59], a[160:163], v[140:143]
 ds_read_b64_tr_b16 a[140:141], v2 offset:57344
 ds_read_b64_tr_b16 a[142:143], v2 offset:58368
M v[144:147], a[64:67], a[160:163], v[144:147]
 buffer_load_dwordx4 v15, s[48:51], s22 offen offset:3072   lds
M v[144:147], a[68:71], a[164:167], v[144:147]
 s_add_u32 s22, s22, 2097152
 v_sub_f32 v118, v118, v27
 v_sub_f32 v119, v119, v27
M v[148:151], a[76:79], a[164:167], v[148:151]
 v_sub_f32 v120, v120, v27
 v_sub_f32 v121, v121, v27
M v[148:151], a[72:75], a[160:163], v[148:151]
 v_sub_f32 v122, v122, v27
 v_sub_f32 v123, v123, v27
M v[152:155], a[80:83], a[160:163], v[152:155]
 v_sub_f32 v124, v124, v27
 v_sub_f32 v125, v125, v27
M v[152:155], a[84:87], a[164:167], v[152:155]
 s_waitcnt lgkmcnt(4)
 v_sub_f32 v126, v126, v27
 v_sub_f32 v127, v127, v27
M v[156:159], a[92:95], a[164:167], v[156:159]
 s_add_u32 m0, s23, 32768
 ds_read_b64_tr_b16 a[144:145], v3 offset:49152
 ds_read_b64_tr_b16 a[146:147], v3 offset:50176
M v[156:159], a[88:91], a[160:163], v[156:159]
 buffer_load_dwordx4 v8, s[16:19], s21 offen offset:0  nt lds
M v[188:191], a[88:91], a[168:171], v[188:191]
 ds_read_b128 a[160:163], v5 offset:20480
 ds_read_b128 a[164:167], v6 offset:20480
M v[188:191], a[92:95], a[172:175], v[188:191]
M v[184:187], a[84:87], a[172:175], v[184:187]
M v[184:187], a[80:83], a[168:171], v[184:187]
M v[180:183], a[72:75], a[168:171], v[180:183]
 v_sub_f32 v128, v128, v27
 v_sub_f32 v129, v129, v27
M v[180:183], a[76:79], a[172:175], v[180:183]
 ds_read_b64_tr_b16 a[148:149], v3 offset:57344
 ds_read_b64_tr_b16 a[150:151], v3 offset:58368
M v[176:179], a[68:71], a[172:175], v[176:179]
 buffer_load_dwordx4 v9, s[16:19], s21 offen offset:1024  nt lds
M v[176:179], a[64:67], a[168:171], v[176:179]
 v_sub_f32 v130, v130, v27
 v_sub_f32 v131, v131, v27
M v[172:175], a[56:59], a[168:171], v[172:175]
 v_sub_f32 v132, v132, v27
 v_sub_f32 v133, v133, v27
M v[172:175], a[60:63], a[172:175], v[172:175]
 v_sub_f32 v134, v134, v27
 v_sub_f32 v135, v135, v27
M v[168:171], a[52:55], a[172:175], v[168:171]
 v_sub_f32 v136, v136, v27
 v_sub_f32 v137, v137, v27
M v[168:171], a[48:51], a[168:171], v[168:171]
 v_sub_f32 v138, v138, v27
 v_sub_f32 v139, v139, v27
M v[164:167], a[40:43], a[168:171], v[164:167]
 ds_read_b64_tr_b16 a[152:153], v4 offset:49152
 ds_read_b64_tr_b16 a[154:155], v4 offset:50176
M v[164:167], a[44:47], a[172:175], v[164:167]
 s_waitcnt lgkmcnt(4)
 v_sub_f32 v140, v140, v27
 v_sub_f32 v141, v141, v27
M v[160:163], a[36:39], a[172:175], v[160:163]
 buffer_load_dwordx4 v10, s[16:19], s21 offen offset:2048  nt lds
M v[160:163], a[32:35], a[168:171], v[160:163]
 v_sub_f32 v142, v142, v27
 v_sub_f32 v143, v143, v27
M v[192:195], a[32:35], a[160:163], v[192:195]
 ds_read_b128 a[168:171], v5 offset:22528
 ds_read_b128 a[172:175], v6 offset:22528
M v[192:195], a[36:39], a[164:167], v[192:195]
 v_sub_f32 v144, v144, v27
 v_sub_f32 v145, v145, v27
M v[196:199], a[44:47], a[164:167], v[196:199]
 v_sub_f32 v146, v146, v27
 v_sub_f32 v147, v147, v27
M v[196:199], a[40:43], a[160:163], v[196:199]
 ds_read_b64_tr_b16 a[156:157], v4 offset:57344
 ds_read_b64_tr_b16 a[158:159], v4 offset:58368
M v[200:203], a[48:51], a[160:163], v[200:203]
 buffer_load_dwordx4 v11, s[16:19], s21 offen offset:3072  nt lds
M v[200:203], a[52:55], a[164:167], v[200:203]
 s_add_u32 s21, s21, 128
 v_sub_f32 v148, v148, v27
 v_sub_f32 v149, v149, v27
M v[204:207], a[60:63], a[164:167], v[204:207]
 v_sub_f32 v150, v150, v27
 v_sub_f32 v151, v151, v27
M v[204:207], a[56:59], a[160:163], v[204:207]
 v_sub_f32 v152, v152, v27
 v_sub_f32 v153, v153, v27
M v[208:211], a[64:67], a[160:163], v[208:211]
 v_sub_f32 v154, v154, v27
 v_sub_f32 v155, v155, v27
M v[208:211], a[68:71], a[164:167], v[208:211]
 v_sub_f32 v156, v156, v27
 v_sub_f32 v157, v157, v27
M v[212:215], a[76:79], a[164:167], v[212:215]
 v_sub_f32 v158, v158, v27
 v_sub_f32 v159, v159, v27
M v[212:215], a[72:75], a[160:163], v[212:215]
M v[216:219], a[80:83], a[160:163], v[216:219]
M v[216:219], a[84:87], a[164:167], v[216:219]
 s_waitcnt lgkmcnt(2)
M v[220:223], a[92:95], a[164:167], v[220:223]
 s_waitcnt vmcnt(17) lgkmcnt(0)
M v[220:223], a[88:91], a[160:163], v[220:223]
 s_barrier
M v[252:255], a[88:91], a[168:171], v[252:255]
 ds_read_b128 a[160:163], v5 offset:32768
 ds_read_b128 a[164:167], v6 offset:32768
M v[252:255], a[92:95], a[172:175], v[252:255]
 buffer_load_dword a240, v23, s[52:55], 0 offen offset:0
M v[248:251], a[84:87], a[172:175], v[248:251]
 v_add_u32 v23, 16384, v23
M v[248:251], a[80:83], a[168:171], v[248:251]
M v[244:247], a[72:75], a[168:171], v[244:247]
M v[244:247], a[76:79], a[172:175], v[244:247]
M v[240:243], a[68:71], a[172:175], v[240:243]
M v[240:243], a[64:67], a[168:171], v[240:243]
M v[236:239], a[56:59], a[168:171], v[236:239]
M v[236:239], a[60:63], a[172:175], v[236:239]
M v[232:235], a[52:55], a[172:175], v[232:235]
M v[232:235], a[48:51], a[168:171], v[232:235]
M v[228:231], a[40:43], a[168:171], v[228:231]
M v[228:231], a[44:47], a[172:175], v[228:231]
 s_waitcnt lgkmcnt(0)
M v[224:227], a[36:39], a[172:175], v[224:227]
M v[224:227], a[32:35], a[168:171], v[224:227]
M a[0:3], a[96:99], a[160:163], a[0:3]
 ds_read_b128 a[168:171], v5 offset:34816
 ds_read_b128 a[172:175], v6 offset:34816
M a[0:3], a[100:103], a[164:167], a[0:3]
 ds_read_b64_tr_b16 a[32:33], v1 offset:0
 ds_read_b64_tr_b16 a[34:35], v1 offset:1024
M a[4:7], a[108:111], a[164:167], a[4:7]
 s_add_u32 m0, s24, 16384
M a[4:7], a[104:107], a[160:163], a[4:7]
 buffer_load_dwordx4 v12, s[48:51], s22 offen offset:0   lds
M a[8:11], a[112:115], a[160:163], a[8:11]
M a[8:11], a[116:119], a[164:167], a[8:11]
M a[12:15], a[124:127], a[164:167], a[12:15]
 ds_read_b64_tr_b16 a[36:37], v1 offset:8192
 ds_read_b64_tr_b16 a[38:39], v1 offset:9216
M a[12:15], a[120:123], a[160:163], a[12:15]
M a[16:19], a[128:131], a[160:163], a[16:19]
 buffer_load_dwordx4 v13, s[48:51], s22 offen offset:1024   lds
M a[16:19], a[132:135], a[164:167], a[16:19]
M a[20:23], a[140:143], a[164:167], a[20:23]
M a[20:23], a[136:139], a[160:163], a[20:23]
 ds_read_b64_tr_b16 a[40:41], v2 offset:0
 ds_read_b64_tr_b16 a[42:43], v2 offset:1024
M a[24:27], a[144:147], a[160:163], a[24:27]
M a[24:27], a[148:151], a[164:167], a[24:27]
 s_waitcnt lgkmcnt(6)
M a[28:31], a[156:159], a[164:167], a[28:31]
 buffer_load_dwordx4 v14, s[48:51], s22 offen offset:2048   lds
M a[28:31], a[152:155], a[160:163], a[28:31]
M v[60:63], a[152:155], a[168:171], v[60:63]
 ds_read_b128 a[160:163], v5 offset:36864
 ds_read_b128 a[164:167], v6 offset:36864
M v[60:63], a[156:159], a[172:175], v[60:63]
 ds_read_b64_tr_b16 a[44:45], v2 offset:8192
 ds_read_b64_tr_b16 a[46:47], v2 offset:9216
M v[56:59], a[148:151], a[172:175], v[56:59]
 buffer_load_dwordx4 v15, s[48:51], s22 offen offset:3072   lds
M v[56:59], a[144:147], a[168:171], v[56:59]
 s_sub_u32 s22, s22, 2097024
M v[52:55], a[136:139], a[168:171], v[52:55]
M v[52:55], a[140:143], a[172:175], v[52:55]
 ds_read_b64_tr_b16 a[48:49], v3 offset:0
 ds_read_b64_tr_b16 a[50:51], v3 offset:1024
M v[48:51], a[132:135], a[172:175], v[48:51]
 s_add_u32 m0, s23, 49152
M v[48:51], a[128:131], a[168:171], v[48:51]
 buffer_load_dwordx4 v8, s[16:19], s21 offen offset:0  nt lds
M v[44:47], a[120:123], a[168:171], v[44:47]
M v[44:47], a[124:127], a[172:175], v[44:47]
M v[40:43], a[116:119], a[172:175], v[40:43]
 ds_read_b64_tr_b16 a[52:53], v3 offset:8192
 ds_read_b64_tr_b16 a[54:55], v3 offset:9216
M v[40:43], a[112:115], a[168:171], v[40:43]
M v[36:39], a[104:107], a[168:171], v[36:39]
 buffer_load_dwordx4 v9, s[16:19], s21 offen offset:1024  nt lds
M v[36:39], a[108:111], a[172:175], v[36:39]
 s_waitcnt lgkmcnt(6)
M v[32:35], a[100:103], a[172:175], v[32:35]
M v[32:35], a[96:99], a[168:171], v[32:35]
 ds_read_b64_tr_b16 a[56:57], v4 offset:0
 ds_read_b64_tr_b16 a[58:59], v4 offset:1024
M v[64:67], a[96:99], a[160:163], v[64:67]
 ds_read_b128 a[168:171], v5 offset:38912
 ds_read_b128 a[172:175], v6 offset:38912
M v[64:67], a[100:103], a[164:167], v[64:67]
 buffer_load_dwordx4 v10, s[16:19], s21 offen offset:2048  nt lds
M v[68:71], a[108:111], a[164:167], v[68:71]
M v[68:71], a[104:107], a[160:163], v[68:71]
M v[72:75], a[112:115], a[160:163], v[72:75]
 ds_read_b64_tr_b16 a[60:61], v4 offset:8192
 ds_read_b64_tr_b16 a[62:63], v4 offset:9216
M v[72:75], a[116:119], a[164:167], v[72:75]
M v[76:79], a[124:127], a[164:167], v[76:79]
 buffer_load_dwordx4 v11, s[16:19], s21 offen offset:3072  nt lds
M v[76:79], a[120:123], a[160:163], v[76:79]
 s_add_u32 s21, s21, 524160
M v[80:83], a[128:131], a[160:163], v[80:83]
M v[80:83], a[132:135], a[164:167], v[80:83]
M v[84:87], a[140:143], a[164:167], v[84:87]
M v[84:87], a[136:139], a[160:163], v[84:87]
M v[88:91], a[144:147], a[160:163], v[88:91]
M v[88:91], a[148:151], a[164:167], v[88:91]
 s_waitcnt lgkmcnt(2)
M v[92:95], a[156:159], a[164:167], v[92:95]
 s_waitcnt vmcnt(17) lgkmcnt(0)
M v[92:95], a[152:155], a[160:163], v[92:95]
 s_barrier
M v[124:127], a[152:155], a[168:171], v[124:127]
 ds_read_b128 a[160:163], v5 offset:49152
 ds_read_b128 a[164:167], v6 offset:49152
M v[124:127], a[156:159], a[172:175], v[124:127]
M v[120:123], a[148:151], a[172:175], v[120:123]
 s_add_u32 m0, s24, 32768
 ds_read_b64_tr_b16 a[64:65], v1 offset:16384
 ds_read_b64_tr_b16 a[66:67], v1 offset:17408
M v[120:123], a[144:147], a[168:171], v[120:123]
 buffer_load_dwordx4 v12, s[48:51], s22 offen offset:0   lds
M v[116:119], a[136:139], a[168:171], v[116:119]
M v[116:119], a[140:143], a[172:175], v[116:119]
M v[112:115], a[132:135], a[172:175], v[112:115]
M v[112:115], a[128:131], a[168:171], v[112:115]
M v[108:111], a[120:123], a[168:171], v[108:111]
M v[108:111], a[124:127], a[172:175], v[108:111]
 ds_read_b64_tr_b16 a[68:69], v1 offset:24576
 ds_read_b64_tr_b16 a[70:71], v1 offset:25600
M v[104:107], a[116:119], a[172:175], v[104:107]
 buffer_load_dwordx4 v13, s[48:51], s22 offen offset:1024   lds
M v[104:107], a[112:115], a[168:171], v[104:107]
M v[100:103], a[104:107], a[168:171], v[100:103]
M v[100:103], a[108:111], a[172:175], v[100:103]
 s_waitcnt lgkmcnt(4)
M v[96:99], a[100:103], a[172:175], v[96:99]
M v[96:99], a[96:99], a[168:171], v[96:99]
M v[128:131], a[96:99], a[160:163], v[128:131]
 ds_read_b128 a[168:171], v5 offset:51200
 ds_read_b128 a[172:175], v6 offset:51200
M v[128:131], a[100:103], a[164:167], v[128:131]
 ds_read_b64_tr_b16 a[72:73], v2 offset:16384
 ds_read_b64_tr_b16 a[74:75], v2 offset:17408
M v[132:135], a[108:111], a[164:167], v[132:135]
 buffer_load_dwordx4 v14, s[48:51], s22 offen offset:2048   lds
M v[132:135], a[104:107], a[160:163], v[132:135]
M v[136:139], a[112:115], a[160:163], v[136:139]
M v[136:139], a[116:119], a[164:167], v[136:139]
M v[140:143], a[124:127], a[164:167], v[140:143]
M v[140:143], a[120:123], a[160:163], v[140:143]
 ds_read_b64_tr_b16 a[76:77], v2 offset:24576
 ds_read_b64_tr_b16 a[78:79], v2 offset:25600
M v[144:147], a[128:131], a[160:163], v[144:147]
 buffer_load_dwordx4 v15, s[48:51], s22 offen offset:3072   lds
M v[144:147], a[132:135], a[164:167], v[144:147]
 s_add_u32 s22, s22, 2097152
M v[148:151], a[140:143], a[164:167], v[148:151]
M v[148:151], a[136:139], a[160:163], v[148:151]
M v[152:155], a[144:147], a[160:163], v[152:155]
M v[152:155], a[148:151], a[164:167], v[152:155]
 s_waitcnt lgkmcnt(4)
M v[156:159], a[156:159], a[164:167], v[156:159]
 s_add_u32 m0, s23, 0
 ds_read_b64_tr_b16 a[80:81], v3 offset:16384
 ds_read_b64_tr_b16 a[82:83], v3 offset:17408
M v[156:159], a[152:155], a[160:163], v[156:159]
 buffer_load_dwordx4 v8, s[52:55], s28 offen offset:0   lds
M v[188:191], a[152:155], a[168:171], v[188:191]
 ds_read_b128 a[160:163], v5 offset:53248
 ds_read_b128 a[164:167], v6 offset:53248
M v[188:191], a[156:159], a[172:175], v[188:191]
M v[184:187], a[148:151], a[172:175], v[184:187]
M v[184:187], a[144:147], a[168:171], v[184:187]
M v[180:183], a[136:139], a[168:171], v[180:183]
M v[180:183], a[140:143], a[172:175], v[180:183]
 ds_read_b64_tr_b16 a[84:85], v3 offset:24576
 ds_read_b64_tr_b16 a[86:87], v3 offset:25600
M v[176:179], a[132:135], a[172:175], v[176:179]
 buffer_load_dwordx4 v9, s[52:55], s28 offen offset:1024   lds
M v[176:179], a[128:131], a[168:171], v[176:179]
M v[172:175], a[120:123], a[168:171], v[172:175]
M v[172:175], a[124:127], a[172:175], v[172:175]
M v[168:171], a[116:119], a[172:175], v[168:171]
M v[168:171], a[112:115], a[168:171], v[168:171]
M v[164:167], a[104:107], a[168:171], v[164:167]
 ds_read_b64_tr_b16 a[88:89], v4 offset:16384
 ds_read_b64_tr_b16 a[90:91], v4 offset:17408
M v[164:167], a[108:111], a[172:175], v[164:167]
 s_waitcnt lgkmcnt(4)
M v[160:163], a[100:103], a[172:175], v[160:163]
 buffer_load_dwordx4 v10, s[52:55], s28 offen offset:2048   lds
M v[160:163], a[96:99], a[168:171], v[160:163]
M v[192:195], a[96:99], a[160:163], v[192:195]
 ds_read_b128 a[168:171], v5 offset:55296
 ds_read_b128 a[172:175], v6 offset:55296
M v[192:195], a[100:103], a[164:167], v[192:195]
M v[196:199], a[108:111], a[164:167], v[196:199]
M v[196:199], a[104:107], a[160:163], v[196:199]
 ds_read_b64_tr_b16 a[92:93], v4 offset:24576
 ds_read_b64_tr_b16 a[94:95], v4 offset:25600
M v[200:203], a[112:115], a[160:163], v[200:203]
 buffer_load_dwordx4 v11, s[52:55], s28 offen offset:3072   lds
M v[200:203], a[116:119], a[164:167], v[200:203]
 s_add_u32 s28, s28, 128
 v_sub_f32 v160, v160, v27
 v_sub_f32 v161, v161, v27
M v[204:207], a[124:127], a[164:167], v[204:207]
 v_sub_f32 v162, v162, v27
 v_sub_f32 v163, v163, v27
M v[204:207], a[120:123], a[160:163], v[204:207]
 v_sub_f32 v164, v164, v27
 v_sub_f32 v165, v165, v27
M v[208:211], a[128:131], a[160:163], v[208:211]
 v_sub_f32 v166, v166, v27
 v_sub_f32 v167, v167, v27
M v[208:211], a[132:135], a[164:167], v[208:211]
 v_sub_f32 v168, v168, v27
 v_sub_f32 v169, v169, v27
M v[212:215], a[140:143], a[164:167], v[212:215]
 v_sub_f32 v170, v170, v27
 v_sub_f32 v171, v171, v27
M v[212:215], a[136:139], a[160:163], v[212:215]
 v_sub_f32 v172, v172, v27
 v_sub_f32 v173, v173, v27
M v[216:219], a[144:147], a[160:163], v[216:219]
 v_sub_f32 v174, v174, v27
 v_sub_f32 v175, v175, v27
M v[216:219], a[148:151], a[164:167], v[216:219]
 s_waitcnt lgkmcnt(2)
 v_sub_f32 v176, v176, v27
 v_sub_f32 v177, v177, v27
M v[220:223], a[156:159], a[164:167], v[220:223]
 s_waitcnt vmcnt(17) lgkmcnt(0)
 v_sub_f32 v178, v178, v27
 v_sub_f32 v179, v179, v27
M v[220:223], a[152:155], a[160:163], v[220:223]
 s_barrier
M v[252:255], a[152:155], a[168:171], v[252:255]
 ds_read_b128 a[160:163], v5 offset:0
 ds_read_b128 a[164:167], v6 offset:0
M v[252:255], a[156:159], a[172:175], v[252:255]
 v_and_b32 v26, 48, v0
 v_lshlrev_b32 v26, 17, v26
M v[248:251], a[148:151], a[172:175], v[248:251]
 v_or_b32 v26, v26, v0
 v_lshl_add_u32 v26, v26, 7, s95
M v[248:251], a[144:147], a[168:171], v[248:251]
 buffer_load_dword a240, v26, s[76:79], 0 offen offset:0
M v[244:247], a[136:139], a[168:171], v[244:247]
 v_sub_f32 v180, v180, v27
 v_sub_f32 v181, v181, v27
M v[244:247], a[140:143], a[172:175], v[244:247]
 v_sub_f32 v182, v182, v27
 v_sub_f32 v183, v183, v27
M v[240:243], a[132:135], a[172:175], v[240:243]
 v_sub_f32 v184, v184, v27
 v_sub_f32 v185, v185, v27
M v[240:243], a[128:131], a[168:171], v[240:243]
 v_sub_f32 v186, v186, v27
 v_sub_f32 v187, v187, v27
M v[236:239], a[120:123], a[168:171], v[236:239]
 v_sub_f32 v188, v188, v27
 v_sub_f32 v189, v189, v27
M v[236:239], a[124:127], a[172:175], v[236:239]
 v_sub_f32 v190, v190, v27
 v_sub_f32 v191, v191, v27
M v[232:235], a[116:119], a[172:175], v[232:235]
 v_sub_f32 v192, v192, v27
 v_sub_f32 v193, v193, v27
M v[232:235], a[112:115], a[168:171], v[232:235]
 v_sub_f32 v194, v194, v27
 v_sub_f32 v195, v195, v27
M v[228:231], a[104:107], a[168:171], v[228:231]
 v_sub_f32 v196, v196, v27
 v_sub_f32 v197, v197, v27
M v[228:231], a[108:111], a[172:175], v[228:231]
 s_waitcnt lgkmcnt(0)
 v_sub_f32 v198, v198, v27
 v_sub_f32 v199, v199, v27
M v[224:227], a[100:103], a[172:175], v[224:227]
 v_sub_f32 v200, v200, v27
 v_sub_f32 v201, v201, v27
M v[224:227], a[96:99], a[168:171], v[224:227]
 v_sub_f32 v202, v202, v27
 v_sub_f32 v203, v203, v27
M a[0:3], a[32:35], a[160:163], a[0:3]
 ds_read_b128 a[168:171], v5 offset:2048
 ds_read_b128 a[172:175], v6 offset:2048
M a[0:3], a[36:39], a[164:167], a[0:3]
 ds_read_b64_tr_b16 a[96:97], v1 offset:32768
 ds_read_b64_tr_b16 a[98:99], v1 offset:33792
M a[4:7], a[44:47], a[164:167], a[4:7]
 s_add_u32 m0, s24, 49152
 v_lshrrev_b32 v28, 4, v0
 v_add_u32 v28, 0, v28
M a[4:7], a[40:43], a[160:163], a[4:7]
 buffer_load_dwordx4 v12, s[48:51], s22 offen offset:0   lds
M a[8:11], a[48:51], a[160:163], a[8:11]
 v_and_b32 v29, 7, v0
 v_xor_b32 v28, v28, v29
M a[8:11], a[52:55], a[164:167], a[8:11]
 v_lshlrev_b32 v28, 4, v28
 v_lshrrev_b32 v29, 3, v0
M a[12:15], a[60:63], a[164:167], a[12:15]
 ds_read_b64_tr_b16 a[100:101], v1 offset:40960
 ds_read_b64_tr_b16 a[102:103], v1 offset:41984
M a[12:15], a[56:59], a[160:163], a[12:15]
 buffer_load_dwordx4 v13, s[48:51], s22 offen offset:1024   lds
M a[16:19], a[64:67], a[160:163], a[16:19]
 v_mul_u32_u24 v29, 896, v29
 s_mul_i32 s64, s20, 28672
M a[16:19], a[68:71], a[164:167], a[16:19]
 buffer_load_dwordx4 v14, s[48:51], s22 offen offset:2048   lds
M a[20:23], a[76:79], a[164:167], a[20:23]
 s_add_u32 s64, s64, 0
 v_add3_u32 v16, v29, v28, s64
M a[20:23], a[72:75], a[160:163], a[20:23]
 ds_read_b64_tr_b16 a[104:105], v2 offset:32768
 ds_read_b64_tr_b16 a[106:107], v2 offset:33792
M a[24:27], a[80:83], a[160:163], a[24:27]
 v_add_u32 v18, 12288, v16
 v_lshrrev_b32 v28, 4, v0
M a[24:27], a[84:87], a[164:167], a[24:27]
 s_waitcnt lgkmcnt(6)
 v_add_u32 v28, 4, v28
 v_and_b32 v29, 7, v0
M a[28:31], a[92:95], a[164:167], a[28:31]
 buffer_load_dwordx4 v15, s[48:51], s22 offen offset:3072   lds
M a[28:31], a[88:91], a[160:163], a[28:31]
 s_sub_u32 s22, s22, 2097024
 v_xor_b32 v28, v28, v29
 v_lshlrev_b32 v28, 4, v28
M v[60:63], a[88:91], a[168:171], v[60:63]
 s_add_u32 m0, s23, 16384
 ds_read_b128 a[160:163], v5 offset:4096
 ds_read_b128 a[164:167], v6 offset:4096
M v[60:63], a[92:95], a[172:175], v[60:63]
 ds_read_b64_tr_b16 a[108:109], v2 offset:40960
 ds_read_b64_tr_b16 a[110:111], v2 offset:41984
M v[56:59], a[84:87], a[172:175], v[56:59]
 buffer_load_dwordx4 v8, s[52:55], s28 offen offset:0   lds
M v[56:59], a[80:83], a[168:171], v[56:59]
 v_lshrrev_b32 v29, 3, v0
 v_mul_u32_u24 v29, 896, v29
M v[52:55], a[72:75], a[168:171], v[52:55]
 buffer_load_dwordx4 v9, s[52:55], s28 offen offset:1024   lds
M v[52:55], a[76:79], a[172:175], v[52:55]
 ds_read_b64_tr_b16 a[112:113], v3 offset:32768
 ds_read_b64_tr_b16 a[114:115], v3 offset:33792
M v[48:51], a[68:71], a[172:175], v[48:51]
 s_mul_i32 s64, s20, 28672
 s_add_u32 s64, s64, 6144
M v[48:51], a[64:67], a[168:171], v[48:51]
 buffer_load_dwordx4 v10, s[52:55], s28 offen offset:2048   lds
M v[44:47], a[56:59], a[168:171], v[44:47]
 v_add3_u32 v17, v29, v28, s64
 v_add_u32 v19, 12288, v17
M v[44:47], a[60:63], a[172:175], v[44:47]
 v_add_u32 v20, 0x20000, v1
 v_add_u32 v21, 0x20000, v2
M v[40:43], a[52:55], a[172:175], v[40:43]
 ds_read_b64_tr_b16 a[116:117], v3 offset:40960
 ds_read_b64_tr_b16 a[118:119], v3 offset:41984
M v[40:43], a[48:51], a[168:171], v[40:43]
 buffer_load_dwordx4 v11, s[52:55], s28 offen offset:3072   lds
M v[36:39], a[40:43], a[168:171], v[36:39]
 s_add_u32 s28, s28, 1048448
 v_add_u32 v22, 0x20000, v3
 v_add_u32 v23, 0x20000, v4
M v[36:39], a[44:47], a[172:175], v[36:39]
 s_waitcnt lgkmcnt(6)
 v_sub_f32 v204, v204, v27
 v_sub_f32 v205, v205, v27
M v[32:35], a[36:39], a[172:175], v[32:35]
 s_add_u32 m0, s23, 131072
 v_sub_f32 v206, v206, v27
 v_sub_f32 v207, v207, v27
M v[32:35], a[32:35], a[168:171], v[32:35]
 ds_read_b64_tr_b16 a[120:121], v4 offset:32768
 ds_read_b64_tr_b16 a[122:123], v4 offset:33792
M v[64:67], a[32:35], a[160:163], v[64:67]
 ds_read_b128 a[168:171], v5 offset:6144
 ds_read_b128 a[172:175], v6 offset:6144
M v[64:67], a[36:39], a[164:167], v[64:67]
 buffer_load_dwordx4 v8, s[52:55], s28 offen offset:0   lds
M v[68:71], a[44:47], a[164:167], v[68:71]
 buffer_load_dwordx4 v9, s[52:55], s28 offen offset:1024   lds
M v[68:71], a[40:43], a[160:163], v[68:71]
 v_sub_f32 v208, v208, v27
 v_sub_f32 v209, v209, v27
M v[72:75], a[48:51], a[160:163], v[72:75]
 ds_read_b64_tr_b16 a[124:125], v4 offset:40960
 ds_read_b64_tr_b16 a[126:127], v4 offset:41984
M v[72:75], a[52:55], a[164:167], v[72:75]
 buffer_load_dwordx4 v10, s[52:55], s28 offen offset:2048   lds
M v[76:79], a[60:63], a[164:167], v[76:79]
 v_sub_f32 v210, v210, v27
 v_sub_f32 v211, v211, v27
M v[76:79], a[56:59], a[160:163], v[76:79]
 v_sub_f32 v212, v212, v27
 v_sub_f32 v213, v213, v27
M v[80:83], a[64:67], a[160:163], v[80:83]
 buffer_load_dwordx4 v11, s[52:55], s28 offen offset:3072   lds
M v[80:83], a[68:71], a[164:167], v[80:83]
 s_sub_u32 s28, s28, 524288
 v_sub_f32 v214, v214, v27
 v_sub_f32 v215, v215, v27
M v[84:87], a[76:79], a[164:167], v[84:87]
 v_sub_f32 v216, v216, v27
 v_sub_f32 v217, v217, v27
M v[84:87], a[72:75], a[160:163], v[84:87]
 v_sub_f32 v218, v218, v27
 v_sub_f32 v219, v219, v27
M v[88:91], a[80:83], a[160:163], v[88:91]
 v_sub_f32 v220, v220, v27
 v_sub_f32 v221, v221, v27
M v[88:91], a[84:87], a[164:167], v[88:91]
 s_waitcnt lgkmcnt(2)
 v_sub_f32 v222, v222, v27
 v_sub_f32 v223, v223, v27
M v[92:95], a[92:95], a[164:167], v[92:95]
 s_waitcnt vmcnt(21) lgkmcnt(0)
 v_sub_f32 v224, v224, v27
 v_sub_f32 v225, v225, v27
M v[92:95], a[88:91], a[160:163], v[92:95]
 s_barrier
M v[124:127], a[88:91], a[168:171], v[124:127]
 ds_read_b128 a[160:163], v5 offset:16384
 ds_read_b128 a[164:167], v6 offset:16384
M v[124:127], a[92:95], a[172:175], v[124:127]
 v_sub_f32 v226, v226, v27
 v_sub_f32 v227, v227, v27
M v[120:123], a[84:87], a[172:175], v[120:123]
 s_add_u32 m0, s24, 0
 ds_read_b64_tr_b16 a[128:129], v1 offset:49152
 ds_read_b64_tr_b16 a[130:131], v1 offset:50176
M v[120:123], a[80:83], a[168:171], v[120:123]
 buffer_load_dwordx4 v16, s[56:59], s29 offen offset:0   lds
M v[116:119], a[72:75], a[168:171], v[116:119]
 s_mul_i32 s72, s41, 4352
 v_sub_f32 v228, v228, v27
M v[116:119], a[76:79], a[172:175], v[116:119]
 s_add_u32 s46, s72, 104923136
 v_sub_f32 v229, v229, v27
 v_sub_f32 v230, v230, v27
M v[112:115], a[68:71], a[172:175], v[112:115]
 s_lshl_b32 s45, s42, 7
 s_add_u32 s45, s45, s46
 s_sub_u32 s66, 15, s42
M v[112:115], a[64:67], a[168:171], v[112:115]
 buffer_load_dwordx4 v17, s[56:59], s29 offen offset:1024   lds
M v[108:111], a[56:59], a[168:171], v[108:111]
 s_min_u32 s66, s66, s42
 v_sub_f32 v231, v231, v27
M v[108:111], a[60:63], a[172:175], v[108:111]
 s_lshl_b32 s47, s66, 7
 ds_read_b64_tr_b16 a[132:133], v1 offset:57344
 ds_read_b64_tr_b16 a[134:135], v1 offset:58368
M v[104:107], a[52:55], a[172:175], v[104:107]
 s_add_u32 s47, s47, s46
 v_sub_f32 v232, v232, v27
 v_sub_f32 v233, v233, v27
M v[104:107], a[48:51], a[168:171], v[104:107]
 s_add_u32 s47, s47, 2048
 s_lshl2_add_u32 s47, s20, s47
 s_lshl_b32 s65, s41, 3
M v[100:103], a[40:43], a[168:171], v[100:103]
 buffer_load_dwordx4 v18, s[56:59], s29 offen offset:2048   lds
M v[100:103], a[44:47], a[172:175], v[100:103]
 s_waitcnt lgkmcnt(4)
 s_add_u32 s65, s65, s66
 v_sub_f32 v234, v234, v27
M v[96:99], a[36:39], a[172:175], v[96:99]
 s_mul_i32 s34, s65, 73728
 v_sub_f32 v235, v235, v27
 v_sub_f32 v236, v236, v27
M v[96:99], a[32:35], a[168:171], v[96:99]
 s_add_u32 s34, s34, 50331648
 v_sub_f32 v237, v237, v27
 v_sub_f32 v238, v238, v27
M v[128:131], a[32:35], a[160:163], v[128:131]
 s_lshl_b32 s65, s42, 4
 ds_read_b128 a[168:171], v5 offset:18432
 ds_read_b128 a[172:175], v6 offset:18432
M v[128:131], a[36:39], a[164:167], v[128:131]
 s_add_u32 s65, s65, s41
 ds_read_b64_tr_b16 a[136:137], v2 offset:49152
 ds_read_b64_tr_b16 a[138:139], v2 offset:50176
M v[132:135], a[44:47], a[164:167], v[132:135]
 buffer_load_dwordx4 v19, s[56:59], s29 offen offset:3072   lds
M v[132:135], a[40:43], a[160:163], v[132:135]
 s_add_u32 s29, s29, 128
 s_mul_i32 s33, s65, 114688
 v_sub_f32 v239, v239, v27
M v[136:139], a[48:51], a[160:163], v[136:139]
 s_mul_i32 s65, s20, 28672
 s_add_u32 s33, s33, s65
 s_add_u32 s33, s33, 67108864
M v[136:139], a[52:55], a[164:167], v[136:139]
 s_add_u32 m0, s23, 32768
 s_sub_u32 s65, 15, s66
 s_lshl_b32 s65, s65, 16
M v[140:143], a[60:63], a[164:167], v[140:143]
 buffer_load_dwordx4 v8, s[52:55], s28 offen offset:0   lds
M v[140:143], a[56:59], a[160:163], v[140:143]
 ds_read_b64_tr_b16 a[140:141], v2 offset:57344
 ds_read_b64_tr_b16 a[142:143], v2 offset:58368
M v[144:147], a[64:67], a[160:163], v[144:147]
 s_lshl_b32 s64, s41, 20
 v_sub_f32 v240, v240, v27
M v[144:147], a[68:71], a[164:167], v[144:147]
 s_add_u32 s32, s64, s65
 s_lshl_b32 s65, s20, 14
 s_add_u32 s32, s32, s65
M v[148:151], a[76:79], a[164:167], v[148:151]
 buffer_load_dwordx4 v9, s[52:55], s28 offen offset:1024   lds
M v[148:151], a[72:75], a[160:163], v[148:151]
 s_add_u32 s32, s32, 33554432
 v_sub_f32 v241, v241, v27
M v[152:155], a[80:83], a[160:163], v[152:155]
 s_mov_b32 s31, 0x53800000
 s_mov_b32 s40, 1
 s_sub_u32 s64, s42, 10
M v[152:155], a[84:87], a[164:167], v[152:155]
 s_waitcnt lgkmcnt(4)
 s_and_b32 s35, s64, 536870912
 v_sub_f32 v242, v242, v27
M v[156:159], a[92:95], a[164:167], v[156:159]
 ds_read_b64_tr_b16 a[144:145], v3 offset:49152
 ds_read_b64_tr_b16 a[146:147], v3 offset:50176
M v[156:159], a[88:91], a[160:163], v[156:159]
 buffer_load_dwordx4 v10, s[52:55], s28 offen offset:2048   lds
M v[188:191], a[88:91], a[168:171], v[188:191]
 ds_read_b128 a[160:163], v5 offset:20480
 ds_read_b128 a[164:167], v6 offset:20480
M v[188:191], a[92:95], a[172:175], v[188:191]
 v_sub_f32 v243, v243, v27
 v_sub_f32 v244, v244, v27
M v[184:187], a[84:87], a[172:175], v[184:187]
 v_sub_f32 v245, v245, v27
 v_sub_f32 v246, v246, v27
M v[184:187], a[80:83], a[168:171], v[184:187]
 v_sub_f32 v247, v247, v27
 v_sub_f32 v248, v248, v27
M v[180:183], a[72:75], a[168:171], v[180:183]
 buffer_load_dwordx4 v11, s[52:55], s28 offen offset:3072   lds
M v[180:183], a[76:79], a[172:175], v[180:183]
 s_add_u32 s28, s28, 524416
 ds_read_b64_tr_b16 a[148:149], v3 offset:57344
 ds_read_b64_tr_b16 a[150:151], v3 offset:58368
M v[176:179], a[68:71], a[172:175], v[176:179]
 v_sub_f32 v249, v249, v27
 v_sub_f32 v250, v250, v27
M v[176:179], a[64:67], a[168:171], v[176:179]
 v_sub_f32 v251, v251, v27
 v_sub_f32 v252, v252, v27
M v[172:175], a[56:59], a[168:171], v[172:175]
 s_add_u32 m0, s23, 147456
 v_sub_f32 v253, v253, v27
 v_sub_f32 v254, v254, v27
M v[172:175], a[60:63], a[172:175], v[172:175]
 buffer_load_dwordx4 v8, s[52:55], s28 offen offset:0   lds
M v[168:171], a[52:55], a[172:175], v[168:171]
 v_sub_f32 v255, v255, v27
M v[168:171], a[48:51], a[168:171], v[168:171]
M v[164:167], a[40:43], a[168:171], v[164:167]
 ds_read_b64_tr_b16 a[152:153], v4 offset:49152
 ds_read_b64_tr_b16 a[154:155], v4 offset:50176
M v[164:167], a[44:47], a[172:175], v[164:167]
 s_waitcnt lgkmcnt(4)
M v[160:163], a[36:39], a[172:175], v[160:163]
 buffer_load_dwordx4 v9, s[52:55], s28 offen offset:1024   lds
M v[160:163], a[32:35], a[168:171], v[160:163]
M v[192:195], a[32:35], a[160:163], v[192:195]
 ds_read_b128 a[168:171], v5 offset:22528
 ds_read_b128 a[172:175], v6 offset:22528
M v[192:195], a[36:39], a[164:167], v[192:195]
M v[196:199], a[44:47], a[164:167], v[196:199]
 buffer_load_dwordx4 v10, s[52:55], s28 offen offset:2048   lds
M v[196:199], a[40:43], a[160:163], v[196:199]
 ds_read_b64_tr_b16 a[156:157], v4 offset:57344
 ds_read_b64_tr_b16 a[158:159], v4 offset:58368
M v[200:203], a[48:51], a[160:163], v[200:203]
M v[200:203], a[52:55], a[164:167], v[200:203]
M v[204:207], a[60:63], a[164:167], v[204:207]
M v[204:207], a[56:59], a[160:163], v[204:207]
 buffer_load_dwordx4 v11, s[52:55], s28 offen offset:3072   lds
M v[208:211], a[64:67], a[160:163], v[208:211]
 s_sub_u32 s28, s28, 524288
M v[208:211], a[68:71], a[164:167], v[208:211]
M v[212:215], a[76:79], a[164:167], v[212:215]
M v[212:215], a[72:75], a[160:163], v[212:215]
M v[216:219], a[80:83], a[160:163], v[216:219]
M v[216:219], a[84:87], a[164:167], v[216:219]
 s_waitcnt lgkmcnt(2)
M v[220:223], a[92:95], a[164:167], v[220:223]
 s_waitcnt vmcnt(25) lgkmcnt(0)
M v[220:223], a[88:91], a[160:163], v[220:223]
 s_barrier
M v[252:255], a[88:91], a[168:171], v[252:255]
 ds_read_b128 a[160:163], v5 offset:32768
 ds_read_b128 a[164:167], v6 offset:32768
M v[252:255], a[92:95], a[172:175], v[252:255]
M v[248:251], a[84:87], a[172:175], v[248:251]
M v[248:251], a[80:83], a[168:171], v[248:251]
M v[244:247], a[72:75], a[168:171], v[244:247]
M v[244:247], a[76:79], a[172:175], v[244:247]
M v[240:243], a[68:71], a[172:175], v[240:243]
M v[240:243], a[64:67], a[168:171], v[240:243]
M v[236:239], a[56:59], a[168:171], v[236:239]
M v[236:239], a[60:63], a[172:175], v[236:239]
M v[232:235], a[52:55], a[172:175], v[232:235]
M v[232:235], a[48:51], a[168:171], v[232:235]
M v[228:231], a[40:43], a[168:171], v[228:231]
M v[228:231], a[44:47], a[172:175], v[228:231]
 s_waitcnt lgkmcnt(0)
M v[224:227], a[36:39], a[172:175], v[224:227]
M v[224:227], a[32:35], a[168:171], v[224:227]
M a[0:3], a[96:99], a[160:163], a[0:3]
 ds_read_b128 a[168:171], v5 offset:34816
 ds_read_b128 a[172:175], v6 offset:34816
M a[0:3], a[100:103], a[164:167], a[0:3]
 ds_read_b64_tr_b16 a[32:33], v1 offset:0
 ds_read_b64_tr_b16 a[34:35], v1 offset:1024
M a[4:7], a[108:111], a[164:167], a[4:7]
 s_add_u32 m0, s24, 16384
M a[4:7], a[104:107], a[160:163], a[4:7]
 buffer_load_dwordx4 v16, s[56:59], s29 offen offset:0   lds
M a[8:11], a[112:115], a[160:163], a[8:11]
M a[8:11], a[116:119], a[164:167], a[8:11]
M a[12:15], a[124:127], a[164:167], a[12:15]
 ds_read_b64_tr_b16 a[36:37], v1 offset:8192
 ds_read_b64_tr_b16 a[38:39], v1 offset:9216
M a[12:15], a[120:123], a[160:163], a[12:15]
M a[16:19], a[128:131], a[160:163], a[16:19]
 buffer_load_dwordx4 v17, s[56:59], s29 offen offset:1024   lds
M a[16:19], a[132:135], a[164:167], a[16:19]
 v_accvgpr_read_b32 v24, a0
 v_accvgpr_read_b32 v25, a1
M a[20:23], a[140:143], a[164:167], a[20:23]
 v_accvgpr_read_b32 v26, a2
 v_accvgpr_read_b32 v27, a3
M a[20:23], a[136:139], a[160:163], a[20:23]
 ds_read_b64_tr_b16 a[40:41], v2 offset:0
 ds_read_b64_tr_b16 a[42:43], v2 offset:1024
M a[24:27], a[144:147], a[160:163], a[24:27]
 v_accvgpr_read_b32 v28, a4
 v_accvgpr_read_b32 v29, a5
M a[24:27], a[148:151], a[164:167], a[24:27]
 s_waitcnt lgkmcnt(6)
 buffer_load_dwordx4 v18, s[56:59], s29 offen offset:2048   lds
M a[28:31], a[156:159], a[164:167], a[28:31]
 v_accvgpr_read_b32 v30, a6
 v_accvgpr_read_b32 v31, a7
M a[28:31], a[152:155], a[160:163], a[28:31]
 v_cvt_pk_bf16_f32 v24, v24, v25
 v_cvt_pk_bf16_f32 v25, v26, v27
M v[32:35], a[96:99], a[168:171], v[32:35]
 ds_read_b128 a[160:163], v5 offset:36864
 ds_read_b128 a[164:167], v6 offset:36864
M v[32:35], a[100:103], a[172:175], v[32:35]
 ds_read_b64_tr_b16 a[44:45], v2 offset:8192
 ds_read_b64_tr_b16 a[46:47], v2 offset:9216
M v[36:39], a[108:111], a[172:175], v[36:39]
 buffer_load_dwordx4 v19, s[56:59], s29 offen offset:3072   lds
M v[36:39], a[104:107], a[168:171], v[36:39]
 s_add_u32 s29, s29, 128
 v_cvt_pk_bf16_f32 v26, v28, v29
 v_cvt_pk_bf16_f32 v27, v30, v31
M v[40:43], a[112:115], a[168:171], v[40:43]
 s_add_u32 s3, s93, 0
 buffer_store_dwordx4 v[24:27], v7, s[8:11], s3 offen offset:0 sc1
M v[40:43], a[116:119], a[172:175], v[40:43]
 ds_read_b64_tr_b16 a[48:49], v3 offset:0
 ds_read_b64_tr_b16 a[50:51], v3 offset:1024
M v[44:47], a[124:127], a[172:175], v[44:47]
 s_add_u32 m0, s23, 49152
 v_accvgpr_read_b32 v24, a8
 v_accvgpr_read_b32 v25, a9
M v[44:47], a[120:123], a[168:171], v[44:47]
 buffer_load_dwordx4 v8, s[52:55], s28 offen offset:0   lds
M v[48:51], a[128:131], a[168:171], v[48:51]
 v_accvgpr_read_b32 v26, a10
 v_accvgpr_read_b32 v27, a11
M v[48:51], a[132:135], a[172:175], v[48:51]
 v_accvgpr_read_b32 v28, a12
 v_accvgpr_read_b32 v29, a13
M v[52:55], a[140:143], a[172:175], v[52:55]
 ds_read_b64_tr_b16 a[52:53], v3 offset:8192
 ds_read_b64_tr_b16 a[54:55], v3 offset:9216
M v[52:55], a[136:139], a[168:171], v[52:55]
 v_accvgpr_read_b32 v30, a14
 v_accvgpr_read_b32 v31, a15
M v[56:59], a[144:147], a[168:171], v[56:59]
 buffer_load_dwordx4 v9, s[52:55], s28 offen offset:1024   lds
M v[56:59], a[148:151], a[172:175], v[56:59]
 s_waitcnt lgkmcnt(6)
 v_cvt_pk_bf16_f32 v24, v24, v25
 v_cvt_pk_bf16_f32 v25, v26, v27
M v[60:63], a[156:159], a[172:175], v[60:63]
 v_cvt_pk_bf16_f32 v26, v28, v29
 v_cvt_pk_bf16_f32 v27, v30, v31
M v[60:63], a[152:155], a[168:171], v[60:63]
 ds_read_b64_tr_b16 a[56:57], v4 offset:0
 ds_read_b64_tr_b16 a[58:59], v4 offset:1024
M v[64:67], a[96:99], a[160:163], v[64:67]
 ds_read_b128 a[168:171], v5 offset:38912
 ds_read_b128 a[172:175], v6 offset:38912
M v[64:67], a[100:103], a[164:167], v[64:67]
 buffer_load_dwordx4 v10, s[52:55], s28 offen offset:2048   lds
M v[68:71], a[108:111], a[164:167], v[68:71]
M v[68:71], a[104:107], a[160:163], v[68:71]
 buffer_store_dwordx4 v[24:27], v7, s[8:11], s3 offen offset:1024 sc1
M v[72:75], a[112:115], a[160:163], v[72:75]
 ds_read_b64_tr_b16 a[60:61], v4 offset:8192
 ds_read_b64_tr_b16 a[62:63], v4 offset:9216
M v[72:75], a[116:119], a[164:167], v[72:75]
 v_accvgpr_read_b32 v24, a16
 v_accvgpr_read_b32 v25, a17
M v[76:79], a[124:127], a[164:167], v[76:79]
 buffer_load_dwordx4 v11, s[52:55], s28 offen offset:3072   lds
M v[76:79], a[120:123], a[160:163], v[76:79]
 s_add_u32 s28, s28, 1048448
 v_accvgpr_read_b32 v26, a18
 v_accvgpr_read_b32 v27, a19
M v[80:83], a[128:131], a[160:163], v[80:83]
 v_accvgpr_read_b32 v28, a20
 v_accvgpr_read_b32 v29, a21
M v[80:83], a[132:135], a[164:167], v[80:83]
 v_accvgpr_read_b32 v30, a22
 v_accvgpr_read_b32 v31, a23
M v[84:87], a[140:143], a[164:167], v[84:87]
 v_cvt_pk_bf16_f32 v24, v24, v25
 v_cvt_pk_bf16_f32 v25, v26, v27
M v[84:87], a[136:139], a[160:163], v[84:87]
 v_cvt_pk_bf16_f32 v26, v28, v29
 v_cvt_pk_bf16_f32 v27, v30, v31
M v[88:91], a[144:147], a[160:163], v[88:91]
 buffer_store_dwordx4 v[24:27], v7, s[8:11], s3 offen offset:2048 sc1
M v[88:91], a[148:151], a[164:167], v[88:91]
 s_waitcnt lgkmcnt(2)
 v_accvgpr_read_b32 v24, a24
 v_accvgpr_read_b32 v25, a25
M v[92:95], a[156:159], a[164:167], v[92:95]
 s_waitcnt vmcnt(27) lgkmcnt(0)
 v_accvgpr_read_b32 v26, a26
 v_accvgpr_read_b32 v27, a27
M v[92:95], a[152:155], a[160:163], v[92:95]
 s_barrier
M v[96:99], a[96:99], a[168:171], v[96:99]
 ds_read_b128 a[160:163], v5 offset:49152
 ds_read_b128 a[164:167], v6 offset:49152
M v[96:99], a[100:103], a[172:175], v[96:99]
 v_accvgpr_read_b32 v28, a28
 v_accvgpr_read_b32 v29, a29
M v[100:103], a[108:111], a[172:175], v[100:103]
 s_add_u32 m0, s24, 32768
 ds_read_b64_tr_b16 a[64:65], v1 offset:16384
 ds_read_b64_tr_b16 a[66:67], v1 offset:17408
M v[100:103], a[104:107], a[168:171], v[100:103]
 buffer_load_dwordx4 v16, s[56:59], s29 offen offset:0   lds
M v[104:107], a[112:115], a[168:171], v[104:107]
 v_accvgpr_read_b32 v30, a30
 v_accvgpr_read_b32 v31, a31
M v[104:107], a[116:119], a[172:175], v[104:107]
 v_cvt_pk_bf16_f32 v24, v24, v25
 v_cvt_pk_bf16_f32 v25, v26, v27
M v[108:111], a[124:127], a[172:175], v[108:111]
 v_cvt_pk_bf16_f32 v26, v28, v29
 v_cvt_pk_bf16_f32 v27, v30, v31
M v[108:111], a[120:123], a[168:171], v[108:111]
 buffer_store_dwordx4 v[24:27], v7, s[8:11], s3 offen offset:3072 sc1
M v[112:115], a[128:131], a[168:171], v[112:115]
 v_cvt_pk_bf16_f32 v32, v32, v33
 v_cvt_pk_bf16_f32 v33, v34, v35
M v[112:115], a[132:135], a[172:175], v[112:115]
 ds_read_b64_tr_b16 a[68:69], v1 offset:24576
 ds_read_b64_tr_b16 a[70:71], v1 offset:25600
M v[116:119], a[140:143], a[172:175], v[116:119]
 buffer_load_dwordx4 v17, s[56:59], s29 offen offset:1024   lds
M v[116:119], a[136:139], a[168:171], v[116:119]
 v_cvt_pk_bf16_f32 v34, v36, v37
 v_cvt_pk_bf16_f32 v35, v38, v39
M v[120:123], a[144:147], a[168:171], v[120:123]
 v_accvgpr_write_b32 a4, v32
 v_accvgpr_write_b32 a5, v33
M v[120:123], a[148:151], a[172:175], v[120:123]
 s_waitcnt lgkmcnt(4)
 v_accvgpr_write_b32 a6, v34
 v_accvgpr_write_b32 a7, v35
M v[124:127], a[156:159], a[172:175], v[124:127]
 v_cvt_pk_bf16_f32 v40, v40, v41
 v_cvt_pk_bf16_f32 v41, v42, v43
M v[124:127], a[152:155], a[168:171], v[124:127]
 v_cvt_pk_bf16_f32 v42, v44, v45
 v_cvt_pk_bf16_f32 v43, v46, v47
M v[128:131], a[96:99], a[160:163], v[128:131]
 ds_read_b128 a[168:171], v5 offset:51200
 ds_read_b128 a[172:175], v6 offset:51200
M v[128:131], a[100:103], a[164:167], v[128:131]
 ds_read_b64_tr_b16 a[72:73], v2 offset:16384
 ds_read_b64_tr_b16 a[74:75], v2 offset:17408
M v[132:135], a[108:111], a[164:167], v[132:135]
 buffer_load_dwordx4 v18, s[56:59], s29 offen offset:2048   lds
M v[132:135], a[104:107], a[160:163], v[132:135]
 v_accvgpr_write_b32 a12, v40
 v_accvgpr_write_b32 a13, v41
M v[136:139], a[112:115], a[160:163], v[136:139]
 v_accvgpr_write_b32 a14, v42
 v_accvgpr_write_b32 a15, v43
M v[136:139], a[116:119], a[164:167], v[136:139]
 v_cvt_pk_bf16_f32 v48, v48, v49
 v_cvt_pk_bf16_f32 v49, v50, v51
M v[140:143], a[124:127], a[164:167], v[140:143]
 v_cvt_pk_bf16_f32 v50, v52, v53
 v_cvt_pk_bf16_f32 v51, v54, v55
M v[140:143], a[120:123], a[160:163], v[140:143]
 ds_read_b64_tr_b16 a[76:77], v2 offset:24576
 ds_read_b64_tr_b16 a[78:79], v2 offset:25600
M v[144:147], a[128:131], a[160:163], v[144:147]
 buffer_load_dwordx4 v19, s[56:59], s29 offen offset:3072   lds
M v[144:147], a[132:135], a[164:167], v[144:147]
 s_add_u32 s29, s29, 128
 v_accvgpr_write_b32 a20, v48
 v_accvgpr_write_b32 a21, v49
M v[148:151], a[140:143], a[164:167], v[148:151]
 v_accvgpr_write_b32 a22, v50
 v_accvgpr_write_b32 a23, v51
M v[148:151], a[136:139], a[160:163], v[148:151]
 v_cvt_pk_bf16_f32 v56, v56, v57
 v_cvt_pk_bf16_f32 v57, v58, v59
M v[152:155], a[144:147], a[160:163], v[152:155]
 v_cvt_pk_bf16_f32 v58, v60, v61
 v_cvt_pk_bf16_f32 v59, v62, v63
M v[152:155], a[148:151], a[164:167], v[152:155]
 s_waitcnt lgkmcnt(4)
 v_accvgpr_write_b32 a28, v56
 v_accvgpr_write_b32 a29, v57
M v[156:159], a[156:159], a[164:167], v[156:159]
 s_add_u32 m0, s23, 0
 ds_read_b64_tr_b16 a[80:81], v3 offset:16384
 ds_read_b64_tr_b16 a[82:83], v3 offset:17408
M v[156:159], a[152:155], a[160:163], v[156:159]
 buffer_load_dwordx4 v8, s[52:55], s28 offen offset:0   lds
M v[160:163], a[96:99], a[168:171], v[160:163]
 ds_read_b128 a[160:163], v5 offset:53248
 ds_read_b128 a[164:167], v6 offset:53248
M v[160:163], a[100:103], a[172:175], v[160:163]
 v_accvgpr_write_b32 a30, v58
 v_accvgpr_write_b32 a31, v59
M v[164:167], a[108:111], a[172:175], v[164:167]
 v_cvt_pk_bf16_f32 v64, v64, v65
 v_cvt_pk_bf16_f32 v65, v66, v67
M v[164:167], a[104:107], a[168:171], v[164:167]
 v_cvt_pk_bf16_f32 v66, v68, v69
 v_cvt_pk_bf16_f32 v67, v70, v71
M v[168:171], a[112:115], a[168:171], v[168:171]
 v_cvt_pk_bf16_f32 v72, v72, v73
 v_cvt_pk_bf16_f32 v73, v74, v75
M v[168:171], a[116:119], a[172:175], v[168:171]
 ds_read_b64_tr_b16 a[84:85], v3 offset:24576
 ds_read_b64_tr_b16 a[86:87], v3 offset:25600
M v[172:175], a[124:127], a[172:175], v[172:175]
 buffer_load_dwordx4 v9, s[52:55], s28 offen offset:1024   lds
M v[172:175], a[120:123], a[168:171], v[172:175]
 v_cvt_pk_bf16_f32 v74, v76, v77
 v_cvt_pk_bf16_f32 v75, v78, v79
M v[176:179], a[128:131], a[168:171], v[176:179]
 v_cvt_pk_bf16_f32 v80, v80, v81
 v_cvt_pk_bf16_f32 v81, v82, v83
M v[176:179], a[132:135], a[172:175], v[176:179]
 v_cvt_pk_bf16_f32 v82, v84, v85
 v_cvt_pk_bf16_f32 v83, v86, v87
M v[180:183], a[140:143], a[172:175], v[180:183]
 v_cvt_pk_bf16_f32 v88, v88, v89
 v_cvt_pk_bf16_f32 v89, v90, v91
M v[180:183], a[136:139], a[168:171], v[180:183]
 v_cvt_pk_bf16_f32 v90, v92, v93
 v_cvt_pk_bf16_f32 v91, v94, v95
M v[184:187], a[144:147], a[168:171], v[184:187]
 ds_read_b64_tr_b16 a[88:89], v4 offset:16384
 ds_read_b64_tr_b16 a[90:91], v4 offset:17408
M v[184:187], a[148:151], a[172:175], v[184:187]
 s_waitcnt lgkmcnt(4)
 buffer_load_dwordx4 v10, s[52:55], s28 offen offset:2048   lds
M v[188:191], a[156:159], a[172:175], v[188:191]
 v_cvt_pk_bf16_f32 v96, v96, v97
 v_cvt_pk_bf16_f32 v97, v98, v99
M v[188:191], a[152:155], a[168:171], v[188:191]
 v_cvt_pk_bf16_f32 v98, v100, v101
 v_cvt_pk_bf16_f32 v99, v102, v103
M v[192:195], a[96:99], a[160:163], v[192:195]
 ds_read_b128 a[168:171], v5 offset:55296
 ds_read_b128 a[172:175], v6 offset:55296
M v[192:195], a[100:103], a[164:167], v[192:195]
 v_cvt_pk_bf16_f32 v104, v104, v105
 v_cvt_pk_bf16_f32 v105, v106, v107
M v[196:199], a[108:111], a[164:167], v[196:199]
 v_cvt_pk_bf16_f32 v106, v108, v109
 v_cvt_pk_bf16_f32 v107, v110, v111
M v[196:199], a[104:107], a[160:163], v[196:199]
 ds_read_b64_tr_b16 a[92:93], v4 offset:24576
 ds_read_b64_tr_b16 a[94:95], v4 offset:25600
M v[200:203], a[112:115], a[160:163], v[200:203]
 buffer_load_dwordx4 v11, s[52:55], s28 offen offset:3072   lds
M v[200:203], a[116:119], a[164:167], v[200:203]
 s_add_u32 s28, s28, 128
 v_cvt_pk_bf16_f32 v112, v112, v113
 v_cvt_pk_bf16_f32 v113, v114, v115
M v[204:207], a[124:127], a[164:167], v[204:207]
 v_cvt_pk_bf16_f32 v114, v116, v117
 v_cvt_pk_bf16_f32 v115, v118, v119
M v[204:207], a[120:123], a[160:163], v[204:207]
 v_cvt_pk_bf16_f32 v120, v120, v121
 v_cvt_pk_bf16_f32 v121, v122, v123
M v[208:211], a[128:131], a[160:163], v[208:211]
 v_cvt_pk_bf16_f32 v122, v124, v125
 v_cvt_pk_bf16_f32 v123, v126, v127
M v[208:211], a[132:135], a[164:167], v[208:211]
 v_cvt_pk_bf16_f32 v128, v128, v129
 v_cvt_pk_bf16_f32 v129, v130, v131
M v[212:215], a[140:143], a[164:167], v[212:215]
 v_cvt_pk_bf16_f32 v130, v132, v133
 v_cvt_pk_bf16_f32 v131, v134, v135
M v[212:215], a[136:139], a[160:163], v[212:215]
 v_cvt_pk_bf16_f32 v136, v136, v137
 v_cvt_pk_bf16_f32 v137, v138, v139
M v[216:219], a[144:147], a[160:163], v[216:219]
 v_cvt_pk_bf16_f32 v138, v140, v141
 v_cvt_pk_bf16_f32 v139, v142, v143
M v[216:219], a[148:151], a[164:167], v[216:219]
 s_waitcnt lgkmcnt(2)
 v_cvt_pk_bf16_f32 v144, v144, v145
 v_cvt_pk_bf16_f32 v145, v146, v147
M v[220:223], a[156:159], a[164:167], v[220:223]
 s_waitcnt vmcnt(24) lgkmcnt(0)
 v_cvt_pk_bf16_f32 v146, v148, v149
 v_cvt_pk_bf16_f32 v147, v150, v151
M v[220:223], a[152:155], a[160:163], v[220:223]
 s_barrier
M v[224:227], a[96:99], a[168:171], v[224:227]
 ds_read_b128 a[160:163], v5 offset:0
 ds_read_b128 a[164:167], v6 offset:0
M v[224:227], a[100:103], a[172:175], v[224:227]
 v_cvt_pk_bf16_f32 v152, v152, v153
 v_cvt_pk_bf16_f32 v153, v154, v155
M v[228:231], a[108:111], a[172:175], v[228:231]
 v_cvt_pk_bf16_f32 v154, v156, v157
 v_cvt_pk_bf16_f32 v155, v158, v159
M v[228:231], a[104:107], a[168:171], v[228:231]
 v_cvt_pk_bf16_f32 v160, v160, v161
 v_cvt_pk_bf16_f32 v161, v162, v163
M v[232:235], a[112:115], a[168:171], v[232:235]
 v_cvt_pk_bf16_f32 v162, v164, v165
 v_cvt_pk_bf16_f32 v163, v166, v167
M v[232:235], a[116:119], a[172:175], v[232:235]
 v_cvt_pk_bf16_f32 v168, v168, v169
 v_cvt_pk_bf16_f32 v169, v170, v171
M v[236:239], a[124:127], a[172:175], v[236:239]
 v_cvt_pk_bf16_f32 v170, v172, v173
 v_cvt_pk_bf16_f32 v171, v174, v175
M v[236:239], a[120:123], a[168:171], v[236:239]
 v_cvt_pk_bf16_f32 v176, v176, v177
 v_cvt_pk_bf16_f32 v177, v178, v179
M v[240:243], a[128:131], a[168:171], v[240:243]
 v_cvt_pk_bf16_f32 v178, v180, v181
 v_cvt_pk_bf16_f32 v179, v182, v183
M v[240:243], a[132:135], a[172:175], v[240:243]
 v_cvt_pk_bf16_f32 v184, v184, v185
 v_cvt_pk_bf16_f32 v185, v186, v187
M v[244:247], a[140:143], a[172:175], v[244:247]
 v_cvt_pk_bf16_f32 v186, v188, v189
 v_cvt_pk_bf16_f32 v187, v190, v191
M v[244:247], a[136:139], a[168:171], v[244:247]
 v_cvt_pk_bf16_f32 v192, v192, v193
 v_cvt_pk_bf16_f32 v193, v194, v195
M v[248:251], a[144:147], a[168:171], v[248:251]
 v_cvt_pk_bf16_f32 v194, v196, v197
 v_cvt_pk_bf16_f32 v195, v198, v199
M v[248:251], a[148:151], a[172:175], v[248:251]
 s_waitcnt lgkmcnt(0)
 v_cvt_pk_bf16_f32 v200, v200, v201
 v_cvt_pk_bf16_f32 v201, v202, v203
M v[252:255], a[156:159], a[172:175], v[252:255]
 v_cvt_pk_bf16_f32 v202, v204, v205
 v_cvt_pk_bf16_f32 v203, v206, v207
M v[252:255], a[152:155], a[168:171], v[252:255]
 v_cvt_pk_bf16_f32 v208, v208, v209
 v_cvt_pk_bf16_f32 v209, v210, v211
M v[32:35], a[32:35], a[160:163], 0
 s_add_u32 m0, s23, 16384
 ds_read_b128 a[168:171], v5 offset:2048
 ds_read_b128 a[172:175], v6 offset:2048
M v[32:35], a[36:39], a[164:167], v[32:35]
 ds_read_b64_tr_b16 a[96:97], v1 offset:32768
 ds_read_b64_tr_b16 a[98:99], v1 offset:33792
M v[36:39], a[44:47], a[164:167], 0
 buffer_load_dwordx4 v8, s[52:55], s28 offen offset:0   lds
M v[36:39], a[40:43], a[160:163], v[36:39]
 v_cvt_pk_bf16_f32 v210, v212, v213
 v_cvt_pk_bf16_f32 v211, v214, v215
M v[40:43], a[48:51], a[160:163], 0
 ds_read_b64_tr_b16 a[100:101], v1 offset:40960
 ds_read_b64_tr_b16 a[102:103], v1 offset:41984
M v[40:43], a[52:55], a[164:167], v[40:43]
 buffer_load_dwordx4 v9, s[52:55], s28 offen offset:1024   lds
M v[44:47], a[60:63], a[164:167], 0
 v_cvt_pk_bf16_f32 v216, v216, v217
 v_cvt_pk_bf16_f32 v217, v218, v219
M v[44:47], a[56:59], a[160:163], v[44:47]
 ds_read_b64_tr_b16 a[104:105], v2 offset:32768
 ds_read_b64_tr_b16 a[106:107], v2 offset:33792
M v[48:51], a[64:67], a[160:163], 0
 v_cvt_pk_bf16_f32 v218, v220, v221
 v_cvt_pk_bf16_f32 v219, v222, v223
M v[48:51], a[68:71], a[164:167], v[48:51]
 v_cvt_pk_bf16_f32 v224, v224, v225
 v_cvt_pk_bf16_f32 v225, v226, v227
M v[52:55], a[76:79], a[164:167], 0
 ds_read_b64_tr_b16 a[108:109], v2 offset:40960
 ds_read_b64_tr_b16 a[110:111], v2 offset:41984
M v[52:55], a[72:75], a[160:163], v[52:55]
 buffer_load_dwordx4 v10, s[52:55], s28 offen offset:2048   lds
M v[56:59], a[80:83], a[160:163], 0
 v_cvt_pk_bf16_f32 v226, v228, v229
 v_cvt_pk_bf16_f32 v227, v230, v231
M v[56:59], a[84:87], a[164:167], v[56:59]
 s_waitcnt lgkmcnt(8)
 ds_read_b64_tr_b16 a[112:113], v3 offset:32768
 ds_read_b64_tr_b16 a[114:115], v3 offset:33792
M v[60:63], a[92:95], a[164:167], 0
 v_cvt_pk_bf16_f32 v232, v232, v233
 v_cvt_pk_bf16_f32 v233, v234, v235
M v[60:63], a[88:91], a[160:163], v[60:63]
 buffer_load_dwordx4 v11, s[52:55], s28 offen offset:3072   lds
M v[68:71], a[32:35], a[168:171], 0
 s_add_u32 s28, s28, 524160
 ds_read_b128 a[160:163], v5 offset:4096
 ds_read_b128 a[164:167], v6 offset:4096
M v[68:71], a[36:39], a[172:175], v[68:71]
 ds_read_b64_tr_b16 a[116:117], v3 offset:40960
 ds_read_b64_tr_b16 a[118:119], v3 offset:41984
M v[76:79], a[44:47], a[172:175], 0
 v_cvt_pk_bf16_f32 v234, v236, v237
 v_cvt_pk_bf16_f32 v235, v238, v239
M v[76:79], a[40:43], a[168:171], v[76:79]
 s_add_u32 m0, s24, 49152
 ds_read_b64_tr_b16 a[120:121], v4 offset:32768
 ds_read_b64_tr_b16 a[122:123], v4 offset:33792
M v[84:87], a[48:51], a[168:171], 0
 buffer_load_dwordx4 v16, s[56:59], s29 offen offset:0   lds
M v[84:87], a[52:55], a[172:175], v[84:87]
 v_cvt_pk_bf16_f32 v240, v240, v241
 v_cvt_pk_bf16_f32 v241, v242, v243
M v[92:95], a[60:63], a[172:175], 0
 ds_read_b64_tr_b16 a[124:125], v4 offset:40960
 ds_read_b64_tr_b16 a[126:127], v4 offset:41984
M v[92:95], a[56:59], a[168:171], v[92:95]
 v_cvt_pk_bf16_f32 v242, v244, v245
 v_cvt_pk_bf16_f32 v243, v246, v247
M v[100:103], a[64:67], a[168:171], 0
 v_cvt_pk_bf16_f32 v248, v248, v249
 v_cvt_pk_bf16_f32 v249, v250, v251
M v[100:103], a[68:71], a[172:175], v[100:103]
 buffer_load_dwordx4 v17, s[56:59], s29 offen offset:1024   lds
M v[108:111], a[76:79], a[172:175], 0
 v_cvt_pk_bf16_f32 v250, v252, v253
 v_cvt_pk_bf16_f32 v251, v254, v255
M v[108:111], a[72:75], a[168:171], v[108:111]
 s_add_u32 s3, s93, 8192
 v_mov_b32 v12, 1
 v_or_b32 v15, s20, v0
M v[116:119], a[80:83], a[168:171], 0
 v_min_u32 v15, 1, v15
 v_lshlrev_b32 v15, 29, v15
M v[116:119], a[84:87], a[172:175], v[116:119]
 s_waitcnt lgkmcnt(6)
 buffer_store_dwordx4 a[4:7], v7, s[8:11], s3 offen offset:0 sc1
M v[124:127], a[92:95], a[172:175], 0
 s_waitcnt vmcnt(17) lgkmcnt(0)
 buffer_load_dwordx4 v18, s[56:59], s29 offen offset:2048   lds
M v[124:127], a[88:91], a[168:171], v[124:127]
 s_barrier
M v[132:135], a[32:35], a[160:163], 0
 ds_read_b128 a[168:171], v5 offset:6144
 ds_read_b128 a[172:175], v6 offset:6144
M v[132:135], a[36:39], a[164:167], v[132:135]
 ds_read_b64_tr_b16 a[128:129], v1 offset:49152
 ds_read_b64_tr_b16 a[130:131], v1 offset:50176
M v[140:143], a[44:47], a[164:167], 0
M v[140:143], a[40:43], a[160:163], v[140:143]
 buffer_load_dwordx4 v19, s[56:59], s29 offen offset:3072   lds
M v[148:151], a[48:51], a[160:163], 0
 s_add_u32 s29, s29, 128
 ds_read_b64_tr_b16 a[132:133], v1 offset:57344
 ds_read_b64_tr_b16 a[134:135], v1 offset:58368
M v[148:151], a[52:55], a[164:167], v[148:151]
 buffer_store_dwordx4 a[12:15], v7, s[8:11], s3 offen offset:1024 sc1
M v[156:159], a[60:63], a[164:167], 0
M v[156:159], a[56:59], a[160:163], v[156:159]
 s_add_u32 m0, s23, 32768
 ds_read_b64_tr_b16 a[136:137], v2 offset:49152
 ds_read_b64_tr_b16 a[138:139], v2 offset:50176
M v[164:167], a[64:67], a[160:163], 0
 buffer_load_dwordx4 v8, s[52:55], s28 offen offset:0   lds
M v[164:167], a[68:71], a[164:167], v[164:167]
M v[172:175], a[76:79], a[164:167], 0
 ds_read_b64_tr_b16 a[140:141], v2 offset:57344
 ds_read_b64_tr_b16 a[142:143], v2 offset:58368
M v[172:175], a[72:75], a[160:163], v[172:175]
M v[180:183], a[80:83], a[160:163], 0
M v[180:183], a[84:87], a[164:167], v[180:183]
 s_waitcnt lgkmcnt(8)
 ds_read_b64_tr_b16 a[144:145], v3 offset:49152
 ds_read_b64_tr_b16 a[146:147], v3 offset:50176
M v[188:191], a[92:95], a[164:167], 0
 buffer_load_dwordx4 v9, s[52:55], s28 offen offset:1024   lds
M v[188:191], a[88:91], a[160:163], v[188:191]
M v[196:199], a[32:35], a[168:171], 0
 ds_read_b128 a[160:163], v5 offset:16384
 ds_read_b128 a[164:167], v6 offset:16384
M v[196:199], a[36:39], a[172:175], v[196:199]
 ds_read_b64_tr_b16 a[148:149], v3 offset:57344
 ds_read_b64_tr_b16 a[150:151], v3 offset:58368
M v[204:207], a[44:47], a[172:175], 0
 buffer_load_dwordx4 v10, s[52:55], s28 offen offset:2048   lds
M v[204:207], a[40:43], a[168:171], v[204:207]
 ds_read_b64_tr_b16 a[152:153], v4 offset:49152
 ds_read_b64_tr_b16 a[154:155], v4 offset:50176
M v[212:215], a[48:51], a[168:171], 0
M v[212:215], a[52:55], a[172:175], v[212:215]
M v[220:223], a[60:63], a[172:175], 0
 ds_read_b64_tr_b16 a[156:157], v4 offset:57344
 ds_read_b64_tr_b16 a[158:159], v4 offset:58368
M v[220:223], a[56:59], a[168:171], v[220:223]
 buffer_load_dwordx4 v11, s[52:55], s28 offen offset:3072   lds
M v[228:231], a[64:67], a[168:171], 0
 s_add_u32 s28, s28, 128
M v[228:231], a[68:71], a[172:175], v[228:231]
M v[236:239], a[76:79], a[172:175], 0
M v[236:239], a[72:75], a[168:171], v[236:239]
M v[244:247], a[80:83], a[168:171], 0
M v[244:247], a[84:87], a[172:175], v[244:247]
 s_waitcnt lgkmcnt(6)
M v[252:255], a[92:95], a[172:175], 0
 s_waitcnt lgkmcnt(0)
M v[252:255], a[88:91], a[168:171], v[252:255]
 s_barrier
M v[32:35], a[96:99], a[160:163], v[32:35]
 s_add_u32 m0, s23, 49152
 ds_read_b128 a[168:171], v5 offset:18432
 ds_read_b128 a[172:175], v6 offset:18432
M v[32:35], a[100:103], a[164:167], v[32:35]
 ds_read_b64_tr_b16 a[32:33], v20 offset:0
 ds_read_b64_tr_b16 a[34:35], v20 offset:1024
M v[36:39], a[108:111], a[164:167], v[36:39]
 s_mov_b32 s39, 1280
 buffer_load_dwordx4 v8, s[52:55], s28 offen offset:0   lds
M v[36:39], a[104:107], a[160:163], v[36:39]
 s_cmp_ge_u32 s42, 10
M v[40:43], a[112:115], a[160:163], v[40:43]
 s_cselect_b32 s64, 0xf000000, 0
 ds_read_b64_tr_b16 a[36:37], v20 offset:8192
 ds_read_b64_tr_b16 a[38:39], v20 offset:9216
M v[40:43], a[116:119], a[164:167], v[40:43]
 s_or_b32 s39, s39, s64
 buffer_load_dwordx4 v9, s[52:55], s28 offen offset:1024   lds
M v[44:47], a[124:127], a[164:167], v[44:47]
 s_lshl_b32 s64, s20, 14
M v[44:47], a[120:123], a[160:163], v[44:47]
 s_add_u32 s12, s64, s34
 ds_read_b64_tr_b16 a[40:41], v21 offset:0
 ds_read_b64_tr_b16 a[42:43], v21 offset:1024
M v[48:51], a[128:131], a[160:163], v[48:51]
 s_add_u32 s13, s12, 4096
 buffer_store_dwordx4 a[20:23], v7, s[8:11], s3 offen offset:2048 sc1
M v[48:51], a[132:135], a[164:167], v[48:51]
 s_add_u32 s14, s12, 8192
M v[52:55], a[140:143], a[164:167], v[52:55]
 s_add_u32 s15, s12, 12288
 ds_read_b64_tr_b16 a[44:45], v21 offset:8192
 ds_read_b64_tr_b16 a[46:47], v21 offset:9216
M v[52:55], a[136:139], a[160:163], v[52:55]
 buffer_load_dwordx4 v10, s[52:55], s28 offen offset:2048   lds
M v[56:59], a[144:147], a[160:163], v[56:59]
M v[56:59], a[148:151], a[164:167], v[56:59]
 s_waitcnt lgkmcnt(8)
 ds_read_b64_tr_b16 a[48:49], v22 offset:0
 ds_read_b64_tr_b16 a[50:51], v22 offset:1024
M v[60:63], a[156:159], a[164:167], v[60:63]
M v[60:63], a[152:155], a[160:163], v[60:63]
 buffer_load_dwordx4 v11, s[52:55], s28 offen offset:3072   lds
M v[68:71], a[96:99], a[168:171], v[68:71]
 s_add_u32 s28, s28, 524160
 ds_read_b128 a[160:163], v5 offset:20480
 ds_read_b128 a[164:167], v6 offset:20480
M v[68:71], a[100:103], a[172:175], v[68:71]
 ds_read_b64_tr_b16 a[52:53], v22 offset:8192
 ds_read_b64_tr_b16 a[54:55], v22 offset:9216
M v[76:79], a[108:111], a[172:175], v[76:79]
M v[76:79], a[104:107], a[168:171], v[76:79]
 s_add_u32 m0, s24, 0
 ds_read_b64_tr_b16 a[56:57], v23 offset:0
 ds_read_b64_tr_b16 a[58:59], v23 offset:1024
M v[84:87], a[112:115], a[168:171], v[84:87]
 buffer_load_dwordx4 v16, s[56:59], s29 offen offset:0   lds
M v[84:87], a[116:119], a[172:175], v[84:87]
M v[92:95], a[124:127], a[172:175], v[92:95]
 ds_read_b64_tr_b16 a[60:61], v23 offset:8192
 ds_read_b64_tr_b16 a[62:63], v23 offset:9216
M v[92:95], a[120:123], a[168:171], v[92:95]
M v[100:103], a[128:131], a[168:171], v[100:103]
M v[100:103], a[132:135], a[172:175], v[100:103]
 buffer_load_dwordx4 v17, s[56:59], s29 offen offset:1024   lds
M v[108:111], a[140:143], a[172:175], v[108:111]
M v[108:111], a[136:139], a[168:171], v[108:111]
M v[116:119], a[144:147], a[168:171], v[116:119]
M v[116:119], a[148:151], a[172:175], v[116:119]
 s_waitcnt lgkmcnt(6)
M v[124:127], a[156:159], a[172:175], v[124:127]
 s_waitcnt vmcnt(25) lgkmcnt(0)
 buffer_load_dwordx4 v18, s[56:59], s29 offen offset:2048   lds
M v[124:127], a[152:155], a[168:171], v[124:127]
 s_barrier
M v[132:135], a[96:99], a[160:163], v[132:135]
 ds_read_b128 a[168:171], v5 offset:22528
 ds_read_b128 a[172:175], v6 offset:22528
M v[132:135], a[100:103], a[164:167], v[132:135]
 ds_read_b64_tr_b16 a[64:65], v20 offset:16384
 ds_read_b64_tr_b16 a[66:67], v20 offset:17408
M v[140:143], a[108:111], a[164:167], v[140:143]
M v[140:143], a[104:107], a[160:163], v[140:143]
 buffer_load_dwordx4 v19, s[56:59], s29 offen offset:3072   lds
M v[148:151], a[112:115], a[160:163], v[148:151]
 s_add_u32 s29, s29, 128
 ds_read_b64_tr_b16 a[68:69], v20 offset:24576
 ds_read_b64_tr_b16 a[70:71], v20 offset:25600
M v[148:151], a[116:119], a[164:167], v[148:151]
 buffer_store_dwordx4 a[28:31], v7, s[8:11], s3 offen offset:3072 sc1
M v[156:159], a[124:127], a[164:167], v[156:159]
M v[156:159], a[120:123], a[160:163], v[156:159]
 s_add_u32 m0, s23, 131072
 ds_read_b64_tr_b16 a[72:73], v21 offset:16384
 ds_read_b64_tr_b16 a[74:75], v21 offset:17408
M v[164:167], a[128:131], a[160:163], v[164:167]
 buffer_load_dwordx4 v8, s[52:55], s28 offen offset:0   lds
M v[164:167], a[132:135], a[164:167], v[164:167]
M v[172:175], a[140:143], a[164:167], v[172:175]
 ds_read_b64_tr_b16 a[76:77], v21 offset:24576
 ds_read_b64_tr_b16 a[78:79], v21 offset:25600
M v[172:175], a[136:139], a[160:163], v[172:175]
M v[180:183], a[144:147], a[160:163], v[180:183]
M v[180:183], a[148:151], a[164:167], v[180:183]
 s_waitcnt lgkmcnt(8)
 ds_read_b64_tr_b16 a[80:81], v22 offset:16384
 ds_read_b64_tr_b16 a[82:83], v22 offset:17408
M v[188:191], a[156:159], a[164:167], v[188:191]
 buffer_load_dwordx4 v9, s[52:55], s28 offen offset:1024   lds
M v[188:191], a[152:155], a[160:163], v[188:191]
M v[196:199], a[96:99], a[168:171], v[196:199]
 ds_read_b128 a[160:163], v5 offset:32768
 ds_read_b128 a[164:167], v6 offset:32768
M v[196:199], a[100:103], a[172:175], v[196:199]
 ds_read_b64_tr_b16 a[84:85], v22 offset:24576
 ds_read_b64_tr_b16 a[86:87], v22 offset:25600
M v[204:207], a[108:111], a[172:175], v[204:207]
 buffer_load_dwordx4 v10, s[52:55], s28 offen offset:2048   lds
M v[204:207], a[104:107], a[168:171], v[204:207]
 ds_read_b64_tr_b16 a[88:89], v23 offset:16384
 ds_read_b64_tr_b16 a[90:91], v23 offset:17408
M v[212:215], a[112:115], a[168:171], v[212:215]
M v[212:215], a[116:119], a[172:175], v[212:215]
M v[220:223], a[124:127], a[172:175], v[220:223]
 ds_read_b64_tr_b16 a[92:93], v23 offset:24576
 ds_read_b64_tr_b16 a[94:95], v23 offset:25600
M v[220:223], a[120:123], a[168:171], v[220:223]
 buffer_load_dwordx4 v11, s[52:55], s28 offen offset:3072   lds
M v[228:231], a[128:131], a[168:171], v[228:231]
 s_add_u32 s28, s28, 128
M v[228:231], a[132:135], a[172:175], v[228:231]
M v[236:239], a[140:143], a[172:175], v[236:239]
M v[236:239], a[136:139], a[168:171], v[236:239]
M v[244:247], a[144:147], a[168:171], v[244:247]
M v[244:247], a[148:151], a[172:175], v[244:247]
 s_waitcnt lgkmcnt(6)
M v[252:255], a[156:159], a[172:175], v[252:255]
 s_waitcnt vmcnt(28) lgkmcnt(0)
M v[252:255], a[152:155], a[168:171], v[252:255]
 s_barrier
M v[32:35], a[32:35], a[160:163], v[32:35]
 s_add_u32 m0, s23, 147456
 ds_read_b128 a[168:171], v5 offset:34816
 ds_read_b128 a[172:175], v6 offset:34816
M v[32:35], a[36:39], a[164:167], v[32:35]
 ds_read_b64_tr_b16 a[96:97], v1 offset:0
 ds_read_b64_tr_b16 a[98:99], v1 offset:1024
M v[36:39], a[44:47], a[164:167], v[36:39]
 buffer_load_dwordx4 v8, s[52:55], s28 offen offset:0   lds
M v[36:39], a[40:43], a[160:163], v[36:39]
M v[40:43], a[48:51], a[160:163], v[40:43]
 ds_read_b64_tr_b16 a[100:101], v1 offset:8192
 ds_read_b64_tr_b16 a[102:103], v1 offset:9216
M v[40:43], a[52:55], a[164:167], v[40:43]
 buffer_load_dwordx4 v9, s[52:55], s28 offen offset:1024   lds
M v[44:47], a[60:63], a[164:167], v[44:47]
M v[44:47], a[56:59], a[160:163], v[44:47]
 ds_read_b64_tr_b16 a[104:105], v2 offset:0
 ds_read_b64_tr_b16 a[106:107], v2 offset:1024
M v[48:51], a[64:67], a[160:163], v[48:51]
M v[48:51], a[68:71], a[164:167], v[48:51]
M v[52:55], a[76:79], a[164:167], v[52:55]
 ds_read_b64_tr_b16 a[108:109], v2 offset:8192
 ds_read_b64_tr_b16 a[110:111], v2 offset:9216
M v[52:55], a[72:75], a[160:163], v[52:55]
 buffer_load_dwordx4 v10, s[52:55], s28 offen offset:2048   lds
M v[56:59], a[80:83], a[160:163], v[56:59]
M v[56:59], a[84:87], a[164:167], v[56:59]
 s_waitcnt lgkmcnt(8)
 ds_read_b64_tr_b16 a[112:113], v3 offset:0
 ds_read_b64_tr_b16 a[114:115], v3 offset:1024
M v[60:63], a[92:95], a[164:167], v[60:63]
M v[60:63], a[88:91], a[160:163], v[60:63]
 buffer_load_dwordx4 v11, s[52:55], s28 offen offset:3072   lds
M v[68:71], a[32:35], a[168:171], v[68:71]
 s_add_u32 s28, s28, 524160
 ds_read_b128 a[160:163], v5 offset:36864
 ds_read_b128 a[164:167], v6 offset:36864
M v[68:71], a[36:39], a[172:175], v[68:71]
 ds_read_b64_tr_b16 a[116:117], v3 offset:8192
 ds_read_b64_tr_b16 a[118:119], v3 offset:9216
M v[76:79], a[44:47], a[172:175], v[76:79]
M v[76:79], a[40:43], a[168:171], v[76:79]
 s_add_u32 m0, s24, 16384
 ds_read_b64_tr_b16 a[120:121], v4 offset:0
 ds_read_b64_tr_b16 a[122:123], v4 offset:1024
M v[84:87], a[48:51], a[168:171], v[84:87]
 buffer_load_dwordx4 v16, s[56:59], s29 offen offset:0   lds
M v[84:87], a[52:55], a[172:175], v[84:87]
M v[92:95], a[60:63], a[172:175], v[92:95]
 ds_read_b64_tr_b16 a[124:125], v4 offset:8192
 ds_read_b64_tr_b16 a[126:127], v4 offset:9216
M v[92:95], a[56:59], a[168:171], v[92:95]
M v[100:103], a[64:67], a[168:171], v[100:103]
M v[100:103], a[68:71], a[172:175], v[100:103]
 buffer_load_dwordx4 v17, s[56:59], s29 offen offset:1024   lds
M v[108:111], a[76:79], a[172:175], v[108:111]
M v[108:111], a[72:75], a[168:171], v[108:111]
M v[116:119], a[80:83], a[168:171], v[116:119]
M v[116:119], a[84:87], a[172:175], v[116:119]
 s_waitcnt lgkmcnt(6)
M v[124:127], a[92:95], a[172:175], v[124:127]
 s_waitcnt vmcnt(25) lgkmcnt(0)
 buffer_load_dwordx4 v18, s[56:59], s29 offen offset:2048   lds
M v[124:127], a[88:91], a[168:171], v[124:127]
 s_barrier
M v[132:135], a[32:35], a[160:163], v[132:135]
 ds_read_b128 a[168:171], v5 offset:38912
 ds_read_b128 a[172:175], v6 offset:38912
M v[132:135], a[36:39], a[164:167], v[132:135]
 ds_read_b64_tr_b16 a[128:129], v1 offset:16384
 ds_read_b64_tr_b16 a[130:131], v1 offset:17408
M v[140:143], a[44:47], a[164:167], v[140:143]
M v[140:143], a[40:43], a[160:163], v[140:143]
 buffer_load_dwordx4 v19, s[56:59], s29 offen offset:3072   lds
M v[148:151], a[48:51], a[160:163], v[148:151]
 s_add_u32 s29, s29, 128
 ds_read_b64_tr_b16 a[132:133], v1 offset:24576
 ds_read_b64_tr_b16 a[134:135], v1 offset:25600
M v[148:151], a[52:55], a[164:167], v[148:151]
M v[156:159], a[60:63], a[164:167], v[156:159]
M v[156:159], a[56:59], a[160:163], v[156:159]
 s_add_u32 m0, s23, 0
 ds_read_b64_tr_b16 a[136:137], v2 offset:16384
 ds_read_b64_tr_b16 a[138:139], v2 offset:17408
M v[164:167], a[64:67], a[160:163], v[164:167]
 buffer_load_dwordx4 v8, s[52:55], s28 offen offset:0   lds
M v[164:167], a[68:71], a[164:167], v[164:167]
M v[172:175], a[76:79], a[164:167], v[172:175]
 ds_read_b64_tr_b16 a[140:141], v2 offset:24576
 ds_read_b64_tr_b16 a[142:143], v2 offset:25600
M v[172:175], a[72:75], a[160:163], v[172:175]
M v[180:183], a[80:83], a[160:163], v[180:183]
M v[180:183], a[84:87], a[164:167], v[180:183]
 s_waitcnt lgkmcnt(8)
 ds_read_b64_tr_b16 a[144:145], v3 offset:16384
 ds_read_b64_tr_b16 a[146:147], v3 offset:17408
M v[188:191], a[92:95], a[164:167], v[188:191]
 buffer_load_dwordx4 v9, s[52:55], s28 offen offset:1024   lds
M v[188:191], a[88:91], a[160:163], v[188:191]
M v[196:199], a[32:35], a[168:171], v[196:199]
 ds_read_b128 a[160:163], v5 offset:49152
 ds_read_b128 a[164:167], v6 offset:49152
M v[196:199], a[36:39], a[172:175], v[196:199]
 ds_read_b64_tr_b16 a[148:149], v3 offset:24576
 ds_read_b64_tr_b16 a[150:151], v3 offset:25600
M v[204:207], a[44:47], a[172:175], v[204:207]
 buffer_load_dwordx4 v10, s[52:55], s28 offen offset:2048   lds
M v[204:207], a[40:43], a[168:171], v[204:207]
 ds_read_b64_tr_b16 a[152:153], v4 offset:16384
 ds_read_b64_tr_b16 a[154:155], v4 offset:17408
M v[212:215], a[48:51], a[168:171], v[212:215]
M v[212:215], a[52:55], a[172:175], v[212:215]
M v[220:223], a[60:63], a[172:175], v[220:223]
 ds_read_b64_tr_b16 a[156:157], v4 offset:24576
 ds_read_b64_tr_b16 a[158:159], v4 offset:25600
M v[220:223], a[56:59], a[168:171], v[220:223]
 buffer_load_dwordx4 v11, s[52:55], s28 offen offset:3072   lds
M v[228:231], a[64:67], a[168:171], v[228:231]
 s_add_u32 s28, s28, 128
M v[228:231], a[68:71], a[172:175], v[228:231]
M v[236:239], a[76:79], a[172:175], v[236:239]
M v[236:239], a[72:75], a[168:171], v[236:239]
M v[244:247], a[80:83], a[168:171], v[244:247]
M v[244:247], a[84:87], a[172:175], v[244:247]
 s_waitcnt lgkmcnt(6)
M v[252:255], a[92:95], a[172:175], v[252:255]
 s_waitcnt vmcnt(16) lgkmcnt(0)
M v[252:255], a[88:91], a[168:171], v[252:255]
 s_barrier
M v[32:35], a[96:99], a[160:163], v[32:35]
 s_add_u32 m0, s23, 16384
 ds_read_b128 a[168:171], v5 offset:51200
 ds_read_b128 a[172:175], v6 offset:51200
M v[32:35], a[100:103], a[164:167], v[32:35]
 ds_read_b64_tr_b16 a[32:33], v1 offset:32768
 ds_read_b64_tr_b16 a[34:35], v1 offset:33792
M v[36:39], a[108:111], a[164:167], v[36:39]
 buffer_load_dwordx4 v8, s[52:55], s28 offen offset:0   lds
M v[36:39], a[104:107], a[160:163], v[36:39]
 buffer_store_dword v12, v15, s[8:11], s45 offen sc1
M v[40:43], a[112:115], a[160:163], v[40:43]
 s_add_u32 s3, s93, 262144
 ds_read_b64_tr_b16 a[36:37], v1 offset:40960
 ds_read_b64_tr_b16 a[38:39], v1 offset:41984
M v[40:43], a[116:119], a[164:167], v[40:43]
 v_min_u32 v25, 15, v0
 v_lshlrev_b32 v25, 7, v25
M v[44:47], a[124:127], a[164:167], v[44:47]
 v_max_u32 v13, 1024, v25
M v[44:47], a[120:123], a[160:163], v[44:47]
 ds_read_b64_tr_b16 a[40:41], v2 offset:32768
 ds_read_b64_tr_b16 a[42:43], v2 offset:33792
M v[48:51], a[128:131], a[160:163], v[48:51]
 buffer_load_dwordx4 v9, s[52:55], s28 offen offset:1024   lds
M v[48:51], a[132:135], a[164:167], v[48:51]
 buffer_store_dwordx4 v[64:67], v7, s[8:11], s3 offen offset:0 sc1
M v[52:55], a[140:143], a[164:167], v[52:55]
 ds_read_b64_tr_b16 a[44:45], v2 offset:40960
 ds_read_b64_tr_b16 a[46:47], v2 offset:41984
M v[52:55], a[136:139], a[160:163], v[52:55]
M v[56:59], a[144:147], a[160:163], v[56:59]
M v[56:59], a[148:151], a[164:167], v[56:59]
 s_waitcnt lgkmcnt(8)
 ds_read_b64_tr_b16 a[48:49], v3 offset:32768
 ds_read_b64_tr_b16 a[50:51], v3 offset:33792
M v[60:63], a[156:159], a[164:167], v[60:63]
 buffer_load_dwordx4 v10, s[52:55], s28 offen offset:2048   lds
M v[60:63], a[152:155], a[160:163], v[60:63]
M v[68:71], a[96:99], a[168:171], v[68:71]
 ds_read_b128 a[160:163], v5 offset:53248
 ds_read_b128 a[164:167], v6 offset:53248
M v[68:71], a[100:103], a[172:175], v[68:71]
 ds_read_b64_tr_b16 a[52:53], v3 offset:40960
 ds_read_b64_tr_b16 a[54:55], v3 offset:41984
M v[76:79], a[108:111], a[172:175], v[76:79]
 buffer_store_dwordx4 v[72:75], v7, s[8:11], s3 offen offset:1024 sc1
M v[76:79], a[104:107], a[168:171], v[76:79]
 ds_read_b64_tr_b16 a[56:57], v4 offset:32768
 ds_read_b64_tr_b16 a[58:59], v4 offset:33792
M v[84:87], a[112:115], a[168:171], v[84:87]
M v[84:87], a[116:119], a[172:175], v[84:87]
 buffer_load_dwordx4 v11, s[52:55], s28 offen offset:3072   lds
M v[92:95], a[124:127], a[172:175], v[92:95]
 s_add_u32 s28, s28, 524160
 ds_read_b64_tr_b16 a[60:61], v4 offset:40960
 ds_read_b64_tr_b16 a[62:63], v4 offset:41984
M v[92:95], a[120:123], a[168:171], v[92:95]
M v[100:103], a[128:131], a[168:171], v[100:103]
M v[100:103], a[132:135], a[172:175], v[100:103]
M v[108:111], a[140:143], a[172:175], v[108:111]
M v[108:111], a[136:139], a[168:171], v[108:111]
M v[116:119], a[144:147], a[168:171], v[116:119]
M v[116:119], a[148:151], a[172:175], v[116:119]
 s_waitcnt lgkmcnt(6)
M v[124:127], a[156:159], a[172:175], v[124:127]
 s_waitcnt lgkmcnt(0)
M v[124:127], a[152:155], a[168:171], v[124:127]
 s_barrier
M v[132:135], a[96:99], a[160:163], v[132:135]
 ds_read_b128 a[168:171], v5 offset:55296
 ds_read_b128 a[172:175], v6 offset:55296
M v[132:135], a[100:103], a[164:167], v[132:135]
 ds_read_b64_tr_b16 a[64:65], v1 offset:49152
 ds_read_b64_tr_b16 a[66:67], v1 offset:50176
M v[140:143], a[108:111], a[164:167], v[140:143]
 buffer_store_dwordx4 v[80:83], v7, s[8:11], s3 offen offset:2048 sc1
M v[140:143], a[104:107], a[160:163], v[140:143]
M v[148:151], a[112:115], a[160:163], v[148:151]
 ds_read_b64_tr_b16 a[68:69], v1 offset:57344
 ds_read_b64_tr_b16 a[70:71], v1 offset:58368
M v[148:151], a[116:119], a[164:167], v[148:151]
M v[156:159], a[124:127], a[164:167], v[156:159]
M v[156:159], a[120:123], a[160:163], v[156:159]
 ds_read_b64_tr_b16 a[72:73], v2 offset:49152
 ds_read_b64_tr_b16 a[74:75], v2 offset:50176
M v[164:167], a[128:131], a[160:163], v[164:167]
M v[164:167], a[132:135], a[164:167], v[164:167]
M v[172:175], a[140:143], a[164:167], v[172:175]
 ds_read_b64_tr_b16 a[76:77], v2 offset:57344
 ds_read_b64_tr_b16 a[78:79], v2 offset:58368
M v[172:175], a[136:139], a[160:163], v[172:175]
M v[180:183], a[144:147], a[160:163], v[180:183]
M v[180:183], a[148:151], a[164:167], v[180:183]
 s_waitcnt lgkmcnt(8)
 ds_read_b64_tr_b16 a[80:81], v3 offset:49152
 ds_read_b64_tr_b16 a[82:83], v3 offset:50176
M v[188:191], a[156:159], a[164:167], v[188:191]
 buffer_store_dwordx4 v[88:91], v7, s[8:11], s3 offen offset:3072 sc1
M v[188:191], a[152:155], a[160:163], v[188:191]
M v[196:199], a[96:99], a[168:171], v[196:199]
 ds_read_b128 a[160:163], v5 offset:0
 ds_read_b128 a[164:167], v6 offset:0
M v[196:199], a[100:103], a[172:175], v[196:199]
 ds_read_b64_tr_b16 a[84:85], v3 offset:57344
 ds_read_b64_tr_b16 a[86:87], v3 offset:58368
M v[204:207], a[108:111], a[172:175], v[204:207]
M v[204:207], a[104:107], a[168:171], v[204:207]
 ds_read_b64_tr_b16 a[88:89], v4 offset:49152
 ds_read_b64_tr_b16 a[90:91], v4 offset:50176
M v[212:215], a[112:115], a[168:171], v[212:215]
M v[212:215], a[116:119], a[172:175], v[212:215]
M v[220:223], a[124:127], a[172:175], v[220:223]
 ds_read_b64_tr_b16 a[92:93], v4 offset:57344
 ds_read_b64_tr_b16 a[94:95], v4 offset:58368
M v[220:223], a[120:123], a[168:171], v[220:223]
M v[228:231], a[128:131], a[168:171], v[228:231]
M v[228:231], a[132:135], a[172:175], v[228:231]
M v[236:239], a[140:143], a[172:175], v[236:239]
M v[236:239], a[136:139], a[168:171], v[236:239]
M v[244:247], a[144:147], a[168:171], v[244:247]
M v[244:247], a[148:151], a[172:175], v[244:247]
 s_waitcnt lgkmcnt(6)
M v[252:255], a[156:159], a[172:175], v[252:255]
 s_waitcnt vmcnt(21) lgkmcnt(0)
M v[252:255], a[152:155], a[168:171], v[252:255]
 s_barrier
M v[32:35], a[32:35], a[160:163], v[32:35]
 s_add_u32 m0, s23, 32768
 ds_read_b128 a[168:171], v5 offset:2048
 ds_read_b128 a[172:175], v6 offset:2048
M v[32:35], a[36:39], a[164:167], v[32:35]
 ds_read_b64_tr_b16 a[96:97], v20 offset:0
 ds_read_b64_tr_b16 a[98:99], v20 offset:1024
M v[36:39], a[44:47], a[164:167], v[36:39]
 buffer_load_dwordx4 v16, s[56:59], s29 offen offset:0   lds
M v[36:39], a[40:43], a[160:163], v[36:39]
M v[40:43], a[48:51], a[160:163], v[40:43]
 s_add_u32 s3, s93, 270336
 ds_read_b64_tr_b16 a[100:101], v20 offset:8192
 ds_read_b64_tr_b16 a[102:103], v20 offset:9216
M v[40:43], a[52:55], a[164:167], v[40:43]
 buffer_load_dwordx4 v17, s[56:59], s29 offen offset:1024   lds
M v[44:47], a[60:63], a[164:167], v[44:47]
 buffer_store_dwordx4 v[96:99], v7, s[8:11], s3 offen offset:0 sc1
M v[44:47], a[56:59], a[160:163], v[44:47]
 ds_read_b64_tr_b16 a[104:105], v21 offset:0
 ds_read_b64_tr_b16 a[106:107], v21 offset:1024
M v[48:51], a[64:67], a[160:163], v[48:51]
M v[48:51], a[68:71], a[164:167], v[48:51]
 buffer_load_dwordx4 v18, s[56:59], s29 offen offset:2048   lds
M v[52:55], a[76:79], a[164:167], v[52:55]
 ds_read_b64_tr_b16 a[108:109], v21 offset:8192
 ds_read_b64_tr_b16 a[110:111], v21 offset:9216
M v[52:55], a[72:75], a[160:163], v[52:55]
M v[56:59], a[80:83], a[160:163], v[56:59]
M v[56:59], a[84:87], a[164:167], v[56:59]
 s_waitcnt lgkmcnt(8)
 ds_read_b64_tr_b16 a[112:113], v22 offset:0
 ds_read_b64_tr_b16 a[114:115], v22 offset:1024
M v[60:63], a[92:95], a[164:167], v[60:63]
 buffer_load_dwordx4 v19, s[56:59], s29 offen offset:3072   lds
M v[60:63], a[88:91], a[160:163], v[60:63]
 s_add_u32 s29, s29, 128
M v[68:71], a[32:35], a[168:171], v[68:71]
 ds_read_b128 a[160:163], v5 offset:4096
 ds_read_b128 a[164:167], v6 offset:4096
M v[68:71], a[36:39], a[172:175], v[68:71]
 ds_read_b64_tr_b16 a[116:117], v22 offset:8192
 ds_read_b64_tr_b16 a[118:119], v22 offset:9216
M v[76:79], a[44:47], a[172:175], v[76:79]
 s_lshl_b32 s28, s20, 13
 buffer_store_dwordx4 v[104:107], v7, s[8:11], s3 offen offset:1024 sc1
M v[76:79], a[40:43], a[168:171], v[76:79]
 s_lshl_b32 s21, s41, 20
 ds_read_b64_tr_b16 a[120:121], v23 offset:0
 ds_read_b64_tr_b16 a[122:123], v23 offset:1024
M v[84:87], a[48:51], a[168:171], v[84:87]
 s_mov_b32 s22, 0
M v[84:87], a[52:55], a[172:175], v[84:87]
 s_lshl_b32 s7, s41, 18
M v[92:95], a[60:63], a[172:175], v[92:95]
 s_add_u32 s7, s7, 100663296
 ds_read_b64_tr_b16 a[124:125], v23 offset:8192
 ds_read_b64_tr_b16 a[126:127], v23 offset:9216
M v[92:95], a[56:59], a[168:171], v[92:95]
 s_add_u32 s38, s7, 65536
M v[100:103], a[64:67], a[168:171], v[100:103]
 s_add_u32 s64, s42, 1
M v[100:103], a[68:71], a[172:175], v[100:103]
 s_min_u32 s64, s64, 10
M v[108:111], a[76:79], a[172:175], v[108:111]
 s_sub_u32 s27, s64, 3
 buffer_load_dword v24, v13, s[8:11], s46 offen sc1
M v[108:111], a[72:75], a[168:171], v[108:111]
 s_lshl_b32 s6, s64, 1
M v[116:119], a[80:83], a[168:171], v[116:119]
 s_sub_u32 s43, s6, 2
 s_lshl_b32 s64, s42, 16
 s_add_u32 s4, s21, s64
M v[116:119], a[84:87], a[172:175], v[116:119]
 s_waitcnt lgkmcnt(6)
 s_sub_u32 s26, 1114112, s64
 s_add_u32 s26, s26, s21
M v[124:127], a[92:95], a[172:175], v[124:127]
 s_waitcnt vmcnt(20) lgkmcnt(0)
 s_lshl_b32 s64, s42, 1
 s_sub_u32 s64, 32, s64
M v[124:127], a[88:91], a[168:171], v[124:127]
 s_barrier
M v[132:135], a[32:35], a[160:163], v[132:135]
 s_cmp_ge_u32 s42, 10
 ds_read_b128 a[168:171], v5 offset:6144
 ds_read_b128 a[172:175], v6 offset:6144
M v[132:135], a[36:39], a[164:167], v[132:135]
 s_cselect_b32 s25, s64, 32767
 ds_read_b64_tr_b16 a[128:129], v20 offset:16384
 ds_read_b64_tr_b16 a[130:131], v20 offset:17408
M v[140:143], a[44:47], a[164:167], v[140:143]
 s_mov_b32 s23, 0
 buffer_store_dwordx4 v[112:115], v7, s[8:11], s3 offen offset:2048 sc1
M v[140:143], a[40:43], a[160:163], v[140:143]
M v[148:151], a[48:51], a[160:163], v[148:151]
 ds_read_b64_tr_b16 a[132:133], v20 offset:24576
 ds_read_b64_tr_b16 a[134:135], v20 offset:25600
M v[148:151], a[52:55], a[164:167], v[148:151]
M v[156:159], a[60:63], a[164:167], v[156:159]
M v[156:159], a[56:59], a[160:163], v[156:159]
 ds_read_b64_tr_b16 a[136:137], v21 offset:16384
 ds_read_b64_tr_b16 a[138:139], v21 offset:17408
M v[164:167], a[64:67], a[160:163], v[164:167]
M v[164:167], a[68:71], a[164:167], v[164:167]
M v[172:175], a[76:79], a[164:167], v[172:175]
 ds_read_b64_tr_b16 a[140:141], v21 offset:24576
 ds_read_b64_tr_b16 a[142:143], v21 offset:25600
M v[172:175], a[72:75], a[160:163], v[172:175]
M v[180:183], a[80:83], a[160:163], v[180:183]
M v[180:183], a[84:87], a[164:167], v[180:183]
 s_waitcnt lgkmcnt(8)
 ds_read_b64_tr_b16 a[144:145], v22 offset:16384
 ds_read_b64_tr_b16 a[146:147], v22 offset:17408
M v[188:191], a[92:95], a[164:167], v[188:191]
 buffer_store_dwordx4 v[120:123], v7, s[8:11], s3 offen offset:3072 sc1
M v[188:191], a[88:91], a[160:163], v[188:191]
M v[196:199], a[32:35], a[168:171], v[196:199]
 ds_read_b128 a[160:163], v5 offset:16384
 ds_read_b128 a[164:167], v6 offset:16384
M v[196:199], a[36:39], a[172:175], v[196:199]
 ds_read_b64_tr_b16 a[148:149], v22 offset:24576
 ds_read_b64_tr_b16 a[150:151], v22 offset:25600
M v[204:207], a[44:47], a[172:175], v[204:207]
M v[204:207], a[40:43], a[168:171], v[204:207]
 ds_read_b64_tr_b16 a[152:153], v23 offset:16384
 ds_read_b64_tr_b16 a[154:155], v23 offset:17408
M v[212:215], a[48:51], a[168:171], v[212:215]
M v[212:215], a[52:55], a[172:175], v[212:215]
M v[220:223], a[60:63], a[172:175], v[220:223]
 ds_read_b64_tr_b16 a[156:157], v23 offset:24576
 ds_read_b64_tr_b16 a[158:159], v23 offset:25600
M v[220:223], a[56:59], a[168:171], v[220:223]
M v[228:231], a[64:67], a[168:171], v[228:231]
M v[228:231], a[68:71], a[172:175], v[228:231]
M v[236:239], a[76:79], a[172:175], v[236:239]
M v[236:239], a[72:75], a[168:171], v[236:239]
M v[244:247], a[80:83], a[168:171], v[244:247]
M v[244:247], a[84:87], a[172:175], v[244:247]
 s_waitcnt lgkmcnt(6)
M v[252:255], a[92:95], a[172:175], v[252:255]
 s_waitcnt vmcnt(18) lgkmcnt(0)
M v[252:255], a[88:91], a[168:171], v[252:255]
 s_barrier
M v[32:35], a[96:99], a[160:163], v[32:35]
 ds_read_b128 a[168:171], v5 offset:18432
 ds_read_b128 a[172:175], v6 offset:18432
M v[32:35], a[100:103], a[164:167], v[32:35]
 ds_read_b64_tr_b16 a[32:33], v1 offset:0
 ds_read_b64_tr_b16 a[34:35], v1 offset:1024
M v[36:39], a[108:111], a[164:167], v[36:39]
 v_add_u32 v10, s28, v7
 v_add_u32 v11, 0x1000, v10
M v[36:39], a[104:107], a[160:163], v[36:39]
 s_waitcnt vmcnt(2)
 v_cmp_eq_u32 vcc, 0, v24
 s_add_u32 s3, s93, 524288
M v[40:43], a[112:115], a[160:163], v[40:43]
 s_lshl_b32 s64, s20, 10
 ds_read_b64_tr_b16 a[36:37], v1 offset:8192
 ds_read_b64_tr_b16 a[38:39], v1 offset:9216
M v[40:43], a[116:119], a[164:167], v[40:43]
 s_cbranch_vccnz L_f1s14
L_f1r14:
M v[44:47], a[124:127], a[164:167], v[44:47]
 s_add_u32 m0, s28, 98304
 s_nop 0
 buffer_load_dwordx4 v10, s[8:11], s21 offen offset:0 sc1 lds
M v[44:47], a[120:123], a[160:163], v[44:47]
 ds_read_b64_tr_b16 a[40:41], v2 offset:0
 ds_read_b64_tr_b16 a[42:43], v2 offset:1024
M v[48:51], a[128:131], a[160:163], v[48:51]
 buffer_store_dwordx4 v[128:131], v7, s[8:11], s3 offen offset:0 sc1
M v[48:51], a[132:135], a[164:167], v[48:51]
M v[52:55], a[140:143], a[164:167], v[52:55]
 ds_read_b64_tr_b16 a[44:45], v2 offset:8192
 ds_read_b64_tr_b16 a[46:47], v2 offset:9216
M v[52:55], a[136:139], a[160:163], v[52:55]
 buffer_load_dwordx4 v10, s[8:11], s21 offen offset:1024 sc1 lds
M v[56:59], a[144:147], a[160:163], v[56:59]
M v[56:59], a[148:151], a[164:167], v[56:59]
 s_waitcnt lgkmcnt(8)
 ds_read_b64_tr_b16 a[48:49], v3 offset:0
 ds_read_b64_tr_b16 a[50:51], v3 offset:1024
M v[60:63], a[156:159], a[164:167], v[60:63]
M v[60:63], a[152:155], a[160:163], v[60:63]
 buffer_load_dwordx4 v10, s[8:11], s21 offen offset:2048 sc1 lds
M v[68:71], a[96:99], a[168:171], v[68:71]
 ds_read_b128 a[160:163], v5 offset:20480
 ds_read_b128 a[164:167], v6 offset:20480
M v[68:71], a[100:103], a[172:175], v[68:71]
 ds_read_b64_tr_b16 a[52:53], v3 offset:8192
 ds_read_b64_tr_b16 a[54:55], v3 offset:9216
M v[76:79], a[108:111], a[172:175], v[76:79]
 buffer_store_dwordx4 v[136:139], v7, s[8:11], s3 offen offset:1024 sc1
M v[76:79], a[104:107], a[168:171], v[76:79]
 ds_read_b64_tr_b16 a[56:57], v4 offset:0
 ds_read_b64_tr_b16 a[58:59], v4 offset:1024
M v[84:87], a[112:115], a[168:171], v[84:87]
 buffer_load_dwordx4 v10, s[8:11], s21 offen offset:3072 sc1 lds
M v[84:87], a[116:119], a[172:175], v[84:87]
 s_add_u32 m0, s28, 102400
M v[92:95], a[124:127], a[172:175], v[92:95]
 ds_read_b64_tr_b16 a[60:61], v4 offset:8192
 ds_read_b64_tr_b16 a[62:63], v4 offset:9216
M v[92:95], a[120:123], a[168:171], v[92:95]
M v[100:103], a[128:131], a[168:171], v[100:103]
 buffer_load_dwordx4 v11, s[8:11], s21 offen offset:0 sc1 lds
M v[100:103], a[132:135], a[172:175], v[100:103]
M v[108:111], a[140:143], a[172:175], v[108:111]
M v[108:111], a[136:139], a[168:171], v[108:111]
M v[116:119], a[144:147], a[168:171], v[116:119]
 buffer_load_dwordx4 v11, s[8:11], s21 offen offset:1024 sc1 lds
M v[116:119], a[148:151], a[172:175], v[116:119]
 s_waitcnt lgkmcnt(6)
M v[124:127], a[156:159], a[172:175], v[124:127]
 s_waitcnt lgkmcnt(0)
 buffer_load_dwordx4 v11, s[8:11], s21 offen offset:2048 sc1 lds
M v[124:127], a[152:155], a[168:171], v[124:127]
 s_barrier
M v[132:135], a[96:99], a[160:163], v[132:135]
 ds_read_b128 a[168:171], v5 offset:22528
 ds_read_b128 a[172:175], v6 offset:22528
M v[132:135], a[100:103], a[164:167], v[132:135]
 ds_read_b64_tr_b16 a[64:65], v1 offset:16384
 ds_read_b64_tr_b16 a[66:67], v1 offset:17408
M v[140:143], a[108:111], a[164:167], v[140:143]
 buffer_load_dwordx4 v11, s[8:11], s21 offen offset:3072 sc1 lds
M v[140:143], a[104:107], a[160:163], v[140:143]
 s_add_u32 s24, s23, 16777216
 buffer_store_dwordx4 v[144:147], v7, s[8:11], s3 offen offset:2048 sc1
M v[148:151], a[112:115], a[160:163], v[148:151]
 s_mov_b32 s23, s21
 ds_read_b64_tr_b16 a[68:69], v1 offset:24576
 ds_read_b64_tr_b16 a[70:71], v1 offset:25600
M v[148:151], a[116:119], a[164:167], v[148:151]
 s_add_u32 s21, s21, 32768
M v[156:159], a[124:127], a[164:167], v[156:159]
 s_add_u32 s22, s22, 1
M v[156:159], a[120:123], a[160:163], v[156:159]
 s_cmp_eq_u32 s22, s25
 ds_read_b64_tr_b16 a[72:73], v2 offset:16384
 ds_read_b64_tr_b16 a[74:75], v2 offset:17408
M v[164:167], a[128:131], a[160:163], v[164:167]
 s_cselect_b32 s21, s26, s21
 v_subrev_u32 v5, 0x10000, v5
 v_subrev_u32 v6, 0x10000, v6
M v[164:167], a[132:135], a[164:167], v[164:167]
 s_cmp_eq_u32 s22, s43
M v[172:175], a[140:143], a[164:167], v[172:175]
 s_cselect_b32 s21, s4, s21
 ds_read_b64_tr_b16 a[76:77], v2 offset:24576
 ds_read_b64_tr_b16 a[78:79], v2 offset:25600
M v[172:175], a[136:139], a[160:163], v[172:175]
 s_cmp_eq_u32 s22, s6
M v[180:183], a[144:147], a[160:163], v[180:183]
 s_cselect_b32 s21, s7, s21
 v_mov_b32 v9, v25
 v_lshrrev_b32 v24, 4, v0
M v[180:183], a[148:151], a[164:167], v[180:183]
 s_waitcnt lgkmcnt(8)
 ds_read_b64_tr_b16 a[80:81], v3 offset:16384
 ds_read_b64_tr_b16 a[82:83], v3 offset:17408
M v[188:191], a[156:159], a[164:167], v[188:191]
 v_lshlrev_b32 v24, 2, v24
 v_and_b32 v25, 15, v0
M v[188:191], a[152:155], a[160:163], v[188:191]
 v_sub_u32 v24, v24, v25
M v[196:199], a[96:99], a[168:171], v[196:199]
 s_add_u32 s64, s64, s34
 ds_read_b128 a[160:163], v5 offset:32768
 ds_read_b128 a[164:167], v6 offset:32768
M v[196:199], a[100:103], a[172:175], v[196:199]
 s_add_u32 s52, s64, 65536
 ds_read_b64_tr_b16 a[84:85], v3 offset:24576
 ds_read_b64_tr_b16 a[86:87], v3 offset:25600
M v[204:207], a[108:111], a[172:175], v[204:207]
 s_mov_b32 s55, 0x21800000
 buffer_store_dwordx4 v[152:155], v7, s[8:11], s3 offen offset:3072 sc1
M v[204:207], a[104:107], a[168:171], v[204:207]
 s_and_b32 s65, s39, 0xf000000
 ds_read_b64_tr_b16 a[88:89], v4 offset:16384
 ds_read_b64_tr_b16 a[90:91], v4 offset:17408
M v[212:215], a[112:115], a[168:171], v[212:215]
 s_cmp_eq_u32 s20, 0
M v[212:215], a[116:119], a[172:175], v[212:215]
 s_cselect_b32 s54, s39, s65
M v[220:223], a[124:127], a[172:175], v[220:223]
 s_lshr_b32 s64, s20, 1
 ds_read_b64_tr_b16 a[92:93], v4 offset:24576
 ds_read_b64_tr_b16 a[94:95], v4 offset:25600
M v[220:223], a[120:123], a[168:171], v[220:223]
 s_lshl_b32 s64, s64, 17
M v[228:231], a[128:131], a[168:171], v[228:231]
 s_and_b32 s65, s20, 1
M v[228:231], a[132:135], a[172:175], v[228:231]
 s_lshl_b32 s65, s65, 12
M v[236:239], a[140:143], a[172:175], v[236:239]
 s_add_u32 s64, s64, s65
 v_add_u32 v14, s64, v7
 v_mov_b32 v8, 0xff800000
M v[236:239], a[136:139], a[168:171], v[236:239]
 v_cmp_lt_i32 s[16:17], 0, v24
 v_cmp_lt_i32 s[18:19], -1, v24
M v[244:247], a[144:147], a[168:171], v[244:247]
 v_cmp_lt_i32 s[48:49], -2, v24
 v_cmp_lt_i32 s[50:51], -3, v24
M v[244:247], a[148:151], a[172:175], v[244:247]
 s_waitcnt lgkmcnt(6)
M v[252:255], a[156:159], a[172:175], v[252:255]
 s_waitcnt lgkmcnt(0)
M v[252:255], a[152:155], a[168:171], v[252:255]
 s_barrier
M v[32:35], a[32:35], a[160:163], v[32:35]
 ds_read_b128 a[168:171], v5 offset:34816
 ds_read_b128 a[172:175], v6 offset:34816
M v[32:35], a[36:39], a[164:167], v[32:35]
 buffer_load_dword v24, v9, s[8:11], s46 offen sc1
M v[36:39], a[44:47], a[164:167], v[36:39]
 v_mov_b32 v1, v15
 v_add_u32 v2, 0x10000, v7
M v[36:39], a[40:43], a[160:163], v[36:39]
 v_mov_b32 v3, v10
 v_mov_b32 v4, v11
M v[40:43], a[48:51], a[160:163], v[40:43]
 s_mov_b64 s[60:61], s[76:77]
M v[40:43], a[52:55], a[164:167], v[40:43]
 s_mov_b32 s62, s78
M v[44:47], a[60:63], a[164:167], v[44:47]
 s_mov_b32 s63, 0x20000
 v_lshl_add_u32 v10, v0, 7, s95
 v_and_b32 v0, 48, v0
M v[44:47], a[56:59], a[160:163], v[44:47]
 v_lshl_add_u32 v0, v0, 24, v10
 v_mul_f32 v32, s5, v32
M v[48:51], a[64:67], a[160:163], v[48:51]
 v_mul_f32 v33, s5, v33
 v_mul_f32 v34, s5, v34
M v[48:51], a[68:71], a[164:167], v[48:51]
 v_mul_f32 v35, s5, v35
 v_mul_f32 v36, s5, v36
M v[52:55], a[76:79], a[164:167], v[52:55]
 v_mul_f32 v37, s5, v37
 v_mul_f32 v38, s5, v38
M v[52:55], a[72:75], a[160:163], v[52:55]
 v_mul_f32 v39, s5, v39
 v_cvt_pk_bf16_f32 v32, v32, v33
M v[56:59], a[80:83], a[160:163], v[56:59]
 v_cvt_pk_bf16_f32 v33, v34, v35
 v_cvt_pk_bf16_f32 v34, v36, v37
M v[56:59], a[84:87], a[164:167], v[56:59]
 s_waitcnt lgkmcnt(0)
 v_cvt_pk_bf16_f32 v35, v38, v39
 ds_write_b128 v14, v[32:35] offset:0
M v[60:63], a[92:95], a[164:167], v[60:63]
 s_add_u32 s3, s93, 532480
 buffer_store_dwordx4 v[160:163], v7, s[8:11], s3 offen offset:0 sc1
M v[60:63], a[88:91], a[160:163], v[60:63]
 v_mul_f32 v40, s5, v40
 v_mul_f32 v41, s5, v41
M v[68:71], a[32:35], a[168:171], v[68:71]
 ds_read_b128 a[160:163], v5 offset:36864
 ds_read_b128 a[164:167], v6 offset:36864
M v[68:71], a[36:39], a[172:175], v[68:71]
 v_mul_f32 v42, s5, v42
 v_mul_f32 v43, s5, v43
M v[76:79], a[44:47], a[172:175], v[76:79]
 v_mul_f32 v44, s5, v44
 v_mul_f32 v45, s5, v45
M v[76:79], a[40:43], a[168:171], v[76:79]
 v_mul_f32 v46, s5, v46
 v_mul_f32 v47, s5, v47
M v[84:87], a[48:51], a[168:171], v[84:87]
 v_cvt_pk_bf16_f32 v40, v40, v41
 v_cvt_pk_bf16_f32 v41, v42, v43
M v[84:87], a[52:55], a[172:175], v[84:87]
 v_cvt_pk_bf16_f32 v42, v44, v45
 v_cvt_pk_bf16_f32 v43, v46, v47
M v[92:95], a[60:63], a[172:175], v[92:95]
 ds_write_b128 v14, v[40:43] offset:1024
M v[92:95], a[56:59], a[168:171], v[92:95]
 buffer_store_dwordx4 v[168:171], v7, s[8:11], s3 offen offset:1024 sc1
M v[100:103], a[64:67], a[168:171], v[100:103]
 v_mul_f32 v48, s5, v48
 v_mul_f32 v49, s5, v49
M v[100:103], a[68:71], a[172:175], v[100:103]
 v_mul_f32 v50, s5, v50
 v_mul_f32 v51, s5, v51
M v[108:111], a[76:79], a[172:175], v[108:111]
 v_mul_f32 v52, s5, v52
 v_mul_f32 v53, s5, v53
M v[108:111], a[72:75], a[168:171], v[108:111]
 v_mul_f32 v54, s5, v54
 v_mul_f32 v55, s5, v55
M v[116:119], a[80:83], a[168:171], v[116:119]
 v_cvt_pk_bf16_f32 v48, v48, v49
 v_cvt_pk_bf16_f32 v49, v50, v51
M v[116:119], a[84:87], a[172:175], v[116:119]
 s_waitcnt lgkmcnt(1)
 v_cvt_pk_bf16_f32 v50, v52, v53
 v_cvt_pk_bf16_f32 v51, v54, v55
M v[124:127], a[92:95], a[172:175], v[124:127]
 ds_write_b128 v14, v[48:51] offset:2048
M v[124:127], a[88:91], a[168:171], v[124:127]
 buffer_store_dwordx4 v[176:179], v7, s[8:11], s3 offen offset:2048 sc1
M v[132:135], a[32:35], a[160:163], v[132:135]
 ds_read_b128 a[168:171], v5 offset:38912
 ds_read_b128 a[172:175], v6 offset:38912
M v[132:135], a[36:39], a[164:167], v[132:135]
 v_mul_f32 v56, s5, v56
 v_mul_f32 v57, s5, v57
M v[140:143], a[44:47], a[164:167], v[140:143]
 v_mul_f32 v58, s5, v58
 v_mul_f32 v59, s5, v59
M v[140:143], a[40:43], a[160:163], v[140:143]
 v_mul_f32 v60, s5, v60
 v_mul_f32 v61, s5, v61
M v[148:151], a[48:51], a[160:163], v[148:151]
 v_mul_f32 v62, s5, v62
 v_mul_f32 v63, s5, v63
M v[148:151], a[52:55], a[164:167], v[148:151]
 v_cvt_pk_bf16_f32 v56, v56, v57
 v_cvt_pk_bf16_f32 v57, v58, v59
M v[156:159], a[60:63], a[164:167], v[156:159]
 v_cvt_pk_bf16_f32 v58, v60, v61
 v_cvt_pk_bf16_f32 v59, v62, v63
M v[156:159], a[56:59], a[160:163], v[156:159]
 s_waitcnt lgkmcnt(0)
 ds_write_b128 v14, v[56:59] offset:3072
M v[164:167], a[64:67], a[160:163], v[164:167]
 s_barrier
M v[164:167], a[68:71], a[164:167], v[164:167]
M v[172:175], a[76:79], a[164:167], v[172:175]
 s_add_u32 m0, s28, 32768
 s_nop 0
 buffer_load_dwordx4 v3, s[8:11], s21 offen offset:0 sc1 lds
M v[172:175], a[72:75], a[160:163], v[172:175]
M v[180:183], a[80:83], a[160:163], v[180:183]
 buffer_store_dwordx4 v[184:187], v7, s[8:11], s3 offen offset:3072 sc1
M v[180:183], a[84:87], a[164:167], v[180:183]
 v_mul_f32 v68, s5, v68
 v_mul_f32 v69, s5, v69
M v[188:191], a[92:95], a[164:167], v[188:191]
 buffer_load_dwordx4 v3, s[8:11], s21 offen offset:1024 sc1 lds
M v[188:191], a[88:91], a[160:163], v[188:191]
 v_mul_f32 v70, s5, v70
 v_mul_f32 v71, s5, v71
M v[196:199], a[32:35], a[168:171], v[196:199]
 v_mul_f32 v76, s5, v76
 v_mul_f32 v77, s5, v77
M v[196:199], a[36:39], a[172:175], v[196:199]
 v_mul_f32 v78, s5, v78
 v_mul_f32 v79, s5, v79
M v[204:207], a[44:47], a[172:175], v[204:207]
 buffer_load_dwordx4 v3, s[8:11], s21 offen offset:2048 sc1 lds
M v[204:207], a[40:43], a[168:171], v[204:207]
 v_cvt_pk_bf16_f32 v68, v68, v69
 v_cvt_pk_bf16_f32 v69, v70, v71
M v[212:215], a[48:51], a[168:171], v[212:215]
 v_cvt_pk_bf16_f32 v70, v76, v77
 v_cvt_pk_bf16_f32 v71, v78, v79
M v[212:215], a[52:55], a[172:175], v[212:215]
 ds_write_b128 v14, v[68:71] offset:8192
 v_mul_f32 v84, s5, v84
M v[220:223], a[60:63], a[172:175], v[220:223]
 buffer_load_dwordx4 v3, s[8:11], s21 offen offset:3072 sc1 lds
M v[220:223], a[56:59], a[168:171], v[220:223]
 s_add_u32 m0, s28, 36864
 v_mul_f32 v85, s5, v85
 v_mul_f32 v86, s5, v86
M v[228:231], a[64:67], a[168:171], v[228:231]
 v_mul_f32 v87, s5, v87
 v_mul_f32 v92, s5, v92
M v[228:231], a[68:71], a[172:175], v[228:231]
 v_mul_f32 v93, s5, v93
 v_mul_f32 v94, s5, v94
M v[236:239], a[76:79], a[172:175], v[236:239]
 buffer_load_dwordx4 v4, s[8:11], s21 offen offset:0 sc1 lds
M v[236:239], a[72:75], a[168:171], v[236:239]
 v_mul_f32 v95, s5, v95
 v_cvt_pk_bf16_f32 v84, v84, v85
M v[244:247], a[80:83], a[168:171], v[244:247]
 v_cvt_pk_bf16_f32 v85, v86, v87
 v_cvt_pk_bf16_f32 v86, v92, v93
M v[244:247], a[84:87], a[172:175], v[244:247]
 v_cvt_pk_bf16_f32 v87, v94, v95
 ds_write_b128 v14, v[84:87] offset:9216
M v[252:255], a[92:95], a[172:175], v[252:255]
 buffer_load_dwordx4 v4, s[8:11], s21 offen offset:1024 sc1 lds
M v[252:255], a[88:91], a[168:171], v[252:255]
 buffer_load_dwordx4 v4, s[8:11], s21 offen offset:2048 sc1 lds
 buffer_load_dwordx4 v4, s[8:11], s21 offen offset:3072 sc1 lds
 s_add_u32 s24, s23, 16777216
 s_mov_b32 s23, s21
 s_add_u32 s21, s21, 32768
 s_add_u32 s22, s22, 1
 s_cmp_eq_u32 s22, s25
 s_cselect_b32 s21, s26, s21
 s_cmp_eq_u32 s22, s43
 s_cselect_b32 s21, s4, s21
 s_cmp_eq_u32 s22, s6
 s_cselect_b32 s21, s7, s21
 v_mul_f32 v100, s5, v100
 v_mul_f32 v101, s5, v101
 v_mul_f32 v102, s5, v102
 v_mul_f32 v103, s5, v103
 v_mul_f32 v108, s5, v108
 v_mul_f32 v109, s5, v109
 v_mul_f32 v110, s5, v110
 v_mul_f32 v111, s5, v111
 v_cvt_pk_bf16_f32 v100, v100, v101
 v_cvt_pk_bf16_f32 v101, v102, v103
 v_cvt_pk_bf16_f32 v102, v108, v109
 v_cvt_pk_bf16_f32 v103, v110, v111
 ds_write_b128 v14, v[100:103] offset:10240
 v_pk_mul_f32 v[116:117], v[116:117], s[4:5] op_sel:[0,1] op_sel_hi:[1,1]
 v_pk_mul_f32 v[118:119], v[118:119], s[4:5] op_sel:[0,1] op_sel_hi:[1,1]
 v_pk_mul_f32 v[124:125], v[124:125], s[4:5] op_sel:[0,1] op_sel_hi:[1,1]
 v_pk_mul_f32 v[126:127], v[126:127], s[4:5] op_sel:[0,1] op_sel_hi:[1,1]
 v_cvt_pk_bf16_f32 v116, v116, v117
 v_cvt_pk_bf16_f32 v117, v118, v119
 v_cvt_pk_bf16_f32 v118, v124, v125
 v_cvt_pk_bf16_f32 v119, v126, v127
 ds_write_b128 v14, v[116:119] offset:11264
 v_pk_mul_f32 v[132:133], v[132:133], s[4:5] op_sel:[0,1] op_sel_hi:[1,1]
 v_pk_mul_f32 v[134:135], v[134:135], s[4:5] op_sel:[0,1] op_sel_hi:[1,1]
 v_pk_mul_f32 v[140:141], v[140:141], s[4:5] op_sel:[0,1] op_sel_hi:[1,1]
 v_pk_mul_f32 v[142:143], v[142:143], s[4:5] op_sel:[0,1] op_sel_hi:[1,1]
 v_cvt_pk_bf16_f32 v132, v132, v133
 v_cvt_pk_bf16_f32 v133, v134, v135
 v_cvt_pk_bf16_f32 v134, v140, v141
 v_cvt_pk_bf16_f32 v135, v142, v143
 ds_write_b128 v14, v[132:135] offset:16384
 v_pk_mul_f32 v[148:149], v[148:149], s[4:5] op_sel:[0,1] op_sel_hi:[1,1]
 v_pk_mul_f32 v[150:151], v[150:151], s[4:5] op_sel:[0,1] op_sel_hi:[1,1]
 v_pk_mul_f32 v[156:157], v[156:157], s[4:5] op_sel:[0,1] op_sel_hi:[1,1]
 v_pk_mul_f32 v[158:159], v[158:159], s[4:5] op_sel:[0,1] op_sel_hi:[1,1]
 v_cvt_pk_bf16_f32 v148, v148, v149
 v_cvt_pk_bf16_f32 v149, v150, v151
 v_cvt_pk_bf16_f32 v150, v156, v157
 v_cvt_pk_bf16_f32 v151, v158, v159
 ds_write_b128 v14, v[148:151] offset:17408
 v_pk_mul_f32 v[164:165], v[164:165], s[4:5] op_sel:[0,1] op_sel_hi:[1,1]
 v_pk_mul_f32 v[166:167], v[166:167], s[4:5] op_sel:[0,1] op_sel_hi:[1,1]
 v_pk_mul_f32 v[172:173], v[172:173], s[4:5] op_sel:[0,1] op_sel_hi:[1,1]
 v_pk_mul_f32 v[174:175], v[174:175], s[4:5] op_sel:[0,1] op_sel_hi:[1,1]
 v_cvt_pk_bf16_f32 v164, v164, v165
 v_cvt_pk_bf16_f32 v165, v166, v167
 v_cvt_pk_bf16_f32 v166, v172, v173
 v_cvt_pk_bf16_f32 v167, v174, v175
 ds_write_b128 v14, v[164:167] offset:18432
 v_pk_mul_f32 v[180:181], v[180:181], s[4:5] op_sel:[0,1] op_sel_hi:[1,1]
 v_pk_mul_f32 v[182:183], v[182:183], s[4:5] op_sel:[0,1] op_sel_hi:[1,1]
 v_pk_mul_f32 v[188:189], v[188:189], s[4:5] op_sel:[0,1] op_sel_hi:[1,1]
 v_pk_mul_f32 v[190:191], v[190:191], s[4:5] op_sel:[0,1] op_sel_hi:[1,1]
 v_cvt_pk_bf16_f32 v180, v180, v181
 v_cvt_pk_bf16_f32 v181, v182, v183
 v_cvt_pk_bf16_f32 v182, v188, v189
 v_cvt_pk_bf16_f32 v183, v190, v191
 ds_write_b128 v14, v[180:183] offset:19456
 v_pk_mul_f32 v[196:197], v[196:197], s[4:5] op_sel:[0,1] op_sel_hi:[1,1]
 v_pk_mul_f32 v[198:199], v[198:199], s[4:5] op_sel:[0,1] op_sel_hi:[1,1]
 v_pk_mul_f32 v[204:205], v[204:205], s[4:5] op_sel:[0,1] op_sel_hi:[1,1]
 v_pk_mul_f32 v[206:207], v[206:207], s[4:5] op_sel:[0,1] op_sel_hi:[1,1]
 v_cvt_pk_bf16_f32 v196, v196, v197
 v_cvt_pk_bf16_f32 v197, v198, v199
 v_cvt_pk_bf16_f32 v198, v204, v205
 v_cvt_pk_bf16_f32 v199, v206, v207
 ds_write_b128 v14, v[196:199] offset:24576
 v_pk_mul_f32 v[212:213], v[212:213], s[4:5] op_sel:[0,1] op_sel_hi:[1,1]
 v_pk_mul_f32 v[214:215], v[214:215], s[4:5] op_sel:[0,1] op_sel_hi:[1,1]
 v_pk_mul_f32 v[220:221], v[220:221], s[4:5] op_sel:[0,1] op_sel_hi:[1,1]
 v_pk_mul_f32 v[222:223], v[222:223], s[4:5] op_sel:[0,1] op_sel_hi:[1,1]
 v_cvt_pk_bf16_f32 v212, v212, v213
 v_cvt_pk_bf16_f32 v213, v214, v215
 v_cvt_pk_bf16_f32 v214, v220, v221
 v_cvt_pk_bf16_f32 v215, v222, v223
 ds_write_b128 v14, v[212:215] offset:25600
 v_pk_mul_f32 v[228:229], v[228:229], s[4:5] op_sel:[0,1] op_sel_hi:[1,1]
 v_pk_mul_f32 v[230:231], v[230:231], s[4:5] op_sel:[0,1] op_sel_hi:[1,1]
 v_pk_mul_f32 v[236:237], v[236:237], s[4:5] op_sel:[0,1] op_sel_hi:[1,1]
 v_pk_mul_f32 v[238:239], v[238:239], s[4:5] op_sel:[0,1] op_sel_hi:[1,1]
 v_cvt_pk_bf16_f32 v228, v228, v229
 v_cvt_pk_bf16_f32 v229, v230, v231
 v_cvt_pk_bf16_f32 v230, v236, v237
 v_cvt_pk_bf16_f32 v231, v238, v239
 ds_write_b128 v14, v[228:231] offset:26624
 v_pk_mul_f32 v[244:245], v[244:245], s[4:5] op_sel:[0,1] op_sel_hi:[1,1]
 v_pk_mul_f32 v[246:247], v[246:247], s[4:5] op_sel:[0,1] op_sel_hi:[1,1]
 v_pk_mul_f32 v[252:253], v[252:253], s[4:5] op_sel:[0,1] op_sel_hi:[1,1]
 v_pk_mul_f32 v[254:255], v[254:255], s[4:5] op_sel:[0,1] op_sel_hi:[1,1]
 v_cvt_pk_bf16_f32 v244, v244, v245
 v_cvt_pk_bf16_f32 v245, v246, v247
 v_cvt_pk_bf16_f32 v246, v252, v253
 v_cvt_pk_bf16_f32 v247, v254, v255
 ds_write_b128 v14, v[244:247] offset:27648
 s_waitcnt vmcnt(15) lgkmcnt(0)
 s_barrier
 ds_read_b128 a[64:67], v2 offset:32768
 ds_read_b128 a[68:71], v2 offset:33792
 ds_read_b128 a[72:75], v2 offset:34816
 ds_read_b128 a[76:79], v2 offset:35840
 ds_read_b128 a[80:83], v2 offset:36864
 ds_read_b128 a[84:87], v2 offset:37888
 ds_read_b128 a[88:91], v2 offset:38912
 ds_read_b128 a[92:95], v2 offset:39936
 s_lshl_b32 s64, s20, 13
 s_sub_u32 s65, 155648, s64
 v_add_u32 v10, s64, v7
 v_add_u32 v11, s65, v7
 ds_read_b128 a[0:3], v10 offset:0
 ds_read_b128 a[4:7], v10 offset:1024
 ds_read_b128 a[8:11], v10 offset:2048
 ds_read_b128 a[12:15], v10 offset:3072
 ds_read_b128 a[16:19], v10 offset:4096
 ds_read_b128 a[20:23], v10 offset:5120
 ds_read_b128 a[24:27], v10 offset:6144
 ds_read_b128 a[28:31], v10 offset:7168
 ds_read_b128 a[32:35], v11 offset:0
 ds_read_b128 a[36:39], v11 offset:1024
 ds_read_b128 a[40:43], v11 offset:2048
 ds_read_b128 a[44:47], v11 offset:3072
 ds_read_b128 a[48:51], v11 offset:4096
 ds_read_b128 a[52:55], v11 offset:5120
 ds_read_b128 a[56:59], v11 offset:6144
 ds_read_b128 a[60:63], v11 offset:7168
 s_waitcnt vmcnt(12)
 v_cmp_eq_u32 vcc, 0, v24
 v_mov_b32 v17, 3
 v_or_b32 v6, s35, v7
 s_cbranch_vccnz L_f1s15
L_f1r15:
 s_mov_b32 s30, s93
 s_mov_b32 s29, s94
 s_cmp_eq_u32 s20, 0
 s_cselect_b32 s5, 5, 0
 v_mov_b32 v32, 0xc1800000
 v_mov_b32 v33, 0xc1800000
 v_mov_b32 v34, 0xc1800000
 v_mov_b32 v35, 0xc1800000
 v_mov_b32 v36, 0xc1800000
 v_mov_b32 v37, 0xc1800000
 v_mov_b32 v38, 0xc1800000
 v_mov_b32 v39, 0xc1800000
 s_waitcnt lgkmcnt(0)
M v[64:67], a[64:67], a[0:3], v[32:35]
 ds_read_b128 a[96:99], v2 offset:40960
 v_mov_b32 v30, 0
M v[64:67], a[68:71], a[4:7], v[64:67]
 s_add_u32 m0, s28, 65536
 ds_read_b128 a[100:103], v2 offset:41984
 v_mov_b32 v31, 0
M v[64:67], a[72:75], a[8:11], v[64:67]
 buffer_load_dwordx4 v3, s[8:11], s24 offen offset:0 sc1 lds
M v[64:67], a[76:79], a[12:15], v[64:67]
 ds_read_b128 a[104:107], v2 offset:43008
 v_accvgpr_write_b32 a128, v192
M v[64:67], a[80:83], a[16:19], v[64:67]
 ds_read_b128 a[108:111], v2 offset:44032
 v_accvgpr_write_b32 a129, v193
M v[64:67], a[84:87], a[20:23], v[64:67]
 buffer_load_dwordx4 v3, s[8:11], s24 offen offset:1024 sc1 lds
M v[64:67], a[88:91], a[24:27], v[64:67]
 ds_read_b128 a[112:115], v2 offset:45056
 v_accvgpr_write_b32 a130, v194
M v[64:67], a[92:95], a[28:31], v[64:67]
 ds_read_b128 a[116:119], v2 offset:46080
 v_accvgpr_write_b32 a131, v195
M v[68:71], a[92:95], a[60:63], v[36:39]
 v_accvgpr_write_b32 a132, v200
 v_accvgpr_write_b32 a133, v201
M v[68:71], a[88:91], a[56:59], v[68:71]
 ds_read_b128 a[120:123], v2 offset:47104
 v_accvgpr_write_b32 a134, v202
M v[68:71], a[84:87], a[52:55], v[68:71]
 ds_read_b128 a[124:127], v2 offset:48128
 v_accvgpr_write_b32 a135, v203
M v[68:71], a[80:83], a[48:51], v[68:71]
 buffer_load_dwordx4 v3, s[8:11], s24 offen offset:2048 sc1 lds
M v[68:71], a[76:79], a[44:47], v[68:71]
 v_accvgpr_write_b32 a136, v208
 v_accvgpr_write_b32 a137, v209
M v[68:71], a[72:75], a[40:43], v[68:71]
 v_accvgpr_write_b32 a138, v210
 v_accvgpr_write_b32 a139, v211
M v[68:71], a[68:71], a[36:39], v[68:71]
 v_exp_f32 v18, v64
M v[68:71], a[64:67], a[32:35], v[68:71]
 s_waitcnt lgkmcnt(0)
 v_exp_f32 v19, v65
M v[72:75], a[96:99], a[0:3], v[32:35]
 ds_read_b128 a[64:67], v2 offset:49152
 v_add_f32 v26, v18, v19
M v[72:75], a[100:103], a[4:7], v[72:75]
 ds_read_b128 a[68:71], v2 offset:50176
 v_cvt_pk_bf16_f32 v40, v18, v19
M v[72:75], a[104:107], a[8:11], v[72:75]
 buffer_load_dwordx4 v3, s[8:11], s24 offen offset:3072 sc1 lds
M v[72:75], a[108:111], a[12:15], v[72:75]
 ds_read_b128 a[72:75], v2 offset:51200
 v_accvgpr_write_b32 a140, v216
M v[72:75], a[112:115], a[16:19], v[72:75]
 s_add_u32 m0, s28, 69632
 ds_read_b128 a[76:79], v2 offset:52224
 v_accvgpr_write_b32 a141, v217
M v[72:75], a[116:119], a[20:23], v[72:75]
 buffer_load_dwordx4 v4, s[8:11], s24 offen offset:0 sc1 lds
M v[72:75], a[120:123], a[24:27], v[72:75]
 ds_read_b128 a[80:83], v2 offset:53248
 v_accvgpr_write_b32 a142, v218
M v[72:75], a[124:127], a[28:31], v[72:75]
 s_add_u32 s3, s32, 0
 ds_read_b128 a[84:87], v2 offset:54272
 v_accvgpr_write_b32 a143, v219
M v[76:79], a[124:127], a[60:63], v[36:39]
 buffer_store_dwordx4 a[0:3], v6, s[8:11], s3 offen offset:0 sc1
M v[76:79], a[120:123], a[56:59], v[76:79]
 ds_read_b128 a[88:91], v2 offset:55296
 v_accvgpr_write_b32 a144, v224
M v[76:79], a[116:119], a[52:55], v[76:79]
 ds_read_b128 a[92:95], v2 offset:56320
 v_accvgpr_write_b32 a145, v225
M v[76:79], a[112:115], a[48:51], v[76:79]
 buffer_load_dwordx4 v4, s[8:11], s24 offen offset:1024 sc1 lds
M v[76:79], a[108:111], a[44:47], v[76:79]
 v_exp_f32 v20, v66
M v[76:79], a[104:107], a[40:43], v[76:79]
 buffer_store_dwordx4 a[4:7], v6, s[8:11], s3 offen offset:1024 sc1
M v[76:79], a[100:103], a[36:39], v[76:79]
 v_exp_f32 v21, v67
M v[76:79], a[96:99], a[32:35], v[76:79]
 s_waitcnt lgkmcnt(0)
 v_exp_f32 v22, v68
M v[80:83], a[64:67], a[0:3], v[32:35]
 ds_read_b128 a[96:99], v2 offset:57344
 v_add_f32 v26, v20, v26
M v[80:83], a[68:71], a[4:7], v[80:83]
 ds_read_b128 a[100:103], v2 offset:58368
 v_cvt_pk_bf16_f32 v41, v20, v21
M v[80:83], a[72:75], a[8:11], v[80:83]
 buffer_load_dwordx4 v4, s[8:11], s24 offen offset:2048 sc1 lds
M v[80:83], a[76:79], a[12:15], v[80:83]
 ds_read_b128 a[104:107], v2 offset:59392
 v_add_f32 v26, v21, v26
M v[80:83], a[80:83], a[16:19], v[80:83]
 ds_read_b128 a[108:111], v2 offset:60416
 v_accvgpr_write_b32 a146, v226
M v[80:83], a[84:87], a[20:23], v[80:83]
 buffer_store_dwordx4 a[8:11], v6, s[8:11], s3 offen offset:2048 sc1
M v[80:83], a[88:91], a[24:27], v[80:83]
 ds_read_b128 a[112:115], v2 offset:61440
 v_accvgpr_write_b32 a147, v227
M v[80:83], a[92:95], a[28:31], v[80:83]
 ds_read_b128 a[116:119], v2 offset:62464
 v_accvgpr_write_b32 a148, v232
M v[84:87], a[92:95], a[60:63], v[36:39]
 buffer_load_dwordx4 v4, s[8:11], s24 offen offset:3072 sc1 lds
M v[84:87], a[88:91], a[56:59], v[84:87]
 ds_read_b128 a[120:123], v2 offset:63488
 v_accvgpr_write_b32 a149, v233
M v[84:87], a[84:87], a[52:55], v[84:87]
 ds_read_b128 a[124:127], v2 offset:64512
 v_accvgpr_write_b32 a150, v234
M v[84:87], a[80:83], a[48:51], v[84:87]
 buffer_store_dwordx4 a[12:15], v6, s[8:11], s3 offen offset:3072 sc1
M v[84:87], a[76:79], a[44:47], v[84:87]
 s_add_u32 s3, s32, 4096
 v_exp_f32 v23, v69
M v[84:87], a[72:75], a[40:43], v[84:87]
 buffer_store_dwordx4 a[16:19], v6, s[8:11], s3 offen offset:0 sc1
M v[84:87], a[68:71], a[36:39], v[84:87]
 s_waitcnt vmcnt(13) lgkmcnt(0)
 v_exp_f32 v24, v70
M v[84:87], a[64:67], a[32:35], v[84:87]
 s_barrier
M v[88:91], a[96:99], a[0:3], v[32:35]
 ds_read_b128 a[64:67], v7 offset:32768
 v_add_f32 v27, v22, v23
M v[88:91], a[100:103], a[4:7], v[88:91]
 ds_read_b128 a[68:71], v7 offset:33792
 v_cvt_pk_bf16_f32 v44, v22, v23
M v[88:91], a[104:107], a[8:11], v[88:91]
 buffer_store_dword v17, v1, s[8:11], s45 offen sc1
M v[88:91], a[108:111], a[12:15], v[88:91]
 ds_read_b128 a[72:75], v7 offset:34816
 v_accvgpr_write_b32 a151, v235
M v[88:91], a[112:115], a[16:19], v[88:91]
 ds_read_b128 a[76:79], v7 offset:35840
 v_accvgpr_write_b32 a152, v240
M v[88:91], a[116:119], a[20:23], v[88:91]
 buffer_store_dwordx4 a[20:23], v6, s[8:11], s3 offen offset:1024 sc1
M v[88:91], a[120:123], a[24:27], v[88:91]
 ds_read_b128 a[80:83], v7 offset:36864
 v_accvgpr_write_b32 a153, v241
M v[88:91], a[124:127], a[28:31], v[88:91]
 ds_read_b128 a[84:87], v7 offset:37888
 v_accvgpr_write_b32 a154, v242
M v[92:95], a[124:127], a[60:63], v[36:39]
 buffer_store_dwordx4 a[24:27], v6, s[8:11], s3 offen offset:2048 sc1
M v[92:95], a[120:123], a[56:59], v[92:95]
 ds_read_b128 a[88:91], v7 offset:38912
 v_accvgpr_write_b32 a155, v243
M v[92:95], a[116:119], a[52:55], v[92:95]
 ds_read_b128 a[92:95], v7 offset:39936
 v_accvgpr_write_b32 a156, v248
M v[92:95], a[112:115], a[48:51], v[92:95]
 buffer_store_dwordx4 a[28:31], v6, s[8:11], s3 offen offset:3072 sc1
M v[92:95], a[108:111], a[44:47], v[92:95]
 v_exp_f32 v25, v71
M v[92:95], a[104:107], a[40:43], v[92:95]
 v_exp_f32 v18, v72
M v[92:95], a[100:103], a[36:39], v[92:95]
 s_waitcnt lgkmcnt(0)
 v_exp_f32 v19, v73
M v[92:95], a[96:99], a[32:35], v[92:95]
 v_exp_f32 v20, v74
M v[96:99], a[64:67], a[0:3], v[32:35]
 s_add_u32 m0, s28, 98304
 ds_read_b128 a[96:99], v7 offset:40960
 ds_read_b128 a[100:103], v7 offset:41984
M v[96:99], a[68:71], a[4:7], v[96:99]
 buffer_load_dwordx4 v3, s[8:11], s21 offen offset:0 sc1 lds
M v[96:99], a[72:75], a[8:11], v[96:99]
 v_exp_f32 v21, v75
M v[96:99], a[76:79], a[12:15], v[96:99]
 s_add_u32 s3, s32, 8192
 ds_read_b128 a[104:107], v7 offset:43008
 ds_read_b128 a[108:111], v7 offset:44032
M v[96:99], a[80:83], a[16:19], v[96:99]
 buffer_store_dwordx4 a[32:35], v6, s[8:11], s3 offen offset:0 sc1
M v[96:99], a[84:87], a[20:23], v[96:99]
 v_exp_f32 v22, v76
M v[96:99], a[88:91], a[24:27], v[96:99]
 ds_read_b128 a[112:115], v7 offset:45056
 ds_read_b128 a[116:119], v7 offset:46080
M v[96:99], a[92:95], a[28:31], v[96:99]
 buffer_load_dwordx4 v3, s[8:11], s21 offen offset:1024 sc1 lds
M v[100:103], a[92:95], a[60:63], v[36:39]
 v_exp_f32 v23, v77
M v[100:103], a[88:91], a[56:59], v[100:103]
 ds_read_b128 a[120:123], v7 offset:47104
 ds_read_b128 a[124:127], v7 offset:48128
M v[100:103], a[84:87], a[52:55], v[100:103]
 buffer_store_dwordx4 a[36:39], v6, s[8:11], s3 offen offset:1024 sc1
M v[100:103], a[80:83], a[48:51], v[100:103]
 v_add_f32 v27, v24, v27
 v_cvt_pk_bf16_f32 v45, v24, v25
M v[100:103], a[76:79], a[44:47], v[100:103]
 buffer_load_dwordx4 v3, s[8:11], s21 offen offset:2048 sc1 lds
M v[100:103], a[72:75], a[40:43], v[100:103]
 v_add_f32 v27, v25, v27
 v_add_f32 v26, v18, v26
M v[100:103], a[68:71], a[36:39], v[100:103]
 v_exp_f32 v24, v78
M v[100:103], a[64:67], a[32:35], v[100:103]
 s_waitcnt lgkmcnt(0)
 v_exp_f32 v25, v79
M v[108:111], a[96:99], a[32:35], v[36:39]
 ds_read_b128 a[64:67], v7 offset:49152
 ds_read_b128 a[68:71], v7 offset:50176
M v[108:111], a[100:103], a[36:39], v[108:111]
 buffer_load_dwordx4 v3, s[8:11], s21 offen offset:3072 sc1 lds
M v[108:111], a[104:107], a[40:43], v[108:111]
 v_cvt_pk_bf16_f32 v42, v18, v19
 v_add_f32 v26, v19, v26
M v[108:111], a[108:111], a[44:47], v[108:111]
 ds_read_b128 a[72:75], v7 offset:51200
 ds_read_b128 a[76:79], v7 offset:52224
M v[108:111], a[112:115], a[48:51], v[108:111]
 buffer_store_dwordx4 a[40:43], v6, s[8:11], s3 offen offset:2048 sc1
M v[108:111], a[116:119], a[52:55], v[108:111]
 v_exp_f32 v18, v80
M v[108:111], a[120:123], a[56:59], v[108:111]
 s_add_u32 m0, s28, 102400
 ds_read_b128 a[80:83], v7 offset:53248
 ds_read_b128 a[84:87], v7 offset:54272
M v[108:111], a[124:127], a[60:63], v[108:111]
 buffer_load_dwordx4 v4, s[8:11], s21 offen offset:0 sc1 lds
M v[104:107], a[124:127], a[28:31], v[32:35]
 v_exp_f32 v19, v81
M v[104:107], a[120:123], a[24:27], v[104:107]
 ds_read_b128 a[88:91], v7 offset:55296
 ds_read_b128 a[92:95], v7 offset:56320
M v[104:107], a[116:119], a[20:23], v[104:107]
 buffer_store_dwordx4 a[44:47], v6, s[8:11], s3 offen offset:3072 sc1
M v[104:107], a[112:115], a[16:19], v[104:107]
 v_add_f32 v26, v20, v26
 v_cvt_pk_bf16_f32 v43, v20, v21
M v[104:107], a[108:111], a[12:15], v[104:107]
 buffer_load_dwordx4 v4, s[8:11], s21 offen offset:1024 sc1 lds
M v[104:107], a[104:107], a[8:11], v[104:107]
 s_add_u32 s3, s32, 12288
 v_add_f32 v26, v21, v26
 v_add_f32 v27, v22, v27
M v[104:107], a[100:103], a[4:7], v[104:107]
 buffer_store_dwordx4 a[48:51], v6, s[8:11], s3 offen offset:0 sc1
M v[104:107], a[96:99], a[0:3], v[104:107]
 s_waitcnt lgkmcnt(0)
 v_exp_f32 v20, v82
M v[112:115], a[64:67], a[0:3], v[32:35]
 ds_read_b128 a[96:99], v7 offset:57344
 ds_read_b128 a[100:103], v7 offset:58368
M v[112:115], a[68:71], a[4:7], v[112:115]
 buffer_load_dwordx4 v4, s[8:11], s21 offen offset:2048 sc1 lds
M v[112:115], a[72:75], a[8:11], v[112:115]
 v_exp_f32 v21, v83
M v[112:115], a[76:79], a[12:15], v[112:115]
 ds_read_b128 a[104:107], v7 offset:59392
 ds_read_b128 a[108:111], v7 offset:60416
M v[112:115], a[80:83], a[16:19], v[112:115]
 buffer_load_dwordx4 v4, s[8:11], s21 offen offset:3072 sc1 lds
M v[112:115], a[84:87], a[20:23], v[112:115]
 s_add_u32 s24, s23, 16777216
 v_cvt_pk_bf16_f32 v46, v22, v23
 v_add_f32 v27, v23, v27
M v[112:115], a[88:91], a[24:27], v[112:115]
 s_mov_b32 s23, s21
 ds_read_b128 a[112:115], v7 offset:61440
 ds_read_b128 a[116:119], v7 offset:62464
M v[112:115], a[92:95], a[28:31], v[112:115]
 buffer_store_dwordx4 a[52:55], v6, s[8:11], s3 offen offset:1024 sc1
M v[116:119], a[92:95], a[60:63], v[36:39]
 s_add_u32 s21, s21, 32768
 v_add_f32 v27, v24, v27
M v[116:119], a[88:91], a[56:59], v[116:119]
 s_add_u32 s22, s22, 1
 ds_read_b128 a[120:123], v7 offset:63488
 ds_read_b128 a[124:127], v7 offset:64512
M v[116:119], a[84:87], a[52:55], v[116:119]
 s_cmp_eq_u32 s22, s25
 v_exp_f32 v22, v88
M v[116:119], a[80:83], a[48:51], v[116:119]
 s_cselect_b32 s21, s26, s21
 v_exp_f32 v23, v89
M v[116:119], a[76:79], a[44:47], v[116:119]
 buffer_store_dwordx4 a[56:59], v6, s[8:11], s3 offen offset:2048 sc1
M v[116:119], a[72:75], a[40:43], v[116:119]
 s_cmp_eq_u32 s22, s43
 v_cvt_pk_bf16_f32 v47, v24, v25
 v_add_f32 v27, v25, v27
M v[116:119], a[68:71], a[36:39], v[116:119]
 s_waitcnt vmcnt(21) lgkmcnt(0)
 v_exp_f32 v24, v90
M v[116:119], a[64:67], a[32:35], v[116:119]
 s_barrier
M v[124:127], a[96:99], a[32:35], v[36:39]
 s_cselect_b32 s21, s4, s21
 ds_read_b128 a[64:67], v2 offset:0
 ds_read_b128 a[68:71], v2 offset:1024
M v[124:127], a[100:103], a[36:39], v[124:127]
 s_cmp_eq_u32 s22, s6
 v_exp_f32 v25, v91
M v[124:127], a[104:107], a[40:43], v[124:127]
 s_cselect_b32 s21, s7, s21
 v_add_f32 v26, v18, v26
 v_cvt_pk_bf16_f32 v56, v18, v19
M v[124:127], a[108:111], a[44:47], v[124:127]
 ds_read_b128 a[72:75], v2 offset:2048
 ds_read_b128 a[76:79], v2 offset:3072
M v[124:127], a[112:115], a[48:51], v[124:127]
 buffer_store_dwordx4 a[60:63], v6, s[8:11], s3 offen offset:3072 sc1
M v[124:127], a[116:119], a[52:55], v[124:127]
 v_add_f32 v26, v19, v26
 v_add_f32 v26, v20, v26
M v[124:127], a[120:123], a[56:59], v[124:127]
 ds_read_b128 a[80:83], v2 offset:4096
 ds_read_b128 a[84:87], v2 offset:5120
M v[124:127], a[124:127], a[60:63], v[124:127]
 v_exp_f32 v18, v84
M v[120:123], a[124:127], a[28:31], v[32:35]
 v_exp_f32 v19, v85
M v[120:123], a[120:123], a[24:27], v[120:123]
 ds_read_b128 a[88:91], v2 offset:6144
 ds_read_b128 a[92:95], v2 offset:7168
M v[120:123], a[116:119], a[20:23], v[120:123]
 v_cvt_pk_bf16_f32 v57, v20, v21
 v_add_f32 v26, v21, v26
M v[120:123], a[112:115], a[16:19], v[120:123]
 v_exp_f32 v20, v86
M v[120:123], a[108:111], a[12:15], v[120:123]
 v_exp_f32 v21, v87
M v[120:123], a[104:107], a[8:11], v[120:123]
 v_add_f32 v26, v22, v26
 v_cvt_pk_bf16_f32 v58, v22, v23
M v[120:123], a[100:103], a[4:7], v[120:123]
 s_waitcnt lgkmcnt(0)
 v_add_f32 v26, v23, v26
 v_add_f32 v26, v24, v26
M v[120:123], a[96:99], a[0:3], v[120:123]
 v_exp_f32 v22, v92
 v_cvt_pk_bf16_f32 v59, v24, v25
 v_add_f32 v26, v25, v26
 v_add_f32 v27, v18, v27
 v_cvt_pk_bf16_f32 v60, v18, v19
 v_add_f32 v27, v19, v27
 v_exp_f32 v23, v93
 v_add_f32 v27, v20, v27
 v_cvt_pk_bf16_f32 v61, v20, v21
 v_add_f32 v27, v21, v27
 v_exp_f32 v24, v94
 v_add_f32 v27, v22, v27
 v_cvt_pk_bf16_f32 v62, v22, v23
 v_exp_f32 v25, v95
 v_add_f32 v27, v23, v27
 v_add_f32 v27, v24, v27
 v_cvt_pk_bf16_f32 v63, v24, v25
 v_add_f32 v27, v25, v27
 v_max_f32 v10, v26, v27
 v_min_f32 v11, v26, v27
 v_cmp_lt_f32 s[36:37], s31, v10
 v_cmp_gt_f32 vcc, s55, v11
 s_nop 0
 s_or_b64 vcc, vcc, s[36:37]
 s_cbranch_vccnz L_st8
L_rt8:
M v[128:131], a[64:67], v[40:43], 0
 s_add_u32 m0, s28, 0
 ds_read_b128 a[96:99], v2 offset:8192
 ds_read_b128 a[100:103], v2 offset:9216
M v[128:131], a[68:71], v[56:59], v[128:131]
 buffer_load_dwordx4 v3, s[8:11], s24 offen offset:0 sc1 lds
M v[132:135], a[68:71], v[60:63], 0
 v_accvgpr_write_b32 a157, v249
 v_accvgpr_write_b32 a158, v250
M v[132:135], a[64:67], v[44:47], v[132:135]
 ds_read_b128 a[104:107], v2 offset:10240
 ds_read_b128 a[108:111], v2 offset:11264
M v[140:143], a[72:75], v[44:47], 0
 buffer_load_dwordx4 v3, s[8:11], s24 offen offset:1024 sc1 lds
M v[140:143], a[76:79], v[60:63], v[140:143]
 v_accvgpr_write_b32 a159, v251
 v_add_f32 v30, v26, v30
M v[136:139], a[76:79], v[56:59], 0
 ds_read_b128 a[112:115], v2 offset:12288
 ds_read_b128 a[116:119], v2 offset:13312
M v[136:139], a[72:75], v[40:43], v[136:139]
 buffer_load_dwordx4 v3, s[8:11], s24 offen offset:2048 sc1 lds
M v[144:147], a[80:83], v[40:43], 0
 v_exp_f32 v18, v96
M v[144:147], a[84:87], v[56:59], v[144:147]
 ds_read_b128 a[120:123], v2 offset:14336
 ds_read_b128 a[124:127], v2 offset:15360
M v[148:151], a[84:87], v[60:63], 0
 buffer_load_dwordx4 v3, s[8:11], s24 offen offset:3072 sc1 lds
M v[148:151], a[80:83], v[44:47], v[148:151]
 s_add_u32 m0, s28, 4096
 v_exp_f32 v19, v97
M v[156:159], a[88:91], v[44:47], 0
 buffer_load_dwordx4 v4, s[8:11], s24 offen offset:0 sc1 lds
M v[156:159], a[92:95], v[60:63], v[156:159]
 v_exp_f32 v20, v98
M v[152:155], a[92:95], v[56:59], 0
 v_exp_f32 v21, v99
M v[152:155], a[88:91], v[40:43], v[152:155]
 s_waitcnt lgkmcnt(0)
 v_exp_f32 v22, v104
M v[160:163], a[96:99], v[40:43], 0
 ds_read_b128 a[64:67], v2 offset:16384
 ds_read_b128 a[68:71], v2 offset:17408
M v[160:163], a[100:103], v[56:59], v[160:163]
 buffer_load_dwordx4 v4, s[8:11], s24 offen offset:1024 sc1 lds
M v[164:167], a[100:103], v[60:63], 0
 v_exp_f32 v23, v105
M v[164:167], a[96:99], v[44:47], v[164:167]
 ds_read_b128 a[72:75], v2 offset:18432
 ds_read_b128 a[76:79], v2 offset:19456
M v[172:175], a[104:107], v[44:47], 0
 buffer_load_dwordx4 v4, s[8:11], s24 offen offset:2048 sc1 lds
M v[172:175], a[108:111], v[60:63], v[172:175]
 v_add_f32 v31, v27, v31
 v_add_f32 v28, v18, v19
M v[168:171], a[108:111], v[56:59], 0
 ds_read_b128 a[80:83], v2 offset:20480
 ds_read_b128 a[84:87], v2 offset:21504
M v[168:171], a[104:107], v[40:43], v[168:171]
 buffer_load_dwordx4 v4, s[8:11], s24 offen offset:3072 sc1 lds
M v[176:179], a[112:115], v[40:43], 0
 v_exp_f32 v24, v106
M v[176:179], a[116:119], v[56:59], v[176:179]
 s_add_u32 m0, s28, 32768
 ds_read_b128 a[88:91], v2 offset:22528
 ds_read_b128 a[92:95], v2 offset:23552
M v[180:183], a[116:119], v[60:63], 0
 buffer_load_dwordx4 v3, s[8:11], s21 offen offset:0 sc1 lds
M v[180:183], a[112:115], v[44:47], v[180:183]
 v_exp_f32 v25, v107
M v[188:191], a[120:123], v[44:47], 0
 buffer_load_dwordx4 v3, s[8:11], s21 offen offset:1024 sc1 lds
M v[188:191], a[124:127], v[60:63], v[188:191]
 v_cvt_pk_bf16_f32 v48, v18, v19
 v_add_f32 v28, v20, v28
M v[184:187], a[124:127], v[56:59], 0
 buffer_load_dwordx4 v3, s[8:11], s21 offen offset:2048 sc1 lds
M v[184:187], a[120:123], v[40:43], v[184:187]
 s_waitcnt lgkmcnt(0)
 v_exp_f32 v18, v100
M v[192:195], a[64:67], v[40:43], 0
 ds_read_b128 a[96:99], v2 offset:24576
 ds_read_b128 a[100:103], v2 offset:25600
M v[192:195], a[68:71], v[56:59], v[192:195]
 buffer_load_dwordx4 v3, s[8:11], s21 offen offset:3072 sc1 lds
M v[196:199], a[68:71], v[60:63], 0
 v_exp_f32 v19, v101
M v[196:199], a[64:67], v[44:47], v[196:199]
 s_add_u32 m0, s28, 36864
 ds_read_b128 a[104:107], v2 offset:26624
 ds_read_b128 a[108:111], v2 offset:27648
M v[204:207], a[72:75], v[44:47], 0
 buffer_load_dwordx4 v4, s[8:11], s21 offen offset:0 sc1 lds
M v[204:207], a[76:79], v[60:63], v[204:207]
 v_cvt_pk_bf16_f32 v49, v20, v21
 v_add_f32 v28, v21, v28
M v[200:203], a[76:79], v[56:59], 0
 ds_read_b128 a[112:115], v2 offset:28672
 ds_read_b128 a[116:119], v2 offset:29696
M v[200:203], a[72:75], v[40:43], v[200:203]
 buffer_load_dwordx4 v4, s[8:11], s21 offen offset:1024 sc1 lds
M v[208:211], a[80:83], v[40:43], 0
 v_exp_f32 v20, v102
M v[208:211], a[84:87], v[56:59], v[208:211]
 ds_read_b128 a[120:123], v2 offset:30720
 ds_read_b128 a[124:127], v2 offset:31744
M v[212:215], a[84:87], v[60:63], 0
 buffer_load_dwordx4 v4, s[8:11], s21 offen offset:2048 sc1 lds
M v[212:215], a[80:83], v[44:47], v[212:215]
 v_exp_f32 v21, v103
M v[220:223], a[88:91], v[44:47], 0
 v_add_f32 v28, v22, v28
 v_cvt_pk_bf16_f32 v50, v22, v23
M v[220:223], a[92:95], v[60:63], v[220:223]
 buffer_load_dwordx4 v4, s[8:11], s21 offen offset:3072 sc1 lds
M v[216:219], a[92:95], v[56:59], 0
 s_waitcnt vmcnt(16) lgkmcnt(0)
 s_add_u32 s24, s23, 16777216
 s_mov_b32 s23, s21
M v[216:219], a[88:91], v[40:43], v[216:219]
 s_barrier
M v[224:227], a[96:99], v[40:43], 0
 ds_read_b128 a[64:67], v2 offset:32768
 ds_read_b128 a[68:71], v2 offset:33792
M v[224:227], a[100:103], v[56:59], v[224:227]
 s_xor_b32 s3, s47, 64
 v_mov_b32 v5, 1
M v[228:231], a[100:103], v[60:63], 0
 v_min_u32 v6, 1, v7
 v_lshlrev_b32 v6, 29, v6
M v[228:231], a[96:99], v[44:47], v[228:231]
 ds_read_b128 a[72:75], v2 offset:34816
 ds_read_b128 a[76:79], v2 offset:35840
M v[236:239], a[104:107], v[44:47], 0
 v_or_b32 v6, s35, v6
 s_add_u32 s21, s21, 32768
M v[236:239], a[108:111], v[60:63], v[236:239]
 buffer_store_dword v5, v6, s[8:11], s3 offen sc1
M v[232:235], a[108:111], v[56:59], 0
 ds_read_b128 a[80:83], v2 offset:36864
 ds_read_b128 a[84:87], v2 offset:37888
M v[232:235], a[104:107], v[40:43], v[232:235]
 s_add_u32 s22, s22, 1
 v_add_f32 v28, v23, v28
M v[240:243], a[112:115], v[40:43], 0
 s_cmp_eq_u32 s22, s25
 v_exp_f32 v22, v108
M v[240:243], a[116:119], v[56:59], v[240:243]
 s_cselect_b32 s21, s26, s21
 ds_read_b128 a[88:91], v2 offset:38912
 ds_read_b128 a[92:95], v2 offset:39936
M v[244:247], a[116:119], v[60:63], 0
 s_cmp_eq_u32 s22, s43
 v_exp_f32 v23, v109
M v[244:247], a[112:115], v[44:47], v[244:247]
 s_cselect_b32 s21, s4, s21
 v_add_f32 v28, v24, v28
 v_cvt_pk_bf16_f32 v51, v24, v25
M v[252:255], a[120:123], v[44:47], 0
 s_cmp_eq_u32 s22, s6
 v_add_f32 v28, v25, v28
 v_add_f32 v29, v18, v19
M v[252:255], a[124:127], v[60:63], v[252:255]
 s_cselect_b32 s21, s7, s21
 v_exp_f32 v24, v110
M v[248:251], a[124:127], v[56:59], 0
 s_waitcnt lgkmcnt(0)
 v_exp_f32 v25, v111
M v[248:251], a[120:123], v[40:43], v[248:251]
 v_cvt_pk_bf16_f32 v52, v18, v19
 v_add_f32 v29, v20, v29
 v_cvt_pk_bf16_f32 v53, v20, v21
 v_add_f32 v29, v21, v29
 v_add_f32 v29, v22, v29
 v_cvt_pk_bf16_f32 v54, v22, v23
 v_add_f32 v29, v23, v29
 v_add_f32 v29, v24, v29
 v_cvt_pk_bf16_f32 v55, v24, v25
 v_add_f32 v29, v25, v29
M v[64:67], a[64:67], a[0:3], v[32:35]
 s_add_u32 m0, s28, 65536
 ds_read_b128 a[96:99], v2 offset:40960
 ds_read_b128 a[100:103], v2 offset:41984
M v[64:67], a[68:71], a[4:7], v[64:67]
 buffer_load_dwordx4 v3, s[8:11], s24 offen offset:0 sc1 lds
M v[64:67], a[72:75], a[8:11], v[64:67]
 v_exp_f32 v18, v112
M v[64:67], a[76:79], a[12:15], v[64:67]
 s_add_u32 s3, s30, 786432
 ds_read_b128 a[104:107], v2 offset:43008
 ds_read_b128 a[108:111], v2 offset:44032
M v[64:67], a[80:83], a[16:19], v[64:67]
 buffer_store_dwordx4 a[128:131], v7, s[8:11], s3 offen offset:0 sc1
M v[64:67], a[84:87], a[20:23], v[64:67]
 v_exp_f32 v19, v113
M v[64:67], a[88:91], a[24:27], v[64:67]
 ds_read_b128 a[112:115], v2 offset:45056
 ds_read_b128 a[116:119], v2 offset:46080
M v[64:67], a[92:95], a[28:31], v[64:67]
 buffer_load_dwordx4 v3, s[8:11], s24 offen offset:1024 sc1 lds
M v[68:71], a[92:95], a[60:63], v[36:39]
 v_exp_f32 v20, v114
M v[68:71], a[88:91], a[56:59], v[68:71]
 ds_read_b128 a[120:123], v2 offset:47104
 ds_read_b128 a[124:127], v2 offset:48128
M v[68:71], a[84:87], a[52:55], v[68:71]
 v_exp_f32 v21, v115
M v[68:71], a[80:83], a[48:51], v[68:71]
 v_add_f32 v28, v18, v28
 v_cvt_pk_bf16_f32 v56, v18, v19
M v[68:71], a[76:79], a[44:47], v[68:71]
 v_add_f32 v28, v19, v28
 v_add_f32 v28, v20, v28
M v[68:71], a[72:75], a[40:43], v[68:71]
 buffer_load_dwordx4 v3, s[8:11], s24 offen offset:2048 sc1 lds
M v[68:71], a[68:71], a[36:39], v[68:71]
 v_exp_f32 v22, v120
M v[68:71], a[64:67], a[32:35], v[68:71]
 s_waitcnt lgkmcnt(0)
 v_cvt_pk_bf16_f32 v57, v20, v21
 v_add_f32 v28, v21, v28
M v[76:79], a[96:99], a[32:35], v[36:39]
 ds_read_b128 a[64:67], v2 offset:49152
 ds_read_b128 a[68:71], v2 offset:50176
M v[76:79], a[100:103], a[36:39], v[76:79]
 buffer_store_dwordx4 a[132:135], v7, s[8:11], s3 offen offset:1024 sc1
M v[76:79], a[104:107], a[40:43], v[76:79]
 v_exp_f32 v23, v121
M v[76:79], a[108:111], a[44:47], v[76:79]
 ds_read_b128 a[72:75], v2 offset:51200
 ds_read_b128 a[76:79], v2 offset:52224
M v[76:79], a[112:115], a[48:51], v[76:79]
 buffer_load_dwordx4 v3, s[8:11], s24 offen offset:3072 sc1 lds
M v[76:79], a[116:119], a[52:55], v[76:79]
 v_exp_f32 v24, v122
M v[76:79], a[120:123], a[56:59], v[76:79]
 ds_read_b128 a[80:83], v2 offset:53248
 ds_read_b128 a[84:87], v2 offset:54272
M v[76:79], a[124:127], a[60:63], v[76:79]
 v_add_f32 v28, v22, v28
 v_cvt_pk_bf16_f32 v58, v22, v23
M v[72:75], a[124:127], a[28:31], v[32:35]
 v_exp_f32 v25, v123
M v[72:75], a[120:123], a[24:27], v[72:75]
 s_add_u32 m0, s28, 69632
 ds_read_b128 a[88:91], v2 offset:55296
 ds_read_b128 a[92:95], v2 offset:56320
M v[72:75], a[116:119], a[20:23], v[72:75]
 buffer_load_dwordx4 v4, s[8:11], s24 offen offset:0 sc1 lds
M v[72:75], a[112:115], a[16:19], v[72:75]
 v_add_f32 v28, v23, v28
 v_add_f32 v28, v24, v28
M v[72:75], a[108:111], a[12:15], v[72:75]
 v_exp_f32 v18, v116
M v[72:75], a[104:107], a[8:11], v[72:75]
 v_cvt_pk_bf16_f32 v59, v24, v25
 v_add_f32 v28, v25, v28
M v[72:75], a[100:103], a[4:7], v[72:75]
M v[72:75], a[96:99], a[0:3], v[72:75]
 s_waitcnt lgkmcnt(0)
 v_exp_f32 v19, v117
M v[80:83], a[64:67], a[0:3], v[32:35]
 ds_read_b128 a[96:99], v2 offset:57344
 ds_read_b128 a[100:103], v2 offset:58368
M v[80:83], a[68:71], a[4:7], v[80:83]
 buffer_store_dwordx4 a[136:139], v7, s[8:11], s3 offen offset:2048 sc1
M v[80:83], a[72:75], a[8:11], v[80:83]
 v_add_f32 v29, v18, v29
 v_cvt_pk_bf16_f32 v60, v18, v19
M v[80:83], a[76:79], a[12:15], v[80:83]
 ds_read_b128 a[104:107], v2 offset:59392
 ds_read_b128 a[108:111], v2 offset:60416
M v[80:83], a[80:83], a[16:19], v[80:83]
 buffer_load_dwordx4 v4, s[8:11], s24 offen offset:1024 sc1 lds
M v[80:83], a[84:87], a[20:23], v[80:83]
 v_exp_f32 v20, v118
M v[80:83], a[88:91], a[24:27], v[80:83]
 ds_read_b128 a[112:115], v2 offset:61440
 ds_read_b128 a[116:119], v2 offset:62464
M v[80:83], a[92:95], a[28:31], v[80:83]
 buffer_load_dwordx4 v4, s[8:11], s24 offen offset:2048 sc1 lds
M v[84:87], a[92:95], a[60:63], v[36:39]
 v_exp_f32 v21, v119
M v[84:87], a[88:91], a[56:59], v[84:87]
 ds_read_b128 a[120:123], v2 offset:63488
 ds_read_b128 a[124:127], v2 offset:64512
M v[84:87], a[84:87], a[52:55], v[84:87]
 v_exp_f32 v22, v124
M v[84:87], a[80:83], a[48:51], v[84:87]
 buffer_load_dwordx4 v4, s[8:11], s24 offen offset:3072 sc1 lds
M v[84:87], a[76:79], a[44:47], v[84:87]
 v_add_f32 v29, v19, v29
 v_add_f32 v29, v20, v29
M v[84:87], a[72:75], a[40:43], v[84:87]
 buffer_store_dwordx4 a[140:143], v7, s[8:11], s3 offen offset:3072 sc1
M v[84:87], a[68:71], a[36:39], v[84:87]
 s_waitcnt vmcnt(21) lgkmcnt(0)
 v_exp_f32 v23, v125
M v[84:87], a[64:67], a[32:35], v[84:87]
 s_barrier
M v[92:95], a[96:99], a[32:35], v[36:39]
 ds_read_b128 a[64:67], v7 offset:0
 ds_read_b128 a[68:71], v7 offset:1024
M v[92:95], a[100:103], a[36:39], v[92:95]
 v_exp_f32 v24, v126
M v[92:95], a[104:107], a[40:43], v[92:95]
 v_cvt_pk_bf16_f32 v61, v20, v21
 v_add_f32 v29, v21, v29
M v[92:95], a[108:111], a[44:47], v[92:95]
 ds_read_b128 a[72:75], v7 offset:2048
 ds_read_b128 a[76:79], v7 offset:3072
M v[92:95], a[112:115], a[48:51], v[92:95]
 v_exp_f32 v25, v127
M v[92:95], a[116:119], a[52:55], v[92:95]
 v_add_f32 v29, v22, v29
 v_cvt_pk_bf16_f32 v62, v22, v23
M v[92:95], a[120:123], a[56:59], v[92:95]
 ds_read_b128 a[80:83], v7 offset:4096
 ds_read_b128 a[84:87], v7 offset:5120
M v[92:95], a[124:127], a[60:63], v[92:95]
 v_add_f32 v29, v23, v29
 v_add_f32 v29, v24, v29
M v[88:91], a[124:127], a[28:31], v[32:35]
 v_cvt_pk_bf16_f32 v63, v24, v25
 v_add_f32 v29, v25, v29
M v[88:91], a[120:123], a[24:27], v[88:91]
 ds_read_b128 a[88:91], v7 offset:6144
 ds_read_b128 a[92:95], v7 offset:7168
M v[88:91], a[116:119], a[20:23], v[88:91]
 v_max_f32 v10, v28, v29
M v[88:91], a[112:115], a[16:19], v[88:91]
 v_cmp_lt_f32 vcc, s31, v10
M v[88:91], a[108:111], a[12:15], v[88:91]
M v[88:91], a[104:107], a[8:11], v[88:91]
M v[88:91], a[100:103], a[4:7], v[88:91]
 s_waitcnt lgkmcnt(0)
M v[88:91], a[96:99], a[0:3], v[88:91]
 s_cbranch_vccnz L_st9
L_rt9:
M v[128:131], a[64:67], v[48:51], v[128:131]
 s_add_u32 m0, s28, 98304
 ds_read_b128 a[96:99], v7 offset:8192
 ds_read_b128 a[100:103], v7 offset:9216
M v[128:131], a[68:71], v[56:59], v[128:131]
 buffer_load_dwordx4 v3, s[8:11], s21 offen offset:0 sc1 lds
M v[132:135], a[68:71], v[60:63], v[132:135]
 v_exp_f32 v18, v64
M v[132:135], a[64:67], v[52:55], v[132:135]
 s_add_u32 s3, s30, 794624
 ds_read_b128 a[104:107], v7 offset:10240
 ds_read_b128 a[108:111], v7 offset:11264
M v[140:143], a[72:75], v[52:55], v[140:143]
 buffer_store_dwordx4 a[144:147], v7, s[8:11], s3 offen offset:0 sc1
M v[140:143], a[76:79], v[60:63], v[140:143]
 v_exp_f32 v19, v65
M v[136:139], a[76:79], v[56:59], v[136:139]
 ds_read_b128 a[112:115], v7 offset:12288
 ds_read_b128 a[116:119], v7 offset:13312
M v[136:139], a[72:75], v[48:51], v[136:139]
 buffer_load_dwordx4 v3, s[8:11], s21 offen offset:1024 sc1 lds
M v[144:147], a[80:83], v[48:51], v[144:147]
 v_exp_f32 v20, v66
M v[144:147], a[84:87], v[56:59], v[144:147]
 ds_read_b128 a[120:123], v7 offset:14336
 ds_read_b128 a[124:127], v7 offset:15360
M v[148:151], a[84:87], v[60:63], v[148:151]
 v_add_f32 v30, v28, v30
 v_add_f32 v31, v29, v31
M v[148:151], a[80:83], v[52:55], v[148:151]
 buffer_load_dwordx4 v3, s[8:11], s21 offen offset:2048 sc1 lds
M v[156:159], a[88:91], v[52:55], v[156:159]
 v_exp_f32 v21, v67
M v[156:159], a[92:95], v[60:63], v[156:159]
 v_add_f32 v26, v18, v19
 v_cvt_pk_bf16_f32 v40, v18, v19
M v[152:155], a[92:95], v[56:59], v[152:155]
 v_exp_f32 v22, v72
M v[152:155], a[88:91], v[48:51], v[152:155]
 s_waitcnt lgkmcnt(0)
 v_add_f32 v26, v20, v26
 v_cvt_pk_bf16_f32 v41, v20, v21
M v[160:163], a[96:99], v[48:51], v[160:163]
 ds_read_b128 a[64:67], v7 offset:16384
 ds_read_b128 a[68:71], v7 offset:17408
M v[160:163], a[100:103], v[56:59], v[160:163]
 buffer_store_dwordx4 a[148:151], v7, s[8:11], s3 offen offset:1024 sc1
M v[164:167], a[100:103], v[60:63], v[164:167]
 v_exp_f32 v23, v73
M v[164:167], a[96:99], v[52:55], v[164:167]
 ds_read_b128 a[72:75], v7 offset:18432
 ds_read_b128 a[76:79], v7 offset:19456
M v[172:175], a[104:107], v[52:55], v[172:175]
 buffer_load_dwordx4 v3, s[8:11], s21 offen offset:3072 sc1 lds
M v[172:175], a[108:111], v[60:63], v[172:175]
 v_add_f32 v26, v21, v26
 v_add_f32 v26, v22, v26
M v[168:171], a[108:111], v[56:59], v[168:171]
 s_add_u32 m0, s28, 102400
 ds_read_b128 a[80:83], v7 offset:20480
 ds_read_b128 a[84:87], v7 offset:21504
M v[168:171], a[104:107], v[48:51], v[168:171]
 buffer_load_dwordx4 v4, s[8:11], s21 offen offset:0 sc1 lds
M v[176:179], a[112:115], v[48:51], v[176:179]
 v_exp_f32 v24, v74
M v[176:179], a[116:119], v[56:59], v[176:179]
 ds_read_b128 a[88:91], v7 offset:22528
 ds_read_b128 a[92:95], v7 offset:23552
M v[180:183], a[116:119], v[60:63], v[180:183]
 v_exp_f32 v25, v75
M v[180:183], a[112:115], v[52:55], v[180:183]
 buffer_load_dwordx4 v4, s[8:11], s21 offen offset:1024 sc1 lds
M v[188:191], a[120:123], v[52:55], v[188:191]
 v_cvt_pk_bf16_f32 v42, v22, v23
 v_add_f32 v26, v23, v26
M v[188:191], a[124:127], v[60:63], v[188:191]
 v_exp_f32 v18, v68
M v[184:187], a[124:127], v[56:59], v[184:187]
 v_add_f32 v26, v24, v26
 v_cvt_pk_bf16_f32 v43, v24, v25
M v[184:187], a[120:123], v[48:51], v[184:187]
 s_waitcnt lgkmcnt(0)
 v_add_f32 v26, v25, v26
M v[192:195], a[64:67], v[48:51], v[192:195]
 ds_read_b128 a[96:99], v7 offset:24576
 ds_read_b128 a[100:103], v7 offset:25600
M v[192:195], a[68:71], v[56:59], v[192:195]
 buffer_store_dwordx4 a[152:155], v7, s[8:11], s3 offen offset:2048 sc1
M v[196:199], a[68:71], v[60:63], v[196:199]
 v_exp_f32 v19, v69
M v[196:199], a[64:67], v[52:55], v[196:199]
 ds_read_b128 a[104:107], v7 offset:26624
 ds_read_b128 a[108:111], v7 offset:27648
M v[204:207], a[72:75], v[52:55], v[204:207]
 buffer_load_dwordx4 v4, s[8:11], s21 offen offset:2048 sc1 lds
M v[204:207], a[76:79], v[60:63], v[204:207]
 v_exp_f32 v20, v70
M v[200:203], a[76:79], v[56:59], v[200:203]
 ds_read_b128 a[112:115], v7 offset:28672
 ds_read_b128 a[116:119], v7 offset:29696
M v[200:203], a[72:75], v[48:51], v[200:203]
 buffer_load_dwordx4 v4, s[8:11], s21 offen offset:3072 sc1 lds
M v[208:211], a[80:83], v[48:51], v[208:211]
 s_add_u32 s24, s23, 16777216
 v_exp_f32 v21, v71
M v[208:211], a[84:87], v[56:59], v[208:211]
 s_mov_b32 s23, s21
 ds_read_b128 a[120:123], v7 offset:30720
 ds_read_b128 a[124:127], v7 offset:31744
M v[212:215], a[84:87], v[60:63], v[212:215]
 s_add_u32 s21, s21, 32768
 v_add_f32 v27, v18, v19
 v_cvt_pk_bf16_f32 v44, v18, v19
M v[212:215], a[80:83], v[52:55], v[212:215]
 s_add_u32 s22, s22, 1
 v_add_f32 v27, v20, v27
 v_cvt_pk_bf16_f32 v45, v20, v21
M v[220:223], a[88:91], v[52:55], v[220:223]
 s_cmp_eq_u32 s22, s25
 v_exp_f32 v22, v76
M v[220:223], a[92:95], v[60:63], v[220:223]
 buffer_store_dwordx4 a[156:159], v7, s[8:11], s3 offen offset:3072 sc1
M v[216:219], a[92:95], v[56:59], v[216:219]
 s_waitcnt vmcnt(25) lgkmcnt(0)
 v_add_f32 v27, v21, v27
M v[216:219], a[88:91], v[48:51], v[216:219]
 s_barrier
M v[224:227], a[96:99], v[48:51], v[224:227]
 s_cselect_b32 s21, s26, s21
 ds_read_b128 a[64:67], v7 offset:32768
 ds_read_b128 a[68:71], v7 offset:33792
M v[224:227], a[100:103], v[56:59], v[224:227]
 s_cmp_eq_u32 s22, s43
 v_exp_f32 v23, v77
M v[228:231], a[100:103], v[60:63], v[228:231]
 s_cselect_b32 s21, s4, s21
 v_add_f32 v27, v22, v27
 v_cvt_pk_bf16_f32 v46, v22, v23
M v[228:231], a[96:99], v[52:55], v[228:231]
 s_cmp_eq_u32 s22, s6
 ds_read_b128 a[72:75], v7 offset:34816
 ds_read_b128 a[76:79], v7 offset:35840
M v[236:239], a[104:107], v[52:55], v[236:239]
 s_cselect_b32 s21, s7, s21
 v_exp_f32 v24, v78
M v[236:239], a[108:111], v[60:63], v[236:239]
 v_add_f32 v27, v23, v27
M v[232:235], a[108:111], v[56:59], v[232:235]
 ds_read_b128 a[80:83], v7 offset:36864
 ds_read_b128 a[84:87], v7 offset:37888
M v[232:235], a[104:107], v[48:51], v[232:235]
 v_exp_f32 v25, v79
M v[240:243], a[112:115], v[48:51], v[240:243]
 v_add_f32 v27, v24, v27
 v_cvt_pk_bf16_f32 v47, v24, v25
M v[240:243], a[116:119], v[56:59], v[240:243]
 ds_read_b128 a[88:91], v7 offset:38912
 ds_read_b128 a[92:95], v7 offset:39936
M v[244:247], a[116:119], v[60:63], v[244:247]
 v_add_f32 v27, v25, v27
M v[244:247], a[112:115], v[52:55], v[244:247]
M v[252:255], a[120:123], v[52:55], v[252:255]
M v[252:255], a[124:127], v[60:63], v[252:255]
M v[248:251], a[124:127], v[56:59], v[248:251]
 s_waitcnt lgkmcnt(0)
M v[248:251], a[120:123], v[48:51], v[248:251]
M v[96:99], a[64:67], a[0:3], v[32:35]
 s_add_u32 m0, s28, 0
 ds_read_b128 a[96:99], v7 offset:40960
M v[96:99], a[68:71], a[4:7], v[96:99]
 ds_read_b128 a[100:103], v7 offset:41984
M v[96:99], a[72:75], a[8:11], v[96:99]
 buffer_load_dword v6, v9, s[8:11], s46 offen sc1
M v[96:99], a[76:79], a[12:15], v[96:99]
 s_cmp_eq_u32 s20, 0
 ds_read_b128 a[104:107], v7 offset:43008
M v[96:99], a[80:83], a[16:19], v[96:99]
 s_cselect_b64 s[64:65], s[16:17], 0
 ds_read_b128 a[108:111], v7 offset:44032
M v[96:99], a[84:87], a[20:23], v[96:99]
 buffer_load_dwordx4 v3, s[8:11], s24 offen offset:0 sc1 lds
M v[96:99], a[88:91], a[24:27], v[96:99]
 s_cselect_b64 s[66:67], s[18:19], 0
 ds_read_b128 a[112:115], v7 offset:45056
M v[96:99], a[92:95], a[28:31], v[96:99]
 s_cselect_b64 s[68:69], s[48:49], 0
 ds_read_b128 a[116:119], v7 offset:46080
M v[100:103], a[92:95], a[60:63], v[36:39]
 buffer_load_dwordx4 v3, s[8:11], s24 offen offset:1024 sc1 lds
M v[100:103], a[88:91], a[56:59], v[100:103]
 s_cselect_b64 s[70:71], s[50:51], 0
 ds_read_b128 a[120:123], v7 offset:47104
M v[100:103], a[84:87], a[52:55], v[100:103]
 s_cmp_lt_u32 s20, 1
 ds_read_b128 a[124:127], v7 offset:48128
M v[100:103], a[80:83], a[48:51], v[100:103]
 s_cselect_b64 s[78:79], -1, 0
 v_exp_f32 v18, v80
M v[100:103], a[76:79], a[44:47], v[100:103]
 buffer_load_dwordx4 v3, s[8:11], s24 offen offset:2048 sc1 lds
M v[100:103], a[72:75], a[40:43], v[100:103]
 s_cmp_eq_u32 s20, 1
 v_exp_f32 v19, v81
M v[100:103], a[68:71], a[36:39], v[100:103]
 s_cselect_b64 s[72:73], s[16:17], s[78:79]
 v_exp_f32 v20, v82
M v[100:103], a[64:67], a[32:35], v[100:103]
 s_waitcnt lgkmcnt(0)
 v_exp_f32 v21, v83
M v[108:111], a[96:99], a[32:35], v[36:39]
 s_cselect_b64 s[74:75], s[18:19], s[78:79]
 ds_read_b128 a[64:67], v7 offset:49152
 v_add_f32 v26, v18, v26
M v[108:111], a[100:103], a[36:39], v[108:111]
 s_cselect_b64 s[76:77], s[48:49], s[78:79]
 ds_read_b128 a[68:71], v7 offset:50176
 v_cvt_pk_bf16_f32 v56, v18, v19
M v[108:111], a[104:107], a[40:43], v[108:111]
 buffer_load_dwordx4 v3, s[8:11], s24 offen offset:3072 sc1 lds
M v[108:111], a[108:111], a[44:47], v[108:111]
 s_cselect_b64 s[78:79], s[50:51], s[78:79]
 ds_read_b128 a[72:75], v7 offset:51200
 v_add_f32 v26, v19, v26
M v[108:111], a[112:115], a[48:51], v[108:111]
 s_add_u32 s3, s29, 0
 ds_read_b128 a[76:79], v7 offset:52224
 v_add_f32 v26, v20, v26
M v[108:111], a[116:119], a[52:55], v[108:111]
 buffer_store_dwordx4 a[192:195], v7, s[8:11], s3 offen sc1
M v[108:111], a[120:123], a[56:59], v[108:111]
 s_add_u32 m0, s28, 4096
 ds_read_b128 a[80:83], v7 offset:53248
 v_cvt_pk_bf16_f32 v57, v20, v21
M v[108:111], a[124:127], a[60:63], v[108:111]
 ds_read_b128 a[84:87], v7 offset:54272
 v_add_f32 v26, v21, v26
M v[104:107], a[124:127], a[28:31], v[32:35]
 buffer_load_dwordx4 v4, s[8:11], s24 offen offset:0 sc1 lds
M v[104:107], a[120:123], a[24:27], v[104:107]
 ds_read_b128 a[88:91], v7 offset:55296
M v[104:107], a[116:119], a[20:23], v[104:107]
 ds_read_b128 a[92:95], v7 offset:56320
M v[104:107], a[112:115], a[16:19], v[104:107]
 v_exp_f32 v22, v88
M v[104:107], a[108:111], a[12:15], v[104:107]
 buffer_load_dwordx4 v4, s[8:11], s24 offen offset:1024 sc1 lds
M v[104:107], a[104:107], a[8:11], v[104:107]
 v_exp_f32 v23, v89
M v[104:107], a[100:103], a[4:7], v[104:107]
 v_exp_f32 v24, v90
M v[104:107], a[96:99], a[0:3], v[104:107]
 s_waitcnt lgkmcnt(0)
 v_exp_f32 v25, v91
M v[112:115], a[64:67], a[0:3], v[32:35]
 s_add_u32 s3, s29, 32768
 ds_read_b128 a[96:99], v7 offset:57344
 v_add_f32 v26, v22, v26
M v[112:115], a[68:71], a[4:7], v[112:115]
 ds_read_b128 a[100:103], v7 offset:58368
 v_cvt_pk_bf16_f32 v58, v22, v23
M v[112:115], a[72:75], a[8:11], v[112:115]
 buffer_load_dwordx4 v4, s[8:11], s24 offen offset:2048 sc1 lds
M v[112:115], a[76:79], a[12:15], v[112:115]
 ds_read_b128 a[104:107], v7 offset:59392
 v_add_f32 v26, v23, v26
M v[112:115], a[80:83], a[16:19], v[112:115]
 ds_read_b128 a[108:111], v7 offset:60416
 v_add_f32 v26, v24, v26
M v[112:115], a[84:87], a[20:23], v[112:115]
 buffer_store_dwordx4 a[196:199], v7, s[8:11], s3 offen sc1
M v[112:115], a[88:91], a[24:27], v[112:115]
 ds_read_b128 a[112:115], v7 offset:61440
 v_cvt_pk_bf16_f32 v59, v24, v25
M v[112:115], a[92:95], a[28:31], v[112:115]
 ds_read_b128 a[116:119], v7 offset:62464
 v_add_f32 v26, v25, v26
M v[116:119], a[92:95], a[60:63], v[36:39]
 buffer_load_dwordx4 v4, s[8:11], s24 offen offset:3072 sc1 lds
M v[116:119], a[88:91], a[56:59], v[116:119]
 ds_read_b128 a[120:123], v7 offset:63488
M v[116:119], a[84:87], a[52:55], v[116:119]
 ds_read_b128 a[124:127], v7 offset:64512
M v[116:119], a[80:83], a[48:51], v[116:119]
 v_exp_f32 v18, v84
M v[116:119], a[76:79], a[44:47], v[116:119]
 v_exp_f32 v19, v85
M v[116:119], a[72:75], a[40:43], v[116:119]
 v_exp_f32 v20, v86
M v[116:119], a[68:71], a[36:39], v[116:119]
 s_waitcnt vmcnt(24) lgkmcnt(0)
 v_exp_f32 v21, v87
M v[116:119], a[64:67], a[32:35], v[116:119]
 s_barrier
M v[124:127], a[96:99], a[32:35], v[36:39]
 ds_read_b128 a[64:67], v2 offset:0
 v_add_f32 v27, v18, v27
M v[124:127], a[100:103], a[36:39], v[124:127]
 ds_read_b128 a[68:71], v2 offset:1024
 v_cvt_pk_bf16_f32 v60, v18, v19
M v[124:127], a[104:107], a[40:43], v[124:127]
 v_exp_f32 v22, v92
M v[124:127], a[108:111], a[44:47], v[124:127]
 ds_read_b128 a[72:75], v2 offset:2048
 v_add_f32 v27, v19, v27
M v[124:127], a[112:115], a[48:51], v[124:127]
 ds_read_b128 a[76:79], v2 offset:3072
 v_add_f32 v27, v20, v27
M v[124:127], a[116:119], a[52:55], v[124:127]
 v_exp_f32 v23, v93
M v[124:127], a[120:123], a[56:59], v[124:127]
 ds_read_b128 a[80:83], v2 offset:4096
 v_cvt_pk_bf16_f32 v61, v20, v21
M v[124:127], a[124:127], a[60:63], v[124:127]
 ds_read_b128 a[84:87], v2 offset:5120
 v_add_f32 v27, v21, v27
M v[120:123], a[124:127], a[28:31], v[32:35]
 v_exp_f32 v24, v94
M v[120:123], a[120:123], a[24:27], v[120:123]
 ds_read_b128 a[88:91], v2 offset:6144
 v_add_f32 v27, v22, v27
M v[120:123], a[116:119], a[20:23], v[120:123]
 ds_read_b128 a[92:95], v2 offset:7168
 v_cvt_pk_bf16_f32 v62, v22, v23
M v[120:123], a[112:115], a[16:19], v[120:123]
 v_exp_f32 v25, v95
M v[120:123], a[108:111], a[12:15], v[120:123]
 v_add_f32 v27, v23, v27
 v_add_f32 v27, v24, v27
M v[120:123], a[104:107], a[8:11], v[120:123]
 v_cvt_pk_bf16_f32 v63, v24, v25
 v_add_f32 v27, v25, v27
M v[120:123], a[100:103], a[4:7], v[120:123]
 s_waitcnt lgkmcnt(0)
M v[120:123], a[96:99], a[0:3], v[120:123]
 v_max_f32 v10, v26, v27
 v_cmp_lt_f32 vcc, s31, v10
 s_nop 0
 s_cbranch_vccnz L_st12
L_rt12:
M v[128:131], a[64:67], v[40:43], v[128:131]
 s_add_u32 m0, s28, 32768
 ds_read_b128 a[96:99], v2 offset:8192
 v_add_f32 v30, v26, v30
M v[128:131], a[68:71], v[56:59], v[128:131]
 ds_read_b128 a[100:103], v2 offset:9216
 v_add_f32 v31, v27, v31
M v[132:135], a[68:71], v[60:63], v[132:135]
 buffer_load_dwordx4 v3, s[8:11], s21 offen offset:0 sc1 lds
M v[132:135], a[64:67], v[44:47], v[132:135]
 s_add_u32 s3, s29, 65536
 ds_read_b128 a[104:107], v2 offset:10240
M v[140:143], a[72:75], v[44:47], v[140:143]
 ds_read_b128 a[108:111], v2 offset:11264
M v[140:143], a[76:79], v[60:63], v[140:143]
 buffer_load_dwordx4 v3, s[8:11], s21 offen offset:1024 sc1 lds
M v[136:139], a[76:79], v[56:59], v[136:139]
 ds_read_b128 a[112:115], v2 offset:12288
M v[136:139], a[72:75], v[40:43], v[136:139]
 ds_read_b128 a[116:119], v2 offset:13312
M v[144:147], a[80:83], v[40:43], v[144:147]
 buffer_store_dwordx4 a[200:203], v7, s[8:11], s3 offen sc1
M v[144:147], a[84:87], v[56:59], v[144:147]
 ds_read_b128 a[120:123], v2 offset:14336
M v[148:151], a[84:87], v[60:63], v[148:151]
 ds_read_b128 a[124:127], v2 offset:15360
M v[148:151], a[80:83], v[44:47], v[148:151]
 buffer_load_dwordx4 v3, s[8:11], s21 offen offset:2048 sc1 lds
M v[156:159], a[88:91], v[44:47], v[156:159]
 v_exp_f32 v18, v96
M v[156:159], a[92:95], v[60:63], v[156:159]
 v_exp_f32 v19, v97
M v[152:155], a[92:95], v[56:59], v[152:155]
 buffer_load_dwordx4 v3, s[8:11], s21 offen offset:3072 sc1 lds
M v[152:155], a[88:91], v[40:43], v[152:155]
 s_waitcnt lgkmcnt(0)
 v_exp_f32 v20, v98
M v[160:163], a[96:99], v[40:43], v[160:163]
 ds_read_b128 a[64:67], v2 offset:16384
 v_add_f32 v28, v18, v19
M v[160:163], a[100:103], v[56:59], v[160:163]
 s_add_u32 m0, s28, 36864
 ds_read_b128 a[68:71], v2 offset:17408
 v_cvt_pk_bf16_f32 v48, v18, v19
M v[164:167], a[100:103], v[60:63], v[164:167]
 buffer_load_dwordx4 v4, s[8:11], s21 offen offset:0 sc1 lds
M v[164:167], a[96:99], v[44:47], v[164:167]
 ds_read_b128 a[72:75], v2 offset:18432
M v[172:175], a[104:107], v[44:47], v[172:175]
 ds_read_b128 a[76:79], v2 offset:19456
M v[172:175], a[108:111], v[60:63], v[172:175]
 v_exp_f32 v21, v99
M v[168:171], a[108:111], v[56:59], v[168:171]
 ds_read_b128 a[80:83], v2 offset:20480
 v_add_f32 v28, v20, v28
M v[168:171], a[104:107], v[40:43], v[168:171]
 s_add_u32 s3, s29, 98304
 ds_read_b128 a[84:87], v2 offset:21504
 v_cvt_pk_bf16_f32 v49, v20, v21
M v[176:179], a[112:115], v[40:43], v[176:179]
 buffer_load_dwordx4 v4, s[8:11], s21 offen offset:1024 sc1 lds
M v[176:179], a[116:119], v[56:59], v[176:179]
 ds_read_b128 a[88:91], v2 offset:22528
 v_add_f32 v28, v21, v28
M v[180:183], a[116:119], v[60:63], v[180:183]
 ds_read_b128 a[92:95], v2 offset:23552
M v[180:183], a[112:115], v[44:47], v[180:183]
 buffer_load_dwordx4 v4, s[8:11], s21 offen offset:2048 sc1 lds
M v[188:191], a[120:123], v[44:47], v[188:191]
 buffer_store_dwordx4 a[204:207], v7, s[8:11], s3 offen sc1
M v[188:191], a[124:127], v[60:63], v[188:191]
 v_exp_f32 v22, v104
M v[184:187], a[124:127], v[56:59], v[184:187]
 v_exp_f32 v23, v105
M v[184:187], a[120:123], v[40:43], v[184:187]
 s_waitcnt lgkmcnt(0)
 v_exp_f32 v24, v106
M v[192:195], a[64:67], v[40:43], v[192:195]
 ds_read_b128 a[96:99], v2 offset:24576
 v_add_f32 v28, v22, v28
M v[192:195], a[68:71], v[56:59], v[192:195]
 ds_read_b128 a[100:103], v2 offset:25600
 v_cvt_pk_bf16_f32 v50, v22, v23
M v[196:199], a[68:71], v[60:63], v[196:199]
 buffer_load_dwordx4 v4, s[8:11], s21 offen offset:3072 sc1 lds
M v[196:199], a[64:67], v[44:47], v[196:199]
 s_add_u32 s24, s23, 16777216
 ds_read_b128 a[104:107], v2 offset:26624
 v_add_f32 v28, v23, v28
M v[204:207], a[72:75], v[44:47], v[204:207]
 s_mov_b32 s23, s21
 ds_read_b128 a[108:111], v2 offset:27648
M v[204:207], a[76:79], v[60:63], v[204:207]
 s_add_u32 s21, s21, 32768
 v_exp_f32 v25, v107
M v[200:203], a[76:79], v[56:59], v[200:203]
 s_add_u32 s22, s22, 1
 ds_read_b128 a[112:115], v2 offset:28672
 v_add_f32 v28, v24, v28
M v[200:203], a[72:75], v[40:43], v[200:203]
 s_cmp_eq_u32 s22, s25
 ds_read_b128 a[116:119], v2 offset:29696
 v_cvt_pk_bf16_f32 v51, v24, v25
M v[208:211], a[80:83], v[40:43], v[208:211]
 s_cselect_b32 s21, s26, s21
 v_exp_f32 v18, v100
M v[208:211], a[84:87], v[56:59], v[208:211]
 s_cmp_eq_u32 s22, s43
 ds_read_b128 a[120:123], v2 offset:30720
 v_add_f32 v28, v25, v28
M v[212:215], a[84:87], v[60:63], v[212:215]
 s_cselect_b32 s21, s4, s21
 ds_read_b128 a[124:127], v2 offset:31744
M v[212:215], a[80:83], v[44:47], v[212:215]
 s_cmp_eq_u32 s22, s6
 v_exp_f32 v19, v101
M v[220:223], a[88:91], v[44:47], v[220:223]
 s_cselect_b32 s21, s7, s21
 v_exp_f32 v20, v102
M v[220:223], a[92:95], v[60:63], v[220:223]
 v_exp_f32 v21, v103
M v[216:219], a[92:95], v[56:59], v[216:219]
 s_waitcnt vmcnt(21) lgkmcnt(0)
 v_exp_f32 v22, v108
M v[216:219], a[88:91], v[40:43], v[216:219]
 s_barrier
M v[224:227], a[96:99], v[40:43], v[224:227]
 ds_read_b128 a[64:67], v2 offset:32768
 v_add_f32 v29, v18, v19
M v[224:227], a[100:103], v[56:59], v[224:227]
 ds_read_b128 a[68:71], v2 offset:33792
 v_mov_b32 v17, 4
M v[228:231], a[100:103], v[60:63], v[228:231]
 s_waitcnt vmcnt(20)
 v_cmp_gt_u32 vcc, 3, v6
 v_cvt_pk_bf16_f32 v52, v18, v19
M v[228:231], a[96:99], v[44:47], v[228:231]
 ds_read_b128 a[72:75], v2 offset:34816
 v_add_f32 v29, v20, v29
M v[236:239], a[104:107], v[44:47], v[236:239]
 ds_read_b128 a[76:79], v2 offset:35840
 v_cvt_pk_bf16_f32 v53, v20, v21
M v[236:239], a[108:111], v[60:63], v[236:239]
 s_cbranch_vccnz L_f4s
L_f4r:
 v_exp_f32 v23, v109
M v[232:235], a[108:111], v[56:59], v[232:235]
 ds_read_b128 a[80:83], v2 offset:36864
 v_add_f32 v29, v21, v29
M v[232:235], a[104:107], v[40:43], v[232:235]
 ds_read_b128 a[84:87], v2 offset:37888
 v_add_f32 v29, v22, v29
M v[240:243], a[112:115], v[40:43], v[240:243]
 buffer_store_dword v17, v1, s[8:11], s45 offen sc1
M v[240:243], a[116:119], v[56:59], v[240:243]
 ds_read_b128 a[88:91], v2 offset:38912
 v_cvt_pk_bf16_f32 v54, v22, v23
M v[244:247], a[116:119], v[60:63], v[244:247]
 ds_read_b128 a[92:95], v2 offset:39936
 v_add_f32 v29, v23, v29
M v[244:247], a[112:115], v[44:47], v[244:247]
 v_exp_f32 v24, v110
M v[252:255], a[120:123], v[44:47], v[252:255]
 v_exp_f32 v25, v111
M v[252:255], a[124:127], v[60:63], v[252:255]
 v_add_f32 v29, v24, v29
 v_cvt_pk_bf16_f32 v55, v24, v25
M v[248:251], a[124:127], v[56:59], v[248:251]
 s_waitcnt lgkmcnt(0)
 v_add_f32 v29, v25, v29
M v[248:251], a[120:123], v[40:43], v[248:251]
M v[64:67], a[64:67], a[0:3], v[32:35]
 s_add_u32 m0, s28, 65536
 ds_read_b128 a[96:99], v2 offset:40960
M v[64:67], a[68:71], a[4:7], v[64:67]
 ds_read_b128 a[100:103], v2 offset:41984
M v[64:67], a[72:75], a[8:11], v[64:67]
 buffer_load_dwordx4 v3, s[8:11], s24 offen offset:0 sc1 lds
M v[64:67], a[76:79], a[12:15], v[64:67]
 s_cmp_lt_u32 s20, 2
 ds_read_b128 a[104:107], v2 offset:43008
M v[64:67], a[80:83], a[16:19], v[64:67]
 s_cselect_b64 s[86:87], -1, 0
 ds_read_b128 a[108:111], v2 offset:44032
M v[64:67], a[84:87], a[20:23], v[64:67]
 s_cmp_eq_u32 s20, 2
 v_exp_f32 v18, v112
M v[64:67], a[88:91], a[24:27], v[64:67]
 s_cselect_b64 s[80:81], s[16:17], s[86:87]
 ds_read_b128 a[112:115], v2 offset:45056
M v[64:67], a[92:95], a[28:31], v[64:67]
 s_cselect_b64 s[82:83], s[18:19], s[86:87]
 ds_read_b128 a[116:119], v2 offset:46080
M v[68:71], a[92:95], a[60:63], v[36:39]
 buffer_load_dwordx4 v3, s[8:11], s24 offen offset:1024 sc1 lds
M v[68:71], a[88:91], a[56:59], v[68:71]
 s_cselect_b64 s[84:85], s[48:49], s[86:87]
 ds_read_b128 a[120:123], v2 offset:47104
M v[68:71], a[84:87], a[52:55], v[68:71]
 s_cselect_b64 s[86:87], s[50:51], s[86:87]
 ds_read_b128 a[124:127], v2 offset:48128
M v[68:71], a[80:83], a[48:51], v[68:71]
 s_cmp_eq_u32 s20, 3
 v_exp_f32 v19, v113
M v[68:71], a[76:79], a[44:47], v[68:71]
 buffer_load_dwordx4 v3, s[8:11], s24 offen offset:2048 sc1 lds
M v[68:71], a[72:75], a[40:43], v[68:71]
 s_cselect_b64 s[88:89], s[16:17], -1
 v_exp_f32 v20, v114
M v[68:71], a[68:71], a[36:39], v[68:71]
 s_cselect_b64 s[90:91], s[18:19], -1
 v_exp_f32 v21, v115
M v[68:71], a[64:67], a[32:35], v[68:71]
 s_waitcnt lgkmcnt(0)
 v_exp_f32 v22, v120
M v[76:79], a[96:99], a[32:35], v[36:39]
 s_cselect_b64 s[92:93], s[48:49], -1
 ds_read_b128 a[64:67], v2 offset:49152
 v_add_f32 v28, v18, v28
M v[76:79], a[100:103], a[36:39], v[76:79]
 s_cselect_b64 s[94:95], s[50:51], -1
 ds_read_b128 a[68:71], v2 offset:50176
 v_cvt_pk_bf16_f32 v56, v18, v19
M v[76:79], a[104:107], a[40:43], v[76:79]
 buffer_load_dwordx4 v3, s[8:11], s24 offen offset:3072 sc1 lds
M v[76:79], a[108:111], a[44:47], v[76:79]
 s_add_u32 s3, s29, 131072
 ds_read_b128 a[72:75], v2 offset:51200
 v_add_f32 v28, v19, v28
M v[76:79], a[112:115], a[48:51], v[76:79]
 ds_read_b128 a[76:79], v2 offset:52224
 v_add_f32 v28, v20, v28
M v[76:79], a[116:119], a[52:55], v[76:79]
 buffer_store_dwordx4 a[208:211], v7, s[8:11], s3 offen sc1
M v[76:79], a[120:123], a[56:59], v[76:79]
 s_add_u32 m0, s28, 69632
 ds_read_b128 a[80:83], v2 offset:53248
 v_cvt_pk_bf16_f32 v57, v20, v21
M v[76:79], a[124:127], a[60:63], v[76:79]
 ds_read_b128 a[84:87], v2 offset:54272
 v_add_f32 v28, v21, v28
M v[72:75], a[124:127], a[28:31], v[32:35]
 buffer_load_dwordx4 v4, s[8:11], s24 offen offset:0 sc1 lds
M v[72:75], a[120:123], a[24:27], v[72:75]
 ds_read_b128 a[88:91], v2 offset:55296
M v[72:75], a[116:119], a[20:23], v[72:75]
 ds_read_b128 a[92:95], v2 offset:56320
M v[72:75], a[112:115], a[16:19], v[72:75]
 v_exp_f32 v23, v121
M v[72:75], a[108:111], a[12:15], v[72:75]
 buffer_load_dwordx4 v4, s[8:11], s24 offen offset:1024 sc1 lds
M v[72:75], a[104:107], a[8:11], v[72:75]
 v_exp_f32 v24, v122
M v[72:75], a[100:103], a[4:7], v[72:75]
 s_add_u32 s3, s29, 163840
 v_exp_f32 v25, v123
M v[72:75], a[96:99], a[0:3], v[72:75]
 s_waitcnt lgkmcnt(0)
 v_exp_f32 v18, v116
M v[80:83], a[64:67], a[0:3], v[32:35]
 ds_read_b128 a[96:99], v2 offset:57344
 v_add_f32 v28, v22, v28
M v[80:83], a[68:71], a[4:7], v[80:83]
 ds_read_b128 a[100:103], v2 offset:58368
 v_cvt_pk_bf16_f32 v58, v22, v23
M v[80:83], a[72:75], a[8:11], v[80:83]
 buffer_load_dwordx4 v4, s[8:11], s24 offen offset:2048 sc1 lds
M v[80:83], a[76:79], a[12:15], v[80:83]
 ds_read_b128 a[104:107], v2 offset:59392
 v_add_f32 v28, v23, v28
M v[80:83], a[80:83], a[16:19], v[80:83]
 ds_read_b128 a[108:111], v2 offset:60416
 v_add_f32 v28, v24, v28
M v[80:83], a[84:87], a[20:23], v[80:83]
 buffer_store_dwordx4 a[212:215], v7, s[8:11], s3 offen sc1
M v[80:83], a[88:91], a[24:27], v[80:83]
 ds_read_b128 a[112:115], v2 offset:61440
 v_cvt_pk_bf16_f32 v59, v24, v25
M v[80:83], a[92:95], a[28:31], v[80:83]
 ds_read_b128 a[116:119], v2 offset:62464
 v_add_f32 v28, v25, v28
M v[84:87], a[92:95], a[60:63], v[36:39]
 buffer_load_dwordx4 v4, s[8:11], s24 offen offset:3072 sc1 lds
M v[84:87], a[88:91], a[56:59], v[84:87]
 ds_read_b128 a[120:123], v2 offset:63488
M v[84:87], a[84:87], a[52:55], v[84:87]
 ds_read_b128 a[124:127], v2 offset:64512
M v[84:87], a[80:83], a[48:51], v[84:87]
 v_exp_f32 v19, v117
M v[84:87], a[76:79], a[44:47], v[84:87]
 v_exp_f32 v20, v118
M v[84:87], a[72:75], a[40:43], v[84:87]
 v_exp_f32 v21, v119
M v[84:87], a[68:71], a[36:39], v[84:87]
 s_waitcnt vmcnt(21) lgkmcnt(0)
 v_exp_f32 v22, v124
M v[84:87], a[64:67], a[32:35], v[84:87]
 s_barrier
M v[92:95], a[96:99], a[32:35], v[36:39]
 ds_read_b128 a[64:67], v7 offset:0
 v_add_f32 v29, v18, v29
M v[92:95], a[100:103], a[36:39], v[92:95]
 ds_read_b128 a[68:71], v7 offset:1024
 v_cvt_pk_bf16_f32 v60, v18, v19
M v[92:95], a[104:107], a[40:43], v[92:95]
 v_exp_f32 v23, v125
M v[92:95], a[108:111], a[44:47], v[92:95]
 ds_read_b128 a[72:75], v7 offset:2048
 v_add_f32 v29, v19, v29
M v[92:95], a[112:115], a[48:51], v[92:95]
 ds_read_b128 a[76:79], v7 offset:3072
 v_add_f32 v29, v20, v29
M v[92:95], a[116:119], a[52:55], v[92:95]
 v_exp_f32 v24, v126
M v[92:95], a[120:123], a[56:59], v[92:95]
 ds_read_b128 a[80:83], v7 offset:4096
 v_cvt_pk_bf16_f32 v61, v20, v21
M v[92:95], a[124:127], a[60:63], v[92:95]
 ds_read_b128 a[84:87], v7 offset:5120
 v_add_f32 v29, v21, v29
M v[88:91], a[124:127], a[28:31], v[32:35]
 v_exp_f32 v25, v127
M v[88:91], a[120:123], a[24:27], v[88:91]
 ds_read_b128 a[88:91], v7 offset:6144
 v_add_f32 v29, v22, v29
M v[88:91], a[116:119], a[20:23], v[88:91]
 ds_read_b128 a[92:95], v7 offset:7168
 v_cvt_pk_bf16_f32 v62, v22, v23
M v[88:91], a[112:115], a[16:19], v[88:91]
 v_add_f32 v29, v23, v29
 v_add_f32 v29, v24, v29
M v[88:91], a[108:111], a[12:15], v[88:91]
 v_cvt_pk_bf16_f32 v63, v24, v25
 v_add_f32 v29, v25, v29
M v[88:91], a[104:107], a[8:11], v[88:91]
M v[88:91], a[100:103], a[4:7], v[88:91]
 s_waitcnt lgkmcnt(0)
M v[88:91], a[96:99], a[0:3], v[88:91]
 v_max_f32 v10, v28, v29
 v_cmp_lt_f32 vcc, s31, v10
 s_nop 0
 s_cbranch_vccnz L_st13
L_rt13:
M v[128:131], a[64:67], v[48:51], v[128:131]
 s_add_u32 m0, s28, 98304
 ds_read_b128 a[96:99], v7 offset:8192
 v_add_f32 v30, v28, v30
M v[128:131], a[68:71], v[56:59], v[128:131]
 s_add_u32 s3, s29, 196608
 ds_read_b128 a[100:103], v7 offset:9216
 v_add_f32 v31, v29, v31
M v[132:135], a[68:71], v[60:63], v[132:135]
 buffer_load_dwordx4 v3, s[8:11], s21 offen offset:0 sc1 lds
M v[132:135], a[64:67], v[52:55], v[132:135]
 ds_read_b128 a[104:107], v7 offset:10240
M v[140:143], a[72:75], v[52:55], v[140:143]
 ds_read_b128 a[108:111], v7 offset:11264
M v[140:143], a[76:79], v[60:63], v[140:143]
 buffer_load_dwordx4 v3, s[8:11], s21 offen offset:1024 sc1 lds
M v[136:139], a[76:79], v[56:59], v[136:139]
 ds_read_b128 a[112:115], v7 offset:12288
M v[136:139], a[72:75], v[48:51], v[136:139]
 ds_read_b128 a[116:119], v7 offset:13312
M v[144:147], a[80:83], v[48:51], v[144:147]
 buffer_store_dwordx4 a[216:219], v7, s[8:11], s3 offen sc1
M v[144:147], a[84:87], v[56:59], v[144:147]
 ds_read_b128 a[120:123], v7 offset:14336
M v[148:151], a[84:87], v[60:63], v[148:151]
 ds_read_b128 a[124:127], v7 offset:15360
M v[148:151], a[80:83], v[52:55], v[148:151]
 buffer_load_dwordx4 v3, s[8:11], s21 offen offset:2048 sc1 lds
M v[156:159], a[88:91], v[52:55], v[156:159]
 v_exp_f32 v18, v64
M v[156:159], a[92:95], v[60:63], v[156:159]
 v_exp_f32 v19, v65
M v[152:155], a[92:95], v[56:59], v[152:155]
 buffer_load_dwordx4 v3, s[8:11], s21 offen offset:3072 sc1 lds
M v[152:155], a[88:91], v[48:51], v[152:155]
 s_waitcnt lgkmcnt(0)
 v_exp_f32 v20, v66
M v[160:163], a[96:99], v[48:51], v[160:163]
 ds_read_b128 a[64:67], v7 offset:16384
 v_add_f32 v26, v18, v19
M v[160:163], a[100:103], v[56:59], v[160:163]
 s_add_u32 m0, s28, 102400
 ds_read_b128 a[68:71], v7 offset:17408
 v_cvt_pk_bf16_f32 v40, v18, v19
M v[164:167], a[100:103], v[60:63], v[164:167]
 buffer_load_dwordx4 v4, s[8:11], s21 offen offset:0 sc1 lds
M v[164:167], a[96:99], v[52:55], v[164:167]
 ds_read_b128 a[72:75], v7 offset:18432
M v[172:175], a[104:107], v[52:55], v[172:175]
 ds_read_b128 a[76:79], v7 offset:19456
M v[172:175], a[108:111], v[60:63], v[172:175]
 v_exp_f32 v21, v67
M v[168:171], a[108:111], v[56:59], v[168:171]
 ds_read_b128 a[80:83], v7 offset:20480
 v_add_f32 v26, v20, v26
M v[168:171], a[104:107], v[48:51], v[168:171]
 ds_read_b128 a[84:87], v7 offset:21504
 v_cvt_pk_bf16_f32 v41, v20, v21
M v[176:179], a[112:115], v[48:51], v[176:179]
 buffer_load_dwordx4 v4, s[8:11], s21 offen offset:1024 sc1 lds
M v[176:179], a[116:119], v[56:59], v[176:179]
 ds_read_b128 a[88:91], v7 offset:22528
 v_add_f32 v26, v21, v26
M v[180:183], a[116:119], v[60:63], v[180:183]
 ds_read_b128 a[92:95], v7 offset:23552
M v[180:183], a[112:115], v[52:55], v[180:183]
 buffer_load_dwordx4 v4, s[8:11], s21 offen offset:2048 sc1 lds
M v[188:191], a[120:123], v[52:55], v[188:191]
 v_exp_f32 v22, v72
M v[188:191], a[124:127], v[60:63], v[188:191]
 v_exp_f32 v23, v73
M v[184:187], a[124:127], v[56:59], v[184:187]
 v_exp_f32 v24, v74
M v[184:187], a[120:123], v[48:51], v[184:187]
 s_waitcnt lgkmcnt(0)
 v_exp_f32 v25, v75
M v[192:195], a[64:67], v[48:51], v[192:195]
 ds_read_b128 a[96:99], v7 offset:24576
 v_add_f32 v26, v22, v26
M v[192:195], a[68:71], v[56:59], v[192:195]
 ds_read_b128 a[100:103], v7 offset:25600
 v_cvt_pk_bf16_f32 v42, v22, v23
M v[196:199], a[68:71], v[60:63], v[196:199]
 buffer_load_dwordx4 v4, s[8:11], s21 offen offset:3072 sc1 lds
M v[196:199], a[64:67], v[52:55], v[196:199]
 s_add_u32 s24, s23, 16777216
 ds_read_b128 a[104:107], v7 offset:26624
 v_add_f32 v26, v23, v26
M v[204:207], a[72:75], v[52:55], v[204:207]
 s_mov_b32 s23, s21
 ds_read_b128 a[108:111], v7 offset:27648
 v_add_f32 v26, v24, v26
M v[204:207], a[76:79], v[60:63], v[204:207]
 s_add_u32 s21, s21, 32768
 v_exp_f32 v18, v68
M v[200:203], a[76:79], v[56:59], v[200:203]
 s_add_u32 s22, s22, 1
 ds_read_b128 a[112:115], v7 offset:28672
 v_cvt_pk_bf16_f32 v43, v24, v25
M v[200:203], a[72:75], v[48:51], v[200:203]
 s_cmp_eq_u32 s22, s25
 ds_read_b128 a[116:119], v7 offset:29696
 v_add_f32 v26, v25, v26
M v[208:211], a[80:83], v[48:51], v[208:211]
 s_cselect_b32 s21, s26, s21
 v_exp_f32 v19, v69
M v[208:211], a[84:87], v[56:59], v[208:211]
 s_cmp_eq_u32 s22, s43
 ds_read_b128 a[120:123], v7 offset:30720
 v_add_f32 v27, v18, v19
M v[212:215], a[84:87], v[60:63], v[212:215]
 s_cselect_b32 s21, s4, s21
 ds_read_b128 a[124:127], v7 offset:31744
 v_cvt_pk_bf16_f32 v44, v18, v19
M v[212:215], a[80:83], v[52:55], v[212:215]
 s_cmp_eq_u32 s22, s6
 v_exp_f32 v20, v70
M v[220:223], a[88:91], v[52:55], v[220:223]
 s_cselect_b32 s21, s7, s21
 v_exp_f32 v21, v71
M v[220:223], a[92:95], v[60:63], v[220:223]
 v_exp_f32 v22, v76
M v[216:219], a[92:95], v[56:59], v[216:219]
 s_waitcnt vmcnt(20) lgkmcnt(0)
 v_add_f32 v27, v20, v27
 v_cvt_pk_bf16_f32 v45, v20, v21
M v[216:219], a[88:91], v[48:51], v[216:219]
 s_barrier
M v[224:227], a[96:99], v[48:51], v[224:227]
 ds_read_b128 a[64:67], v7 offset:32768
 v_add_f32 v27, v21, v27
M v[224:227], a[100:103], v[56:59], v[224:227]
 ds_read_b128 a[68:71], v7 offset:33792
M v[228:231], a[100:103], v[60:63], v[228:231]
 v_exp_f32 v23, v77
M v[228:231], a[96:99], v[52:55], v[228:231]
 ds_read_b128 a[72:75], v7 offset:34816
 v_add_f32 v27, v22, v27
M v[236:239], a[104:107], v[52:55], v[236:239]
 ds_read_b128 a[76:79], v7 offset:35840
 v_cvt_pk_bf16_f32 v46, v22, v23
M v[236:239], a[108:111], v[60:63], v[236:239]
 v_exp_f32 v24, v78
M v[232:235], a[108:111], v[56:59], v[232:235]
 ds_read_b128 a[80:83], v7 offset:36864
 v_add_f32 v27, v23, v27
M v[232:235], a[104:107], v[48:51], v[232:235]
 ds_read_b128 a[84:87], v7 offset:37888
M v[240:243], a[112:115], v[48:51], v[240:243]
 v_exp_f32 v25, v79
M v[240:243], a[116:119], v[56:59], v[240:243]
 ds_read_b128 a[88:91], v7 offset:38912
 v_add_f32 v27, v24, v27
M v[244:247], a[116:119], v[60:63], v[244:247]
 ds_read_b128 a[92:95], v7 offset:39936
 v_cvt_pk_bf16_f32 v47, v24, v25
M v[244:247], a[112:115], v[52:55], v[244:247]
 v_add_f32 v27, v25, v27
M v[252:255], a[120:123], v[52:55], v[252:255]
M v[252:255], a[124:127], v[60:63], v[252:255]
M v[248:251], a[124:127], v[56:59], v[248:251]
 s_waitcnt lgkmcnt(0)
M v[248:251], a[120:123], v[48:51], v[248:251]
 s_branch L_loop_mid
L_zs0:
 s_mov_b32 s64, 65536
L_zs0_l:
 s_sleep 2
 buffer_load_dword v17, v16, s[12:15], 0 offen offset:64 sc1
 s_sub_u32 s64, s64, 1
 s_cbranch_scc1 L_zs0_x
 s_waitcnt vmcnt(0)
 v_cmp_ne_u32 vcc, 1, v17
 s_nop 0
 s_cbranch_vccnz L_zs0_l
L_zs0_x:
 s_waitcnt vmcnt(0)
 s_branch L_zr0
L_zs1:
 s_mov_b32 s64, 65536
L_zs1_l:
 s_sleep 2
 buffer_load_dword v17, v16, s[12:15], 0 offen offset:64 sc1
 s_sub_u32 s64, s64, 1
 s_cbranch_scc1 L_zs1_x
 s_waitcnt vmcnt(0)
 v_cmp_ne_u32 vcc, 1, v17
 s_nop 0
 s_cbranch_vccnz L_zs1_l
L_zs1_x:
 s_waitcnt vmcnt(0)
 s_branch L_zr1
L_hs:
 s_mov_b32 s91, 65536
L_hs_l:
 buffer_load_dwordx4 v[16:19], v7, s[8:11], s67 offen offset:0 sc1
 buffer_load_dwordx4 v[20:23], v7, s[8:11], s67 offen offset:1024 sc1
 s_waitcnt vmcnt(0)
 s_sub_u32 s91, s91, 1
 s_cbranch_scc1 L_hr
 v_min3_u32 v28, v16, v17, v18
 v_min3_u32 v28, v28, v19, v20
 v_min3_u32 v28, v28, v21, v22
 v_min_u32 v28, v28, v23
 v_cmp_eq_u32 vcc, 0, v28
 s_nop 0
 s_cbranch_vccnz L_hs_l
 s_branch L_hr
L_f1s04:
 s_mov_b32 s91, 65536
L_f1s04_l:
 s_sleep 2
 buffer_load_dword v24, v13, s[8:11], s46 offen sc1
 s_sub_u32 s91, s91, 1
 s_cbranch_scc1 L_f1s04_x
 s_waitcnt vmcnt(0)
 v_cmp_eq_u32 vcc, 0, v24
 s_nop 0
 s_cbranch_vccnz L_f1s04_l
L_f1s04_x:
 s_waitcnt vmcnt(0)
 s_branch L_f1r04
L_f1s05:
 s_mov_b32 s91, 65536
L_f1s05_l:
 s_sleep 2
 buffer_load_dword v24, v9, s[8:11], s46 offen sc1
 s_sub_u32 s91, s91, 1
 s_cbranch_scc1 L_f1s05_x
 s_waitcnt vmcnt(0)
 v_cmp_eq_u32 vcc, 0, v24
 s_nop 0
 s_cbranch_vccnz L_f1s05_l
L_f1s05_x:
 s_waitcnt vmcnt(0)
 s_branch L_f1r05
L_f1s14:
 s_mov_b32 s91, 65536
L_f1s14_l:
 s_sleep 2
 buffer_load_dword v24, v13, s[8:11], s46 offen sc1
 s_sub_u32 s91, s91, 1
 s_cbranch_scc1 L_f1s14_x
 s_waitcnt vmcnt(0)
 v_cmp_eq_u32 vcc, 0, v24
 s_nop 0
 s_cbranch_vccnz L_f1s14_l
L_f1s14_x:
 s_waitcnt vmcnt(0)
 s_branch L_f1r14
L_f1s15:
 s_mov_b32 s91, 65536
L_f1s15_l:
 s_sleep 2
 buffer_load_dword v24, v9, s[8:11], s46 offen sc1
 s_sub_u32 s91, s91, 1
 s_cbranch_scc1 L_f1s15_x
 s_waitcnt vmcnt(0)
 v_cmp_eq_u32 vcc, 0, v24
 s_nop 0
 s_cbranch_vccnz L_f1s15_l
L_f1s15_x:
 s_waitcnt vmcnt(0)
 s_branch L_f1r15
.p2align 6
L_loop_top:
M v[64:67], a[64:67], a[0:3], v[32:35]
 s_add_u32 m0, s28, 65536
 ds_read_b128 a[96:99], v2 offset:40960
M v[64:67], a[68:71], a[4:7], v[64:67]
 ds_read_b128 a[100:103], v2 offset:41984
M v[64:67], a[72:75], a[8:11], v[64:67]
 buffer_load_dword a240, v0, s[60:63], 0 offen offset:0
M v[64:67], a[76:79], a[12:15], v[64:67]
 ds_read_b128 a[104:107], v2 offset:43008
M v[64:67], a[80:83], a[16:19], v[64:67]
 ds_read_b128 a[108:111], v2 offset:44032
M v[64:67], a[84:87], a[20:23], v[64:67]
 buffer_load_dwordx4 v3, s[8:11], s24 offen offset:0 sc1 lds
M v[64:67], a[88:91], a[24:27], v[64:67]
 ds_read_b128 a[112:115], v2 offset:45056
M v[64:67], a[92:95], a[28:31], v[64:67]
 ds_read_b128 a[116:119], v2 offset:46080
M v[68:71], a[92:95], a[60:63], v[36:39]
 buffer_load_dwordx4 v3, s[8:11], s24 offen offset:1024 sc1 lds
M v[68:71], a[88:91], a[56:59], v[68:71]
 ds_read_b128 a[120:123], v2 offset:47104
M v[68:71], a[84:87], a[52:55], v[68:71]
 ds_read_b128 a[124:127], v2 offset:48128
M v[68:71], a[80:83], a[48:51], v[68:71]
 v_exp_f32 v18, v112
M v[68:71], a[76:79], a[44:47], v[68:71]
 buffer_load_dwordx4 v3, s[8:11], s24 offen offset:2048 sc1 lds
M v[68:71], a[72:75], a[40:43], v[68:71]
 v_exp_f32 v19, v113
M v[68:71], a[68:71], a[36:39], v[68:71]
 v_exp_f32 v20, v114
M v[68:71], a[64:67], a[32:35], v[68:71]
 s_waitcnt lgkmcnt(0)
 v_exp_f32 v21, v115
M v[76:79], a[96:99], a[32:35], v[36:39]
 ds_read_b128 a[64:67], v2 offset:49152
 v_add_f32 v28, v18, v28
M v[76:79], a[100:103], a[36:39], v[76:79]
 ds_read_b128 a[68:71], v2 offset:50176
 v_cvt_pk_bf16_f32 v56, v18, v19
M v[76:79], a[104:107], a[40:43], v[76:79]
 buffer_load_dwordx4 v3, s[8:11], s24 offen offset:3072 sc1 lds
M v[76:79], a[108:111], a[44:47], v[76:79]
 ds_read_b128 a[72:75], v2 offset:51200
 v_add_f32 v28, v19, v28
M v[76:79], a[112:115], a[48:51], v[76:79]
 ds_read_b128 a[76:79], v2 offset:52224
 v_add_f32 v28, v20, v28
M v[76:79], a[116:119], a[52:55], v[76:79]
 v_exp_f32 v22, v120
M v[76:79], a[120:123], a[56:59], v[76:79]
 s_add_u32 m0, s28, 69632
 ds_read_b128 a[80:83], v2 offset:53248
 v_cvt_pk_bf16_f32 v57, v20, v21
M v[76:79], a[124:127], a[60:63], v[76:79]
 ds_read_b128 a[84:87], v2 offset:54272
 v_add_f32 v28, v21, v28
M v[72:75], a[124:127], a[28:31], v[32:35]
 buffer_load_dwordx4 v4, s[8:11], s24 offen offset:0 sc1 lds
M v[72:75], a[120:123], a[24:27], v[72:75]
 ds_read_b128 a[88:91], v2 offset:55296
M v[72:75], a[116:119], a[20:23], v[72:75]
 ds_read_b128 a[92:95], v2 offset:56320
M v[72:75], a[112:115], a[16:19], v[72:75]
 v_exp_f32 v23, v121
M v[72:75], a[108:111], a[12:15], v[72:75]
 buffer_load_dwordx4 v4, s[8:11], s24 offen offset:1024 sc1 lds
M v[72:75], a[104:107], a[8:11], v[72:75]
 v_exp_f32 v24, v122
M v[72:75], a[100:103], a[4:7], v[72:75]
 v_exp_f32 v25, v123
M v[72:75], a[96:99], a[0:3], v[72:75]
 s_waitcnt lgkmcnt(0)
 v_exp_f32 v18, v116
M v[80:83], a[64:67], a[0:3], v[32:35]
 ds_read_b128 a[96:99], v2 offset:57344
 v_add_f32 v28, v22, v28
M v[80:83], a[68:71], a[4:7], v[80:83]
 ds_read_b128 a[100:103], v2 offset:58368
 v_cvt_pk_bf16_f32 v58, v22, v23
M v[80:83], a[72:75], a[8:11], v[80:83]
 buffer_load_dwordx4 v4, s[8:11], s24 offen offset:2048 sc1 lds
M v[80:83], a[76:79], a[12:15], v[80:83]
 ds_read_b128 a[104:107], v2 offset:59392
 v_add_f32 v28, v23, v28
M v[80:83], a[80:83], a[16:19], v[80:83]
 ds_read_b128 a[108:111], v2 offset:60416
 v_add_f32 v28, v24, v28
M v[80:83], a[84:87], a[20:23], v[80:83]
 v_exp_f32 v19, v117
M v[80:83], a[88:91], a[24:27], v[80:83]
 ds_read_b128 a[112:115], v2 offset:61440
 v_cvt_pk_bf16_f32 v59, v24, v25
M v[80:83], a[92:95], a[28:31], v[80:83]
 ds_read_b128 a[116:119], v2 offset:62464
 v_add_f32 v28, v25, v28
M v[84:87], a[92:95], a[60:63], v[36:39]
 buffer_load_dwordx4 v4, s[8:11], s24 offen offset:3072 sc1 lds
M v[84:87], a[88:91], a[56:59], v[84:87]
 ds_read_b128 a[120:123], v2 offset:63488
 v_add_f32 v29, v18, v29
M v[84:87], a[84:87], a[52:55], v[84:87]
 ds_read_b128 a[124:127], v2 offset:64512
 v_cvt_pk_bf16_f32 v60, v18, v19
M v[84:87], a[80:83], a[48:51], v[84:87]
 v_exp_f32 v20, v118
M v[84:87], a[76:79], a[44:47], v[84:87]
 v_exp_f32 v21, v119
M v[84:87], a[72:75], a[40:43], v[84:87]
 v_exp_f32 v22, v124
M v[84:87], a[68:71], a[36:39], v[84:87]
 s_waitcnt vmcnt(17) lgkmcnt(0)
 v_exp_f32 v23, v125
M v[84:87], a[64:67], a[32:35], v[84:87]
 s_barrier
M v[92:95], a[96:99], a[32:35], v[36:39]
 ds_read_b128 a[64:67], v7 offset:0
 v_add_f32 v29, v19, v29
M v[92:95], a[100:103], a[36:39], v[92:95]
 ds_read_b128 a[68:71], v7 offset:1024
 v_add_f32 v29, v20, v29
M v[92:95], a[104:107], a[40:43], v[92:95]
 v_exp_f32 v24, v126
M v[92:95], a[108:111], a[44:47], v[92:95]
 ds_read_b128 a[72:75], v7 offset:2048
 v_cvt_pk_bf16_f32 v61, v20, v21
M v[92:95], a[112:115], a[48:51], v[92:95]
 ds_read_b128 a[76:79], v7 offset:3072
 v_add_f32 v29, v21, v29
M v[92:95], a[116:119], a[52:55], v[92:95]
 v_exp_f32 v25, v127
M v[92:95], a[120:123], a[56:59], v[92:95]
 ds_read_b128 a[80:83], v7 offset:4096
 v_add_f32 v29, v22, v29
M v[92:95], a[124:127], a[60:63], v[92:95]
 ds_read_b128 a[84:87], v7 offset:5120
 v_cvt_pk_bf16_f32 v62, v22, v23
M v[88:91], a[124:127], a[28:31], v[32:35]
 v_add_f32 v29, v23, v29
 v_add_f32 v29, v24, v29
M v[88:91], a[120:123], a[24:27], v[88:91]
 ds_read_b128 a[88:91], v7 offset:6144
 v_cvt_pk_bf16_f32 v63, v24, v25
M v[88:91], a[116:119], a[20:23], v[88:91]
 ds_read_b128 a[92:95], v7 offset:7168
 v_add_f32 v29, v25, v29
M v[88:91], a[112:115], a[16:19], v[88:91]
 v_max_f32 v10, v28, v29
M v[88:91], a[108:111], a[12:15], v[88:91]
 v_cmp_lt_f32 vcc, s31, v10
M v[88:91], a[104:107], a[8:11], v[88:91]
M v[88:91], a[100:103], a[4:7], v[88:91]
 s_waitcnt lgkmcnt(0)
M v[88:91], a[96:99], a[0:3], v[88:91]
 s_cbranch_vccnz L_st1
L_rt1:
M v[128:131], a[64:67], v[48:51], v[128:131]
 s_add_u32 m0, s28, 98304
 ds_read_b128 a[96:99], v7 offset:8192
 v_add_f32 v30, v28, v30
M v[128:131], a[68:71], v[56:59], v[128:131]
 ds_read_b128 a[100:103], v7 offset:9216
 v_add_f32 v31, v29, v31
M v[132:135], a[68:71], v[60:63], v[132:135]
 buffer_load_dwordx4 v3, s[8:11], s21 offen offset:0 sc1 lds
M v[132:135], a[64:67], v[52:55], v[132:135]
 ds_read_b128 a[104:107], v7 offset:10240
M v[140:143], a[72:75], v[52:55], v[140:143]
 ds_read_b128 a[108:111], v7 offset:11264
M v[140:143], a[76:79], v[60:63], v[140:143]
 buffer_load_dwordx4 v3, s[8:11], s21 offen offset:1024 sc1 lds
M v[136:139], a[76:79], v[56:59], v[136:139]
 ds_read_b128 a[112:115], v7 offset:12288
M v[136:139], a[72:75], v[48:51], v[136:139]
 ds_read_b128 a[116:119], v7 offset:13312
M v[144:147], a[80:83], v[48:51], v[144:147]
 v_exp_f32 v18, v64
M v[144:147], a[84:87], v[56:59], v[144:147]
 ds_read_b128 a[120:123], v7 offset:14336
M v[148:151], a[84:87], v[60:63], v[148:151]
 ds_read_b128 a[124:127], v7 offset:15360
M v[148:151], a[80:83], v[52:55], v[148:151]
 buffer_load_dwordx4 v3, s[8:11], s21 offen offset:2048 sc1 lds
M v[156:159], a[88:91], v[52:55], v[156:159]
 v_exp_f32 v19, v65
M v[156:159], a[92:95], v[60:63], v[156:159]
 v_exp_f32 v20, v66
M v[152:155], a[92:95], v[56:59], v[152:155]
 buffer_load_dwordx4 v3, s[8:11], s21 offen offset:3072 sc1 lds
M v[152:155], a[88:91], v[48:51], v[152:155]
 s_waitcnt lgkmcnt(0)
 v_exp_f32 v21, v67
M v[160:163], a[96:99], v[48:51], v[160:163]
 ds_read_b128 a[64:67], v7 offset:16384
 v_add_f32 v26, v18, v19
M v[160:163], a[100:103], v[56:59], v[160:163]
 s_add_u32 m0, s28, 102400
 ds_read_b128 a[68:71], v7 offset:17408
 v_cvt_pk_bf16_f32 v40, v18, v19
M v[164:167], a[100:103], v[60:63], v[164:167]
 buffer_load_dwordx4 v4, s[8:11], s21 offen offset:0 sc1 lds
M v[164:167], a[96:99], v[52:55], v[164:167]
 ds_read_b128 a[72:75], v7 offset:18432
 v_add_f32 v26, v20, v26
M v[172:175], a[104:107], v[52:55], v[172:175]
 ds_read_b128 a[76:79], v7 offset:19456
 v_cvt_pk_bf16_f32 v41, v20, v21
M v[172:175], a[108:111], v[60:63], v[172:175]
 v_exp_f32 v22, v72
M v[168:171], a[108:111], v[56:59], v[168:171]
 ds_read_b128 a[80:83], v7 offset:20480
 v_add_f32 v26, v21, v26
M v[168:171], a[104:107], v[48:51], v[168:171]
 ds_read_b128 a[84:87], v7 offset:21504
M v[176:179], a[112:115], v[48:51], v[176:179]
 buffer_load_dwordx4 v4, s[8:11], s21 offen offset:1024 sc1 lds
M v[176:179], a[116:119], v[56:59], v[176:179]
 ds_read_b128 a[88:91], v7 offset:22528
M v[180:183], a[116:119], v[60:63], v[180:183]
 ds_read_b128 a[92:95], v7 offset:23552
M v[180:183], a[112:115], v[52:55], v[180:183]
 buffer_load_dwordx4 v4, s[8:11], s21 offen offset:2048 sc1 lds
M v[188:191], a[120:123], v[52:55], v[188:191]
 v_exp_f32 v23, v73
M v[188:191], a[124:127], v[60:63], v[188:191]
 v_exp_f32 v24, v74
M v[184:187], a[124:127], v[56:59], v[184:187]
 v_exp_f32 v25, v75
M v[184:187], a[120:123], v[48:51], v[184:187]
 s_waitcnt lgkmcnt(0)
 v_exp_f32 v18, v68
M v[192:195], a[64:67], v[48:51], v[192:195]
 ds_read_b128 a[96:99], v7 offset:24576
 v_add_f32 v26, v22, v26
M v[192:195], a[68:71], v[56:59], v[192:195]
 ds_read_b128 a[100:103], v7 offset:25600
 v_cvt_pk_bf16_f32 v42, v22, v23
M v[196:199], a[68:71], v[60:63], v[196:199]
 buffer_load_dwordx4 v4, s[8:11], s21 offen offset:3072 sc1 lds
M v[196:199], a[64:67], v[52:55], v[196:199]
 s_add_u32 s24, s23, 16777216
 ds_read_b128 a[104:107], v7 offset:26624
 v_add_f32 v26, v23, v26
M v[204:207], a[72:75], v[52:55], v[204:207]
 s_mov_b32 s23, s21
 ds_read_b128 a[108:111], v7 offset:27648
 v_add_f32 v26, v24, v26
M v[204:207], a[76:79], v[60:63], v[204:207]
 s_add_u32 s21, s21, 32768
 v_exp_f32 v19, v69
M v[200:203], a[76:79], v[56:59], v[200:203]
 s_add_u32 s22, s22, 1
 ds_read_b128 a[112:115], v7 offset:28672
 v_cvt_pk_bf16_f32 v43, v24, v25
M v[200:203], a[72:75], v[48:51], v[200:203]
 s_cmp_eq_u32 s22, s25
 ds_read_b128 a[116:119], v7 offset:29696
 v_add_f32 v26, v25, v26
M v[208:211], a[80:83], v[48:51], v[208:211]
 s_cselect_b32 s21, s26, s21
 v_exp_f32 v20, v70
M v[208:211], a[84:87], v[56:59], v[208:211]
 s_cmp_eq_u32 s22, s43
 ds_read_b128 a[120:123], v7 offset:30720
 v_add_f32 v27, v18, v19
M v[212:215], a[84:87], v[60:63], v[212:215]
 s_cselect_b32 s21, s4, s21
 ds_read_b128 a[124:127], v7 offset:31744
 v_cvt_pk_bf16_f32 v44, v18, v19
M v[212:215], a[80:83], v[52:55], v[212:215]
 s_cmp_eq_u32 s22, s6
 v_exp_f32 v21, v71
M v[220:223], a[88:91], v[52:55], v[220:223]
 s_cselect_b32 s21, s7, s21
 v_exp_f32 v22, v76
M v[220:223], a[92:95], v[60:63], v[220:223]
 v_add_f32 v27, v20, v27
 v_cvt_pk_bf16_f32 v45, v20, v21
M v[216:219], a[92:95], v[56:59], v[216:219]
 s_waitcnt vmcnt(17) lgkmcnt(0)
 v_add_f32 v27, v21, v27
M v[216:219], a[88:91], v[48:51], v[216:219]
 s_barrier
M v[224:227], a[96:99], v[48:51], v[224:227]
 ds_read_b128 a[64:67], v7 offset:32768
M v[224:227], a[100:103], v[56:59], v[224:227]
 ds_read_b128 a[68:71], v7 offset:33792
M v[228:231], a[100:103], v[60:63], v[228:231]
 v_exp_f32 v23, v77
M v[228:231], a[96:99], v[52:55], v[228:231]
 ds_read_b128 a[72:75], v7 offset:34816
 v_add_f32 v27, v22, v27
M v[236:239], a[104:107], v[52:55], v[236:239]
 ds_read_b128 a[76:79], v7 offset:35840
 v_cvt_pk_bf16_f32 v46, v22, v23
M v[236:239], a[108:111], v[60:63], v[236:239]
 v_exp_f32 v24, v78
M v[232:235], a[108:111], v[56:59], v[232:235]
 ds_read_b128 a[80:83], v7 offset:36864
 v_add_f32 v27, v23, v27
M v[232:235], a[104:107], v[48:51], v[232:235]
 ds_read_b128 a[84:87], v7 offset:37888
M v[240:243], a[112:115], v[48:51], v[240:243]
 v_exp_f32 v25, v79
M v[240:243], a[116:119], v[56:59], v[240:243]
 ds_read_b128 a[88:91], v7 offset:38912
 v_add_f32 v27, v24, v27
M v[244:247], a[116:119], v[60:63], v[244:247]
 ds_read_b128 a[92:95], v7 offset:39936
 v_cvt_pk_bf16_f32 v47, v24, v25
M v[244:247], a[112:115], v[52:55], v[244:247]
 v_add_f32 v27, v25, v27
M v[252:255], a[120:123], v[52:55], v[252:255]
M v[252:255], a[124:127], v[60:63], v[252:255]
M v[248:251], a[124:127], v[56:59], v[248:251]
 s_waitcnt lgkmcnt(0)
M v[248:251], a[120:123], v[48:51], v[248:251]
L_loop_mid:
M v[96:99], a[64:67], a[0:3], v[32:35]
 s_and_b32 s39, s54, 15
 ds_read_b128 a[96:99], v7 offset:40960
M v[96:99], a[68:71], a[4:7], v[96:99]
 s_cbranch_scc1 L_fll
L_fllr:
 ds_read_b128 a[100:103], v7 offset:41984
M v[96:99], a[72:75], a[8:11], v[96:99]
 s_lshr_b32 s54, s54, 4
 v_exp_f32 v18, v80
M v[96:99], a[76:79], a[12:15], v[96:99]
 s_add_u32 m0, s28, 0
 ds_read_b128 a[104:107], v7 offset:43008
M v[96:99], a[80:83], a[16:19], v[96:99]
 ds_read_b128 a[108:111], v7 offset:44032
M v[96:99], a[84:87], a[20:23], v[96:99]
 buffer_load_dwordx4 v3, s[8:11], s24 offen offset:0 sc1 lds
M v[96:99], a[88:91], a[24:27], v[96:99]
 ds_read_b128 a[112:115], v7 offset:45056
M v[96:99], a[92:95], a[28:31], v[96:99]
 ds_read_b128 a[116:119], v7 offset:46080
M v[100:103], a[92:95], a[60:63], v[36:39]
 v_exp_f32 v19, v81
M v[100:103], a[88:91], a[56:59], v[100:103]
 ds_read_b128 a[120:123], v7 offset:47104
 v_add_f32 v26, v18, v26
M v[100:103], a[84:87], a[52:55], v[100:103]
 ds_read_b128 a[124:127], v7 offset:48128
 v_cvt_pk_bf16_f32 v56, v18, v19
M v[100:103], a[80:83], a[48:51], v[100:103]
 buffer_load_dwordx4 v3, s[8:11], s24 offen offset:1024 sc1 lds
M v[100:103], a[76:79], a[44:47], v[100:103]
 v_exp_f32 v20, v82
M v[100:103], a[72:75], a[40:43], v[100:103]
 v_exp_f32 v21, v83
M v[100:103], a[68:71], a[36:39], v[100:103]
 buffer_load_dwordx4 v3, s[8:11], s24 offen offset:2048 sc1 lds
M v[100:103], a[64:67], a[32:35], v[100:103]
 s_waitcnt lgkmcnt(0)
 v_exp_f32 v22, v88
M v[108:111], a[96:99], a[32:35], v[36:39]
 ds_read_b128 a[64:67], v7 offset:49152
 v_add_f32 v26, v19, v26
M v[108:111], a[100:103], a[36:39], v[108:111]
 ds_read_b128 a[68:71], v7 offset:50176
 v_add_f32 v26, v20, v26
M v[108:111], a[104:107], a[40:43], v[108:111]
 v_exp_f32 v23, v89
M v[108:111], a[108:111], a[44:47], v[108:111]
 ds_read_b128 a[72:75], v7 offset:51200
 v_cvt_pk_bf16_f32 v57, v20, v21
M v[108:111], a[112:115], a[48:51], v[108:111]
 ds_read_b128 a[76:79], v7 offset:52224
 v_add_f32 v26, v21, v26
M v[108:111], a[116:119], a[52:55], v[108:111]
 buffer_load_dwordx4 v3, s[8:11], s24 offen offset:3072 sc1 lds
M v[108:111], a[120:123], a[56:59], v[108:111]
 ds_read_b128 a[80:83], v7 offset:53248
 v_add_f32 v26, v22, v26
M v[108:111], a[124:127], a[60:63], v[108:111]
 s_add_u32 m0, s28, 4096
 ds_read_b128 a[84:87], v7 offset:54272
 v_cvt_pk_bf16_f32 v58, v22, v23
M v[104:107], a[124:127], a[28:31], v[32:35]
 buffer_load_dwordx4 v4, s[8:11], s24 offen offset:0 sc1 lds
M v[104:107], a[120:123], a[24:27], v[104:107]
 ds_read_b128 a[88:91], v7 offset:55296
 v_add_f32 v26, v23, v26
M v[104:107], a[116:119], a[20:23], v[104:107]
 ds_read_b128 a[92:95], v7 offset:56320
M v[104:107], a[112:115], a[16:19], v[104:107]
 v_exp_f32 v24, v90
M v[104:107], a[108:111], a[12:15], v[104:107]
 v_exp_f32 v25, v91
M v[104:107], a[104:107], a[8:11], v[104:107]
 buffer_load_dwordx4 v4, s[8:11], s24 offen offset:1024 sc1 lds
M v[104:107], a[100:103], a[4:7], v[104:107]
 v_exp_f32 v18, v84
M v[104:107], a[96:99], a[0:3], v[104:107]
 s_waitcnt lgkmcnt(0)
 v_exp_f32 v19, v85
M v[112:115], a[64:67], a[0:3], v[32:35]
 ds_read_b128 a[96:99], v7 offset:57344
 v_add_f32 v26, v24, v26
M v[112:115], a[68:71], a[4:7], v[112:115]
 ds_read_b128 a[100:103], v7 offset:58368
 v_cvt_pk_bf16_f32 v59, v24, v25
M v[112:115], a[72:75], a[8:11], v[112:115]
 buffer_load_dwordx4 v4, s[8:11], s24 offen offset:2048 sc1 lds
M v[112:115], a[76:79], a[12:15], v[112:115]
 ds_read_b128 a[104:107], v7 offset:59392
 v_add_f32 v26, v25, v26
M v[112:115], a[80:83], a[16:19], v[112:115]
 ds_read_b128 a[108:111], v7 offset:60416
 v_add_f32 v27, v18, v27
M v[112:115], a[84:87], a[20:23], v[112:115]
 v_exp_f32 v20, v86
M v[112:115], a[88:91], a[24:27], v[112:115]
 ds_read_b128 a[112:115], v7 offset:61440
 v_cvt_pk_bf16_f32 v60, v18, v19
M v[112:115], a[92:95], a[28:31], v[112:115]
 ds_read_b128 a[116:119], v7 offset:62464
 v_add_f32 v27, v19, v27
M v[116:119], a[92:95], a[60:63], v[36:39]
 buffer_load_dwordx4 v4, s[8:11], s24 offen offset:3072 sc1 lds
M v[116:119], a[88:91], a[56:59], v[116:119]
 ds_read_b128 a[120:123], v7 offset:63488
M v[116:119], a[84:87], a[52:55], v[116:119]
 ds_read_b128 a[124:127], v7 offset:64512
M v[116:119], a[80:83], a[48:51], v[116:119]
 v_exp_f32 v21, v87
M v[116:119], a[76:79], a[44:47], v[116:119]
 v_exp_f32 v22, v92
M v[116:119], a[72:75], a[40:43], v[116:119]
 v_exp_f32 v23, v93
M v[116:119], a[68:71], a[36:39], v[116:119]
 s_waitcnt vmcnt(16) lgkmcnt(0)
 v_add_f32 v27, v20, v27
 v_cvt_pk_bf16_f32 v61, v20, v21
M v[116:119], a[64:67], a[32:35], v[116:119]
 s_barrier
M v[124:127], a[96:99], a[32:35], v[36:39]
 ds_read_b128 a[64:67], v2 offset:0
 v_add_f32 v27, v21, v27
M v[124:127], a[100:103], a[36:39], v[124:127]
 ds_read_b128 a[68:71], v2 offset:1024
 v_add_f32 v27, v22, v27
M v[124:127], a[104:107], a[40:43], v[124:127]
 v_exp_f32 v24, v94
M v[124:127], a[108:111], a[44:47], v[124:127]
 ds_read_b128 a[72:75], v2 offset:2048
 v_cvt_pk_bf16_f32 v62, v22, v23
M v[124:127], a[112:115], a[48:51], v[124:127]
 ds_read_b128 a[76:79], v2 offset:3072
 v_add_f32 v27, v23, v27
M v[124:127], a[116:119], a[52:55], v[124:127]
 v_exp_f32 v25, v95
M v[124:127], a[120:123], a[56:59], v[124:127]
 ds_read_b128 a[80:83], v2 offset:4096
 v_add_f32 v27, v24, v27
M v[124:127], a[124:127], a[60:63], v[124:127]
 ds_read_b128 a[84:87], v2 offset:5120
 v_cvt_pk_bf16_f32 v63, v24, v25
M v[120:123], a[124:127], a[28:31], v[32:35]
 v_add_f32 v27, v25, v27
M v[120:123], a[120:123], a[24:27], v[120:123]
 ds_read_b128 a[88:91], v2 offset:6144
M v[120:123], a[116:119], a[20:23], v[120:123]
 ds_read_b128 a[92:95], v2 offset:7168
 v_max_f32 v10, v26, v27
M v[120:123], a[112:115], a[16:19], v[120:123]
 v_cmp_lt_f32 vcc, s31, v10
M v[120:123], a[108:111], a[12:15], v[120:123]
M v[120:123], a[104:107], a[8:11], v[120:123]
M v[120:123], a[100:103], a[4:7], v[120:123]
 s_waitcnt lgkmcnt(0)
M v[120:123], a[96:99], a[0:3], v[120:123]
 s_cbranch_vccnz L_st0
L_rt0:
M v[128:131], a[64:67], v[40:43], v[128:131]
 s_add_u32 m0, s28, 32768
 ds_read_b128 a[96:99], v2 offset:8192
 v_add_f32 v30, v26, v30
M v[128:131], a[68:71], v[56:59], v[128:131]
 ds_read_b128 a[100:103], v2 offset:9216
 v_add_f32 v31, v27, v31
M v[132:135], a[68:71], v[60:63], v[132:135]
 buffer_load_dwordx4 v3, s[8:11], s21 offen offset:0 sc1 lds
M v[132:135], a[64:67], v[44:47], v[132:135]
 ds_read_b128 a[104:107], v2 offset:10240
M v[140:143], a[72:75], v[44:47], v[140:143]
 ds_read_b128 a[108:111], v2 offset:11264
M v[140:143], a[76:79], v[60:63], v[140:143]
 buffer_load_dwordx4 v3, s[8:11], s21 offen offset:1024 sc1 lds
M v[136:139], a[76:79], v[56:59], v[136:139]
 ds_read_b128 a[112:115], v2 offset:12288
M v[136:139], a[72:75], v[40:43], v[136:139]
 ds_read_b128 a[116:119], v2 offset:13312
M v[144:147], a[80:83], v[40:43], v[144:147]
 v_exp_f32 v18, v96
M v[144:147], a[84:87], v[56:59], v[144:147]
 ds_read_b128 a[120:123], v2 offset:14336
M v[148:151], a[84:87], v[60:63], v[148:151]
 ds_read_b128 a[124:127], v2 offset:15360
M v[148:151], a[80:83], v[44:47], v[148:151]
 buffer_load_dwordx4 v3, s[8:11], s21 offen offset:2048 sc1 lds
M v[156:159], a[88:91], v[44:47], v[156:159]
 v_exp_f32 v19, v97
M v[156:159], a[92:95], v[60:63], v[156:159]
 v_exp_f32 v20, v98
M v[152:155], a[92:95], v[56:59], v[152:155]
 buffer_load_dwordx4 v3, s[8:11], s21 offen offset:3072 sc1 lds
M v[152:155], a[88:91], v[40:43], v[152:155]
 s_waitcnt lgkmcnt(0)
 v_exp_f32 v21, v99
M v[160:163], a[96:99], v[40:43], v[160:163]
 ds_read_b128 a[64:67], v2 offset:16384
 v_add_f32 v28, v18, v19
M v[160:163], a[100:103], v[56:59], v[160:163]
 s_add_u32 m0, s28, 36864
 ds_read_b128 a[68:71], v2 offset:17408
 v_cvt_pk_bf16_f32 v48, v18, v19
M v[164:167], a[100:103], v[60:63], v[164:167]
 buffer_load_dwordx4 v4, s[8:11], s21 offen offset:0 sc1 lds
M v[164:167], a[96:99], v[44:47], v[164:167]
 ds_read_b128 a[72:75], v2 offset:18432
 v_add_f32 v28, v20, v28
M v[172:175], a[104:107], v[44:47], v[172:175]
 ds_read_b128 a[76:79], v2 offset:19456
 v_cvt_pk_bf16_f32 v49, v20, v21
M v[172:175], a[108:111], v[60:63], v[172:175]
 v_exp_f32 v22, v104
M v[168:171], a[108:111], v[56:59], v[168:171]
 ds_read_b128 a[80:83], v2 offset:20480
 v_add_f32 v28, v21, v28
M v[168:171], a[104:107], v[40:43], v[168:171]
 ds_read_b128 a[84:87], v2 offset:21504
M v[176:179], a[112:115], v[40:43], v[176:179]
 buffer_load_dwordx4 v4, s[8:11], s21 offen offset:1024 sc1 lds
M v[176:179], a[116:119], v[56:59], v[176:179]
 ds_read_b128 a[88:91], v2 offset:22528
M v[180:183], a[116:119], v[60:63], v[180:183]
 ds_read_b128 a[92:95], v2 offset:23552
M v[180:183], a[112:115], v[44:47], v[180:183]
 buffer_load_dwordx4 v4, s[8:11], s21 offen offset:2048 sc1 lds
M v[188:191], a[120:123], v[44:47], v[188:191]
 v_exp_f32 v23, v105
M v[188:191], a[124:127], v[60:63], v[188:191]
 v_exp_f32 v24, v106
M v[184:187], a[124:127], v[56:59], v[184:187]
 v_exp_f32 v25, v107
M v[184:187], a[120:123], v[40:43], v[184:187]
 s_waitcnt lgkmcnt(0)
 v_exp_f32 v18, v100
M v[192:195], a[64:67], v[40:43], v[192:195]
 ds_read_b128 a[96:99], v2 offset:24576
 v_add_f32 v28, v22, v28
M v[192:195], a[68:71], v[56:59], v[192:195]
 ds_read_b128 a[100:103], v2 offset:25600
 v_cvt_pk_bf16_f32 v50, v22, v23
M v[196:199], a[68:71], v[60:63], v[196:199]
 buffer_load_dwordx4 v4, s[8:11], s21 offen offset:3072 sc1 lds
M v[196:199], a[64:67], v[44:47], v[196:199]
 s_add_u32 s24, s23, 16777216
 ds_read_b128 a[104:107], v2 offset:26624
 v_add_f32 v28, v23, v28
M v[204:207], a[72:75], v[44:47], v[204:207]
 s_mov_b32 s23, s21
 ds_read_b128 a[108:111], v2 offset:27648
 v_add_f32 v28, v24, v28
M v[204:207], a[76:79], v[60:63], v[204:207]
 s_add_u32 s21, s21, 32768
 v_exp_f32 v19, v101
M v[200:203], a[76:79], v[56:59], v[200:203]
 s_add_u32 s22, s22, 1
 ds_read_b128 a[112:115], v2 offset:28672
 v_cvt_pk_bf16_f32 v51, v24, v25
M v[200:203], a[72:75], v[40:43], v[200:203]
 s_cmp_eq_u32 s22, s25
 ds_read_b128 a[116:119], v2 offset:29696
 v_add_f32 v28, v25, v28
M v[208:211], a[80:83], v[40:43], v[208:211]
 s_cselect_b32 s21, s26, s21
 v_exp_f32 v20, v102
M v[208:211], a[84:87], v[56:59], v[208:211]
 s_cmp_eq_u32 s22, s43
 ds_read_b128 a[120:123], v2 offset:30720
 v_add_f32 v29, v18, v19
M v[212:215], a[84:87], v[60:63], v[212:215]
 s_cselect_b32 s21, s4, s21
 ds_read_b128 a[124:127], v2 offset:31744
 v_cvt_pk_bf16_f32 v52, v18, v19
M v[212:215], a[80:83], v[44:47], v[212:215]
 s_cmp_eq_u32 s22, s6
 v_exp_f32 v21, v103
M v[220:223], a[88:91], v[44:47], v[220:223]
 s_cselect_b32 s21, s7, s21
 v_exp_f32 v22, v108
M v[220:223], a[92:95], v[60:63], v[220:223]
 v_add_f32 v29, v20, v29
 v_cvt_pk_bf16_f32 v53, v20, v21
M v[216:219], a[92:95], v[56:59], v[216:219]
 s_waitcnt vmcnt(16) lgkmcnt(0)
 v_exp_f32 v23, v109
M v[216:219], a[88:91], v[40:43], v[216:219]
 s_barrier
M v[224:227], a[96:99], v[40:43], v[224:227]
 ds_read_b128 a[64:67], v2 offset:32768
 v_add_f32 v29, v21, v29
M v[224:227], a[100:103], v[56:59], v[224:227]
 ds_read_b128 a[68:71], v2 offset:33792
 v_add_f32 v29, v22, v29
M v[228:231], a[100:103], v[60:63], v[228:231]
 v_cmp_gt_u32 vcc, s39, v6
 v_cvt_pk_bf16_f32 v54, v22, v23
M v[228:231], a[96:99], v[44:47], v[228:231]
 ds_read_b128 a[72:75], v2 offset:34816
 v_add_f32 v29, v23, v29
M v[236:239], a[104:107], v[44:47], v[236:239]
 ds_read_b128 a[76:79], v2 offset:35840
M v[236:239], a[108:111], v[60:63], v[236:239]
 s_cbranch_vccnz L_fls0
L_flr0:
 v_exp_f32 v24, v110
M v[232:235], a[108:111], v[56:59], v[232:235]
 s_and_b32 s3, s5, 15
 ds_read_b128 a[80:83], v2 offset:36864
M v[232:235], a[104:107], v[40:43], v[232:235]
 s_cbranch_scc1 L_pub3
L_pub3r:
 ds_read_b128 a[84:87], v2 offset:37888
M v[240:243], a[112:115], v[40:43], v[240:243]
 s_lshr_b32 s5, s5, 4
 v_exp_f32 v25, v111
M v[240:243], a[116:119], v[56:59], v[240:243]
 ds_read_b128 a[88:91], v2 offset:38912
 v_add_f32 v29, v24, v29
M v[244:247], a[116:119], v[60:63], v[244:247]
 ds_read_b128 a[92:95], v2 offset:39936
 v_cvt_pk_bf16_f32 v55, v24, v25
M v[244:247], a[112:115], v[44:47], v[244:247]
 v_add_f32 v29, v25, v29
M v[252:255], a[120:123], v[44:47], v[252:255]
 s_sub_u32 s27, s27, 1
M v[252:255], a[124:127], v[60:63], v[252:255]
 s_cmp_lg_u32 s27, 0
M v[248:251], a[124:127], v[56:59], v[248:251]
 s_waitcnt lgkmcnt(0)
M v[248:251], a[120:123], v[40:43], v[248:251]
 s_cbranch_scc1 L_loop_top
L_p1:
 s_cmp_eq_u32 s40, 0
 s_cbranch_scc1 L_final_h
 s_cmp_ge_u32 s42, 10
 s_cbranch_scc1 L_p1c
 v_cndmask_b32 v64, v32, v8, s[64:65]
 v_cndmask_b32 v65, v32, v8, s[66:67]
 v_cndmask_b32 v66, v32, v8, s[68:69]
 v_cndmask_b32 v67, v32, v8, s[70:71]
 s_nop 1
M v[64:67], a[64:67], a[0:3], v[64:67]
 s_add_u32 m0, s28, 65536
 ds_read_b128 a[96:99], v2 offset:40960
 v_cndmask_b32 v72, v32, v8, s[72:73]
M v[64:67], a[68:71], a[4:7], v[64:67]
 ds_read_b128 a[100:103], v2 offset:41984
 v_cndmask_b32 v73, v32, v8, s[74:75]
M v[64:67], a[72:75], a[8:11], v[64:67]
 buffer_load_dwordx4 v3, s[8:11], s24 offen offset:0 sc1 lds
M v[64:67], a[76:79], a[12:15], v[64:67]
 ds_read_b128 a[104:107], v2 offset:43008
 v_cndmask_b32 v74, v32, v8, s[76:77]
M v[64:67], a[80:83], a[16:19], v[64:67]
 ds_read_b128 a[108:111], v2 offset:44032
 v_cndmask_b32 v75, v32, v8, s[78:79]
M v[64:67], a[84:87], a[20:23], v[64:67]
 v_exp_f32 v18, v112
M v[64:67], a[88:91], a[24:27], v[64:67]
 ds_read_b128 a[112:115], v2 offset:45056
M v[64:67], a[92:95], a[28:31], v[64:67]
 ds_read_b128 a[116:119], v2 offset:46080
M v[68:71], a[92:95], a[60:63], v[36:39]
 buffer_load_dwordx4 v3, s[8:11], s24 offen offset:1024 sc1 lds
M v[68:71], a[88:91], a[56:59], v[68:71]
 ds_read_b128 a[120:123], v2 offset:47104
M v[68:71], a[84:87], a[52:55], v[68:71]
 ds_read_b128 a[124:127], v2 offset:48128
M v[68:71], a[80:83], a[48:51], v[68:71]
 v_exp_f32 v19, v113
M v[68:71], a[76:79], a[44:47], v[68:71]
 buffer_load_dwordx4 v3, s[8:11], s24 offen offset:2048 sc1 lds
M v[68:71], a[72:75], a[40:43], v[68:71]
 v_exp_f32 v20, v114
M v[68:71], a[68:71], a[36:39], v[68:71]
 v_exp_f32 v21, v115
M v[68:71], a[64:67], a[32:35], v[68:71]
 s_waitcnt lgkmcnt(0)
 v_exp_f32 v22, v120
M v[72:75], a[96:99], a[0:3], v[72:75]
 ds_read_b128 a[64:67], v2 offset:49152
 v_cndmask_b32 v80, v32, v8, s[80:81]
M v[72:75], a[100:103], a[4:7], v[72:75]
 ds_read_b128 a[68:71], v2 offset:50176
 v_cndmask_b32 v81, v32, v8, s[82:83]
M v[72:75], a[104:107], a[8:11], v[72:75]
 buffer_load_dwordx4 v3, s[8:11], s24 offen offset:3072 sc1 lds
M v[72:75], a[108:111], a[12:15], v[72:75]
 ds_read_b128 a[72:75], v2 offset:51200
 v_cndmask_b32 v82, v32, v8, s[84:85]
M v[72:75], a[112:115], a[16:19], v[72:75]
 ds_read_b128 a[76:79], v2 offset:52224
 v_cndmask_b32 v83, v32, v8, s[86:87]
M v[72:75], a[116:119], a[20:23], v[72:75]
 v_exp_f32 v23, v121
M v[72:75], a[120:123], a[24:27], v[72:75]
 s_add_u32 m0, s28, 69632
 ds_read_b128 a[80:83], v2 offset:53248
 v_add_f32 v28, v18, v28
M v[72:75], a[124:127], a[28:31], v[72:75]
 ds_read_b128 a[84:87], v2 offset:54272
 v_cvt_pk_bf16_f32 v56, v18, v19
M v[76:79], a[124:127], a[60:63], v[36:39]
 buffer_load_dwordx4 v4, s[8:11], s24 offen offset:0 sc1 lds
M v[76:79], a[120:123], a[56:59], v[76:79]
 ds_read_b128 a[88:91], v2 offset:55296
 v_add_f32 v28, v19, v28
M v[76:79], a[116:119], a[52:55], v[76:79]
 ds_read_b128 a[92:95], v2 offset:56320
 v_add_f32 v28, v20, v28
M v[76:79], a[112:115], a[48:51], v[76:79]
 v_exp_f32 v24, v122
M v[76:79], a[108:111], a[44:47], v[76:79]
 buffer_load_dwordx4 v4, s[8:11], s24 offen offset:1024 sc1 lds
M v[76:79], a[104:107], a[40:43], v[76:79]
 v_exp_f32 v25, v123
M v[76:79], a[100:103], a[36:39], v[76:79]
 v_exp_f32 v18, v116
M v[76:79], a[96:99], a[32:35], v[76:79]
 s_waitcnt lgkmcnt(0)
 v_exp_f32 v19, v117
M v[80:83], a[64:67], a[0:3], v[80:83]
 ds_read_b128 a[96:99], v2 offset:57344
 v_cndmask_b32 v88, v32, v8, s[88:89]
M v[80:83], a[68:71], a[4:7], v[80:83]
 ds_read_b128 a[100:103], v2 offset:58368
 v_cndmask_b32 v89, v32, v8, s[90:91]
M v[80:83], a[72:75], a[8:11], v[80:83]
 buffer_load_dwordx4 v4, s[8:11], s24 offen offset:2048 sc1 lds
M v[80:83], a[76:79], a[12:15], v[80:83]
 ds_read_b128 a[104:107], v2 offset:59392
 v_cndmask_b32 v90, v32, v8, s[92:93]
M v[80:83], a[80:83], a[16:19], v[80:83]
 ds_read_b128 a[108:111], v2 offset:60416
 v_cndmask_b32 v91, v32, v8, s[94:95]
M v[80:83], a[84:87], a[20:23], v[80:83]
 v_cvt_pk_bf16_f32 v57, v20, v21
 v_add_f32 v28, v21, v28
M v[80:83], a[88:91], a[24:27], v[80:83]
 ds_read_b128 a[112:115], v2 offset:61440
 v_add_f32 v28, v22, v28
M v[80:83], a[92:95], a[28:31], v[80:83]
 ds_read_b128 a[116:119], v2 offset:62464
 v_cvt_pk_bf16_f32 v58, v22, v23
M v[84:87], a[92:95], a[60:63], v[36:39]
 buffer_load_dwordx4 v4, s[8:11], s24 offen offset:3072 sc1 lds
M v[84:87], a[88:91], a[56:59], v[84:87]
 ds_read_b128 a[120:123], v2 offset:63488
 v_add_f32 v28, v23, v28
M v[84:87], a[84:87], a[52:55], v[84:87]
 ds_read_b128 a[124:127], v2 offset:64512
 v_add_f32 v28, v24, v28
M v[84:87], a[80:83], a[48:51], v[84:87]
 v_exp_f32 v20, v118
M v[84:87], a[76:79], a[44:47], v[84:87]
 v_exp_f32 v21, v119
M v[84:87], a[72:75], a[40:43], v[84:87]
 v_exp_f32 v22, v124
M v[84:87], a[68:71], a[36:39], v[84:87]
 s_waitcnt vmcnt(16) lgkmcnt(0)
 v_exp_f32 v23, v125
M v[84:87], a[64:67], a[32:35], v[84:87]
 s_barrier
M v[88:91], a[96:99], a[0:3], v[88:91]
 ds_read_b128 a[64:67], v7 offset:0
 v_cvt_pk_bf16_f32 v59, v24, v25
M v[88:91], a[100:103], a[4:7], v[88:91]
 ds_read_b128 a[68:71], v7 offset:1024
 v_add_f32 v28, v25, v28
M v[88:91], a[104:107], a[8:11], v[88:91]
 v_exp_f32 v24, v126
M v[88:91], a[108:111], a[12:15], v[88:91]
 ds_read_b128 a[72:75], v7 offset:2048
 v_add_f32 v29, v18, v29
M v[88:91], a[112:115], a[16:19], v[88:91]
 ds_read_b128 a[76:79], v7 offset:3072
 v_cvt_pk_bf16_f32 v60, v18, v19
M v[88:91], a[116:119], a[20:23], v[88:91]
 v_exp_f32 v25, v127
M v[88:91], a[120:123], a[24:27], v[88:91]
 ds_read_b128 a[80:83], v7 offset:4096
 v_add_f32 v29, v19, v29
M v[88:91], a[124:127], a[28:31], v[88:91]
 ds_read_b128 a[84:87], v7 offset:5120
 v_add_f32 v29, v20, v29
M v[92:95], a[124:127], a[60:63], v[36:39]
 v_cvt_pk_bf16_f32 v61, v20, v21
 v_add_f32 v29, v21, v29
M v[92:95], a[120:123], a[56:59], v[92:95]
 ds_read_b128 a[88:91], v7 offset:6144
 v_add_f32 v29, v22, v29
M v[92:95], a[116:119], a[52:55], v[92:95]
 ds_read_b128 a[92:95], v7 offset:7168
 v_cvt_pk_bf16_f32 v62, v22, v23
M v[92:95], a[112:115], a[48:51], v[92:95]
 v_add_f32 v29, v23, v29
 v_add_f32 v29, v24, v29
M v[92:95], a[108:111], a[44:47], v[92:95]
 v_cvt_pk_bf16_f32 v63, v24, v25
 v_add_f32 v29, v25, v29
M v[92:95], a[104:107], a[40:43], v[92:95]
M v[92:95], a[100:103], a[36:39], v[92:95]
 s_waitcnt lgkmcnt(0)
M v[92:95], a[96:99], a[32:35], v[92:95]
 v_max_f32 v10, v28, v29
 v_cmp_lt_f32 vcc, s31, v10
 s_nop 0
 s_cbranch_vccnz L_st5
L_rt5:
M v[128:131], a[64:67], v[48:51], v[128:131]
 s_add_u32 m0, s28, 98304
 ds_read_b128 a[96:99], v7 offset:8192
 v_add_f32 v30, v28, v30
M v[128:131], a[68:71], v[56:59], v[128:131]
 ds_read_b128 a[100:103], v7 offset:9216
 v_add_f32 v31, v29, v31
M v[132:135], a[68:71], v[60:63], v[132:135]
 buffer_load_dwordx4 v3, s[8:11], s21 offen offset:0 sc1 lds
M v[132:135], a[64:67], v[52:55], v[132:135]
 s_cmp_eq_u32 s20, 3
 ds_read_b128 a[104:107], v7 offset:10240
M v[140:143], a[72:75], v[52:55], v[140:143]
 s_cselect_b64 s[64:65], s[16:17], 0
 ds_read_b128 a[108:111], v7 offset:11264
M v[140:143], a[76:79], v[60:63], v[140:143]
 buffer_load_dwordx4 v3, s[8:11], s21 offen offset:1024 sc1 lds
M v[136:139], a[76:79], v[56:59], v[136:139]
 s_cselect_b64 s[66:67], s[18:19], 0
 ds_read_b128 a[112:115], v7 offset:12288
M v[136:139], a[72:75], v[48:51], v[136:139]
 s_cselect_b64 s[68:69], s[48:49], 0
 ds_read_b128 a[116:119], v7 offset:13312
M v[144:147], a[80:83], v[48:51], v[144:147]
 s_cselect_b64 s[70:71], s[50:51], 0
 v_exp_f32 v18, v64
M v[144:147], a[84:87], v[56:59], v[144:147]
 s_cmp_gt_u32 s20, 2
 ds_read_b128 a[120:123], v7 offset:14336
M v[148:151], a[84:87], v[60:63], v[148:151]
 s_cselect_b64 s[78:79], -1, 0
 ds_read_b128 a[124:127], v7 offset:15360
M v[148:151], a[80:83], v[52:55], v[148:151]
 buffer_load_dwordx4 v3, s[8:11], s21 offen offset:2048 sc1 lds
M v[156:159], a[88:91], v[52:55], v[156:159]
 v_exp_f32 v19, v65
M v[156:159], a[92:95], v[60:63], v[156:159]
 v_exp_f32 v20, v66
M v[152:155], a[92:95], v[56:59], v[152:155]
 buffer_load_dwordx4 v3, s[8:11], s21 offen offset:3072 sc1 lds
M v[152:155], a[88:91], v[48:51], v[152:155]
 s_waitcnt lgkmcnt(0)
 v_exp_f32 v21, v67
M v[160:163], a[96:99], v[48:51], v[160:163]
 ds_read_b128 a[64:67], v7 offset:16384
 v_add_f32 v26, v18, v19
M v[160:163], a[100:103], v[56:59], v[160:163]
 s_add_u32 m0, s28, 102400
 ds_read_b128 a[68:71], v7 offset:17408
 v_cvt_pk_bf16_f32 v40, v18, v19
M v[164:167], a[100:103], v[60:63], v[164:167]
 buffer_load_dwordx4 v4, s[8:11], s21 offen offset:0 sc1 lds
M v[164:167], a[96:99], v[52:55], v[164:167]
 s_cmp_eq_u32 s20, 2
 ds_read_b128 a[72:75], v7 offset:18432
 v_add_f32 v26, v20, v26
M v[172:175], a[104:107], v[52:55], v[172:175]
 s_cselect_b64 s[72:73], s[16:17], s[78:79]
 ds_read_b128 a[76:79], v7 offset:19456
 v_cvt_pk_bf16_f32 v41, v20, v21
M v[172:175], a[108:111], v[60:63], v[172:175]
 s_cselect_b64 s[74:75], s[18:19], s[78:79]
 v_exp_f32 v22, v72
M v[168:171], a[108:111], v[56:59], v[168:171]
 s_cselect_b64 s[76:77], s[48:49], s[78:79]
 ds_read_b128 a[80:83], v7 offset:20480
 v_add_f32 v26, v21, v26
M v[168:171], a[104:107], v[48:51], v[168:171]
 s_cselect_b64 s[78:79], s[50:51], s[78:79]
 ds_read_b128 a[84:87], v7 offset:21504
M v[176:179], a[112:115], v[48:51], v[176:179]
 buffer_load_dwordx4 v4, s[8:11], s21 offen offset:1024 sc1 lds
M v[176:179], a[116:119], v[56:59], v[176:179]
 s_cmp_gt_u32 s20, 1
 ds_read_b128 a[88:91], v7 offset:22528
M v[180:183], a[116:119], v[60:63], v[180:183]
 s_cselect_b64 s[86:87], -1, 0
 ds_read_b128 a[92:95], v7 offset:23552
M v[180:183], a[112:115], v[52:55], v[180:183]
 buffer_load_dwordx4 v4, s[8:11], s21 offen offset:2048 sc1 lds
M v[188:191], a[120:123], v[52:55], v[188:191]
 s_cmp_eq_u32 s20, 1
 v_exp_f32 v23, v73
M v[188:191], a[124:127], v[60:63], v[188:191]
 s_cselect_b64 s[80:81], s[16:17], s[86:87]
 v_exp_f32 v24, v74
M v[184:187], a[124:127], v[56:59], v[184:187]
 s_cselect_b64 s[82:83], s[18:19], s[86:87]
 v_exp_f32 v25, v75
M v[184:187], a[120:123], v[48:51], v[184:187]
 s_waitcnt lgkmcnt(0)
 v_exp_f32 v18, v68
M v[192:195], a[64:67], v[48:51], v[192:195]
 s_cselect_b64 s[84:85], s[48:49], s[86:87]
 ds_read_b128 a[96:99], v7 offset:24576
 v_add_f32 v26, v22, v26
M v[192:195], a[68:71], v[56:59], v[192:195]
 s_cselect_b64 s[86:87], s[50:51], s[86:87]
 ds_read_b128 a[100:103], v7 offset:25600
 v_cvt_pk_bf16_f32 v42, v22, v23
M v[196:199], a[68:71], v[60:63], v[196:199]
 buffer_load_dwordx4 v4, s[8:11], s21 offen offset:3072 sc1 lds
M v[196:199], a[64:67], v[52:55], v[196:199]
 s_add_u32 s24, s23, 16777216
 ds_read_b128 a[104:107], v7 offset:26624
 v_add_f32 v26, v23, v26
M v[204:207], a[72:75], v[52:55], v[204:207]
 s_mov_b32 s23, s21
 ds_read_b128 a[108:111], v7 offset:27648
 v_add_f32 v26, v24, v26
M v[204:207], a[76:79], v[60:63], v[204:207]
 s_add_u32 s21, s21, 32768
 v_exp_f32 v19, v69
M v[200:203], a[76:79], v[56:59], v[200:203]
 s_add_u32 s22, s22, 1
 ds_read_b128 a[112:115], v7 offset:28672
 v_cvt_pk_bf16_f32 v43, v24, v25
M v[200:203], a[72:75], v[48:51], v[200:203]
 s_cmp_eq_u32 s22, s25
 ds_read_b128 a[116:119], v7 offset:29696
 v_add_f32 v26, v25, v26
M v[208:211], a[80:83], v[48:51], v[208:211]
 s_cselect_b32 s21, s26, s21
 v_exp_f32 v20, v70
M v[208:211], a[84:87], v[56:59], v[208:211]
 s_cmp_eq_u32 s22, s43
 ds_read_b128 a[120:123], v7 offset:30720
 v_add_f32 v27, v18, v19
M v[212:215], a[84:87], v[60:63], v[212:215]
 s_cselect_b32 s21, s4, s21
 ds_read_b128 a[124:127], v7 offset:31744
 v_cvt_pk_bf16_f32 v44, v18, v19
M v[212:215], a[80:83], v[52:55], v[212:215]
 s_cmp_eq_u32 s22, s6
 v_exp_f32 v21, v71
M v[220:223], a[88:91], v[52:55], v[220:223]
 s_cselect_b32 s21, s7, s21
 v_exp_f32 v22, v76
M v[220:223], a[92:95], v[60:63], v[220:223]
 s_cmp_eq_u32 s20, 0
 v_exp_f32 v23, v77
M v[216:219], a[92:95], v[56:59], v[216:219]
 s_waitcnt vmcnt(16) lgkmcnt(0)
 v_exp_f32 v24, v78
M v[216:219], a[88:91], v[48:51], v[216:219]
 s_barrier
M v[224:227], a[96:99], v[48:51], v[224:227]
 s_cselect_b64 s[88:89], s[16:17], -1
 ds_read_b128 a[64:67], v7 offset:32768
 v_add_f32 v27, v20, v27
M v[224:227], a[100:103], v[56:59], v[224:227]
 s_cselect_b64 s[90:91], s[18:19], -1
 ds_read_b128 a[68:71], v7 offset:33792
 v_cvt_pk_bf16_f32 v45, v20, v21
M v[228:231], a[100:103], v[60:63], v[228:231]
 buffer_load_dword v5, off, s[8:11], s47 sc1
M v[228:231], a[96:99], v[52:55], v[228:231]
 s_cselect_b64 s[92:93], s[48:49], -1
 ds_read_b128 a[72:75], v7 offset:34816
 v_add_f32 v27, v21, v27
M v[236:239], a[104:107], v[52:55], v[236:239]
 s_cselect_b64 s[94:95], s[50:51], -1
 ds_read_b128 a[76:79], v7 offset:35840
 v_add_f32 v27, v22, v27
M v[236:239], a[108:111], v[60:63], v[236:239]
 v_cndmask_b32 v100, v36, v8, s[64:65]
 v_cndmask_b32 v101, v36, v8, s[66:67]
M v[232:235], a[108:111], v[56:59], v[232:235]
 ds_read_b128 a[80:83], v7 offset:36864
 v_cndmask_b32 v102, v36, v8, s[68:69]
M v[232:235], a[104:107], v[48:51], v[232:235]
 ds_read_b128 a[84:87], v7 offset:37888
 v_cndmask_b32 v103, v36, v8, s[70:71]
M v[240:243], a[112:115], v[48:51], v[240:243]
 v_cndmask_b32 v108, v36, v8, s[72:73]
 v_cndmask_b32 v109, v36, v8, s[74:75]
M v[240:243], a[116:119], v[56:59], v[240:243]
 ds_read_b128 a[88:91], v7 offset:38912
 v_cndmask_b32 v110, v36, v8, s[76:77]
M v[244:247], a[116:119], v[60:63], v[244:247]
 ds_read_b128 a[92:95], v7 offset:39936
 v_cndmask_b32 v111, v36, v8, s[78:79]
M v[244:247], a[112:115], v[52:55], v[244:247]
 v_cndmask_b32 v116, v36, v8, s[80:81]
 v_cndmask_b32 v117, v36, v8, s[82:83]
M v[252:255], a[120:123], v[52:55], v[252:255]
 v_cndmask_b32 v118, v36, v8, s[84:85]
 v_cndmask_b32 v119, v36, v8, s[86:87]
M v[252:255], a[124:127], v[60:63], v[252:255]
 v_cndmask_b32 v124, v36, v8, s[88:89]
 v_cndmask_b32 v125, v36, v8, s[90:91]
M v[248:251], a[124:127], v[56:59], v[248:251]
 s_waitcnt lgkmcnt(0)
 v_cndmask_b32 v126, v36, v8, s[92:93]
 v_cndmask_b32 v127, v36, v8, s[94:95]
M v[248:251], a[120:123], v[48:51], v[248:251]
 v_exp_f32 v25, v79
 v_cvt_pk_bf16_f32 v46, v22, v23
 v_add_f32 v27, v23, v27
 v_add_f32 v27, v24, v27
 v_cvt_pk_bf16_f32 v47, v24, v25
 v_add_f32 v27, v25, v27
L_p2:
M v[100:103], a[64:67], a[32:35], v[100:103]
 ds_read_b128 a[96:99], v7 offset:40960
 ds_read_b128 a[100:103], v7 offset:41984
 v_exp_f32 v18, v80
M v[100:103], a[68:71], a[36:39], v[100:103]
 ds_read_b128 a[104:107], v7 offset:43008
 v_exp_f32 v19, v81
M v[100:103], a[72:75], a[40:43], v[100:103]
 ds_read_b128 a[108:111], v7 offset:44032
 ds_read_b128 a[112:115], v7 offset:45056
 v_exp_f32 v20, v82
 v_add_f32 v26, v18, v26
M v[100:103], a[76:79], a[44:47], v[100:103]
 ds_read_b128 a[116:119], v7 offset:46080
 v_cvt_pk_bf16_f32 v56, v18, v19
 v_exp_f32 v21, v83
M v[100:103], a[80:83], a[48:51], v[100:103]
 s_add_u32 m0, s28, 0
 ds_read_b128 a[120:123], v7 offset:47104
 ds_read_b128 a[124:127], v7 offset:48128
 v_add_f32 v26, v19, v26
M v[100:103], a[84:87], a[52:55], v[100:103]
 buffer_load_dwordx4 v3, s[8:11], s24 offen offset:0 sc1 lds
M v[100:103], a[88:91], a[56:59], v[100:103]
 ds_read_b128 a[128:131], v7 offset:49152
 ds_read_b128 a[132:135], v7 offset:50176
 v_exp_f32 v22, v88
 v_add_f32 v26, v20, v26
 v_cvt_pk_bf16_f32 v57, v20, v21
M v[100:103], a[92:95], a[60:63], v[100:103]
 s_waitcnt lgkmcnt(2)
 ds_read_b128 a[136:139], v7 offset:51200
 v_exp_f32 v23, v89
 v_add_f32 v26, v21, v26
M v[108:111], a[124:127], a[60:63], v[108:111]
 ds_read_b128 a[140:143], v7 offset:52224
 ds_read_b128 a[144:147], v7 offset:53248
 v_exp_f32 v24, v90
M v[108:111], a[120:123], a[56:59], v[108:111]
 buffer_load_dwordx4 v3, s[8:11], s24 offen offset:1024 sc1 lds
M v[108:111], a[116:119], a[52:55], v[108:111]
 ds_read_b128 a[148:151], v7 offset:54272
 ds_read_b128 a[152:155], v7 offset:55296
 v_add_f32 v26, v22, v26
 v_cvt_pk_bf16_f32 v58, v22, v23
M v[108:111], a[112:115], a[48:51], v[108:111]
 ds_read_b128 a[156:159], v7 offset:56320
 v_exp_f32 v25, v91
 v_add_f32 v26, v23, v26
M v[108:111], a[108:111], a[44:47], v[108:111]
 ds_read_b128 a[160:163], v7 offset:57344
 ds_read_b128 a[164:167], v7 offset:58368
 v_exp_f32 v18, v84
M v[108:111], a[104:107], a[40:43], v[108:111]
 buffer_load_dwordx4 v3, s[8:11], s24 offen offset:2048 sc1 lds
M v[108:111], a[100:103], a[36:39], v[108:111]
 ds_read_b128 a[168:171], v7 offset:59392
 ds_read_b128 a[172:175], v7 offset:60416
 v_add_f32 v26, v24, v26
 v_cvt_pk_bf16_f32 v59, v24, v25
M v[108:111], a[96:99], a[32:35], v[108:111]
 s_waitcnt lgkmcnt(4)
 ds_read_b128 a[176:179], v7 offset:61440
 v_exp_f32 v19, v85
 v_add_f32 v26, v25, v26
M v[116:119], a[128:131], a[32:35], v[116:119]
 ds_read_b128 a[180:183], v7 offset:62464
 ds_read_b128 a[184:187], v7 offset:63488
 v_exp_f32 v20, v86
M v[116:119], a[132:135], a[36:39], v[116:119]
 ds_read_b128 a[188:191], v7 offset:64512
 v_add_f32 v27, v18, v27
 v_cvt_pk_bf16_f32 v60, v18, v19
M v[116:119], a[136:139], a[40:43], v[116:119]
 buffer_load_dwordx4 v3, s[8:11], s24 offen offset:3072 sc1 lds
M v[116:119], a[140:143], a[44:47], v[116:119]
 s_add_u32 m0, s28, 4096
 v_exp_f32 v21, v87
 v_add_f32 v27, v19, v27
 v_exp_f32 v22, v92
M v[116:119], a[144:147], a[48:51], v[116:119]
 buffer_load_dwordx4 v4, s[8:11], s24 offen offset:0 sc1 lds
M v[116:119], a[148:151], a[52:55], v[116:119]
 s_waitcnt vmcnt(14) lgkmcnt(0)
 v_add_f32 v27, v20, v27
 v_cvt_pk_bf16_f32 v61, v20, v21
 v_exp_f32 v23, v93
 v_add_f32 v27, v21, v27
M v[116:119], a[152:155], a[56:59], v[116:119]
 s_barrier
M v[116:119], a[156:159], a[60:63], v[116:119]
 ds_read_b128 a[64:67], v2 offset:0
 ds_read_b128 a[68:71], v2 offset:1024
 v_exp_f32 v24, v94
M v[124:127], a[188:191], a[60:63], v[124:127]
 ds_read_b128 a[72:75], v2 offset:2048
 v_add_f32 v27, v22, v27
 v_cvt_pk_bf16_f32 v62, v22, v23
M v[124:127], a[184:187], a[56:59], v[124:127]
 ds_read_b128 a[76:79], v2 offset:3072
 ds_read_b128 a[80:83], v2 offset:4096
 v_exp_f32 v25, v95
 v_add_f32 v27, v23, v27
M v[124:127], a[180:183], a[52:55], v[124:127]
 ds_read_b128 a[84:87], v2 offset:5120
 v_add_f32 v27, v24, v27
 v_cvt_pk_bf16_f32 v63, v24, v25
 v_add_f32 v27, v25, v27
M v[124:127], a[176:179], a[48:51], v[124:127]
 ds_read_b128 a[88:91], v2 offset:6144
 ds_read_b128 a[92:95], v2 offset:7168
 v_max_f32 v10, v26, v27
 v_cmp_lt_f32 vcc, s31, v10
M v[124:127], a[172:175], a[44:47], v[124:127]
 buffer_load_dwordx4 v4, s[8:11], s24 offen offset:1024 sc1 lds
M v[124:127], a[168:171], a[40:43], v[124:127]
 buffer_load_dwordx4 v4, s[8:11], s24 offen offset:2048 sc1 lds
M v[124:127], a[164:167], a[36:39], v[124:127]
 buffer_load_dwordx4 v4, s[8:11], s24 offen offset:3072 sc1 lds
M v[124:127], a[160:163], a[32:35], v[124:127]
 s_waitcnt lgkmcnt(0)
 s_cbranch_vccnz L_st6
L_rt6:
 s_cmp_le_u32 s42, 5
 s_cbranch_scc1 L_p3k
L_p3o:
M v[128:131], a[64:67], v[40:43], v[128:131]
 s_add_u32 m0, s28, 32768
 ds_read_b128 a[96:99], v2 offset:8192
 v_add_f32 v30, v26, v30
M v[128:131], a[68:71], v[56:59], v[128:131]
 ds_read_b128 a[100:103], v2 offset:9216
 v_add_f32 v31, v27, v31
M v[132:135], a[68:71], v[60:63], v[132:135]
 buffer_load_dwordx4 v3, s[8:11], s21 offen offset:0 sc1 lds
M v[132:135], a[64:67], v[44:47], v[132:135]
 ds_read_b128 a[104:107], v2 offset:10240
M v[140:143], a[72:75], v[44:47], v[140:143]
 ds_read_b128 a[108:111], v2 offset:11264
M v[140:143], a[76:79], v[60:63], v[140:143]
 buffer_load_dwordx4 v3, s[8:11], s21 offen offset:1024 sc1 lds
M v[136:139], a[76:79], v[56:59], v[136:139]
 ds_read_b128 a[112:115], v2 offset:12288
M v[136:139], a[72:75], v[40:43], v[136:139]
 ds_read_b128 a[116:119], v2 offset:13312
M v[144:147], a[80:83], v[40:43], v[144:147]
 v_exp_f32 v18, v100
M v[144:147], a[84:87], v[56:59], v[144:147]
 ds_read_b128 a[120:123], v2 offset:14336
M v[148:151], a[84:87], v[60:63], v[148:151]
 ds_read_b128 a[124:127], v2 offset:15360
M v[148:151], a[80:83], v[44:47], v[148:151]
 buffer_load_dwordx4 v3, s[8:11], s21 offen offset:2048 sc1 lds
M v[156:159], a[88:91], v[44:47], v[156:159]
 v_exp_f32 v19, v101
M v[156:159], a[92:95], v[60:63], v[156:159]
 v_exp_f32 v20, v102
M v[152:155], a[92:95], v[56:59], v[152:155]
 buffer_load_dwordx4 v3, s[8:11], s21 offen offset:3072 sc1 lds
M v[152:155], a[88:91], v[40:43], v[152:155]
 s_waitcnt lgkmcnt(0)
 v_exp_f32 v21, v103
M v[160:163], a[96:99], v[40:43], v[160:163]
 ds_read_b128 a[64:67], v2 offset:16384
 v_add_f32 v29, v18, v19
M v[160:163], a[100:103], v[56:59], v[160:163]
 s_add_u32 m0, s28, 36864
 ds_read_b128 a[68:71], v2 offset:17408
 v_cvt_pk_bf16_f32 v52, v18, v19
M v[164:167], a[100:103], v[60:63], v[164:167]
 buffer_load_dwordx4 v4, s[8:11], s21 offen offset:0 sc1 lds
M v[164:167], a[96:99], v[44:47], v[164:167]
 ds_read_b128 a[72:75], v2 offset:18432
 v_add_f32 v29, v20, v29
M v[172:175], a[104:107], v[44:47], v[172:175]
 ds_read_b128 a[76:79], v2 offset:19456
 v_cvt_pk_bf16_f32 v53, v20, v21
M v[172:175], a[108:111], v[60:63], v[172:175]
 v_exp_f32 v22, v108
M v[168:171], a[108:111], v[56:59], v[168:171]
 ds_read_b128 a[80:83], v2 offset:20480
 v_add_f32 v29, v21, v29
M v[168:171], a[104:107], v[40:43], v[168:171]
 ds_read_b128 a[84:87], v2 offset:21504
M v[176:179], a[112:115], v[40:43], v[176:179]
 buffer_load_dwordx4 v4, s[8:11], s21 offen offset:1024 sc1 lds
M v[176:179], a[116:119], v[56:59], v[176:179]
 ds_read_b128 a[88:91], v2 offset:22528
M v[180:183], a[116:119], v[60:63], v[180:183]
 ds_read_b128 a[92:95], v2 offset:23552
M v[180:183], a[112:115], v[44:47], v[180:183]
 buffer_load_dwordx4 v4, s[8:11], s21 offen offset:2048 sc1 lds
M v[188:191], a[120:123], v[44:47], v[188:191]
 v_exp_f32 v23, v109
M v[188:191], a[124:127], v[60:63], v[188:191]
 v_exp_f32 v24, v110
M v[184:187], a[124:127], v[56:59], v[184:187]
 v_exp_f32 v25, v111
M v[184:187], a[120:123], v[40:43], v[184:187]
 s_waitcnt lgkmcnt(0)
 v_exp_f32 v18, v116
M v[192:195], a[64:67], v[40:43], v[192:195]
 ds_read_b128 a[96:99], v2 offset:24576
 v_add_f32 v29, v22, v29
M v[192:195], a[68:71], v[56:59], v[192:195]
 ds_read_b128 a[100:103], v2 offset:25600
 v_cvt_pk_bf16_f32 v54, v22, v23
M v[196:199], a[68:71], v[60:63], v[196:199]
 buffer_load_dwordx4 v4, s[8:11], s21 offen offset:3072 sc1 lds
M v[196:199], a[64:67], v[44:47], v[196:199]
 s_add_u32 s24, s23, 16777216
 ds_read_b128 a[104:107], v2 offset:26624
 v_add_f32 v29, v23, v29
M v[204:207], a[72:75], v[44:47], v[204:207]
 s_mov_b32 s23, s21
 ds_read_b128 a[108:111], v2 offset:27648
 v_add_f32 v29, v24, v29
M v[204:207], a[76:79], v[60:63], v[204:207]
 s_add_u32 s21, s21, 32768
 v_exp_f32 v19, v117
M v[200:203], a[76:79], v[56:59], v[200:203]
 s_add_u32 s22, s22, 1
 ds_read_b128 a[112:115], v2 offset:28672
 v_cvt_pk_bf16_f32 v55, v24, v25
M v[200:203], a[72:75], v[40:43], v[200:203]
 s_cmp_eq_u32 s22, s25
 ds_read_b128 a[116:119], v2 offset:29696
 v_add_f32 v29, v25, v29
M v[208:211], a[80:83], v[40:43], v[208:211]
 s_cselect_b32 s21, s26, s21
 v_exp_f32 v20, v118
M v[208:211], a[84:87], v[56:59], v[208:211]
 s_cmp_eq_u32 s22, s43
 ds_read_b128 a[120:123], v2 offset:30720
 v_add_f32 v29, v18, v29
M v[212:215], a[84:87], v[60:63], v[212:215]
 s_cselect_b32 s21, s4, s21
 ds_read_b128 a[124:127], v2 offset:31744
 v_cvt_pk_bf16_f32 v48, v18, v19
M v[212:215], a[80:83], v[44:47], v[212:215]
 s_cmp_eq_u32 s22, s6
 v_exp_f32 v21, v119
M v[220:223], a[88:91], v[44:47], v[220:223]
 s_cselect_b32 s21, s7, s21
 v_exp_f32 v22, v124
M v[220:223], a[92:95], v[60:63], v[220:223]
 v_exp_f32 v23, v125
M v[216:219], a[92:95], v[56:59], v[216:219]
 s_waitcnt vmcnt(8) lgkmcnt(0)
 v_add_f32 v29, v19, v29
 v_add_f32 v29, v20, v29
M v[216:219], a[88:91], v[40:43], v[216:219]
 s_barrier
M v[224:227], a[96:99], v[40:43], v[224:227]
 ds_read_b128 a[64:67], v7 offset:0
 v_cvt_pk_bf16_f32 v49, v20, v21
M v[224:227], a[100:103], v[56:59], v[224:227]
 ds_read_b128 a[68:71], v7 offset:1024
 v_add_f32 v29, v21, v29
M v[228:231], a[100:103], v[60:63], v[228:231]
 v_exp_f32 v24, v126
M v[228:231], a[96:99], v[44:47], v[228:231]
 ds_read_b128 a[72:75], v7 offset:2048
 v_add_f32 v29, v22, v29
M v[236:239], a[104:107], v[44:47], v[236:239]
 ds_read_b128 a[76:79], v7 offset:3072
 v_cvt_pk_bf16_f32 v50, v22, v23
M v[236:239], a[108:111], v[60:63], v[236:239]
 v_exp_f32 v25, v127
M v[232:235], a[108:111], v[56:59], v[232:235]
 ds_read_b128 a[80:83], v7 offset:4096
 v_add_f32 v29, v23, v29
M v[232:235], a[104:107], v[40:43], v[232:235]
 ds_read_b128 a[84:87], v7 offset:5120
 v_add_f32 v29, v24, v29
M v[240:243], a[112:115], v[40:43], v[240:243]
 v_cvt_pk_bf16_f32 v51, v24, v25
 v_add_f32 v29, v25, v29
M v[240:243], a[116:119], v[56:59], v[240:243]
 ds_read_b128 a[88:91], v7 offset:6144
M v[244:247], a[116:119], v[60:63], v[244:247]
 ds_read_b128 a[92:95], v7 offset:7168
M v[244:247], a[112:115], v[44:47], v[244:247]
 v_cmp_lt_f32 vcc, s31, v29
M v[252:255], a[120:123], v[44:47], v[252:255]
M v[252:255], a[124:127], v[60:63], v[252:255]
M v[248:251], a[124:127], v[56:59], v[248:251]
 s_waitcnt lgkmcnt(0)
M v[248:251], a[120:123], v[40:43], v[248:251]
 s_cbranch_vccnz L_st2
L_rt2:
L_pBo:
M v[132:135], a[64:67], v[52:55], v[132:135]
 ds_read_b128 a[96:99], v7 offset:8192
 ds_read_b128 a[100:103], v7 offset:9216
M v[132:135], a[68:71], v[48:51], v[132:135]
 ds_read_b128 a[104:107], v7 offset:10240
 v_cvt_pk_bf16_f32 v128, v128, v129
 v_cvt_pk_bf16_f32 v129, v130, v131
M v[140:143], a[76:79], v[48:51], v[140:143]
 ds_read_b128 a[108:111], v7 offset:11264
 ds_read_b128 a[112:115], v7 offset:12288
 v_cvt_pk_bf16_f32 v130, v136, v137
M v[140:143], a[72:75], v[52:55], v[140:143]
 ds_read_b128 a[116:119], v7 offset:13312
 v_cvt_pk_bf16_f32 v131, v138, v139
 v_cvt_pk_bf16_f32 v144, v144, v145
M v[148:151], a[80:83], v[52:55], v[148:151]
 s_add_u32 m0, s28, 65536
 ds_read_b128 a[120:123], v7 offset:14336
 ds_read_b128 a[124:127], v7 offset:15360
M v[148:151], a[84:87], v[48:51], v[148:151]
 buffer_load_dwordx4 v3, s[8:11], s38 offen offset:0 sc1 lds
M v[156:159], a[92:95], v[48:51], v[156:159]
 ds_read_b128 a[128:131], v7 offset:16384
 ds_read_b128 a[132:135], v7 offset:17408
 v_cvt_pk_bf16_f32 v145, v146, v147
M v[156:159], a[88:91], v[52:55], v[156:159]
 s_waitcnt lgkmcnt(2)
 ds_read_b128 a[136:139], v7 offset:18432
 v_cvt_pk_bf16_f32 v146, v152, v153
 v_cvt_pk_bf16_f32 v147, v154, v155
M v[164:167], a[96:99], v[52:55], v[164:167]
 ds_read_b128 a[140:143], v7 offset:19456
 ds_read_b128 a[144:147], v7 offset:20480
 v_cvt_pk_bf16_f32 v160, v160, v161
M v[164:167], a[100:103], v[48:51], v[164:167]
 buffer_load_dwordx4 v3, s[8:11], s38 offen offset:1024 sc1 lds
M v[172:175], a[108:111], v[48:51], v[172:175]
 ds_read_b128 a[148:151], v7 offset:21504
 ds_read_b128 a[152:155], v7 offset:22528
 v_cvt_pk_bf16_f32 v161, v162, v163
M v[172:175], a[104:107], v[52:55], v[172:175]
 ds_read_b128 a[156:159], v7 offset:23552
 v_cvt_pk_bf16_f32 v162, v168, v169
 v_cvt_pk_bf16_f32 v163, v170, v171
M v[180:183], a[112:115], v[52:55], v[180:183]
 ds_read_b128 a[160:163], v7 offset:24576
 ds_read_b128 a[164:167], v7 offset:25600
 v_cvt_pk_bf16_f32 v176, v176, v177
M v[180:183], a[116:119], v[48:51], v[180:183]
 buffer_load_dwordx4 v3, s[8:11], s38 offen offset:2048 sc1 lds
M v[188:191], a[124:127], v[48:51], v[188:191]
 ds_read_b128 a[168:171], v7 offset:26624
 ds_read_b128 a[172:175], v7 offset:27648
 v_cvt_pk_bf16_f32 v177, v178, v179
M v[188:191], a[120:123], v[52:55], v[188:191]
 s_waitcnt lgkmcnt(4)
 ds_read_b128 a[176:179], v7 offset:28672
 v_cvt_pk_bf16_f32 v178, v184, v185
M v[196:199], a[128:131], v[52:55], v[196:199]
 ds_read_b128 a[180:183], v7 offset:29696
 ds_read_b128 a[184:187], v7 offset:30720
 v_cvt_pk_bf16_f32 v179, v186, v187
M v[196:199], a[132:135], v[48:51], v[196:199]
 ds_read_b128 a[188:191], v7 offset:31744
 v_cvt_pk_bf16_f32 v192, v192, v193
 v_cvt_pk_bf16_f32 v193, v194, v195
M v[204:207], a[140:143], v[48:51], v[204:207]
 buffer_load_dwordx4 v3, s[8:11], s38 offen offset:3072 sc1 lds
M v[204:207], a[136:139], v[52:55], v[204:207]
 s_add_u32 m0, s28, 69632
 v_cvt_pk_bf16_f32 v194, v200, v201
 v_cvt_pk_bf16_f32 v195, v202, v203
 v_cvt_pk_bf16_f32 v208, v208, v209
M v[212:215], a[144:147], v[52:55], v[212:215]
 buffer_load_dwordx4 v4, s[8:11], s38 offen offset:0 sc1 lds
M v[212:215], a[148:151], v[48:51], v[212:215]
 s_waitcnt lgkmcnt(0)
 v_cvt_pk_bf16_f32 v209, v210, v211
 v_cvt_pk_bf16_f32 v210, v216, v217
 v_cvt_pk_bf16_f32 v211, v218, v219
M v[220:223], a[156:159], v[48:51], v[220:223]
 s_barrier
M v[220:223], a[152:155], v[52:55], v[220:223]
 ds_read_b128 a[64:67], v2 offset:32768
 ds_read_b128 a[68:71], v2 offset:33792
 v_cvt_pk_bf16_f32 v224, v224, v225
M v[228:231], a[160:163], v[52:55], v[228:231]
 ds_read_b128 a[72:75], v2 offset:34816
 v_cvt_pk_bf16_f32 v225, v226, v227
 v_cvt_pk_bf16_f32 v226, v232, v233
M v[228:231], a[164:167], v[48:51], v[228:231]
 ds_read_b128 a[76:79], v2 offset:35840
 ds_read_b128 a[80:83], v2 offset:36864
M v[236:239], a[172:175], v[48:51], v[236:239]
 ds_read_b128 a[84:87], v2 offset:37888
 v_cvt_pk_bf16_f32 v227, v234, v235
 v_cvt_pk_bf16_f32 v240, v240, v241
M v[236:239], a[168:171], v[52:55], v[236:239]
 ds_read_b128 a[88:91], v2 offset:38912
 ds_read_b128 a[92:95], v2 offset:39936
 v_cvt_pk_bf16_f32 v241, v242, v243
M v[244:247], a[176:179], v[52:55], v[244:247]
 buffer_load_dwordx4 v4, s[8:11], s38 offen offset:1024 sc1 lds
M v[244:247], a[180:183], v[48:51], v[244:247]
 buffer_load_dwordx4 v4, s[8:11], s38 offen offset:2048 sc1 lds
M v[252:255], a[188:191], v[48:51], v[252:255]
 buffer_load_dwordx4 v4, s[8:11], s38 offen offset:3072 sc1 lds
M v[252:255], a[184:187], v[52:55], v[252:255]
 s_waitcnt lgkmcnt(0)
 s_add_u32 s38, s38, 32768
 v_cvt_pk_bf16_f32 v242, v248, v249
 v_cvt_pk_bf16_f32 v243, v250, v251
 s_branch L_op1
L_p1c:
 v_cndmask_b32 v64, v32, v8, s[64:65]
 v_cndmask_b32 v65, v32, v8, s[66:67]
 v_cndmask_b32 v66, v32, v8, s[68:69]
 v_cndmask_b32 v67, v32, v8, s[70:71]
 s_nop 1
M v[64:67], a[64:67], a[0:3], v[64:67]
 s_add_u32 m0, s28, 65536
 ds_read_b128 a[96:99], v2 offset:40960
 ds_read_b128 a[100:103], v2 offset:41984
M v[64:67], a[68:71], a[4:7], v[64:67]
 buffer_load_dwordx4 v3, s[8:11], s24 offen offset:0 sc1 lds
M v[64:67], a[72:75], a[8:11], v[64:67]
 v_exp_f32 v18, v112
M v[64:67], a[76:79], a[12:15], v[64:67]
 ds_read_b128 a[104:107], v2 offset:43008
 ds_read_b128 a[108:111], v2 offset:44032
M v[64:67], a[80:83], a[16:19], v[64:67]
 buffer_load_dwordx4 v[14:17], v7, s[8:11], s52 offen sc1
M v[64:67], a[84:87], a[20:23], v[64:67]
 s_cmp_eq_u32 s20, 3
 v_exp_f32 v19, v113
M v[64:67], a[88:91], a[24:27], v[64:67]
 s_cselect_b64 s[64:65], s[16:17], 0
 ds_read_b128 a[112:115], v2 offset:45056
 ds_read_b128 a[116:119], v2 offset:46080
M v[64:67], a[92:95], a[28:31], v[64:67]
 s_cselect_b64 s[66:67], s[18:19], 0
 v_exp_f32 v20, v114
M v[68:71], a[92:95], a[60:63], v[36:39]
 s_cselect_b64 s[68:69], s[48:49], 0
 v_add_f32 v28, v18, v28
 v_cvt_pk_bf16_f32 v56, v18, v19
M v[68:71], a[88:91], a[56:59], v[68:71]
 s_cselect_b64 s[70:71], s[50:51], 0
 ds_read_b128 a[120:123], v2 offset:47104
 ds_read_b128 a[124:127], v2 offset:48128
M v[68:71], a[84:87], a[52:55], v[68:71]
 buffer_load_dwordx4 v3, s[8:11], s24 offen offset:1024 sc1 lds
M v[68:71], a[80:83], a[48:51], v[68:71]
 v_cndmask_b32 v72, v32, v8, s[72:73]
 v_cndmask_b32 v73, v32, v8, s[74:75]
M v[68:71], a[76:79], a[44:47], v[68:71]
 v_cndmask_b32 v74, v32, v8, s[76:77]
 v_cndmask_b32 v75, v32, v8, s[78:79]
M v[68:71], a[72:75], a[40:43], v[68:71]
 buffer_load_dwordx4 a[128:131], v7, s[8:11], s12 offen offset:0 sc1
M v[68:71], a[68:71], a[36:39], v[68:71]
 buffer_load_dwordx4 a[132:135], v7, s[8:11], s12 offen offset:1024 sc1
M v[68:71], a[64:67], a[32:35], v[68:71]
 s_waitcnt lgkmcnt(0)
 v_exp_f32 v21, v115
M v[72:75], a[96:99], a[0:3], v[72:75]
 ds_read_b128 a[64:67], v2 offset:49152
 ds_read_b128 a[68:71], v2 offset:50176
M v[72:75], a[100:103], a[4:7], v[72:75]
 buffer_load_dwordx4 v3, s[8:11], s24 offen offset:2048 sc1 lds
M v[72:75], a[104:107], a[8:11], v[72:75]
 v_exp_f32 v22, v120
M v[72:75], a[108:111], a[12:15], v[72:75]
 ds_read_b128 a[72:75], v2 offset:51200
 ds_read_b128 a[76:79], v2 offset:52224
M v[72:75], a[112:115], a[16:19], v[72:75]
 buffer_load_dwordx4 v3, s[8:11], s24 offen offset:3072 sc1 lds
M v[72:75], a[116:119], a[20:23], v[72:75]
 s_cmp_gt_u32 s20, 2
 v_exp_f32 v23, v121
M v[72:75], a[120:123], a[24:27], v[72:75]
 s_cselect_b64 s[78:79], -1, 0
 ds_read_b128 a[80:83], v2 offset:53248
 ds_read_b128 a[84:87], v2 offset:54272
M v[72:75], a[124:127], a[28:31], v[72:75]
 s_cmp_eq_u32 s20, 2
 v_exp_f32 v24, v122
M v[76:79], a[124:127], a[60:63], v[36:39]
 s_cselect_b64 s[72:73], s[16:17], s[78:79]
 v_exp_f32 v25, v123
M v[76:79], a[120:123], a[56:59], v[76:79]
 s_cselect_b64 s[74:75], s[18:19], s[78:79]
 ds_read_b128 a[88:91], v2 offset:55296
 ds_read_b128 a[92:95], v2 offset:56320
M v[76:79], a[116:119], a[52:55], v[76:79]
 s_cselect_b64 s[76:77], s[48:49], s[78:79]
 v_add_f32 v28, v19, v28
 v_add_f32 v28, v20, v28
M v[76:79], a[112:115], a[48:51], v[76:79]
 s_cselect_b64 s[78:79], s[50:51], s[78:79]
 v_cndmask_b32 v80, v32, v8, s[80:81]
 v_cndmask_b32 v81, v32, v8, s[82:83]
M v[76:79], a[108:111], a[44:47], v[76:79]
 s_add_u32 m0, s28, 69632
 v_cndmask_b32 v82, v32, v8, s[84:85]
 v_cndmask_b32 v83, v32, v8, s[86:87]
M v[76:79], a[104:107], a[40:43], v[76:79]
 buffer_load_dwordx4 a[136:139], v7, s[8:11], s12 offen offset:2048 sc1
M v[76:79], a[100:103], a[36:39], v[76:79]
 buffer_load_dwordx4 v4, s[8:11], s24 offen offset:0 sc1 lds
M v[76:79], a[96:99], a[32:35], v[76:79]
 s_waitcnt lgkmcnt(0)
 v_exp_f32 v18, v116
M v[80:83], a[64:67], a[0:3], v[80:83]
 ds_read_b128 a[96:99], v2 offset:57344
 ds_read_b128 a[100:103], v2 offset:58368
M v[80:83], a[68:71], a[4:7], v[80:83]
 buffer_load_dwordx4 a[140:143], v7, s[8:11], s12 offen offset:3072 sc1
M v[80:83], a[72:75], a[8:11], v[80:83]
 buffer_load_dwordx4 v4, s[8:11], s24 offen offset:1024 sc1 lds
M v[80:83], a[76:79], a[12:15], v[80:83]
 ds_read_b128 a[104:107], v2 offset:59392
 ds_read_b128 a[108:111], v2 offset:60416
M v[80:83], a[80:83], a[16:19], v[80:83]
 buffer_load_dwordx4 a[144:147], v7, s[8:11], s13 offen offset:0 sc1
M v[80:83], a[84:87], a[20:23], v[80:83]
 s_cmp_gt_u32 s20, 1
 v_exp_f32 v19, v117
M v[80:83], a[88:91], a[24:27], v[80:83]
 s_cselect_b64 s[86:87], -1, 0
 ds_read_b128 a[112:115], v2 offset:61440
 ds_read_b128 a[116:119], v2 offset:62464
M v[80:83], a[92:95], a[28:31], v[80:83]
 s_cmp_eq_u32 s20, 1
 v_cvt_pk_bf16_f32 v57, v20, v21
 v_add_f32 v28, v21, v28
M v[84:87], a[92:95], a[60:63], v[36:39]
 s_cselect_b64 s[80:81], s[16:17], s[86:87]
 v_exp_f32 v20, v118
M v[84:87], a[88:91], a[56:59], v[84:87]
 s_cselect_b64 s[82:83], s[18:19], s[86:87]
 ds_read_b128 a[120:123], v2 offset:63488
 ds_read_b128 a[124:127], v2 offset:64512
M v[84:87], a[84:87], a[52:55], v[84:87]
 s_cselect_b64 s[84:85], s[48:49], s[86:87]
 v_exp_f32 v21, v119
M v[84:87], a[80:83], a[48:51], v[84:87]
 s_cselect_b64 s[86:87], s[50:51], s[86:87]
 v_cndmask_b32 v88, v32, v8, s[88:89]
 v_cndmask_b32 v89, v32, v8, s[90:91]
M v[84:87], a[76:79], a[44:47], v[84:87]
 v_cndmask_b32 v90, v32, v8, s[92:93]
 v_cndmask_b32 v91, v32, v8, s[94:95]
M v[84:87], a[72:75], a[40:43], v[84:87]
 buffer_load_dwordx4 v4, s[8:11], s24 offen offset:2048 sc1 lds
M v[84:87], a[68:71], a[36:39], v[84:87]
 s_waitcnt vmcnt(21) lgkmcnt(0)
 v_add_f32 v28, v22, v28
 v_cvt_pk_bf16_f32 v58, v22, v23
M v[84:87], a[64:67], a[32:35], v[84:87]
 s_barrier
M v[88:91], a[96:99], a[0:3], v[88:91]
 ds_read_b128 a[64:67], v7 offset:0
 ds_read_b128 a[68:71], v7 offset:1024
M v[88:91], a[100:103], a[4:7], v[88:91]
 s_cmp_eq_u32 s20, 0
 v_add_f32 v28, v23, v28
 v_add_f32 v28, v24, v28
M v[88:91], a[104:107], a[8:11], v[88:91]
 s_cselect_b64 s[88:89], s[16:17], -1
 v_exp_f32 v22, v124
M v[88:91], a[108:111], a[12:15], v[88:91]
 s_cselect_b64 s[90:91], s[18:19], -1
 ds_read_b128 a[72:75], v7 offset:2048
 ds_read_b128 a[76:79], v7 offset:3072
M v[88:91], a[112:115], a[16:19], v[88:91]
 s_cselect_b64 s[92:93], s[48:49], -1
 v_exp_f32 v23, v125
M v[88:91], a[116:119], a[20:23], v[88:91]
 s_cselect_b64 s[94:95], s[50:51], -1
 v_cvt_pk_bf16_f32 v59, v24, v25
 v_add_f32 v28, v25, v28
M v[88:91], a[120:123], a[24:27], v[88:91]
 ds_read_b128 a[80:83], v7 offset:4096
 ds_read_b128 a[84:87], v7 offset:5120
M v[88:91], a[124:127], a[28:31], v[88:91]
 buffer_load_dwordx4 a[148:151], v7, s[8:11], s13 offen offset:1024 sc1
M v[92:95], a[124:127], a[60:63], v[36:39]
 buffer_load_dwordx4 v4, s[8:11], s24 offen offset:3072 sc1 lds
M v[92:95], a[120:123], a[56:59], v[92:95]
 ds_read_b128 a[88:91], v7 offset:6144
 ds_read_b128 a[92:95], v7 offset:7168
M v[92:95], a[116:119], a[52:55], v[92:95]
 buffer_load_dwordx4 a[152:155], v7, s[8:11], s13 offen offset:2048 sc1
M v[92:95], a[112:115], a[48:51], v[92:95]
 v_exp_f32 v24, v126
M v[92:95], a[108:111], a[44:47], v[92:95]
 buffer_load_dwordx4 a[156:159], v7, s[8:11], s13 offen offset:3072 sc1
M v[92:95], a[104:107], a[40:43], v[92:95]
 v_exp_f32 v25, v127
M v[92:95], a[100:103], a[36:39], v[92:95]
 s_waitcnt lgkmcnt(0)
 v_add_f32 v29, v18, v29
 v_cvt_pk_bf16_f32 v60, v18, v19
M v[92:95], a[96:99], a[32:35], v[92:95]
 v_add_f32 v29, v19, v29
 v_add_f32 v29, v20, v29
 v_cvt_pk_bf16_f32 v61, v20, v21
 v_add_f32 v29, v21, v29
 v_add_f32 v29, v22, v29
 v_cvt_pk_bf16_f32 v62, v22, v23
 v_add_f32 v29, v23, v29
 v_add_f32 v29, v24, v29
 v_cvt_pk_bf16_f32 v63, v24, v25
 v_add_f32 v29, v25, v29
 v_max_f32 v10, v28, v29
 v_cmp_lt_f32 vcc, s31, v10
 s_nop 0
 s_cbranch_vccnz L_st3
L_rt3:
M v[128:131], a[64:67], v[48:51], v[128:131]
 s_add_u32 m0, s28, 98304
 ds_read_b128 a[96:99], v7 offset:8192
 ds_read_b128 a[100:103], v7 offset:9216
M v[128:131], a[68:71], v[56:59], v[128:131]
 buffer_load_dwordx4 v3, s[8:11], s21 offen offset:0 sc1 lds
M v[132:135], a[68:71], v[60:63], v[132:135]
 v_exp_f32 v18, v64
M v[132:135], a[64:67], v[52:55], v[132:135]
 ds_read_b128 a[104:107], v7 offset:10240
 ds_read_b128 a[108:111], v7 offset:11264
M v[140:143], a[72:75], v[52:55], v[140:143]
 buffer_load_dwordx4 a[160:163], v7, s[8:11], s14 offen offset:0 sc1
M v[140:143], a[76:79], v[60:63], v[140:143]
 v_cndmask_b32 v100, v36, v8, s[64:65]
 v_add_f32 v30, v28, v30
M v[136:139], a[76:79], v[56:59], v[136:139]
 ds_read_b128 a[112:115], v7 offset:12288
 ds_read_b128 a[116:119], v7 offset:13312
M v[136:139], a[72:75], v[48:51], v[136:139]
 buffer_load_dwordx4 v3, s[8:11], s21 offen offset:1024 sc1 lds
M v[144:147], a[80:83], v[48:51], v[144:147]
 v_cndmask_b32 v101, v36, v8, s[66:67]
 v_add_f32 v31, v29, v31
M v[144:147], a[84:87], v[56:59], v[144:147]
 ds_read_b128 a[120:123], v7 offset:14336
 ds_read_b128 a[124:127], v7 offset:15360
M v[148:151], a[84:87], v[60:63], v[148:151]
 buffer_load_dwordx4 a[164:167], v7, s[8:11], s14 offen offset:1024 sc1
M v[148:151], a[80:83], v[52:55], v[148:151]
 v_cndmask_b32 v102, v36, v8, s[68:69]
M v[156:159], a[88:91], v[52:55], v[156:159]
 buffer_load_dwordx4 v3, s[8:11], s21 offen offset:2048 sc1 lds
M v[156:159], a[92:95], v[60:63], v[156:159]
 v_exp_f32 v19, v65
M v[152:155], a[92:95], v[56:59], v[152:155]
 buffer_load_dwordx4 a[168:171], v7, s[8:11], s14 offen offset:2048 sc1
M v[152:155], a[88:91], v[48:51], v[152:155]
 s_waitcnt lgkmcnt(0)
 v_cndmask_b32 v103, v36, v8, s[70:71]
 v_add_f32 v26, v18, v19
M v[160:163], a[96:99], v[48:51], v[160:163]
 ds_read_b128 a[64:67], v7 offset:16384
 ds_read_b128 a[68:71], v7 offset:17408
M v[160:163], a[100:103], v[56:59], v[160:163]
 buffer_load_dwordx4 v3, s[8:11], s21 offen offset:3072 sc1 lds
M v[164:167], a[100:103], v[60:63], v[164:167]
 v_cndmask_b32 v108, v36, v8, s[72:73]
 v_cvt_pk_bf16_f32 v40, v18, v19
M v[164:167], a[96:99], v[52:55], v[164:167]
 ds_read_b128 a[72:75], v7 offset:18432
 ds_read_b128 a[76:79], v7 offset:19456
M v[172:175], a[104:107], v[52:55], v[172:175]
 buffer_load_dwordx4 a[172:175], v7, s[8:11], s14 offen offset:3072 sc1
M v[172:175], a[108:111], v[60:63], v[172:175]
 v_exp_f32 v20, v66
M v[168:171], a[108:111], v[56:59], v[168:171]
 s_add_u32 m0, s28, 102400
 ds_read_b128 a[80:83], v7 offset:20480
 ds_read_b128 a[84:87], v7 offset:21504
M v[168:171], a[104:107], v[48:51], v[168:171]
 buffer_load_dwordx4 v4, s[8:11], s21 offen offset:0 sc1 lds
M v[176:179], a[112:115], v[48:51], v[176:179]
 v_cndmask_b32 v109, v36, v8, s[74:75]
M v[176:179], a[116:119], v[56:59], v[176:179]
 ds_read_b128 a[88:91], v7 offset:22528
 ds_read_b128 a[92:95], v7 offset:23552
M v[180:183], a[116:119], v[60:63], v[180:183]
 buffer_load_dwordx4 a[176:179], v7, s[8:11], s15 offen offset:0 sc1
M v[180:183], a[112:115], v[52:55], v[180:183]
 v_cndmask_b32 v110, v36, v8, s[76:77]
M v[188:191], a[120:123], v[52:55], v[188:191]
 buffer_load_dwordx4 v4, s[8:11], s21 offen offset:1024 sc1 lds
M v[188:191], a[124:127], v[60:63], v[188:191]
 v_cndmask_b32 v111, v36, v8, s[78:79]
M v[184:187], a[124:127], v[56:59], v[184:187]
 buffer_load_dwordx4 a[180:183], v7, s[8:11], s15 offen offset:1024 sc1
M v[184:187], a[120:123], v[48:51], v[184:187]
 s_waitcnt lgkmcnt(0)
 v_exp_f32 v21, v67
M v[192:195], a[64:67], v[48:51], v[192:195]
 ds_read_b128 a[96:99], v7 offset:24576
 ds_read_b128 a[100:103], v7 offset:25600
M v[192:195], a[68:71], v[56:59], v[192:195]
 buffer_load_dwordx4 v4, s[8:11], s21 offen offset:2048 sc1 lds
M v[196:199], a[68:71], v[60:63], v[196:199]
 v_cndmask_b32 v116, v36, v8, s[80:81]
 v_add_f32 v26, v20, v26
M v[196:199], a[64:67], v[52:55], v[196:199]
 ds_read_b128 a[104:107], v7 offset:26624
 ds_read_b128 a[108:111], v7 offset:27648
M v[204:207], a[72:75], v[52:55], v[204:207]
 buffer_load_dwordx4 a[184:187], v7, s[8:11], s15 offen offset:2048 sc1
M v[204:207], a[76:79], v[60:63], v[204:207]
 v_cndmask_b32 v117, v36, v8, s[82:83]
 v_cvt_pk_bf16_f32 v41, v20, v21
M v[200:203], a[76:79], v[56:59], v[200:203]
 ds_read_b128 a[112:115], v7 offset:28672
 ds_read_b128 a[116:119], v7 offset:29696
M v[200:203], a[72:75], v[48:51], v[200:203]
 buffer_load_dwordx4 v4, s[8:11], s21 offen offset:3072 sc1 lds
M v[208:211], a[80:83], v[48:51], v[208:211]
 s_add_u32 s24, s23, 16777216
 v_cndmask_b32 v118, v36, v8, s[84:85]
 v_add_f32 v26, v21, v26
M v[208:211], a[84:87], v[56:59], v[208:211]
 s_mov_b32 s23, s21
 ds_read_b128 a[120:123], v7 offset:30720
 ds_read_b128 a[124:127], v7 offset:31744
M v[212:215], a[84:87], v[60:63], v[212:215]
 buffer_load_dwordx4 a[188:191], v7, s[8:11], s15 offen offset:3072 sc1
M v[212:215], a[80:83], v[52:55], v[212:215]
 s_add_u32 s21, s21, 32768
 v_cndmask_b32 v119, v36, v8, s[86:87]
M v[220:223], a[88:91], v[52:55], v[220:223]
 s_add_u32 s22, s22, 1
 v_exp_f32 v22, v72
M v[220:223], a[92:95], v[60:63], v[220:223]
 s_cmp_eq_u32 s22, s25
 v_exp_f32 v23, v73
M v[216:219], a[92:95], v[56:59], v[216:219]
 s_waitcnt vmcnt(33) lgkmcnt(0)
 v_exp_f32 v24, v74
M v[216:219], a[88:91], v[48:51], v[216:219]
 s_barrier
M v[224:227], a[96:99], v[48:51], v[224:227]
 s_cselect_b32 s21, s26, s21
 ds_read_b128 a[64:67], v7 offset:32768
 ds_read_b128 a[68:71], v7 offset:33792
M v[224:227], a[100:103], v[56:59], v[224:227]
 s_cmp_eq_u32 s22, s43
 v_cndmask_b32 v124, v36, v8, s[88:89]
 v_add_f32 v26, v22, v26
M v[228:231], a[100:103], v[60:63], v[228:231]
 s_cselect_b32 s21, s4, s21
 v_exp_f32 v25, v75
M v[228:231], a[96:99], v[52:55], v[228:231]
 s_cmp_eq_u32 s22, s6
 ds_read_b128 a[72:75], v7 offset:34816
 ds_read_b128 a[76:79], v7 offset:35840
M v[236:239], a[104:107], v[52:55], v[236:239]
 s_cselect_b32 s21, s7, s21
 v_cndmask_b32 v125, v36, v8, s[90:91]
 v_cvt_pk_bf16_f32 v42, v22, v23
M v[236:239], a[108:111], v[60:63], v[236:239]
 v_exp_f32 v18, v68
M v[232:235], a[108:111], v[56:59], v[232:235]
 ds_read_b128 a[80:83], v7 offset:36864
 ds_read_b128 a[84:87], v7 offset:37888
M v[232:235], a[104:107], v[48:51], v[232:235]
 v_cndmask_b32 v126, v36, v8, s[92:93]
 v_add_f32 v26, v23, v26
M v[240:243], a[112:115], v[48:51], v[240:243]
 v_exp_f32 v19, v69
M v[240:243], a[116:119], v[56:59], v[240:243]
 ds_read_b128 a[88:91], v7 offset:38912
 ds_read_b128 a[92:95], v7 offset:39936
M v[244:247], a[116:119], v[60:63], v[244:247]
 v_cndmask_b32 v127, v36, v8, s[94:95]
 v_add_f32 v26, v24, v26
M v[244:247], a[112:115], v[52:55], v[244:247]
 v_exp_f32 v20, v70
M v[252:255], a[120:123], v[52:55], v[252:255]
 v_exp_f32 v21, v71
M v[252:255], a[124:127], v[60:63], v[252:255]
 v_exp_f32 v22, v76
M v[248:251], a[124:127], v[56:59], v[248:251]
 s_waitcnt lgkmcnt(0)
 v_exp_f32 v23, v77
M v[248:251], a[120:123], v[48:51], v[248:251]
 v_cvt_pk_bf16_f32 v43, v24, v25
 v_add_f32 v26, v25, v26
 v_add_f32 v27, v18, v19
 v_cvt_pk_bf16_f32 v44, v18, v19
 v_add_f32 v27, v20, v27
 v_cvt_pk_bf16_f32 v45, v20, v21
 v_add_f32 v27, v21, v27
 v_exp_f32 v24, v78
 v_add_f32 v27, v22, v27
 v_cvt_pk_bf16_f32 v46, v22, v23
 v_exp_f32 v25, v79
 v_add_f32 v27, v23, v27
 v_add_f32 v27, v24, v27
 v_cvt_pk_bf16_f32 v47, v24, v25
 v_add_f32 v27, v25, v27
 s_waitcnt vmcnt(31)
 v_cmp_neq_f32 vcc, v32, v14
 v_cmp_neq_f32 s[64:65], v36, v15
 s_nop 0
 s_or_b64 vcc, vcc, s[64:65]
 s_cbranch_vccnz L_comb
 v_add_f32 v30, v16, v30
 v_add_f32 v31, v17, v31
M v[100:103], a[64:67], a[32:35], v[100:103]
 ds_read_b128 a[96:99], v7 offset:40960
 ds_read_b128 a[100:103], v7 offset:41984
M v[100:103], a[68:71], a[36:39], v[100:103]
 ds_read_b128 a[104:107], v7 offset:43008
M v[100:103], a[72:75], a[40:43], v[100:103]
 ds_read_b128 a[108:111], v7 offset:44032
 ds_read_b128 a[112:115], v7 offset:45056
M v[100:103], a[76:79], a[44:47], v[100:103]
 ds_read_b128 a[116:119], v7 offset:46080
M v[100:103], a[80:83], a[48:51], v[100:103]
 s_add_u32 m0, s28, 0
 ds_read_b128 a[120:123], v7 offset:47104
 ds_read_b128 a[124:127], v7 offset:48128
M v[100:103], a[84:87], a[52:55], v[100:103]
 buffer_load_dwordx4 v3, s[8:11], s24 offen offset:0 sc1 lds
M v[100:103], a[88:91], a[56:59], v[100:103]
 ds_read_b128 a[0:3], v7 offset:49152
 ds_read_b128 a[4:7], v7 offset:50176
M v[100:103], a[92:95], a[60:63], v[100:103]
 s_waitcnt lgkmcnt(2)
 ds_read_b128 a[8:11], v7 offset:51200
M v[108:111], a[124:127], a[60:63], v[108:111]
 ds_read_b128 a[12:15], v7 offset:52224
 ds_read_b128 a[16:19], v7 offset:53248
M v[108:111], a[120:123], a[56:59], v[108:111]
 buffer_load_dwordx4 v3, s[8:11], s24 offen offset:1024 sc1 lds
M v[108:111], a[116:119], a[52:55], v[108:111]
 ds_read_b128 a[20:23], v7 offset:54272
 ds_read_b128 a[24:27], v7 offset:55296
M v[108:111], a[112:115], a[48:51], v[108:111]
 ds_read_b128 a[28:31], v7 offset:56320
M v[108:111], a[108:111], a[44:47], v[108:111]
 ds_read_b128 a[192:195], v7 offset:57344
 ds_read_b128 a[196:199], v7 offset:58368
M v[108:111], a[104:107], a[40:43], v[108:111]
 v_exp_f32 v18, v80
M v[108:111], a[100:103], a[36:39], v[108:111]
 ds_read_b128 a[200:203], v7 offset:59392
 ds_read_b128 a[204:207], v7 offset:60416
M v[108:111], a[96:99], a[32:35], v[108:111]
 s_waitcnt lgkmcnt(4)
 ds_read_b128 a[208:211], v7 offset:61440
M v[116:119], a[0:3], a[32:35], v[116:119]
 ds_read_b128 a[212:215], v7 offset:62464
 ds_read_b128 a[216:219], v7 offset:63488
M v[116:119], a[4:7], a[36:39], v[116:119]
 ds_read_b128 a[220:223], v7 offset:64512
M v[116:119], a[8:11], a[40:43], v[116:119]
 buffer_load_dwordx4 v3, s[8:11], s24 offen offset:2048 sc1 lds
M v[116:119], a[12:15], a[44:47], v[116:119]
 v_exp_f32 v19, v81
M v[116:119], a[16:19], a[48:51], v[116:119]
 buffer_load_dwordx4 v3, s[8:11], s24 offen offset:3072 sc1 lds
M v[116:119], a[20:23], a[52:55], v[116:119]
 v_exp_f32 v20, v82
M v[116:119], a[24:27], a[56:59], v[116:119]
 s_add_u32 m0, s28, 4096
 v_exp_f32 v21, v83
M v[116:119], a[28:31], a[60:63], v[116:119]
 s_waitcnt lgkmcnt(0)
 v_exp_f32 v22, v88
M v[124:127], a[220:223], a[60:63], v[124:127]
 buffer_load_dwordx4 v4, s[8:11], s24 offen offset:0 sc1 lds
M v[124:127], a[216:219], a[56:59], v[124:127]
 v_exp_f32 v23, v89
M v[124:127], a[212:215], a[52:55], v[124:127]
 v_exp_f32 v24, v90
M v[124:127], a[208:211], a[48:51], v[124:127]
 v_exp_f32 v25, v91
M v[124:127], a[204:207], a[44:47], v[124:127]
 v_add_f32 v26, v18, v26
 v_cvt_pk_bf16_f32 v56, v18, v19
M v[124:127], a[200:203], a[40:43], v[124:127]
 buffer_load_dwordx4 v4, s[8:11], s24 offen offset:1024 sc1 lds
M v[124:127], a[196:199], a[36:39], v[124:127]
 v_add_f32 v26, v19, v26
 v_add_f32 v26, v20, v26
M v[124:127], a[192:195], a[32:35], v[124:127]
 s_waitcnt vmcnt(22)
 v_exp_f32 v18, v84
M v[128:131], a[246:249], a[128:131], v[128:131]
 v_exp_f32 v19, v85
M v[136:139], a[244:247], a[128:131], v[136:139]
 v_cvt_pk_bf16_f32 v57, v20, v21
 v_add_f32 v26, v21, v26
M v[144:147], a[246:249], a[132:135], v[144:147]
 buffer_load_dwordx4 v4, s[8:11], s24 offen offset:2048 sc1 lds
M v[152:155], a[244:247], a[132:135], v[152:155]
 v_exp_f32 v20, v86
M v[160:163], a[246:249], a[136:139], v[160:163]
 v_add_f32 v26, v22, v26
 v_cvt_pk_bf16_f32 v58, v22, v23
M v[168:171], a[244:247], a[136:139], v[168:171]
 v_add_f32 v26, v23, v26
 v_add_f32 v26, v24, v26
M v[176:179], a[246:249], a[140:143], v[176:179]
 v_exp_f32 v21, v87
M v[184:187], a[244:247], a[140:143], v[184:187]
 buffer_load_dwordx4 v4, s[8:11], s24 offen offset:3072 sc1 lds
M v[192:195], a[246:249], a[144:147], v[192:195]
 v_cvt_pk_bf16_f32 v59, v24, v25
 v_add_f32 v26, v25, v26
M v[200:203], a[244:247], a[144:147], v[200:203]
 v_add_f32 v27, v18, v27
 v_cvt_pk_bf16_f32 v60, v18, v19
M v[208:211], a[246:249], a[148:151], v[208:211]
 v_exp_f32 v22, v92
M v[216:219], a[244:247], a[148:151], v[216:219]
 v_add_f32 v27, v19, v27
 v_add_f32 v27, v20, v27
M v[224:227], a[246:249], a[152:155], v[224:227]
 v_cvt_pk_bf16_f32 v61, v20, v21
 v_add_f32 v27, v21, v27
M v[232:235], a[244:247], a[152:155], v[232:235]
 s_waitcnt vmcnt(8)
 v_exp_f32 v23, v93
M v[240:243], a[246:249], a[156:159], v[240:243]
 v_add_f32 v27, v22, v27
 v_cvt_pk_bf16_f32 v62, v22, v23
M v[248:251], a[244:247], a[156:159], v[248:251]
 s_barrier
M v[132:135], a[246:249], a[160:163], v[132:135]
 ds_read_b128 a[64:67], v2 offset:0
 v_add_f32 v27, v23, v27
M v[140:143], a[244:247], a[160:163], v[140:143]
 ds_read_b128 a[68:71], v2 offset:1024
M v[148:151], a[246:249], a[164:167], v[148:151]
 v_exp_f32 v24, v94
M v[156:159], a[244:247], a[164:167], v[156:159]
 ds_read_b128 a[72:75], v2 offset:2048
M v[164:167], a[246:249], a[168:171], v[164:167]
 ds_read_b128 a[76:79], v2 offset:3072
M v[172:175], a[244:247], a[168:171], v[172:175]
 v_exp_f32 v25, v95
M v[180:183], a[246:249], a[172:175], v[180:183]
 ds_read_b128 a[80:83], v2 offset:4096
 v_add_f32 v27, v24, v27
M v[188:191], a[244:247], a[172:175], v[188:191]
 ds_read_b128 a[84:87], v2 offset:5120
 v_cvt_pk_bf16_f32 v63, v24, v25
M v[196:199], a[246:249], a[176:179], v[196:199]
 v_add_f32 v27, v25, v27
M v[204:207], a[244:247], a[176:179], v[204:207]
 ds_read_b128 a[88:91], v2 offset:6144
M v[212:215], a[246:249], a[180:183], v[212:215]
 ds_read_b128 a[92:95], v2 offset:7168
 v_max_f32 v10, v26, v27
M v[220:223], a[244:247], a[180:183], v[220:223]
 v_cmp_lt_f32 vcc, s31, v10
M v[228:231], a[246:249], a[184:187], v[228:231]
M v[236:239], a[244:247], a[184:187], v[236:239]
M v[244:247], a[246:249], a[188:191], v[244:247]
 s_waitcnt lgkmcnt(0)
M v[252:255], a[244:247], a[188:191], v[252:255]
 s_cbranch_vccnz L_st14
L_rt14:
 s_branch L_p3o
L_op1:
M v[64:67], a[64:67], v[128:131], 0
 ds_read_b128 a[96:99], v2 offset:40960
 ds_read_b128 a[100:103], v2 offset:41984
M v[64:67], a[68:71], v[144:147], v[64:67]
 ds_read_b128 a[104:107], v2 offset:43008
 v_cvt_pk_bf16_f32 v132, v132, v133
 v_cvt_pk_bf16_f32 v133, v134, v135
M v[64:67], a[72:75], v[160:163], v[64:67]
 ds_read_b128 a[108:111], v2 offset:44032
 ds_read_b128 a[112:115], v2 offset:45056
M v[64:67], a[76:79], v[176:179], v[64:67]
 ds_read_b128 a[116:119], v2 offset:46080
 v_cvt_pk_bf16_f32 v134, v140, v141
 v_cvt_pk_bf16_f32 v135, v142, v143
M v[64:67], a[80:83], v[192:195], v[64:67]
 s_add_u32 m0, s28, 0
 ds_read_b128 a[120:123], v2 offset:47104
 ds_read_b128 a[124:127], v2 offset:48128
M v[64:67], a[84:87], v[208:211], v[64:67]
 buffer_load_dwordx4 v3, s[8:11], s38 offen offset:0 sc1 lds
M v[64:67], a[88:91], v[224:227], v[64:67]
 ds_read_b128 a[128:131], v2 offset:49152
 ds_read_b128 a[132:135], v2 offset:50176
 v_cvt_pk_bf16_f32 v148, v148, v149
M v[64:67], a[92:95], v[240:243], v[64:67]
 s_waitcnt lgkmcnt(2)
 ds_read_b128 a[136:139], v2 offset:51200
 v_cvt_pk_bf16_f32 v149, v150, v151
M v[72:75], a[96:99], v[128:131], 0
 ds_read_b128 a[140:143], v2 offset:52224
 ds_read_b128 a[144:147], v2 offset:53248
M v[72:75], a[100:103], v[144:147], v[72:75]
 buffer_load_dwordx4 v3, s[8:11], s38 offen offset:1024 sc1 lds
M v[72:75], a[104:107], v[160:163], v[72:75]
 ds_read_b128 a[148:151], v2 offset:54272
 ds_read_b128 a[152:155], v2 offset:55296
 v_cvt_pk_bf16_f32 v150, v156, v157
M v[72:75], a[108:111], v[176:179], v[72:75]
 ds_read_b128 a[156:159], v2 offset:56320
 v_cvt_pk_bf16_f32 v151, v158, v159
M v[72:75], a[112:115], v[192:195], v[72:75]
 ds_read_b128 a[160:163], v2 offset:57344
 ds_read_b128 a[164:167], v2 offset:58368
 v_cvt_pk_bf16_f32 v164, v164, v165
M v[72:75], a[116:119], v[208:211], v[72:75]
 buffer_load_dwordx4 v3, s[8:11], s38 offen offset:2048 sc1 lds
M v[72:75], a[120:123], v[224:227], v[72:75]
 ds_read_b128 a[168:171], v2 offset:59392
 ds_read_b128 a[172:175], v2 offset:60416
M v[72:75], a[124:127], v[240:243], v[72:75]
 s_waitcnt lgkmcnt(4)
 ds_read_b128 a[176:179], v2 offset:61440
 v_cvt_pk_bf16_f32 v165, v166, v167
 v_cvt_pk_bf16_f32 v166, v172, v173
M v[80:83], a[128:131], v[128:131], 0
 ds_read_b128 a[180:183], v2 offset:62464
 ds_read_b128 a[184:187], v2 offset:63488
M v[80:83], a[132:135], v[144:147], v[80:83]
 ds_read_b128 a[188:191], v2 offset:64512
 v_cvt_pk_bf16_f32 v167, v174, v175
 v_cvt_pk_bf16_f32 v180, v180, v181
M v[80:83], a[136:139], v[160:163], v[80:83]
 buffer_load_dwordx4 v3, s[8:11], s38 offen offset:3072 sc1 lds
M v[80:83], a[140:143], v[176:179], v[80:83]
 s_add_u32 m0, s28, 4096
 v_cvt_pk_bf16_f32 v181, v182, v183
 v_cvt_pk_bf16_f32 v182, v188, v189
M v[80:83], a[144:147], v[192:195], v[80:83]
 buffer_load_dwordx4 v4, s[8:11], s38 offen offset:0 sc1 lds
M v[80:83], a[148:151], v[208:211], v[80:83]
 v_cvt_pk_bf16_f32 v183, v190, v191
 v_cvt_pk_bf16_f32 v196, v196, v197
M v[80:83], a[152:155], v[224:227], v[80:83]
 buffer_load_dwordx4 v4, s[8:11], s38 offen offset:1024 sc1 lds
M v[80:83], a[156:159], v[240:243], v[80:83]
 s_waitcnt lgkmcnt(0)
 v_cvt_pk_bf16_f32 v197, v198, v199
 v_cvt_pk_bf16_f32 v198, v204, v205
 v_cvt_pk_bf16_f32 v199, v206, v207
M v[88:91], a[160:163], v[128:131], 0
 v_cvt_pk_bf16_f32 v212, v212, v213
 v_cvt_pk_bf16_f32 v213, v214, v215
M v[88:91], a[164:167], v[144:147], v[88:91]
 v_cvt_pk_bf16_f32 v214, v220, v221
 v_cvt_pk_bf16_f32 v215, v222, v223
 v_cvt_pk_bf16_f32 v228, v228, v229
M v[88:91], a[168:171], v[160:163], v[88:91]
 buffer_load_dwordx4 v4, s[8:11], s38 offen offset:2048 sc1 lds
M v[88:91], a[172:175], v[176:179], v[88:91]
 v_cvt_pk_bf16_f32 v229, v230, v231
 v_cvt_pk_bf16_f32 v230, v236, v237
M v[88:91], a[176:179], v[192:195], v[88:91]
 v_cvt_pk_bf16_f32 v231, v238, v239
 v_cvt_pk_bf16_f32 v244, v244, v245
 v_cvt_pk_bf16_f32 v245, v246, v247
M v[88:91], a[180:183], v[208:211], v[88:91]
 buffer_load_dwordx4 v4, s[8:11], s38 offen offset:3072 sc1 lds
M v[88:91], a[184:187], v[224:227], v[88:91]
 v_cvt_pk_bf16_f32 v246, v252, v253
 v_cvt_pk_bf16_f32 v247, v254, v255
M v[88:91], a[188:191], v[240:243], v[88:91]
 s_add_u32 s38, s38, 32768
 v_add_f32 v31, v29, v31
 v_mov_b32 v10, v30
M v[68:71], a[64:67], v[132:135], 0
 s_add_u32 m0, s28, 131072
 v_mov_b32 v11, v31
 v_permlane16_swap_b32 v10, v30
M v[68:71], a[68:71], v[148:151], v[68:71]
 buffer_load_dwordx4 v3, s[8:11], s38 offen offset:0 sc1 lds
M v[68:71], a[72:75], v[164:167], v[68:71]
 v_permlane16_swap_b32 v11, v31
 v_add_f32 v30, v10, v30
M v[68:71], a[76:79], v[180:183], v[68:71]
 v_add_f32 v31, v11, v31
 v_mov_b32 v10, v30
M v[68:71], a[80:83], v[196:199], v[68:71]
 buffer_load_dwordx4 v3, s[8:11], s38 offen offset:1024 sc1 lds
M v[68:71], a[84:87], v[212:215], v[68:71]
 v_mov_b32 v11, v31
 v_permlane32_swap_b32 v10, v30
M v[68:71], a[88:91], v[228:231], v[68:71]
 v_permlane32_swap_b32 v11, v31
 v_add_f32 v30, v10, v30
M v[68:71], a[92:95], v[244:247], v[68:71]
 v_add_f32 v31, v11, v31
M v[76:79], a[96:99], v[132:135], 0
 buffer_load_dwordx4 v3, s[8:11], s38 offen offset:2048 sc1 lds
M v[76:79], a[100:103], v[148:151], v[76:79]
 v_rcp_f32 v5, v30
M v[76:79], a[104:107], v[164:167], v[76:79]
 v_rcp_f32 v6, v31
M v[76:79], a[108:111], v[180:183], v[76:79]
 buffer_load_dwordx4 v3, s[8:11], s38 offen offset:3072 sc1 lds
M v[76:79], a[112:115], v[196:199], v[76:79]
M v[76:79], a[116:119], v[212:215], v[76:79]
M v[76:79], a[120:123], v[228:231], v[76:79]
 s_waitcnt vmcnt(20)
M v[76:79], a[124:127], v[244:247], v[76:79]
 s_barrier
M v[84:87], a[128:131], v[132:135], 0
 ds_read_b128 a[64:67], v7 offset:32768
M v[84:87], a[132:135], v[148:151], v[84:87]
 s_add_u32 m0, s28, 135168
 ds_read_b128 a[68:71], v7 offset:33792
M v[84:87], a[136:139], v[164:167], v[84:87]
 buffer_load_dwordx4 v4, s[8:11], s38 offen offset:0 sc1 lds
M v[84:87], a[140:143], v[180:183], v[84:87]
 ds_read_b128 a[72:75], v7 offset:34816
M v[84:87], a[144:147], v[196:199], v[84:87]
 ds_read_b128 a[76:79], v7 offset:35840
M v[84:87], a[148:151], v[212:215], v[84:87]
 buffer_load_dwordx4 v4, s[8:11], s38 offen offset:1024 sc1 lds
M v[84:87], a[152:155], v[228:231], v[84:87]
 ds_read_b128 a[80:83], v7 offset:36864
M v[84:87], a[156:159], v[244:247], v[84:87]
 ds_read_b128 a[84:87], v7 offset:37888
M v[92:95], a[160:163], v[132:135], 0
 buffer_load_dwordx4 v4, s[8:11], s38 offen offset:2048 sc1 lds
M v[92:95], a[164:167], v[148:151], v[92:95]
 ds_read_b128 a[88:91], v7 offset:38912
M v[92:95], a[168:171], v[164:167], v[92:95]
 ds_read_b128 a[92:95], v7 offset:39936
M v[92:95], a[172:175], v[180:183], v[92:95]
 buffer_load_dwordx4 v4, s[8:11], s38 offen offset:3072 sc1 lds
M v[92:95], a[176:179], v[196:199], v[92:95]
 s_add_u32 s38, s38, 32768
M v[92:95], a[180:183], v[212:215], v[92:95]
M v[92:95], a[184:187], v[228:231], v[92:95]
 s_waitcnt lgkmcnt(0)
 s_cmp_eq_u32 s42, 6
M v[92:95], a[188:191], v[244:247], v[92:95]
 s_cbranch_scc1 L_y1
L_y1r:
M v[96:99], a[64:67], v[128:131], 0
 s_add_u32 m0, s28, 98304
 ds_read_b128 a[96:99], v7 offset:40960
M v[96:99], a[68:71], v[144:147], v[96:99]
 ds_read_b128 a[100:103], v7 offset:41984
M v[96:99], a[72:75], v[160:163], v[96:99]
 buffer_load_dwordx4 v3, s[8:11], s38 offen offset:0 sc1 lds
M v[96:99], a[76:79], v[176:179], v[96:99]
 ds_read_b128 a[104:107], v7 offset:43008
 s_add_u32 s29, s33, 0
M v[96:99], a[80:83], v[192:195], v[96:99]
 ds_read_b128 a[108:111], v7 offset:44032
 s_add_u32 s30, s33, 14336
M v[96:99], a[84:87], v[208:211], v[96:99]
 buffer_load_dwordx4 v3, s[8:11], s38 offen offset:1024 sc1 lds
M v[96:99], a[88:91], v[224:227], v[96:99]
 ds_read_b128 a[112:115], v7 offset:45056
 v_max3_f32 v32, |v64|, |v65|, |v66|
M v[96:99], a[92:95], v[240:243], v[96:99]
 ds_read_b128 a[116:119], v7 offset:46080
 v_max3_f32 v32, |v67|, |v72|, v32
M v[100:103], a[92:95], v[244:247], 0
 buffer_load_dwordx4 v3, s[8:11], s38 offen offset:2048 sc1 lds
M v[100:103], a[88:91], v[228:231], v[100:103]
 ds_read_b128 a[120:123], v7 offset:47104
 v_max3_f32 v32, |v73|, |v74|, v32
M v[100:103], a[84:87], v[212:215], v[100:103]
 ds_read_b128 a[124:127], v7 offset:48128
 v_mul_f32 v32, 2.0, v32
M v[100:103], a[80:83], v[196:199], v[100:103]
 buffer_load_dwordx4 v3, s[8:11], s38 offen offset:3072 sc1 lds
M v[100:103], a[76:79], v[180:183], v[100:103]
 s_add_u32 m0, s28, 102400
 v_mov_b32 v33, v32
 v_mov_b32 v34, v32
M v[100:103], a[72:75], v[164:167], v[100:103]
 buffer_load_dwordx4 v4, s[8:11], s38 offen offset:0 sc1 lds
M v[100:103], a[68:71], v[148:151], v[100:103]
 v_mov_b32 v35, v32
 v_mul_f32 v28, -v32, v5
M v[100:103], a[64:67], v[132:135], v[100:103]
 s_waitcnt lgkmcnt(0)
 v_mul_f32 v64, v5, v64
 v_mul_f32 v65, v5, v65
M v[108:111], a[96:99], v[132:135], 0
 ds_read_b128 a[64:67], v7 offset:49152
 v_mul_f32 v66, v5, v66
M v[108:111], a[100:103], v[148:151], v[108:111]
 ds_read_b128 a[68:71], v7 offset:50176
 v_mul_f32 v67, v5, v67
M v[108:111], a[104:107], v[164:167], v[108:111]
 buffer_load_dwordx4 v4, s[8:11], s38 offen offset:1024 sc1 lds
M v[108:111], a[108:111], v[180:183], v[108:111]
 ds_read_b128 a[72:75], v7 offset:51200
 v_mul_f32 v72, v5, v72
M v[108:111], a[112:115], v[196:199], v[108:111]
 ds_read_b128 a[76:79], v7 offset:52224
 v_mul_f32 v73, v5, v73
M v[108:111], a[116:119], v[212:215], v[108:111]
 buffer_load_dwordx4 v4, s[8:11], s38 offen offset:2048 sc1 lds
M v[108:111], a[120:123], v[228:231], v[108:111]
 ds_read_b128 a[80:83], v7 offset:53248
 v_mul_f32 v74, v5, v74
M v[108:111], a[124:127], v[244:247], v[108:111]
 ds_read_b128 a[84:87], v7 offset:54272
 v_mul_f32 v75, v5, v75
M v[104:107], a[124:127], v[240:243], 0
 buffer_load_dwordx4 v4, s[8:11], s38 offen offset:3072 sc1 lds
M v[104:107], a[120:123], v[224:227], v[104:107]
 s_add_u32 s38, s38, 32768
 ds_read_b128 a[88:91], v7 offset:55296
 v_cvt_pk_bf16_f32 v64, v64, v65
M v[104:107], a[116:119], v[208:211], v[104:107]
 ds_read_b128 a[92:95], v7 offset:56320
 v_cvt_pk_bf16_f32 v65, v66, v67
M v[104:107], a[112:115], v[192:195], v[104:107]
 v_cvt_pk_bf16_f32 v66, v72, v73
 v_cvt_pk_bf16_f32 v67, v74, v75
M v[104:107], a[108:111], v[176:179], v[104:107]
 buffer_store_dwordx4 v[64:67], v7, s[8:11], s29 offen offset:0 sc1
M v[104:107], a[104:107], v[160:163], v[104:107]
 v_max3_f32 v36, |v68|, |v69|, |v70|
 v_max3_f32 v36, |v71|, |v76|, v36
M v[104:107], a[100:103], v[144:147], v[104:107]
 v_max3_f32 v36, |v77|, |v78|, v36
 v_mul_f32 v36, 2.0, v36
M v[104:107], a[96:99], v[128:131], v[104:107]
 s_waitcnt lgkmcnt(0)
 v_mov_b32 v37, v36
 v_mov_b32 v38, v36
M v[112:115], a[64:67], v[128:131], 0
 ds_read_b128 a[96:99], v7 offset:57344
 v_mov_b32 v39, v36
M v[112:115], a[68:71], v[144:147], v[112:115]
 ds_read_b128 a[100:103], v7 offset:58368
 v_mul_f32 v29, -v36, v6
M v[112:115], a[72:75], v[160:163], v[112:115]
 v_mul_f32 v68, v6, v68
 v_mul_f32 v69, v6, v69
M v[112:115], a[76:79], v[176:179], v[112:115]
 ds_read_b128 a[104:107], v7 offset:59392
 v_mul_f32 v70, v6, v70
M v[112:115], a[80:83], v[192:195], v[112:115]
 ds_read_b128 a[108:111], v7 offset:60416
 v_mul_f32 v71, v6, v71
M v[112:115], a[84:87], v[208:211], v[112:115]
 v_mul_f32 v76, v6, v76
 v_mul_f32 v77, v6, v77
M v[112:115], a[88:91], v[224:227], v[112:115]
 ds_read_b128 a[112:115], v7 offset:61440
 v_mul_f32 v78, v6, v78
M v[112:115], a[92:95], v[240:243], v[112:115]
 ds_read_b128 a[116:119], v7 offset:62464
 v_mul_f32 v79, v6, v79
M v[116:119], a[92:95], v[244:247], 0
 v_cvt_pk_bf16_f32 v68, v68, v69
 v_cvt_pk_bf16_f32 v69, v70, v71
M v[116:119], a[88:91], v[228:231], v[116:119]
 ds_read_b128 a[120:123], v7 offset:63488
 v_cvt_pk_bf16_f32 v70, v76, v77
M v[116:119], a[84:87], v[212:215], v[116:119]
 ds_read_b128 a[124:127], v7 offset:64512
 v_cvt_pk_bf16_f32 v71, v78, v79
M v[116:119], a[80:83], v[196:199], v[116:119]
 buffer_store_dwordx4 v[68:71], v7, s[8:11], s30 offen offset:0 sc1
M v[116:119], a[76:79], v[180:183], v[116:119]
 v_mul_f32 v80, v5, v80
 v_mul_f32 v81, v5, v81
M v[116:119], a[72:75], v[164:167], v[116:119]
 v_mul_f32 v82, v5, v82
 v_mul_f32 v83, v5, v83
M v[116:119], a[68:71], v[148:151], v[116:119]
 s_waitcnt vmcnt(26) lgkmcnt(0)
 v_mul_f32 v88, v5, v88
 v_mul_f32 v89, v5, v89
M v[116:119], a[64:67], v[132:135], v[116:119]
 s_barrier
M v[124:127], a[96:99], v[132:135], 0
 ds_read_b128 a[64:67], v2 offset:0
 v_mul_f32 v90, v5, v90
M v[124:127], a[100:103], v[148:151], v[124:127]
 ds_read_b128 a[68:71], v2 offset:1024
 v_mul_f32 v91, v5, v91
M v[124:127], a[104:107], v[164:167], v[124:127]
 v_cvt_pk_bf16_f32 v80, v80, v81
 v_cvt_pk_bf16_f32 v81, v82, v83
M v[124:127], a[108:111], v[180:183], v[124:127]
 ds_read_b128 a[72:75], v2 offset:2048
 v_cvt_pk_bf16_f32 v82, v88, v89
M v[124:127], a[112:115], v[196:199], v[124:127]
 ds_read_b128 a[76:79], v2 offset:3072
 v_cvt_pk_bf16_f32 v83, v90, v91
M v[124:127], a[116:119], v[212:215], v[124:127]
 buffer_store_dwordx4 v[80:83], v7, s[8:11], s29 offen offset:1024 sc1
M v[124:127], a[120:123], v[228:231], v[124:127]
 ds_read_b128 a[80:83], v2 offset:4096
 v_mul_f32 v84, v6, v84
M v[124:127], a[124:127], v[244:247], v[124:127]
 ds_read_b128 a[84:87], v2 offset:5120
 v_mul_f32 v85, v6, v85
M v[120:123], a[124:127], v[240:243], 0
 v_mul_f32 v86, v6, v86
 v_mul_f32 v87, v6, v87
M v[120:123], a[120:123], v[224:227], v[120:123]
 ds_read_b128 a[88:91], v2 offset:6144
 v_mul_f32 v92, v6, v92
M v[120:123], a[116:119], v[208:211], v[120:123]
 ds_read_b128 a[92:95], v2 offset:7168
 v_mul_f32 v93, v6, v93
M v[120:123], a[112:115], v[192:195], v[120:123]
 v_mul_f32 v94, v6, v94
 v_mul_f32 v95, v6, v95
M v[120:123], a[108:111], v[176:179], v[120:123]
 v_cvt_pk_bf16_f32 v84, v84, v85
 v_cvt_pk_bf16_f32 v85, v86, v87
M v[120:123], a[104:107], v[160:163], v[120:123]
 v_cvt_pk_bf16_f32 v86, v92, v93
 v_cvt_pk_bf16_f32 v87, v94, v95
M v[120:123], a[100:103], v[144:147], v[120:123]
 s_waitcnt lgkmcnt(0)
M v[120:123], a[96:99], v[128:131], v[120:123]
 buffer_store_dwordx4 v[84:87], v7, s[8:11], s30 offen offset:1024 sc1
M v[64:67], a[64:67], v[128:131], v[32:35]
 s_add_u32 m0, s28, 32768
 ds_read_b128 a[96:99], v2 offset:8192
M v[64:67], a[68:71], v[144:147], v[64:67]
 ds_read_b128 a[100:103], v2 offset:9216
 s_mov_b32 s79, 104923136
M v[64:67], a[72:75], v[160:163], v[64:67]
 buffer_load_dwordx4 v3, s[8:11], s38 offen offset:0 sc1 lds
M v[64:67], a[76:79], v[176:179], v[64:67]
 ds_read_b128 a[104:107], v2 offset:10240
 s_add_u32 s29, s33, 2048
M v[64:67], a[80:83], v[192:195], v[64:67]
 ds_read_b128 a[108:111], v2 offset:11264
 s_add_u32 s30, s33, 16384
M v[64:67], a[84:87], v[208:211], v[64:67]
 buffer_load_dwordx4 v3, s[8:11], s38 offen offset:1024 sc1 lds
M v[64:67], a[88:91], v[224:227], v[64:67]
 ds_read_b128 a[112:115], v2 offset:12288
 v_mul_f32 v96, v5, v96
M v[64:67], a[92:95], v[240:243], v[64:67]
 ds_read_b128 a[116:119], v2 offset:13312
 v_mul_f32 v97, v5, v97
M v[68:71], a[92:95], v[244:247], v[36:39]
 buffer_load_dwordx4 v3, s[8:11], s38 offen offset:2048 sc1 lds
M v[68:71], a[88:91], v[228:231], v[68:71]
 ds_read_b128 a[120:123], v2 offset:14336
 v_mul_f32 v98, v5, v98
M v[68:71], a[84:87], v[212:215], v[68:71]
 ds_read_b128 a[124:127], v2 offset:15360
 v_mul_f32 v99, v5, v99
M v[68:71], a[80:83], v[196:199], v[68:71]
 buffer_load_dwordx4 v3, s[8:11], s38 offen offset:3072 sc1 lds
M v[68:71], a[76:79], v[180:183], v[68:71]
 s_add_u32 m0, s28, 36864
 v_mul_f32 v104, v5, v104
 v_mul_f32 v105, v5, v105
M v[68:71], a[72:75], v[164:167], v[68:71]
 buffer_load_dwordx4 v4, s[8:11], s38 offen offset:0 sc1 lds
M v[68:71], a[68:71], v[148:151], v[68:71]
 buffer_load_dword v24, off, s[8:11], s79 sc1
M v[68:71], a[64:67], v[132:135], v[68:71]
 s_waitcnt lgkmcnt(0)
 v_lshrrev_b32 v0, 4, v7
 v_and_b32 v14, 15, v0
M v[76:79], a[96:99], v[132:135], v[36:39]
 ds_read_b128 a[64:67], v2 offset:16384
 v_lshlrev_b32 v14, 2, v14
M v[76:79], a[100:103], v[148:151], v[76:79]
 ds_read_b128 a[68:71], v2 offset:17408
 v_lshrrev_b32 v11, 4, v0
M v[76:79], a[104:107], v[164:167], v[76:79]
 buffer_load_dwordx4 v4, s[8:11], s38 offen offset:1024 sc1 lds
M v[76:79], a[108:111], v[180:183], v[76:79]
 ds_read_b128 a[72:75], v2 offset:18432
 s_mov_b32 s52, s96
M v[76:79], a[112:115], v[196:199], v[76:79]
 s_and_b32 s53, s97, 0xffff
 ds_read_b128 a[76:79], v2 offset:19456
 s_mov_b32 s54, 1835008
M v[76:79], a[116:119], v[212:215], v[76:79]
 buffer_load_dwordx4 v4, s[8:11], s38 offen offset:2048 sc1 lds
M v[76:79], a[120:123], v[228:231], v[76:79]
 ds_read_b128 a[80:83], v2 offset:20480
 s_mov_b32 s55, 0x20000
M v[76:79], a[124:127], v[244:247], v[76:79]
 s_lshr_b32 s74, s41, 3
 ds_read_b128 a[84:87], v2 offset:21504
 s_xor_b32 s74, s74, 0
M v[72:75], a[124:127], v[240:243], v[32:35]
 buffer_load_dwordx4 v4, s[8:11], s38 offen offset:3072 sc1 lds
M v[72:75], a[120:123], v[224:227], v[72:75]
 s_add_u32 s38, s38, 32768
 ds_read_b128 a[88:91], v2 offset:22528
 s_mul_i32 s67, s74, -2
M v[72:75], a[116:119], v[208:211], v[72:75]
 s_mul_i32 s74, s74, 8
 ds_read_b128 a[92:95], v2 offset:23552
 v_mul_f32 v106, v5, v106
M v[72:75], a[112:115], v[192:195], v[72:75]
 s_add_u32 s74, s74, s20
 v_mul_f32 v107, v5, v107
 v_cvt_pk_bf16_f32 v96, v96, v97
M v[72:75], a[108:111], v[176:179], v[72:75]
 s_lshl_b32 s75, s74, 6
 v_cvt_pk_bf16_f32 v97, v98, v99
 v_cvt_pk_bf16_f32 v98, v104, v105
M v[72:75], a[104:107], v[160:163], v[72:75]
 s_add_u32 s76, s75, 256
 v_cvt_pk_bf16_f32 v99, v106, v107
M v[72:75], a[100:103], v[144:147], v[72:75]
 s_add_u32 s67, s67, 3
 v_add_u32 v43, 0x20000, v7
 s_sub_u32 s67, s67, s20
M v[72:75], a[96:99], v[128:131], v[72:75]
 s_waitcnt lgkmcnt(0)
 s_and_b32 s67, s67, 536870912
M v[80:83], a[64:67], v[128:131], v[32:35]
 s_or_b32 s76, s76, s67
 ds_read_b128 a[96:99], v2 offset:24576
 v_or_b32 v27, s67, v7
M v[80:83], a[68:71], v[144:147], v[80:83]
 ds_read_b128 a[100:103], v2 offset:25600
 v_add_u32 v27, 4096, v27
M v[80:83], a[72:75], v[160:163], v[80:83]
 buffer_store_dwordx4 v[96:99], v7, s[8:11], s29 offen offset:0 sc1
M v[80:83], a[76:79], v[176:179], v[80:83]
 ds_read_b128 a[104:107], v2 offset:26624
 v_mul_f32 v100, v6, v100
M v[80:83], a[80:83], v[192:195], v[80:83]
 ds_read_b128 a[108:111], v2 offset:27648
 v_mul_f32 v101, v6, v101
M v[80:83], a[84:87], v[208:211], v[80:83]
 v_mul_f32 v102, v6, v102
 v_mul_f32 v103, v6, v103
M v[80:83], a[88:91], v[224:227], v[80:83]
 ds_read_b128 a[112:115], v2 offset:28672
 v_mul_f32 v108, v6, v108
M v[80:83], a[92:95], v[240:243], v[80:83]
 ds_read_b128 a[116:119], v2 offset:29696
 v_mul_f32 v109, v6, v109
M v[84:87], a[92:95], v[244:247], v[36:39]
 v_mul_f32 v110, v6, v110
 v_mul_f32 v111, v6, v111
M v[84:87], a[88:91], v[228:231], v[84:87]
 ds_read_b128 a[120:123], v2 offset:30720
 v_cvt_pk_bf16_f32 v100, v100, v101
M v[84:87], a[84:87], v[212:215], v[84:87]
 ds_read_b128 a[124:127], v2 offset:31744
 v_cvt_pk_bf16_f32 v101, v102, v103
M v[84:87], a[80:83], v[196:199], v[84:87]
 v_cvt_pk_bf16_f32 v102, v108, v109
 v_cvt_pk_bf16_f32 v103, v110, v111
M v[84:87], a[76:79], v[180:183], v[84:87]
 buffer_store_dwordx4 v[100:103], v7, s[8:11], s30 offen offset:0 sc1
M v[84:87], a[72:75], v[164:167], v[84:87]
 v_mul_f32 v112, v5, v112
 v_mul_f32 v113, v5, v113
M v[84:87], a[68:71], v[148:151], v[84:87]
 s_waitcnt vmcnt(31) lgkmcnt(0)
 v_mul_f32 v114, v5, v114
 v_mul_f32 v115, v5, v115
M v[84:87], a[64:67], v[132:135], v[84:87]
 s_barrier
M v[92:95], a[96:99], v[132:135], v[36:39]
 ds_read_b128 a[64:67], v7 offset:0
 v_mul_f32 v120, v5, v120
M v[92:95], a[100:103], v[148:151], v[92:95]
 ds_read_b128 a[68:71], v7 offset:1024
 v_mul_f32 v121, v5, v121
M v[92:95], a[104:107], v[164:167], v[92:95]
 v_mul_f32 v122, v5, v122
 v_mul_f32 v123, v5, v123
M v[92:95], a[108:111], v[180:183], v[92:95]
 ds_read_b128 a[72:75], v7 offset:2048
 v_cvt_pk_bf16_f32 v112, v112, v113
M v[92:95], a[112:115], v[196:199], v[92:95]
 ds_read_b128 a[76:79], v7 offset:3072
 v_cvt_pk_bf16_f32 v113, v114, v115
M v[92:95], a[116:119], v[212:215], v[92:95]
 v_cvt_pk_bf16_f32 v114, v120, v121
 v_cvt_pk_bf16_f32 v115, v122, v123
M v[92:95], a[120:123], v[228:231], v[92:95]
 ds_read_b128 a[80:83], v7 offset:4096
M v[92:95], a[124:127], v[244:247], v[92:95]
 ds_read_b128 a[84:87], v7 offset:5120
M v[88:91], a[124:127], v[240:243], v[32:35]
 buffer_store_dwordx4 v[112:115], v7, s[8:11], s29 offen offset:1024 sc1
M v[88:91], a[120:123], v[224:227], v[88:91]
 ds_read_b128 a[88:91], v7 offset:6144
 v_mul_f32 v116, v6, v116
M v[88:91], a[116:119], v[208:211], v[88:91]
 ds_read_b128 a[92:95], v7 offset:7168
 v_mul_f32 v117, v6, v117
M v[88:91], a[112:115], v[192:195], v[88:91]
 v_mul_f32 v118, v6, v118
 v_mul_f32 v119, v6, v119
M v[88:91], a[108:111], v[176:179], v[88:91]
 v_mul_f32 v124, v6, v124
 v_mul_f32 v125, v6, v125
M v[88:91], a[104:107], v[160:163], v[88:91]
 v_mul_f32 v126, v6, v126
 v_mul_f32 v127, v6, v127
M v[88:91], a[100:103], v[144:147], v[88:91]
 s_waitcnt lgkmcnt(0)
 v_cvt_pk_bf16_f32 v116, v116, v117
 v_cvt_pk_bf16_f32 v117, v118, v119
M v[88:91], a[96:99], v[128:131], v[88:91]
 v_cvt_pk_bf16_f32 v118, v124, v125
 v_cvt_pk_bf16_f32 v119, v126, v127
 buffer_store_dwordx4 v[116:119], v7, s[8:11], s30 offen offset:1024 sc1
M v[96:99], a[64:67], v[128:131], v[32:35]
 ds_read_b128 a[96:99], v7 offset:8192
M v[96:99], a[68:71], v[144:147], v[96:99]
 ds_read_b128 a[100:103], v7 offset:9216
M v[96:99], a[72:75], v[160:163], v[96:99]
 s_sub_u32 s64, 15, s42
M v[96:99], a[76:79], v[176:179], v[96:99]
 s_min_u32 s64, s64, s42
 ds_read_b128 a[104:107], v7 offset:10240
 s_add_u32 s29, s33, 4096
M v[96:99], a[80:83], v[192:195], v[96:99]
 s_mul_i32 s45, s64, 8704
 ds_read_b128 a[108:111], v7 offset:11264
 s_add_u32 s30, s33, 18432
M v[96:99], a[84:87], v[208:211], v[96:99]
 s_lshl_b32 s64, s20, 6
 v_fma_f32 v64, v64, v5, v28
 v_fma_f32 v65, v65, v5, v28
M v[96:99], a[88:91], v[224:227], v[96:99]
 s_add_u32 s64, s64, s41
 ds_read_b128 a[112:115], v7 offset:12288
 v_fma_f32 v66, v66, v5, v28
M v[96:99], a[92:95], v[240:243], v[96:99]
 s_lshl2_add_u32 s45, s64, s45
 ds_read_b128 a[116:119], v7 offset:13312
 v_fma_f32 v67, v67, v5, v28
M v[100:103], a[92:95], v[244:247], v[36:39]
 s_add_u32 s45, s45, 104992768
 v_fma_f32 v72, v72, v5, v28
M v[100:103], a[88:91], v[228:231], v[100:103]
 s_movk_i32 s65, 1024
 ds_read_b128 a[120:123], v7 offset:14336
 v_fma_f32 v73, v73, v5, v28
M v[100:103], a[84:87], v[212:215], v[100:103]
 s_cmp_lt_u32 s42, 8
 ds_read_b128 a[124:127], v7 offset:15360
 v_fma_f32 v74, v74, v5, v28
M v[100:103], a[80:83], v[196:199], v[100:103]
 s_cselect_b32 s64, 4352, s65
 v_fma_f32 v75, v75, v5, v28
M v[100:103], a[76:79], v[180:183], v[100:103]
 s_cselect_b32 s65, 0, 64
 v_cvt_pk_bf16_f32 v64, v64, v65
M v[100:103], a[72:75], v[164:167], v[100:103]
 s_cselect_b32 s66, 32, 64
 v_cvt_pk_bf16_f32 v65, v66, v67
M v[100:103], a[68:71], v[148:151], v[100:103]
 s_add_u32 s3, s45, s64
 s_add_u32 s45, s45, s65
 v_lshrrev_b32 v42, 5, v7
M v[100:103], a[64:67], v[132:135], v[100:103]
 s_waitcnt lgkmcnt(0)
 v_mul_u32_u24 v42, 4352, v42
 v_and_b32 v41, 16, v7
M v[108:111], a[96:99], v[132:135], v[36:39]
 ds_read_b128 a[64:67], v7 offset:16384
 v_lshl_add_u32 v41, v41, 3, v42
M v[108:111], a[100:103], v[148:151], v[108:111]
 ds_read_b128 a[68:71], v7 offset:17408
 v_mov_b32 v42, 536870912
M v[108:111], a[104:107], v[164:167], v[108:111]
 v_cmp_gt_u32 vcc, s66, v7
 v_mov_b32 v40, 1
M v[108:111], a[108:111], v[180:183], v[108:111]
 s_nop 0
 ds_read_b128 a[72:75], v7 offset:18432
 v_cndmask_b32 v41, v42, v41, vcc
M v[108:111], a[112:115], v[196:199], v[108:111]
 ds_read_b128 a[76:79], v7 offset:19456
 v_cvt_pk_bf16_f32 v66, v72, v73
M v[108:111], a[116:119], v[212:215], v[108:111]
 v_cvt_pk_bf16_f32 v67, v74, v75
M v[108:111], a[120:123], v[228:231], v[108:111]
 ds_read_b128 a[80:83], v7 offset:20480
M v[108:111], a[124:127], v[244:247], v[108:111]
 ds_read_b128 a[84:87], v7 offset:21504
M v[104:107], a[124:127], v[240:243], v[32:35]
 buffer_store_dwordx4 v[64:67], v7, s[8:11], s29 offen offset:0 sc1
M v[104:107], a[120:123], v[224:227], v[104:107]
 ds_read_b128 a[88:91], v7 offset:22528
 v_fma_f32 v68, v68, v6, v29
M v[104:107], a[116:119], v[208:211], v[104:107]
 ds_read_b128 a[92:95], v7 offset:23552
 v_fma_f32 v69, v69, v6, v29
M v[104:107], a[112:115], v[192:195], v[104:107]
 v_fma_f32 v70, v70, v6, v29
 v_fma_f32 v71, v71, v6, v29
M v[104:107], a[108:111], v[176:179], v[104:107]
 v_fma_f32 v76, v76, v6, v29
 v_fma_f32 v77, v77, v6, v29
M v[104:107], a[104:107], v[160:163], v[104:107]
 v_fma_f32 v78, v78, v6, v29
 v_fma_f32 v79, v79, v6, v29
M v[104:107], a[100:103], v[144:147], v[104:107]
 v_cvt_pk_bf16_f32 v68, v68, v69
 v_cvt_pk_bf16_f32 v69, v70, v71
M v[104:107], a[96:99], v[128:131], v[104:107]
 s_waitcnt lgkmcnt(0)
 v_cvt_pk_bf16_f32 v70, v76, v77
 v_cvt_pk_bf16_f32 v71, v78, v79
M v[112:115], a[64:67], v[128:131], v[32:35]
 ds_read_b128 a[96:99], v7 offset:24576
M v[112:115], a[68:71], v[144:147], v[112:115]
 ds_read_b128 a[100:103], v7 offset:25600
M v[112:115], a[72:75], v[160:163], v[112:115]
 buffer_store_dwordx4 v[68:71], v7, s[8:11], s30 offen offset:0 sc1
M v[112:115], a[76:79], v[176:179], v[112:115]
 ds_read_b128 a[104:107], v7 offset:26624
 v_fma_f32 v80, v80, v5, v28
M v[112:115], a[80:83], v[192:195], v[112:115]
 ds_read_b128 a[108:111], v7 offset:27648
 v_fma_f32 v81, v81, v5, v28
M v[112:115], a[84:87], v[208:211], v[112:115]
 v_fma_f32 v82, v82, v5, v28
 v_fma_f32 v83, v83, v5, v28
M v[112:115], a[88:91], v[224:227], v[112:115]
 ds_read_b128 a[112:115], v7 offset:28672
 v_fma_f32 v88, v88, v5, v28
M v[112:115], a[92:95], v[240:243], v[112:115]
 ds_read_b128 a[116:119], v7 offset:29696
 v_fma_f32 v89, v89, v5, v28
M v[116:119], a[92:95], v[244:247], v[36:39]
 v_fma_f32 v90, v90, v5, v28
 v_fma_f32 v91, v91, v5, v28
M v[116:119], a[88:91], v[228:231], v[116:119]
 ds_read_b128 a[120:123], v7 offset:30720
 v_cvt_pk_bf16_f32 v80, v80, v81
M v[116:119], a[84:87], v[212:215], v[116:119]
 ds_read_b128 a[124:127], v7 offset:31744
 v_cvt_pk_bf16_f32 v81, v82, v83
M v[116:119], a[80:83], v[196:199], v[116:119]
 v_cvt_pk_bf16_f32 v82, v88, v89
 v_cvt_pk_bf16_f32 v83, v90, v91
M v[116:119], a[76:79], v[180:183], v[116:119]
 buffer_store_dwordx4 v[80:83], v7, s[8:11], s29 offen offset:1024 sc1
M v[116:119], a[72:75], v[164:167], v[116:119]
 v_fma_f32 v84, v84, v6, v29
 v_fma_f32 v85, v85, v6, v29
M v[116:119], a[68:71], v[148:151], v[116:119]
 s_waitcnt vmcnt(28) lgkmcnt(0)
 v_fma_f32 v86, v86, v6, v29
M v[116:119], a[64:67], v[132:135], v[116:119]
 s_barrier
M v[124:127], a[96:99], v[132:135], v[36:39]
 ds_read_b128 a[64:67], v43 offset:0
 v_fma_f32 v87, v87, v6, v29
M v[124:127], a[100:103], v[148:151], v[124:127]
 ds_read_b128 a[68:71], v43 offset:1024
 v_fma_f32 v92, v92, v6, v29
M v[124:127], a[104:107], v[164:167], v[124:127]
 v_fma_f32 v93, v93, v6, v29
 v_fma_f32 v94, v94, v6, v29
M v[124:127], a[108:111], v[180:183], v[124:127]
 ds_read_b128 a[72:75], v43 offset:2048
 v_fma_f32 v95, v95, v6, v29
M v[124:127], a[112:115], v[196:199], v[124:127]
 ds_read_b128 a[76:79], v43 offset:3072
 v_cvt_pk_bf16_f32 v84, v84, v85
M v[124:127], a[116:119], v[212:215], v[124:127]
 v_cvt_pk_bf16_f32 v85, v86, v87
M v[124:127], a[120:123], v[228:231], v[124:127]
 ds_read_b128 a[80:83], v43 offset:4096
 v_cvt_pk_bf16_f32 v86, v92, v93
M v[124:127], a[124:127], v[244:247], v[124:127]
 ds_read_b128 a[84:87], v43 offset:5120
 v_cvt_pk_bf16_f32 v87, v94, v95
M v[120:123], a[124:127], v[240:243], v[32:35]
 buffer_store_dwordx4 v[84:87], v7, s[8:11], s30 offen offset:1024 sc1
M v[120:123], a[120:123], v[224:227], v[120:123]
 ds_read_b128 a[88:91], v43 offset:6144
M v[120:123], a[116:119], v[208:211], v[120:123]
 ds_read_b128 a[92:95], v43 offset:7168
M v[120:123], a[112:115], v[192:195], v[120:123]
M v[120:123], a[108:111], v[176:179], v[120:123]
M v[120:123], a[104:107], v[160:163], v[120:123]
M v[120:123], a[100:103], v[144:147], v[120:123]
 s_waitcnt lgkmcnt(0)
 s_cmp_eq_u32 s42, 6
M v[120:123], a[96:99], v[128:131], v[120:123]
 s_cbranch_scc1 L_y2
L_y2r:
M v[64:67], a[64:67], v[128:131], v[32:35]
 ds_read_b128 a[96:99], v43 offset:8192
M v[64:67], a[68:71], v[144:147], v[64:67]
 ds_read_b128 a[100:103], v43 offset:9216
M v[64:67], a[72:75], v[160:163], v[64:67]
 s_waitcnt vmcnt(11)
 v_cmp_gt_u32 vcc, 1, v24
M v[64:67], a[76:79], v[176:179], v[64:67]
 s_mov_b32 s65, 104890368
 ds_read_b128 a[104:107], v43 offset:10240
 s_add_u32 s29, s33, 6144
M v[64:67], a[80:83], v[192:195], v[64:67]
 s_cbranch_vccnz L_fhs1
L_fhr1:
 ds_read_b128 a[108:111], v43 offset:11264
 s_add_u32 s30, s33, 20480
M v[64:67], a[84:87], v[208:211], v[64:67]
 buffer_load_dword v25, v14, s[8:11], s65 offen sc1
M v[64:67], a[88:91], v[224:227], v[64:67]
 ds_read_b128 a[112:115], v43 offset:12288
 v_fma_f32 v96, v96, v5, v28
M v[64:67], a[92:95], v[240:243], v[64:67]
 ds_read_b128 a[116:119], v43 offset:13312
 v_fma_f32 v97, v97, v5, v28
M v[68:71], a[92:95], v[244:247], v[36:39]
 v_fma_f32 v98, v98, v5, v28
 v_fma_f32 v99, v99, v5, v28
M v[68:71], a[88:91], v[228:231], v[68:71]
 ds_read_b128 a[120:123], v43 offset:14336
 v_fma_f32 v104, v104, v5, v28
M v[68:71], a[84:87], v[212:215], v[68:71]
 ds_read_b128 a[124:127], v43 offset:15360
 v_fma_f32 v105, v105, v5, v28
M v[68:71], a[80:83], v[196:199], v[68:71]
 v_fma_f32 v106, v106, v5, v28
 v_fma_f32 v107, v107, v5, v28
M v[68:71], a[76:79], v[180:183], v[68:71]
 v_cvt_pk_bf16_f32 v96, v96, v97
M v[68:71], a[72:75], v[164:167], v[68:71]
 v_cvt_pk_bf16_f32 v97, v98, v99
M v[68:71], a[68:71], v[148:151], v[68:71]
 v_cvt_pk_bf16_f32 v98, v104, v105
M v[68:71], a[64:67], v[132:135], v[68:71]
 s_waitcnt lgkmcnt(0)
 v_cvt_pk_bf16_f32 v99, v106, v107
M v[76:79], a[96:99], v[132:135], v[36:39]
 ds_read_b128 a[64:67], v43 offset:16384
M v[76:79], a[100:103], v[148:151], v[76:79]
 ds_read_b128 a[68:71], v43 offset:17408
M v[76:79], a[104:107], v[164:167], v[76:79]
 buffer_store_dwordx4 v[96:99], v7, s[8:11], s29 offen offset:0 sc1
M v[76:79], a[108:111], v[180:183], v[76:79]
 ds_read_b128 a[72:75], v43 offset:18432
 v_fma_f32 v100, v100, v6, v29
M v[76:79], a[112:115], v[196:199], v[76:79]
 ds_read_b128 a[76:79], v43 offset:19456
 v_fma_f32 v101, v101, v6, v29
M v[76:79], a[116:119], v[212:215], v[76:79]
 v_fma_f32 v102, v102, v6, v29
 v_fma_f32 v103, v103, v6, v29
M v[76:79], a[120:123], v[228:231], v[76:79]
 ds_read_b128 a[80:83], v43 offset:20480
 v_fma_f32 v108, v108, v6, v29
M v[76:79], a[124:127], v[244:247], v[76:79]
 ds_read_b128 a[84:87], v43 offset:21504
 v_fma_f32 v109, v109, v6, v29
M v[72:75], a[124:127], v[240:243], v[32:35]
 v_fma_f32 v110, v110, v6, v29
 v_fma_f32 v111, v111, v6, v29
M v[72:75], a[120:123], v[224:227], v[72:75]
 ds_read_b128 a[88:91], v43 offset:22528
 v_cvt_pk_bf16_f32 v100, v100, v101
M v[72:75], a[116:119], v[208:211], v[72:75]
 ds_read_b128 a[92:95], v43 offset:23552
 v_cvt_pk_bf16_f32 v101, v102, v103
M v[72:75], a[112:115], v[192:195], v[72:75]
 v_cvt_pk_bf16_f32 v102, v108, v109
M v[72:75], a[108:111], v[176:179], v[72:75]
 v_cvt_pk_bf16_f32 v103, v110, v111
M v[72:75], a[104:107], v[160:163], v[72:75]
 buffer_store_dwordx4 v[100:103], v7, s[8:11], s30 offen offset:0 sc1
M v[72:75], a[100:103], v[144:147], v[72:75]
M v[72:75], a[96:99], v[128:131], v[72:75]
 s_waitcnt lgkmcnt(0)
 v_fma_f32 v112, v112, v5, v28
M v[80:83], a[64:67], v[128:131], v[32:35]
 ds_read_b128 a[96:99], v43 offset:24576
 v_fma_f32 v113, v113, v5, v28
M v[80:83], a[68:71], v[144:147], v[80:83]
 ds_read_b128 a[100:103], v43 offset:25600
 v_fma_f32 v114, v114, v5, v28
M v[80:83], a[72:75], v[160:163], v[80:83]
 v_fma_f32 v115, v115, v5, v28
M v[80:83], a[76:79], v[176:179], v[80:83]
 ds_read_b128 a[104:107], v43 offset:26624
 v_fma_f32 v120, v120, v5, v28
M v[80:83], a[80:83], v[192:195], v[80:83]
 ds_read_b128 a[108:111], v43 offset:27648
 v_fma_f32 v121, v121, v5, v28
M v[80:83], a[84:87], v[208:211], v[80:83]
 v_fma_f32 v122, v122, v5, v28
M v[80:83], a[88:91], v[224:227], v[80:83]
 ds_read_b128 a[112:115], v43 offset:28672
 v_fma_f32 v123, v123, v5, v28
M v[80:83], a[92:95], v[240:243], v[80:83]
 ds_read_b128 a[116:119], v43 offset:29696
 v_cvt_pk_bf16_f32 v112, v112, v113
M v[84:87], a[92:95], v[244:247], v[36:39]
 v_cvt_pk_bf16_f32 v113, v114, v115
 v_cvt_pk_bf16_f32 v114, v120, v121
M v[84:87], a[88:91], v[228:231], v[84:87]
 ds_read_b128 a[120:123], v43 offset:30720
 v_cvt_pk_bf16_f32 v115, v122, v123
M v[84:87], a[84:87], v[212:215], v[84:87]
 ds_read_b128 a[124:127], v43 offset:31744
M v[84:87], a[80:83], v[196:199], v[84:87]
 buffer_store_dwordx4 v[112:115], v7, s[8:11], s29 offen offset:1024 sc1
M v[84:87], a[76:79], v[180:183], v[84:87]
 v_fma_f32 v116, v116, v6, v29
M v[84:87], a[72:75], v[164:167], v[84:87]
 v_fma_f32 v117, v117, v6, v29
M v[84:87], a[68:71], v[148:151], v[84:87]
 s_waitcnt lgkmcnt(0)
 v_fma_f32 v118, v118, v6, v29
M v[84:87], a[64:67], v[132:135], v[84:87]
 s_barrier
M v[92:95], a[96:99], v[132:135], v[36:39]
 ds_read_b128 a[64:67], v2 offset:32768
 v_fma_f32 v119, v119, v6, v29
M v[92:95], a[100:103], v[148:151], v[92:95]
 ds_read_b128 a[68:71], v2 offset:33792
 v_fma_f32 v124, v124, v6, v29
M v[92:95], a[104:107], v[164:167], v[92:95]
 v_fma_f32 v125, v125, v6, v29
 v_fma_f32 v126, v126, v6, v29
M v[92:95], a[108:111], v[180:183], v[92:95]
 ds_read_b128 a[72:75], v2 offset:34816
 v_fma_f32 v127, v127, v6, v29
M v[92:95], a[112:115], v[196:199], v[92:95]
 ds_read_b128 a[76:79], v2 offset:35840
 v_cvt_pk_bf16_f32 v116, v116, v117
M v[92:95], a[116:119], v[212:215], v[92:95]
 v_cvt_pk_bf16_f32 v117, v118, v119
M v[92:95], a[120:123], v[228:231], v[92:95]
 ds_read_b128 a[80:83], v2 offset:36864
 v_cvt_pk_bf16_f32 v118, v124, v125
M v[92:95], a[124:127], v[244:247], v[92:95]
 ds_read_b128 a[84:87], v2 offset:37888
 v_cvt_pk_bf16_f32 v119, v126, v127
M v[88:91], a[124:127], v[240:243], v[32:35]
 buffer_store_dwordx4 v[116:119], v7, s[8:11], s30 offen offset:1024 sc1
M v[88:91], a[120:123], v[224:227], v[88:91]
 ds_read_b128 a[88:91], v2 offset:38912
M v[88:91], a[116:119], v[208:211], v[88:91]
 ds_read_b128 a[92:95], v2 offset:39936
M v[88:91], a[112:115], v[192:195], v[88:91]
M v[88:91], a[108:111], v[176:179], v[88:91]
M v[88:91], a[104:107], v[160:163], v[88:91]
M v[88:91], a[100:103], v[144:147], v[88:91]
 s_waitcnt lgkmcnt(0)
M v[88:91], a[96:99], v[128:131], v[88:91]
M v[96:99], a[64:67], v[128:131], v[32:35]
 ds_read_b128 a[96:99], v2 offset:40960
M v[96:99], a[68:71], v[144:147], v[96:99]
 ds_read_b128 a[100:103], v2 offset:41984
M v[96:99], a[72:75], v[160:163], v[96:99]
M v[96:99], a[76:79], v[176:179], v[96:99]
 ds_read_b128 a[104:107], v2 offset:43008
 s_add_u32 s29, s33, 8192
M v[96:99], a[80:83], v[192:195], v[96:99]
 ds_read_b128 a[108:111], v2 offset:44032
 s_add_u32 s30, s33, 22528
M v[96:99], a[84:87], v[208:211], v[96:99]
 v_fma_f32 v64, v64, v5, v28
 v_fma_f32 v65, v65, v5, v28
M v[96:99], a[88:91], v[224:227], v[96:99]
 ds_read_b128 a[112:115], v2 offset:45056
 v_fma_f32 v66, v66, v5, v28
M v[96:99], a[92:95], v[240:243], v[96:99]
 ds_read_b128 a[116:119], v2 offset:46080
 v_fma_f32 v67, v67, v5, v28
M v[100:103], a[92:95], v[244:247], v[36:39]
 v_fma_f32 v72, v72, v5, v28
M v[100:103], a[88:91], v[228:231], v[100:103]
 ds_read_b128 a[120:123], v2 offset:47104
 v_fma_f32 v73, v73, v5, v28
M v[100:103], a[84:87], v[212:215], v[100:103]
 ds_read_b128 a[124:127], v2 offset:48128
 v_fma_f32 v74, v74, v5, v28
M v[100:103], a[80:83], v[196:199], v[100:103]
 v_fma_f32 v75, v75, v5, v28
M v[100:103], a[76:79], v[180:183], v[100:103]
 v_cvt_pk_bf16_f32 v64, v64, v65
M v[100:103], a[72:75], v[164:167], v[100:103]
 v_cvt_pk_bf16_f32 v65, v66, v67
M v[100:103], a[68:71], v[148:151], v[100:103]
 v_cvt_pk_bf16_f32 v66, v72, v73
M v[100:103], a[64:67], v[132:135], v[100:103]
 s_waitcnt lgkmcnt(0)
 v_cvt_pk_bf16_f32 v67, v74, v75
M v[108:111], a[96:99], v[132:135], v[36:39]
 ds_read_b128 a[64:67], v2 offset:49152
M v[108:111], a[100:103], v[148:151], v[108:111]
 ds_read_b128 a[68:71], v2 offset:50176
M v[108:111], a[104:107], v[164:167], v[108:111]
 buffer_store_dwordx4 v[64:67], v7, s[8:11], s29 offen offset:0 sc1
M v[108:111], a[108:111], v[180:183], v[108:111]
 ds_read_b128 a[72:75], v2 offset:51200
 v_fma_f32 v68, v68, v6, v29
M v[108:111], a[112:115], v[196:199], v[108:111]
 ds_read_b128 a[76:79], v2 offset:52224
 v_fma_f32 v69, v69, v6, v29
M v[108:111], a[116:119], v[212:215], v[108:111]
 v_fma_f32 v70, v70, v6, v29
 v_fma_f32 v71, v71, v6, v29
M v[108:111], a[120:123], v[228:231], v[108:111]
 ds_read_b128 a[80:83], v2 offset:53248
 v_fma_f32 v76, v76, v6, v29
M v[108:111], a[124:127], v[244:247], v[108:111]
 ds_read_b128 a[84:87], v2 offset:54272
 v_fma_f32 v77, v77, v6, v29
M v[104:107], a[124:127], v[240:243], v[32:35]
 v_fma_f32 v78, v78, v6, v29
 v_fma_f32 v79, v79, v6, v29
M v[104:107], a[120:123], v[224:227], v[104:107]
 ds_read_b128 a[88:91], v2 offset:55296
 v_cvt_pk_bf16_f32 v68, v68, v69
M v[104:107], a[116:119], v[208:211], v[104:107]
 ds_read_b128 a[92:95], v2 offset:56320
 v_cvt_pk_bf16_f32 v69, v70, v71
M v[104:107], a[112:115], v[192:195], v[104:107]
 v_cvt_pk_bf16_f32 v70, v76, v77
M v[104:107], a[108:111], v[176:179], v[104:107]
 v_cvt_pk_bf16_f32 v71, v78, v79
M v[104:107], a[104:107], v[160:163], v[104:107]
 buffer_store_dwordx4 v[68:71], v7, s[8:11], s30 offen offset:0 sc1
M v[104:107], a[100:103], v[144:147], v[104:107]
M v[104:107], a[96:99], v[128:131], v[104:107]
 s_waitcnt lgkmcnt(0)
 v_fma_f32 v80, v80, v5, v28
M v[112:115], a[64:67], v[128:131], v[32:35]
 ds_read_b128 a[96:99], v2 offset:57344
 v_fma_f32 v81, v81, v5, v28
M v[112:115], a[68:71], v[144:147], v[112:115]
 ds_read_b128 a[100:103], v2 offset:58368
 v_fma_f32 v82, v82, v5, v28
M v[112:115], a[72:75], v[160:163], v[112:115]
 v_fma_f32 v83, v83, v5, v28
M v[112:115], a[76:79], v[176:179], v[112:115]
 ds_read_b128 a[104:107], v2 offset:59392
 v_fma_f32 v88, v88, v5, v28
M v[112:115], a[80:83], v[192:195], v[112:115]
 ds_read_b128 a[108:111], v2 offset:60416
 v_fma_f32 v89, v89, v5, v28
M v[112:115], a[84:87], v[208:211], v[112:115]
 v_fma_f32 v90, v90, v5, v28
M v[112:115], a[88:91], v[224:227], v[112:115]
 ds_read_b128 a[112:115], v2 offset:61440
 v_fma_f32 v91, v91, v5, v28
M v[112:115], a[92:95], v[240:243], v[112:115]
 ds_read_b128 a[116:119], v2 offset:62464
 v_cvt_pk_bf16_f32 v80, v80, v81
M v[116:119], a[92:95], v[244:247], v[36:39]
 s_waitcnt vmcnt(6)
 v_readlane_b32 s84, v25, 0
 v_readlane_b32 s85, v25, 1
M v[116:119], a[88:91], v[228:231], v[116:119]
 ds_read_b128 a[120:123], v2 offset:63488
 v_mov_b32 v24, 0x3f80
M v[116:119], a[84:87], v[212:215], v[116:119]
 ds_read_b128 a[124:127], v2 offset:64512
 v_mov_b32 v25, 0x3f800000
M v[116:119], a[80:83], v[196:199], v[116:119]
 v_cvt_pk_bf16_f32 v81, v82, v83
 v_cvt_pk_bf16_f32 v82, v88, v89
M v[116:119], a[76:79], v[180:183], v[116:119]
 v_cvt_pk_bf16_f32 v83, v90, v91
M v[116:119], a[72:75], v[164:167], v[116:119]
 buffer_store_dwordx4 v[80:83], v7, s[8:11], s29 offen offset:1024 sc1
M v[116:119], a[68:71], v[148:151], v[116:119]
 s_waitcnt lgkmcnt(0)
 v_fma_f32 v84, v84, v6, v29
 v_fma_f32 v85, v85, v6, v29
M v[116:119], a[64:67], v[132:135], v[116:119]
 s_barrier
M v[124:127], a[96:99], v[132:135], v[36:39]
 ds_read_b128 a[64:67], v7 offset:32768
 v_fma_f32 v86, v86, v6, v29
M v[124:127], a[100:103], v[148:151], v[124:127]
 ds_read_b128 a[68:71], v7 offset:33792
 v_fma_f32 v87, v87, v6, v29
M v[124:127], a[104:107], v[164:167], v[124:127]
 v_fma_f32 v92, v92, v6, v29
 v_fma_f32 v93, v93, v6, v29
M v[124:127], a[108:111], v[180:183], v[124:127]
 ds_read_b128 a[72:75], v7 offset:34816
 v_fma_f32 v94, v94, v6, v29
M v[124:127], a[112:115], v[196:199], v[124:127]
 ds_read_b128 a[76:79], v7 offset:35840
 v_fma_f32 v95, v95, v6, v29
M v[124:127], a[116:119], v[212:215], v[124:127]
 s_waitcnt vmcnt(3)
 v_cvt_pk_bf16_f32 v84, v84, v85
 v_cvt_pk_bf16_f32 v85, v86, v87
M v[124:127], a[120:123], v[228:231], v[124:127]
 ds_read_b128 a[80:83], v7 offset:36864
 v_cvt_pk_bf16_f32 v86, v92, v93
M v[124:127], a[124:127], v[244:247], v[124:127]
 ds_read_b128 a[84:87], v7 offset:37888
 v_cvt_pk_bf16_f32 v87, v94, v95
M v[120:123], a[124:127], v[240:243], v[32:35]
 buffer_store_dword v40, v41, s[8:11], s45 offen sc1
M v[120:123], a[120:123], v[224:227], v[120:123]
 ds_read_b128 a[88:91], v7 offset:38912
M v[120:123], a[116:119], v[208:211], v[120:123]
 ds_read_b128 a[92:95], v7 offset:39936
M v[120:123], a[112:115], v[192:195], v[120:123]
 buffer_store_dwordx4 v[84:87], v7, s[8:11], s30 offen offset:1024 sc1
M v[120:123], a[108:111], v[176:179], v[120:123]
M v[120:123], a[104:107], v[160:163], v[120:123]
M v[120:123], a[100:103], v[144:147], v[120:123]
 s_waitcnt lgkmcnt(0)
 s_cmp_eq_u32 s42, 6
M v[120:123], a[96:99], v[128:131], v[120:123]
 s_cbranch_scc1 L_y3
L_y3r:
M v[64:67], a[64:67], v[128:131], v[32:35]
 ds_read_b128 a[96:99], v7 offset:40960
M v[64:67], a[68:71], v[144:147], v[64:67]
 ds_read_b128 a[100:103], v7 offset:41984
M v[64:67], a[72:75], v[160:163], v[64:67]
M v[64:67], a[76:79], v[176:179], v[64:67]
 ds_read_b128 a[104:107], v7 offset:43008
 s_add_u32 s29, s33, 10240
M v[64:67], a[80:83], v[192:195], v[64:67]
 ds_read_b128 a[108:111], v7 offset:44032
 s_add_u32 s30, s33, 24576
M v[64:67], a[84:87], v[208:211], v[64:67]
 v_fma_f32 v96, v96, v5, v28
 v_fma_f32 v97, v97, v5, v28
M v[64:67], a[88:91], v[224:227], v[64:67]
 ds_read_b128 a[112:115], v7 offset:45056
 v_fma_f32 v98, v98, v5, v28
M v[64:67], a[92:95], v[240:243], v[64:67]
 ds_read_b128 a[116:119], v7 offset:46080
 v_fma_f32 v99, v99, v5, v28
M v[68:71], a[92:95], v[244:247], v[36:39]
 v_fma_f32 v104, v104, v5, v28
 v_fma_f32 v105, v105, v5, v28
M v[68:71], a[88:91], v[228:231], v[68:71]
 ds_read_b128 a[120:123], v7 offset:47104
 v_fma_f32 v106, v106, v5, v28
M v[68:71], a[84:87], v[212:215], v[68:71]
 ds_read_b128 a[124:127], v7 offset:48128
 v_fma_f32 v107, v107, v5, v28
M v[68:71], a[80:83], v[196:199], v[68:71]
 v_cvt_pk_bf16_f32 v96, v96, v97
 v_cvt_pk_bf16_f32 v97, v98, v99
M v[68:71], a[76:79], v[180:183], v[68:71]
 v_cvt_pk_bf16_f32 v98, v104, v105
 v_cvt_pk_bf16_f32 v99, v106, v107
M v[68:71], a[72:75], v[164:167], v[68:71]
 buffer_store_dwordx4 v[96:99], v7, s[8:11], s29 offen offset:0 sc1
M v[68:71], a[68:71], v[148:151], v[68:71]
 v_fma_f32 v100, v100, v6, v29
 v_fma_f32 v101, v101, v6, v29
M v[68:71], a[64:67], v[132:135], v[68:71]
 s_waitcnt lgkmcnt(0)
 v_fma_f32 v102, v102, v6, v29
 v_fma_f32 v103, v103, v6, v29
M v[72:75], a[96:99], v[128:131], v[32:35]
 ds_read_b128 a[64:67], v7 offset:49152
 v_fma_f32 v108, v108, v6, v29
M v[72:75], a[100:103], v[144:147], v[72:75]
 ds_read_b128 a[68:71], v7 offset:50176
 v_fma_f32 v109, v109, v6, v29
M v[72:75], a[104:107], v[160:163], v[72:75]
 v_fma_f32 v110, v110, v6, v29
 v_fma_f32 v111, v111, v6, v29
M v[72:75], a[108:111], v[176:179], v[72:75]
 ds_read_b128 a[72:75], v7 offset:51200
 v_cvt_pk_bf16_f32 v100, v100, v101
M v[72:75], a[112:115], v[192:195], v[72:75]
 ds_read_b128 a[76:79], v7 offset:52224
 v_cvt_pk_bf16_f32 v101, v102, v103
M v[72:75], a[116:119], v[208:211], v[72:75]
 v_cvt_pk_bf16_f32 v102, v108, v109
 v_cvt_pk_bf16_f32 v103, v110, v111
M v[72:75], a[120:123], v[224:227], v[72:75]
 ds_read_b128 a[80:83], v7 offset:53248
M v[72:75], a[124:127], v[240:243], v[72:75]
 ds_read_b128 a[84:87], v7 offset:54272
M v[76:79], a[124:127], v[244:247], v[36:39]
 buffer_store_dwordx4 v[100:103], v7, s[8:11], s30 offen offset:0 sc1
M v[76:79], a[120:123], v[228:231], v[76:79]
 ds_read_b128 a[88:91], v7 offset:55296
 v_fma_f32 v112, v112, v5, v28
M v[76:79], a[116:119], v[212:215], v[76:79]
 ds_read_b128 a[92:95], v7 offset:56320
 v_fma_f32 v113, v113, v5, v28
M v[76:79], a[112:115], v[196:199], v[76:79]
 v_fma_f32 v114, v114, v5, v28
 v_fma_f32 v115, v115, v5, v28
M v[76:79], a[108:111], v[180:183], v[76:79]
 v_fma_f32 v120, v120, v5, v28
 v_fma_f32 v121, v121, v5, v28
M v[76:79], a[104:107], v[164:167], v[76:79]
 v_fma_f32 v122, v122, v5, v28
 v_fma_f32 v123, v123, v5, v28
M v[76:79], a[100:103], v[148:151], v[76:79]
 v_cvt_pk_bf16_f32 v112, v112, v113
 v_cvt_pk_bf16_f32 v113, v114, v115
M v[76:79], a[96:99], v[132:135], v[76:79]
 s_waitcnt lgkmcnt(0)
 v_cvt_pk_bf16_f32 v114, v120, v121
 v_cvt_pk_bf16_f32 v115, v122, v123
M v[80:83], a[64:67], v[128:131], v[32:35]
 ds_read_b128 a[96:99], v7 offset:57344
M v[80:83], a[68:71], v[144:147], v[80:83]
 ds_read_b128 a[100:103], v7 offset:58368
M v[80:83], a[72:75], v[160:163], v[80:83]
 buffer_store_dwordx4 v[112:115], v7, s[8:11], s29 offen offset:1024 sc1
M v[80:83], a[76:79], v[176:179], v[80:83]
 ds_read_b128 a[104:107], v7 offset:59392
 v_fma_f32 v116, v116, v6, v29
M v[80:83], a[80:83], v[192:195], v[80:83]
 ds_read_b128 a[108:111], v7 offset:60416
 v_fma_f32 v117, v117, v6, v29
M v[80:83], a[84:87], v[208:211], v[80:83]
 v_fma_f32 v118, v118, v6, v29
 v_fma_f32 v119, v119, v6, v29
M v[80:83], a[88:91], v[224:227], v[80:83]
 ds_read_b128 a[112:115], v7 offset:61440
 v_fma_f32 v124, v124, v6, v29
M v[80:83], a[92:95], v[240:243], v[80:83]
 ds_read_b128 a[116:119], v7 offset:62464
 v_fma_f32 v125, v125, v6, v29
M v[84:87], a[92:95], v[244:247], v[36:39]
 v_fma_f32 v126, v126, v6, v29
 v_fma_f32 v127, v127, v6, v29
M v[84:87], a[88:91], v[228:231], v[84:87]
 ds_read_b128 a[120:123], v7 offset:63488
 v_cvt_pk_bf16_f32 v116, v116, v117
M v[84:87], a[84:87], v[212:215], v[84:87]
 ds_read_b128 a[124:127], v7 offset:64512
 v_cvt_pk_bf16_f32 v117, v118, v119
M v[84:87], a[80:83], v[196:199], v[84:87]
 v_cvt_pk_bf16_f32 v118, v124, v125
 v_cvt_pk_bf16_f32 v119, v126, v127
M v[84:87], a[76:79], v[180:183], v[84:87]
 buffer_store_dwordx4 v[116:119], v7, s[8:11], s30 offen offset:1024 sc1
M v[84:87], a[72:75], v[164:167], v[84:87]
 s_add_u32 s29, s33, 12288
M v[84:87], a[68:71], v[148:151], v[84:87]
 s_add_u32 s30, s33, 26624
 v_fma_f32 v64, v64, v5, v28
 v_fma_f32 v65, v65, v5, v28
M v[84:87], a[64:67], v[132:135], v[84:87]
 s_waitcnt lgkmcnt(0)
 v_fma_f32 v66, v66, v5, v28
 v_fma_f32 v67, v67, v5, v28
M v[88:91], a[96:99], v[128:131], v[32:35]
 v_fma_f32 v72, v72, v5, v28
 v_fma_f32 v73, v73, v5, v28
M v[88:91], a[100:103], v[144:147], v[88:91]
 v_fma_f32 v74, v74, v5, v28
 v_fma_f32 v75, v75, v5, v28
M v[88:91], a[104:107], v[160:163], v[88:91]
 v_cvt_pk_bf16_f32 v64, v64, v65
 v_cvt_pk_bf16_f32 v65, v66, v67
M v[88:91], a[108:111], v[176:179], v[88:91]
 v_cvt_pk_bf16_f32 v66, v72, v73
 v_cvt_pk_bf16_f32 v67, v74, v75
M v[88:91], a[112:115], v[192:195], v[88:91]
 buffer_store_dwordx4 v[64:67], v7, s[8:11], s29 offen offset:0 sc1
M v[88:91], a[116:119], v[208:211], v[88:91]
 v_fma_f32 v68, v68, v6, v29
 v_fma_f32 v69, v69, v6, v29
M v[88:91], a[120:123], v[224:227], v[88:91]
 v_fma_f32 v70, v70, v6, v29
 v_fma_f32 v71, v71, v6, v29
M v[88:91], a[124:127], v[240:243], v[88:91]
 v_fma_f32 v76, v76, v6, v29
 v_fma_f32 v77, v77, v6, v29
M v[92:95], a[124:127], v[244:247], v[36:39]
 v_fma_f32 v78, v78, v6, v29
 v_fma_f32 v79, v79, v6, v29
M v[92:95], a[120:123], v[228:231], v[92:95]
 v_cvt_pk_bf16_f32 v68, v68, v69
 v_cvt_pk_bf16_f32 v69, v70, v71
M v[92:95], a[116:119], v[212:215], v[92:95]
 v_cvt_pk_bf16_f32 v70, v76, v77
 v_cvt_pk_bf16_f32 v71, v78, v79
M v[92:95], a[112:115], v[196:199], v[92:95]
 buffer_store_dwordx4 v[68:71], v7, s[8:11], s30 offen offset:0 sc1
M v[92:95], a[108:111], v[180:183], v[92:95]
M v[92:95], a[104:107], v[164:167], v[92:95]
M v[92:95], a[100:103], v[148:151], v[92:95]
M v[92:95], a[96:99], v[132:135], v[92:95]
 v_fma_f32 v80, v80, v5, v28
 v_fma_f32 v81, v81, v5, v28
 v_fma_f32 v82, v82, v5, v28
 v_fma_f32 v83, v83, v5, v28
 v_fma_f32 v88, v88, v5, v28
 v_fma_f32 v89, v89, v5, v28
 v_fma_f32 v90, v90, v5, v28
 v_fma_f32 v91, v91, v5, v28
 v_cvt_pk_bf16_f32 v80, v80, v81
 v_cvt_pk_bf16_f32 v81, v82, v83
 v_cvt_pk_bf16_f32 v82, v88, v89
 v_cvt_pk_bf16_f32 v83, v90, v91
 buffer_store_dwordx4 v[80:83], v7, s[8:11], s29 offen offset:1024 sc1
 v_fma_f32 v84, v84, v6, v29
 v_fma_f32 v85, v85, v6, v29
 v_fma_f32 v86, v86, v6, v29
 v_fma_f32 v87, v87, v6, v29
 v_fma_f32 v92, v92, v6, v29
 v_fma_f32 v93, v93, v6, v29
 v_fma_f32 v94, v94, v6, v29
 v_fma_f32 v95, v95, v6, v29
 v_cvt_pk_bf16_f32 v84, v84, v85
 v_cvt_pk_bf16_f32 v85, v86, v87
 v_cvt_pk_bf16_f32 v86, v92, v93
 v_cvt_pk_bf16_f32 v87, v94, v95
 buffer_store_dwordx4 v[84:87], v7, s[8:11], s30 offen offset:1024 sc1
 s_cmp_lt_u32 s42, 8
 s_cbranch_scc1 L_red
 s_cmp_eq_u32 s20, 3
 s_cbranch_scc1 L_vend3
 s_sub_u32 s64, 15, s42
 s_lshl_b32 s64, s64, 1
 s_lshr_b32 s65, s41, 3
 s_add_u32 s46, s64, s65
 s_mul_i32 s46, s46, 4352
 s_and_b32 s72, s41, 7
 s_lshl_b32 s66, s72, 7
 s_add_u32 s46, s46, s66
 s_add_u32 s46, s46, 104993792
 v_and_b32 v14, 15, v0
 v_lshlrev_b32 v14, 2, v14
 buffer_load_dword v9, v14, s[8:11], s46 offen sc1
 s_mul_i32 s86, s65, 3
 s_add_u32 s86, s86, s20
 s_add_u32 s86, s86, 8
 s_mul_i32 s77, s42, 1835008
 s_mul_i32 s78, s72, 14336
 s_add_u32 s77, s77, s78
 s_add_u32 s77, s77, 67108864
 s_lshl_b32 s78, s86, 10
 s_add_u32 s77, s77, s78
 s_lshl_b32 s86, s86, 6
 s_lshr_b32 s73, s72, 1
 s_sub_u32 s65, 7, s73
 s_bitcmp1_b32 s72, 0
 s_cselect_b32 s73, s65, s73
 s_lshl_b32 s73, s73, 4
 s_lshl_b32 s65, s42, 7
 s_add_u32 s73, s73, s65
 v_and_b32 v10, 15, v0
 v_add_u32 v10, s73, v10
 s_mov_b32 s64, 104857664
 v_mul_u32_u24 v12, 896, v10
 v_lshl_add_u32 v12, v11, 4, v12
 v_lshrrev_b32 v13, 4, v10
 v_lshlrev_b32 v13, 5, v13
 v_and_b32 v104, 15, v10
 v_add_lshl_u32 v13, v13, v104, 2
 buffer_load_dword v15, v13, s[8:11], s64 offen sc1
 buffer_load_dwordx4 v[16:19], v12, s[56:59], s86 offen
 v_mov_b32 v48, 0
 v_mov_b32 v49, 0
 v_mov_b32 v50, 0
 v_mov_b32 v51, 0
 v_mov_b32 v52, 0
 v_mov_b32 v53, 0
 v_mov_b32 v54, 0
 v_mov_b32 v55, 0
 s_waitcnt vmcnt(3)
 buffer_store_dword v40, v41, s[8:11], s3 offen sc1
 s_waitcnt vmcnt(3)
 v_cmp_eq_u32 vcc, 1, v9
 s_mov_b32 s91, 65536
 s_mov_b32 s69, 0
 s_and_b32 s70, vcc_lo, 0xffff
 s_or_b32 s68, s70, 0xffff0000
 s_cmp_lg_u32 s70, 0
 s_cbranch_scc1 L_vk0
 s_call_b64 s[36:37], L_rpoll
L_vk0:
 s_ff1_i32_b32 s71, s70
 s_bitset0_b32 s70, s71
 s_mul_i32 s71, s71, 114688
 s_add_u32 s12, s71, s77
 buffer_load_dwordx4 v[128:131], v7, s[8:11], s12 offen sc1
 s_cmp_lg_u32 s70, 0
 s_cbranch_scc1 L_vk1
 s_call_b64 s[36:37], L_rpoll
L_vk1:
 s_ff1_i32_b32 s71, s70
 s_bitset0_b32 s70, s71
 s_mul_i32 s71, s71, 114688
 s_add_u32 s13, s71, s77
 buffer_load_dwordx4 v[132:135], v7, s[8:11], s13 offen sc1
 s_waitcnt vmcnt(3)
 v_lshlrev_b32 v32, 16, v16
 v_and_b32 v33, 0xffff0000, v16
 v_lshlrev_b32 v34, 16, v17
 v_and_b32 v35, 0xffff0000, v17
 v_lshlrev_b32 v36, 16, v18
 v_and_b32 v37, 0xffff0000, v18
 v_lshlrev_b32 v38, 16, v19
 v_and_b32 v39, 0xffff0000, v19
 v_sub_f32 v13, 1.0, v15
 v_cmp_eq_u32 s[80:81], s84, v10
 v_cmp_eq_u32 s[82:83], s85, v10
 s_nop 0
 s_or_b64 vcc, s[80:81], s[82:83]
 s_cbranch_vccnz L_moe2
L_moe_ret2:
 v_mul_f32 v32, v13, v32
 v_mul_f32 v33, v13, v33
 v_mul_f32 v34, v13, v34
 v_mul_f32 v35, v13, v35
 v_mul_f32 v36, v13, v36
 v_mul_f32 v37, v13, v37
 v_mul_f32 v38, v13, v38
 v_mul_f32 v39, v13, v39
 s_cmp_lg_u32 s70, 0
 s_cbranch_scc1 L_vk2
 s_call_b64 s[36:37], L_rpoll
L_vk2:
 s_ff1_i32_b32 s71, s70
 s_bitset0_b32 s70, s71
 s_mul_i32 s71, s71, 114688
 s_add_u32 s14, s71, s77
 buffer_load_dwordx4 v[136:139], v7, s[8:11], s14 offen sc1
 s_cmp_lg_u32 s70, 0
 s_cbranch_scc1 L_vk3
 s_call_b64 s[36:37], L_rpoll
L_vk3:
 s_ff1_i32_b32 s71, s70
 s_bitset0_b32 s70, s71
 s_mul_i32 s71, s71, 114688
 s_add_u32 s15, s71, s77
 buffer_load_dwordx4 v[140:143], v7, s[8:11], s15 offen sc1
 s_cmp_lg_u32 s70, 0
 s_cbranch_scc1 L_vk4
 s_call_b64 s[36:37], L_rpoll
L_vk4:
 s_ff1_i32_b32 s71, s70
 s_bitset0_b32 s70, s71
 s_mul_i32 s71, s71, 114688
 s_add_u32 s16, s71, s77
 buffer_load_dwordx4 v[144:147], v7, s[8:11], s16 offen sc1
 s_cmp_lg_u32 s70, 0
 s_cbranch_scc1 L_vk5
 s_call_b64 s[36:37], L_rpoll
L_vk5:
 s_ff1_i32_b32 s71, s70
 s_bitset0_b32 s70, s71
 s_mul_i32 s71, s71, 114688
 s_add_u32 s17, s71, s77
 buffer_load_dwordx4 v[148:151], v7, s[8:11], s17 offen sc1
 s_cmp_lg_u32 s70, 0
 s_cbranch_scc1 L_vk6
 s_call_b64 s[36:37], L_rpoll
L_vk6:
 s_ff1_i32_b32 s71, s70
 s_bitset0_b32 s70, s71
 s_mul_i32 s71, s71, 114688
 s_add_u32 s18, s71, s77
 buffer_load_dwordx4 v[152:155], v7, s[8:11], s18 offen sc1
 s_cmp_lg_u32 s70, 0
 s_cbranch_scc1 L_vk7
 s_call_b64 s[36:37], L_rpoll
L_vk7:
 s_ff1_i32_b32 s71, s70
 s_bitset0_b32 s70, s71
 s_mul_i32 s71, s71, 114688
 s_add_u32 s19, s71, s77
 buffer_load_dwordx4 v[156:159], v7, s[8:11], s19 offen sc1
 s_cmp_lg_u32 s70, 0
 s_cbranch_scc1 L_vk8
 s_call_b64 s[36:37], L_rpoll
L_vk8:
 s_ff1_i32_b32 s71, s70
 s_bitset0_b32 s70, s71
 s_mul_i32 s71, s71, 114688
 s_add_u32 s21, s71, s77
 buffer_load_dwordx4 v[160:163], v7, s[8:11], s21 offen sc1
 s_cmp_lg_u32 s70, 0
 s_cbranch_scc1 L_vk9
 s_call_b64 s[36:37], L_rpoll
L_vk9:
 s_ff1_i32_b32 s71, s70
 s_bitset0_b32 s70, s71
 s_mul_i32 s71, s71, 114688
 s_add_u32 s22, s71, s77
 buffer_load_dwordx4 v[164:167], v7, s[8:11], s22 offen sc1
 s_cmp_lg_u32 s70, 0
 s_cbranch_scc1 L_vk10
 s_call_b64 s[36:37], L_rpoll
L_vk10:
 s_ff1_i32_b32 s71, s70
 s_bitset0_b32 s70, s71
 s_mul_i32 s71, s71, 114688
 s_add_u32 s23, s71, s77
 buffer_load_dwordx4 v[168:171], v7, s[8:11], s23 offen sc1
 s_cmp_lg_u32 s70, 0
 s_cbranch_scc1 L_vk11
 s_call_b64 s[36:37], L_rpoll
L_vk11:
 s_ff1_i32_b32 s71, s70
 s_bitset0_b32 s70, s71
 s_mul_i32 s71, s71, 114688
 s_add_u32 s24, s71, s77
 buffer_load_dwordx4 v[172:175], v7, s[8:11], s24 offen sc1
 s_cmp_lg_u32 s70, 0
 s_cbranch_scc1 L_vk12
 s_call_b64 s[36:37], L_rpoll
L_vk12:
 s_ff1_i32_b32 s71, s70
 s_bitset0_b32 s70, s71
 s_mul_i32 s71, s71, 114688
 s_add_u32 s48, s71, s77
 buffer_load_dwordx4 v[176:179], v7, s[8:11], s48 offen sc1
 s_cmp_lg_u32 s70, 0
 s_cbranch_scc1 L_vk13
 s_call_b64 s[36:37], L_rpoll
L_vk13:
 s_ff1_i32_b32 s71, s70
 s_bitset0_b32 s70, s71
 s_mul_i32 s71, s71, 114688
 s_add_u32 s49, s71, s77
 buffer_load_dwordx4 v[180:183], v7, s[8:11], s49 offen sc1
 s_cmp_lg_u32 s70, 0
 s_cbranch_scc1 L_vk14
 s_call_b64 s[36:37], L_rpoll
L_vk14:
 s_ff1_i32_b32 s71, s70
 s_bitset0_b32 s70, s71
 s_mul_i32 s71, s71, 114688
 s_add_u32 s50, s71, s77
 buffer_load_dwordx4 v[184:187], v7, s[8:11], s50 offen sc1
 s_cmp_lg_u32 s70, 0
 s_cbranch_scc1 L_vk15
 s_call_b64 s[36:37], L_rpoll
L_vk15:
 s_ff1_i32_b32 s71, s70
 s_bitset0_b32 s70, s71
 s_mul_i32 s71, s71, 114688
 s_add_u32 s51, s71, s77
 buffer_load_dwordx4 v[188:191], v7, s[8:11], s51 offen sc1
 s_waitcnt vmcnt(15)
 v_dot2c_f32_bf16 v48, v128, v24
 v_dot2c_f32_bf16 v49, v128, v25
 v_dot2c_f32_bf16 v50, v129, v24
 v_dot2c_f32_bf16 v51, v129, v25
 v_dot2c_f32_bf16 v52, v130, v24
 v_dot2c_f32_bf16 v53, v130, v25
 v_dot2c_f32_bf16 v54, v131, v24
 v_dot2c_f32_bf16 v55, v131, v25
 s_waitcnt vmcnt(14)
 v_dot2c_f32_bf16 v48, v132, v24
 v_dot2c_f32_bf16 v49, v132, v25
 v_dot2c_f32_bf16 v50, v133, v24
 v_dot2c_f32_bf16 v51, v133, v25
 v_dot2c_f32_bf16 v52, v134, v24
 v_dot2c_f32_bf16 v53, v134, v25
 v_dot2c_f32_bf16 v54, v135, v24
 v_dot2c_f32_bf16 v55, v135, v25
 s_waitcnt vmcnt(13)
 v_dot2c_f32_bf16 v48, v136, v24
 v_dot2c_f32_bf16 v49, v136, v25
 v_dot2c_f32_bf16 v50, v137, v24
 v_dot2c_f32_bf16 v51, v137, v25
 v_dot2c_f32_bf16 v52, v138, v24
 v_dot2c_f32_bf16 v53, v138, v25
 v_dot2c_f32_bf16 v54, v139, v24
 v_dot2c_f32_bf16 v55, v139, v25
 s_waitcnt vmcnt(12)
 v_dot2c_f32_bf16 v48, v140, v24
 v_dot2c_f32_bf16 v49, v140, v25
 v_dot2c_f32_bf16 v50, v141, v24
 v_dot2c_f32_bf16 v51, v141, v25
 v_dot2c_f32_bf16 v52, v142, v24
 v_dot2c_f32_bf16 v53, v142, v25
 v_dot2c_f32_bf16 v54, v143, v24
 v_dot2c_f32_bf16 v55, v143, v25
 s_waitcnt vmcnt(11)
 v_dot2c_f32_bf16 v48, v144, v24
 v_dot2c_f32_bf16 v49, v144, v25
 v_dot2c_f32_bf16 v50, v145, v24
 v_dot2c_f32_bf16 v51, v145, v25
 v_dot2c_f32_bf16 v52, v146, v24
 v_dot2c_f32_bf16 v53, v146, v25
 v_dot2c_f32_bf16 v54, v147, v24
 v_dot2c_f32_bf16 v55, v147, v25
 s_waitcnt vmcnt(10)
 v_dot2c_f32_bf16 v48, v148, v24
 v_dot2c_f32_bf16 v49, v148, v25
 v_dot2c_f32_bf16 v50, v149, v24
 v_dot2c_f32_bf16 v51, v149, v25
 v_dot2c_f32_bf16 v52, v150, v24
 v_dot2c_f32_bf16 v53, v150, v25
 v_dot2c_f32_bf16 v54, v151, v24
 v_dot2c_f32_bf16 v55, v151, v25
 s_waitcnt vmcnt(9)
 v_dot2c_f32_bf16 v48, v152, v24
 v_dot2c_f32_bf16 v49, v152, v25
 v_dot2c_f32_bf16 v50, v153, v24
 v_dot2c_f32_bf16 v51, v153, v25
 v_dot2c_f32_bf16 v52, v154, v24
 v_dot2c_f32_bf16 v53, v154, v25
 v_dot2c_f32_bf16 v54, v155, v24
 v_dot2c_f32_bf16 v55, v155, v25
 s_waitcnt vmcnt(8)
 v_dot2c_f32_bf16 v48, v156, v24
 v_dot2c_f32_bf16 v49, v156, v25
 v_dot2c_f32_bf16 v50, v157, v24
 v_dot2c_f32_bf16 v51, v157, v25
 v_dot2c_f32_bf16 v52, v158, v24
 v_dot2c_f32_bf16 v53, v158, v25
 v_dot2c_f32_bf16 v54, v159, v24
 v_dot2c_f32_bf16 v55, v159, v25
 s_waitcnt vmcnt(7)
 v_dot2c_f32_bf16 v48, v160, v24
 v_dot2c_f32_bf16 v49, v160, v25
 v_dot2c_f32_bf16 v50, v161, v24
 v_dot2c_f32_bf16 v51, v161, v25
 v_dot2c_f32_bf16 v52, v162, v24
 v_dot2c_f32_bf16 v53, v162, v25
 v_dot2c_f32_bf16 v54, v163, v24
 v_dot2c_f32_bf16 v55, v163, v25
 s_waitcnt vmcnt(6)
 v_dot2c_f32_bf16 v48, v164, v24
 v_dot2c_f32_bf16 v49, v164, v25
 v_dot2c_f32_bf16 v50, v165, v24
 v_dot2c_f32_bf16 v51, v165, v25
 v_dot2c_f32_bf16 v52, v166, v24
 v_dot2c_f32_bf16 v53, v166, v25
 v_dot2c_f32_bf16 v54, v167, v24
 v_dot2c_f32_bf16 v55, v167, v25
 s_waitcnt vmcnt(5)
 v_dot2c_f32_bf16 v48, v168, v24
 v_dot2c_f32_bf16 v49, v168, v25
 v_dot2c_f32_bf16 v50, v169, v24
 v_dot2c_f32_bf16 v51, v169, v25
 v_dot2c_f32_bf16 v52, v170, v24
 v_dot2c_f32_bf16 v53, v170, v25
 v_dot2c_f32_bf16 v54, v171, v24
 v_dot2c_f32_bf16 v55, v171, v25
 s_waitcnt vmcnt(4)
 v_dot2c_f32_bf16 v48, v172, v24
 v_dot2c_f32_bf16 v49, v172, v25
 v_dot2c_f32_bf16 v50, v173, v24
 v_dot2c_f32_bf16 v51, v173, v25
 v_dot2c_f32_bf16 v52, v174, v24
 v_dot2c_f32_bf16 v53, v174, v25
 v_dot2c_f32_bf16 v54, v175, v24
 v_dot2c_f32_bf16 v55, v175, v25
 s_waitcnt vmcnt(3)
 v_dot2c_f32_bf16 v48, v176, v24
 v_dot2c_f32_bf16 v49, v176, v25
 v_dot2c_f32_bf16 v50, v177, v24
 v_dot2c_f32_bf16 v51, v177, v25
 v_dot2c_f32_bf16 v52, v178, v24
 v_dot2c_f32_bf16 v53, v178, v25
 v_dot2c_f32_bf16 v54, v179, v24
 v_dot2c_f32_bf16 v55, v179, v25
 s_waitcnt vmcnt(2)
 v_dot2c_f32_bf16 v48, v180, v24
 v_dot2c_f32_bf16 v49, v180, v25
 v_dot2c_f32_bf16 v50, v181, v24
 v_dot2c_f32_bf16 v51, v181, v25
 v_dot2c_f32_bf16 v52, v182, v24
 v_dot2c_f32_bf16 v53, v182, v25
 v_dot2c_f32_bf16 v54, v183, v24
 v_dot2c_f32_bf16 v55, v183, v25
 s_waitcnt vmcnt(1)
 v_dot2c_f32_bf16 v48, v184, v24
 v_dot2c_f32_bf16 v49, v184, v25
 v_dot2c_f32_bf16 v50, v185, v24
 v_dot2c_f32_bf16 v51, v185, v25
 v_dot2c_f32_bf16 v52, v186, v24
 v_dot2c_f32_bf16 v53, v186, v25
 v_dot2c_f32_bf16 v54, v187, v24
 v_dot2c_f32_bf16 v55, v187, v25
 s_waitcnt vmcnt(0)
 v_dot2c_f32_bf16 v48, v188, v24
 v_dot2c_f32_bf16 v49, v188, v25
 v_dot2c_f32_bf16 v50, v189, v24
 v_dot2c_f32_bf16 v51, v189, v25
 v_dot2c_f32_bf16 v52, v190, v24
 v_dot2c_f32_bf16 v53, v190, v25
 v_dot2c_f32_bf16 v54, v191, v24
 v_dot2c_f32_bf16 v55, v191, v25
 s_nop 1
 v_fmac_f32 v32, v15, v48
 v_fmac_f32 v33, v15, v49
 v_fmac_f32 v34, v15, v50
 v_fmac_f32 v35, v15, v51
 v_fmac_f32 v36, v15, v52
 v_fmac_f32 v37, v15, v53
 v_fmac_f32 v38, v15, v54
 v_fmac_f32 v39, v15, v55
 v_cvt_pk_bf16_f32 v16, v32, v33
 v_cvt_pk_bf16_f32 v17, v34, v35
 v_cvt_pk_bf16_f32 v18, v36, v37
 v_cvt_pk_bf16_f32 v19, v38, v39
 buffer_store_dwordx4 v[16:19], v12, s[52:55], s86 offen sc1
L_vend:
 s_endpgm
L_vend3:
 s_waitcnt vmcnt(0)
 buffer_store_dword v40, v41, s[8:11], s3 offen sc1
 s_branch L_vend
 s_waitcnt vmcnt(0)
L_p3k:
 s_mov_b32 s72, s32
 s_add_u32 s73, s72, 4096
 s_add_u32 s74, s72, 8192
 s_add_u32 s75, s72, 12288
 s_waitcnt vmcnt(8)
 v_cmp_ne_u32 vcc, 1, v5
 s_nop 0
 s_cbranch_vccnz L_fps1
L_fpr1:
M v[128:131], a[64:67], v[40:43], v[128:131]
 ds_read_b128 a[96:99], v2 offset:8192
 ds_read_b128 a[100:103], v2 offset:9216
M v[128:131], a[68:71], v[56:59], v[128:131]
 buffer_load_dwordx4 a[0:3], v7, s[8:11], s72 offen offset:0 sc1
M v[132:135], a[68:71], v[60:63], v[132:135]
 v_exp_f32 v18, v100
M v[132:135], a[64:67], v[44:47], v[132:135]
 ds_read_b128 a[104:107], v2 offset:10240
 ds_read_b128 a[108:111], v2 offset:11264
M v[140:143], a[72:75], v[44:47], v[140:143]
 buffer_load_dwordx4 a[4:7], v7, s[8:11], s72 offen offset:1024 sc1
M v[140:143], a[76:79], v[60:63], v[140:143]
 v_exp_f32 v19, v101
M v[136:139], a[76:79], v[56:59], v[136:139]
 ds_read_b128 a[112:115], v2 offset:12288
 ds_read_b128 a[116:119], v2 offset:13312
M v[136:139], a[72:75], v[40:43], v[136:139]
 buffer_load_dwordx4 a[8:11], v7, s[8:11], s72 offen offset:2048 sc1
M v[144:147], a[80:83], v[40:43], v[144:147]
 v_exp_f32 v20, v102
M v[144:147], a[84:87], v[56:59], v[144:147]
 ds_read_b128 a[120:123], v2 offset:14336
 ds_read_b128 a[124:127], v2 offset:15360
M v[148:151], a[84:87], v[60:63], v[148:151]
 v_exp_f32 v21, v103
M v[148:151], a[80:83], v[44:47], v[148:151]
 buffer_load_dwordx4 a[12:15], v7, s[8:11], s72 offen offset:3072 sc1
M v[156:159], a[88:91], v[44:47], v[156:159]
 v_add_f32 v30, v26, v30
 v_add_f32 v31, v27, v31
M v[156:159], a[92:95], v[60:63], v[156:159]
 v_add_f32 v29, v18, v19
 v_cvt_pk_bf16_f32 v52, v18, v19
M v[152:155], a[92:95], v[56:59], v[152:155]
 v_exp_f32 v22, v108
M v[152:155], a[88:91], v[40:43], v[152:155]
 s_waitcnt lgkmcnt(0)
 v_add_f32 v29, v20, v29
 v_cvt_pk_bf16_f32 v53, v20, v21
M v[160:163], a[96:99], v[40:43], v[160:163]
 ds_read_b128 a[64:67], v2 offset:16384
 ds_read_b128 a[68:71], v2 offset:17408
M v[160:163], a[100:103], v[56:59], v[160:163]
 buffer_load_dwordx4 a[16:19], v7, s[8:11], s73 offen offset:0 sc1
M v[164:167], a[100:103], v[60:63], v[164:167]
 v_exp_f32 v23, v109
M v[164:167], a[96:99], v[44:47], v[164:167]
 ds_read_b128 a[72:75], v2 offset:18432
 ds_read_b128 a[76:79], v2 offset:19456
M v[172:175], a[104:107], v[44:47], v[172:175]
 buffer_load_dwordx4 a[20:23], v7, s[8:11], s73 offen offset:1024 sc1
M v[172:175], a[108:111], v[60:63], v[172:175]
 v_exp_f32 v24, v110
M v[168:171], a[108:111], v[56:59], v[168:171]
 ds_read_b128 a[80:83], v2 offset:20480
 ds_read_b128 a[84:87], v2 offset:21504
M v[168:171], a[104:107], v[40:43], v[168:171]
 buffer_load_dwordx4 a[24:27], v7, s[8:11], s73 offen offset:2048 sc1
M v[176:179], a[112:115], v[40:43], v[176:179]
 v_exp_f32 v25, v111
M v[176:179], a[116:119], v[56:59], v[176:179]
 ds_read_b128 a[88:91], v2 offset:22528
 ds_read_b128 a[92:95], v2 offset:23552
M v[180:183], a[116:119], v[60:63], v[180:183]
 buffer_load_dwordx4 a[28:31], v7, s[8:11], s73 offen offset:3072 sc1
M v[180:183], a[112:115], v[44:47], v[180:183]
 v_add_f32 v29, v21, v29
 v_add_f32 v29, v22, v29
M v[188:191], a[120:123], v[44:47], v[188:191]
 v_exp_f32 v18, v116
M v[188:191], a[124:127], v[60:63], v[188:191]
 v_cvt_pk_bf16_f32 v54, v22, v23
 v_add_f32 v29, v23, v29
M v[184:187], a[124:127], v[56:59], v[184:187]
 buffer_load_dwordx4 a[32:35], v7, s[8:11], s74 offen offset:0 sc1
M v[184:187], a[120:123], v[40:43], v[184:187]
 s_waitcnt lgkmcnt(0)
 v_exp_f32 v19, v117
M v[192:195], a[64:67], v[40:43], v[192:195]
 ds_read_b128 a[96:99], v2 offset:24576
 ds_read_b128 a[100:103], v2 offset:25600
M v[192:195], a[68:71], v[56:59], v[192:195]
 buffer_load_dwordx4 a[36:39], v7, s[8:11], s74 offen offset:1024 sc1
M v[196:199], a[68:71], v[60:63], v[196:199]
 v_add_f32 v29, v24, v29
 v_cvt_pk_bf16_f32 v55, v24, v25
M v[196:199], a[64:67], v[44:47], v[196:199]
 ds_read_b128 a[104:107], v2 offset:26624
 ds_read_b128 a[108:111], v2 offset:27648
M v[204:207], a[72:75], v[44:47], v[204:207]
 v_exp_f32 v20, v118
M v[204:207], a[76:79], v[60:63], v[204:207]
 buffer_load_dwordx4 a[40:43], v7, s[8:11], s74 offen offset:2048 sc1
M v[200:203], a[76:79], v[56:59], v[200:203]
 ds_read_b128 a[112:115], v2 offset:28672
 ds_read_b128 a[116:119], v2 offset:29696
M v[200:203], a[72:75], v[40:43], v[200:203]
 v_exp_f32 v21, v119
M v[208:211], a[80:83], v[40:43], v[208:211]
 v_add_f32 v29, v25, v29
 v_add_f32 v29, v18, v29
M v[208:211], a[84:87], v[56:59], v[208:211]
 ds_read_b128 a[120:123], v2 offset:30720
 ds_read_b128 a[124:127], v2 offset:31744
M v[212:215], a[84:87], v[60:63], v[212:215]
 buffer_load_dwordx4 a[44:47], v7, s[8:11], s74 offen offset:3072 sc1
M v[212:215], a[80:83], v[44:47], v[212:215]
 v_exp_f32 v22, v124
M v[220:223], a[88:91], v[44:47], v[220:223]
 v_cvt_pk_bf16_f32 v48, v18, v19
 v_add_f32 v29, v19, v29
M v[220:223], a[92:95], v[60:63], v[220:223]
 buffer_load_dwordx4 a[48:51], v7, s[8:11], s75 offen offset:0 sc1
M v[216:219], a[92:95], v[56:59], v[216:219]
 s_waitcnt vmcnt(13) lgkmcnt(0)
 v_exp_f32 v23, v125
M v[216:219], a[88:91], v[40:43], v[216:219]
 s_barrier
M v[224:227], a[96:99], v[40:43], v[224:227]
 ds_read_b128 a[64:67], v7 offset:0
 ds_read_b128 a[68:71], v7 offset:1024
M v[224:227], a[100:103], v[56:59], v[224:227]
 buffer_load_dwordx4 a[52:55], v7, s[8:11], s75 offen offset:1024 sc1
M v[228:231], a[100:103], v[60:63], v[228:231]
 v_exp_f32 v24, v126
M v[228:231], a[96:99], v[44:47], v[228:231]
 ds_read_b128 a[72:75], v7 offset:2048
 ds_read_b128 a[76:79], v7 offset:3072
M v[236:239], a[104:107], v[44:47], v[236:239]
 buffer_load_dwordx4 a[56:59], v7, s[8:11], s75 offen offset:2048 sc1
M v[236:239], a[108:111], v[60:63], v[236:239]
 v_exp_f32 v25, v127
M v[232:235], a[108:111], v[56:59], v[232:235]
 ds_read_b128 a[80:83], v7 offset:4096
 ds_read_b128 a[84:87], v7 offset:5120
M v[232:235], a[104:107], v[40:43], v[232:235]
 v_add_f32 v29, v20, v29
 v_cvt_pk_bf16_f32 v49, v20, v21
M v[240:243], a[112:115], v[40:43], v[240:243]
 buffer_load_dwordx4 a[60:63], v7, s[8:11], s75 offen offset:3072 sc1
M v[240:243], a[116:119], v[56:59], v[240:243]
 ds_read_b128 a[88:91], v7 offset:6144
 ds_read_b128 a[92:95], v7 offset:7168
M v[244:247], a[116:119], v[60:63], v[244:247]
 v_add_f32 v29, v21, v29
 v_add_f32 v29, v22, v29
M v[244:247], a[112:115], v[44:47], v[244:247]
 v_cvt_pk_bf16_f32 v50, v22, v23
 v_add_f32 v29, v23, v29
M v[252:255], a[120:123], v[44:47], v[252:255]
 v_add_f32 v29, v24, v29
 v_cvt_pk_bf16_f32 v51, v24, v25
M v[252:255], a[124:127], v[60:63], v[252:255]
 v_add_f32 v29, v25, v29
M v[248:251], a[124:127], v[56:59], v[248:251]
 s_waitcnt lgkmcnt(0)
M v[248:251], a[120:123], v[40:43], v[248:251]
 v_cmp_lt_f32 vcc, s31, v29
 s_nop 0
 s_cbranch_vccnz L_st7
L_rt7:
M v[132:135], a[64:67], v[52:55], v[132:135]
 ds_read_b128 a[96:99], v7 offset:8192
 ds_read_b128 a[100:103], v7 offset:9216
M v[132:135], a[68:71], v[48:51], v[132:135]
 ds_read_b128 a[104:107], v7 offset:10240
 v_add_f32 v31, v29, v31
M v[140:143], a[76:79], v[48:51], v[140:143]
 s_sub_u32 s27, 5, s42
 ds_read_b128 a[108:111], v7 offset:11264
 ds_read_b128 a[112:115], v7 offset:12288
M v[140:143], a[72:75], v[52:55], v[140:143]
 s_mov_b32 s40, 0
 ds_read_b128 a[116:119], v7 offset:13312
 v_mov_b32 v10, v30
M v[148:151], a[80:83], v[52:55], v[148:151]
 s_add_u32 m0, s28, 32768
 ds_read_b128 a[120:123], v7 offset:14336
 ds_read_b128 a[124:127], v7 offset:15360
M v[148:151], a[84:87], v[48:51], v[148:151]
 buffer_load_dwordx4 v3, s[8:11], s21 offen offset:0 sc1 lds
M v[156:159], a[92:95], v[48:51], v[156:159]
 ds_read_b128 a[128:131], v7 offset:16384
 ds_read_b128 a[132:135], v7 offset:17408
M v[156:159], a[88:91], v[52:55], v[156:159]
 s_waitcnt lgkmcnt(2)
 ds_read_b128 a[136:139], v7 offset:18432
 v_mov_b32 v11, v31
M v[164:167], a[96:99], v[52:55], v[164:167]
 ds_read_b128 a[140:143], v7 offset:19456
 ds_read_b128 a[144:147], v7 offset:20480
M v[164:167], a[100:103], v[48:51], v[164:167]
 buffer_load_dwordx4 v3, s[8:11], s21 offen offset:1024 sc1 lds
M v[172:175], a[108:111], v[48:51], v[172:175]
 ds_read_b128 a[148:151], v7 offset:21504
 ds_read_b128 a[152:155], v7 offset:22528
M v[172:175], a[104:107], v[52:55], v[172:175]
 ds_read_b128 a[156:159], v7 offset:23552
 v_permlane16_swap_b32 v10, v30
M v[180:183], a[112:115], v[52:55], v[180:183]
 ds_read_b128 a[160:163], v7 offset:24576
 ds_read_b128 a[164:167], v7 offset:25600
M v[180:183], a[116:119], v[48:51], v[180:183]
 buffer_load_dwordx4 v3, s[8:11], s21 offen offset:2048 sc1 lds
M v[188:191], a[124:127], v[48:51], v[188:191]
 ds_read_b128 a[168:171], v7 offset:26624
 ds_read_b128 a[172:175], v7 offset:27648
M v[188:191], a[120:123], v[52:55], v[188:191]
 s_waitcnt lgkmcnt(4)
 ds_read_b128 a[176:179], v7 offset:28672
 v_permlane16_swap_b32 v11, v31
M v[196:199], a[128:131], v[52:55], v[196:199]
 ds_read_b128 a[180:183], v7 offset:29696
 ds_read_b128 a[184:187], v7 offset:30720
M v[196:199], a[132:135], v[48:51], v[196:199]
 ds_read_b128 a[188:191], v7 offset:31744
 v_add_f32 v30, v10, v30
M v[204:207], a[140:143], v[48:51], v[204:207]
 buffer_load_dwordx4 v3, s[8:11], s21 offen offset:3072 sc1 lds
M v[204:207], a[136:139], v[52:55], v[204:207]
 s_add_u32 m0, s28, 36864
 v_add_f32 v31, v11, v31
 v_mov_b32 v10, v30
M v[212:215], a[144:147], v[52:55], v[212:215]
 buffer_load_dwordx4 v4, s[8:11], s21 offen offset:0 sc1 lds
M v[212:215], a[148:151], v[48:51], v[212:215]
 s_waitcnt lgkmcnt(0)
 v_mov_b32 v11, v31
 v_permlane32_swap_b32 v10, v30
M v[220:223], a[156:159], v[48:51], v[220:223]
 s_barrier
M v[220:223], a[152:155], v[52:55], v[220:223]
 ds_read_b128 a[64:67], v2 offset:32768
 ds_read_b128 a[68:71], v2 offset:33792
M v[228:231], a[160:163], v[52:55], v[228:231]
 ds_read_b128 a[72:75], v2 offset:34816
 v_permlane32_swap_b32 v11, v31
M v[228:231], a[164:167], v[48:51], v[228:231]
 ds_read_b128 a[76:79], v2 offset:35840
 ds_read_b128 a[80:83], v2 offset:36864
M v[236:239], a[172:175], v[48:51], v[236:239]
 ds_read_b128 a[84:87], v2 offset:37888
 v_add_f32 v30, v10, v30
M v[236:239], a[168:171], v[52:55], v[236:239]
 ds_read_b128 a[88:91], v2 offset:38912
 ds_read_b128 a[92:95], v2 offset:39936
M v[244:247], a[176:179], v[52:55], v[244:247]
 buffer_load_dwordx4 v4, s[8:11], s21 offen offset:1024 sc1 lds
M v[244:247], a[180:183], v[48:51], v[244:247]
 buffer_load_dwordx4 v4, s[8:11], s21 offen offset:2048 sc1 lds
M v[252:255], a[188:191], v[48:51], v[252:255]
 buffer_load_dwordx4 v4, s[8:11], s21 offen offset:3072 sc1 lds
M v[252:255], a[184:187], v[52:55], v[252:255]
 s_waitcnt lgkmcnt(0)
 s_add_u32 s24, s23, 16777216
 s_mov_b32 s23, s21
 s_add_u32 s21, s21, 32768
 s_add_u32 s22, s22, 1
 s_cmp_eq_u32 s22, s25
 s_cselect_b32 s21, s26, s21
 s_cmp_eq_u32 s22, s43
 s_cselect_b32 s21, s4, s21
 s_cmp_eq_u32 s22, s6
 s_cselect_b32 s21, s7, s21
 v_add_f32 v31, v11, v31
 v_rcp_f32 v5, v30
 v_rcp_f32 v6, v31
 v_accvgpr_write_b32 a192, v5
 v_accvgpr_write_b32 a193, v6
 v_mov_b32 v30, 0
 v_mov_b32 v31, 0
 v_mov_b32 v32, 0xc1800000
 v_mov_b32 v33, 0xc1800000
 v_mov_b32 v34, 0xc1800000
 v_mov_b32 v35, 0xc1800000
 v_mov_b32 v36, 0xc1800000
 v_mov_b32 v37, 0xc1800000
 v_mov_b32 v38, 0xc1800000
 v_mov_b32 v39, 0xc1800000
 s_waitcnt vmcnt(8)
M v[64:67], a[64:67], a[0:3], v[32:35]
 ds_read_b128 a[96:99], v2 offset:40960
 v_cvt_pk_bf16_f32 v128, v128, v129
M v[64:67], a[68:71], a[4:7], v[64:67]
 ds_read_b128 a[100:103], v2 offset:41984
 v_cvt_pk_bf16_f32 v129, v130, v131
M v[64:67], a[72:75], a[8:11], v[64:67]
 buffer_load_dword v6, v9, s[8:11], s46 offen sc1
M v[64:67], a[76:79], a[12:15], v[64:67]
 ds_read_b128 a[104:107], v2 offset:43008
 v_cvt_pk_bf16_f32 v130, v136, v137
M v[64:67], a[80:83], a[16:19], v[64:67]
 s_add_u32 m0, s28, 65536
 ds_read_b128 a[108:111], v2 offset:44032
 v_cvt_pk_bf16_f32 v131, v138, v139
M v[64:67], a[84:87], a[20:23], v[64:67]
 buffer_load_dwordx4 v3, s[8:11], s24 offen offset:0 sc1 lds
M v[64:67], a[88:91], a[24:27], v[64:67]
 ds_read_b128 a[112:115], v2 offset:45056
 v_accvgpr_write_b32 a128, v128
M v[64:67], a[92:95], a[28:31], v[64:67]
 ds_read_b128 a[116:119], v2 offset:46080
 v_accvgpr_write_b32 a129, v129
M v[68:71], a[92:95], a[60:63], v[36:39]
 buffer_load_dwordx4 v3, s[8:11], s24 offen offset:1024 sc1 lds
M v[68:71], a[88:91], a[56:59], v[68:71]
 ds_read_b128 a[120:123], v2 offset:47104
 v_accvgpr_write_b32 a130, v130
M v[68:71], a[84:87], a[52:55], v[68:71]
 ds_read_b128 a[124:127], v2 offset:48128
 v_accvgpr_write_b32 a131, v131
M v[68:71], a[80:83], a[48:51], v[68:71]
 v_exp_f32 v18, v64
M v[68:71], a[76:79], a[44:47], v[68:71]
 v_exp_f32 v19, v65
M v[68:71], a[72:75], a[40:43], v[68:71]
 buffer_load_dwordx4 v3, s[8:11], s24 offen offset:2048 sc1 lds
M v[68:71], a[68:71], a[36:39], v[68:71]
 v_exp_f32 v20, v66
M v[68:71], a[64:67], a[32:35], v[68:71]
 s_waitcnt lgkmcnt(0)
 v_exp_f32 v21, v67
M v[72:75], a[96:99], a[0:3], v[32:35]
 ds_read_b128 a[64:67], v2 offset:49152
 v_add_f32 v26, v18, v19
M v[72:75], a[100:103], a[4:7], v[72:75]
 ds_read_b128 a[68:71], v2 offset:50176
 v_cvt_pk_bf16_f32 v40, v18, v19
M v[72:75], a[104:107], a[8:11], v[72:75]
 buffer_load_dwordx4 v3, s[8:11], s24 offen offset:3072 sc1 lds
M v[72:75], a[108:111], a[12:15], v[72:75]
 ds_read_b128 a[72:75], v2 offset:51200
 v_add_f32 v26, v20, v26
M v[72:75], a[112:115], a[16:19], v[72:75]
 ds_read_b128 a[76:79], v2 offset:52224
 v_cvt_pk_bf16_f32 v41, v20, v21
M v[72:75], a[116:119], a[20:23], v[72:75]
 v_exp_f32 v22, v68
M v[72:75], a[120:123], a[24:27], v[72:75]
 ds_read_b128 a[80:83], v2 offset:53248
 v_add_f32 v26, v21, v26
M v[72:75], a[124:127], a[28:31], v[72:75]
 s_add_u32 m0, s28, 69632
 ds_read_b128 a[84:87], v2 offset:54272
 v_cvt_pk_bf16_f32 v132, v132, v133
M v[76:79], a[124:127], a[60:63], v[36:39]
 buffer_load_dwordx4 v4, s[8:11], s24 offen offset:0 sc1 lds
M v[76:79], a[120:123], a[56:59], v[76:79]
 ds_read_b128 a[88:91], v2 offset:55296
 v_cvt_pk_bf16_f32 v133, v134, v135
M v[76:79], a[116:119], a[52:55], v[76:79]
 ds_read_b128 a[92:95], v2 offset:56320
 v_cvt_pk_bf16_f32 v134, v140, v141
M v[76:79], a[112:115], a[48:51], v[76:79]
 v_exp_f32 v23, v69
M v[76:79], a[108:111], a[44:47], v[76:79]
 buffer_load_dwordx4 v4, s[8:11], s24 offen offset:1024 sc1 lds
M v[76:79], a[104:107], a[40:43], v[76:79]
 v_exp_f32 v24, v70
M v[76:79], a[100:103], a[36:39], v[76:79]
 v_exp_f32 v25, v71
M v[76:79], a[96:99], a[32:35], v[76:79]
 s_waitcnt lgkmcnt(0)
 v_exp_f32 v18, v72
M v[80:83], a[64:67], a[0:3], v[32:35]
 ds_read_b128 a[96:99], v2 offset:57344
 v_add_f32 v27, v22, v23
M v[80:83], a[68:71], a[4:7], v[80:83]
 ds_read_b128 a[100:103], v2 offset:58368
 v_cvt_pk_bf16_f32 v44, v22, v23
M v[80:83], a[72:75], a[8:11], v[80:83]
 buffer_load_dwordx4 v4, s[8:11], s24 offen offset:2048 sc1 lds
M v[80:83], a[76:79], a[12:15], v[80:83]
 ds_read_b128 a[104:107], v2 offset:59392
 v_add_f32 v27, v24, v27
M v[80:83], a[80:83], a[16:19], v[80:83]
 ds_read_b128 a[108:111], v2 offset:60416
 v_cvt_pk_bf16_f32 v45, v24, v25
M v[80:83], a[84:87], a[20:23], v[80:83]
 v_exp_f32 v19, v73
M v[80:83], a[88:91], a[24:27], v[80:83]
 ds_read_b128 a[112:115], v2 offset:61440
 v_add_f32 v27, v25, v27
M v[80:83], a[92:95], a[28:31], v[80:83]
 ds_read_b128 a[116:119], v2 offset:62464
 v_add_f32 v26, v18, v26
M v[84:87], a[92:95], a[60:63], v[36:39]
 s_waitcnt vmcnt(7)
 v_cmp_gt_u32 vcc, 3, v6
 v_cvt_pk_bf16_f32 v42, v18, v19
M v[84:87], a[88:91], a[56:59], v[84:87]
 ds_read_b128 a[120:123], v2 offset:63488
 v_add_f32 v26, v19, v26
M v[84:87], a[84:87], a[52:55], v[84:87]
 ds_read_b128 a[124:127], v2 offset:64512
 v_cvt_pk_bf16_f32 v135, v142, v143
M v[84:87], a[80:83], a[48:51], v[84:87]
 s_cbranch_vccnz L_f2s
L_f2r:
 v_exp_f32 v20, v74
M v[84:87], a[76:79], a[44:47], v[84:87]
 buffer_load_dwordx4 v4, s[8:11], s24 offen offset:3072 sc1 lds
M v[84:87], a[72:75], a[40:43], v[84:87]
 v_exp_f32 v21, v75
M v[84:87], a[68:71], a[36:39], v[84:87]
 s_waitcnt lgkmcnt(0)
 v_exp_f32 v22, v76
M v[84:87], a[64:67], a[32:35], v[84:87]
 s_barrier
M v[88:91], a[96:99], a[0:3], v[32:35]
 ds_read_b128 a[64:67], v7 offset:32768
 v_add_f32 v26, v20, v26
M v[88:91], a[100:103], a[4:7], v[88:91]
 ds_read_b128 a[68:71], v7 offset:33792
 v_cvt_pk_bf16_f32 v43, v20, v21
M v[88:91], a[104:107], a[8:11], v[88:91]
 v_exp_f32 v23, v77
M v[88:91], a[108:111], a[12:15], v[88:91]
 ds_read_b128 a[72:75], v7 offset:34816
 v_add_f32 v26, v21, v26
M v[88:91], a[112:115], a[16:19], v[88:91]
 ds_read_b128 a[76:79], v7 offset:35840
 v_add_f32 v27, v22, v27
M v[88:91], a[116:119], a[20:23], v[88:91]
 v_exp_f32 v24, v78
M v[88:91], a[120:123], a[24:27], v[88:91]
 ds_read_b128 a[80:83], v7 offset:36864
 v_cvt_pk_bf16_f32 v46, v22, v23
M v[88:91], a[124:127], a[28:31], v[88:91]
 ds_read_b128 a[84:87], v7 offset:37888
 v_add_f32 v27, v23, v27
M v[92:95], a[124:127], a[60:63], v[36:39]
 v_exp_f32 v25, v79
M v[92:95], a[120:123], a[56:59], v[92:95]
 ds_read_b128 a[88:91], v7 offset:38912
 v_add_f32 v27, v24, v27
M v[92:95], a[116:119], a[52:55], v[92:95]
 ds_read_b128 a[92:95], v7 offset:39936
 v_cvt_pk_bf16_f32 v47, v24, v25
M v[92:95], a[112:115], a[48:51], v[92:95]
 v_add_f32 v27, v25, v27
 v_accvgpr_write_b32 a160, v132
M v[92:95], a[108:111], a[44:47], v[92:95]
 v_accvgpr_write_b32 a161, v133
 v_accvgpr_write_b32 a162, v134
M v[92:95], a[104:107], a[40:43], v[92:95]
 v_accvgpr_write_b32 a163, v135
 v_cvt_pk_bf16_f32 v144, v144, v145
M v[92:95], a[100:103], a[36:39], v[92:95]
 s_waitcnt lgkmcnt(0)
 v_cvt_pk_bf16_f32 v145, v146, v147
 v_cvt_pk_bf16_f32 v146, v152, v153
M v[92:95], a[96:99], a[32:35], v[92:95]
 v_cvt_pk_bf16_f32 v147, v154, v155
 v_accvgpr_write_b32 a132, v144
M v[96:99], a[64:67], a[0:3], v[32:35]
 s_add_u32 m0, s28, 98304
 ds_read_b128 a[96:99], v7 offset:40960
 v_accvgpr_write_b32 a133, v145
M v[96:99], a[68:71], a[4:7], v[96:99]
 ds_read_b128 a[100:103], v7 offset:41984
 v_accvgpr_write_b32 a134, v146
M v[96:99], a[72:75], a[8:11], v[96:99]
 buffer_load_dwordx4 v3, s[8:11], s21 offen offset:0 sc1 lds
M v[96:99], a[76:79], a[12:15], v[96:99]
 ds_read_b128 a[104:107], v7 offset:43008
 v_accvgpr_write_b32 a135, v147
M v[96:99], a[80:83], a[16:19], v[96:99]
 ds_read_b128 a[108:111], v7 offset:44032
 v_cvt_pk_bf16_f32 v148, v148, v149
M v[96:99], a[84:87], a[20:23], v[96:99]
 buffer_load_dwordx4 v3, s[8:11], s21 offen offset:1024 sc1 lds
M v[96:99], a[88:91], a[24:27], v[96:99]
 ds_read_b128 a[112:115], v7 offset:45056
 v_cvt_pk_bf16_f32 v149, v150, v151
M v[96:99], a[92:95], a[28:31], v[96:99]
 ds_read_b128 a[116:119], v7 offset:46080
 v_cvt_pk_bf16_f32 v150, v156, v157
M v[100:103], a[92:95], a[60:63], v[36:39]
 v_exp_f32 v18, v80
M v[100:103], a[88:91], a[56:59], v[100:103]
 ds_read_b128 a[120:123], v7 offset:47104
 v_cvt_pk_bf16_f32 v151, v158, v159
M v[100:103], a[84:87], a[52:55], v[100:103]
 ds_read_b128 a[124:127], v7 offset:48128
 v_accvgpr_write_b32 a164, v148
M v[100:103], a[80:83], a[48:51], v[100:103]
 buffer_load_dwordx4 v3, s[8:11], s21 offen offset:2048 sc1 lds
M v[100:103], a[76:79], a[44:47], v[100:103]
 v_exp_f32 v19, v81
M v[100:103], a[72:75], a[40:43], v[100:103]
 v_exp_f32 v20, v82
M v[100:103], a[68:71], a[36:39], v[100:103]
 v_exp_f32 v21, v83
M v[100:103], a[64:67], a[32:35], v[100:103]
 s_waitcnt lgkmcnt(0)
 v_exp_f32 v22, v88
M v[108:111], a[96:99], a[32:35], v[36:39]
 ds_read_b128 a[64:67], v7 offset:49152
 v_add_f32 v26, v18, v26
M v[108:111], a[100:103], a[36:39], v[108:111]
 ds_read_b128 a[68:71], v7 offset:50176
 v_cvt_pk_bf16_f32 v56, v18, v19
M v[108:111], a[104:107], a[40:43], v[108:111]
 buffer_load_dwordx4 v3, s[8:11], s21 offen offset:3072 sc1 lds
M v[108:111], a[108:111], a[44:47], v[108:111]
 s_add_u32 m0, s28, 102400
 ds_read_b128 a[72:75], v7 offset:51200
 v_add_f32 v26, v19, v26
M v[108:111], a[112:115], a[48:51], v[108:111]
 ds_read_b128 a[76:79], v7 offset:52224
 v_add_f32 v26, v20, v26
M v[108:111], a[116:119], a[52:55], v[108:111]
 buffer_load_dwordx4 v4, s[8:11], s21 offen offset:0 sc1 lds
M v[108:111], a[120:123], a[56:59], v[108:111]
 ds_read_b128 a[80:83], v7 offset:53248
 v_cvt_pk_bf16_f32 v57, v20, v21
M v[108:111], a[124:127], a[60:63], v[108:111]
 ds_read_b128 a[84:87], v7 offset:54272
 v_add_f32 v26, v21, v26
M v[104:107], a[124:127], a[28:31], v[32:35]
 v_exp_f32 v23, v89
M v[104:107], a[120:123], a[24:27], v[104:107]
 ds_read_b128 a[88:91], v7 offset:55296
 v_add_f32 v26, v22, v26
M v[104:107], a[116:119], a[20:23], v[104:107]
 ds_read_b128 a[92:95], v7 offset:56320
 v_cvt_pk_bf16_f32 v58, v22, v23
M v[104:107], a[112:115], a[16:19], v[104:107]
 buffer_load_dwordx4 v4, s[8:11], s21 offen offset:1024 sc1 lds
M v[104:107], a[108:111], a[12:15], v[104:107]
 v_exp_f32 v24, v90
M v[104:107], a[104:107], a[8:11], v[104:107]
 v_exp_f32 v25, v91
M v[104:107], a[100:103], a[4:7], v[104:107]
 buffer_load_dwordx4 v4, s[8:11], s21 offen offset:2048 sc1 lds
M v[104:107], a[96:99], a[0:3], v[104:107]
 s_waitcnt lgkmcnt(0)
 v_exp_f32 v18, v84
M v[112:115], a[64:67], a[0:3], v[32:35]
 ds_read_b128 a[96:99], v7 offset:57344
 v_add_f32 v26, v23, v26
M v[112:115], a[68:71], a[4:7], v[112:115]
 ds_read_b128 a[100:103], v7 offset:58368
 v_add_f32 v26, v24, v26
M v[112:115], a[72:75], a[8:11], v[112:115]
 v_exp_f32 v19, v85
M v[112:115], a[76:79], a[12:15], v[112:115]
 ds_read_b128 a[104:107], v7 offset:59392
 v_cvt_pk_bf16_f32 v59, v24, v25
M v[112:115], a[80:83], a[16:19], v[112:115]
 ds_read_b128 a[108:111], v7 offset:60416
 v_add_f32 v26, v25, v26
M v[112:115], a[84:87], a[20:23], v[112:115]
 buffer_load_dwordx4 v4, s[8:11], s21 offen offset:3072 sc1 lds
M v[112:115], a[88:91], a[24:27], v[112:115]
 s_add_u32 s24, s23, 16777216
 ds_read_b128 a[112:115], v7 offset:61440
 v_add_f32 v27, v18, v27
M v[112:115], a[92:95], a[28:31], v[112:115]
 s_mov_b32 s23, s21
 ds_read_b128 a[116:119], v7 offset:62464
 v_cvt_pk_bf16_f32 v60, v18, v19
M v[116:119], a[92:95], a[60:63], v[36:39]
 s_add_u32 s21, s21, 32768
 v_exp_f32 v20, v86
M v[116:119], a[88:91], a[56:59], v[116:119]
 s_add_u32 s22, s22, 1
 ds_read_b128 a[120:123], v7 offset:63488
 v_add_f32 v27, v19, v27
M v[116:119], a[84:87], a[52:55], v[116:119]
 s_cmp_eq_u32 s22, s25
 ds_read_b128 a[124:127], v7 offset:64512
 v_accvgpr_write_b32 a165, v149
M v[116:119], a[80:83], a[48:51], v[116:119]
 s_cselect_b32 s21, s26, s21
 v_exp_f32 v21, v87
M v[116:119], a[76:79], a[44:47], v[116:119]
 s_cmp_eq_u32 s22, s43
 v_exp_f32 v22, v92
M v[116:119], a[72:75], a[40:43], v[116:119]
 s_cselect_b32 s21, s4, s21
 v_exp_f32 v23, v93
M v[116:119], a[68:71], a[36:39], v[116:119]
 s_waitcnt vmcnt(8) lgkmcnt(0)
 v_add_f32 v27, v20, v27
 v_cvt_pk_bf16_f32 v61, v20, v21
M v[116:119], a[64:67], a[32:35], v[116:119]
 s_barrier
M v[124:127], a[96:99], a[32:35], v[36:39]
 s_cmp_eq_u32 s22, s6
 ds_read_b128 a[64:67], v2 offset:0
 v_add_f32 v27, v21, v27
M v[124:127], a[100:103], a[36:39], v[124:127]
 s_cselect_b32 s21, s7, s21
 ds_read_b128 a[68:71], v2 offset:1024
 v_add_f32 v27, v22, v27
M v[124:127], a[104:107], a[40:43], v[124:127]
 v_exp_f32 v24, v94
M v[124:127], a[108:111], a[44:47], v[124:127]
 ds_read_b128 a[72:75], v2 offset:2048
 v_cvt_pk_bf16_f32 v62, v22, v23
M v[124:127], a[112:115], a[48:51], v[124:127]
 ds_read_b128 a[76:79], v2 offset:3072
 v_add_f32 v27, v23, v27
M v[124:127], a[116:119], a[52:55], v[124:127]
 v_exp_f32 v25, v95
M v[124:127], a[120:123], a[56:59], v[124:127]
 ds_read_b128 a[80:83], v2 offset:4096
 v_add_f32 v27, v24, v27
M v[124:127], a[124:127], a[60:63], v[124:127]
 ds_read_b128 a[84:87], v2 offset:5120
 v_cvt_pk_bf16_f32 v63, v24, v25
M v[120:123], a[124:127], a[28:31], v[32:35]
 v_add_f32 v27, v25, v27
 v_accvgpr_write_b32 a166, v150
M v[120:123], a[120:123], a[24:27], v[120:123]
 ds_read_b128 a[88:91], v2 offset:6144
 v_max_f32 v10, v26, v27
M v[120:123], a[116:119], a[20:23], v[120:123]
 ds_read_b128 a[92:95], v2 offset:7168
 v_min_f32 v11, v26, v27
M v[120:123], a[112:115], a[16:19], v[120:123]
 v_cmp_lt_f32 s[36:37], s31, v10
 v_accvgpr_write_b32 a167, v151
M v[120:123], a[108:111], a[12:15], v[120:123]
 v_cmp_gt_f32 vcc, s55, v11
 v_cvt_pk_bf16_f32 v160, v160, v161
M v[120:123], a[104:107], a[8:11], v[120:123]
 v_cvt_pk_bf16_f32 v161, v162, v163
 v_cvt_pk_bf16_f32 v162, v168, v169
M v[120:123], a[100:103], a[4:7], v[120:123]
 s_waitcnt lgkmcnt(0)
 s_or_b64 vcc, vcc, s[36:37]
M v[120:123], a[96:99], a[0:3], v[120:123]
 s_cbranch_vccnz L_st11
L_rt11:
 v_cvt_pk_bf16_f32 v163, v170, v171
 v_accvgpr_write_b32 a136, v160
 v_accvgpr_write_b32 a137, v161
 v_accvgpr_write_b32 a138, v162
 v_accvgpr_write_b32 a139, v163
 v_cvt_pk_bf16_f32 v164, v164, v165
 v_cvt_pk_bf16_f32 v165, v166, v167
 v_cvt_pk_bf16_f32 v166, v172, v173
 v_cvt_pk_bf16_f32 v167, v174, v175
 v_accvgpr_write_b32 a168, v164
 v_accvgpr_write_b32 a169, v165
 v_accvgpr_write_b32 a170, v166
 v_accvgpr_write_b32 a171, v167
 v_cvt_pk_bf16_f32 v176, v176, v177
 v_cvt_pk_bf16_f32 v177, v178, v179
 v_cvt_pk_bf16_f32 v178, v184, v185
 v_cvt_pk_bf16_f32 v179, v186, v187
 v_accvgpr_write_b32 a140, v176
 v_accvgpr_write_b32 a141, v177
 v_accvgpr_write_b32 a142, v178
 v_accvgpr_write_b32 a143, v179
 v_cvt_pk_bf16_f32 v180, v180, v181
 v_cvt_pk_bf16_f32 v181, v182, v183
 v_cvt_pk_bf16_f32 v182, v188, v189
 v_cvt_pk_bf16_f32 v183, v190, v191
 v_accvgpr_write_b32 a172, v180
 v_accvgpr_write_b32 a173, v181
 v_accvgpr_write_b32 a174, v182
 v_accvgpr_write_b32 a175, v183
 v_cvt_pk_bf16_f32 v192, v192, v193
 v_cvt_pk_bf16_f32 v193, v194, v195
 v_cvt_pk_bf16_f32 v194, v200, v201
 v_cvt_pk_bf16_f32 v195, v202, v203
 v_accvgpr_write_b32 a144, v192
 v_accvgpr_write_b32 a145, v193
 v_accvgpr_write_b32 a146, v194
 v_accvgpr_write_b32 a147, v195
 v_cvt_pk_bf16_f32 v196, v196, v197
 v_cvt_pk_bf16_f32 v197, v198, v199
 v_cvt_pk_bf16_f32 v198, v204, v205
 v_cvt_pk_bf16_f32 v199, v206, v207
 v_accvgpr_write_b32 a176, v196
 v_accvgpr_write_b32 a177, v197
 v_accvgpr_write_b32 a178, v198
 v_accvgpr_write_b32 a179, v199
 v_cvt_pk_bf16_f32 v208, v208, v209
 v_cvt_pk_bf16_f32 v209, v210, v211
 v_cvt_pk_bf16_f32 v210, v216, v217
 v_cvt_pk_bf16_f32 v211, v218, v219
 v_accvgpr_write_b32 a148, v208
 v_accvgpr_write_b32 a149, v209
 v_accvgpr_write_b32 a150, v210
 v_accvgpr_write_b32 a151, v211
 v_cvt_pk_bf16_f32 v212, v212, v213
 v_cvt_pk_bf16_f32 v213, v214, v215
 v_cvt_pk_bf16_f32 v214, v220, v221
 v_cvt_pk_bf16_f32 v215, v222, v223
 v_accvgpr_write_b32 a180, v212
 v_accvgpr_write_b32 a181, v213
 v_accvgpr_write_b32 a182, v214
 v_accvgpr_write_b32 a183, v215
 v_cvt_pk_bf16_f32 v224, v224, v225
 v_cvt_pk_bf16_f32 v225, v226, v227
 v_cvt_pk_bf16_f32 v226, v232, v233
 v_cvt_pk_bf16_f32 v227, v234, v235
 v_accvgpr_write_b32 a152, v224
 v_accvgpr_write_b32 a153, v225
 v_accvgpr_write_b32 a154, v226
 v_accvgpr_write_b32 a155, v227
 v_cvt_pk_bf16_f32 v228, v228, v229
 v_cvt_pk_bf16_f32 v229, v230, v231
 v_cvt_pk_bf16_f32 v230, v236, v237
 v_cvt_pk_bf16_f32 v231, v238, v239
 v_accvgpr_write_b32 a184, v228
 v_accvgpr_write_b32 a185, v229
 v_accvgpr_write_b32 a186, v230
 v_accvgpr_write_b32 a187, v231
M v[128:131], a[64:67], v[40:43], 0
 s_add_u32 m0, s28, 0
 ds_read_b128 a[96:99], v2 offset:8192
 ds_read_b128 a[100:103], v2 offset:9216
M v[128:131], a[68:71], v[56:59], v[128:131]
 buffer_load_dwordx4 v3, s[8:11], s24 offen offset:0 sc1 lds
M v[132:135], a[68:71], v[60:63], 0
 v_cvt_pk_bf16_f32 v240, v240, v241
 v_cvt_pk_bf16_f32 v241, v242, v243
M v[132:135], a[64:67], v[44:47], v[132:135]
 ds_read_b128 a[104:107], v2 offset:10240
 ds_read_b128 a[108:111], v2 offset:11264
M v[140:143], a[72:75], v[44:47], 0
 buffer_load_dwordx4 v3, s[8:11], s24 offen offset:1024 sc1 lds
M v[140:143], a[76:79], v[60:63], v[140:143]
 v_cvt_pk_bf16_f32 v242, v248, v249
 v_cvt_pk_bf16_f32 v243, v250, v251
M v[136:139], a[76:79], v[56:59], 0
 ds_read_b128 a[112:115], v2 offset:12288
 ds_read_b128 a[116:119], v2 offset:13312
M v[136:139], a[72:75], v[40:43], v[136:139]
 buffer_load_dwordx4 v3, s[8:11], s24 offen offset:2048 sc1 lds
M v[144:147], a[80:83], v[40:43], 0
 v_accvgpr_write_b32 a156, v240
 v_accvgpr_write_b32 a157, v241
M v[144:147], a[84:87], v[56:59], v[144:147]
 ds_read_b128 a[120:123], v2 offset:14336
 ds_read_b128 a[124:127], v2 offset:15360
M v[148:151], a[84:87], v[60:63], 0
 buffer_load_dwordx4 v3, s[8:11], s24 offen offset:3072 sc1 lds
M v[148:151], a[80:83], v[44:47], v[148:151]
 s_add_u32 m0, s28, 4096
 v_accvgpr_write_b32 a158, v242
 v_accvgpr_write_b32 a159, v243
M v[156:159], a[88:91], v[44:47], 0
 buffer_load_dwordx4 v4, s[8:11], s24 offen offset:0 sc1 lds
M v[156:159], a[92:95], v[60:63], v[156:159]
 v_cvt_pk_bf16_f32 v244, v244, v245
 v_cvt_pk_bf16_f32 v245, v246, v247
M v[152:155], a[92:95], v[56:59], 0
 v_cvt_pk_bf16_f32 v246, v252, v253
 v_cvt_pk_bf16_f32 v247, v254, v255
M v[152:155], a[88:91], v[40:43], v[152:155]
 s_waitcnt lgkmcnt(0)
 v_accvgpr_write_b32 a188, v244
 v_accvgpr_write_b32 a189, v245
M v[160:163], a[96:99], v[40:43], 0
 ds_read_b128 a[64:67], v2 offset:16384
 ds_read_b128 a[68:71], v2 offset:17408
M v[160:163], a[100:103], v[56:59], v[160:163]
 buffer_load_dwordx4 v4, s[8:11], s24 offen offset:1024 sc1 lds
M v[164:167], a[100:103], v[60:63], 0
 v_accvgpr_write_b32 a190, v246
 v_accvgpr_write_b32 a191, v247
M v[164:167], a[96:99], v[44:47], v[164:167]
 ds_read_b128 a[72:75], v2 offset:18432
 ds_read_b128 a[76:79], v2 offset:19456
M v[172:175], a[104:107], v[44:47], 0
 buffer_load_dwordx4 v4, s[8:11], s24 offen offset:2048 sc1 lds
M v[172:175], a[108:111], v[60:63], v[172:175]
 v_exp_f32 v18, v96
M v[168:171], a[108:111], v[56:59], 0
 ds_read_b128 a[80:83], v2 offset:20480
 ds_read_b128 a[84:87], v2 offset:21504
M v[168:171], a[104:107], v[40:43], v[168:171]
 buffer_load_dwordx4 v4, s[8:11], s24 offen offset:3072 sc1 lds
M v[176:179], a[112:115], v[40:43], 0
 v_exp_f32 v19, v97
M v[176:179], a[116:119], v[56:59], v[176:179]
 s_add_u32 m0, s28, 32768
 ds_read_b128 a[88:91], v2 offset:22528
 ds_read_b128 a[92:95], v2 offset:23552
M v[180:183], a[116:119], v[60:63], 0
 buffer_load_dwordx4 v3, s[8:11], s21 offen offset:0 sc1 lds
M v[180:183], a[112:115], v[44:47], v[180:183]
 v_exp_f32 v20, v98
M v[188:191], a[120:123], v[44:47], 0
 buffer_load_dwordx4 v3, s[8:11], s21 offen offset:1024 sc1 lds
M v[188:191], a[124:127], v[60:63], v[188:191]
 v_exp_f32 v21, v99
M v[184:187], a[124:127], v[56:59], 0
 buffer_load_dwordx4 v3, s[8:11], s21 offen offset:2048 sc1 lds
M v[184:187], a[120:123], v[40:43], v[184:187]
 s_waitcnt lgkmcnt(0)
 v_exp_f32 v22, v104
M v[192:195], a[64:67], v[40:43], 0
 ds_read_b128 a[96:99], v2 offset:24576
 ds_read_b128 a[100:103], v2 offset:25600
M v[192:195], a[68:71], v[56:59], v[192:195]
 buffer_load_dwordx4 v3, s[8:11], s21 offen offset:3072 sc1 lds
M v[196:199], a[68:71], v[60:63], 0
 v_exp_f32 v23, v105
M v[196:199], a[64:67], v[44:47], v[196:199]
 s_add_u32 m0, s28, 36864
 ds_read_b128 a[104:107], v2 offset:26624
 ds_read_b128 a[108:111], v2 offset:27648
M v[204:207], a[72:75], v[44:47], 0
 buffer_load_dwordx4 v4, s[8:11], s21 offen offset:0 sc1 lds
M v[204:207], a[76:79], v[60:63], v[204:207]
 v_add_f32 v30, v26, v30
 v_add_f32 v31, v27, v31
M v[200:203], a[76:79], v[56:59], 0
 ds_read_b128 a[112:115], v2 offset:28672
 ds_read_b128 a[116:119], v2 offset:29696
M v[200:203], a[72:75], v[40:43], v[200:203]
 buffer_load_dwordx4 v4, s[8:11], s21 offen offset:1024 sc1 lds
M v[208:211], a[80:83], v[40:43], 0
 v_exp_f32 v24, v106
M v[208:211], a[84:87], v[56:59], v[208:211]
 ds_read_b128 a[120:123], v2 offset:30720
 ds_read_b128 a[124:127], v2 offset:31744
M v[212:215], a[84:87], v[60:63], 0
 buffer_load_dwordx4 v4, s[8:11], s21 offen offset:2048 sc1 lds
M v[212:215], a[80:83], v[44:47], v[212:215]
 v_exp_f32 v25, v107
M v[220:223], a[88:91], v[44:47], 0
 v_add_f32 v28, v18, v19
 v_cvt_pk_bf16_f32 v48, v18, v19
M v[220:223], a[92:95], v[60:63], v[220:223]
 buffer_load_dwordx4 v4, s[8:11], s21 offen offset:3072 sc1 lds
M v[216:219], a[92:95], v[56:59], 0
 s_waitcnt vmcnt(16) lgkmcnt(0)
 s_add_u32 s24, s23, 16777216
 s_mov_b32 s23, s21
M v[216:219], a[88:91], v[40:43], v[216:219]
 s_barrier
M v[224:227], a[96:99], v[40:43], 0
 ds_read_b128 a[64:67], v2 offset:32768
 ds_read_b128 a[68:71], v2 offset:33792
M v[224:227], a[100:103], v[56:59], v[224:227]
 s_add_u32 s21, s21, 32768
 v_add_f32 v28, v20, v28
M v[228:231], a[100:103], v[60:63], 0
 s_add_u32 s22, s22, 1
 v_exp_f32 v18, v100
M v[228:231], a[96:99], v[44:47], v[228:231]
 s_cmp_eq_u32 s22, s25
 ds_read_b128 a[72:75], v2 offset:34816
 ds_read_b128 a[76:79], v2 offset:35840
M v[236:239], a[104:107], v[44:47], 0
 s_cselect_b32 s21, s26, s21
 v_exp_f32 v19, v101
M v[236:239], a[108:111], v[60:63], v[236:239]
 s_cmp_eq_u32 s22, s43
 v_cvt_pk_bf16_f32 v49, v20, v21
 v_add_f32 v28, v21, v28
M v[232:235], a[108:111], v[56:59], 0
 s_cselect_b32 s21, s4, s21
 ds_read_b128 a[80:83], v2 offset:36864
 ds_read_b128 a[84:87], v2 offset:37888
M v[232:235], a[104:107], v[40:43], v[232:235]
 s_cmp_eq_u32 s22, s6
 v_exp_f32 v20, v102
M v[240:243], a[112:115], v[40:43], 0
 s_cselect_b32 s21, s7, s21
 v_exp_f32 v21, v103
M v[240:243], a[116:119], v[56:59], v[240:243]
 ds_read_b128 a[88:91], v2 offset:38912
 ds_read_b128 a[92:95], v2 offset:39936
M v[244:247], a[116:119], v[60:63], 0
 v_add_f32 v28, v22, v28
 v_cvt_pk_bf16_f32 v50, v22, v23
M v[244:247], a[112:115], v[44:47], v[244:247]
 v_add_f32 v28, v23, v28
 v_add_f32 v28, v24, v28
M v[252:255], a[120:123], v[44:47], 0
 v_exp_f32 v22, v108
M v[252:255], a[124:127], v[60:63], v[252:255]
 s_cmp_lg_u32 s27, 0
 v_exp_f32 v23, v109
M v[248:251], a[124:127], v[56:59], 0
 s_waitcnt lgkmcnt(0)
 v_cvt_pk_bf16_f32 v51, v24, v25
 v_add_f32 v28, v25, v28
M v[248:251], a[120:123], v[40:43], v[248:251]
 v_exp_f32 v24, v110
 v_add_f32 v29, v18, v19
 v_cvt_pk_bf16_f32 v52, v18, v19
 v_add_f32 v29, v20, v29
 v_cvt_pk_bf16_f32 v53, v20, v21
 v_add_f32 v29, v21, v29
 v_exp_f32 v25, v111
 v_add_f32 v29, v22, v29
 v_cvt_pk_bf16_f32 v54, v22, v23
 v_add_f32 v29, v23, v29
 v_add_f32 v29, v24, v29
 v_cvt_pk_bf16_f32 v55, v24, v25
 v_add_f32 v29, v25, v29
 s_cbranch_scc1 L_loop_top
L_final_h:
 s_waitcnt vmcnt(8)
 s_barrier
 ds_read_b128 a[64:67], v7 offset:0
 ds_read_b128 a[68:71], v7 offset:1024
 ds_read_b128 a[72:75], v7 offset:2048
 ds_read_b128 a[76:79], v7 offset:3072
 ds_read_b128 a[80:83], v7 offset:4096
 ds_read_b128 a[84:87], v7 offset:5120
 ds_read_b128 a[88:91], v7 offset:6144
 ds_read_b128 a[92:95], v7 offset:7168
 s_add_u32 m0, s28, 65536
 v_exp_f32 v18, v112
 buffer_load_dwordx4 v3, s[8:11], s38 offen offset:0 sc1 lds
 v_exp_f32 v19, v113
 v_exp_f32 v20, v114
 v_add_f32 v28, v18, v28
 v_cvt_pk_bf16_f32 v56, v18, v19
 buffer_load_dwordx4 v3, s[8:11], s38 offen offset:1024 sc1 lds
 v_exp_f32 v21, v115
 v_add_f32 v28, v19, v28
 v_exp_f32 v22, v120
 v_add_f32 v28, v20, v28
 v_cvt_pk_bf16_f32 v57, v20, v21
 buffer_load_dwordx4 v3, s[8:11], s38 offen offset:2048 sc1 lds
 v_exp_f32 v23, v121
 v_add_f32 v28, v21, v28
 v_exp_f32 v24, v122
 v_add_f32 v28, v22, v28
 v_cvt_pk_bf16_f32 v58, v22, v23
 buffer_load_dwordx4 v3, s[8:11], s38 offen offset:3072 sc1 lds
 v_exp_f32 v25, v123
 v_add_f32 v28, v23, v28
 v_exp_f32 v18, v116
 v_add_f32 v28, v24, v28
 s_add_u32 m0, s28, 69632
 v_cvt_pk_bf16_f32 v59, v24, v25
 buffer_load_dwordx4 v4, s[8:11], s38 offen offset:0 sc1 lds
 v_exp_f32 v19, v117
 v_add_f32 v28, v25, v28
 v_exp_f32 v20, v118
 v_add_f32 v29, v18, v29
 v_cvt_pk_bf16_f32 v60, v18, v19
 buffer_load_dwordx4 v4, s[8:11], s38 offen offset:1024 sc1 lds
 v_exp_f32 v21, v119
 v_add_f32 v29, v19, v29
 v_exp_f32 v22, v124
 v_add_f32 v29, v20, v29
 v_cvt_pk_bf16_f32 v61, v20, v21
 buffer_load_dwordx4 v4, s[8:11], s38 offen offset:2048 sc1 lds
 v_exp_f32 v23, v125
 v_add_f32 v29, v21, v29
 v_exp_f32 v24, v126
 v_add_f32 v29, v22, v29
 v_cvt_pk_bf16_f32 v62, v22, v23
 buffer_load_dwordx4 v4, s[8:11], s38 offen offset:3072 sc1 lds
 s_add_u32 s38, s38, 32768
 v_exp_f32 v25, v127
 v_add_f32 v29, v23, v29
 v_add_f32 v29, v24, v29
 v_cvt_pk_bf16_f32 v63, v24, v25
 v_add_f32 v29, v25, v29
 v_max_f32 v10, v28, v29
 v_cmp_lt_f32 vcc, s31, v10
 s_nop 0
 s_cbranch_vccnz L_st4
L_rt4:
 v_add_f32 v30, v28, v30
 v_add_f32 v31, v29, v31
 v_mov_b32 v12, v32
 v_mov_b32 v13, v36
 v_mov_b32 v14, v30
 v_mov_b32 v15, v31
 buffer_store_dwordx4 v[12:15], v7, s[8:11], s52 offen sc1
 s_waitcnt lgkmcnt(0)
M v[128:131], a[64:67], v[48:51], v[128:131]
 ds_read_b128 a[96:99], v7 offset:8192
M v[128:131], a[68:71], v[56:59], v[128:131]
 ds_read_b128 a[100:103], v7 offset:9216
M v[132:135], a[68:71], v[60:63], v[132:135]
M v[132:135], a[64:67], v[52:55], v[132:135]
 ds_read_b128 a[104:107], v7 offset:10240
M v[140:143], a[72:75], v[52:55], v[140:143]
 ds_read_b128 a[108:111], v7 offset:11264
M v[140:143], a[76:79], v[60:63], v[140:143]
M v[136:139], a[76:79], v[56:59], v[136:139]
 ds_read_b128 a[112:115], v7 offset:12288
M v[136:139], a[72:75], v[48:51], v[136:139]
 ds_read_b128 a[116:119], v7 offset:13312
M v[144:147], a[80:83], v[48:51], v[144:147]
M v[144:147], a[84:87], v[56:59], v[144:147]
 ds_read_b128 a[120:123], v7 offset:14336
M v[148:151], a[84:87], v[60:63], v[148:151]
 ds_read_b128 a[124:127], v7 offset:15360
M v[148:151], a[80:83], v[52:55], v[148:151]
 v_cvt_pk_bf16_f32 v128, v128, v129
 v_cvt_pk_bf16_f32 v129, v130, v131
M v[156:159], a[88:91], v[52:55], v[156:159]
 v_cvt_pk_bf16_f32 v130, v136, v137
 v_cvt_pk_bf16_f32 v131, v138, v139
M v[156:159], a[92:95], v[60:63], v[156:159]
 buffer_store_dwordx4 v[128:131], v7, s[8:11], s12 offen offset:0 sc1
M v[152:155], a[92:95], v[56:59], v[152:155]
 v_cvt_pk_bf16_f32 v132, v132, v133
 v_cvt_pk_bf16_f32 v133, v134, v135
M v[152:155], a[88:91], v[48:51], v[152:155]
 s_waitcnt lgkmcnt(0)
 v_cvt_pk_bf16_f32 v134, v140, v141
 v_cvt_pk_bf16_f32 v135, v142, v143
M v[160:163], a[96:99], v[48:51], v[160:163]
 ds_read_b128 a[64:67], v7 offset:16384
M v[160:163], a[100:103], v[56:59], v[160:163]
 ds_read_b128 a[68:71], v7 offset:17408
M v[164:167], a[100:103], v[60:63], v[164:167]
 buffer_store_dwordx4 v[132:135], v7, s[8:11], s14 offen offset:0 sc1
M v[164:167], a[96:99], v[52:55], v[164:167]
 ds_read_b128 a[72:75], v7 offset:18432
 v_cvt_pk_bf16_f32 v144, v144, v145
M v[172:175], a[104:107], v[52:55], v[172:175]
 ds_read_b128 a[76:79], v7 offset:19456
 v_cvt_pk_bf16_f32 v145, v146, v147
M v[172:175], a[108:111], v[60:63], v[172:175]
 v_cvt_pk_bf16_f32 v146, v152, v153
 v_cvt_pk_bf16_f32 v147, v154, v155
M v[168:171], a[108:111], v[56:59], v[168:171]
 ds_read_b128 a[80:83], v7 offset:20480
M v[168:171], a[104:107], v[48:51], v[168:171]
 ds_read_b128 a[84:87], v7 offset:21504
M v[176:179], a[112:115], v[48:51], v[176:179]
 buffer_store_dwordx4 v[144:147], v7, s[8:11], s12 offen offset:1024 sc1
M v[176:179], a[116:119], v[56:59], v[176:179]
 ds_read_b128 a[88:91], v7 offset:22528
 v_cvt_pk_bf16_f32 v148, v148, v149
M v[180:183], a[116:119], v[60:63], v[180:183]
 ds_read_b128 a[92:95], v7 offset:23552
 v_cvt_pk_bf16_f32 v149, v150, v151
M v[180:183], a[112:115], v[52:55], v[180:183]
 v_cvt_pk_bf16_f32 v150, v156, v157
 v_cvt_pk_bf16_f32 v151, v158, v159
M v[188:191], a[120:123], v[52:55], v[188:191]
 buffer_store_dwordx4 v[148:151], v7, s[8:11], s14 offen offset:1024 sc1
M v[188:191], a[124:127], v[60:63], v[188:191]
 v_cvt_pk_bf16_f32 v160, v160, v161
 v_cvt_pk_bf16_f32 v161, v162, v163
M v[184:187], a[124:127], v[56:59], v[184:187]
 v_cvt_pk_bf16_f32 v162, v168, v169
 v_cvt_pk_bf16_f32 v163, v170, v171
M v[184:187], a[120:123], v[48:51], v[184:187]
 s_waitcnt lgkmcnt(0)
M v[192:195], a[64:67], v[48:51], v[192:195]
 ds_read_b128 a[96:99], v7 offset:24576
M v[192:195], a[68:71], v[56:59], v[192:195]
 ds_read_b128 a[100:103], v7 offset:25600
M v[196:199], a[68:71], v[60:63], v[196:199]
 buffer_store_dwordx4 v[160:163], v7, s[8:11], s12 offen offset:2048 sc1
M v[196:199], a[64:67], v[52:55], v[196:199]
 ds_read_b128 a[104:107], v7 offset:26624
 v_cvt_pk_bf16_f32 v164, v164, v165
M v[204:207], a[72:75], v[52:55], v[204:207]
 ds_read_b128 a[108:111], v7 offset:27648
 v_cvt_pk_bf16_f32 v165, v166, v167
M v[204:207], a[76:79], v[60:63], v[204:207]
 v_cvt_pk_bf16_f32 v166, v172, v173
 v_cvt_pk_bf16_f32 v167, v174, v175
M v[200:203], a[76:79], v[56:59], v[200:203]
 ds_read_b128 a[112:115], v7 offset:28672
M v[200:203], a[72:75], v[48:51], v[200:203]
 ds_read_b128 a[116:119], v7 offset:29696
M v[208:211], a[80:83], v[48:51], v[208:211]
 buffer_store_dwordx4 v[164:167], v7, s[8:11], s14 offen offset:2048 sc1
M v[208:211], a[84:87], v[56:59], v[208:211]
 ds_read_b128 a[120:123], v7 offset:30720
 v_cvt_pk_bf16_f32 v176, v176, v177
M v[212:215], a[84:87], v[60:63], v[212:215]
 ds_read_b128 a[124:127], v7 offset:31744
 v_cvt_pk_bf16_f32 v177, v178, v179
M v[212:215], a[80:83], v[52:55], v[212:215]
 v_cvt_pk_bf16_f32 v178, v184, v185
 v_cvt_pk_bf16_f32 v179, v186, v187
M v[220:223], a[88:91], v[52:55], v[220:223]
 buffer_store_dwordx4 v[176:179], v7, s[8:11], s12 offen offset:3072 sc1
M v[220:223], a[92:95], v[60:63], v[220:223]
 v_cvt_pk_bf16_f32 v180, v180, v181
 v_cvt_pk_bf16_f32 v181, v182, v183
M v[216:219], a[92:95], v[56:59], v[216:219]
 s_waitcnt lgkmcnt(0)
 v_cvt_pk_bf16_f32 v182, v188, v189
 v_cvt_pk_bf16_f32 v183, v190, v191
M v[216:219], a[88:91], v[48:51], v[216:219]
 s_barrier
M v[224:227], a[96:99], v[48:51], v[224:227]
 ds_read_b128 a[64:67], v2 offset:32768
M v[224:227], a[100:103], v[56:59], v[224:227]
 ds_read_b128 a[68:71], v2 offset:33792
M v[228:231], a[100:103], v[60:63], v[228:231]
 buffer_store_dwordx4 v[180:183], v7, s[8:11], s14 offen offset:3072 sc1
M v[228:231], a[96:99], v[52:55], v[228:231]
 ds_read_b128 a[72:75], v2 offset:34816
 v_cvt_pk_bf16_f32 v192, v192, v193
M v[236:239], a[104:107], v[52:55], v[236:239]
 ds_read_b128 a[76:79], v2 offset:35840
 v_cvt_pk_bf16_f32 v193, v194, v195
M v[236:239], a[108:111], v[60:63], v[236:239]
 v_cvt_pk_bf16_f32 v194, v200, v201
 v_cvt_pk_bf16_f32 v195, v202, v203
M v[232:235], a[108:111], v[56:59], v[232:235]
 ds_read_b128 a[80:83], v2 offset:36864
M v[232:235], a[104:107], v[48:51], v[232:235]
 ds_read_b128 a[84:87], v2 offset:37888
M v[240:243], a[112:115], v[48:51], v[240:243]
 buffer_store_dwordx4 v[192:195], v7, s[8:11], s13 offen offset:0 sc1
M v[240:243], a[116:119], v[56:59], v[240:243]
 ds_read_b128 a[88:91], v2 offset:38912
 v_cvt_pk_bf16_f32 v196, v196, v197
M v[244:247], a[116:119], v[60:63], v[244:247]
 ds_read_b128 a[92:95], v2 offset:39936
 v_cvt_pk_bf16_f32 v197, v198, v199
M v[244:247], a[112:115], v[52:55], v[244:247]
 v_cvt_pk_bf16_f32 v198, v204, v205
 v_cvt_pk_bf16_f32 v199, v206, v207
M v[252:255], a[120:123], v[52:55], v[252:255]
 buffer_store_dwordx4 v[196:199], v7, s[8:11], s15 offen offset:0 sc1
M v[252:255], a[124:127], v[60:63], v[252:255]
 v_cvt_pk_bf16_f32 v208, v208, v209
 v_cvt_pk_bf16_f32 v209, v210, v211
M v[248:251], a[124:127], v[56:59], v[248:251]
 s_waitcnt lgkmcnt(0)
 v_cvt_pk_bf16_f32 v210, v216, v217
 v_cvt_pk_bf16_f32 v211, v218, v219
M v[248:251], a[120:123], v[48:51], v[248:251]
 buffer_store_dwordx4 v[208:211], v7, s[8:11], s13 offen offset:1024 sc1
 v_cvt_pk_bf16_f32 v212, v212, v213
 v_cvt_pk_bf16_f32 v213, v214, v215
 v_cvt_pk_bf16_f32 v214, v220, v221
 v_cvt_pk_bf16_f32 v215, v222, v223
 buffer_store_dwordx4 v[212:215], v7, s[8:11], s15 offen offset:1024 sc1
 v_cvt_pk_bf16_f32 v224, v224, v225
 v_cvt_pk_bf16_f32 v225, v226, v227
 v_cvt_pk_bf16_f32 v226, v232, v233
 v_cvt_pk_bf16_f32 v227, v234, v235
 buffer_store_dwordx4 v[224:227], v7, s[8:11], s13 offen offset:2048 sc1
 v_cvt_pk_bf16_f32 v228, v228, v229
 v_cvt_pk_bf16_f32 v229, v230, v231
 v_cvt_pk_bf16_f32 v230, v236, v237
 v_cvt_pk_bf16_f32 v231, v238, v239
 buffer_store_dwordx4 v[228:231], v7, s[8:11], s15 offen offset:2048 sc1
 v_cvt_pk_bf16_f32 v240, v240, v241
 v_cvt_pk_bf16_f32 v241, v242, v243
 v_cvt_pk_bf16_f32 v242, v248, v249
 v_cvt_pk_bf16_f32 v243, v250, v251
 buffer_store_dwordx4 v[240:243], v7, s[8:11], s13 offen offset:3072 sc1
 v_cvt_pk_bf16_f32 v244, v244, v245
 v_cvt_pk_bf16_f32 v245, v246, v247
 v_cvt_pk_bf16_f32 v246, v252, v253
 v_cvt_pk_bf16_f32 v247, v254, v255
 buffer_store_dwordx4 v[244:247], v7, s[8:11], s15 offen offset:3072 sc1
M v[64:67], a[64:67], a[128:131], 0
 ds_read_b128 a[96:99], v2 offset:40960
M v[64:67], a[68:71], a[132:135], v[64:67]
 s_add_u32 m0, s28, 0
 ds_read_b128 a[100:103], v2 offset:41984
M v[64:67], a[72:75], a[136:139], v[64:67]
 buffer_load_dwordx4 v3, s[8:11], s38 offen offset:0 sc1 lds
M v[64:67], a[76:79], a[140:143], v[64:67]
 ds_read_b128 a[104:107], v2 offset:43008
 v_accvgpr_read_b32 v5, a192
M v[64:67], a[80:83], a[144:147], v[64:67]
 ds_read_b128 a[108:111], v2 offset:44032
 v_accvgpr_read_b32 v6, a193
M v[64:67], a[84:87], a[148:151], v[64:67]
 buffer_load_dwordx4 v3, s[8:11], s38 offen offset:1024 sc1 lds
M v[64:67], a[88:91], a[152:155], v[64:67]
 ds_read_b128 a[112:115], v2 offset:45056
M v[64:67], a[92:95], a[156:159], v[64:67]
 ds_read_b128 a[116:119], v2 offset:46080
M v[68:71], a[92:95], a[188:191], 0
 buffer_load_dwordx4 v3, s[8:11], s38 offen offset:2048 sc1 lds
M v[68:71], a[88:91], a[184:187], v[68:71]
 ds_read_b128 a[120:123], v2 offset:47104
M v[68:71], a[84:87], a[180:183], v[68:71]
 ds_read_b128 a[124:127], v2 offset:48128
M v[68:71], a[80:83], a[176:179], v[68:71]
M v[68:71], a[76:79], a[172:175], v[68:71]
 buffer_load_dwordx4 v3, s[8:11], s38 offen offset:3072 sc1 lds
M v[68:71], a[72:75], a[168:171], v[68:71]
M v[68:71], a[68:71], a[164:167], v[68:71]
M v[68:71], a[64:67], a[160:163], v[68:71]
 s_waitcnt lgkmcnt(0)
M v[76:79], a[96:99], a[160:163], 0
 ds_read_b128 a[64:67], v2 offset:49152
M v[76:79], a[100:103], a[164:167], v[76:79]
 s_add_u32 m0, s28, 4096
 ds_read_b128 a[68:71], v2 offset:50176
M v[76:79], a[104:107], a[168:171], v[76:79]
 buffer_load_dwordx4 v4, s[8:11], s38 offen offset:0 sc1 lds
M v[76:79], a[108:111], a[172:175], v[76:79]
 ds_read_b128 a[72:75], v2 offset:51200
M v[76:79], a[112:115], a[176:179], v[76:79]
 s_xor_b32 s47, s47, 64
 ds_read_b128 a[76:79], v2 offset:52224
M v[76:79], a[116:119], a[180:183], v[76:79]
 v_mov_b32 v18, 1
 v_min_u32 v19, 1, v7
M v[76:79], a[120:123], a[184:187], v[76:79]
 ds_read_b128 a[80:83], v2 offset:53248
 v_lshlrev_b32 v19, 29, v19
M v[76:79], a[124:127], a[188:191], v[76:79]
 s_waitcnt vmcnt(5)
 ds_read_b128 a[84:87], v2 offset:54272
M v[72:75], a[124:127], a[156:159], 0
 buffer_store_dword v18, v19, s[8:11], s47 offen sc1
M v[72:75], a[120:123], a[152:155], v[72:75]
 ds_read_b128 a[88:91], v2 offset:55296
M v[72:75], a[116:119], a[148:151], v[72:75]
 ds_read_b128 a[92:95], v2 offset:56320
M v[72:75], a[112:115], a[144:147], v[72:75]
 buffer_load_dwordx4 v4, s[8:11], s38 offen offset:1024 sc1 lds
M v[72:75], a[108:111], a[140:143], v[72:75]
M v[72:75], a[104:107], a[136:139], v[72:75]
 buffer_load_dwordx4 v4, s[8:11], s38 offen offset:2048 sc1 lds
M v[72:75], a[100:103], a[132:135], v[72:75]
M v[72:75], a[96:99], a[128:131], v[72:75]
 s_waitcnt lgkmcnt(0)
M v[80:83], a[64:67], a[128:131], 0
 ds_read_b128 a[96:99], v2 offset:57344
M v[80:83], a[68:71], a[132:135], v[80:83]
 ds_read_b128 a[100:103], v2 offset:58368
M v[80:83], a[72:75], a[136:139], v[80:83]
 buffer_load_dwordx4 v4, s[8:11], s38 offen offset:3072 sc1 lds
M v[80:83], a[76:79], a[140:143], v[80:83]
 s_add_u32 s38, s38, 32768
 ds_read_b128 a[104:107], v2 offset:59392
M v[80:83], a[80:83], a[144:147], v[80:83]
 s_add_u32 m0, s28, 131072
 ds_read_b128 a[108:111], v2 offset:60416
M v[80:83], a[84:87], a[148:151], v[80:83]
 buffer_load_dwordx4 v3, s[8:11], s38 offen offset:0 sc1 lds
M v[80:83], a[88:91], a[152:155], v[80:83]
 ds_read_b128 a[112:115], v2 offset:61440
M v[80:83], a[92:95], a[156:159], v[80:83]
 ds_read_b128 a[116:119], v2 offset:62464
M v[84:87], a[92:95], a[188:191], 0
 buffer_load_dwordx4 v3, s[8:11], s38 offen offset:1024 sc1 lds
M v[84:87], a[88:91], a[184:187], v[84:87]
 ds_read_b128 a[120:123], v2 offset:63488
M v[84:87], a[84:87], a[180:183], v[84:87]
 ds_read_b128 a[124:127], v2 offset:64512
M v[84:87], a[80:83], a[176:179], v[84:87]
 buffer_load_dwordx4 v3, s[8:11], s38 offen offset:2048 sc1 lds
M v[84:87], a[76:79], a[172:175], v[84:87]
M v[84:87], a[72:75], a[168:171], v[84:87]
 buffer_load_dwordx4 v3, s[8:11], s38 offen offset:3072 sc1 lds
M v[84:87], a[68:71], a[164:167], v[84:87]
 s_waitcnt lgkmcnt(0)
M v[84:87], a[64:67], a[160:163], v[84:87]
 s_barrier
M v[92:95], a[96:99], a[160:163], 0
 ds_read_b128 a[64:67], v7 offset:32768
M v[92:95], a[100:103], a[164:167], v[92:95]
 s_add_u32 m0, s28, 135168
 ds_read_b128 a[68:71], v7 offset:33792
M v[92:95], a[104:107], a[168:171], v[92:95]
 buffer_load_dwordx4 v4, s[8:11], s38 offen offset:0 sc1 lds
M v[92:95], a[108:111], a[172:175], v[92:95]
 ds_read_b128 a[72:75], v7 offset:34816
M v[92:95], a[112:115], a[176:179], v[92:95]
 ds_read_b128 a[76:79], v7 offset:35840
M v[92:95], a[116:119], a[180:183], v[92:95]
 buffer_load_dwordx4 v4, s[8:11], s38 offen offset:1024 sc1 lds
M v[92:95], a[120:123], a[184:187], v[92:95]
 ds_read_b128 a[80:83], v7 offset:36864
M v[92:95], a[124:127], a[188:191], v[92:95]
 ds_read_b128 a[84:87], v7 offset:37888
M v[88:91], a[124:127], a[156:159], 0
 buffer_load_dwordx4 v4, s[8:11], s38 offen offset:2048 sc1 lds
M v[88:91], a[120:123], a[152:155], v[88:91]
 ds_read_b128 a[88:91], v7 offset:38912
M v[88:91], a[116:119], a[148:151], v[88:91]
 ds_read_b128 a[92:95], v7 offset:39936
M v[88:91], a[112:115], a[144:147], v[88:91]
 buffer_load_dwordx4 v4, s[8:11], s38 offen offset:3072 sc1 lds
M v[88:91], a[108:111], a[140:143], v[88:91]
 s_add_u32 s38, s38, 32768
M v[88:91], a[104:107], a[136:139], v[88:91]
M v[88:91], a[100:103], a[132:135], v[88:91]
 s_waitcnt lgkmcnt(0)
M v[88:91], a[96:99], a[128:131], v[88:91]
M v[96:99], a[64:67], a[128:131], 0
 s_add_u32 m0, s28, 98304
 ds_read_b128 a[96:99], v7 offset:40960
M v[96:99], a[68:71], a[132:135], v[96:99]
 ds_read_b128 a[100:103], v7 offset:41984
M v[96:99], a[72:75], a[136:139], v[96:99]
 buffer_load_dwordx4 v3, s[8:11], s38 offen offset:0 sc1 lds
M v[96:99], a[76:79], a[140:143], v[96:99]
 ds_read_b128 a[104:107], v7 offset:43008
 s_add_u32 s29, s33, 0
M v[96:99], a[80:83], a[144:147], v[96:99]
 ds_read_b128 a[108:111], v7 offset:44032
 s_add_u32 s30, s33, 14336
M v[96:99], a[84:87], a[148:151], v[96:99]
 buffer_load_dwordx4 v3, s[8:11], s38 offen offset:1024 sc1 lds
M v[96:99], a[88:91], a[152:155], v[96:99]
 ds_read_b128 a[112:115], v7 offset:45056
 v_max3_f32 v32, |v64|, |v65|, |v66|
M v[96:99], a[92:95], a[156:159], v[96:99]
 ds_read_b128 a[116:119], v7 offset:46080
 v_max3_f32 v32, |v67|, |v72|, v32
M v[100:103], a[92:95], a[188:191], 0
 buffer_load_dwordx4 v3, s[8:11], s38 offen offset:2048 sc1 lds
M v[100:103], a[88:91], a[184:187], v[100:103]
 ds_read_b128 a[120:123], v7 offset:47104
 v_max3_f32 v32, |v73|, |v74|, v32
M v[100:103], a[84:87], a[180:183], v[100:103]
 ds_read_b128 a[124:127], v7 offset:48128
 v_mul_f32 v32, 2.0, v32
M v[100:103], a[80:83], a[176:179], v[100:103]
 buffer_load_dwordx4 v3, s[8:11], s38 offen offset:3072 sc1 lds
M v[100:103], a[76:79], a[172:175], v[100:103]
 s_add_u32 m0, s28, 102400
 v_mov_b32 v33, v32
 v_mov_b32 v34, v32
M v[100:103], a[72:75], a[168:171], v[100:103]
 buffer_load_dwordx4 v4, s[8:11], s38 offen offset:0 sc1 lds
M v[100:103], a[68:71], a[164:167], v[100:103]
 v_mov_b32 v35, v32
 v_mul_f32 v28, -v32, v5
M v[100:103], a[64:67], a[160:163], v[100:103]
 s_waitcnt lgkmcnt(0)
 v_mul_f32 v64, v5, v64
 v_mul_f32 v65, v5, v65
M v[108:111], a[96:99], a[160:163], 0
 ds_read_b128 a[64:67], v7 offset:49152
 v_mul_f32 v66, v5, v66
M v[108:111], a[100:103], a[164:167], v[108:111]
 ds_read_b128 a[68:71], v7 offset:50176
 v_mul_f32 v67, v5, v67
M v[108:111], a[104:107], a[168:171], v[108:111]
 buffer_load_dwordx4 v4, s[8:11], s38 offen offset:1024 sc1 lds
M v[108:111], a[108:111], a[172:175], v[108:111]
 ds_read_b128 a[72:75], v7 offset:51200
 v_mul_f32 v72, v5, v72
M v[108:111], a[112:115], a[176:179], v[108:111]
 ds_read_b128 a[76:79], v7 offset:52224
 v_mul_f32 v73, v5, v73
M v[108:111], a[116:119], a[180:183], v[108:111]
 buffer_load_dwordx4 v4, s[8:11], s38 offen offset:2048 sc1 lds
M v[108:111], a[120:123], a[184:187], v[108:111]
 ds_read_b128 a[80:83], v7 offset:53248
 v_mul_f32 v74, v5, v74
M v[108:111], a[124:127], a[188:191], v[108:111]
 ds_read_b128 a[84:87], v7 offset:54272
 v_mul_f32 v75, v5, v75
M v[104:107], a[124:127], a[156:159], 0
 buffer_load_dwordx4 v4, s[8:11], s38 offen offset:3072 sc1 lds
M v[104:107], a[120:123], a[152:155], v[104:107]
 s_add_u32 s38, s38, 32768
 ds_read_b128 a[88:91], v7 offset:55296
 v_cvt_pk_bf16_f32 v64, v64, v65
M v[104:107], a[116:119], a[148:151], v[104:107]
 ds_read_b128 a[92:95], v7 offset:56320
 v_cvt_pk_bf16_f32 v65, v66, v67
M v[104:107], a[112:115], a[144:147], v[104:107]
 v_cvt_pk_bf16_f32 v66, v72, v73
 v_cvt_pk_bf16_f32 v67, v74, v75
M v[104:107], a[108:111], a[140:143], v[104:107]
 buffer_store_dwordx4 v[64:67], v7, s[8:11], s29 offen offset:0 sc1
M v[104:107], a[104:107], a[136:139], v[104:107]
 v_max3_f32 v36, |v68|, |v69|, |v70|
 v_max3_f32 v36, |v71|, |v76|, v36
M v[104:107], a[100:103], a[132:135], v[104:107]
 v_max3_f32 v36, |v77|, |v78|, v36
 v_mul_f32 v36, 2.0, v36
M v[104:107], a[96:99], a[128:131], v[104:107]
 s_waitcnt lgkmcnt(0)
 v_mov_b32 v37, v36
 v_mov_b32 v38, v36
M v[112:115], a[64:67], a[128:131], 0
 ds_read_b128 a[96:99], v7 offset:57344
 v_mov_b32 v39, v36
M v[112:115], a[68:71], a[132:135], v[112:115]
 ds_read_b128 a[100:103], v7 offset:58368
 v_mul_f32 v29, -v36, v6
M v[112:115], a[72:75], a[136:139], v[112:115]
 v_mul_f32 v68, v6, v68
 v_mul_f32 v69, v6, v69
M v[112:115], a[76:79], a[140:143], v[112:115]
 ds_read_b128 a[104:107], v7 offset:59392
 v_mul_f32 v70, v6, v70
M v[112:115], a[80:83], a[144:147], v[112:115]
 ds_read_b128 a[108:111], v7 offset:60416
 v_mul_f32 v71, v6, v71
M v[112:115], a[84:87], a[148:151], v[112:115]
 v_mul_f32 v76, v6, v76
 v_mul_f32 v77, v6, v77
M v[112:115], a[88:91], a[152:155], v[112:115]
 ds_read_b128 a[112:115], v7 offset:61440
 v_mul_f32 v78, v6, v78
M v[112:115], a[92:95], a[156:159], v[112:115]
 ds_read_b128 a[116:119], v7 offset:62464
 v_mul_f32 v79, v6, v79
M v[116:119], a[92:95], a[188:191], 0
 v_cvt_pk_bf16_f32 v68, v68, v69
 v_cvt_pk_bf16_f32 v69, v70, v71
M v[116:119], a[88:91], a[184:187], v[116:119]
 ds_read_b128 a[120:123], v7 offset:63488
 v_cvt_pk_bf16_f32 v70, v76, v77
M v[116:119], a[84:87], a[180:183], v[116:119]
 ds_read_b128 a[124:127], v7 offset:64512
 v_cvt_pk_bf16_f32 v71, v78, v79
M v[116:119], a[80:83], a[176:179], v[116:119]
 buffer_store_dwordx4 v[68:71], v7, s[8:11], s30 offen offset:0 sc1
M v[116:119], a[76:79], a[172:175], v[116:119]
 v_mul_f32 v80, v5, v80
 v_mul_f32 v81, v5, v81
M v[116:119], a[72:75], a[168:171], v[116:119]
 v_mul_f32 v82, v5, v82
 v_mul_f32 v83, v5, v83
M v[116:119], a[68:71], a[164:167], v[116:119]
 s_waitcnt lgkmcnt(0)
 v_mul_f32 v88, v5, v88
 v_mul_f32 v89, v5, v89
M v[116:119], a[64:67], a[160:163], v[116:119]
 s_barrier
M v[124:127], a[96:99], a[160:163], 0
 ds_read_b128 a[64:67], v2 offset:0
 v_mul_f32 v90, v5, v90
M v[124:127], a[100:103], a[164:167], v[124:127]
 ds_read_b128 a[68:71], v2 offset:1024
 v_mul_f32 v91, v5, v91
M v[124:127], a[104:107], a[168:171], v[124:127]
 v_cvt_pk_bf16_f32 v80, v80, v81
 v_cvt_pk_bf16_f32 v81, v82, v83
M v[124:127], a[108:111], a[172:175], v[124:127]
 ds_read_b128 a[72:75], v2 offset:2048
 v_cvt_pk_bf16_f32 v82, v88, v89
M v[124:127], a[112:115], a[176:179], v[124:127]
 ds_read_b128 a[76:79], v2 offset:3072
 v_cvt_pk_bf16_f32 v83, v90, v91
M v[124:127], a[116:119], a[180:183], v[124:127]
 buffer_store_dwordx4 v[80:83], v7, s[8:11], s29 offen offset:1024 sc1
M v[124:127], a[120:123], a[184:187], v[124:127]
 ds_read_b128 a[80:83], v2 offset:4096
 v_mul_f32 v84, v6, v84
M v[124:127], a[124:127], a[188:191], v[124:127]
 ds_read_b128 a[84:87], v2 offset:5120
 v_mul_f32 v85, v6, v85
M v[120:123], a[124:127], a[156:159], 0
 v_mul_f32 v86, v6, v86
 v_mul_f32 v87, v6, v87
M v[120:123], a[120:123], a[152:155], v[120:123]
 ds_read_b128 a[88:91], v2 offset:6144
 v_mul_f32 v92, v6, v92
M v[120:123], a[116:119], a[148:151], v[120:123]
 ds_read_b128 a[92:95], v2 offset:7168
 v_mul_f32 v93, v6, v93
M v[120:123], a[112:115], a[144:147], v[120:123]
 v_mul_f32 v94, v6, v94
 v_mul_f32 v95, v6, v95
M v[120:123], a[108:111], a[140:143], v[120:123]
 v_cvt_pk_bf16_f32 v84, v84, v85
 v_cvt_pk_bf16_f32 v85, v86, v87
M v[120:123], a[104:107], a[136:139], v[120:123]
 v_cvt_pk_bf16_f32 v86, v92, v93
 v_cvt_pk_bf16_f32 v87, v94, v95
M v[120:123], a[100:103], a[132:135], v[120:123]
 s_waitcnt lgkmcnt(0)
M v[120:123], a[96:99], a[128:131], v[120:123]
 buffer_store_dwordx4 v[84:87], v7, s[8:11], s30 offen offset:1024 sc1
M v[64:67], a[64:67], a[128:131], v[32:35]
 s_add_u32 m0, s28, 32768
 ds_read_b128 a[96:99], v2 offset:8192
M v[64:67], a[68:71], a[132:135], v[64:67]
 ds_read_b128 a[100:103], v2 offset:9216
 s_mov_b32 s79, 104923136
M v[64:67], a[72:75], a[136:139], v[64:67]
 buffer_load_dwordx4 v3, s[8:11], s38 offen offset:0 sc1 lds
M v[64:67], a[76:79], a[140:143], v[64:67]
 ds_read_b128 a[104:107], v2 offset:10240
 s_add_u32 s29, s33, 2048
M v[64:67], a[80:83], a[144:147], v[64:67]
 ds_read_b128 a[108:111], v2 offset:11264
 s_add_u32 s30, s33, 16384
M v[64:67], a[84:87], a[148:151], v[64:67]
 buffer_load_dwordx4 v3, s[8:11], s38 offen offset:1024 sc1 lds
M v[64:67], a[88:91], a[152:155], v[64:67]
 ds_read_b128 a[112:115], v2 offset:12288
 v_mul_f32 v96, v5, v96
M v[64:67], a[92:95], a[156:159], v[64:67]
 ds_read_b128 a[116:119], v2 offset:13312
 v_mul_f32 v97, v5, v97
M v[68:71], a[92:95], a[188:191], v[36:39]
 buffer_load_dwordx4 v3, s[8:11], s38 offen offset:2048 sc1 lds
M v[68:71], a[88:91], a[184:187], v[68:71]
 ds_read_b128 a[120:123], v2 offset:14336
 v_mul_f32 v98, v5, v98
M v[68:71], a[84:87], a[180:183], v[68:71]
 ds_read_b128 a[124:127], v2 offset:15360
 v_mul_f32 v99, v5, v99
M v[68:71], a[80:83], a[176:179], v[68:71]
 buffer_load_dwordx4 v3, s[8:11], s38 offen offset:3072 sc1 lds
M v[68:71], a[76:79], a[172:175], v[68:71]
 s_add_u32 m0, s28, 36864
 v_mul_f32 v104, v5, v104
 v_mul_f32 v105, v5, v105
M v[68:71], a[72:75], a[168:171], v[68:71]
 buffer_load_dwordx4 v4, s[8:11], s38 offen offset:0 sc1 lds
M v[68:71], a[68:71], a[164:167], v[68:71]
 buffer_load_dword v24, off, s[8:11], s79 sc1
M v[68:71], a[64:67], a[160:163], v[68:71]
 s_waitcnt lgkmcnt(0)
 v_lshrrev_b32 v0, 4, v7
 v_and_b32 v14, 15, v0
M v[76:79], a[96:99], a[160:163], v[36:39]
 ds_read_b128 a[64:67], v2 offset:16384
 v_lshlrev_b32 v14, 2, v14
M v[76:79], a[100:103], a[164:167], v[76:79]
 ds_read_b128 a[68:71], v2 offset:17408
 v_lshrrev_b32 v11, 4, v0
M v[76:79], a[104:107], a[168:171], v[76:79]
 buffer_load_dwordx4 v4, s[8:11], s38 offen offset:1024 sc1 lds
M v[76:79], a[108:111], a[172:175], v[76:79]
 ds_read_b128 a[72:75], v2 offset:18432
 s_mov_b32 s52, s96
M v[76:79], a[112:115], a[176:179], v[76:79]
 s_and_b32 s53, s97, 0xffff
 ds_read_b128 a[76:79], v2 offset:19456
 s_mov_b32 s54, 1835008
M v[76:79], a[116:119], a[180:183], v[76:79]
 buffer_load_dwordx4 v4, s[8:11], s38 offen offset:2048 sc1 lds
M v[76:79], a[120:123], a[184:187], v[76:79]
 ds_read_b128 a[80:83], v2 offset:20480
 s_mov_b32 s55, 0x20000
M v[76:79], a[124:127], a[188:191], v[76:79]
 s_lshr_b32 s74, s41, 3
 ds_read_b128 a[84:87], v2 offset:21504
 s_xor_b32 s74, s74, 0
M v[72:75], a[124:127], a[156:159], v[32:35]
 buffer_load_dwordx4 v4, s[8:11], s38 offen offset:3072 sc1 lds
M v[72:75], a[120:123], a[152:155], v[72:75]
 s_add_u32 s38, s38, 32768
 ds_read_b128 a[88:91], v2 offset:22528
 s_mul_i32 s67, s74, -2
M v[72:75], a[116:119], a[148:151], v[72:75]
 s_mul_i32 s74, s74, 8
 ds_read_b128 a[92:95], v2 offset:23552
 v_mul_f32 v106, v5, v106
M v[72:75], a[112:115], a[144:147], v[72:75]
 s_add_u32 s74, s74, s20
 v_mul_f32 v107, v5, v107
 v_cvt_pk_bf16_f32 v96, v96, v97
M v[72:75], a[108:111], a[140:143], v[72:75]
 s_lshl_b32 s75, s74, 6
 v_cvt_pk_bf16_f32 v97, v98, v99
 v_cvt_pk_bf16_f32 v98, v104, v105
M v[72:75], a[104:107], a[136:139], v[72:75]
 s_add_u32 s76, s75, 256
 v_cvt_pk_bf16_f32 v99, v106, v107
M v[72:75], a[100:103], a[132:135], v[72:75]
 s_add_u32 s67, s67, 3
 v_add_u32 v43, 0x20000, v7
 s_sub_u32 s67, s67, s20
M v[72:75], a[96:99], a[128:131], v[72:75]
 s_waitcnt lgkmcnt(0)
 s_and_b32 s67, s67, 536870912
M v[80:83], a[64:67], a[128:131], v[32:35]
 s_or_b32 s76, s76, s67
 ds_read_b128 a[96:99], v2 offset:24576
 v_or_b32 v27, s67, v7
M v[80:83], a[68:71], a[132:135], v[80:83]
 ds_read_b128 a[100:103], v2 offset:25600
 v_add_u32 v27, 4096, v27
M v[80:83], a[72:75], a[136:139], v[80:83]
 buffer_store_dwordx4 v[96:99], v7, s[8:11], s29 offen offset:0 sc1
M v[80:83], a[76:79], a[140:143], v[80:83]
 ds_read_b128 a[104:107], v2 offset:26624
 v_mul_f32 v100, v6, v100
M v[80:83], a[80:83], a[144:147], v[80:83]
 ds_read_b128 a[108:111], v2 offset:27648
 v_mul_f32 v101, v6, v101
M v[80:83], a[84:87], a[148:151], v[80:83]
 v_mul_f32 v102, v6, v102
 v_mul_f32 v103, v6, v103
M v[80:83], a[88:91], a[152:155], v[80:83]
 ds_read_b128 a[112:115], v2 offset:28672
 v_mul_f32 v108, v6, v108
M v[80:83], a[92:95], a[156:159], v[80:83]
 ds_read_b128 a[116:119], v2 offset:29696
 v_mul_f32 v109, v6, v109
M v[84:87], a[92:95], a[188:191], v[36:39]
 v_mul_f32 v110, v6, v110
 v_mul_f32 v111, v6, v111
M v[84:87], a[88:91], a[184:187], v[84:87]
 ds_read_b128 a[120:123], v2 offset:30720
 v_cvt_pk_bf16_f32 v100, v100, v101
M v[84:87], a[84:87], a[180:183], v[84:87]
 ds_read_b128 a[124:127], v2 offset:31744
 v_cvt_pk_bf16_f32 v101, v102, v103
M v[84:87], a[80:83], a[176:179], v[84:87]
 v_cvt_pk_bf16_f32 v102, v108, v109
 v_cvt_pk_bf16_f32 v103, v110, v111
M v[84:87], a[76:79], a[172:175], v[84:87]
 buffer_store_dwordx4 v[100:103], v7, s[8:11], s30 offen offset:0 sc1
M v[84:87], a[72:75], a[168:171], v[84:87]
 v_mul_f32 v112, v5, v112
 v_mul_f32 v113, v5, v113
M v[84:87], a[68:71], a[164:167], v[84:87]
 s_waitcnt vmcnt(31) lgkmcnt(0)
 v_mul_f32 v114, v5, v114
 v_mul_f32 v115, v5, v115
M v[84:87], a[64:67], a[160:163], v[84:87]
 s_barrier
M v[92:95], a[96:99], a[160:163], v[36:39]
 ds_read_b128 a[64:67], v7 offset:0
 v_mul_f32 v120, v5, v120
M v[92:95], a[100:103], a[164:167], v[92:95]
 ds_read_b128 a[68:71], v7 offset:1024
 v_mul_f32 v121, v5, v121
M v[92:95], a[104:107], a[168:171], v[92:95]
 v_mul_f32 v122, v5, v122
 v_mul_f32 v123, v5, v123
M v[92:95], a[108:111], a[172:175], v[92:95]
 ds_read_b128 a[72:75], v7 offset:2048
 v_cvt_pk_bf16_f32 v112, v112, v113
M v[92:95], a[112:115], a[176:179], v[92:95]
 ds_read_b128 a[76:79], v7 offset:3072
 v_cvt_pk_bf16_f32 v113, v114, v115
M v[92:95], a[116:119], a[180:183], v[92:95]
 v_cvt_pk_bf16_f32 v114, v120, v121
 v_cvt_pk_bf16_f32 v115, v122, v123
M v[92:95], a[120:123], a[184:187], v[92:95]
 ds_read_b128 a[80:83], v7 offset:4096
M v[92:95], a[124:127], a[188:191], v[92:95]
 ds_read_b128 a[84:87], v7 offset:5120
M v[88:91], a[124:127], a[156:159], v[32:35]
 buffer_store_dwordx4 v[112:115], v7, s[8:11], s29 offen offset:1024 sc1
M v[88:91], a[120:123], a[152:155], v[88:91]
 ds_read_b128 a[88:91], v7 offset:6144
 v_mul_f32 v116, v6, v116
M v[88:91], a[116:119], a[148:151], v[88:91]
 ds_read_b128 a[92:95], v7 offset:7168
 v_mul_f32 v117, v6, v117
M v[88:91], a[112:115], a[144:147], v[88:91]
 v_mul_f32 v118, v6, v118
 v_mul_f32 v119, v6, v119
M v[88:91], a[108:111], a[140:143], v[88:91]
 v_mul_f32 v124, v6, v124
 v_mul_f32 v125, v6, v125
M v[88:91], a[104:107], a[136:139], v[88:91]
 v_mul_f32 v126, v6, v126
 v_mul_f32 v127, v6, v127
M v[88:91], a[100:103], a[132:135], v[88:91]
 s_waitcnt lgkmcnt(0)
 v_cvt_pk_bf16_f32 v116, v116, v117
 v_cvt_pk_bf16_f32 v117, v118, v119
M v[88:91], a[96:99], a[128:131], v[88:91]
 v_cvt_pk_bf16_f32 v118, v124, v125
 v_cvt_pk_bf16_f32 v119, v126, v127
 buffer_store_dwordx4 v[116:119], v7, s[8:11], s30 offen offset:1024 sc1
M v[96:99], a[64:67], a[128:131], v[32:35]
 ds_read_b128 a[96:99], v7 offset:8192
M v[96:99], a[68:71], a[132:135], v[96:99]
 ds_read_b128 a[100:103], v7 offset:9216
M v[96:99], a[72:75], a[136:139], v[96:99]
 s_sub_u32 s64, 15, s42
M v[96:99], a[76:79], a[140:143], v[96:99]
 s_min_u32 s64, s64, s42
 ds_read_b128 a[104:107], v7 offset:10240
 s_add_u32 s29, s33, 4096
M v[96:99], a[80:83], a[144:147], v[96:99]
 s_mul_i32 s45, s64, 8704
 ds_read_b128 a[108:111], v7 offset:11264
 s_add_u32 s30, s33, 18432
M v[96:99], a[84:87], a[148:151], v[96:99]
 s_lshl_b32 s64, s20, 6
 v_fma_f32 v64, v64, v5, v28
 v_fma_f32 v65, v65, v5, v28
M v[96:99], a[88:91], a[152:155], v[96:99]
 s_add_u32 s64, s64, s41
 ds_read_b128 a[112:115], v7 offset:12288
 v_fma_f32 v66, v66, v5, v28
M v[96:99], a[92:95], a[156:159], v[96:99]
 s_lshl2_add_u32 s45, s64, s45
 ds_read_b128 a[116:119], v7 offset:13312
 v_fma_f32 v67, v67, v5, v28
M v[100:103], a[92:95], a[188:191], v[36:39]
 s_add_u32 s45, s45, 104992768
 v_fma_f32 v72, v72, v5, v28
M v[100:103], a[88:91], a[184:187], v[100:103]
 s_movk_i32 s65, 1024
 ds_read_b128 a[120:123], v7 offset:14336
 v_fma_f32 v73, v73, v5, v28
M v[100:103], a[84:87], a[180:183], v[100:103]
 s_cmp_lt_u32 s42, 8
 ds_read_b128 a[124:127], v7 offset:15360
 v_fma_f32 v74, v74, v5, v28
M v[100:103], a[80:83], a[176:179], v[100:103]
 s_cselect_b32 s64, 4352, s65
 v_fma_f32 v75, v75, v5, v28
M v[100:103], a[76:79], a[172:175], v[100:103]
 s_cselect_b32 s65, 0, 64
 v_cvt_pk_bf16_f32 v64, v64, v65
M v[100:103], a[72:75], a[168:171], v[100:103]
 s_cselect_b32 s66, 32, 64
 v_cvt_pk_bf16_f32 v65, v66, v67
M v[100:103], a[68:71], a[164:167], v[100:103]
 s_add_u32 s3, s45, s64
 s_add_u32 s45, s45, s65
 v_lshrrev_b32 v42, 5, v7
M v[100:103], a[64:67], a[160:163], v[100:103]
 s_waitcnt lgkmcnt(0)
 v_mul_u32_u24 v42, 4352, v42
 v_and_b32 v41, 16, v7
M v[108:111], a[96:99], a[160:163], v[36:39]
 ds_read_b128 a[64:67], v7 offset:16384
 v_lshl_add_u32 v41, v41, 3, v42
M v[108:111], a[100:103], a[164:167], v[108:111]
 ds_read_b128 a[68:71], v7 offset:17408
 v_mov_b32 v42, 536870912
M v[108:111], a[104:107], a[168:171], v[108:111]
 v_cmp_gt_u32 vcc, s66, v7
 v_mov_b32 v40, 1
M v[108:111], a[108:111], a[172:175], v[108:111]
 s_nop 0
 ds_read_b128 a[72:75], v7 offset:18432
 v_cndmask_b32 v41, v42, v41, vcc
M v[108:111], a[112:115], a[176:179], v[108:111]
 ds_read_b128 a[76:79], v7 offset:19456
 v_cvt_pk_bf16_f32 v66, v72, v73
M v[108:111], a[116:119], a[180:183], v[108:111]
 v_cvt_pk_bf16_f32 v67, v74, v75
M v[108:111], a[120:123], a[184:187], v[108:111]
 ds_read_b128 a[80:83], v7 offset:20480
M v[108:111], a[124:127], a[188:191], v[108:111]
 ds_read_b128 a[84:87], v7 offset:21504
M v[104:107], a[124:127], a[156:159], v[32:35]
 buffer_store_dwordx4 v[64:67], v7, s[8:11], s29 offen offset:0 sc1
M v[104:107], a[120:123], a[152:155], v[104:107]
 ds_read_b128 a[88:91], v7 offset:22528
 v_fma_f32 v68, v68, v6, v29
M v[104:107], a[116:119], a[148:151], v[104:107]
 ds_read_b128 a[92:95], v7 offset:23552
 v_fma_f32 v69, v69, v6, v29
M v[104:107], a[112:115], a[144:147], v[104:107]
 v_fma_f32 v70, v70, v6, v29
 v_fma_f32 v71, v71, v6, v29
M v[104:107], a[108:111], a[140:143], v[104:107]
 v_fma_f32 v76, v76, v6, v29
 v_fma_f32 v77, v77, v6, v29
M v[104:107], a[104:107], a[136:139], v[104:107]
 v_fma_f32 v78, v78, v6, v29
 v_fma_f32 v79, v79, v6, v29
M v[104:107], a[100:103], a[132:135], v[104:107]
 v_cvt_pk_bf16_f32 v68, v68, v69
 v_cvt_pk_bf16_f32 v69, v70, v71
M v[104:107], a[96:99], a[128:131], v[104:107]
 s_waitcnt lgkmcnt(0)
 v_cvt_pk_bf16_f32 v70, v76, v77
 v_cvt_pk_bf16_f32 v71, v78, v79
M v[112:115], a[64:67], a[128:131], v[32:35]
 ds_read_b128 a[96:99], v7 offset:24576
M v[112:115], a[68:71], a[132:135], v[112:115]
 ds_read_b128 a[100:103], v7 offset:25600
M v[112:115], a[72:75], a[136:139], v[112:115]
 buffer_store_dwordx4 v[68:71], v7, s[8:11], s30 offen offset:0 sc1
M v[112:115], a[76:79], a[140:143], v[112:115]
 ds_read_b128 a[104:107], v7 offset:26624
 v_fma_f32 v80, v80, v5, v28
M v[112:115], a[80:83], a[144:147], v[112:115]
 ds_read_b128 a[108:111], v7 offset:27648
 v_fma_f32 v81, v81, v5, v28
M v[112:115], a[84:87], a[148:151], v[112:115]
 v_fma_f32 v82, v82, v5, v28
 v_fma_f32 v83, v83, v5, v28
M v[112:115], a[88:91], a[152:155], v[112:115]
 ds_read_b128 a[112:115], v7 offset:28672
 v_fma_f32 v88, v88, v5, v28
M v[112:115], a[92:95], a[156:159], v[112:115]
 ds_read_b128 a[116:119], v7 offset:29696
 v_fma_f32 v89, v89, v5, v28
M v[116:119], a[92:95], a[188:191], v[36:39]
 v_fma_f32 v90, v90, v5, v28
 v_fma_f32 v91, v91, v5, v28
M v[116:119], a[88:91], a[184:187], v[116:119]
 ds_read_b128 a[120:123], v7 offset:30720
 v_cvt_pk_bf16_f32 v80, v80, v81
M v[116:119], a[84:87], a[180:183], v[116:119]
 ds_read_b128 a[124:127], v7 offset:31744
 v_cvt_pk_bf16_f32 v81, v82, v83
M v[116:119], a[80:83], a[176:179], v[116:119]
 v_cvt_pk_bf16_f32 v82, v88, v89
 v_cvt_pk_bf16_f32 v83, v90, v91
M v[116:119], a[76:79], a[172:175], v[116:119]
 buffer_store_dwordx4 v[80:83], v7, s[8:11], s29 offen offset:1024 sc1
M v[116:119], a[72:75], a[168:171], v[116:119]
 v_fma_f32 v84, v84, v6, v29
 v_fma_f32 v85, v85, v6, v29
M v[116:119], a[68:71], a[164:167], v[116:119]
 s_waitcnt vmcnt(28) lgkmcnt(0)
 v_fma_f32 v86, v86, v6, v29
M v[116:119], a[64:67], a[160:163], v[116:119]
 s_barrier
M v[124:127], a[96:99], a[160:163], v[36:39]
 ds_read_b128 a[64:67], v43 offset:0
 v_fma_f32 v87, v87, v6, v29
M v[124:127], a[100:103], a[164:167], v[124:127]
 ds_read_b128 a[68:71], v43 offset:1024
 v_fma_f32 v92, v92, v6, v29
M v[124:127], a[104:107], a[168:171], v[124:127]
 v_fma_f32 v93, v93, v6, v29
 v_fma_f32 v94, v94, v6, v29
M v[124:127], a[108:111], a[172:175], v[124:127]
 ds_read_b128 a[72:75], v43 offset:2048
 v_fma_f32 v95, v95, v6, v29
M v[124:127], a[112:115], a[176:179], v[124:127]
 ds_read_b128 a[76:79], v43 offset:3072
 v_cvt_pk_bf16_f32 v84, v84, v85
M v[124:127], a[116:119], a[180:183], v[124:127]
 v_cvt_pk_bf16_f32 v85, v86, v87
M v[124:127], a[120:123], a[184:187], v[124:127]
 ds_read_b128 a[80:83], v43 offset:4096
 v_cvt_pk_bf16_f32 v86, v92, v93
M v[124:127], a[124:127], a[188:191], v[124:127]
 ds_read_b128 a[84:87], v43 offset:5120
 v_cvt_pk_bf16_f32 v87, v94, v95
M v[120:123], a[124:127], a[156:159], v[32:35]
 buffer_store_dwordx4 v[84:87], v7, s[8:11], s30 offen offset:1024 sc1
M v[120:123], a[120:123], a[152:155], v[120:123]
 ds_read_b128 a[88:91], v43 offset:6144
M v[120:123], a[116:119], a[148:151], v[120:123]
 ds_read_b128 a[92:95], v43 offset:7168
M v[120:123], a[112:115], a[144:147], v[120:123]
M v[120:123], a[108:111], a[140:143], v[120:123]
M v[120:123], a[104:107], a[136:139], v[120:123]
M v[120:123], a[100:103], a[132:135], v[120:123]
 s_waitcnt lgkmcnt(0)
M v[120:123], a[96:99], a[128:131], v[120:123]
M v[64:67], a[64:67], a[128:131], v[32:35]
 ds_read_b128 a[96:99], v43 offset:8192
M v[64:67], a[68:71], a[132:135], v[64:67]
 ds_read_b128 a[100:103], v43 offset:9216
M v[64:67], a[72:75], a[136:139], v[64:67]
 s_waitcnt vmcnt(11)
 v_cmp_gt_u32 vcc, 1, v24
M v[64:67], a[76:79], a[140:143], v[64:67]
 s_mov_b32 s65, 104890368
 ds_read_b128 a[104:107], v43 offset:10240
 s_add_u32 s29, s33, 6144
M v[64:67], a[80:83], a[144:147], v[64:67]
 s_cbranch_vccnz L_fhs0
L_fhr0:
 ds_read_b128 a[108:111], v43 offset:11264
 s_add_u32 s30, s33, 20480
M v[64:67], a[84:87], a[148:151], v[64:67]
 buffer_load_dword v25, v14, s[8:11], s65 offen sc1
M v[64:67], a[88:91], a[152:155], v[64:67]
 ds_read_b128 a[112:115], v43 offset:12288
 v_fma_f32 v96, v96, v5, v28
M v[64:67], a[92:95], a[156:159], v[64:67]
 ds_read_b128 a[116:119], v43 offset:13312
 v_fma_f32 v97, v97, v5, v28
M v[68:71], a[92:95], a[188:191], v[36:39]
 v_fma_f32 v98, v98, v5, v28
 v_fma_f32 v99, v99, v5, v28
M v[68:71], a[88:91], a[184:187], v[68:71]
 ds_read_b128 a[120:123], v43 offset:14336
 v_fma_f32 v104, v104, v5, v28
M v[68:71], a[84:87], a[180:183], v[68:71]
 ds_read_b128 a[124:127], v43 offset:15360
 v_fma_f32 v105, v105, v5, v28
M v[68:71], a[80:83], a[176:179], v[68:71]
 v_fma_f32 v106, v106, v5, v28
 v_fma_f32 v107, v107, v5, v28
M v[68:71], a[76:79], a[172:175], v[68:71]
 v_cvt_pk_bf16_f32 v96, v96, v97
M v[68:71], a[72:75], a[168:171], v[68:71]
 v_cvt_pk_bf16_f32 v97, v98, v99
M v[68:71], a[68:71], a[164:167], v[68:71]
 v_cvt_pk_bf16_f32 v98, v104, v105
M v[68:71], a[64:67], a[160:163], v[68:71]
 s_waitcnt lgkmcnt(0)
 v_cvt_pk_bf16_f32 v99, v106, v107
M v[76:79], a[96:99], a[160:163], v[36:39]
 ds_read_b128 a[64:67], v43 offset:16384
M v[76:79], a[100:103], a[164:167], v[76:79]
 ds_read_b128 a[68:71], v43 offset:17408
M v[76:79], a[104:107], a[168:171], v[76:79]
 buffer_store_dwordx4 v[96:99], v7, s[8:11], s29 offen offset:0 sc1
M v[76:79], a[108:111], a[172:175], v[76:79]
 ds_read_b128 a[72:75], v43 offset:18432
 v_fma_f32 v100, v100, v6, v29
M v[76:79], a[112:115], a[176:179], v[76:79]
 ds_read_b128 a[76:79], v43 offset:19456
 v_fma_f32 v101, v101, v6, v29
M v[76:79], a[116:119], a[180:183], v[76:79]
 v_fma_f32 v102, v102, v6, v29
 v_fma_f32 v103, v103, v6, v29
M v[76:79], a[120:123], a[184:187], v[76:79]
 ds_read_b128 a[80:83], v43 offset:20480
 v_fma_f32 v108, v108, v6, v29
M v[76:79], a[124:127], a[188:191], v[76:79]
 ds_read_b128 a[84:87], v43 offset:21504
 v_fma_f32 v109, v109, v6, v29
M v[72:75], a[124:127], a[156:159], v[32:35]
 v_fma_f32 v110, v110, v6, v29
 v_fma_f32 v111, v111, v6, v29
M v[72:75], a[120:123], a[152:155], v[72:75]
 ds_read_b128 a[88:91], v43 offset:22528
 v_cvt_pk_bf16_f32 v100, v100, v101
M v[72:75], a[116:119], a[148:151], v[72:75]
 ds_read_b128 a[92:95], v43 offset:23552
 v_cvt_pk_bf16_f32 v101, v102, v103
M v[72:75], a[112:115], a[144:147], v[72:75]
 v_cvt_pk_bf16_f32 v102, v108, v109
M v[72:75], a[108:111], a[140:143], v[72:75]
 v_cvt_pk_bf16_f32 v103, v110, v111
M v[72:75], a[104:107], a[136:139], v[72:75]
 buffer_store_dwordx4 v[100:103], v7, s[8:11], s30 offen offset:0 sc1
M v[72:75], a[100:103], a[132:135], v[72:75]
M v[72:75], a[96:99], a[128:131], v[72:75]
 s_waitcnt lgkmcnt(0)
 v_fma_f32 v112, v112, v5, v28
M v[80:83], a[64:67], a[128:131], v[32:35]
 ds_read_b128 a[96:99], v43 offset:24576
 v_fma_f32 v113, v113, v5, v28
M v[80:83], a[68:71], a[132:135], v[80:83]
 ds_read_b128 a[100:103], v43 offset:25600
 v_fma_f32 v114, v114, v5, v28
M v[80:83], a[72:75], a[136:139], v[80:83]
 v_fma_f32 v115, v115, v5, v28
M v[80:83], a[76:79], a[140:143], v[80:83]
 ds_read_b128 a[104:107], v43 offset:26624
 v_fma_f32 v120, v120, v5, v28
M v[80:83], a[80:83], a[144:147], v[80:83]
 ds_read_b128 a[108:111], v43 offset:27648
 v_fma_f32 v121, v121, v5, v28
M v[80:83], a[84:87], a[148:151], v[80:83]
 v_fma_f32 v122, v122, v5, v28
M v[80:83], a[88:91], a[152:155], v[80:83]
 ds_read_b128 a[112:115], v43 offset:28672
 v_fma_f32 v123, v123, v5, v28
M v[80:83], a[92:95], a[156:159], v[80:83]
 ds_read_b128 a[116:119], v43 offset:29696
 v_cvt_pk_bf16_f32 v112, v112, v113
M v[84:87], a[92:95], a[188:191], v[36:39]
 v_cvt_pk_bf16_f32 v113, v114, v115
 v_cvt_pk_bf16_f32 v114, v120, v121
M v[84:87], a[88:91], a[184:187], v[84:87]
 ds_read_b128 a[120:123], v43 offset:30720
 v_cvt_pk_bf16_f32 v115, v122, v123
M v[84:87], a[84:87], a[180:183], v[84:87]
 ds_read_b128 a[124:127], v43 offset:31744
M v[84:87], a[80:83], a[176:179], v[84:87]
 buffer_store_dwordx4 v[112:115], v7, s[8:11], s29 offen offset:1024 sc1
M v[84:87], a[76:79], a[172:175], v[84:87]
 v_fma_f32 v116, v116, v6, v29
M v[84:87], a[72:75], a[168:171], v[84:87]
 v_fma_f32 v117, v117, v6, v29
M v[84:87], a[68:71], a[164:167], v[84:87]
 s_waitcnt lgkmcnt(0)
 v_fma_f32 v118, v118, v6, v29
M v[84:87], a[64:67], a[160:163], v[84:87]
 s_barrier
M v[92:95], a[96:99], a[160:163], v[36:39]
 ds_read_b128 a[64:67], v2 offset:32768
 v_fma_f32 v119, v119, v6, v29
M v[92:95], a[100:103], a[164:167], v[92:95]
 ds_read_b128 a[68:71], v2 offset:33792
 v_fma_f32 v124, v124, v6, v29
M v[92:95], a[104:107], a[168:171], v[92:95]
 v_fma_f32 v125, v125, v6, v29
 v_fma_f32 v126, v126, v6, v29
M v[92:95], a[108:111], a[172:175], v[92:95]
 ds_read_b128 a[72:75], v2 offset:34816
 v_fma_f32 v127, v127, v6, v29
M v[92:95], a[112:115], a[176:179], v[92:95]
 ds_read_b128 a[76:79], v2 offset:35840
 v_cvt_pk_bf16_f32 v116, v116, v117
M v[92:95], a[116:119], a[180:183], v[92:95]
 v_cvt_pk_bf16_f32 v117, v118, v119
M v[92:95], a[120:123], a[184:187], v[92:95]
 ds_read_b128 a[80:83], v2 offset:36864
 v_cvt_pk_bf16_f32 v118, v124, v125
M v[92:95], a[124:127], a[188:191], v[92:95]
 ds_read_b128 a[84:87], v2 offset:37888
 v_cvt_pk_bf16_f32 v119, v126, v127
M v[88:91], a[124:127], a[156:159], v[32:35]
 buffer_store_dwordx4 v[116:119], v7, s[8:11], s30 offen offset:1024 sc1
M v[88:91], a[120:123], a[152:155], v[88:91]
 ds_read_b128 a[88:91], v2 offset:38912
M v[88:91], a[116:119], a[148:151], v[88:91]
 ds_read_b128 a[92:95], v2 offset:39936
M v[88:91], a[112:115], a[144:147], v[88:91]
M v[88:91], a[108:111], a[140:143], v[88:91]
M v[88:91], a[104:107], a[136:139], v[88:91]
M v[88:91], a[100:103], a[132:135], v[88:91]
 s_waitcnt lgkmcnt(0)
M v[88:91], a[96:99], a[128:131], v[88:91]
M v[96:99], a[64:67], a[128:131], v[32:35]
 ds_read_b128 a[96:99], v2 offset:40960
M v[96:99], a[68:71], a[132:135], v[96:99]
 ds_read_b128 a[100:103], v2 offset:41984
M v[96:99], a[72:75], a[136:139], v[96:99]
M v[96:99], a[76:79], a[140:143], v[96:99]
 ds_read_b128 a[104:107], v2 offset:43008
 s_add_u32 s29, s33, 8192
M v[96:99], a[80:83], a[144:147], v[96:99]
 ds_read_b128 a[108:111], v2 offset:44032
 s_add_u32 s30, s33, 22528
M v[96:99], a[84:87], a[148:151], v[96:99]
 v_fma_f32 v64, v64, v5, v28
 v_fma_f32 v65, v65, v5, v28
M v[96:99], a[88:91], a[152:155], v[96:99]
 ds_read_b128 a[112:115], v2 offset:45056
 v_fma_f32 v66, v66, v5, v28
M v[96:99], a[92:95], a[156:159], v[96:99]
 ds_read_b128 a[116:119], v2 offset:46080
 v_fma_f32 v67, v67, v5, v28
M v[100:103], a[92:95], a[188:191], v[36:39]
 v_fma_f32 v72, v72, v5, v28
M v[100:103], a[88:91], a[184:187], v[100:103]
 ds_read_b128 a[120:123], v2 offset:47104
 v_fma_f32 v73, v73, v5, v28
M v[100:103], a[84:87], a[180:183], v[100:103]
 ds_read_b128 a[124:127], v2 offset:48128
 v_fma_f32 v74, v74, v5, v28
M v[100:103], a[80:83], a[176:179], v[100:103]
 v_fma_f32 v75, v75, v5, v28
M v[100:103], a[76:79], a[172:175], v[100:103]
 v_cvt_pk_bf16_f32 v64, v64, v65
M v[100:103], a[72:75], a[168:171], v[100:103]
 v_cvt_pk_bf16_f32 v65, v66, v67
M v[100:103], a[68:71], a[164:167], v[100:103]
 v_cvt_pk_bf16_f32 v66, v72, v73
M v[100:103], a[64:67], a[160:163], v[100:103]
 s_waitcnt lgkmcnt(0)
 v_cvt_pk_bf16_f32 v67, v74, v75
M v[108:111], a[96:99], a[160:163], v[36:39]
 ds_read_b128 a[64:67], v2 offset:49152
M v[108:111], a[100:103], a[164:167], v[108:111]
 ds_read_b128 a[68:71], v2 offset:50176
M v[108:111], a[104:107], a[168:171], v[108:111]
 buffer_store_dwordx4 v[64:67], v7, s[8:11], s29 offen offset:0 sc1
M v[108:111], a[108:111], a[172:175], v[108:111]
 ds_read_b128 a[72:75], v2 offset:51200
 v_fma_f32 v68, v68, v6, v29
M v[108:111], a[112:115], a[176:179], v[108:111]
 ds_read_b128 a[76:79], v2 offset:52224
 v_fma_f32 v69, v69, v6, v29
M v[108:111], a[116:119], a[180:183], v[108:111]
 v_fma_f32 v70, v70, v6, v29
 v_fma_f32 v71, v71, v6, v29
M v[108:111], a[120:123], a[184:187], v[108:111]
 ds_read_b128 a[80:83], v2 offset:53248
 v_fma_f32 v76, v76, v6, v29
M v[108:111], a[124:127], a[188:191], v[108:111]
 ds_read_b128 a[84:87], v2 offset:54272
 v_fma_f32 v77, v77, v6, v29
M v[104:107], a[124:127], a[156:159], v[32:35]
 v_fma_f32 v78, v78, v6, v29
 v_fma_f32 v79, v79, v6, v29
M v[104:107], a[120:123], a[152:155], v[104:107]
 ds_read_b128 a[88:91], v2 offset:55296
 v_cvt_pk_bf16_f32 v68, v68, v69
M v[104:107], a[116:119], a[148:151], v[104:107]
 ds_read_b128 a[92:95], v2 offset:56320
 v_cvt_pk_bf16_f32 v69, v70, v71
M v[104:107], a[112:115], a[144:147], v[104:107]
 v_cvt_pk_bf16_f32 v70, v76, v77
M v[104:107], a[108:111], a[140:143], v[104:107]
 v_cvt_pk_bf16_f32 v71, v78, v79
M v[104:107], a[104:107], a[136:139], v[104:107]
 buffer_store_dwordx4 v[68:71], v7, s[8:11], s30 offen offset:0 sc1
M v[104:107], a[100:103], a[132:135], v[104:107]
M v[104:107], a[96:99], a[128:131], v[104:107]
 s_waitcnt lgkmcnt(0)
 v_fma_f32 v80, v80, v5, v28
M v[112:115], a[64:67], a[128:131], v[32:35]
 ds_read_b128 a[96:99], v2 offset:57344
 v_fma_f32 v81, v81, v5, v28
M v[112:115], a[68:71], a[132:135], v[112:115]
 ds_read_b128 a[100:103], v2 offset:58368
 v_fma_f32 v82, v82, v5, v28
M v[112:115], a[72:75], a[136:139], v[112:115]
 v_fma_f32 v83, v83, v5, v28
M v[112:115], a[76:79], a[140:143], v[112:115]
 ds_read_b128 a[104:107], v2 offset:59392
 v_fma_f32 v88, v88, v5, v28
M v[112:115], a[80:83], a[144:147], v[112:115]
 ds_read_b128 a[108:111], v2 offset:60416
 v_fma_f32 v89, v89, v5, v28
M v[112:115], a[84:87], a[148:151], v[112:115]
 v_fma_f32 v90, v90, v5, v28
M v[112:115], a[88:91], a[152:155], v[112:115]
 ds_read_b128 a[112:115], v2 offset:61440
 v_fma_f32 v91, v91, v5, v28
M v[112:115], a[92:95], a[156:159], v[112:115]
 ds_read_b128 a[116:119], v2 offset:62464
 v_cvt_pk_bf16_f32 v80, v80, v81
M v[116:119], a[92:95], a[188:191], v[36:39]
 s_waitcnt vmcnt(6)
 v_readlane_b32 s84, v25, 0
 v_readlane_b32 s85, v25, 1
M v[116:119], a[88:91], a[184:187], v[116:119]
 ds_read_b128 a[120:123], v2 offset:63488
 v_mov_b32 v24, 0x3f80
M v[116:119], a[84:87], a[180:183], v[116:119]
 ds_read_b128 a[124:127], v2 offset:64512
 v_mov_b32 v25, 0x3f800000
M v[116:119], a[80:83], a[176:179], v[116:119]
 v_cvt_pk_bf16_f32 v81, v82, v83
 v_cvt_pk_bf16_f32 v82, v88, v89
M v[116:119], a[76:79], a[172:175], v[116:119]
 v_cvt_pk_bf16_f32 v83, v90, v91
M v[116:119], a[72:75], a[168:171], v[116:119]
 buffer_store_dwordx4 v[80:83], v7, s[8:11], s29 offen offset:1024 sc1
M v[116:119], a[68:71], a[164:167], v[116:119]
 s_waitcnt lgkmcnt(0)
 v_fma_f32 v84, v84, v6, v29
 v_fma_f32 v85, v85, v6, v29
M v[116:119], a[64:67], a[160:163], v[116:119]
 s_barrier
M v[124:127], a[96:99], a[160:163], v[36:39]
 ds_read_b128 a[64:67], v7 offset:32768
 v_fma_f32 v86, v86, v6, v29
M v[124:127], a[100:103], a[164:167], v[124:127]
 ds_read_b128 a[68:71], v7 offset:33792
 v_fma_f32 v87, v87, v6, v29
M v[124:127], a[104:107], a[168:171], v[124:127]
 v_fma_f32 v92, v92, v6, v29
 v_fma_f32 v93, v93, v6, v29
M v[124:127], a[108:111], a[172:175], v[124:127]
 ds_read_b128 a[72:75], v7 offset:34816
 v_fma_f32 v94, v94, v6, v29
M v[124:127], a[112:115], a[176:179], v[124:127]
 ds_read_b128 a[76:79], v7 offset:35840
 v_fma_f32 v95, v95, v6, v29
M v[124:127], a[116:119], a[180:183], v[124:127]
 s_waitcnt vmcnt(3)
 v_cvt_pk_bf16_f32 v84, v84, v85
 v_cvt_pk_bf16_f32 v85, v86, v87
M v[124:127], a[120:123], a[184:187], v[124:127]
 ds_read_b128 a[80:83], v7 offset:36864
 v_cvt_pk_bf16_f32 v86, v92, v93
M v[124:127], a[124:127], a[188:191], v[124:127]
 ds_read_b128 a[84:87], v7 offset:37888
 v_cvt_pk_bf16_f32 v87, v94, v95
M v[120:123], a[124:127], a[156:159], v[32:35]
 buffer_store_dword v40, v41, s[8:11], s45 offen sc1
M v[120:123], a[120:123], a[152:155], v[120:123]
 ds_read_b128 a[88:91], v7 offset:38912
M v[120:123], a[116:119], a[148:151], v[120:123]
 ds_read_b128 a[92:95], v7 offset:39936
M v[120:123], a[112:115], a[144:147], v[120:123]
 buffer_store_dwordx4 v[84:87], v7, s[8:11], s30 offen offset:1024 sc1
M v[120:123], a[108:111], a[140:143], v[120:123]
M v[120:123], a[104:107], a[136:139], v[120:123]
M v[120:123], a[100:103], a[132:135], v[120:123]
 s_waitcnt lgkmcnt(0)
M v[120:123], a[96:99], a[128:131], v[120:123]
M v[64:67], a[64:67], a[128:131], v[32:35]
 ds_read_b128 a[96:99], v7 offset:40960
M v[64:67], a[68:71], a[132:135], v[64:67]
 ds_read_b128 a[100:103], v7 offset:41984
M v[64:67], a[72:75], a[136:139], v[64:67]
M v[64:67], a[76:79], a[140:143], v[64:67]
 ds_read_b128 a[104:107], v7 offset:43008
 s_add_u32 s29, s33, 10240
M v[64:67], a[80:83], a[144:147], v[64:67]
 ds_read_b128 a[108:111], v7 offset:44032
 s_add_u32 s30, s33, 24576
M v[64:67], a[84:87], a[148:151], v[64:67]
 v_fma_f32 v96, v96, v5, v28
 v_fma_f32 v97, v97, v5, v28
M v[64:67], a[88:91], a[152:155], v[64:67]
 ds_read_b128 a[112:115], v7 offset:45056
 v_fma_f32 v98, v98, v5, v28
M v[64:67], a[92:95], a[156:159], v[64:67]
 ds_read_b128 a[116:119], v7 offset:46080
 v_fma_f32 v99, v99, v5, v28
M v[68:71], a[92:95], a[188:191], v[36:39]
 v_fma_f32 v104, v104, v5, v28
 v_fma_f32 v105, v105, v5, v28
M v[68:71], a[88:91], a[184:187], v[68:71]
 ds_read_b128 a[120:123], v7 offset:47104
 v_fma_f32 v106, v106, v5, v28
M v[68:71], a[84:87], a[180:183], v[68:71]
 ds_read_b128 a[124:127], v7 offset:48128
 v_fma_f32 v107, v107, v5, v28
M v[68:71], a[80:83], a[176:179], v[68:71]
 v_cvt_pk_bf16_f32 v96, v96, v97
 v_cvt_pk_bf16_f32 v97, v98, v99
M v[68:71], a[76:79], a[172:175], v[68:71]
 v_cvt_pk_bf16_f32 v98, v104, v105
 v_cvt_pk_bf16_f32 v99, v106, v107
M v[68:71], a[72:75], a[168:171], v[68:71]
 buffer_store_dwordx4 v[96:99], v7, s[8:11], s29 offen offset:0 sc1
M v[68:71], a[68:71], a[164:167], v[68:71]
 v_fma_f32 v100, v100, v6, v29
 v_fma_f32 v101, v101, v6, v29
M v[68:71], a[64:67], a[160:163], v[68:71]
 s_waitcnt lgkmcnt(0)
 v_fma_f32 v102, v102, v6, v29
 v_fma_f32 v103, v103, v6, v29
M v[72:75], a[96:99], a[128:131], v[32:35]
 ds_read_b128 a[64:67], v7 offset:49152
 v_fma_f32 v108, v108, v6, v29
M v[72:75], a[100:103], a[132:135], v[72:75]
 ds_read_b128 a[68:71], v7 offset:50176
 v_fma_f32 v109, v109, v6, v29
M v[72:75], a[104:107], a[136:139], v[72:75]
 v_fma_f32 v110, v110, v6, v29
 v_fma_f32 v111, v111, v6, v29
M v[72:75], a[108:111], a[140:143], v[72:75]
 ds_read_b128 a[72:75], v7 offset:51200
 v_cvt_pk_bf16_f32 v100, v100, v101
M v[72:75], a[112:115], a[144:147], v[72:75]
 ds_read_b128 a[76:79], v7 offset:52224
 v_cvt_pk_bf16_f32 v101, v102, v103
M v[72:75], a[116:119], a[148:151], v[72:75]
 v_cvt_pk_bf16_f32 v102, v108, v109
 v_cvt_pk_bf16_f32 v103, v110, v111
M v[72:75], a[120:123], a[152:155], v[72:75]
 ds_read_b128 a[80:83], v7 offset:53248
M v[72:75], a[124:127], a[156:159], v[72:75]
 ds_read_b128 a[84:87], v7 offset:54272
M v[76:79], a[124:127], a[188:191], v[36:39]
 buffer_store_dwordx4 v[100:103], v7, s[8:11], s30 offen offset:0 sc1
M v[76:79], a[120:123], a[184:187], v[76:79]
 ds_read_b128 a[88:91], v7 offset:55296
 v_fma_f32 v112, v112, v5, v28
M v[76:79], a[116:119], a[180:183], v[76:79]
 ds_read_b128 a[92:95], v7 offset:56320
 v_fma_f32 v113, v113, v5, v28
M v[76:79], a[112:115], a[176:179], v[76:79]
 v_fma_f32 v114, v114, v5, v28
 v_fma_f32 v115, v115, v5, v28
M v[76:79], a[108:111], a[172:175], v[76:79]
 v_fma_f32 v120, v120, v5, v28
 v_fma_f32 v121, v121, v5, v28
M v[76:79], a[104:107], a[168:171], v[76:79]
 v_fma_f32 v122, v122, v5, v28
 v_fma_f32 v123, v123, v5, v28
M v[76:79], a[100:103], a[164:167], v[76:79]
 v_cvt_pk_bf16_f32 v112, v112, v113
 v_cvt_pk_bf16_f32 v113, v114, v115
M v[76:79], a[96:99], a[160:163], v[76:79]
 s_waitcnt lgkmcnt(0)
 v_cvt_pk_bf16_f32 v114, v120, v121
 v_cvt_pk_bf16_f32 v115, v122, v123
M v[80:83], a[64:67], a[128:131], v[32:35]
 ds_read_b128 a[96:99], v7 offset:57344
M v[80:83], a[68:71], a[132:135], v[80:83]
 ds_read_b128 a[100:103], v7 offset:58368
M v[80:83], a[72:75], a[136:139], v[80:83]
 buffer_store_dwordx4 v[112:115], v7, s[8:11], s29 offen offset:1024 sc1
M v[80:83], a[76:79], a[140:143], v[80:83]
 ds_read_b128 a[104:107], v7 offset:59392
 v_fma_f32 v116, v116, v6, v29
M v[80:83], a[80:83], a[144:147], v[80:83]
 ds_read_b128 a[108:111], v7 offset:60416
 v_fma_f32 v117, v117, v6, v29
M v[80:83], a[84:87], a[148:151], v[80:83]
 v_fma_f32 v118, v118, v6, v29
 v_fma_f32 v119, v119, v6, v29
M v[80:83], a[88:91], a[152:155], v[80:83]
 ds_read_b128 a[112:115], v7 offset:61440
 v_fma_f32 v124, v124, v6, v29
M v[80:83], a[92:95], a[156:159], v[80:83]
 ds_read_b128 a[116:119], v7 offset:62464
 v_fma_f32 v125, v125, v6, v29
M v[84:87], a[92:95], a[188:191], v[36:39]
 v_fma_f32 v126, v126, v6, v29
 v_fma_f32 v127, v127, v6, v29
M v[84:87], a[88:91], a[184:187], v[84:87]
 ds_read_b128 a[120:123], v7 offset:63488
 v_cvt_pk_bf16_f32 v116, v116, v117
M v[84:87], a[84:87], a[180:183], v[84:87]
 ds_read_b128 a[124:127], v7 offset:64512
 v_cvt_pk_bf16_f32 v117, v118, v119
M v[84:87], a[80:83], a[176:179], v[84:87]
 v_cvt_pk_bf16_f32 v118, v124, v125
 v_cvt_pk_bf16_f32 v119, v126, v127
M v[84:87], a[76:79], a[172:175], v[84:87]
 buffer_store_dwordx4 v[116:119], v7, s[8:11], s30 offen offset:1024 sc1
M v[84:87], a[72:75], a[168:171], v[84:87]
 s_add_u32 s29, s33, 12288
M v[84:87], a[68:71], a[164:167], v[84:87]
 s_add_u32 s30, s33, 26624
 v_fma_f32 v64, v64, v5, v28
 v_fma_f32 v65, v65, v5, v28
M v[84:87], a[64:67], a[160:163], v[84:87]
 s_waitcnt lgkmcnt(0)
 v_fma_f32 v66, v66, v5, v28
 v_fma_f32 v67, v67, v5, v28
M v[88:91], a[96:99], a[128:131], v[32:35]
 v_fma_f32 v72, v72, v5, v28
 v_fma_f32 v73, v73, v5, v28
M v[88:91], a[100:103], a[132:135], v[88:91]
 v_fma_f32 v74, v74, v5, v28
 v_fma_f32 v75, v75, v5, v28
M v[88:91], a[104:107], a[136:139], v[88:91]
 v_cvt_pk_bf16_f32 v64, v64, v65
 v_cvt_pk_bf16_f32 v65, v66, v67
M v[88:91], a[108:111], a[140:143], v[88:91]
 v_cvt_pk_bf16_f32 v66, v72, v73
 v_cvt_pk_bf16_f32 v67, v74, v75
M v[88:91], a[112:115], a[144:147], v[88:91]
 buffer_store_dwordx4 v[64:67], v7, s[8:11], s29 offen offset:0 sc1
M v[88:91], a[116:119], a[148:151], v[88:91]
 v_fma_f32 v68, v68, v6, v29
 v_fma_f32 v69, v69, v6, v29
M v[88:91], a[120:123], a[152:155], v[88:91]
 v_fma_f32 v70, v70, v6, v29
 v_fma_f32 v71, v71, v6, v29
M v[88:91], a[124:127], a[156:159], v[88:91]
 v_fma_f32 v76, v76, v6, v29
 v_fma_f32 v77, v77, v6, v29
M v[92:95], a[124:127], a[188:191], v[36:39]
 v_fma_f32 v78, v78, v6, v29
 v_fma_f32 v79, v79, v6, v29
M v[92:95], a[120:123], a[184:187], v[92:95]
 v_cvt_pk_bf16_f32 v68, v68, v69
 v_cvt_pk_bf16_f32 v69, v70, v71
M v[92:95], a[116:119], a[180:183], v[92:95]
 v_cvt_pk_bf16_f32 v70, v76, v77
 v_cvt_pk_bf16_f32 v71, v78, v79
M v[92:95], a[112:115], a[176:179], v[92:95]
 buffer_store_dwordx4 v[68:71], v7, s[8:11], s30 offen offset:0 sc1
M v[92:95], a[108:111], a[172:175], v[92:95]
M v[92:95], a[104:107], a[168:171], v[92:95]
M v[92:95], a[100:103], a[164:167], v[92:95]
M v[92:95], a[96:99], a[160:163], v[92:95]
 v_fma_f32 v80, v80, v5, v28
 v_fma_f32 v81, v81, v5, v28
 v_fma_f32 v82, v82, v5, v28
 v_fma_f32 v83, v83, v5, v28
 v_fma_f32 v88, v88, v5, v28
 v_fma_f32 v89, v89, v5, v28
 v_fma_f32 v90, v90, v5, v28
 v_fma_f32 v91, v91, v5, v28
 v_cvt_pk_bf16_f32 v80, v80, v81
 v_cvt_pk_bf16_f32 v81, v82, v83
 v_cvt_pk_bf16_f32 v82, v88, v89
 v_cvt_pk_bf16_f32 v83, v90, v91
 buffer_store_dwordx4 v[80:83], v7, s[8:11], s29 offen offset:1024 sc1
 v_fma_f32 v84, v84, v6, v29
 v_fma_f32 v85, v85, v6, v29
 v_fma_f32 v86, v86, v6, v29
 v_fma_f32 v87, v87, v6, v29
 v_fma_f32 v92, v92, v6, v29
 v_fma_f32 v93, v93, v6, v29
 v_fma_f32 v94, v94, v6, v29
 v_fma_f32 v95, v95, v6, v29
 v_cvt_pk_bf16_f32 v84, v84, v85
 v_cvt_pk_bf16_f32 v85, v86, v87
 v_cvt_pk_bf16_f32 v86, v92, v93
 v_cvt_pk_bf16_f32 v87, v94, v95
 buffer_store_dwordx4 v[84:87], v7, s[8:11], s30 offen offset:1024 sc1
L_red:
 s_lshl_b32 s64, s42, 1
 s_lshr_b32 s65, s41, 3
 s_add_u32 s46, s64, s65
 s_mul_i32 s46, s46, 4352
 s_and_b32 s72, s41, 7
 s_lshl_b32 s66, s72, 7
 s_add_u32 s46, s46, s66
 s_add_u32 s46, s46, 104992768
 v_and_b32 v14, 31, v0
 v_lshlrev_b32 v14, 2, v14
 buffer_load_dword v9, v14, s[8:11], s46 offen sc1
 s_mul_i32 s86, s65, 4
 s_add_u32 s86, s86, s20
 s_mul_i32 s77, s42, 1835008
 s_mul_i32 s78, s72, 14336
 s_add_u32 s77, s77, s78
 s_add_u32 s77, s77, 67108864
 s_sub_u32 s64, 15, s64
 s_sub_u32 s78, s64, 1
 s_mul_i32 s78, s78, 1835008
 s_add_u32 s78, s78, s77
 s_lshl_b32 s66, s86, 10
 s_add_u32 s78, s78, s66
 s_lshl_b32 s66, s74, 10
 s_add_u32 s77, s77, s66
 s_lshl_b32 s66, s64, 7
 s_lshl_b32 s86, s86, 6
 s_lshr_b32 s73, s72, 1
 s_sub_u32 s65, 7, s73
 s_bitcmp1_b32 s72, 0
 s_cselect_b32 s73, s65, s73
 s_lshl_b32 s73, s73, 4
 s_lshl_b32 s65, s42, 7
 s_add_u32 s73, s73, s65
 v_and_b32 v10, 15, v0
 v_add_u32 v10, s73, v10
 v_add_u32 v29, s66, v10
 s_mov_b32 s64, 104857664
 v_mul_u32_u24 v12, 896, v10
 v_lshl_add_u32 v12, v11, 4, v12
 v_lshrrev_b32 v13, 4, v10
 v_lshlrev_b32 v13, 5, v13
 v_and_b32 v104, 15, v10
 v_add_lshl_u32 v13, v13, v104, 2
 buffer_load_dword v15, v13, s[8:11], s64 offen sc1
 buffer_load_dwordx4 v[16:19], v12, s[56:59], s75 offen
 buffer_load_dwordx4 v[20:23], v12, s[56:59], s76 offen
 v_mov_b32 v48, 0
 v_mov_b32 v49, 0
 v_mov_b32 v50, 0
 v_mov_b32 v51, 0
 v_mov_b32 v52, 0
 v_mov_b32 v53, 0
 v_mov_b32 v54, 0
 v_mov_b32 v55, 0
 v_mov_b32 v56, 0
 v_mov_b32 v57, 0
 v_mov_b32 v58, 0
 v_mov_b32 v59, 0
 v_mov_b32 v60, 0
 v_mov_b32 v61, 0
 v_mov_b32 v62, 0
 v_mov_b32 v63, 0
 v_mul_u32_u24 v28, 896, v29
 v_lshl_add_u32 v28, v11, 4, v28
 v_lshrrev_b32 v13, 4, v29
 v_lshlrev_b32 v13, 5, v13
 v_and_b32 v104, 15, v29
 v_add_lshl_u32 v13, v13, v104, 2
 buffer_load_dword v26, v13, s[8:11], s64 offen sc1
 buffer_load_dwordx4 v[96:99], v28, s[56:59], s86 offen
 v_mov_b32 v64, 0
 v_mov_b32 v65, 0
 v_mov_b32 v66, 0
 v_mov_b32 v67, 0
 v_mov_b32 v68, 0
 v_mov_b32 v69, 0
 v_mov_b32 v70, 0
 v_mov_b32 v71, 0
 s_waitcnt vmcnt(6)
 buffer_store_dword v40, v41, s[8:11], s3 offen sc1
 s_waitcnt vmcnt(6)
 v_cmp_eq_u32 vcc, 1, v9
 s_mov_b32 s91, 65536
 s_mov_b32 s69, 0
 s_mov_b32 s70, vcc_lo
 s_mov_b32 s68, vcc_lo
 s_cmp_lg_u32 s70, 0
 s_cbranch_scc1 L_rk0
 s_call_b64 s[36:37], L_rpoll
L_rk0:
 s_ff1_i32_b32 s71, s70
 s_bitset0_b32 s70, s71
 s_cmp_ge_u32 s71, 16
 s_cselect_b32 s72, s78, s77
 s_cselect_b32 s73, 0x1, 0
 s_cselect_b32 s87, 536870912, 0
 s_mul_i32 s71, s71, 114688
 s_add_u32 s71, s71, s72
 buffer_load_dwordx4 v[128:131], v7, s[8:11], s71 offen sc1
 s_or_b32 s69, s69, s73
 s_or_b32 s71, s71, s87
 buffer_load_dwordx4 v[132:135], v27, s[8:11], s71 offen sc1
 s_cmp_lg_u32 s70, 0
 s_cbranch_scc1 L_rk1
 s_call_b64 s[36:37], L_rpoll
L_rk1:
 s_ff1_i32_b32 s71, s70
 s_bitset0_b32 s70, s71
 s_cmp_ge_u32 s71, 16
 s_cselect_b32 s72, s78, s77
 s_cselect_b32 s73, 0x2, 0
 s_cselect_b32 s87, 536870912, 0
 s_mul_i32 s71, s71, 114688
 s_add_u32 s71, s71, s72
 buffer_load_dwordx4 v[136:139], v7, s[8:11], s71 offen sc1
 s_or_b32 s69, s69, s73
 s_or_b32 s71, s71, s87
 buffer_load_dwordx4 v[140:143], v27, s[8:11], s71 offen sc1
 s_waitcnt vmcnt(8)
 v_lshlrev_b32 v32, 16, v16
 v_and_b32 v33, 0xffff0000, v16
 v_lshlrev_b32 v34, 16, v17
 v_and_b32 v35, 0xffff0000, v17
 v_lshlrev_b32 v36, 16, v18
 v_and_b32 v37, 0xffff0000, v18
 v_lshlrev_b32 v38, 16, v19
 v_and_b32 v39, 0xffff0000, v19
 s_waitcnt vmcnt(7)
 v_lshlrev_b32 v40, 16, v20
 v_and_b32 v41, 0xffff0000, v20
 v_lshlrev_b32 v42, 16, v21
 v_and_b32 v43, 0xffff0000, v21
 v_lshlrev_b32 v44, 16, v22
 v_and_b32 v45, 0xffff0000, v22
 v_lshlrev_b32 v46, 16, v23
 v_and_b32 v47, 0xffff0000, v23
 v_sub_f32 v13, 1.0, v15
 v_cmp_eq_u32 s[80:81], s84, v10
 v_cmp_eq_u32 s[82:83], s85, v10
 s_nop 0
 s_or_b64 vcc, s[80:81], s[82:83]
 s_cbranch_vccnz L_moe0
L_moe_ret0:
 v_mul_f32 v32, v13, v32
 v_mul_f32 v33, v13, v33
 v_mul_f32 v34, v13, v34
 v_mul_f32 v35, v13, v35
 v_mul_f32 v36, v13, v36
 v_mul_f32 v37, v13, v37
 v_mul_f32 v38, v13, v38
 v_mul_f32 v39, v13, v39
 v_mul_f32 v40, v13, v40
 v_mul_f32 v41, v13, v41
 v_mul_f32 v42, v13, v42
 v_mul_f32 v43, v13, v43
 v_mul_f32 v44, v13, v44
 v_mul_f32 v45, v13, v45
 v_mul_f32 v46, v13, v46
 v_mul_f32 v47, v13, v47
 s_cmp_lg_u32 s70, 0
 s_cbranch_scc1 L_rk2
 s_call_b64 s[36:37], L_rpoll
L_rk2:
 s_ff1_i32_b32 s71, s70
 s_bitset0_b32 s70, s71
 s_cmp_ge_u32 s71, 16
 s_cselect_b32 s72, s78, s77
 s_cselect_b32 s73, 0x4, 0
 s_cselect_b32 s87, 536870912, 0
 s_mul_i32 s71, s71, 114688
 s_add_u32 s71, s71, s72
 buffer_load_dwordx4 v[144:147], v7, s[8:11], s71 offen sc1
 s_or_b32 s69, s69, s73
 s_or_b32 s71, s71, s87
 buffer_load_dwordx4 v[148:151], v27, s[8:11], s71 offen sc1
 s_waitcnt vmcnt(7)
 v_lshlrev_b32 v80, 16, v96
 v_and_b32 v81, 0xffff0000, v96
 v_lshlrev_b32 v82, 16, v97
 v_and_b32 v83, 0xffff0000, v97
 v_lshlrev_b32 v84, 16, v98
 v_and_b32 v85, 0xffff0000, v98
 v_lshlrev_b32 v86, 16, v99
 v_and_b32 v87, 0xffff0000, v99
 v_sub_f32 v13, 1.0, v26
 v_cmp_eq_u32 s[80:81], s84, v29
 v_cmp_eq_u32 s[82:83], s85, v29
 s_nop 0
 s_or_b64 vcc, s[80:81], s[82:83]
 s_cbranch_vccnz L_moe1
L_moe_ret1:
 v_mul_f32 v80, v13, v80
 v_mul_f32 v81, v13, v81
 v_mul_f32 v82, v13, v82
 v_mul_f32 v83, v13, v83
 v_mul_f32 v84, v13, v84
 v_mul_f32 v85, v13, v85
 v_mul_f32 v86, v13, v86
 v_mul_f32 v87, v13, v87
 s_cmp_lg_u32 s70, 0
 s_cbranch_scc1 L_rk3
 s_call_b64 s[36:37], L_rpoll
L_rk3:
 s_ff1_i32_b32 s71, s70
 s_bitset0_b32 s70, s71
 s_cmp_ge_u32 s71, 16
 s_cselect_b32 s72, s78, s77
 s_cselect_b32 s73, 0x8, 0
 s_cselect_b32 s87, 536870912, 0
 s_mul_i32 s71, s71, 114688
 s_add_u32 s71, s71, s72
 buffer_load_dwordx4 v[152:155], v7, s[8:11], s71 offen sc1
 s_or_b32 s69, s69, s73
 s_or_b32 s71, s71, s87
 buffer_load_dwordx4 v[156:159], v27, s[8:11], s71 offen sc1
 s_cmp_lg_u32 s70, 0
 s_cbranch_scc1 L_rk4
 s_call_b64 s[36:37], L_rpoll
L_rk4:
 s_ff1_i32_b32 s71, s70
 s_bitset0_b32 s70, s71
 s_cmp_ge_u32 s71, 16
 s_cselect_b32 s72, s78, s77
 s_cselect_b32 s73, 0x10, 0
 s_cselect_b32 s87, 536870912, 0
 s_mul_i32 s71, s71, 114688
 s_add_u32 s71, s71, s72
 buffer_load_dwordx4 v[160:163], v7, s[8:11], s71 offen sc1
 s_or_b32 s69, s69, s73
 s_or_b32 s71, s71, s87
 buffer_load_dwordx4 v[164:167], v27, s[8:11], s71 offen sc1
 s_cmp_lg_u32 s70, 0
 s_cbranch_scc1 L_rk5
 s_call_b64 s[36:37], L_rpoll
L_rk5:
 s_ff1_i32_b32 s71, s70
 s_bitset0_b32 s70, s71
 s_cmp_ge_u32 s71, 16
 s_cselect_b32 s72, s78, s77
 s_cselect_b32 s73, 0x20, 0
 s_cselect_b32 s87, 536870912, 0
 s_mul_i32 s71, s71, 114688
 s_add_u32 s71, s71, s72
 buffer_load_dwordx4 v[168:171], v7, s[8:11], s71 offen sc1
 s_or_b32 s69, s69, s73
 s_or_b32 s71, s71, s87
 buffer_load_dwordx4 v[172:175], v27, s[8:11], s71 offen sc1
 s_cmp_lg_u32 s70, 0
 s_cbranch_scc1 L_rk6
 s_call_b64 s[36:37], L_rpoll
L_rk6:
 s_ff1_i32_b32 s71, s70
 s_bitset0_b32 s70, s71
 s_cmp_ge_u32 s71, 16
 s_cselect_b32 s72, s78, s77
 s_cselect_b32 s73, 0x40, 0
 s_cselect_b32 s87, 536870912, 0
 s_mul_i32 s71, s71, 114688
 s_add_u32 s71, s71, s72
 buffer_load_dwordx4 v[176:179], v7, s[8:11], s71 offen sc1
 s_or_b32 s69, s69, s73
 s_or_b32 s71, s71, s87
 buffer_load_dwordx4 v[180:183], v27, s[8:11], s71 offen sc1
 s_cmp_lg_u32 s70, 0
 s_cbranch_scc1 L_rk7
 s_call_b64 s[36:37], L_rpoll
L_rk7:
 s_ff1_i32_b32 s71, s70
 s_bitset0_b32 s70, s71
 s_cmp_ge_u32 s71, 16
 s_cselect_b32 s72, s78, s77
 s_cselect_b32 s73, 0x80, 0
 s_cselect_b32 s87, 536870912, 0
 s_mul_i32 s71, s71, 114688
 s_add_u32 s71, s71, s72
 buffer_load_dwordx4 v[184:187], v7, s[8:11], s71 offen sc1
 s_or_b32 s69, s69, s73
 s_or_b32 s71, s71, s87
 buffer_load_dwordx4 v[188:191], v27, s[8:11], s71 offen sc1
 s_cmp_lg_u32 s70, 0
 s_cbranch_scc1 L_rk8
 s_call_b64 s[36:37], L_rpoll
L_rk8:
 s_ff1_i32_b32 s71, s70
 s_bitset0_b32 s70, s71
 s_cmp_ge_u32 s71, 16
 s_cselect_b32 s72, s78, s77
 s_cselect_b32 s73, 0x100, 0
 s_cselect_b32 s87, 536870912, 0
 s_mul_i32 s71, s71, 114688
 s_add_u32 s71, s71, s72
 buffer_load_dwordx4 v[192:195], v7, s[8:11], s71 offen sc1
 s_or_b32 s69, s69, s73
 s_or_b32 s71, s71, s87
 buffer_load_dwordx4 v[196:199], v27, s[8:11], s71 offen sc1
 s_waitcnt vmcnt(16)
 s_bitcmp1_b32 s69, 0
 s_cbranch_scc1 L_rx0
 v_dot2c_f32_bf16 v48, v128, v24
 v_dot2c_f32_bf16 v49, v128, v25
 v_dot2c_f32_bf16 v50, v129, v24
 v_dot2c_f32_bf16 v51, v129, v25
 v_dot2c_f32_bf16 v52, v130, v24
 v_dot2c_f32_bf16 v53, v130, v25
 v_dot2c_f32_bf16 v54, v131, v24
 v_dot2c_f32_bf16 v55, v131, v25
 v_dot2c_f32_bf16 v56, v132, v24
 v_dot2c_f32_bf16 v57, v132, v25
 v_dot2c_f32_bf16 v58, v133, v24
 v_dot2c_f32_bf16 v59, v133, v25
 v_dot2c_f32_bf16 v60, v134, v24
 v_dot2c_f32_bf16 v61, v134, v25
 v_dot2c_f32_bf16 v62, v135, v24
 v_dot2c_f32_bf16 v63, v135, v25
L_ry0:
 s_cmp_lg_u32 s70, 0
 s_cbranch_scc1 L_rk9
 s_call_b64 s[36:37], L_rpoll
L_rk9:
 s_ff1_i32_b32 s71, s70
 s_bitset0_b32 s70, s71
 s_cmp_ge_u32 s71, 16
 s_cselect_b32 s72, s78, s77
 s_cselect_b32 s73, 0x200, 0
 s_cselect_b32 s87, 536870912, 0
 s_mul_i32 s71, s71, 114688
 s_add_u32 s71, s71, s72
 buffer_load_dwordx4 v[200:203], v7, s[8:11], s71 offen sc1
 s_or_b32 s69, s69, s73
 s_or_b32 s71, s71, s87
 buffer_load_dwordx4 v[204:207], v27, s[8:11], s71 offen sc1
 s_waitcnt vmcnt(16)
 s_bitcmp1_b32 s69, 1
 s_cbranch_scc1 L_rx1
 v_dot2c_f32_bf16 v48, v136, v24
 v_dot2c_f32_bf16 v49, v136, v25
 v_dot2c_f32_bf16 v50, v137, v24
 v_dot2c_f32_bf16 v51, v137, v25
 v_dot2c_f32_bf16 v52, v138, v24
 v_dot2c_f32_bf16 v53, v138, v25
 v_dot2c_f32_bf16 v54, v139, v24
 v_dot2c_f32_bf16 v55, v139, v25
 v_dot2c_f32_bf16 v56, v140, v24
 v_dot2c_f32_bf16 v57, v140, v25
 v_dot2c_f32_bf16 v58, v141, v24
 v_dot2c_f32_bf16 v59, v141, v25
 v_dot2c_f32_bf16 v60, v142, v24
 v_dot2c_f32_bf16 v61, v142, v25
 v_dot2c_f32_bf16 v62, v143, v24
 v_dot2c_f32_bf16 v63, v143, v25
L_ry1:
 s_cmp_lg_u32 s70, 0
 s_cbranch_scc1 L_rk10
 s_call_b64 s[36:37], L_rpoll
L_rk10:
 s_ff1_i32_b32 s71, s70
 s_bitset0_b32 s70, s71
 s_cmp_ge_u32 s71, 16
 s_cselect_b32 s72, s78, s77
 s_cselect_b32 s73, 0x400, 0
 s_cselect_b32 s87, 536870912, 0
 s_mul_i32 s71, s71, 114688
 s_add_u32 s71, s71, s72
 buffer_load_dwordx4 v[208:211], v7, s[8:11], s71 offen sc1
 s_or_b32 s69, s69, s73
 s_or_b32 s71, s71, s87
 buffer_load_dwordx4 v[212:215], v27, s[8:11], s71 offen sc1
 s_waitcnt vmcnt(16)
 s_bitcmp1_b32 s69, 2
 s_cbranch_scc1 L_rx2
 v_dot2c_f32_bf16 v48, v144, v24
 v_dot2c_f32_bf16 v49, v144, v25
 v_dot2c_f32_bf16 v50, v145, v24
 v_dot2c_f32_bf16 v51, v145, v25
 v_dot2c_f32_bf16 v52, v146, v24
 v_dot2c_f32_bf16 v53, v146, v25
 v_dot2c_f32_bf16 v54, v147, v24
 v_dot2c_f32_bf16 v55, v147, v25
 v_dot2c_f32_bf16 v56, v148, v24
 v_dot2c_f32_bf16 v57, v148, v25
 v_dot2c_f32_bf16 v58, v149, v24
 v_dot2c_f32_bf16 v59, v149, v25
 v_dot2c_f32_bf16 v60, v150, v24
 v_dot2c_f32_bf16 v61, v150, v25
 v_dot2c_f32_bf16 v62, v151, v24
 v_dot2c_f32_bf16 v63, v151, v25
L_ry2:
 s_cmp_lg_u32 s70, 0
 s_cbranch_scc1 L_rk11
 s_call_b64 s[36:37], L_rpoll
L_rk11:
 s_ff1_i32_b32 s71, s70
 s_bitset0_b32 s70, s71
 s_cmp_ge_u32 s71, 16
 s_cselect_b32 s72, s78, s77
 s_cselect_b32 s73, 0x800, 0
 s_cselect_b32 s87, 536870912, 0
 s_mul_i32 s71, s71, 114688
 s_add_u32 s71, s71, s72
 buffer_load_dwordx4 v[216:219], v7, s[8:11], s71 offen sc1
 s_or_b32 s69, s69, s73
 s_or_b32 s71, s71, s87
 buffer_load_dwordx4 v[220:223], v27, s[8:11], s71 offen sc1
 s_waitcnt vmcnt(16)
 s_bitcmp1_b32 s69, 3
 s_cbranch_scc1 L_rx3
 v_dot2c_f32_bf16 v48, v152, v24
 v_dot2c_f32_bf16 v49, v152, v25
 v_dot2c_f32_bf16 v50, v153, v24
 v_dot2c_f32_bf16 v51, v153, v25
 v_dot2c_f32_bf16 v52, v154, v24
 v_dot2c_f32_bf16 v53, v154, v25
 v_dot2c_f32_bf16 v54, v155, v24
 v_dot2c_f32_bf16 v55, v155, v25
 v_dot2c_f32_bf16 v56, v156, v24
 v_dot2c_f32_bf16 v57, v156, v25
 v_dot2c_f32_bf16 v58, v157, v24
 v_dot2c_f32_bf16 v59, v157, v25
 v_dot2c_f32_bf16 v60, v158, v24
 v_dot2c_f32_bf16 v61, v158, v25
 v_dot2c_f32_bf16 v62, v159, v24
 v_dot2c_f32_bf16 v63, v159, v25
L_ry3:
 s_cmp_lg_u32 s70, 0
 s_cbranch_scc1 L_rk12
 s_call_b64 s[36:37], L_rpoll
L_rk12:
 s_ff1_i32_b32 s71, s70
 s_bitset0_b32 s70, s71
 s_cmp_ge_u32 s71, 16
 s_cselect_b32 s72, s78, s77
 s_cselect_b32 s73, 0x1000, 0
 s_cselect_b32 s87, 536870912, 0
 s_mul_i32 s71, s71, 114688
 s_add_u32 s71, s71, s72
 buffer_load_dwordx4 v[224:227], v7, s[8:11], s71 offen sc1
 s_or_b32 s69, s69, s73
 s_or_b32 s71, s71, s87
 buffer_load_dwordx4 v[228:231], v27, s[8:11], s71 offen sc1
 s_waitcnt vmcnt(16)
 s_bitcmp1_b32 s69, 4
 s_cbranch_scc1 L_rx4
 v_dot2c_f32_bf16 v48, v160, v24
 v_dot2c_f32_bf16 v49, v160, v25
 v_dot2c_f32_bf16 v50, v161, v24
 v_dot2c_f32_bf16 v51, v161, v25
 v_dot2c_f32_bf16 v52, v162, v24
 v_dot2c_f32_bf16 v53, v162, v25
 v_dot2c_f32_bf16 v54, v163, v24
 v_dot2c_f32_bf16 v55, v163, v25
 v_dot2c_f32_bf16 v56, v164, v24
 v_dot2c_f32_bf16 v57, v164, v25
 v_dot2c_f32_bf16 v58, v165, v24
 v_dot2c_f32_bf16 v59, v165, v25
 v_dot2c_f32_bf16 v60, v166, v24
 v_dot2c_f32_bf16 v61, v166, v25
 v_dot2c_f32_bf16 v62, v167, v24
 v_dot2c_f32_bf16 v63, v167, v25
L_ry4:
 s_cmp_lg_u32 s70, 0
 s_cbranch_scc1 L_rk13
 s_call_b64 s[36:37], L_rpoll
L_rk13:
 s_ff1_i32_b32 s71, s70
 s_bitset0_b32 s70, s71
 s_cmp_ge_u32 s71, 16
 s_cselect_b32 s72, s78, s77
 s_cselect_b32 s73, 0x2000, 0
 s_cselect_b32 s87, 536870912, 0
 s_mul_i32 s71, s71, 114688
 s_add_u32 s71, s71, s72
 buffer_load_dwordx4 v[232:235], v7, s[8:11], s71 offen sc1
 s_or_b32 s69, s69, s73
 s_or_b32 s71, s71, s87
 buffer_load_dwordx4 v[236:239], v27, s[8:11], s71 offen sc1
 s_waitcnt vmcnt(16)
 s_bitcmp1_b32 s69, 5
 s_cbranch_scc1 L_rx5
 v_dot2c_f32_bf16 v48, v168, v24
 v_dot2c_f32_bf16 v49, v168, v25
 v_dot2c_f32_bf16 v50, v169, v24
 v_dot2c_f32_bf16 v51, v169, v25
 v_dot2c_f32_bf16 v52, v170, v24
 v_dot2c_f32_bf16 v53, v170, v25
 v_dot2c_f32_bf16 v54, v171, v24
 v_dot2c_f32_bf16 v55, v171, v25
 v_dot2c_f32_bf16 v56, v172, v24
 v_dot2c_f32_bf16 v57, v172, v25
 v_dot2c_f32_bf16 v58, v173, v24
 v_dot2c_f32_bf16 v59, v173, v25
 v_dot2c_f32_bf16 v60, v174, v24
 v_dot2c_f32_bf16 v61, v174, v25
 v_dot2c_f32_bf16 v62, v175, v24
 v_dot2c_f32_bf16 v63, v175, v25
L_ry5:
 s_cmp_lg_u32 s70, 0
 s_cbranch_scc1 L_rk14
 s_call_b64 s[36:37], L_rpoll
L_rk14:
 s_ff1_i32_b32 s71, s70
 s_bitset0_b32 s70, s71
 s_cmp_ge_u32 s71, 16
 s_cselect_b32 s72, s78, s77
 s_cselect_b32 s73, 0x4000, 0
 s_cselect_b32 s87, 536870912, 0
 s_mul_i32 s71, s71, 114688
 s_add_u32 s71, s71, s72
 buffer_load_dwordx4 v[240:243], v7, s[8:11], s71 offen sc1
 s_or_b32 s69, s69, s73
 s_or_b32 s71, s71, s87
 buffer_load_dwordx4 v[244:247], v27, s[8:11], s71 offen sc1
 s_waitcnt vmcnt(16)
 s_bitcmp1_b32 s69, 6
 s_cbranch_scc1 L_rx6
 v_dot2c_f32_bf16 v48, v176, v24
 v_dot2c_f32_bf16 v49, v176, v25
 v_dot2c_f32_bf16 v50, v177, v24
 v_dot2c_f32_bf16 v51, v177, v25
 v_dot2c_f32_bf16 v52, v178, v24
 v_dot2c_f32_bf16 v53, v178, v25
 v_dot2c_f32_bf16 v54, v179, v24
 v_dot2c_f32_bf16 v55, v179, v25
 v_dot2c_f32_bf16 v56, v180, v24
 v_dot2c_f32_bf16 v57, v180, v25
 v_dot2c_f32_bf16 v58, v181, v24
 v_dot2c_f32_bf16 v59, v181, v25
 v_dot2c_f32_bf16 v60, v182, v24
 v_dot2c_f32_bf16 v61, v182, v25
 v_dot2c_f32_bf16 v62, v183, v24
 v_dot2c_f32_bf16 v63, v183, v25
L_ry6:
 s_cmp_lg_u32 s70, 0
 s_cbranch_scc1 L_rk15
 s_call_b64 s[36:37], L_rpoll
L_rk15:
 s_ff1_i32_b32 s71, s70
 s_bitset0_b32 s70, s71
 s_cmp_ge_u32 s71, 16
 s_cselect_b32 s72, s78, s77
 s_cselect_b32 s73, 0x8000, 0
 s_cselect_b32 s87, 536870912, 0
 s_mul_i32 s71, s71, 114688
 s_add_u32 s71, s71, s72
 buffer_load_dwordx4 v[248:251], v7, s[8:11], s71 offen sc1
 s_or_b32 s69, s69, s73
 s_or_b32 s71, s71, s87
 buffer_load_dwordx4 v[252:255], v27, s[8:11], s71 offen sc1
 s_waitcnt vmcnt(16)
 s_bitcmp1_b32 s69, 7
 s_cbranch_scc1 L_rx7
 v_dot2c_f32_bf16 v48, v184, v24
 v_dot2c_f32_bf16 v49, v184, v25
 v_dot2c_f32_bf16 v50, v185, v24
 v_dot2c_f32_bf16 v51, v185, v25
 v_dot2c_f32_bf16 v52, v186, v24
 v_dot2c_f32_bf16 v53, v186, v25
 v_dot2c_f32_bf16 v54, v187, v24
 v_dot2c_f32_bf16 v55, v187, v25
 v_dot2c_f32_bf16 v56, v188, v24
 v_dot2c_f32_bf16 v57, v188, v25
 v_dot2c_f32_bf16 v58, v189, v24
 v_dot2c_f32_bf16 v59, v189, v25
 v_dot2c_f32_bf16 v60, v190, v24
 v_dot2c_f32_bf16 v61, v190, v25
 v_dot2c_f32_bf16 v62, v191, v24
 v_dot2c_f32_bf16 v63, v191, v25
L_ry7:
 s_cmp_lg_u32 s70, 0
 s_cbranch_scc1 L_rk16
 s_call_b64 s[36:37], L_rpoll
L_rk16:
 s_ff1_i32_b32 s71, s70
 s_bitset0_b32 s70, s71
 s_cmp_ge_u32 s71, 16
 s_cselect_b32 s72, s78, s77
 s_cselect_b32 s73, 0x10000, 0
 s_cselect_b32 s87, 536870912, 0
 s_mul_i32 s71, s71, 114688
 s_add_u32 s71, s71, s72
 buffer_load_dwordx4 v[128:131], v7, s[8:11], s71 offen sc1
 s_or_b32 s69, s69, s73
 s_or_b32 s71, s71, s87
 buffer_load_dwordx4 v[132:135], v27, s[8:11], s71 offen sc1
 s_waitcnt vmcnt(16)
 s_bitcmp1_b32 s69, 8
 s_cbranch_scc1 L_rx8
 v_dot2c_f32_bf16 v48, v192, v24
 v_dot2c_f32_bf16 v49, v192, v25
 v_dot2c_f32_bf16 v50, v193, v24
 v_dot2c_f32_bf16 v51, v193, v25
 v_dot2c_f32_bf16 v52, v194, v24
 v_dot2c_f32_bf16 v53, v194, v25
 v_dot2c_f32_bf16 v54, v195, v24
 v_dot2c_f32_bf16 v55, v195, v25
 v_dot2c_f32_bf16 v56, v196, v24
 v_dot2c_f32_bf16 v57, v196, v25
 v_dot2c_f32_bf16 v58, v197, v24
 v_dot2c_f32_bf16 v59, v197, v25
 v_dot2c_f32_bf16 v60, v198, v24
 v_dot2c_f32_bf16 v61, v198, v25
 v_dot2c_f32_bf16 v62, v199, v24
 v_dot2c_f32_bf16 v63, v199, v25
L_ry8:
 s_cmp_lg_u32 s70, 0
 s_cbranch_scc1 L_rk17
 s_call_b64 s[36:37], L_rpoll
L_rk17:
 s_ff1_i32_b32 s71, s70
 s_bitset0_b32 s70, s71
 s_cmp_ge_u32 s71, 16
 s_cselect_b32 s72, s78, s77
 s_cselect_b32 s73, 0x20000, 0
 s_cselect_b32 s87, 536870912, 0
 s_mul_i32 s71, s71, 114688
 s_add_u32 s71, s71, s72
 buffer_load_dwordx4 v[136:139], v7, s[8:11], s71 offen sc1
 s_or_b32 s69, s69, s73
 s_or_b32 s71, s71, s87
 buffer_load_dwordx4 v[140:143], v27, s[8:11], s71 offen sc1
 s_waitcnt vmcnt(16)
 s_bitcmp1_b32 s69, 9
 s_cbranch_scc1 L_rx9
 v_dot2c_f32_bf16 v48, v200, v24
 v_dot2c_f32_bf16 v49, v200, v25
 v_dot2c_f32_bf16 v50, v201, v24
 v_dot2c_f32_bf16 v51, v201, v25
 v_dot2c_f32_bf16 v52, v202, v24
 v_dot2c_f32_bf16 v53, v202, v25
 v_dot2c_f32_bf16 v54, v203, v24
 v_dot2c_f32_bf16 v55, v203, v25
 v_dot2c_f32_bf16 v56, v204, v24
 v_dot2c_f32_bf16 v57, v204, v25
 v_dot2c_f32_bf16 v58, v205, v24
 v_dot2c_f32_bf16 v59, v205, v25
 v_dot2c_f32_bf16 v60, v206, v24
 v_dot2c_f32_bf16 v61, v206, v25
 v_dot2c_f32_bf16 v62, v207, v24
 v_dot2c_f32_bf16 v63, v207, v25
L_ry9:
 s_cmp_lg_u32 s70, 0
 s_cbranch_scc1 L_rk18
 s_call_b64 s[36:37], L_rpoll
L_rk18:
 s_ff1_i32_b32 s71, s70
 s_bitset0_b32 s70, s71
 s_cmp_ge_u32 s71, 16
 s_cselect_b32 s72, s78, s77
 s_cselect_b32 s73, 0x40000, 0
 s_cselect_b32 s87, 536870912, 0
 s_mul_i32 s71, s71, 114688
 s_add_u32 s71, s71, s72
 buffer_load_dwordx4 v[144:147], v7, s[8:11], s71 offen sc1
 s_or_b32 s69, s69, s73
 s_or_b32 s71, s71, s87
 buffer_load_dwordx4 v[148:151], v27, s[8:11], s71 offen sc1
 s_waitcnt vmcnt(16)
 s_bitcmp1_b32 s69, 10
 s_cbranch_scc1 L_rx10
 v_dot2c_f32_bf16 v48, v208, v24
 v_dot2c_f32_bf16 v49, v208, v25
 v_dot2c_f32_bf16 v50, v209, v24
 v_dot2c_f32_bf16 v51, v209, v25
 v_dot2c_f32_bf16 v52, v210, v24
 v_dot2c_f32_bf16 v53, v210, v25
 v_dot2c_f32_bf16 v54, v211, v24
 v_dot2c_f32_bf16 v55, v211, v25
 v_dot2c_f32_bf16 v56, v212, v24
 v_dot2c_f32_bf16 v57, v212, v25
 v_dot2c_f32_bf16 v58, v213, v24
 v_dot2c_f32_bf16 v59, v213, v25
 v_dot2c_f32_bf16 v60, v214, v24
 v_dot2c_f32_bf16 v61, v214, v25
 v_dot2c_f32_bf16 v62, v215, v24
 v_dot2c_f32_bf16 v63, v215, v25
L_ry10:
 s_cmp_lg_u32 s70, 0
 s_cbranch_scc1 L_rk19
 s_call_b64 s[36:37], L_rpoll
L_rk19:
 s_ff1_i32_b32 s71, s70
 s_bitset0_b32 s70, s71
 s_cmp_ge_u32 s71, 16
 s_cselect_b32 s72, s78, s77
 s_cselect_b32 s73, 0x80000, 0
 s_cselect_b32 s87, 536870912, 0
 s_mul_i32 s71, s71, 114688
 s_add_u32 s71, s71, s72
 buffer_load_dwordx4 v[152:155], v7, s[8:11], s71 offen sc1
 s_or_b32 s69, s69, s73
 s_or_b32 s71, s71, s87
 buffer_load_dwordx4 v[156:159], v27, s[8:11], s71 offen sc1
 s_waitcnt vmcnt(16)
 s_bitcmp1_b32 s69, 11
 s_cbranch_scc1 L_rx11
 v_dot2c_f32_bf16 v48, v216, v24
 v_dot2c_f32_bf16 v49, v216, v25
 v_dot2c_f32_bf16 v50, v217, v24
 v_dot2c_f32_bf16 v51, v217, v25
 v_dot2c_f32_bf16 v52, v218, v24
 v_dot2c_f32_bf16 v53, v218, v25
 v_dot2c_f32_bf16 v54, v219, v24
 v_dot2c_f32_bf16 v55, v219, v25
 v_dot2c_f32_bf16 v56, v220, v24
 v_dot2c_f32_bf16 v57, v220, v25
 v_dot2c_f32_bf16 v58, v221, v24
 v_dot2c_f32_bf16 v59, v221, v25
 v_dot2c_f32_bf16 v60, v222, v24
 v_dot2c_f32_bf16 v61, v222, v25
 v_dot2c_f32_bf16 v62, v223, v24
 v_dot2c_f32_bf16 v63, v223, v25
L_ry11:
 s_cmp_lg_u32 s70, 0
 s_cbranch_scc1 L_rk20
 s_call_b64 s[36:37], L_rpoll
L_rk20:
 s_ff1_i32_b32 s71, s70
 s_bitset0_b32 s70, s71
 s_cmp_ge_u32 s71, 16
 s_cselect_b32 s72, s78, s77
 s_cselect_b32 s73, 0x100000, 0
 s_cselect_b32 s87, 536870912, 0
 s_mul_i32 s71, s71, 114688
 s_add_u32 s71, s71, s72
 buffer_load_dwordx4 v[160:163], v7, s[8:11], s71 offen sc1
 s_or_b32 s69, s69, s73
 s_or_b32 s71, s71, s87
 buffer_load_dwordx4 v[164:167], v27, s[8:11], s71 offen sc1
 s_waitcnt vmcnt(16)
 s_bitcmp1_b32 s69, 12
 s_cbranch_scc1 L_rx12
 v_dot2c_f32_bf16 v48, v224, v24
 v_dot2c_f32_bf16 v49, v224, v25
 v_dot2c_f32_bf16 v50, v225, v24
 v_dot2c_f32_bf16 v51, v225, v25
 v_dot2c_f32_bf16 v52, v226, v24
 v_dot2c_f32_bf16 v53, v226, v25
 v_dot2c_f32_bf16 v54, v227, v24
 v_dot2c_f32_bf16 v55, v227, v25
 v_dot2c_f32_bf16 v56, v228, v24
 v_dot2c_f32_bf16 v57, v228, v25
 v_dot2c_f32_bf16 v58, v229, v24
 v_dot2c_f32_bf16 v59, v229, v25
 v_dot2c_f32_bf16 v60, v230, v24
 v_dot2c_f32_bf16 v61, v230, v25
 v_dot2c_f32_bf16 v62, v231, v24
 v_dot2c_f32_bf16 v63, v231, v25
L_ry12:
 s_cmp_lg_u32 s70, 0
 s_cbranch_scc1 L_rk21
 s_call_b64 s[36:37], L_rpoll
L_rk21:
 s_ff1_i32_b32 s71, s70
 s_bitset0_b32 s70, s71
 s_cmp_ge_u32 s71, 16
 s_cselect_b32 s72, s78, s77
 s_cselect_b32 s73, 0x200000, 0
 s_cselect_b32 s87, 536870912, 0
 s_mul_i32 s71, s71, 114688
 s_add_u32 s71, s71, s72
 buffer_load_dwordx4 v[168:171], v7, s[8:11], s71 offen sc1
 s_or_b32 s69, s69, s73
 s_or_b32 s71, s71, s87
 buffer_load_dwordx4 v[172:175], v27, s[8:11], s71 offen sc1
 s_waitcnt vmcnt(16)
 s_bitcmp1_b32 s69, 13
 s_cbranch_scc1 L_rx13
 v_dot2c_f32_bf16 v48, v232, v24
 v_dot2c_f32_bf16 v49, v232, v25
 v_dot2c_f32_bf16 v50, v233, v24
 v_dot2c_f32_bf16 v51, v233, v25
 v_dot2c_f32_bf16 v52, v234, v24
 v_dot2c_f32_bf16 v53, v234, v25
 v_dot2c_f32_bf16 v54, v235, v24
 v_dot2c_f32_bf16 v55, v235, v25
 v_dot2c_f32_bf16 v56, v236, v24
 v_dot2c_f32_bf16 v57, v236, v25
 v_dot2c_f32_bf16 v58, v237, v24
 v_dot2c_f32_bf16 v59, v237, v25
 v_dot2c_f32_bf16 v60, v238, v24
 v_dot2c_f32_bf16 v61, v238, v25
 v_dot2c_f32_bf16 v62, v239, v24
 v_dot2c_f32_bf16 v63, v239, v25
L_ry13:
 s_cmp_lg_u32 s70, 0
 s_cbranch_scc1 L_rk22
 s_call_b64 s[36:37], L_rpoll
L_rk22:
 s_ff1_i32_b32 s71, s70
 s_bitset0_b32 s70, s71
 s_cmp_ge_u32 s71, 16
 s_cselect_b32 s72, s78, s77
 s_cselect_b32 s73, 0x400000, 0
 s_cselect_b32 s87, 536870912, 0
 s_mul_i32 s71, s71, 114688
 s_add_u32 s71, s71, s72
 buffer_load_dwordx4 v[176:179], v7, s[8:11], s71 offen sc1
 s_or_b32 s69, s69, s73
 s_or_b32 s71, s71, s87
 buffer_load_dwordx4 v[180:183], v27, s[8:11], s71 offen sc1
 s_waitcnt vmcnt(16)
 s_bitcmp1_b32 s69, 14
 s_cbranch_scc1 L_rx14
 v_dot2c_f32_bf16 v48, v240, v24
 v_dot2c_f32_bf16 v49, v240, v25
 v_dot2c_f32_bf16 v50, v241, v24
 v_dot2c_f32_bf16 v51, v241, v25
 v_dot2c_f32_bf16 v52, v242, v24
 v_dot2c_f32_bf16 v53, v242, v25
 v_dot2c_f32_bf16 v54, v243, v24
 v_dot2c_f32_bf16 v55, v243, v25
 v_dot2c_f32_bf16 v56, v244, v24
 v_dot2c_f32_bf16 v57, v244, v25
 v_dot2c_f32_bf16 v58, v245, v24
 v_dot2c_f32_bf16 v59, v245, v25
 v_dot2c_f32_bf16 v60, v246, v24
 v_dot2c_f32_bf16 v61, v246, v25
 v_dot2c_f32_bf16 v62, v247, v24
 v_dot2c_f32_bf16 v63, v247, v25
L_ry14:
 s_cmp_lg_u32 s70, 0
 s_cbranch_scc1 L_rk23
 s_call_b64 s[36:37], L_rpoll
L_rk23:
 s_ff1_i32_b32 s71, s70
 s_bitset0_b32 s70, s71
 s_cmp_ge_u32 s71, 16
 s_cselect_b32 s72, s78, s77
 s_cselect_b32 s73, 0x800000, 0
 s_cselect_b32 s87, 536870912, 0
 s_mul_i32 s71, s71, 114688
 s_add_u32 s71, s71, s72
 buffer_load_dwordx4 v[184:187], v7, s[8:11], s71 offen sc1
 s_or_b32 s69, s69, s73
 s_or_b32 s71, s71, s87
 buffer_load_dwordx4 v[188:191], v27, s[8:11], s71 offen sc1
 s_waitcnt vmcnt(16)
 s_bitcmp1_b32 s69, 15
 s_cbranch_scc1 L_rx15
 v_dot2c_f32_bf16 v48, v248, v24
 v_dot2c_f32_bf16 v49, v248, v25
 v_dot2c_f32_bf16 v50, v249, v24
 v_dot2c_f32_bf16 v51, v249, v25
 v_dot2c_f32_bf16 v52, v250, v24
 v_dot2c_f32_bf16 v53, v250, v25
 v_dot2c_f32_bf16 v54, v251, v24
 v_dot2c_f32_bf16 v55, v251, v25
 v_dot2c_f32_bf16 v56, v252, v24
 v_dot2c_f32_bf16 v57, v252, v25
 v_dot2c_f32_bf16 v58, v253, v24
 v_dot2c_f32_bf16 v59, v253, v25
 v_dot2c_f32_bf16 v60, v254, v24
 v_dot2c_f32_bf16 v61, v254, v25
 v_dot2c_f32_bf16 v62, v255, v24
 v_dot2c_f32_bf16 v63, v255, v25
L_ry15:
 s_cmp_lg_u32 s70, 0
 s_cbranch_scc1 L_rk24
 s_call_b64 s[36:37], L_rpoll
L_rk24:
 s_ff1_i32_b32 s71, s70
 s_bitset0_b32 s70, s71
 s_cmp_ge_u32 s71, 16
 s_cselect_b32 s72, s78, s77
 s_cselect_b32 s73, 0x1000000, 0
 s_cselect_b32 s87, 536870912, 0
 s_mul_i32 s71, s71, 114688
 s_add_u32 s71, s71, s72
 buffer_load_dwordx4 v[192:195], v7, s[8:11], s71 offen sc1
 s_or_b32 s69, s69, s73
 s_or_b32 s71, s71, s87
 buffer_load_dwordx4 v[196:199], v27, s[8:11], s71 offen sc1
 s_waitcnt vmcnt(16)
 s_bitcmp0_b32 s69, 16
 s_cbranch_scc1 L_rx16
 v_dot2c_f32_bf16 v64, v128, v24
 v_dot2c_f32_bf16 v65, v128, v25
 v_dot2c_f32_bf16 v66, v129, v24
 v_dot2c_f32_bf16 v67, v129, v25
 v_dot2c_f32_bf16 v68, v130, v24
 v_dot2c_f32_bf16 v69, v130, v25
 v_dot2c_f32_bf16 v70, v131, v24
 v_dot2c_f32_bf16 v71, v131, v25
L_ry16:
 s_cmp_lg_u32 s70, 0
 s_cbranch_scc1 L_rk25
 s_call_b64 s[36:37], L_rpoll
L_rk25:
 s_ff1_i32_b32 s71, s70
 s_bitset0_b32 s70, s71
 s_cmp_ge_u32 s71, 16
 s_cselect_b32 s72, s78, s77
 s_cselect_b32 s73, 0x2000000, 0
 s_cselect_b32 s87, 536870912, 0
 s_mul_i32 s71, s71, 114688
 s_add_u32 s71, s71, s72
 buffer_load_dwordx4 v[200:203], v7, s[8:11], s71 offen sc1
 s_or_b32 s69, s69, s73
 s_or_b32 s71, s71, s87
 buffer_load_dwordx4 v[204:207], v27, s[8:11], s71 offen sc1
 s_waitcnt vmcnt(16)
 s_bitcmp0_b32 s69, 17
 s_cbranch_scc1 L_rx17
 v_dot2c_f32_bf16 v64, v136, v24
 v_dot2c_f32_bf16 v65, v136, v25
 v_dot2c_f32_bf16 v66, v137, v24
 v_dot2c_f32_bf16 v67, v137, v25
 v_dot2c_f32_bf16 v68, v138, v24
 v_dot2c_f32_bf16 v69, v138, v25
 v_dot2c_f32_bf16 v70, v139, v24
 v_dot2c_f32_bf16 v71, v139, v25
L_ry17:
 s_cmp_lg_u32 s70, 0
 s_cbranch_scc1 L_rk26
 s_call_b64 s[36:37], L_rpoll
L_rk26:
 s_ff1_i32_b32 s71, s70
 s_bitset0_b32 s70, s71
 s_cmp_ge_u32 s71, 16
 s_cselect_b32 s72, s78, s77
 s_cselect_b32 s73, 0x4000000, 0
 s_cselect_b32 s87, 536870912, 0
 s_mul_i32 s71, s71, 114688
 s_add_u32 s71, s71, s72
 buffer_load_dwordx4 v[208:211], v7, s[8:11], s71 offen sc1
 s_or_b32 s69, s69, s73
 s_or_b32 s71, s71, s87
 buffer_load_dwordx4 v[212:215], v27, s[8:11], s71 offen sc1
 s_waitcnt vmcnt(16)
 s_bitcmp0_b32 s69, 18
 s_cbranch_scc1 L_rx18
 v_dot2c_f32_bf16 v64, v144, v24
 v_dot2c_f32_bf16 v65, v144, v25
 v_dot2c_f32_bf16 v66, v145, v24
 v_dot2c_f32_bf16 v67, v145, v25
 v_dot2c_f32_bf16 v68, v146, v24
 v_dot2c_f32_bf16 v69, v146, v25
 v_dot2c_f32_bf16 v70, v147, v24
 v_dot2c_f32_bf16 v71, v147, v25
L_ry18:
 s_cmp_lg_u32 s70, 0
 s_cbranch_scc1 L_rk27
 s_call_b64 s[36:37], L_rpoll
L_rk27:
 s_ff1_i32_b32 s71, s70
 s_bitset0_b32 s70, s71
 s_cmp_ge_u32 s71, 16
 s_cselect_b32 s72, s78, s77
 s_cselect_b32 s73, 0x8000000, 0
 s_cselect_b32 s87, 536870912, 0
 s_mul_i32 s71, s71, 114688
 s_add_u32 s71, s71, s72
 buffer_load_dwordx4 v[216:219], v7, s[8:11], s71 offen sc1
 s_or_b32 s69, s69, s73
 s_or_b32 s71, s71, s87
 buffer_load_dwordx4 v[220:223], v27, s[8:11], s71 offen sc1
 s_waitcnt vmcnt(16)
 s_bitcmp0_b32 s69, 19
 s_cbranch_scc1 L_rx19
 v_dot2c_f32_bf16 v64, v152, v24
 v_dot2c_f32_bf16 v65, v152, v25
 v_dot2c_f32_bf16 v66, v153, v24
 v_dot2c_f32_bf16 v67, v153, v25
 v_dot2c_f32_bf16 v68, v154, v24
 v_dot2c_f32_bf16 v69, v154, v25
 v_dot2c_f32_bf16 v70, v155, v24
 v_dot2c_f32_bf16 v71, v155, v25
L_ry19:
 s_and_b32 s71, s69, 0xfffff
 s_bcnt1_i32_b32 s71, s71
 s_cmp_eq_u32 s71, 4
 s_cselect_b32 s66, 1, 0
 s_cbranch_scc0 L_rne
 v_fmac_f32 v32, v15, v48
 v_fmac_f32 v33, v15, v49
 v_fmac_f32 v34, v15, v50
 v_fmac_f32 v35, v15, v51
 v_fmac_f32 v36, v15, v52
 v_fmac_f32 v37, v15, v53
 v_fmac_f32 v38, v15, v54
 v_fmac_f32 v39, v15, v55
 v_cvt_pk_bf16_f32 v16, v32, v33
 v_cvt_pk_bf16_f32 v17, v34, v35
 v_cvt_pk_bf16_f32 v18, v36, v37
 v_cvt_pk_bf16_f32 v19, v38, v39
 buffer_store_dwordx4 v[16:19], v12, s[52:55], s75 offen sc1
 v_fmac_f32 v40, v15, v56
 v_fmac_f32 v41, v15, v57
 v_fmac_f32 v42, v15, v58
 v_fmac_f32 v43, v15, v59
 v_fmac_f32 v44, v15, v60
 v_fmac_f32 v45, v15, v61
 v_fmac_f32 v46, v15, v62
 v_fmac_f32 v47, v15, v63
 v_cvt_pk_bf16_f32 v20, v40, v41
 v_cvt_pk_bf16_f32 v21, v42, v43
 v_cvt_pk_bf16_f32 v22, v44, v45
 v_cvt_pk_bf16_f32 v23, v46, v47
 buffer_store_dwordx4 v[20:23], v12, s[52:55], s76 offen sc1
L_rne:
 s_cmp_lg_u32 s70, 0
 s_cbranch_scc1 L_rk28
 s_call_b64 s[36:37], L_rpoll
L_rk28:
 s_ff1_i32_b32 s71, s70
 s_bitset0_b32 s70, s71
 s_cmp_ge_u32 s71, 16
 s_cselect_b32 s72, s78, s77
 s_cselect_b32 s73, 0x10000000, 0
 s_cselect_b32 s87, 536870912, 0
 s_mul_i32 s71, s71, 114688
 s_add_u32 s71, s71, s72
 buffer_load_dwordx4 v[224:227], v7, s[8:11], s71 offen sc1
 s_or_b32 s69, s69, s73
 s_or_b32 s71, s71, s87
 buffer_load_dwordx4 v[228:231], v27, s[8:11], s71 offen sc1
 s_waitcnt vmcnt(16)
 s_bitcmp0_b32 s69, 20
 s_cbranch_scc1 L_rx20
 v_dot2c_f32_bf16 v64, v160, v24
 v_dot2c_f32_bf16 v65, v160, v25
 v_dot2c_f32_bf16 v66, v161, v24
 v_dot2c_f32_bf16 v67, v161, v25
 v_dot2c_f32_bf16 v68, v162, v24
 v_dot2c_f32_bf16 v69, v162, v25
 v_dot2c_f32_bf16 v70, v163, v24
 v_dot2c_f32_bf16 v71, v163, v25
L_ry20:
 s_cmp_lg_u32 s70, 0
 s_cbranch_scc1 L_rk29
 s_call_b64 s[36:37], L_rpoll
L_rk29:
 s_ff1_i32_b32 s71, s70
 s_bitset0_b32 s70, s71
 s_cmp_ge_u32 s71, 16
 s_cselect_b32 s72, s78, s77
 s_cselect_b32 s73, 0x20000000, 0
 s_cselect_b32 s87, 536870912, 0
 s_mul_i32 s71, s71, 114688
 s_add_u32 s71, s71, s72
 buffer_load_dwordx4 v[232:235], v7, s[8:11], s71 offen sc1
 s_or_b32 s69, s69, s73
 s_or_b32 s71, s71, s87
 buffer_load_dwordx4 v[236:239], v27, s[8:11], s71 offen sc1
 s_waitcnt vmcnt(16)
 s_bitcmp0_b32 s69, 21
 s_cbranch_scc1 L_rx21
 v_dot2c_f32_bf16 v64, v168, v24
 v_dot2c_f32_bf16 v65, v168, v25
 v_dot2c_f32_bf16 v66, v169, v24
 v_dot2c_f32_bf16 v67, v169, v25
 v_dot2c_f32_bf16 v68, v170, v24
 v_dot2c_f32_bf16 v69, v170, v25
 v_dot2c_f32_bf16 v70, v171, v24
 v_dot2c_f32_bf16 v71, v171, v25
L_ry21:
 s_cmp_lg_u32 s70, 0
 s_cbranch_scc1 L_rk30
 s_call_b64 s[36:37], L_rpoll
L_rk30:
 s_ff1_i32_b32 s71, s70
 s_bitset0_b32 s70, s71
 s_cmp_ge_u32 s71, 16
 s_cselect_b32 s72, s78, s77
 s_cselect_b32 s73, 0x40000000, 0
 s_cselect_b32 s87, 536870912, 0
 s_mul_i32 s71, s71, 114688
 s_add_u32 s71, s71, s72
 buffer_load_dwordx4 v[240:243], v7, s[8:11], s71 offen sc1
 s_or_b32 s69, s69, s73
 s_or_b32 s71, s71, s87
 buffer_load_dwordx4 v[244:247], v27, s[8:11], s71 offen sc1
 s_waitcnt vmcnt(16)
 s_bitcmp0_b32 s69, 22
 s_cbranch_scc1 L_rx22
 v_dot2c_f32_bf16 v64, v176, v24
 v_dot2c_f32_bf16 v65, v176, v25
 v_dot2c_f32_bf16 v66, v177, v24
 v_dot2c_f32_bf16 v67, v177, v25
 v_dot2c_f32_bf16 v68, v178, v24
 v_dot2c_f32_bf16 v69, v178, v25
 v_dot2c_f32_bf16 v70, v179, v24
 v_dot2c_f32_bf16 v71, v179, v25
L_ry22:
 s_cmp_lg_u32 s70, 0
 s_cbranch_scc1 L_rk31
 s_call_b64 s[36:37], L_rpoll
L_rk31:
 s_ff1_i32_b32 s71, s70
 s_bitset0_b32 s70, s71
 s_cmp_ge_u32 s71, 16
 s_cselect_b32 s72, s78, s77
 s_cselect_b32 s73, 0x80000000, 0
 s_cselect_b32 s87, 536870912, 0
 s_mul_i32 s71, s71, 114688
 s_add_u32 s71, s71, s72
 buffer_load_dwordx4 v[248:251], v7, s[8:11], s71 offen sc1
 s_or_b32 s69, s69, s73
 s_or_b32 s71, s71, s87
 buffer_load_dwordx4 v[252:255], v27, s[8:11], s71 offen sc1
 s_waitcnt vmcnt(16)
 s_bitcmp0_b32 s69, 23
 s_cbranch_scc1 L_rx23
 v_dot2c_f32_bf16 v64, v184, v24
 v_dot2c_f32_bf16 v65, v184, v25
 v_dot2c_f32_bf16 v66, v185, v24
 v_dot2c_f32_bf16 v67, v185, v25
 v_dot2c_f32_bf16 v68, v186, v24
 v_dot2c_f32_bf16 v69, v186, v25
 v_dot2c_f32_bf16 v70, v187, v24
 v_dot2c_f32_bf16 v71, v187, v25
L_ry23:
 s_waitcnt vmcnt(14)
 s_bitcmp0_b32 s69, 24
 s_cbranch_scc1 L_rx24
 v_dot2c_f32_bf16 v64, v192, v24
 v_dot2c_f32_bf16 v65, v192, v25
 v_dot2c_f32_bf16 v66, v193, v24
 v_dot2c_f32_bf16 v67, v193, v25
 v_dot2c_f32_bf16 v68, v194, v24
 v_dot2c_f32_bf16 v69, v194, v25
 v_dot2c_f32_bf16 v70, v195, v24
 v_dot2c_f32_bf16 v71, v195, v25
L_ry24:
 s_waitcnt vmcnt(12)
 s_bitcmp0_b32 s69, 25
 s_cbranch_scc1 L_rx25
 v_dot2c_f32_bf16 v64, v200, v24
 v_dot2c_f32_bf16 v65, v200, v25
 v_dot2c_f32_bf16 v66, v201, v24
 v_dot2c_f32_bf16 v67, v201, v25
 v_dot2c_f32_bf16 v68, v202, v24
 v_dot2c_f32_bf16 v69, v202, v25
 v_dot2c_f32_bf16 v70, v203, v24
 v_dot2c_f32_bf16 v71, v203, v25
L_ry25:
 s_waitcnt vmcnt(10)
 s_bitcmp0_b32 s69, 26
 s_cbranch_scc1 L_rx26
 v_dot2c_f32_bf16 v64, v208, v24
 v_dot2c_f32_bf16 v65, v208, v25
 v_dot2c_f32_bf16 v66, v209, v24
 v_dot2c_f32_bf16 v67, v209, v25
 v_dot2c_f32_bf16 v68, v210, v24
 v_dot2c_f32_bf16 v69, v210, v25
 v_dot2c_f32_bf16 v70, v211, v24
 v_dot2c_f32_bf16 v71, v211, v25
L_ry26:
 s_waitcnt vmcnt(8)
 s_bitcmp0_b32 s69, 27
 s_cbranch_scc1 L_rx27
 v_dot2c_f32_bf16 v64, v216, v24
 v_dot2c_f32_bf16 v65, v216, v25
 v_dot2c_f32_bf16 v66, v217, v24
 v_dot2c_f32_bf16 v67, v217, v25
 v_dot2c_f32_bf16 v68, v218, v24
 v_dot2c_f32_bf16 v69, v218, v25
 v_dot2c_f32_bf16 v70, v219, v24
 v_dot2c_f32_bf16 v71, v219, v25
L_ry27:
 s_waitcnt vmcnt(6)
 s_bitcmp0_b32 s69, 28
 s_cbranch_scc1 L_rx28
 v_dot2c_f32_bf16 v64, v224, v24
 v_dot2c_f32_bf16 v65, v224, v25
 v_dot2c_f32_bf16 v66, v225, v24
 v_dot2c_f32_bf16 v67, v225, v25
 v_dot2c_f32_bf16 v68, v226, v24
 v_dot2c_f32_bf16 v69, v226, v25
 v_dot2c_f32_bf16 v70, v227, v24
 v_dot2c_f32_bf16 v71, v227, v25
L_ry28:
 s_waitcnt vmcnt(4)
 s_bitcmp0_b32 s69, 29
 s_cbranch_scc1 L_rx29
 v_dot2c_f32_bf16 v64, v232, v24
 v_dot2c_f32_bf16 v65, v232, v25
 v_dot2c_f32_bf16 v66, v233, v24
 v_dot2c_f32_bf16 v67, v233, v25
 v_dot2c_f32_bf16 v68, v234, v24
 v_dot2c_f32_bf16 v69, v234, v25
 v_dot2c_f32_bf16 v70, v235, v24
 v_dot2c_f32_bf16 v71, v235, v25
L_ry29:
 s_waitcnt vmcnt(2)
 s_bitcmp0_b32 s69, 30
 s_cbranch_scc1 L_rx30
 v_dot2c_f32_bf16 v64, v240, v24
 v_dot2c_f32_bf16 v65, v240, v25
 v_dot2c_f32_bf16 v66, v241, v24
 v_dot2c_f32_bf16 v67, v241, v25
 v_dot2c_f32_bf16 v68, v242, v24
 v_dot2c_f32_bf16 v69, v242, v25
 v_dot2c_f32_bf16 v70, v243, v24
 v_dot2c_f32_bf16 v71, v243, v25
L_ry30:
 s_waitcnt vmcnt(0)
 s_bitcmp0_b32 s69, 31
 s_cbranch_scc1 L_rx31
 v_dot2c_f32_bf16 v64, v248, v24
 v_dot2c_f32_bf16 v65, v248, v25
 v_dot2c_f32_bf16 v66, v249, v24
 v_dot2c_f32_bf16 v67, v249, v25
 v_dot2c_f32_bf16 v68, v250, v24
 v_dot2c_f32_bf16 v69, v250, v25
 v_dot2c_f32_bf16 v70, v251, v24
 v_dot2c_f32_bf16 v71, v251, v25
L_ry31:
 s_nop 1
 v_fmac_f32 v80, v26, v64
 v_fmac_f32 v81, v26, v65
 v_fmac_f32 v82, v26, v66
 v_fmac_f32 v83, v26, v67
 v_fmac_f32 v84, v26, v68
 v_fmac_f32 v85, v26, v69
 v_fmac_f32 v86, v26, v70
 v_fmac_f32 v87, v26, v71
 v_cvt_pk_bf16_f32 v96, v80, v81
 v_cvt_pk_bf16_f32 v97, v82, v83
 v_cvt_pk_bf16_f32 v98, v84, v85
 v_cvt_pk_bf16_f32 v99, v86, v87
 buffer_store_dwordx4 v[96:99], v28, s[52:55], s86 offen sc1
 s_cmp_eq_u32 s66, 1
 s_cbranch_scc1 L_rdone
 v_fmac_f32 v32, v15, v48
 v_fmac_f32 v33, v15, v49
 v_fmac_f32 v34, v15, v50
 v_fmac_f32 v35, v15, v51
 v_fmac_f32 v36, v15, v52
 v_fmac_f32 v37, v15, v53
 v_fmac_f32 v38, v15, v54
 v_fmac_f32 v39, v15, v55
 v_cvt_pk_bf16_f32 v16, v32, v33
 v_cvt_pk_bf16_f32 v17, v34, v35
 v_cvt_pk_bf16_f32 v18, v36, v37
 v_cvt_pk_bf16_f32 v19, v38, v39
 buffer_store_dwordx4 v[16:19], v12, s[52:55], s75 offen sc1
 v_fmac_f32 v40, v15, v56
 v_fmac_f32 v41, v15, v57
 v_fmac_f32 v42, v15, v58
 v_fmac_f32 v43, v15, v59
 v_fmac_f32 v44, v15, v60
 v_fmac_f32 v45, v15, v61
 v_fmac_f32 v46, v15, v62
 v_fmac_f32 v47, v15, v63
 v_cvt_pk_bf16_f32 v20, v40, v41
 v_cvt_pk_bf16_f32 v21, v42, v43
 v_cvt_pk_bf16_f32 v22, v44, v45
 v_cvt_pk_bf16_f32 v23, v46, v47
 buffer_store_dwordx4 v[20:23], v12, s[52:55], s76 offen sc1
L_rdone:
 s_endpgm
L_rx0:
 v_dot2c_f32_bf16 v64, v128, v24
 v_dot2c_f32_bf16 v65, v128, v25
 v_dot2c_f32_bf16 v66, v129, v24
 v_dot2c_f32_bf16 v67, v129, v25
 v_dot2c_f32_bf16 v68, v130, v24
 v_dot2c_f32_bf16 v69, v130, v25
 v_dot2c_f32_bf16 v70, v131, v24
 v_dot2c_f32_bf16 v71, v131, v25
 s_branch L_ry0
L_rx1:
 v_dot2c_f32_bf16 v64, v136, v24
 v_dot2c_f32_bf16 v65, v136, v25
 v_dot2c_f32_bf16 v66, v137, v24
 v_dot2c_f32_bf16 v67, v137, v25
 v_dot2c_f32_bf16 v68, v138, v24
 v_dot2c_f32_bf16 v69, v138, v25
 v_dot2c_f32_bf16 v70, v139, v24
 v_dot2c_f32_bf16 v71, v139, v25
 s_branch L_ry1
L_rx2:
 v_dot2c_f32_bf16 v64, v144, v24
 v_dot2c_f32_bf16 v65, v144, v25
 v_dot2c_f32_bf16 v66, v145, v24
 v_dot2c_f32_bf16 v67, v145, v25
 v_dot2c_f32_bf16 v68, v146, v24
 v_dot2c_f32_bf16 v69, v146, v25
 v_dot2c_f32_bf16 v70, v147, v24
 v_dot2c_f32_bf16 v71, v147, v25
 s_branch L_ry2
L_rx3:
 v_dot2c_f32_bf16 v64, v152, v24
 v_dot2c_f32_bf16 v65, v152, v25
 v_dot2c_f32_bf16 v66, v153, v24
 v_dot2c_f32_bf16 v67, v153, v25
 v_dot2c_f32_bf16 v68, v154, v24
 v_dot2c_f32_bf16 v69, v154, v25
 v_dot2c_f32_bf16 v70, v155, v24
 v_dot2c_f32_bf16 v71, v155, v25
 s_branch L_ry3
L_rx4:
 v_dot2c_f32_bf16 v64, v160, v24
 v_dot2c_f32_bf16 v65, v160, v25
 v_dot2c_f32_bf16 v66, v161, v24
 v_dot2c_f32_bf16 v67, v161, v25
 v_dot2c_f32_bf16 v68, v162, v24
 v_dot2c_f32_bf16 v69, v162, v25
 v_dot2c_f32_bf16 v70, v163, v24
 v_dot2c_f32_bf16 v71, v163, v25
 s_branch L_ry4
L_rx5:
 v_dot2c_f32_bf16 v64, v168, v24
 v_dot2c_f32_bf16 v65, v168, v25
 v_dot2c_f32_bf16 v66, v169, v24
 v_dot2c_f32_bf16 v67, v169, v25
 v_dot2c_f32_bf16 v68, v170, v24
 v_dot2c_f32_bf16 v69, v170, v25
 v_dot2c_f32_bf16 v70, v171, v24
 v_dot2c_f32_bf16 v71, v171, v25
 s_branch L_ry5
L_rx6:
 v_dot2c_f32_bf16 v64, v176, v24
 v_dot2c_f32_bf16 v65, v176, v25
 v_dot2c_f32_bf16 v66, v177, v24
 v_dot2c_f32_bf16 v67, v177, v25
 v_dot2c_f32_bf16 v68, v178, v24
 v_dot2c_f32_bf16 v69, v178, v25
 v_dot2c_f32_bf16 v70, v179, v24
 v_dot2c_f32_bf16 v71, v179, v25
 s_branch L_ry6
L_rx7:
 v_dot2c_f32_bf16 v64, v184, v24
 v_dot2c_f32_bf16 v65, v184, v25
 v_dot2c_f32_bf16 v66, v185, v24
 v_dot2c_f32_bf16 v67, v185, v25
 v_dot2c_f32_bf16 v68, v186, v24
 v_dot2c_f32_bf16 v69, v186, v25
 v_dot2c_f32_bf16 v70, v187, v24
 v_dot2c_f32_bf16 v71, v187, v25
 s_branch L_ry7
L_rx8:
 v_dot2c_f32_bf16 v64, v192, v24
 v_dot2c_f32_bf16 v65, v192, v25
 v_dot2c_f32_bf16 v66, v193, v24
 v_dot2c_f32_bf16 v67, v193, v25
 v_dot2c_f32_bf16 v68, v194, v24
 v_dot2c_f32_bf16 v69, v194, v25
 v_dot2c_f32_bf16 v70, v195, v24
 v_dot2c_f32_bf16 v71, v195, v25
 s_branch L_ry8
L_rx9:
 v_dot2c_f32_bf16 v64, v200, v24
 v_dot2c_f32_bf16 v65, v200, v25
 v_dot2c_f32_bf16 v66, v201, v24
 v_dot2c_f32_bf16 v67, v201, v25
 v_dot2c_f32_bf16 v68, v202, v24
 v_dot2c_f32_bf16 v69, v202, v25
 v_dot2c_f32_bf16 v70, v203, v24
 v_dot2c_f32_bf16 v71, v203, v25
 s_branch L_ry9
L_rx10:
 v_dot2c_f32_bf16 v64, v208, v24
 v_dot2c_f32_bf16 v65, v208, v25
 v_dot2c_f32_bf16 v66, v209, v24
 v_dot2c_f32_bf16 v67, v209, v25
 v_dot2c_f32_bf16 v68, v210, v24
 v_dot2c_f32_bf16 v69, v210, v25
 v_dot2c_f32_bf16 v70, v211, v24
 v_dot2c_f32_bf16 v71, v211, v25
 s_branch L_ry10
L_rx11:
 v_dot2c_f32_bf16 v64, v216, v24
 v_dot2c_f32_bf16 v65, v216, v25
 v_dot2c_f32_bf16 v66, v217, v24
 v_dot2c_f32_bf16 v67, v217, v25
 v_dot2c_f32_bf16 v68, v218, v24
 v_dot2c_f32_bf16 v69, v218, v25
 v_dot2c_f32_bf16 v70, v219, v24
 v_dot2c_f32_bf16 v71, v219, v25
 s_branch L_ry11
L_rx12:
 v_dot2c_f32_bf16 v64, v224, v24
 v_dot2c_f32_bf16 v65, v224, v25
 v_dot2c_f32_bf16 v66, v225, v24
 v_dot2c_f32_bf16 v67, v225, v25
 v_dot2c_f32_bf16 v68, v226, v24
 v_dot2c_f32_bf16 v69, v226, v25
 v_dot2c_f32_bf16 v70, v227, v24
 v_dot2c_f32_bf16 v71, v227, v25
 s_branch L_ry12
L_rx13:
 v_dot2c_f32_bf16 v64, v232, v24
 v_dot2c_f32_bf16 v65, v232, v25
 v_dot2c_f32_bf16 v66, v233, v24
 v_dot2c_f32_bf16 v67, v233, v25
 v_dot2c_f32_bf16 v68, v234, v24
 v_dot2c_f32_bf16 v69, v234, v25
 v_dot2c_f32_bf16 v70, v235, v24
 v_dot2c_f32_bf16 v71, v235, v25
 s_branch L_ry13
L_rx14:
 v_dot2c_f32_bf16 v64, v240, v24
 v_dot2c_f32_bf16 v65, v240, v25
 v_dot2c_f32_bf16 v66, v241, v24
 v_dot2c_f32_bf16 v67, v241, v25
 v_dot2c_f32_bf16 v68, v242, v24
 v_dot2c_f32_bf16 v69, v242, v25
 v_dot2c_f32_bf16 v70, v243, v24
 v_dot2c_f32_bf16 v71, v243, v25
 s_branch L_ry14
L_rx15:
 v_dot2c_f32_bf16 v64, v248, v24
 v_dot2c_f32_bf16 v65, v248, v25
 v_dot2c_f32_bf16 v66, v249, v24
 v_dot2c_f32_bf16 v67, v249, v25
 v_dot2c_f32_bf16 v68, v250, v24
 v_dot2c_f32_bf16 v69, v250, v25
 v_dot2c_f32_bf16 v70, v251, v24
 v_dot2c_f32_bf16 v71, v251, v25
 s_branch L_ry15
L_rx16:
 v_dot2c_f32_bf16 v48, v128, v24
 v_dot2c_f32_bf16 v49, v128, v25
 v_dot2c_f32_bf16 v50, v129, v24
 v_dot2c_f32_bf16 v51, v129, v25
 v_dot2c_f32_bf16 v52, v130, v24
 v_dot2c_f32_bf16 v53, v130, v25
 v_dot2c_f32_bf16 v54, v131, v24
 v_dot2c_f32_bf16 v55, v131, v25
 v_dot2c_f32_bf16 v56, v132, v24
 v_dot2c_f32_bf16 v57, v132, v25
 v_dot2c_f32_bf16 v58, v133, v24
 v_dot2c_f32_bf16 v59, v133, v25
 v_dot2c_f32_bf16 v60, v134, v24
 v_dot2c_f32_bf16 v61, v134, v25
 v_dot2c_f32_bf16 v62, v135, v24
 v_dot2c_f32_bf16 v63, v135, v25
 s_branch L_ry16
L_rx17:
 v_dot2c_f32_bf16 v48, v136, v24
 v_dot2c_f32_bf16 v49, v136, v25
 v_dot2c_f32_bf16 v50, v137, v24
 v_dot2c_f32_bf16 v51, v137, v25
 v_dot2c_f32_bf16 v52, v138, v24
 v_dot2c_f32_bf16 v53, v138, v25
 v_dot2c_f32_bf16 v54, v139, v24
 v_dot2c_f32_bf16 v55, v139, v25
 v_dot2c_f32_bf16 v56, v140, v24
 v_dot2c_f32_bf16 v57, v140, v25
 v_dot2c_f32_bf16 v58, v141, v24
 v_dot2c_f32_bf16 v59, v141, v25
 v_dot2c_f32_bf16 v60, v142, v24
 v_dot2c_f32_bf16 v61, v142, v25
 v_dot2c_f32_bf16 v62, v143, v24
 v_dot2c_f32_bf16 v63, v143, v25
 s_branch L_ry17
L_rx18:
 v_dot2c_f32_bf16 v48, v144, v24
 v_dot2c_f32_bf16 v49, v144, v25
 v_dot2c_f32_bf16 v50, v145, v24
 v_dot2c_f32_bf16 v51, v145, v25
 v_dot2c_f32_bf16 v52, v146, v24
 v_dot2c_f32_bf16 v53, v146, v25
 v_dot2c_f32_bf16 v54, v147, v24
 v_dot2c_f32_bf16 v55, v147, v25
 v_dot2c_f32_bf16 v56, v148, v24
 v_dot2c_f32_bf16 v57, v148, v25
 v_dot2c_f32_bf16 v58, v149, v24
 v_dot2c_f32_bf16 v59, v149, v25
 v_dot2c_f32_bf16 v60, v150, v24
 v_dot2c_f32_bf16 v61, v150, v25
 v_dot2c_f32_bf16 v62, v151, v24
 v_dot2c_f32_bf16 v63, v151, v25
 s_branch L_ry18
L_rx19:
 v_dot2c_f32_bf16 v48, v152, v24
 v_dot2c_f32_bf16 v49, v152, v25
 v_dot2c_f32_bf16 v50, v153, v24
 v_dot2c_f32_bf16 v51, v153, v25
 v_dot2c_f32_bf16 v52, v154, v24
 v_dot2c_f32_bf16 v53, v154, v25
 v_dot2c_f32_bf16 v54, v155, v24
 v_dot2c_f32_bf16 v55, v155, v25
 v_dot2c_f32_bf16 v56, v156, v24
 v_dot2c_f32_bf16 v57, v156, v25
 v_dot2c_f32_bf16 v58, v157, v24
 v_dot2c_f32_bf16 v59, v157, v25
 v_dot2c_f32_bf16 v60, v158, v24
 v_dot2c_f32_bf16 v61, v158, v25
 v_dot2c_f32_bf16 v62, v159, v24
 v_dot2c_f32_bf16 v63, v159, v25
 s_branch L_ry19
L_rx20:
 v_dot2c_f32_bf16 v48, v160, v24
 v_dot2c_f32_bf16 v49, v160, v25
 v_dot2c_f32_bf16 v50, v161, v24
 v_dot2c_f32_bf16 v51, v161, v25
 v_dot2c_f32_bf16 v52, v162, v24
 v_dot2c_f32_bf16 v53, v162, v25
 v_dot2c_f32_bf16 v54, v163, v24
 v_dot2c_f32_bf16 v55, v163, v25
 v_dot2c_f32_bf16 v56, v164, v24
 v_dot2c_f32_bf16 v57, v164, v25
 v_dot2c_f32_bf16 v58, v165, v24
 v_dot2c_f32_bf16 v59, v165, v25
 v_dot2c_f32_bf16 v60, v166, v24
 v_dot2c_f32_bf16 v61, v166, v25
 v_dot2c_f32_bf16 v62, v167, v24
 v_dot2c_f32_bf16 v63, v167, v25
 s_branch L_ry20
L_rx21:
 v_dot2c_f32_bf16 v48, v168, v24
 v_dot2c_f32_bf16 v49, v168, v25
 v_dot2c_f32_bf16 v50, v169, v24
 v_dot2c_f32_bf16 v51, v169, v25
 v_dot2c_f32_bf16 v52, v170, v24
 v_dot2c_f32_bf16 v53, v170, v25
 v_dot2c_f32_bf16 v54, v171, v24
 v_dot2c_f32_bf16 v55, v171, v25
 v_dot2c_f32_bf16 v56, v172, v24
 v_dot2c_f32_bf16 v57, v172, v25
 v_dot2c_f32_bf16 v58, v173, v24
 v_dot2c_f32_bf16 v59, v173, v25
 v_dot2c_f32_bf16 v60, v174, v24
 v_dot2c_f32_bf16 v61, v174, v25
 v_dot2c_f32_bf16 v62, v175, v24
 v_dot2c_f32_bf16 v63, v175, v25
 s_branch L_ry21
L_rx22:
 v_dot2c_f32_bf16 v48, v176, v24
 v_dot2c_f32_bf16 v49, v176, v25
 v_dot2c_f32_bf16 v50, v177, v24
 v_dot2c_f32_bf16 v51, v177, v25
 v_dot2c_f32_bf16 v52, v178, v24
 v_dot2c_f32_bf16 v53, v178, v25
 v_dot2c_f32_bf16 v54, v179, v24
 v_dot2c_f32_bf16 v55, v179, v25
 v_dot2c_f32_bf16 v56, v180, v24
 v_dot2c_f32_bf16 v57, v180, v25
 v_dot2c_f32_bf16 v58, v181, v24
 v_dot2c_f32_bf16 v59, v181, v25
 v_dot2c_f32_bf16 v60, v182, v24
 v_dot2c_f32_bf16 v61, v182, v25
 v_dot2c_f32_bf16 v62, v183, v24
 v_dot2c_f32_bf16 v63, v183, v25
 s_branch L_ry22
L_rx23:
 v_dot2c_f32_bf16 v48, v184, v24
 v_dot2c_f32_bf16 v49, v184, v25
 v_dot2c_f32_bf16 v50, v185, v24
 v_dot2c_f32_bf16 v51, v185, v25
 v_dot2c_f32_bf16 v52, v186, v24
 v_dot2c_f32_bf16 v53, v186, v25
 v_dot2c_f32_bf16 v54, v187, v24
 v_dot2c_f32_bf16 v55, v187, v25
 v_dot2c_f32_bf16 v56, v188, v24
 v_dot2c_f32_bf16 v57, v188, v25
 v_dot2c_f32_bf16 v58, v189, v24
 v_dot2c_f32_bf16 v59, v189, v25
 v_dot2c_f32_bf16 v60, v190, v24
 v_dot2c_f32_bf16 v61, v190, v25
 v_dot2c_f32_bf16 v62, v191, v24
 v_dot2c_f32_bf16 v63, v191, v25
 s_branch L_ry23
L_rx24:
 v_dot2c_f32_bf16 v48, v192, v24
 v_dot2c_f32_bf16 v49, v192, v25
 v_dot2c_f32_bf16 v50, v193, v24
 v_dot2c_f32_bf16 v51, v193, v25
 v_dot2c_f32_bf16 v52, v194, v24
 v_dot2c_f32_bf16 v53, v194, v25
 v_dot2c_f32_bf16 v54, v195, v24
 v_dot2c_f32_bf16 v55, v195, v25
 v_dot2c_f32_bf16 v56, v196, v24
 v_dot2c_f32_bf16 v57, v196, v25
 v_dot2c_f32_bf16 v58, v197, v24
 v_dot2c_f32_bf16 v59, v197, v25
 v_dot2c_f32_bf16 v60, v198, v24
 v_dot2c_f32_bf16 v61, v198, v25
 v_dot2c_f32_bf16 v62, v199, v24
 v_dot2c_f32_bf16 v63, v199, v25
 s_branch L_ry24
L_rx25:
 v_dot2c_f32_bf16 v48, v200, v24
 v_dot2c_f32_bf16 v49, v200, v25
 v_dot2c_f32_bf16 v50, v201, v24
 v_dot2c_f32_bf16 v51, v201, v25
 v_dot2c_f32_bf16 v52, v202, v24
 v_dot2c_f32_bf16 v53, v202, v25
 v_dot2c_f32_bf16 v54, v203, v24
 v_dot2c_f32_bf16 v55, v203, v25
 v_dot2c_f32_bf16 v56, v204, v24
 v_dot2c_f32_bf16 v57, v204, v25
 v_dot2c_f32_bf16 v58, v205, v24
 v_dot2c_f32_bf16 v59, v205, v25
 v_dot2c_f32_bf16 v60, v206, v24
 v_dot2c_f32_bf16 v61, v206, v25
 v_dot2c_f32_bf16 v62, v207, v24
 v_dot2c_f32_bf16 v63, v207, v25
 s_branch L_ry25
L_rx26:
 v_dot2c_f32_bf16 v48, v208, v24
 v_dot2c_f32_bf16 v49, v208, v25
 v_dot2c_f32_bf16 v50, v209, v24
 v_dot2c_f32_bf16 v51, v209, v25
 v_dot2c_f32_bf16 v52, v210, v24
 v_dot2c_f32_bf16 v53, v210, v25
 v_dot2c_f32_bf16 v54, v211, v24
 v_dot2c_f32_bf16 v55, v211, v25
 v_dot2c_f32_bf16 v56, v212, v24
 v_dot2c_f32_bf16 v57, v212, v25
 v_dot2c_f32_bf16 v58, v213, v24
 v_dot2c_f32_bf16 v59, v213, v25
 v_dot2c_f32_bf16 v60, v214, v24
 v_dot2c_f32_bf16 v61, v214, v25
 v_dot2c_f32_bf16 v62, v215, v24
 v_dot2c_f32_bf16 v63, v215, v25
 s_branch L_ry26
L_rx27:
 v_dot2c_f32_bf16 v48, v216, v24
 v_dot2c_f32_bf16 v49, v216, v25
 v_dot2c_f32_bf16 v50, v217, v24
 v_dot2c_f32_bf16 v51, v217, v25
 v_dot2c_f32_bf16 v52, v218, v24
 v_dot2c_f32_bf16 v53, v218, v25
 v_dot2c_f32_bf16 v54, v219, v24
 v_dot2c_f32_bf16 v55, v219, v25
 v_dot2c_f32_bf16 v56, v220, v24
 v_dot2c_f32_bf16 v57, v220, v25
 v_dot2c_f32_bf16 v58, v221, v24
 v_dot2c_f32_bf16 v59, v221, v25
 v_dot2c_f32_bf16 v60, v222, v24
 v_dot2c_f32_bf16 v61, v222, v25
 v_dot2c_f32_bf16 v62, v223, v24
 v_dot2c_f32_bf16 v63, v223, v25
 s_branch L_ry27
L_rx28:
 v_dot2c_f32_bf16 v48, v224, v24
 v_dot2c_f32_bf16 v49, v224, v25
 v_dot2c_f32_bf16 v50, v225, v24
 v_dot2c_f32_bf16 v51, v225, v25
 v_dot2c_f32_bf16 v52, v226, v24
 v_dot2c_f32_bf16 v53, v226, v25
 v_dot2c_f32_bf16 v54, v227, v24
 v_dot2c_f32_bf16 v55, v227, v25
 v_dot2c_f32_bf16 v56, v228, v24
 v_dot2c_f32_bf16 v57, v228, v25
 v_dot2c_f32_bf16 v58, v229, v24
 v_dot2c_f32_bf16 v59, v229, v25
 v_dot2c_f32_bf16 v60, v230, v24
 v_dot2c_f32_bf16 v61, v230, v25
 v_dot2c_f32_bf16 v62, v231, v24
 v_dot2c_f32_bf16 v63, v231, v25
 s_branch L_ry28
L_rx29:
 v_dot2c_f32_bf16 v48, v232, v24
 v_dot2c_f32_bf16 v49, v232, v25
 v_dot2c_f32_bf16 v50, v233, v24
 v_dot2c_f32_bf16 v51, v233, v25
 v_dot2c_f32_bf16 v52, v234, v24
 v_dot2c_f32_bf16 v53, v234, v25
 v_dot2c_f32_bf16 v54, v235, v24
 v_dot2c_f32_bf16 v55, v235, v25
 v_dot2c_f32_bf16 v56, v236, v24
 v_dot2c_f32_bf16 v57, v236, v25
 v_dot2c_f32_bf16 v58, v237, v24
 v_dot2c_f32_bf16 v59, v237, v25
 v_dot2c_f32_bf16 v60, v238, v24
 v_dot2c_f32_bf16 v61, v238, v25
 v_dot2c_f32_bf16 v62, v239, v24
 v_dot2c_f32_bf16 v63, v239, v25
 s_branch L_ry29
L_rx30:
 v_dot2c_f32_bf16 v48, v240, v24
 v_dot2c_f32_bf16 v49, v240, v25
 v_dot2c_f32_bf16 v50, v241, v24
 v_dot2c_f32_bf16 v51, v241, v25
 v_dot2c_f32_bf16 v52, v242, v24
 v_dot2c_f32_bf16 v53, v242, v25
 v_dot2c_f32_bf16 v54, v243, v24
 v_dot2c_f32_bf16 v55, v243, v25
 v_dot2c_f32_bf16 v56, v244, v24
 v_dot2c_f32_bf16 v57, v244, v25
 v_dot2c_f32_bf16 v58, v245, v24
 v_dot2c_f32_bf16 v59, v245, v25
 v_dot2c_f32_bf16 v60, v246, v24
 v_dot2c_f32_bf16 v61, v246, v25
 v_dot2c_f32_bf16 v62, v247, v24
 v_dot2c_f32_bf16 v63, v247, v25
 s_branch L_ry30
L_rx31:
 v_dot2c_f32_bf16 v48, v248, v24
 v_dot2c_f32_bf16 v49, v248, v25
 v_dot2c_f32_bf16 v50, v249, v24
 v_dot2c_f32_bf16 v51, v249, v25
 v_dot2c_f32_bf16 v52, v250, v24
 v_dot2c_f32_bf16 v53, v250, v25
 v_dot2c_f32_bf16 v54, v251, v24
 v_dot2c_f32_bf16 v55, v251, v25
 v_dot2c_f32_bf16 v56, v252, v24
 v_dot2c_f32_bf16 v57, v252, v25
 v_dot2c_f32_bf16 v58, v253, v24
 v_dot2c_f32_bf16 v59, v253, v25
 v_dot2c_f32_bf16 v60, v254, v24
 v_dot2c_f32_bf16 v61, v254, v25
 v_dot2c_f32_bf16 v62, v255, v24
 v_dot2c_f32_bf16 v63, v255, v25
 s_branch L_ry31
L_rpoll0:
 s_sleep 1
L_rpoll:
 buffer_load_dword v9, v14, s[8:11], s46 offen sc1
 s_waitcnt vmcnt(0)
 v_cmp_eq_u32 vcc, 1, v9
 s_sub_u32 s91, s91, 1
 s_cselect_b32 s70, -1, 0
 s_or_b32 s70, s70, vcc_lo
 s_andn2_b32 s70, s70, s68
 s_cbranch_scc0 L_rpoll0
 s_or_b32 s68, s68, s70
 s_setpc_b64 s[36:37]
L_comb:
 buffer_load_dwordx4 v[14:17], v7, s[8:11], s52 offen sc1
 s_waitcnt vmcnt(0)
 s_nop 7
 v_sub_f32 v10, v32, v14
 v_sub_f32 v11, v36, v15
 v_max_f32 v10, 0, v10
 v_max_f32 v11, 0, v11
 v_sub_f32 v100, v100, v11
 v_sub_f32 v101, v101, v11
 v_sub_f32 v102, v102, v11
 v_sub_f32 v103, v103, v11
 v_sub_f32 v108, v108, v11
 v_sub_f32 v109, v109, v11
 v_sub_f32 v110, v110, v11
 v_sub_f32 v111, v111, v11
 v_sub_f32 v116, v116, v11
 v_sub_f32 v117, v117, v11
 v_sub_f32 v118, v118, v11
 v_sub_f32 v119, v119, v11
 v_sub_f32 v124, v124, v11
 v_sub_f32 v125, v125, v11
 v_sub_f32 v126, v126, v11
 v_sub_f32 v127, v127, v11
 v_sub_f32 v64, v64, v10
 v_sub_f32 v65, v65, v10
 v_sub_f32 v66, v66, v10
 v_sub_f32 v67, v67, v10
 v_sub_f32 v68, v68, v11
 v_sub_f32 v69, v69, v11
 v_sub_f32 v70, v70, v11
 v_sub_f32 v71, v71, v11
 v_sub_f32 v72, v72, v10
 v_sub_f32 v73, v73, v10
 v_sub_f32 v74, v74, v10
 v_sub_f32 v75, v75, v10
 v_sub_f32 v76, v76, v11
 v_sub_f32 v77, v77, v11
 v_sub_f32 v78, v78, v11
 v_sub_f32 v79, v79, v11
 v_sub_f32 v80, v80, v10
 v_sub_f32 v81, v81, v10
 v_sub_f32 v82, v82, v10
 v_sub_f32 v83, v83, v10
 v_sub_f32 v84, v84, v11
 v_sub_f32 v85, v85, v11
 v_sub_f32 v86, v86, v11
 v_sub_f32 v87, v87, v11
 v_sub_f32 v88, v88, v10
 v_sub_f32 v89, v89, v10
 v_sub_f32 v90, v90, v10
 v_sub_f32 v91, v91, v10
 v_sub_f32 v92, v92, v11
 v_sub_f32 v93, v93, v11
 v_sub_f32 v94, v94, v11
 v_sub_f32 v95, v95, v11
 v_sub_f32 v32, v32, v10
 v_sub_f32 v33, v33, v10
 v_sub_f32 v34, v34, v10
 v_sub_f32 v35, v35, v10
 v_sub_f32 v36, v36, v11
 v_sub_f32 v37, v37, v11
 v_sub_f32 v38, v38, v11
 v_sub_f32 v39, v39, v11
 v_exp_f32 v12, -v10
 v_exp_f32 v13, -v11
 v_mul_f32 v30, v12, v30
 v_mul_f32 v31, v13, v31
 v_mul_f32 v128, v12, v128
 v_mul_f32 v129, v12, v129
 v_mul_f32 v130, v12, v130
 v_mul_f32 v131, v12, v131
 v_mul_f32 v132, v13, v132
 v_mul_f32 v133, v13, v133
 v_mul_f32 v134, v13, v134
 v_mul_f32 v135, v13, v135
 v_mul_f32 v136, v12, v136
 v_mul_f32 v137, v12, v137
 v_mul_f32 v138, v12, v138
 v_mul_f32 v139, v12, v139
 v_mul_f32 v140, v13, v140
 v_mul_f32 v141, v13, v141
 v_mul_f32 v142, v13, v142
 v_mul_f32 v143, v13, v143
 v_mul_f32 v144, v12, v144
 v_mul_f32 v145, v12, v145
 v_mul_f32 v146, v12, v146
 v_mul_f32 v147, v12, v147
 v_mul_f32 v148, v13, v148
 v_mul_f32 v149, v13, v149
 v_mul_f32 v150, v13, v150
 v_mul_f32 v151, v13, v151
 v_mul_f32 v152, v12, v152
 v_mul_f32 v153, v12, v153
 v_mul_f32 v154, v12, v154
 v_mul_f32 v155, v12, v155
 v_mul_f32 v156, v13, v156
 v_mul_f32 v157, v13, v157
 v_mul_f32 v158, v13, v158
 v_mul_f32 v159, v13, v159
 v_mul_f32 v160, v12, v160
 v_mul_f32 v161, v12, v161
 v_mul_f32 v162, v12, v162
 v_mul_f32 v163, v12, v163
 v_mul_f32 v164, v13, v164
 v_mul_f32 v165, v13, v165
 v_mul_f32 v166, v13, v166
 v_mul_f32 v167, v13, v167
 v_mul_f32 v168, v12, v168
 v_mul_f32 v169, v12, v169
 v_mul_f32 v170, v12, v170
 v_mul_f32 v171, v12, v171
 v_mul_f32 v172, v13, v172
 v_mul_f32 v173, v13, v173
 v_mul_f32 v174, v13, v174
 v_mul_f32 v175, v13, v175
 v_mul_f32 v176, v12, v176
 v_mul_f32 v177, v12, v177
 v_mul_f32 v178, v12, v178
 v_mul_f32 v179, v12, v179
 v_mul_f32 v180, v13, v180
 v_mul_f32 v181, v13, v181
 v_mul_f32 v182, v13, v182
 v_mul_f32 v183, v13, v183
 v_mul_f32 v184, v12, v184
 v_mul_f32 v185, v12, v185
 v_mul_f32 v186, v12, v186
 v_mul_f32 v187, v12, v187
 v_mul_f32 v188, v13, v188
 v_mul_f32 v189, v13, v189
 v_mul_f32 v190, v13, v190
 v_mul_f32 v191, v13, v191
 v_mul_f32 v192, v12, v192
 v_mul_f32 v193, v12, v193
 v_mul_f32 v194, v12, v194
 v_mul_f32 v195, v12, v195
 v_mul_f32 v196, v13, v196
 v_mul_f32 v197, v13, v197
 v_mul_f32 v198, v13, v198
 v_mul_f32 v199, v13, v199
 v_mul_f32 v200, v12, v200
 v_mul_f32 v201, v12, v201
 v_mul_f32 v202, v12, v202
 v_mul_f32 v203, v12, v203
 v_mul_f32 v204, v13, v204
 v_mul_f32 v205, v13, v205
 v_mul_f32 v206, v13, v206
 v_mul_f32 v207, v13, v207
 v_mul_f32 v208, v12, v208
 v_mul_f32 v209, v12, v209
 v_mul_f32 v210, v12, v210
 v_mul_f32 v211, v12, v211
 v_mul_f32 v212, v13, v212
 v_mul_f32 v213, v13, v213
 v_mul_f32 v214, v13, v214
 v_mul_f32 v215, v13, v215
 v_mul_f32 v216, v12, v216
 v_mul_f32 v217, v12, v217
 v_mul_f32 v218, v12, v218
 v_mul_f32 v219, v12, v219
 v_mul_f32 v220, v13, v220
 v_mul_f32 v221, v13, v221
 v_mul_f32 v222, v13, v222
 v_mul_f32 v223, v13, v223
 v_mul_f32 v224, v12, v224
 v_mul_f32 v225, v12, v225
 v_mul_f32 v226, v12, v226
 v_mul_f32 v227, v12, v227
 v_mul_f32 v228, v13, v228
 v_mul_f32 v229, v13, v229
 v_mul_f32 v230, v13, v230
 v_mul_f32 v231, v13, v231
 v_mul_f32 v232, v12, v232
 v_mul_f32 v233, v12, v233
 v_mul_f32 v234, v12, v234
 v_mul_f32 v235, v12, v235
 v_mul_f32 v236, v13, v236
 v_mul_f32 v237, v13, v237
 v_mul_f32 v238, v13, v238
 v_mul_f32 v239, v13, v239
 v_mul_f32 v240, v12, v240
 v_mul_f32 v241, v12, v241
 v_mul_f32 v242, v12, v242
 v_mul_f32 v243, v12, v243
 v_mul_f32 v244, v13, v244
 v_mul_f32 v245, v13, v245
 v_mul_f32 v246, v13, v246
 v_mul_f32 v247, v13, v247
 v_mul_f32 v248, v12, v248
 v_mul_f32 v249, v12, v249
 v_mul_f32 v250, v12, v250
 v_mul_f32 v251, v12, v251
 v_mul_f32 v252, v13, v252
 v_mul_f32 v253, v13, v253
 v_mul_f32 v254, v13, v254
 v_mul_f32 v255, v13, v255
 v_exp_f32 v18, v64
 v_exp_f32 v19, v65
 v_exp_f32 v20, v66
 v_add_f32 v26, v18, v19
 v_cvt_pk_bf16_f32 v40, v18, v19
 v_exp_f32 v21, v67
 v_exp_f32 v22, v72
 v_add_f32 v26, v20, v26
 v_cvt_pk_bf16_f32 v41, v20, v21
 v_exp_f32 v23, v73
 v_add_f32 v26, v21, v26
 v_exp_f32 v24, v74
 v_add_f32 v26, v22, v26
 v_cvt_pk_bf16_f32 v42, v22, v23
 v_exp_f32 v25, v75
 v_add_f32 v26, v23, v26
 v_exp_f32 v18, v68
 v_add_f32 v26, v24, v26
 v_cvt_pk_bf16_f32 v43, v24, v25
 v_exp_f32 v19, v69
 v_add_f32 v26, v25, v26
 v_exp_f32 v20, v70
 v_add_f32 v27, v18, v19
 v_cvt_pk_bf16_f32 v44, v18, v19
 v_exp_f32 v21, v71
 v_exp_f32 v22, v76
 v_add_f32 v27, v20, v27
 v_cvt_pk_bf16_f32 v45, v20, v21
 v_exp_f32 v23, v77
 v_add_f32 v27, v21, v27
 v_exp_f32 v24, v78
 v_add_f32 v27, v22, v27
 v_cvt_pk_bf16_f32 v46, v22, v23
 v_exp_f32 v25, v79
 v_add_f32 v27, v23, v27
 v_add_f32 v27, v24, v27
 v_cvt_pk_bf16_f32 v47, v24, v25
 v_add_f32 v27, v25, v27
 v_sub_f32 v10, v32, v14
 v_sub_f32 v11, v36, v15
 v_cvt_i32_f32 v10, v10
 v_cvt_i32_f32 v11, v11
 v_ldexp_f32 v10, 1.0, v10
 v_ldexp_f32 v11, 1.0, v11
 v_and_b32 v10, 0xffff0000, v10
 v_and_b32 v11, 0xffff0000, v11
 v_fmac_f32 v30, v10, v16
 v_fmac_f32 v31, v11, v17
 v_lshrrev_b32 v12, 16, v10
 v_lshrrev_b32 v13, 16, v11
 v_accvgpr_read_b32 v18, a128
 v_dot2c_f32_bf16 v128, v18, v12
 v_dot2c_f32_bf16 v129, v18, v10
 v_accvgpr_read_b32 v19, a129
 v_dot2c_f32_bf16 v130, v19, v12
 v_dot2c_f32_bf16 v131, v19, v10
 v_accvgpr_read_b32 v20, a130
 v_dot2c_f32_bf16 v136, v20, v12
 v_dot2c_f32_bf16 v137, v20, v10
 v_accvgpr_read_b32 v21, a131
 v_dot2c_f32_bf16 v138, v21, v12
 v_dot2c_f32_bf16 v139, v21, v10
 v_accvgpr_read_b32 v22, a132
 v_dot2c_f32_bf16 v144, v22, v12
 v_dot2c_f32_bf16 v145, v22, v10
 v_accvgpr_read_b32 v23, a133
 v_dot2c_f32_bf16 v146, v23, v12
 v_dot2c_f32_bf16 v147, v23, v10
 v_accvgpr_read_b32 v24, a134
 v_dot2c_f32_bf16 v152, v24, v12
 v_dot2c_f32_bf16 v153, v24, v10
 v_accvgpr_read_b32 v25, a135
 v_dot2c_f32_bf16 v154, v25, v12
 v_dot2c_f32_bf16 v155, v25, v10
 v_accvgpr_read_b32 v18, a136
 v_dot2c_f32_bf16 v160, v18, v12
 v_dot2c_f32_bf16 v161, v18, v10
 v_accvgpr_read_b32 v19, a137
 v_dot2c_f32_bf16 v162, v19, v12
 v_dot2c_f32_bf16 v163, v19, v10
 v_accvgpr_read_b32 v20, a138
 v_dot2c_f32_bf16 v168, v20, v12
 v_dot2c_f32_bf16 v169, v20, v10
 v_accvgpr_read_b32 v21, a139
 v_dot2c_f32_bf16 v170, v21, v12
 v_dot2c_f32_bf16 v171, v21, v10
 v_accvgpr_read_b32 v22, a140
 v_dot2c_f32_bf16 v176, v22, v12
 v_dot2c_f32_bf16 v177, v22, v10
 v_accvgpr_read_b32 v23, a141
 v_dot2c_f32_bf16 v178, v23, v12
 v_dot2c_f32_bf16 v179, v23, v10
 v_accvgpr_read_b32 v24, a142
 v_dot2c_f32_bf16 v184, v24, v12
 v_dot2c_f32_bf16 v185, v24, v10
 v_accvgpr_read_b32 v25, a143
 v_dot2c_f32_bf16 v186, v25, v12
 v_dot2c_f32_bf16 v187, v25, v10
 v_accvgpr_read_b32 v18, a144
 v_dot2c_f32_bf16 v192, v18, v12
 v_dot2c_f32_bf16 v193, v18, v10
 v_accvgpr_read_b32 v19, a145
 v_dot2c_f32_bf16 v194, v19, v12
 v_dot2c_f32_bf16 v195, v19, v10
 v_accvgpr_read_b32 v20, a146
 v_dot2c_f32_bf16 v200, v20, v12
 v_dot2c_f32_bf16 v201, v20, v10
 v_accvgpr_read_b32 v21, a147
 v_dot2c_f32_bf16 v202, v21, v12
 v_dot2c_f32_bf16 v203, v21, v10
 v_accvgpr_read_b32 v22, a148
 v_dot2c_f32_bf16 v208, v22, v12
 v_dot2c_f32_bf16 v209, v22, v10
 v_accvgpr_read_b32 v23, a149
 v_dot2c_f32_bf16 v210, v23, v12
 v_dot2c_f32_bf16 v211, v23, v10
 v_accvgpr_read_b32 v24, a150
 v_dot2c_f32_bf16 v216, v24, v12
 v_dot2c_f32_bf16 v217, v24, v10
 v_accvgpr_read_b32 v25, a151
 v_dot2c_f32_bf16 v218, v25, v12
 v_dot2c_f32_bf16 v219, v25, v10
 v_accvgpr_read_b32 v18, a152
 v_dot2c_f32_bf16 v224, v18, v12
 v_dot2c_f32_bf16 v225, v18, v10
 v_accvgpr_read_b32 v19, a153
 v_dot2c_f32_bf16 v226, v19, v12
 v_dot2c_f32_bf16 v227, v19, v10
 v_accvgpr_read_b32 v20, a154
 v_dot2c_f32_bf16 v232, v20, v12
 v_dot2c_f32_bf16 v233, v20, v10
 v_accvgpr_read_b32 v21, a155
 v_dot2c_f32_bf16 v234, v21, v12
 v_dot2c_f32_bf16 v235, v21, v10
 v_accvgpr_read_b32 v22, a156
 v_dot2c_f32_bf16 v240, v22, v12
 v_dot2c_f32_bf16 v241, v22, v10
 v_accvgpr_read_b32 v23, a157
 v_dot2c_f32_bf16 v242, v23, v12
 v_dot2c_f32_bf16 v243, v23, v10
 v_accvgpr_read_b32 v24, a158
 v_dot2c_f32_bf16 v248, v24, v12
 v_dot2c_f32_bf16 v249, v24, v10
 v_accvgpr_read_b32 v25, a159
 v_dot2c_f32_bf16 v250, v25, v12
 v_dot2c_f32_bf16 v251, v25, v10
 v_accvgpr_read_b32 v18, a160
 v_dot2c_f32_bf16 v132, v18, v13
 v_dot2c_f32_bf16 v133, v18, v11
 v_accvgpr_read_b32 v19, a161
 v_dot2c_f32_bf16 v134, v19, v13
 v_dot2c_f32_bf16 v135, v19, v11
 v_accvgpr_read_b32 v20, a162
 v_dot2c_f32_bf16 v140, v20, v13
 v_dot2c_f32_bf16 v141, v20, v11
 v_accvgpr_read_b32 v21, a163
 v_dot2c_f32_bf16 v142, v21, v13
 v_dot2c_f32_bf16 v143, v21, v11
 v_accvgpr_read_b32 v22, a164
 v_dot2c_f32_bf16 v148, v22, v13
 v_dot2c_f32_bf16 v149, v22, v11
 v_accvgpr_read_b32 v23, a165
 v_dot2c_f32_bf16 v150, v23, v13
 v_dot2c_f32_bf16 v151, v23, v11
 v_accvgpr_read_b32 v24, a166
 v_dot2c_f32_bf16 v156, v24, v13
 v_dot2c_f32_bf16 v157, v24, v11
 v_accvgpr_read_b32 v25, a167
 v_dot2c_f32_bf16 v158, v25, v13
 v_dot2c_f32_bf16 v159, v25, v11
 v_accvgpr_read_b32 v18, a168
 v_dot2c_f32_bf16 v164, v18, v13
 v_dot2c_f32_bf16 v165, v18, v11
 v_accvgpr_read_b32 v19, a169
 v_dot2c_f32_bf16 v166, v19, v13
 v_dot2c_f32_bf16 v167, v19, v11
 v_accvgpr_read_b32 v20, a170
 v_dot2c_f32_bf16 v172, v20, v13
 v_dot2c_f32_bf16 v173, v20, v11
 v_accvgpr_read_b32 v21, a171
 v_dot2c_f32_bf16 v174, v21, v13
 v_dot2c_f32_bf16 v175, v21, v11
 v_accvgpr_read_b32 v22, a172
 v_dot2c_f32_bf16 v180, v22, v13
 v_dot2c_f32_bf16 v181, v22, v11
 v_accvgpr_read_b32 v23, a173
 v_dot2c_f32_bf16 v182, v23, v13
 v_dot2c_f32_bf16 v183, v23, v11
 v_accvgpr_read_b32 v24, a174
 v_dot2c_f32_bf16 v188, v24, v13
 v_dot2c_f32_bf16 v189, v24, v11
 v_accvgpr_read_b32 v25, a175
 v_dot2c_f32_bf16 v190, v25, v13
 v_dot2c_f32_bf16 v191, v25, v11
 v_accvgpr_read_b32 v18, a176
 v_dot2c_f32_bf16 v196, v18, v13
 v_dot2c_f32_bf16 v197, v18, v11
 v_accvgpr_read_b32 v19, a177
 v_dot2c_f32_bf16 v198, v19, v13
 v_dot2c_f32_bf16 v199, v19, v11
 v_accvgpr_read_b32 v20, a178
 v_dot2c_f32_bf16 v204, v20, v13
 v_dot2c_f32_bf16 v205, v20, v11
 v_accvgpr_read_b32 v21, a179
 v_dot2c_f32_bf16 v206, v21, v13
 v_dot2c_f32_bf16 v207, v21, v11
 v_accvgpr_read_b32 v22, a180
 v_dot2c_f32_bf16 v212, v22, v13
 v_dot2c_f32_bf16 v213, v22, v11
 v_accvgpr_read_b32 v23, a181
 v_dot2c_f32_bf16 v214, v23, v13
 v_dot2c_f32_bf16 v215, v23, v11
 v_accvgpr_read_b32 v24, a182
 v_dot2c_f32_bf16 v220, v24, v13
 v_dot2c_f32_bf16 v221, v24, v11
 v_accvgpr_read_b32 v25, a183
 v_dot2c_f32_bf16 v222, v25, v13
 v_dot2c_f32_bf16 v223, v25, v11
 v_accvgpr_read_b32 v18, a184
 v_dot2c_f32_bf16 v228, v18, v13
 v_dot2c_f32_bf16 v229, v18, v11
 v_accvgpr_read_b32 v19, a185
 v_dot2c_f32_bf16 v230, v19, v13
 v_dot2c_f32_bf16 v231, v19, v11
 v_accvgpr_read_b32 v20, a186
 v_dot2c_f32_bf16 v236, v20, v13
 v_dot2c_f32_bf16 v237, v20, v11
 v_accvgpr_read_b32 v21, a187
 v_dot2c_f32_bf16 v238, v21, v13
 v_dot2c_f32_bf16 v239, v21, v11
 v_accvgpr_read_b32 v22, a188
 v_dot2c_f32_bf16 v244, v22, v13
 v_dot2c_f32_bf16 v245, v22, v11
 v_accvgpr_read_b32 v23, a189
 v_dot2c_f32_bf16 v246, v23, v13
 v_dot2c_f32_bf16 v247, v23, v11
 v_accvgpr_read_b32 v24, a190
 v_dot2c_f32_bf16 v252, v24, v13
 v_dot2c_f32_bf16 v253, v24, v11
 v_accvgpr_read_b32 v25, a191
 v_dot2c_f32_bf16 v254, v25, v13
 v_dot2c_f32_bf16 v255, v25, v11
 s_nop 3
 s_branch L_p2
L_st0:
 s_call_b64 s[36:37], L_slow0
 s_branch L_rt0
L_st1:
 s_call_b64 s[36:37], L_slow1
 s_branch L_rt1
L_st2:
 s_call_b64 s[36:37], L_slowB
 s_branch L_rt2
L_st3:
 s_call_b64 s[36:37], L_slow1
 s_branch L_rt3
L_st4:
 s_call_b64 s[36:37], L_slow1n
 s_branch L_rt4
L_st5:
 s_call_b64 s[36:37], L_slow1
 s_branch L_rt5
L_st6:
 s_call_b64 s[36:37], L_slow0B
 s_branch L_rt6
L_st7:
 s_call_b64 s[36:37], L_slowB
 s_branch L_rt7
L_st8:
 s_call_b64 s[36:37], L_slowf
 s_branch L_rt8
L_st9:
 s_call_b64 s[36:37], L_slow1
 s_branch L_rt9
L_st10:
 s_call_b64 s[36:37], L_slowf
 s_branch L_rt10
L_st11:
 s_call_b64 s[36:37], L_slowf
 s_branch L_rt11
L_st14:
 s_call_b64 s[36:37], L_slow0B
 s_branch L_rt14
L_st12:
 s_call_b64 s[36:37], L_slow0
 s_branch L_rt12
L_st13:
 s_call_b64 s[36:37], L_slow1
 s_branch L_rt13
L_slow0:
 s_nop 7
 s_nop 3
 v_max3_f32 v10, v64, v65, v66
 v_max3_f32 v10, v67, v72, v10
 v_max3_f32 v10, v73, v74, v10
 v_max3_f32 v10, v75, v80, v10
 v_max3_f32 v10, v81, v82, v10
 v_max3_f32 v10, v83, v88, v10
 v_max3_f32 v10, v89, v90, v10
 v_max_f32 v10, v91, v10
 v_max3_f32 v11, v68, v69, v70
 v_max3_f32 v11, v71, v76, v11
 v_max3_f32 v11, v77, v78, v11
 v_max3_f32 v11, v79, v84, v11
 v_max3_f32 v11, v85, v86, v11
 v_max3_f32 v11, v87, v92, v11
 v_max3_f32 v11, v93, v94, v11
 v_max_f32 v11, v95, v11
 v_mov_b32 v12, v10
 v_mov_b32 v13, v11
 s_nop 0
 v_permlane16_swap_b32 v12, v10
 v_permlane16_swap_b32 v13, v11
 v_max_f32 v10, v12, v10
 v_max_f32 v11, v13, v11
 v_mov_b32 v12, v10
 v_mov_b32 v13, v11
 s_nop 0
 v_permlane32_swap_b32 v12, v10
 v_permlane32_swap_b32 v13, v11
 v_max_f32 v10, v12, v10
 v_max_f32 v11, v13, v11
 v_ceil_f32 v10, v10
 v_ceil_f32 v11, v11
 v_max_f32 v10, 0, v10
 v_max_f32 v11, 0, v11
 v_sub_f32 v64, v64, v10
 v_sub_f32 v65, v65, v10
 v_sub_f32 v66, v66, v10
 v_sub_f32 v67, v67, v10
 v_sub_f32 v68, v68, v11
 v_sub_f32 v69, v69, v11
 v_sub_f32 v70, v70, v11
 v_sub_f32 v71, v71, v11
 v_sub_f32 v72, v72, v10
 v_sub_f32 v73, v73, v10
 v_sub_f32 v74, v74, v10
 v_sub_f32 v75, v75, v10
 v_sub_f32 v76, v76, v11
 v_sub_f32 v77, v77, v11
 v_sub_f32 v78, v78, v11
 v_sub_f32 v79, v79, v11
 v_sub_f32 v80, v80, v10
 v_sub_f32 v81, v81, v10
 v_sub_f32 v82, v82, v10
 v_sub_f32 v83, v83, v10
 v_sub_f32 v84, v84, v11
 v_sub_f32 v85, v85, v11
 v_sub_f32 v86, v86, v11
 v_sub_f32 v87, v87, v11
 v_sub_f32 v88, v88, v10
 v_sub_f32 v89, v89, v10
 v_sub_f32 v90, v90, v10
 v_sub_f32 v91, v91, v10
 v_sub_f32 v92, v92, v11
 v_sub_f32 v93, v93, v11
 v_sub_f32 v94, v94, v11
 v_sub_f32 v95, v95, v11
 v_sub_f32 v96, v96, v10
 v_sub_f32 v97, v97, v10
 v_sub_f32 v98, v98, v10
 v_sub_f32 v99, v99, v10
 v_sub_f32 v100, v100, v11
 v_sub_f32 v101, v101, v11
 v_sub_f32 v102, v102, v11
 v_sub_f32 v103, v103, v11
 v_sub_f32 v104, v104, v10
 v_sub_f32 v105, v105, v10
 v_sub_f32 v106, v106, v10
 v_sub_f32 v107, v107, v10
 v_sub_f32 v108, v108, v11
 v_sub_f32 v109, v109, v11
 v_sub_f32 v110, v110, v11
 v_sub_f32 v111, v111, v11
 v_sub_f32 v112, v112, v10
 v_sub_f32 v113, v113, v10
 v_sub_f32 v114, v114, v10
 v_sub_f32 v115, v115, v10
 v_sub_f32 v116, v116, v11
 v_sub_f32 v117, v117, v11
 v_sub_f32 v118, v118, v11
 v_sub_f32 v119, v119, v11
 v_sub_f32 v120, v120, v10
 v_sub_f32 v121, v121, v10
 v_sub_f32 v122, v122, v10
 v_sub_f32 v123, v123, v10
 v_sub_f32 v124, v124, v11
 v_sub_f32 v125, v125, v11
 v_sub_f32 v126, v126, v11
 v_sub_f32 v127, v127, v11
 v_sub_f32 v32, v32, v10
 v_sub_f32 v33, v33, v10
 v_sub_f32 v34, v34, v10
 v_sub_f32 v35, v35, v10
 v_sub_f32 v36, v36, v11
 v_sub_f32 v37, v37, v11
 v_sub_f32 v38, v38, v11
 v_sub_f32 v39, v39, v11
 v_exp_f32 v12, -v10
 v_exp_f32 v13, -v11
 v_mul_f32 v30, v12, v30
 v_mul_f32 v31, v13, v31
 v_mul_f32 v128, v12, v128
 v_mul_f32 v129, v12, v129
 v_mul_f32 v130, v12, v130
 v_mul_f32 v131, v12, v131
 v_mul_f32 v132, v13, v132
 v_mul_f32 v133, v13, v133
 v_mul_f32 v134, v13, v134
 v_mul_f32 v135, v13, v135
 v_mul_f32 v136, v12, v136
 v_mul_f32 v137, v12, v137
 v_mul_f32 v138, v12, v138
 v_mul_f32 v139, v12, v139
 v_mul_f32 v140, v13, v140
 v_mul_f32 v141, v13, v141
 v_mul_f32 v142, v13, v142
 v_mul_f32 v143, v13, v143
 v_mul_f32 v144, v12, v144
 v_mul_f32 v145, v12, v145
 v_mul_f32 v146, v12, v146
 v_mul_f32 v147, v12, v147
 v_mul_f32 v148, v13, v148
 v_mul_f32 v149, v13, v149
 v_mul_f32 v150, v13, v150
 v_mul_f32 v151, v13, v151
 v_mul_f32 v152, v12, v152
 v_mul_f32 v153, v12, v153
 v_mul_f32 v154, v12, v154
 v_mul_f32 v155, v12, v155
 v_mul_f32 v156, v13, v156
 v_mul_f32 v157, v13, v157
 v_mul_f32 v158, v13, v158
 v_mul_f32 v159, v13, v159
 v_mul_f32 v160, v12, v160
 v_mul_f32 v161, v12, v161
 v_mul_f32 v162, v12, v162
 v_mul_f32 v163, v12, v163
 v_mul_f32 v164, v13, v164
 v_mul_f32 v165, v13, v165
 v_mul_f32 v166, v13, v166
 v_mul_f32 v167, v13, v167
 v_mul_f32 v168, v12, v168
 v_mul_f32 v169, v12, v169
 v_mul_f32 v170, v12, v170
 v_mul_f32 v171, v12, v171
 v_mul_f32 v172, v13, v172
 v_mul_f32 v173, v13, v173
 v_mul_f32 v174, v13, v174
 v_mul_f32 v175, v13, v175
 v_mul_f32 v176, v12, v176
 v_mul_f32 v177, v12, v177
 v_mul_f32 v178, v12, v178
 v_mul_f32 v179, v12, v179
 v_mul_f32 v180, v13, v180
 v_mul_f32 v181, v13, v181
 v_mul_f32 v182, v13, v182
 v_mul_f32 v183, v13, v183
 v_mul_f32 v184, v12, v184
 v_mul_f32 v185, v12, v185
 v_mul_f32 v186, v12, v186
 v_mul_f32 v187, v12, v187
 v_mul_f32 v188, v13, v188
 v_mul_f32 v189, v13, v189
 v_mul_f32 v190, v13, v190
 v_mul_f32 v191, v13, v191
 v_mul_f32 v192, v12, v192
 v_mul_f32 v193, v12, v193
 v_mul_f32 v194, v12, v194
 v_mul_f32 v195, v12, v195
 v_mul_f32 v196, v13, v196
 v_mul_f32 v197, v13, v197
 v_mul_f32 v198, v13, v198
 v_mul_f32 v199, v13, v199
 v_mul_f32 v200, v12, v200
 v_mul_f32 v201, v12, v201
 v_mul_f32 v202, v12, v202
 v_mul_f32 v203, v12, v203
 v_mul_f32 v204, v13, v204
 v_mul_f32 v205, v13, v205
 v_mul_f32 v206, v13, v206
 v_mul_f32 v207, v13, v207
 v_mul_f32 v208, v12, v208
 v_mul_f32 v209, v12, v209
 v_mul_f32 v210, v12, v210
 v_mul_f32 v211, v12, v211
 v_mul_f32 v212, v13, v212
 v_mul_f32 v213, v13, v213
 v_mul_f32 v214, v13, v214
 v_mul_f32 v215, v13, v215
 v_mul_f32 v216, v12, v216
 v_mul_f32 v217, v12, v217
 v_mul_f32 v218, v12, v218
 v_mul_f32 v219, v12, v219
 v_mul_f32 v220, v13, v220
 v_mul_f32 v221, v13, v221
 v_mul_f32 v222, v13, v222
 v_mul_f32 v223, v13, v223
 v_mul_f32 v224, v12, v224
 v_mul_f32 v225, v12, v225
 v_mul_f32 v226, v12, v226
 v_mul_f32 v227, v12, v227
 v_mul_f32 v228, v13, v228
 v_mul_f32 v229, v13, v229
 v_mul_f32 v230, v13, v230
 v_mul_f32 v231, v13, v231
 v_mul_f32 v232, v12, v232
 v_mul_f32 v233, v12, v233
 v_mul_f32 v234, v12, v234
 v_mul_f32 v235, v12, v235
 v_mul_f32 v236, v13, v236
 v_mul_f32 v237, v13, v237
 v_mul_f32 v238, v13, v238
 v_mul_f32 v239, v13, v239
 v_mul_f32 v240, v12, v240
 v_mul_f32 v241, v12, v241
 v_mul_f32 v242, v12, v242
 v_mul_f32 v243, v12, v243
 v_mul_f32 v244, v13, v244
 v_mul_f32 v245, v13, v245
 v_mul_f32 v246, v13, v246
 v_mul_f32 v247, v13, v247
 v_mul_f32 v248, v12, v248
 v_mul_f32 v249, v12, v249
 v_mul_f32 v250, v12, v250
 v_mul_f32 v251, v12, v251
 v_mul_f32 v252, v13, v252
 v_mul_f32 v253, v13, v253
 v_mul_f32 v254, v13, v254
 v_mul_f32 v255, v13, v255
 v_exp_f32 v18, v64
 v_exp_f32 v19, v65
 v_exp_f32 v20, v66
 v_add_f32 v26, v18, v19
 v_cvt_pk_bf16_f32 v40, v18, v19
 v_exp_f32 v21, v67
 v_exp_f32 v22, v72
 v_add_f32 v26, v20, v26
 v_cvt_pk_bf16_f32 v41, v20, v21
 v_exp_f32 v23, v73
 v_add_f32 v26, v21, v26
 v_exp_f32 v24, v74
 v_add_f32 v26, v22, v26
 v_cvt_pk_bf16_f32 v42, v22, v23
 v_exp_f32 v25, v75
 v_add_f32 v26, v23, v26
 v_exp_f32 v18, v68
 v_add_f32 v26, v24, v26
 v_cvt_pk_bf16_f32 v43, v24, v25
 v_exp_f32 v19, v69
 v_add_f32 v26, v25, v26
 v_exp_f32 v20, v70
 v_add_f32 v27, v18, v19
 v_cvt_pk_bf16_f32 v44, v18, v19
 v_exp_f32 v21, v71
 v_exp_f32 v22, v76
 v_add_f32 v27, v20, v27
 v_cvt_pk_bf16_f32 v45, v20, v21
 v_exp_f32 v23, v77
 v_add_f32 v27, v21, v27
 v_exp_f32 v24, v78
 v_add_f32 v27, v22, v27
 v_cvt_pk_bf16_f32 v46, v22, v23
 v_exp_f32 v25, v79
 v_add_f32 v27, v23, v27
 v_add_f32 v27, v24, v27
 v_cvt_pk_bf16_f32 v47, v24, v25
 v_add_f32 v27, v25, v27
 v_exp_f32 v18, v80
 v_exp_f32 v19, v81
 v_exp_f32 v20, v82
 v_add_f32 v26, v18, v26
 v_cvt_pk_bf16_f32 v56, v18, v19
 v_exp_f32 v21, v83
 v_add_f32 v26, v19, v26
 v_exp_f32 v22, v88
 v_add_f32 v26, v20, v26
 v_cvt_pk_bf16_f32 v57, v20, v21
 v_exp_f32 v23, v89
 v_add_f32 v26, v21, v26
 v_exp_f32 v24, v90
 v_add_f32 v26, v22, v26
 v_cvt_pk_bf16_f32 v58, v22, v23
 v_exp_f32 v25, v91
 v_add_f32 v26, v23, v26
 v_exp_f32 v18, v84
 v_add_f32 v26, v24, v26
 v_cvt_pk_bf16_f32 v59, v24, v25
 v_exp_f32 v19, v85
 v_add_f32 v26, v25, v26
 v_exp_f32 v20, v86
 v_add_f32 v27, v18, v27
 v_cvt_pk_bf16_f32 v60, v18, v19
 v_exp_f32 v21, v87
 v_add_f32 v27, v19, v27
 v_exp_f32 v22, v92
 v_add_f32 v27, v20, v27
 v_cvt_pk_bf16_f32 v61, v20, v21
 v_exp_f32 v23, v93
 v_add_f32 v27, v21, v27
 v_exp_f32 v24, v94
 v_add_f32 v27, v22, v27
 v_cvt_pk_bf16_f32 v62, v22, v23
 v_exp_f32 v25, v95
 v_add_f32 v27, v23, v27
 v_add_f32 v27, v24, v27
 v_cvt_pk_bf16_f32 v63, v24, v25
 v_add_f32 v27, v25, v27
 s_nop 3
 s_setpc_b64 s[36:37]
L_slow1:
 s_nop 7
 s_nop 3
 v_max3_f32 v10, v96, v97, v98
 v_max3_f32 v10, v99, v104, v10
 v_max3_f32 v10, v105, v106, v10
 v_max3_f32 v10, v107, v112, v10
 v_max3_f32 v10, v113, v114, v10
 v_max3_f32 v10, v115, v120, v10
 v_max3_f32 v10, v121, v122, v10
 v_max_f32 v10, v123, v10
 v_max3_f32 v11, v100, v101, v102
 v_max3_f32 v11, v103, v108, v11
 v_max3_f32 v11, v109, v110, v11
 v_max3_f32 v11, v111, v116, v11
 v_max3_f32 v11, v117, v118, v11
 v_max3_f32 v11, v119, v124, v11
 v_max3_f32 v11, v125, v126, v11
 v_max_f32 v11, v127, v11
 v_mov_b32 v12, v10
 v_mov_b32 v13, v11
 s_nop 0
 v_permlane16_swap_b32 v12, v10
 v_permlane16_swap_b32 v13, v11
 v_max_f32 v10, v12, v10
 v_max_f32 v11, v13, v11
 v_mov_b32 v12, v10
 v_mov_b32 v13, v11
 s_nop 0
 v_permlane32_swap_b32 v12, v10
 v_permlane32_swap_b32 v13, v11
 v_max_f32 v10, v12, v10
 v_max_f32 v11, v13, v11
 v_ceil_f32 v10, v10
 v_ceil_f32 v11, v11
 v_max_f32 v10, 0, v10
 v_max_f32 v11, 0, v11
 v_sub_f32 v96, v96, v10
 v_sub_f32 v97, v97, v10
 v_sub_f32 v98, v98, v10
 v_sub_f32 v99, v99, v10
 v_sub_f32 v100, v100, v11
 v_sub_f32 v101, v101, v11
 v_sub_f32 v102, v102, v11
 v_sub_f32 v103, v103, v11
 v_sub_f32 v104, v104, v10
 v_sub_f32 v105, v105, v10
 v_sub_f32 v106, v106, v10
 v_sub_f32 v107, v107, v10
 v_sub_f32 v108, v108, v11
 v_sub_f32 v109, v109, v11
 v_sub_f32 v110, v110, v11
 v_sub_f32 v111, v111, v11
 v_sub_f32 v112, v112, v10
 v_sub_f32 v113, v113, v10
 v_sub_f32 v114, v114, v10
 v_sub_f32 v115, v115, v10
 v_sub_f32 v116, v116, v11
 v_sub_f32 v117, v117, v11
 v_sub_f32 v118, v118, v11
 v_sub_f32 v119, v119, v11
 v_sub_f32 v120, v120, v10
 v_sub_f32 v121, v121, v10
 v_sub_f32 v122, v122, v10
 v_sub_f32 v123, v123, v10
 v_sub_f32 v124, v124, v11
 v_sub_f32 v125, v125, v11
 v_sub_f32 v126, v126, v11
 v_sub_f32 v127, v127, v11
 v_sub_f32 v64, v64, v10
 v_sub_f32 v65, v65, v10
 v_sub_f32 v66, v66, v10
 v_sub_f32 v67, v67, v10
 v_sub_f32 v68, v68, v11
 v_sub_f32 v69, v69, v11
 v_sub_f32 v70, v70, v11
 v_sub_f32 v71, v71, v11
 v_sub_f32 v72, v72, v10
 v_sub_f32 v73, v73, v10
 v_sub_f32 v74, v74, v10
 v_sub_f32 v75, v75, v10
 v_sub_f32 v76, v76, v11
 v_sub_f32 v77, v77, v11
 v_sub_f32 v78, v78, v11
 v_sub_f32 v79, v79, v11
 v_sub_f32 v80, v80, v10
 v_sub_f32 v81, v81, v10
 v_sub_f32 v82, v82, v10
 v_sub_f32 v83, v83, v10
 v_sub_f32 v84, v84, v11
 v_sub_f32 v85, v85, v11
 v_sub_f32 v86, v86, v11
 v_sub_f32 v87, v87, v11
 v_sub_f32 v88, v88, v10
 v_sub_f32 v89, v89, v10
 v_sub_f32 v90, v90, v10
 v_sub_f32 v91, v91, v10
 v_sub_f32 v92, v92, v11
 v_sub_f32 v93, v93, v11
 v_sub_f32 v94, v94, v11
 v_sub_f32 v95, v95, v11
 v_sub_f32 v32, v32, v10
 v_sub_f32 v33, v33, v10
 v_sub_f32 v34, v34, v10
 v_sub_f32 v35, v35, v10
 v_sub_f32 v36, v36, v11
 v_sub_f32 v37, v37, v11
 v_sub_f32 v38, v38, v11
 v_sub_f32 v39, v39, v11
 v_exp_f32 v12, -v10
 v_exp_f32 v13, -v11
 v_mul_f32 v30, v12, v30
 v_mul_f32 v31, v13, v31
 v_mul_f32 v128, v12, v128
 v_mul_f32 v129, v12, v129
 v_mul_f32 v130, v12, v130
 v_mul_f32 v131, v12, v131
 v_mul_f32 v132, v13, v132
 v_mul_f32 v133, v13, v133
 v_mul_f32 v134, v13, v134
 v_mul_f32 v135, v13, v135
 v_mul_f32 v136, v12, v136
 v_mul_f32 v137, v12, v137
 v_mul_f32 v138, v12, v138
 v_mul_f32 v139, v12, v139
 v_mul_f32 v140, v13, v140
 v_mul_f32 v141, v13, v141
 v_mul_f32 v142, v13, v142
 v_mul_f32 v143, v13, v143
 v_mul_f32 v144, v12, v144
 v_mul_f32 v145, v12, v145
 v_mul_f32 v146, v12, v146
 v_mul_f32 v147, v12, v147
 v_mul_f32 v148, v13, v148
 v_mul_f32 v149, v13, v149
 v_mul_f32 v150, v13, v150
 v_mul_f32 v151, v13, v151
 v_mul_f32 v152, v12, v152
 v_mul_f32 v153, v12, v153
 v_mul_f32 v154, v12, v154
 v_mul_f32 v155, v12, v155
 v_mul_f32 v156, v13, v156
 v_mul_f32 v157, v13, v157
 v_mul_f32 v158, v13, v158
 v_mul_f32 v159, v13, v159
 v_mul_f32 v160, v12, v160
 v_mul_f32 v161, v12, v161
 v_mul_f32 v162, v12, v162
 v_mul_f32 v163, v12, v163
 v_mul_f32 v164, v13, v164
 v_mul_f32 v165, v13, v165
 v_mul_f32 v166, v13, v166
 v_mul_f32 v167, v13, v167
 v_mul_f32 v168, v12, v168
 v_mul_f32 v169, v12, v169
 v_mul_f32 v170, v12, v170
 v_mul_f32 v171, v12, v171
 v_mul_f32 v172, v13, v172
 v_mul_f32 v173, v13, v173
 v_mul_f32 v174, v13, v174
 v_mul_f32 v175, v13, v175
 v_mul_f32 v176, v12, v176
 v_mul_f32 v177, v12, v177
 v_mul_f32 v178, v12, v178
 v_mul_f32 v179, v12, v179
 v_mul_f32 v180, v13, v180
 v_mul_f32 v181, v13, v181
 v_mul_f32 v182, v13, v182
 v_mul_f32 v183, v13, v183
 v_mul_f32 v184, v12, v184
 v_mul_f32 v185, v12, v185
 v_mul_f32 v186, v12, v186
 v_mul_f32 v187, v12, v187
 v_mul_f32 v188, v13, v188
 v_mul_f32 v189, v13, v189
 v_mul_f32 v190, v13, v190
 v_mul_f32 v191, v13, v191
 v_mul_f32 v192, v12, v192
 v_mul_f32 v193, v12, v193
 v_mul_f32 v194, v12, v194
 v_mul_f32 v195, v12, v195
 v_mul_f32 v196, v13, v196
 v_mul_f32 v197, v13, v197
 v_mul_f32 v198, v13, v198
 v_mul_f32 v199, v13, v199
 v_mul_f32 v200, v12, v200
 v_mul_f32 v201, v12, v201
 v_mul_f32 v202, v12, v202
 v_mul_f32 v203, v12, v203
 v_mul_f32 v204, v13, v204
 v_mul_f32 v205, v13, v205
 v_mul_f32 v206, v13, v206
 v_mul_f32 v207, v13, v207
 v_mul_f32 v208, v12, v208
 v_mul_f32 v209, v12, v209
 v_mul_f32 v210, v12, v210
 v_mul_f32 v211, v12, v211
 v_mul_f32 v212, v13, v212
 v_mul_f32 v213, v13, v213
 v_mul_f32 v214, v13, v214
 v_mul_f32 v215, v13, v215
 v_mul_f32 v216, v12, v216
 v_mul_f32 v217, v12, v217
 v_mul_f32 v218, v12, v218
 v_mul_f32 v219, v12, v219
 v_mul_f32 v220, v13, v220
 v_mul_f32 v221, v13, v221
 v_mul_f32 v222, v13, v222
 v_mul_f32 v223, v13, v223
 v_mul_f32 v224, v12, v224
 v_mul_f32 v225, v12, v225
 v_mul_f32 v226, v12, v226
 v_mul_f32 v227, v12, v227
 v_mul_f32 v228, v13, v228
 v_mul_f32 v229, v13, v229
 v_mul_f32 v230, v13, v230
 v_mul_f32 v231, v13, v231
 v_mul_f32 v232, v12, v232
 v_mul_f32 v233, v12, v233
 v_mul_f32 v234, v12, v234
 v_mul_f32 v235, v12, v235
 v_mul_f32 v236, v13, v236
 v_mul_f32 v237, v13, v237
 v_mul_f32 v238, v13, v238
 v_mul_f32 v239, v13, v239
 v_mul_f32 v240, v12, v240
 v_mul_f32 v241, v12, v241
 v_mul_f32 v242, v12, v242
 v_mul_f32 v243, v12, v243
 v_mul_f32 v244, v13, v244
 v_mul_f32 v245, v13, v245
 v_mul_f32 v246, v13, v246
 v_mul_f32 v247, v13, v247
 v_mul_f32 v248, v12, v248
 v_mul_f32 v249, v12, v249
 v_mul_f32 v250, v12, v250
 v_mul_f32 v251, v12, v251
 v_mul_f32 v252, v13, v252
 v_mul_f32 v253, v13, v253
 v_mul_f32 v254, v13, v254
 v_mul_f32 v255, v13, v255
 v_exp_f32 v18, v96
 v_exp_f32 v19, v97
 v_exp_f32 v20, v98
 v_add_f32 v28, v18, v19
 v_cvt_pk_bf16_f32 v48, v18, v19
 v_exp_f32 v21, v99
 v_exp_f32 v22, v104
 v_add_f32 v28, v20, v28
 v_cvt_pk_bf16_f32 v49, v20, v21
 v_exp_f32 v23, v105
 v_add_f32 v28, v21, v28
 v_exp_f32 v24, v106
 v_add_f32 v28, v22, v28
 v_cvt_pk_bf16_f32 v50, v22, v23
 v_exp_f32 v25, v107
 v_add_f32 v28, v23, v28
 v_exp_f32 v18, v100
 v_add_f32 v28, v24, v28
 v_cvt_pk_bf16_f32 v51, v24, v25
 v_exp_f32 v19, v101
 v_add_f32 v28, v25, v28
 v_exp_f32 v20, v102
 v_add_f32 v29, v18, v19
 v_cvt_pk_bf16_f32 v52, v18, v19
 v_exp_f32 v21, v103
 v_exp_f32 v22, v108
 v_add_f32 v29, v20, v29
 v_cvt_pk_bf16_f32 v53, v20, v21
 v_exp_f32 v23, v109
 v_add_f32 v29, v21, v29
 v_exp_f32 v24, v110
 v_add_f32 v29, v22, v29
 v_cvt_pk_bf16_f32 v54, v22, v23
 v_exp_f32 v25, v111
 v_add_f32 v29, v23, v29
 v_add_f32 v29, v24, v29
 v_cvt_pk_bf16_f32 v55, v24, v25
 v_add_f32 v29, v25, v29
 v_exp_f32 v18, v112
 v_exp_f32 v19, v113
 v_exp_f32 v20, v114
 v_add_f32 v28, v18, v28
 v_cvt_pk_bf16_f32 v56, v18, v19
 v_exp_f32 v21, v115
 v_add_f32 v28, v19, v28
 v_exp_f32 v22, v120
 v_add_f32 v28, v20, v28
 v_cvt_pk_bf16_f32 v57, v20, v21
 v_exp_f32 v23, v121
 v_add_f32 v28, v21, v28
 v_exp_f32 v24, v122
 v_add_f32 v28, v22, v28
 v_cvt_pk_bf16_f32 v58, v22, v23
 v_exp_f32 v25, v123
 v_add_f32 v28, v23, v28
 v_exp_f32 v18, v116
 v_add_f32 v28, v24, v28
 v_cvt_pk_bf16_f32 v59, v24, v25
 v_exp_f32 v19, v117
 v_add_f32 v28, v25, v28
 v_exp_f32 v20, v118
 v_add_f32 v29, v18, v29
 v_cvt_pk_bf16_f32 v60, v18, v19
 v_exp_f32 v21, v119
 v_add_f32 v29, v19, v29
 v_exp_f32 v22, v124
 v_add_f32 v29, v20, v29
 v_cvt_pk_bf16_f32 v61, v20, v21
 v_exp_f32 v23, v125
 v_add_f32 v29, v21, v29
 v_exp_f32 v24, v126
 v_add_f32 v29, v22, v29
 v_cvt_pk_bf16_f32 v62, v22, v23
 v_exp_f32 v25, v127
 v_add_f32 v29, v23, v29
 v_add_f32 v29, v24, v29
 v_cvt_pk_bf16_f32 v63, v24, v25
 v_add_f32 v29, v25, v29
 s_nop 3
 s_setpc_b64 s[36:37]
L_slow1n:
 s_nop 7
 s_nop 3
 v_max3_f32 v10, v96, v97, v98
 v_max3_f32 v10, v99, v104, v10
 v_max3_f32 v10, v105, v106, v10
 v_max3_f32 v10, v107, v112, v10
 v_max3_f32 v10, v113, v114, v10
 v_max3_f32 v10, v115, v120, v10
 v_max3_f32 v10, v121, v122, v10
 v_max_f32 v10, v123, v10
 v_max3_f32 v11, v100, v101, v102
 v_max3_f32 v11, v103, v108, v11
 v_max3_f32 v11, v109, v110, v11
 v_max3_f32 v11, v111, v116, v11
 v_max3_f32 v11, v117, v118, v11
 v_max3_f32 v11, v119, v124, v11
 v_max3_f32 v11, v125, v126, v11
 v_max_f32 v11, v127, v11
 v_mov_b32 v12, v10
 v_mov_b32 v13, v11
 s_nop 0
 v_permlane16_swap_b32 v12, v10
 v_permlane16_swap_b32 v13, v11
 v_max_f32 v10, v12, v10
 v_max_f32 v11, v13, v11
 v_mov_b32 v12, v10
 v_mov_b32 v13, v11
 s_nop 0
 v_permlane32_swap_b32 v12, v10
 v_permlane32_swap_b32 v13, v11
 v_max_f32 v10, v12, v10
 v_max_f32 v11, v13, v11
 v_ceil_f32 v10, v10
 v_ceil_f32 v11, v11
 v_max_f32 v10, 0, v10
 v_max_f32 v11, 0, v11
 v_sub_f32 v96, v96, v10
 v_sub_f32 v97, v97, v10
 v_sub_f32 v98, v98, v10
 v_sub_f32 v99, v99, v10
 v_sub_f32 v100, v100, v11
 v_sub_f32 v101, v101, v11
 v_sub_f32 v102, v102, v11
 v_sub_f32 v103, v103, v11
 v_sub_f32 v104, v104, v10
 v_sub_f32 v105, v105, v10
 v_sub_f32 v106, v106, v10
 v_sub_f32 v107, v107, v10
 v_sub_f32 v108, v108, v11
 v_sub_f32 v109, v109, v11
 v_sub_f32 v110, v110, v11
 v_sub_f32 v111, v111, v11
 v_sub_f32 v112, v112, v10
 v_sub_f32 v113, v113, v10
 v_sub_f32 v114, v114, v10
 v_sub_f32 v115, v115, v10
 v_sub_f32 v116, v116, v11
 v_sub_f32 v117, v117, v11
 v_sub_f32 v118, v118, v11
 v_sub_f32 v119, v119, v11
 v_sub_f32 v120, v120, v10
 v_sub_f32 v121, v121, v10
 v_sub_f32 v122, v122, v10
 v_sub_f32 v123, v123, v10
 v_sub_f32 v124, v124, v11
 v_sub_f32 v125, v125, v11
 v_sub_f32 v126, v126, v11
 v_sub_f32 v127, v127, v11
 v_sub_f32 v32, v32, v10
 v_sub_f32 v33, v33, v10
 v_sub_f32 v34, v34, v10
 v_sub_f32 v35, v35, v10
 v_sub_f32 v36, v36, v11
 v_sub_f32 v37, v37, v11
 v_sub_f32 v38, v38, v11
 v_sub_f32 v39, v39, v11
 v_exp_f32 v12, -v10
 v_exp_f32 v13, -v11
 v_mul_f32 v30, v12, v30
 v_mul_f32 v31, v13, v31
 v_mul_f32 v128, v12, v128
 v_mul_f32 v129, v12, v129
 v_mul_f32 v130, v12, v130
 v_mul_f32 v131, v12, v131
 v_mul_f32 v132, v13, v132
 v_mul_f32 v133, v13, v133
 v_mul_f32 v134, v13, v134
 v_mul_f32 v135, v13, v135
 v_mul_f32 v136, v12, v136
 v_mul_f32 v137, v12, v137
 v_mul_f32 v138, v12, v138
 v_mul_f32 v139, v12, v139
 v_mul_f32 v140, v13, v140
 v_mul_f32 v141, v13, v141
 v_mul_f32 v142, v13, v142
 v_mul_f32 v143, v13, v143
 v_mul_f32 v144, v12, v144
 v_mul_f32 v145, v12, v145
 v_mul_f32 v146, v12, v146
 v_mul_f32 v147, v12, v147
 v_mul_f32 v148, v13, v148
 v_mul_f32 v149, v13, v149
 v_mul_f32 v150, v13, v150
 v_mul_f32 v151, v13, v151
 v_mul_f32 v152, v12, v152
 v_mul_f32 v153, v12, v153
 v_mul_f32 v154, v12, v154
 v_mul_f32 v155, v12, v155
 v_mul_f32 v156, v13, v156
 v_mul_f32 v157, v13, v157
 v_mul_f32 v158, v13, v158
 v_mul_f32 v159, v13, v159
 v_mul_f32 v160, v12, v160
 v_mul_f32 v161, v12, v161
 v_mul_f32 v162, v12, v162
 v_mul_f32 v163, v12, v163
 v_mul_f32 v164, v13, v164
 v_mul_f32 v165, v13, v165
 v_mul_f32 v166, v13, v166
 v_mul_f32 v167, v13, v167
 v_mul_f32 v168, v12, v168
 v_mul_f32 v169, v12, v169
 v_mul_f32 v170, v12, v170
 v_mul_f32 v171, v12, v171
 v_mul_f32 v172, v13, v172
 v_mul_f32 v173, v13, v173
 v_mul_f32 v174, v13, v174
 v_mul_f32 v175, v13, v175
 v_mul_f32 v176, v12, v176
 v_mul_f32 v177, v12, v177
 v_mul_f32 v178, v12, v178
 v_mul_f32 v179, v12, v179
 v_mul_f32 v180, v13, v180
 v_mul_f32 v181, v13, v181
 v_mul_f32 v182, v13, v182
 v_mul_f32 v183, v13, v183
 v_mul_f32 v184, v12, v184
 v_mul_f32 v185, v12, v185
 v_mul_f32 v186, v12, v186
 v_mul_f32 v187, v12, v187
 v_mul_f32 v188, v13, v188
 v_mul_f32 v189, v13, v189
 v_mul_f32 v190, v13, v190
 v_mul_f32 v191, v13, v191
 v_mul_f32 v192, v12, v192
 v_mul_f32 v193, v12, v193
 v_mul_f32 v194, v12, v194
 v_mul_f32 v195, v12, v195
 v_mul_f32 v196, v13, v196
 v_mul_f32 v197, v13, v197
 v_mul_f32 v198, v13, v198
 v_mul_f32 v199, v13, v199
 v_mul_f32 v200, v12, v200
 v_mul_f32 v201, v12, v201
 v_mul_f32 v202, v12, v202
 v_mul_f32 v203, v12, v203
 v_mul_f32 v204, v13, v204
 v_mul_f32 v205, v13, v205
 v_mul_f32 v206, v13, v206
 v_mul_f32 v207, v13, v207
 v_mul_f32 v208, v12, v208
 v_mul_f32 v209, v12, v209
 v_mul_f32 v210, v12, v210
 v_mul_f32 v211, v12, v211
 v_mul_f32 v212, v13, v212
 v_mul_f32 v213, v13, v213
 v_mul_f32 v214, v13, v214
 v_mul_f32 v215, v13, v215
 v_mul_f32 v216, v12, v216
 v_mul_f32 v217, v12, v217
 v_mul_f32 v218, v12, v218
 v_mul_f32 v219, v12, v219
 v_mul_f32 v220, v13, v220
 v_mul_f32 v221, v13, v221
 v_mul_f32 v222, v13, v222
 v_mul_f32 v223, v13, v223
 v_mul_f32 v224, v12, v224
 v_mul_f32 v225, v12, v225
 v_mul_f32 v226, v12, v226
 v_mul_f32 v227, v12, v227
 v_mul_f32 v228, v13, v228
 v_mul_f32 v229, v13, v229
 v_mul_f32 v230, v13, v230
 v_mul_f32 v231, v13, v231
 v_mul_f32 v232, v12, v232
 v_mul_f32 v233, v12, v233
 v_mul_f32 v234, v12, v234
 v_mul_f32 v235, v12, v235
 v_mul_f32 v236, v13, v236
 v_mul_f32 v237, v13, v237
 v_mul_f32 v238, v13, v238
 v_mul_f32 v239, v13, v239
 v_mul_f32 v240, v12, v240
 v_mul_f32 v241, v12, v241
 v_mul_f32 v242, v12, v242
 v_mul_f32 v243, v12, v243
 v_mul_f32 v244, v13, v244
 v_mul_f32 v245, v13, v245
 v_mul_f32 v246, v13, v246
 v_mul_f32 v247, v13, v247
 v_mul_f32 v248, v12, v248
 v_mul_f32 v249, v12, v249
 v_mul_f32 v250, v12, v250
 v_mul_f32 v251, v12, v251
 v_mul_f32 v252, v13, v252
 v_mul_f32 v253, v13, v253
 v_mul_f32 v254, v13, v254
 v_mul_f32 v255, v13, v255
 v_exp_f32 v18, v96
 v_exp_f32 v19, v97
 v_exp_f32 v20, v98
 v_add_f32 v28, v18, v19
 v_cvt_pk_bf16_f32 v48, v18, v19
 v_exp_f32 v21, v99
 v_exp_f32 v22, v104
 v_add_f32 v28, v20, v28
 v_cvt_pk_bf16_f32 v49, v20, v21
 v_exp_f32 v23, v105
 v_add_f32 v28, v21, v28
 v_exp_f32 v24, v106
 v_add_f32 v28, v22, v28
 v_cvt_pk_bf16_f32 v50, v22, v23
 v_exp_f32 v25, v107
 v_add_f32 v28, v23, v28
 v_exp_f32 v18, v100
 v_add_f32 v28, v24, v28
 v_cvt_pk_bf16_f32 v51, v24, v25
 v_exp_f32 v19, v101
 v_add_f32 v28, v25, v28
 v_exp_f32 v20, v102
 v_add_f32 v29, v18, v19
 v_cvt_pk_bf16_f32 v52, v18, v19
 v_exp_f32 v21, v103
 v_exp_f32 v22, v108
 v_add_f32 v29, v20, v29
 v_cvt_pk_bf16_f32 v53, v20, v21
 v_exp_f32 v23, v109
 v_add_f32 v29, v21, v29
 v_exp_f32 v24, v110
 v_add_f32 v29, v22, v29
 v_cvt_pk_bf16_f32 v54, v22, v23
 v_exp_f32 v25, v111
 v_add_f32 v29, v23, v29
 v_add_f32 v29, v24, v29
 v_cvt_pk_bf16_f32 v55, v24, v25
 v_add_f32 v29, v25, v29
 v_exp_f32 v18, v112
 v_exp_f32 v19, v113
 v_exp_f32 v20, v114
 v_add_f32 v28, v18, v28
 v_cvt_pk_bf16_f32 v56, v18, v19
 v_exp_f32 v21, v115
 v_add_f32 v28, v19, v28
 v_exp_f32 v22, v120
 v_add_f32 v28, v20, v28
 v_cvt_pk_bf16_f32 v57, v20, v21
 v_exp_f32 v23, v121
 v_add_f32 v28, v21, v28
 v_exp_f32 v24, v122
 v_add_f32 v28, v22, v28
 v_cvt_pk_bf16_f32 v58, v22, v23
 v_exp_f32 v25, v123
 v_add_f32 v28, v23, v28
 v_exp_f32 v18, v116
 v_add_f32 v28, v24, v28
 v_cvt_pk_bf16_f32 v59, v24, v25
 v_exp_f32 v19, v117
 v_add_f32 v28, v25, v28
 v_exp_f32 v20, v118
 v_add_f32 v29, v18, v29
 v_cvt_pk_bf16_f32 v60, v18, v19
 v_exp_f32 v21, v119
 v_add_f32 v29, v19, v29
 v_exp_f32 v22, v124
 v_add_f32 v29, v20, v29
 v_cvt_pk_bf16_f32 v61, v20, v21
 v_exp_f32 v23, v125
 v_add_f32 v29, v21, v29
 v_exp_f32 v24, v126
 v_add_f32 v29, v22, v29
 v_cvt_pk_bf16_f32 v62, v22, v23
 v_exp_f32 v25, v127
 v_add_f32 v29, v23, v29
 v_add_f32 v29, v24, v29
 v_cvt_pk_bf16_f32 v63, v24, v25
 v_add_f32 v29, v25, v29
 s_nop 3
 s_setpc_b64 s[36:37]
L_slow0B:
 s_nop 7
 s_nop 3
 v_max3_f32 v10, v64, v65, v66
 v_max3_f32 v10, v67, v72, v10
 v_max3_f32 v10, v73, v74, v10
 v_max3_f32 v10, v75, v80, v10
 v_max3_f32 v10, v81, v82, v10
 v_max3_f32 v10, v83, v88, v10
 v_max3_f32 v10, v89, v90, v10
 v_max_f32 v10, v91, v10
 v_max3_f32 v11, v68, v69, v70
 v_max3_f32 v11, v71, v76, v11
 v_max3_f32 v11, v77, v78, v11
 v_max3_f32 v11, v79, v84, v11
 v_max3_f32 v11, v85, v86, v11
 v_max3_f32 v11, v87, v92, v11
 v_max3_f32 v11, v93, v94, v11
 v_max_f32 v11, v95, v11
 v_mov_b32 v12, v10
 v_mov_b32 v13, v11
 s_nop 0
 v_permlane16_swap_b32 v12, v10
 v_permlane16_swap_b32 v13, v11
 v_max_f32 v10, v12, v10
 v_max_f32 v11, v13, v11
 v_mov_b32 v12, v10
 v_mov_b32 v13, v11
 s_nop 0
 v_permlane32_swap_b32 v12, v10
 v_permlane32_swap_b32 v13, v11
 v_max_f32 v10, v12, v10
 v_max_f32 v11, v13, v11
 v_ceil_f32 v10, v10
 v_ceil_f32 v11, v11
 v_max_f32 v10, 0, v10
 v_max_f32 v11, 0, v11
 v_sub_f32 v64, v64, v10
 v_sub_f32 v65, v65, v10
 v_sub_f32 v66, v66, v10
 v_sub_f32 v67, v67, v10
 v_sub_f32 v68, v68, v11
 v_sub_f32 v69, v69, v11
 v_sub_f32 v70, v70, v11
 v_sub_f32 v71, v71, v11
 v_sub_f32 v72, v72, v10
 v_sub_f32 v73, v73, v10
 v_sub_f32 v74, v74, v10
 v_sub_f32 v75, v75, v10
 v_sub_f32 v76, v76, v11
 v_sub_f32 v77, v77, v11
 v_sub_f32 v78, v78, v11
 v_sub_f32 v79, v79, v11
 v_sub_f32 v80, v80, v10
 v_sub_f32 v81, v81, v10
 v_sub_f32 v82, v82, v10
 v_sub_f32 v83, v83, v10
 v_sub_f32 v84, v84, v11
 v_sub_f32 v85, v85, v11
 v_sub_f32 v86, v86, v11
 v_sub_f32 v87, v87, v11
 v_sub_f32 v88, v88, v10
 v_sub_f32 v89, v89, v10
 v_sub_f32 v90, v90, v10
 v_sub_f32 v91, v91, v10
 v_sub_f32 v92, v92, v11
 v_sub_f32 v93, v93, v11
 v_sub_f32 v94, v94, v11
 v_sub_f32 v95, v95, v11
 v_sub_f32 v100, v100, v11
 v_sub_f32 v101, v101, v11
 v_sub_f32 v102, v102, v11
 v_sub_f32 v103, v103, v11
 v_sub_f32 v108, v108, v11
 v_sub_f32 v109, v109, v11
 v_sub_f32 v110, v110, v11
 v_sub_f32 v111, v111, v11
 v_sub_f32 v116, v116, v11
 v_sub_f32 v117, v117, v11
 v_sub_f32 v118, v118, v11
 v_sub_f32 v119, v119, v11
 v_sub_f32 v124, v124, v11
 v_sub_f32 v125, v125, v11
 v_sub_f32 v126, v126, v11
 v_sub_f32 v127, v127, v11
 v_sub_f32 v32, v32, v10
 v_sub_f32 v33, v33, v10
 v_sub_f32 v34, v34, v10
 v_sub_f32 v35, v35, v10
 v_sub_f32 v36, v36, v11
 v_sub_f32 v37, v37, v11
 v_sub_f32 v38, v38, v11
 v_sub_f32 v39, v39, v11
 v_exp_f32 v12, -v10
 v_exp_f32 v13, -v11
 v_mul_f32 v30, v12, v30
 v_mul_f32 v31, v13, v31
 v_mul_f32 v128, v12, v128
 v_mul_f32 v129, v12, v129
 v_mul_f32 v130, v12, v130
 v_mul_f32 v131, v12, v131
 v_mul_f32 v132, v13, v132
 v_mul_f32 v133, v13, v133
 v_mul_f32 v134, v13, v134
 v_mul_f32 v135, v13, v135
 v_mul_f32 v136, v12, v136
 v_mul_f32 v137, v12, v137
 v_mul_f32 v138, v12, v138
 v_mul_f32 v139, v12, v139
 v_mul_f32 v140, v13, v140
 v_mul_f32 v141, v13, v141
 v_mul_f32 v142, v13, v142
 v_mul_f32 v143, v13, v143
 v_mul_f32 v144, v12, v144
 v_mul_f32 v145, v12, v145
 v_mul_f32 v146, v12, v146
 v_mul_f32 v147, v12, v147
 v_mul_f32 v148, v13, v148
 v_mul_f32 v149, v13, v149
 v_mul_f32 v150, v13, v150
 v_mul_f32 v151, v13, v151
 v_mul_f32 v152, v12, v152
 v_mul_f32 v153, v12, v153
 v_mul_f32 v154, v12, v154
 v_mul_f32 v155, v12, v155
 v_mul_f32 v156, v13, v156
 v_mul_f32 v157, v13, v157
 v_mul_f32 v158, v13, v158
 v_mul_f32 v159, v13, v159
 v_mul_f32 v160, v12, v160
 v_mul_f32 v161, v12, v161
 v_mul_f32 v162, v12, v162
 v_mul_f32 v163, v12, v163
 v_mul_f32 v164, v13, v164
 v_mul_f32 v165, v13, v165
 v_mul_f32 v166, v13, v166
 v_mul_f32 v167, v13, v167
 v_mul_f32 v168, v12, v168
 v_mul_f32 v169, v12, v169
 v_mul_f32 v170, v12, v170
 v_mul_f32 v171, v12, v171
 v_mul_f32 v172, v13, v172
 v_mul_f32 v173, v13, v173
 v_mul_f32 v174, v13, v174
 v_mul_f32 v175, v13, v175
 v_mul_f32 v176, v12, v176
 v_mul_f32 v177, v12, v177
 v_mul_f32 v178, v12, v178
 v_mul_f32 v179, v12, v179
 v_mul_f32 v180, v13, v180
 v_mul_f32 v181, v13, v181
 v_mul_f32 v182, v13, v182
 v_mul_f32 v183, v13, v183
 v_mul_f32 v184, v12, v184
 v_mul_f32 v185, v12, v185
 v_mul_f32 v186, v12, v186
 v_mul_f32 v187, v12, v187
 v_mul_f32 v188, v13, v188
 v_mul_f32 v189, v13, v189
 v_mul_f32 v190, v13, v190
 v_mul_f32 v191, v13, v191
 v_mul_f32 v192, v12, v192
 v_mul_f32 v193, v12, v193
 v_mul_f32 v194, v12, v194
 v_mul_f32 v195, v12, v195
 v_mul_f32 v196, v13, v196
 v_mul_f32 v197, v13, v197
 v_mul_f32 v198, v13, v198
 v_mul_f32 v199, v13, v199
 v_mul_f32 v200, v12, v200
 v_mul_f32 v201, v12, v201
 v_mul_f32 v202, v12, v202
 v_mul_f32 v203, v12, v203
 v_mul_f32 v204, v13, v204
 v_mul_f32 v205, v13, v205
 v_mul_f32 v206, v13, v206
 v_mul_f32 v207, v13, v207
 v_mul_f32 v208, v12, v208
 v_mul_f32 v209, v12, v209
 v_mul_f32 v210, v12, v210
 v_mul_f32 v211, v12, v211
 v_mul_f32 v212, v13, v212
 v_mul_f32 v213, v13, v213
 v_mul_f32 v214, v13, v214
 v_mul_f32 v215, v13, v215
 v_mul_f32 v216, v12, v216
 v_mul_f32 v217, v12, v217
 v_mul_f32 v218, v12, v218
 v_mul_f32 v219, v12, v219
 v_mul_f32 v220, v13, v220
 v_mul_f32 v221, v13, v221
 v_mul_f32 v222, v13, v222
 v_mul_f32 v223, v13, v223
 v_mul_f32 v224, v12, v224
 v_mul_f32 v225, v12, v225
 v_mul_f32 v226, v12, v226
 v_mul_f32 v227, v12, v227
 v_mul_f32 v228, v13, v228
 v_mul_f32 v229, v13, v229
 v_mul_f32 v230, v13, v230
 v_mul_f32 v231, v13, v231
 v_mul_f32 v232, v12, v232
 v_mul_f32 v233, v12, v233
 v_mul_f32 v234, v12, v234
 v_mul_f32 v235, v12, v235
 v_mul_f32 v236, v13, v236
 v_mul_f32 v237, v13, v237
 v_mul_f32 v238, v13, v238
 v_mul_f32 v239, v13, v239
 v_mul_f32 v240, v12, v240
 v_mul_f32 v241, v12, v241
 v_mul_f32 v242, v12, v242
 v_mul_f32 v243, v12, v243
 v_mul_f32 v244, v13, v244
 v_mul_f32 v245, v13, v245
 v_mul_f32 v246, v13, v246
 v_mul_f32 v247, v13, v247
 v_mul_f32 v248, v12, v248
 v_mul_f32 v249, v12, v249
 v_mul_f32 v250, v12, v250
 v_mul_f32 v251, v12, v251
 v_mul_f32 v252, v13, v252
 v_mul_f32 v253, v13, v253
 v_mul_f32 v254, v13, v254
 v_mul_f32 v255, v13, v255
 v_exp_f32 v18, v64
 v_exp_f32 v19, v65
 v_exp_f32 v20, v66
 v_add_f32 v26, v18, v19
 v_cvt_pk_bf16_f32 v40, v18, v19
 v_exp_f32 v21, v67
 v_exp_f32 v22, v72
 v_add_f32 v26, v20, v26
 v_cvt_pk_bf16_f32 v41, v20, v21
 v_exp_f32 v23, v73
 v_add_f32 v26, v21, v26
 v_exp_f32 v24, v74
 v_add_f32 v26, v22, v26
 v_cvt_pk_bf16_f32 v42, v22, v23
 v_exp_f32 v25, v75
 v_add_f32 v26, v23, v26
 v_exp_f32 v18, v68
 v_add_f32 v26, v24, v26
 v_cvt_pk_bf16_f32 v43, v24, v25
 v_exp_f32 v19, v69
 v_add_f32 v26, v25, v26
 v_exp_f32 v20, v70
 v_add_f32 v27, v18, v19
 v_cvt_pk_bf16_f32 v44, v18, v19
 v_exp_f32 v21, v71
 v_exp_f32 v22, v76
 v_add_f32 v27, v20, v27
 v_cvt_pk_bf16_f32 v45, v20, v21
 v_exp_f32 v23, v77
 v_add_f32 v27, v21, v27
 v_exp_f32 v24, v78
 v_add_f32 v27, v22, v27
 v_cvt_pk_bf16_f32 v46, v22, v23
 v_exp_f32 v25, v79
 v_add_f32 v27, v23, v27
 v_add_f32 v27, v24, v27
 v_cvt_pk_bf16_f32 v47, v24, v25
 v_add_f32 v27, v25, v27
 v_exp_f32 v18, v80
 v_exp_f32 v19, v81
 v_exp_f32 v20, v82
 v_add_f32 v26, v18, v26
 v_cvt_pk_bf16_f32 v56, v18, v19
 v_exp_f32 v21, v83
 v_add_f32 v26, v19, v26
 v_exp_f32 v22, v88
 v_add_f32 v26, v20, v26
 v_cvt_pk_bf16_f32 v57, v20, v21
 v_exp_f32 v23, v89
 v_add_f32 v26, v21, v26
 v_exp_f32 v24, v90
 v_add_f32 v26, v22, v26
 v_cvt_pk_bf16_f32 v58, v22, v23
 v_exp_f32 v25, v91
 v_add_f32 v26, v23, v26
 v_exp_f32 v18, v84
 v_add_f32 v26, v24, v26
 v_cvt_pk_bf16_f32 v59, v24, v25
 v_exp_f32 v19, v85
 v_add_f32 v26, v25, v26
 v_exp_f32 v20, v86
 v_add_f32 v27, v18, v27
 v_cvt_pk_bf16_f32 v60, v18, v19
 v_exp_f32 v21, v87
 v_add_f32 v27, v19, v27
 v_exp_f32 v22, v92
 v_add_f32 v27, v20, v27
 v_cvt_pk_bf16_f32 v61, v20, v21
 v_exp_f32 v23, v93
 v_add_f32 v27, v21, v27
 v_exp_f32 v24, v94
 v_add_f32 v27, v22, v27
 v_cvt_pk_bf16_f32 v62, v22, v23
 v_exp_f32 v25, v95
 v_add_f32 v27, v23, v27
 v_add_f32 v27, v24, v27
 v_cvt_pk_bf16_f32 v63, v24, v25
 v_add_f32 v27, v25, v27
 s_nop 3
 s_setpc_b64 s[36:37]
L_slowB:
 s_nop 7
 s_nop 3
 v_max3_f32 v11, v100, v101, v102
 v_max3_f32 v11, v103, v108, v11
 v_max3_f32 v11, v109, v110, v11
 v_max3_f32 v11, v111, v116, v11
 v_max3_f32 v11, v117, v118, v11
 v_max3_f32 v11, v119, v124, v11
 v_max3_f32 v11, v125, v126, v11
 v_max_f32 v11, v127, v11
 v_mov_b32 v13, v11
 s_nop 1
 v_permlane16_swap_b32 v13, v11
 v_max_f32 v11, v13, v11
 v_mov_b32 v13, v11
 s_nop 1
 v_permlane32_swap_b32 v13, v11
 v_max_f32 v11, v13, v11
 v_ceil_f32 v11, v11
 v_max_f32 v11, 0, v11
 v_sub_f32 v100, v100, v11
 v_sub_f32 v101, v101, v11
 v_sub_f32 v102, v102, v11
 v_sub_f32 v103, v103, v11
 v_sub_f32 v108, v108, v11
 v_sub_f32 v109, v109, v11
 v_sub_f32 v110, v110, v11
 v_sub_f32 v111, v111, v11
 v_sub_f32 v116, v116, v11
 v_sub_f32 v117, v117, v11
 v_sub_f32 v118, v118, v11
 v_sub_f32 v119, v119, v11
 v_sub_f32 v124, v124, v11
 v_sub_f32 v125, v125, v11
 v_sub_f32 v126, v126, v11
 v_sub_f32 v127, v127, v11
 v_sub_f32 v36, v36, v11
 v_sub_f32 v37, v37, v11
 v_sub_f32 v38, v38, v11
 v_sub_f32 v39, v39, v11
 v_exp_f32 v13, -v11
 s_nop 0
 v_mul_f32 v31, v13, v31
 v_mul_f32 v132, v13, v132
 v_mul_f32 v133, v13, v133
 v_mul_f32 v134, v13, v134
 v_mul_f32 v135, v13, v135
 v_mul_f32 v140, v13, v140
 v_mul_f32 v141, v13, v141
 v_mul_f32 v142, v13, v142
 v_mul_f32 v143, v13, v143
 v_mul_f32 v148, v13, v148
 v_mul_f32 v149, v13, v149
 v_mul_f32 v150, v13, v150
 v_mul_f32 v151, v13, v151
 v_mul_f32 v156, v13, v156
 v_mul_f32 v157, v13, v157
 v_mul_f32 v158, v13, v158
 v_mul_f32 v159, v13, v159
 v_mul_f32 v164, v13, v164
 v_mul_f32 v165, v13, v165
 v_mul_f32 v166, v13, v166
 v_mul_f32 v167, v13, v167
 v_mul_f32 v172, v13, v172
 v_mul_f32 v173, v13, v173
 v_mul_f32 v174, v13, v174
 v_mul_f32 v175, v13, v175
 v_mul_f32 v180, v13, v180
 v_mul_f32 v181, v13, v181
 v_mul_f32 v182, v13, v182
 v_mul_f32 v183, v13, v183
 v_mul_f32 v188, v13, v188
 v_mul_f32 v189, v13, v189
 v_mul_f32 v190, v13, v190
 v_mul_f32 v191, v13, v191
 v_mul_f32 v196, v13, v196
 v_mul_f32 v197, v13, v197
 v_mul_f32 v198, v13, v198
 v_mul_f32 v199, v13, v199
 v_mul_f32 v204, v13, v204
 v_mul_f32 v205, v13, v205
 v_mul_f32 v206, v13, v206
 v_mul_f32 v207, v13, v207
 v_mul_f32 v212, v13, v212
 v_mul_f32 v213, v13, v213
 v_mul_f32 v214, v13, v214
 v_mul_f32 v215, v13, v215
 v_mul_f32 v220, v13, v220
 v_mul_f32 v221, v13, v221
 v_mul_f32 v222, v13, v222
 v_mul_f32 v223, v13, v223
 v_mul_f32 v228, v13, v228
 v_mul_f32 v229, v13, v229
 v_mul_f32 v230, v13, v230
 v_mul_f32 v231, v13, v231
 v_mul_f32 v236, v13, v236
 v_mul_f32 v237, v13, v237
 v_mul_f32 v238, v13, v238
 v_mul_f32 v239, v13, v239
 v_mul_f32 v244, v13, v244
 v_mul_f32 v245, v13, v245
 v_mul_f32 v246, v13, v246
 v_mul_f32 v247, v13, v247
 v_mul_f32 v252, v13, v252
 v_mul_f32 v253, v13, v253
 v_mul_f32 v254, v13, v254
 v_mul_f32 v255, v13, v255
 v_exp_f32 v18, v100
 v_exp_f32 v19, v101
 v_exp_f32 v20, v102
 v_add_f32 v29, v18, v19
 v_cvt_pk_bf16_f32 v52, v18, v19
 v_exp_f32 v21, v103
 v_exp_f32 v22, v108
 v_add_f32 v29, v20, v29
 v_cvt_pk_bf16_f32 v53, v20, v21
 v_exp_f32 v23, v109
 v_add_f32 v29, v21, v29
 v_exp_f32 v24, v110
 v_add_f32 v29, v22, v29
 v_cvt_pk_bf16_f32 v54, v22, v23
 v_exp_f32 v25, v111
 v_add_f32 v29, v23, v29
 v_exp_f32 v18, v116
 v_add_f32 v29, v24, v29
 v_cvt_pk_bf16_f32 v55, v24, v25
 v_exp_f32 v19, v117
 v_add_f32 v29, v25, v29
 v_exp_f32 v20, v118
 v_add_f32 v29, v18, v29
 v_cvt_pk_bf16_f32 v48, v18, v19
 v_exp_f32 v21, v119
 v_add_f32 v29, v19, v29
 v_exp_f32 v22, v124
 v_add_f32 v29, v20, v29
 v_cvt_pk_bf16_f32 v49, v20, v21
 v_exp_f32 v23, v125
 v_add_f32 v29, v21, v29
 v_exp_f32 v24, v126
 v_add_f32 v29, v22, v29
 v_cvt_pk_bf16_f32 v50, v22, v23
 v_exp_f32 v25, v127
 v_add_f32 v29, v23, v29
 v_add_f32 v29, v24, v29
 v_cvt_pk_bf16_f32 v51, v24, v25
 v_add_f32 v29, v25, v29
 s_nop 3
 s_setpc_b64 s[36:37]
L_slowf:
 s_nop 7
 s_nop 3
 v_max3_f32 v10, v64, v65, v66
 v_max3_f32 v10, v67, v72, v10
 v_max3_f32 v10, v73, v74, v10
 v_max3_f32 v10, v75, v80, v10
 v_max3_f32 v10, v81, v82, v10
 v_max3_f32 v10, v83, v88, v10
 v_max3_f32 v10, v89, v90, v10
 v_max_f32 v10, v91, v10
 v_max3_f32 v11, v68, v69, v70
 v_max3_f32 v11, v71, v76, v11
 v_max3_f32 v11, v77, v78, v11
 v_max3_f32 v11, v79, v84, v11
 v_max3_f32 v11, v85, v86, v11
 v_max3_f32 v11, v87, v92, v11
 v_max3_f32 v11, v93, v94, v11
 v_max_f32 v11, v95, v11
 v_mov_b32 v12, v10
 v_mov_b32 v13, v11
 s_nop 0
 v_permlane16_swap_b32 v12, v10
 v_permlane16_swap_b32 v13, v11
 v_max_f32 v10, v12, v10
 v_max_f32 v11, v13, v11
 v_mov_b32 v12, v10
 v_mov_b32 v13, v11
 s_nop 0
 v_permlane32_swap_b32 v12, v10
 v_permlane32_swap_b32 v13, v11
 v_max_f32 v10, v12, v10
 v_max_f32 v11, v13, v11
 v_ceil_f32 v10, v10
 v_ceil_f32 v11, v11
 v_sub_f32 v64, v64, v10
 v_sub_f32 v65, v65, v10
 v_sub_f32 v66, v66, v10
 v_sub_f32 v67, v67, v10
 v_sub_f32 v68, v68, v11
 v_sub_f32 v69, v69, v11
 v_sub_f32 v70, v70, v11
 v_sub_f32 v71, v71, v11
 v_sub_f32 v72, v72, v10
 v_sub_f32 v73, v73, v10
 v_sub_f32 v74, v74, v10
 v_sub_f32 v75, v75, v10
 v_sub_f32 v76, v76, v11
 v_sub_f32 v77, v77, v11
 v_sub_f32 v78, v78, v11
 v_sub_f32 v79, v79, v11
 v_sub_f32 v80, v80, v10
 v_sub_f32 v81, v81, v10
 v_sub_f32 v82, v82, v10
 v_sub_f32 v83, v83, v10
 v_sub_f32 v84, v84, v11
 v_sub_f32 v85, v85, v11
 v_sub_f32 v86, v86, v11
 v_sub_f32 v87, v87, v11
 v_sub_f32 v88, v88, v10
 v_sub_f32 v89, v89, v10
 v_sub_f32 v90, v90, v10
 v_sub_f32 v91, v91, v10
 v_sub_f32 v92, v92, v11
 v_sub_f32 v93, v93, v11
 v_sub_f32 v94, v94, v11
 v_sub_f32 v95, v95, v11
 v_sub_f32 v96, v96, v10
 v_sub_f32 v97, v97, v10
 v_sub_f32 v98, v98, v10
 v_sub_f32 v99, v99, v10
 v_sub_f32 v100, v100, v11
 v_sub_f32 v101, v101, v11
 v_sub_f32 v102, v102, v11
 v_sub_f32 v103, v103, v11
 v_sub_f32 v104, v104, v10
 v_sub_f32 v105, v105, v10
 v_sub_f32 v106, v106, v10
 v_sub_f32 v107, v107, v10
 v_sub_f32 v108, v108, v11
 v_sub_f32 v109, v109, v11
 v_sub_f32 v110, v110, v11
 v_sub_f32 v111, v111, v11
 v_sub_f32 v112, v112, v10
 v_sub_f32 v113, v113, v10
 v_sub_f32 v114, v114, v10
 v_sub_f32 v115, v115, v10
 v_sub_f32 v116, v116, v11
 v_sub_f32 v117, v117, v11
 v_sub_f32 v118, v118, v11
 v_sub_f32 v119, v119, v11
 v_sub_f32 v120, v120, v10
 v_sub_f32 v121, v121, v10
 v_sub_f32 v122, v122, v10
 v_sub_f32 v123, v123, v10
 v_sub_f32 v124, v124, v11
 v_sub_f32 v125, v125, v11
 v_sub_f32 v126, v126, v11
 v_sub_f32 v127, v127, v11
 v_sub_f32 v32, v32, v10
 v_sub_f32 v33, v33, v10
 v_sub_f32 v34, v34, v10
 v_sub_f32 v35, v35, v10
 v_sub_f32 v36, v36, v11
 v_sub_f32 v37, v37, v11
 v_sub_f32 v38, v38, v11
 v_sub_f32 v39, v39, v11
 v_exp_f32 v18, v64
 v_exp_f32 v19, v65
 v_exp_f32 v20, v66
 v_add_f32 v26, v18, v19
 v_cvt_pk_bf16_f32 v40, v18, v19
 v_exp_f32 v21, v67
 v_exp_f32 v22, v72
 v_add_f32 v26, v20, v26
 v_cvt_pk_bf16_f32 v41, v20, v21
 v_exp_f32 v23, v73
 v_add_f32 v26, v21, v26
 v_exp_f32 v24, v74
 v_add_f32 v26, v22, v26
 v_cvt_pk_bf16_f32 v42, v22, v23
 v_exp_f32 v25, v75
 v_add_f32 v26, v23, v26
 v_exp_f32 v18, v68
 v_add_f32 v26, v24, v26
 v_cvt_pk_bf16_f32 v43, v24, v25
 v_exp_f32 v19, v69
 v_add_f32 v26, v25, v26
 v_exp_f32 v20, v70
 v_add_f32 v27, v18, v19
 v_cvt_pk_bf16_f32 v44, v18, v19
 v_exp_f32 v21, v71
 v_exp_f32 v22, v76
 v_add_f32 v27, v20, v27
 v_cvt_pk_bf16_f32 v45, v20, v21
 v_exp_f32 v23, v77
 v_add_f32 v27, v21, v27
 v_exp_f32 v24, v78
 v_add_f32 v27, v22, v27
 v_cvt_pk_bf16_f32 v46, v22, v23
 v_exp_f32 v25, v79
 v_add_f32 v27, v23, v27
 v_add_f32 v27, v24, v27
 v_cvt_pk_bf16_f32 v47, v24, v25
 v_add_f32 v27, v25, v27
 v_exp_f32 v18, v80
 v_exp_f32 v19, v81
 v_exp_f32 v20, v82
 v_add_f32 v26, v18, v26
 v_cvt_pk_bf16_f32 v56, v18, v19
 v_exp_f32 v21, v83
 v_add_f32 v26, v19, v26
 v_exp_f32 v22, v88
 v_add_f32 v26, v20, v26
 v_cvt_pk_bf16_f32 v57, v20, v21
 v_exp_f32 v23, v89
 v_add_f32 v26, v21, v26
 v_exp_f32 v24, v90
 v_add_f32 v26, v22, v26
 v_cvt_pk_bf16_f32 v58, v22, v23
 v_exp_f32 v25, v91
 v_add_f32 v26, v23, v26
 v_exp_f32 v18, v84
 v_add_f32 v26, v24, v26
 v_cvt_pk_bf16_f32 v59, v24, v25
 v_exp_f32 v19, v85
 v_add_f32 v26, v25, v26
 v_exp_f32 v20, v86
 v_add_f32 v27, v18, v27
 v_cvt_pk_bf16_f32 v60, v18, v19
 v_exp_f32 v21, v87
 v_add_f32 v27, v19, v27
 v_exp_f32 v22, v92
 v_add_f32 v27, v20, v27
 v_cvt_pk_bf16_f32 v61, v20, v21
 v_exp_f32 v23, v93
 v_add_f32 v27, v21, v27
 v_exp_f32 v24, v94
 v_add_f32 v27, v22, v27
 v_cvt_pk_bf16_f32 v62, v22, v23
 v_exp_f32 v25, v95
 v_add_f32 v27, v23, v27
 v_add_f32 v27, v24, v27
 v_cvt_pk_bf16_f32 v63, v24, v25
 v_add_f32 v27, v25, v27
 s_nop 3
 s_setpc_b64 s[36:37]
L_moe0:
 s_lshl_b32 s88, s75, 1
 s_call_b64 s[36:37], L_moe
 v_add_f32 v32, v108, v32
 v_add_f32 v33, v109, v33
 v_add_f32 v34, v110, v34
 v_add_f32 v35, v111, v35
 v_add_f32 v36, v112, v36
 v_add_f32 v37, v113, v37
 v_add_f32 v38, v114, v38
 v_add_f32 v39, v115, v39
 v_add_f32 v40, v116, v40
 v_add_f32 v41, v117, v41
 v_add_f32 v42, v118, v42
 v_add_f32 v43, v119, v43
 v_add_f32 v44, v120, v44
 v_add_f32 v45, v121, v45
 v_add_f32 v46, v122, v46
 v_add_f32 v47, v123, v47
 s_mov_b64 exec, -1
 s_branch L_moe_ret0
L_moe1:
 s_lshl_b32 s88, s86, 1
 s_call_b64 s[36:37], L_moe
 v_add_f32 v80, v108, v80
 v_add_f32 v81, v109, v81
 v_add_f32 v82, v110, v82
 v_add_f32 v83, v111, v83
 v_add_f32 v84, v112, v84
 v_add_f32 v85, v113, v85
 v_add_f32 v86, v114, v86
 v_add_f32 v87, v115, v87
 s_mov_b64 exec, -1
 s_branch L_moe_ret1
L_moe2:
 s_lshl_b32 s88, s86, 1
 s_call_b64 s[36:37], L_moe
 v_add_f32 v32, v108, v32
 v_add_f32 v33, v109, v33
 v_add_f32 v34, v110, v34
 v_add_f32 v35, v111, v35
 v_add_f32 v36, v112, v36
 v_add_f32 v37, v113, v37
 v_add_f32 v38, v114, v38
 v_add_f32 v39, v115, v39
 s_mov_b64 exec, -1
 s_branch L_moe_ret2
L_moe:
 v_min_u32 v104, 27, v0
 v_lshlrev_b32 v104, 2, v104
 s_mov_b32 s64, 105062912
 s_mov_b32 s65, 65536
 s_mov_b32 exec_lo, 0xffffffff
 s_mov_b32 exec_hi, 0xffffffff
L_pfy:
 buffer_load_dword v105, v104, s[8:11], s64 offen sc1
 s_sub_u32 s65, s65, 1
 s_cbranch_scc1 L_pfy_x
 s_waitcnt vmcnt(0)
 v_cmp_ne_u32 vcc, 1, v105
 s_nop 0
 s_cbranch_vccz L_pfy_x
 s_sleep 2
 s_branch L_pfy
L_pfy_x:
 s_waitcnt vmcnt(0)
 s_mov_b64 exec, -1
 s_or_b64 exec, s[80:81], s[82:83]
 v_mov_b32 v104, 1792
 v_cndmask_b32 v104, v104, 0, s[80:81]
 v_lshl_add_u32 v104, v11, 5, v104
 s_add_u32 s88, s88, 104898560
 buffer_load_dwordx4 v[108:111], v104, s[8:11], s88 offen sc1
 buffer_load_dwordx4 v[112:115], v104, s[8:11], s88 offen offset:16 sc1
 buffer_load_dwordx4 v[116:119], v104, s[8:11], s88 offen offset:512 sc1
 buffer_load_dwordx4 v[120:123], v104, s[8:11], s88 offen offset:528 sc1
 s_waitcnt vmcnt(0)
 s_setpc_b64 s[36:37]
L_y1:
 s_lshl_b32 s89, s41, 1
 s_add_u32 s89, s89, s20
 s_cmp_ge_u32 s20, 2
 s_cselect_b32 s89, 28, s89
 s_cmp_ge_u32 s89, 28
 s_cbranch_scc1 L_y1r
 v_lshrrev_b32 v50, 4, v7
 v_lshrrev_b32 v51, 3, v50
 v_mul_u32_u24 v51, 4352, v51
 v_and_b32 v52, 7, v50
 v_lshl_add_u32 v51, v52, 7, v51
 s_mov_b32 s90, 104923136
 s_mov_b32 s88, 104957952
 s_mov_b32 s91, 65536
L_yp:
 buffer_load_dword v52, v51, s[8:11], s90 offen sc1
 buffer_load_dword v53, v51, s[8:11], s88 offen sc1
 s_waitcnt vmcnt(0)
 v_min_u32 v52, v52, v53
 v_cmp_gt_u32 vcc, 4, v52
 s_sub_u32 s91, s91, 1
 s_cbranch_scc1 L_ypx
 s_cbranch_vccnz L_yp
L_ypx:
 s_cmp_lt_u32 s89, 14
 s_cselect_b32 s90, 8, 12
 s_add_u32 s90, s90, 104890368
 buffer_load_dword v53, off, s[8:11], s90 sc1
 v_lshrrev_b32 v51, 3, v50
 v_mul_u32_u24 v51, 3584, v51
 v_and_b32 v52, 7, v50
 v_lshl_add_u32 v51, v52, 4, v51
 s_lshl_b32 s88, s89, 7
 s_add_u32 s90, s88, 104898560
 s_add_u32 s88, s88, 105906176
 buffer_load_dwordx4 v[136:139], v51, s[8:11], s88 offen sc1
 s_add_u32 s88, s88, 28672
 buffer_load_dwordx4 v[140:143], v51, s[8:11], s88 offen sc1
 s_add_u32 s88, s88, 28672
 buffer_load_dwordx4 v[152:155], v51, s[8:11], s88 offen sc1
 s_add_u32 s88, s88, 28672
 buffer_load_dwordx4 v[156:159], v51, s[8:11], s88 offen sc1
 s_add_u32 s88, s88, 28672
 buffer_load_dwordx4 v[168:171], v51, s[8:11], s88 offen sc1
 s_add_u32 s88, s88, 28672
 buffer_load_dwordx4 v[172:175], v51, s[8:11], s88 offen sc1
 s_add_u32 s88, s88, 28672
 buffer_load_dwordx4 v[184:187], v51, s[8:11], s88 offen sc1
 s_add_u32 s88, s88, 28672
 buffer_load_dwordx4 v[188:191], v51, s[8:11], s88 offen sc1
 s_add_u32 s88, s88, 28672
 buffer_load_dwordx4 v[200:203], v51, s[8:11], s88 offen sc1
 s_add_u32 s88, s88, 28672
 buffer_load_dwordx4 v[204:207], v51, s[8:11], s88 offen sc1
 s_add_u32 s88, s88, 28672
 buffer_load_dwordx4 v[216:219], v51, s[8:11], s88 offen sc1
 s_add_u32 s88, s88, 28672
 buffer_load_dwordx4 v[220:223], v51, s[8:11], s88 offen sc1
 s_add_u32 s88, s88, 28672
 buffer_load_dwordx4 v[232:235], v51, s[8:11], s88 offen sc1
 s_add_u32 s88, s88, 28672
 buffer_load_dwordx4 v[236:239], v51, s[8:11], s88 offen sc1
 s_add_u32 s88, s88, 28672
 s_branch L_y1r
L_y2:
 s_cmp_ge_u32 s89, 28
 s_cbranch_scc1 L_y2r
 s_waitcnt vmcnt(24)
 s_waitcnt vmcnt(12)
 v_add_f32 v136, v140, v136
 v_add_f32 v137, v141, v137
 v_add_f32 v138, v142, v138
 v_add_f32 v139, v143, v139
 s_waitcnt vmcnt(11)
 v_add_f32 v136, v152, v136
 v_add_f32 v137, v153, v137
 v_add_f32 v138, v154, v138
 v_add_f32 v139, v155, v139
 s_waitcnt vmcnt(10)
 v_add_f32 v136, v156, v136
 v_add_f32 v137, v157, v137
 v_add_f32 v138, v158, v138
 v_add_f32 v139, v159, v139
 s_waitcnt vmcnt(9)
 v_add_f32 v136, v168, v136
 v_add_f32 v137, v169, v137
 v_add_f32 v138, v170, v138
 v_add_f32 v139, v171, v139
 s_waitcnt vmcnt(8)
 v_add_f32 v136, v172, v136
 v_add_f32 v137, v173, v137
 v_add_f32 v138, v174, v138
 v_add_f32 v139, v175, v139
 s_waitcnt vmcnt(7)
 v_add_f32 v136, v184, v136
 v_add_f32 v137, v185, v137
 v_add_f32 v138, v186, v138
 v_add_f32 v139, v187, v139
 s_waitcnt vmcnt(6)
 v_add_f32 v136, v188, v136
 v_add_f32 v137, v189, v137
 v_add_f32 v138, v190, v138
 v_add_f32 v139, v191, v139
 s_waitcnt vmcnt(5)
 v_add_f32 v136, v200, v136
 v_add_f32 v137, v201, v137
 v_add_f32 v138, v202, v138
 v_add_f32 v139, v203, v139
 s_waitcnt vmcnt(4)
 v_add_f32 v136, v204, v136
 v_add_f32 v137, v205, v137
 v_add_f32 v138, v206, v138
 v_add_f32 v139, v207, v139
 s_waitcnt vmcnt(3)
 v_add_f32 v136, v216, v136
 v_add_f32 v137, v217, v137
 v_add_f32 v138, v218, v138
 v_add_f32 v139, v219, v139
 s_waitcnt vmcnt(2)
 v_add_f32 v136, v220, v136
 v_add_f32 v137, v221, v137
 v_add_f32 v138, v222, v138
 v_add_f32 v139, v223, v139
 s_waitcnt vmcnt(1)
 v_add_f32 v136, v232, v136
 v_add_f32 v137, v233, v137
 v_add_f32 v138, v234, v138
 v_add_f32 v139, v235, v139
 s_waitcnt vmcnt(0)
 v_add_f32 v136, v236, v136
 v_add_f32 v137, v237, v137
 v_add_f32 v138, v238, v138
 v_add_f32 v139, v239, v139
 v_add_f32 v136, v136, v136 row_ror:8 row_mask:0xf bank_mask:0xf
 v_add_f32 v137, v137, v137 row_ror:8 row_mask:0xf bank_mask:0xf
 v_add_f32 v138, v138, v138 row_ror:8 row_mask:0xf bank_mask:0xf
 v_add_f32 v139, v139, v139 row_ror:8 row_mask:0xf bank_mask:0xf
 v_mov_b32 v140, v136
 v_mov_b32 v141, v137
 v_mov_b32 v142, v138
 v_mov_b32 v143, v139
 v_permlane16_swap_b32 v140, v136
 v_permlane16_swap_b32 v141, v137
 v_permlane16_swap_b32 v142, v138
 v_permlane16_swap_b32 v143, v139
 v_add_f32 v136, v140, v136
 v_add_f32 v137, v141, v137
 v_add_f32 v138, v142, v138
 v_add_f32 v139, v143, v139
 v_mov_b32 v140, v136
 v_mov_b32 v141, v137
 v_mov_b32 v142, v138
 v_mov_b32 v143, v139
 v_permlane32_swap_b32 v140, v136
 v_permlane32_swap_b32 v141, v137
 v_permlane32_swap_b32 v142, v138
 v_permlane32_swap_b32 v143, v139
 v_add_f32 v136, v140, v136
 v_add_f32 v137, v141, v137
 v_add_f32 v138, v142, v138
 v_add_f32 v139, v143, v139
 v_cvt_pk_bf16_f32 v51, v136, v137
 v_lshlrev_b32 v136, 16, v51
 v_and_b32 v137, 0xffff0000, v51
 v_cvt_pk_bf16_f32 v51, v138, v139
 v_lshlrev_b32 v138, 16, v51
 v_and_b32 v139, 0xffff0000, v51
 v_mul_f32 v136, v53, v136
 v_mul_f32 v137, v53, v137
 v_mul_f32 v138, v53, v138
 v_mul_f32 v139, v53, v139
 v_cvt_pk_bf16_f32 v51, v136, v137
 v_lshlrev_b32 v136, 16, v51
 v_and_b32 v137, 0xffff0000, v51
 v_cvt_pk_bf16_f32 v51, v138, v139
 v_lshlrev_b32 v138, 16, v51
 v_and_b32 v139, 0xffff0000, v51
 s_mov_b64 exec, 0xff
 buffer_store_dwordx4 v[136:139], v7, s[8:11], s90 offen sc1
 s_mov_b64 exec, -1
 s_branch L_y2r
L_y3:
 s_cmp_ge_u32 s89, 28
 s_cbranch_scc1 L_y3r
 v_mov_b32 v52, 1
 s_lshl_b32 s89, s89, 2
 s_add_u32 s89, s89, 105062912
 s_mov_b64 exec, 1
 s_waitcnt vmcnt(5)
 buffer_store_dword v52, off, s[8:11], s89 sc1
 s_mov_b64 exec, -1
 s_branch L_y3r
L_fll:
 s_cmp_lg_u32 s39, 15
 s_cbranch_scc1 L_fll1
 v_mov_b32 v9, 0
 s_mov_b32 s46, s47
 s_mov_b32 s39, 1
L_fll1:
 buffer_load_dword v6, v9, s[8:11], s46 offen sc1
 s_branch L_fllr
L_pub3:
 v_mov_b32 v17, s3
 buffer_store_dword v17, v1, s[8:11], s45 offen sc1
 s_branch L_pub3r
L_fhs0:
 s_mov_b32 s91, 65536
L_fhs0_l:
 s_sleep 2
 buffer_load_dword v24, off, s[8:11], s79 sc1
 s_sub_u32 s91, s91, 1
 s_cbranch_scc1 L_fhs0_x
 s_waitcnt vmcnt(0)
 v_cmp_gt_u32 vcc, 1, v24
 s_nop 0
 s_cbranch_vccnz L_fhs0_l
L_fhs0_x:
 s_waitcnt vmcnt(0)
 s_branch L_fhr0
L_fhs1:
 s_mov_b32 s91, 65536
L_fhs1_l:
 s_sleep 2
 buffer_load_dword v24, off, s[8:11], s79 sc1
 s_sub_u32 s91, s91, 1
 s_cbranch_scc1 L_fhs1_x
 s_waitcnt vmcnt(0)
 v_cmp_gt_u32 vcc, 1, v24
 s_nop 0
 s_cbranch_vccnz L_fhs1_l
L_fhs1_x:
 s_waitcnt vmcnt(0)
 s_branch L_fhr1
L_fps1:
 s_mov_b32 s53, 65536
L_fps1_l:
 s_sleep 2
 buffer_load_dword v5, off, s[8:11], s47 sc1
 s_sub_u32 s53, s53, 1
 s_cbranch_scc1 L_fps1_x
 s_waitcnt vmcnt(0)
 v_cmp_ne_u32 vcc, 1, v5
 s_nop 0
 s_cbranch_vccnz L_fps1_l
L_fps1_x:
 s_waitcnt vmcnt(0)
 s_branch L_fpr1
L_f4s:
 s_mov_b32 s53, 65536
L_f4s_l:
 s_sleep 2
 buffer_load_dword v6, v9, s[8:11], s46 offen sc1
 s_sub_u32 s53, s53, 1
 s_cbranch_scc1 L_f4s_x
 s_waitcnt vmcnt(0)
 v_cmp_gt_u32 vcc, 3, v6
 s_nop 0
 s_cbranch_vccnz L_f4s_l
L_f4s_x:
 s_waitcnt vmcnt(0)
 s_branch L_f4r
L_f2s:
 s_mov_b32 s53, 65536
L_f2s_l:
 s_sleep 2
 buffer_load_dword v6, v9, s[8:11], s46 offen sc1
 s_sub_u32 s53, s53, 1
 s_cbranch_scc1 L_f2s_x
 s_waitcnt vmcnt(0)
 v_cmp_gt_u32 vcc, 3, v6
 s_nop 0
 s_cbranch_vccnz L_f2s_l
L_f2s_x:
 s_waitcnt vmcnt(0)
 s_branch L_f2r
L_fls0:
 s_mov_b32 s53, 65536
L_fls0_l:
 s_sleep 2
 buffer_load_dword v6, v9, s[8:11], s46 offen sc1
 s_sub_u32 s53, s53, 1
 s_cbranch_scc1 L_fls0_x
 s_waitcnt vmcnt(0)
 v_cmp_gt_u32 vcc, s39, v6
 s_nop 0
 s_cbranch_vccnz L_fls0_l
L_fls0_x:
 s_waitcnt vmcnt(0)
 s_branch L_flr0
L_code_end:
.section .rodata,"a"
.p2align 6
.amdhsa_kernel gated_mix__compressed_kv_cla__moe_arch_mod__prompt_kernel
  .amdhsa_next_free_vgpr 512
  .amdhsa_next_free_sgpr 102
  .amdhsa_accum_offset 256
  .amdhsa_group_segment_fixed_size 0
  .amdhsa_kernarg_size 120
  .amdhsa_user_sgpr_count 2
  .amdhsa_user_sgpr_kernarg_segment_ptr 1
  .amdhsa_system_sgpr_workgroup_id_x 1
  .amdhsa_float_denorm_mode_32 3
.end_amdhsa_kernel
```

```asm
; @launch grid=(256,1,1) block=(256,1,1) lds=163840
.amdgcn_target "amdgcn-amd-amdhsa--gfx950"
.text
.macro M d, a, b, c
v_mfma_f32_16x16x32_bf16 \d, \a, \b, \c
.endm
.globl gated_mix__compressed_kv_cla__moe_arch_mod__prompt_kernel
.p2align 8
.type gated_mix__compressed_kv_cla__moe_arch_mod__prompt_kernel,@function
gated_mix__compressed_kv_cla__moe_arch_mod__prompt_kernel:
 s_cmp_lt_u32 s2, 256
 s_cbranch_scc1 L_go
 s_endpgm
L_go:
 s_load_dwordx8 s[80:87], s[0:1], 0
 s_load_dwordx4 s[88:91], s[0:1], 32
 s_load_dwordx2 s[92:93], s[0:1], 56
 s_load_dwordx2 s[30:31], s[0:1], 88
 s_load_dwordx4 s[4:7], s[0:1], 104
 v_lshrrev_b32 v24, 6, v0
 v_and_b32 v0, 63, v0
 v_readfirstlane_b32 s20, v24
 s_getpc_b64 s[76:77]
L_pc0:
 s_and_b32 s77, s77, 0xffff
 s_mov_b32 s78, L_code_end-L_pc0
 s_mov_b32 s79, 0x20000
 s_lshr_b32 s64, s2, 3
 s_lshl_b32 s64, s64, 2
 s_add_u32 s64, s64, s20
 s_lshl_b32 s95, s64, 11
 v_lshl_add_u32 v29, v0, 7, s95
 v_and_b32 v28, 48, v0
 v_lshl_add_u32 v28, v28, 24, v29
 buffer_load_dword a240, v28, s[76:79], 0 offen offset:0
 s_and_b32 s41, s2, 7
 s_lshr_b32 s42, s2, 3
 s_lshr_b32 s64, s42, 4
 s_lshl_b32 s64, s64, 3
 s_add_u32 s41, s41, s64
 s_and_b32 s42, s42, 15
 s_lshr_b32 s45, s42, 3
 s_xor_b32 s45, s45, 1
 s_mov_b32 s44, 0
 v_accvgpr_write_b32 a250, 0
 v_accvgpr_write_b32 a251, 0
 v_and_b32 v24, 15, v0
 v_lshrrev_b32 v25, 4, v0
 v_lshlrev_b32 v7, 4, v0
 s_and_b32 s65, s20, 1
 s_lshr_b32 s66, s20, 1
 v_or_b32 v28, 0, v25
 v_lshlrev_b32 v28, 1, v28
 v_xor_b32 v28, v28, v24
 v_lshrrev_b32 v29, 3, v28
 v_lshlrev_b32 v29, 8, v29
 v_and_b32 v28, 7, v28
 v_lshl_add_u32 v28, v28, 4, v29
 v_lshl_add_u32 v28, v25, 13, v28
 s_lshl_b32 s64, s20, 17
 s_add_u32 s64, s64, 0
 v_add_u32 v8, s64, v28
 v_add_u32 v9, 31744, v8
 v_or_b32 v28, 4, v25
 v_lshlrev_b32 v28, 1, v28
 v_xor_b32 v28, v28, v24
 v_lshrrev_b32 v29, 3, v28
 v_lshlrev_b32 v29, 8, v29
 v_and_b32 v28, 7, v28
 v_lshl_add_u32 v28, v28, 4, v29
 v_lshl_add_u32 v28, v25, 13, v28
 s_lshl_b32 s64, s20, 17
 s_add_u32 s64, s64, 63488
 v_add_u32 v10, s64, v28
 v_add_u32 v11, 31744, v10
 v_add_u32 v28, 0, v25
 v_and_b32 v29, 7, v0
 v_xor_b32 v28, v28, v29
 v_lshlrev_b32 v28, 4, v28
 v_lshrrev_b32 v29, 3, v0
 v_lshl_add_u32 v30, v29, 11, v28
 s_lshl_b32 s64, s66, 19
 s_lshl_b32 s67, s65, 20
 s_add_u32 s64, s64, s67
 s_add_u32 s64, s64, 0
 v_add_u32 v12, s64, v30
 v_add_u32 v14, 30720, v12
 v_add_u32 v28, 4, v25
 v_and_b32 v29, 7, v0
 v_xor_b32 v28, v28, v29
 v_lshlrev_b32 v28, 4, v28
 v_lshrrev_b32 v29, 3, v0
 v_lshl_add_u32 v30, v29, 11, v28
 s_lshl_b32 s64, s66, 19
 s_lshl_b32 s67, s65, 20
 s_add_u32 s64, s64, s67
 s_add_u32 s64, s64, 15360
 v_add_u32 v13, s64, v30
 v_add_u32 v15, 30720, v13
 s_mov_b32 s21, 0
 s_mov_b32 s22, 0
 s_lshl_b32 s23, s20, 12
 s_add_u32 s24, s23, 65536
 s_lshl_b32 s74, s41, 9
 s_sub_u32 s18, 8388608, s74
 s_mov_b32 s19, 0x20000
 s_and_b32 s75, s42, 7
 s_lshl_b32 s75, s75, 16
 s_sub_u32 s50, 4194304, s75
 s_mov_b32 s51, 0x20000
 s_mov_b32 m0, s23
 s_cmp_eq_u32 s45, 0
 s_waitcnt lgkmcnt(0)
 s_cselect_b64 s[72:73], s[86:87], s[88:89]
 s_add_u32 s16, s72, s74
 s_addc_u32 s17, s73, 0
 s_and_b32 s17, s17, 0xffff
 buffer_load_dwordx4 v8, s[16:19], s21 offen offset:0  nt lds
 buffer_load_dwordx4 v9, s[16:19], s21 offen offset:1024  nt lds
 buffer_load_dwordx4 v10, s[16:19], s21 offen offset:2048  nt lds
 buffer_load_dwordx4 v11, s[16:19], s21 offen offset:3072  nt lds
 s_add_u32 s21, s21, 128
 s_add_u32 s48, s82, s75
 s_addc_u32 s49, s83, 0
 s_and_b32 s49, s49, 0xffff
 s_add_u32 m0, s24, 0
 s_nop 0
 buffer_load_dwordx4 v12, s[48:51], s22 offen offset:0   lds
 buffer_load_dwordx4 v13, s[48:51], s22 offen offset:1024   lds
 buffer_load_dwordx4 v14, s[48:51], s22 offen offset:2048   lds
 buffer_load_dwordx4 v15, s[48:51], s22 offen offset:3072   lds
 s_add_u32 s22, s22, 2097152
 s_add_u32 m0, s23, 16384
 s_nop 0
 buffer_load_dwordx4 v8, s[16:19], s21 offen offset:0  nt lds
 buffer_load_dwordx4 v9, s[16:19], s21 offen offset:1024  nt lds
 buffer_load_dwordx4 v10, s[16:19], s21 offen offset:2048  nt lds
 buffer_load_dwordx4 v11, s[16:19], s21 offen offset:3072  nt lds
 s_add_u32 s21, s21, 524160
 v_lshrrev_b32 v26, 2, v24
 v_and_b32 v28, 1, v25
 v_lshl_or_b32 v28, v28, 2, v26
 v_lshl_add_u32 v29, v25, 3, v26
 v_lshlrev_b32 v29, 8, v29
 v_and_b32 v30, 3, v0
 v_lshl_add_u32 v29, v30, 3, v29
 s_lshl_b32 s64, s65, 2
 s_add_u32 s64, s64, 0
 v_xor_b32 v30, s64, v28
 v_lshl_add_u32 v1, v30, 5, v29
 s_lshl_b32 s64, s65, 2
 s_add_u32 s64, s64, 1
 v_xor_b32 v30, s64, v28
 v_lshl_add_u32 v2, v30, 5, v29
 s_lshl_b32 s64, s65, 2
 s_add_u32 s64, s64, 2
 v_xor_b32 v30, s64, v28
 v_lshl_add_u32 v3, v30, 5, v29
 s_lshl_b32 s64, s65, 2
 s_add_u32 s64, s64, 3
 v_xor_b32 v30, s64, v28
 v_lshl_add_u32 v4, v30, 5, v29
 v_add_u32 v28, 0, v25
 v_lshrrev_b32 v29, 1, v24
 v_xor_b32 v28, v28, v29
 v_lshlrev_b32 v28, 4, v28
 v_lshl_add_u32 v28, v24, 7, v28
 s_lshl_b32 s64, s66, 13
 s_add_u32 s64, s64, 65536
 v_add_u32 v5, s64, v28
 v_add_u32 v28, 4, v25
 v_lshrrev_b32 v29, 1, v24
 v_xor_b32 v28, v28, v29
 v_lshlrev_b32 v28, 4, v28
 v_lshl_add_u32 v28, v24, 7, v28
 s_lshl_b32 s64, s66, 13
 s_add_u32 s64, s64, 65536
 v_add_u32 v6, s64, v28
 s_lshl_b32 s64, s2, 2
 s_add_u32 s64, s64, s20
 s_lshl_b32 s64, s64, 12
 v_lshrrev_b32 v28, 2, v0
 v_and_b32 v29, 3, v0
 v_lshlrev_b32 v29, 7, v29
 v_lshl_add_u32 v28, v28, 11, v29
 v_add_u32 v24, s64, v28
 v_and_b32 v28, 56, v0
 v_lshl_add_u32 v24, v28, 24, v24
 s_mov_b32 s32, s82
 s_and_b32 s33, s83, 0xffff
 s_mov_b32 s34, 4194304
 s_mov_b32 s35, 0x20000
 s_mov_b32 s56, s80
 s_and_b32 s57, s81, 0xffff
 s_mov_b32 s58, 1835008
 s_mov_b32 s59, 0x20000
 s_mov_b32 s60, s92
 s_and_b32 s61, s93, 0xffff
 s_mov_b32 s62, 896
 s_mov_b32 s63, 0x20000
 s_mov_b32 s68, s30
 s_and_b32 s69, s31, 0xffff
 s_mov_b32 s70, 896
 s_mov_b32 s71, 0x20000
 s_mov_b32 s8, s6
 s_and_b32 s9, s7, 0xffff
 s_mov_b32 s10, 268435456
 s_mov_b32 s11, 0x20000
 s_mov_b32 s12, s4
 s_and_b32 s13, s5, 0xffff
 s_mov_b32 s14, 256
 s_mov_b32 s15, 0x20000
 s_add_u32 s72, s84, s74
 s_addc_u32 s73, s85, 0
 s_sub_u32 s75, 3670016, s74
 s_mov_b32 s52, s72
 s_and_b32 s53, s73, 0xffff
 s_mov_b32 s54, s75
 s_mov_b32 s55, 0x20000
 s_mov_b32 s5, 0x3db8aa3b
 s_mov_b32 s28, 0
 s_mul_i32 s29, s42, 114688
 s_lshl_b32 s72, s45, 24
 s_lshl_b32 s73, s41, 20
 s_add_u32 s72, s72, s73
 s_bfe_u32 s64, s42, 0x20001
 s_lshl_b32 s64, s64, 15
 s_add_u32 s72, s72, s64
 s_lshl_b32 s64, s66, 17
 s_add_u32 s72, s72, s64
 s_and_b32 s67, s42, 1
 s_cmp_eq_u32 s45, 0
 s_cselect_b32 s64, 12, 14
 s_cselect_b32 s75, 14, 10
 s_lshl_b32 s67, s67, s75
 s_add_u32 s72, s72, s67
 s_lshl_b32 s64, s65, s64
 s_add_u32 s93, s72, s64
 s_load_dwordx4 s[80:83], s[0:1], 64
 s_load_dwordx2 s[84:85], s[0:1], 80
 s_load_dwordx2 s[96:97], s[0:1], 96
 s_cmp_lt_u32 s42, 8
 s_cbranch_scc0 L_kv1
L_kv0:
 s_lshl_b32 s64, s42, 4
 s_add_u32 s64, s64, s41
 s_lshl_b32 s64, s64, 2
 s_add_u32 s64, s64, s20
 s_cmp_lt_u32 s64, 41
 s_cselect_b32 s39, 0, 536870912
 s_min_u32 s64, s64, 41
 s_lshl_b32 s38, s64, 2
 s_max_u32 s67, s64, 8
 s_sub_u32 s67, s67, 8
 s_mul_i32 s67, s67, 3328
 s_lshl_b32 s64, s64, 10
 s_add_u32 s64, s64, s67
 s_add_u32 s73, s64, 104914944
 v_or_b32 v64, s39, v7
 v_mov_b32 v68, 0
 v_mov_b32 v69, 0
 v_mov_b32 v70, 0
 v_mov_b32 v71, 0
 s_lshl_b32 s30, s41, 3
 s_add_u32 s30, s30, s42
 s_lshl_b32 s64, s30, 2
 s_add_u32 s64, s64, s20
 s_mul_i32 s72, s64, 3584
 v_mov_b32 v32, 536870912
 v_cmp_gt_u32 vcc, 56, v0
 s_lshl_b32 s67, s64, 2
 s_nop 0
 v_cndmask_b32 v32, v32, v7, vcc
 buffer_load_dwordx4 v[40:43], v32, s[56:59], s72 offen offset:0
 buffer_load_dwordx4 v[44:47], v32, s[56:59], s72 offen offset:896
 buffer_load_dwordx4 v[48:51], v32, s[56:59], s72 offen offset:1792
 buffer_load_dwordx4 v[52:55], v32, s[56:59], s72 offen offset:2688
 buffer_load_dwordx4 v[56:59], v32, s[60:63], 0 offen
 buffer_load_dwordx4 v[60:63], v32, s[68:71], 0 offen
 buffer_store_dwordx4 v[68:71], v64, s[8:11], s73 offen offset:0 sc1
 buffer_store_dwordx4 v[68:71], v64, s[8:11], s73 offen offset:1024 sc1
 buffer_store_dwordx4 v[68:71], v64, s[8:11], s73 offen offset:2048 sc1
 s_waitcnt vmcnt(13) lgkmcnt(0)
 s_barrier
 ds_read_b128 a[160:163], v5 offset:0
 ds_read_b128 a[164:167], v6 offset:0
 ds_read_b64_tr_b16 a[32:33], v1 offset:0
 ds_read_b64_tr_b16 a[34:35], v1 offset:1024
 ds_read_b64_tr_b16 a[36:37], v1 offset:8192
 ds_read_b64_tr_b16 a[38:39], v1 offset:9216
 ds_read_b64_tr_b16 a[40:41], v2 offset:0
 ds_read_b64_tr_b16 a[42:43], v2 offset:1024
 ds_read_b64_tr_b16 a[44:45], v2 offset:8192
 ds_read_b64_tr_b16 a[46:47], v2 offset:9216
 ds_read_b128 a[168:171], v5 offset:2048
 ds_read_b128 a[172:175], v6 offset:2048
 ds_read_b64_tr_b16 a[48:49], v3 offset:0
 ds_read_b64_tr_b16 a[50:51], v3 offset:1024
 ds_read_b64_tr_b16 a[52:53], v3 offset:8192
 ds_read_b64_tr_b16 a[54:55], v3 offset:9216
 ds_read_b64_tr_b16 a[56:57], v4 offset:0
 ds_read_b64_tr_b16 a[58:59], v4 offset:1024
 ds_read_b64_tr_b16 a[60:61], v4 offset:8192
 ds_read_b64_tr_b16 a[62:63], v4 offset:9216
 ds_read_b128 a[176:179], v5 offset:4096
 ds_read_b128 a[180:183], v6 offset:4096
 ds_read_b128 a[184:187], v5 offset:6144
 ds_read_b128 a[188:191], v6 offset:6144
 s_add_u32 m0, s24, 16384
 s_nop 0
 buffer_load_dwordx4 v12, s[48:51], s22 offen offset:0   lds
 buffer_load_dwordx4 v13, s[48:51], s22 offen offset:1024   lds
 buffer_load_dwordx4 v14, s[48:51], s22 offen offset:2048   lds
 buffer_load_dwordx4 v15, s[48:51], s22 offen offset:3072   lds
 s_sub_u32 s22, s22, 2097024
 s_add_u32 m0, s23, 32768
 s_nop 0
 buffer_load_dwordx4 v8, s[16:19], s21 offen offset:0  nt lds
 buffer_load_dwordx4 v9, s[16:19], s21 offen offset:1024  nt lds
 buffer_load_dwordx4 v10, s[16:19], s21 offen offset:2048  nt lds
 buffer_load_dwordx4 v11, s[16:19], s21 offen offset:3072  nt lds
 s_add_u32 s21, s21, 128
 v_mov_b32 v72, 0
 v_mov_b32 v73, 0
 v_mov_b32 v74, 0
 v_mov_b32 v75, 0
 v_mov_b32 v76, 0
 v_mov_b32 v77, 0
 v_mov_b32 v78, 0
 v_mov_b32 v79, 0
 s_waitcnt vmcnt(12)
 v_dot2c_f32_bf16 v72, v40, v56
 v_dot2c_f32_bf16 v73, v44, v56
 v_dot2c_f32_bf16 v74, v48, v56
 v_dot2c_f32_bf16 v75, v52, v56
 s_waitcnt vmcnt(11)
 v_dot2c_f32_bf16 v76, v40, v60
 v_dot2c_f32_bf16 v77, v44, v60
 v_dot2c_f32_bf16 v78, v48, v60
 v_dot2c_f32_bf16 v79, v52, v60
 v_dot2c_f32_bf16 v72, v41, v57
 v_dot2c_f32_bf16 v73, v45, v57
 v_dot2c_f32_bf16 v74, v49, v57
 v_dot2c_f32_bf16 v75, v53, v57
 v_dot2c_f32_bf16 v76, v41, v61
 v_dot2c_f32_bf16 v77, v45, v61
 v_dot2c_f32_bf16 v78, v49, v61
 v_dot2c_f32_bf16 v79, v53, v61
 v_dot2c_f32_bf16 v72, v42, v58
 v_dot2c_f32_bf16 v73, v46, v58
 v_dot2c_f32_bf16 v74, v50, v58
 v_dot2c_f32_bf16 v75, v54, v58
 v_dot2c_f32_bf16 v76, v42, v62
 v_dot2c_f32_bf16 v77, v46, v62
 v_dot2c_f32_bf16 v78, v50, v62
 v_dot2c_f32_bf16 v79, v54, v62
 v_dot2c_f32_bf16 v72, v43, v59
 v_dot2c_f32_bf16 v73, v47, v59
 v_dot2c_f32_bf16 v74, v51, v59
 v_dot2c_f32_bf16 v75, v55, v59
 v_dot2c_f32_bf16 v76, v43, v63
 v_dot2c_f32_bf16 v77, v47, v63
 v_dot2c_f32_bf16 v78, v51, v63
 v_dot2c_f32_bf16 v79, v55, v63
 v_permlane32_swap_b32 v72, v74
 v_permlane32_swap_b32 v73, v75
 v_permlane32_swap_b32 v76, v78
 v_permlane32_swap_b32 v77, v79
 v_add_f32 v72, v72, v74
 v_add_f32 v73, v73, v75
 v_add_f32 v76, v76, v78
 v_add_f32 v77, v77, v79
 v_lshrrev_b32 v80, 4, v0
 v_permlane16_swap_b32 v72, v73
 v_permlane16_swap_b32 v76, v77
 v_add_f32 v72, v72, v73
 v_add_f32 v76, v76, v77
 v_add_u32 v81, s67, v80
 v_add_f32 v72, v72, v72 row_ror:8 row_mask:0xf bank_mask:0xf
 v_add_f32 v76, v76, v76 row_ror:8 row_mask:0xf bank_mask:0xf
 s_nop 0
 v_add_f32 v72, v72, v72 row_ror:4 row_mask:0xf bank_mask:0xf
 v_add_f32 v76, v76, v76 row_ror:4 row_mask:0xf bank_mask:0xf
 s_nop 0
 v_add_f32 v72, v72, v72 row_ror:2 row_mask:0xf bank_mask:0xf
 v_add_f32 v76, v76, v76 row_ror:2 row_mask:0xf bank_mask:0xf
 s_nop 0
 v_add_f32 v72, v72, v72 row_ror:1 row_mask:0xf bank_mask:0xf
 v_add_f32 v76, v76, v76 row_ror:1 row_mask:0xf bank_mask:0xf
 v_ashrrev_i32 v82, 31, v72
 v_or_b32 v82, 0x80000000, v82
 v_xor_b32 v82, v82, v72
 v_and_b32 v82, 0xfffff800, v82
 v_sub_u32 v81, 2047, v81
 v_or_b32 v82, v82, v81
 v_max_u32 v82, 1, v82
 v_mul_f32 v77, 0xbfb8aa3b, v76
 v_exp_f32 v77, v77
 s_nop 0
 v_add_f32 v77, 1.0, v77
 v_rcp_f32 v76, v77
 s_lshl_b32 s72, s20, 4
 s_add_u32 s72, s72, 163584
 v_lshl_add_u32 v80, v80, 2, s72
 ds_write_b32 v80, v82
 ds_write_b32 v80, v72 offset:64
 ds_write_b32 v80, v76 offset:128
 s_waitcnt lgkmcnt(15)
M a[0:3], a[160:163], a[32:35], 0
M a[0:3], a[164:167], a[36:39], a[0:3]
M a[4:7], a[164:167], a[44:47], 0
M a[4:7], a[160:163], a[40:43], a[4:7]
 s_waitcnt lgkmcnt(11)
M a[8:11], a[160:163], a[48:51], 0
M a[8:11], a[164:167], a[52:55], a[8:11]
 s_waitcnt lgkmcnt(7)
M a[12:15], a[164:167], a[60:63], 0
 s_add_u32 m0, s23, 49152
M a[12:15], a[160:163], a[56:59], a[12:15]
 buffer_load_dwordx4 v8, s[16:19], s21 offen offset:0  nt lds
M v[32:35], a[168:171], a[32:35], 0
 buffer_load_dwordx4 v9, s[16:19], s21 offen offset:1024  nt lds
M v[32:35], a[172:175], a[36:39], v[32:35]
M v[36:39], a[172:175], a[44:47], 0
 buffer_load_dwordx4 v10, s[16:19], s21 offen offset:2048  nt lds
M v[36:39], a[168:171], a[40:43], v[36:39]
M v[40:43], a[168:171], a[48:51], 0
 buffer_load_dwordx4 v11, s[16:19], s21 offen offset:3072  nt lds
M v[40:43], a[172:175], a[52:55], v[40:43]
 s_add_u32 s21, s21, 524160
M v[44:47], a[172:175], a[60:63], 0
 s_waitcnt lgkmcnt(0)
M v[44:47], a[168:171], a[56:59], v[44:47]
 s_barrier
M v[64:67], a[176:179], a[32:35], 0
 s_add_u32 m0, s24, 32768
 ds_read_b64_tr_b16 a[64:65], v1 offset:16384
 ds_read_b64_tr_b16 a[66:67], v1 offset:17408
M v[64:67], a[180:183], a[36:39], v[64:67]
 ds_read_b64_tr_b16 a[68:69], v1 offset:24576
 ds_read_b64_tr_b16 a[70:71], v1 offset:25600
M v[68:71], a[180:183], a[44:47], 0
 buffer_load_dwordx4 v12, s[48:51], s22 offen offset:0   lds
M v[68:71], a[176:179], a[40:43], v[68:71]
 ds_read_b64_tr_b16 a[72:73], v2 offset:16384
 ds_read_b64_tr_b16 a[74:75], v2 offset:17408
M v[72:75], a[176:179], a[48:51], 0
 ds_read_b64_tr_b16 a[76:77], v2 offset:24576
 ds_read_b64_tr_b16 a[78:79], v2 offset:25600
M v[72:75], a[180:183], a[52:55], v[72:75]
 buffer_load_dwordx4 v13, s[48:51], s22 offen offset:1024   lds
M v[76:79], a[180:183], a[60:63], 0
 ds_read_b64_tr_b16 a[80:81], v3 offset:16384
 ds_read_b64_tr_b16 a[82:83], v3 offset:17408
M v[76:79], a[176:179], a[56:59], v[76:79]
 ds_read_b64_tr_b16 a[84:85], v3 offset:24576
 ds_read_b64_tr_b16 a[86:87], v3 offset:25600
M v[96:99], a[184:187], a[32:35], 0
 buffer_load_dwordx4 v14, s[48:51], s22 offen offset:2048   lds
M v[96:99], a[188:191], a[36:39], v[96:99]
 ds_read_b64_tr_b16 a[88:89], v4 offset:16384
 ds_read_b64_tr_b16 a[90:91], v4 offset:17408
M v[100:103], a[188:191], a[44:47], 0
 ds_read_b64_tr_b16 a[92:93], v4 offset:24576
 ds_read_b64_tr_b16 a[94:95], v4 offset:25600
M v[100:103], a[184:187], a[40:43], v[100:103]
 buffer_load_dwordx4 v15, s[48:51], s22 offen offset:3072   lds
M v[104:107], a[184:187], a[48:51], 0
 s_add_u32 s22, s22, 2097152
 v_max3_f32 v20, |v32|, |v33|, |v34|
 v_max3_f32 v20, |v35|, |v36|, v20
M v[104:107], a[188:191], a[52:55], v[104:107]
 v_max3_f32 v20, |v37|, |v38|, v20
 v_max3_f32 v21, |v64|, |v65|, |v66|
M v[108:111], a[188:191], a[60:63], 0
 s_add_u32 m0, s23, 0
 v_max3_f32 v21, |v67|, |v68|, v21
 v_max3_f32 v21, |v69|, |v70|, v21
M v[108:111], a[184:187], a[56:59], v[108:111]
 s_waitcnt lgkmcnt(0)
 v_min_f32 v20, v20, v21
 v_mul_f32 v20, 0x41000000, v20
M a[16:19], a[160:163], a[64:67], 0
 buffer_load_dwordx4 v8, s[16:19], s21 offen offset:0  nt lds
M a[16:19], a[164:167], a[68:71], a[16:19]
 v_mov_b32 v21, v20
 v_mov_b32 v22, v20
M a[20:23], a[164:167], a[76:79], 0
 buffer_load_dwordx4 v9, s[16:19], s21 offen offset:1024  nt lds
M a[20:23], a[160:163], a[72:75], a[20:23]
 v_mov_b32 v23, v20
 v_accvgpr_write_b32 a241, v20
M a[24:27], a[160:163], a[80:83], 0
M a[24:27], a[164:167], a[84:87], a[24:27]
M a[28:31], a[164:167], a[92:95], 0
 buffer_load_dwordx4 v10, s[16:19], s21 offen offset:2048  nt lds
M a[28:31], a[160:163], a[88:91], a[28:31]
M v[48:51], a[168:171], a[64:67], v[20:23]
M v[48:51], a[172:175], a[68:71], v[48:51]
 buffer_load_dwordx4 v11, s[16:19], s21 offen offset:3072  nt lds
M v[52:55], a[172:175], a[76:79], v[20:23]
 s_add_u32 s21, s21, 128
M v[52:55], a[168:171], a[72:75], v[52:55]
M v[56:59], a[168:171], a[80:83], v[20:23]
M v[56:59], a[172:175], a[84:87], v[56:59]
M v[60:63], a[172:175], a[92:95], v[20:23]
 s_waitcnt vmcnt(12)
M v[60:63], a[168:171], a[88:91], v[60:63]
 s_barrier
M v[80:83], a[176:179], a[64:67], v[20:23]
 s_add_u32 m0, s24, 49152
 ds_read_b128 a[160:163], v5 offset:16384
 ds_read_b128 a[164:167], v6 offset:16384
M v[80:83], a[180:183], a[68:71], v[80:83]
 buffer_load_dwordx4 v12, s[48:51], s22 offen offset:0   lds
M v[84:87], a[180:183], a[76:79], v[20:23]
 ds_read_b64_tr_b16 a[96:97], v1 offset:32768
 ds_read_b64_tr_b16 a[98:99], v1 offset:33792
M v[84:87], a[176:179], a[72:75], v[84:87]
M v[88:91], a[176:179], a[80:83], v[20:23]
 buffer_load_dwordx4 v13, s[48:51], s22 offen offset:1024   lds
M v[88:91], a[180:183], a[84:87], v[88:91]
 ds_read_b64_tr_b16 a[100:101], v1 offset:40960
 ds_read_b64_tr_b16 a[102:103], v1 offset:41984
M v[92:95], a[180:183], a[92:95], v[20:23]
M v[92:95], a[176:179], a[88:91], v[92:95]
M v[112:115], a[184:187], a[64:67], v[20:23]
 ds_read_b64_tr_b16 a[104:105], v2 offset:32768
 ds_read_b64_tr_b16 a[106:107], v2 offset:33792
M v[112:115], a[188:191], a[68:71], v[112:115]
 buffer_load_dwordx4 v14, s[48:51], s22 offen offset:2048   lds
M v[116:119], a[188:191], a[76:79], v[20:23]
M v[116:119], a[184:187], a[72:75], v[116:119]
 ds_read_b64_tr_b16 a[108:109], v2 offset:40960
 ds_read_b64_tr_b16 a[110:111], v2 offset:41984
M v[120:123], a[184:187], a[80:83], v[20:23]
 buffer_load_dwordx4 v15, s[48:51], s22 offen offset:3072   lds
M v[120:123], a[188:191], a[84:87], v[120:123]
 s_waitcnt lgkmcnt(8)
M v[124:127], a[188:191], a[92:95], v[20:23]
 s_sub_u32 s22, s22, 2097024
M v[124:127], a[184:187], a[88:91], v[124:127]
 s_add_u32 m0, s23, 16384
 ds_read_b64_tr_b16 a[112:113], v3 offset:32768
 ds_read_b64_tr_b16 a[114:115], v3 offset:33792
M v[128:131], a[160:163], a[32:35], v[20:23]
 ds_read_b128 a[168:171], v5 offset:18432
 ds_read_b128 a[172:175], v6 offset:18432
M v[128:131], a[164:167], a[36:39], v[128:131]
 buffer_load_dwordx4 v8, s[16:19], s21 offen offset:0  nt lds
M v[132:135], a[164:167], a[44:47], v[20:23]
 ds_read_b64_tr_b16 a[116:117], v3 offset:40960
 ds_read_b64_tr_b16 a[118:119], v3 offset:41984
M v[132:135], a[160:163], a[40:43], v[132:135]
 buffer_load_dwordx4 v9, s[16:19], s21 offen offset:1024  nt lds
M v[136:139], a[160:163], a[48:51], v[20:23]
M v[136:139], a[164:167], a[52:55], v[136:139]
 ds_read_b64_tr_b16 a[120:121], v4 offset:32768
 ds_read_b64_tr_b16 a[122:123], v4 offset:33792
M v[140:143], a[164:167], a[60:63], v[20:23]
 buffer_load_dwordx4 v10, s[16:19], s21 offen offset:2048  nt lds
M v[140:143], a[160:163], a[56:59], v[140:143]
M v[144:147], a[160:163], a[64:67], v[20:23]
 ds_read_b64_tr_b16 a[124:125], v4 offset:40960
 ds_read_b64_tr_b16 a[126:127], v4 offset:41984
M v[144:147], a[164:167], a[68:71], v[144:147]
 buffer_load_dwordx4 v11, s[16:19], s21 offen offset:3072  nt lds
M v[148:151], a[164:167], a[76:79], v[20:23]
 s_add_u32 s21, s21, 524160
M v[148:151], a[160:163], a[72:75], v[148:151]
M v[152:155], a[160:163], a[80:83], v[20:23]
M v[152:155], a[164:167], a[84:87], v[152:155]
 s_waitcnt lgkmcnt(6)
M v[156:159], a[164:167], a[92:95], v[20:23]
 s_waitcnt vmcnt(16) lgkmcnt(0)
M v[156:159], a[160:163], a[88:91], v[156:159]
 s_barrier
M v[160:163], a[168:171], a[32:35], v[20:23]
 s_add_u32 m0, s24, 0
 ds_read_b128 a[160:163], v5 offset:20480
 ds_read_b128 a[164:167], v6 offset:20480
M v[160:163], a[172:175], a[36:39], v[160:163]
 buffer_load_dwordx4 v12, s[48:51], s22 offen offset:0   lds
M v[164:167], a[172:175], a[44:47], v[20:23]
 ds_read_b64_tr_b16 a[128:129], v1 offset:49152
 ds_read_b64_tr_b16 a[130:131], v1 offset:50176
M v[164:167], a[168:171], a[40:43], v[164:167]
M v[168:171], a[168:171], a[48:51], v[20:23]
 buffer_load_dwordx4 v13, s[48:51], s22 offen offset:1024   lds
M v[168:171], a[172:175], a[52:55], v[168:171]
 ds_read_b64_tr_b16 a[132:133], v1 offset:57344
 ds_read_b64_tr_b16 a[134:135], v1 offset:58368
M v[172:175], a[172:175], a[60:63], v[20:23]
M v[172:175], a[168:171], a[56:59], v[172:175]
M v[176:179], a[168:171], a[64:67], v[20:23]
 ds_read_b64_tr_b16 a[136:137], v2 offset:49152
 ds_read_b64_tr_b16 a[138:139], v2 offset:50176
M v[176:179], a[172:175], a[68:71], v[176:179]
 buffer_load_dwordx4 v14, s[48:51], s22 offen offset:2048   lds
M v[180:183], a[172:175], a[76:79], v[20:23]
M v[180:183], a[168:171], a[72:75], v[180:183]
 ds_read_b64_tr_b16 a[140:141], v2 offset:57344
 ds_read_b64_tr_b16 a[142:143], v2 offset:58368
M v[184:187], a[168:171], a[80:83], v[20:23]
 buffer_load_dwordx4 v15, s[48:51], s22 offen offset:3072   lds
M v[184:187], a[172:175], a[84:87], v[184:187]
 s_waitcnt lgkmcnt(8)
M v[188:191], a[172:175], a[92:95], v[20:23]
 s_add_u32 s22, s22, 2097152
M v[188:191], a[168:171], a[88:91], v[188:191]
 s_add_u32 m0, s23, 32768
 ds_read_b64_tr_b16 a[144:145], v3 offset:49152
 ds_read_b64_tr_b16 a[146:147], v3 offset:50176
M v[192:195], a[160:163], a[32:35], v[20:23]
 ds_read_b128 a[168:171], v5 offset:22528
 ds_read_b128 a[172:175], v6 offset:22528
M v[192:195], a[164:167], a[36:39], v[192:195]
 buffer_load_dwordx4 v8, s[16:19], s21 offen offset:0  nt lds
M v[196:199], a[164:167], a[44:47], v[20:23]
 ds_read_b64_tr_b16 a[148:149], v3 offset:57344
 ds_read_b64_tr_b16 a[150:151], v3 offset:58368
M v[196:199], a[160:163], a[40:43], v[196:199]
 buffer_load_dwordx4 v9, s[16:19], s21 offen offset:1024  nt lds
M v[200:203], a[160:163], a[48:51], v[20:23]
M v[200:203], a[164:167], a[52:55], v[200:203]
 ds_read_b64_tr_b16 a[152:153], v4 offset:49152
 ds_read_b64_tr_b16 a[154:155], v4 offset:50176
M v[204:207], a[164:167], a[60:63], v[20:23]
 buffer_load_dwordx4 v10, s[16:19], s21 offen offset:2048  nt lds
M v[204:207], a[160:163], a[56:59], v[204:207]
M v[208:211], a[160:163], a[64:67], v[20:23]
 ds_read_b64_tr_b16 a[156:157], v4 offset:57344
 ds_read_b64_tr_b16 a[158:159], v4 offset:58368
M v[208:211], a[164:167], a[68:71], v[208:211]
 buffer_load_dwordx4 v11, s[16:19], s21 offen offset:3072  nt lds
M v[212:215], a[164:167], a[76:79], v[20:23]
 s_add_u32 s21, s21, 128
M v[212:215], a[160:163], a[72:75], v[212:215]
M v[216:219], a[160:163], a[80:83], v[20:23]
M v[216:219], a[164:167], a[84:87], v[216:219]
 s_waitcnt lgkmcnt(6)
M v[220:223], a[164:167], a[92:95], v[20:23]
 s_waitcnt vmcnt(16) lgkmcnt(0)
M v[220:223], a[160:163], a[88:91], v[220:223]
 s_barrier
M v[224:227], a[168:171], a[32:35], v[20:23]
 ds_read_b128 a[160:163], v5 offset:32768
 ds_read_b128 a[164:167], v6 offset:32768
M v[224:227], a[172:175], a[36:39], v[224:227]
 buffer_load_dword a240, v24, s[32:35], 0 offen offset:512
M v[228:231], a[172:175], a[44:47], v[20:23]
M v[228:231], a[168:171], a[40:43], v[228:231]
M v[232:235], a[168:171], a[48:51], v[20:23]
M v[232:235], a[172:175], a[52:55], v[232:235]
M v[236:239], a[172:175], a[60:63], v[20:23]
M v[236:239], a[168:171], a[56:59], v[236:239]
M v[240:243], a[168:171], a[64:67], v[20:23]
M v[240:243], a[172:175], a[68:71], v[240:243]
M v[244:247], a[172:175], a[76:79], v[20:23]
M v[244:247], a[168:171], a[72:75], v[244:247]
M v[248:251], a[168:171], a[80:83], v[20:23]
M v[248:251], a[172:175], a[84:87], v[248:251]
 s_waitcnt lgkmcnt(0)
M v[252:255], a[172:175], a[92:95], v[20:23]
M v[252:255], a[168:171], a[88:91], v[252:255]
M a[0:3], a[160:163], a[96:99], a[0:3]
 ds_read_b128 a[168:171], v5 offset:34816
 ds_read_b128 a[172:175], v6 offset:34816
M a[0:3], a[164:167], a[100:103], a[0:3]
 ds_read_b64_tr_b16 a[32:33], v1 offset:0
 ds_read_b64_tr_b16 a[34:35], v1 offset:1024
M a[4:7], a[164:167], a[108:111], a[4:7]
 s_add_u32 m0, s24, 16384
M a[4:7], a[160:163], a[104:107], a[4:7]
 buffer_load_dwordx4 v12, s[48:51], s22 offen offset:0   lds
M a[8:11], a[160:163], a[112:115], a[8:11]
M a[8:11], a[164:167], a[116:119], a[8:11]
M a[12:15], a[164:167], a[124:127], a[12:15]
 ds_read_b64_tr_b16 a[36:37], v1 offset:8192
 ds_read_b64_tr_b16 a[38:39], v1 offset:9216
M a[12:15], a[160:163], a[120:123], a[12:15]
M a[16:19], a[160:163], a[128:131], a[16:19]
 buffer_load_dwordx4 v13, s[48:51], s22 offen offset:1024   lds
M a[16:19], a[164:167], a[132:135], a[16:19]
M a[20:23], a[164:167], a[140:143], a[20:23]
M a[20:23], a[160:163], a[136:139], a[20:23]
 ds_read_b64_tr_b16 a[40:41], v2 offset:0
 ds_read_b64_tr_b16 a[42:43], v2 offset:1024
M a[24:27], a[160:163], a[144:147], a[24:27]
M a[24:27], a[164:167], a[148:151], a[24:27]
 s_waitcnt lgkmcnt(6)
M a[28:31], a[164:167], a[156:159], a[28:31]
 buffer_load_dwordx4 v14, s[48:51], s22 offen offset:2048   lds
M a[28:31], a[160:163], a[152:155], a[28:31]
M v[60:63], a[168:171], a[152:155], v[60:63]
 ds_read_b128 a[160:163], v5 offset:36864
 ds_read_b128 a[164:167], v6 offset:36864
M v[60:63], a[172:175], a[156:159], v[60:63]
 ds_read_b64_tr_b16 a[44:45], v2 offset:8192
 ds_read_b64_tr_b16 a[46:47], v2 offset:9216
M v[56:59], a[172:175], a[148:151], v[56:59]
 buffer_load_dwordx4 v15, s[48:51], s22 offen offset:3072   lds
M v[56:59], a[168:171], a[144:147], v[56:59]
 s_sub_u32 s22, s22, 2097024
M v[52:55], a[168:171], a[136:139], v[52:55]
M v[52:55], a[172:175], a[140:143], v[52:55]
 ds_read_b64_tr_b16 a[48:49], v3 offset:0
 ds_read_b64_tr_b16 a[50:51], v3 offset:1024
M v[48:51], a[172:175], a[132:135], v[48:51]
 s_add_u32 m0, s23, 49152
M v[48:51], a[168:171], a[128:131], v[48:51]
 buffer_load_dwordx4 v8, s[16:19], s21 offen offset:0  nt lds
M v[44:47], a[168:171], a[120:123], v[44:47]
M v[44:47], a[172:175], a[124:127], v[44:47]
M v[40:43], a[172:175], a[116:119], v[40:43]
 ds_read_b64_tr_b16 a[52:53], v3 offset:8192
 ds_read_b64_tr_b16 a[54:55], v3 offset:9216
M v[40:43], a[168:171], a[112:115], v[40:43]
M v[36:39], a[168:171], a[104:107], v[36:39]
 buffer_load_dwordx4 v9, s[16:19], s21 offen offset:1024  nt lds
M v[36:39], a[172:175], a[108:111], v[36:39]
 s_waitcnt lgkmcnt(6)
M v[32:35], a[172:175], a[100:103], v[32:35]
M v[32:35], a[168:171], a[96:99], v[32:35]
 ds_read_b64_tr_b16 a[56:57], v4 offset:0
 ds_read_b64_tr_b16 a[58:59], v4 offset:1024
M v[64:67], a[160:163], a[96:99], v[64:67]
 ds_read_b128 a[168:171], v5 offset:38912
 ds_read_b128 a[172:175], v6 offset:38912
M v[64:67], a[164:167], a[100:103], v[64:67]
 buffer_load_dwordx4 v10, s[16:19], s21 offen offset:2048  nt lds
M v[68:71], a[164:167], a[108:111], v[68:71]
M v[68:71], a[160:163], a[104:107], v[68:71]
M v[72:75], a[160:163], a[112:115], v[72:75]
 ds_read_b64_tr_b16 a[60:61], v4 offset:8192
 ds_read_b64_tr_b16 a[62:63], v4 offset:9216
M v[72:75], a[164:167], a[116:119], v[72:75]
M v[76:79], a[164:167], a[124:127], v[76:79]
 buffer_load_dwordx4 v11, s[16:19], s21 offen offset:3072  nt lds
M v[76:79], a[160:163], a[120:123], v[76:79]
 s_add_u32 s21, s21, 524160
M v[80:83], a[160:163], a[128:131], v[80:83]
M v[80:83], a[164:167], a[132:135], v[80:83]
M v[84:87], a[164:167], a[140:143], v[84:87]
M v[84:87], a[160:163], a[136:139], v[84:87]
M v[88:91], a[160:163], a[144:147], v[88:91]
M v[88:91], a[164:167], a[148:151], v[88:91]
 s_waitcnt lgkmcnt(2)
M v[92:95], a[164:167], a[156:159], v[92:95]
 s_waitcnt vmcnt(17) lgkmcnt(0)
M v[92:95], a[160:163], a[152:155], v[92:95]
 s_barrier
M v[124:127], a[168:171], a[152:155], v[124:127]
 ds_read_b128 a[160:163], v5 offset:49152
 ds_read_b128 a[164:167], v6 offset:49152
M v[124:127], a[172:175], a[156:159], v[124:127]
M v[120:123], a[172:175], a[148:151], v[120:123]
 s_add_u32 m0, s24, 32768
 ds_read_b64_tr_b16 a[64:65], v1 offset:16384
 ds_read_b64_tr_b16 a[66:67], v1 offset:17408
M v[120:123], a[168:171], a[144:147], v[120:123]
 buffer_load_dwordx4 v12, s[48:51], s22 offen offset:0   lds
M v[116:119], a[168:171], a[136:139], v[116:119]
M v[116:119], a[172:175], a[140:143], v[116:119]
M v[112:115], a[172:175], a[132:135], v[112:115]
M v[112:115], a[168:171], a[128:131], v[112:115]
M v[108:111], a[168:171], a[120:123], v[108:111]
M v[108:111], a[172:175], a[124:127], v[108:111]
 ds_read_b64_tr_b16 a[68:69], v1 offset:24576
 ds_read_b64_tr_b16 a[70:71], v1 offset:25600
M v[104:107], a[172:175], a[116:119], v[104:107]
 buffer_load_dwordx4 v13, s[48:51], s22 offen offset:1024   lds
M v[104:107], a[168:171], a[112:115], v[104:107]
M v[100:103], a[168:171], a[104:107], v[100:103]
M v[100:103], a[172:175], a[108:111], v[100:103]
 s_waitcnt lgkmcnt(4)
M v[96:99], a[172:175], a[100:103], v[96:99]
M v[96:99], a[168:171], a[96:99], v[96:99]
M v[128:131], a[160:163], a[96:99], v[128:131]
 ds_read_b128 a[168:171], v5 offset:51200
 ds_read_b128 a[172:175], v6 offset:51200
M v[128:131], a[164:167], a[100:103], v[128:131]
 ds_read_b64_tr_b16 a[72:73], v2 offset:16384
 ds_read_b64_tr_b16 a[74:75], v2 offset:17408
M v[132:135], a[164:167], a[108:111], v[132:135]
 buffer_load_dwordx4 v14, s[48:51], s22 offen offset:2048   lds
M v[132:135], a[160:163], a[104:107], v[132:135]
M v[136:139], a[160:163], a[112:115], v[136:139]
M v[136:139], a[164:167], a[116:119], v[136:139]
M v[140:143], a[164:167], a[124:127], v[140:143]
M v[140:143], a[160:163], a[120:123], v[140:143]
 ds_read_b64_tr_b16 a[76:77], v2 offset:24576
 ds_read_b64_tr_b16 a[78:79], v2 offset:25600
M v[144:147], a[160:163], a[128:131], v[144:147]
 buffer_load_dwordx4 v15, s[48:51], s22 offen offset:3072   lds
M v[144:147], a[164:167], a[132:135], v[144:147]
 s_add_u32 s22, s22, 2097152
M v[148:151], a[164:167], a[140:143], v[148:151]
M v[148:151], a[160:163], a[136:139], v[148:151]
M v[152:155], a[160:163], a[144:147], v[152:155]
M v[152:155], a[164:167], a[148:151], v[152:155]
 s_waitcnt lgkmcnt(4)
M v[156:159], a[164:167], a[156:159], v[156:159]
 s_add_u32 m0, s23, 0
 ds_read_b64_tr_b16 a[80:81], v3 offset:16384
 ds_read_b64_tr_b16 a[82:83], v3 offset:17408
M v[156:159], a[160:163], a[152:155], v[156:159]
 buffer_load_dwordx4 v8, s[16:19], s21 offen offset:0  nt lds
M v[188:191], a[168:171], a[152:155], v[188:191]
 ds_read_b128 a[160:163], v5 offset:53248
 ds_read_b128 a[164:167], v6 offset:53248
M v[188:191], a[172:175], a[156:159], v[188:191]
M v[184:187], a[172:175], a[148:151], v[184:187]
M v[184:187], a[168:171], a[144:147], v[184:187]
M v[180:183], a[168:171], a[136:139], v[180:183]
M v[180:183], a[172:175], a[140:143], v[180:183]
 ds_read_b64_tr_b16 a[84:85], v3 offset:24576
 ds_read_b64_tr_b16 a[86:87], v3 offset:25600
M v[176:179], a[172:175], a[132:135], v[176:179]
 buffer_load_dwordx4 v9, s[16:19], s21 offen offset:1024  nt lds
M v[176:179], a[168:171], a[128:131], v[176:179]
M v[172:175], a[168:171], a[120:123], v[172:175]
M v[172:175], a[172:175], a[124:127], v[172:175]
M v[168:171], a[172:175], a[116:119], v[168:171]
M v[168:171], a[168:171], a[112:115], v[168:171]
M v[164:167], a[168:171], a[104:107], v[164:167]
 ds_read_b64_tr_b16 a[88:89], v4 offset:16384
 ds_read_b64_tr_b16 a[90:91], v4 offset:17408
M v[164:167], a[172:175], a[108:111], v[164:167]
 s_waitcnt lgkmcnt(4)
M v[160:163], a[172:175], a[100:103], v[160:163]
 buffer_load_dwordx4 v10, s[16:19], s21 offen offset:2048  nt lds
M v[160:163], a[168:171], a[96:99], v[160:163]
M v[192:195], a[160:163], a[96:99], v[192:195]
 ds_read_b128 a[168:171], v5 offset:55296
 ds_read_b128 a[172:175], v6 offset:55296
M v[192:195], a[164:167], a[100:103], v[192:195]
M v[196:199], a[164:167], a[108:111], v[196:199]
M v[196:199], a[160:163], a[104:107], v[196:199]
 ds_read_b64_tr_b16 a[92:93], v4 offset:24576
 ds_read_b64_tr_b16 a[94:95], v4 offset:25600
M v[200:203], a[160:163], a[112:115], v[200:203]
 buffer_load_dwordx4 v11, s[16:19], s21 offen offset:3072  nt lds
M v[200:203], a[164:167], a[116:119], v[200:203]
 s_add_u32 s21, s21, 128
M v[204:207], a[164:167], a[124:127], v[204:207]
M v[204:207], a[160:163], a[120:123], v[204:207]
M v[208:211], a[160:163], a[128:131], v[208:211]
M v[208:211], a[164:167], a[132:135], v[208:211]
M v[212:215], a[164:167], a[140:143], v[212:215]
M v[212:215], a[160:163], a[136:139], v[212:215]
M v[216:219], a[160:163], a[144:147], v[216:219]
M v[216:219], a[164:167], a[148:151], v[216:219]
 s_waitcnt lgkmcnt(2)
M v[220:223], a[164:167], a[156:159], v[220:223]
 s_waitcnt vmcnt(17) lgkmcnt(0)
M v[220:223], a[160:163], a[152:155], v[220:223]
 s_barrier
M v[252:255], a[168:171], a[152:155], v[252:255]
 ds_read_b128 a[160:163], v5 offset:0
 ds_read_b128 a[164:167], v6 offset:0
M v[252:255], a[172:175], a[156:159], v[252:255]
 v_min_u32 v16, 1, v0
 v_lshlrev_b32 v16, 29, v16
M v[248:251], a[172:175], a[148:151], v[248:251]
 v_or_b32 v16, s39, v16
 v_mov_b32 v17, 1
M v[248:251], a[168:171], a[144:147], v[248:251]
M v[244:247], a[168:171], a[136:139], v[244:247]
 buffer_store_dword v17, v16, s[12:15], s38 offen offset:64 sc1
M v[244:247], a[172:175], a[140:143], v[244:247]
M v[240:243], a[172:175], a[132:135], v[240:243]
M v[240:243], a[168:171], a[128:131], v[240:243]
M v[236:239], a[168:171], a[120:123], v[236:239]
M v[236:239], a[172:175], a[124:127], v[236:239]
M v[232:235], a[172:175], a[116:119], v[232:235]
M v[232:235], a[168:171], a[112:115], v[232:235]
M v[228:231], a[168:171], a[104:107], v[228:231]
M v[228:231], a[172:175], a[108:111], v[228:231]
 s_waitcnt lgkmcnt(0)
M v[224:227], a[172:175], a[100:103], v[224:227]
M v[224:227], a[168:171], a[96:99], v[224:227]
M a[0:3], a[160:163], a[32:35], a[0:3]
 ds_read_b128 a[168:171], v5 offset:2048
 ds_read_b128 a[172:175], v6 offset:2048
M a[0:3], a[164:167], a[36:39], a[0:3]
 ds_read_b64_tr_b16 a[96:97], v1 offset:32768
 ds_read_b64_tr_b16 a[98:99], v1 offset:33792
M a[4:7], a[164:167], a[44:47], a[4:7]
 s_add_u32 m0, s24, 49152
M a[4:7], a[160:163], a[40:43], a[4:7]
 buffer_load_dwordx4 v12, s[48:51], s22 offen offset:0   lds
M a[8:11], a[160:163], a[48:51], a[8:11]
 v_and_b32 v20, 31, v0
M a[8:11], a[164:167], a[52:55], a[8:11]
 v_lshlrev_b32 v20, 2, v20
M a[12:15], a[164:167], a[60:63], a[12:15]
 ds_read_b64_tr_b16 a[100:101], v1 offset:40960
 ds_read_b64_tr_b16 a[102:103], v1 offset:41984
M a[12:15], a[160:163], a[56:59], a[12:15]
 v_add_u32 v21, 163584, v20
M a[16:19], a[160:163], a[64:67], a[16:19]
 buffer_load_dwordx4 v13, s[48:51], s22 offen offset:1024   lds
M a[16:19], a[164:167], a[68:71], a[16:19]
 ds_read_b32 v19, v21
M a[20:23], a[164:167], a[76:79], a[20:23]
 ds_read_b32 v21, v21 offset:64
M a[20:23], a[160:163], a[72:75], a[20:23]
 s_min_u32 s64, s20, 1
 ds_read_b64_tr_b16 a[104:105], v2 offset:32768
 ds_read_b64_tr_b16 a[106:107], v2 offset:33792
M a[24:27], a[160:163], a[80:83], a[24:27]
 s_lshl_b32 s64, s64, 29
 v_and_b32 v22, 32, v0
M a[24:27], a[164:167], a[84:87], a[24:27]
 s_waitcnt lgkmcnt(8)
 v_lshl_or_b32 v20, v22, 24, v20
M a[28:31], a[164:167], a[92:95], a[28:31]
 buffer_load_dwordx4 v14, s[48:51], s22 offen offset:2048   lds
M a[28:31], a[160:163], a[88:91], a[28:31]
 v_or_b32 v20, s64, v20
M v[60:63], a[168:171], a[88:91], v[60:63]
 ds_read_b128 a[160:163], v5 offset:4096
 ds_read_b128 a[164:167], v6 offset:4096
M v[60:63], a[172:175], a[92:95], v[60:63]
 ds_read_b64_tr_b16 a[108:109], v2 offset:40960
 ds_read_b64_tr_b16 a[110:111], v2 offset:41984
M v[56:59], a[172:175], a[84:87], v[56:59]
 buffer_load_dwordx4 v15, s[48:51], s22 offen offset:3072   lds
M v[56:59], a[168:171], a[80:83], v[56:59]
 s_sub_u32 s22, s22, 2097024
 v_and_b32 v22, 16, v0
M v[52:55], a[168:171], a[72:75], v[52:55]
 v_lshl_or_b32 v18, v22, 25, v20
M v[52:55], a[172:175], a[76:79], v[52:55]
 s_lshl_b32 s72, s30, 7
 ds_read_b64_tr_b16 a[112:113], v3 offset:32768
 ds_read_b64_tr_b16 a[114:115], v3 offset:33792
M v[48:51], a[172:175], a[68:71], v[48:51]
 s_add_u32 m0, s23, 16384
 s_add_u32 s72, s72, 104857600
M v[48:51], a[168:171], a[64:67], v[48:51]
 buffer_load_dwordx4 v8, s[16:19], s21 offen offset:0  nt lds
M v[44:47], a[168:171], a[56:59], v[44:47]
M v[44:47], a[172:175], a[60:63], v[44:47]
M v[40:43], a[172:175], a[52:55], v[40:43]
 ds_read_b64_tr_b16 a[116:117], v3 offset:40960
 ds_read_b64_tr_b16 a[118:119], v3 offset:41984
M v[40:43], a[168:171], a[48:51], v[40:43]
M v[36:39], a[168:171], a[40:43], v[36:39]
 buffer_load_dwordx4 v9, s[16:19], s21 offen offset:1024  nt lds
M v[36:39], a[172:175], a[44:47], v[36:39]
 s_waitcnt lgkmcnt(6)
M v[32:35], a[172:175], a[36:39], v[32:35]
 buffer_store_dword v21, v20, s[8:11], s72 offen sc1
M v[32:35], a[168:171], a[32:35], v[32:35]
 ds_read_b64_tr_b16 a[120:121], v4 offset:32768
 ds_read_b64_tr_b16 a[122:123], v4 offset:33792
M v[64:67], a[160:163], a[32:35], v[64:67]
 ds_read_b128 a[168:171], v5 offset:6144
 ds_read_b128 a[172:175], v6 offset:6144
M v[64:67], a[164:167], a[36:39], v[64:67]
 buffer_load_dwordx4 v10, s[16:19], s21 offen offset:2048  nt lds
M v[68:71], a[164:167], a[44:47], v[68:71]
M v[68:71], a[160:163], a[40:43], v[68:71]
M v[72:75], a[160:163], a[48:51], v[72:75]
 ds_read_b64_tr_b16 a[124:125], v4 offset:40960
 ds_read_b64_tr_b16 a[126:127], v4 offset:41984
M v[72:75], a[164:167], a[52:55], v[72:75]
M v[76:79], a[164:167], a[60:63], v[76:79]
 buffer_load_dwordx4 v11, s[16:19], s21 offen offset:3072  nt lds
M v[76:79], a[160:163], a[56:59], v[76:79]
 s_add_u32 s21, s21, 524160
M v[80:83], a[160:163], a[64:67], v[80:83]
M v[80:83], a[164:167], a[68:71], v[80:83]
M v[84:87], a[164:167], a[76:79], v[84:87]
M v[84:87], a[160:163], a[72:75], v[84:87]
 s_and_b32 s86, s41, 7
M v[88:91], a[160:163], a[80:83], v[88:91]
 s_mul_i32 s86, s86, 14
 s_lshr_b32 s64, s41, 3
 s_mul_i32 s64, s64, 7
M v[88:91], a[164:167], a[84:87], v[88:91]
 s_waitcnt lgkmcnt(2)
 s_add_u32 s86, s86, s64
 s_min_u32 s64, s42, 6
M v[92:95], a[164:167], a[92:95], v[92:95]
 s_waitcnt vmcnt(18) lgkmcnt(0)
 s_add_u32 s86, s86, s64
 s_sub_u32 s64, 6, s42
M v[92:95], a[160:163], a[88:91], v[92:95]
 s_barrier
M v[124:127], a[168:171], a[88:91], v[124:127]
 ds_read_b128 a[160:163], v5 offset:16384
 ds_read_b128 a[164:167], v6 offset:16384
M v[124:127], a[172:175], a[92:95], v[124:127]
 s_and_b32 s88, s64, 536870912
 s_mul_i32 s87, s20, 7168
M v[120:123], a[172:175], a[84:87], v[120:123]
 s_add_u32 m0, s24, 0
 ds_read_b64_tr_b16 a[128:129], v1 offset:49152
 ds_read_b64_tr_b16 a[130:131], v1 offset:50176
M v[120:123], a[168:171], a[80:83], v[120:123]
 buffer_load_dwordx4 v12, s[48:51], s22 offen offset:0   lds
M v[116:119], a[168:171], a[72:75], v[116:119]
 s_add_u32 s87, s87, 131072
M v[116:119], a[172:175], a[76:79], v[116:119]
 s_cmp_lt_u32 s20, 2
M v[112:115], a[172:175], a[68:71], v[112:115]
 s_cselect_b64 s[72:73], s[80:81], s[82:83]
M v[112:115], a[168:171], a[64:67], v[112:115]
 s_mov_b32 s60, s72
M v[108:111], a[168:171], a[56:59], v[108:111]
 s_and_b32 s61, s73, 0xffff
M v[108:111], a[172:175], a[60:63], v[108:111]
 s_mov_b32 s62, 1605632
 ds_read_b64_tr_b16 a[132:133], v1 offset:57344
 ds_read_b64_tr_b16 a[134:135], v1 offset:58368
M v[104:107], a[172:175], a[52:55], v[104:107]
 buffer_load_dwordx4 v13, s[48:51], s22 offen offset:1024   lds
M v[104:107], a[168:171], a[48:51], v[104:107]
 s_mov_b32 s63, 0x20000
M v[100:103], a[168:171], a[40:43], v[100:103]
 s_mov_b32 s68, s84
 s_and_b32 s69, s85, 0xffff
 s_mov_b32 s70, 1605632
M v[100:103], a[172:175], a[44:47], v[100:103]
 s_waitcnt lgkmcnt(4)
 s_mov_b32 s71, 0x20000
M v[96:99], a[172:175], a[36:39], v[96:99]
 s_lshl_b32 s89, s86, 5
 s_and_b32 s64, s20, 1
 s_mul_i32 s64, s64, 802816
M v[96:99], a[168:171], a[32:35], v[96:99]
 buffer_load_dwordx4 v14, s[48:51], s22 offen offset:2048   lds
M v[128:131], a[160:163], a[32:35], v[128:131]
 ds_read_b128 a[168:171], v5 offset:18432
 ds_read_b128 a[172:175], v6 offset:18432
M v[128:131], a[164:167], a[36:39], v[128:131]
 ds_read_b64_tr_b16 a[136:137], v2 offset:49152
 ds_read_b64_tr_b16 a[138:139], v2 offset:50176
M v[132:135], a[164:167], a[44:47], v[132:135]
 s_add_u32 s89, s89, s64
 v_lshrrev_b32 v28, 1, v0
M v[132:135], a[160:163], a[40:43], v[132:135]
 v_mul_u32_u24 v28, 3584, v28
 v_and_b32 v29, 1, v0
M v[136:139], a[160:163], a[48:51], v[136:139]
 v_lshl_add_u32 v25, v29, 4, v28
 v_or_b32 v25, s88, v25
M v[136:139], a[164:167], a[52:55], v[136:139]
M v[140:143], a[164:167], a[60:63], v[140:143]
 buffer_load_dwordx4 v15, s[48:51], s22 offen offset:3072   lds
M v[140:143], a[160:163], a[56:59], v[140:143]
 s_add_u32 s22, s22, 2097152
 ds_read_b64_tr_b16 a[140:141], v2 offset:57344
 ds_read_b64_tr_b16 a[142:143], v2 offset:58368
M v[144:147], a[160:163], a[64:67], v[144:147]
M v[144:147], a[164:167], a[68:71], v[144:147]
M v[148:151], a[164:167], a[76:79], v[148:151]
M v[148:151], a[160:163], a[72:75], v[148:151]
 s_add_u32 m0, s23, 32768
M v[152:155], a[160:163], a[80:83], v[152:155]
 buffer_load_dwordx4 v8, s[16:19], s21 offen offset:0  nt lds
M v[152:155], a[164:167], a[84:87], v[152:155]
 s_waitcnt lgkmcnt(4)
M v[156:159], a[164:167], a[92:95], v[156:159]
 ds_read_b64_tr_b16 a[144:145], v3 offset:49152
 ds_read_b64_tr_b16 a[146:147], v3 offset:50176
M v[156:159], a[160:163], a[88:91], v[156:159]
M v[188:191], a[168:171], a[88:91], v[188:191]
 ds_read_b128 a[160:163], v5 offset:20480
 ds_read_b128 a[164:167], v6 offset:20480
M v[188:191], a[172:175], a[92:95], v[188:191]
M v[184:187], a[172:175], a[84:87], v[184:187]
 buffer_load_dwordx4 v9, s[16:19], s21 offen offset:1024  nt lds
M v[184:187], a[168:171], a[80:83], v[184:187]
M v[180:183], a[168:171], a[72:75], v[180:183]
M v[180:183], a[172:175], a[76:79], v[180:183]
 ds_read_b64_tr_b16 a[148:149], v3 offset:57344
 ds_read_b64_tr_b16 a[150:151], v3 offset:58368
M v[176:179], a[172:175], a[68:71], v[176:179]
M v[176:179], a[168:171], a[64:67], v[176:179]
M v[172:175], a[168:171], a[56:59], v[172:175]
M v[172:175], a[172:175], a[60:63], v[172:175]
 buffer_load_dwordx4 v10, s[16:19], s21 offen offset:2048  nt lds
M v[168:171], a[172:175], a[52:55], v[168:171]
M v[168:171], a[168:171], a[48:51], v[168:171]
M v[164:167], a[168:171], a[40:43], v[164:167]
 ds_read_b64_tr_b16 a[152:153], v4 offset:49152
 ds_read_b64_tr_b16 a[154:155], v4 offset:50176
M v[164:167], a[172:175], a[44:47], v[164:167]
 s_waitcnt lgkmcnt(4)
M v[160:163], a[172:175], a[36:39], v[160:163]
M v[160:163], a[168:171], a[32:35], v[160:163]
 buffer_load_dwordx4 v11, s[16:19], s21 offen offset:3072  nt lds
M v[192:195], a[160:163], a[32:35], v[192:195]
 s_add_u32 s21, s21, 128
 ds_read_b128 a[168:171], v5 offset:22528
 ds_read_b128 a[172:175], v6 offset:22528
M v[192:195], a[164:167], a[36:39], v[192:195]
M v[196:199], a[164:167], a[44:47], v[196:199]
M v[196:199], a[160:163], a[40:43], v[196:199]
 ds_read_b64_tr_b16 a[156:157], v4 offset:57344
 ds_read_b64_tr_b16 a[158:159], v4 offset:58368
M v[200:203], a[160:163], a[48:51], v[200:203]
 s_add_u32 m0, s87, 0
M v[200:203], a[164:167], a[52:55], v[200:203]
 buffer_load_dwordx4 v25, s[60:63], s89 offen offset:0 nt lds
M v[204:207], a[164:167], a[60:63], v[204:207]
 s_add_u32 s89, s89, 114688
M v[204:207], a[160:163], a[56:59], v[204:207]
M v[208:211], a[160:163], a[64:67], v[208:211]
M v[208:211], a[164:167], a[68:71], v[208:211]
M v[212:215], a[164:167], a[76:79], v[212:215]
M v[212:215], a[160:163], a[72:75], v[212:215]
M v[216:219], a[160:163], a[80:83], v[216:219]
M v[216:219], a[164:167], a[84:87], v[216:219]
 s_waitcnt lgkmcnt(2)
M v[220:223], a[164:167], a[92:95], v[220:223]
 s_waitcnt vmcnt(19) lgkmcnt(0)
M v[220:223], a[160:163], a[88:91], v[220:223]
 s_barrier
M v[252:255], a[168:171], a[88:91], v[252:255]
 ds_read_b128 a[160:163], v5 offset:32768
 ds_read_b128 a[164:167], v6 offset:32768
M v[252:255], a[172:175], a[92:95], v[252:255]
M v[248:251], a[172:175], a[84:87], v[248:251]
M v[248:251], a[168:171], a[80:83], v[248:251]
M v[244:247], a[168:171], a[72:75], v[244:247]
M v[244:247], a[172:175], a[76:79], v[244:247]
M v[240:243], a[172:175], a[68:71], v[240:243]
M v[240:243], a[168:171], a[64:67], v[240:243]
M v[236:239], a[168:171], a[56:59], v[236:239]
M v[236:239], a[172:175], a[60:63], v[236:239]
M v[232:235], a[172:175], a[52:55], v[232:235]
M v[232:235], a[168:171], a[48:51], v[232:235]
M v[228:231], a[168:171], a[40:43], v[228:231]
M v[228:231], a[172:175], a[44:47], v[228:231]
 s_waitcnt lgkmcnt(0)
M v[224:227], a[172:175], a[36:39], v[224:227]
M v[224:227], a[168:171], a[32:35], v[224:227]
M a[0:3], a[160:163], a[96:99], a[0:3]
 ds_read_b128 a[168:171], v5 offset:34816
 ds_read_b128 a[172:175], v6 offset:34816
M a[0:3], a[164:167], a[100:103], a[0:3]
 ds_read_b64_tr_b16 a[32:33], v1 offset:0
 ds_read_b64_tr_b16 a[34:35], v1 offset:1024
M a[4:7], a[164:167], a[108:111], a[4:7]
 s_add_u32 m0, s24, 16384
M a[4:7], a[160:163], a[104:107], a[4:7]
 buffer_load_dwordx4 v12, s[48:51], s22 offen offset:0   lds
M a[8:11], a[160:163], a[112:115], a[8:11]
M a[8:11], a[164:167], a[116:119], a[8:11]
M a[12:15], a[164:167], a[124:127], a[12:15]
 ds_read_b64_tr_b16 a[36:37], v1 offset:8192
 ds_read_b64_tr_b16 a[38:39], v1 offset:9216
M a[12:15], a[160:163], a[120:123], a[12:15]
M a[16:19], a[160:163], a[128:131], a[16:19]
 buffer_load_dwordx4 v13, s[48:51], s22 offen offset:1024   lds
M a[16:19], a[164:167], a[132:135], a[16:19]
M a[20:23], a[164:167], a[140:143], a[20:23]
M a[20:23], a[160:163], a[136:139], a[20:23]
 ds_read_b64_tr_b16 a[40:41], v2 offset:0
 ds_read_b64_tr_b16 a[42:43], v2 offset:1024
M a[24:27], a[160:163], a[144:147], a[24:27]
M a[24:27], a[164:167], a[148:151], a[24:27]
 s_waitcnt lgkmcnt(6)
M a[28:31], a[164:167], a[156:159], a[28:31]
 buffer_load_dwordx4 v14, s[48:51], s22 offen offset:2048   lds
M a[28:31], a[160:163], a[152:155], a[28:31]
M v[60:63], a[168:171], a[152:155], v[60:63]
 ds_read_b128 a[160:163], v5 offset:36864
 ds_read_b128 a[164:167], v6 offset:36864
M v[60:63], a[172:175], a[156:159], v[60:63]
 ds_read_b64_tr_b16 a[44:45], v2 offset:8192
 ds_read_b64_tr_b16 a[46:47], v2 offset:9216
M v[56:59], a[172:175], a[148:151], v[56:59]
 buffer_load_dwordx4 v15, s[48:51], s22 offen offset:3072   lds
M v[56:59], a[168:171], a[144:147], v[56:59]
 s_sub_u32 s22, s22, 2097024
M v[52:55], a[168:171], a[136:139], v[52:55]
M v[52:55], a[172:175], a[140:143], v[52:55]
 ds_read_b64_tr_b16 a[48:49], v3 offset:0
 ds_read_b64_tr_b16 a[50:51], v3 offset:1024
M v[48:51], a[172:175], a[132:135], v[48:51]
 s_add_u32 m0, s23, 49152
M v[48:51], a[168:171], a[128:131], v[48:51]
 buffer_load_dwordx4 v8, s[16:19], s21 offen offset:0  nt lds
M v[44:47], a[168:171], a[120:123], v[44:47]
M v[44:47], a[172:175], a[124:127], v[44:47]
M v[40:43], a[172:175], a[116:119], v[40:43]
 ds_read_b64_tr_b16 a[52:53], v3 offset:8192
 ds_read_b64_tr_b16 a[54:55], v3 offset:9216
M v[40:43], a[168:171], a[112:115], v[40:43]
M v[36:39], a[168:171], a[104:107], v[36:39]
 buffer_load_dwordx4 v9, s[16:19], s21 offen offset:1024  nt lds
M v[36:39], a[172:175], a[108:111], v[36:39]
 s_waitcnt lgkmcnt(6)
M v[32:35], a[172:175], a[100:103], v[32:35]
M v[32:35], a[168:171], a[96:99], v[32:35]
 ds_read_b64_tr_b16 a[56:57], v4 offset:0
 ds_read_b64_tr_b16 a[58:59], v4 offset:1024
M v[64:67], a[160:163], a[96:99], v[64:67]
 ds_read_b128 a[168:171], v5 offset:38912
 ds_read_b128 a[172:175], v6 offset:38912
M v[64:67], a[164:167], a[100:103], v[64:67]
 buffer_load_dwordx4 v10, s[16:19], s21 offen offset:2048  nt lds
M v[68:71], a[164:167], a[108:111], v[68:71]
M v[68:71], a[160:163], a[104:107], v[68:71]
M v[72:75], a[160:163], a[112:115], v[72:75]
 ds_read_b64_tr_b16 a[60:61], v4 offset:8192
 ds_read_b64_tr_b16 a[62:63], v4 offset:9216
M v[72:75], a[164:167], a[116:119], v[72:75]
M v[76:79], a[164:167], a[124:127], v[76:79]
 buffer_load_dwordx4 v11, s[16:19], s21 offen offset:3072  nt lds
M v[76:79], a[160:163], a[120:123], v[76:79]
 s_add_u32 s21, s21, 524160
M v[80:83], a[160:163], a[128:131], v[80:83]
M v[80:83], a[164:167], a[132:135], v[80:83]
M v[84:87], a[164:167], a[140:143], v[84:87]
M v[84:87], a[160:163], a[136:139], v[84:87]
M v[88:91], a[160:163], a[144:147], v[88:91]
M v[88:91], a[164:167], a[148:151], v[88:91]
 s_waitcnt lgkmcnt(2)
M v[92:95], a[164:167], a[156:159], v[92:95]
 s_waitcnt vmcnt(17) lgkmcnt(0)
M v[92:95], a[160:163], a[152:155], v[92:95]
 s_barrier
M v[124:127], a[168:171], a[152:155], v[124:127]
 ds_read_b128 a[160:163], v5 offset:49152
 ds_read_b128 a[164:167], v6 offset:49152
M v[124:127], a[172:175], a[156:159], v[124:127]
M v[120:123], a[172:175], a[148:151], v[120:123]
 s_add_u32 m0, s24, 32768
 ds_read_b64_tr_b16 a[64:65], v1 offset:16384
 ds_read_b64_tr_b16 a[66:67], v1 offset:17408
M v[120:123], a[168:171], a[144:147], v[120:123]
 buffer_load_dwordx4 v12, s[48:51], s22 offen offset:0   lds
M v[116:119], a[168:171], a[136:139], v[116:119]
 v_min_u32 v16, 40, v0
 v_lshlrev_b32 v16, 2, v16
M v[116:119], a[172:175], a[140:143], v[116:119]
 buffer_load_dword v17, v16, s[12:15], 0 offen offset:64 sc1
M v[112:115], a[172:175], a[132:135], v[112:115]
M v[112:115], a[168:171], a[128:131], v[112:115]
M v[108:111], a[168:171], a[120:123], v[108:111]
M v[108:111], a[172:175], a[124:127], v[108:111]
 ds_read_b64_tr_b16 a[68:69], v1 offset:24576
 ds_read_b64_tr_b16 a[70:71], v1 offset:25600
M v[104:107], a[172:175], a[116:119], v[104:107]
 buffer_load_dwordx4 v13, s[48:51], s22 offen offset:1024   lds
M v[104:107], a[168:171], a[112:115], v[104:107]
M v[100:103], a[168:171], a[104:107], v[100:103]
M v[100:103], a[172:175], a[108:111], v[100:103]
 s_waitcnt lgkmcnt(4)
M v[96:99], a[172:175], a[100:103], v[96:99]
M v[96:99], a[168:171], a[96:99], v[96:99]
 buffer_load_dwordx4 v14, s[48:51], s22 offen offset:2048   lds
M v[128:131], a[160:163], a[96:99], v[128:131]
 ds_read_b128 a[168:171], v5 offset:51200
 ds_read_b128 a[172:175], v6 offset:51200
M v[128:131], a[164:167], a[100:103], v[128:131]
 ds_read_b64_tr_b16 a[72:73], v2 offset:16384
 ds_read_b64_tr_b16 a[74:75], v2 offset:17408
M v[132:135], a[164:167], a[108:111], v[132:135]
M v[132:135], a[160:163], a[104:107], v[132:135]
M v[136:139], a[160:163], a[112:115], v[136:139]
M v[136:139], a[164:167], a[116:119], v[136:139]
M v[140:143], a[164:167], a[124:127], v[140:143]
 buffer_load_dwordx4 v15, s[48:51], s22 offen offset:3072   lds
M v[140:143], a[160:163], a[120:123], v[140:143]
 s_add_u32 s22, s22, 2097152
 ds_read_b64_tr_b16 a[76:77], v2 offset:24576
 ds_read_b64_tr_b16 a[78:79], v2 offset:25600
M v[144:147], a[160:163], a[128:131], v[144:147]
M v[144:147], a[164:167], a[132:135], v[144:147]
M v[148:151], a[164:167], a[140:143], v[148:151]
M v[148:151], a[160:163], a[136:139], v[148:151]
 s_add_u32 m0, s23, 0
M v[152:155], a[160:163], a[144:147], v[152:155]
 buffer_load_dwordx4 v8, s[16:19], s21 offen offset:0  nt lds
M v[152:155], a[164:167], a[148:151], v[152:155]
 s_waitcnt lgkmcnt(4)
M v[156:159], a[164:167], a[156:159], v[156:159]
 ds_read_b64_tr_b16 a[80:81], v3 offset:16384
 ds_read_b64_tr_b16 a[82:83], v3 offset:17408
M v[156:159], a[160:163], a[152:155], v[156:159]
M v[188:191], a[168:171], a[152:155], v[188:191]
 ds_read_b128 a[160:163], v5 offset:53248
 ds_read_b128 a[164:167], v6 offset:53248
M v[188:191], a[172:175], a[156:159], v[188:191]
M v[184:187], a[172:175], a[148:151], v[184:187]
 buffer_load_dwordx4 v9, s[16:19], s21 offen offset:1024  nt lds
M v[184:187], a[168:171], a[144:147], v[184:187]
M v[180:183], a[168:171], a[136:139], v[180:183]
M v[180:183], a[172:175], a[140:143], v[180:183]
 ds_read_b64_tr_b16 a[84:85], v3 offset:24576
 ds_read_b64_tr_b16 a[86:87], v3 offset:25600
M v[176:179], a[172:175], a[132:135], v[176:179]
M v[176:179], a[168:171], a[128:131], v[176:179]
M v[172:175], a[168:171], a[120:123], v[172:175]
M v[172:175], a[172:175], a[124:127], v[172:175]
 buffer_load_dwordx4 v10, s[16:19], s21 offen offset:2048  nt lds
M v[168:171], a[172:175], a[116:119], v[168:171]
M v[168:171], a[168:171], a[112:115], v[168:171]
M v[164:167], a[168:171], a[104:107], v[164:167]
 ds_read_b64_tr_b16 a[88:89], v4 offset:16384
 ds_read_b64_tr_b16 a[90:91], v4 offset:17408
M v[164:167], a[172:175], a[108:111], v[164:167]
 s_waitcnt lgkmcnt(4)
M v[160:163], a[172:175], a[100:103], v[160:163]
M v[160:163], a[168:171], a[96:99], v[160:163]
 buffer_load_dwordx4 v11, s[16:19], s21 offen offset:3072  nt lds
M v[192:195], a[160:163], a[96:99], v[192:195]
 s_add_u32 s21, s21, 128
 ds_read_b128 a[168:171], v5 offset:55296
 ds_read_b128 a[172:175], v6 offset:55296
M v[192:195], a[164:167], a[100:103], v[192:195]
M v[196:199], a[164:167], a[108:111], v[196:199]
M v[196:199], a[160:163], a[104:107], v[196:199]
 ds_read_b64_tr_b16 a[92:93], v4 offset:24576
 ds_read_b64_tr_b16 a[94:95], v4 offset:25600
M v[200:203], a[160:163], a[112:115], v[200:203]
 s_add_u32 m0, s87, 1024
M v[200:203], a[164:167], a[116:119], v[200:203]
 buffer_load_dwordx4 v25, s[60:63], s89 offen offset:0 nt lds
M v[204:207], a[164:167], a[124:127], v[204:207]
 s_add_u32 s89, s89, 114688
M v[204:207], a[160:163], a[120:123], v[204:207]
M v[208:211], a[160:163], a[128:131], v[208:211]
M v[208:211], a[164:167], a[132:135], v[208:211]
M v[212:215], a[164:167], a[140:143], v[212:215]
M v[212:215], a[160:163], a[136:139], v[212:215]
M v[216:219], a[160:163], a[144:147], v[216:219]
M v[216:219], a[164:167], a[148:151], v[216:219]
 s_waitcnt lgkmcnt(2)
M v[220:223], a[164:167], a[156:159], v[220:223]
 s_waitcnt vmcnt(19) lgkmcnt(0)
M v[220:223], a[160:163], a[152:155], v[220:223]
 s_barrier
M v[252:255], a[168:171], a[152:155], v[252:255]
 ds_read_b128 a[160:163], v5 offset:0
 ds_read_b128 a[164:167], v6 offset:0
M v[252:255], a[172:175], a[156:159], v[252:255]
M v[248:251], a[172:175], a[148:151], v[248:251]
M v[248:251], a[168:171], a[144:147], v[248:251]
M v[244:247], a[168:171], a[136:139], v[244:247]
M v[244:247], a[172:175], a[140:143], v[244:247]
M v[240:243], a[172:175], a[132:135], v[240:243]
M v[240:243], a[168:171], a[128:131], v[240:243]
M v[236:239], a[168:171], a[120:123], v[236:239]
M v[236:239], a[172:175], a[124:127], v[236:239]
M v[232:235], a[172:175], a[116:119], v[232:235]
M v[232:235], a[168:171], a[112:115], v[232:235]
M v[228:231], a[168:171], a[104:107], v[228:231]
M v[228:231], a[172:175], a[108:111], v[228:231]
 s_waitcnt lgkmcnt(0)
M v[224:227], a[172:175], a[100:103], v[224:227]
M v[224:227], a[168:171], a[96:99], v[224:227]
M a[0:3], a[160:163], a[32:35], a[0:3]
 ds_read_b128 a[168:171], v5 offset:2048
 ds_read_b128 a[172:175], v6 offset:2048
M a[0:3], a[164:167], a[36:39], a[0:3]
 ds_read_b64_tr_b16 a[96:97], v1 offset:32768
 ds_read_b64_tr_b16 a[98:99], v1 offset:33792
M a[4:7], a[164:167], a[44:47], a[4:7]
 s_add_u32 m0, s24, 49152
M a[4:7], a[160:163], a[40:43], a[4:7]
 buffer_load_dwordx4 v12, s[48:51], s22 offen offset:0   lds
M a[8:11], a[160:163], a[48:51], a[8:11]
M a[8:11], a[164:167], a[52:55], a[8:11]
M a[12:15], a[164:167], a[60:63], a[12:15]
 ds_read_b64_tr_b16 a[100:101], v1 offset:40960
 ds_read_b64_tr_b16 a[102:103], v1 offset:41984
M a[12:15], a[160:163], a[56:59], a[12:15]
M a[16:19], a[160:163], a[64:67], a[16:19]
 buffer_load_dwordx4 v13, s[48:51], s22 offen offset:1024   lds
M a[16:19], a[164:167], a[68:71], a[16:19]
M a[20:23], a[164:167], a[76:79], a[20:23]
M a[20:23], a[160:163], a[72:75], a[20:23]
 ds_read_b64_tr_b16 a[104:105], v2 offset:32768
 ds_read_b64_tr_b16 a[106:107], v2 offset:33792
M a[24:27], a[160:163], a[80:83], a[24:27]
M a[24:27], a[164:167], a[84:87], a[24:27]
 s_waitcnt lgkmcnt(6)
M a[28:31], a[164:167], a[92:95], a[28:31]
 buffer_load_dwordx4 v14, s[48:51], s22 offen offset:2048   lds
M a[28:31], a[160:163], a[88:91], a[28:31]
M v[60:63], a[168:171], a[88:91], v[60:63]
 ds_read_b128 a[160:163], v5 offset:4096
 ds_read_b128 a[164:167], v6 offset:4096
M v[60:63], a[172:175], a[92:95], v[60:63]
 ds_read_b64_tr_b16 a[108:109], v2 offset:40960
 ds_read_b64_tr_b16 a[110:111], v2 offset:41984
M v[56:59], a[172:175], a[84:87], v[56:59]
 buffer_load_dwordx4 v15, s[48:51], s22 offen offset:3072   lds
M v[56:59], a[168:171], a[80:83], v[56:59]
 s_sub_u32 s22, s22, 2097024
M v[52:55], a[168:171], a[72:75], v[52:55]
M v[52:55], a[172:175], a[76:79], v[52:55]
 ds_read_b64_tr_b16 a[112:113], v3 offset:32768
 ds_read_b64_tr_b16 a[114:115], v3 offset:33792
M v[48:51], a[172:175], a[68:71], v[48:51]
 s_add_u32 m0, s23, 16384
M v[48:51], a[168:171], a[64:67], v[48:51]
 buffer_load_dwordx4 v8, s[16:19], s21 offen offset:0  nt lds
M v[44:47], a[168:171], a[56:59], v[44:47]
M v[44:47], a[172:175], a[60:63], v[44:47]
M v[40:43], a[172:175], a[52:55], v[40:43]
 ds_read_b64_tr_b16 a[116:117], v3 offset:40960
 ds_read_b64_tr_b16 a[118:119], v3 offset:41984
M v[40:43], a[168:171], a[48:51], v[40:43]
M v[36:39], a[168:171], a[40:43], v[36:39]
 buffer_load_dwordx4 v9, s[16:19], s21 offen offset:1024  nt lds
M v[36:39], a[172:175], a[44:47], v[36:39]
 s_waitcnt lgkmcnt(6)
M v[32:35], a[172:175], a[36:39], v[32:35]
M v[32:35], a[168:171], a[32:35], v[32:35]
 ds_read_b64_tr_b16 a[120:121], v4 offset:32768
 ds_read_b64_tr_b16 a[122:123], v4 offset:33792
M v[64:67], a[160:163], a[32:35], v[64:67]
 ds_read_b128 a[168:171], v5 offset:6144
 ds_read_b128 a[172:175], v6 offset:6144
M v[64:67], a[164:167], a[36:39], v[64:67]
 buffer_load_dwordx4 v10, s[16:19], s21 offen offset:2048  nt lds
M v[68:71], a[164:167], a[44:47], v[68:71]
M v[68:71], a[160:163], a[40:43], v[68:71]
M v[72:75], a[160:163], a[48:51], v[72:75]
 ds_read_b64_tr_b16 a[124:125], v4 offset:40960
 ds_read_b64_tr_b16 a[126:127], v4 offset:41984
M v[72:75], a[164:167], a[52:55], v[72:75]
M v[76:79], a[164:167], a[60:63], v[76:79]
 buffer_load_dwordx4 v11, s[16:19], s21 offen offset:3072  nt lds
M v[76:79], a[160:163], a[56:59], v[76:79]
 s_add_u32 s21, s21, 524160
M v[80:83], a[160:163], a[64:67], v[80:83]
M v[80:83], a[164:167], a[68:71], v[80:83]
M v[84:87], a[164:167], a[76:79], v[84:87]
M v[84:87], a[160:163], a[72:75], v[84:87]
M v[88:91], a[160:163], a[80:83], v[88:91]
M v[88:91], a[164:167], a[84:87], v[88:91]
 s_waitcnt lgkmcnt(2)
M v[92:95], a[164:167], a[92:95], v[92:95]
 s_waitcnt vmcnt(18) lgkmcnt(0)
M v[92:95], a[160:163], a[88:91], v[92:95]
 s_barrier
M v[124:127], a[168:171], a[88:91], v[124:127]
 ds_read_b128 a[160:163], v5 offset:16384
 ds_read_b128 a[164:167], v6 offset:16384
M v[124:127], a[172:175], a[92:95], v[124:127]
M v[120:123], a[172:175], a[84:87], v[120:123]
 s_add_u32 m0, s24, 0
 ds_read_b64_tr_b16 a[128:129], v1 offset:49152
 ds_read_b64_tr_b16 a[130:131], v1 offset:50176
M v[120:123], a[168:171], a[80:83], v[120:123]
 buffer_load_dwordx4 v12, s[48:51], s22 offen offset:0   lds
M v[116:119], a[168:171], a[72:75], v[116:119]
M v[116:119], a[172:175], a[76:79], v[116:119]
M v[112:115], a[172:175], a[68:71], v[112:115]
M v[112:115], a[168:171], a[64:67], v[112:115]
M v[108:111], a[168:171], a[56:59], v[108:111]
M v[108:111], a[172:175], a[60:63], v[108:111]
 ds_read_b64_tr_b16 a[132:133], v1 offset:57344
 ds_read_b64_tr_b16 a[134:135], v1 offset:58368
M v[104:107], a[172:175], a[52:55], v[104:107]
 buffer_load_dwordx4 v13, s[48:51], s22 offen offset:1024   lds
M v[104:107], a[168:171], a[48:51], v[104:107]
M v[100:103], a[168:171], a[40:43], v[100:103]
M v[100:103], a[172:175], a[44:47], v[100:103]
 s_waitcnt lgkmcnt(4)
M v[96:99], a[172:175], a[36:39], v[96:99]
M v[96:99], a[168:171], a[32:35], v[96:99]
 buffer_load_dwordx4 v14, s[48:51], s22 offen offset:2048   lds
M v[128:131], a[160:163], a[32:35], v[128:131]
 ds_read_b128 a[168:171], v5 offset:18432
 ds_read_b128 a[172:175], v6 offset:18432
M v[128:131], a[164:167], a[36:39], v[128:131]
 ds_read_b64_tr_b16 a[136:137], v2 offset:49152
 ds_read_b64_tr_b16 a[138:139], v2 offset:50176
M v[132:135], a[164:167], a[44:47], v[132:135]
M v[132:135], a[160:163], a[40:43], v[132:135]
M v[136:139], a[160:163], a[48:51], v[136:139]
M v[136:139], a[164:167], a[52:55], v[136:139]
M v[140:143], a[164:167], a[60:63], v[140:143]
 buffer_load_dwordx4 v15, s[48:51], s22 offen offset:3072   lds
M v[140:143], a[160:163], a[56:59], v[140:143]
 s_add_u32 s22, s22, 2097152
 ds_read_b64_tr_b16 a[140:141], v2 offset:57344
 ds_read_b64_tr_b16 a[142:143], v2 offset:58368
M v[144:147], a[160:163], a[64:67], v[144:147]
M v[144:147], a[164:167], a[68:71], v[144:147]
M v[148:151], a[164:167], a[76:79], v[148:151]
M v[148:151], a[160:163], a[72:75], v[148:151]
 s_add_u32 m0, s23, 32768
M v[152:155], a[160:163], a[80:83], v[152:155]
 buffer_load_dwordx4 v8, s[16:19], s21 offen offset:0  nt lds
M v[152:155], a[164:167], a[84:87], v[152:155]
 s_waitcnt lgkmcnt(4)
M v[156:159], a[164:167], a[92:95], v[156:159]
 ds_read_b64_tr_b16 a[144:145], v3 offset:49152
 ds_read_b64_tr_b16 a[146:147], v3 offset:50176
M v[156:159], a[160:163], a[88:91], v[156:159]
M v[188:191], a[168:171], a[88:91], v[188:191]
 ds_read_b128 a[160:163], v5 offset:20480
 ds_read_b128 a[164:167], v6 offset:20480
M v[188:191], a[172:175], a[92:95], v[188:191]
M v[184:187], a[172:175], a[84:87], v[184:187]
 buffer_load_dwordx4 v9, s[16:19], s21 offen offset:1024  nt lds
M v[184:187], a[168:171], a[80:83], v[184:187]
M v[180:183], a[168:171], a[72:75], v[180:183]
M v[180:183], a[172:175], a[76:79], v[180:183]
 ds_read_b64_tr_b16 a[148:149], v3 offset:57344
 ds_read_b64_tr_b16 a[150:151], v3 offset:58368
M v[176:179], a[172:175], a[68:71], v[176:179]
M v[176:179], a[168:171], a[64:67], v[176:179]
M v[172:175], a[168:171], a[56:59], v[172:175]
M v[172:175], a[172:175], a[60:63], v[172:175]
 buffer_load_dwordx4 v10, s[16:19], s21 offen offset:2048  nt lds
M v[168:171], a[172:175], a[52:55], v[168:171]
M v[168:171], a[168:171], a[48:51], v[168:171]
M v[164:167], a[168:171], a[40:43], v[164:167]
 ds_read_b64_tr_b16 a[152:153], v4 offset:49152
 ds_read_b64_tr_b16 a[154:155], v4 offset:50176
M v[164:167], a[172:175], a[44:47], v[164:167]
 s_waitcnt lgkmcnt(4)
M v[160:163], a[172:175], a[36:39], v[160:163]
M v[160:163], a[168:171], a[32:35], v[160:163]
 buffer_load_dwordx4 v11, s[16:19], s21 offen offset:3072  nt lds
M v[192:195], a[160:163], a[32:35], v[192:195]
 s_add_u32 s21, s21, 128
 ds_read_b128 a[168:171], v5 offset:22528
 ds_read_b128 a[172:175], v6 offset:22528
M v[192:195], a[164:167], a[36:39], v[192:195]
M v[196:199], a[164:167], a[44:47], v[196:199]
M v[196:199], a[160:163], a[40:43], v[196:199]
 ds_read_b64_tr_b16 a[156:157], v4 offset:57344
 ds_read_b64_tr_b16 a[158:159], v4 offset:58368
M v[200:203], a[160:163], a[48:51], v[200:203]
 s_add_u32 m0, s87, 2048
M v[200:203], a[164:167], a[52:55], v[200:203]
 buffer_load_dwordx4 v25, s[60:63], s89 offen offset:0 nt lds
M v[204:207], a[164:167], a[60:63], v[204:207]
 s_add_u32 s89, s89, 114688
M v[204:207], a[160:163], a[56:59], v[204:207]
M v[208:211], a[160:163], a[64:67], v[208:211]
M v[208:211], a[164:167], a[68:71], v[208:211]
M v[212:215], a[164:167], a[76:79], v[212:215]
M v[212:215], a[160:163], a[72:75], v[212:215]
M v[216:219], a[160:163], a[80:83], v[216:219]
M v[216:219], a[164:167], a[84:87], v[216:219]
 s_waitcnt lgkmcnt(2)
M v[220:223], a[164:167], a[92:95], v[220:223]
 s_waitcnt vmcnt(18) lgkmcnt(0)
M v[220:223], a[160:163], a[88:91], v[220:223]
 s_barrier
M v[252:255], a[168:171], a[88:91], v[252:255]
 ds_read_b128 a[160:163], v5 offset:32768
 ds_read_b128 a[164:167], v6 offset:32768
M v[252:255], a[172:175], a[92:95], v[252:255]
 v_cmp_ne_u32 vcc, 1, v17
M v[248:251], a[172:175], a[84:87], v[248:251]
 s_nop 0
M v[248:251], a[168:171], a[80:83], v[248:251]
 s_cbranch_vccnz L_zs0
L_zr0:
M v[244:247], a[168:171], a[72:75], v[244:247]
 buffer_load_dword a240, v24, s[32:35], 0 offen offset:1024
M v[244:247], a[172:175], a[76:79], v[244:247]
 s_lshl_b32 s72, s30, 6
M v[240:243], a[172:175], a[68:71], v[240:243]
 s_add_u32 s72, s72, 104914944
M v[240:243], a[168:171], a[64:67], v[240:243]
M v[236:239], a[168:171], a[56:59], v[236:239]
 buffer_store_dword v19, v18, s[8:11], s72 offen sc1
M v[236:239], a[172:175], a[60:63], v[236:239]
M v[232:235], a[172:175], a[52:55], v[232:235]
M v[232:235], a[168:171], a[48:51], v[232:235]
M v[228:231], a[168:171], a[40:43], v[228:231]
M v[228:231], a[172:175], a[44:47], v[228:231]
 s_waitcnt lgkmcnt(0)
M v[224:227], a[172:175], a[36:39], v[224:227]
M v[224:227], a[168:171], a[32:35], v[224:227]
M a[0:3], a[160:163], a[96:99], a[0:3]
 ds_read_b128 a[168:171], v5 offset:34816
 ds_read_b128 a[172:175], v6 offset:34816
M a[0:3], a[164:167], a[100:103], a[0:3]
 ds_read_b64_tr_b16 a[32:33], v1 offset:0
 ds_read_b64_tr_b16 a[34:35], v1 offset:1024
M a[4:7], a[164:167], a[108:111], a[4:7]
 s_add_u32 m0, s24, 16384
M a[4:7], a[160:163], a[104:107], a[4:7]
 buffer_load_dwordx4 v12, s[48:51], s22 offen offset:0   lds
M a[8:11], a[160:163], a[112:115], a[8:11]
M a[8:11], a[164:167], a[116:119], a[8:11]
M a[12:15], a[164:167], a[124:127], a[12:15]
 ds_read_b64_tr_b16 a[36:37], v1 offset:8192
 ds_read_b64_tr_b16 a[38:39], v1 offset:9216
M a[12:15], a[160:163], a[120:123], a[12:15]
M a[16:19], a[160:163], a[128:131], a[16:19]
 buffer_load_dwordx4 v13, s[48:51], s22 offen offset:1024   lds
M a[16:19], a[164:167], a[132:135], a[16:19]
M a[20:23], a[164:167], a[140:143], a[20:23]
M a[20:23], a[160:163], a[136:139], a[20:23]
 ds_read_b64_tr_b16 a[40:41], v2 offset:0
 ds_read_b64_tr_b16 a[42:43], v2 offset:1024
M a[24:27], a[160:163], a[144:147], a[24:27]
M a[24:27], a[164:167], a[148:151], a[24:27]
 s_waitcnt lgkmcnt(6)
M a[28:31], a[164:167], a[156:159], a[28:31]
 buffer_load_dwordx4 v14, s[48:51], s22 offen offset:2048   lds
M a[28:31], a[160:163], a[152:155], a[28:31]
M v[60:63], a[168:171], a[152:155], v[60:63]
 ds_read_b128 a[160:163], v5 offset:36864
 ds_read_b128 a[164:167], v6 offset:36864
M v[60:63], a[172:175], a[156:159], v[60:63]
 ds_read_b64_tr_b16 a[44:45], v2 offset:8192
 ds_read_b64_tr_b16 a[46:47], v2 offset:9216
M v[56:59], a[172:175], a[148:151], v[56:59]
 buffer_load_dwordx4 v15, s[48:51], s22 offen offset:3072   lds
M v[56:59], a[168:171], a[144:147], v[56:59]
 s_sub_u32 s22, s22, 2097024
M v[52:55], a[168:171], a[136:139], v[52:55]
M v[52:55], a[172:175], a[140:143], v[52:55]
 ds_read_b64_tr_b16 a[48:49], v3 offset:0
 ds_read_b64_tr_b16 a[50:51], v3 offset:1024
M v[48:51], a[172:175], a[132:135], v[48:51]
 s_add_u32 m0, s23, 49152
M v[48:51], a[168:171], a[128:131], v[48:51]
 buffer_load_dwordx4 v8, s[16:19], s21 offen offset:0  nt lds
M v[44:47], a[168:171], a[120:123], v[44:47]
M v[44:47], a[172:175], a[124:127], v[44:47]
M v[40:43], a[172:175], a[116:119], v[40:43]
 ds_read_b64_tr_b16 a[52:53], v3 offset:8192
 ds_read_b64_tr_b16 a[54:55], v3 offset:9216
M v[40:43], a[168:171], a[112:115], v[40:43]
M v[36:39], a[168:171], a[104:107], v[36:39]
 buffer_load_dwordx4 v9, s[16:19], s21 offen offset:1024  nt lds
M v[36:39], a[172:175], a[108:111], v[36:39]
 s_waitcnt lgkmcnt(6)
M v[32:35], a[172:175], a[100:103], v[32:35]
M v[32:35], a[168:171], a[96:99], v[32:35]
 ds_read_b64_tr_b16 a[56:57], v4 offset:0
 ds_read_b64_tr_b16 a[58:59], v4 offset:1024
M v[64:67], a[160:163], a[96:99], v[64:67]
 ds_read_b128 a[168:171], v5 offset:38912
 ds_read_b128 a[172:175], v6 offset:38912
M v[64:67], a[164:167], a[100:103], v[64:67]
 buffer_load_dwordx4 v10, s[16:19], s21 offen offset:2048  nt lds
M v[68:71], a[164:167], a[108:111], v[68:71]
M v[68:71], a[160:163], a[104:107], v[68:71]
M v[72:75], a[160:163], a[112:115], v[72:75]
 ds_read_b64_tr_b16 a[60:61], v4 offset:8192
 ds_read_b64_tr_b16 a[62:63], v4 offset:9216
M v[72:75], a[164:167], a[116:119], v[72:75]
M v[76:79], a[164:167], a[124:127], v[76:79]
 buffer_load_dwordx4 v11, s[16:19], s21 offen offset:3072  nt lds
M v[76:79], a[160:163], a[120:123], v[76:79]
 s_add_u32 s21, s21, 524160
M v[80:83], a[160:163], a[128:131], v[80:83]
M v[80:83], a[164:167], a[132:135], v[80:83]
M v[84:87], a[164:167], a[140:143], v[84:87]
M v[84:87], a[160:163], a[136:139], v[84:87]
M v[88:91], a[160:163], a[144:147], v[88:91]
M v[88:91], a[164:167], a[148:151], v[88:91]
 s_waitcnt lgkmcnt(2)
M v[92:95], a[164:167], a[156:159], v[92:95]
 s_waitcnt vmcnt(19) lgkmcnt(0)
M v[92:95], a[160:163], a[152:155], v[92:95]
 s_barrier
M v[124:127], a[168:171], a[152:155], v[124:127]
 ds_read_b128 a[160:163], v5 offset:49152
 ds_read_b128 a[164:167], v6 offset:49152
M v[124:127], a[172:175], a[156:159], v[124:127]
M v[120:123], a[172:175], a[148:151], v[120:123]
 s_add_u32 m0, s24, 32768
 ds_read_b64_tr_b16 a[64:65], v1 offset:16384
 ds_read_b64_tr_b16 a[66:67], v1 offset:17408
M v[120:123], a[168:171], a[144:147], v[120:123]
 buffer_load_dwordx4 v12, s[48:51], s22 offen offset:0   lds
M v[116:119], a[168:171], a[136:139], v[116:119]
M v[116:119], a[172:175], a[140:143], v[116:119]
M v[112:115], a[172:175], a[132:135], v[112:115]
M v[112:115], a[168:171], a[128:131], v[112:115]
M v[108:111], a[168:171], a[120:123], v[108:111]
M v[108:111], a[172:175], a[124:127], v[108:111]
 ds_read_b64_tr_b16 a[68:69], v1 offset:24576
 ds_read_b64_tr_b16 a[70:71], v1 offset:25600
M v[104:107], a[172:175], a[116:119], v[104:107]
 buffer_load_dwordx4 v13, s[48:51], s22 offen offset:1024   lds
M v[104:107], a[168:171], a[112:115], v[104:107]
M v[100:103], a[168:171], a[104:107], v[100:103]
M v[100:103], a[172:175], a[108:111], v[100:103]
 s_waitcnt lgkmcnt(4)
M v[96:99], a[172:175], a[100:103], v[96:99]
M v[96:99], a[168:171], a[96:99], v[96:99]
 buffer_load_dwordx4 v14, s[48:51], s22 offen offset:2048   lds
M v[128:131], a[160:163], a[96:99], v[128:131]
 ds_read_b128 a[168:171], v5 offset:51200
 ds_read_b128 a[172:175], v6 offset:51200
M v[128:131], a[164:167], a[100:103], v[128:131]
 ds_read_b64_tr_b16 a[72:73], v2 offset:16384
 ds_read_b64_tr_b16 a[74:75], v2 offset:17408
M v[132:135], a[164:167], a[108:111], v[132:135]
M v[132:135], a[160:163], a[104:107], v[132:135]
M v[136:139], a[160:163], a[112:115], v[136:139]
M v[136:139], a[164:167], a[116:119], v[136:139]
M v[140:143], a[164:167], a[124:127], v[140:143]
 buffer_load_dwordx4 v15, s[48:51], s22 offen offset:3072   lds
M v[140:143], a[160:163], a[120:123], v[140:143]
 s_add_u32 s22, s22, 2097152
 ds_read_b64_tr_b16 a[76:77], v2 offset:24576
 ds_read_b64_tr_b16 a[78:79], v2 offset:25600
M v[144:147], a[160:163], a[128:131], v[144:147]
M v[144:147], a[164:167], a[132:135], v[144:147]
M v[148:151], a[164:167], a[140:143], v[148:151]
M v[148:151], a[160:163], a[136:139], v[148:151]
 s_add_u32 m0, s23, 0
M v[152:155], a[160:163], a[144:147], v[152:155]
 buffer_load_dwordx4 v8, s[16:19], s21 offen offset:0  nt lds
M v[152:155], a[164:167], a[148:151], v[152:155]
 s_waitcnt lgkmcnt(4)
M v[156:159], a[164:167], a[156:159], v[156:159]
 ds_read_b64_tr_b16 a[80:81], v3 offset:16384
 ds_read_b64_tr_b16 a[82:83], v3 offset:17408
M v[156:159], a[160:163], a[152:155], v[156:159]
M v[188:191], a[168:171], a[152:155], v[188:191]
 ds_read_b128 a[160:163], v5 offset:53248
 ds_read_b128 a[164:167], v6 offset:53248
M v[188:191], a[172:175], a[156:159], v[188:191]
M v[184:187], a[172:175], a[148:151], v[184:187]
 buffer_load_dwordx4 v9, s[16:19], s21 offen offset:1024  nt lds
M v[184:187], a[168:171], a[144:147], v[184:187]
M v[180:183], a[168:171], a[136:139], v[180:183]
M v[180:183], a[172:175], a[140:143], v[180:183]
 ds_read_b64_tr_b16 a[84:85], v3 offset:24576
 ds_read_b64_tr_b16 a[86:87], v3 offset:25600
M v[176:179], a[172:175], a[132:135], v[176:179]
M v[176:179], a[168:171], a[128:131], v[176:179]
M v[172:175], a[168:171], a[120:123], v[172:175]
M v[172:175], a[172:175], a[124:127], v[172:175]
 buffer_load_dwordx4 v10, s[16:19], s21 offen offset:2048  nt lds
M v[168:171], a[172:175], a[116:119], v[168:171]
M v[168:171], a[168:171], a[112:115], v[168:171]
M v[164:167], a[168:171], a[104:107], v[164:167]
 ds_read_b64_tr_b16 a[88:89], v4 offset:16384
 ds_read_b64_tr_b16 a[90:91], v4 offset:17408
M v[164:167], a[172:175], a[108:111], v[164:167]
 s_waitcnt lgkmcnt(4)
M v[160:163], a[172:175], a[100:103], v[160:163]
M v[160:163], a[168:171], a[96:99], v[160:163]
 buffer_load_dwordx4 v11, s[16:19], s21 offen offset:3072  nt lds
M v[192:195], a[160:163], a[96:99], v[192:195]
 s_add_u32 s21, s21, 128
 ds_read_b128 a[168:171], v5 offset:55296
 ds_read_b128 a[172:175], v6 offset:55296
M v[192:195], a[164:167], a[100:103], v[192:195]
M v[196:199], a[164:167], a[108:111], v[196:199]
M v[196:199], a[160:163], a[104:107], v[196:199]
 ds_read_b64_tr_b16 a[92:93], v4 offset:24576
 ds_read_b64_tr_b16 a[94:95], v4 offset:25600
M v[200:203], a[160:163], a[112:115], v[200:203]
 s_add_u32 m0, s87, 3072
M v[200:203], a[164:167], a[116:119], v[200:203]
 buffer_load_dwordx4 v25, s[60:63], s89 offen offset:0 nt lds
M v[204:207], a[164:167], a[124:127], v[204:207]
 s_add_u32 s89, s89, 114688
M v[204:207], a[160:163], a[120:123], v[204:207]
M v[208:211], a[160:163], a[128:131], v[208:211]
M v[208:211], a[164:167], a[132:135], v[208:211]
M v[212:215], a[164:167], a[140:143], v[212:215]
M v[212:215], a[160:163], a[136:139], v[212:215]
M v[216:219], a[160:163], a[144:147], v[216:219]
M v[216:219], a[164:167], a[148:151], v[216:219]
 s_waitcnt lgkmcnt(2)
M v[220:223], a[164:167], a[156:159], v[220:223]
 s_waitcnt vmcnt(20) lgkmcnt(0)
M v[220:223], a[160:163], a[152:155], v[220:223]
 s_barrier
M v[252:255], a[168:171], a[152:155], v[252:255]
 ds_read_b128 a[160:163], v5 offset:0
 ds_read_b128 a[164:167], v6 offset:0
M v[252:255], a[172:175], a[156:159], v[252:255]
M v[248:251], a[172:175], a[148:151], v[248:251]
M v[248:251], a[168:171], a[144:147], v[248:251]
M v[244:247], a[168:171], a[136:139], v[244:247]
M v[244:247], a[172:175], a[140:143], v[244:247]
M v[240:243], a[172:175], a[132:135], v[240:243]
M v[240:243], a[168:171], a[128:131], v[240:243]
M v[236:239], a[168:171], a[120:123], v[236:239]
M v[236:239], a[172:175], a[124:127], v[236:239]
M v[232:235], a[172:175], a[116:119], v[232:235]
M v[232:235], a[168:171], a[112:115], v[232:235]
M v[228:231], a[168:171], a[104:107], v[228:231]
M v[228:231], a[172:175], a[108:111], v[228:231]
 s_waitcnt lgkmcnt(0)
M v[224:227], a[172:175], a[100:103], v[224:227]
M v[224:227], a[168:171], a[96:99], v[224:227]
M a[0:3], a[160:163], a[32:35], a[0:3]
 ds_read_b128 a[168:171], v5 offset:2048
 ds_read_b128 a[172:175], v6 offset:2048
M a[0:3], a[164:167], a[36:39], a[0:3]
 ds_read_b64_tr_b16 a[96:97], v1 offset:32768
 ds_read_b64_tr_b16 a[98:99], v1 offset:33792
M a[4:7], a[164:167], a[44:47], a[4:7]
 s_add_u32 m0, s24, 49152
M a[4:7], a[160:163], a[40:43], a[4:7]
 buffer_load_dwordx4 v12, s[48:51], s22 offen offset:0   lds
M a[8:11], a[160:163], a[48:51], a[8:11]
M a[8:11], a[164:167], a[52:55], a[8:11]
M a[12:15], a[164:167], a[60:63], a[12:15]
 ds_read_b64_tr_b16 a[100:101], v1 offset:40960
 ds_read_b64_tr_b16 a[102:103], v1 offset:41984
M a[12:15], a[160:163], a[56:59], a[12:15]
M a[16:19], a[160:163], a[64:67], a[16:19]
 buffer_load_dwordx4 v13, s[48:51], s22 offen offset:1024   lds
M a[16:19], a[164:167], a[68:71], a[16:19]
M a[20:23], a[164:167], a[76:79], a[20:23]
M a[20:23], a[160:163], a[72:75], a[20:23]
 ds_read_b64_tr_b16 a[104:105], v2 offset:32768
 ds_read_b64_tr_b16 a[106:107], v2 offset:33792
M a[24:27], a[160:163], a[80:83], a[24:27]
M a[24:27], a[164:167], a[84:87], a[24:27]
 s_waitcnt lgkmcnt(6)
M a[28:31], a[164:167], a[92:95], a[28:31]
 buffer_load_dwordx4 v14, s[48:51], s22 offen offset:2048   lds
M a[28:31], a[160:163], a[88:91], a[28:31]
M v[60:63], a[168:171], a[88:91], v[60:63]
 ds_read_b128 a[160:163], v5 offset:4096
 ds_read_b128 a[164:167], v6 offset:4096
M v[60:63], a[172:175], a[92:95], v[60:63]
 ds_read_b64_tr_b16 a[108:109], v2 offset:40960
 ds_read_b64_tr_b16 a[110:111], v2 offset:41984
M v[56:59], a[172:175], a[84:87], v[56:59]
 buffer_load_dwordx4 v15, s[48:51], s22 offen offset:3072   lds
M v[56:59], a[168:171], a[80:83], v[56:59]
 s_sub_u32 s22, s22, 2097024
M v[52:55], a[168:171], a[72:75], v[52:55]
M v[52:55], a[172:175], a[76:79], v[52:55]
 ds_read_b64_tr_b16 a[112:113], v3 offset:32768
 ds_read_b64_tr_b16 a[114:115], v3 offset:33792
M v[48:51], a[172:175], a[68:71], v[48:51]
 s_add_u32 m0, s23, 16384
M v[48:51], a[168:171], a[64:67], v[48:51]
 buffer_load_dwordx4 v8, s[16:19], s21 offen offset:0  nt lds
M v[44:47], a[168:171], a[56:59], v[44:47]
M v[44:47], a[172:175], a[60:63], v[44:47]
M v[40:43], a[172:175], a[52:55], v[40:43]
 ds_read_b64_tr_b16 a[116:117], v3 offset:40960
 ds_read_b64_tr_b16 a[118:119], v3 offset:41984
M v[40:43], a[168:171], a[48:51], v[40:43]
M v[36:39], a[168:171], a[40:43], v[36:39]
 buffer_load_dwordx4 v9, s[16:19], s21 offen offset:1024  nt lds
M v[36:39], a[172:175], a[44:47], v[36:39]
 s_waitcnt lgkmcnt(6)
M v[32:35], a[172:175], a[36:39], v[32:35]
M v[32:35], a[168:171], a[32:35], v[32:35]
 ds_read_b64_tr_b16 a[120:121], v4 offset:32768
 ds_read_b64_tr_b16 a[122:123], v4 offset:33792
M v[64:67], a[160:163], a[32:35], v[64:67]
 ds_read_b128 a[168:171], v5 offset:6144
 ds_read_b128 a[172:175], v6 offset:6144
M v[64:67], a[164:167], a[36:39], v[64:67]
 buffer_load_dwordx4 v10, s[16:19], s21 offen offset:2048  nt lds
M v[68:71], a[164:167], a[44:47], v[68:71]
M v[68:71], a[160:163], a[40:43], v[68:71]
M v[72:75], a[160:163], a[48:51], v[72:75]
 ds_read_b64_tr_b16 a[124:125], v4 offset:40960
 ds_read_b64_tr_b16 a[126:127], v4 offset:41984
M v[72:75], a[164:167], a[52:55], v[72:75]
M v[76:79], a[164:167], a[60:63], v[76:79]
 buffer_load_dwordx4 v11, s[16:19], s21 offen offset:3072  nt lds
M v[76:79], a[160:163], a[56:59], v[76:79]
 s_add_u32 s21, s21, 524160
M v[80:83], a[160:163], a[64:67], v[80:83]
M v[80:83], a[164:167], a[68:71], v[80:83]
M v[84:87], a[164:167], a[76:79], v[84:87]
M v[84:87], a[160:163], a[72:75], v[84:87]
M v[88:91], a[160:163], a[80:83], v[88:91]
M v[88:91], a[164:167], a[84:87], v[88:91]
 s_waitcnt lgkmcnt(2)
M v[92:95], a[164:167], a[92:95], v[92:95]
 s_waitcnt vmcnt(17) lgkmcnt(0)
M v[92:95], a[160:163], a[88:91], v[92:95]
 s_barrier
M v[124:127], a[168:171], a[88:91], v[124:127]
 ds_read_b128 a[160:163], v5 offset:16384
 ds_read_b128 a[164:167], v6 offset:16384
M v[124:127], a[172:175], a[92:95], v[124:127]
M v[120:123], a[172:175], a[84:87], v[120:123]
 s_add_u32 m0, s24, 0
 ds_read_b64_tr_b16 a[128:129], v1 offset:49152
 ds_read_b64_tr_b16 a[130:131], v1 offset:50176
M v[120:123], a[168:171], a[80:83], v[120:123]
 buffer_load_dwordx4 v12, s[48:51], s22 offen offset:0   lds
M v[116:119], a[168:171], a[72:75], v[116:119]
M v[116:119], a[172:175], a[76:79], v[116:119]
M v[112:115], a[172:175], a[68:71], v[112:115]
M v[112:115], a[168:171], a[64:67], v[112:115]
M v[108:111], a[168:171], a[56:59], v[108:111]
M v[108:111], a[172:175], a[60:63], v[108:111]
 ds_read_b64_tr_b16 a[132:133], v1 offset:57344
 ds_read_b64_tr_b16 a[134:135], v1 offset:58368
M v[104:107], a[172:175], a[52:55], v[104:107]
 buffer_load_dwordx4 v13, s[48:51], s22 offen offset:1024   lds
M v[104:107], a[168:171], a[48:51], v[104:107]
M v[100:103], a[168:171], a[40:43], v[100:103]
M v[100:103], a[172:175], a[44:47], v[100:103]
 s_waitcnt lgkmcnt(4)
M v[96:99], a[172:175], a[36:39], v[96:99]
M v[96:99], a[168:171], a[32:35], v[96:99]
 buffer_load_dwordx4 v14, s[48:51], s22 offen offset:2048   lds
M v[128:131], a[160:163], a[32:35], v[128:131]
 ds_read_b128 a[168:171], v5 offset:18432
 ds_read_b128 a[172:175], v6 offset:18432
M v[128:131], a[164:167], a[36:39], v[128:131]
 ds_read_b64_tr_b16 a[136:137], v2 offset:49152
 ds_read_b64_tr_b16 a[138:139], v2 offset:50176
M v[132:135], a[164:167], a[44:47], v[132:135]
M v[132:135], a[160:163], a[40:43], v[132:135]
M v[136:139], a[160:163], a[48:51], v[136:139]
M v[136:139], a[164:167], a[52:55], v[136:139]
M v[140:143], a[164:167], a[60:63], v[140:143]
 buffer_load_dwordx4 v15, s[48:51], s22 offen offset:3072   lds
M v[140:143], a[160:163], a[56:59], v[140:143]
 s_add_u32 s22, s22, 2097152
 ds_read_b64_tr_b16 a[140:141], v2 offset:57344
 ds_read_b64_tr_b16 a[142:143], v2 offset:58368
M v[144:147], a[160:163], a[64:67], v[144:147]
M v[144:147], a[164:167], a[68:71], v[144:147]
M v[148:151], a[164:167], a[76:79], v[148:151]
M v[148:151], a[160:163], a[72:75], v[148:151]
 s_add_u32 m0, s23, 32768
M v[152:155], a[160:163], a[80:83], v[152:155]
 buffer_load_dwordx4 v8, s[16:19], s21 offen offset:0  nt lds
M v[152:155], a[164:167], a[84:87], v[152:155]
 s_waitcnt lgkmcnt(4)
M v[156:159], a[164:167], a[92:95], v[156:159]
 ds_read_b64_tr_b16 a[144:145], v3 offset:49152
 ds_read_b64_tr_b16 a[146:147], v3 offset:50176
M v[156:159], a[160:163], a[88:91], v[156:159]
M v[188:191], a[168:171], a[88:91], v[188:191]
 ds_read_b128 a[160:163], v5 offset:20480
 ds_read_b128 a[164:167], v6 offset:20480
M v[188:191], a[172:175], a[92:95], v[188:191]
M v[184:187], a[172:175], a[84:87], v[184:187]
 buffer_load_dwordx4 v9, s[16:19], s21 offen offset:1024  nt lds
M v[184:187], a[168:171], a[80:83], v[184:187]
M v[180:183], a[168:171], a[72:75], v[180:183]
M v[180:183], a[172:175], a[76:79], v[180:183]
 ds_read_b64_tr_b16 a[148:149], v3 offset:57344
 ds_read_b64_tr_b16 a[150:151], v3 offset:58368
M v[176:179], a[172:175], a[68:71], v[176:179]
M v[176:179], a[168:171], a[64:67], v[176:179]
M v[172:175], a[168:171], a[56:59], v[172:175]
M v[172:175], a[172:175], a[60:63], v[172:175]
 buffer_load_dwordx4 v10, s[16:19], s21 offen offset:2048  nt lds
M v[168:171], a[172:175], a[52:55], v[168:171]
M v[168:171], a[168:171], a[48:51], v[168:171]
M v[164:167], a[168:171], a[40:43], v[164:167]
 ds_read_b64_tr_b16 a[152:153], v4 offset:49152
 ds_read_b64_tr_b16 a[154:155], v4 offset:50176
M v[164:167], a[172:175], a[44:47], v[164:167]
 s_waitcnt lgkmcnt(4)
M v[160:163], a[172:175], a[36:39], v[160:163]
M v[160:163], a[168:171], a[32:35], v[160:163]
 buffer_load_dwordx4 v11, s[16:19], s21 offen offset:3072  nt lds
M v[192:195], a[160:163], a[32:35], v[192:195]
 s_add_u32 s21, s21, 128
 ds_read_b128 a[168:171], v5 offset:22528
 ds_read_b128 a[172:175], v6 offset:22528
M v[192:195], a[164:167], a[36:39], v[192:195]
M v[196:199], a[164:167], a[44:47], v[196:199]
M v[196:199], a[160:163], a[40:43], v[196:199]
 ds_read_b64_tr_b16 a[156:157], v4 offset:57344
 ds_read_b64_tr_b16 a[158:159], v4 offset:58368
M v[200:203], a[160:163], a[48:51], v[200:203]
 s_add_u32 m0, s87, 4096
M v[200:203], a[164:167], a[52:55], v[200:203]
 buffer_load_dwordx4 v25, s[60:63], s89 offen offset:0 nt lds
M v[204:207], a[164:167], a[60:63], v[204:207]
 s_add_u32 s89, s89, 114688
M v[204:207], a[160:163], a[56:59], v[204:207]
M v[208:211], a[160:163], a[64:67], v[208:211]
M v[208:211], a[164:167], a[68:71], v[208:211]
M v[212:215], a[164:167], a[76:79], v[212:215]
M v[212:215], a[160:163], a[72:75], v[212:215]
M v[216:219], a[160:163], a[80:83], v[216:219]
M v[216:219], a[164:167], a[84:87], v[216:219]
 s_waitcnt lgkmcnt(2)
M v[220:223], a[164:167], a[92:95], v[220:223]
 s_waitcnt vmcnt(18) lgkmcnt(0)
M v[220:223], a[160:163], a[88:91], v[220:223]
 s_barrier
M v[252:255], a[168:171], a[88:91], v[252:255]
 ds_read_b128 a[160:163], v5 offset:32768
 ds_read_b128 a[164:167], v6 offset:32768
M v[252:255], a[172:175], a[92:95], v[252:255]
 v_and_b32 v26, 48, v0
 v_lshlrev_b32 v26, 17, v26
M v[248:251], a[172:175], a[84:87], v[248:251]
 v_or_b32 v26, v26, v0
 v_lshl_add_u32 v26, v26, 7, s95
M v[248:251], a[168:171], a[80:83], v[248:251]
 buffer_load_dword a240, v26, s[76:79], 0 offen offset:0
M v[244:247], a[168:171], a[72:75], v[244:247]
M v[244:247], a[172:175], a[76:79], v[244:247]
M v[240:243], a[172:175], a[68:71], v[240:243]
M v[240:243], a[168:171], a[64:67], v[240:243]
M v[236:239], a[168:171], a[56:59], v[236:239]
M v[236:239], a[172:175], a[60:63], v[236:239]
M v[232:235], a[172:175], a[52:55], v[232:235]
M v[232:235], a[168:171], a[48:51], v[232:235]
M v[228:231], a[168:171], a[40:43], v[228:231]
M v[228:231], a[172:175], a[44:47], v[228:231]
 s_waitcnt lgkmcnt(0)
M v[224:227], a[172:175], a[36:39], v[224:227]
M v[224:227], a[168:171], a[32:35], v[224:227]
M a[0:3], a[160:163], a[96:99], a[0:3]
 ds_read_b128 a[168:171], v5 offset:34816
 ds_read_b128 a[172:175], v6 offset:34816
M a[0:3], a[164:167], a[100:103], a[0:3]
 ds_read_b64_tr_b16 a[32:33], v1 offset:0
 ds_read_b64_tr_b16 a[34:35], v1 offset:1024
M a[4:7], a[164:167], a[108:111], a[4:7]
 s_add_u32 m0, s24, 16384
M a[4:7], a[160:163], a[104:107], a[4:7]
 buffer_load_dwordx4 v12, s[48:51], s22 offen offset:0   lds
M a[8:11], a[160:163], a[112:115], a[8:11]
M a[8:11], a[164:167], a[116:119], a[8:11]
 s_lshl_b32 s67, s20, 11
M a[12:15], a[164:167], a[124:127], a[12:15]
 s_add_u32 s67, s67, 104914944
 ds_read_b64_tr_b16 a[36:37], v1 offset:8192
 ds_read_b64_tr_b16 a[38:39], v1 offset:9216
M a[12:15], a[160:163], a[120:123], a[12:15]
M a[16:19], a[160:163], a[128:131], a[16:19]
 buffer_load_dwordx4 v13, s[48:51], s22 offen offset:1024   lds
M a[16:19], a[164:167], a[132:135], a[16:19]
M a[20:23], a[164:167], a[140:143], a[20:23]
 buffer_load_dwordx4 v[16:19], v7, s[8:11], s67 offen offset:0 sc1
M a[20:23], a[160:163], a[136:139], a[20:23]
 ds_read_b64_tr_b16 a[40:41], v2 offset:0
 ds_read_b64_tr_b16 a[42:43], v2 offset:1024
M a[24:27], a[160:163], a[144:147], a[24:27]
 buffer_load_dwordx4 v[20:23], v7, s[8:11], s67 offen offset:1024 sc1
M a[24:27], a[164:167], a[148:151], a[24:27]
 s_waitcnt lgkmcnt(6)
M a[28:31], a[164:167], a[156:159], a[28:31]
 buffer_load_dwordx4 v14, s[48:51], s22 offen offset:2048   lds
M a[28:31], a[160:163], a[152:155], a[28:31]
M v[60:63], a[168:171], a[152:155], v[60:63]
 ds_read_b128 a[160:163], v5 offset:36864
 ds_read_b128 a[164:167], v6 offset:36864
M v[60:63], a[172:175], a[156:159], v[60:63]
 ds_read_b64_tr_b16 a[44:45], v2 offset:8192
 ds_read_b64_tr_b16 a[46:47], v2 offset:9216
M v[56:59], a[172:175], a[148:151], v[56:59]
 buffer_load_dwordx4 v15, s[48:51], s22 offen offset:3072   lds
M v[56:59], a[168:171], a[144:147], v[56:59]
 s_sub_u32 s22, s22, 2097024
M v[52:55], a[168:171], a[136:139], v[52:55]
M v[52:55], a[172:175], a[140:143], v[52:55]
 ds_read_b64_tr_b16 a[48:49], v3 offset:0
 ds_read_b64_tr_b16 a[50:51], v3 offset:1024
M v[48:51], a[172:175], a[132:135], v[48:51]
 s_add_u32 m0, s23, 49152
M v[48:51], a[168:171], a[128:131], v[48:51]
 buffer_load_dwordx4 v8, s[16:19], s21 offen offset:0  nt lds
M v[44:47], a[168:171], a[120:123], v[44:47]
M v[44:47], a[172:175], a[124:127], v[44:47]
M v[40:43], a[172:175], a[116:119], v[40:43]
 ds_read_b64_tr_b16 a[52:53], v3 offset:8192
 ds_read_b64_tr_b16 a[54:55], v3 offset:9216
M v[40:43], a[168:171], a[112:115], v[40:43]
M v[36:39], a[168:171], a[104:107], v[36:39]
 buffer_load_dwordx4 v9, s[16:19], s21 offen offset:1024  nt lds
M v[36:39], a[172:175], a[108:111], v[36:39]
 s_waitcnt lgkmcnt(6)
M v[32:35], a[172:175], a[100:103], v[32:35]
M v[32:35], a[168:171], a[96:99], v[32:35]
 ds_read_b64_tr_b16 a[56:57], v4 offset:0
 ds_read_b64_tr_b16 a[58:59], v4 offset:1024
M v[64:67], a[160:163], a[96:99], v[64:67]
 ds_read_b128 a[168:171], v5 offset:38912
 ds_read_b128 a[172:175], v6 offset:38912
M v[64:67], a[164:167], a[100:103], v[64:67]
 buffer_load_dwordx4 v10, s[16:19], s21 offen offset:2048  nt lds
M v[68:71], a[164:167], a[108:111], v[68:71]
M v[68:71], a[160:163], a[104:107], v[68:71]
M v[72:75], a[160:163], a[112:115], v[72:75]
 ds_read_b64_tr_b16 a[60:61], v4 offset:8192
 ds_read_b64_tr_b16 a[62:63], v4 offset:9216
M v[72:75], a[164:167], a[116:119], v[72:75]
M v[76:79], a[164:167], a[124:127], v[76:79]
 buffer_load_dwordx4 v11, s[16:19], s21 offen offset:3072  nt lds
M v[76:79], a[160:163], a[120:123], v[76:79]
 s_add_u32 s21, s21, 524160
M v[80:83], a[160:163], a[128:131], v[80:83]
M v[80:83], a[164:167], a[132:135], v[80:83]
M v[84:87], a[164:167], a[140:143], v[84:87]
M v[84:87], a[160:163], a[136:139], v[84:87]
M v[88:91], a[160:163], a[144:147], v[88:91]
M v[88:91], a[164:167], a[148:151], v[88:91]
 s_waitcnt lgkmcnt(2)
M v[92:95], a[164:167], a[156:159], v[92:95]
 s_waitcnt vmcnt(20) lgkmcnt(0)
M v[92:95], a[160:163], a[152:155], v[92:95]
 s_barrier
M v[124:127], a[168:171], a[152:155], v[124:127]
 ds_read_b128 a[160:163], v5 offset:49152
 ds_read_b128 a[164:167], v6 offset:49152
M v[124:127], a[172:175], a[156:159], v[124:127]
M v[120:123], a[172:175], a[148:151], v[120:123]
 s_add_u32 m0, s24, 32768
 ds_read_b64_tr_b16 a[64:65], v1 offset:16384
 ds_read_b64_tr_b16 a[66:67], v1 offset:17408
M v[120:123], a[168:171], a[144:147], v[120:123]
 buffer_load_dwordx4 v12, s[48:51], s22 offen offset:0   lds
M v[116:119], a[168:171], a[136:139], v[116:119]
M v[116:119], a[172:175], a[140:143], v[116:119]
M v[112:115], a[172:175], a[132:135], v[112:115]
M v[112:115], a[168:171], a[128:131], v[112:115]
M v[108:111], a[168:171], a[120:123], v[108:111]
M v[108:111], a[172:175], a[124:127], v[108:111]
 ds_read_b64_tr_b16 a[68:69], v1 offset:24576
 ds_read_b64_tr_b16 a[70:71], v1 offset:25600
M v[104:107], a[172:175], a[116:119], v[104:107]
 buffer_load_dwordx4 v13, s[48:51], s22 offen offset:1024   lds
M v[104:107], a[168:171], a[112:115], v[104:107]
M v[100:103], a[168:171], a[104:107], v[100:103]
M v[100:103], a[172:175], a[108:111], v[100:103]
 s_waitcnt lgkmcnt(4)
M v[96:99], a[172:175], a[100:103], v[96:99]
M v[96:99], a[168:171], a[96:99], v[96:99]
 buffer_load_dwordx4 v14, s[48:51], s22 offen offset:2048   lds
M v[128:131], a[160:163], a[96:99], v[128:131]
 ds_read_b128 a[168:171], v5 offset:51200
 ds_read_b128 a[172:175], v6 offset:51200
M v[128:131], a[164:167], a[100:103], v[128:131]
 ds_read_b64_tr_b16 a[72:73], v2 offset:16384
 ds_read_b64_tr_b16 a[74:75], v2 offset:17408
M v[132:135], a[164:167], a[108:111], v[132:135]
M v[132:135], a[160:163], a[104:107], v[132:135]
M v[136:139], a[160:163], a[112:115], v[136:139]
M v[136:139], a[164:167], a[116:119], v[136:139]
M v[140:143], a[164:167], a[124:127], v[140:143]
 buffer_load_dwordx4 v15, s[48:51], s22 offen offset:3072   lds
M v[140:143], a[160:163], a[120:123], v[140:143]
 s_add_u32 s22, s22, 2097152
 ds_read_b64_tr_b16 a[76:77], v2 offset:24576
 ds_read_b64_tr_b16 a[78:79], v2 offset:25600
M v[144:147], a[160:163], a[128:131], v[144:147]
M v[144:147], a[164:167], a[132:135], v[144:147]
M v[148:151], a[164:167], a[140:143], v[148:151]
M v[148:151], a[160:163], a[136:139], v[148:151]
 s_add_u32 m0, s23, 0
M v[152:155], a[160:163], a[144:147], v[152:155]
 buffer_load_dwordx4 v8, s[16:19], s21 offen offset:0  nt lds
M v[152:155], a[164:167], a[148:151], v[152:155]
 s_waitcnt lgkmcnt(4)
M v[156:159], a[164:167], a[156:159], v[156:159]
 ds_read_b64_tr_b16 a[80:81], v3 offset:16384
 ds_read_b64_tr_b16 a[82:83], v3 offset:17408
M v[156:159], a[160:163], a[152:155], v[156:159]
M v[188:191], a[168:171], a[152:155], v[188:191]
 ds_read_b128 a[160:163], v5 offset:53248
 ds_read_b128 a[164:167], v6 offset:53248
M v[188:191], a[172:175], a[156:159], v[188:191]
M v[184:187], a[172:175], a[148:151], v[184:187]
 buffer_load_dwordx4 v9, s[16:19], s21 offen offset:1024  nt lds
M v[184:187], a[168:171], a[144:147], v[184:187]
M v[180:183], a[168:171], a[136:139], v[180:183]
M v[180:183], a[172:175], a[140:143], v[180:183]
 ds_read_b64_tr_b16 a[84:85], v3 offset:24576
 ds_read_b64_tr_b16 a[86:87], v3 offset:25600
M v[176:179], a[172:175], a[132:135], v[176:179]
M v[176:179], a[168:171], a[128:131], v[176:179]
M v[172:175], a[168:171], a[120:123], v[172:175]
M v[172:175], a[172:175], a[124:127], v[172:175]
 buffer_load_dwordx4 v10, s[16:19], s21 offen offset:2048  nt lds
M v[168:171], a[172:175], a[116:119], v[168:171]
M v[168:171], a[168:171], a[112:115], v[168:171]
M v[164:167], a[168:171], a[104:107], v[164:167]
 ds_read_b64_tr_b16 a[88:89], v4 offset:16384
 ds_read_b64_tr_b16 a[90:91], v4 offset:17408
M v[164:167], a[172:175], a[108:111], v[164:167]
 s_waitcnt lgkmcnt(4)
M v[160:163], a[172:175], a[100:103], v[160:163]
M v[160:163], a[168:171], a[96:99], v[160:163]
 buffer_load_dwordx4 v11, s[16:19], s21 offen offset:3072  nt lds
M v[192:195], a[160:163], a[96:99], v[192:195]
 s_add_u32 s21, s21, 128
 ds_read_b128 a[168:171], v5 offset:55296
 ds_read_b128 a[172:175], v6 offset:55296
M v[192:195], a[164:167], a[100:103], v[192:195]
M v[196:199], a[164:167], a[108:111], v[196:199]
M v[196:199], a[160:163], a[104:107], v[196:199]
 ds_read_b64_tr_b16 a[92:93], v4 offset:24576
 ds_read_b64_tr_b16 a[94:95], v4 offset:25600
M v[200:203], a[160:163], a[112:115], v[200:203]
 s_add_u32 m0, s87, 5120
M v[200:203], a[164:167], a[116:119], v[200:203]
 buffer_load_dwordx4 v25, s[60:63], s89 offen offset:0 nt lds
M v[204:207], a[164:167], a[124:127], v[204:207]
 s_add_u32 s89, s89, 114688
M v[204:207], a[160:163], a[120:123], v[204:207]
M v[208:211], a[160:163], a[128:131], v[208:211]
M v[208:211], a[164:167], a[132:135], v[208:211]
M v[212:215], a[164:167], a[140:143], v[212:215]
M v[212:215], a[160:163], a[136:139], v[212:215]
M v[216:219], a[160:163], a[144:147], v[216:219]
M v[216:219], a[164:167], a[148:151], v[216:219]
 s_waitcnt lgkmcnt(2)
M v[220:223], a[164:167], a[156:159], v[220:223]
 s_waitcnt vmcnt(21) lgkmcnt(0)
M v[220:223], a[160:163], a[152:155], v[220:223]
 s_barrier
M v[252:255], a[168:171], a[152:155], v[252:255]
 ds_read_b128 a[160:163], v5 offset:0
 ds_read_b128 a[164:167], v6 offset:0
M v[252:255], a[172:175], a[156:159], v[252:255]
M v[248:251], a[172:175], a[148:151], v[248:251]
M v[248:251], a[168:171], a[144:147], v[248:251]
M v[244:247], a[168:171], a[136:139], v[244:247]
M v[244:247], a[172:175], a[140:143], v[244:247]
M v[240:243], a[172:175], a[132:135], v[240:243]
M v[240:243], a[168:171], a[128:131], v[240:243]
M v[236:239], a[168:171], a[120:123], v[236:239]
M v[236:239], a[172:175], a[124:127], v[236:239]
M v[232:235], a[172:175], a[116:119], v[232:235]
M v[232:235], a[168:171], a[112:115], v[232:235]
M v[228:231], a[168:171], a[104:107], v[228:231]
M v[228:231], a[172:175], a[108:111], v[228:231]
 s_waitcnt lgkmcnt(0)
M v[224:227], a[172:175], a[100:103], v[224:227]
M v[224:227], a[168:171], a[96:99], v[224:227]
M a[0:3], a[160:163], a[32:35], a[0:3]
 ds_read_b128 a[168:171], v5 offset:2048
 ds_read_b128 a[172:175], v6 offset:2048
M a[0:3], a[164:167], a[36:39], a[0:3]
 ds_read_b64_tr_b16 a[96:97], v1 offset:32768
 ds_read_b64_tr_b16 a[98:99], v1 offset:33792
M a[4:7], a[164:167], a[44:47], a[4:7]
 s_add_u32 m0, s24, 49152
M a[4:7], a[160:163], a[40:43], a[4:7]
 buffer_load_dwordx4 v12, s[48:51], s22 offen offset:0   lds
M a[8:11], a[160:163], a[48:51], a[8:11]
M a[8:11], a[164:167], a[52:55], a[8:11]
M a[12:15], a[164:167], a[60:63], a[12:15]
 ds_read_b64_tr_b16 a[100:101], v1 offset:40960
 ds_read_b64_tr_b16 a[102:103], v1 offset:41984
M a[12:15], a[160:163], a[56:59], a[12:15]
M a[16:19], a[160:163], a[64:67], a[16:19]
 buffer_load_dwordx4 v13, s[48:51], s22 offen offset:1024   lds
M a[16:19], a[164:167], a[68:71], a[16:19]
M a[20:23], a[164:167], a[76:79], a[20:23]
 s_waitcnt vmcnt(18)
 v_min3_u32 v28, v16, v17, v18
M a[20:23], a[160:163], a[72:75], a[20:23]
 ds_read_b64_tr_b16 a[104:105], v2 offset:32768
 ds_read_b64_tr_b16 a[106:107], v2 offset:33792
M a[24:27], a[160:163], a[80:83], a[24:27]
 s_waitcnt vmcnt(17)
 v_min3_u32 v28, v28, v19, v20
M a[24:27], a[164:167], a[84:87], a[24:27]
 s_waitcnt lgkmcnt(6)
 v_min3_u32 v28, v28, v21, v22
M a[28:31], a[164:167], a[92:95], a[28:31]
 buffer_load_dwordx4 v14, s[48:51], s22 offen offset:2048   lds
M a[28:31], a[160:163], a[88:91], a[28:31]
 v_min_u32 v28, v28, v23
M v[60:63], a[168:171], a[88:91], v[60:63]
 ds_read_b128 a[160:163], v5 offset:4096
 ds_read_b128 a[164:167], v6 offset:4096
M v[60:63], a[172:175], a[92:95], v[60:63]
 ds_read_b64_tr_b16 a[108:109], v2 offset:40960
 ds_read_b64_tr_b16 a[110:111], v2 offset:41984
M v[56:59], a[172:175], a[84:87], v[56:59]
 buffer_load_dwordx4 v15, s[48:51], s22 offen offset:3072   lds
M v[56:59], a[168:171], a[80:83], v[56:59]
 s_sub_u32 s22, s22, 2097024
 v_cmp_eq_u32 vcc, 0, v28
M v[52:55], a[168:171], a[72:75], v[52:55]
 s_nop 0
M v[52:55], a[172:175], a[76:79], v[52:55]
 s_cbranch_vccnz L_hs
L_hr:
 ds_read_b64_tr_b16 a[112:113], v3 offset:32768
 ds_read_b64_tr_b16 a[114:115], v3 offset:33792
M v[48:51], a[172:175], a[68:71], v[48:51]
 s_add_u32 m0, s23, 16384
 v_max_u32 v28, v16, v17
M v[48:51], a[168:171], a[64:67], v[48:51]
 buffer_load_dwordx4 v8, s[16:19], s21 offen offset:0  nt lds
M v[44:47], a[168:171], a[56:59], v[44:47]
 v_min_u32 v29, v16, v17
M v[44:47], a[172:175], a[60:63], v[44:47]
 v_med3_u32 v29, v28, v29, v18
M v[40:43], a[172:175], a[52:55], v[40:43]
 ds_read_b64_tr_b16 a[116:117], v3 offset:40960
 ds_read_b64_tr_b16 a[118:119], v3 offset:41984
M v[40:43], a[168:171], a[48:51], v[40:43]
 v_max_u32 v28, v28, v18
M v[36:39], a[168:171], a[40:43], v[36:39]
 buffer_load_dwordx4 v9, s[16:19], s21 offen offset:1024  nt lds
M v[36:39], a[172:175], a[44:47], v[36:39]
 s_waitcnt lgkmcnt(6)
 v_med3_u32 v29, v28, v29, v19
M v[32:35], a[172:175], a[36:39], v[32:35]
 v_max_u32 v28, v28, v19
M v[32:35], a[168:171], a[32:35], v[32:35]
 ds_read_b64_tr_b16 a[120:121], v4 offset:32768
 ds_read_b64_tr_b16 a[122:123], v4 offset:33792
M v[64:67], a[160:163], a[32:35], v[64:67]
 ds_read_b128 a[168:171], v5 offset:6144
 ds_read_b128 a[172:175], v6 offset:6144
M v[64:67], a[164:167], a[36:39], v[64:67]
 buffer_load_dwordx4 v10, s[16:19], s21 offen offset:2048  nt lds
M v[68:71], a[164:167], a[44:47], v[68:71]
 v_med3_u32 v29, v28, v29, v20
M v[68:71], a[160:163], a[40:43], v[68:71]
 v_max_u32 v28, v28, v20
M v[72:75], a[160:163], a[48:51], v[72:75]
 ds_read_b64_tr_b16 a[124:125], v4 offset:40960
 ds_read_b64_tr_b16 a[126:127], v4 offset:41984
M v[72:75], a[164:167], a[52:55], v[72:75]
 v_med3_u32 v29, v28, v29, v21
M v[76:79], a[164:167], a[60:63], v[76:79]
 buffer_load_dwordx4 v11, s[16:19], s21 offen offset:3072  nt lds
M v[76:79], a[160:163], a[56:59], v[76:79]
 s_add_u32 s21, s21, 524160
 v_max_u32 v28, v28, v21
M v[80:83], a[160:163], a[64:67], v[80:83]
 v_med3_u32 v29, v28, v29, v22
M v[80:83], a[164:167], a[68:71], v[80:83]
 v_max_u32 v28, v28, v22
M v[84:87], a[164:167], a[76:79], v[84:87]
 v_med3_u32 v29, v28, v29, v23
M v[84:87], a[160:163], a[72:75], v[84:87]
 v_max_u32 v28, v28, v23
M v[88:91], a[160:163], a[80:83], v[88:91]
 s_nop 0
 v_mov_b32 v30, v28 row_ror:8 row_mask:0xf bank_mask:0xf
M v[88:91], a[164:167], a[84:87], v[88:91]
 s_waitcnt lgkmcnt(2)
 v_mov_b32 v31, v29 row_ror:8 row_mask:0xf bank_mask:0xf
M v[92:95], a[164:167], a[92:95], v[92:95]
 s_waitcnt vmcnt(17) lgkmcnt(0)
 v_min_u32 v16, v28, v30
M v[92:95], a[160:163], a[88:91], v[92:95]
 s_barrier
M v[124:127], a[168:171], a[88:91], v[124:127]
 ds_read_b128 a[160:163], v5 offset:16384
 ds_read_b128 a[164:167], v6 offset:16384
M v[124:127], a[172:175], a[92:95], v[124:127]
 v_max_u32 v28, v28, v30
M v[120:123], a[172:175], a[84:87], v[120:123]
 s_add_u32 m0, s24, 0
 ds_read_b64_tr_b16 a[128:129], v1 offset:49152
 ds_read_b64_tr_b16 a[130:131], v1 offset:50176
M v[120:123], a[168:171], a[80:83], v[120:123]
 buffer_load_dwordx4 v12, s[48:51], s22 offen offset:0   lds
M v[116:119], a[168:171], a[72:75], v[116:119]
 v_max3_u32 v29, v29, v31, v16
M v[116:119], a[172:175], a[76:79], v[116:119]
 v_mov_b32 v30, v28 row_ror:4 row_mask:0xf bank_mask:0xf
M v[112:115], a[172:175], a[68:71], v[112:115]
 v_mov_b32 v31, v29 row_ror:4 row_mask:0xf bank_mask:0xf
M v[112:115], a[168:171], a[64:67], v[112:115]
 v_min_u32 v16, v28, v30
M v[108:111], a[168:171], a[56:59], v[108:111]
 v_max_u32 v28, v28, v30
M v[108:111], a[172:175], a[60:63], v[108:111]
 ds_read_b64_tr_b16 a[132:133], v1 offset:57344
 ds_read_b64_tr_b16 a[134:135], v1 offset:58368
M v[104:107], a[172:175], a[52:55], v[104:107]
 buffer_load_dwordx4 v13, s[48:51], s22 offen offset:1024   lds
M v[104:107], a[168:171], a[48:51], v[104:107]
 v_max3_u32 v29, v29, v31, v16
M v[100:103], a[168:171], a[40:43], v[100:103]
 v_mov_b32 v30, v28 row_ror:2 row_mask:0xf bank_mask:0xf
M v[100:103], a[172:175], a[44:47], v[100:103]
 s_waitcnt lgkmcnt(4)
 v_mov_b32 v31, v29 row_ror:2 row_mask:0xf bank_mask:0xf
M v[96:99], a[172:175], a[36:39], v[96:99]
 v_min_u32 v16, v28, v30
M v[96:99], a[168:171], a[32:35], v[96:99]
 buffer_load_dwordx4 v14, s[48:51], s22 offen offset:2048   lds
M v[128:131], a[160:163], a[32:35], v[128:131]
 ds_read_b128 a[168:171], v5 offset:18432
 ds_read_b128 a[172:175], v6 offset:18432
M v[128:131], a[164:167], a[36:39], v[128:131]
 ds_read_b64_tr_b16 a[136:137], v2 offset:49152
 ds_read_b64_tr_b16 a[138:139], v2 offset:50176
M v[132:135], a[164:167], a[44:47], v[132:135]
 v_max_u32 v28, v28, v30
M v[132:135], a[160:163], a[40:43], v[132:135]
 v_max3_u32 v29, v29, v31, v16
M v[136:139], a[160:163], a[48:51], v[136:139]
 v_mov_b32 v30, v28 row_ror:1 row_mask:0xf bank_mask:0xf
M v[136:139], a[164:167], a[52:55], v[136:139]
 v_mov_b32 v31, v29 row_ror:1 row_mask:0xf bank_mask:0xf
M v[140:143], a[164:167], a[60:63], v[140:143]
 buffer_load_dwordx4 v15, s[48:51], s22 offen offset:3072   lds
M v[140:143], a[160:163], a[56:59], v[140:143]
 s_add_u32 s22, s22, 2097152
 ds_read_b64_tr_b16 a[140:141], v2 offset:57344
 ds_read_b64_tr_b16 a[142:143], v2 offset:58368
M v[144:147], a[160:163], a[64:67], v[144:147]
 v_min_u32 v16, v28, v30
M v[144:147], a[164:167], a[68:71], v[144:147]
 v_max_u32 v28, v28, v30
M v[148:151], a[164:167], a[76:79], v[148:151]
 v_max3_u32 v29, v29, v31, v16
M v[148:151], a[160:163], a[72:75], v[148:151]
 s_add_u32 m0, s23, 32768
 v_mov_b32 v30, v28
M v[152:155], a[160:163], a[80:83], v[152:155]
 buffer_load_dwordx4 v8, s[16:19], s21 offen offset:0  nt lds
M v[152:155], a[164:167], a[84:87], v[152:155]
 s_waitcnt lgkmcnt(4)
 v_mov_b32 v31, v29
M v[156:159], a[164:167], a[92:95], v[156:159]
 ds_read_b64_tr_b16 a[144:145], v3 offset:49152
 ds_read_b64_tr_b16 a[146:147], v3 offset:50176
M v[156:159], a[160:163], a[88:91], v[156:159]
 v_permlane16_swap_b32 v30, v28
M v[188:191], a[168:171], a[88:91], v[188:191]
 ds_read_b128 a[160:163], v5 offset:20480
 ds_read_b128 a[164:167], v6 offset:20480
M v[188:191], a[172:175], a[92:95], v[188:191]
 v_permlane16_swap_b32 v31, v29
M v[184:187], a[172:175], a[84:87], v[184:187]
 buffer_load_dwordx4 v9, s[16:19], s21 offen offset:1024  nt lds
M v[184:187], a[168:171], a[80:83], v[184:187]
 v_min_u32 v16, v28, v30
M v[180:183], a[168:171], a[72:75], v[180:183]
 v_max_u32 v28, v28, v30
M v[180:183], a[172:175], a[76:79], v[180:183]
 ds_read_b64_tr_b16 a[148:149], v3 offset:57344
 ds_read_b64_tr_b16 a[150:151], v3 offset:58368
M v[176:179], a[172:175], a[68:71], v[176:179]
 v_max3_u32 v29, v29, v31, v16
M v[176:179], a[168:171], a[64:67], v[176:179]
 v_mov_b32 v30, v28
M v[172:175], a[168:171], a[56:59], v[172:175]
 v_mov_b32 v31, v29
M v[172:175], a[172:175], a[60:63], v[172:175]
 buffer_load_dwordx4 v10, s[16:19], s21 offen offset:2048  nt lds
M v[168:171], a[172:175], a[52:55], v[168:171]
 v_permlane32_swap_b32 v30, v28
M v[168:171], a[168:171], a[48:51], v[168:171]
 v_permlane32_swap_b32 v31, v29
M v[164:167], a[168:171], a[40:43], v[164:167]
 ds_read_b64_tr_b16 a[152:153], v4 offset:49152
 ds_read_b64_tr_b16 a[154:155], v4 offset:50176
M v[164:167], a[172:175], a[44:47], v[164:167]
 s_waitcnt lgkmcnt(4)
 v_min_u32 v16, v28, v30
M v[160:163], a[172:175], a[36:39], v[160:163]
 v_max_u32 v28, v28, v30
M v[160:163], a[168:171], a[32:35], v[160:163]
 buffer_load_dwordx4 v11, s[16:19], s21 offen offset:3072  nt lds
M v[192:195], a[160:163], a[32:35], v[192:195]
 s_add_u32 s21, s21, 128
 ds_read_b128 a[168:171], v5 offset:22528
 ds_read_b128 a[172:175], v6 offset:22528
M v[192:195], a[164:167], a[36:39], v[192:195]
 v_max3_u32 v29, v29, v31, v16
M v[196:199], a[164:167], a[44:47], v[196:199]
 s_lshl_b32 s64, s20, 3
M v[196:199], a[160:163], a[40:43], v[196:199]
 s_add_u32 s64, s64, 159744
 ds_read_b64_tr_b16 a[156:157], v4 offset:57344
 ds_read_b64_tr_b16 a[158:159], v4 offset:58368
M v[200:203], a[160:163], a[48:51], v[200:203]
 s_add_u32 m0, s87, 6144
 v_mov_b32 v16, s64
M v[200:203], a[164:167], a[52:55], v[200:203]
 buffer_load_dwordx4 v25, s[60:63], s89 offen offset:0 nt lds
M v[204:207], a[164:167], a[60:63], v[204:207]
 s_add_u32 s89, s89, 114688
 ds_write_b64 v16, v[28:29]
M v[204:207], a[160:163], a[56:59], v[204:207]
M v[208:211], a[160:163], a[64:67], v[208:211]
M v[208:211], a[164:167], a[68:71], v[208:211]
M v[212:215], a[164:167], a[76:79], v[212:215]
M v[212:215], a[160:163], a[72:75], v[212:215]
M v[216:219], a[160:163], a[80:83], v[216:219]
M v[216:219], a[164:167], a[84:87], v[216:219]
 s_waitcnt lgkmcnt(3)
M v[220:223], a[164:167], a[92:95], v[220:223]
 s_waitcnt vmcnt(18) lgkmcnt(0)
M v[220:223], a[160:163], a[88:91], v[220:223]
 s_barrier
M v[252:255], a[168:171], a[88:91], v[252:255]
 ds_read_b128 a[160:163], v5 offset:32768
 ds_read_b128 a[164:167], v6 offset:32768
M v[252:255], a[172:175], a[92:95], v[252:255]
 buffer_load_dword a240, v24, s[32:35], 0 offen offset:1536
M v[248:251], a[172:175], a[84:87], v[248:251]
M v[248:251], a[168:171], a[80:83], v[248:251]
M v[244:247], a[168:171], a[72:75], v[244:247]
M v[244:247], a[172:175], a[76:79], v[244:247]
M v[240:243], a[172:175], a[68:71], v[240:243]
M v[240:243], a[168:171], a[64:67], v[240:243]
M v[236:239], a[168:171], a[56:59], v[236:239]
M v[236:239], a[172:175], a[60:63], v[236:239]
M v[232:235], a[172:175], a[52:55], v[232:235]
M v[232:235], a[168:171], a[48:51], v[232:235]
M v[228:231], a[168:171], a[40:43], v[228:231]
M v[228:231], a[172:175], a[44:47], v[228:231]
 s_waitcnt lgkmcnt(0)
M v[224:227], a[172:175], a[36:39], v[224:227]
M v[224:227], a[168:171], a[32:35], v[224:227]
M a[0:3], a[160:163], a[96:99], a[0:3]
 ds_read_b128 a[168:171], v5 offset:34816
 ds_read_b128 a[172:175], v6 offset:34816
M a[0:3], a[164:167], a[100:103], a[0:3]
 ds_read_b64_tr_b16 a[32:33], v1 offset:0
 ds_read_b64_tr_b16 a[34:35], v1 offset:1024
M a[4:7], a[164:167], a[108:111], a[4:7]
 s_add_u32 m0, s24, 16384
M a[4:7], a[160:163], a[104:107], a[4:7]
 buffer_load_dwordx4 v12, s[48:51], s22 offen offset:0   lds
M a[8:11], a[160:163], a[112:115], a[8:11]
 v_mov_b32 v28, 159744
M a[8:11], a[164:167], a[116:119], a[8:11]
 ds_read_b128 v[16:19], v28
M a[12:15], a[164:167], a[124:127], a[12:15]
 ds_read_b64_tr_b16 a[36:37], v1 offset:8192
 ds_read_b64_tr_b16 a[38:39], v1 offset:9216
M a[12:15], a[160:163], a[120:123], a[12:15]
 ds_read_b128 v[20:23], v28 offset:16
M a[16:19], a[160:163], a[128:131], a[16:19]
 buffer_load_dwordx4 v13, s[48:51], s22 offen offset:1024   lds
M a[16:19], a[164:167], a[132:135], a[16:19]
M a[20:23], a[164:167], a[140:143], a[20:23]
M a[20:23], a[160:163], a[136:139], a[20:23]
 ds_read_b64_tr_b16 a[40:41], v2 offset:0
 ds_read_b64_tr_b16 a[42:43], v2 offset:1024
M a[24:27], a[160:163], a[144:147], a[24:27]
M a[24:27], a[164:167], a[148:151], a[24:27]
 s_waitcnt lgkmcnt(8)
M a[28:31], a[164:167], a[156:159], a[28:31]
 buffer_load_dwordx4 v14, s[48:51], s22 offen offset:2048   lds
M a[28:31], a[160:163], a[152:155], a[28:31]
M v[60:63], a[168:171], a[152:155], v[60:63]
 ds_read_b128 a[160:163], v5 offset:36864
 ds_read_b128 a[164:167], v6 offset:36864
M v[60:63], a[172:175], a[156:159], v[60:63]
 ds_read_b64_tr_b16 a[44:45], v2 offset:8192
 ds_read_b64_tr_b16 a[46:47], v2 offset:9216
M v[56:59], a[172:175], a[148:151], v[56:59]
 buffer_load_dwordx4 v15, s[48:51], s22 offen offset:3072   lds
M v[56:59], a[168:171], a[144:147], v[56:59]
 s_sub_u32 s22, s22, 2097024
 s_waitcnt lgkmcnt(9)
 v_min_u32 v28, v16, v18
M v[52:55], a[168:171], a[136:139], v[52:55]
 v_max_u32 v16, v16, v18
M v[52:55], a[172:175], a[140:143], v[52:55]
 ds_read_b64_tr_b16 a[48:49], v3 offset:0
 ds_read_b64_tr_b16 a[50:51], v3 offset:1024
M v[48:51], a[172:175], a[132:135], v[48:51]
 s_add_u32 m0, s23, 49152
 v_max3_u32 v17, v17, v19, v28
M v[48:51], a[168:171], a[128:131], v[48:51]
 buffer_load_dwordx4 v8, s[16:19], s21 offen offset:0  nt lds
M v[44:47], a[168:171], a[120:123], v[44:47]
 s_waitcnt lgkmcnt(8)
 v_min_u32 v29, v20, v22
M v[44:47], a[172:175], a[124:127], v[44:47]
 v_max_u32 v20, v20, v22
M v[40:43], a[172:175], a[116:119], v[40:43]
 ds_read_b64_tr_b16 a[52:53], v3 offset:8192
 ds_read_b64_tr_b16 a[54:55], v3 offset:9216
M v[40:43], a[168:171], a[112:115], v[40:43]
 v_max3_u32 v21, v21, v23, v29
M v[36:39], a[168:171], a[104:107], v[36:39]
 buffer_load_dwordx4 v9, s[16:19], s21 offen offset:1024  nt lds
M v[36:39], a[172:175], a[108:111], v[36:39]
 s_waitcnt lgkmcnt(6)
 v_min_u32 v28, v16, v20
M v[32:35], a[172:175], a[100:103], v[32:35]
 v_max_u32 v16, v16, v20
M v[32:35], a[168:171], a[96:99], v[32:35]
 ds_read_b64_tr_b16 a[56:57], v4 offset:0
 ds_read_b64_tr_b16 a[58:59], v4 offset:1024
M v[64:67], a[160:163], a[96:99], v[64:67]
 ds_read_b128 a[168:171], v5 offset:38912
 ds_read_b128 a[172:175], v6 offset:38912
M v[64:67], a[164:167], a[100:103], v[64:67]
 buffer_load_dwordx4 v10, s[16:19], s21 offen offset:2048  nt lds
M v[68:71], a[164:167], a[108:111], v[68:71]
 v_max3_u32 v17, v17, v21, v28
M v[68:71], a[160:163], a[104:107], v[68:71]
 v_and_b32 v28, 1, v0
M v[72:75], a[160:163], a[112:115], v[72:75]
 ds_read_b64_tr_b16 a[60:61], v4 offset:8192
 ds_read_b64_tr_b16 a[62:63], v4 offset:9216
M v[72:75], a[164:167], a[116:119], v[72:75]
 v_cmp_eq_u32 vcc, 0, v28
M v[76:79], a[164:167], a[124:127], v[76:79]
 buffer_load_dwordx4 v11, s[16:19], s21 offen offset:3072  nt lds
M v[76:79], a[160:163], a[120:123], v[76:79]
 s_add_u32 s21, s21, 524160
 s_and_b32 s64, s20, 1
M v[80:83], a[160:163], a[128:131], v[80:83]
 s_mul_i32 s64, s64, 448
 v_cndmask_b32 v24, v17, v16, vcc
M v[80:83], a[164:167], a[132:135], v[80:83]
 v_and_b32 v24, 0x7ff, v24
M v[84:87], a[164:167], a[140:143], v[84:87]
 v_sub_u32 v24, 2047, v24
M v[84:87], a[160:163], a[136:139], v[84:87]
 v_mul_u32_u24 v28, 896, v24
M v[88:91], a[160:163], a[144:147], v[88:91]
 v_lshrrev_b32 v29, 4, v0
M v[88:91], a[164:167], a[148:151], v[88:91]
 s_waitcnt lgkmcnt(2)
 v_lshl_add_u32 v28, v29, 4, v28
M v[92:95], a[164:167], a[156:159], v[92:95]
 s_waitcnt vmcnt(18) lgkmcnt(0)
 v_bfe_u32 v30, v0, 1, 3
M v[92:95], a[160:163], a[152:155], v[92:95]
 s_barrier
M v[124:127], a[168:171], a[152:155], v[124:127]
 ds_read_b128 a[160:163], v5 offset:49152
 ds_read_b128 a[164:167], v6 offset:49152
M v[124:127], a[172:175], a[156:159], v[124:127]
 v_lshl_or_b32 v28, v30, 26, v28
M v[120:123], a[172:175], a[148:151], v[120:123]
 s_add_u32 m0, s24, 32768
 ds_read_b64_tr_b16 a[64:65], v1 offset:16384
 ds_read_b64_tr_b16 a[66:67], v1 offset:17408
M v[120:123], a[168:171], a[144:147], v[120:123]
 buffer_load_dwordx4 v12, s[48:51], s22 offen offset:0   lds
M v[116:119], a[168:171], a[136:139], v[116:119]
M v[116:119], a[172:175], a[140:143], v[116:119]
M v[112:115], a[172:175], a[132:135], v[112:115]
 buffer_load_dwordx4 a[208:211], v28, s[56:59], s64 offen offset:0
M v[112:115], a[168:171], a[128:131], v[112:115]
M v[108:111], a[168:171], a[120:123], v[108:111]
 buffer_load_dwordx4 a[212:215], v28, s[56:59], s64 offen offset:64
M v[108:111], a[172:175], a[124:127], v[108:111]
 ds_read_b64_tr_b16 a[68:69], v1 offset:24576
 ds_read_b64_tr_b16 a[70:71], v1 offset:25600
M v[104:107], a[172:175], a[116:119], v[104:107]
 buffer_load_dwordx4 v13, s[48:51], s22 offen offset:1024   lds
M v[104:107], a[168:171], a[112:115], v[104:107]
M v[100:103], a[168:171], a[104:107], v[100:103]
M v[100:103], a[172:175], a[108:111], v[100:103]
 s_waitcnt lgkmcnt(4)
M v[96:99], a[172:175], a[100:103], v[96:99]
 buffer_load_dwordx4 a[216:219], v28, s[56:59], s64 offen offset:128
M v[96:99], a[168:171], a[96:99], v[96:99]
M v[128:131], a[160:163], a[96:99], v[128:131]
 ds_read_b128 a[168:171], v5 offset:51200
 ds_read_b128 a[172:175], v6 offset:51200
M v[128:131], a[164:167], a[100:103], v[128:131]
 ds_read_b64_tr_b16 a[72:73], v2 offset:16384
 ds_read_b64_tr_b16 a[74:75], v2 offset:17408
M v[132:135], a[164:167], a[108:111], v[132:135]
 buffer_load_dwordx4 v14, s[48:51], s22 offen offset:2048   lds
M v[132:135], a[160:163], a[104:107], v[132:135]
M v[136:139], a[160:163], a[112:115], v[136:139]
 buffer_load_dwordx4 a[220:223], v28, s[56:59], s64 offen offset:192
M v[136:139], a[164:167], a[116:119], v[136:139]
M v[140:143], a[164:167], a[124:127], v[140:143]
 buffer_load_dwordx4 a[224:227], v28, s[56:59], s64 offen offset:256
M v[140:143], a[160:163], a[120:123], v[140:143]
 ds_read_b64_tr_b16 a[76:77], v2 offset:24576
 ds_read_b64_tr_b16 a[78:79], v2 offset:25600
M v[144:147], a[160:163], a[128:131], v[144:147]
 buffer_load_dwordx4 v15, s[48:51], s22 offen offset:3072   lds
M v[144:147], a[164:167], a[132:135], v[144:147]
 s_add_u32 s22, s22, 2097152
M v[148:151], a[164:167], a[140:143], v[148:151]
M v[148:151], a[160:163], a[136:139], v[148:151]
 buffer_load_dwordx4 a[228:231], v28, s[56:59], s64 offen offset:320
M v[152:155], a[160:163], a[144:147], v[152:155]
M v[152:155], a[164:167], a[148:151], v[152:155]
 s_waitcnt lgkmcnt(4)
M v[156:159], a[164:167], a[156:159], v[156:159]
 s_add_u32 m0, s23, 0
 ds_read_b64_tr_b16 a[80:81], v3 offset:16384
 ds_read_b64_tr_b16 a[82:83], v3 offset:17408
M v[156:159], a[160:163], a[152:155], v[156:159]
 buffer_load_dwordx4 v8, s[16:19], s21 offen offset:0  nt lds
M v[188:191], a[168:171], a[152:155], v[188:191]
 ds_read_b128 a[160:163], v5 offset:53248
 ds_read_b128 a[164:167], v6 offset:53248
M v[188:191], a[172:175], a[156:159], v[188:191]
 buffer_load_dwordx4 a[232:235], v28, s[56:59], s64 offen offset:384
M v[184:187], a[172:175], a[148:151], v[184:187]
 v_lshrrev_b32 v28, 4, v24
M v[184:187], a[168:171], a[144:147], v[184:187]
 v_lshlrev_b32 v28, 5, v28
M v[180:183], a[168:171], a[136:139], v[180:183]
 v_and_b32 v30, 15, v24
M v[180:183], a[172:175], a[140:143], v[180:183]
 ds_read_b64_tr_b16 a[84:85], v3 offset:24576
 ds_read_b64_tr_b16 a[86:87], v3 offset:25600
M v[176:179], a[172:175], a[132:135], v[176:179]
 buffer_load_dwordx4 v9, s[16:19], s21 offen offset:1024  nt lds
M v[176:179], a[168:171], a[128:131], v[176:179]
 v_add_lshl_u32 v28, v28, v30, 2
M v[172:175], a[168:171], a[120:123], v[172:175]
 v_lshrrev_b32 v30, 1, v0
M v[172:175], a[172:175], a[124:127], v[172:175]
 v_min_u32 v30, 1, v30
M v[168:171], a[172:175], a[116:119], v[168:171]
 v_lshl_or_b32 v28, v30, 29, v28
M v[168:171], a[168:171], a[112:115], v[168:171]
 s_mov_b32 s64, 104857600
M v[164:167], a[168:171], a[104:107], v[164:167]
 ds_read_b64_tr_b16 a[88:89], v4 offset:16384
 ds_read_b64_tr_b16 a[90:91], v4 offset:17408
M v[164:167], a[172:175], a[108:111], v[164:167]
 s_waitcnt lgkmcnt(4)
M v[160:163], a[172:175], a[100:103], v[160:163]
 buffer_load_dwordx4 v10, s[16:19], s21 offen offset:2048  nt lds
M v[160:163], a[168:171], a[96:99], v[160:163]
 buffer_load_dword v23, v28, s[8:11], s64 offen sc1
M v[192:195], a[160:163], a[96:99], v[192:195]
 ds_read_b128 a[168:171], v5 offset:55296
 ds_read_b128 a[172:175], v6 offset:55296
M v[192:195], a[164:167], a[100:103], v[192:195]
 v_bfe_u32 v28, v0, 2, 2
M v[196:199], a[164:167], a[108:111], v[196:199]
 v_lshl_add_u32 v28, v29, 3, v28
M v[196:199], a[160:163], a[104:107], v[196:199]
 ds_read_b64_tr_b16 a[92:93], v4 offset:24576
 ds_read_b64_tr_b16 a[94:95], v4 offset:25600
M v[200:203], a[160:163], a[112:115], v[200:203]
 buffer_load_dwordx4 v11, s[16:19], s21 offen offset:3072  nt lds
M v[200:203], a[164:167], a[116:119], v[200:203]
 s_add_u32 s21, s21, 128
 v_lshlrev_b32 v28, 5, v28
M v[204:207], a[164:167], a[124:127], v[204:207]
 v_and_b32 v30, 3, v0
M v[204:207], a[160:163], a[120:123], v[204:207]
 v_lshl_add_u32 v28, v30, 3, v28
M v[208:211], a[160:163], a[128:131], v[208:211]
 v_add_u32 v22, s87, v28
M v[208:211], a[164:167], a[132:135], v[208:211]
M v[212:215], a[164:167], a[140:143], v[212:215]
M v[212:215], a[160:163], a[136:139], v[212:215]
M v[216:219], a[160:163], a[144:147], v[216:219]
M v[216:219], a[164:167], a[148:151], v[216:219]
 s_waitcnt lgkmcnt(2)
M v[220:223], a[164:167], a[156:159], v[220:223]
 s_waitcnt vmcnt(26) lgkmcnt(0)
M v[220:223], a[160:163], a[152:155], v[220:223]
 s_barrier
M v[252:255], a[168:171], a[152:155], v[252:255]
 ds_read_b128 a[160:163], v5 offset:0
 ds_read_b128 a[164:167], v6 offset:0
M v[252:255], a[172:175], a[156:159], v[252:255]
M v[248:251], a[172:175], a[148:151], v[248:251]
M v[248:251], a[168:171], a[144:147], v[248:251]
M v[244:247], a[168:171], a[136:139], v[244:247]
M v[244:247], a[172:175], a[140:143], v[244:247]
M v[240:243], a[172:175], a[132:135], v[240:243]
M v[240:243], a[168:171], a[128:131], v[240:243]
M v[236:239], a[168:171], a[120:123], v[236:239]
M v[236:239], a[172:175], a[124:127], v[236:239]
M v[232:235], a[172:175], a[116:119], v[232:235]
M v[232:235], a[168:171], a[112:115], v[232:235]
M v[228:231], a[168:171], a[104:107], v[228:231]
M v[228:231], a[172:175], a[108:111], v[228:231]
 s_waitcnt lgkmcnt(0)
M v[224:227], a[172:175], a[100:103], v[224:227]
M v[224:227], a[168:171], a[96:99], v[224:227]
M a[0:3], a[160:163], a[32:35], a[0:3]
 ds_read_b128 a[168:171], v5 offset:2048
 ds_read_b128 a[172:175], v6 offset:2048
M a[0:3], a[164:167], a[36:39], a[0:3]
 ds_read_b64_tr_b16 a[96:97], v1 offset:32768
 ds_read_b64_tr_b16 a[98:99], v1 offset:33792
M a[4:7], a[164:167], a[44:47], a[4:7]
 s_add_u32 m0, s24, 49152
M a[4:7], a[160:163], a[40:43], a[4:7]
 buffer_load_dwordx4 v12, s[48:51], s22 offen offset:0   lds
M a[8:11], a[160:163], a[48:51], a[8:11]
M a[8:11], a[164:167], a[52:55], a[8:11]
M a[12:15], a[164:167], a[60:63], a[12:15]
 ds_read_b64_tr_b16 a[100:101], v1 offset:40960
 ds_read_b64_tr_b16 a[102:103], v1 offset:41984
M a[12:15], a[160:163], a[56:59], a[12:15]
M a[16:19], a[160:163], a[64:67], a[16:19]
 buffer_load_dwordx4 v13, s[48:51], s22 offen offset:1024   lds
M a[16:19], a[164:167], a[68:71], a[16:19]
M a[20:23], a[164:167], a[76:79], a[20:23]
M a[20:23], a[160:163], a[72:75], a[20:23]
 ds_read_b64_tr_b16 a[104:105], v2 offset:32768
 ds_read_b64_tr_b16 a[106:107], v2 offset:33792
M a[24:27], a[160:163], a[80:83], a[24:27]
M a[24:27], a[164:167], a[84:87], a[24:27]
 s_waitcnt lgkmcnt(6)
M a[28:31], a[164:167], a[92:95], a[28:31]
 buffer_load_dwordx4 v14, s[48:51], s22 offen offset:2048   lds
M a[28:31], a[160:163], a[88:91], a[28:31]
M v[60:63], a[168:171], a[88:91], v[60:63]
 ds_read_b128 a[160:163], v5 offset:4096
 ds_read_b128 a[164:167], v6 offset:4096
M v[60:63], a[172:175], a[92:95], v[60:63]
 ds_read_b64_tr_b16 a[108:109], v2 offset:40960
 ds_read_b64_tr_b16 a[110:111], v2 offset:41984
M v[56:59], a[172:175], a[84:87], v[56:59]
 buffer_load_dwordx4 v15, s[48:51], s22 offen offset:3072   lds
M v[56:59], a[168:171], a[80:83], v[56:59]
 s_sub_u32 s22, s22, 2097024
M v[52:55], a[168:171], a[72:75], v[52:55]
M v[52:55], a[172:175], a[76:79], v[52:55]
 ds_read_b64_tr_b16 a[112:113], v3 offset:32768
 ds_read_b64_tr_b16 a[114:115], v3 offset:33792
M v[48:51], a[172:175], a[68:71], v[48:51]
 s_add_u32 m0, s23, 16384
M v[48:51], a[168:171], a[64:67], v[48:51]
 buffer_load_dwordx4 v8, s[16:19], s21 offen offset:0  nt lds
M v[44:47], a[168:171], a[56:59], v[44:47]
M v[44:47], a[172:175], a[60:63], v[44:47]
M v[40:43], a[172:175], a[52:55], v[40:43]
 ds_read_b64_tr_b16 a[116:117], v3 offset:40960
 ds_read_b64_tr_b16 a[118:119], v3 offset:41984
M v[40:43], a[168:171], a[48:51], v[40:43]
M v[36:39], a[168:171], a[40:43], v[36:39]
 buffer_load_dwordx4 v9, s[16:19], s21 offen offset:1024  nt lds
M v[36:39], a[172:175], a[44:47], v[36:39]
 s_waitcnt lgkmcnt(6)
M v[32:35], a[172:175], a[36:39], v[32:35]
M v[32:35], a[168:171], a[32:35], v[32:35]
 ds_read_b64_tr_b16 a[120:121], v4 offset:32768
 ds_read_b64_tr_b16 a[122:123], v4 offset:33792
M v[64:67], a[160:163], a[32:35], v[64:67]
 ds_read_b128 a[168:171], v5 offset:6144
 ds_read_b128 a[172:175], v6 offset:6144
M v[64:67], a[164:167], a[36:39], v[64:67]
 buffer_load_dwordx4 v10, s[16:19], s21 offen offset:2048  nt lds
M v[68:71], a[164:167], a[44:47], v[68:71]
M v[68:71], a[160:163], a[40:43], v[68:71]
M v[72:75], a[160:163], a[48:51], v[72:75]
 ds_read_b64_tr_b16 a[124:125], v4 offset:40960
 ds_read_b64_tr_b16 a[126:127], v4 offset:41984
M v[72:75], a[164:167], a[52:55], v[72:75]
M v[76:79], a[164:167], a[60:63], v[76:79]
 buffer_load_dwordx4 v11, s[16:19], s21 offen offset:3072  nt lds
M v[76:79], a[160:163], a[56:59], v[76:79]
 s_add_u32 s21, s21, 524160
M v[80:83], a[160:163], a[64:67], v[80:83]
M v[80:83], a[164:167], a[68:71], v[80:83]
M v[84:87], a[164:167], a[76:79], v[84:87]
M v[84:87], a[160:163], a[72:75], v[84:87]
M v[88:91], a[160:163], a[80:83], v[88:91]
M v[88:91], a[164:167], a[84:87], v[88:91]
 s_waitcnt lgkmcnt(2)
M v[92:95], a[164:167], a[92:95], v[92:95]
 s_waitcnt vmcnt(24) lgkmcnt(0)
M v[92:95], a[160:163], a[88:91], v[92:95]
 s_barrier
M v[124:127], a[168:171], a[88:91], v[124:127]
 ds_read_b128 a[160:163], v5 offset:16384
 ds_read_b128 a[164:167], v6 offset:16384
M v[124:127], a[172:175], a[92:95], v[124:127]
M v[120:123], a[172:175], a[84:87], v[120:123]
 s_add_u32 m0, s24, 0
 ds_read_b64_tr_b16 a[128:129], v1 offset:49152
 ds_read_b64_tr_b16 a[130:131], v1 offset:50176
M v[120:123], a[168:171], a[80:83], v[120:123]
 buffer_load_dwordx4 v12, s[48:51], s22 offen offset:0   lds
M v[116:119], a[168:171], a[72:75], v[116:119]
 ds_read_b64_tr_b16 a[176:177], v22 offset:0
M v[116:119], a[172:175], a[76:79], v[116:119]
 ds_read_b64_tr_b16 a[178:179], v22 offset:128
 ds_read_b64_tr_b16 a[180:181], v22 offset:1024
M v[112:115], a[172:175], a[68:71], v[112:115]
 ds_read_b64_tr_b16 a[182:183], v22 offset:1152
M v[112:115], a[168:171], a[64:67], v[112:115]
 ds_read_b64_tr_b16 a[184:185], v22 offset:2048
 ds_read_b64_tr_b16 a[186:187], v22 offset:2176
M v[108:111], a[168:171], a[56:59], v[108:111]
 ds_read_b64_tr_b16 a[188:189], v22 offset:3072
M v[108:111], a[172:175], a[60:63], v[108:111]
 ds_read_b64_tr_b16 a[132:133], v1 offset:57344
 ds_read_b64_tr_b16 a[134:135], v1 offset:58368
M v[104:107], a[172:175], a[52:55], v[104:107]
 buffer_load_dwordx4 v13, s[48:51], s22 offen offset:1024   lds
M v[104:107], a[168:171], a[48:51], v[104:107]
 ds_read_b64_tr_b16 a[190:191], v22 offset:3200
M v[100:103], a[168:171], a[40:43], v[100:103]
M v[100:103], a[172:175], a[44:47], v[100:103]
 s_waitcnt lgkmcnt(12)
M v[96:99], a[172:175], a[36:39], v[96:99]
M v[96:99], a[168:171], a[32:35], v[96:99]
M v[128:131], a[160:163], a[32:35], v[128:131]
 ds_read_b128 a[168:171], v5 offset:18432
 ds_read_b128 a[172:175], v6 offset:18432
M v[128:131], a[164:167], a[36:39], v[128:131]
 ds_read_b64_tr_b16 a[136:137], v2 offset:49152
 ds_read_b64_tr_b16 a[138:139], v2 offset:50176
M v[132:135], a[164:167], a[44:47], v[132:135]
 buffer_load_dwordx4 v14, s[48:51], s22 offen offset:2048   lds
M v[132:135], a[160:163], a[40:43], v[132:135]
M v[136:139], a[160:163], a[48:51], v[136:139]
M v[136:139], a[164:167], a[52:55], v[136:139]
M v[140:143], a[164:167], a[60:63], v[140:143]
M v[140:143], a[160:163], a[56:59], v[140:143]
 ds_read_b64_tr_b16 a[140:141], v2 offset:57344
 ds_read_b64_tr_b16 a[142:143], v2 offset:58368
M v[144:147], a[160:163], a[64:67], v[144:147]
 buffer_load_dwordx4 v15, s[48:51], s22 offen offset:3072   lds
M v[144:147], a[164:167], a[68:71], v[144:147]
 s_add_u32 s22, s22, 2097152
M v[148:151], a[164:167], a[76:79], v[148:151]
M v[148:151], a[160:163], a[72:75], v[148:151]
M v[152:155], a[160:163], a[80:83], v[152:155]
M v[152:155], a[164:167], a[84:87], v[152:155]
 s_waitcnt lgkmcnt(4)
M v[156:159], a[164:167], a[92:95], v[156:159]
 s_add_u32 m0, s23, 32768
 ds_read_b64_tr_b16 a[144:145], v3 offset:49152
 ds_read_b64_tr_b16 a[146:147], v3 offset:50176
M v[156:159], a[160:163], a[88:91], v[156:159]
 buffer_load_dwordx4 v8, s[16:19], s21 offen offset:0  nt lds
 s_waitcnt vmcnt(27)
M v[16:19], a[176:179], a[208:211], 0
 s_waitcnt vmcnt(26)
M v[16:19], a[180:183], a[212:215], v[16:19]
 s_waitcnt vmcnt(24)
M v[16:19], a[184:187], a[216:219], v[16:19]
 s_waitcnt vmcnt(22)
M v[16:19], a[188:191], a[220:223], v[16:19]
M v[188:191], a[168:171], a[88:91], v[188:191]
 ds_read_b128 a[160:163], v5 offset:20480
 ds_read_b128 a[164:167], v6 offset:20480
M v[188:191], a[172:175], a[92:95], v[188:191]
 ds_read_b64_tr_b16 a[176:177], v22 offset:4096
M v[184:187], a[172:175], a[84:87], v[184:187]
 ds_read_b64_tr_b16 a[178:179], v22 offset:4224
 ds_read_b64_tr_b16 a[180:181], v22 offset:5120
M v[184:187], a[168:171], a[80:83], v[184:187]
 ds_read_b64_tr_b16 a[182:183], v22 offset:5248
M v[180:183], a[168:171], a[72:75], v[180:183]
 ds_read_b64_tr_b16 a[184:185], v22 offset:6144
M v[180:183], a[172:175], a[76:79], v[180:183]
 ds_read_b64_tr_b16 a[148:149], v3 offset:57344
 ds_read_b64_tr_b16 a[150:151], v3 offset:58368
M v[176:179], a[172:175], a[68:71], v[176:179]
 buffer_load_dwordx4 v9, s[16:19], s21 offen offset:1024  nt lds
M v[176:179], a[168:171], a[64:67], v[176:179]
 ds_read_b64_tr_b16 a[186:187], v22 offset:6272
M v[172:175], a[168:171], a[56:59], v[172:175]
M v[172:175], a[172:175], a[60:63], v[172:175]
M v[168:171], a[172:175], a[52:55], v[168:171]
M v[168:171], a[168:171], a[48:51], v[168:171]
M v[164:167], a[168:171], a[40:43], v[164:167]
 ds_read_b64_tr_b16 a[152:153], v4 offset:49152
 ds_read_b64_tr_b16 a[154:155], v4 offset:50176
M v[164:167], a[172:175], a[44:47], v[164:167]
 s_waitcnt lgkmcnt(10)
M v[160:163], a[172:175], a[36:39], v[160:163]
 buffer_load_dwordx4 v10, s[16:19], s21 offen offset:2048  nt lds
M v[160:163], a[168:171], a[32:35], v[160:163]
M v[192:195], a[160:163], a[32:35], v[192:195]
 ds_read_b128 a[168:171], v5 offset:22528
 ds_read_b128 a[172:175], v6 offset:22528
M v[192:195], a[164:167], a[36:39], v[192:195]
M v[196:199], a[164:167], a[44:47], v[196:199]
M v[196:199], a[160:163], a[40:43], v[196:199]
 ds_read_b64_tr_b16 a[156:157], v4 offset:57344
 ds_read_b64_tr_b16 a[158:159], v4 offset:58368
M v[200:203], a[160:163], a[48:51], v[200:203]
 buffer_load_dwordx4 v11, s[16:19], s21 offen offset:3072  nt lds
M v[200:203], a[164:167], a[52:55], v[200:203]
 s_add_u32 s21, s21, 128
M v[204:207], a[164:167], a[60:63], v[204:207]
M v[204:207], a[160:163], a[56:59], v[204:207]
M v[208:211], a[160:163], a[64:67], v[208:211]
M v[208:211], a[164:167], a[68:71], v[208:211]
M v[212:215], a[164:167], a[76:79], v[212:215]
M v[212:215], a[160:163], a[72:75], v[212:215]
M v[216:219], a[160:163], a[80:83], v[216:219]
M v[216:219], a[164:167], a[84:87], v[216:219]
 s_waitcnt lgkmcnt(2)
M v[220:223], a[164:167], a[92:95], v[220:223]
 s_waitcnt vmcnt(16) lgkmcnt(0)
M v[220:223], a[160:163], a[88:91], v[220:223]
 s_barrier
M v[16:19], a[176:179], a[224:227], v[16:19]
M v[16:19], a[180:183], a[228:231], v[16:19]
M v[16:19], a[184:187], a[232:235], v[16:19]
M v[252:255], a[168:171], a[88:91], v[252:255]
 ds_read_b128 a[160:163], v5 offset:32768
 ds_read_b128 a[164:167], v6 offset:32768
M v[252:255], a[172:175], a[92:95], v[252:255]
M v[248:251], a[172:175], a[84:87], v[248:251]
M v[248:251], a[168:171], a[80:83], v[248:251]
M v[244:247], a[168:171], a[72:75], v[244:247]
M v[244:247], a[172:175], a[76:79], v[244:247]
M v[240:243], a[172:175], a[68:71], v[240:243]
M v[240:243], a[168:171], a[64:67], v[240:243]
M v[236:239], a[168:171], a[56:59], v[236:239]
M v[236:239], a[172:175], a[60:63], v[236:239]
M v[232:235], a[172:175], a[52:55], v[232:235]
M v[232:235], a[168:171], a[48:51], v[232:235]
M v[228:231], a[168:171], a[40:43], v[228:231]
M v[228:231], a[172:175], a[44:47], v[228:231]
 s_waitcnt lgkmcnt(0)
M v[224:227], a[172:175], a[36:39], v[224:227]
M v[224:227], a[168:171], a[32:35], v[224:227]
M a[0:3], a[160:163], a[96:99], a[0:3]
 ds_read_b128 a[168:171], v5 offset:34816
 ds_read_b128 a[172:175], v6 offset:34816
M a[0:3], a[164:167], a[100:103], a[0:3]
 ds_read_b64_tr_b16 a[32:33], v1 offset:0
 ds_read_b64_tr_b16 a[34:35], v1 offset:1024
M a[4:7], a[164:167], a[108:111], a[4:7]
 s_add_u32 m0, s24, 16384
M a[4:7], a[160:163], a[104:107], a[4:7]
 buffer_load_dwordx4 v12, s[48:51], s22 offen offset:0   lds
M a[8:11], a[160:163], a[112:115], a[8:11]
M a[8:11], a[164:167], a[116:119], a[8:11]
 s_lshl_b32 s64, s20, 10
M a[12:15], a[164:167], a[124:127], a[12:15]
 s_add_u32 s64, s64, 159744
 ds_read_b64_tr_b16 a[36:37], v1 offset:8192
 ds_read_b64_tr_b16 a[38:39], v1 offset:9216
M a[12:15], a[160:163], a[120:123], a[12:15]
 v_add_u32 v21, s64, v7
 ds_write_b128 v21, v[16:19]
M a[16:19], a[160:163], a[128:131], a[16:19]
 buffer_load_dwordx4 v13, s[48:51], s22 offen offset:1024   lds
M a[16:19], a[164:167], a[132:135], a[16:19]
 s_mul_i32 s67, s86, 14336
M a[20:23], a[164:167], a[140:143], a[20:23]
 s_mul_i32 s64, s20, 224
M a[20:23], a[160:163], a[136:139], a[20:23]
 s_add_u32 s67, s67, s64
 ds_read_b64_tr_b16 a[40:41], v2 offset:0
 ds_read_b64_tr_b16 a[42:43], v2 offset:1024
M a[24:27], a[160:163], a[144:147], a[24:27]
 v_lshrrev_b32 v28, 4, v0
 v_mul_u32_u24 v28, 896, v28
M a[24:27], a[164:167], a[148:151], a[24:27]
 s_waitcnt lgkmcnt(7)
 v_and_b32 v29, 15, v0
 v_lshl_add_u32 v28, v29, 4, v28
M a[28:31], a[164:167], a[156:159], a[28:31]
 buffer_load_dwordx4 v14, s[48:51], s22 offen offset:2048   lds
M a[28:31], a[160:163], a[152:155], a[28:31]
 v_mov_b32 v30, 536870912
 v_cmp_gt_u32 vcc, 14, v29
M v[60:63], a[168:171], a[152:155], v[60:63]
 s_nop 0
 ds_read_b128 a[160:163], v5 offset:36864
 ds_read_b128 a[164:167], v6 offset:36864
M v[60:63], a[172:175], a[156:159], v[60:63]
 s_nop 0
 ds_read_b64_tr_b16 a[44:45], v2 offset:8192
 ds_read_b64_tr_b16 a[46:47], v2 offset:9216
M v[56:59], a[172:175], a[148:151], v[56:59]
 buffer_load_dwordx4 v15, s[48:51], s22 offen offset:3072   lds
M v[56:59], a[168:171], a[144:147], v[56:59]
 s_sub_u32 s22, s22, 2097024
 v_cndmask_b32 v28, v30, v28, vcc
 v_add_u32 v29, 2560, v28
M v[52:55], a[168:171], a[136:139], v[52:55]
 v_add_u32 v30, 5120, v28
 v_add_u32 v31, 7680, v28
M v[52:55], a[172:175], a[140:143], v[52:55]
 ds_read_b64_tr_b16 a[48:49], v3 offset:0
 ds_read_b64_tr_b16 a[50:51], v3 offset:1024
M v[48:51], a[172:175], a[132:135], v[48:51]
 s_add_u32 m0, s23, 49152
M v[48:51], a[168:171], a[128:131], v[48:51]
 buffer_load_dwordx4 v8, s[16:19], s21 offen offset:0  nt lds
M v[44:47], a[168:171], a[120:123], v[44:47]
M v[44:47], a[172:175], a[124:127], v[44:47]
M v[40:43], a[172:175], a[116:119], v[40:43]
 ds_read_b64_tr_b16 a[52:53], v3 offset:8192
 ds_read_b64_tr_b16 a[54:55], v3 offset:9216
M v[40:43], a[168:171], a[112:115], v[40:43]
M v[36:39], a[168:171], a[104:107], v[36:39]
 buffer_load_dwordx4 v9, s[16:19], s21 offen offset:1024  nt lds
M v[36:39], a[172:175], a[108:111], v[36:39]
 s_waitcnt lgkmcnt(6)
M v[32:35], a[172:175], a[100:103], v[32:35]
M v[32:35], a[168:171], a[96:99], v[32:35]
 ds_read_b64_tr_b16 a[56:57], v4 offset:0
 ds_read_b64_tr_b16 a[58:59], v4 offset:1024
M v[64:67], a[160:163], a[96:99], v[64:67]
 ds_read_b128 a[168:171], v5 offset:38912
 ds_read_b128 a[172:175], v6 offset:38912
M v[64:67], a[164:167], a[100:103], v[64:67]
 buffer_load_dwordx4 v10, s[16:19], s21 offen offset:2048  nt lds
M v[68:71], a[164:167], a[108:111], v[68:71]
M v[68:71], a[160:163], a[104:107], v[68:71]
M v[72:75], a[160:163], a[112:115], v[72:75]
 ds_read_b64_tr_b16 a[60:61], v4 offset:8192
 ds_read_b64_tr_b16 a[62:63], v4 offset:9216
M v[72:75], a[164:167], a[116:119], v[72:75]
M v[76:79], a[164:167], a[124:127], v[76:79]
 buffer_load_dwordx4 v11, s[16:19], s21 offen offset:3072  nt lds
M v[76:79], a[160:163], a[120:123], v[76:79]
 s_add_u32 s21, s21, 524160
M v[80:83], a[160:163], a[128:131], v[80:83]
M v[80:83], a[164:167], a[132:135], v[80:83]
M v[84:87], a[164:167], a[140:143], v[84:87]
M v[84:87], a[160:163], a[136:139], v[84:87]
M v[88:91], a[160:163], a[144:147], v[88:91]
M v[88:91], a[164:167], a[148:151], v[88:91]
 s_waitcnt lgkmcnt(2)
M v[92:95], a[164:167], a[156:159], v[92:95]
 s_waitcnt vmcnt(16) lgkmcnt(0)
M v[92:95], a[160:163], a[152:155], v[92:95]
 s_barrier
M v[124:127], a[168:171], a[152:155], v[124:127]
 ds_read_b128 a[160:163], v5 offset:49152
 ds_read_b128 a[164:167], v6 offset:49152
M v[124:127], a[172:175], a[156:159], v[124:127]
M v[120:123], a[172:175], a[148:151], v[120:123]
 s_add_u32 m0, s24, 32768
 ds_read_b64_tr_b16 a[64:65], v1 offset:16384
 ds_read_b64_tr_b16 a[66:67], v1 offset:17408
M v[120:123], a[168:171], a[144:147], v[120:123]
 buffer_load_dwordx4 v12, s[48:51], s22 offen offset:0   lds
M v[116:119], a[168:171], a[136:139], v[116:119]
M v[116:119], a[172:175], a[140:143], v[116:119]
M v[112:115], a[172:175], a[132:135], v[112:115]
M v[112:115], a[168:171], a[128:131], v[112:115]
 buffer_load_dwordx4 v13, s[48:51], s22 offen offset:1024   lds
M v[108:111], a[168:171], a[120:123], v[108:111]
M v[108:111], a[172:175], a[124:127], v[108:111]
 ds_read_b64_tr_b16 a[68:69], v1 offset:24576
 ds_read_b64_tr_b16 a[70:71], v1 offset:25600
M v[104:107], a[172:175], a[116:119], v[104:107]
M v[104:107], a[168:171], a[112:115], v[104:107]
M v[100:103], a[168:171], a[104:107], v[100:103]
 buffer_load_dwordx4 v14, s[48:51], s22 offen offset:2048   lds
M v[100:103], a[172:175], a[108:111], v[100:103]
 s_waitcnt lgkmcnt(4)
M v[96:99], a[172:175], a[100:103], v[96:99]
M v[96:99], a[168:171], a[96:99], v[96:99]
M v[128:131], a[160:163], a[96:99], v[128:131]
 ds_read_b128 a[168:171], v5 offset:51200
 ds_read_b128 a[172:175], v6 offset:51200
M v[128:131], a[164:167], a[100:103], v[128:131]
 ds_read_b64_tr_b16 a[72:73], v2 offset:16384
 ds_read_b64_tr_b16 a[74:75], v2 offset:17408
M v[132:135], a[164:167], a[108:111], v[132:135]
 buffer_load_dwordx4 v15, s[48:51], s22 offen offset:3072   lds
M v[132:135], a[160:163], a[104:107], v[132:135]
 s_add_u32 s22, s22, 2097152
M v[136:139], a[160:163], a[112:115], v[136:139]
M v[136:139], a[164:167], a[116:119], v[136:139]
 s_add_u32 m0, s23, 0
M v[140:143], a[164:167], a[124:127], v[140:143]
 buffer_load_dwordx4 v8, s[16:19], s21 offen offset:0  nt lds
M v[140:143], a[160:163], a[120:123], v[140:143]
 ds_read_b64_tr_b16 a[76:77], v2 offset:24576
 ds_read_b64_tr_b16 a[78:79], v2 offset:25600
M v[144:147], a[160:163], a[128:131], v[144:147]
M v[144:147], a[164:167], a[132:135], v[144:147]
M v[148:151], a[164:167], a[140:143], v[148:151]
 buffer_load_dwordx4 v9, s[16:19], s21 offen offset:1024  nt lds
M v[148:151], a[160:163], a[136:139], v[148:151]
M v[152:155], a[160:163], a[144:147], v[152:155]
M v[152:155], a[164:167], a[148:151], v[152:155]
 s_waitcnt lgkmcnt(4)
M v[156:159], a[164:167], a[156:159], v[156:159]
 ds_read_b64_tr_b16 a[80:81], v3 offset:16384
 ds_read_b64_tr_b16 a[82:83], v3 offset:17408
M v[156:159], a[160:163], a[152:155], v[156:159]
 buffer_load_dwordx4 v10, s[16:19], s21 offen offset:2048  nt lds
M v[188:191], a[168:171], a[152:155], v[188:191]
 ds_read_b128 a[160:163], v5 offset:53248
 ds_read_b128 a[164:167], v6 offset:53248
M v[188:191], a[172:175], a[156:159], v[188:191]
M v[184:187], a[172:175], a[148:151], v[184:187]
M v[184:187], a[168:171], a[144:147], v[184:187]
M v[180:183], a[168:171], a[136:139], v[180:183]
 buffer_load_dwordx4 v11, s[16:19], s21 offen offset:3072  nt lds
M v[180:183], a[172:175], a[140:143], v[180:183]
 s_add_u32 s21, s21, 128
 ds_read_b64_tr_b16 a[84:85], v3 offset:24576
 ds_read_b64_tr_b16 a[86:87], v3 offset:25600
M v[176:179], a[172:175], a[132:135], v[176:179]
M v[176:179], a[168:171], a[128:131], v[176:179]
M v[172:175], a[168:171], a[120:123], v[172:175]
 s_add_u32 m0, s87, 0
M v[172:175], a[172:175], a[124:127], v[172:175]
 buffer_load_dwordx4 v28, s[68:71], s67 offen offset:0 nt lds
M v[168:171], a[172:175], a[116:119], v[168:171]
M v[168:171], a[168:171], a[112:115], v[168:171]
M v[164:167], a[168:171], a[104:107], v[164:167]
 ds_read_b64_tr_b16 a[88:89], v4 offset:16384
 ds_read_b64_tr_b16 a[90:91], v4 offset:17408
M v[164:167], a[172:175], a[108:111], v[164:167]
 s_waitcnt lgkmcnt(4)
M v[160:163], a[172:175], a[100:103], v[160:163]
 buffer_load_dwordx4 v29, s[68:71], s67 offen offset:1024 nt lds
M v[160:163], a[168:171], a[96:99], v[160:163]
M v[192:195], a[160:163], a[96:99], v[192:195]
 ds_read_b128 a[168:171], v5 offset:55296
 ds_read_b128 a[172:175], v6 offset:55296
M v[192:195], a[164:167], a[100:103], v[192:195]
M v[196:199], a[164:167], a[108:111], v[196:199]
 buffer_load_dwordx4 v30, s[68:71], s67 offen offset:2048 nt lds
M v[196:199], a[160:163], a[104:107], v[196:199]
 ds_read_b64_tr_b16 a[92:93], v4 offset:24576
 ds_read_b64_tr_b16 a[94:95], v4 offset:25600
M v[200:203], a[160:163], a[112:115], v[200:203]
M v[200:203], a[164:167], a[116:119], v[200:203]
M v[204:207], a[164:167], a[124:127], v[204:207]
M v[204:207], a[160:163], a[120:123], v[204:207]
 buffer_load_dwordx4 v31, s[68:71], s67 offen offset:3072 nt lds
M v[208:211], a[160:163], a[128:131], v[208:211]
 s_add_u32 s67, s67, 0
M v[208:211], a[164:167], a[132:135], v[208:211]
M v[212:215], a[164:167], a[140:143], v[212:215]
M v[212:215], a[160:163], a[136:139], v[212:215]
M v[216:219], a[160:163], a[144:147], v[216:219]
M v[216:219], a[164:167], a[148:151], v[216:219]
 s_waitcnt lgkmcnt(2)
M v[220:223], a[164:167], a[156:159], v[220:223]
 s_waitcnt vmcnt(20) lgkmcnt(0)
M v[220:223], a[160:163], a[152:155], v[220:223]
 s_barrier
M v[252:255], a[168:171], a[152:155], v[252:255]
 ds_read_b128 a[160:163], v5 offset:0
 ds_read_b128 a[164:167], v6 offset:0
M v[252:255], a[172:175], a[156:159], v[252:255]
M v[248:251], a[172:175], a[148:151], v[248:251]
M v[248:251], a[168:171], a[144:147], v[248:251]
M v[244:247], a[168:171], a[136:139], v[244:247]
M v[244:247], a[172:175], a[140:143], v[244:247]
M v[240:243], a[172:175], a[132:135], v[240:243]
M v[240:243], a[168:171], a[128:131], v[240:243]
M v[236:239], a[168:171], a[120:123], v[236:239]
M v[236:239], a[172:175], a[124:127], v[236:239]
M v[232:235], a[172:175], a[116:119], v[232:235]
M v[232:235], a[168:171], a[112:115], v[232:235]
M v[228:231], a[168:171], a[104:107], v[228:231]
M v[228:231], a[172:175], a[108:111], v[228:231]
 s_waitcnt lgkmcnt(0)
M v[224:227], a[172:175], a[100:103], v[224:227]
M v[224:227], a[168:171], a[96:99], v[224:227]
M a[0:3], a[160:163], a[32:35], a[0:3]
 ds_read_b128 a[168:171], v5 offset:2048
 ds_read_b128 a[172:175], v6 offset:2048
M a[0:3], a[164:167], a[36:39], a[0:3]
 ds_read_b64_tr_b16 a[96:97], v1 offset:32768
 ds_read_b64_tr_b16 a[98:99], v1 offset:33792
M a[4:7], a[164:167], a[44:47], a[4:7]
 s_add_u32 m0, s24, 49152
 v_cvt_pk_bf16_f32 v23, v23, v23
 v_accvgpr_read_b32 v27, a241
M a[4:7], a[160:163], a[40:43], a[4:7]
 buffer_load_dwordx4 v12, s[48:51], s22 offen offset:0   lds
M a[8:11], a[160:163], a[48:51], a[8:11]
 v_and_b32 v23, 0xffff0000, v23
M a[8:11], a[164:167], a[52:55], a[8:11]
 v_mul_f32 v22, 0xbfb8aa3b, v23
M a[12:15], a[164:167], a[60:63], a[12:15]
 ds_read_b64_tr_b16 a[100:101], v1 offset:40960
 ds_read_b64_tr_b16 a[102:103], v1 offset:41984
M a[12:15], a[160:163], a[56:59], a[12:15]
 v_exp_f32 v22, v22
M a[16:19], a[160:163], a[64:67], a[16:19]
 buffer_load_dwordx4 v13, s[48:51], s22 offen offset:1024   lds
M a[16:19], a[164:167], a[68:71], a[16:19]
 v_add_f32 v22, 1.0, v22
M a[20:23], a[164:167], a[76:79], a[20:23]
 v_rcp_f32 v23, v22
M a[20:23], a[160:163], a[72:75], a[20:23]
 s_or_b32 s64, s86, s20
 ds_read_b64_tr_b16 a[104:105], v2 offset:32768
 ds_read_b64_tr_b16 a[106:107], v2 offset:33792
M a[24:27], a[160:163], a[80:83], a[24:27]
 s_min_u32 s64, s64, 1
 s_lshl_b32 s64, s64, 29
 v_lshrrev_b32 v22, 1, v0
M a[24:27], a[164:167], a[84:87], a[24:27]
 s_waitcnt lgkmcnt(6)
 v_min_u32 v22, 1, v22
M a[28:31], a[164:167], a[92:95], a[28:31]
 buffer_load_dwordx4 v14, s[48:51], s22 offen offset:2048   lds
M a[28:31], a[160:163], a[88:91], a[28:31]
 v_lshlrev_b32 v22, 29, v22
M v[60:63], a[168:171], a[88:91], v[60:63]
 ds_read_b128 a[160:163], v5 offset:4096
 ds_read_b128 a[164:167], v6 offset:4096
M v[60:63], a[172:175], a[92:95], v[60:63]
 ds_read_b64_tr_b16 a[108:109], v2 offset:40960
 ds_read_b64_tr_b16 a[110:111], v2 offset:41984
M v[56:59], a[172:175], a[84:87], v[56:59]
 buffer_load_dwordx4 v15, s[48:51], s22 offen offset:3072   lds
M v[56:59], a[168:171], a[80:83], v[56:59]
 s_sub_u32 s22, s22, 2097024
 v_lshl_or_b32 v22, v0, 2, v22
M v[52:55], a[168:171], a[72:75], v[52:55]
 v_or_b32 v22, s64, v22
M v[52:55], a[172:175], a[76:79], v[52:55]
 ds_read_b64_tr_b16 a[112:113], v3 offset:32768
 ds_read_b64_tr_b16 a[114:115], v3 offset:33792
M v[48:51], a[172:175], a[68:71], v[48:51]
 s_add_u32 m0, s23, 16384
 v_cvt_pk_bf16_f32 v23, v23, v23
M v[48:51], a[168:171], a[64:67], v[48:51]
 buffer_load_dwordx4 v8, s[16:19], s21 offen offset:0  nt lds
M v[44:47], a[168:171], a[56:59], v[44:47]
 v_and_b32 v23, 0xffff0000, v23
M v[44:47], a[172:175], a[60:63], v[44:47]
 s_mov_b32 s64, 104890368
M v[40:43], a[172:175], a[52:55], v[40:43]
 ds_read_b64_tr_b16 a[116:117], v3 offset:40960
 ds_read_b64_tr_b16 a[118:119], v3 offset:41984
M v[40:43], a[168:171], a[48:51], v[40:43]
 buffer_store_dword v24, v22, s[8:11], s64 offen sc1
M v[36:39], a[168:171], a[40:43], v[36:39]
 buffer_load_dwordx4 v9, s[16:19], s21 offen offset:1024  nt lds
M v[36:39], a[172:175], a[44:47], v[36:39]
 s_waitcnt lgkmcnt(6)
M v[32:35], a[172:175], a[36:39], v[32:35]
 buffer_store_dword v23, v22, s[8:11], s64 offen offset:8 sc1
M v[32:35], a[168:171], a[32:35], v[32:35]
 ds_read_b64_tr_b16 a[120:121], v4 offset:32768
 ds_read_b64_tr_b16 a[122:123], v4 offset:33792
M v[64:67], a[160:163], a[32:35], v[64:67]
 ds_read_b128 a[168:171], v5 offset:6144
 ds_read_b128 a[172:175], v6 offset:6144
M v[64:67], a[164:167], a[36:39], v[64:67]
 buffer_load_dwordx4 v10, s[16:19], s21 offen offset:2048  nt lds
M v[68:71], a[164:167], a[44:47], v[68:71]
 v_add_u32 v25, 159744, v7
M v[68:71], a[160:163], a[40:43], v[68:71]
 ds_read_b128 v[16:19], v25
M v[72:75], a[160:163], a[48:51], v[72:75]
 ds_read_b64_tr_b16 a[124:125], v4 offset:40960
 ds_read_b64_tr_b16 a[126:127], v4 offset:41984
M v[72:75], a[164:167], a[52:55], v[72:75]
 ds_read_b128 v[28:31], v25 offset:1024
 v_sub_f32 v48, v48, v27
M v[76:79], a[164:167], a[60:63], v[76:79]
 buffer_load_dwordx4 v11, s[16:19], s21 offen offset:3072  nt lds
M v[76:79], a[160:163], a[56:59], v[76:79]
 s_add_u32 s21, s21, 524160
 ds_read_b128 v[20:23], v25 offset:2048
 v_sub_f32 v49, v49, v27
M v[80:83], a[160:163], a[64:67], v[80:83]
 v_sub_f32 v50, v50, v27
 v_sub_f32 v51, v51, v27
M v[80:83], a[164:167], a[68:71], v[80:83]
 v_sub_f32 v52, v52, v27
 v_sub_f32 v53, v53, v27
M v[84:87], a[164:167], a[76:79], v[84:87]
 v_sub_f32 v54, v54, v27
 v_sub_f32 v55, v55, v27
M v[84:87], a[160:163], a[72:75], v[84:87]
 v_sub_f32 v56, v56, v27
 v_sub_f32 v57, v57, v27
M v[88:91], a[160:163], a[80:83], v[88:91]
 v_sub_f32 v58, v58, v27
 v_sub_f32 v59, v59, v27
M v[88:91], a[164:167], a[84:87], v[88:91]
 s_waitcnt lgkmcnt(5)
 v_sub_f32 v60, v60, v27
 v_sub_f32 v61, v61, v27
M v[92:95], a[164:167], a[92:95], v[92:95]
 s_waitcnt vmcnt(22) lgkmcnt(0)
 v_sub_f32 v62, v62, v27
 v_sub_f32 v63, v63, v27
M v[92:95], a[160:163], a[88:91], v[92:95]
 s_barrier
M v[124:127], a[168:171], a[88:91], v[124:127]
 ds_read_b128 a[160:163], v5 offset:16384
 ds_read_b128 a[164:167], v6 offset:16384
M v[124:127], a[172:175], a[92:95], v[124:127]
 v_add_f32 v16, v28, v16
M v[120:123], a[172:175], a[84:87], v[120:123]
 s_add_u32 m0, s24, 0
 ds_read_b64_tr_b16 a[128:129], v1 offset:49152
 ds_read_b64_tr_b16 a[130:131], v1 offset:50176
M v[120:123], a[168:171], a[80:83], v[120:123]
 buffer_load_dwordx4 v12, s[48:51], s22 offen offset:0   lds
M v[116:119], a[168:171], a[72:75], v[116:119]
 v_add_f32 v17, v29, v17
 v_sub_f32 v80, v80, v27
M v[116:119], a[172:175], a[76:79], v[116:119]
 v_add_f32 v18, v30, v18
 v_sub_f32 v81, v81, v27
M v[112:115], a[172:175], a[68:71], v[112:115]
 v_add_f32 v19, v31, v19
 v_sub_f32 v82, v82, v27
M v[112:115], a[168:171], a[64:67], v[112:115]
 ds_read_b128 v[28:31], v25 offset:3072
 v_sub_f32 v83, v83, v27
M v[108:111], a[168:171], a[56:59], v[108:111]
 v_cvt_pk_bf16_f32 v25, v16, v17
 v_sub_f32 v84, v84, v27
M v[108:111], a[172:175], a[60:63], v[108:111]
 ds_read_b64_tr_b16 a[132:133], v1 offset:57344
 ds_read_b64_tr_b16 a[134:135], v1 offset:58368
M v[104:107], a[172:175], a[52:55], v[104:107]
 buffer_load_dwordx4 v13, s[48:51], s22 offen offset:1024   lds
M v[104:107], a[168:171], a[48:51], v[104:107]
 v_lshlrev_b32 v16, 16, v25
 v_sub_f32 v85, v85, v27
M v[100:103], a[168:171], a[40:43], v[100:103]
 v_and_b32 v17, 0xffff0000, v25
 v_sub_f32 v86, v86, v27
M v[100:103], a[172:175], a[44:47], v[100:103]
 s_waitcnt lgkmcnt(5)
 v_cvt_pk_bf16_f32 v25, v18, v19
 v_sub_f32 v87, v87, v27
M v[96:99], a[172:175], a[36:39], v[96:99]
 v_lshlrev_b32 v18, 16, v25
 v_sub_f32 v88, v88, v27
M v[96:99], a[168:171], a[32:35], v[96:99]
 v_and_b32 v19, 0xffff0000, v25
 v_sub_f32 v89, v89, v27
M v[128:131], a[160:163], a[32:35], v[128:131]
 ds_read_b128 a[168:171], v5 offset:18432
 ds_read_b128 a[172:175], v6 offset:18432
M v[128:131], a[164:167], a[36:39], v[128:131]
 ds_read_b64_tr_b16 a[136:137], v2 offset:49152
 ds_read_b64_tr_b16 a[138:139], v2 offset:50176
M v[132:135], a[164:167], a[44:47], v[132:135]
 buffer_load_dwordx4 v14, s[48:51], s22 offen offset:2048   lds
M v[132:135], a[160:163], a[40:43], v[132:135]
 s_waitcnt lgkmcnt(6)
 v_add_f32 v20, v28, v20
 v_sub_f32 v90, v90, v27
M v[136:139], a[160:163], a[48:51], v[136:139]
 v_add_f32 v21, v29, v21
 v_sub_f32 v91, v91, v27
M v[136:139], a[164:167], a[52:55], v[136:139]
 v_add_f32 v22, v30, v22
 v_sub_f32 v92, v92, v27
M v[140:143], a[164:167], a[60:63], v[140:143]
 v_add_f32 v23, v31, v23
 v_sub_f32 v93, v93, v27
M v[140:143], a[160:163], a[56:59], v[140:143]
 ds_read_b64_tr_b16 a[140:141], v2 offset:57344
 ds_read_b64_tr_b16 a[142:143], v2 offset:58368
M v[144:147], a[160:163], a[64:67], v[144:147]
 buffer_load_dwordx4 v15, s[48:51], s22 offen offset:3072   lds
M v[144:147], a[164:167], a[68:71], v[144:147]
 s_add_u32 s22, s22, 2097152
 v_mul_f32 v28, 0xbfb8aa3b, v16
 v_sub_f32 v94, v94, v27
M v[148:151], a[164:167], a[76:79], v[148:151]
 v_mul_f32 v29, 0xbfb8aa3b, v17
 v_sub_f32 v95, v95, v27
M v[148:151], a[160:163], a[72:75], v[148:151]
 v_mul_f32 v30, 0xbfb8aa3b, v18
 v_sub_f32 v112, v112, v27
M v[152:155], a[160:163], a[80:83], v[152:155]
 v_mul_f32 v31, 0xbfb8aa3b, v19
 v_sub_f32 v113, v113, v27
M v[152:155], a[164:167], a[84:87], v[152:155]
 s_waitcnt lgkmcnt(4)
 v_exp_f32 v28, v28
M v[156:159], a[164:167], a[92:95], v[156:159]
 s_add_u32 m0, s23, 32768
 ds_read_b64_tr_b16 a[144:145], v3 offset:49152
 ds_read_b64_tr_b16 a[146:147], v3 offset:50176
M v[156:159], a[160:163], a[88:91], v[156:159]
 buffer_load_dwordx4 v8, s[16:19], s21 offen offset:0  nt lds
M v[188:191], a[168:171], a[88:91], v[188:191]
 ds_read_b128 a[160:163], v5 offset:20480
 ds_read_b128 a[164:167], v6 offset:20480
M v[188:191], a[172:175], a[92:95], v[188:191]
 v_exp_f32 v29, v29
M v[184:187], a[172:175], a[84:87], v[184:187]
 v_exp_f32 v30, v30
M v[184:187], a[168:171], a[80:83], v[184:187]
 v_exp_f32 v31, v31
M v[180:183], a[168:171], a[72:75], v[180:183]
 v_cvt_pk_bf16_f32 v25, v20, v21
 v_sub_f32 v114, v114, v27
M v[180:183], a[172:175], a[76:79], v[180:183]
 ds_read_b64_tr_b16 a[148:149], v3 offset:57344
 ds_read_b64_tr_b16 a[150:151], v3 offset:58368
M v[176:179], a[172:175], a[68:71], v[176:179]
 buffer_load_dwordx4 v9, s[16:19], s21 offen offset:1024  nt lds
M v[176:179], a[168:171], a[64:67], v[176:179]
 v_lshlrev_b32 v20, 16, v25
 v_sub_f32 v115, v115, v27
M v[172:175], a[168:171], a[56:59], v[172:175]
 v_and_b32 v21, 0xffff0000, v25
 v_sub_f32 v116, v116, v27
M v[172:175], a[172:175], a[60:63], v[172:175]
 v_cvt_pk_bf16_f32 v25, v22, v23
 v_sub_f32 v117, v117, v27
M v[168:171], a[172:175], a[52:55], v[168:171]
 v_lshlrev_b32 v22, 16, v25
 v_sub_f32 v118, v118, v27
M v[168:171], a[168:171], a[48:51], v[168:171]
 v_and_b32 v23, 0xffff0000, v25
 v_sub_f32 v119, v119, v27
M v[164:167], a[168:171], a[40:43], v[164:167]
 ds_read_b64_tr_b16 a[152:153], v4 offset:49152
 ds_read_b64_tr_b16 a[154:155], v4 offset:50176
M v[164:167], a[172:175], a[44:47], v[164:167]
 s_waitcnt lgkmcnt(4)
 v_add_f32 v28, 1.0, v28
 v_sub_f32 v120, v120, v27
M v[160:163], a[172:175], a[36:39], v[160:163]
 buffer_load_dwordx4 v10, s[16:19], s21 offen offset:2048  nt lds
M v[160:163], a[168:171], a[32:35], v[160:163]
 v_add_f32 v29, 1.0, v29
 v_sub_f32 v121, v121, v27
M v[192:195], a[160:163], a[32:35], v[192:195]
 ds_read_b128 a[168:171], v5 offset:22528
 ds_read_b128 a[172:175], v6 offset:22528
M v[192:195], a[164:167], a[36:39], v[192:195]
 v_add_f32 v30, 1.0, v30
 v_sub_f32 v122, v122, v27
M v[196:199], a[164:167], a[44:47], v[196:199]
 v_add_f32 v31, 1.0, v31
 v_sub_f32 v123, v123, v27
M v[196:199], a[160:163], a[40:43], v[196:199]
 ds_read_b64_tr_b16 a[156:157], v4 offset:57344
 ds_read_b64_tr_b16 a[158:159], v4 offset:58368
M v[200:203], a[160:163], a[48:51], v[200:203]
 buffer_load_dwordx4 v11, s[16:19], s21 offen offset:3072  nt lds
M v[200:203], a[164:167], a[52:55], v[200:203]
 s_add_u32 s21, s21, 128
 v_rcp_f32 v28, v28
M v[204:207], a[164:167], a[60:63], v[204:207]
 v_rcp_f32 v29, v29
M v[204:207], a[160:163], a[56:59], v[204:207]
 v_rcp_f32 v30, v30
M v[208:211], a[160:163], a[64:67], v[208:211]
 v_rcp_f32 v31, v31
M v[208:211], a[164:167], a[68:71], v[208:211]
 v_mul_f32 v16, v28, v16
 v_sub_f32 v124, v124, v27
M v[212:215], a[164:167], a[76:79], v[212:215]
 v_mul_f32 v17, v29, v17
 v_sub_f32 v125, v125, v27
M v[212:215], a[160:163], a[72:75], v[212:215]
 v_mul_f32 v18, v30, v18
 v_sub_f32 v126, v126, v27
M v[216:219], a[160:163], a[80:83], v[216:219]
 v_mul_f32 v19, v31, v19
 v_sub_f32 v127, v127, v27
M v[216:219], a[164:167], a[84:87], v[216:219]
 s_waitcnt lgkmcnt(2)
 v_cvt_pk_bf16_f32 v25, v16, v17
 v_sub_f32 v128, v128, v27
M v[220:223], a[164:167], a[92:95], v[220:223]
 s_waitcnt vmcnt(22) lgkmcnt(0)
 v_lshlrev_b32 v16, 16, v25
 v_sub_f32 v129, v129, v27
M v[220:223], a[160:163], a[88:91], v[220:223]
 s_barrier
M v[252:255], a[168:171], a[88:91], v[252:255]
 ds_read_b128 a[160:163], v5 offset:32768
 ds_read_b128 a[164:167], v6 offset:32768
M v[252:255], a[172:175], a[92:95], v[252:255]
 v_and_b32 v17, 0xffff0000, v25
 v_sub_f32 v130, v130, v27
M v[248:251], a[172:175], a[84:87], v[248:251]
 v_cvt_pk_bf16_f32 v25, v18, v19
 v_sub_f32 v131, v131, v27
M v[248:251], a[168:171], a[80:83], v[248:251]
 v_lshlrev_b32 v18, 16, v25
 v_sub_f32 v132, v132, v27
M v[244:247], a[168:171], a[72:75], v[244:247]
 v_and_b32 v19, 0xffff0000, v25
 v_sub_f32 v133, v133, v27
M v[244:247], a[172:175], a[76:79], v[244:247]
 v_mul_f32 v16, v20, v16
 v_sub_f32 v134, v134, v27
M v[240:243], a[172:175], a[68:71], v[240:243]
 v_mul_f32 v17, v21, v17
 v_sub_f32 v135, v135, v27
M v[240:243], a[168:171], a[64:67], v[240:243]
 v_mul_f32 v18, v22, v18
 v_sub_f32 v136, v136, v27
M v[236:239], a[168:171], a[56:59], v[236:239]
 v_mul_f32 v19, v23, v19
 v_sub_f32 v137, v137, v27
M v[236:239], a[172:175], a[60:63], v[236:239]
 v_cvt_pk_bf16_f32 v16, v16, v17
 v_sub_f32 v138, v138, v27
M v[232:235], a[172:175], a[52:55], v[232:235]
 v_cvt_pk_bf16_f32 v17, v18, v19
 v_sub_f32 v139, v139, v27
M v[232:235], a[168:171], a[48:51], v[232:235]
 v_sub_f32 v140, v140, v27
 v_sub_f32 v141, v141, v27
M v[228:231], a[168:171], a[40:43], v[228:231]
 v_sub_f32 v142, v142, v27
 v_sub_f32 v143, v143, v27
M v[228:231], a[172:175], a[44:47], v[228:231]
 s_waitcnt lgkmcnt(0)
 v_sub_f32 v144, v144, v27
 v_sub_f32 v145, v145, v27
M v[224:227], a[172:175], a[36:39], v[224:227]
 v_sub_f32 v146, v146, v27
 v_sub_f32 v147, v147, v27
M v[224:227], a[168:171], a[32:35], v[224:227]
 v_sub_f32 v148, v148, v27
 v_sub_f32 v149, v149, v27
M a[0:3], a[160:163], a[96:99], a[0:3]
 ds_read_b128 a[168:171], v5 offset:34816
 ds_read_b128 a[172:175], v6 offset:34816
M a[0:3], a[164:167], a[100:103], a[0:3]
 ds_read_b64_tr_b16 a[32:33], v1 offset:0
 ds_read_b64_tr_b16 a[34:35], v1 offset:1024
M a[4:7], a[164:167], a[108:111], a[4:7]
 s_add_u32 m0, s24, 16384
 v_lshrrev_b32 v28, 2, v0
 v_lshlrev_b32 v28, 8, v28
M a[4:7], a[160:163], a[104:107], a[4:7]
 buffer_load_dwordx4 v12, s[48:51], s22 offen offset:0   lds
M a[8:11], a[160:163], a[112:115], a[8:11]
 v_and_b32 v29, 3, v0
 v_lshl_add_u32 v28, v29, 3, v28
M a[8:11], a[164:167], a[116:119], a[8:11]
 v_add_u32 v28, s87, v28
 v_sub_f32 v150, v150, v27
M a[12:15], a[164:167], a[124:127], a[12:15]
 s_waitcnt vmcnt(19)
 ds_read_b64_tr_b16 a[36:37], v1 offset:8192
 ds_read_b64_tr_b16 a[38:39], v1 offset:9216
M a[12:15], a[160:163], a[120:123], a[12:15]
 ds_read_b64_tr_b16 a[176:177], v28 offset:0
 v_sub_f32 v151, v151, v27
M a[16:19], a[160:163], a[128:131], a[16:19]
 buffer_load_dwordx4 v13, s[48:51], s22 offen offset:1024   lds
M a[16:19], a[164:167], a[132:135], a[16:19]
 ds_read_b64_tr_b16 a[178:179], v28 offset:32
 ds_read_b64_tr_b16 a[180:181], v28 offset:64
M a[20:23], a[164:167], a[140:143], a[20:23]
 ds_read_b64_tr_b16 a[182:183], v28 offset:96
 v_sub_f32 v152, v152, v27
M a[20:23], a[160:163], a[136:139], a[20:23]
 ds_read_b64_tr_b16 a[40:41], v2 offset:0
 ds_read_b64_tr_b16 a[42:43], v2 offset:1024
M a[24:27], a[160:163], a[144:147], a[24:27]
 ds_read_b64_tr_b16 a[184:185], v28 offset:128
 v_sub_f32 v153, v153, v27
M a[24:27], a[164:167], a[148:151], a[24:27]
 s_waitcnt lgkmcnt(11)
 ds_read_b64_tr_b16 a[186:187], v28 offset:160
 ds_read_b64_tr_b16 a[188:189], v28 offset:192
M a[28:31], a[164:167], a[156:159], a[28:31]
 buffer_load_dwordx4 v14, s[48:51], s22 offen offset:2048   lds
M a[28:31], a[160:163], a[152:155], a[28:31]
 v_sub_f32 v154, v154, v27
 v_sub_f32 v155, v155, v27
M v[60:63], a[168:171], a[152:155], v[60:63]
 ds_read_b128 a[160:163], v5 offset:36864
 ds_read_b128 a[164:167], v6 offset:36864
M v[60:63], a[172:175], a[156:159], v[60:63]
 ds_read_b64_tr_b16 a[44:45], v2 offset:8192
 ds_read_b64_tr_b16 a[46:47], v2 offset:9216
M v[56:59], a[172:175], a[148:151], v[56:59]
 buffer_load_dwordx4 v15, s[48:51], s22 offen offset:3072   lds
M v[56:59], a[168:171], a[144:147], v[56:59]
 s_sub_u32 s22, s22, 2097024
 v_sub_f32 v156, v156, v27
 v_sub_f32 v157, v157, v27
M v[52:55], a[168:171], a[136:139], v[52:55]
 v_sub_f32 v158, v158, v27
 v_sub_f32 v159, v159, v27
M v[52:55], a[172:175], a[140:143], v[52:55]
 ds_read_b64_tr_b16 a[48:49], v3 offset:0
 ds_read_b64_tr_b16 a[50:51], v3 offset:1024
M v[48:51], a[172:175], a[132:135], v[48:51]
 s_add_u32 m0, s23, 49152
M v[48:51], a[168:171], a[128:131], v[48:51]
 buffer_load_dwordx4 v8, s[16:19], s21 offen offset:0  nt lds
M v[44:47], a[168:171], a[120:123], v[44:47]
M v[44:47], a[172:175], a[124:127], v[44:47]
M v[40:43], a[172:175], a[116:119], v[40:43]
 ds_read_b64_tr_b16 a[52:53], v3 offset:8192
 ds_read_b64_tr_b16 a[54:55], v3 offset:9216
M v[40:43], a[168:171], a[112:115], v[40:43]
M v[36:39], a[168:171], a[104:107], v[36:39]
 buffer_load_dwordx4 v9, s[16:19], s21 offen offset:1024  nt lds
M v[36:39], a[172:175], a[108:111], v[36:39]
 s_waitcnt lgkmcnt(6)
M v[32:35], a[172:175], a[100:103], v[32:35]
M v[32:35], a[168:171], a[96:99], v[32:35]
 ds_read_b64_tr_b16 a[56:57], v4 offset:0
 ds_read_b64_tr_b16 a[58:59], v4 offset:1024
M v[64:67], a[160:163], a[96:99], v[64:67]
 ds_read_b128 a[168:171], v5 offset:38912
 ds_read_b128 a[172:175], v6 offset:38912
M v[64:67], a[164:167], a[100:103], v[64:67]
 buffer_load_dwordx4 v10, s[16:19], s21 offen offset:2048  nt lds
M v[68:71], a[164:167], a[108:111], v[68:71]
M v[68:71], a[160:163], a[104:107], v[68:71]
M v[72:75], a[160:163], a[112:115], v[72:75]
 ds_read_b64_tr_b16 a[60:61], v4 offset:8192
 ds_read_b64_tr_b16 a[62:63], v4 offset:9216
M v[72:75], a[164:167], a[116:119], v[72:75]
M v[76:79], a[164:167], a[124:127], v[76:79]
 buffer_load_dwordx4 v11, s[16:19], s21 offen offset:3072  nt lds
M v[76:79], a[160:163], a[120:123], v[76:79]
 s_add_u32 s21, s21, 524160
M v[80:83], a[160:163], a[128:131], v[80:83]
M v[80:83], a[164:167], a[132:135], v[80:83]
M v[84:87], a[164:167], a[140:143], v[84:87]
M v[84:87], a[160:163], a[136:139], v[84:87]
M v[88:91], a[160:163], a[144:147], v[88:91]
M v[88:91], a[164:167], a[148:151], v[88:91]
 s_waitcnt lgkmcnt(2)
M v[92:95], a[164:167], a[156:159], v[92:95]
 s_waitcnt vmcnt(16) lgkmcnt(0)
M v[92:95], a[160:163], a[152:155], v[92:95]
 s_barrier
 v_mfma_f32_16x16x16_bf16 a[208:211], a[176:177], v[16:17], 0
 v_mfma_f32_16x16x16_bf16 a[212:215], a[178:179], v[16:17], 0
 v_mfma_f32_16x16x16_bf16 a[216:219], a[180:181], v[16:17], 0
 v_mfma_f32_16x16x16_bf16 a[220:223], a[182:183], v[16:17], 0
 v_mfma_f32_16x16x16_bf16 a[224:227], a[184:185], v[16:17], 0
 v_mfma_f32_16x16x16_bf16 a[228:231], a[186:187], v[16:17], 0
 v_mfma_f32_16x16x16_bf16 a[232:235], a[188:189], v[16:17], 0
M v[124:127], a[168:171], a[152:155], v[124:127]
 ds_read_b128 a[160:163], v5 offset:49152
 ds_read_b128 a[164:167], v6 offset:49152
M v[124:127], a[172:175], a[156:159], v[124:127]
M v[120:123], a[172:175], a[148:151], v[120:123]
 s_add_u32 m0, s24, 32768
 ds_read_b64_tr_b16 a[64:65], v1 offset:16384
 ds_read_b64_tr_b16 a[66:67], v1 offset:17408
M v[120:123], a[168:171], a[144:147], v[120:123]
 buffer_load_dwordx4 v12, s[48:51], s22 offen offset:0   lds
M v[116:119], a[168:171], a[136:139], v[116:119]
M v[116:119], a[172:175], a[140:143], v[116:119]
M v[112:115], a[172:175], a[132:135], v[112:115]
M v[112:115], a[168:171], a[128:131], v[112:115]
M v[108:111], a[168:171], a[120:123], v[108:111]
M v[108:111], a[172:175], a[124:127], v[108:111]
 ds_read_b64_tr_b16 a[68:69], v1 offset:24576
 ds_read_b64_tr_b16 a[70:71], v1 offset:25600
M v[104:107], a[172:175], a[116:119], v[104:107]
 buffer_load_dwordx4 v13, s[48:51], s22 offen offset:1024   lds
M v[104:107], a[168:171], a[112:115], v[104:107]
M v[100:103], a[168:171], a[104:107], v[100:103]
M v[100:103], a[172:175], a[108:111], v[100:103]
 s_waitcnt lgkmcnt(4)
M v[96:99], a[172:175], a[100:103], v[96:99]
M v[96:99], a[168:171], a[96:99], v[96:99]
M v[128:131], a[160:163], a[96:99], v[128:131]
 ds_read_b128 a[168:171], v5 offset:51200
 ds_read_b128 a[172:175], v6 offset:51200
M v[128:131], a[164:167], a[100:103], v[128:131]
 ds_read_b64_tr_b16 a[72:73], v2 offset:16384
 ds_read_b64_tr_b16 a[74:75], v2 offset:17408
M v[132:135], a[164:167], a[108:111], v[132:135]
 buffer_load_dwordx4 v14, s[48:51], s22 offen offset:2048   lds
M v[132:135], a[160:163], a[104:107], v[132:135]
M v[136:139], a[160:163], a[112:115], v[136:139]
M v[136:139], a[164:167], a[116:119], v[136:139]
M v[140:143], a[164:167], a[124:127], v[140:143]
M v[140:143], a[160:163], a[120:123], v[140:143]
 ds_read_b64_tr_b16 a[76:77], v2 offset:24576
 ds_read_b64_tr_b16 a[78:79], v2 offset:25600
M v[144:147], a[160:163], a[128:131], v[144:147]
 buffer_load_dwordx4 v15, s[48:51], s22 offen offset:3072   lds
M v[144:147], a[164:167], a[132:135], v[144:147]
 s_add_u32 s22, s22, 2097152
M v[148:151], a[164:167], a[140:143], v[148:151]
M v[148:151], a[160:163], a[136:139], v[148:151]
M v[152:155], a[160:163], a[144:147], v[152:155]
M v[152:155], a[164:167], a[148:151], v[152:155]
 s_waitcnt lgkmcnt(4)
M v[156:159], a[164:167], a[156:159], v[156:159]
 s_add_u32 m0, s23, 0
 ds_read_b64_tr_b16 a[80:81], v3 offset:16384
 ds_read_b64_tr_b16 a[82:83], v3 offset:17408
M v[156:159], a[160:163], a[152:155], v[156:159]
 buffer_load_dwordx4 v8, s[52:55], s28 offen offset:0   lds
M v[188:191], a[168:171], a[152:155], v[188:191]
 ds_read_b128 a[160:163], v5 offset:53248
 ds_read_b128 a[164:167], v6 offset:53248
M v[188:191], a[172:175], a[156:159], v[188:191]
M v[184:187], a[172:175], a[148:151], v[184:187]
M v[184:187], a[168:171], a[144:147], v[184:187]
M v[180:183], a[168:171], a[136:139], v[180:183]
M v[180:183], a[172:175], a[140:143], v[180:183]
 ds_read_b64_tr_b16 a[84:85], v3 offset:24576
 ds_read_b64_tr_b16 a[86:87], v3 offset:25600
M v[176:179], a[172:175], a[132:135], v[176:179]
 buffer_load_dwordx4 v9, s[52:55], s28 offen offset:1024   lds
M v[176:179], a[168:171], a[128:131], v[176:179]
M v[172:175], a[168:171], a[120:123], v[172:175]
M v[172:175], a[172:175], a[124:127], v[172:175]
M v[168:171], a[172:175], a[116:119], v[168:171]
M v[168:171], a[168:171], a[112:115], v[168:171]
M v[164:167], a[168:171], a[104:107], v[164:167]
 ds_read_b64_tr_b16 a[88:89], v4 offset:16384
 ds_read_b64_tr_b16 a[90:91], v4 offset:17408
M v[164:167], a[172:175], a[108:111], v[164:167]
 s_waitcnt lgkmcnt(4)
M v[160:163], a[172:175], a[100:103], v[160:163]
 buffer_load_dwordx4 v10, s[52:55], s28 offen offset:2048   lds
M v[160:163], a[168:171], a[96:99], v[160:163]
M v[192:195], a[160:163], a[96:99], v[192:195]
 ds_read_b128 a[168:171], v5 offset:55296
 ds_read_b128 a[172:175], v6 offset:55296
M v[192:195], a[164:167], a[100:103], v[192:195]
M v[196:199], a[164:167], a[108:111], v[196:199]
M v[196:199], a[160:163], a[104:107], v[196:199]
 ds_read_b64_tr_b16 a[92:93], v4 offset:24576
 ds_read_b64_tr_b16 a[94:95], v4 offset:25600
M v[200:203], a[160:163], a[112:115], v[200:203]
 buffer_load_dwordx4 v11, s[52:55], s28 offen offset:3072   lds
M v[200:203], a[164:167], a[116:119], v[200:203]
 s_add_u32 s28, s28, 128
 v_sub_f32 v160, v160, v27
 v_sub_f32 v161, v161, v27
M v[204:207], a[164:167], a[124:127], v[204:207]
 v_sub_f32 v162, v162, v27
 v_sub_f32 v163, v163, v27
M v[204:207], a[160:163], a[120:123], v[204:207]
 v_sub_f32 v164, v164, v27
 v_sub_f32 v165, v165, v27
M v[208:211], a[160:163], a[128:131], v[208:211]
 v_sub_f32 v166, v166, v27
 v_sub_f32 v167, v167, v27
M v[208:211], a[164:167], a[132:135], v[208:211]
 v_sub_f32 v168, v168, v27
 v_sub_f32 v169, v169, v27
M v[212:215], a[164:167], a[140:143], v[212:215]
 v_sub_f32 v170, v170, v27
 v_sub_f32 v171, v171, v27
M v[212:215], a[160:163], a[136:139], v[212:215]
 v_sub_f32 v172, v172, v27
 v_sub_f32 v173, v173, v27
M v[216:219], a[160:163], a[144:147], v[216:219]
 v_sub_f32 v174, v174, v27
 v_sub_f32 v175, v175, v27
M v[216:219], a[164:167], a[148:151], v[216:219]
 s_waitcnt lgkmcnt(2)
 v_sub_f32 v176, v176, v27
 v_sub_f32 v177, v177, v27
M v[220:223], a[164:167], a[156:159], v[220:223]
 s_waitcnt vmcnt(16) lgkmcnt(0)
 v_sub_f32 v178, v178, v27
 v_sub_f32 v179, v179, v27
M v[220:223], a[160:163], a[152:155], v[220:223]
 s_barrier
M v[252:255], a[168:171], a[152:155], v[252:255]
 ds_read_b128 a[160:163], v5 offset:0
 ds_read_b128 a[164:167], v6 offset:0
M v[252:255], a[172:175], a[156:159], v[252:255]
 v_and_b32 v26, 48, v0
 v_lshlrev_b32 v26, 17, v26
M v[248:251], a[172:175], a[148:151], v[248:251]
 v_or_b32 v26, v26, v0
 v_lshl_add_u32 v26, v26, 7, s95
M v[248:251], a[168:171], a[144:147], v[248:251]
 buffer_load_dword a240, v26, s[76:79], 0 offen offset:0
M v[244:247], a[168:171], a[136:139], v[244:247]
 v_sub_f32 v180, v180, v27
 v_sub_f32 v181, v181, v27
M v[244:247], a[172:175], a[140:143], v[244:247]
 v_sub_f32 v182, v182, v27
 v_sub_f32 v183, v183, v27
M v[240:243], a[172:175], a[132:135], v[240:243]
 v_sub_f32 v184, v184, v27
 v_sub_f32 v185, v185, v27
M v[240:243], a[168:171], a[128:131], v[240:243]
 v_sub_f32 v186, v186, v27
 v_sub_f32 v187, v187, v27
M v[236:239], a[168:171], a[120:123], v[236:239]
 v_sub_f32 v188, v188, v27
 v_sub_f32 v189, v189, v27
M v[236:239], a[172:175], a[124:127], v[236:239]
 v_sub_f32 v190, v190, v27
 v_sub_f32 v191, v191, v27
M v[232:235], a[172:175], a[116:119], v[232:235]
 v_sub_f32 v192, v192, v27
 v_sub_f32 v193, v193, v27
M v[232:235], a[168:171], a[112:115], v[232:235]
 v_sub_f32 v194, v194, v27
 v_sub_f32 v195, v195, v27
M v[228:231], a[168:171], a[104:107], v[228:231]
 v_sub_f32 v196, v196, v27
 v_sub_f32 v197, v197, v27
M v[228:231], a[172:175], a[108:111], v[228:231]
 s_waitcnt lgkmcnt(0)
 v_sub_f32 v198, v198, v27
 v_sub_f32 v199, v199, v27
M v[224:227], a[172:175], a[100:103], v[224:227]
 v_sub_f32 v200, v200, v27
 v_sub_f32 v201, v201, v27
M v[224:227], a[168:171], a[96:99], v[224:227]
 v_sub_f32 v202, v202, v27
 v_sub_f32 v203, v203, v27
M a[0:3], a[160:163], a[32:35], a[0:3]
 ds_read_b128 a[168:171], v5 offset:2048
 ds_read_b128 a[172:175], v6 offset:2048
M a[0:3], a[164:167], a[36:39], a[0:3]
 ds_read_b64_tr_b16 a[96:97], v1 offset:32768
 ds_read_b64_tr_b16 a[98:99], v1 offset:33792
M a[4:7], a[164:167], a[44:47], a[4:7]
 s_add_u32 m0, s24, 49152
 v_lshrrev_b32 v28, 4, v0
 v_add_u32 v28, 0, v28
M a[4:7], a[160:163], a[40:43], a[4:7]
 buffer_load_dwordx4 v12, s[48:51], s22 offen offset:0   lds
M a[8:11], a[160:163], a[48:51], a[8:11]
 v_and_b32 v29, 7, v0
 v_xor_b32 v28, v28, v29
M a[8:11], a[164:167], a[52:55], a[8:11]
 v_lshlrev_b32 v28, 4, v28
 v_lshrrev_b32 v29, 3, v0
M a[12:15], a[164:167], a[60:63], a[12:15]
 ds_read_b64_tr_b16 a[100:101], v1 offset:40960
 ds_read_b64_tr_b16 a[102:103], v1 offset:41984
M a[12:15], a[160:163], a[56:59], a[12:15]
 buffer_load_dwordx4 v13, s[48:51], s22 offen offset:1024   lds
M a[16:19], a[160:163], a[64:67], a[16:19]
 v_mul_u32_u24 v29, 896, v29
 s_mul_i32 s64, s20, 28672
M a[16:19], a[164:167], a[68:71], a[16:19]
 buffer_load_dwordx4 v14, s[48:51], s22 offen offset:2048   lds
M a[20:23], a[164:167], a[76:79], a[20:23]
 s_add_u32 s64, s64, 0
 v_add3_u32 v16, v29, v28, s64
M a[20:23], a[160:163], a[72:75], a[20:23]
 ds_read_b64_tr_b16 a[104:105], v2 offset:32768
 ds_read_b64_tr_b16 a[106:107], v2 offset:33792
M a[24:27], a[160:163], a[80:83], a[24:27]
 v_add_u32 v18, 12288, v16
 v_lshrrev_b32 v28, 4, v0
M a[24:27], a[164:167], a[84:87], a[24:27]
 s_waitcnt lgkmcnt(6)
 v_add_u32 v28, 4, v28
 v_and_b32 v29, 7, v0
M a[28:31], a[164:167], a[92:95], a[28:31]
 buffer_load_dwordx4 v15, s[48:51], s22 offen offset:3072   lds
M a[28:31], a[160:163], a[88:91], a[28:31]
 s_sub_u32 s22, s22, 2097024
 v_xor_b32 v28, v28, v29
 v_lshlrev_b32 v28, 4, v28
M v[60:63], a[168:171], a[88:91], v[60:63]
 s_add_u32 m0, s23, 16384
 ds_read_b128 a[160:163], v5 offset:4096
 ds_read_b128 a[164:167], v6 offset:4096
M v[60:63], a[172:175], a[92:95], v[60:63]
 ds_read_b64_tr_b16 a[108:109], v2 offset:40960
 ds_read_b64_tr_b16 a[110:111], v2 offset:41984
M v[56:59], a[172:175], a[84:87], v[56:59]
 buffer_load_dwordx4 v8, s[52:55], s28 offen offset:0   lds
M v[56:59], a[168:171], a[80:83], v[56:59]
 v_lshrrev_b32 v29, 3, v0
 v_mul_u32_u24 v29, 896, v29
M v[52:55], a[168:171], a[72:75], v[52:55]
 buffer_load_dwordx4 v9, s[52:55], s28 offen offset:1024   lds
M v[52:55], a[172:175], a[76:79], v[52:55]
 ds_read_b64_tr_b16 a[112:113], v3 offset:32768
 ds_read_b64_tr_b16 a[114:115], v3 offset:33792
M v[48:51], a[172:175], a[68:71], v[48:51]
 s_mul_i32 s64, s20, 28672
 s_add_u32 s64, s64, 6144
M v[48:51], a[168:171], a[64:67], v[48:51]
 buffer_load_dwordx4 v10, s[52:55], s28 offen offset:2048   lds
M v[44:47], a[168:171], a[56:59], v[44:47]
 v_add3_u32 v17, v29, v28, s64
 v_add_u32 v19, 12288, v17
M v[44:47], a[172:175], a[60:63], v[44:47]
 v_add_u32 v20, 0x20000, v1
 v_add_u32 v21, 0x20000, v2
M v[40:43], a[172:175], a[52:55], v[40:43]
 ds_read_b64_tr_b16 a[116:117], v3 offset:40960
 ds_read_b64_tr_b16 a[118:119], v3 offset:41984
M v[40:43], a[168:171], a[48:51], v[40:43]
 buffer_load_dwordx4 v11, s[52:55], s28 offen offset:3072   lds
M v[36:39], a[168:171], a[40:43], v[36:39]
 s_add_u32 s28, s28, 1048448
 v_add_u32 v22, 0x20000, v3
 v_add_u32 v23, 0x20000, v4
M v[36:39], a[172:175], a[44:47], v[36:39]
 s_waitcnt lgkmcnt(6)
 v_sub_f32 v204, v204, v27
 v_sub_f32 v205, v205, v27
M v[32:35], a[172:175], a[36:39], v[32:35]
 s_add_u32 m0, s23, 131072
 v_sub_f32 v206, v206, v27
 v_sub_f32 v207, v207, v27
M v[32:35], a[168:171], a[32:35], v[32:35]
 ds_read_b64_tr_b16 a[120:121], v4 offset:32768
 ds_read_b64_tr_b16 a[122:123], v4 offset:33792
M v[64:67], a[160:163], a[32:35], v[64:67]
 ds_read_b128 a[168:171], v5 offset:6144
 ds_read_b128 a[172:175], v6 offset:6144
M v[64:67], a[164:167], a[36:39], v[64:67]
 buffer_load_dwordx4 v8, s[52:55], s28 offen offset:0   lds
M v[68:71], a[164:167], a[44:47], v[68:71]
 buffer_load_dwordx4 v9, s[52:55], s28 offen offset:1024   lds
M v[68:71], a[160:163], a[40:43], v[68:71]
 v_sub_f32 v208, v208, v27
 v_sub_f32 v209, v209, v27
M v[72:75], a[160:163], a[48:51], v[72:75]
 ds_read_b64_tr_b16 a[124:125], v4 offset:40960
 ds_read_b64_tr_b16 a[126:127], v4 offset:41984
M v[72:75], a[164:167], a[52:55], v[72:75]
 buffer_load_dwordx4 v10, s[52:55], s28 offen offset:2048   lds
M v[76:79], a[164:167], a[60:63], v[76:79]
 v_sub_f32 v210, v210, v27
 v_sub_f32 v211, v211, v27
M v[76:79], a[160:163], a[56:59], v[76:79]
 v_sub_f32 v212, v212, v27
 v_sub_f32 v213, v213, v27
M v[80:83], a[160:163], a[64:67], v[80:83]
 buffer_load_dwordx4 v11, s[52:55], s28 offen offset:3072   lds
M v[80:83], a[164:167], a[68:71], v[80:83]
 s_sub_u32 s28, s28, 524288
 v_sub_f32 v214, v214, v27
 v_sub_f32 v215, v215, v27
M v[84:87], a[164:167], a[76:79], v[84:87]
 v_sub_f32 v216, v216, v27
 v_sub_f32 v217, v217, v27
M v[84:87], a[160:163], a[72:75], v[84:87]
 v_sub_f32 v218, v218, v27
 v_sub_f32 v219, v219, v27
M v[88:91], a[160:163], a[80:83], v[88:91]
 v_sub_f32 v220, v220, v27
 v_sub_f32 v221, v221, v27
M v[88:91], a[164:167], a[84:87], v[88:91]
 s_waitcnt lgkmcnt(2)
 v_sub_f32 v222, v222, v27
 v_sub_f32 v223, v223, v27
M v[92:95], a[164:167], a[92:95], v[92:95]
 s_waitcnt vmcnt(21) lgkmcnt(0)
 v_sub_f32 v224, v224, v27
 v_sub_f32 v225, v225, v27
M v[92:95], a[160:163], a[88:91], v[92:95]
 s_barrier
M v[124:127], a[168:171], a[88:91], v[124:127]
 ds_read_b128 a[160:163], v5 offset:16384
 ds_read_b128 a[164:167], v6 offset:16384
M v[124:127], a[172:175], a[92:95], v[124:127]
 v_sub_f32 v226, v226, v27
 v_sub_f32 v227, v227, v27
M v[120:123], a[172:175], a[84:87], v[120:123]
 s_add_u32 m0, s24, 0
 ds_read_b64_tr_b16 a[128:129], v1 offset:49152
 ds_read_b64_tr_b16 a[130:131], v1 offset:50176
M v[120:123], a[168:171], a[80:83], v[120:123]
 buffer_load_dwordx4 v16, s[56:59], s29 offen offset:0   lds
M v[116:119], a[168:171], a[72:75], v[116:119]
 s_mul_i32 s72, s41, 4352
 v_sub_f32 v228, v228, v27
M v[116:119], a[172:175], a[76:79], v[116:119]
 s_add_u32 s46, s72, 104923136
 v_sub_f32 v229, v229, v27
 v_sub_f32 v230, v230, v27
M v[112:115], a[172:175], a[68:71], v[112:115]
 s_lshl_b32 s45, s42, 7
 s_add_u32 s45, s45, s46
 s_sub_u32 s66, 15, s42
M v[112:115], a[168:171], a[64:67], v[112:115]
 buffer_load_dwordx4 v17, s[56:59], s29 offen offset:1024   lds
M v[108:111], a[168:171], a[56:59], v[108:111]
 s_min_u32 s66, s66, s42
 v_sub_f32 v231, v231, v27
M v[108:111], a[172:175], a[60:63], v[108:111]
 s_lshl_b32 s47, s66, 7
 ds_read_b64_tr_b16 a[132:133], v1 offset:57344
 ds_read_b64_tr_b16 a[134:135], v1 offset:58368
M v[104:107], a[172:175], a[52:55], v[104:107]
 s_add_u32 s47, s47, s46
 v_sub_f32 v232, v232, v27
 v_sub_f32 v233, v233, v27
M v[104:107], a[168:171], a[48:51], v[104:107]
 s_add_u32 s47, s47, 2112
 s_lshl2_add_u32 s47, s20, s47
 s_lshl_b32 s65, s41, 3
M v[100:103], a[168:171], a[40:43], v[100:103]
 buffer_load_dwordx4 v18, s[56:59], s29 offen offset:2048   lds
M v[100:103], a[172:175], a[44:47], v[100:103]
 s_waitcnt lgkmcnt(4)
 s_add_u32 s65, s65, s66
 v_sub_f32 v234, v234, v27
M v[96:99], a[172:175], a[36:39], v[96:99]
 s_mul_i32 s34, s65, 73728
 v_sub_f32 v235, v235, v27
 v_sub_f32 v236, v236, v27
M v[96:99], a[168:171], a[32:35], v[96:99]
 s_add_u32 s34, s34, 50331648
 v_sub_f32 v237, v237, v27
 v_sub_f32 v238, v238, v27
M v[128:131], a[160:163], a[32:35], v[128:131]
 s_lshl_b32 s65, s42, 4
 ds_read_b128 a[168:171], v5 offset:18432
 ds_read_b128 a[172:175], v6 offset:18432
M v[128:131], a[164:167], a[36:39], v[128:131]
 s_add_u32 s65, s65, s41
 ds_read_b64_tr_b16 a[136:137], v2 offset:49152
 ds_read_b64_tr_b16 a[138:139], v2 offset:50176
M v[132:135], a[164:167], a[44:47], v[132:135]
 buffer_load_dwordx4 v19, s[56:59], s29 offen offset:3072   lds
M v[132:135], a[160:163], a[40:43], v[132:135]
 s_add_u32 s29, s29, 128
 s_mul_i32 s33, s65, 114688
 v_sub_f32 v239, v239, v27
M v[136:139], a[160:163], a[48:51], v[136:139]
 s_mul_i32 s65, s20, 28672
 s_add_u32 s33, s33, s65
 s_add_u32 s33, s33, 67108864
M v[136:139], a[164:167], a[52:55], v[136:139]
 s_add_u32 m0, s23, 32768
 s_sub_u32 s65, 15, s66
 s_lshl_b32 s65, s65, 16
M v[140:143], a[164:167], a[60:63], v[140:143]
 buffer_load_dwordx4 v8, s[52:55], s28 offen offset:0   lds
M v[140:143], a[160:163], a[56:59], v[140:143]
 ds_read_b64_tr_b16 a[140:141], v2 offset:57344
 ds_read_b64_tr_b16 a[142:143], v2 offset:58368
M v[144:147], a[160:163], a[64:67], v[144:147]
 s_lshl_b32 s64, s41, 20
 v_sub_f32 v240, v240, v27
M v[144:147], a[164:167], a[68:71], v[144:147]
 s_add_u32 s32, s64, s65
 s_lshl_b32 s65, s20, 14
 s_add_u32 s32, s32, s65
M v[148:151], a[164:167], a[76:79], v[148:151]
 buffer_load_dwordx4 v9, s[52:55], s28 offen offset:1024   lds
M v[148:151], a[160:163], a[72:75], v[148:151]
 s_add_u32 s32, s32, 33554432
 v_sub_f32 v241, v241, v27
M v[152:155], a[160:163], a[80:83], v[152:155]
 s_mov_b32 s31, 0x53800000
 s_mov_b32 s40, 1
 s_sub_u32 s64, s42, 10
M v[152:155], a[164:167], a[84:87], v[152:155]
 s_waitcnt lgkmcnt(4)
 s_and_b32 s35, s64, 536870912
 v_sub_f32 v242, v242, v27
M v[156:159], a[164:167], a[92:95], v[156:159]
 ds_read_b64_tr_b16 a[144:145], v3 offset:49152
 ds_read_b64_tr_b16 a[146:147], v3 offset:50176
M v[156:159], a[160:163], a[88:91], v[156:159]
 buffer_load_dwordx4 v10, s[52:55], s28 offen offset:2048   lds
M v[188:191], a[168:171], a[88:91], v[188:191]
 ds_read_b128 a[160:163], v5 offset:20480
 ds_read_b128 a[164:167], v6 offset:20480
M v[188:191], a[172:175], a[92:95], v[188:191]
 v_sub_f32 v243, v243, v27
 v_sub_f32 v244, v244, v27
M v[184:187], a[172:175], a[84:87], v[184:187]
 v_sub_f32 v245, v245, v27
 v_sub_f32 v246, v246, v27
M v[184:187], a[168:171], a[80:83], v[184:187]
 v_sub_f32 v247, v247, v27
 v_sub_f32 v248, v248, v27
M v[180:183], a[168:171], a[72:75], v[180:183]
 buffer_load_dwordx4 v11, s[52:55], s28 offen offset:3072   lds
M v[180:183], a[172:175], a[76:79], v[180:183]
 s_add_u32 s28, s28, 524416
 ds_read_b64_tr_b16 a[148:149], v3 offset:57344
 ds_read_b64_tr_b16 a[150:151], v3 offset:58368
M v[176:179], a[172:175], a[68:71], v[176:179]
 v_sub_f32 v249, v249, v27
 v_sub_f32 v250, v250, v27
M v[176:179], a[168:171], a[64:67], v[176:179]
 v_sub_f32 v251, v251, v27
 v_sub_f32 v252, v252, v27
M v[172:175], a[168:171], a[56:59], v[172:175]
 s_add_u32 m0, s23, 147456
 v_sub_f32 v253, v253, v27
 v_sub_f32 v254, v254, v27
M v[172:175], a[172:175], a[60:63], v[172:175]
 buffer_load_dwordx4 v8, s[52:55], s28 offen offset:0   lds
M v[168:171], a[172:175], a[52:55], v[168:171]
 v_sub_f32 v255, v255, v27
M v[168:171], a[168:171], a[48:51], v[168:171]
M v[164:167], a[168:171], a[40:43], v[164:167]
 ds_read_b64_tr_b16 a[152:153], v4 offset:49152
 ds_read_b64_tr_b16 a[154:155], v4 offset:50176
M v[164:167], a[172:175], a[44:47], v[164:167]
 s_waitcnt lgkmcnt(4)
M v[160:163], a[172:175], a[36:39], v[160:163]
 buffer_load_dwordx4 v9, s[52:55], s28 offen offset:1024   lds
M v[160:163], a[168:171], a[32:35], v[160:163]
M v[192:195], a[160:163], a[32:35], v[192:195]
 ds_read_b128 a[168:171], v5 offset:22528
 ds_read_b128 a[172:175], v6 offset:22528
M v[192:195], a[164:167], a[36:39], v[192:195]
M v[196:199], a[164:167], a[44:47], v[196:199]
 buffer_load_dwordx4 v10, s[52:55], s28 offen offset:2048   lds
M v[196:199], a[160:163], a[40:43], v[196:199]
 ds_read_b64_tr_b16 a[156:157], v4 offset:57344
 ds_read_b64_tr_b16 a[158:159], v4 offset:58368
M v[200:203], a[160:163], a[48:51], v[200:203]
M v[200:203], a[164:167], a[52:55], v[200:203]
M v[204:207], a[164:167], a[60:63], v[204:207]
M v[204:207], a[160:163], a[56:59], v[204:207]
 buffer_load_dwordx4 v11, s[52:55], s28 offen offset:3072   lds
M v[208:211], a[160:163], a[64:67], v[208:211]
 s_sub_u32 s28, s28, 524288
M v[208:211], a[164:167], a[68:71], v[208:211]
M v[212:215], a[164:167], a[76:79], v[212:215]
M v[212:215], a[160:163], a[72:75], v[212:215]
M v[216:219], a[160:163], a[80:83], v[216:219]
M v[216:219], a[164:167], a[84:87], v[216:219]
 s_waitcnt lgkmcnt(2)
M v[220:223], a[164:167], a[92:95], v[220:223]
 s_waitcnt vmcnt(25) lgkmcnt(0)
M v[220:223], a[160:163], a[88:91], v[220:223]
 s_barrier
M v[252:255], a[168:171], a[88:91], v[252:255]
 ds_read_b128 a[160:163], v5 offset:32768
 ds_read_b128 a[164:167], v6 offset:32768
M v[252:255], a[172:175], a[92:95], v[252:255]
M v[248:251], a[172:175], a[84:87], v[248:251]
M v[248:251], a[168:171], a[80:83], v[248:251]
M v[244:247], a[168:171], a[72:75], v[244:247]
M v[244:247], a[172:175], a[76:79], v[244:247]
M v[240:243], a[172:175], a[68:71], v[240:243]
M v[240:243], a[168:171], a[64:67], v[240:243]
M v[236:239], a[168:171], a[56:59], v[236:239]
M v[236:239], a[172:175], a[60:63], v[236:239]
M v[232:235], a[172:175], a[52:55], v[232:235]
M v[232:235], a[168:171], a[48:51], v[232:235]
M v[228:231], a[168:171], a[40:43], v[228:231]
M v[228:231], a[172:175], a[44:47], v[228:231]
 s_waitcnt lgkmcnt(0)
M v[224:227], a[172:175], a[36:39], v[224:227]
M v[224:227], a[168:171], a[32:35], v[224:227]
M a[0:3], a[160:163], a[96:99], a[0:3]
 ds_read_b128 a[168:171], v5 offset:34816
 ds_read_b128 a[172:175], v6 offset:34816
M a[0:3], a[164:167], a[100:103], a[0:3]
 ds_read_b64_tr_b16 a[32:33], v1 offset:0
 ds_read_b64_tr_b16 a[34:35], v1 offset:1024
M a[4:7], a[164:167], a[108:111], a[4:7]
 s_add_u32 m0, s24, 16384
M a[4:7], a[160:163], a[104:107], a[4:7]
 buffer_load_dwordx4 v16, s[56:59], s29 offen offset:0   lds
M a[8:11], a[160:163], a[112:115], a[8:11]
M a[8:11], a[164:167], a[116:119], a[8:11]
M a[12:15], a[164:167], a[124:127], a[12:15]
 ds_read_b64_tr_b16 a[36:37], v1 offset:8192
 ds_read_b64_tr_b16 a[38:39], v1 offset:9216
M a[12:15], a[160:163], a[120:123], a[12:15]
M a[16:19], a[160:163], a[128:131], a[16:19]
 buffer_load_dwordx4 v17, s[56:59], s29 offen offset:1024   lds
M a[16:19], a[164:167], a[132:135], a[16:19]
M a[20:23], a[164:167], a[140:143], a[20:23]
M a[20:23], a[160:163], a[136:139], a[20:23]
 ds_read_b64_tr_b16 a[40:41], v2 offset:0
 ds_read_b64_tr_b16 a[42:43], v2 offset:1024
M a[24:27], a[160:163], a[144:147], a[24:27]
M a[24:27], a[164:167], a[148:151], a[24:27]
 s_waitcnt lgkmcnt(6)
 buffer_load_dwordx4 v18, s[56:59], s29 offen offset:2048   lds
M a[28:31], a[164:167], a[156:159], a[28:31]
M a[28:31], a[160:163], a[152:155], a[28:31]
M v[32:35], a[168:171], a[96:99], v[32:35]
 ds_read_b128 a[160:163], v5 offset:36864
 ds_read_b128 a[164:167], v6 offset:36864
M v[32:35], a[172:175], a[100:103], v[32:35]
 ds_read_b64_tr_b16 a[44:45], v2 offset:8192
 ds_read_b64_tr_b16 a[46:47], v2 offset:9216
M v[36:39], a[172:175], a[108:111], v[36:39]
 buffer_load_dwordx4 v19, s[56:59], s29 offen offset:3072   lds
M v[36:39], a[168:171], a[104:107], v[36:39]
 s_add_u32 s29, s29, 128
M v[40:43], a[168:171], a[112:115], v[40:43]
M v[40:43], a[172:175], a[116:119], v[40:43]
 ds_read_b64_tr_b16 a[48:49], v3 offset:0
 ds_read_b64_tr_b16 a[50:51], v3 offset:1024
M v[44:47], a[172:175], a[124:127], v[44:47]
 s_add_u32 m0, s23, 49152
 v_accvgpr_read_b32 v24, a0
 v_accvgpr_read_b32 v25, a1
M v[44:47], a[168:171], a[120:123], v[44:47]
 buffer_load_dwordx4 v8, s[52:55], s28 offen offset:0   lds
M v[48:51], a[168:171], a[128:131], v[48:51]
 v_accvgpr_read_b32 v26, a2
 v_accvgpr_read_b32 v27, a3
M v[48:51], a[172:175], a[132:135], v[48:51]
 v_cvt_pk_bf16_f32 v24, v24, v25
 v_cvt_pk_bf16_f32 v25, v26, v27
M v[52:55], a[172:175], a[140:143], v[52:55]
 ds_read_b64_tr_b16 a[52:53], v3 offset:8192
 ds_read_b64_tr_b16 a[54:55], v3 offset:9216
M v[52:55], a[168:171], a[136:139], v[52:55]
 v_cvt_pk_bf16_f32 v26, v32, v33
 v_cvt_pk_bf16_f32 v27, v34, v35
M v[56:59], a[168:171], a[144:147], v[56:59]
 s_add_u32 s3, s93, 0
 buffer_load_dwordx4 v9, s[52:55], s28 offen offset:1024   lds
M v[56:59], a[172:175], a[148:151], v[56:59]
 s_waitcnt lgkmcnt(6)
M v[60:63], a[172:175], a[156:159], v[60:63]
 buffer_store_dwordx4 v[24:27], v7, s[8:11], s3 offen offset:0 sc1
M v[60:63], a[168:171], a[152:155], v[60:63]
 ds_read_b64_tr_b16 a[56:57], v4 offset:0
 ds_read_b64_tr_b16 a[58:59], v4 offset:1024
M v[64:67], a[160:163], a[96:99], v[64:67]
 ds_read_b128 a[168:171], v5 offset:38912
 ds_read_b128 a[172:175], v6 offset:38912
M v[64:67], a[164:167], a[100:103], v[64:67]
 buffer_load_dwordx4 v10, s[52:55], s28 offen offset:2048   lds
M v[68:71], a[164:167], a[108:111], v[68:71]
 v_accvgpr_read_b32 v24, a4
 v_accvgpr_read_b32 v25, a5
M v[68:71], a[160:163], a[104:107], v[68:71]
 v_accvgpr_read_b32 v26, a6
 v_accvgpr_read_b32 v27, a7
M v[72:75], a[160:163], a[112:115], v[72:75]
 ds_read_b64_tr_b16 a[60:61], v4 offset:8192
 ds_read_b64_tr_b16 a[62:63], v4 offset:9216
M v[72:75], a[164:167], a[116:119], v[72:75]
 v_cvt_pk_bf16_f32 v24, v24, v25
 v_cvt_pk_bf16_f32 v25, v26, v27
M v[76:79], a[164:167], a[124:127], v[76:79]
 buffer_load_dwordx4 v11, s[52:55], s28 offen offset:3072   lds
M v[76:79], a[160:163], a[120:123], v[76:79]
 s_add_u32 s28, s28, 1048448
 v_cvt_pk_bf16_f32 v26, v36, v37
 v_cvt_pk_bf16_f32 v27, v38, v39
M v[80:83], a[160:163], a[128:131], v[80:83]
M v[80:83], a[164:167], a[132:135], v[80:83]
M v[84:87], a[164:167], a[140:143], v[84:87]
 buffer_store_dwordx4 v[24:27], v7, s[8:11], s3 offen offset:2048 sc1
M v[84:87], a[160:163], a[136:139], v[84:87]
M v[88:91], a[160:163], a[144:147], v[88:91]
M v[88:91], a[164:167], a[148:151], v[88:91]
 s_waitcnt lgkmcnt(2)
M v[92:95], a[164:167], a[156:159], v[92:95]
 s_waitcnt vmcnt(26) lgkmcnt(0)
 v_accvgpr_read_b32 v24, a8
 v_accvgpr_read_b32 v25, a9
M v[92:95], a[160:163], a[152:155], v[92:95]
 s_barrier
M v[96:99], a[168:171], a[96:99], v[96:99]
 ds_read_b128 a[160:163], v5 offset:49152
 ds_read_b128 a[164:167], v6 offset:49152
M v[96:99], a[172:175], a[100:103], v[96:99]
 v_accvgpr_read_b32 v26, a10
 v_accvgpr_read_b32 v27, a11
M v[100:103], a[172:175], a[108:111], v[100:103]
 s_add_u32 m0, s24, 32768
 ds_read_b64_tr_b16 a[64:65], v1 offset:16384
 ds_read_b64_tr_b16 a[66:67], v1 offset:17408
M v[100:103], a[168:171], a[104:107], v[100:103]
 buffer_load_dwordx4 v16, s[56:59], s29 offen offset:0   lds
M v[104:107], a[168:171], a[112:115], v[104:107]
 v_cvt_pk_bf16_f32 v24, v24, v25
 v_cvt_pk_bf16_f32 v25, v26, v27
M v[104:107], a[172:175], a[116:119], v[104:107]
 v_cvt_pk_bf16_f32 v26, v40, v41
 v_cvt_pk_bf16_f32 v27, v42, v43
M v[108:111], a[172:175], a[124:127], v[108:111]
 s_add_u32 s3, s93, 4096
 buffer_store_dwordx4 v[24:27], v7, s[8:11], s3 offen offset:0 sc1
M v[108:111], a[168:171], a[120:123], v[108:111]
 v_cvt_pk_bf16_f32 v64, v64, v65
 v_cvt_pk_bf16_f32 v65, v66, v67
M v[112:115], a[168:171], a[128:131], v[112:115]
 v_cvt_pk_bf16_f32 v66, v96, v97
 v_cvt_pk_bf16_f32 v67, v98, v99
M v[112:115], a[172:175], a[132:135], v[112:115]
 ds_read_b64_tr_b16 a[68:69], v1 offset:24576
 ds_read_b64_tr_b16 a[70:71], v1 offset:25600
M v[116:119], a[172:175], a[140:143], v[116:119]
 buffer_load_dwordx4 v17, s[56:59], s29 offen offset:1024   lds
M v[116:119], a[168:171], a[136:139], v[116:119]
 v_accvgpr_read_b32 v24, a12
 v_accvgpr_read_b32 v25, a13
M v[120:123], a[168:171], a[144:147], v[120:123]
 v_accvgpr_read_b32 v26, a14
 v_accvgpr_read_b32 v27, a15
M v[120:123], a[172:175], a[148:151], v[120:123]
 s_waitcnt lgkmcnt(4)
 v_cvt_pk_bf16_f32 v24, v24, v25
 v_cvt_pk_bf16_f32 v25, v26, v27
M v[124:127], a[172:175], a[156:159], v[124:127]
 v_cvt_pk_bf16_f32 v26, v44, v45
 v_cvt_pk_bf16_f32 v27, v46, v47
M v[124:127], a[168:171], a[152:155], v[124:127]
 buffer_store_dwordx4 v[24:27], v7, s[8:11], s3 offen offset:2048 sc1
M v[128:131], a[160:163], a[96:99], v[128:131]
 ds_read_b128 a[168:171], v5 offset:51200
 ds_read_b128 a[172:175], v6 offset:51200
M v[128:131], a[164:167], a[100:103], v[128:131]
 ds_read_b64_tr_b16 a[72:73], v2 offset:16384
 ds_read_b64_tr_b16 a[74:75], v2 offset:17408
M v[132:135], a[164:167], a[108:111], v[132:135]
 buffer_load_dwordx4 v18, s[56:59], s29 offen offset:2048   lds
M v[132:135], a[160:163], a[104:107], v[132:135]
 v_cvt_pk_bf16_f32 v68, v68, v69
 v_cvt_pk_bf16_f32 v69, v70, v71
M v[136:139], a[160:163], a[112:115], v[136:139]
 v_cvt_pk_bf16_f32 v70, v100, v101
 v_cvt_pk_bf16_f32 v71, v102, v103
M v[136:139], a[164:167], a[116:119], v[136:139]
 v_cvt_pk_bf16_f32 v72, v72, v73
 v_cvt_pk_bf16_f32 v73, v74, v75
M v[140:143], a[164:167], a[124:127], v[140:143]
 v_accvgpr_read_b32 v24, a16
 v_accvgpr_read_b32 v25, a17
M v[140:143], a[160:163], a[120:123], v[140:143]
 ds_read_b64_tr_b16 a[76:77], v2 offset:24576
 ds_read_b64_tr_b16 a[78:79], v2 offset:25600
M v[144:147], a[160:163], a[128:131], v[144:147]
 buffer_load_dwordx4 v19, s[56:59], s29 offen offset:3072   lds
M v[144:147], a[164:167], a[132:135], v[144:147]
 s_add_u32 s29, s29, 128
 v_accvgpr_read_b32 v26, a18
 v_accvgpr_read_b32 v27, a19
M v[148:151], a[164:167], a[140:143], v[148:151]
 v_cvt_pk_bf16_f32 v24, v24, v25
 v_cvt_pk_bf16_f32 v25, v26, v27
M v[148:151], a[160:163], a[136:139], v[148:151]
 v_cvt_pk_bf16_f32 v26, v48, v49
 v_cvt_pk_bf16_f32 v27, v50, v51
M v[152:155], a[160:163], a[144:147], v[152:155]
 s_add_u32 s3, s93, 8192
 buffer_store_dwordx4 v[24:27], v7, s[8:11], s3 offen offset:0 sc1
M v[152:155], a[164:167], a[148:151], v[152:155]
 s_waitcnt lgkmcnt(4)
 v_cvt_pk_bf16_f32 v74, v104, v105
 v_cvt_pk_bf16_f32 v75, v106, v107
M v[156:159], a[164:167], a[156:159], v[156:159]
 s_add_u32 m0, s23, 0
 ds_read_b64_tr_b16 a[80:81], v3 offset:16384
 ds_read_b64_tr_b16 a[82:83], v3 offset:17408
M v[156:159], a[160:163], a[152:155], v[156:159]
 buffer_load_dwordx4 v8, s[52:55], s28 offen offset:0   lds
M v[160:163], a[168:171], a[96:99], v[160:163]
 ds_read_b128 a[160:163], v5 offset:53248
 ds_read_b128 a[164:167], v6 offset:53248
M v[160:163], a[172:175], a[100:103], v[160:163]
 v_cvt_pk_bf16_f32 v76, v76, v77
 v_cvt_pk_bf16_f32 v77, v78, v79
M v[164:167], a[172:175], a[108:111], v[164:167]
 v_accvgpr_read_b32 v24, a20
 v_accvgpr_read_b32 v25, a21
M v[164:167], a[168:171], a[104:107], v[164:167]
 v_accvgpr_read_b32 v26, a22
 v_accvgpr_read_b32 v27, a23
M v[168:171], a[168:171], a[112:115], v[168:171]
 v_cvt_pk_bf16_f32 v24, v24, v25
 v_cvt_pk_bf16_f32 v25, v26, v27
M v[168:171], a[172:175], a[116:119], v[168:171]
 ds_read_b64_tr_b16 a[84:85], v3 offset:24576
 ds_read_b64_tr_b16 a[86:87], v3 offset:25600
M v[172:175], a[172:175], a[124:127], v[172:175]
 buffer_load_dwordx4 v9, s[52:55], s28 offen offset:1024   lds
M v[172:175], a[168:171], a[120:123], v[172:175]
 v_cvt_pk_bf16_f32 v26, v52, v53
 v_cvt_pk_bf16_f32 v27, v54, v55
M v[176:179], a[168:171], a[128:131], v[176:179]
 v_cvt_pk_bf16_f32 v78, v108, v109
 v_cvt_pk_bf16_f32 v79, v110, v111
M v[176:179], a[172:175], a[132:135], v[176:179]
 buffer_store_dwordx4 v[24:27], v7, s[8:11], s3 offen offset:2048 sc1
M v[180:183], a[172:175], a[140:143], v[180:183]
 v_cvt_pk_bf16_f32 v80, v80, v81
 v_cvt_pk_bf16_f32 v81, v82, v83
M v[180:183], a[168:171], a[136:139], v[180:183]
 v_cvt_pk_bf16_f32 v82, v112, v113
 v_cvt_pk_bf16_f32 v83, v114, v115
M v[184:187], a[168:171], a[144:147], v[184:187]
 ds_read_b64_tr_b16 a[88:89], v4 offset:16384
 ds_read_b64_tr_b16 a[90:91], v4 offset:17408
M v[184:187], a[172:175], a[148:151], v[184:187]
 s_waitcnt lgkmcnt(4)
 buffer_load_dwordx4 v10, s[52:55], s28 offen offset:2048   lds
M v[188:191], a[172:175], a[156:159], v[188:191]
 v_accvgpr_read_b32 v24, a24
 v_accvgpr_read_b32 v25, a25
M v[188:191], a[168:171], a[152:155], v[188:191]
 v_accvgpr_read_b32 v26, a26
 v_accvgpr_read_b32 v27, a27
M v[192:195], a[160:163], a[96:99], v[192:195]
 ds_read_b128 a[168:171], v5 offset:55296
 ds_read_b128 a[172:175], v6 offset:55296
M v[192:195], a[164:167], a[100:103], v[192:195]
 v_cvt_pk_bf16_f32 v24, v24, v25
 v_cvt_pk_bf16_f32 v25, v26, v27
M v[196:199], a[164:167], a[108:111], v[196:199]
 v_cvt_pk_bf16_f32 v26, v56, v57
 v_cvt_pk_bf16_f32 v27, v58, v59
M v[196:199], a[160:163], a[104:107], v[196:199]
 s_add_u32 s3, s93, 12288
 ds_read_b64_tr_b16 a[92:93], v4 offset:24576
 ds_read_b64_tr_b16 a[94:95], v4 offset:25600
M v[200:203], a[160:163], a[112:115], v[200:203]
 buffer_load_dwordx4 v11, s[52:55], s28 offen offset:3072   lds
M v[200:203], a[164:167], a[116:119], v[200:203]
 s_add_u32 s28, s28, 128
 v_cvt_pk_bf16_f32 v84, v84, v85
 v_cvt_pk_bf16_f32 v85, v86, v87
M v[204:207], a[164:167], a[124:127], v[204:207]
 v_cvt_pk_bf16_f32 v86, v116, v117
 v_cvt_pk_bf16_f32 v87, v118, v119
M v[204:207], a[160:163], a[120:123], v[204:207]
 v_cvt_pk_bf16_f32 v88, v88, v89
 v_cvt_pk_bf16_f32 v89, v90, v91
M v[208:211], a[160:163], a[128:131], v[208:211]
 buffer_store_dwordx4 v[24:27], v7, s[8:11], s3 offen offset:0 sc1
M v[208:211], a[164:167], a[132:135], v[208:211]
 v_cvt_pk_bf16_f32 v90, v120, v121
 v_cvt_pk_bf16_f32 v91, v122, v123
M v[212:215], a[164:167], a[140:143], v[212:215]
 v_accvgpr_read_b32 v24, a28
 v_accvgpr_read_b32 v25, a29
M v[212:215], a[160:163], a[136:139], v[212:215]
 v_accvgpr_read_b32 v26, a30
 v_accvgpr_read_b32 v27, a31
M v[216:219], a[160:163], a[144:147], v[216:219]
 v_cvt_pk_bf16_f32 v24, v24, v25
 v_cvt_pk_bf16_f32 v25, v26, v27
M v[216:219], a[164:167], a[148:151], v[216:219]
 s_waitcnt lgkmcnt(2)
 v_cvt_pk_bf16_f32 v26, v60, v61
 v_cvt_pk_bf16_f32 v27, v62, v63
M v[220:223], a[164:167], a[156:159], v[220:223]
 s_waitcnt vmcnt(27) lgkmcnt(0)
 buffer_store_dwordx4 v[24:27], v7, s[8:11], s3 offen offset:2048 sc1
M v[220:223], a[160:163], a[152:155], v[220:223]
 s_barrier
M v[224:227], a[168:171], a[96:99], v[224:227]
 ds_read_b128 a[160:163], v5 offset:0
 ds_read_b128 a[164:167], v6 offset:0
M v[224:227], a[172:175], a[100:103], v[224:227]
 v_cvt_pk_bf16_f32 v92, v92, v93
 v_cvt_pk_bf16_f32 v93, v94, v95
M v[228:231], a[172:175], a[108:111], v[228:231]
 v_cvt_pk_bf16_f32 v94, v124, v125
 v_cvt_pk_bf16_f32 v95, v126, v127
M v[228:231], a[168:171], a[104:107], v[228:231]
 v_cvt_pk_bf16_f32 v128, v128, v129
 v_cvt_pk_bf16_f32 v129, v130, v131
M v[232:235], a[168:171], a[112:115], v[232:235]
 v_cvt_pk_bf16_f32 v130, v160, v161
 v_cvt_pk_bf16_f32 v131, v162, v163
M v[232:235], a[172:175], a[116:119], v[232:235]
 v_cvt_pk_bf16_f32 v132, v132, v133
 v_cvt_pk_bf16_f32 v133, v134, v135
M v[236:239], a[172:175], a[124:127], v[236:239]
 v_cvt_pk_bf16_f32 v134, v164, v165
 v_cvt_pk_bf16_f32 v135, v166, v167
M v[236:239], a[168:171], a[120:123], v[236:239]
 v_cvt_pk_bf16_f32 v136, v136, v137
 v_cvt_pk_bf16_f32 v137, v138, v139
M v[240:243], a[168:171], a[128:131], v[240:243]
 v_cvt_pk_bf16_f32 v138, v168, v169
 v_cvt_pk_bf16_f32 v139, v170, v171
M v[240:243], a[172:175], a[132:135], v[240:243]
 v_cvt_pk_bf16_f32 v140, v140, v141
 v_cvt_pk_bf16_f32 v141, v142, v143
M v[244:247], a[172:175], a[140:143], v[244:247]
 v_cvt_pk_bf16_f32 v142, v172, v173
 v_cvt_pk_bf16_f32 v143, v174, v175
M v[244:247], a[168:171], a[136:139], v[244:247]
 v_cvt_pk_bf16_f32 v144, v144, v145
 v_cvt_pk_bf16_f32 v145, v146, v147
M v[248:251], a[168:171], a[144:147], v[248:251]
 v_cvt_pk_bf16_f32 v146, v176, v177
 v_cvt_pk_bf16_f32 v147, v178, v179
M v[248:251], a[172:175], a[148:151], v[248:251]
 s_waitcnt lgkmcnt(0)
 v_cvt_pk_bf16_f32 v148, v148, v149
 v_cvt_pk_bf16_f32 v149, v150, v151
M v[252:255], a[172:175], a[156:159], v[252:255]
 v_cvt_pk_bf16_f32 v150, v180, v181
 v_cvt_pk_bf16_f32 v151, v182, v183
M v[252:255], a[168:171], a[152:155], v[252:255]
 v_cvt_pk_bf16_f32 v152, v152, v153
 v_cvt_pk_bf16_f32 v153, v154, v155
M v[32:35], a[32:35], a[160:163], 0
 s_add_u32 m0, s23, 16384
 ds_read_b128 a[168:171], v5 offset:2048
 ds_read_b128 a[172:175], v6 offset:2048
M v[32:35], a[36:39], a[164:167], v[32:35]
 ds_read_b64_tr_b16 a[96:97], v1 offset:32768
 ds_read_b64_tr_b16 a[98:99], v1 offset:33792
M v[36:39], a[44:47], a[164:167], 0
 buffer_load_dwordx4 v8, s[52:55], s28 offen offset:0   lds
M v[36:39], a[40:43], a[160:163], v[36:39]
 v_cvt_pk_bf16_f32 v154, v184, v185
 v_cvt_pk_bf16_f32 v155, v186, v187
M v[40:43], a[48:51], a[160:163], 0
 ds_read_b64_tr_b16 a[100:101], v1 offset:40960
 ds_read_b64_tr_b16 a[102:103], v1 offset:41984
M v[40:43], a[52:55], a[164:167], v[40:43]
 buffer_load_dwordx4 v9, s[52:55], s28 offen offset:1024   lds
M v[44:47], a[60:63], a[164:167], 0
 v_cvt_pk_bf16_f32 v156, v156, v157
 v_cvt_pk_bf16_f32 v157, v158, v159
M v[44:47], a[56:59], a[160:163], v[44:47]
 ds_read_b64_tr_b16 a[104:105], v2 offset:32768
 ds_read_b64_tr_b16 a[106:107], v2 offset:33792
M v[48:51], a[64:67], a[160:163], 0
 v_cvt_pk_bf16_f32 v158, v188, v189
 v_cvt_pk_bf16_f32 v159, v190, v191
M v[48:51], a[68:71], a[164:167], v[48:51]
 v_cvt_pk_bf16_f32 v192, v192, v193
 v_cvt_pk_bf16_f32 v193, v194, v195
M v[52:55], a[76:79], a[164:167], 0
 ds_read_b64_tr_b16 a[108:109], v2 offset:40960
 ds_read_b64_tr_b16 a[110:111], v2 offset:41984
M v[52:55], a[72:75], a[160:163], v[52:55]
 buffer_load_dwordx4 v10, s[52:55], s28 offen offset:2048   lds
M v[56:59], a[80:83], a[160:163], 0
 v_cvt_pk_bf16_f32 v194, v224, v225
 v_cvt_pk_bf16_f32 v195, v226, v227
M v[56:59], a[84:87], a[164:167], v[56:59]
 s_waitcnt lgkmcnt(8)
 ds_read_b64_tr_b16 a[112:113], v3 offset:32768
 ds_read_b64_tr_b16 a[114:115], v3 offset:33792
M v[60:63], a[92:95], a[164:167], 0
 v_cvt_pk_bf16_f32 v196, v196, v197
 v_cvt_pk_bf16_f32 v197, v198, v199
M v[60:63], a[88:91], a[160:163], v[60:63]
 buffer_load_dwordx4 v11, s[52:55], s28 offen offset:3072   lds
M v[96:99], a[32:35], a[168:171], 0
 s_add_u32 s28, s28, 524160
 ds_read_b128 a[160:163], v5 offset:4096
 ds_read_b128 a[164:167], v6 offset:4096
M v[96:99], a[36:39], a[172:175], v[96:99]
 ds_read_b64_tr_b16 a[116:117], v3 offset:40960
 ds_read_b64_tr_b16 a[118:119], v3 offset:41984
M v[100:103], a[44:47], a[172:175], 0
 v_cvt_pk_bf16_f32 v198, v228, v229
 v_cvt_pk_bf16_f32 v199, v230, v231
M v[100:103], a[40:43], a[168:171], v[100:103]
 s_add_u32 m0, s24, 49152
 ds_read_b64_tr_b16 a[120:121], v4 offset:32768
 ds_read_b64_tr_b16 a[122:123], v4 offset:33792
M v[104:107], a[48:51], a[168:171], 0
 buffer_load_dwordx4 v16, s[56:59], s29 offen offset:0   lds
M v[104:107], a[52:55], a[172:175], v[104:107]
 v_cvt_pk_bf16_f32 v200, v200, v201
 v_cvt_pk_bf16_f32 v201, v202, v203
M v[108:111], a[60:63], a[172:175], 0
 ds_read_b64_tr_b16 a[124:125], v4 offset:40960
 ds_read_b64_tr_b16 a[126:127], v4 offset:41984
M v[108:111], a[56:59], a[168:171], v[108:111]
 v_cvt_pk_bf16_f32 v202, v232, v233
 v_cvt_pk_bf16_f32 v203, v234, v235
M v[112:115], a[64:67], a[168:171], 0
 v_cvt_pk_bf16_f32 v204, v204, v205
 v_cvt_pk_bf16_f32 v205, v206, v207
M v[112:115], a[68:71], a[172:175], v[112:115]
 buffer_load_dwordx4 v17, s[56:59], s29 offen offset:1024   lds
M v[116:119], a[76:79], a[172:175], 0
 v_cvt_pk_bf16_f32 v206, v236, v237
 v_cvt_pk_bf16_f32 v207, v238, v239
M v[116:119], a[72:75], a[168:171], v[116:119]
 v_cvt_pk_bf16_f32 v208, v208, v209
 v_cvt_pk_bf16_f32 v209, v210, v211
M v[120:123], a[80:83], a[168:171], 0
 v_cvt_pk_bf16_f32 v210, v240, v241
 v_cvt_pk_bf16_f32 v211, v242, v243
M v[120:123], a[84:87], a[172:175], v[120:123]
 s_waitcnt lgkmcnt(6)
 v_cvt_pk_bf16_f32 v212, v212, v213
 v_cvt_pk_bf16_f32 v213, v214, v215
M v[124:127], a[92:95], a[172:175], 0
 s_waitcnt vmcnt(21) lgkmcnt(0)
 buffer_load_dwordx4 v18, s[56:59], s29 offen offset:2048   lds
M v[124:127], a[88:91], a[168:171], v[124:127]
 s_barrier
M v[160:163], a[32:35], a[160:163], 0
 ds_read_b128 a[168:171], v5 offset:6144
 ds_read_b128 a[172:175], v6 offset:6144
M v[160:163], a[36:39], a[164:167], v[160:163]
 ds_read_b64_tr_b16 a[128:129], v1 offset:49152
 ds_read_b64_tr_b16 a[130:131], v1 offset:50176
M v[164:167], a[44:47], a[164:167], 0
 v_cvt_pk_bf16_f32 v214, v244, v245
 v_cvt_pk_bf16_f32 v215, v246, v247
M v[164:167], a[40:43], a[160:163], v[164:167]
 buffer_load_dwordx4 v19, s[56:59], s29 offen offset:3072   lds
M v[168:171], a[48:51], a[160:163], 0
 s_add_u32 s29, s29, 128
 ds_read_b64_tr_b16 a[132:133], v1 offset:57344
 ds_read_b64_tr_b16 a[134:135], v1 offset:58368
M v[168:171], a[52:55], a[164:167], v[168:171]
 v_cvt_pk_bf16_f32 v216, v216, v217
 v_cvt_pk_bf16_f32 v217, v218, v219
M v[172:175], a[60:63], a[164:167], 0
 v_cvt_pk_bf16_f32 v218, v248, v249
 v_cvt_pk_bf16_f32 v219, v250, v251
M v[172:175], a[56:59], a[160:163], v[172:175]
 s_add_u32 m0, s23, 32768
 ds_read_b64_tr_b16 a[136:137], v2 offset:49152
 ds_read_b64_tr_b16 a[138:139], v2 offset:50176
M v[176:179], a[64:67], a[160:163], 0
 buffer_load_dwordx4 v8, s[52:55], s28 offen offset:0   lds
M v[176:179], a[68:71], a[164:167], v[176:179]
 v_cvt_pk_bf16_f32 v220, v220, v221
 v_cvt_pk_bf16_f32 v221, v222, v223
M v[180:183], a[76:79], a[164:167], 0
 ds_read_b64_tr_b16 a[140:141], v2 offset:57344
 ds_read_b64_tr_b16 a[142:143], v2 offset:58368
M v[180:183], a[72:75], a[160:163], v[180:183]
 v_cvt_pk_bf16_f32 v222, v252, v253
 v_cvt_pk_bf16_f32 v223, v254, v255
M v[184:187], a[80:83], a[160:163], 0
 s_add_u32 s3, s93, 262144
 v_mov_b32 v12, 1
 v_or_b32 v15, s20, v0
M v[184:187], a[84:87], a[164:167], v[184:187]
 s_waitcnt lgkmcnt(8)
 ds_read_b64_tr_b16 a[144:145], v3 offset:49152
 ds_read_b64_tr_b16 a[146:147], v3 offset:50176
M v[188:191], a[92:95], a[164:167], 0
 buffer_load_dwordx4 v9, s[52:55], s28 offen offset:1024   lds
M v[188:191], a[88:91], a[160:163], v[188:191]
 v_min_u32 v15, 1, v15
 v_lshlrev_b32 v15, 29, v15
M v[224:227], a[32:35], a[168:171], 0
 ds_read_b128 a[160:163], v5 offset:16384
 ds_read_b128 a[164:167], v6 offset:16384
M v[224:227], a[36:39], a[172:175], v[224:227]
 ds_read_b64_tr_b16 a[148:149], v3 offset:57344
 ds_read_b64_tr_b16 a[150:151], v3 offset:58368
M v[228:231], a[44:47], a[172:175], 0
 buffer_load_dwordx4 v10, s[52:55], s28 offen offset:2048   lds
M v[228:231], a[40:43], a[168:171], v[228:231]
 ds_read_b64_tr_b16 a[152:153], v4 offset:49152
 ds_read_b64_tr_b16 a[154:155], v4 offset:50176
M v[232:235], a[48:51], a[168:171], 0
 buffer_store_dwordx4 v[64:67], v7, s[8:11], s3 offen offset:0 sc1
M v[232:235], a[52:55], a[172:175], v[232:235]
M v[236:239], a[60:63], a[172:175], 0
 ds_read_b64_tr_b16 a[156:157], v4 offset:57344
 ds_read_b64_tr_b16 a[158:159], v4 offset:58368
M v[236:239], a[56:59], a[168:171], v[236:239]
 buffer_load_dwordx4 v11, s[52:55], s28 offen offset:3072   lds
M v[240:243], a[64:67], a[168:171], 0
 s_add_u32 s28, s28, 128
M v[240:243], a[68:71], a[172:175], v[240:243]
 buffer_store_dwordx4 v[68:71], v7, s[8:11], s3 offen offset:2048 sc1
M v[244:247], a[76:79], a[172:175], 0
M v[244:247], a[72:75], a[168:171], v[244:247]
M v[248:251], a[80:83], a[168:171], 0
M v[248:251], a[84:87], a[172:175], v[248:251]
 s_waitcnt lgkmcnt(6)
M v[252:255], a[92:95], a[172:175], 0
 s_waitcnt vmcnt(14) lgkmcnt(0)
M v[252:255], a[88:91], a[168:171], v[252:255]
 s_barrier
M v[32:35], a[96:99], a[160:163], v[32:35]
 s_add_u32 m0, s23, 49152
 ds_read_b128 a[168:171], v5 offset:18432
 ds_read_b128 a[172:175], v6 offset:18432
M v[32:35], a[100:103], a[164:167], v[32:35]
 ds_read_b64_tr_b16 a[32:33], v20 offset:0
 ds_read_b64_tr_b16 a[34:35], v20 offset:1024
M v[36:39], a[108:111], a[164:167], v[36:39]
 s_mov_b32 s39, 1347
 buffer_load_dwordx4 v8, s[52:55], s28 offen offset:0   lds
M v[36:39], a[104:107], a[160:163], v[36:39]
 s_cmp_lt_u32 s42, 2
 buffer_store_dword v12, v15, s[8:11], s45 offen sc1
M v[40:43], a[112:115], a[160:163], v[40:43]
 s_cselect_b32 s39, 1284, s39
 ds_read_b64_tr_b16 a[36:37], v20 offset:8192
 ds_read_b64_tr_b16 a[38:39], v20 offset:9216
M v[40:43], a[116:119], a[164:167], v[40:43]
 s_lshl_b32 s64, s20, 14
 buffer_load_dwordx4 v9, s[52:55], s28 offen offset:1024   lds
M v[44:47], a[124:127], a[164:167], v[44:47]
 s_add_u32 s12, s64, s34
 s_add_u32 s3, s93, 266240
M v[44:47], a[120:123], a[160:163], v[44:47]
 s_add_u32 s13, s12, 4096
 ds_read_b64_tr_b16 a[40:41], v21 offset:0
 ds_read_b64_tr_b16 a[42:43], v21 offset:1024
M v[48:51], a[128:131], a[160:163], v[48:51]
 s_add_u32 s14, s12, 8192
 buffer_store_dwordx4 v[72:75], v7, s[8:11], s3 offen offset:0 sc1
M v[48:51], a[132:135], a[164:167], v[48:51]
 s_add_u32 s15, s12, 12288
M v[52:55], a[140:143], a[164:167], v[52:55]
 ds_read_b64_tr_b16 a[44:45], v21 offset:8192
 ds_read_b64_tr_b16 a[46:47], v21 offset:9216
M v[52:55], a[136:139], a[160:163], v[52:55]
 buffer_load_dwordx4 v10, s[52:55], s28 offen offset:2048   lds
M v[56:59], a[144:147], a[160:163], v[56:59]
M v[56:59], a[148:151], a[164:167], v[56:59]
 s_waitcnt lgkmcnt(8)
 ds_read_b64_tr_b16 a[48:49], v22 offset:0
 ds_read_b64_tr_b16 a[50:51], v22 offset:1024
M v[60:63], a[156:159], a[164:167], v[60:63]
M v[60:63], a[152:155], a[160:163], v[60:63]
 buffer_load_dwordx4 v11, s[52:55], s28 offen offset:3072   lds
M v[96:99], a[96:99], a[168:171], v[96:99]
 s_add_u32 s28, s28, 524160
 ds_read_b128 a[160:163], v5 offset:20480
 ds_read_b128 a[164:167], v6 offset:20480
M v[96:99], a[100:103], a[172:175], v[96:99]
 ds_read_b64_tr_b16 a[52:53], v22 offset:8192
 ds_read_b64_tr_b16 a[54:55], v22 offset:9216
M v[100:103], a[108:111], a[172:175], v[100:103]
M v[100:103], a[104:107], a[168:171], v[100:103]
 s_add_u32 m0, s24, 0
 ds_read_b64_tr_b16 a[56:57], v23 offset:0
 ds_read_b64_tr_b16 a[58:59], v23 offset:1024
M v[104:107], a[112:115], a[168:171], v[104:107]
 buffer_load_dwordx4 v16, s[56:59], s29 offen offset:0   lds
M v[104:107], a[116:119], a[172:175], v[104:107]
M v[108:111], a[124:127], a[172:175], v[108:111]
 ds_read_b64_tr_b16 a[60:61], v23 offset:8192
 ds_read_b64_tr_b16 a[62:63], v23 offset:9216
M v[108:111], a[120:123], a[168:171], v[108:111]
M v[112:115], a[128:131], a[168:171], v[112:115]
M v[112:115], a[132:135], a[172:175], v[112:115]
 buffer_load_dwordx4 v17, s[56:59], s29 offen offset:1024   lds
M v[116:119], a[140:143], a[172:175], v[116:119]
M v[116:119], a[136:139], a[168:171], v[116:119]
M v[120:123], a[144:147], a[168:171], v[120:123]
M v[120:123], a[148:151], a[172:175], v[120:123]
 s_waitcnt lgkmcnt(6)
M v[124:127], a[156:159], a[172:175], v[124:127]
 s_waitcnt lgkmcnt(0)
 buffer_load_dwordx4 v18, s[56:59], s29 offen offset:2048   lds
M v[124:127], a[152:155], a[168:171], v[124:127]
 s_barrier
M v[160:163], a[96:99], a[160:163], v[160:163]
 ds_read_b128 a[168:171], v5 offset:22528
 ds_read_b128 a[172:175], v6 offset:22528
M v[160:163], a[100:103], a[164:167], v[160:163]
 ds_read_b64_tr_b16 a[64:65], v20 offset:16384
 ds_read_b64_tr_b16 a[66:67], v20 offset:17408
M v[164:167], a[108:111], a[164:167], v[164:167]
M v[164:167], a[104:107], a[160:163], v[164:167]
 buffer_load_dwordx4 v19, s[56:59], s29 offen offset:3072   lds
M v[168:171], a[112:115], a[160:163], v[168:171]
 s_add_u32 s29, s29, 128
 ds_read_b64_tr_b16 a[68:69], v20 offset:24576
 ds_read_b64_tr_b16 a[70:71], v20 offset:25600
M v[168:171], a[116:119], a[164:167], v[168:171]
 buffer_store_dwordx4 v[76:79], v7, s[8:11], s3 offen offset:2048 sc1
M v[172:175], a[124:127], a[164:167], v[172:175]
M v[172:175], a[120:123], a[160:163], v[172:175]
 s_add_u32 m0, s23, 131072
 ds_read_b64_tr_b16 a[72:73], v21 offset:16384
 ds_read_b64_tr_b16 a[74:75], v21 offset:17408
M v[176:179], a[128:131], a[160:163], v[176:179]
 buffer_load_dwordx4 v8, s[52:55], s28 offen offset:0   lds
M v[176:179], a[132:135], a[164:167], v[176:179]
M v[180:183], a[140:143], a[164:167], v[180:183]
 ds_read_b64_tr_b16 a[76:77], v21 offset:24576
 ds_read_b64_tr_b16 a[78:79], v21 offset:25600
M v[180:183], a[136:139], a[160:163], v[180:183]
M v[184:187], a[144:147], a[160:163], v[184:187]
M v[184:187], a[148:151], a[164:167], v[184:187]
 s_waitcnt lgkmcnt(8)
 ds_read_b64_tr_b16 a[80:81], v22 offset:16384
 ds_read_b64_tr_b16 a[82:83], v22 offset:17408
M v[188:191], a[156:159], a[164:167], v[188:191]
 buffer_load_dwordx4 v9, s[52:55], s28 offen offset:1024   lds
M v[188:191], a[152:155], a[160:163], v[188:191]
M v[224:227], a[96:99], a[168:171], v[224:227]
 ds_read_b128 a[160:163], v5 offset:32768
 ds_read_b128 a[164:167], v6 offset:32768
M v[224:227], a[100:103], a[172:175], v[224:227]
 ds_read_b64_tr_b16 a[84:85], v22 offset:24576
 ds_read_b64_tr_b16 a[86:87], v22 offset:25600
M v[228:231], a[108:111], a[172:175], v[228:231]
 buffer_load_dwordx4 v10, s[52:55], s28 offen offset:2048   lds
M v[228:231], a[104:107], a[168:171], v[228:231]
 ds_read_b64_tr_b16 a[88:89], v23 offset:16384
 ds_read_b64_tr_b16 a[90:91], v23 offset:17408
M v[232:235], a[112:115], a[168:171], v[232:235]
M v[232:235], a[116:119], a[172:175], v[232:235]
M v[236:239], a[124:127], a[172:175], v[236:239]
 ds_read_b64_tr_b16 a[92:93], v23 offset:24576
 ds_read_b64_tr_b16 a[94:95], v23 offset:25600
M v[236:239], a[120:123], a[168:171], v[236:239]
 buffer_load_dwordx4 v11, s[52:55], s28 offen offset:3072   lds
M v[240:243], a[128:131], a[168:171], v[240:243]
 s_add_u32 s28, s28, 128
M v[240:243], a[132:135], a[172:175], v[240:243]
M v[244:247], a[140:143], a[172:175], v[244:247]
M v[244:247], a[136:139], a[168:171], v[244:247]
M v[248:251], a[144:147], a[168:171], v[248:251]
M v[248:251], a[148:151], a[172:175], v[248:251]
 s_waitcnt lgkmcnt(6)
M v[252:255], a[156:159], a[172:175], v[252:255]
 s_waitcnt lgkmcnt(0)
M v[252:255], a[152:155], a[168:171], v[252:255]
 s_barrier
M v[32:35], a[32:35], a[160:163], v[32:35]
 s_add_u32 m0, s23, 147456
 ds_read_b128 a[168:171], v5 offset:34816
 ds_read_b128 a[172:175], v6 offset:34816
M v[32:35], a[36:39], a[164:167], v[32:35]
 ds_read_b64_tr_b16 a[96:97], v1 offset:0
 ds_read_b64_tr_b16 a[98:99], v1 offset:1024
M v[36:39], a[44:47], a[164:167], v[36:39]
 buffer_load_dwordx4 v8, s[52:55], s28 offen offset:0   lds
M v[36:39], a[40:43], a[160:163], v[36:39]
 v_and_b32 v29, 15, v0
 v_mul_u32_u24 v30, 1792, v29
M v[40:43], a[48:51], a[160:163], v[40:43]
 s_add_u32 s3, s93, 270336
 ds_read_b64_tr_b16 a[100:101], v1 offset:8192
 ds_read_b64_tr_b16 a[102:103], v1 offset:9216
M v[40:43], a[52:55], a[164:167], v[40:43]
 buffer_load_dwordx4 v9, s[52:55], s28 offen offset:1024   lds
M v[44:47], a[60:63], a[164:167], v[44:47]
 v_lshrrev_b32 v31, 4, v0
 v_lshl_add_u32 v30, v31, 4, v30
M v[44:47], a[56:59], a[160:163], v[44:47]
 ds_read_b64_tr_b16 a[104:105], v2 offset:0
 ds_read_b64_tr_b16 a[106:107], v2 offset:1024
M v[48:51], a[64:67], a[160:163], v[48:51]
 v_lshrrev_b32 v29, 1, v29
 v_min_u32 v29, 1, v29
M v[48:51], a[68:71], a[164:167], v[48:51]
 v_lshl_or_b32 v30, v29, 29, v30
 v_or_b32 v30, s88, v30
M v[52:55], a[76:79], a[164:167], v[52:55]
 s_mul_i32 s89, s86, 3584
 ds_read_b64_tr_b16 a[108:109], v2 offset:8192
 ds_read_b64_tr_b16 a[110:111], v2 offset:9216
M v[52:55], a[72:75], a[160:163], v[52:55]
 s_mul_i32 s64, s20, 448
 buffer_load_dwordx4 v10, s[52:55], s28 offen offset:2048   lds
M v[56:59], a[80:83], a[160:163], v[56:59]
 s_add_u32 s89, s89, s64
 s_add_u32 s89, s89, 105906176
M v[56:59], a[84:87], a[164:167], v[56:59]
 s_waitcnt lgkmcnt(8)
 ds_read_b64_tr_b16 a[112:113], v3 offset:0
 ds_read_b64_tr_b16 a[114:115], v3 offset:1024
M v[60:63], a[92:95], a[164:167], v[60:63]
 buffer_store_dwordx4 v[80:83], v7, s[8:11], s3 offen offset:0 sc1
M v[60:63], a[88:91], a[160:163], v[60:63]
 buffer_load_dwordx4 v11, s[52:55], s28 offen offset:3072   lds
M v[96:99], a[32:35], a[168:171], v[96:99]
 s_add_u32 s28, s28, 524160
 ds_read_b128 a[160:163], v5 offset:36864
 ds_read_b128 a[164:167], v6 offset:36864
M v[96:99], a[36:39], a[172:175], v[96:99]
 ds_read_b64_tr_b16 a[116:117], v3 offset:8192
 ds_read_b64_tr_b16 a[118:119], v3 offset:9216
M v[100:103], a[44:47], a[172:175], v[100:103]
M v[100:103], a[40:43], a[168:171], v[100:103]
 s_add_u32 m0, s24, 16384
 ds_read_b64_tr_b16 a[120:121], v4 offset:0
 ds_read_b64_tr_b16 a[122:123], v4 offset:1024
M v[104:107], a[48:51], a[168:171], v[104:107]
 buffer_load_dwordx4 v16, s[56:59], s29 offen offset:0   lds
M v[104:107], a[52:55], a[172:175], v[104:107]
M v[108:111], a[60:63], a[172:175], v[108:111]
 ds_read_b64_tr_b16 a[124:125], v4 offset:8192
 ds_read_b64_tr_b16 a[126:127], v4 offset:9216
M v[108:111], a[56:59], a[168:171], v[108:111]
M v[112:115], a[64:67], a[168:171], v[112:115]
M v[112:115], a[68:71], a[172:175], v[112:115]
 buffer_load_dwordx4 v17, s[56:59], s29 offen offset:1024   lds
M v[116:119], a[76:79], a[172:175], v[116:119]
M v[116:119], a[72:75], a[168:171], v[116:119]
M v[120:123], a[80:83], a[168:171], v[120:123]
M v[120:123], a[84:87], a[172:175], v[120:123]
 s_waitcnt lgkmcnt(6)
M v[124:127], a[92:95], a[172:175], v[124:127]
 s_waitcnt vmcnt(28) lgkmcnt(0)
 buffer_load_dwordx4 v18, s[56:59], s29 offen offset:2048   lds
M v[124:127], a[88:91], a[168:171], v[124:127]
 s_barrier
M v[160:163], a[32:35], a[160:163], v[160:163]
 ds_read_b128 a[168:171], v5 offset:38912
 ds_read_b128 a[172:175], v6 offset:38912
M v[160:163], a[36:39], a[164:167], v[160:163]
 ds_read_b64_tr_b16 a[128:129], v1 offset:16384
 ds_read_b64_tr_b16 a[130:131], v1 offset:17408
M v[164:167], a[44:47], a[164:167], v[164:167]
M v[164:167], a[40:43], a[160:163], v[164:167]
 buffer_load_dwordx4 v19, s[56:59], s29 offen offset:3072   lds
M v[168:171], a[48:51], a[160:163], v[168:171]
 s_add_u32 s29, s29, 128
 ds_read_b64_tr_b16 a[132:133], v1 offset:24576
 ds_read_b64_tr_b16 a[134:135], v1 offset:25600
M v[168:171], a[52:55], a[164:167], v[168:171]
 buffer_store_dwordx4 v[84:87], v7, s[8:11], s3 offen offset:2048 sc1
M v[172:175], a[60:63], a[164:167], v[172:175]
M v[172:175], a[56:59], a[160:163], v[172:175]
 s_add_u32 m0, s23, 0
 ds_read_b64_tr_b16 a[136:137], v2 offset:16384
 ds_read_b64_tr_b16 a[138:139], v2 offset:17408
M v[176:179], a[64:67], a[160:163], v[176:179]
 buffer_load_dwordx4 v8, s[52:55], s28 offen offset:0   lds
M v[176:179], a[68:71], a[164:167], v[176:179]
M v[180:183], a[76:79], a[164:167], v[180:183]
 ds_read_b64_tr_b16 a[140:141], v2 offset:24576
 ds_read_b64_tr_b16 a[142:143], v2 offset:25600
M v[180:183], a[72:75], a[160:163], v[180:183]
M v[184:187], a[80:83], a[160:163], v[184:187]
M v[184:187], a[84:87], a[164:167], v[184:187]
 s_waitcnt lgkmcnt(8)
 ds_read_b64_tr_b16 a[144:145], v3 offset:16384
 ds_read_b64_tr_b16 a[146:147], v3 offset:17408
M v[188:191], a[92:95], a[164:167], v[188:191]
 buffer_load_dwordx4 v9, s[52:55], s28 offen offset:1024   lds
M v[188:191], a[88:91], a[160:163], v[188:191]
M v[224:227], a[32:35], a[168:171], v[224:227]
 ds_read_b128 a[160:163], v5 offset:49152
 ds_read_b128 a[164:167], v6 offset:49152
M v[224:227], a[36:39], a[172:175], v[224:227]
 ds_read_b64_tr_b16 a[148:149], v3 offset:24576
 ds_read_b64_tr_b16 a[150:151], v3 offset:25600
M v[228:231], a[44:47], a[172:175], v[228:231]
 buffer_load_dwordx4 v10, s[52:55], s28 offen offset:2048   lds
M v[228:231], a[40:43], a[168:171], v[228:231]
 ds_read_b64_tr_b16 a[152:153], v4 offset:16384
 ds_read_b64_tr_b16 a[154:155], v4 offset:17408
M v[232:235], a[48:51], a[168:171], v[232:235]
M v[232:235], a[52:55], a[172:175], v[232:235]
M v[236:239], a[60:63], a[172:175], v[236:239]
 ds_read_b64_tr_b16 a[156:157], v4 offset:24576
 ds_read_b64_tr_b16 a[158:159], v4 offset:25600
M v[236:239], a[56:59], a[168:171], v[236:239]
 buffer_load_dwordx4 v11, s[52:55], s28 offen offset:3072   lds
M v[240:243], a[64:67], a[168:171], v[240:243]
 s_add_u32 s28, s28, 128
M v[240:243], a[68:71], a[172:175], v[240:243]
M v[244:247], a[76:79], a[172:175], v[244:247]
M v[244:247], a[72:75], a[168:171], v[244:247]
M v[248:251], a[80:83], a[168:171], v[248:251]
M v[248:251], a[84:87], a[172:175], v[248:251]
 s_waitcnt lgkmcnt(6)
M v[252:255], a[92:95], a[172:175], v[252:255]
 s_waitcnt vmcnt(30) lgkmcnt(0)
M v[252:255], a[88:91], a[168:171], v[252:255]
 s_barrier
M v[32:35], a[96:99], a[160:163], v[32:35]
 s_add_u32 m0, s23, 16384
 ds_read_b128 a[168:171], v5 offset:51200
 ds_read_b128 a[172:175], v6 offset:51200
M v[32:35], a[100:103], a[164:167], v[32:35]
 ds_read_b64_tr_b16 a[32:33], v1 offset:32768
 ds_read_b64_tr_b16 a[34:35], v1 offset:33792
M v[36:39], a[108:111], a[164:167], v[36:39]
 buffer_load_dwordx4 v8, s[52:55], s28 offen offset:0   lds
M v[36:39], a[104:107], a[160:163], v[36:39]
 v_min_u32 v25, 15, v0
 v_lshlrev_b32 v25, 7, v25
M v[40:43], a[112:115], a[160:163], v[40:43]
 s_add_u32 s3, s93, 274432
 ds_read_b64_tr_b16 a[36:37], v1 offset:40960
 ds_read_b64_tr_b16 a[38:39], v1 offset:41984
M v[40:43], a[116:119], a[164:167], v[40:43]
 v_max_u32 v13, 1024, v25
M v[44:47], a[124:127], a[164:167], v[44:47]
 buffer_store_dwordx4 v[88:91], v7, s[8:11], s3 offen offset:0 sc1
M v[44:47], a[120:123], a[160:163], v[44:47]
 ds_read_b64_tr_b16 a[40:41], v2 offset:32768
 ds_read_b64_tr_b16 a[42:43], v2 offset:33792
M v[48:51], a[128:131], a[160:163], v[48:51]
 buffer_load_dwordx4 v9, s[52:55], s28 offen offset:1024   lds
M v[48:51], a[132:135], a[164:167], v[48:51]
M v[52:55], a[140:143], a[164:167], v[52:55]
 ds_read_b64_tr_b16 a[44:45], v2 offset:40960
 ds_read_b64_tr_b16 a[46:47], v2 offset:41984
M v[52:55], a[136:139], a[160:163], v[52:55]
M v[56:59], a[144:147], a[160:163], v[56:59]
M v[56:59], a[148:151], a[164:167], v[56:59]
 s_waitcnt lgkmcnt(8)
 ds_read_b64_tr_b16 a[48:49], v3 offset:32768
 ds_read_b64_tr_b16 a[50:51], v3 offset:33792
M v[60:63], a[156:159], a[164:167], v[60:63]
 buffer_load_dwordx4 v10, s[52:55], s28 offen offset:2048   lds
M v[60:63], a[152:155], a[160:163], v[60:63]
M v[96:99], a[96:99], a[168:171], v[96:99]
 ds_read_b128 a[160:163], v5 offset:53248
 ds_read_b128 a[164:167], v6 offset:53248
M v[96:99], a[100:103], a[172:175], v[96:99]
 ds_read_b64_tr_b16 a[52:53], v3 offset:40960
 ds_read_b64_tr_b16 a[54:55], v3 offset:41984
M v[100:103], a[108:111], a[172:175], v[100:103]
 buffer_store_dwordx4 v[92:95], v7, s[8:11], s3 offen offset:2048 sc1
M v[100:103], a[104:107], a[168:171], v[100:103]
 ds_read_b64_tr_b16 a[56:57], v4 offset:32768
 ds_read_b64_tr_b16 a[58:59], v4 offset:33792
M v[104:107], a[112:115], a[168:171], v[104:107]
M v[104:107], a[116:119], a[172:175], v[104:107]
 buffer_load_dwordx4 v11, s[52:55], s28 offen offset:3072   lds
M v[108:111], a[124:127], a[172:175], v[108:111]
 s_add_u32 s28, s28, 524160
 ds_read_b64_tr_b16 a[60:61], v4 offset:40960
 ds_read_b64_tr_b16 a[62:63], v4 offset:41984
M v[108:111], a[120:123], a[168:171], v[108:111]
M v[112:115], a[128:131], a[168:171], v[112:115]
M v[112:115], a[132:135], a[172:175], v[112:115]
M v[116:119], a[140:143], a[172:175], v[116:119]
M v[116:119], a[136:139], a[168:171], v[116:119]
M v[120:123], a[144:147], a[168:171], v[120:123]
M v[120:123], a[148:151], a[172:175], v[120:123]
 s_waitcnt lgkmcnt(6)
M v[124:127], a[156:159], a[172:175], v[124:127]
 s_waitcnt vmcnt(25) lgkmcnt(0)
M v[124:127], a[152:155], a[168:171], v[124:127]
 s_barrier
M v[160:163], a[96:99], a[160:163], v[160:163]
 ds_read_b128 a[168:171], v5 offset:55296
 ds_read_b128 a[172:175], v6 offset:55296
M v[160:163], a[100:103], a[164:167], v[160:163]
 ds_read_b64_tr_b16 a[64:65], v1 offset:49152
 ds_read_b64_tr_b16 a[66:67], v1 offset:50176
M v[164:167], a[108:111], a[164:167], v[164:167]
 buffer_store_dwordx4 a[208:211], v30, s[8:11], s89 offen offset:0 sc1
M v[164:167], a[104:107], a[160:163], v[164:167]
M v[168:171], a[112:115], a[160:163], v[168:171]
 ds_read_b64_tr_b16 a[68:69], v1 offset:57344
 ds_read_b64_tr_b16 a[70:71], v1 offset:58368
M v[168:171], a[116:119], a[164:167], v[168:171]
M v[172:175], a[124:127], a[164:167], v[172:175]
M v[172:175], a[120:123], a[160:163], v[172:175]
 ds_read_b64_tr_b16 a[72:73], v2 offset:49152
 ds_read_b64_tr_b16 a[74:75], v2 offset:50176
M v[176:179], a[128:131], a[160:163], v[176:179]
M v[176:179], a[132:135], a[164:167], v[176:179]
M v[180:183], a[140:143], a[164:167], v[180:183]
 ds_read_b64_tr_b16 a[76:77], v2 offset:57344
 ds_read_b64_tr_b16 a[78:79], v2 offset:58368
M v[180:183], a[136:139], a[160:163], v[180:183]
M v[184:187], a[144:147], a[160:163], v[184:187]
M v[184:187], a[148:151], a[164:167], v[184:187]
 s_waitcnt lgkmcnt(8)
 ds_read_b64_tr_b16 a[80:81], v3 offset:49152
 ds_read_b64_tr_b16 a[82:83], v3 offset:50176
M v[188:191], a[156:159], a[164:167], v[188:191]
 buffer_store_dwordx4 a[212:215], v30, s[8:11], s89 offen offset:64 sc1
M v[188:191], a[152:155], a[160:163], v[188:191]
M v[224:227], a[96:99], a[168:171], v[224:227]
 ds_read_b128 a[160:163], v5 offset:0
 ds_read_b128 a[164:167], v6 offset:0
M v[224:227], a[100:103], a[172:175], v[224:227]
 ds_read_b64_tr_b16 a[84:85], v3 offset:57344
 ds_read_b64_tr_b16 a[86:87], v3 offset:58368
M v[228:231], a[108:111], a[172:175], v[228:231]
M v[228:231], a[104:107], a[168:171], v[228:231]
 ds_read_b64_tr_b16 a[88:89], v4 offset:49152
 ds_read_b64_tr_b16 a[90:91], v4 offset:50176
M v[232:235], a[112:115], a[168:171], v[232:235]
M v[232:235], a[116:119], a[172:175], v[232:235]
M v[236:239], a[124:127], a[172:175], v[236:239]
 ds_read_b64_tr_b16 a[92:93], v4 offset:57344
 ds_read_b64_tr_b16 a[94:95], v4 offset:58368
M v[236:239], a[120:123], a[168:171], v[236:239]
M v[240:243], a[128:131], a[168:171], v[240:243]
M v[240:243], a[132:135], a[172:175], v[240:243]
M v[244:247], a[140:143], a[172:175], v[244:247]
M v[244:247], a[136:139], a[168:171], v[244:247]
M v[248:251], a[144:147], a[168:171], v[248:251]
M v[248:251], a[148:151], a[172:175], v[248:251]
 s_waitcnt lgkmcnt(6)
M v[252:255], a[156:159], a[172:175], v[252:255]
 s_waitcnt vmcnt(22) lgkmcnt(0)
M v[252:255], a[152:155], a[168:171], v[252:255]
 s_barrier
M v[32:35], a[32:35], a[160:163], v[32:35]
 s_add_u32 m0, s23, 32768
 ds_read_b128 a[168:171], v5 offset:2048
 ds_read_b128 a[172:175], v6 offset:2048
M v[32:35], a[36:39], a[164:167], v[32:35]
 ds_read_b64_tr_b16 a[96:97], v20 offset:0
 ds_read_b64_tr_b16 a[98:99], v20 offset:1024
M v[36:39], a[44:47], a[164:167], v[36:39]
 buffer_load_dwordx4 v16, s[56:59], s29 offen offset:0   lds
M v[36:39], a[40:43], a[160:163], v[36:39]
 buffer_store_dwordx4 a[216:219], v30, s[8:11], s89 offen offset:128 sc1
M v[40:43], a[48:51], a[160:163], v[40:43]
 ds_read_b64_tr_b16 a[100:101], v20 offset:8192
 ds_read_b64_tr_b16 a[102:103], v20 offset:9216
M v[40:43], a[52:55], a[164:167], v[40:43]
 buffer_load_dwordx4 v17, s[56:59], s29 offen offset:1024   lds
M v[44:47], a[60:63], a[164:167], v[44:47]
M v[44:47], a[56:59], a[160:163], v[44:47]
 ds_read_b64_tr_b16 a[104:105], v21 offset:0
 ds_read_b64_tr_b16 a[106:107], v21 offset:1024
M v[48:51], a[64:67], a[160:163], v[48:51]
M v[48:51], a[68:71], a[164:167], v[48:51]
 buffer_load_dwordx4 v18, s[56:59], s29 offen offset:2048   lds
M v[52:55], a[76:79], a[164:167], v[52:55]
 ds_read_b64_tr_b16 a[108:109], v21 offset:8192
 ds_read_b64_tr_b16 a[110:111], v21 offset:9216
M v[52:55], a[72:75], a[160:163], v[52:55]
 buffer_store_dwordx4 a[220:223], v30, s[8:11], s89 offen offset:192 sc1
M v[56:59], a[80:83], a[160:163], v[56:59]
M v[56:59], a[84:87], a[164:167], v[56:59]
 s_waitcnt lgkmcnt(8)
 ds_read_b64_tr_b16 a[112:113], v22 offset:0
 ds_read_b64_tr_b16 a[114:115], v22 offset:1024
M v[60:63], a[92:95], a[164:167], v[60:63]
 buffer_load_dwordx4 v19, s[56:59], s29 offen offset:3072   lds
M v[60:63], a[88:91], a[160:163], v[60:63]
 s_add_u32 s29, s29, 128
M v[96:99], a[32:35], a[168:171], v[96:99]
 ds_read_b128 a[160:163], v5 offset:4096
 ds_read_b128 a[164:167], v6 offset:4096
M v[96:99], a[36:39], a[172:175], v[96:99]
 ds_read_b64_tr_b16 a[116:117], v22 offset:8192
 ds_read_b64_tr_b16 a[118:119], v22 offset:9216
M v[100:103], a[44:47], a[172:175], v[100:103]
 s_lshl_b32 s28, s20, 13
 buffer_store_dwordx4 a[224:227], v30, s[8:11], s89 offen offset:256 sc1
M v[100:103], a[40:43], a[168:171], v[100:103]
 s_lshl_b32 s21, s41, 20
 ds_read_b64_tr_b16 a[120:121], v23 offset:0
 ds_read_b64_tr_b16 a[122:123], v23 offset:1024
M v[104:107], a[48:51], a[168:171], v[104:107]
 s_mov_b32 s22, 0
M v[104:107], a[52:55], a[172:175], v[104:107]
 s_lshl_b32 s7, s41, 18
M v[108:111], a[60:63], a[172:175], v[108:111]
 s_add_u32 s7, s7, 100663296
 ds_read_b64_tr_b16 a[124:125], v23 offset:8192
 ds_read_b64_tr_b16 a[126:127], v23 offset:9216
M v[108:111], a[56:59], a[168:171], v[108:111]
 s_add_u32 s38, s7, 65536
 buffer_store_dwordx4 a[228:231], v30, s[8:11], s89 offen offset:320 sc1
M v[112:115], a[64:67], a[168:171], v[112:115]
 s_sub_u32 s27, s42, 1
M v[112:115], a[68:71], a[172:175], v[112:115]
 s_mov_b32 s43, 32767
M v[116:119], a[76:79], a[172:175], v[116:119]
 s_mov_b32 s4, 0
 buffer_load_dword v24, v13, s[8:11], s46 offen sc1
M v[116:119], a[72:75], a[168:171], v[116:119]
 s_add_u32 s26, s21, 655360
 buffer_store_dwordx4 a[232:235], v30, s[8:11], s89 offen offset:384 sc1
M v[120:123], a[80:83], a[168:171], v[120:123]
 s_lshl_b32 s64, s42, 1
 s_add_u32 s65, s64, 4
 s_add_u32 s64, s64, 2
M v[120:123], a[84:87], a[172:175], v[120:123]
 s_waitcnt lgkmcnt(6)
 s_add_u32 s3, s93, 524288
M v[124:127], a[92:95], a[172:175], v[124:127]
 s_waitcnt vmcnt(23) lgkmcnt(0)
M v[124:127], a[88:91], a[168:171], v[124:127]
 s_barrier
M v[160:163], a[32:35], a[160:163], v[160:163]
 s_cmp_le_u32 s42, 5
 ds_read_b128 a[168:171], v5 offset:6144
 ds_read_b128 a[172:175], v6 offset:6144
M v[160:163], a[36:39], a[164:167], v[160:163]
 s_cselect_b32 s25, s65, 32767
 ds_read_b64_tr_b16 a[128:129], v20 offset:16384
 ds_read_b64_tr_b16 a[130:131], v20 offset:17408
M v[164:167], a[44:47], a[164:167], v[164:167]
 s_cselect_b32 s6, 14, s64
 buffer_store_dwordx4 v[128:131], v7, s[8:11], s3 offen offset:0 sc1
M v[164:167], a[40:43], a[160:163], v[164:167]
 s_mov_b32 s23, 0
M v[168:171], a[48:51], a[160:163], v[168:171]
 ds_read_b64_tr_b16 a[132:133], v20 offset:24576
 ds_read_b64_tr_b16 a[134:135], v20 offset:25600
M v[168:171], a[52:55], a[164:167], v[168:171]
M v[172:175], a[60:63], a[164:167], v[172:175]
 buffer_store_dwordx4 v[132:135], v7, s[8:11], s3 offen offset:2048 sc1
M v[172:175], a[56:59], a[160:163], v[172:175]
 s_add_u32 s3, s93, 528384
 ds_read_b64_tr_b16 a[136:137], v21 offset:16384
 ds_read_b64_tr_b16 a[138:139], v21 offset:17408
M v[176:179], a[64:67], a[160:163], v[176:179]
M v[176:179], a[68:71], a[164:167], v[176:179]
M v[180:183], a[76:79], a[164:167], v[180:183]
 ds_read_b64_tr_b16 a[140:141], v21 offset:24576
 ds_read_b64_tr_b16 a[142:143], v21 offset:25600
M v[180:183], a[72:75], a[160:163], v[180:183]
 buffer_store_dwordx4 v[136:139], v7, s[8:11], s3 offen offset:0 sc1
M v[184:187], a[80:83], a[160:163], v[184:187]
M v[184:187], a[84:87], a[164:167], v[184:187]
 s_waitcnt lgkmcnt(8)
 ds_read_b64_tr_b16 a[144:145], v22 offset:16384
 ds_read_b64_tr_b16 a[146:147], v22 offset:17408
M v[188:191], a[92:95], a[164:167], v[188:191]
M v[188:191], a[88:91], a[160:163], v[188:191]
 buffer_store_dwordx4 v[140:143], v7, s[8:11], s3 offen offset:2048 sc1
M v[224:227], a[32:35], a[168:171], v[224:227]
 ds_read_b128 a[160:163], v5 offset:16384
 ds_read_b128 a[164:167], v6 offset:16384
M v[224:227], a[36:39], a[172:175], v[224:227]
 s_add_u32 s3, s93, 532480
 ds_read_b64_tr_b16 a[148:149], v22 offset:24576
 ds_read_b64_tr_b16 a[150:151], v22 offset:25600
M v[228:231], a[44:47], a[172:175], v[228:231]
M v[228:231], a[40:43], a[168:171], v[228:231]
 ds_read_b64_tr_b16 a[152:153], v23 offset:16384
 ds_read_b64_tr_b16 a[154:155], v23 offset:17408
M v[232:235], a[48:51], a[168:171], v[232:235]
 buffer_store_dwordx4 v[144:147], v7, s[8:11], s3 offen offset:0 sc1
M v[232:235], a[52:55], a[172:175], v[232:235]
M v[236:239], a[60:63], a[172:175], v[236:239]
 ds_read_b64_tr_b16 a[156:157], v23 offset:24576
 ds_read_b64_tr_b16 a[158:159], v23 offset:25600
M v[236:239], a[56:59], a[168:171], v[236:239]
M v[240:243], a[64:67], a[168:171], v[240:243]
M v[240:243], a[68:71], a[172:175], v[240:243]
M v[244:247], a[76:79], a[172:175], v[244:247]
M v[244:247], a[72:75], a[168:171], v[244:247]
M v[248:251], a[80:83], a[168:171], v[248:251]
M v[248:251], a[84:87], a[172:175], v[248:251]
 s_waitcnt lgkmcnt(6)
M v[252:255], a[92:95], a[172:175], v[252:255]
 s_waitcnt vmcnt(23) lgkmcnt(0)
M v[252:255], a[88:91], a[168:171], v[252:255]
 s_barrier
M v[32:35], a[96:99], a[160:163], v[32:35]
 ds_read_b128 a[168:171], v5 offset:18432
 ds_read_b128 a[172:175], v6 offset:18432
M v[32:35], a[100:103], a[164:167], v[32:35]
 ds_read_b64_tr_b16 a[32:33], v1 offset:0
 ds_read_b64_tr_b16 a[34:35], v1 offset:1024
M v[36:39], a[108:111], a[164:167], v[36:39]
 v_add_u32 v10, s28, v7
 v_add_u32 v11, 0x1000, v10
M v[36:39], a[104:107], a[160:163], v[36:39]
 s_waitcnt vmcnt(6)
 v_cmp_eq_u32 vcc, 0, v24
M v[40:43], a[112:115], a[160:163], v[40:43]
 s_lshl_b32 s64, s20, 10
 ds_read_b64_tr_b16 a[36:37], v1 offset:8192
 ds_read_b64_tr_b16 a[38:39], v1 offset:9216
M v[40:43], a[116:119], a[164:167], v[40:43]
 s_cbranch_vccnz L_f1s04
L_f1r04:
M v[44:47], a[124:127], a[164:167], v[44:47]
 s_add_u32 m0, s28, 98304
 s_nop 0
 buffer_load_dwordx4 v10, s[8:11], s21 offen offset:0 sc1 lds
M v[44:47], a[120:123], a[160:163], v[44:47]
 ds_read_b64_tr_b16 a[40:41], v2 offset:0
 ds_read_b64_tr_b16 a[42:43], v2 offset:1024
M v[48:51], a[128:131], a[160:163], v[48:51]
 buffer_store_dwordx4 v[148:151], v7, s[8:11], s3 offen offset:2048 sc1
M v[48:51], a[132:135], a[164:167], v[48:51]
M v[52:55], a[140:143], a[164:167], v[52:55]
 ds_read_b64_tr_b16 a[44:45], v2 offset:8192
 ds_read_b64_tr_b16 a[46:47], v2 offset:9216
M v[52:55], a[136:139], a[160:163], v[52:55]
 buffer_load_dwordx4 v10, s[8:11], s21 offen offset:1024 sc1 lds
M v[56:59], a[144:147], a[160:163], v[56:59]
M v[56:59], a[148:151], a[164:167], v[56:59]
 s_waitcnt lgkmcnt(8)
 ds_read_b64_tr_b16 a[48:49], v3 offset:0
 ds_read_b64_tr_b16 a[50:51], v3 offset:1024
M v[60:63], a[156:159], a[164:167], v[60:63]
M v[60:63], a[152:155], a[160:163], v[60:63]
 s_add_u32 s3, s93, 536576
 buffer_load_dwordx4 v10, s[8:11], s21 offen offset:2048 sc1 lds
M v[96:99], a[96:99], a[168:171], v[96:99]
 ds_read_b128 a[160:163], v5 offset:20480
 ds_read_b128 a[164:167], v6 offset:20480
M v[96:99], a[100:103], a[172:175], v[96:99]
 ds_read_b64_tr_b16 a[52:53], v3 offset:8192
 ds_read_b64_tr_b16 a[54:55], v3 offset:9216
M v[100:103], a[108:111], a[172:175], v[100:103]
 buffer_store_dwordx4 v[152:155], v7, s[8:11], s3 offen offset:0 sc1
M v[100:103], a[104:107], a[168:171], v[100:103]
 ds_read_b64_tr_b16 a[56:57], v4 offset:0
 ds_read_b64_tr_b16 a[58:59], v4 offset:1024
M v[104:107], a[112:115], a[168:171], v[104:107]
 buffer_load_dwordx4 v10, s[8:11], s21 offen offset:3072 sc1 lds
M v[104:107], a[116:119], a[172:175], v[104:107]
 s_add_u32 m0, s28, 102400
M v[108:111], a[124:127], a[172:175], v[108:111]
 ds_read_b64_tr_b16 a[60:61], v4 offset:8192
 ds_read_b64_tr_b16 a[62:63], v4 offset:9216
M v[108:111], a[120:123], a[168:171], v[108:111]
M v[112:115], a[128:131], a[168:171], v[112:115]
 buffer_load_dwordx4 v11, s[8:11], s21 offen offset:0 sc1 lds
M v[112:115], a[132:135], a[172:175], v[112:115]
M v[116:119], a[140:143], a[172:175], v[116:119]
 buffer_store_dwordx4 v[156:159], v7, s[8:11], s3 offen offset:2048 sc1
M v[116:119], a[136:139], a[168:171], v[116:119]
M v[120:123], a[144:147], a[168:171], v[120:123]
 buffer_load_dwordx4 v11, s[8:11], s21 offen offset:1024 sc1 lds
M v[120:123], a[148:151], a[172:175], v[120:123]
 s_waitcnt lgkmcnt(6)
M v[124:127], a[156:159], a[172:175], v[124:127]
 s_waitcnt lgkmcnt(0)
 buffer_load_dwordx4 v11, s[8:11], s21 offen offset:2048 sc1 lds
M v[124:127], a[152:155], a[168:171], v[124:127]
 s_barrier
M v[160:163], a[96:99], a[160:163], v[160:163]
 ds_read_b128 a[168:171], v5 offset:22528
 ds_read_b128 a[172:175], v6 offset:22528
M v[160:163], a[100:103], a[164:167], v[160:163]
 ds_read_b64_tr_b16 a[64:65], v1 offset:16384
 ds_read_b64_tr_b16 a[66:67], v1 offset:17408
M v[164:167], a[108:111], a[164:167], v[164:167]
 buffer_load_dwordx4 v11, s[8:11], s21 offen offset:3072 sc1 lds
M v[164:167], a[104:107], a[160:163], v[164:167]
 s_add_u32 s24, s23, 16777216
M v[168:171], a[112:115], a[160:163], v[168:171]
 s_mov_b32 s23, s21
 ds_read_b64_tr_b16 a[68:69], v1 offset:24576
 ds_read_b64_tr_b16 a[70:71], v1 offset:25600
M v[168:171], a[116:119], a[164:167], v[168:171]
 s_add_u32 s21, s21, 32768
 s_add_u32 s3, s93, 786432
M v[172:175], a[124:127], a[164:167], v[172:175]
 s_add_u32 s22, s22, 1
 buffer_store_dwordx4 v[192:195], v7, s[8:11], s3 offen offset:0 sc1
M v[172:175], a[120:123], a[160:163], v[172:175]
 s_cmp_eq_u32 s22, s25
 ds_read_b64_tr_b16 a[72:73], v2 offset:16384
 ds_read_b64_tr_b16 a[74:75], v2 offset:17408
M v[176:179], a[128:131], a[160:163], v[176:179]
 s_cselect_b32 s21, s26, s21
 v_subrev_u32 v5, 0x10000, v5
 v_subrev_u32 v6, 0x10000, v6
M v[176:179], a[132:135], a[164:167], v[176:179]
 s_cmp_eq_u32 s22, s43
M v[180:183], a[140:143], a[164:167], v[180:183]
 s_cselect_b32 s21, s4, s21
 ds_read_b64_tr_b16 a[76:77], v2 offset:24576
 ds_read_b64_tr_b16 a[78:79], v2 offset:25600
M v[180:183], a[136:139], a[160:163], v[180:183]
 s_cmp_eq_u32 s22, s6
M v[184:187], a[144:147], a[160:163], v[184:187]
 s_cselect_b32 s21, s7, s21
 v_mov_b32 v9, v25
 v_lshrrev_b32 v24, 4, v0
M v[184:187], a[148:151], a[164:167], v[184:187]
 s_waitcnt lgkmcnt(8)
 ds_read_b64_tr_b16 a[80:81], v3 offset:16384
 ds_read_b64_tr_b16 a[82:83], v3 offset:17408
M v[188:191], a[156:159], a[164:167], v[188:191]
 v_lshlrev_b32 v24, 2, v24
 v_and_b32 v25, 15, v0
M v[188:191], a[152:155], a[160:163], v[188:191]
 v_sub_u32 v24, v24, v25
M v[224:227], a[96:99], a[168:171], v[224:227]
 s_add_u32 s64, s64, s34
 ds_read_b128 a[160:163], v5 offset:32768
 ds_read_b128 a[164:167], v6 offset:32768
M v[224:227], a[100:103], a[172:175], v[224:227]
 s_add_u32 s52, s64, 65536
 ds_read_b64_tr_b16 a[84:85], v3 offset:24576
 ds_read_b64_tr_b16 a[86:87], v3 offset:25600
M v[228:231], a[108:111], a[172:175], v[228:231]
 s_mov_b32 s55, 0x21800000
 buffer_store_dwordx4 v[196:199], v7, s[8:11], s3 offen offset:2048 sc1
M v[228:231], a[104:107], a[168:171], v[228:231]
 s_and_b32 s65, s39, 0
 ds_read_b64_tr_b16 a[88:89], v4 offset:16384
 ds_read_b64_tr_b16 a[90:91], v4 offset:17408
M v[232:235], a[112:115], a[168:171], v[232:235]
 s_cmp_eq_u32 s20, 0
M v[232:235], a[116:119], a[172:175], v[232:235]
 s_cselect_b32 s54, s39, s65
M v[236:239], a[124:127], a[172:175], v[236:239]
 s_lshr_b32 s64, s20, 1
 ds_read_b64_tr_b16 a[92:93], v4 offset:24576
 ds_read_b64_tr_b16 a[94:95], v4 offset:25600
M v[236:239], a[120:123], a[168:171], v[236:239]
 s_lshl_b32 s64, s64, 17
M v[240:243], a[128:131], a[168:171], v[240:243]
 s_and_b32 s65, s20, 1
M v[240:243], a[132:135], a[172:175], v[240:243]
 s_lshl_b32 s65, s65, 12
M v[244:247], a[140:143], a[172:175], v[244:247]
 s_add_u32 s64, s64, s65
 v_add_u32 v14, s64, v7
 v_mov_b32 v8, 0xff800000
M v[244:247], a[136:139], a[168:171], v[244:247]
 v_cmp_lt_i32 s[16:17], 0, v24
 v_cmp_lt_i32 s[18:19], -1, v24
M v[248:251], a[144:147], a[168:171], v[248:251]
 v_cmp_lt_i32 s[48:49], -2, v24
 v_cmp_lt_i32 s[50:51], -3, v24
M v[248:251], a[148:151], a[172:175], v[248:251]
 s_waitcnt lgkmcnt(6)
M v[252:255], a[156:159], a[172:175], v[252:255]
 s_waitcnt lgkmcnt(0)
M v[252:255], a[152:155], a[168:171], v[252:255]
 s_barrier
M v[32:35], a[32:35], a[160:163], v[32:35]
 ds_read_b128 a[168:171], v5 offset:34816
 ds_read_b128 a[172:175], v6 offset:34816
M v[32:35], a[36:39], a[164:167], v[32:35]
 buffer_load_dword v24, v9, s[8:11], s46 offen sc1
M v[36:39], a[44:47], a[164:167], v[36:39]
 v_mov_b32 v1, v15
 v_add_u32 v2, 0x10000, v7
M v[36:39], a[40:43], a[160:163], v[36:39]
 v_mov_b32 v3, v10
 v_mov_b32 v4, v11
M v[40:43], a[48:51], a[160:163], v[40:43]
 s_mov_b64 s[60:61], s[76:77]
M v[40:43], a[52:55], a[164:167], v[40:43]
 s_mov_b32 s62, s78
M v[44:47], a[60:63], a[164:167], v[44:47]
 s_mov_b32 s63, 0x20000
 v_lshl_add_u32 v10, v0, 7, s95
 v_and_b32 v0, 48, v0
M v[44:47], a[56:59], a[160:163], v[44:47]
 v_lshl_add_u32 v0, v0, 24, v10
 v_mul_f32 v32, s5, v32
M v[48:51], a[64:67], a[160:163], v[48:51]
 v_mul_f32 v33, s5, v33
 v_mul_f32 v34, s5, v34
M v[48:51], a[68:71], a[164:167], v[48:51]
 v_mul_f32 v35, s5, v35
 v_mul_f32 v36, s5, v36
M v[52:55], a[76:79], a[164:167], v[52:55]
 v_mul_f32 v37, s5, v37
 v_mul_f32 v38, s5, v38
M v[52:55], a[72:75], a[160:163], v[52:55]
 v_mul_f32 v39, s5, v39
 v_cvt_pk_bf16_f32 v32, v32, v33
M v[56:59], a[80:83], a[160:163], v[56:59]
 v_cvt_pk_bf16_f32 v33, v34, v35
 v_cvt_pk_bf16_f32 v34, v36, v37
M v[56:59], a[84:87], a[164:167], v[56:59]
 s_waitcnt lgkmcnt(0)
 v_cvt_pk_bf16_f32 v35, v38, v39
 ds_write_b128 v14, v[32:35] offset:0
M v[60:63], a[92:95], a[164:167], v[60:63]
 s_add_u32 s3, s93, 790528
 buffer_store_dwordx4 v[200:203], v7, s[8:11], s3 offen offset:0 sc1
M v[60:63], a[88:91], a[160:163], v[60:63]
 v_mul_f32 v40, s5, v40
 v_mul_f32 v41, s5, v41
M v[96:99], a[32:35], a[168:171], v[96:99]
 ds_read_b128 a[160:163], v5 offset:36864
 ds_read_b128 a[164:167], v6 offset:36864
M v[96:99], a[36:39], a[172:175], v[96:99]
 v_mul_f32 v42, s5, v42
 v_mul_f32 v43, s5, v43
M v[100:103], a[44:47], a[172:175], v[100:103]
 v_mul_f32 v44, s5, v44
 v_mul_f32 v45, s5, v45
M v[100:103], a[40:43], a[168:171], v[100:103]
 v_mul_f32 v46, s5, v46
 v_mul_f32 v47, s5, v47
M v[104:107], a[48:51], a[168:171], v[104:107]
 v_cvt_pk_bf16_f32 v40, v40, v41
 v_cvt_pk_bf16_f32 v41, v42, v43
M v[104:107], a[52:55], a[172:175], v[104:107]
 v_cvt_pk_bf16_f32 v42, v44, v45
 v_cvt_pk_bf16_f32 v43, v46, v47
M v[108:111], a[60:63], a[172:175], v[108:111]
 ds_write_b128 v14, v[40:43] offset:1024
M v[108:111], a[56:59], a[168:171], v[108:111]
 buffer_store_dwordx4 v[204:207], v7, s[8:11], s3 offen offset:2048 sc1
M v[112:115], a[64:67], a[168:171], v[112:115]
 v_mul_f32 v48, s5, v48
 v_mul_f32 v49, s5, v49
M v[112:115], a[68:71], a[172:175], v[112:115]
 v_mul_f32 v50, s5, v50
 v_mul_f32 v51, s5, v51
M v[116:119], a[76:79], a[172:175], v[116:119]
 v_mul_f32 v52, s5, v52
 v_mul_f32 v53, s5, v53
M v[116:119], a[72:75], a[168:171], v[116:119]
 v_mul_f32 v54, s5, v54
 v_mul_f32 v55, s5, v55
M v[120:123], a[80:83], a[168:171], v[120:123]
 v_cvt_pk_bf16_f32 v48, v48, v49
 v_cvt_pk_bf16_f32 v49, v50, v51
M v[120:123], a[84:87], a[172:175], v[120:123]
 s_waitcnt lgkmcnt(1)
 v_cvt_pk_bf16_f32 v50, v52, v53
 v_cvt_pk_bf16_f32 v51, v54, v55
M v[124:127], a[92:95], a[172:175], v[124:127]
 ds_write_b128 v14, v[48:51] offset:2048
M v[124:127], a[88:91], a[168:171], v[124:127]
 s_add_u32 s3, s93, 794624
 buffer_store_dwordx4 v[208:211], v7, s[8:11], s3 offen offset:0 sc1
M v[160:163], a[32:35], a[160:163], v[160:163]
 ds_read_b128 a[168:171], v5 offset:38912
 ds_read_b128 a[172:175], v6 offset:38912
M v[160:163], a[36:39], a[164:167], v[160:163]
 v_mul_f32 v56, s5, v56
 v_mul_f32 v57, s5, v57
M v[164:167], a[44:47], a[164:167], v[164:167]
 v_mul_f32 v58, s5, v58
 v_mul_f32 v59, s5, v59
M v[164:167], a[40:43], a[160:163], v[164:167]
 v_mul_f32 v60, s5, v60
 v_mul_f32 v61, s5, v61
M v[168:171], a[48:51], a[160:163], v[168:171]
 v_mul_f32 v62, s5, v62
 v_mul_f32 v63, s5, v63
M v[168:171], a[52:55], a[164:167], v[168:171]
 v_cvt_pk_bf16_f32 v56, v56, v57
 v_cvt_pk_bf16_f32 v57, v58, v59
M v[172:175], a[60:63], a[164:167], v[172:175]
 v_cvt_pk_bf16_f32 v58, v60, v61
 v_cvt_pk_bf16_f32 v59, v62, v63
M v[172:175], a[56:59], a[160:163], v[172:175]
 s_waitcnt lgkmcnt(0)
 ds_write_b128 v14, v[56:59] offset:3072
M v[176:179], a[64:67], a[160:163], v[176:179]
 s_barrier
M v[176:179], a[68:71], a[164:167], v[176:179]
M v[180:183], a[76:79], a[164:167], v[180:183]
 s_add_u32 m0, s28, 32768
 s_nop 0
 buffer_load_dwordx4 v3, s[8:11], s21 offen offset:0 sc1 lds
M v[180:183], a[72:75], a[160:163], v[180:183]
M v[184:187], a[80:83], a[160:163], v[184:187]
 buffer_store_dwordx4 v[212:215], v7, s[8:11], s3 offen offset:2048 sc1
M v[184:187], a[84:87], a[164:167], v[184:187]
 v_mul_f32 v96, s5, v96
 v_mul_f32 v97, s5, v97
M v[188:191], a[92:95], a[164:167], v[188:191]
 buffer_load_dwordx4 v3, s[8:11], s21 offen offset:1024 sc1 lds
M v[188:191], a[88:91], a[160:163], v[188:191]
 v_mul_f32 v98, s5, v98
 v_mul_f32 v99, s5, v99
M v[224:227], a[32:35], a[168:171], v[224:227]
 v_mul_f32 v100, s5, v100
 v_mul_f32 v101, s5, v101
M v[224:227], a[36:39], a[172:175], v[224:227]
 v_mul_f32 v102, s5, v102
 v_mul_f32 v103, s5, v103
M v[228:231], a[44:47], a[172:175], v[228:231]
 buffer_load_dwordx4 v3, s[8:11], s21 offen offset:2048 sc1 lds
M v[228:231], a[40:43], a[168:171], v[228:231]
 v_cvt_pk_bf16_f32 v96, v96, v97
 v_cvt_pk_bf16_f32 v97, v98, v99
M v[232:235], a[48:51], a[168:171], v[232:235]
 v_cvt_pk_bf16_f32 v98, v100, v101
 v_cvt_pk_bf16_f32 v99, v102, v103
M v[232:235], a[52:55], a[172:175], v[232:235]
 ds_write_b128 v14, v[96:99] offset:8192
M v[236:239], a[60:63], a[172:175], v[236:239]
 s_add_u32 s3, s93, 798720
 buffer_load_dwordx4 v3, s[8:11], s21 offen offset:3072 sc1 lds
M v[236:239], a[56:59], a[168:171], v[236:239]
 s_add_u32 m0, s28, 36864
M v[240:243], a[64:67], a[168:171], v[240:243]
 buffer_store_dwordx4 v[216:219], v7, s[8:11], s3 offen offset:0 sc1
M v[240:243], a[68:71], a[172:175], v[240:243]
 v_mul_f32 v104, s5, v104
 v_mul_f32 v105, s5, v105
M v[244:247], a[76:79], a[172:175], v[244:247]
 buffer_load_dwordx4 v4, s[8:11], s21 offen offset:0 sc1 lds
M v[244:247], a[72:75], a[168:171], v[244:247]
 v_mul_f32 v106, s5, v106
 v_mul_f32 v107, s5, v107
M v[248:251], a[80:83], a[168:171], v[248:251]
 v_mul_f32 v108, s5, v108
 v_mul_f32 v109, s5, v109
M v[248:251], a[84:87], a[172:175], v[248:251]
 v_mul_f32 v110, s5, v110
 v_mul_f32 v111, s5, v111
M v[252:255], a[92:95], a[172:175], v[252:255]
 buffer_load_dwordx4 v4, s[8:11], s21 offen offset:1024 sc1 lds
M v[252:255], a[88:91], a[168:171], v[252:255]
 buffer_load_dwordx4 v4, s[8:11], s21 offen offset:2048 sc1 lds
 buffer_load_dwordx4 v4, s[8:11], s21 offen offset:3072 sc1 lds
 s_add_u32 s24, s23, 16777216
 s_mov_b32 s23, s21
 s_add_u32 s21, s21, 32768
 s_add_u32 s22, s22, 1
 s_cmp_eq_u32 s22, s25
 s_cselect_b32 s21, s26, s21
 s_cmp_eq_u32 s22, s43
 s_cselect_b32 s21, s4, s21
 s_cmp_eq_u32 s22, s6
 s_cselect_b32 s21, s7, s21
 v_cvt_pk_bf16_f32 v104, v104, v105
 v_cvt_pk_bf16_f32 v105, v106, v107
 v_cvt_pk_bf16_f32 v106, v108, v109
 v_cvt_pk_bf16_f32 v107, v110, v111
 ds_write_b128 v14, v[104:107] offset:9216
 buffer_store_dwordx4 v[220:223], v7, s[8:11], s3 offen offset:2048 sc1
 v_pk_mul_f32 v[112:113], v[112:113], s[4:5] op_sel:[0,1] op_sel_hi:[1,1]
 v_pk_mul_f32 v[114:115], v[114:115], s[4:5] op_sel:[0,1] op_sel_hi:[1,1]
 v_pk_mul_f32 v[116:117], v[116:117], s[4:5] op_sel:[0,1] op_sel_hi:[1,1]
 v_pk_mul_f32 v[118:119], v[118:119], s[4:5] op_sel:[0,1] op_sel_hi:[1,1]
 v_cvt_pk_bf16_f32 v112, v112, v113
 v_cvt_pk_bf16_f32 v113, v114, v115
 v_cvt_pk_bf16_f32 v114, v116, v117
 v_cvt_pk_bf16_f32 v115, v118, v119
 ds_write_b128 v14, v[112:115] offset:10240
 v_pk_mul_f32 v[120:121], v[120:121], s[4:5] op_sel:[0,1] op_sel_hi:[1,1]
 v_pk_mul_f32 v[122:123], v[122:123], s[4:5] op_sel:[0,1] op_sel_hi:[1,1]
 v_pk_mul_f32 v[124:125], v[124:125], s[4:5] op_sel:[0,1] op_sel_hi:[1,1]
 v_pk_mul_f32 v[126:127], v[126:127], s[4:5] op_sel:[0,1] op_sel_hi:[1,1]
 v_cvt_pk_bf16_f32 v120, v120, v121
 v_cvt_pk_bf16_f32 v121, v122, v123
 v_cvt_pk_bf16_f32 v122, v124, v125
 v_cvt_pk_bf16_f32 v123, v126, v127
 ds_write_b128 v14, v[120:123] offset:11264
 v_pk_mul_f32 v[160:161], v[160:161], s[4:5] op_sel:[0,1] op_sel_hi:[1,1]
 v_pk_mul_f32 v[162:163], v[162:163], s[4:5] op_sel:[0,1] op_sel_hi:[1,1]
 v_pk_mul_f32 v[164:165], v[164:165], s[4:5] op_sel:[0,1] op_sel_hi:[1,1]
 v_pk_mul_f32 v[166:167], v[166:167], s[4:5] op_sel:[0,1] op_sel_hi:[1,1]
 v_cvt_pk_bf16_f32 v160, v160, v161
 v_cvt_pk_bf16_f32 v161, v162, v163
 v_cvt_pk_bf16_f32 v162, v164, v165
 v_cvt_pk_bf16_f32 v163, v166, v167
 ds_write_b128 v14, v[160:163] offset:16384
 v_pk_mul_f32 v[168:169], v[168:169], s[4:5] op_sel:[0,1] op_sel_hi:[1,1]
 v_pk_mul_f32 v[170:171], v[170:171], s[4:5] op_sel:[0,1] op_sel_hi:[1,1]
 v_pk_mul_f32 v[172:173], v[172:173], s[4:5] op_sel:[0,1] op_sel_hi:[1,1]
 v_pk_mul_f32 v[174:175], v[174:175], s[4:5] op_sel:[0,1] op_sel_hi:[1,1]
 v_cvt_pk_bf16_f32 v168, v168, v169
 v_cvt_pk_bf16_f32 v169, v170, v171
 v_cvt_pk_bf16_f32 v170, v172, v173
 v_cvt_pk_bf16_f32 v171, v174, v175
 ds_write_b128 v14, v[168:171] offset:17408
 v_pk_mul_f32 v[176:177], v[176:177], s[4:5] op_sel:[0,1] op_sel_hi:[1,1]
 v_pk_mul_f32 v[178:179], v[178:179], s[4:5] op_sel:[0,1] op_sel_hi:[1,1]
 v_pk_mul_f32 v[180:181], v[180:181], s[4:5] op_sel:[0,1] op_sel_hi:[1,1]
 v_pk_mul_f32 v[182:183], v[182:183], s[4:5] op_sel:[0,1] op_sel_hi:[1,1]
 v_cvt_pk_bf16_f32 v176, v176, v177
 v_cvt_pk_bf16_f32 v177, v178, v179
 v_cvt_pk_bf16_f32 v178, v180, v181
 v_cvt_pk_bf16_f32 v179, v182, v183
 ds_write_b128 v14, v[176:179] offset:18432
 v_pk_mul_f32 v[184:185], v[184:185], s[4:5] op_sel:[0,1] op_sel_hi:[1,1]
 v_pk_mul_f32 v[186:187], v[186:187], s[4:5] op_sel:[0,1] op_sel_hi:[1,1]
 v_pk_mul_f32 v[188:189], v[188:189], s[4:5] op_sel:[0,1] op_sel_hi:[1,1]
 v_pk_mul_f32 v[190:191], v[190:191], s[4:5] op_sel:[0,1] op_sel_hi:[1,1]
 v_cvt_pk_bf16_f32 v184, v184, v185
 v_cvt_pk_bf16_f32 v185, v186, v187
 v_cvt_pk_bf16_f32 v186, v188, v189
 v_cvt_pk_bf16_f32 v187, v190, v191
 ds_write_b128 v14, v[184:187] offset:19456
 v_pk_mul_f32 v[224:225], v[224:225], s[4:5] op_sel:[0,1] op_sel_hi:[1,1]
 v_pk_mul_f32 v[226:227], v[226:227], s[4:5] op_sel:[0,1] op_sel_hi:[1,1]
 v_pk_mul_f32 v[228:229], v[228:229], s[4:5] op_sel:[0,1] op_sel_hi:[1,1]
 v_pk_mul_f32 v[230:231], v[230:231], s[4:5] op_sel:[0,1] op_sel_hi:[1,1]
 v_cvt_pk_bf16_f32 v224, v224, v225
 v_cvt_pk_bf16_f32 v225, v226, v227
 v_cvt_pk_bf16_f32 v226, v228, v229
 v_cvt_pk_bf16_f32 v227, v230, v231
 ds_write_b128 v14, v[224:227] offset:24576
 v_pk_mul_f32 v[232:233], v[232:233], s[4:5] op_sel:[0,1] op_sel_hi:[1,1]
 v_pk_mul_f32 v[234:235], v[234:235], s[4:5] op_sel:[0,1] op_sel_hi:[1,1]
 v_pk_mul_f32 v[236:237], v[236:237], s[4:5] op_sel:[0,1] op_sel_hi:[1,1]
 v_pk_mul_f32 v[238:239], v[238:239], s[4:5] op_sel:[0,1] op_sel_hi:[1,1]
 v_cvt_pk_bf16_f32 v232, v232, v233
 v_cvt_pk_bf16_f32 v233, v234, v235
 v_cvt_pk_bf16_f32 v234, v236, v237
 v_cvt_pk_bf16_f32 v235, v238, v239
 ds_write_b128 v14, v[232:235] offset:25600
 v_pk_mul_f32 v[240:241], v[240:241], s[4:5] op_sel:[0,1] op_sel_hi:[1,1]
 v_pk_mul_f32 v[242:243], v[242:243], s[4:5] op_sel:[0,1] op_sel_hi:[1,1]
 v_pk_mul_f32 v[244:245], v[244:245], s[4:5] op_sel:[0,1] op_sel_hi:[1,1]
 v_pk_mul_f32 v[246:247], v[246:247], s[4:5] op_sel:[0,1] op_sel_hi:[1,1]
 v_cvt_pk_bf16_f32 v240, v240, v241
 v_cvt_pk_bf16_f32 v241, v242, v243
 v_cvt_pk_bf16_f32 v242, v244, v245
 v_cvt_pk_bf16_f32 v243, v246, v247
 ds_write_b128 v14, v[240:243] offset:26624
 v_pk_mul_f32 v[248:249], v[248:249], s[4:5] op_sel:[0,1] op_sel_hi:[1,1]
 v_pk_mul_f32 v[250:251], v[250:251], s[4:5] op_sel:[0,1] op_sel_hi:[1,1]
 v_pk_mul_f32 v[252:253], v[252:253], s[4:5] op_sel:[0,1] op_sel_hi:[1,1]
 v_pk_mul_f32 v[254:255], v[254:255], s[4:5] op_sel:[0,1] op_sel_hi:[1,1]
 v_cvt_pk_bf16_f32 v248, v248, v249
 v_cvt_pk_bf16_f32 v249, v250, v251
 v_cvt_pk_bf16_f32 v250, v252, v253
 v_cvt_pk_bf16_f32 v251, v254, v255
 ds_write_b128 v14, v[248:251] offset:27648
 s_waitcnt vmcnt(17) lgkmcnt(0)
 s_barrier
 ds_read_b128 a[64:67], v2 offset:32768
 ds_read_b128 a[68:71], v2 offset:33792
 ds_read_b128 a[72:75], v2 offset:34816
 ds_read_b128 a[76:79], v2 offset:35840
 ds_read_b128 a[80:83], v2 offset:36864
 ds_read_b128 a[84:87], v2 offset:37888
 ds_read_b128 a[88:91], v2 offset:38912
 ds_read_b128 a[92:95], v2 offset:39936
 s_lshl_b32 s64, s20, 13
 s_sub_u32 s65, 155648, s64
 v_add_u32 v10, s64, v7
 v_add_u32 v11, s65, v7
 ds_read_b128 a[0:3], v10 offset:0
 ds_read_b128 a[4:7], v10 offset:1024
 ds_read_b128 a[8:11], v10 offset:2048
 ds_read_b128 a[12:15], v10 offset:3072
 ds_read_b128 a[16:19], v10 offset:4096
 ds_read_b128 a[20:23], v10 offset:5120
 ds_read_b128 a[24:27], v10 offset:6144
 ds_read_b128 a[28:31], v10 offset:7168
 ds_read_b128 a[32:35], v11 offset:0
 ds_read_b128 a[36:39], v11 offset:1024
 ds_read_b128 a[40:43], v11 offset:2048
 ds_read_b128 a[44:47], v11 offset:3072
 ds_read_b128 a[48:51], v11 offset:4096
 ds_read_b128 a[52:55], v11 offset:5120
 ds_read_b128 a[56:59], v11 offset:6144
 ds_read_b128 a[60:63], v11 offset:7168
 s_waitcnt vmcnt(14)
 v_cmp_eq_u32 vcc, 0, v24
 v_mov_b32 v17, 5
 v_or_b32 v6, s35, v7
 s_cbranch_vccnz L_f1s05
L_f1r05:
 s_mov_b32 s30, s93
 s_mov_b32 s29, s94
 s_cmp_eq_u32 s20, 0
 s_cselect_b32 s5, 0, 0
 v_mov_b32 v32, 0xc1800000
 v_mov_b32 v33, 0xc1800000
 v_mov_b32 v34, 0xc1800000
 v_mov_b32 v35, 0xc1800000
 v_mov_b32 v36, 0xc1800000
 v_mov_b32 v37, 0xc1800000
 v_mov_b32 v38, 0xc1800000
 v_mov_b32 v39, 0xc1800000
 s_waitcnt lgkmcnt(0)
M v[64:67], a[64:67], a[0:3], v[32:35]
 ds_read_b128 a[96:99], v2 offset:40960
 v_mov_b32 v30, 0
M v[64:67], a[68:71], a[4:7], v[64:67]
 s_add_u32 m0, s28, 65536
 ds_read_b128 a[100:103], v2 offset:41984
 v_mov_b32 v31, 0
M v[64:67], a[72:75], a[8:11], v[64:67]
 buffer_load_dwordx4 v3, s[8:11], s24 offen offset:0 sc1 lds
M v[64:67], a[76:79], a[12:15], v[64:67]
 ds_read_b128 a[104:107], v2 offset:43008
M v[64:67], a[80:83], a[16:19], v[64:67]
 ds_read_b128 a[108:111], v2 offset:44032
M v[64:67], a[84:87], a[20:23], v[64:67]
 buffer_load_dwordx4 v3, s[8:11], s24 offen offset:1024 sc1 lds
M v[64:67], a[88:91], a[24:27], v[64:67]
 ds_read_b128 a[112:115], v2 offset:45056
M v[64:67], a[92:95], a[28:31], v[64:67]
 ds_read_b128 a[116:119], v2 offset:46080
M v[68:71], a[92:95], a[60:63], v[36:39]
M v[68:71], a[88:91], a[56:59], v[68:71]
 ds_read_b128 a[120:123], v2 offset:47104
M v[68:71], a[84:87], a[52:55], v[68:71]
 ds_read_b128 a[124:127], v2 offset:48128
M v[68:71], a[80:83], a[48:51], v[68:71]
 buffer_load_dwordx4 v3, s[8:11], s24 offen offset:2048 sc1 lds
M v[68:71], a[76:79], a[44:47], v[68:71]
 v_exp_f32 v18, v64
M v[68:71], a[72:75], a[40:43], v[68:71]
 v_exp_f32 v19, v65
M v[68:71], a[68:71], a[36:39], v[68:71]
 v_exp_f32 v20, v66
M v[68:71], a[64:67], a[32:35], v[68:71]
 s_waitcnt lgkmcnt(0)
 v_exp_f32 v21, v67
M v[72:75], a[96:99], a[0:3], v[32:35]
 ds_read_b128 a[64:67], v2 offset:49152
 v_add_f32 v26, v18, v19
M v[72:75], a[100:103], a[4:7], v[72:75]
 ds_read_b128 a[68:71], v2 offset:50176
 v_cvt_pk_bf16_f32 v40, v18, v19
M v[72:75], a[104:107], a[8:11], v[72:75]
 buffer_load_dwordx4 v3, s[8:11], s24 offen offset:3072 sc1 lds
M v[72:75], a[108:111], a[12:15], v[72:75]
 ds_read_b128 a[72:75], v2 offset:51200
 v_add_f32 v26, v20, v26
M v[72:75], a[112:115], a[16:19], v[72:75]
 s_add_u32 m0, s28, 69632
 ds_read_b128 a[76:79], v2 offset:52224
 v_cvt_pk_bf16_f32 v41, v20, v21
M v[72:75], a[116:119], a[20:23], v[72:75]
 buffer_load_dwordx4 v4, s[8:11], s24 offen offset:0 sc1 lds
M v[72:75], a[120:123], a[24:27], v[72:75]
 ds_read_b128 a[80:83], v2 offset:53248
 v_add_f32 v26, v21, v26
M v[72:75], a[124:127], a[28:31], v[72:75]
 ds_read_b128 a[84:87], v2 offset:54272
M v[76:79], a[124:127], a[60:63], v[36:39]
 v_exp_f32 v22, v68
M v[76:79], a[120:123], a[56:59], v[76:79]
 ds_read_b128 a[88:91], v2 offset:55296
M v[76:79], a[116:119], a[52:55], v[76:79]
 ds_read_b128 a[92:95], v2 offset:56320
M v[76:79], a[112:115], a[48:51], v[76:79]
 buffer_load_dwordx4 v4, s[8:11], s24 offen offset:1024 sc1 lds
M v[76:79], a[108:111], a[44:47], v[76:79]
 v_exp_f32 v23, v69
M v[76:79], a[104:107], a[40:43], v[76:79]
 v_exp_f32 v24, v70
M v[76:79], a[100:103], a[36:39], v[76:79]
 buffer_load_dwordx4 v4, s[8:11], s24 offen offset:2048 sc1 lds
M v[76:79], a[96:99], a[32:35], v[76:79]
 s_waitcnt lgkmcnt(0)
 v_exp_f32 v25, v71
M v[80:83], a[64:67], a[0:3], v[32:35]
 ds_read_b128 a[96:99], v2 offset:57344
 v_add_f32 v27, v22, v23
M v[80:83], a[68:71], a[4:7], v[80:83]
 ds_read_b128 a[100:103], v2 offset:58368
 v_cvt_pk_bf16_f32 v44, v22, v23
M v[80:83], a[72:75], a[8:11], v[80:83]
 v_exp_f32 v18, v72
M v[80:83], a[76:79], a[12:15], v[80:83]
 ds_read_b128 a[104:107], v2 offset:59392
 v_add_f32 v27, v24, v27
M v[80:83], a[80:83], a[16:19], v[80:83]
 ds_read_b128 a[108:111], v2 offset:60416
 v_cvt_pk_bf16_f32 v45, v24, v25
M v[80:83], a[84:87], a[20:23], v[80:83]
 buffer_load_dwordx4 v4, s[8:11], s24 offen offset:3072 sc1 lds
M v[80:83], a[88:91], a[24:27], v[80:83]
 ds_read_b128 a[112:115], v2 offset:61440
 v_add_f32 v27, v25, v27
M v[80:83], a[92:95], a[28:31], v[80:83]
 ds_read_b128 a[116:119], v2 offset:62464
M v[84:87], a[92:95], a[60:63], v[36:39]
 v_exp_f32 v19, v73
M v[84:87], a[88:91], a[56:59], v[84:87]
 ds_read_b128 a[120:123], v2 offset:63488
 v_add_f32 v26, v18, v26
M v[84:87], a[84:87], a[52:55], v[84:87]
 ds_read_b128 a[124:127], v2 offset:64512
 v_cvt_pk_bf16_f32 v42, v18, v19
M v[84:87], a[80:83], a[48:51], v[84:87]
 v_exp_f32 v20, v74
M v[84:87], a[76:79], a[44:47], v[84:87]
 v_exp_f32 v21, v75
M v[84:87], a[72:75], a[40:43], v[84:87]
 v_exp_f32 v22, v76
M v[84:87], a[68:71], a[36:39], v[84:87]
 s_waitcnt vmcnt(8) lgkmcnt(0)
 v_exp_f32 v23, v77
M v[84:87], a[64:67], a[32:35], v[84:87]
 s_barrier
M v[88:91], a[96:99], a[0:3], v[32:35]
 ds_read_b128 a[64:67], v7 offset:32768
 v_add_f32 v26, v19, v26
M v[88:91], a[100:103], a[4:7], v[88:91]
 ds_read_b128 a[68:71], v7 offset:33792
 v_add_f32 v26, v20, v26
M v[88:91], a[104:107], a[8:11], v[88:91]
 buffer_store_dword v17, v1, s[8:11], s45 offen sc1
M v[88:91], a[108:111], a[12:15], v[88:91]
 ds_read_b128 a[72:75], v7 offset:34816
 v_cvt_pk_bf16_f32 v43, v20, v21
M v[88:91], a[112:115], a[16:19], v[88:91]
 ds_read_b128 a[76:79], v7 offset:35840
 v_add_f32 v26, v21, v26
M v[88:91], a[116:119], a[20:23], v[88:91]
 v_exp_f32 v24, v78
M v[88:91], a[120:123], a[24:27], v[88:91]
 ds_read_b128 a[80:83], v7 offset:36864
 v_add_f32 v27, v22, v27
M v[88:91], a[124:127], a[28:31], v[88:91]
 ds_read_b128 a[84:87], v7 offset:37888
 v_cvt_pk_bf16_f32 v46, v22, v23
M v[92:95], a[124:127], a[60:63], v[36:39]
 v_exp_f32 v25, v79
M v[92:95], a[120:123], a[56:59], v[92:95]
 ds_read_b128 a[88:91], v7 offset:38912
 v_add_f32 v27, v23, v27
M v[92:95], a[116:119], a[52:55], v[92:95]
 ds_read_b128 a[92:95], v7 offset:39936
 v_add_f32 v27, v24, v27
M v[92:95], a[112:115], a[48:51], v[92:95]
 v_cvt_pk_bf16_f32 v47, v24, v25
 v_add_f32 v27, v25, v27
M v[92:95], a[108:111], a[44:47], v[92:95]
M v[92:95], a[104:107], a[40:43], v[92:95]
M v[92:95], a[100:103], a[36:39], v[92:95]
 s_waitcnt lgkmcnt(0)
M v[92:95], a[96:99], a[32:35], v[92:95]
 s_cmp_eq_u32 s42, 0
 s_cbranch_scc1 L_j0
M v[96:99], a[64:67], a[0:3], v[32:35]
 s_add_u32 m0, s28, 98304
 ds_read_b128 a[96:99], v7 offset:40960
M v[96:99], a[68:71], a[4:7], v[96:99]
 ds_read_b128 a[100:103], v7 offset:41984
M v[96:99], a[72:75], a[8:11], v[96:99]
 buffer_load_dwordx4 v3, s[8:11], s21 offen offset:0 sc1 lds
M v[96:99], a[76:79], a[12:15], v[96:99]
 s_cmp_eq_u32 s20, 0
 ds_read_b128 a[104:107], v7 offset:43008
M v[96:99], a[80:83], a[16:19], v[96:99]
 s_cselect_b64 s[64:65], s[16:17], 0
 ds_read_b128 a[108:111], v7 offset:44032
M v[96:99], a[84:87], a[20:23], v[96:99]
 buffer_load_dwordx4 v3, s[8:11], s21 offen offset:1024 sc1 lds
M v[96:99], a[88:91], a[24:27], v[96:99]
 s_cselect_b64 s[66:67], s[18:19], 0
 ds_read_b128 a[112:115], v7 offset:45056
M v[96:99], a[92:95], a[28:31], v[96:99]
 s_cselect_b64 s[68:69], s[48:49], 0
 ds_read_b128 a[116:119], v7 offset:46080
M v[100:103], a[92:95], a[60:63], v[36:39]
 s_cselect_b64 s[70:71], s[50:51], 0
 v_exp_f32 v18, v80
M v[100:103], a[88:91], a[56:59], v[100:103]
 s_cmp_lt_u32 s20, 1
 ds_read_b128 a[120:123], v7 offset:47104
M v[100:103], a[84:87], a[52:55], v[100:103]
 s_cselect_b64 s[78:79], -1, 0
 ds_read_b128 a[124:127], v7 offset:48128
M v[100:103], a[80:83], a[48:51], v[100:103]
 buffer_load_dwordx4 v3, s[8:11], s21 offen offset:2048 sc1 lds
M v[100:103], a[76:79], a[44:47], v[100:103]
 s_cmp_eq_u32 s20, 1
 v_exp_f32 v19, v81
M v[100:103], a[72:75], a[40:43], v[100:103]
 s_cselect_b64 s[72:73], s[16:17], s[78:79]
 v_exp_f32 v20, v82
M v[100:103], a[68:71], a[36:39], v[100:103]
 s_cselect_b64 s[74:75], s[18:19], s[78:79]
 v_exp_f32 v21, v83
M v[100:103], a[64:67], a[32:35], v[100:103]
 s_waitcnt lgkmcnt(0)
 v_exp_f32 v22, v88
M v[108:111], a[96:99], a[32:35], v[36:39]
 s_cselect_b64 s[76:77], s[48:49], s[78:79]
 ds_read_b128 a[64:67], v7 offset:49152
 v_add_f32 v26, v18, v26
M v[108:111], a[100:103], a[36:39], v[108:111]
 s_cselect_b64 s[78:79], s[50:51], s[78:79]
 ds_read_b128 a[68:71], v7 offset:50176
 v_cvt_pk_bf16_f32 v56, v18, v19
M v[108:111], a[104:107], a[40:43], v[108:111]
 buffer_load_dwordx4 v3, s[8:11], s21 offen offset:3072 sc1 lds
M v[108:111], a[108:111], a[44:47], v[108:111]
 s_add_u32 m0, s28, 102400
 ds_read_b128 a[72:75], v7 offset:51200
 v_add_f32 v26, v19, v26
M v[108:111], a[112:115], a[48:51], v[108:111]
 s_cmp_lt_u32 s20, 2
 ds_read_b128 a[76:79], v7 offset:52224
 v_add_f32 v26, v20, v26
M v[108:111], a[116:119], a[52:55], v[108:111]
 buffer_load_dwordx4 v4, s[8:11], s21 offen offset:0 sc1 lds
M v[108:111], a[120:123], a[56:59], v[108:111]
 s_cselect_b64 s[86:87], -1, 0
 ds_read_b128 a[80:83], v7 offset:53248
 v_cvt_pk_bf16_f32 v57, v20, v21
M v[108:111], a[124:127], a[60:63], v[108:111]
 s_cmp_eq_u32 s20, 2
 ds_read_b128 a[84:87], v7 offset:54272
 v_add_f32 v26, v21, v26
M v[104:107], a[124:127], a[28:31], v[32:35]
 s_cselect_b64 s[80:81], s[16:17], s[86:87]
 v_exp_f32 v23, v89
M v[104:107], a[120:123], a[24:27], v[104:107]
 s_cselect_b64 s[82:83], s[18:19], s[86:87]
 ds_read_b128 a[88:91], v7 offset:55296
 v_add_f32 v26, v22, v26
M v[104:107], a[116:119], a[20:23], v[104:107]
 s_cselect_b64 s[84:85], s[48:49], s[86:87]
 ds_read_b128 a[92:95], v7 offset:56320
 v_cvt_pk_bf16_f32 v58, v22, v23
M v[104:107], a[112:115], a[16:19], v[104:107]
 buffer_load_dwordx4 v4, s[8:11], s21 offen offset:1024 sc1 lds
M v[104:107], a[108:111], a[12:15], v[104:107]
 s_cselect_b64 s[86:87], s[50:51], s[86:87]
 v_exp_f32 v24, v90
M v[104:107], a[104:107], a[8:11], v[104:107]
 s_cmp_eq_u32 s20, 3
 v_exp_f32 v25, v91
M v[104:107], a[100:103], a[4:7], v[104:107]
 buffer_load_dwordx4 v4, s[8:11], s21 offen offset:2048 sc1 lds
M v[104:107], a[96:99], a[0:3], v[104:107]
 s_waitcnt lgkmcnt(0)
 v_exp_f32 v18, v84
M v[112:115], a[64:67], a[0:3], v[32:35]
 s_cselect_b64 s[88:89], s[16:17], -1
 ds_read_b128 a[96:99], v7 offset:57344
 v_add_f32 v26, v23, v26
M v[112:115], a[68:71], a[4:7], v[112:115]
 s_cselect_b64 s[90:91], s[18:19], -1
 ds_read_b128 a[100:103], v7 offset:58368
 v_add_f32 v26, v24, v26
M v[112:115], a[72:75], a[8:11], v[112:115]
 s_cselect_b64 s[92:93], s[48:49], -1
 v_exp_f32 v19, v85
M v[112:115], a[76:79], a[12:15], v[112:115]
 s_cselect_b64 s[94:95], s[50:51], -1
 ds_read_b128 a[104:107], v7 offset:59392
 v_cvt_pk_bf16_f32 v59, v24, v25
M v[112:115], a[80:83], a[16:19], v[112:115]
 ds_read_b128 a[108:111], v7 offset:60416
 v_add_f32 v26, v25, v26
M v[112:115], a[84:87], a[20:23], v[112:115]
 buffer_load_dwordx4 v4, s[8:11], s21 offen offset:3072 sc1 lds
M v[112:115], a[88:91], a[24:27], v[112:115]
 s_add_u32 s24, s23, 16777216
 ds_read_b128 a[112:115], v7 offset:61440
 v_add_f32 v27, v18, v27
M v[112:115], a[92:95], a[28:31], v[112:115]
 s_mov_b32 s23, s21
 ds_read_b128 a[116:119], v7 offset:62464
 v_cvt_pk_bf16_f32 v60, v18, v19
M v[116:119], a[92:95], a[60:63], v[36:39]
 s_add_u32 s21, s21, 32768
 v_exp_f32 v20, v86
M v[116:119], a[88:91], a[56:59], v[116:119]
 s_add_u32 s22, s22, 1
 ds_read_b128 a[120:123], v7 offset:63488
 v_add_f32 v27, v19, v27
M v[116:119], a[84:87], a[52:55], v[116:119]
 s_cmp_eq_u32 s22, s25
 ds_read_b128 a[124:127], v7 offset:64512
M v[116:119], a[80:83], a[48:51], v[116:119]
 s_cselect_b32 s21, s26, s21
 v_exp_f32 v21, v87
M v[116:119], a[76:79], a[44:47], v[116:119]
 s_cmp_eq_u32 s22, s43
 v_exp_f32 v22, v92
M v[116:119], a[72:75], a[40:43], v[116:119]
 s_cselect_b32 s21, s4, s21
 v_exp_f32 v23, v93
M v[116:119], a[68:71], a[36:39], v[116:119]
 s_waitcnt vmcnt(9) lgkmcnt(0)
 v_add_f32 v27, v20, v27
 v_cvt_pk_bf16_f32 v61, v20, v21
M v[116:119], a[64:67], a[32:35], v[116:119]
 s_barrier
M v[124:127], a[96:99], a[32:35], v[36:39]
 s_cmp_eq_u32 s22, s6
 ds_read_b128 a[64:67], v2 offset:0
 v_add_f32 v27, v21, v27
M v[124:127], a[100:103], a[36:39], v[124:127]
 s_cselect_b32 s21, s7, s21
 ds_read_b128 a[68:71], v2 offset:1024
 v_add_f32 v27, v22, v27
M v[124:127], a[104:107], a[40:43], v[124:127]
 v_exp_f32 v24, v94
M v[124:127], a[108:111], a[44:47], v[124:127]
 ds_read_b128 a[72:75], v2 offset:2048
 v_cvt_pk_bf16_f32 v62, v22, v23
M v[124:127], a[112:115], a[48:51], v[124:127]
 ds_read_b128 a[76:79], v2 offset:3072
 v_add_f32 v27, v23, v27
M v[124:127], a[116:119], a[52:55], v[124:127]
 v_exp_f32 v25, v95
M v[124:127], a[120:123], a[56:59], v[124:127]
 ds_read_b128 a[80:83], v2 offset:4096
 v_add_f32 v27, v24, v27
M v[124:127], a[124:127], a[60:63], v[124:127]
 ds_read_b128 a[84:87], v2 offset:5120
 v_cvt_pk_bf16_f32 v63, v24, v25
M v[120:123], a[124:127], a[28:31], v[32:35]
 v_add_f32 v27, v25, v27
M v[120:123], a[120:123], a[24:27], v[120:123]
 ds_read_b128 a[88:91], v2 offset:6144
 v_max_f32 v10, v26, v27
M v[120:123], a[116:119], a[20:23], v[120:123]
 ds_read_b128 a[92:95], v2 offset:7168
 v_min_f32 v11, v26, v27
M v[120:123], a[112:115], a[16:19], v[120:123]
 v_cmp_lt_f32 s[36:37], s31, v10
M v[120:123], a[108:111], a[12:15], v[120:123]
 v_cmp_gt_f32 vcc, s55, v11
M v[120:123], a[104:107], a[8:11], v[120:123]
M v[120:123], a[100:103], a[4:7], v[120:123]
 s_waitcnt lgkmcnt(0)
 s_or_b64 vcc, vcc, s[36:37]
M v[120:123], a[96:99], a[0:3], v[120:123]
 s_cbranch_vccnz L_st10
L_rt10:
M v[128:131], a[64:67], v[40:43], 0
 s_add_u32 m0, s28, 0
 ds_read_b128 a[96:99], v2 offset:8192
 ds_read_b128 a[100:103], v2 offset:9216
M v[128:131], a[68:71], v[56:59], v[128:131]
 buffer_load_dwordx4 v3, s[8:11], s24 offen offset:0 sc1 lds
M v[132:135], a[68:71], v[60:63], 0
 v_exp_f32 v18, v96
M v[132:135], a[64:67], v[44:47], v[132:135]
 ds_read_b128 a[104:107], v2 offset:10240
 ds_read_b128 a[108:111], v2 offset:11264
M v[140:143], a[72:75], v[44:47], 0
 buffer_load_dwordx4 v3, s[8:11], s24 offen offset:1024 sc1 lds
M v[140:143], a[76:79], v[60:63], v[140:143]
 v_exp_f32 v19, v97
M v[136:139], a[76:79], v[56:59], 0
 ds_read_b128 a[112:115], v2 offset:12288
 ds_read_b128 a[116:119], v2 offset:13312
M v[136:139], a[72:75], v[40:43], v[136:139]
 buffer_load_dwordx4 v3, s[8:11], s24 offen offset:2048 sc1 lds
M v[144:147], a[80:83], v[40:43], 0
 v_exp_f32 v20, v98
M v[144:147], a[84:87], v[56:59], v[144:147]
 ds_read_b128 a[120:123], v2 offset:14336
 ds_read_b128 a[124:127], v2 offset:15360
M v[148:151], a[84:87], v[60:63], 0
 buffer_load_dwordx4 v3, s[8:11], s24 offen offset:3072 sc1 lds
M v[148:151], a[80:83], v[44:47], v[148:151]
 s_add_u32 m0, s28, 4096
 v_exp_f32 v21, v99
M v[156:159], a[88:91], v[44:47], 0
 buffer_load_dwordx4 v4, s[8:11], s24 offen offset:0 sc1 lds
M v[156:159], a[92:95], v[60:63], v[156:159]
 v_add_f32 v30, v26, v30
 v_add_f32 v31, v27, v31
M v[152:155], a[92:95], v[56:59], 0
 v_exp_f32 v22, v104
M v[152:155], a[88:91], v[40:43], v[152:155]
 s_waitcnt lgkmcnt(0)
 v_add_f32 v28, v18, v19
 v_cvt_pk_bf16_f32 v48, v18, v19
M v[160:163], a[96:99], v[40:43], 0
 ds_read_b128 a[64:67], v2 offset:16384
 ds_read_b128 a[68:71], v2 offset:17408
M v[160:163], a[100:103], v[56:59], v[160:163]
 buffer_load_dwordx4 v4, s[8:11], s24 offen offset:1024 sc1 lds
M v[164:167], a[100:103], v[60:63], 0
 v_exp_f32 v23, v105
M v[164:167], a[96:99], v[44:47], v[164:167]
 ds_read_b128 a[72:75], v2 offset:18432
 ds_read_b128 a[76:79], v2 offset:19456
M v[172:175], a[104:107], v[44:47], 0
 buffer_load_dwordx4 v4, s[8:11], s24 offen offset:2048 sc1 lds
M v[172:175], a[108:111], v[60:63], v[172:175]
 v_add_f32 v28, v20, v28
 v_cvt_pk_bf16_f32 v49, v20, v21
M v[168:171], a[108:111], v[56:59], 0
 ds_read_b128 a[80:83], v2 offset:20480
 ds_read_b128 a[84:87], v2 offset:21504
M v[168:171], a[104:107], v[40:43], v[168:171]
 buffer_load_dwordx4 v4, s[8:11], s24 offen offset:3072 sc1 lds
M v[176:179], a[112:115], v[40:43], 0
 v_exp_f32 v24, v106
M v[176:179], a[116:119], v[56:59], v[176:179]
 s_add_u32 m0, s28, 32768
 ds_read_b128 a[88:91], v2 offset:22528
 ds_read_b128 a[92:95], v2 offset:23552
M v[180:183], a[116:119], v[60:63], 0
 buffer_load_dwordx4 v3, s[8:11], s21 offen offset:0 sc1 lds
M v[180:183], a[112:115], v[44:47], v[180:183]
 v_exp_f32 v25, v107
M v[188:191], a[120:123], v[44:47], 0
 buffer_load_dwordx4 v3, s[8:11], s21 offen offset:1024 sc1 lds
M v[188:191], a[124:127], v[60:63], v[188:191]
 v_exp_f32 v18, v100
M v[184:187], a[124:127], v[56:59], 0
 buffer_load_dwordx4 v3, s[8:11], s21 offen offset:2048 sc1 lds
M v[184:187], a[120:123], v[40:43], v[184:187]
 s_waitcnt lgkmcnt(0)
 v_add_f32 v28, v21, v28
 v_add_f32 v28, v22, v28
M v[192:195], a[64:67], v[40:43], 0
 ds_read_b128 a[96:99], v2 offset:24576
 ds_read_b128 a[100:103], v2 offset:25600
M v[192:195], a[68:71], v[56:59], v[192:195]
 buffer_load_dwordx4 v3, s[8:11], s21 offen offset:3072 sc1 lds
M v[196:199], a[68:71], v[60:63], 0
 v_exp_f32 v19, v101
M v[196:199], a[64:67], v[44:47], v[196:199]
 s_add_u32 m0, s28, 36864
 ds_read_b128 a[104:107], v2 offset:26624
 ds_read_b128 a[108:111], v2 offset:27648
M v[204:207], a[72:75], v[44:47], 0
 buffer_load_dwordx4 v4, s[8:11], s21 offen offset:0 sc1 lds
M v[204:207], a[76:79], v[60:63], v[204:207]
 v_exp_f32 v20, v102
M v[200:203], a[76:79], v[56:59], 0
 ds_read_b128 a[112:115], v2 offset:28672
 ds_read_b128 a[116:119], v2 offset:29696
M v[200:203], a[72:75], v[40:43], v[200:203]
 buffer_load_dwordx4 v4, s[8:11], s21 offen offset:1024 sc1 lds
M v[208:211], a[80:83], v[40:43], 0
 v_exp_f32 v21, v103
M v[208:211], a[84:87], v[56:59], v[208:211]
 ds_read_b128 a[120:123], v2 offset:30720
 ds_read_b128 a[124:127], v2 offset:31744
M v[212:215], a[84:87], v[60:63], 0
 buffer_load_dwordx4 v4, s[8:11], s21 offen offset:2048 sc1 lds
M v[212:215], a[80:83], v[44:47], v[212:215]
 v_cvt_pk_bf16_f32 v50, v22, v23
 v_add_f32 v28, v23, v28
M v[220:223], a[88:91], v[44:47], 0
 v_exp_f32 v22, v108
M v[220:223], a[92:95], v[60:63], v[220:223]
 buffer_load_dwordx4 v4, s[8:11], s21 offen offset:3072 sc1 lds
M v[216:219], a[92:95], v[56:59], 0
 s_waitcnt vmcnt(16) lgkmcnt(0)
 s_add_u32 s24, s23, 16777216
 s_mov_b32 s23, s21
M v[216:219], a[88:91], v[40:43], v[216:219]
 s_barrier
M v[224:227], a[96:99], v[40:43], 0
 ds_read_b128 a[64:67], v2 offset:32768
 ds_read_b128 a[68:71], v2 offset:33792
M v[224:227], a[100:103], v[56:59], v[224:227]
 s_add_u32 s21, s21, 32768
 v_add_f32 v28, v24, v28
M v[228:231], a[100:103], v[60:63], 0
 s_add_u32 s22, s22, 1
 v_exp_f32 v23, v109
M v[228:231], a[96:99], v[44:47], v[228:231]
 s_cmp_eq_u32 s22, s25
 ds_read_b128 a[72:75], v2 offset:34816
 ds_read_b128 a[76:79], v2 offset:35840
M v[236:239], a[104:107], v[44:47], 0
 s_cselect_b32 s21, s26, s21
 v_cvt_pk_bf16_f32 v51, v24, v25
 v_add_f32 v28, v25, v28
M v[236:239], a[108:111], v[60:63], v[236:239]
 s_cmp_eq_u32 s22, s43
 v_exp_f32 v24, v110
M v[232:235], a[108:111], v[56:59], 0
 s_cselect_b32 s21, s4, s21
 ds_read_b128 a[80:83], v2 offset:36864
 ds_read_b128 a[84:87], v2 offset:37888
M v[232:235], a[104:107], v[40:43], v[232:235]
 s_cmp_eq_u32 s22, s6
 v_exp_f32 v25, v111
M v[240:243], a[112:115], v[40:43], 0
 s_cselect_b32 s21, s7, s21
 v_add_f32 v29, v18, v19
 v_cvt_pk_bf16_f32 v52, v18, v19
M v[240:243], a[116:119], v[56:59], v[240:243]
 ds_read_b128 a[88:91], v2 offset:38912
 ds_read_b128 a[92:95], v2 offset:39936
M v[244:247], a[116:119], v[60:63], 0
 v_add_f32 v29, v20, v29
 v_cvt_pk_bf16_f32 v53, v20, v21
M v[244:247], a[112:115], v[44:47], v[244:247]
 v_add_f32 v29, v21, v29
 v_add_f32 v29, v22, v29
M v[252:255], a[120:123], v[44:47], 0
 v_cvt_pk_bf16_f32 v54, v22, v23
 v_add_f32 v29, v23, v29
M v[252:255], a[124:127], v[60:63], v[252:255]
 s_cmp_lg_u32 s27, 0
 v_add_f32 v29, v24, v29
 v_cvt_pk_bf16_f32 v55, v24, v25
M v[248:251], a[124:127], v[56:59], 0
 s_waitcnt lgkmcnt(0)
 v_add_f32 v29, v25, v29
M v[248:251], a[120:123], v[40:43], v[248:251]
 s_cbranch_scc1 L_loop_top
 s_branch L_p1
L_j0:
 s_cmp_eq_u32 s20, 0
 s_cselect_b64 s[64:65], s[16:17], 0
 s_cselect_b64 s[66:67], s[18:19], 0
 s_cselect_b64 s[68:69], s[48:49], 0
 s_cselect_b64 s[70:71], s[50:51], 0
 s_cmp_lt_u32 s20, 1
 s_cselect_b64 s[78:79], -1, 0
 s_cmp_eq_u32 s20, 1
 s_cselect_b64 s[72:73], s[16:17], s[78:79]
 s_cselect_b64 s[74:75], s[18:19], s[78:79]
 s_cselect_b64 s[76:77], s[48:49], s[78:79]
 s_cselect_b64 s[78:79], s[50:51], s[78:79]
 s_cmp_lt_u32 s20, 2
 s_cselect_b64 s[86:87], -1, 0
 s_cmp_eq_u32 s20, 2
 s_cselect_b64 s[80:81], s[16:17], s[86:87]
 s_cselect_b64 s[82:83], s[18:19], s[86:87]
 s_cselect_b64 s[84:85], s[48:49], s[86:87]
 s_cselect_b64 s[86:87], s[50:51], s[86:87]
 s_cmp_eq_u32 s20, 3
 s_cselect_b64 s[88:89], s[16:17], -1
 s_cselect_b64 s[90:91], s[18:19], -1
 s_cselect_b64 s[92:93], s[48:49], -1
 s_cselect_b64 s[94:95], s[50:51], -1
 v_mov_b32 v56, 0
 v_mov_b32 v57, 0
 v_mov_b32 v58, 0
 v_mov_b32 v59, 0
 v_accvgpr_write_b32 a242, 0
 v_accvgpr_write_b32 a243, 0
 v_cndmask_b32 v64, v64, v8, s[64:65]
 v_cndmask_b32 v65, v65, v8, s[66:67]
 v_cndmask_b32 v66, v66, v8, s[68:69]
 v_cndmask_b32 v67, v67, v8, s[70:71]
 v_cndmask_b32 v72, v72, v8, s[72:73]
 v_cndmask_b32 v73, v73, v8, s[74:75]
 v_cndmask_b32 v74, v74, v8, s[76:77]
 v_cndmask_b32 v75, v75, v8, s[78:79]
 v_cndmask_b32 v80, v80, v8, s[80:81]
 v_cndmask_b32 v81, v81, v8, s[82:83]
 v_cndmask_b32 v82, v82, v8, s[84:85]
 v_cndmask_b32 v83, v83, v8, s[86:87]
 v_cndmask_b32 v88, v88, v8, s[88:89]
 v_cndmask_b32 v89, v89, v8, s[90:91]
 v_cndmask_b32 v90, v90, v8, s[92:93]
 v_cndmask_b32 v91, v91, v8, s[94:95]
 s_cmp_eq_u32 s20, 3
 s_cselect_b64 s[64:65], s[16:17], 0
 s_cselect_b64 s[66:67], s[18:19], 0
 s_cselect_b64 s[68:69], s[48:49], 0
 s_cselect_b64 s[70:71], s[50:51], 0
 s_cmp_gt_u32 s20, 2
 s_cselect_b64 s[78:79], -1, 0
 s_cmp_eq_u32 s20, 2
 s_cselect_b64 s[72:73], s[16:17], s[78:79]
 s_cselect_b64 s[74:75], s[18:19], s[78:79]
 s_cselect_b64 s[76:77], s[48:49], s[78:79]
 s_cselect_b64 s[78:79], s[50:51], s[78:79]
 s_cmp_gt_u32 s20, 1
 s_cselect_b64 s[86:87], -1, 0
 s_cmp_eq_u32 s20, 1
 s_cselect_b64 s[80:81], s[16:17], s[86:87]
 s_cselect_b64 s[82:83], s[18:19], s[86:87]
 s_cselect_b64 s[84:85], s[48:49], s[86:87]
 s_cselect_b64 s[86:87], s[50:51], s[86:87]
 s_cmp_eq_u32 s20, 0
 s_cselect_b64 s[88:89], s[16:17], -1
 s_cselect_b64 s[90:91], s[18:19], -1
 s_cselect_b64 s[92:93], s[48:49], -1
 s_cselect_b64 s[94:95], s[50:51], -1
 s_add_u32 m0, s28, 98304
 v_max3_f32 v10, v64, v65, v66
 buffer_load_dwordx4 v3, s[8:11], s21 offen offset:0 sc1 lds
 v_max3_f32 v10, v67, v72, v10
 v_max3_f32 v10, v73, v74, v10
 v_max3_f32 v10, v75, v80, v10
 v_max3_f32 v10, v81, v82, v10
 v_max3_f32 v10, v83, v88, v10
 v_max3_f32 v10, v89, v90, v10
 v_max_f32 v10, v91, v10
 v_max3_f32 v11, v68, v69, v70
 v_max3_f32 v11, v71, v76, v11
 v_max3_f32 v11, v77, v78, v11
 v_max3_f32 v11, v79, v84, v11
 v_mfma_f32_32x32x16_bf16 v[128:143], v[56:59], v[56:59], 0
 buffer_load_dwordx4 v3, s[8:11], s21 offen offset:1024 sc1 lds
 v_max3_f32 v11, v85, v86, v11
 v_max3_f32 v11, v87, v92, v11
 v_max3_f32 v11, v93, v94, v11
 v_max_f32 v11, v95, v11
 v_mov_b32 v12, v10
 v_mov_b32 v13, v11
 s_nop 0
 v_permlane16_swap_b32 v12, v10
 v_permlane16_swap_b32 v13, v11
 v_max_f32 v10, v12, v10
 v_max_f32 v11, v13, v11
 v_mov_b32 v12, v10
 buffer_load_dwordx4 v3, s[8:11], s21 offen offset:2048 sc1 lds
 v_mov_b32 v13, v11
 v_mfma_f32_32x32x16_bf16 v[144:159], v[56:59], v[56:59], 0
 v_permlane32_swap_b32 v12, v10
 v_permlane32_swap_b32 v13, v11
 v_max_f32 v10, v12, v10
 v_max_f32 v11, v13, v11
 v_ceil_f32 v10, v10
 v_ceil_f32 v11, v11
 v_sub_f32 v32, v32, v10
 v_sub_f32 v33, v33, v10
 v_sub_f32 v34, v34, v10
 v_sub_f32 v35, v35, v10
 buffer_load_dwordx4 v3, s[8:11], s21 offen offset:3072 sc1 lds
 v_sub_f32 v36, v36, v11
 v_sub_f32 v37, v37, v11
 v_sub_f32 v38, v38, v11
 v_mfma_f32_32x32x16_bf16 v[160:175], v[56:59], v[56:59], 0
 v_sub_f32 v39, v39, v11
 v_sub_f32 v64, v64, v10
 v_sub_f32 v65, v65, v10
 v_sub_f32 v66, v66, v10
 v_sub_f32 v67, v67, v10
 v_sub_f32 v68, v68, v11
 v_sub_f32 v69, v69, v11
 s_add_u32 m0, s28, 102400
 v_sub_f32 v70, v70, v11
 buffer_load_dwordx4 v4, s[8:11], s21 offen offset:0 sc1 lds
 v_sub_f32 v71, v71, v11
 v_sub_f32 v72, v72, v10
 v_sub_f32 v73, v73, v10
 v_sub_f32 v74, v74, v10
 v_mfma_f32_32x32x16_bf16 v[176:191], v[56:59], v[56:59], 0
 v_sub_f32 v75, v75, v10
 v_sub_f32 v76, v76, v11
 v_sub_f32 v77, v77, v11
 v_sub_f32 v78, v78, v11
 v_sub_f32 v79, v79, v11
 v_sub_f32 v80, v80, v10
 v_sub_f32 v81, v81, v10
 buffer_load_dwordx4 v4, s[8:11], s21 offen offset:1024 sc1 lds
 v_sub_f32 v82, v82, v10
 v_sub_f32 v83, v83, v10
 v_sub_f32 v84, v84, v11
 v_sub_f32 v85, v85, v11
 v_sub_f32 v86, v86, v11
 v_sub_f32 v87, v87, v11
 v_mfma_f32_32x32x16_bf16 v[192:207], v[56:59], v[56:59], 0
 v_sub_f32 v88, v88, v10
 v_sub_f32 v89, v89, v10
 v_sub_f32 v90, v90, v10
 v_sub_f32 v91, v91, v10
 v_sub_f32 v92, v92, v11
 buffer_load_dwordx4 v4, s[8:11], s21 offen offset:2048 sc1 lds
 v_sub_f32 v93, v93, v11
 v_sub_f32 v94, v94, v11
 v_sub_f32 v95, v95, v11
 v_exp_f32 v18, v64
 v_exp_f32 v19, v65
 v_exp_f32 v20, v66
 v_add_f32 v26, v18, v19
 v_cvt_pk_bf16_f32 v40, v18, v19
 v_mfma_f32_32x32x16_bf16 v[208:223], v[56:59], v[56:59], 0
 v_exp_f32 v21, v67
 v_exp_f32 v22, v72
 v_add_f32 v26, v20, v26
 buffer_load_dwordx4 v4, s[8:11], s21 offen offset:3072 sc1 lds
 v_cvt_pk_bf16_f32 v41, v20, v21
 v_exp_f32 v23, v73
 v_add_f32 v26, v21, v26
 v_exp_f32 v24, v74
 v_add_f32 v26, v22, v26
 v_cvt_pk_bf16_f32 v42, v22, v23
 v_exp_f32 v25, v75
 v_add_f32 v26, v23, v26
 v_exp_f32 v18, v68
 v_add_f32 v26, v24, v26
 v_mfma_f32_32x32x16_bf16 v[224:239], v[56:59], v[56:59], 0
 s_add_u32 s24, s23, 16777216
 s_mov_b32 s23, s21
 s_add_u32 s21, s21, 32768
 s_add_u32 s22, s22, 1
 s_cmp_eq_u32 s22, s25
 s_cselect_b32 s21, s26, s21
 s_cmp_eq_u32 s22, s43
 s_cselect_b32 s21, s4, s21
 s_cmp_eq_u32 s22, s6
 s_cselect_b32 s21, s7, s21
 v_cvt_pk_bf16_f32 v43, v24, v25
 buffer_load_dword v5, off, s[8:11], s47 sc1
 v_exp_f32 v19, v69
 v_add_f32 v26, v25, v26
 v_mfma_f32_32x32x16_bf16 v[240:255], v[56:59], v[56:59], 0
 v_exp_f32 v20, v70
 v_add_f32 v27, v18, v19
 v_cvt_pk_bf16_f32 v44, v18, v19
 v_exp_f32 v21, v71
 v_exp_f32 v22, v76
 v_add_f32 v27, v20, v27
 v_cvt_pk_bf16_f32 v45, v20, v21
 v_exp_f32 v23, v77
 v_add_f32 v27, v21, v27
 v_exp_f32 v24, v78
 v_add_f32 v27, v22, v27
 v_cvt_pk_bf16_f32 v46, v22, v23
 v_exp_f32 v25, v79
 v_add_f32 v27, v23, v27
 v_add_f32 v27, v24, v27
 v_cvt_pk_bf16_f32 v47, v24, v25
 v_add_f32 v27, v25, v27
 v_cndmask_b32 v100, v36, v8, s[64:65]
 v_cndmask_b32 v101, v36, v8, s[66:67]
 v_cndmask_b32 v102, v36, v8, s[68:69]
 v_cndmask_b32 v103, v36, v8, s[70:71]
 v_cndmask_b32 v108, v36, v8, s[72:73]
 v_cndmask_b32 v109, v36, v8, s[74:75]
 v_cndmask_b32 v110, v36, v8, s[76:77]
 v_cndmask_b32 v111, v36, v8, s[78:79]
 v_cndmask_b32 v116, v36, v8, s[80:81]
 v_cndmask_b32 v117, v36, v8, s[82:83]
 v_cndmask_b32 v118, v36, v8, s[84:85]
 v_cndmask_b32 v119, v36, v8, s[86:87]
 v_cndmask_b32 v124, v36, v8, s[88:89]
 v_cndmask_b32 v125, v36, v8, s[90:91]
 v_cndmask_b32 v126, v36, v8, s[92:93]
 v_cndmask_b32 v127, v36, v8, s[94:95]
 s_branch L_p2
L_kv1:
 s_mov_b32 s60, s90
 s_and_b32 s61, s91, 0xffff
 s_mov_b32 s62, 3670016
 s_mov_b32 s63, 0x20000
 s_waitcnt vmcnt(4) lgkmcnt(0)
 s_barrier
 ds_read_b128 a[160:163], v5 offset:0
 ds_read_b128 a[164:167], v6 offset:0
 ds_read_b64_tr_b16 a[32:33], v1 offset:0
 ds_read_b64_tr_b16 a[34:35], v1 offset:1024
 ds_read_b64_tr_b16 a[36:37], v1 offset:8192
 ds_read_b64_tr_b16 a[38:39], v1 offset:9216
 ds_read_b64_tr_b16 a[40:41], v2 offset:0
 ds_read_b64_tr_b16 a[42:43], v2 offset:1024
 ds_read_b64_tr_b16 a[44:45], v2 offset:8192
 ds_read_b64_tr_b16 a[46:47], v2 offset:9216
 ds_read_b128 a[168:171], v5 offset:2048
 ds_read_b128 a[172:175], v6 offset:2048
 ds_read_b64_tr_b16 a[48:49], v3 offset:0
 ds_read_b64_tr_b16 a[50:51], v3 offset:1024
 ds_read_b64_tr_b16 a[52:53], v3 offset:8192
 ds_read_b64_tr_b16 a[54:55], v3 offset:9216
 ds_read_b64_tr_b16 a[56:57], v4 offset:0
 ds_read_b64_tr_b16 a[58:59], v4 offset:1024
 ds_read_b64_tr_b16 a[60:61], v4 offset:8192
 ds_read_b64_tr_b16 a[62:63], v4 offset:9216
 ds_read_b128 a[176:179], v5 offset:4096
 ds_read_b128 a[180:183], v6 offset:4096
 ds_read_b128 a[184:187], v5 offset:6144
 ds_read_b128 a[188:191], v6 offset:6144
 s_add_u32 m0, s24, 16384
 s_nop 0
 buffer_load_dwordx4 v12, s[48:51], s22 offen offset:0   lds
 buffer_load_dwordx4 v13, s[48:51], s22 offen offset:1024   lds
 buffer_load_dwordx4 v14, s[48:51], s22 offen offset:2048   lds
 buffer_load_dwordx4 v15, s[48:51], s22 offen offset:3072   lds
 s_sub_u32 s22, s22, 2097024
 s_add_u32 m0, s23, 32768
 s_nop 0
 buffer_load_dwordx4 v8, s[16:19], s21 offen offset:0  nt lds
 buffer_load_dwordx4 v9, s[16:19], s21 offen offset:1024  nt lds
 buffer_load_dwordx4 v10, s[16:19], s21 offen offset:2048  nt lds
 buffer_load_dwordx4 v11, s[16:19], s21 offen offset:3072  nt lds
 s_add_u32 s21, s21, 128
 s_waitcnt lgkmcnt(15)
M a[0:3], a[32:35], a[160:163], 0
M a[0:3], a[36:39], a[164:167], a[0:3]
 s_waitcnt lgkmcnt(14)
M a[4:7], a[44:47], a[164:167], 0
M a[4:7], a[40:43], a[160:163], a[4:7]
 s_waitcnt lgkmcnt(8)
M a[8:11], a[48:51], a[160:163], 0
M a[8:11], a[52:55], a[164:167], a[8:11]
 s_waitcnt lgkmcnt(4)
M a[12:15], a[60:63], a[164:167], 0
 s_add_u32 m0, s23, 49152
M a[12:15], a[56:59], a[160:163], a[12:15]
 buffer_load_dwordx4 v8, s[16:19], s21 offen offset:0  nt lds
M v[32:35], a[32:35], a[168:171], 0
 buffer_load_dwordx4 v9, s[16:19], s21 offen offset:1024  nt lds
M v[32:35], a[36:39], a[172:175], v[32:35]
M v[36:39], a[44:47], a[172:175], 0
 buffer_load_dwordx4 v10, s[16:19], s21 offen offset:2048  nt lds
M v[36:39], a[40:43], a[168:171], v[36:39]
M v[40:43], a[48:51], a[168:171], 0
 buffer_load_dwordx4 v11, s[16:19], s21 offen offset:3072  nt lds
M v[40:43], a[52:55], a[172:175], v[40:43]
 s_add_u32 s21, s21, 524160
M v[44:47], a[60:63], a[172:175], 0
 s_waitcnt vmcnt(12) lgkmcnt(0)
M v[44:47], a[56:59], a[168:171], v[44:47]
 s_barrier
M v[64:67], a[32:35], a[176:179], 0
 s_add_u32 m0, s24, 32768
 ds_read_b64_tr_b16 a[64:65], v1 offset:16384
 ds_read_b64_tr_b16 a[66:67], v1 offset:17408
M v[64:67], a[36:39], a[180:183], v[64:67]
 ds_read_b64_tr_b16 a[68:69], v1 offset:24576
 ds_read_b64_tr_b16 a[70:71], v1 offset:25600
M v[68:71], a[44:47], a[180:183], 0
 buffer_load_dwordx4 v12, s[48:51], s22 offen offset:0   lds
M v[68:71], a[40:43], a[176:179], v[68:71]
 ds_read_b64_tr_b16 a[72:73], v2 offset:16384
 ds_read_b64_tr_b16 a[74:75], v2 offset:17408
M v[72:75], a[48:51], a[176:179], 0
 ds_read_b64_tr_b16 a[76:77], v2 offset:24576
 ds_read_b64_tr_b16 a[78:79], v2 offset:25600
M v[72:75], a[52:55], a[180:183], v[72:75]
 buffer_load_dwordx4 v13, s[48:51], s22 offen offset:1024   lds
M v[76:79], a[60:63], a[180:183], 0
 ds_read_b64_tr_b16 a[80:81], v3 offset:16384
 ds_read_b64_tr_b16 a[82:83], v3 offset:17408
M v[76:79], a[56:59], a[176:179], v[76:79]
 ds_read_b64_tr_b16 a[84:85], v3 offset:24576
 ds_read_b64_tr_b16 a[86:87], v3 offset:25600
M v[96:99], a[32:35], a[184:187], 0
 buffer_load_dwordx4 v14, s[48:51], s22 offen offset:2048   lds
M v[96:99], a[36:39], a[188:191], v[96:99]
 ds_read_b64_tr_b16 a[88:89], v4 offset:16384
 ds_read_b64_tr_b16 a[90:91], v4 offset:17408
M v[100:103], a[44:47], a[188:191], 0
 ds_read_b64_tr_b16 a[92:93], v4 offset:24576
 ds_read_b64_tr_b16 a[94:95], v4 offset:25600
M v[100:103], a[40:43], a[184:187], v[100:103]
 buffer_load_dwordx4 v15, s[48:51], s22 offen offset:3072   lds
M v[104:107], a[48:51], a[184:187], 0
 s_add_u32 s22, s22, 2097152
 v_max3_f32 v20, |v32|, |v33|, |v34|
 v_max3_f32 v20, |v35|, |v36|, v20
M v[104:107], a[52:55], a[188:191], v[104:107]
 v_max3_f32 v20, |v37|, |v38|, v20
 v_max3_f32 v21, |v64|, |v65|, |v66|
M v[108:111], a[60:63], a[188:191], 0
 s_add_u32 m0, s23, 0
 v_max3_f32 v21, |v67|, |v68|, v21
 v_max3_f32 v21, |v69|, |v70|, v21
M v[108:111], a[56:59], a[184:187], v[108:111]
 s_waitcnt lgkmcnt(0)
 v_min_f32 v20, v20, v21
 v_mul_f32 v20, 0x41000000, v20
M a[16:19], a[64:67], a[160:163], 0
 buffer_load_dwordx4 v8, s[16:19], s21 offen offset:0  nt lds
M a[16:19], a[68:71], a[164:167], a[16:19]
 v_mov_b32 v21, v20
 v_mov_b32 v22, v20
M a[20:23], a[76:79], a[164:167], 0
 buffer_load_dwordx4 v9, s[16:19], s21 offen offset:1024  nt lds
M a[20:23], a[72:75], a[160:163], a[20:23]
 v_mov_b32 v23, v20
 v_accvgpr_write_b32 a241, v20
M a[24:27], a[80:83], a[160:163], 0
M a[24:27], a[84:87], a[164:167], a[24:27]
M a[28:31], a[92:95], a[164:167], 0
 buffer_load_dwordx4 v10, s[16:19], s21 offen offset:2048  nt lds
M a[28:31], a[88:91], a[160:163], a[28:31]
M v[48:51], a[64:67], a[168:171], v[20:23]
M v[48:51], a[68:71], a[172:175], v[48:51]
 buffer_load_dwordx4 v11, s[16:19], s21 offen offset:3072  nt lds
M v[52:55], a[76:79], a[172:175], v[20:23]
 s_add_u32 s21, s21, 128
M v[52:55], a[72:75], a[168:171], v[52:55]
M v[56:59], a[80:83], a[168:171], v[20:23]
M v[56:59], a[84:87], a[172:175], v[56:59]
M v[60:63], a[92:95], a[172:175], v[20:23]
 s_waitcnt vmcnt(12)
M v[60:63], a[88:91], a[168:171], v[60:63]
 s_barrier
M v[80:83], a[64:67], a[176:179], v[20:23]
 s_add_u32 m0, s24, 49152
 ds_read_b128 a[160:163], v5 offset:16384
 ds_read_b128 a[164:167], v6 offset:16384
M v[80:83], a[68:71], a[180:183], v[80:83]
 buffer_load_dwordx4 v12, s[48:51], s22 offen offset:0   lds
M v[84:87], a[76:79], a[180:183], v[20:23]
 ds_read_b64_tr_b16 a[96:97], v1 offset:32768
 ds_read_b64_tr_b16 a[98:99], v1 offset:33792
M v[84:87], a[72:75], a[176:179], v[84:87]
M v[88:91], a[80:83], a[176:179], v[20:23]
 buffer_load_dwordx4 v13, s[48:51], s22 offen offset:1024   lds
M v[88:91], a[84:87], a[180:183], v[88:91]
 ds_read_b64_tr_b16 a[100:101], v1 offset:40960
 ds_read_b64_tr_b16 a[102:103], v1 offset:41984
M v[92:95], a[92:95], a[180:183], v[20:23]
M v[92:95], a[88:91], a[176:179], v[92:95]
M v[112:115], a[64:67], a[184:187], v[20:23]
 ds_read_b64_tr_b16 a[104:105], v2 offset:32768
 ds_read_b64_tr_b16 a[106:107], v2 offset:33792
M v[112:115], a[68:71], a[188:191], v[112:115]
 buffer_load_dwordx4 v14, s[48:51], s22 offen offset:2048   lds
M v[116:119], a[76:79], a[188:191], v[20:23]
M v[116:119], a[72:75], a[184:187], v[116:119]
 ds_read_b64_tr_b16 a[108:109], v2 offset:40960
 ds_read_b64_tr_b16 a[110:111], v2 offset:41984
M v[120:123], a[80:83], a[184:187], v[20:23]
 buffer_load_dwordx4 v15, s[48:51], s22 offen offset:3072   lds
M v[120:123], a[84:87], a[188:191], v[120:123]
 s_waitcnt lgkmcnt(8)
M v[124:127], a[92:95], a[188:191], v[20:23]
 s_sub_u32 s22, s22, 2097024
M v[124:127], a[88:91], a[184:187], v[124:127]
 s_add_u32 m0, s23, 16384
 ds_read_b64_tr_b16 a[112:113], v3 offset:32768
 ds_read_b64_tr_b16 a[114:115], v3 offset:33792
M v[128:131], a[32:35], a[160:163], v[20:23]
 ds_read_b128 a[168:171], v5 offset:18432
 ds_read_b128 a[172:175], v6 offset:18432
M v[128:131], a[36:39], a[164:167], v[128:131]
 buffer_load_dwordx4 v8, s[16:19], s21 offen offset:0  nt lds
M v[132:135], a[44:47], a[164:167], v[20:23]
 ds_read_b64_tr_b16 a[116:117], v3 offset:40960
 ds_read_b64_tr_b16 a[118:119], v3 offset:41984
M v[132:135], a[40:43], a[160:163], v[132:135]
 buffer_load_dwordx4 v9, s[16:19], s21 offen offset:1024  nt lds
M v[136:139], a[48:51], a[160:163], v[20:23]
M v[136:139], a[52:55], a[164:167], v[136:139]
 ds_read_b64_tr_b16 a[120:121], v4 offset:32768
 ds_read_b64_tr_b16 a[122:123], v4 offset:33792
M v[140:143], a[60:63], a[164:167], v[20:23]
 buffer_load_dwordx4 v10, s[16:19], s21 offen offset:2048  nt lds
M v[140:143], a[56:59], a[160:163], v[140:143]
M v[144:147], a[64:67], a[160:163], v[20:23]
 ds_read_b64_tr_b16 a[124:125], v4 offset:40960
 ds_read_b64_tr_b16 a[126:127], v4 offset:41984
M v[144:147], a[68:71], a[164:167], v[144:147]
 buffer_load_dwordx4 v11, s[16:19], s21 offen offset:3072  nt lds
M v[148:151], a[76:79], a[164:167], v[20:23]
 s_add_u32 s21, s21, 524160
M v[148:151], a[72:75], a[160:163], v[148:151]
M v[152:155], a[80:83], a[160:163], v[20:23]
M v[152:155], a[84:87], a[164:167], v[152:155]
 s_waitcnt lgkmcnt(6)
M v[156:159], a[92:95], a[164:167], v[20:23]
 s_waitcnt vmcnt(16) lgkmcnt(0)
M v[156:159], a[88:91], a[160:163], v[156:159]
 s_barrier
M v[160:163], a[32:35], a[168:171], v[20:23]
 s_add_u32 m0, s24, 0
 ds_read_b128 a[160:163], v5 offset:20480
 ds_read_b128 a[164:167], v6 offset:20480
M v[160:163], a[36:39], a[172:175], v[160:163]
 buffer_load_dwordx4 v12, s[48:51], s22 offen offset:0   lds
M v[164:167], a[44:47], a[172:175], v[20:23]
 ds_read_b64_tr_b16 a[128:129], v1 offset:49152
 ds_read_b64_tr_b16 a[130:131], v1 offset:50176
M v[164:167], a[40:43], a[168:171], v[164:167]
M v[168:171], a[48:51], a[168:171], v[20:23]
 buffer_load_dwordx4 v13, s[48:51], s22 offen offset:1024   lds
M v[168:171], a[52:55], a[172:175], v[168:171]
 ds_read_b64_tr_b16 a[132:133], v1 offset:57344
 ds_read_b64_tr_b16 a[134:135], v1 offset:58368
M v[172:175], a[60:63], a[172:175], v[20:23]
M v[172:175], a[56:59], a[168:171], v[172:175]
M v[176:179], a[64:67], a[168:171], v[20:23]
 ds_read_b64_tr_b16 a[136:137], v2 offset:49152
 ds_read_b64_tr_b16 a[138:139], v2 offset:50176
M v[176:179], a[68:71], a[172:175], v[176:179]
 buffer_load_dwordx4 v14, s[48:51], s22 offen offset:2048   lds
M v[180:183], a[76:79], a[172:175], v[20:23]
M v[180:183], a[72:75], a[168:171], v[180:183]
 ds_read_b64_tr_b16 a[140:141], v2 offset:57344
 ds_read_b64_tr_b16 a[142:143], v2 offset:58368
M v[184:187], a[80:83], a[168:171], v[20:23]
 buffer_load_dwordx4 v15, s[48:51], s22 offen offset:3072   lds
M v[184:187], a[84:87], a[172:175], v[184:187]
 s_waitcnt lgkmcnt(8)
M v[188:191], a[92:95], a[172:175], v[20:23]
 s_add_u32 s22, s22, 2097152
M v[188:191], a[88:91], a[168:171], v[188:191]
 s_add_u32 m0, s23, 32768
 ds_read_b64_tr_b16 a[144:145], v3 offset:49152
 ds_read_b64_tr_b16 a[146:147], v3 offset:50176
M v[192:195], a[32:35], a[160:163], v[20:23]
 ds_read_b128 a[168:171], v5 offset:22528
 ds_read_b128 a[172:175], v6 offset:22528
M v[192:195], a[36:39], a[164:167], v[192:195]
 buffer_load_dwordx4 v8, s[16:19], s21 offen offset:0  nt lds
M v[196:199], a[44:47], a[164:167], v[20:23]
 ds_read_b64_tr_b16 a[148:149], v3 offset:57344
 ds_read_b64_tr_b16 a[150:151], v3 offset:58368
M v[196:199], a[40:43], a[160:163], v[196:199]
 buffer_load_dwordx4 v9, s[16:19], s21 offen offset:1024  nt lds
M v[200:203], a[48:51], a[160:163], v[20:23]
M v[200:203], a[52:55], a[164:167], v[200:203]
 ds_read_b64_tr_b16 a[152:153], v4 offset:49152
 ds_read_b64_tr_b16 a[154:155], v4 offset:50176
M v[204:207], a[60:63], a[164:167], v[20:23]
 buffer_load_dwordx4 v10, s[16:19], s21 offen offset:2048  nt lds
M v[204:207], a[56:59], a[160:163], v[204:207]
M v[208:211], a[64:67], a[160:163], v[20:23]
 ds_read_b64_tr_b16 a[156:157], v4 offset:57344
 ds_read_b64_tr_b16 a[158:159], v4 offset:58368
M v[208:211], a[68:71], a[164:167], v[208:211]
 buffer_load_dwordx4 v11, s[16:19], s21 offen offset:3072  nt lds
M v[212:215], a[76:79], a[164:167], v[20:23]
 s_add_u32 s21, s21, 128
M v[212:215], a[72:75], a[160:163], v[212:215]
M v[216:219], a[80:83], a[160:163], v[20:23]
M v[216:219], a[84:87], a[164:167], v[216:219]
 s_waitcnt lgkmcnt(6)
M v[220:223], a[92:95], a[164:167], v[20:23]
 s_waitcnt vmcnt(16) lgkmcnt(0)
M v[220:223], a[88:91], a[160:163], v[220:223]
 s_barrier
M v[224:227], a[32:35], a[168:171], v[20:23]
 ds_read_b128 a[160:163], v5 offset:32768
 ds_read_b128 a[164:167], v6 offset:32768
M v[224:227], a[36:39], a[172:175], v[224:227]
 buffer_load_dword a240, v24, s[32:35], 0 offen offset:512
M v[228:231], a[44:47], a[172:175], v[20:23]
M v[228:231], a[40:43], a[168:171], v[228:231]
M v[232:235], a[48:51], a[168:171], v[20:23]
M v[232:235], a[52:55], a[172:175], v[232:235]
M v[236:239], a[60:63], a[172:175], v[20:23]
M v[236:239], a[56:59], a[168:171], v[236:239]
M v[240:243], a[64:67], a[168:171], v[20:23]
M v[240:243], a[68:71], a[172:175], v[240:243]
M v[244:247], a[76:79], a[172:175], v[20:23]
M v[244:247], a[72:75], a[168:171], v[244:247]
M v[248:251], a[80:83], a[168:171], v[20:23]
M v[248:251], a[84:87], a[172:175], v[248:251]
 s_waitcnt lgkmcnt(0)
M v[252:255], a[92:95], a[172:175], v[20:23]
M v[252:255], a[88:91], a[168:171], v[252:255]
M a[0:3], a[96:99], a[160:163], a[0:3]
 ds_read_b128 a[168:171], v5 offset:34816
 ds_read_b128 a[172:175], v6 offset:34816
M a[0:3], a[100:103], a[164:167], a[0:3]
 ds_read_b64_tr_b16 a[32:33], v1 offset:0
 ds_read_b64_tr_b16 a[34:35], v1 offset:1024
M a[4:7], a[108:111], a[164:167], a[4:7]
 s_add_u32 m0, s24, 16384
M a[4:7], a[104:107], a[160:163], a[4:7]
 buffer_load_dwordx4 v12, s[48:51], s22 offen offset:0   lds
M a[8:11], a[112:115], a[160:163], a[8:11]
M a[8:11], a[116:119], a[164:167], a[8:11]
M a[12:15], a[124:127], a[164:167], a[12:15]
 ds_read_b64_tr_b16 a[36:37], v1 offset:8192
 ds_read_b64_tr_b16 a[38:39], v1 offset:9216
M a[12:15], a[120:123], a[160:163], a[12:15]
M a[16:19], a[128:131], a[160:163], a[16:19]
 buffer_load_dwordx4 v13, s[48:51], s22 offen offset:1024   lds
M a[16:19], a[132:135], a[164:167], a[16:19]
M a[20:23], a[140:143], a[164:167], a[20:23]
M a[20:23], a[136:139], a[160:163], a[20:23]
 ds_read_b64_tr_b16 a[40:41], v2 offset:0
 ds_read_b64_tr_b16 a[42:43], v2 offset:1024
M a[24:27], a[144:147], a[160:163], a[24:27]
M a[24:27], a[148:151], a[164:167], a[24:27]
 s_waitcnt lgkmcnt(6)
M a[28:31], a[156:159], a[164:167], a[28:31]
 buffer_load_dwordx4 v14, s[48:51], s22 offen offset:2048   lds
M a[28:31], a[152:155], a[160:163], a[28:31]
M v[60:63], a[152:155], a[168:171], v[60:63]
 ds_read_b128 a[160:163], v5 offset:36864
 ds_read_b128 a[164:167], v6 offset:36864
M v[60:63], a[156:159], a[172:175], v[60:63]
 ds_read_b64_tr_b16 a[44:45], v2 offset:8192
 ds_read_b64_tr_b16 a[46:47], v2 offset:9216
M v[56:59], a[148:151], a[172:175], v[56:59]
 buffer_load_dwordx4 v15, s[48:51], s22 offen offset:3072   lds
M v[56:59], a[144:147], a[168:171], v[56:59]
 s_sub_u32 s22, s22, 2097024
M v[52:55], a[136:139], a[168:171], v[52:55]
M v[52:55], a[140:143], a[172:175], v[52:55]
 ds_read_b64_tr_b16 a[48:49], v3 offset:0
 ds_read_b64_tr_b16 a[50:51], v3 offset:1024
M v[48:51], a[132:135], a[172:175], v[48:51]
 s_add_u32 m0, s23, 49152
M v[48:51], a[128:131], a[168:171], v[48:51]
 buffer_load_dwordx4 v8, s[16:19], s21 offen offset:0  nt lds
M v[44:47], a[120:123], a[168:171], v[44:47]
M v[44:47], a[124:127], a[172:175], v[44:47]
M v[40:43], a[116:119], a[172:175], v[40:43]
 ds_read_b64_tr_b16 a[52:53], v3 offset:8192
 ds_read_b64_tr_b16 a[54:55], v3 offset:9216
M v[40:43], a[112:115], a[168:171], v[40:43]
M v[36:39], a[104:107], a[168:171], v[36:39]
 buffer_load_dwordx4 v9, s[16:19], s21 offen offset:1024  nt lds
M v[36:39], a[108:111], a[172:175], v[36:39]
 s_waitcnt lgkmcnt(6)
M v[32:35], a[100:103], a[172:175], v[32:35]
M v[32:35], a[96:99], a[168:171], v[32:35]
 ds_read_b64_tr_b16 a[56:57], v4 offset:0
 ds_read_b64_tr_b16 a[58:59], v4 offset:1024
M v[64:67], a[96:99], a[160:163], v[64:67]
 ds_read_b128 a[168:171], v5 offset:38912
 ds_read_b128 a[172:175], v6 offset:38912
M v[64:67], a[100:103], a[164:167], v[64:67]
 buffer_load_dwordx4 v10, s[16:19], s21 offen offset:2048  nt lds
M v[68:71], a[108:111], a[164:167], v[68:71]
M v[68:71], a[104:107], a[160:163], v[68:71]
M v[72:75], a[112:115], a[160:163], v[72:75]
 ds_read_b64_tr_b16 a[60:61], v4 offset:8192
 ds_read_b64_tr_b16 a[62:63], v4 offset:9216
M v[72:75], a[116:119], a[164:167], v[72:75]
M v[76:79], a[124:127], a[164:167], v[76:79]
 buffer_load_dwordx4 v11, s[16:19], s21 offen offset:3072  nt lds
M v[76:79], a[120:123], a[160:163], v[76:79]
 s_add_u32 s21, s21, 524160
M v[80:83], a[128:131], a[160:163], v[80:83]
M v[80:83], a[132:135], a[164:167], v[80:83]
M v[84:87], a[140:143], a[164:167], v[84:87]
M v[84:87], a[136:139], a[160:163], v[84:87]
M v[88:91], a[144:147], a[160:163], v[88:91]
M v[88:91], a[148:151], a[164:167], v[88:91]
 s_waitcnt lgkmcnt(2)
M v[92:95], a[156:159], a[164:167], v[92:95]
 s_waitcnt vmcnt(17) lgkmcnt(0)
M v[92:95], a[152:155], a[160:163], v[92:95]
 s_barrier
M v[124:127], a[152:155], a[168:171], v[124:127]
 ds_read_b128 a[160:163], v5 offset:49152
 ds_read_b128 a[164:167], v6 offset:49152
M v[124:127], a[156:159], a[172:175], v[124:127]
M v[120:123], a[148:151], a[172:175], v[120:123]
 s_add_u32 m0, s24, 32768
 ds_read_b64_tr_b16 a[64:65], v1 offset:16384
 ds_read_b64_tr_b16 a[66:67], v1 offset:17408
M v[120:123], a[144:147], a[168:171], v[120:123]
 buffer_load_dwordx4 v12, s[48:51], s22 offen offset:0   lds
M v[116:119], a[136:139], a[168:171], v[116:119]
M v[116:119], a[140:143], a[172:175], v[116:119]
M v[112:115], a[132:135], a[172:175], v[112:115]
M v[112:115], a[128:131], a[168:171], v[112:115]
M v[108:111], a[120:123], a[168:171], v[108:111]
M v[108:111], a[124:127], a[172:175], v[108:111]
 ds_read_b64_tr_b16 a[68:69], v1 offset:24576
 ds_read_b64_tr_b16 a[70:71], v1 offset:25600
M v[104:107], a[116:119], a[172:175], v[104:107]
 buffer_load_dwordx4 v13, s[48:51], s22 offen offset:1024   lds
M v[104:107], a[112:115], a[168:171], v[104:107]
M v[100:103], a[104:107], a[168:171], v[100:103]
M v[100:103], a[108:111], a[172:175], v[100:103]
 s_waitcnt lgkmcnt(4)
M v[96:99], a[100:103], a[172:175], v[96:99]
M v[96:99], a[96:99], a[168:171], v[96:99]
M v[128:131], a[96:99], a[160:163], v[128:131]
 ds_read_b128 a[168:171], v5 offset:51200
 ds_read_b128 a[172:175], v6 offset:51200
M v[128:131], a[100:103], a[164:167], v[128:131]
 ds_read_b64_tr_b16 a[72:73], v2 offset:16384
 ds_read_b64_tr_b16 a[74:75], v2 offset:17408
M v[132:135], a[108:111], a[164:167], v[132:135]
 buffer_load_dwordx4 v14, s[48:51], s22 offen offset:2048   lds
M v[132:135], a[104:107], a[160:163], v[132:135]
M v[136:139], a[112:115], a[160:163], v[136:139]
M v[136:139], a[116:119], a[164:167], v[136:139]
M v[140:143], a[124:127], a[164:167], v[140:143]
M v[140:143], a[120:123], a[160:163], v[140:143]
 ds_read_b64_tr_b16 a[76:77], v2 offset:24576
 ds_read_b64_tr_b16 a[78:79], v2 offset:25600
M v[144:147], a[128:131], a[160:163], v[144:147]
 buffer_load_dwordx4 v15, s[48:51], s22 offen offset:3072   lds
M v[144:147], a[132:135], a[164:167], v[144:147]
 s_add_u32 s22, s22, 2097152
M v[148:151], a[140:143], a[164:167], v[148:151]
M v[148:151], a[136:139], a[160:163], v[148:151]
M v[152:155], a[144:147], a[160:163], v[152:155]
M v[152:155], a[148:151], a[164:167], v[152:155]
 s_waitcnt lgkmcnt(4)
M v[156:159], a[156:159], a[164:167], v[156:159]
 s_add_u32 m0, s23, 0
 ds_read_b64_tr_b16 a[80:81], v3 offset:16384
 ds_read_b64_tr_b16 a[82:83], v3 offset:17408
M v[156:159], a[152:155], a[160:163], v[156:159]
 buffer_load_dwordx4 v8, s[16:19], s21 offen offset:0  nt lds
M v[188:191], a[152:155], a[168:171], v[188:191]
 ds_read_b128 a[160:163], v5 offset:53248
 ds_read_b128 a[164:167], v6 offset:53248
M v[188:191], a[156:159], a[172:175], v[188:191]
M v[184:187], a[148:151], a[172:175], v[184:187]
M v[184:187], a[144:147], a[168:171], v[184:187]
M v[180:183], a[136:139], a[168:171], v[180:183]
M v[180:183], a[140:143], a[172:175], v[180:183]
 ds_read_b64_tr_b16 a[84:85], v3 offset:24576
 ds_read_b64_tr_b16 a[86:87], v3 offset:25600
M v[176:179], a[132:135], a[172:175], v[176:179]
 buffer_load_dwordx4 v9, s[16:19], s21 offen offset:1024  nt lds
M v[176:179], a[128:131], a[168:171], v[176:179]
M v[172:175], a[120:123], a[168:171], v[172:175]
M v[172:175], a[124:127], a[172:175], v[172:175]
M v[168:171], a[116:119], a[172:175], v[168:171]
M v[168:171], a[112:115], a[168:171], v[168:171]
M v[164:167], a[104:107], a[168:171], v[164:167]
 ds_read_b64_tr_b16 a[88:89], v4 offset:16384
 ds_read_b64_tr_b16 a[90:91], v4 offset:17408
M v[164:167], a[108:111], a[172:175], v[164:167]
 s_waitcnt lgkmcnt(4)
M v[160:163], a[100:103], a[172:175], v[160:163]
 buffer_load_dwordx4 v10, s[16:19], s21 offen offset:2048  nt lds
M v[160:163], a[96:99], a[168:171], v[160:163]
M v[192:195], a[96:99], a[160:163], v[192:195]
 ds_read_b128 a[168:171], v5 offset:55296
 ds_read_b128 a[172:175], v6 offset:55296
M v[192:195], a[100:103], a[164:167], v[192:195]
M v[196:199], a[108:111], a[164:167], v[196:199]
M v[196:199], a[104:107], a[160:163], v[196:199]
 ds_read_b64_tr_b16 a[92:93], v4 offset:24576
 ds_read_b64_tr_b16 a[94:95], v4 offset:25600
M v[200:203], a[112:115], a[160:163], v[200:203]
 buffer_load_dwordx4 v11, s[16:19], s21 offen offset:3072  nt lds
M v[200:203], a[116:119], a[164:167], v[200:203]
 s_add_u32 s21, s21, 128
M v[204:207], a[124:127], a[164:167], v[204:207]
M v[204:207], a[120:123], a[160:163], v[204:207]
M v[208:211], a[128:131], a[160:163], v[208:211]
M v[208:211], a[132:135], a[164:167], v[208:211]
M v[212:215], a[140:143], a[164:167], v[212:215]
M v[212:215], a[136:139], a[160:163], v[212:215]
M v[216:219], a[144:147], a[160:163], v[216:219]
M v[216:219], a[148:151], a[164:167], v[216:219]
 s_waitcnt lgkmcnt(2)
M v[220:223], a[156:159], a[164:167], v[220:223]
 s_waitcnt vmcnt(17) lgkmcnt(0)
M v[220:223], a[152:155], a[160:163], v[220:223]
 s_barrier
M v[252:255], a[152:155], a[168:171], v[252:255]
 ds_read_b128 a[160:163], v5 offset:0
 ds_read_b128 a[164:167], v6 offset:0
M v[252:255], a[156:159], a[172:175], v[252:255]
M v[248:251], a[148:151], a[172:175], v[248:251]
M v[248:251], a[144:147], a[168:171], v[248:251]
M v[244:247], a[136:139], a[168:171], v[244:247]
M v[244:247], a[140:143], a[172:175], v[244:247]
M v[240:243], a[132:135], a[172:175], v[240:243]
M v[240:243], a[128:131], a[168:171], v[240:243]
M v[236:239], a[120:123], a[168:171], v[236:239]
M v[236:239], a[124:127], a[172:175], v[236:239]
M v[232:235], a[116:119], a[172:175], v[232:235]
M v[232:235], a[112:115], a[168:171], v[232:235]
M v[228:231], a[104:107], a[168:171], v[228:231]
M v[228:231], a[108:111], a[172:175], v[228:231]
 s_waitcnt lgkmcnt(0)
M v[224:227], a[100:103], a[172:175], v[224:227]
M v[224:227], a[96:99], a[168:171], v[224:227]
M a[0:3], a[32:35], a[160:163], a[0:3]
 ds_read_b128 a[168:171], v5 offset:2048
 ds_read_b128 a[172:175], v6 offset:2048
M a[0:3], a[36:39], a[164:167], a[0:3]
 ds_read_b64_tr_b16 a[96:97], v1 offset:32768
 ds_read_b64_tr_b16 a[98:99], v1 offset:33792
M a[4:7], a[44:47], a[164:167], a[4:7]
 s_add_u32 m0, s24, 49152
M a[4:7], a[40:43], a[160:163], a[4:7]
 buffer_load_dwordx4 v12, s[48:51], s22 offen offset:0   lds
M a[8:11], a[48:51], a[160:163], a[8:11]
M a[8:11], a[52:55], a[164:167], a[8:11]
M a[12:15], a[60:63], a[164:167], a[12:15]
 ds_read_b64_tr_b16 a[100:101], v1 offset:40960
 ds_read_b64_tr_b16 a[102:103], v1 offset:41984
M a[12:15], a[56:59], a[160:163], a[12:15]
M a[16:19], a[64:67], a[160:163], a[16:19]
 buffer_load_dwordx4 v13, s[48:51], s22 offen offset:1024   lds
M a[16:19], a[68:71], a[164:167], a[16:19]
M a[20:23], a[76:79], a[164:167], a[20:23]
 v_mov_b32 v16, 0x3f80
M a[20:23], a[72:75], a[160:163], a[20:23]
 ds_read_b64_tr_b16 a[104:105], v2 offset:32768
 ds_read_b64_tr_b16 a[106:107], v2 offset:33792
M a[24:27], a[80:83], a[160:163], a[24:27]
 v_lshrrev_b32 v17, 8, v7
M a[24:27], a[84:87], a[164:167], a[24:27]
 s_waitcnt lgkmcnt(6)
 v_bfe_u32 v18, v7, 6, 2
M a[28:31], a[92:95], a[164:167], a[28:31]
 buffer_load_dwordx4 v14, s[48:51], s22 offen offset:2048   lds
M a[28:31], a[88:91], a[160:163], a[28:31]
 v_and_b32 v19, 16, v7
M v[60:63], a[88:91], a[168:171], v[60:63]
 ds_read_b128 a[160:163], v5 offset:4096
 ds_read_b128 a[164:167], v6 offset:4096
M v[60:63], a[92:95], a[172:175], v[60:63]
 ds_read_b64_tr_b16 a[108:109], v2 offset:40960
 ds_read_b64_tr_b16 a[110:111], v2 offset:41984
M v[56:59], a[84:87], a[172:175], v[56:59]
 buffer_load_dwordx4 v15, s[48:51], s22 offen offset:3072   lds
M v[56:59], a[80:83], a[168:171], v[56:59]
 s_sub_u32 s22, s22, 2097024
 v_lshlrev_b32 v19, v19, v16
M v[52:55], a[72:75], a[168:171], v[52:55]
 v_cmp_eq_u32 vcc, v17, v18
M v[52:55], a[76:79], a[172:175], v[52:55]
 ds_read_b64_tr_b16 a[112:113], v3 offset:32768
 ds_read_b64_tr_b16 a[114:115], v3 offset:33792
M v[48:51], a[68:71], a[172:175], v[48:51]
 s_add_u32 m0, s23, 16384
 v_and_b32 v16, 32, v7
M v[48:51], a[64:67], a[168:171], v[48:51]
 buffer_load_dwordx4 v8, s[16:19], s21 offen offset:0  nt lds
M v[44:47], a[56:59], a[168:171], v[44:47]
 v_accvgpr_write_b32 a244, 0
M v[44:47], a[60:63], a[172:175], v[44:47]
 v_accvgpr_write_b32 a245, 0
M v[40:43], a[52:55], a[172:175], v[40:43]
 ds_read_b64_tr_b16 a[116:117], v3 offset:40960
 ds_read_b64_tr_b16 a[118:119], v3 offset:41984
M v[40:43], a[48:51], a[168:171], v[40:43]
 v_cndmask_b32 v19, 0, v19, vcc
M v[36:39], a[40:43], a[168:171], v[36:39]
 buffer_load_dwordx4 v9, s[16:19], s21 offen offset:1024  nt lds
M v[36:39], a[44:47], a[172:175], v[36:39]
 s_waitcnt lgkmcnt(6)
 v_cmp_eq_u32 vcc, 0, v16
M v[32:35], a[36:39], a[172:175], v[32:35]
 v_accvgpr_write_b32 a248, 0
M v[32:35], a[32:35], a[168:171], v[32:35]
 ds_read_b64_tr_b16 a[120:121], v4 offset:32768
 ds_read_b64_tr_b16 a[122:123], v4 offset:33792
M v[64:67], a[32:35], a[160:163], v[64:67]
 ds_read_b128 a[168:171], v5 offset:6144
 ds_read_b128 a[172:175], v6 offset:6144
M v[64:67], a[36:39], a[164:167], v[64:67]
 buffer_load_dwordx4 v10, s[16:19], s21 offen offset:2048  nt lds
M v[68:71], a[44:47], a[164:167], v[68:71]
 v_accvgpr_write_b32 a249, 0
M v[68:71], a[40:43], a[160:163], v[68:71]
 v_cndmask_b32 v17, 0, v19, vcc
M v[72:75], a[48:51], a[160:163], v[72:75]
 ds_read_b64_tr_b16 a[124:125], v4 offset:40960
 ds_read_b64_tr_b16 a[126:127], v4 offset:41984
M v[72:75], a[52:55], a[164:167], v[72:75]
 v_sub_u32 v18, v19, v17
M v[76:79], a[60:63], a[164:167], v[76:79]
 buffer_load_dwordx4 v11, s[16:19], s21 offen offset:3072  nt lds
M v[76:79], a[56:59], a[160:163], v[76:79]
 s_add_u32 s21, s21, 524160
 v_accvgpr_write_b32 a246, v17
M v[80:83], a[64:67], a[160:163], v[80:83]
 v_accvgpr_write_b32 a247, v18
M v[80:83], a[68:71], a[164:167], v[80:83]
M v[84:87], a[76:79], a[164:167], v[84:87]
M v[84:87], a[72:75], a[160:163], v[84:87]
M v[88:91], a[80:83], a[160:163], v[88:91]
M v[88:91], a[84:87], a[164:167], v[88:91]
 s_waitcnt lgkmcnt(2)
M v[92:95], a[92:95], a[164:167], v[92:95]
 s_waitcnt vmcnt(16) lgkmcnt(0)
M v[92:95], a[88:91], a[160:163], v[92:95]
 s_barrier
M v[124:127], a[88:91], a[168:171], v[124:127]
 ds_read_b128 a[160:163], v5 offset:16384
 ds_read_b128 a[164:167], v6 offset:16384
M v[124:127], a[92:95], a[172:175], v[124:127]
M v[120:123], a[84:87], a[172:175], v[120:123]
 s_add_u32 m0, s24, 0
 ds_read_b64_tr_b16 a[128:129], v1 offset:49152
 ds_read_b64_tr_b16 a[130:131], v1 offset:50176
M v[120:123], a[80:83], a[168:171], v[120:123]
 buffer_load_dwordx4 v12, s[48:51], s22 offen offset:0   lds
M v[116:119], a[72:75], a[168:171], v[116:119]
M v[116:119], a[76:79], a[172:175], v[116:119]
M v[112:115], a[68:71], a[172:175], v[112:115]
M v[112:115], a[64:67], a[168:171], v[112:115]
M v[108:111], a[56:59], a[168:171], v[108:111]
M v[108:111], a[60:63], a[172:175], v[108:111]
 ds_read_b64_tr_b16 a[132:133], v1 offset:57344
 ds_read_b64_tr_b16 a[134:135], v1 offset:58368
M v[104:107], a[52:55], a[172:175], v[104:107]
 buffer_load_dwordx4 v13, s[48:51], s22 offen offset:1024   lds
M v[104:107], a[48:51], a[168:171], v[104:107]
M v[100:103], a[40:43], a[168:171], v[100:103]
M v[100:103], a[44:47], a[172:175], v[100:103]
 s_waitcnt lgkmcnt(4)
M v[96:99], a[36:39], a[172:175], v[96:99]
M v[96:99], a[32:35], a[168:171], v[96:99]
M v[128:131], a[32:35], a[160:163], v[128:131]
 ds_read_b128 a[168:171], v5 offset:18432
 ds_read_b128 a[172:175], v6 offset:18432
M v[128:131], a[36:39], a[164:167], v[128:131]
 ds_read_b64_tr_b16 a[136:137], v2 offset:49152
 ds_read_b64_tr_b16 a[138:139], v2 offset:50176
M v[132:135], a[44:47], a[164:167], v[132:135]
 buffer_load_dwordx4 v14, s[48:51], s22 offen offset:2048   lds
M v[132:135], a[40:43], a[160:163], v[132:135]
M v[136:139], a[48:51], a[160:163], v[136:139]
M v[136:139], a[52:55], a[164:167], v[136:139]
M v[140:143], a[60:63], a[164:167], v[140:143]
M v[140:143], a[56:59], a[160:163], v[140:143]
 ds_read_b64_tr_b16 a[140:141], v2 offset:57344
 ds_read_b64_tr_b16 a[142:143], v2 offset:58368
M v[144:147], a[64:67], a[160:163], v[144:147]
 buffer_load_dwordx4 v15, s[48:51], s22 offen offset:3072   lds
M v[144:147], a[68:71], a[164:167], v[144:147]
 s_add_u32 s22, s22, 2097152
M v[148:151], a[76:79], a[164:167], v[148:151]
M v[148:151], a[72:75], a[160:163], v[148:151]
M v[152:155], a[80:83], a[160:163], v[152:155]
M v[152:155], a[84:87], a[164:167], v[152:155]
 s_waitcnt lgkmcnt(4)
M v[156:159], a[92:95], a[164:167], v[156:159]
 s_add_u32 m0, s23, 32768
 ds_read_b64_tr_b16 a[144:145], v3 offset:49152
 ds_read_b64_tr_b16 a[146:147], v3 offset:50176
M v[156:159], a[88:91], a[160:163], v[156:159]
 buffer_load_dwordx4 v8, s[16:19], s21 offen offset:0  nt lds
M v[188:191], a[88:91], a[168:171], v[188:191]
 ds_read_b128 a[160:163], v5 offset:20480
 ds_read_b128 a[164:167], v6 offset:20480
M v[188:191], a[92:95], a[172:175], v[188:191]
M v[184:187], a[84:87], a[172:175], v[184:187]
M v[184:187], a[80:83], a[168:171], v[184:187]
M v[180:183], a[72:75], a[168:171], v[180:183]
M v[180:183], a[76:79], a[172:175], v[180:183]
 ds_read_b64_tr_b16 a[148:149], v3 offset:57344
 ds_read_b64_tr_b16 a[150:151], v3 offset:58368
M v[176:179], a[68:71], a[172:175], v[176:179]
 buffer_load_dwordx4 v9, s[16:19], s21 offen offset:1024  nt lds
M v[176:179], a[64:67], a[168:171], v[176:179]
M v[172:175], a[56:59], a[168:171], v[172:175]
M v[172:175], a[60:63], a[172:175], v[172:175]
M v[168:171], a[52:55], a[172:175], v[168:171]
M v[168:171], a[48:51], a[168:171], v[168:171]
M v[164:167], a[40:43], a[168:171], v[164:167]
 ds_read_b64_tr_b16 a[152:153], v4 offset:49152
 ds_read_b64_tr_b16 a[154:155], v4 offset:50176
M v[164:167], a[44:47], a[172:175], v[164:167]
 s_waitcnt lgkmcnt(4)
M v[160:163], a[36:39], a[172:175], v[160:163]
 buffer_load_dwordx4 v10, s[16:19], s21 offen offset:2048  nt lds
M v[160:163], a[32:35], a[168:171], v[160:163]
M v[192:195], a[32:35], a[160:163], v[192:195]
 ds_read_b128 a[168:171], v5 offset:22528
 ds_read_b128 a[172:175], v6 offset:22528
M v[192:195], a[36:39], a[164:167], v[192:195]
M v[196:199], a[44:47], a[164:167], v[196:199]
M v[196:199], a[40:43], a[160:163], v[196:199]
 ds_read_b64_tr_b16 a[156:157], v4 offset:57344
 ds_read_b64_tr_b16 a[158:159], v4 offset:58368
M v[200:203], a[48:51], a[160:163], v[200:203]
 buffer_load_dwordx4 v11, s[16:19], s21 offen offset:3072  nt lds
M v[200:203], a[52:55], a[164:167], v[200:203]
 s_add_u32 s21, s21, 128
M v[204:207], a[60:63], a[164:167], v[204:207]
M v[204:207], a[56:59], a[160:163], v[204:207]
M v[208:211], a[64:67], a[160:163], v[208:211]
M v[208:211], a[68:71], a[164:167], v[208:211]
M v[212:215], a[76:79], a[164:167], v[212:215]
M v[212:215], a[72:75], a[160:163], v[212:215]
M v[216:219], a[80:83], a[160:163], v[216:219]
M v[216:219], a[84:87], a[164:167], v[216:219]
 s_waitcnt lgkmcnt(2)
M v[220:223], a[92:95], a[164:167], v[220:223]
 s_waitcnt vmcnt(16) lgkmcnt(0)
M v[220:223], a[88:91], a[160:163], v[220:223]
 s_barrier
M v[252:255], a[88:91], a[168:171], v[252:255]
 ds_read_b128 a[160:163], v5 offset:32768
 ds_read_b128 a[164:167], v6 offset:32768
M v[252:255], a[92:95], a[172:175], v[252:255]
M v[248:251], a[84:87], a[172:175], v[248:251]
M v[248:251], a[80:83], a[168:171], v[248:251]
M v[244:247], a[72:75], a[168:171], v[244:247]
M v[244:247], a[76:79], a[172:175], v[244:247]
M v[240:243], a[68:71], a[172:175], v[240:243]
M v[240:243], a[64:67], a[168:171], v[240:243]
M v[236:239], a[56:59], a[168:171], v[236:239]
M v[236:239], a[60:63], a[172:175], v[236:239]
M v[232:235], a[52:55], a[172:175], v[232:235]
M v[232:235], a[48:51], a[168:171], v[232:235]
M v[228:231], a[40:43], a[168:171], v[228:231]
M v[228:231], a[44:47], a[172:175], v[228:231]
 s_waitcnt lgkmcnt(0)
M v[224:227], a[36:39], a[172:175], v[224:227]
M v[224:227], a[32:35], a[168:171], v[224:227]
M a[0:3], a[96:99], a[160:163], a[0:3]
 ds_read_b128 a[168:171], v5 offset:34816
 ds_read_b128 a[172:175], v6 offset:34816
M a[0:3], a[100:103], a[164:167], a[0:3]
 ds_read_b64_tr_b16 a[32:33], v1 offset:0
 ds_read_b64_tr_b16 a[34:35], v1 offset:1024
M a[4:7], a[108:111], a[164:167], a[4:7]
 s_add_u32 m0, s24, 16384
M a[4:7], a[104:107], a[160:163], a[4:7]
 buffer_load_dwordx4 v12, s[48:51], s22 offen offset:0   lds
M a[8:11], a[112:115], a[160:163], a[8:11]
M a[8:11], a[116:119], a[164:167], a[8:11]
M a[12:15], a[124:127], a[164:167], a[12:15]
 ds_read_b64_tr_b16 a[36:37], v1 offset:8192
 ds_read_b64_tr_b16 a[38:39], v1 offset:9216
M a[12:15], a[120:123], a[160:163], a[12:15]
M a[16:19], a[128:131], a[160:163], a[16:19]
 buffer_load_dwordx4 v13, s[48:51], s22 offen offset:1024   lds
M a[16:19], a[132:135], a[164:167], a[16:19]
M a[20:23], a[140:143], a[164:167], a[20:23]
M a[20:23], a[136:139], a[160:163], a[20:23]
 ds_read_b64_tr_b16 a[40:41], v2 offset:0
 ds_read_b64_tr_b16 a[42:43], v2 offset:1024
M a[24:27], a[144:147], a[160:163], a[24:27]
M a[24:27], a[148:151], a[164:167], a[24:27]
 s_waitcnt lgkmcnt(6)
M a[28:31], a[156:159], a[164:167], a[28:31]
 buffer_load_dwordx4 v14, s[48:51], s22 offen offset:2048   lds
M a[28:31], a[152:155], a[160:163], a[28:31]
M v[60:63], a[152:155], a[168:171], v[60:63]
 ds_read_b128 a[160:163], v5 offset:36864
 ds_read_b128 a[164:167], v6 offset:36864
M v[60:63], a[156:159], a[172:175], v[60:63]
 ds_read_b64_tr_b16 a[44:45], v2 offset:8192
 ds_read_b64_tr_b16 a[46:47], v2 offset:9216
M v[56:59], a[148:151], a[172:175], v[56:59]
 buffer_load_dwordx4 v15, s[48:51], s22 offen offset:3072   lds
M v[56:59], a[144:147], a[168:171], v[56:59]
 s_sub_u32 s22, s22, 2097024
M v[52:55], a[136:139], a[168:171], v[52:55]
M v[52:55], a[140:143], a[172:175], v[52:55]
 ds_read_b64_tr_b16 a[48:49], v3 offset:0
 ds_read_b64_tr_b16 a[50:51], v3 offset:1024
M v[48:51], a[132:135], a[172:175], v[48:51]
 s_add_u32 m0, s23, 49152
M v[48:51], a[128:131], a[168:171], v[48:51]
 buffer_load_dwordx4 v8, s[16:19], s21 offen offset:0  nt lds
M v[44:47], a[120:123], a[168:171], v[44:47]
M v[44:47], a[124:127], a[172:175], v[44:47]
M v[40:43], a[116:119], a[172:175], v[40:43]
 ds_read_b64_tr_b16 a[52:53], v3 offset:8192
 ds_read_b64_tr_b16 a[54:55], v3 offset:9216
M v[40:43], a[112:115], a[168:171], v[40:43]
M v[36:39], a[104:107], a[168:171], v[36:39]
 buffer_load_dwordx4 v9, s[16:19], s21 offen offset:1024  nt lds
M v[36:39], a[108:111], a[172:175], v[36:39]
 s_waitcnt lgkmcnt(6)
M v[32:35], a[100:103], a[172:175], v[32:35]
M v[32:35], a[96:99], a[168:171], v[32:35]
 ds_read_b64_tr_b16 a[56:57], v4 offset:0
 ds_read_b64_tr_b16 a[58:59], v4 offset:1024
M v[64:67], a[96:99], a[160:163], v[64:67]
 ds_read_b128 a[168:171], v5 offset:38912
 ds_read_b128 a[172:175], v6 offset:38912
M v[64:67], a[100:103], a[164:167], v[64:67]
 buffer_load_dwordx4 v10, s[16:19], s21 offen offset:2048  nt lds
M v[68:71], a[108:111], a[164:167], v[68:71]
M v[68:71], a[104:107], a[160:163], v[68:71]
M v[72:75], a[112:115], a[160:163], v[72:75]
 ds_read_b64_tr_b16 a[60:61], v4 offset:8192
 ds_read_b64_tr_b16 a[62:63], v4 offset:9216
M v[72:75], a[116:119], a[164:167], v[72:75]
M v[76:79], a[124:127], a[164:167], v[76:79]
 buffer_load_dwordx4 v11, s[16:19], s21 offen offset:3072  nt lds
M v[76:79], a[120:123], a[160:163], v[76:79]
 s_add_u32 s21, s21, 524160
M v[80:83], a[128:131], a[160:163], v[80:83]
M v[80:83], a[132:135], a[164:167], v[80:83]
M v[84:87], a[140:143], a[164:167], v[84:87]
M v[84:87], a[136:139], a[160:163], v[84:87]
M v[88:91], a[144:147], a[160:163], v[88:91]
M v[88:91], a[148:151], a[164:167], v[88:91]
 s_waitcnt lgkmcnt(2)
M v[92:95], a[156:159], a[164:167], v[92:95]
 s_waitcnt vmcnt(16) lgkmcnt(0)
M v[92:95], a[152:155], a[160:163], v[92:95]
 s_barrier
M v[124:127], a[152:155], a[168:171], v[124:127]
 ds_read_b128 a[160:163], v5 offset:49152
 ds_read_b128 a[164:167], v6 offset:49152
M v[124:127], a[156:159], a[172:175], v[124:127]
M v[120:123], a[148:151], a[172:175], v[120:123]
 s_add_u32 m0, s24, 32768
 ds_read_b64_tr_b16 a[64:65], v1 offset:16384
 ds_read_b64_tr_b16 a[66:67], v1 offset:17408
M v[120:123], a[144:147], a[168:171], v[120:123]
 buffer_load_dwordx4 v12, s[48:51], s22 offen offset:0   lds
M v[116:119], a[136:139], a[168:171], v[116:119]
 v_min_u32 v16, 40, v0
 v_lshlrev_b32 v16, 2, v16
M v[116:119], a[140:143], a[172:175], v[116:119]
 buffer_load_dword v17, v16, s[12:15], 0 offen offset:64 sc1
M v[112:115], a[132:135], a[172:175], v[112:115]
M v[112:115], a[128:131], a[168:171], v[112:115]
M v[108:111], a[120:123], a[168:171], v[108:111]
M v[108:111], a[124:127], a[172:175], v[108:111]
 ds_read_b64_tr_b16 a[68:69], v1 offset:24576
 ds_read_b64_tr_b16 a[70:71], v1 offset:25600
M v[104:107], a[116:119], a[172:175], v[104:107]
 buffer_load_dwordx4 v13, s[48:51], s22 offen offset:1024   lds
M v[104:107], a[112:115], a[168:171], v[104:107]
M v[100:103], a[104:107], a[168:171], v[100:103]
M v[100:103], a[108:111], a[172:175], v[100:103]
 s_waitcnt lgkmcnt(4)
M v[96:99], a[100:103], a[172:175], v[96:99]
M v[96:99], a[96:99], a[168:171], v[96:99]
M v[128:131], a[96:99], a[160:163], v[128:131]
 ds_read_b128 a[168:171], v5 offset:51200
 ds_read_b128 a[172:175], v6 offset:51200
M v[128:131], a[100:103], a[164:167], v[128:131]
 ds_read_b64_tr_b16 a[72:73], v2 offset:16384
 ds_read_b64_tr_b16 a[74:75], v2 offset:17408
M v[132:135], a[108:111], a[164:167], v[132:135]
 buffer_load_dwordx4 v14, s[48:51], s22 offen offset:2048   lds
M v[132:135], a[104:107], a[160:163], v[132:135]
M v[136:139], a[112:115], a[160:163], v[136:139]
M v[136:139], a[116:119], a[164:167], v[136:139]
M v[140:143], a[124:127], a[164:167], v[140:143]
M v[140:143], a[120:123], a[160:163], v[140:143]
 ds_read_b64_tr_b16 a[76:77], v2 offset:24576
 ds_read_b64_tr_b16 a[78:79], v2 offset:25600
M v[144:147], a[128:131], a[160:163], v[144:147]
 buffer_load_dwordx4 v15, s[48:51], s22 offen offset:3072   lds
M v[144:147], a[132:135], a[164:167], v[144:147]
 s_add_u32 s22, s22, 2097152
M v[148:151], a[140:143], a[164:167], v[148:151]
M v[148:151], a[136:139], a[160:163], v[148:151]
M v[152:155], a[144:147], a[160:163], v[152:155]
M v[152:155], a[148:151], a[164:167], v[152:155]
 s_waitcnt lgkmcnt(4)
M v[156:159], a[156:159], a[164:167], v[156:159]
 s_add_u32 m0, s23, 0
 ds_read_b64_tr_b16 a[80:81], v3 offset:16384
 ds_read_b64_tr_b16 a[82:83], v3 offset:17408
M v[156:159], a[152:155], a[160:163], v[156:159]
 buffer_load_dwordx4 v8, s[16:19], s21 offen offset:0  nt lds
M v[188:191], a[152:155], a[168:171], v[188:191]
 ds_read_b128 a[160:163], v5 offset:53248
 ds_read_b128 a[164:167], v6 offset:53248
M v[188:191], a[156:159], a[172:175], v[188:191]
M v[184:187], a[148:151], a[172:175], v[184:187]
M v[184:187], a[144:147], a[168:171], v[184:187]
M v[180:183], a[136:139], a[168:171], v[180:183]
M v[180:183], a[140:143], a[172:175], v[180:183]
 ds_read_b64_tr_b16 a[84:85], v3 offset:24576
 ds_read_b64_tr_b16 a[86:87], v3 offset:25600
M v[176:179], a[132:135], a[172:175], v[176:179]
 buffer_load_dwordx4 v9, s[16:19], s21 offen offset:1024  nt lds
M v[176:179], a[128:131], a[168:171], v[176:179]
M v[172:175], a[120:123], a[168:171], v[172:175]
M v[172:175], a[124:127], a[172:175], v[172:175]
M v[168:171], a[116:119], a[172:175], v[168:171]
M v[168:171], a[112:115], a[168:171], v[168:171]
M v[164:167], a[104:107], a[168:171], v[164:167]
 ds_read_b64_tr_b16 a[88:89], v4 offset:16384
 ds_read_b64_tr_b16 a[90:91], v4 offset:17408
M v[164:167], a[108:111], a[172:175], v[164:167]
 s_waitcnt lgkmcnt(4)
M v[160:163], a[100:103], a[172:175], v[160:163]
 buffer_load_dwordx4 v10, s[16:19], s21 offen offset:2048  nt lds
M v[160:163], a[96:99], a[168:171], v[160:163]
M v[192:195], a[96:99], a[160:163], v[192:195]
 ds_read_b128 a[168:171], v5 offset:55296
 ds_read_b128 a[172:175], v6 offset:55296
M v[192:195], a[100:103], a[164:167], v[192:195]
M v[196:199], a[108:111], a[164:167], v[196:199]
M v[196:199], a[104:107], a[160:163], v[196:199]
 ds_read_b64_tr_b16 a[92:93], v4 offset:24576
 ds_read_b64_tr_b16 a[94:95], v4 offset:25600
M v[200:203], a[112:115], a[160:163], v[200:203]
 buffer_load_dwordx4 v11, s[16:19], s21 offen offset:3072  nt lds
M v[200:203], a[116:119], a[164:167], v[200:203]
 s_add_u32 s21, s21, 128
M v[204:207], a[124:127], a[164:167], v[204:207]
M v[204:207], a[120:123], a[160:163], v[204:207]
M v[208:211], a[128:131], a[160:163], v[208:211]
M v[208:211], a[132:135], a[164:167], v[208:211]
M v[212:215], a[140:143], a[164:167], v[212:215]
M v[212:215], a[136:139], a[160:163], v[212:215]
M v[216:219], a[144:147], a[160:163], v[216:219]
M v[216:219], a[148:151], a[164:167], v[216:219]
 s_waitcnt lgkmcnt(2)
M v[220:223], a[156:159], a[164:167], v[220:223]
 s_waitcnt vmcnt(17) lgkmcnt(0)
M v[220:223], a[152:155], a[160:163], v[220:223]
 s_barrier
M v[252:255], a[152:155], a[168:171], v[252:255]
 ds_read_b128 a[160:163], v5 offset:0
 ds_read_b128 a[164:167], v6 offset:0
M v[252:255], a[156:159], a[172:175], v[252:255]
M v[248:251], a[148:151], a[172:175], v[248:251]
M v[248:251], a[144:147], a[168:171], v[248:251]
M v[244:247], a[136:139], a[168:171], v[244:247]
M v[244:247], a[140:143], a[172:175], v[244:247]
M v[240:243], a[132:135], a[172:175], v[240:243]
M v[240:243], a[128:131], a[168:171], v[240:243]
M v[236:239], a[120:123], a[168:171], v[236:239]
M v[236:239], a[124:127], a[172:175], v[236:239]
M v[232:235], a[116:119], a[172:175], v[232:235]
M v[232:235], a[112:115], a[168:171], v[232:235]
M v[228:231], a[104:107], a[168:171], v[228:231]
M v[228:231], a[108:111], a[172:175], v[228:231]
 s_waitcnt lgkmcnt(0)
M v[224:227], a[100:103], a[172:175], v[224:227]
M v[224:227], a[96:99], a[168:171], v[224:227]
M a[0:3], a[32:35], a[160:163], a[0:3]
 ds_read_b128 a[168:171], v5 offset:2048
 ds_read_b128 a[172:175], v6 offset:2048
M a[0:3], a[36:39], a[164:167], a[0:3]
 ds_read_b64_tr_b16 a[96:97], v1 offset:32768
 ds_read_b64_tr_b16 a[98:99], v1 offset:33792
M a[4:7], a[44:47], a[164:167], a[4:7]
 s_add_u32 m0, s24, 49152
M a[4:7], a[40:43], a[160:163], a[4:7]
 buffer_load_dwordx4 v12, s[48:51], s22 offen offset:0   lds
M a[8:11], a[48:51], a[160:163], a[8:11]
M a[8:11], a[52:55], a[164:167], a[8:11]
M a[12:15], a[60:63], a[164:167], a[12:15]
 ds_read_b64_tr_b16 a[100:101], v1 offset:40960
 ds_read_b64_tr_b16 a[102:103], v1 offset:41984
M a[12:15], a[56:59], a[160:163], a[12:15]
M a[16:19], a[64:67], a[160:163], a[16:19]
 buffer_load_dwordx4 v13, s[48:51], s22 offen offset:1024   lds
M a[16:19], a[68:71], a[164:167], a[16:19]
M a[20:23], a[76:79], a[164:167], a[20:23]
M a[20:23], a[72:75], a[160:163], a[20:23]
 ds_read_b64_tr_b16 a[104:105], v2 offset:32768
 ds_read_b64_tr_b16 a[106:107], v2 offset:33792
M a[24:27], a[80:83], a[160:163], a[24:27]
M a[24:27], a[84:87], a[164:167], a[24:27]
 s_waitcnt lgkmcnt(6)
M a[28:31], a[92:95], a[164:167], a[28:31]
 buffer_load_dwordx4 v14, s[48:51], s22 offen offset:2048   lds
M a[28:31], a[88:91], a[160:163], a[28:31]
M v[60:63], a[88:91], a[168:171], v[60:63]
 ds_read_b128 a[160:163], v5 offset:4096
 ds_read_b128 a[164:167], v6 offset:4096
M v[60:63], a[92:95], a[172:175], v[60:63]
 ds_read_b64_tr_b16 a[108:109], v2 offset:40960
 ds_read_b64_tr_b16 a[110:111], v2 offset:41984
M v[56:59], a[84:87], a[172:175], v[56:59]
 buffer_load_dwordx4 v15, s[48:51], s22 offen offset:3072   lds
M v[56:59], a[80:83], a[168:171], v[56:59]
 s_sub_u32 s22, s22, 2097024
M v[52:55], a[72:75], a[168:171], v[52:55]
M v[52:55], a[76:79], a[172:175], v[52:55]
 ds_read_b64_tr_b16 a[112:113], v3 offset:32768
 ds_read_b64_tr_b16 a[114:115], v3 offset:33792
M v[48:51], a[68:71], a[172:175], v[48:51]
 s_add_u32 m0, s23, 16384
M v[48:51], a[64:67], a[168:171], v[48:51]
 buffer_load_dwordx4 v8, s[16:19], s21 offen offset:0  nt lds
M v[44:47], a[56:59], a[168:171], v[44:47]
M v[44:47], a[60:63], a[172:175], v[44:47]
M v[40:43], a[52:55], a[172:175], v[40:43]
 ds_read_b64_tr_b16 a[116:117], v3 offset:40960
 ds_read_b64_tr_b16 a[118:119], v3 offset:41984
M v[40:43], a[48:51], a[168:171], v[40:43]
M v[36:39], a[40:43], a[168:171], v[36:39]
 buffer_load_dwordx4 v9, s[16:19], s21 offen offset:1024  nt lds
M v[36:39], a[44:47], a[172:175], v[36:39]
 s_waitcnt lgkmcnt(6)
M v[32:35], a[36:39], a[172:175], v[32:35]
M v[32:35], a[32:35], a[168:171], v[32:35]
 ds_read_b64_tr_b16 a[120:121], v4 offset:32768
 ds_read_b64_tr_b16 a[122:123], v4 offset:33792
M v[64:67], a[32:35], a[160:163], v[64:67]
 ds_read_b128 a[168:171], v5 offset:6144
 ds_read_b128 a[172:175], v6 offset:6144
M v[64:67], a[36:39], a[164:167], v[64:67]
 buffer_load_dwordx4 v10, s[16:19], s21 offen offset:2048  nt lds
M v[68:71], a[44:47], a[164:167], v[68:71]
M v[68:71], a[40:43], a[160:163], v[68:71]
M v[72:75], a[48:51], a[160:163], v[72:75]
 ds_read_b64_tr_b16 a[124:125], v4 offset:40960
 ds_read_b64_tr_b16 a[126:127], v4 offset:41984
M v[72:75], a[52:55], a[164:167], v[72:75]
M v[76:79], a[60:63], a[164:167], v[76:79]
 buffer_load_dwordx4 v11, s[16:19], s21 offen offset:3072  nt lds
M v[76:79], a[56:59], a[160:163], v[76:79]
 s_add_u32 s21, s21, 524160
M v[80:83], a[64:67], a[160:163], v[80:83]
M v[80:83], a[68:71], a[164:167], v[80:83]
M v[84:87], a[76:79], a[164:167], v[84:87]
M v[84:87], a[72:75], a[160:163], v[84:87]
M v[88:91], a[80:83], a[160:163], v[88:91]
M v[88:91], a[84:87], a[164:167], v[88:91]
 s_waitcnt lgkmcnt(2)
M v[92:95], a[92:95], a[164:167], v[92:95]
 s_waitcnt vmcnt(17) lgkmcnt(0)
M v[92:95], a[88:91], a[160:163], v[92:95]
 s_barrier
M v[124:127], a[88:91], a[168:171], v[124:127]
 ds_read_b128 a[160:163], v5 offset:16384
 ds_read_b128 a[164:167], v6 offset:16384
M v[124:127], a[92:95], a[172:175], v[124:127]
M v[120:123], a[84:87], a[172:175], v[120:123]
 s_add_u32 m0, s24, 0
 ds_read_b64_tr_b16 a[128:129], v1 offset:49152
 ds_read_b64_tr_b16 a[130:131], v1 offset:50176
M v[120:123], a[80:83], a[168:171], v[120:123]
 buffer_load_dwordx4 v12, s[48:51], s22 offen offset:0   lds
M v[116:119], a[72:75], a[168:171], v[116:119]
M v[116:119], a[76:79], a[172:175], v[116:119]
M v[112:115], a[68:71], a[172:175], v[112:115]
M v[112:115], a[64:67], a[168:171], v[112:115]
M v[108:111], a[56:59], a[168:171], v[108:111]
M v[108:111], a[60:63], a[172:175], v[108:111]
 ds_read_b64_tr_b16 a[132:133], v1 offset:57344
 ds_read_b64_tr_b16 a[134:135], v1 offset:58368
M v[104:107], a[52:55], a[172:175], v[104:107]
 buffer_load_dwordx4 v13, s[48:51], s22 offen offset:1024   lds
M v[104:107], a[48:51], a[168:171], v[104:107]
M v[100:103], a[40:43], a[168:171], v[100:103]
M v[100:103], a[44:47], a[172:175], v[100:103]
 s_waitcnt lgkmcnt(4)
M v[96:99], a[36:39], a[172:175], v[96:99]
M v[96:99], a[32:35], a[168:171], v[96:99]
M v[128:131], a[32:35], a[160:163], v[128:131]
 ds_read_b128 a[168:171], v5 offset:18432
 ds_read_b128 a[172:175], v6 offset:18432
M v[128:131], a[36:39], a[164:167], v[128:131]
 ds_read_b64_tr_b16 a[136:137], v2 offset:49152
 ds_read_b64_tr_b16 a[138:139], v2 offset:50176
M v[132:135], a[44:47], a[164:167], v[132:135]
 buffer_load_dwordx4 v14, s[48:51], s22 offen offset:2048   lds
M v[132:135], a[40:43], a[160:163], v[132:135]
M v[136:139], a[48:51], a[160:163], v[136:139]
M v[136:139], a[52:55], a[164:167], v[136:139]
M v[140:143], a[60:63], a[164:167], v[140:143]
M v[140:143], a[56:59], a[160:163], v[140:143]
 ds_read_b64_tr_b16 a[140:141], v2 offset:57344
 ds_read_b64_tr_b16 a[142:143], v2 offset:58368
M v[144:147], a[64:67], a[160:163], v[144:147]
 buffer_load_dwordx4 v15, s[48:51], s22 offen offset:3072   lds
M v[144:147], a[68:71], a[164:167], v[144:147]
 s_add_u32 s22, s22, 2097152
M v[148:151], a[76:79], a[164:167], v[148:151]
M v[148:151], a[72:75], a[160:163], v[148:151]
M v[152:155], a[80:83], a[160:163], v[152:155]
M v[152:155], a[84:87], a[164:167], v[152:155]
 s_waitcnt lgkmcnt(4)
M v[156:159], a[92:95], a[164:167], v[156:159]
 s_add_u32 m0, s23, 32768
 ds_read_b64_tr_b16 a[144:145], v3 offset:49152
 ds_read_b64_tr_b16 a[146:147], v3 offset:50176
M v[156:159], a[88:91], a[160:163], v[156:159]
 buffer_load_dwordx4 v8, s[16:19], s21 offen offset:0  nt lds
M v[188:191], a[88:91], a[168:171], v[188:191]
 ds_read_b128 a[160:163], v5 offset:20480
 ds_read_b128 a[164:167], v6 offset:20480
M v[188:191], a[92:95], a[172:175], v[188:191]
M v[184:187], a[84:87], a[172:175], v[184:187]
M v[184:187], a[80:83], a[168:171], v[184:187]
M v[180:183], a[72:75], a[168:171], v[180:183]
M v[180:183], a[76:79], a[172:175], v[180:183]
 ds_read_b64_tr_b16 a[148:149], v3 offset:57344
 ds_read_b64_tr_b16 a[150:151], v3 offset:58368
M v[176:179], a[68:71], a[172:175], v[176:179]
 buffer_load_dwordx4 v9, s[16:19], s21 offen offset:1024  nt lds
M v[176:179], a[64:67], a[168:171], v[176:179]
M v[172:175], a[56:59], a[168:171], v[172:175]
M v[172:175], a[60:63], a[172:175], v[172:175]
M v[168:171], a[52:55], a[172:175], v[168:171]
M v[168:171], a[48:51], a[168:171], v[168:171]
M v[164:167], a[40:43], a[168:171], v[164:167]
 ds_read_b64_tr_b16 a[152:153], v4 offset:49152
 ds_read_b64_tr_b16 a[154:155], v4 offset:50176
M v[164:167], a[44:47], a[172:175], v[164:167]
 s_waitcnt lgkmcnt(4)
M v[160:163], a[36:39], a[172:175], v[160:163]
 buffer_load_dwordx4 v10, s[16:19], s21 offen offset:2048  nt lds
M v[160:163], a[32:35], a[168:171], v[160:163]
M v[192:195], a[32:35], a[160:163], v[192:195]
 ds_read_b128 a[168:171], v5 offset:22528
 ds_read_b128 a[172:175], v6 offset:22528
M v[192:195], a[36:39], a[164:167], v[192:195]
M v[196:199], a[44:47], a[164:167], v[196:199]
M v[196:199], a[40:43], a[160:163], v[196:199]
 ds_read_b64_tr_b16 a[156:157], v4 offset:57344
 ds_read_b64_tr_b16 a[158:159], v4 offset:58368
M v[200:203], a[48:51], a[160:163], v[200:203]
 buffer_load_dwordx4 v11, s[16:19], s21 offen offset:3072  nt lds
M v[200:203], a[52:55], a[164:167], v[200:203]
 s_add_u32 s21, s21, 128
M v[204:207], a[60:63], a[164:167], v[204:207]
M v[204:207], a[56:59], a[160:163], v[204:207]
M v[208:211], a[64:67], a[160:163], v[208:211]
M v[208:211], a[68:71], a[164:167], v[208:211]
M v[212:215], a[76:79], a[164:167], v[212:215]
M v[212:215], a[72:75], a[160:163], v[212:215]
M v[216:219], a[80:83], a[160:163], v[216:219]
M v[216:219], a[84:87], a[164:167], v[216:219]
 s_waitcnt lgkmcnt(2)
M v[220:223], a[92:95], a[164:167], v[220:223]
 s_waitcnt vmcnt(16) lgkmcnt(0)
M v[220:223], a[88:91], a[160:163], v[220:223]
 s_barrier
M v[252:255], a[88:91], a[168:171], v[252:255]
 ds_read_b128 a[160:163], v5 offset:32768
 ds_read_b128 a[164:167], v6 offset:32768
M v[252:255], a[92:95], a[172:175], v[252:255]
 v_cmp_ne_u32 vcc, 1, v17
M v[248:251], a[84:87], a[172:175], v[248:251]
 s_nop 0
M v[248:251], a[80:83], a[168:171], v[248:251]
 s_cbranch_vccnz L_zs1
L_zr1:
M v[244:247], a[72:75], a[168:171], v[244:247]
 buffer_load_dword a240, v24, s[32:35], 0 offen offset:1024
M v[244:247], a[76:79], a[172:175], v[244:247]
M v[240:243], a[68:71], a[172:175], v[240:243]
M v[240:243], a[64:67], a[168:171], v[240:243]
M v[236:239], a[56:59], a[168:171], v[236:239]
M v[236:239], a[60:63], a[172:175], v[236:239]
M v[232:235], a[52:55], a[172:175], v[232:235]
M v[232:235], a[48:51], a[168:171], v[232:235]
M v[228:231], a[40:43], a[168:171], v[228:231]
M v[228:231], a[44:47], a[172:175], v[228:231]
 s_waitcnt lgkmcnt(0)
M v[224:227], a[36:39], a[172:175], v[224:227]
M v[224:227], a[32:35], a[168:171], v[224:227]
M a[0:3], a[96:99], a[160:163], a[0:3]
 ds_read_b128 a[168:171], v5 offset:34816
 ds_read_b128 a[172:175], v6 offset:34816
M a[0:3], a[100:103], a[164:167], a[0:3]
 ds_read_b64_tr_b16 a[32:33], v1 offset:0
 ds_read_b64_tr_b16 a[34:35], v1 offset:1024
M a[4:7], a[108:111], a[164:167], a[4:7]
 s_add_u32 m0, s24, 16384
M a[4:7], a[104:107], a[160:163], a[4:7]
 buffer_load_dwordx4 v12, s[48:51], s22 offen offset:0   lds
M a[8:11], a[112:115], a[160:163], a[8:11]
M a[8:11], a[116:119], a[164:167], a[8:11]
M a[12:15], a[124:127], a[164:167], a[12:15]
 ds_read_b64_tr_b16 a[36:37], v1 offset:8192
 ds_read_b64_tr_b16 a[38:39], v1 offset:9216
M a[12:15], a[120:123], a[160:163], a[12:15]
M a[16:19], a[128:131], a[160:163], a[16:19]
 buffer_load_dwordx4 v13, s[48:51], s22 offen offset:1024   lds
M a[16:19], a[132:135], a[164:167], a[16:19]
M a[20:23], a[140:143], a[164:167], a[20:23]
M a[20:23], a[136:139], a[160:163], a[20:23]
 ds_read_b64_tr_b16 a[40:41], v2 offset:0
 ds_read_b64_tr_b16 a[42:43], v2 offset:1024
M a[24:27], a[144:147], a[160:163], a[24:27]
M a[24:27], a[148:151], a[164:167], a[24:27]
 s_waitcnt lgkmcnt(6)
M a[28:31], a[156:159], a[164:167], a[28:31]
 buffer_load_dwordx4 v14, s[48:51], s22 offen offset:2048   lds
M a[28:31], a[152:155], a[160:163], a[28:31]
M v[60:63], a[152:155], a[168:171], v[60:63]
 ds_read_b128 a[160:163], v5 offset:36864
 ds_read_b128 a[164:167], v6 offset:36864
M v[60:63], a[156:159], a[172:175], v[60:63]
 ds_read_b64_tr_b16 a[44:45], v2 offset:8192
 ds_read_b64_tr_b16 a[46:47], v2 offset:9216
M v[56:59], a[148:151], a[172:175], v[56:59]
 buffer_load_dwordx4 v15, s[48:51], s22 offen offset:3072   lds
M v[56:59], a[144:147], a[168:171], v[56:59]
 s_sub_u32 s22, s22, 2097024
M v[52:55], a[136:139], a[168:171], v[52:55]
M v[52:55], a[140:143], a[172:175], v[52:55]
 ds_read_b64_tr_b16 a[48:49], v3 offset:0
 ds_read_b64_tr_b16 a[50:51], v3 offset:1024
M v[48:51], a[132:135], a[172:175], v[48:51]
 s_add_u32 m0, s23, 49152
M v[48:51], a[128:131], a[168:171], v[48:51]
 buffer_load_dwordx4 v8, s[16:19], s21 offen offset:0  nt lds
M v[44:47], a[120:123], a[168:171], v[44:47]
M v[44:47], a[124:127], a[172:175], v[44:47]
M v[40:43], a[116:119], a[172:175], v[40:43]
 ds_read_b64_tr_b16 a[52:53], v3 offset:8192
 ds_read_b64_tr_b16 a[54:55], v3 offset:9216
M v[40:43], a[112:115], a[168:171], v[40:43]
M v[36:39], a[104:107], a[168:171], v[36:39]
 buffer_load_dwordx4 v9, s[16:19], s21 offen offset:1024  nt lds
M v[36:39], a[108:111], a[172:175], v[36:39]
 s_waitcnt lgkmcnt(6)
M v[32:35], a[100:103], a[172:175], v[32:35]
M v[32:35], a[96:99], a[168:171], v[32:35]
 ds_read_b64_tr_b16 a[56:57], v4 offset:0
 ds_read_b64_tr_b16 a[58:59], v4 offset:1024
M v[64:67], a[96:99], a[160:163], v[64:67]
 ds_read_b128 a[168:171], v5 offset:38912
 ds_read_b128 a[172:175], v6 offset:38912
M v[64:67], a[100:103], a[164:167], v[64:67]
 buffer_load_dwordx4 v10, s[16:19], s21 offen offset:2048  nt lds
M v[68:71], a[108:111], a[164:167], v[68:71]
M v[68:71], a[104:107], a[160:163], v[68:71]
M v[72:75], a[112:115], a[160:163], v[72:75]
 ds_read_b64_tr_b16 a[60:61], v4 offset:8192
 ds_read_b64_tr_b16 a[62:63], v4 offset:9216
M v[72:75], a[116:119], a[164:167], v[72:75]
M v[76:79], a[124:127], a[164:167], v[76:79]
 buffer_load_dwordx4 v11, s[16:19], s21 offen offset:3072  nt lds
M v[76:79], a[120:123], a[160:163], v[76:79]
 s_add_u32 s21, s21, 524160
M v[80:83], a[128:131], a[160:163], v[80:83]
M v[80:83], a[132:135], a[164:167], v[80:83]
M v[84:87], a[140:143], a[164:167], v[84:87]
M v[84:87], a[136:139], a[160:163], v[84:87]
 s_and_b32 s64, s42, 7
M v[88:91], a[144:147], a[160:163], v[88:91]
 s_lshl_b32 s72, s41, 3
 s_add_u32 s64, s64, s72
 s_lshl_b32 s64, s64, 2
M v[88:91], a[148:151], a[164:167], v[88:91]
 s_waitcnt lgkmcnt(2)
 s_add_u32 s64, s64, s20
 s_mul_i32 s67, s64, 7168
M v[92:95], a[156:159], a[164:167], v[92:95]
 s_waitcnt vmcnt(17) lgkmcnt(0)
 s_mul_i32 s86, s20, 7168
 s_add_u32 s86, s86, 131072
M v[92:95], a[152:155], a[160:163], v[92:95]
 s_barrier
M v[124:127], a[152:155], a[168:171], v[124:127]
 ds_read_b128 a[160:163], v5 offset:49152
 ds_read_b128 a[164:167], v6 offset:49152
M v[124:127], a[156:159], a[172:175], v[124:127]
M v[120:123], a[148:151], a[172:175], v[120:123]
 s_add_u32 m0, s24, 32768
 ds_read_b64_tr_b16 a[64:65], v1 offset:16384
 ds_read_b64_tr_b16 a[66:67], v1 offset:17408
M v[120:123], a[144:147], a[168:171], v[120:123]
 buffer_load_dwordx4 v12, s[48:51], s22 offen offset:0   lds
M v[116:119], a[136:139], a[168:171], v[116:119]
M v[116:119], a[140:143], a[172:175], v[116:119]
M v[112:115], a[132:135], a[172:175], v[112:115]
M v[112:115], a[128:131], a[168:171], v[112:115]
 buffer_load_dwordx4 v13, s[48:51], s22 offen offset:1024   lds
M v[108:111], a[120:123], a[168:171], v[108:111]
M v[108:111], a[124:127], a[172:175], v[108:111]
 ds_read_b64_tr_b16 a[68:69], v1 offset:24576
 ds_read_b64_tr_b16 a[70:71], v1 offset:25600
M v[104:107], a[116:119], a[172:175], v[104:107]
M v[104:107], a[112:115], a[168:171], v[104:107]
M v[100:103], a[104:107], a[168:171], v[100:103]
 buffer_load_dwordx4 v14, s[48:51], s22 offen offset:2048   lds
M v[100:103], a[108:111], a[172:175], v[100:103]
 s_waitcnt lgkmcnt(4)
M v[96:99], a[100:103], a[172:175], v[96:99]
M v[96:99], a[96:99], a[168:171], v[96:99]
M v[128:131], a[96:99], a[160:163], v[128:131]
 ds_read_b128 a[168:171], v5 offset:51200
 ds_read_b128 a[172:175], v6 offset:51200
M v[128:131], a[100:103], a[164:167], v[128:131]
 ds_read_b64_tr_b16 a[72:73], v2 offset:16384
 ds_read_b64_tr_b16 a[74:75], v2 offset:17408
M v[132:135], a[108:111], a[164:167], v[132:135]
 buffer_load_dwordx4 v15, s[48:51], s22 offen offset:3072   lds
M v[132:135], a[104:107], a[160:163], v[132:135]
 s_add_u32 s22, s22, 2097152
M v[136:139], a[112:115], a[160:163], v[136:139]
M v[136:139], a[116:119], a[164:167], v[136:139]
 s_add_u32 m0, s23, 0
M v[140:143], a[124:127], a[164:167], v[140:143]
 buffer_load_dwordx4 v8, s[16:19], s21 offen offset:0  nt lds
M v[140:143], a[120:123], a[160:163], v[140:143]
 ds_read_b64_tr_b16 a[76:77], v2 offset:24576
 ds_read_b64_tr_b16 a[78:79], v2 offset:25600
M v[144:147], a[128:131], a[160:163], v[144:147]
M v[144:147], a[132:135], a[164:167], v[144:147]
M v[148:151], a[140:143], a[164:167], v[148:151]
 buffer_load_dwordx4 v9, s[16:19], s21 offen offset:1024  nt lds
M v[148:151], a[136:139], a[160:163], v[148:151]
M v[152:155], a[144:147], a[160:163], v[152:155]
M v[152:155], a[148:151], a[164:167], v[152:155]
 s_waitcnt lgkmcnt(4)
M v[156:159], a[156:159], a[164:167], v[156:159]
 ds_read_b64_tr_b16 a[80:81], v3 offset:16384
 ds_read_b64_tr_b16 a[82:83], v3 offset:17408
M v[156:159], a[152:155], a[160:163], v[156:159]
 buffer_load_dwordx4 v10, s[16:19], s21 offen offset:2048  nt lds
M v[188:191], a[152:155], a[168:171], v[188:191]
 ds_read_b128 a[160:163], v5 offset:53248
 ds_read_b128 a[164:167], v6 offset:53248
M v[188:191], a[156:159], a[172:175], v[188:191]
M v[184:187], a[148:151], a[172:175], v[184:187]
M v[184:187], a[144:147], a[168:171], v[184:187]
M v[180:183], a[136:139], a[168:171], v[180:183]
 buffer_load_dwordx4 v11, s[16:19], s21 offen offset:3072  nt lds
M v[180:183], a[140:143], a[172:175], v[180:183]
 s_add_u32 s21, s21, 128
 ds_read_b64_tr_b16 a[84:85], v3 offset:24576
 ds_read_b64_tr_b16 a[86:87], v3 offset:25600
M v[176:179], a[132:135], a[172:175], v[176:179]
M v[176:179], a[128:131], a[168:171], v[176:179]
M v[172:175], a[120:123], a[168:171], v[172:175]
 s_add_u32 m0, s86, 0
M v[172:175], a[124:127], a[172:175], v[172:175]
 buffer_load_dwordx4 v7, s[60:63], s67 offen offset:0 nt lds
M v[168:171], a[116:119], a[172:175], v[168:171]
M v[168:171], a[112:115], a[168:171], v[168:171]
M v[164:167], a[104:107], a[168:171], v[164:167]
 ds_read_b64_tr_b16 a[88:89], v4 offset:16384
 ds_read_b64_tr_b16 a[90:91], v4 offset:17408
M v[164:167], a[108:111], a[172:175], v[164:167]
 s_waitcnt lgkmcnt(4)
M v[160:163], a[100:103], a[172:175], v[160:163]
 buffer_load_dwordx4 v7, s[60:63], s67 offen offset:1024 nt lds
M v[160:163], a[96:99], a[168:171], v[160:163]
M v[192:195], a[96:99], a[160:163], v[192:195]
 ds_read_b128 a[168:171], v5 offset:55296
 ds_read_b128 a[172:175], v6 offset:55296
M v[192:195], a[100:103], a[164:167], v[192:195]
M v[196:199], a[108:111], a[164:167], v[196:199]
 buffer_load_dwordx4 v7, s[60:63], s67 offen offset:2048 nt lds
M v[196:199], a[104:107], a[160:163], v[196:199]
 ds_read_b64_tr_b16 a[92:93], v4 offset:24576
 ds_read_b64_tr_b16 a[94:95], v4 offset:25600
M v[200:203], a[112:115], a[160:163], v[200:203]
M v[200:203], a[116:119], a[164:167], v[200:203]
M v[204:207], a[124:127], a[164:167], v[204:207]
M v[204:207], a[120:123], a[160:163], v[204:207]
 buffer_load_dwordx4 v7, s[60:63], s67 offen offset:3072 nt lds
M v[208:211], a[128:131], a[160:163], v[208:211]
 s_add_u32 s67, s67, 4096
M v[208:211], a[132:135], a[164:167], v[208:211]
M v[212:215], a[140:143], a[164:167], v[212:215]
M v[212:215], a[136:139], a[160:163], v[212:215]
M v[216:219], a[144:147], a[160:163], v[216:219]
M v[216:219], a[148:151], a[164:167], v[216:219]
 s_waitcnt lgkmcnt(2)
M v[220:223], a[156:159], a[164:167], v[220:223]
 s_waitcnt vmcnt(21) lgkmcnt(0)
M v[220:223], a[152:155], a[160:163], v[220:223]
 s_barrier
M v[252:255], a[152:155], a[168:171], v[252:255]
 ds_read_b128 a[160:163], v5 offset:0
 ds_read_b128 a[164:167], v6 offset:0
M v[252:255], a[156:159], a[172:175], v[252:255]
M v[248:251], a[148:151], a[172:175], v[248:251]
M v[248:251], a[144:147], a[168:171], v[248:251]
M v[244:247], a[136:139], a[168:171], v[244:247]
M v[244:247], a[140:143], a[172:175], v[244:247]
M v[240:243], a[132:135], a[172:175], v[240:243]
M v[240:243], a[128:131], a[168:171], v[240:243]
M v[236:239], a[120:123], a[168:171], v[236:239]
M v[236:239], a[124:127], a[172:175], v[236:239]
M v[232:235], a[116:119], a[172:175], v[232:235]
M v[232:235], a[112:115], a[168:171], v[232:235]
M v[228:231], a[104:107], a[168:171], v[228:231]
M v[228:231], a[108:111], a[172:175], v[228:231]
 s_waitcnt lgkmcnt(0)
M v[224:227], a[100:103], a[172:175], v[224:227]
M v[224:227], a[96:99], a[168:171], v[224:227]
M a[0:3], a[32:35], a[160:163], a[0:3]
 ds_read_b128 a[168:171], v5 offset:2048
 ds_read_b128 a[172:175], v6 offset:2048
M a[0:3], a[36:39], a[164:167], a[0:3]
 ds_read_b64_tr_b16 a[96:97], v1 offset:32768
 ds_read_b64_tr_b16 a[98:99], v1 offset:33792
M a[4:7], a[44:47], a[164:167], a[4:7]
 s_add_u32 m0, s24, 49152
M a[4:7], a[40:43], a[160:163], a[4:7]
 buffer_load_dwordx4 v12, s[48:51], s22 offen offset:0   lds
M a[8:11], a[48:51], a[160:163], a[8:11]
M a[8:11], a[52:55], a[164:167], a[8:11]
M a[12:15], a[60:63], a[164:167], a[12:15]
 ds_read_b64_tr_b16 a[100:101], v1 offset:40960
 ds_read_b64_tr_b16 a[102:103], v1 offset:41984
M a[12:15], a[56:59], a[160:163], a[12:15]
M a[16:19], a[64:67], a[160:163], a[16:19]
 buffer_load_dwordx4 v13, s[48:51], s22 offen offset:1024   lds
M a[16:19], a[68:71], a[164:167], a[16:19]
M a[20:23], a[76:79], a[164:167], a[20:23]
M a[20:23], a[72:75], a[160:163], a[20:23]
 ds_read_b64_tr_b16 a[104:105], v2 offset:32768
 ds_read_b64_tr_b16 a[106:107], v2 offset:33792
M a[24:27], a[80:83], a[160:163], a[24:27]
M a[24:27], a[84:87], a[164:167], a[24:27]
 s_waitcnt lgkmcnt(6)
M a[28:31], a[92:95], a[164:167], a[28:31]
 buffer_load_dwordx4 v14, s[48:51], s22 offen offset:2048   lds
M a[28:31], a[88:91], a[160:163], a[28:31]
M v[60:63], a[88:91], a[168:171], v[60:63]
 ds_read_b128 a[160:163], v5 offset:4096
 ds_read_b128 a[164:167], v6 offset:4096
M v[60:63], a[92:95], a[172:175], v[60:63]
 ds_read_b64_tr_b16 a[108:109], v2 offset:40960
 ds_read_b64_tr_b16 a[110:111], v2 offset:41984
M v[56:59], a[84:87], a[172:175], v[56:59]
 buffer_load_dwordx4 v15, s[48:51], s22 offen offset:3072   lds
M v[56:59], a[80:83], a[168:171], v[56:59]
 s_sub_u32 s22, s22, 2097024
M v[52:55], a[72:75], a[168:171], v[52:55]
M v[52:55], a[76:79], a[172:175], v[52:55]
 ds_read_b64_tr_b16 a[112:113], v3 offset:32768
 ds_read_b64_tr_b16 a[114:115], v3 offset:33792
M v[48:51], a[68:71], a[172:175], v[48:51]
 s_add_u32 m0, s23, 16384
M v[48:51], a[64:67], a[168:171], v[48:51]
 buffer_load_dwordx4 v8, s[16:19], s21 offen offset:0  nt lds
M v[44:47], a[56:59], a[168:171], v[44:47]
M v[44:47], a[60:63], a[172:175], v[44:47]
M v[40:43], a[52:55], a[172:175], v[40:43]
 ds_read_b64_tr_b16 a[116:117], v3 offset:40960
 ds_read_b64_tr_b16 a[118:119], v3 offset:41984
M v[40:43], a[48:51], a[168:171], v[40:43]
M v[36:39], a[40:43], a[168:171], v[36:39]
 buffer_load_dwordx4 v9, s[16:19], s21 offen offset:1024  nt lds
M v[36:39], a[44:47], a[172:175], v[36:39]
 s_waitcnt lgkmcnt(6)
M v[32:35], a[36:39], a[172:175], v[32:35]
M v[32:35], a[32:35], a[168:171], v[32:35]
 ds_read_b64_tr_b16 a[120:121], v4 offset:32768
 ds_read_b64_tr_b16 a[122:123], v4 offset:33792
M v[64:67], a[32:35], a[160:163], v[64:67]
 ds_read_b128 a[168:171], v5 offset:6144
 ds_read_b128 a[172:175], v6 offset:6144
M v[64:67], a[36:39], a[164:167], v[64:67]
 buffer_load_dwordx4 v10, s[16:19], s21 offen offset:2048  nt lds
M v[68:71], a[44:47], a[164:167], v[68:71]
M v[68:71], a[40:43], a[160:163], v[68:71]
M v[72:75], a[48:51], a[160:163], v[72:75]
 ds_read_b64_tr_b16 a[124:125], v4 offset:40960
 ds_read_b64_tr_b16 a[126:127], v4 offset:41984
M v[72:75], a[52:55], a[164:167], v[72:75]
M v[76:79], a[60:63], a[164:167], v[76:79]
 buffer_load_dwordx4 v11, s[16:19], s21 offen offset:3072  nt lds
M v[76:79], a[56:59], a[160:163], v[76:79]
 s_add_u32 s21, s21, 524160
M v[80:83], a[64:67], a[160:163], v[80:83]
M v[80:83], a[68:71], a[164:167], v[80:83]
M v[84:87], a[76:79], a[164:167], v[84:87]
M v[84:87], a[72:75], a[160:163], v[84:87]
M v[88:91], a[80:83], a[160:163], v[88:91]
M v[88:91], a[84:87], a[164:167], v[88:91]
 s_waitcnt lgkmcnt(2)
M v[92:95], a[92:95], a[164:167], v[92:95]
 s_waitcnt vmcnt(20) lgkmcnt(0)
M v[92:95], a[88:91], a[160:163], v[92:95]
 s_barrier
M v[124:127], a[88:91], a[168:171], v[124:127]
 ds_read_b128 a[160:163], v5 offset:16384
 ds_read_b128 a[164:167], v6 offset:16384
M v[124:127], a[92:95], a[172:175], v[124:127]
M v[120:123], a[84:87], a[172:175], v[120:123]
 s_add_u32 m0, s24, 0
 ds_read_b64_tr_b16 a[128:129], v1 offset:49152
 ds_read_b64_tr_b16 a[130:131], v1 offset:50176
M v[120:123], a[80:83], a[168:171], v[120:123]
 buffer_load_dwordx4 v12, s[48:51], s22 offen offset:0   lds
M v[116:119], a[72:75], a[168:171], v[116:119]
M v[116:119], a[76:79], a[172:175], v[116:119]
M v[112:115], a[68:71], a[172:175], v[112:115]
M v[112:115], a[64:67], a[168:171], v[112:115]
M v[108:111], a[56:59], a[168:171], v[108:111]
 buffer_load_dwordx4 v13, s[48:51], s22 offen offset:1024   lds
M v[108:111], a[60:63], a[172:175], v[108:111]
 ds_read_b64_tr_b16 a[132:133], v1 offset:57344
 ds_read_b64_tr_b16 a[134:135], v1 offset:58368
M v[104:107], a[52:55], a[172:175], v[104:107]
M v[104:107], a[48:51], a[168:171], v[104:107]
M v[100:103], a[40:43], a[168:171], v[100:103]
M v[100:103], a[44:47], a[172:175], v[100:103]
 s_waitcnt lgkmcnt(4)
M v[96:99], a[36:39], a[172:175], v[96:99]
 buffer_load_dwordx4 v14, s[48:51], s22 offen offset:2048   lds
M v[96:99], a[32:35], a[168:171], v[96:99]
M v[128:131], a[32:35], a[160:163], v[128:131]
 ds_read_b128 a[168:171], v5 offset:18432
 ds_read_b128 a[172:175], v6 offset:18432
M v[128:131], a[36:39], a[164:167], v[128:131]
 ds_read_b64_tr_b16 a[136:137], v2 offset:49152
 ds_read_b64_tr_b16 a[138:139], v2 offset:50176
M v[132:135], a[44:47], a[164:167], v[132:135]
 buffer_load_dwordx4 v15, s[48:51], s22 offen offset:3072   lds
M v[132:135], a[40:43], a[160:163], v[132:135]
 s_add_u32 s22, s22, 2097152
M v[136:139], a[48:51], a[160:163], v[136:139]
M v[136:139], a[52:55], a[164:167], v[136:139]
M v[140:143], a[60:63], a[164:167], v[140:143]
 s_add_u32 m0, s23, 32768
M v[140:143], a[56:59], a[160:163], v[140:143]
 ds_read_b64_tr_b16 a[140:141], v2 offset:57344
 ds_read_b64_tr_b16 a[142:143], v2 offset:58368
M v[144:147], a[64:67], a[160:163], v[144:147]
 buffer_load_dwordx4 v8, s[16:19], s21 offen offset:0  nt lds
M v[144:147], a[68:71], a[164:167], v[144:147]
M v[148:151], a[76:79], a[164:167], v[148:151]
M v[148:151], a[72:75], a[160:163], v[148:151]
M v[152:155], a[80:83], a[160:163], v[152:155]
 buffer_load_dwordx4 v9, s[16:19], s21 offen offset:1024  nt lds
M v[152:155], a[84:87], a[164:167], v[152:155]
 s_waitcnt lgkmcnt(4)
M v[156:159], a[92:95], a[164:167], v[156:159]
 ds_read_b64_tr_b16 a[144:145], v3 offset:49152
 ds_read_b64_tr_b16 a[146:147], v3 offset:50176
M v[156:159], a[88:91], a[160:163], v[156:159]
M v[188:191], a[88:91], a[168:171], v[188:191]
 ds_read_b128 a[160:163], v5 offset:20480
 ds_read_b128 a[164:167], v6 offset:20480
M v[188:191], a[92:95], a[172:175], v[188:191]
M v[184:187], a[84:87], a[172:175], v[184:187]
 buffer_load_dwordx4 v10, s[16:19], s21 offen offset:2048  nt lds
M v[184:187], a[80:83], a[168:171], v[184:187]
M v[180:183], a[72:75], a[168:171], v[180:183]
M v[180:183], a[76:79], a[172:175], v[180:183]
 ds_read_b64_tr_b16 a[148:149], v3 offset:57344
 ds_read_b64_tr_b16 a[150:151], v3 offset:58368
M v[176:179], a[68:71], a[172:175], v[176:179]
M v[176:179], a[64:67], a[168:171], v[176:179]
 buffer_load_dwordx4 v11, s[16:19], s21 offen offset:3072  nt lds
M v[172:175], a[56:59], a[168:171], v[172:175]
 s_add_u32 s21, s21, 128
M v[172:175], a[60:63], a[172:175], v[172:175]
M v[168:171], a[52:55], a[172:175], v[168:171]
M v[168:171], a[48:51], a[168:171], v[168:171]
 s_add_u32 m0, s86, 4096
M v[164:167], a[40:43], a[168:171], v[164:167]
 ds_read_b64_tr_b16 a[152:153], v4 offset:49152
 ds_read_b64_tr_b16 a[154:155], v4 offset:50176
M v[164:167], a[44:47], a[172:175], v[164:167]
 s_waitcnt lgkmcnt(4)
M v[160:163], a[36:39], a[172:175], v[160:163]
 buffer_load_dwordx4 v7, s[60:63], s67 offen offset:0 nt lds
M v[160:163], a[32:35], a[168:171], v[160:163]
M v[192:195], a[32:35], a[160:163], v[192:195]
 ds_read_b128 a[168:171], v5 offset:22528
 ds_read_b128 a[172:175], v6 offset:22528
M v[192:195], a[36:39], a[164:167], v[192:195]
 buffer_load_dwordx4 v7, s[60:63], s67 offen offset:1024 nt lds
M v[196:199], a[44:47], a[164:167], v[196:199]
M v[196:199], a[40:43], a[160:163], v[196:199]
 ds_read_b64_tr_b16 a[156:157], v4 offset:57344
 ds_read_b64_tr_b16 a[158:159], v4 offset:58368
M v[200:203], a[48:51], a[160:163], v[200:203]
M v[200:203], a[52:55], a[164:167], v[200:203]
M v[204:207], a[60:63], a[164:167], v[204:207]
 buffer_load_dwordx4 v7, s[60:63], s67 offen offset:2048 nt lds
M v[204:207], a[56:59], a[160:163], v[204:207]
 s_add_u32 s67, s67, 4096
M v[208:211], a[64:67], a[160:163], v[208:211]
M v[208:211], a[68:71], a[164:167], v[208:211]
M v[212:215], a[76:79], a[164:167], v[212:215]
M v[212:215], a[72:75], a[160:163], v[212:215]
M v[216:219], a[80:83], a[160:163], v[216:219]
M v[216:219], a[84:87], a[164:167], v[216:219]
 s_waitcnt lgkmcnt(2)
M v[220:223], a[92:95], a[164:167], v[220:223]
 s_waitcnt vmcnt(23) lgkmcnt(0)
M v[220:223], a[88:91], a[160:163], v[220:223]
 s_barrier
M v[252:255], a[88:91], a[168:171], v[252:255]
 ds_read_b128 a[160:163], v5 offset:32768
 ds_read_b128 a[164:167], v6 offset:32768
M v[252:255], a[92:95], a[172:175], v[252:255]
 v_and_b32 v26, 48, v0
 v_lshlrev_b32 v26, 17, v26
M v[248:251], a[84:87], a[172:175], v[248:251]
 v_or_b32 v26, v26, v0
 v_lshl_add_u32 v26, v26, 7, s95
M v[248:251], a[80:83], a[168:171], v[248:251]
 buffer_load_dword a240, v26, s[76:79], 0 offen offset:0
M v[244:247], a[72:75], a[168:171], v[244:247]
M v[244:247], a[76:79], a[172:175], v[244:247]
M v[240:243], a[68:71], a[172:175], v[240:243]
M v[240:243], a[64:67], a[168:171], v[240:243]
M v[236:239], a[56:59], a[168:171], v[236:239]
M v[236:239], a[60:63], a[172:175], v[236:239]
M v[232:235], a[52:55], a[172:175], v[232:235]
M v[232:235], a[48:51], a[168:171], v[232:235]
M v[228:231], a[40:43], a[168:171], v[228:231]
M v[228:231], a[44:47], a[172:175], v[228:231]
 s_waitcnt lgkmcnt(0)
M v[224:227], a[36:39], a[172:175], v[224:227]
M v[224:227], a[32:35], a[168:171], v[224:227]
M a[0:3], a[96:99], a[160:163], a[0:3]
 ds_read_b128 a[168:171], v5 offset:34816
 ds_read_b128 a[172:175], v6 offset:34816
M a[0:3], a[100:103], a[164:167], a[0:3]
 ds_read_b64_tr_b16 a[32:33], v1 offset:0
 ds_read_b64_tr_b16 a[34:35], v1 offset:1024
M a[4:7], a[108:111], a[164:167], a[4:7]
 s_add_u32 m0, s24, 16384
M a[4:7], a[104:107], a[160:163], a[4:7]
 buffer_load_dwordx4 v12, s[48:51], s22 offen offset:0   lds
M a[8:11], a[112:115], a[160:163], a[8:11]
M a[8:11], a[116:119], a[164:167], a[8:11]
M a[12:15], a[124:127], a[164:167], a[12:15]
 ds_read_b64_tr_b16 a[36:37], v1 offset:8192
 ds_read_b64_tr_b16 a[38:39], v1 offset:9216
M a[12:15], a[120:123], a[160:163], a[12:15]
M a[16:19], a[128:131], a[160:163], a[16:19]
 buffer_load_dwordx4 v13, s[48:51], s22 offen offset:1024   lds
M a[16:19], a[132:135], a[164:167], a[16:19]
M a[20:23], a[140:143], a[164:167], a[20:23]
M a[20:23], a[136:139], a[160:163], a[20:23]
 ds_read_b64_tr_b16 a[40:41], v2 offset:0
 ds_read_b64_tr_b16 a[42:43], v2 offset:1024
M a[24:27], a[144:147], a[160:163], a[24:27]
M a[24:27], a[148:151], a[164:167], a[24:27]
 s_waitcnt lgkmcnt(6)
M a[28:31], a[156:159], a[164:167], a[28:31]
 buffer_load_dwordx4 v14, s[48:51], s22 offen offset:2048   lds
M a[28:31], a[152:155], a[160:163], a[28:31]
M v[60:63], a[152:155], a[168:171], v[60:63]
 ds_read_b128 a[160:163], v5 offset:36864
 ds_read_b128 a[164:167], v6 offset:36864
M v[60:63], a[156:159], a[172:175], v[60:63]
 ds_read_b64_tr_b16 a[44:45], v2 offset:8192
 ds_read_b64_tr_b16 a[46:47], v2 offset:9216
M v[56:59], a[148:151], a[172:175], v[56:59]
 buffer_load_dwordx4 v15, s[48:51], s22 offen offset:3072   lds
M v[56:59], a[144:147], a[168:171], v[56:59]
 s_sub_u32 s22, s22, 2097024
M v[52:55], a[136:139], a[168:171], v[52:55]
M v[52:55], a[140:143], a[172:175], v[52:55]
 ds_read_b64_tr_b16 a[48:49], v3 offset:0
 ds_read_b64_tr_b16 a[50:51], v3 offset:1024
M v[48:51], a[132:135], a[172:175], v[48:51]
 s_add_u32 m0, s23, 49152
M v[48:51], a[128:131], a[168:171], v[48:51]
 buffer_load_dwordx4 v8, s[16:19], s21 offen offset:0  nt lds
M v[44:47], a[120:123], a[168:171], v[44:47]
M v[44:47], a[124:127], a[172:175], v[44:47]
M v[40:43], a[116:119], a[172:175], v[40:43]
 ds_read_b64_tr_b16 a[52:53], v3 offset:8192
 ds_read_b64_tr_b16 a[54:55], v3 offset:9216
M v[40:43], a[112:115], a[168:171], v[40:43]
M v[36:39], a[104:107], a[168:171], v[36:39]
 buffer_load_dwordx4 v9, s[16:19], s21 offen offset:1024  nt lds
M v[36:39], a[108:111], a[172:175], v[36:39]
 s_waitcnt lgkmcnt(6)
M v[32:35], a[100:103], a[172:175], v[32:35]
M v[32:35], a[96:99], a[168:171], v[32:35]
 ds_read_b64_tr_b16 a[56:57], v4 offset:0
 ds_read_b64_tr_b16 a[58:59], v4 offset:1024
M v[64:67], a[96:99], a[160:163], v[64:67]
 ds_read_b128 a[168:171], v5 offset:38912
 ds_read_b128 a[172:175], v6 offset:38912
M v[64:67], a[100:103], a[164:167], v[64:67]
 buffer_load_dwordx4 v10, s[16:19], s21 offen offset:2048  nt lds
M v[68:71], a[108:111], a[164:167], v[68:71]
M v[68:71], a[104:107], a[160:163], v[68:71]
M v[72:75], a[112:115], a[160:163], v[72:75]
 ds_read_b64_tr_b16 a[60:61], v4 offset:8192
 ds_read_b64_tr_b16 a[62:63], v4 offset:9216
M v[72:75], a[116:119], a[164:167], v[72:75]
M v[76:79], a[124:127], a[164:167], v[76:79]
 buffer_load_dwordx4 v11, s[16:19], s21 offen offset:3072  nt lds
M v[76:79], a[120:123], a[160:163], v[76:79]
 s_add_u32 s21, s21, 524160
M v[80:83], a[128:131], a[160:163], v[80:83]
M v[80:83], a[132:135], a[164:167], v[80:83]
M v[84:87], a[140:143], a[164:167], v[84:87]
M v[84:87], a[136:139], a[160:163], v[84:87]
M v[88:91], a[144:147], a[160:163], v[88:91]
M v[88:91], a[148:151], a[164:167], v[88:91]
 s_waitcnt lgkmcnt(2)
M v[92:95], a[156:159], a[164:167], v[92:95]
 s_waitcnt vmcnt(20) lgkmcnt(0)
M v[92:95], a[152:155], a[160:163], v[92:95]
 s_barrier
M v[124:127], a[152:155], a[168:171], v[124:127]
 ds_read_b128 a[160:163], v5 offset:49152
 ds_read_b128 a[164:167], v6 offset:49152
M v[124:127], a[156:159], a[172:175], v[124:127]
M v[120:123], a[148:151], a[172:175], v[120:123]
 s_add_u32 m0, s24, 32768
 ds_read_b64_tr_b16 a[64:65], v1 offset:16384
 ds_read_b64_tr_b16 a[66:67], v1 offset:17408
M v[120:123], a[144:147], a[168:171], v[120:123]
 buffer_load_dwordx4 v12, s[48:51], s22 offen offset:0   lds
M v[116:119], a[136:139], a[168:171], v[116:119]
M v[116:119], a[140:143], a[172:175], v[116:119]
M v[112:115], a[132:135], a[172:175], v[112:115]
M v[112:115], a[128:131], a[168:171], v[112:115]
M v[108:111], a[120:123], a[168:171], v[108:111]
M v[108:111], a[124:127], a[172:175], v[108:111]
 ds_read_b64_tr_b16 a[68:69], v1 offset:24576
 ds_read_b64_tr_b16 a[70:71], v1 offset:25600
M v[104:107], a[116:119], a[172:175], v[104:107]
 buffer_load_dwordx4 v13, s[48:51], s22 offen offset:1024   lds
M v[104:107], a[112:115], a[168:171], v[104:107]
M v[100:103], a[104:107], a[168:171], v[100:103]
M v[100:103], a[108:111], a[172:175], v[100:103]
 s_waitcnt lgkmcnt(4)
M v[96:99], a[100:103], a[172:175], v[96:99]
M v[96:99], a[96:99], a[168:171], v[96:99]
M v[128:131], a[96:99], a[160:163], v[128:131]
 ds_read_b128 a[168:171], v5 offset:51200
 ds_read_b128 a[172:175], v6 offset:51200
M v[128:131], a[100:103], a[164:167], v[128:131]
 ds_read_b64_tr_b16 a[72:73], v2 offset:16384
 ds_read_b64_tr_b16 a[74:75], v2 offset:17408
M v[132:135], a[108:111], a[164:167], v[132:135]
 buffer_load_dwordx4 v14, s[48:51], s22 offen offset:2048   lds
M v[132:135], a[104:107], a[160:163], v[132:135]
M v[136:139], a[112:115], a[160:163], v[136:139]
M v[136:139], a[116:119], a[164:167], v[136:139]
M v[140:143], a[124:127], a[164:167], v[140:143]
M v[140:143], a[120:123], a[160:163], v[140:143]
 ds_read_b64_tr_b16 a[76:77], v2 offset:24576
 ds_read_b64_tr_b16 a[78:79], v2 offset:25600
M v[144:147], a[128:131], a[160:163], v[144:147]
 buffer_load_dwordx4 v15, s[48:51], s22 offen offset:3072   lds
M v[144:147], a[132:135], a[164:167], v[144:147]
 s_add_u32 s22, s22, 2097152
M v[148:151], a[140:143], a[164:167], v[148:151]
M v[148:151], a[136:139], a[160:163], v[148:151]
M v[152:155], a[144:147], a[160:163], v[152:155]
M v[152:155], a[148:151], a[164:167], v[152:155]
 s_waitcnt lgkmcnt(4)
M v[156:159], a[156:159], a[164:167], v[156:159]
 s_add_u32 m0, s23, 0
 ds_read_b64_tr_b16 a[80:81], v3 offset:16384
 ds_read_b64_tr_b16 a[82:83], v3 offset:17408
M v[156:159], a[152:155], a[160:163], v[156:159]
 buffer_load_dwordx4 v8, s[16:19], s21 offen offset:0  nt lds
M v[188:191], a[152:155], a[168:171], v[188:191]
 ds_read_b128 a[160:163], v5 offset:53248
 ds_read_b128 a[164:167], v6 offset:53248
M v[188:191], a[156:159], a[172:175], v[188:191]
M v[184:187], a[148:151], a[172:175], v[184:187]
M v[184:187], a[144:147], a[168:171], v[184:187]
M v[180:183], a[136:139], a[168:171], v[180:183]
M v[180:183], a[140:143], a[172:175], v[180:183]
 ds_read_b64_tr_b16 a[84:85], v3 offset:24576
 ds_read_b64_tr_b16 a[86:87], v3 offset:25600
M v[176:179], a[132:135], a[172:175], v[176:179]
 buffer_load_dwordx4 v9, s[16:19], s21 offen offset:1024  nt lds
M v[176:179], a[128:131], a[168:171], v[176:179]
M v[172:175], a[120:123], a[168:171], v[172:175]
M v[172:175], a[124:127], a[172:175], v[172:175]
M v[168:171], a[116:119], a[172:175], v[168:171]
M v[168:171], a[112:115], a[168:171], v[168:171]
M v[164:167], a[104:107], a[168:171], v[164:167]
 ds_read_b64_tr_b16 a[88:89], v4 offset:16384
 ds_read_b64_tr_b16 a[90:91], v4 offset:17408
M v[164:167], a[108:111], a[172:175], v[164:167]
 s_waitcnt lgkmcnt(4)
M v[160:163], a[100:103], a[172:175], v[160:163]
 buffer_load_dwordx4 v10, s[16:19], s21 offen offset:2048  nt lds
M v[160:163], a[96:99], a[168:171], v[160:163]
M v[192:195], a[96:99], a[160:163], v[192:195]
 ds_read_b128 a[168:171], v5 offset:55296
 ds_read_b128 a[172:175], v6 offset:55296
M v[192:195], a[100:103], a[164:167], v[192:195]
M v[196:199], a[108:111], a[164:167], v[196:199]
M v[196:199], a[104:107], a[160:163], v[196:199]
 ds_read_b64_tr_b16 a[92:93], v4 offset:24576
 ds_read_b64_tr_b16 a[94:95], v4 offset:25600
M v[200:203], a[112:115], a[160:163], v[200:203]
 buffer_load_dwordx4 v11, s[16:19], s21 offen offset:3072  nt lds
M v[200:203], a[116:119], a[164:167], v[200:203]
 s_add_u32 s21, s21, 128
M v[204:207], a[124:127], a[164:167], v[204:207]
M v[204:207], a[120:123], a[160:163], v[204:207]
M v[208:211], a[128:131], a[160:163], v[208:211]
M v[208:211], a[132:135], a[164:167], v[208:211]
M v[212:215], a[140:143], a[164:167], v[212:215]
M v[212:215], a[136:139], a[160:163], v[212:215]
M v[216:219], a[144:147], a[160:163], v[216:219]
M v[216:219], a[148:151], a[164:167], v[216:219]
 s_waitcnt lgkmcnt(2)
M v[220:223], a[156:159], a[164:167], v[220:223]
 s_waitcnt vmcnt(17) lgkmcnt(0)
M v[220:223], a[152:155], a[160:163], v[220:223]
 s_barrier
M v[252:255], a[152:155], a[168:171], v[252:255]
 ds_read_b128 a[160:163], v5 offset:0
 ds_read_b128 a[164:167], v6 offset:0
M v[252:255], a[156:159], a[172:175], v[252:255]
M v[248:251], a[148:151], a[172:175], v[248:251]
M v[248:251], a[144:147], a[168:171], v[248:251]
M v[244:247], a[136:139], a[168:171], v[244:247]
M v[244:247], a[140:143], a[172:175], v[244:247]
M v[240:243], a[132:135], a[172:175], v[240:243]
M v[240:243], a[128:131], a[168:171], v[240:243]
M v[236:239], a[120:123], a[168:171], v[236:239]
M v[236:239], a[124:127], a[172:175], v[236:239]
M v[232:235], a[116:119], a[172:175], v[232:235]
M v[232:235], a[112:115], a[168:171], v[232:235]
M v[228:231], a[104:107], a[168:171], v[228:231]
M v[228:231], a[108:111], a[172:175], v[228:231]
 s_waitcnt lgkmcnt(0)
M v[224:227], a[100:103], a[172:175], v[224:227]
M v[224:227], a[96:99], a[168:171], v[224:227]
M a[0:3], a[32:35], a[160:163], a[0:3]
 ds_read_b128 a[168:171], v5 offset:2048
 ds_read_b128 a[172:175], v6 offset:2048
M a[0:3], a[36:39], a[164:167], a[0:3]
 ds_read_b64_tr_b16 a[96:97], v1 offset:32768
 ds_read_b64_tr_b16 a[98:99], v1 offset:33792
M a[4:7], a[44:47], a[164:167], a[4:7]
 s_add_u32 m0, s24, 49152
 v_lshrrev_b32 v28, 2, v0
M a[4:7], a[40:43], a[160:163], a[4:7]
 buffer_load_dwordx4 v12, s[48:51], s22 offen offset:0   lds
M a[8:11], a[48:51], a[160:163], a[8:11]
 v_mul_u32_u24 v28, 896, v28
M a[8:11], a[52:55], a[164:167], a[8:11]
M a[12:15], a[60:63], a[164:167], a[12:15]
 ds_read_b64_tr_b16 a[100:101], v1 offset:40960
 ds_read_b64_tr_b16 a[102:103], v1 offset:41984
M a[12:15], a[56:59], a[160:163], a[12:15]
 v_and_b32 v29, 3, v0
M a[16:19], a[64:67], a[160:163], a[16:19]
 buffer_load_dwordx4 v13, s[48:51], s22 offen offset:1024   lds
M a[16:19], a[68:71], a[164:167], a[16:19]
 v_lshl_add_u32 v28, v29, 4, v28
M a[20:23], a[76:79], a[164:167], a[20:23]
M a[20:23], a[72:75], a[160:163], a[20:23]
 s_lshr_b32 s64, s20, 1
 ds_read_b64_tr_b16 a[104:105], v2 offset:32768
 ds_read_b64_tr_b16 a[106:107], v2 offset:33792
M a[24:27], a[80:83], a[160:163], a[24:27]
 s_lshl_b32 s64, s64, 6
 s_and_b32 s72, s20, 1
 s_lshl_b32 s72, s72, 3
M a[24:27], a[84:87], a[164:167], a[24:27]
 s_waitcnt lgkmcnt(6)
 s_add_u32 s64, s64, s72
 s_add_u32 s64, s64, 131072
M a[28:31], a[92:95], a[164:167], a[28:31]
 buffer_load_dwordx4 v14, s[48:51], s22 offen offset:2048   lds
M a[28:31], a[88:91], a[160:163], a[28:31]
 v_add_u32 v28, s64, v28
M v[60:63], a[88:91], a[168:171], v[60:63]
 ds_read_b128 a[160:163], v5 offset:4096
 ds_read_b128 a[164:167], v6 offset:4096
M v[60:63], a[92:95], a[172:175], v[60:63]
 s_lshl_b32 s94, s41, 18
 ds_read_b64_tr_b16 a[108:109], v2 offset:40960
 ds_read_b64_tr_b16 a[110:111], v2 offset:41984
M v[56:59], a[84:87], a[172:175], v[56:59]
 buffer_load_dwordx4 v15, s[48:51], s22 offen offset:3072   lds
M v[56:59], a[80:83], a[168:171], v[56:59]
 s_sub_u32 s22, s22, 2097024
 s_and_b32 s64, s42, 7
M v[52:55], a[72:75], a[168:171], v[52:55]
 s_lshl_b32 s64, s64, 10
M v[52:55], a[76:79], a[172:175], v[52:55]
 s_add_u32 s94, s94, s64
 ds_read_b64_tr_b16 a[112:113], v3 offset:32768
 ds_read_b64_tr_b16 a[114:115], v3 offset:33792
M v[48:51], a[68:71], a[172:175], v[48:51]
 s_add_u32 m0, s23, 16384
 s_lshl_b32 s64, s20, 13
 s_add_u32 s94, s94, s64
M v[48:51], a[64:67], a[168:171], v[48:51]
 buffer_load_dwordx4 v8, s[16:19], s21 offen offset:0  nt lds
M v[44:47], a[56:59], a[168:171], v[44:47]
 s_add_u32 s94, s94, 100663296
 ds_read_b64_tr_b16 a[192:193], v28 offset:0
M v[44:47], a[60:63], a[172:175], v[44:47]
M v[40:43], a[52:55], a[172:175], v[40:43]
 ds_read_b64_tr_b16 a[116:117], v3 offset:40960
 ds_read_b64_tr_b16 a[118:119], v3 offset:41984
M v[40:43], a[48:51], a[168:171], v[40:43]
 ds_read_b64_tr_b16 a[194:195], v28 offset:14336
M v[36:39], a[40:43], a[168:171], v[36:39]
 buffer_load_dwordx4 v9, s[16:19], s21 offen offset:1024  nt lds
M v[36:39], a[44:47], a[172:175], v[36:39]
 s_waitcnt lgkmcnt(8)
 ds_read_b64_tr_b16 a[196:197], v28 offset:128
M v[32:35], a[36:39], a[172:175], v[32:35]
M v[32:35], a[32:35], a[168:171], v[32:35]
 ds_read_b64_tr_b16 a[120:121], v4 offset:32768
 ds_read_b64_tr_b16 a[122:123], v4 offset:33792
M v[64:67], a[32:35], a[160:163], v[64:67]
 ds_read_b128 a[168:171], v5 offset:6144
 ds_read_b128 a[172:175], v6 offset:6144
M v[64:67], a[36:39], a[164:167], v[64:67]
 buffer_load_dwordx4 v10, s[16:19], s21 offen offset:2048  nt lds
M v[68:71], a[44:47], a[164:167], v[68:71]
 ds_read_b64_tr_b16 a[198:199], v28 offset:14464
M v[68:71], a[40:43], a[160:163], v[68:71]
M v[72:75], a[48:51], a[160:163], v[72:75]
 ds_read_b64_tr_b16 a[124:125], v4 offset:40960
 ds_read_b64_tr_b16 a[126:127], v4 offset:41984
M v[72:75], a[52:55], a[164:167], v[72:75]
 ds_read_b64_tr_b16 a[200:201], v28 offset:256
M v[76:79], a[60:63], a[164:167], v[76:79]
 buffer_load_dwordx4 v11, s[16:19], s21 offen offset:3072  nt lds
M v[76:79], a[56:59], a[160:163], v[76:79]
 s_add_u32 s21, s21, 524160
 ds_read_b64_tr_b16 a[202:203], v28 offset:14592
M v[80:83], a[64:67], a[160:163], v[80:83]
M v[80:83], a[68:71], a[164:167], v[80:83]
 ds_read_b64_tr_b16 a[204:205], v28 offset:384
M v[84:87], a[76:79], a[164:167], v[84:87]
M v[84:87], a[72:75], a[160:163], v[84:87]
 ds_read_b64_tr_b16 a[206:207], v28 offset:14720
M v[88:91], a[80:83], a[160:163], v[88:91]
M v[88:91], a[84:87], a[164:167], v[88:91]
 s_waitcnt lgkmcnt(7)
 ds_read_b64_tr_b16 a[208:209], v28 offset:512
M v[92:95], a[92:95], a[164:167], v[92:95]
 s_waitcnt vmcnt(16) lgkmcnt(0)
M v[92:95], a[88:91], a[160:163], v[92:95]
 s_barrier
M v[124:127], a[88:91], a[168:171], v[124:127]
 ds_read_b128 a[160:163], v5 offset:16384
 ds_read_b128 a[164:167], v6 offset:16384
M v[124:127], a[92:95], a[172:175], v[124:127]
 ds_read_b64_tr_b16 a[210:211], v28 offset:14848
M v[120:123], a[84:87], a[172:175], v[120:123]
 s_add_u32 m0, s24, 0
 ds_read_b64_tr_b16 a[128:129], v1 offset:49152
 ds_read_b64_tr_b16 a[130:131], v1 offset:50176
M v[120:123], a[80:83], a[168:171], v[120:123]
 buffer_load_dwordx4 v12, s[48:51], s22 offen offset:0   lds
M v[116:119], a[72:75], a[168:171], v[116:119]
 ds_read_b64_tr_b16 a[212:213], v28 offset:640
M v[116:119], a[76:79], a[172:175], v[116:119]
M v[112:115], a[68:71], a[172:175], v[112:115]
 ds_read_b64_tr_b16 a[214:215], v28 offset:14976
M v[112:115], a[64:67], a[168:171], v[112:115]
M v[108:111], a[56:59], a[168:171], v[108:111]
 ds_read_b64_tr_b16 a[216:217], v28 offset:768
M v[108:111], a[60:63], a[172:175], v[108:111]
 ds_read_b64_tr_b16 a[132:133], v1 offset:57344
 ds_read_b64_tr_b16 a[134:135], v1 offset:58368
M v[104:107], a[52:55], a[172:175], v[104:107]
 buffer_load_dwordx4 v13, s[48:51], s22 offen offset:1024   lds
M v[104:107], a[48:51], a[168:171], v[104:107]
 ds_read_b64_tr_b16 a[218:219], v28 offset:15104
M v[100:103], a[40:43], a[168:171], v[100:103]
M v[100:103], a[44:47], a[172:175], v[100:103]
 s_waitcnt lgkmcnt(9)
M v[96:99], a[36:39], a[172:175], v[96:99]
M v[96:99], a[32:35], a[168:171], v[96:99]
M v[128:131], a[32:35], a[160:163], v[128:131]
 ds_read_b128 a[168:171], v5 offset:18432
 ds_read_b128 a[172:175], v6 offset:18432
M v[128:131], a[36:39], a[164:167], v[128:131]
 ds_read_b64_tr_b16 a[136:137], v2 offset:49152
 ds_read_b64_tr_b16 a[138:139], v2 offset:50176
M v[132:135], a[44:47], a[164:167], v[132:135]
 buffer_load_dwordx4 v14, s[48:51], s22 offen offset:2048   lds
M v[132:135], a[40:43], a[160:163], v[132:135]
M v[136:139], a[48:51], a[160:163], v[136:139]
M v[136:139], a[52:55], a[164:167], v[136:139]
M v[140:143], a[60:63], a[164:167], v[140:143]
M v[140:143], a[56:59], a[160:163], v[140:143]
 ds_read_b64_tr_b16 a[140:141], v2 offset:57344
 ds_read_b64_tr_b16 a[142:143], v2 offset:58368
M v[144:147], a[64:67], a[160:163], v[144:147]
 buffer_load_dwordx4 v15, s[48:51], s22 offen offset:3072   lds
M v[144:147], a[68:71], a[164:167], v[144:147]
 s_add_u32 s22, s22, 2097152
M v[148:151], a[76:79], a[164:167], v[148:151]
M v[148:151], a[72:75], a[160:163], v[148:151]
M v[152:155], a[80:83], a[160:163], v[152:155]
M v[152:155], a[84:87], a[164:167], v[152:155]
 s_waitcnt lgkmcnt(4)
M v[156:159], a[92:95], a[164:167], v[156:159]
 s_add_u32 m0, s23, 32768
 ds_read_b64_tr_b16 a[144:145], v3 offset:49152
 ds_read_b64_tr_b16 a[146:147], v3 offset:50176
M v[156:159], a[88:91], a[160:163], v[156:159]
 buffer_load_dwordx4 v8, s[16:19], s21 offen offset:0  nt lds
M v[188:191], a[88:91], a[168:171], v[188:191]
 ds_read_b128 a[160:163], v5 offset:20480
 ds_read_b128 a[164:167], v6 offset:20480
M v[188:191], a[92:95], a[172:175], v[188:191]
M v[184:187], a[84:87], a[172:175], v[184:187]
M v[184:187], a[80:83], a[168:171], v[184:187]
M v[180:183], a[72:75], a[168:171], v[180:183]
M v[180:183], a[76:79], a[172:175], v[180:183]
 ds_read_b64_tr_b16 a[148:149], v3 offset:57344
 ds_read_b64_tr_b16 a[150:151], v3 offset:58368
M v[176:179], a[68:71], a[172:175], v[176:179]
 buffer_load_dwordx4 v9, s[16:19], s21 offen offset:1024  nt lds
M v[176:179], a[64:67], a[168:171], v[176:179]
M v[172:175], a[56:59], a[168:171], v[172:175]
M v[172:175], a[60:63], a[172:175], v[172:175]
M v[168:171], a[52:55], a[172:175], v[168:171]
M v[168:171], a[48:51], a[168:171], v[168:171]
M v[164:167], a[40:43], a[168:171], v[164:167]
 ds_read_b64_tr_b16 a[152:153], v4 offset:49152
 ds_read_b64_tr_b16 a[154:155], v4 offset:50176
M v[164:167], a[44:47], a[172:175], v[164:167]
 s_waitcnt lgkmcnt(4)
M v[160:163], a[36:39], a[172:175], v[160:163]
 buffer_load_dwordx4 v10, s[16:19], s21 offen offset:2048  nt lds
M v[160:163], a[32:35], a[168:171], v[160:163]
M v[192:195], a[32:35], a[160:163], v[192:195]
 ds_read_b128 a[168:171], v5 offset:22528
 ds_read_b128 a[172:175], v6 offset:22528
M v[192:195], a[36:39], a[164:167], v[192:195]
M v[196:199], a[44:47], a[164:167], v[196:199]
M v[196:199], a[40:43], a[160:163], v[196:199]
 ds_read_b64_tr_b16 a[156:157], v4 offset:57344
 ds_read_b64_tr_b16 a[158:159], v4 offset:58368
M v[200:203], a[48:51], a[160:163], v[200:203]
 buffer_load_dwordx4 v11, s[16:19], s21 offen offset:3072  nt lds
M v[200:203], a[52:55], a[164:167], v[200:203]
 s_add_u32 s21, s21, 128
M v[204:207], a[60:63], a[164:167], v[204:207]
M v[204:207], a[56:59], a[160:163], v[204:207]
M v[208:211], a[64:67], a[160:163], v[208:211]
M v[208:211], a[68:71], a[164:167], v[208:211]
M v[212:215], a[76:79], a[164:167], v[212:215]
M v[212:215], a[72:75], a[160:163], v[212:215]
M v[216:219], a[80:83], a[160:163], v[216:219]
M v[216:219], a[84:87], a[164:167], v[216:219]
 s_waitcnt lgkmcnt(2)
M v[220:223], a[92:95], a[164:167], v[220:223]
 s_waitcnt vmcnt(16) lgkmcnt(0)
M v[220:223], a[88:91], a[160:163], v[220:223]
 s_barrier
M v[252:255], a[88:91], a[168:171], v[252:255]
 ds_read_b128 a[160:163], v5 offset:32768
 ds_read_b128 a[164:167], v6 offset:32768
M v[252:255], a[92:95], a[172:175], v[252:255]
 buffer_load_dword a240, v24, s[32:35], 0 offen offset:1536
M v[248:251], a[84:87], a[172:175], v[248:251]
M v[248:251], a[80:83], a[168:171], v[248:251]
M v[244:247], a[72:75], a[168:171], v[244:247]
M v[244:247], a[76:79], a[172:175], v[244:247]
M v[240:243], a[68:71], a[172:175], v[240:243]
M v[240:243], a[64:67], a[168:171], v[240:243]
M v[236:239], a[56:59], a[168:171], v[236:239]
M v[236:239], a[60:63], a[172:175], v[236:239]
M v[232:235], a[52:55], a[172:175], v[232:235]
M v[232:235], a[48:51], a[168:171], v[232:235]
M v[228:231], a[40:43], a[168:171], v[228:231]
M v[228:231], a[44:47], a[172:175], v[228:231]
 s_waitcnt lgkmcnt(0)
M v[224:227], a[36:39], a[172:175], v[224:227]
M v[224:227], a[32:35], a[168:171], v[224:227]
M a[0:3], a[96:99], a[160:163], a[0:3]
 ds_read_b128 a[168:171], v5 offset:34816
 ds_read_b128 a[172:175], v6 offset:34816
M a[0:3], a[100:103], a[164:167], a[0:3]
 ds_read_b64_tr_b16 a[32:33], v1 offset:0
 ds_read_b64_tr_b16 a[34:35], v1 offset:1024
M a[4:7], a[108:111], a[164:167], a[4:7]
 s_add_u32 m0, s24, 16384
M a[4:7], a[104:107], a[160:163], a[4:7]
 buffer_load_dwordx4 v12, s[48:51], s22 offen offset:0   lds
M a[8:11], a[112:115], a[160:163], a[8:11]
M a[8:11], a[116:119], a[164:167], a[8:11]
M a[12:15], a[124:127], a[164:167], a[12:15]
 ds_read_b64_tr_b16 a[36:37], v1 offset:8192
 ds_read_b64_tr_b16 a[38:39], v1 offset:9216
M a[12:15], a[120:123], a[160:163], a[12:15]
M a[16:19], a[128:131], a[160:163], a[16:19]
 buffer_load_dwordx4 v13, s[48:51], s22 offen offset:1024   lds
M a[16:19], a[132:135], a[164:167], a[16:19]
M a[20:23], a[140:143], a[164:167], a[20:23]
M a[20:23], a[136:139], a[160:163], a[20:23]
 ds_read_b64_tr_b16 a[40:41], v2 offset:0
 ds_read_b64_tr_b16 a[42:43], v2 offset:1024
M a[24:27], a[144:147], a[160:163], a[24:27]
M a[24:27], a[148:151], a[164:167], a[24:27]
 s_waitcnt lgkmcnt(6)
M a[28:31], a[156:159], a[164:167], a[28:31]
 buffer_load_dwordx4 v14, s[48:51], s22 offen offset:2048   lds
M a[28:31], a[152:155], a[160:163], a[28:31]
M v[60:63], a[152:155], a[168:171], v[60:63]
 ds_read_b128 a[160:163], v5 offset:36864
 ds_read_b128 a[164:167], v6 offset:36864
M v[60:63], a[156:159], a[172:175], v[60:63]
 ds_read_b64_tr_b16 a[44:45], v2 offset:8192
 ds_read_b64_tr_b16 a[46:47], v2 offset:9216
M v[56:59], a[148:151], a[172:175], v[56:59]
 buffer_load_dwordx4 v15, s[48:51], s22 offen offset:3072   lds
M v[56:59], a[144:147], a[168:171], v[56:59]
 s_sub_u32 s22, s22, 2097024
M v[52:55], a[136:139], a[168:171], v[52:55]
M v[52:55], a[140:143], a[172:175], v[52:55]
 ds_read_b64_tr_b16 a[48:49], v3 offset:0
 ds_read_b64_tr_b16 a[50:51], v3 offset:1024
M v[48:51], a[132:135], a[172:175], v[48:51]
 s_add_u32 m0, s23, 49152
M v[48:51], a[128:131], a[168:171], v[48:51]
 buffer_load_dwordx4 v8, s[16:19], s21 offen offset:0  nt lds
M v[44:47], a[120:123], a[168:171], v[44:47]
M v[44:47], a[124:127], a[172:175], v[44:47]
M v[40:43], a[116:119], a[172:175], v[40:43]
 ds_read_b64_tr_b16 a[52:53], v3 offset:8192
 ds_read_b64_tr_b16 a[54:55], v3 offset:9216
M v[40:43], a[112:115], a[168:171], v[40:43]
M v[36:39], a[104:107], a[168:171], v[36:39]
 buffer_load_dwordx4 v9, s[16:19], s21 offen offset:1024  nt lds
M v[36:39], a[108:111], a[172:175], v[36:39]
 s_waitcnt lgkmcnt(6)
M v[32:35], a[100:103], a[172:175], v[32:35]
M v[32:35], a[96:99], a[168:171], v[32:35]
 ds_read_b64_tr_b16 a[56:57], v4 offset:0
 ds_read_b64_tr_b16 a[58:59], v4 offset:1024
M v[64:67], a[96:99], a[160:163], v[64:67]
 ds_read_b128 a[168:171], v5 offset:38912
 ds_read_b128 a[172:175], v6 offset:38912
M v[64:67], a[100:103], a[164:167], v[64:67]
 buffer_load_dwordx4 v10, s[16:19], s21 offen offset:2048  nt lds
M v[68:71], a[108:111], a[164:167], v[68:71]
M v[68:71], a[104:107], a[160:163], v[68:71]
M v[72:75], a[112:115], a[160:163], v[72:75]
 ds_read_b64_tr_b16 a[60:61], v4 offset:8192
 ds_read_b64_tr_b16 a[62:63], v4 offset:9216
M v[72:75], a[116:119], a[164:167], v[72:75]
M v[76:79], a[124:127], a[164:167], v[76:79]
 buffer_load_dwordx4 v11, s[16:19], s21 offen offset:3072  nt lds
M v[76:79], a[120:123], a[160:163], v[76:79]
 s_add_u32 s21, s21, 524160
M v[80:83], a[128:131], a[160:163], v[80:83]
M v[80:83], a[132:135], a[164:167], v[80:83]
M v[84:87], a[140:143], a[164:167], v[84:87]
M v[84:87], a[136:139], a[160:163], v[84:87]
M v[88:91], a[144:147], a[160:163], v[88:91]
M v[88:91], a[148:151], a[164:167], v[88:91]
 s_waitcnt lgkmcnt(2)
M v[92:95], a[156:159], a[164:167], v[92:95]
 s_waitcnt vmcnt(17) lgkmcnt(0)
M v[92:95], a[152:155], a[160:163], v[92:95]
 s_barrier
M v[124:127], a[152:155], a[168:171], v[124:127]
 ds_read_b128 a[160:163], v5 offset:49152
 ds_read_b128 a[164:167], v6 offset:49152
M v[124:127], a[156:159], a[172:175], v[124:127]
M v[120:123], a[148:151], a[172:175], v[120:123]
 s_add_u32 m0, s24, 32768
 ds_read_b64_tr_b16 a[64:65], v1 offset:16384
 ds_read_b64_tr_b16 a[66:67], v1 offset:17408
M v[120:123], a[144:147], a[168:171], v[120:123]
 buffer_load_dwordx4 v12, s[48:51], s22 offen offset:0   lds
M v[116:119], a[136:139], a[168:171], v[116:119]
M v[116:119], a[140:143], a[172:175], v[116:119]
M v[112:115], a[132:135], a[172:175], v[112:115]
M v[112:115], a[128:131], a[168:171], v[112:115]
M v[108:111], a[120:123], a[168:171], v[108:111]
M v[108:111], a[124:127], a[172:175], v[108:111]
 ds_read_b64_tr_b16 a[68:69], v1 offset:24576
 ds_read_b64_tr_b16 a[70:71], v1 offset:25600
M v[104:107], a[116:119], a[172:175], v[104:107]
 buffer_load_dwordx4 v13, s[48:51], s22 offen offset:1024   lds
M v[104:107], a[112:115], a[168:171], v[104:107]
M v[100:103], a[104:107], a[168:171], v[100:103]
 s_and_b32 s64, s42, 7
 s_lshl_b32 s64, s64, 2
M v[100:103], a[108:111], a[172:175], v[100:103]
 s_waitcnt lgkmcnt(4)
 s_add_u32 s64, s64, s20
M v[96:99], a[100:103], a[172:175], v[96:99]
 s_mul_i32 s64, s64, 114688
 v_bfe_u32 v28, v0, 2, 2
 v_and_b32 v29, 3, v0
M v[96:99], a[96:99], a[168:171], v[96:99]
 v_lshlrev_b32 v29, 7, v29
 v_lshl_add_u32 v28, v28, 13, v29
M v[128:131], a[96:99], a[160:163], v[128:131]
 ds_read_b128 a[168:171], v5 offset:51200
 ds_read_b128 a[172:175], v6 offset:51200
M v[128:131], a[100:103], a[164:167], v[128:131]
 ds_read_b64_tr_b16 a[72:73], v2 offset:16384
 ds_read_b64_tr_b16 a[74:75], v2 offset:17408
M v[132:135], a[108:111], a[164:167], v[132:135]
 buffer_load_dwordx4 v14, s[48:51], s22 offen offset:2048   lds
M v[132:135], a[104:107], a[160:163], v[132:135]
 v_add_u32 v23, s64, v28
 v_and_b32 v28, 48, v0
M v[136:139], a[112:115], a[160:163], v[136:139]
 v_lshl_add_u32 v23, v28, 24, v23
M v[136:139], a[116:119], a[164:167], v[136:139]
M v[140:143], a[124:127], a[164:167], v[140:143]
M v[140:143], a[120:123], a[160:163], v[140:143]
 ds_read_b64_tr_b16 a[76:77], v2 offset:24576
 ds_read_b64_tr_b16 a[78:79], v2 offset:25600
M v[144:147], a[128:131], a[160:163], v[144:147]
 buffer_load_dwordx4 v15, s[48:51], s22 offen offset:3072   lds
M v[144:147], a[132:135], a[164:167], v[144:147]
 s_add_u32 s22, s22, 2097152
M v[148:151], a[140:143], a[164:167], v[148:151]
M v[148:151], a[136:139], a[160:163], v[148:151]
M v[152:155], a[144:147], a[160:163], v[152:155]
M v[152:155], a[148:151], a[164:167], v[152:155]
 s_waitcnt lgkmcnt(4)
M v[156:159], a[156:159], a[164:167], v[156:159]
 s_add_u32 m0, s23, 0
 ds_read_b64_tr_b16 a[80:81], v3 offset:16384
 ds_read_b64_tr_b16 a[82:83], v3 offset:17408
M v[156:159], a[152:155], a[160:163], v[156:159]
 buffer_load_dwordx4 v8, s[16:19], s21 offen offset:0  nt lds
M v[188:191], a[152:155], a[168:171], v[188:191]
 ds_read_b128 a[160:163], v5 offset:53248
 ds_read_b128 a[164:167], v6 offset:53248
M v[188:191], a[156:159], a[172:175], v[188:191]
M v[184:187], a[148:151], a[172:175], v[184:187]
M v[184:187], a[144:147], a[168:171], v[184:187]
M v[180:183], a[136:139], a[168:171], v[180:183]
M v[180:183], a[140:143], a[172:175], v[180:183]
 ds_read_b64_tr_b16 a[84:85], v3 offset:24576
 ds_read_b64_tr_b16 a[86:87], v3 offset:25600
M v[176:179], a[132:135], a[172:175], v[176:179]
 buffer_load_dwordx4 v9, s[16:19], s21 offen offset:1024  nt lds
M v[176:179], a[128:131], a[168:171], v[176:179]
M v[172:175], a[120:123], a[168:171], v[172:175]
M v[172:175], a[124:127], a[172:175], v[172:175]
M v[168:171], a[116:119], a[172:175], v[168:171]
M v[168:171], a[112:115], a[168:171], v[168:171]
M v[164:167], a[104:107], a[168:171], v[164:167]
 ds_read_b64_tr_b16 a[88:89], v4 offset:16384
 ds_read_b64_tr_b16 a[90:91], v4 offset:17408
M v[164:167], a[108:111], a[172:175], v[164:167]
 s_waitcnt lgkmcnt(4)
M v[160:163], a[100:103], a[172:175], v[160:163]
 buffer_load_dwordx4 v10, s[16:19], s21 offen offset:2048  nt lds
M v[160:163], a[96:99], a[168:171], v[160:163]
M v[192:195], a[96:99], a[160:163], v[192:195]
 ds_read_b128 a[168:171], v5 offset:55296
 ds_read_b128 a[172:175], v6 offset:55296
M v[192:195], a[100:103], a[164:167], v[192:195]
M v[196:199], a[108:111], a[164:167], v[196:199]
M v[196:199], a[104:107], a[160:163], v[196:199]
 ds_read_b64_tr_b16 a[92:93], v4 offset:24576
 ds_read_b64_tr_b16 a[94:95], v4 offset:25600
M v[200:203], a[112:115], a[160:163], v[200:203]
 buffer_load_dwordx4 v11, s[16:19], s21 offen offset:3072  nt lds
M v[200:203], a[116:119], a[164:167], v[200:203]
 s_add_u32 s21, s21, 128
M v[204:207], a[124:127], a[164:167], v[204:207]
M v[204:207], a[120:123], a[160:163], v[204:207]
M v[208:211], a[128:131], a[160:163], v[208:211]
M v[208:211], a[132:135], a[164:167], v[208:211]
M v[212:215], a[140:143], a[164:167], v[212:215]
M v[212:215], a[136:139], a[160:163], v[212:215]
M v[216:219], a[144:147], a[160:163], v[216:219]
M v[216:219], a[148:151], a[164:167], v[216:219]
 s_waitcnt lgkmcnt(2)
M v[220:223], a[156:159], a[164:167], v[220:223]
 s_waitcnt vmcnt(17) lgkmcnt(0)
M v[220:223], a[152:155], a[160:163], v[220:223]
 s_barrier
M v[252:255], a[152:155], a[168:171], v[252:255]
 ds_read_b128 a[160:163], v5 offset:0
 ds_read_b128 a[164:167], v6 offset:0
M v[252:255], a[156:159], a[172:175], v[252:255]
 buffer_load_dword a240, v23, s[52:55], 0 offen offset:0
M v[248:251], a[148:151], a[172:175], v[248:251]
 v_add_u32 v23, 32768, v23
M v[248:251], a[144:147], a[168:171], v[248:251]
M v[244:247], a[136:139], a[168:171], v[244:247]
M v[244:247], a[140:143], a[172:175], v[244:247]
M v[240:243], a[132:135], a[172:175], v[240:243]
M v[240:243], a[128:131], a[168:171], v[240:243]
M v[236:239], a[120:123], a[168:171], v[236:239]
M v[236:239], a[124:127], a[172:175], v[236:239]
M v[232:235], a[116:119], a[172:175], v[232:235]
M v[232:235], a[112:115], a[168:171], v[232:235]
M v[228:231], a[104:107], a[168:171], v[228:231]
M v[228:231], a[108:111], a[172:175], v[228:231]
 s_waitcnt lgkmcnt(0)
M v[224:227], a[100:103], a[172:175], v[224:227]
M v[224:227], a[96:99], a[168:171], v[224:227]
M a[0:3], a[32:35], a[160:163], a[0:3]
 ds_read_b128 a[168:171], v5 offset:2048
 ds_read_b128 a[172:175], v6 offset:2048
M a[0:3], a[36:39], a[164:167], a[0:3]
 ds_read_b64_tr_b16 a[96:97], v1 offset:32768
 ds_read_b64_tr_b16 a[98:99], v1 offset:33792
M a[4:7], a[44:47], a[164:167], a[4:7]
 s_add_u32 m0, s24, 49152
M a[4:7], a[40:43], a[160:163], a[4:7]
 buffer_load_dwordx4 v12, s[48:51], s22 offen offset:0   lds
M a[8:11], a[48:51], a[160:163], a[8:11]
M a[8:11], a[52:55], a[164:167], a[8:11]
M a[12:15], a[60:63], a[164:167], a[12:15]
 ds_read_b64_tr_b16 a[100:101], v1 offset:40960
 ds_read_b64_tr_b16 a[102:103], v1 offset:41984
M a[12:15], a[56:59], a[160:163], a[12:15]
M a[16:19], a[64:67], a[160:163], a[16:19]
 buffer_load_dwordx4 v13, s[48:51], s22 offen offset:1024   lds
M a[16:19], a[68:71], a[164:167], a[16:19]
M a[20:23], a[76:79], a[164:167], a[20:23]
M a[20:23], a[72:75], a[160:163], a[20:23]
 ds_read_b64_tr_b16 a[104:105], v2 offset:32768
 ds_read_b64_tr_b16 a[106:107], v2 offset:33792
M a[24:27], a[80:83], a[160:163], a[24:27]
M a[24:27], a[84:87], a[164:167], a[24:27]
 s_waitcnt lgkmcnt(6)
M a[28:31], a[92:95], a[164:167], a[28:31]
 buffer_load_dwordx4 v14, s[48:51], s22 offen offset:2048   lds
M a[28:31], a[88:91], a[160:163], a[28:31]
M v[60:63], a[88:91], a[168:171], v[60:63]
 ds_read_b128 a[160:163], v5 offset:4096
 ds_read_b128 a[164:167], v6 offset:4096
M v[60:63], a[92:95], a[172:175], v[60:63]
 ds_read_b64_tr_b16 a[108:109], v2 offset:40960
 ds_read_b64_tr_b16 a[110:111], v2 offset:41984
M v[56:59], a[84:87], a[172:175], v[56:59]
 buffer_load_dwordx4 v15, s[48:51], s22 offen offset:3072   lds
M v[56:59], a[80:83], a[168:171], v[56:59]
 s_sub_u32 s22, s22, 2097024
M v[52:55], a[72:75], a[168:171], v[52:55]
M v[52:55], a[76:79], a[172:175], v[52:55]
 ds_read_b64_tr_b16 a[112:113], v3 offset:32768
 ds_read_b64_tr_b16 a[114:115], v3 offset:33792
M v[48:51], a[68:71], a[172:175], v[48:51]
 s_add_u32 m0, s23, 16384
M v[48:51], a[64:67], a[168:171], v[48:51]
 buffer_load_dwordx4 v8, s[16:19], s21 offen offset:0  nt lds
M v[44:47], a[56:59], a[168:171], v[44:47]
M v[44:47], a[60:63], a[172:175], v[44:47]
M v[40:43], a[52:55], a[172:175], v[40:43]
 ds_read_b64_tr_b16 a[116:117], v3 offset:40960
 ds_read_b64_tr_b16 a[118:119], v3 offset:41984
M v[40:43], a[48:51], a[168:171], v[40:43]
M v[36:39], a[40:43], a[168:171], v[36:39]
 buffer_load_dwordx4 v9, s[16:19], s21 offen offset:1024  nt lds
M v[36:39], a[44:47], a[172:175], v[36:39]
 s_waitcnt lgkmcnt(6)
M v[32:35], a[36:39], a[172:175], v[32:35]
M v[32:35], a[32:35], a[168:171], v[32:35]
 ds_read_b64_tr_b16 a[120:121], v4 offset:32768
 ds_read_b64_tr_b16 a[122:123], v4 offset:33792
M v[64:67], a[32:35], a[160:163], v[64:67]
 ds_read_b128 a[168:171], v5 offset:6144
 ds_read_b128 a[172:175], v6 offset:6144
M v[64:67], a[36:39], a[164:167], v[64:67]
 buffer_load_dwordx4 v10, s[16:19], s21 offen offset:2048  nt lds
M v[68:71], a[44:47], a[164:167], v[68:71]
M v[68:71], a[40:43], a[160:163], v[68:71]
M v[72:75], a[48:51], a[160:163], v[72:75]
 ds_read_b64_tr_b16 a[124:125], v4 offset:40960
 ds_read_b64_tr_b16 a[126:127], v4 offset:41984
M v[72:75], a[52:55], a[164:167], v[72:75]
M v[76:79], a[60:63], a[164:167], v[76:79]
 buffer_load_dwordx4 v11, s[16:19], s21 offen offset:3072  nt lds
M v[76:79], a[56:59], a[160:163], v[76:79]
 s_add_u32 s21, s21, 524160
M v[80:83], a[64:67], a[160:163], v[80:83]
M v[80:83], a[68:71], a[164:167], v[80:83]
M v[84:87], a[76:79], a[164:167], v[84:87]
M v[84:87], a[72:75], a[160:163], v[84:87]
M v[88:91], a[80:83], a[160:163], v[88:91]
M v[88:91], a[84:87], a[164:167], v[88:91]
 s_waitcnt lgkmcnt(2)
M v[92:95], a[92:95], a[164:167], v[92:95]
 s_waitcnt vmcnt(17) lgkmcnt(0)
M v[92:95], a[88:91], a[160:163], v[92:95]
 s_barrier
M v[124:127], a[88:91], a[168:171], v[124:127]
 ds_read_b128 a[160:163], v5 offset:16384
 ds_read_b128 a[164:167], v6 offset:16384
M v[124:127], a[92:95], a[172:175], v[124:127]
M v[120:123], a[84:87], a[172:175], v[120:123]
 s_add_u32 m0, s24, 0
 ds_read_b64_tr_b16 a[128:129], v1 offset:49152
 ds_read_b64_tr_b16 a[130:131], v1 offset:50176
M v[120:123], a[80:83], a[168:171], v[120:123]
 buffer_load_dwordx4 v12, s[48:51], s22 offen offset:0   lds
M v[116:119], a[72:75], a[168:171], v[116:119]
M v[116:119], a[76:79], a[172:175], v[116:119]
M v[112:115], a[68:71], a[172:175], v[112:115]
M v[112:115], a[64:67], a[168:171], v[112:115]
M v[108:111], a[56:59], a[168:171], v[108:111]
M v[108:111], a[60:63], a[172:175], v[108:111]
 ds_read_b64_tr_b16 a[132:133], v1 offset:57344
 ds_read_b64_tr_b16 a[134:135], v1 offset:58368
M v[104:107], a[52:55], a[172:175], v[104:107]
 buffer_load_dwordx4 v13, s[48:51], s22 offen offset:1024   lds
M v[104:107], a[48:51], a[168:171], v[104:107]
M v[100:103], a[40:43], a[168:171], v[100:103]
M v[100:103], a[44:47], a[172:175], v[100:103]
 s_waitcnt lgkmcnt(4)
M v[96:99], a[36:39], a[172:175], v[96:99]
M v[96:99], a[32:35], a[168:171], v[96:99]
M v[128:131], a[32:35], a[160:163], v[128:131]
 ds_read_b128 a[168:171], v5 offset:18432
 ds_read_b128 a[172:175], v6 offset:18432
M v[128:131], a[36:39], a[164:167], v[128:131]
 ds_read_b64_tr_b16 a[136:137], v2 offset:49152
 ds_read_b64_tr_b16 a[138:139], v2 offset:50176
M v[132:135], a[44:47], a[164:167], v[132:135]
 buffer_load_dwordx4 v14, s[48:51], s22 offen offset:2048   lds
M v[132:135], a[40:43], a[160:163], v[132:135]
M v[136:139], a[48:51], a[160:163], v[136:139]
M v[136:139], a[52:55], a[164:167], v[136:139]
M v[140:143], a[60:63], a[164:167], v[140:143]
M v[140:143], a[56:59], a[160:163], v[140:143]
 ds_read_b64_tr_b16 a[140:141], v2 offset:57344
 ds_read_b64_tr_b16 a[142:143], v2 offset:58368
M v[144:147], a[64:67], a[160:163], v[144:147]
 buffer_load_dwordx4 v15, s[48:51], s22 offen offset:3072   lds
M v[144:147], a[68:71], a[164:167], v[144:147]
 s_add_u32 s22, s22, 2097152
M v[148:151], a[76:79], a[164:167], v[148:151]
M v[148:151], a[72:75], a[160:163], v[148:151]
M v[152:155], a[80:83], a[160:163], v[152:155]
M v[152:155], a[84:87], a[164:167], v[152:155]
 s_waitcnt lgkmcnt(4)
M v[156:159], a[92:95], a[164:167], v[156:159]
 s_add_u32 m0, s23, 32768
 ds_read_b64_tr_b16 a[144:145], v3 offset:49152
 ds_read_b64_tr_b16 a[146:147], v3 offset:50176
M v[156:159], a[88:91], a[160:163], v[156:159]
 buffer_load_dwordx4 v8, s[16:19], s21 offen offset:0  nt lds
M v[188:191], a[88:91], a[168:171], v[188:191]
 ds_read_b128 a[160:163], v5 offset:20480
 ds_read_b128 a[164:167], v6 offset:20480
M v[188:191], a[92:95], a[172:175], v[188:191]
M v[184:187], a[84:87], a[172:175], v[184:187]
M v[184:187], a[80:83], a[168:171], v[184:187]
M v[180:183], a[72:75], a[168:171], v[180:183]
M v[180:183], a[76:79], a[172:175], v[180:183]
 ds_read_b64_tr_b16 a[148:149], v3 offset:57344
 ds_read_b64_tr_b16 a[150:151], v3 offset:58368
M v[176:179], a[68:71], a[172:175], v[176:179]
 buffer_load_dwordx4 v9, s[16:19], s21 offen offset:1024  nt lds
M v[176:179], a[64:67], a[168:171], v[176:179]
M v[172:175], a[56:59], a[168:171], v[172:175]
M v[172:175], a[60:63], a[172:175], v[172:175]
M v[168:171], a[52:55], a[172:175], v[168:171]
M v[168:171], a[48:51], a[168:171], v[168:171]
M v[164:167], a[40:43], a[168:171], v[164:167]
 ds_read_b64_tr_b16 a[152:153], v4 offset:49152
 ds_read_b64_tr_b16 a[154:155], v4 offset:50176
M v[164:167], a[44:47], a[172:175], v[164:167]
 s_waitcnt lgkmcnt(4)
M v[160:163], a[36:39], a[172:175], v[160:163]
 buffer_load_dwordx4 v10, s[16:19], s21 offen offset:2048  nt lds
M v[160:163], a[32:35], a[168:171], v[160:163]
M v[192:195], a[32:35], a[160:163], v[192:195]
 ds_read_b128 a[168:171], v5 offset:22528
 ds_read_b128 a[172:175], v6 offset:22528
M v[192:195], a[36:39], a[164:167], v[192:195]
M v[196:199], a[44:47], a[164:167], v[196:199]
M v[196:199], a[40:43], a[160:163], v[196:199]
 ds_read_b64_tr_b16 a[156:157], v4 offset:57344
 ds_read_b64_tr_b16 a[158:159], v4 offset:58368
M v[200:203], a[48:51], a[160:163], v[200:203]
 buffer_load_dwordx4 v11, s[16:19], s21 offen offset:3072  nt lds
M v[200:203], a[52:55], a[164:167], v[200:203]
 s_add_u32 s21, s21, 128
M v[204:207], a[60:63], a[164:167], v[204:207]
M v[204:207], a[56:59], a[160:163], v[204:207]
M v[208:211], a[64:67], a[160:163], v[208:211]
M v[208:211], a[68:71], a[164:167], v[208:211]
M v[212:215], a[76:79], a[164:167], v[212:215]
M v[212:215], a[72:75], a[160:163], v[212:215]
M v[216:219], a[80:83], a[160:163], v[216:219]
M v[216:219], a[84:87], a[164:167], v[216:219]
 s_waitcnt lgkmcnt(2)
M v[220:223], a[92:95], a[164:167], v[220:223]
 s_waitcnt vmcnt(17) lgkmcnt(0)
M v[220:223], a[88:91], a[160:163], v[220:223]
 s_barrier
M v[252:255], a[88:91], a[168:171], v[252:255]
 ds_read_b128 a[160:163], v5 offset:32768
 ds_read_b128 a[164:167], v6 offset:32768
M v[252:255], a[92:95], a[172:175], v[252:255]
 buffer_load_dword a240, v23, s[52:55], 0 offen offset:0
M v[248:251], a[84:87], a[172:175], v[248:251]
 v_add_u32 v23, 32768, v23
M v[248:251], a[80:83], a[168:171], v[248:251]
M v[244:247], a[72:75], a[168:171], v[244:247]
M v[244:247], a[76:79], a[172:175], v[244:247]
M v[240:243], a[68:71], a[172:175], v[240:243]
M v[240:243], a[64:67], a[168:171], v[240:243]
M v[236:239], a[56:59], a[168:171], v[236:239]
M v[236:239], a[60:63], a[172:175], v[236:239]
M v[232:235], a[52:55], a[172:175], v[232:235]
M v[232:235], a[48:51], a[168:171], v[232:235]
M v[228:231], a[40:43], a[168:171], v[228:231]
M v[228:231], a[44:47], a[172:175], v[228:231]
 s_waitcnt lgkmcnt(0)
M v[224:227], a[36:39], a[172:175], v[224:227]
M v[224:227], a[32:35], a[168:171], v[224:227]
M a[0:3], a[96:99], a[160:163], a[0:3]
 ds_read_b128 a[168:171], v5 offset:34816
 ds_read_b128 a[172:175], v6 offset:34816
M a[0:3], a[100:103], a[164:167], a[0:3]
 ds_read_b64_tr_b16 a[32:33], v1 offset:0
 ds_read_b64_tr_b16 a[34:35], v1 offset:1024
M a[4:7], a[108:111], a[164:167], a[4:7]
 s_add_u32 m0, s24, 16384
M a[4:7], a[104:107], a[160:163], a[4:7]
 buffer_load_dwordx4 v12, s[48:51], s22 offen offset:0   lds
M a[8:11], a[112:115], a[160:163], a[8:11]
M a[8:11], a[116:119], a[164:167], a[8:11]
M a[12:15], a[124:127], a[164:167], a[12:15]
 ds_read_b64_tr_b16 a[36:37], v1 offset:8192
 ds_read_b64_tr_b16 a[38:39], v1 offset:9216
M a[12:15], a[120:123], a[160:163], a[12:15]
M a[16:19], a[128:131], a[160:163], a[16:19]
 buffer_load_dwordx4 v13, s[48:51], s22 offen offset:1024   lds
M a[16:19], a[132:135], a[164:167], a[16:19]
M a[20:23], a[140:143], a[164:167], a[20:23]
M a[20:23], a[136:139], a[160:163], a[20:23]
 ds_read_b64_tr_b16 a[40:41], v2 offset:0
 ds_read_b64_tr_b16 a[42:43], v2 offset:1024
M a[24:27], a[144:147], a[160:163], a[24:27]
M a[24:27], a[148:151], a[164:167], a[24:27]
 s_waitcnt lgkmcnt(6)
M a[28:31], a[156:159], a[164:167], a[28:31]
 buffer_load_dwordx4 v14, s[48:51], s22 offen offset:2048   lds
M a[28:31], a[152:155], a[160:163], a[28:31]
M v[60:63], a[152:155], a[168:171], v[60:63]
 ds_read_b128 a[160:163], v5 offset:36864
 ds_read_b128 a[164:167], v6 offset:36864
M v[60:63], a[156:159], a[172:175], v[60:63]
 ds_read_b64_tr_b16 a[44:45], v2 offset:8192
 ds_read_b64_tr_b16 a[46:47], v2 offset:9216
M v[56:59], a[148:151], a[172:175], v[56:59]
 buffer_load_dwordx4 v15, s[48:51], s22 offen offset:3072   lds
M v[56:59], a[144:147], a[168:171], v[56:59]
 s_sub_u32 s22, s22, 2097024
M v[52:55], a[136:139], a[168:171], v[52:55]
M v[52:55], a[140:143], a[172:175], v[52:55]
 ds_read_b64_tr_b16 a[48:49], v3 offset:0
 ds_read_b64_tr_b16 a[50:51], v3 offset:1024
M v[48:51], a[132:135], a[172:175], v[48:51]
 s_add_u32 m0, s23, 49152
M v[48:51], a[128:131], a[168:171], v[48:51]
 buffer_load_dwordx4 v8, s[16:19], s21 offen offset:0  nt lds
M v[44:47], a[120:123], a[168:171], v[44:47]
M v[44:47], a[124:127], a[172:175], v[44:47]
M v[40:43], a[116:119], a[172:175], v[40:43]
 ds_read_b64_tr_b16 a[52:53], v3 offset:8192
 ds_read_b64_tr_b16 a[54:55], v3 offset:9216
M v[40:43], a[112:115], a[168:171], v[40:43]
M v[36:39], a[104:107], a[168:171], v[36:39]
 buffer_load_dwordx4 v9, s[16:19], s21 offen offset:1024  nt lds
M v[36:39], a[108:111], a[172:175], v[36:39]
 s_waitcnt lgkmcnt(6)
M v[32:35], a[100:103], a[172:175], v[32:35]
M v[32:35], a[96:99], a[168:171], v[32:35]
 ds_read_b64_tr_b16 a[56:57], v4 offset:0
 ds_read_b64_tr_b16 a[58:59], v4 offset:1024
M v[64:67], a[96:99], a[160:163], v[64:67]
 ds_read_b128 a[168:171], v5 offset:38912
 ds_read_b128 a[172:175], v6 offset:38912
M v[64:67], a[100:103], a[164:167], v[64:67]
 buffer_load_dwordx4 v10, s[16:19], s21 offen offset:2048  nt lds
M v[68:71], a[108:111], a[164:167], v[68:71]
M v[68:71], a[104:107], a[160:163], v[68:71]
M v[72:75], a[112:115], a[160:163], v[72:75]
 ds_read_b64_tr_b16 a[60:61], v4 offset:8192
 ds_read_b64_tr_b16 a[62:63], v4 offset:9216
M v[72:75], a[116:119], a[164:167], v[72:75]
M v[76:79], a[124:127], a[164:167], v[76:79]
 buffer_load_dwordx4 v11, s[16:19], s21 offen offset:3072  nt lds
M v[76:79], a[120:123], a[160:163], v[76:79]
 s_add_u32 s21, s21, 524160
M v[80:83], a[128:131], a[160:163], v[80:83]
M v[80:83], a[132:135], a[164:167], v[80:83]
M v[84:87], a[140:143], a[164:167], v[84:87]
M v[84:87], a[136:139], a[160:163], v[84:87]
M v[88:91], a[144:147], a[160:163], v[88:91]
M v[88:91], a[148:151], a[164:167], v[88:91]
 s_waitcnt lgkmcnt(2)
M v[92:95], a[156:159], a[164:167], v[92:95]
 s_waitcnt vmcnt(17) lgkmcnt(0)
M v[92:95], a[152:155], a[160:163], v[92:95]
 s_barrier
M v[124:127], a[152:155], a[168:171], v[124:127]
 ds_read_b128 a[160:163], v5 offset:49152
 ds_read_b128 a[164:167], v6 offset:49152
M v[124:127], a[156:159], a[172:175], v[124:127]
M v[120:123], a[148:151], a[172:175], v[120:123]
 s_add_u32 m0, s24, 32768
 ds_read_b64_tr_b16 a[64:65], v1 offset:16384
 ds_read_b64_tr_b16 a[66:67], v1 offset:17408
M v[120:123], a[144:147], a[168:171], v[120:123]
 buffer_load_dwordx4 v12, s[48:51], s22 offen offset:0   lds
M v[116:119], a[136:139], a[168:171], v[116:119]
M v[116:119], a[140:143], a[172:175], v[116:119]
M v[112:115], a[132:135], a[172:175], v[112:115]
M v[112:115], a[128:131], a[168:171], v[112:115]
M v[108:111], a[120:123], a[168:171], v[108:111]
M v[108:111], a[124:127], a[172:175], v[108:111]
 ds_read_b64_tr_b16 a[68:69], v1 offset:24576
 ds_read_b64_tr_b16 a[70:71], v1 offset:25600
M v[104:107], a[116:119], a[172:175], v[104:107]
 buffer_load_dwordx4 v13, s[48:51], s22 offen offset:1024   lds
M v[104:107], a[112:115], a[168:171], v[104:107]
M v[100:103], a[104:107], a[168:171], v[100:103]
M v[100:103], a[108:111], a[172:175], v[100:103]
 s_waitcnt lgkmcnt(4)
M v[96:99], a[100:103], a[172:175], v[96:99]
M v[96:99], a[96:99], a[168:171], v[96:99]
M v[128:131], a[96:99], a[160:163], v[128:131]
 ds_read_b128 a[168:171], v5 offset:51200
 ds_read_b128 a[172:175], v6 offset:51200
M v[128:131], a[100:103], a[164:167], v[128:131]
 ds_read_b64_tr_b16 a[72:73], v2 offset:16384
 ds_read_b64_tr_b16 a[74:75], v2 offset:17408
M v[132:135], a[108:111], a[164:167], v[132:135]
 buffer_load_dwordx4 v14, s[48:51], s22 offen offset:2048   lds
M v[132:135], a[104:107], a[160:163], v[132:135]
M v[136:139], a[112:115], a[160:163], v[136:139]
M v[136:139], a[116:119], a[164:167], v[136:139]
M v[140:143], a[124:127], a[164:167], v[140:143]
M v[140:143], a[120:123], a[160:163], v[140:143]
 ds_read_b64_tr_b16 a[76:77], v2 offset:24576
 ds_read_b64_tr_b16 a[78:79], v2 offset:25600
M v[144:147], a[128:131], a[160:163], v[144:147]
 buffer_load_dwordx4 v15, s[48:51], s22 offen offset:3072   lds
M v[144:147], a[132:135], a[164:167], v[144:147]
 s_add_u32 s22, s22, 2097152
M v[148:151], a[140:143], a[164:167], v[148:151]
M v[148:151], a[136:139], a[160:163], v[148:151]
M v[152:155], a[144:147], a[160:163], v[152:155]
M v[152:155], a[148:151], a[164:167], v[152:155]
 s_waitcnt lgkmcnt(4)
M v[156:159], a[156:159], a[164:167], v[156:159]
 s_add_u32 m0, s23, 0
 ds_read_b64_tr_b16 a[80:81], v3 offset:16384
 ds_read_b64_tr_b16 a[82:83], v3 offset:17408
M v[156:159], a[152:155], a[160:163], v[156:159]
 buffer_load_dwordx4 v8, s[16:19], s21 offen offset:0  nt lds
M v[188:191], a[152:155], a[168:171], v[188:191]
 ds_read_b128 a[160:163], v5 offset:53248
 ds_read_b128 a[164:167], v6 offset:53248
M v[188:191], a[156:159], a[172:175], v[188:191]
M v[184:187], a[148:151], a[172:175], v[184:187]
M v[184:187], a[144:147], a[168:171], v[184:187]
M v[180:183], a[136:139], a[168:171], v[180:183]
M v[180:183], a[140:143], a[172:175], v[180:183]
 ds_read_b64_tr_b16 a[84:85], v3 offset:24576
 ds_read_b64_tr_b16 a[86:87], v3 offset:25600
M v[176:179], a[132:135], a[172:175], v[176:179]
 buffer_load_dwordx4 v9, s[16:19], s21 offen offset:1024  nt lds
M v[176:179], a[128:131], a[168:171], v[176:179]
M v[172:175], a[120:123], a[168:171], v[172:175]
M v[172:175], a[124:127], a[172:175], v[172:175]
M v[168:171], a[116:119], a[172:175], v[168:171]
M v[168:171], a[112:115], a[168:171], v[168:171]
M v[164:167], a[104:107], a[168:171], v[164:167]
 ds_read_b64_tr_b16 a[88:89], v4 offset:16384
 ds_read_b64_tr_b16 a[90:91], v4 offset:17408
M v[164:167], a[108:111], a[172:175], v[164:167]
 s_waitcnt lgkmcnt(4)
M v[160:163], a[100:103], a[172:175], v[160:163]
 buffer_load_dwordx4 v10, s[16:19], s21 offen offset:2048  nt lds
M v[160:163], a[96:99], a[168:171], v[160:163]
M v[192:195], a[96:99], a[160:163], v[192:195]
 ds_read_b128 a[168:171], v5 offset:55296
 ds_read_b128 a[172:175], v6 offset:55296
M v[192:195], a[100:103], a[164:167], v[192:195]
M v[196:199], a[108:111], a[164:167], v[196:199]
M v[196:199], a[104:107], a[160:163], v[196:199]
 ds_read_b64_tr_b16 a[92:93], v4 offset:24576
 ds_read_b64_tr_b16 a[94:95], v4 offset:25600
M v[200:203], a[112:115], a[160:163], v[200:203]
 buffer_load_dwordx4 v11, s[16:19], s21 offen offset:3072  nt lds
M v[200:203], a[116:119], a[164:167], v[200:203]
 s_add_u32 s21, s21, 128
M v[204:207], a[124:127], a[164:167], v[204:207]
M v[204:207], a[120:123], a[160:163], v[204:207]
M v[208:211], a[128:131], a[160:163], v[208:211]
M v[208:211], a[132:135], a[164:167], v[208:211]
M v[212:215], a[140:143], a[164:167], v[212:215]
M v[212:215], a[136:139], a[160:163], v[212:215]
M v[216:219], a[144:147], a[160:163], v[216:219]
M v[216:219], a[148:151], a[164:167], v[216:219]
 s_waitcnt lgkmcnt(2)
M v[220:223], a[156:159], a[164:167], v[220:223]
 s_waitcnt vmcnt(17) lgkmcnt(0)
M v[220:223], a[152:155], a[160:163], v[220:223]
 s_barrier
M v[252:255], a[152:155], a[168:171], v[252:255]
 ds_read_b128 a[160:163], v5 offset:0
 ds_read_b128 a[164:167], v6 offset:0
M v[252:255], a[156:159], a[172:175], v[252:255]
 buffer_load_dword a240, v23, s[52:55], 0 offen offset:0
M v[248:251], a[148:151], a[172:175], v[248:251]
 v_add_u32 v23, 16384, v23
M v[248:251], a[144:147], a[168:171], v[248:251]
M v[244:247], a[136:139], a[168:171], v[244:247]
M v[244:247], a[140:143], a[172:175], v[244:247]
M v[240:243], a[132:135], a[172:175], v[240:243]
M v[240:243], a[128:131], a[168:171], v[240:243]
M v[236:239], a[120:123], a[168:171], v[236:239]
M v[236:239], a[124:127], a[172:175], v[236:239]
M v[232:235], a[116:119], a[172:175], v[232:235]
M v[232:235], a[112:115], a[168:171], v[232:235]
M v[228:231], a[104:107], a[168:171], v[228:231]
M v[228:231], a[108:111], a[172:175], v[228:231]
 s_waitcnt lgkmcnt(0)
M v[224:227], a[100:103], a[172:175], v[224:227]
M v[224:227], a[96:99], a[168:171], v[224:227]
M a[0:3], a[32:35], a[160:163], a[0:3]
 ds_read_b128 a[168:171], v5 offset:2048
 ds_read_b128 a[172:175], v6 offset:2048
M a[0:3], a[36:39], a[164:167], a[0:3]
 ds_read_b64_tr_b16 a[96:97], v1 offset:32768
 ds_read_b64_tr_b16 a[98:99], v1 offset:33792
M a[4:7], a[44:47], a[164:167], a[4:7]
 s_add_u32 m0, s24, 49152
 v_accvgpr_read_b32 v27, a241
M a[4:7], a[40:43], a[160:163], a[4:7]
 buffer_load_dwordx4 v12, s[48:51], s22 offen offset:0   lds
M a[8:11], a[48:51], a[160:163], a[8:11]
M a[8:11], a[52:55], a[164:167], a[8:11]
M a[12:15], a[60:63], a[164:167], a[12:15]
 ds_read_b64_tr_b16 a[100:101], v1 offset:40960
 ds_read_b64_tr_b16 a[102:103], v1 offset:41984
M a[12:15], a[56:59], a[160:163], a[12:15]
M a[16:19], a[64:67], a[160:163], a[16:19]
 buffer_load_dwordx4 v13, s[48:51], s22 offen offset:1024   lds
M a[16:19], a[68:71], a[164:167], a[16:19]
M a[20:23], a[76:79], a[164:167], a[20:23]
M a[20:23], a[72:75], a[160:163], a[20:23]
 ds_read_b64_tr_b16 a[104:105], v2 offset:32768
 ds_read_b64_tr_b16 a[106:107], v2 offset:33792
M a[24:27], a[80:83], a[160:163], a[24:27]
M a[24:27], a[84:87], a[164:167], a[24:27]
 s_waitcnt lgkmcnt(6)
M a[28:31], a[92:95], a[164:167], a[28:31]
 buffer_load_dwordx4 v14, s[48:51], s22 offen offset:2048   lds
M a[28:31], a[88:91], a[160:163], a[28:31]
M v[60:63], a[88:91], a[168:171], v[60:63]
 ds_read_b128 a[160:163], v5 offset:4096
 ds_read_b128 a[164:167], v6 offset:4096
M v[60:63], a[92:95], a[172:175], v[60:63]
 ds_read_b64_tr_b16 a[108:109], v2 offset:40960
 ds_read_b64_tr_b16 a[110:111], v2 offset:41984
M v[56:59], a[84:87], a[172:175], v[56:59]
 buffer_load_dwordx4 v15, s[48:51], s22 offen offset:3072   lds
M v[56:59], a[80:83], a[168:171], v[56:59]
 s_sub_u32 s22, s22, 2097024
M v[52:55], a[72:75], a[168:171], v[52:55]
M v[52:55], a[76:79], a[172:175], v[52:55]
 ds_read_b64_tr_b16 a[112:113], v3 offset:32768
 ds_read_b64_tr_b16 a[114:115], v3 offset:33792
M v[48:51], a[68:71], a[172:175], v[48:51]
 s_add_u32 m0, s23, 16384
M v[48:51], a[64:67], a[168:171], v[48:51]
 buffer_load_dwordx4 v8, s[16:19], s21 offen offset:0  nt lds
M v[44:47], a[56:59], a[168:171], v[44:47]
M v[44:47], a[60:63], a[172:175], v[44:47]
M v[40:43], a[52:55], a[172:175], v[40:43]
 ds_read_b64_tr_b16 a[116:117], v3 offset:40960
 ds_read_b64_tr_b16 a[118:119], v3 offset:41984
M v[40:43], a[48:51], a[168:171], v[40:43]
M v[36:39], a[40:43], a[168:171], v[36:39]
 buffer_load_dwordx4 v9, s[16:19], s21 offen offset:1024  nt lds
M v[36:39], a[44:47], a[172:175], v[36:39]
 s_waitcnt lgkmcnt(6)
M v[32:35], a[36:39], a[172:175], v[32:35]
M v[32:35], a[32:35], a[168:171], v[32:35]
 ds_read_b64_tr_b16 a[120:121], v4 offset:32768
 ds_read_b64_tr_b16 a[122:123], v4 offset:33792
M v[64:67], a[32:35], a[160:163], v[64:67]
 ds_read_b128 a[168:171], v5 offset:6144
 ds_read_b128 a[172:175], v6 offset:6144
M v[64:67], a[36:39], a[164:167], v[64:67]
 buffer_load_dwordx4 v10, s[16:19], s21 offen offset:2048  nt lds
M v[68:71], a[44:47], a[164:167], v[68:71]
M v[68:71], a[40:43], a[160:163], v[68:71]
M v[72:75], a[48:51], a[160:163], v[72:75]
 ds_read_b64_tr_b16 a[124:125], v4 offset:40960
 ds_read_b64_tr_b16 a[126:127], v4 offset:41984
M v[72:75], a[52:55], a[164:167], v[72:75]
 v_sub_f32 v48, v48, v27
 v_sub_f32 v49, v49, v27
M v[76:79], a[60:63], a[164:167], v[76:79]
 buffer_load_dwordx4 v11, s[16:19], s21 offen offset:3072  nt lds
M v[76:79], a[56:59], a[160:163], v[76:79]
 s_add_u32 s21, s21, 524160
 v_sub_f32 v50, v50, v27
 v_sub_f32 v51, v51, v27
M v[80:83], a[64:67], a[160:163], v[80:83]
 v_sub_f32 v52, v52, v27
 v_sub_f32 v53, v53, v27
M v[80:83], a[68:71], a[164:167], v[80:83]
 v_sub_f32 v54, v54, v27
 v_sub_f32 v55, v55, v27
M v[84:87], a[76:79], a[164:167], v[84:87]
 v_sub_f32 v56, v56, v27
 v_sub_f32 v57, v57, v27
M v[84:87], a[72:75], a[160:163], v[84:87]
 v_sub_f32 v58, v58, v27
 v_sub_f32 v59, v59, v27
M v[88:91], a[80:83], a[160:163], v[88:91]
 v_sub_f32 v60, v60, v27
 v_sub_f32 v61, v61, v27
M v[88:91], a[84:87], a[164:167], v[88:91]
 s_waitcnt lgkmcnt(2)
 v_sub_f32 v62, v62, v27
 v_sub_f32 v63, v63, v27
M v[92:95], a[92:95], a[164:167], v[92:95]
 s_waitcnt vmcnt(17) lgkmcnt(0)
M v[92:95], a[88:91], a[160:163], v[92:95]
 s_barrier
M v[124:127], a[88:91], a[168:171], v[124:127]
 ds_read_b128 a[160:163], v5 offset:16384
 ds_read_b128 a[164:167], v6 offset:16384
M v[124:127], a[92:95], a[172:175], v[124:127]
M v[120:123], a[84:87], a[172:175], v[120:123]
 s_add_u32 m0, s24, 0
 ds_read_b64_tr_b16 a[128:129], v1 offset:49152
 ds_read_b64_tr_b16 a[130:131], v1 offset:50176
M v[120:123], a[80:83], a[168:171], v[120:123]
 buffer_load_dwordx4 v12, s[48:51], s22 offen offset:0   lds
M v[116:119], a[72:75], a[168:171], v[116:119]
 v_sub_f32 v80, v80, v27
 v_sub_f32 v81, v81, v27
M v[116:119], a[76:79], a[172:175], v[116:119]
 v_sub_f32 v82, v82, v27
 v_sub_f32 v83, v83, v27
M v[112:115], a[68:71], a[172:175], v[112:115]
 v_sub_f32 v84, v84, v27
 v_sub_f32 v85, v85, v27
M v[112:115], a[64:67], a[168:171], v[112:115]
 v_sub_f32 v86, v86, v27
 v_sub_f32 v87, v87, v27
M v[108:111], a[56:59], a[168:171], v[108:111]
 v_sub_f32 v88, v88, v27
 v_sub_f32 v89, v89, v27
M v[108:111], a[60:63], a[172:175], v[108:111]
 ds_read_b64_tr_b16 a[132:133], v1 offset:57344
 ds_read_b64_tr_b16 a[134:135], v1 offset:58368
M v[104:107], a[52:55], a[172:175], v[104:107]
 buffer_load_dwordx4 v13, s[48:51], s22 offen offset:1024   lds
M v[104:107], a[48:51], a[168:171], v[104:107]
 v_sub_f32 v90, v90, v27
 v_sub_f32 v91, v91, v27
M v[100:103], a[40:43], a[168:171], v[100:103]
 v_sub_f32 v92, v92, v27
 v_sub_f32 v93, v93, v27
M v[100:103], a[44:47], a[172:175], v[100:103]
 s_waitcnt lgkmcnt(4)
 v_sub_f32 v94, v94, v27
 v_sub_f32 v95, v95, v27
M v[96:99], a[36:39], a[172:175], v[96:99]
M v[96:99], a[32:35], a[168:171], v[96:99]
M v[128:131], a[32:35], a[160:163], v[128:131]
 ds_read_b128 a[168:171], v5 offset:18432
 ds_read_b128 a[172:175], v6 offset:18432
M v[128:131], a[36:39], a[164:167], v[128:131]
 ds_read_b64_tr_b16 a[136:137], v2 offset:49152
 ds_read_b64_tr_b16 a[138:139], v2 offset:50176
M v[132:135], a[44:47], a[164:167], v[132:135]
 buffer_load_dwordx4 v14, s[48:51], s22 offen offset:2048   lds
M v[132:135], a[40:43], a[160:163], v[132:135]
M v[136:139], a[48:51], a[160:163], v[136:139]
 v_sub_f32 v112, v112, v27
 v_sub_f32 v113, v113, v27
M v[136:139], a[52:55], a[164:167], v[136:139]
 v_sub_f32 v114, v114, v27
 v_sub_f32 v115, v115, v27
M v[140:143], a[60:63], a[164:167], v[140:143]
 v_sub_f32 v116, v116, v27
 v_sub_f32 v117, v117, v27
M v[140:143], a[56:59], a[160:163], v[140:143]
 ds_read_b64_tr_b16 a[140:141], v2 offset:57344
 ds_read_b64_tr_b16 a[142:143], v2 offset:58368
M v[144:147], a[64:67], a[160:163], v[144:147]
 buffer_load_dwordx4 v15, s[48:51], s22 offen offset:3072   lds
M v[144:147], a[68:71], a[164:167], v[144:147]
 s_add_u32 s22, s22, 2097152
 v_sub_f32 v118, v118, v27
 v_sub_f32 v119, v119, v27
M v[148:151], a[76:79], a[164:167], v[148:151]
 v_sub_f32 v120, v120, v27
 v_sub_f32 v121, v121, v27
M v[148:151], a[72:75], a[160:163], v[148:151]
 v_sub_f32 v122, v122, v27
 v_sub_f32 v123, v123, v27
M v[152:155], a[80:83], a[160:163], v[152:155]
 v_sub_f32 v124, v124, v27
 v_sub_f32 v125, v125, v27
M v[152:155], a[84:87], a[164:167], v[152:155]
 s_waitcnt lgkmcnt(4)
 v_sub_f32 v126, v126, v27
 v_sub_f32 v127, v127, v27
M v[156:159], a[92:95], a[164:167], v[156:159]
 s_add_u32 m0, s23, 32768
 ds_read_b64_tr_b16 a[144:145], v3 offset:49152
 ds_read_b64_tr_b16 a[146:147], v3 offset:50176
M v[156:159], a[88:91], a[160:163], v[156:159]
 buffer_load_dwordx4 v8, s[16:19], s21 offen offset:0  nt lds
M v[188:191], a[88:91], a[168:171], v[188:191]
 ds_read_b128 a[160:163], v5 offset:20480
 ds_read_b128 a[164:167], v6 offset:20480
M v[188:191], a[92:95], a[172:175], v[188:191]
M v[184:187], a[84:87], a[172:175], v[184:187]
M v[184:187], a[80:83], a[168:171], v[184:187]
M v[180:183], a[72:75], a[168:171], v[180:183]
 v_sub_f32 v128, v128, v27
 v_sub_f32 v129, v129, v27
M v[180:183], a[76:79], a[172:175], v[180:183]
 ds_read_b64_tr_b16 a[148:149], v3 offset:57344
 ds_read_b64_tr_b16 a[150:151], v3 offset:58368
M v[176:179], a[68:71], a[172:175], v[176:179]
 buffer_load_dwordx4 v9, s[16:19], s21 offen offset:1024  nt lds
M v[176:179], a[64:67], a[168:171], v[176:179]
 v_sub_f32 v130, v130, v27
 v_sub_f32 v131, v131, v27
M v[172:175], a[56:59], a[168:171], v[172:175]
 v_sub_f32 v132, v132, v27
 v_sub_f32 v133, v133, v27
M v[172:175], a[60:63], a[172:175], v[172:175]
 v_sub_f32 v134, v134, v27
 v_sub_f32 v135, v135, v27
M v[168:171], a[52:55], a[172:175], v[168:171]
 v_sub_f32 v136, v136, v27
 v_sub_f32 v137, v137, v27
M v[168:171], a[48:51], a[168:171], v[168:171]
 v_sub_f32 v138, v138, v27
 v_sub_f32 v139, v139, v27
M v[164:167], a[40:43], a[168:171], v[164:167]
 ds_read_b64_tr_b16 a[152:153], v4 offset:49152
 ds_read_b64_tr_b16 a[154:155], v4 offset:50176
M v[164:167], a[44:47], a[172:175], v[164:167]
 s_waitcnt lgkmcnt(4)
 v_sub_f32 v140, v140, v27
 v_sub_f32 v141, v141, v27
M v[160:163], a[36:39], a[172:175], v[160:163]
 buffer_load_dwordx4 v10, s[16:19], s21 offen offset:2048  nt lds
M v[160:163], a[32:35], a[168:171], v[160:163]
 v_sub_f32 v142, v142, v27
 v_sub_f32 v143, v143, v27
M v[192:195], a[32:35], a[160:163], v[192:195]
 ds_read_b128 a[168:171], v5 offset:22528
 ds_read_b128 a[172:175], v6 offset:22528
M v[192:195], a[36:39], a[164:167], v[192:195]
 v_sub_f32 v144, v144, v27
 v_sub_f32 v145, v145, v27
M v[196:199], a[44:47], a[164:167], v[196:199]
 v_sub_f32 v146, v146, v27
 v_sub_f32 v147, v147, v27
M v[196:199], a[40:43], a[160:163], v[196:199]
 ds_read_b64_tr_b16 a[156:157], v4 offset:57344
 ds_read_b64_tr_b16 a[158:159], v4 offset:58368
M v[200:203], a[48:51], a[160:163], v[200:203]
 buffer_load_dwordx4 v11, s[16:19], s21 offen offset:3072  nt lds
M v[200:203], a[52:55], a[164:167], v[200:203]
 s_add_u32 s21, s21, 128
 v_sub_f32 v148, v148, v27
 v_sub_f32 v149, v149, v27
M v[204:207], a[60:63], a[164:167], v[204:207]
 v_sub_f32 v150, v150, v27
 v_sub_f32 v151, v151, v27
M v[204:207], a[56:59], a[160:163], v[204:207]
 v_sub_f32 v152, v152, v27
 v_sub_f32 v153, v153, v27
M v[208:211], a[64:67], a[160:163], v[208:211]
 v_sub_f32 v154, v154, v27
 v_sub_f32 v155, v155, v27
M v[208:211], a[68:71], a[164:167], v[208:211]
 v_sub_f32 v156, v156, v27
 v_sub_f32 v157, v157, v27
M v[212:215], a[76:79], a[164:167], v[212:215]
 v_sub_f32 v158, v158, v27
 v_sub_f32 v159, v159, v27
M v[212:215], a[72:75], a[160:163], v[212:215]
M v[216:219], a[80:83], a[160:163], v[216:219]
M v[216:219], a[84:87], a[164:167], v[216:219]
 s_waitcnt lgkmcnt(2)
M v[220:223], a[92:95], a[164:167], v[220:223]
 s_waitcnt vmcnt(17) lgkmcnt(0)
M v[220:223], a[88:91], a[160:163], v[220:223]
 s_barrier
M v[252:255], a[88:91], a[168:171], v[252:255]
 ds_read_b128 a[160:163], v5 offset:32768
 ds_read_b128 a[164:167], v6 offset:32768
M v[252:255], a[92:95], a[172:175], v[252:255]
 buffer_load_dword a240, v23, s[52:55], 0 offen offset:0
M v[248:251], a[84:87], a[172:175], v[248:251]
 v_add_u32 v23, 16384, v23
M v[248:251], a[80:83], a[168:171], v[248:251]
M v[244:247], a[72:75], a[168:171], v[244:247]
M v[244:247], a[76:79], a[172:175], v[244:247]
M v[240:243], a[68:71], a[172:175], v[240:243]
M v[240:243], a[64:67], a[168:171], v[240:243]
M v[236:239], a[56:59], a[168:171], v[236:239]
M v[236:239], a[60:63], a[172:175], v[236:239]
M v[232:235], a[52:55], a[172:175], v[232:235]
M v[232:235], a[48:51], a[168:171], v[232:235]
M v[228:231], a[40:43], a[168:171], v[228:231]
M v[228:231], a[44:47], a[172:175], v[228:231]
 s_waitcnt lgkmcnt(0)
M v[224:227], a[36:39], a[172:175], v[224:227]
M v[224:227], a[32:35], a[168:171], v[224:227]
M a[0:3], a[96:99], a[160:163], a[0:3]
 ds_read_b128 a[168:171], v5 offset:34816
 ds_read_b128 a[172:175], v6 offset:34816
M a[0:3], a[100:103], a[164:167], a[0:3]
 ds_read_b64_tr_b16 a[32:33], v1 offset:0
 ds_read_b64_tr_b16 a[34:35], v1 offset:1024
M a[4:7], a[108:111], a[164:167], a[4:7]
 s_add_u32 m0, s24, 16384
M a[4:7], a[104:107], a[160:163], a[4:7]
 buffer_load_dwordx4 v12, s[48:51], s22 offen offset:0   lds
M a[8:11], a[112:115], a[160:163], a[8:11]
M a[8:11], a[116:119], a[164:167], a[8:11]
M a[12:15], a[124:127], a[164:167], a[12:15]
 ds_read_b64_tr_b16 a[36:37], v1 offset:8192
 ds_read_b64_tr_b16 a[38:39], v1 offset:9216
M a[12:15], a[120:123], a[160:163], a[12:15]
M a[16:19], a[128:131], a[160:163], a[16:19]
 buffer_load_dwordx4 v13, s[48:51], s22 offen offset:1024   lds
M a[16:19], a[132:135], a[164:167], a[16:19]
M a[20:23], a[140:143], a[164:167], a[20:23]
M a[20:23], a[136:139], a[160:163], a[20:23]
 ds_read_b64_tr_b16 a[40:41], v2 offset:0
 ds_read_b64_tr_b16 a[42:43], v2 offset:1024
M a[24:27], a[144:147], a[160:163], a[24:27]
M a[24:27], a[148:151], a[164:167], a[24:27]
 s_waitcnt lgkmcnt(6)
M a[28:31], a[156:159], a[164:167], a[28:31]
 buffer_load_dwordx4 v14, s[48:51], s22 offen offset:2048   lds
M a[28:31], a[152:155], a[160:163], a[28:31]
M v[60:63], a[152:155], a[168:171], v[60:63]
 ds_read_b128 a[160:163], v5 offset:36864
 ds_read_b128 a[164:167], v6 offset:36864
M v[60:63], a[156:159], a[172:175], v[60:63]
 ds_read_b64_tr_b16 a[44:45], v2 offset:8192
 ds_read_b64_tr_b16 a[46:47], v2 offset:9216
M v[56:59], a[148:151], a[172:175], v[56:59]
 buffer_load_dwordx4 v15, s[48:51], s22 offen offset:3072   lds
M v[56:59], a[144:147], a[168:171], v[56:59]
 s_sub_u32 s22, s22, 2097024
M v[52:55], a[136:139], a[168:171], v[52:55]
M v[52:55], a[140:143], a[172:175], v[52:55]
 ds_read_b64_tr_b16 a[48:49], v3 offset:0
 ds_read_b64_tr_b16 a[50:51], v3 offset:1024
M v[48:51], a[132:135], a[172:175], v[48:51]
 s_add_u32 m0, s23, 49152
M v[48:51], a[128:131], a[168:171], v[48:51]
 buffer_load_dwordx4 v8, s[16:19], s21 offen offset:0  nt lds
M v[44:47], a[120:123], a[168:171], v[44:47]
M v[44:47], a[124:127], a[172:175], v[44:47]
M v[40:43], a[116:119], a[172:175], v[40:43]
 ds_read_b64_tr_b16 a[52:53], v3 offset:8192
 ds_read_b64_tr_b16 a[54:55], v3 offset:9216
M v[40:43], a[112:115], a[168:171], v[40:43]
M v[36:39], a[104:107], a[168:171], v[36:39]
 buffer_load_dwordx4 v9, s[16:19], s21 offen offset:1024  nt lds
M v[36:39], a[108:111], a[172:175], v[36:39]
 s_waitcnt lgkmcnt(6)
M v[32:35], a[100:103], a[172:175], v[32:35]
M v[32:35], a[96:99], a[168:171], v[32:35]
 ds_read_b64_tr_b16 a[56:57], v4 offset:0
 ds_read_b64_tr_b16 a[58:59], v4 offset:1024
M v[64:67], a[96:99], a[160:163], v[64:67]
 ds_read_b128 a[168:171], v5 offset:38912
 ds_read_b128 a[172:175], v6 offset:38912
M v[64:67], a[100:103], a[164:167], v[64:67]
 buffer_load_dwordx4 v10, s[16:19], s21 offen offset:2048  nt lds
M v[68:71], a[108:111], a[164:167], v[68:71]
M v[68:71], a[104:107], a[160:163], v[68:71]
M v[72:75], a[112:115], a[160:163], v[72:75]
 ds_read_b64_tr_b16 a[60:61], v4 offset:8192
 ds_read_b64_tr_b16 a[62:63], v4 offset:9216
M v[72:75], a[116:119], a[164:167], v[72:75]
M v[76:79], a[124:127], a[164:167], v[76:79]
 buffer_load_dwordx4 v11, s[16:19], s21 offen offset:3072  nt lds
M v[76:79], a[120:123], a[160:163], v[76:79]
 s_add_u32 s21, s21, 524160
M v[80:83], a[128:131], a[160:163], v[80:83]
M v[80:83], a[132:135], a[164:167], v[80:83]
M v[84:87], a[140:143], a[164:167], v[84:87]
M v[84:87], a[136:139], a[160:163], v[84:87]
M v[88:91], a[144:147], a[160:163], v[88:91]
M v[88:91], a[148:151], a[164:167], v[88:91]
 s_waitcnt lgkmcnt(2)
M v[92:95], a[156:159], a[164:167], v[92:95]
 s_waitcnt vmcnt(17) lgkmcnt(0)
M v[92:95], a[152:155], a[160:163], v[92:95]
 s_barrier
M v[124:127], a[152:155], a[168:171], v[124:127]
 ds_read_b128 a[160:163], v5 offset:49152
 ds_read_b128 a[164:167], v6 offset:49152
M v[124:127], a[156:159], a[172:175], v[124:127]
M v[120:123], a[148:151], a[172:175], v[120:123]
 s_add_u32 m0, s24, 32768
 ds_read_b64_tr_b16 a[64:65], v1 offset:16384
 ds_read_b64_tr_b16 a[66:67], v1 offset:17408
M v[120:123], a[144:147], a[168:171], v[120:123]
 buffer_load_dwordx4 v12, s[48:51], s22 offen offset:0   lds
M v[116:119], a[136:139], a[168:171], v[116:119]
M v[116:119], a[140:143], a[172:175], v[116:119]
M v[112:115], a[132:135], a[172:175], v[112:115]
M v[112:115], a[128:131], a[168:171], v[112:115]
M v[108:111], a[120:123], a[168:171], v[108:111]
M v[108:111], a[124:127], a[172:175], v[108:111]
 ds_read_b64_tr_b16 a[68:69], v1 offset:24576
 ds_read_b64_tr_b16 a[70:71], v1 offset:25600
M v[104:107], a[116:119], a[172:175], v[104:107]
 buffer_load_dwordx4 v13, s[48:51], s22 offen offset:1024   lds
M v[104:107], a[112:115], a[168:171], v[104:107]
M v[100:103], a[104:107], a[168:171], v[100:103]
M v[100:103], a[108:111], a[172:175], v[100:103]
 s_waitcnt lgkmcnt(4)
M v[96:99], a[100:103], a[172:175], v[96:99]
M v[96:99], a[96:99], a[168:171], v[96:99]
M v[128:131], a[96:99], a[160:163], v[128:131]
 ds_read_b128 a[168:171], v5 offset:51200
 ds_read_b128 a[172:175], v6 offset:51200
M v[128:131], a[100:103], a[164:167], v[128:131]
 ds_read_b64_tr_b16 a[72:73], v2 offset:16384
 ds_read_b64_tr_b16 a[74:75], v2 offset:17408
M v[132:135], a[108:111], a[164:167], v[132:135]
 buffer_load_dwordx4 v14, s[48:51], s22 offen offset:2048   lds
M v[132:135], a[104:107], a[160:163], v[132:135]
M v[136:139], a[112:115], a[160:163], v[136:139]
M v[136:139], a[116:119], a[164:167], v[136:139]
M v[140:143], a[124:127], a[164:167], v[140:143]
M v[140:143], a[120:123], a[160:163], v[140:143]
 ds_read_b64_tr_b16 a[76:77], v2 offset:24576
 ds_read_b64_tr_b16 a[78:79], v2 offset:25600
M v[144:147], a[128:131], a[160:163], v[144:147]
 buffer_load_dwordx4 v15, s[48:51], s22 offen offset:3072   lds
M v[144:147], a[132:135], a[164:167], v[144:147]
 s_add_u32 s22, s22, 2097152
M v[148:151], a[140:143], a[164:167], v[148:151]
M v[148:151], a[136:139], a[160:163], v[148:151]
M v[152:155], a[144:147], a[160:163], v[152:155]
M v[152:155], a[148:151], a[164:167], v[152:155]
 s_waitcnt lgkmcnt(4)
M v[156:159], a[156:159], a[164:167], v[156:159]
 s_add_u32 m0, s23, 0
 ds_read_b64_tr_b16 a[80:81], v3 offset:16384
 ds_read_b64_tr_b16 a[82:83], v3 offset:17408
M v[156:159], a[152:155], a[160:163], v[156:159]
 buffer_load_dwordx4 v8, s[52:55], s28 offen offset:0   lds
M v[188:191], a[152:155], a[168:171], v[188:191]
 ds_read_b128 a[160:163], v5 offset:53248
 ds_read_b128 a[164:167], v6 offset:53248
M v[188:191], a[156:159], a[172:175], v[188:191]
M v[184:187], a[148:151], a[172:175], v[184:187]
M v[184:187], a[144:147], a[168:171], v[184:187]
M v[180:183], a[136:139], a[168:171], v[180:183]
M v[180:183], a[140:143], a[172:175], v[180:183]
 ds_read_b64_tr_b16 a[84:85], v3 offset:24576
 ds_read_b64_tr_b16 a[86:87], v3 offset:25600
M v[176:179], a[132:135], a[172:175], v[176:179]
 buffer_load_dwordx4 v9, s[52:55], s28 offen offset:1024   lds
M v[176:179], a[128:131], a[168:171], v[176:179]
M v[172:175], a[120:123], a[168:171], v[172:175]
M v[172:175], a[124:127], a[172:175], v[172:175]
M v[168:171], a[116:119], a[172:175], v[168:171]
M v[168:171], a[112:115], a[168:171], v[168:171]
M v[164:167], a[104:107], a[168:171], v[164:167]
 ds_read_b64_tr_b16 a[88:89], v4 offset:16384
 ds_read_b64_tr_b16 a[90:91], v4 offset:17408
M v[164:167], a[108:111], a[172:175], v[164:167]
 s_waitcnt lgkmcnt(4)
M v[160:163], a[100:103], a[172:175], v[160:163]
 buffer_load_dwordx4 v10, s[52:55], s28 offen offset:2048   lds
M v[160:163], a[96:99], a[168:171], v[160:163]
M v[192:195], a[96:99], a[160:163], v[192:195]
 ds_read_b128 a[168:171], v5 offset:55296
 ds_read_b128 a[172:175], v6 offset:55296
M v[192:195], a[100:103], a[164:167], v[192:195]
M v[196:199], a[108:111], a[164:167], v[196:199]
M v[196:199], a[104:107], a[160:163], v[196:199]
 ds_read_b64_tr_b16 a[92:93], v4 offset:24576
 ds_read_b64_tr_b16 a[94:95], v4 offset:25600
M v[200:203], a[112:115], a[160:163], v[200:203]
 buffer_load_dwordx4 v11, s[52:55], s28 offen offset:3072   lds
M v[200:203], a[116:119], a[164:167], v[200:203]
 s_add_u32 s28, s28, 128
 v_sub_f32 v160, v160, v27
 v_sub_f32 v161, v161, v27
M v[204:207], a[124:127], a[164:167], v[204:207]
 v_sub_f32 v162, v162, v27
 v_sub_f32 v163, v163, v27
M v[204:207], a[120:123], a[160:163], v[204:207]
 v_sub_f32 v164, v164, v27
 v_sub_f32 v165, v165, v27
M v[208:211], a[128:131], a[160:163], v[208:211]
 v_sub_f32 v166, v166, v27
 v_sub_f32 v167, v167, v27
M v[208:211], a[132:135], a[164:167], v[208:211]
 v_sub_f32 v168, v168, v27
 v_sub_f32 v169, v169, v27
M v[212:215], a[140:143], a[164:167], v[212:215]
 v_sub_f32 v170, v170, v27
 v_sub_f32 v171, v171, v27
M v[212:215], a[136:139], a[160:163], v[212:215]
 v_sub_f32 v172, v172, v27
 v_sub_f32 v173, v173, v27
M v[216:219], a[144:147], a[160:163], v[216:219]
 v_sub_f32 v174, v174, v27
 v_sub_f32 v175, v175, v27
M v[216:219], a[148:151], a[164:167], v[216:219]
 s_waitcnt lgkmcnt(2)
 v_sub_f32 v176, v176, v27
 v_sub_f32 v177, v177, v27
M v[220:223], a[156:159], a[164:167], v[220:223]
 s_waitcnt vmcnt(17) lgkmcnt(0)
 v_sub_f32 v178, v178, v27
 v_sub_f32 v179, v179, v27
M v[220:223], a[152:155], a[160:163], v[220:223]
 s_barrier
M v[252:255], a[152:155], a[168:171], v[252:255]
 ds_read_b128 a[160:163], v5 offset:0
 ds_read_b128 a[164:167], v6 offset:0
M v[252:255], a[156:159], a[172:175], v[252:255]
 v_and_b32 v26, 48, v0
 v_lshlrev_b32 v26, 17, v26
M v[248:251], a[148:151], a[172:175], v[248:251]
 v_or_b32 v26, v26, v0
 v_lshl_add_u32 v26, v26, 7, s95
M v[248:251], a[144:147], a[168:171], v[248:251]
 buffer_load_dword a240, v26, s[76:79], 0 offen offset:0
M v[244:247], a[136:139], a[168:171], v[244:247]
 v_sub_f32 v180, v180, v27
 v_sub_f32 v181, v181, v27
M v[244:247], a[140:143], a[172:175], v[244:247]
 v_sub_f32 v182, v182, v27
 v_sub_f32 v183, v183, v27
M v[240:243], a[132:135], a[172:175], v[240:243]
 v_sub_f32 v184, v184, v27
 v_sub_f32 v185, v185, v27
M v[240:243], a[128:131], a[168:171], v[240:243]
 v_sub_f32 v186, v186, v27
 v_sub_f32 v187, v187, v27
M v[236:239], a[120:123], a[168:171], v[236:239]
 v_sub_f32 v188, v188, v27
 v_sub_f32 v189, v189, v27
M v[236:239], a[124:127], a[172:175], v[236:239]
 v_sub_f32 v190, v190, v27
 v_sub_f32 v191, v191, v27
M v[232:235], a[116:119], a[172:175], v[232:235]
 v_sub_f32 v192, v192, v27
 v_sub_f32 v193, v193, v27
M v[232:235], a[112:115], a[168:171], v[232:235]
 v_sub_f32 v194, v194, v27
 v_sub_f32 v195, v195, v27
M v[228:231], a[104:107], a[168:171], v[228:231]
 v_sub_f32 v196, v196, v27
 v_sub_f32 v197, v197, v27
M v[228:231], a[108:111], a[172:175], v[228:231]
 s_waitcnt lgkmcnt(0)
 v_sub_f32 v198, v198, v27
 v_sub_f32 v199, v199, v27
M v[224:227], a[100:103], a[172:175], v[224:227]
 v_sub_f32 v200, v200, v27
 v_sub_f32 v201, v201, v27
M v[224:227], a[96:99], a[168:171], v[224:227]
 v_sub_f32 v202, v202, v27
 v_sub_f32 v203, v203, v27
M a[0:3], a[32:35], a[160:163], a[0:3]
 ds_read_b128 a[168:171], v5 offset:2048
 ds_read_b128 a[172:175], v6 offset:2048
M a[0:3], a[36:39], a[164:167], a[0:3]
 ds_read_b64_tr_b16 a[96:97], v1 offset:32768
 ds_read_b64_tr_b16 a[98:99], v1 offset:33792
M a[4:7], a[44:47], a[164:167], a[4:7]
 s_add_u32 m0, s24, 49152
 v_lshrrev_b32 v28, 4, v0
 v_add_u32 v28, 0, v28
M a[4:7], a[40:43], a[160:163], a[4:7]
 buffer_load_dwordx4 v12, s[48:51], s22 offen offset:0   lds
M a[8:11], a[48:51], a[160:163], a[8:11]
 v_and_b32 v29, 7, v0
 v_xor_b32 v28, v28, v29
M a[8:11], a[52:55], a[164:167], a[8:11]
 v_lshlrev_b32 v28, 4, v28
 v_lshrrev_b32 v29, 3, v0
M a[12:15], a[60:63], a[164:167], a[12:15]
 ds_read_b64_tr_b16 a[100:101], v1 offset:40960
 ds_read_b64_tr_b16 a[102:103], v1 offset:41984
M a[12:15], a[56:59], a[160:163], a[12:15]
 buffer_load_dwordx4 v13, s[48:51], s22 offen offset:1024   lds
M a[16:19], a[64:67], a[160:163], a[16:19]
 v_mul_u32_u24 v29, 896, v29
 s_mul_i32 s64, s20, 28672
M a[16:19], a[68:71], a[164:167], a[16:19]
 buffer_load_dwordx4 v14, s[48:51], s22 offen offset:2048   lds
M a[20:23], a[76:79], a[164:167], a[20:23]
 s_add_u32 s64, s64, 0
 v_add3_u32 v16, v29, v28, s64
M a[20:23], a[72:75], a[160:163], a[20:23]
 ds_read_b64_tr_b16 a[104:105], v2 offset:32768
 ds_read_b64_tr_b16 a[106:107], v2 offset:33792
M a[24:27], a[80:83], a[160:163], a[24:27]
 v_add_u32 v18, 12288, v16
 v_lshrrev_b32 v28, 4, v0
M a[24:27], a[84:87], a[164:167], a[24:27]
 s_waitcnt lgkmcnt(6)
 v_add_u32 v28, 4, v28
 v_and_b32 v29, 7, v0
M a[28:31], a[92:95], a[164:167], a[28:31]
 buffer_load_dwordx4 v15, s[48:51], s22 offen offset:3072   lds
M a[28:31], a[88:91], a[160:163], a[28:31]
 s_sub_u32 s22, s22, 2097024
 v_xor_b32 v28, v28, v29
 v_lshlrev_b32 v28, 4, v28
M v[60:63], a[88:91], a[168:171], v[60:63]
 s_add_u32 m0, s23, 16384
 ds_read_b128 a[160:163], v5 offset:4096
 ds_read_b128 a[164:167], v6 offset:4096
M v[60:63], a[92:95], a[172:175], v[60:63]
 ds_read_b64_tr_b16 a[108:109], v2 offset:40960
 ds_read_b64_tr_b16 a[110:111], v2 offset:41984
M v[56:59], a[84:87], a[172:175], v[56:59]
 buffer_load_dwordx4 v8, s[52:55], s28 offen offset:0   lds
M v[56:59], a[80:83], a[168:171], v[56:59]
 v_lshrrev_b32 v29, 3, v0
 v_mul_u32_u24 v29, 896, v29
M v[52:55], a[72:75], a[168:171], v[52:55]
 buffer_load_dwordx4 v9, s[52:55], s28 offen offset:1024   lds
M v[52:55], a[76:79], a[172:175], v[52:55]
 ds_read_b64_tr_b16 a[112:113], v3 offset:32768
 ds_read_b64_tr_b16 a[114:115], v3 offset:33792
M v[48:51], a[68:71], a[172:175], v[48:51]
 s_mul_i32 s64, s20, 28672
 s_add_u32 s64, s64, 6144
M v[48:51], a[64:67], a[168:171], v[48:51]
 buffer_load_dwordx4 v10, s[52:55], s28 offen offset:2048   lds
M v[44:47], a[56:59], a[168:171], v[44:47]
 v_add3_u32 v17, v29, v28, s64
 v_add_u32 v19, 12288, v17
M v[44:47], a[60:63], a[172:175], v[44:47]
 v_add_u32 v20, 0x20000, v1
 v_add_u32 v21, 0x20000, v2
M v[40:43], a[52:55], a[172:175], v[40:43]
 ds_read_b64_tr_b16 a[116:117], v3 offset:40960
 ds_read_b64_tr_b16 a[118:119], v3 offset:41984
M v[40:43], a[48:51], a[168:171], v[40:43]
 buffer_load_dwordx4 v11, s[52:55], s28 offen offset:3072   lds
M v[36:39], a[40:43], a[168:171], v[36:39]
 s_add_u32 s28, s28, 1048448
 v_add_u32 v22, 0x20000, v3
 v_add_u32 v23, 0x20000, v4
M v[36:39], a[44:47], a[172:175], v[36:39]
 s_waitcnt lgkmcnt(6)
 v_sub_f32 v204, v204, v27
 v_sub_f32 v205, v205, v27
M v[32:35], a[36:39], a[172:175], v[32:35]
 s_add_u32 m0, s23, 131072
 v_sub_f32 v206, v206, v27
 v_sub_f32 v207, v207, v27
M v[32:35], a[32:35], a[168:171], v[32:35]
 ds_read_b64_tr_b16 a[120:121], v4 offset:32768
 ds_read_b64_tr_b16 a[122:123], v4 offset:33792
M v[64:67], a[32:35], a[160:163], v[64:67]
 ds_read_b128 a[168:171], v5 offset:6144
 ds_read_b128 a[172:175], v6 offset:6144
M v[64:67], a[36:39], a[164:167], v[64:67]
 buffer_load_dwordx4 v8, s[52:55], s28 offen offset:0   lds
M v[68:71], a[44:47], a[164:167], v[68:71]
 buffer_load_dwordx4 v9, s[52:55], s28 offen offset:1024   lds
M v[68:71], a[40:43], a[160:163], v[68:71]
 v_sub_f32 v208, v208, v27
 v_sub_f32 v209, v209, v27
M v[72:75], a[48:51], a[160:163], v[72:75]
 ds_read_b64_tr_b16 a[124:125], v4 offset:40960
 ds_read_b64_tr_b16 a[126:127], v4 offset:41984
M v[72:75], a[52:55], a[164:167], v[72:75]
 buffer_load_dwordx4 v10, s[52:55], s28 offen offset:2048   lds
M v[76:79], a[60:63], a[164:167], v[76:79]
 v_sub_f32 v210, v210, v27
 v_sub_f32 v211, v211, v27
M v[76:79], a[56:59], a[160:163], v[76:79]
 v_sub_f32 v212, v212, v27
 v_sub_f32 v213, v213, v27
M v[80:83], a[64:67], a[160:163], v[80:83]
 buffer_load_dwordx4 v11, s[52:55], s28 offen offset:3072   lds
M v[80:83], a[68:71], a[164:167], v[80:83]
 s_sub_u32 s28, s28, 524288
 v_sub_f32 v214, v214, v27
 v_sub_f32 v215, v215, v27
M v[84:87], a[76:79], a[164:167], v[84:87]
 v_sub_f32 v216, v216, v27
 v_sub_f32 v217, v217, v27
M v[84:87], a[72:75], a[160:163], v[84:87]
 v_sub_f32 v218, v218, v27
 v_sub_f32 v219, v219, v27
M v[88:91], a[80:83], a[160:163], v[88:91]
 v_sub_f32 v220, v220, v27
 v_sub_f32 v221, v221, v27
M v[88:91], a[84:87], a[164:167], v[88:91]
 s_waitcnt lgkmcnt(2)
 v_sub_f32 v222, v222, v27
 v_sub_f32 v223, v223, v27
M v[92:95], a[92:95], a[164:167], v[92:95]
 s_waitcnt vmcnt(21) lgkmcnt(0)
 v_sub_f32 v224, v224, v27
 v_sub_f32 v225, v225, v27
M v[92:95], a[88:91], a[160:163], v[92:95]
 s_barrier
M v[124:127], a[88:91], a[168:171], v[124:127]
 ds_read_b128 a[160:163], v5 offset:16384
 ds_read_b128 a[164:167], v6 offset:16384
M v[124:127], a[92:95], a[172:175], v[124:127]
 v_sub_f32 v226, v226, v27
 v_sub_f32 v227, v227, v27
M v[120:123], a[84:87], a[172:175], v[120:123]
 s_add_u32 m0, s24, 0
 ds_read_b64_tr_b16 a[128:129], v1 offset:49152
 ds_read_b64_tr_b16 a[130:131], v1 offset:50176
M v[120:123], a[80:83], a[168:171], v[120:123]
 buffer_load_dwordx4 v16, s[56:59], s29 offen offset:0   lds
M v[116:119], a[72:75], a[168:171], v[116:119]
 s_mul_i32 s72, s41, 4352
 v_sub_f32 v228, v228, v27
M v[116:119], a[76:79], a[172:175], v[116:119]
 s_add_u32 s46, s72, 104923136
 v_sub_f32 v229, v229, v27
 v_sub_f32 v230, v230, v27
M v[112:115], a[68:71], a[172:175], v[112:115]
 s_lshl_b32 s45, s42, 7
 s_add_u32 s45, s45, s46
 s_sub_u32 s66, 15, s42
M v[112:115], a[64:67], a[168:171], v[112:115]
 buffer_load_dwordx4 v17, s[56:59], s29 offen offset:1024   lds
M v[108:111], a[56:59], a[168:171], v[108:111]
 s_min_u32 s66, s66, s42
 v_sub_f32 v231, v231, v27
M v[108:111], a[60:63], a[172:175], v[108:111]
 s_lshl_b32 s47, s66, 7
 ds_read_b64_tr_b16 a[132:133], v1 offset:57344
 ds_read_b64_tr_b16 a[134:135], v1 offset:58368
M v[104:107], a[52:55], a[172:175], v[104:107]
 s_add_u32 s47, s47, s46
 v_sub_f32 v232, v232, v27
 v_sub_f32 v233, v233, v27
M v[104:107], a[48:51], a[168:171], v[104:107]
 s_add_u32 s47, s47, 2048
 s_lshl2_add_u32 s47, s20, s47
 s_lshl_b32 s65, s41, 3
M v[100:103], a[40:43], a[168:171], v[100:103]
 buffer_load_dwordx4 v18, s[56:59], s29 offen offset:2048   lds
M v[100:103], a[44:47], a[172:175], v[100:103]
 s_waitcnt lgkmcnt(4)
 s_add_u32 s65, s65, s66
 v_sub_f32 v234, v234, v27
M v[96:99], a[36:39], a[172:175], v[96:99]
 s_mul_i32 s34, s65, 73728
 v_sub_f32 v235, v235, v27
 v_sub_f32 v236, v236, v27
M v[96:99], a[32:35], a[168:171], v[96:99]
 s_add_u32 s34, s34, 50331648
 v_sub_f32 v237, v237, v27
 v_sub_f32 v238, v238, v27
M v[128:131], a[32:35], a[160:163], v[128:131]
 s_lshl_b32 s65, s42, 4
 ds_read_b128 a[168:171], v5 offset:18432
 ds_read_b128 a[172:175], v6 offset:18432
M v[128:131], a[36:39], a[164:167], v[128:131]
 s_add_u32 s65, s65, s41
 ds_read_b64_tr_b16 a[136:137], v2 offset:49152
 ds_read_b64_tr_b16 a[138:139], v2 offset:50176
M v[132:135], a[44:47], a[164:167], v[132:135]
 buffer_load_dwordx4 v19, s[56:59], s29 offen offset:3072   lds
M v[132:135], a[40:43], a[160:163], v[132:135]
 s_add_u32 s29, s29, 128
 s_mul_i32 s33, s65, 114688
 v_sub_f32 v239, v239, v27
M v[136:139], a[48:51], a[160:163], v[136:139]
 s_mul_i32 s65, s20, 28672
 s_add_u32 s33, s33, s65
 s_add_u32 s33, s33, 67108864
M v[136:139], a[52:55], a[164:167], v[136:139]
 s_add_u32 m0, s23, 32768
 s_sub_u32 s65, 15, s66
 s_lshl_b32 s65, s65, 16
M v[140:143], a[60:63], a[164:167], v[140:143]
 buffer_load_dwordx4 v8, s[52:55], s28 offen offset:0   lds
M v[140:143], a[56:59], a[160:163], v[140:143]
 ds_read_b64_tr_b16 a[140:141], v2 offset:57344
 ds_read_b64_tr_b16 a[142:143], v2 offset:58368
M v[144:147], a[64:67], a[160:163], v[144:147]
 s_lshl_b32 s64, s41, 20
 v_sub_f32 v240, v240, v27
M v[144:147], a[68:71], a[164:167], v[144:147]
 s_add_u32 s32, s64, s65
 s_lshl_b32 s65, s20, 14
 s_add_u32 s32, s32, s65
M v[148:151], a[76:79], a[164:167], v[148:151]
 buffer_load_dwordx4 v9, s[52:55], s28 offen offset:1024   lds
M v[148:151], a[72:75], a[160:163], v[148:151]
 s_add_u32 s32, s32, 33554432
 v_sub_f32 v241, v241, v27
M v[152:155], a[80:83], a[160:163], v[152:155]
 s_mov_b32 s31, 0x53800000
 s_mov_b32 s40, 1
 s_sub_u32 s64, s42, 10
M v[152:155], a[84:87], a[164:167], v[152:155]
 s_waitcnt lgkmcnt(4)
 s_and_b32 s35, s64, 536870912
 v_sub_f32 v242, v242, v27
M v[156:159], a[92:95], a[164:167], v[156:159]
 ds_read_b64_tr_b16 a[144:145], v3 offset:49152
 ds_read_b64_tr_b16 a[146:147], v3 offset:50176
M v[156:159], a[88:91], a[160:163], v[156:159]
 buffer_load_dwordx4 v10, s[52:55], s28 offen offset:2048   lds
M v[188:191], a[88:91], a[168:171], v[188:191]
 ds_read_b128 a[160:163], v5 offset:20480
 ds_read_b128 a[164:167], v6 offset:20480
M v[188:191], a[92:95], a[172:175], v[188:191]
 v_sub_f32 v243, v243, v27
 v_sub_f32 v244, v244, v27
M v[184:187], a[84:87], a[172:175], v[184:187]
 v_sub_f32 v245, v245, v27
 v_sub_f32 v246, v246, v27
M v[184:187], a[80:83], a[168:171], v[184:187]
 v_sub_f32 v247, v247, v27
 v_sub_f32 v248, v248, v27
M v[180:183], a[72:75], a[168:171], v[180:183]
 buffer_load_dwordx4 v11, s[52:55], s28 offen offset:3072   lds
M v[180:183], a[76:79], a[172:175], v[180:183]
 s_add_u32 s28, s28, 524416
 ds_read_b64_tr_b16 a[148:149], v3 offset:57344
 ds_read_b64_tr_b16 a[150:151], v3 offset:58368
M v[176:179], a[68:71], a[172:175], v[176:179]
 v_sub_f32 v249, v249, v27
 v_sub_f32 v250, v250, v27
M v[176:179], a[64:67], a[168:171], v[176:179]
 v_sub_f32 v251, v251, v27
 v_sub_f32 v252, v252, v27
M v[172:175], a[56:59], a[168:171], v[172:175]
 s_add_u32 m0, s23, 147456
 v_sub_f32 v253, v253, v27
 v_sub_f32 v254, v254, v27
M v[172:175], a[60:63], a[172:175], v[172:175]
 buffer_load_dwordx4 v8, s[52:55], s28 offen offset:0   lds
M v[168:171], a[52:55], a[172:175], v[168:171]
 v_sub_f32 v255, v255, v27
M v[168:171], a[48:51], a[168:171], v[168:171]
M v[164:167], a[40:43], a[168:171], v[164:167]
 ds_read_b64_tr_b16 a[152:153], v4 offset:49152
 ds_read_b64_tr_b16 a[154:155], v4 offset:50176
M v[164:167], a[44:47], a[172:175], v[164:167]
 s_waitcnt lgkmcnt(4)
M v[160:163], a[36:39], a[172:175], v[160:163]
 buffer_load_dwordx4 v9, s[52:55], s28 offen offset:1024   lds
M v[160:163], a[32:35], a[168:171], v[160:163]
M v[192:195], a[32:35], a[160:163], v[192:195]
 ds_read_b128 a[168:171], v5 offset:22528
 ds_read_b128 a[172:175], v6 offset:22528
M v[192:195], a[36:39], a[164:167], v[192:195]
M v[196:199], a[44:47], a[164:167], v[196:199]
 buffer_load_dwordx4 v10, s[52:55], s28 offen offset:2048   lds
M v[196:199], a[40:43], a[160:163], v[196:199]
 ds_read_b64_tr_b16 a[156:157], v4 offset:57344
 ds_read_b64_tr_b16 a[158:159], v4 offset:58368
M v[200:203], a[48:51], a[160:163], v[200:203]
M v[200:203], a[52:55], a[164:167], v[200:203]
M v[204:207], a[60:63], a[164:167], v[204:207]
M v[204:207], a[56:59], a[160:163], v[204:207]
 buffer_load_dwordx4 v11, s[52:55], s28 offen offset:3072   lds
M v[208:211], a[64:67], a[160:163], v[208:211]
 s_sub_u32 s28, s28, 524288
M v[208:211], a[68:71], a[164:167], v[208:211]
M v[212:215], a[76:79], a[164:167], v[212:215]
M v[212:215], a[72:75], a[160:163], v[212:215]
M v[216:219], a[80:83], a[160:163], v[216:219]
M v[216:219], a[84:87], a[164:167], v[216:219]
 s_waitcnt lgkmcnt(2)
M v[220:223], a[92:95], a[164:167], v[220:223]
 s_waitcnt vmcnt(25) lgkmcnt(0)
M v[220:223], a[88:91], a[160:163], v[220:223]
 s_barrier
M v[252:255], a[88:91], a[168:171], v[252:255]
 ds_read_b128 a[160:163], v5 offset:32768
 ds_read_b128 a[164:167], v6 offset:32768
M v[252:255], a[92:95], a[172:175], v[252:255]
M v[248:251], a[84:87], a[172:175], v[248:251]
M v[248:251], a[80:83], a[168:171], v[248:251]
M v[244:247], a[72:75], a[168:171], v[244:247]
M v[244:247], a[76:79], a[172:175], v[244:247]
M v[240:243], a[68:71], a[172:175], v[240:243]
M v[240:243], a[64:67], a[168:171], v[240:243]
M v[236:239], a[56:59], a[168:171], v[236:239]
M v[236:239], a[60:63], a[172:175], v[236:239]
M v[232:235], a[52:55], a[172:175], v[232:235]
M v[232:235], a[48:51], a[168:171], v[232:235]
M v[228:231], a[40:43], a[168:171], v[228:231]
M v[228:231], a[44:47], a[172:175], v[228:231]
 s_waitcnt lgkmcnt(0)
M v[224:227], a[36:39], a[172:175], v[224:227]
M v[224:227], a[32:35], a[168:171], v[224:227]
M a[0:3], a[96:99], a[160:163], a[0:3]
 ds_read_b128 a[168:171], v5 offset:34816
 ds_read_b128 a[172:175], v6 offset:34816
M a[0:3], a[100:103], a[164:167], a[0:3]
 ds_read_b64_tr_b16 a[32:33], v1 offset:0
 ds_read_b64_tr_b16 a[34:35], v1 offset:1024
M a[4:7], a[108:111], a[164:167], a[4:7]
 s_add_u32 m0, s24, 16384
M a[4:7], a[104:107], a[160:163], a[4:7]
 buffer_load_dwordx4 v16, s[56:59], s29 offen offset:0   lds
M a[8:11], a[112:115], a[160:163], a[8:11]
M a[8:11], a[116:119], a[164:167], a[8:11]
M a[12:15], a[124:127], a[164:167], a[12:15]
 ds_read_b64_tr_b16 a[36:37], v1 offset:8192
 ds_read_b64_tr_b16 a[38:39], v1 offset:9216
M a[12:15], a[120:123], a[160:163], a[12:15]
M a[16:19], a[128:131], a[160:163], a[16:19]
 buffer_load_dwordx4 v17, s[56:59], s29 offen offset:1024   lds
M a[16:19], a[132:135], a[164:167], a[16:19]
 v_accvgpr_read_b32 v24, a0
 v_accvgpr_read_b32 v25, a1
M a[20:23], a[140:143], a[164:167], a[20:23]
 v_accvgpr_read_b32 v26, a2
 v_accvgpr_read_b32 v27, a3
M a[20:23], a[136:139], a[160:163], a[20:23]
 ds_read_b64_tr_b16 a[40:41], v2 offset:0
 ds_read_b64_tr_b16 a[42:43], v2 offset:1024
M a[24:27], a[144:147], a[160:163], a[24:27]
 v_accvgpr_read_b32 v28, a4
 v_accvgpr_read_b32 v29, a5
M a[24:27], a[148:151], a[164:167], a[24:27]
 s_waitcnt lgkmcnt(6)
 buffer_load_dwordx4 v18, s[56:59], s29 offen offset:2048   lds
M a[28:31], a[156:159], a[164:167], a[28:31]
 v_accvgpr_read_b32 v30, a6
 v_accvgpr_read_b32 v31, a7
M a[28:31], a[152:155], a[160:163], a[28:31]
 v_cvt_pk_bf16_f32 v24, v24, v25
 v_cvt_pk_bf16_f32 v25, v26, v27
M v[32:35], a[96:99], a[168:171], v[32:35]
 ds_read_b128 a[160:163], v5 offset:36864
 ds_read_b128 a[164:167], v6 offset:36864
M v[32:35], a[100:103], a[172:175], v[32:35]
 ds_read_b64_tr_b16 a[44:45], v2 offset:8192
 ds_read_b64_tr_b16 a[46:47], v2 offset:9216
M v[36:39], a[108:111], a[172:175], v[36:39]
 buffer_load_dwordx4 v19, s[56:59], s29 offen offset:3072   lds
M v[36:39], a[104:107], a[168:171], v[36:39]
 s_add_u32 s29, s29, 128
 v_cvt_pk_bf16_f32 v26, v28, v29
 v_cvt_pk_bf16_f32 v27, v30, v31
M v[40:43], a[112:115], a[168:171], v[40:43]
 s_add_u32 s3, s93, 0
 buffer_store_dwordx4 v[24:27], v7, s[8:11], s3 offen offset:0 sc1
M v[40:43], a[116:119], a[172:175], v[40:43]
 ds_read_b64_tr_b16 a[48:49], v3 offset:0
 ds_read_b64_tr_b16 a[50:51], v3 offset:1024
M v[44:47], a[124:127], a[172:175], v[44:47]
 s_add_u32 m0, s23, 49152
 v_accvgpr_read_b32 v24, a8
 v_accvgpr_read_b32 v25, a9
M v[44:47], a[120:123], a[168:171], v[44:47]
 buffer_load_dwordx4 v8, s[52:55], s28 offen offset:0   lds
M v[48:51], a[128:131], a[168:171], v[48:51]
 v_accvgpr_read_b32 v26, a10
 v_accvgpr_read_b32 v27, a11
M v[48:51], a[132:135], a[172:175], v[48:51]
 v_accvgpr_read_b32 v28, a12
 v_accvgpr_read_b32 v29, a13
M v[52:55], a[140:143], a[172:175], v[52:55]
 ds_read_b64_tr_b16 a[52:53], v3 offset:8192
 ds_read_b64_tr_b16 a[54:55], v3 offset:9216
M v[52:55], a[136:139], a[168:171], v[52:55]
 v_accvgpr_read_b32 v30, a14
 v_accvgpr_read_b32 v31, a15
M v[56:59], a[144:147], a[168:171], v[56:59]
 buffer_load_dwordx4 v9, s[52:55], s28 offen offset:1024   lds
M v[56:59], a[148:151], a[172:175], v[56:59]
 s_waitcnt lgkmcnt(6)
 v_cvt_pk_bf16_f32 v24, v24, v25
 v_cvt_pk_bf16_f32 v25, v26, v27
M v[60:63], a[156:159], a[172:175], v[60:63]
 v_cvt_pk_bf16_f32 v26, v28, v29
 v_cvt_pk_bf16_f32 v27, v30, v31
M v[60:63], a[152:155], a[168:171], v[60:63]
 ds_read_b64_tr_b16 a[56:57], v4 offset:0
 ds_read_b64_tr_b16 a[58:59], v4 offset:1024
M v[64:67], a[96:99], a[160:163], v[64:67]
 ds_read_b128 a[168:171], v5 offset:38912
 ds_read_b128 a[172:175], v6 offset:38912
M v[64:67], a[100:103], a[164:167], v[64:67]
 buffer_load_dwordx4 v10, s[52:55], s28 offen offset:2048   lds
M v[68:71], a[108:111], a[164:167], v[68:71]
M v[68:71], a[104:107], a[160:163], v[68:71]
 buffer_store_dwordx4 v[24:27], v7, s[8:11], s3 offen offset:1024 sc1
M v[72:75], a[112:115], a[160:163], v[72:75]
 ds_read_b64_tr_b16 a[60:61], v4 offset:8192
 ds_read_b64_tr_b16 a[62:63], v4 offset:9216
M v[72:75], a[116:119], a[164:167], v[72:75]
 v_accvgpr_read_b32 v24, a16
 v_accvgpr_read_b32 v25, a17
M v[76:79], a[124:127], a[164:167], v[76:79]
 buffer_load_dwordx4 v11, s[52:55], s28 offen offset:3072   lds
M v[76:79], a[120:123], a[160:163], v[76:79]
 s_add_u32 s28, s28, 1048448
 v_accvgpr_read_b32 v26, a18
 v_accvgpr_read_b32 v27, a19
M v[80:83], a[128:131], a[160:163], v[80:83]
 v_accvgpr_read_b32 v28, a20
 v_accvgpr_read_b32 v29, a21
M v[80:83], a[132:135], a[164:167], v[80:83]
 v_accvgpr_read_b32 v30, a22
 v_accvgpr_read_b32 v31, a23
M v[84:87], a[140:143], a[164:167], v[84:87]
 v_cvt_pk_bf16_f32 v24, v24, v25
 v_cvt_pk_bf16_f32 v25, v26, v27
M v[84:87], a[136:139], a[160:163], v[84:87]
 v_cvt_pk_bf16_f32 v26, v28, v29
 v_cvt_pk_bf16_f32 v27, v30, v31
M v[88:91], a[144:147], a[160:163], v[88:91]
 buffer_store_dwordx4 v[24:27], v7, s[8:11], s3 offen offset:2048 sc1
M v[88:91], a[148:151], a[164:167], v[88:91]
 s_waitcnt lgkmcnt(2)
 v_accvgpr_read_b32 v24, a24
 v_accvgpr_read_b32 v25, a25
M v[92:95], a[156:159], a[164:167], v[92:95]
 s_waitcnt vmcnt(27) lgkmcnt(0)
 v_accvgpr_read_b32 v26, a26
 v_accvgpr_read_b32 v27, a27
M v[92:95], a[152:155], a[160:163], v[92:95]
 s_barrier
M v[96:99], a[96:99], a[168:171], v[96:99]
 ds_read_b128 a[160:163], v5 offset:49152
 ds_read_b128 a[164:167], v6 offset:49152
M v[96:99], a[100:103], a[172:175], v[96:99]
 v_accvgpr_read_b32 v28, a28
 v_accvgpr_read_b32 v29, a29
M v[100:103], a[108:111], a[172:175], v[100:103]
 s_add_u32 m0, s24, 32768
 ds_read_b64_tr_b16 a[64:65], v1 offset:16384
 ds_read_b64_tr_b16 a[66:67], v1 offset:17408
M v[100:103], a[104:107], a[168:171], v[100:103]
 buffer_load_dwordx4 v16, s[56:59], s29 offen offset:0   lds
M v[104:107], a[112:115], a[168:171], v[104:107]
 v_accvgpr_read_b32 v30, a30
 v_accvgpr_read_b32 v31, a31
M v[104:107], a[116:119], a[172:175], v[104:107]
 v_cvt_pk_bf16_f32 v24, v24, v25
 v_cvt_pk_bf16_f32 v25, v26, v27
M v[108:111], a[124:127], a[172:175], v[108:111]
 v_cvt_pk_bf16_f32 v26, v28, v29
 v_cvt_pk_bf16_f32 v27, v30, v31
M v[108:111], a[120:123], a[168:171], v[108:111]
 buffer_store_dwordx4 v[24:27], v7, s[8:11], s3 offen offset:3072 sc1
M v[112:115], a[128:131], a[168:171], v[112:115]
 v_cvt_pk_bf16_f32 v32, v32, v33
 v_cvt_pk_bf16_f32 v33, v34, v35
M v[112:115], a[132:135], a[172:175], v[112:115]
 ds_read_b64_tr_b16 a[68:69], v1 offset:24576
 ds_read_b64_tr_b16 a[70:71], v1 offset:25600
M v[116:119], a[140:143], a[172:175], v[116:119]
 buffer_load_dwordx4 v17, s[56:59], s29 offen offset:1024   lds
M v[116:119], a[136:139], a[168:171], v[116:119]
 v_cvt_pk_bf16_f32 v34, v36, v37
 v_cvt_pk_bf16_f32 v35, v38, v39
M v[120:123], a[144:147], a[168:171], v[120:123]
 v_accvgpr_write_b32 a4, v32
 v_accvgpr_write_b32 a5, v33
M v[120:123], a[148:151], a[172:175], v[120:123]
 s_waitcnt lgkmcnt(4)
 v_accvgpr_write_b32 a6, v34
 v_accvgpr_write_b32 a7, v35
M v[124:127], a[156:159], a[172:175], v[124:127]
 v_cvt_pk_bf16_f32 v40, v40, v41
 v_cvt_pk_bf16_f32 v41, v42, v43
M v[124:127], a[152:155], a[168:171], v[124:127]
 v_cvt_pk_bf16_f32 v42, v44, v45
 v_cvt_pk_bf16_f32 v43, v46, v47
M v[128:131], a[96:99], a[160:163], v[128:131]
 ds_read_b128 a[168:171], v5 offset:51200
 ds_read_b128 a[172:175], v6 offset:51200
M v[128:131], a[100:103], a[164:167], v[128:131]
 ds_read_b64_tr_b16 a[72:73], v2 offset:16384
 ds_read_b64_tr_b16 a[74:75], v2 offset:17408
M v[132:135], a[108:111], a[164:167], v[132:135]
 buffer_load_dwordx4 v18, s[56:59], s29 offen offset:2048   lds
M v[132:135], a[104:107], a[160:163], v[132:135]
 v_accvgpr_write_b32 a12, v40
 v_accvgpr_write_b32 a13, v41
M v[136:139], a[112:115], a[160:163], v[136:139]
 v_accvgpr_write_b32 a14, v42
 v_accvgpr_write_b32 a15, v43
M v[136:139], a[116:119], a[164:167], v[136:139]
 v_cvt_pk_bf16_f32 v48, v48, v49
 v_cvt_pk_bf16_f32 v49, v50, v51
M v[140:143], a[124:127], a[164:167], v[140:143]
 v_cvt_pk_bf16_f32 v50, v52, v53
 v_cvt_pk_bf16_f32 v51, v54, v55
M v[140:143], a[120:123], a[160:163], v[140:143]
 ds_read_b64_tr_b16 a[76:77], v2 offset:24576
 ds_read_b64_tr_b16 a[78:79], v2 offset:25600
M v[144:147], a[128:131], a[160:163], v[144:147]
 buffer_load_dwordx4 v19, s[56:59], s29 offen offset:3072   lds
M v[144:147], a[132:135], a[164:167], v[144:147]
 s_add_u32 s29, s29, 128
 v_accvgpr_write_b32 a20, v48
 v_accvgpr_write_b32 a21, v49
M v[148:151], a[140:143], a[164:167], v[148:151]
 v_accvgpr_write_b32 a22, v50
 v_accvgpr_write_b32 a23, v51
M v[148:151], a[136:139], a[160:163], v[148:151]
 v_cvt_pk_bf16_f32 v56, v56, v57
 v_cvt_pk_bf16_f32 v57, v58, v59
M v[152:155], a[144:147], a[160:163], v[152:155]
 v_cvt_pk_bf16_f32 v58, v60, v61
 v_cvt_pk_bf16_f32 v59, v62, v63
M v[152:155], a[148:151], a[164:167], v[152:155]
 s_waitcnt lgkmcnt(4)
 v_accvgpr_write_b32 a28, v56
 v_accvgpr_write_b32 a29, v57
M v[156:159], a[156:159], a[164:167], v[156:159]
 s_add_u32 m0, s23, 0
 ds_read_b64_tr_b16 a[80:81], v3 offset:16384
 ds_read_b64_tr_b16 a[82:83], v3 offset:17408
M v[156:159], a[152:155], a[160:163], v[156:159]
 buffer_load_dwordx4 v8, s[52:55], s28 offen offset:0   lds
M v[160:163], a[96:99], a[168:171], v[160:163]
 ds_read_b128 a[160:163], v5 offset:53248
 ds_read_b128 a[164:167], v6 offset:53248
M v[160:163], a[100:103], a[172:175], v[160:163]
 v_accvgpr_write_b32 a30, v58
 v_accvgpr_write_b32 a31, v59
M v[164:167], a[108:111], a[172:175], v[164:167]
 v_cvt_pk_bf16_f32 v64, v64, v65
 v_cvt_pk_bf16_f32 v65, v66, v67
M v[164:167], a[104:107], a[168:171], v[164:167]
 v_cvt_pk_bf16_f32 v66, v68, v69
 v_cvt_pk_bf16_f32 v67, v70, v71
M v[168:171], a[112:115], a[168:171], v[168:171]
 v_cvt_pk_bf16_f32 v72, v72, v73
 v_cvt_pk_bf16_f32 v73, v74, v75
M v[168:171], a[116:119], a[172:175], v[168:171]
 ds_read_b64_tr_b16 a[84:85], v3 offset:24576
 ds_read_b64_tr_b16 a[86:87], v3 offset:25600
M v[172:175], a[124:127], a[172:175], v[172:175]
 buffer_load_dwordx4 v9, s[52:55], s28 offen offset:1024   lds
M v[172:175], a[120:123], a[168:171], v[172:175]
 v_cvt_pk_bf16_f32 v74, v76, v77
 v_cvt_pk_bf16_f32 v75, v78, v79
M v[176:179], a[128:131], a[168:171], v[176:179]
 v_cvt_pk_bf16_f32 v80, v80, v81
 v_cvt_pk_bf16_f32 v81, v82, v83
M v[176:179], a[132:135], a[172:175], v[176:179]
 v_cvt_pk_bf16_f32 v82, v84, v85
 v_cvt_pk_bf16_f32 v83, v86, v87
M v[180:183], a[140:143], a[172:175], v[180:183]
 v_cvt_pk_bf16_f32 v88, v88, v89
 v_cvt_pk_bf16_f32 v89, v90, v91
M v[180:183], a[136:139], a[168:171], v[180:183]
 v_cvt_pk_bf16_f32 v90, v92, v93
 v_cvt_pk_bf16_f32 v91, v94, v95
M v[184:187], a[144:147], a[168:171], v[184:187]
 ds_read_b64_tr_b16 a[88:89], v4 offset:16384
 ds_read_b64_tr_b16 a[90:91], v4 offset:17408
M v[184:187], a[148:151], a[172:175], v[184:187]
 s_waitcnt lgkmcnt(4)
 buffer_load_dwordx4 v10, s[52:55], s28 offen offset:2048   lds
M v[188:191], a[156:159], a[172:175], v[188:191]
 v_cvt_pk_bf16_f32 v96, v96, v97
 v_cvt_pk_bf16_f32 v97, v98, v99
M v[188:191], a[152:155], a[168:171], v[188:191]
 v_cvt_pk_bf16_f32 v98, v100, v101
 v_cvt_pk_bf16_f32 v99, v102, v103
M v[192:195], a[96:99], a[160:163], v[192:195]
 ds_read_b128 a[168:171], v5 offset:55296
 ds_read_b128 a[172:175], v6 offset:55296
M v[192:195], a[100:103], a[164:167], v[192:195]
 v_cvt_pk_bf16_f32 v104, v104, v105
 v_cvt_pk_bf16_f32 v105, v106, v107
M v[196:199], a[108:111], a[164:167], v[196:199]
 v_cvt_pk_bf16_f32 v106, v108, v109
 v_cvt_pk_bf16_f32 v107, v110, v111
M v[196:199], a[104:107], a[160:163], v[196:199]
 ds_read_b64_tr_b16 a[92:93], v4 offset:24576
 ds_read_b64_tr_b16 a[94:95], v4 offset:25600
M v[200:203], a[112:115], a[160:163], v[200:203]
 buffer_load_dwordx4 v11, s[52:55], s28 offen offset:3072   lds
M v[200:203], a[116:119], a[164:167], v[200:203]
 s_add_u32 s28, s28, 128
 v_cvt_pk_bf16_f32 v112, v112, v113
 v_cvt_pk_bf16_f32 v113, v114, v115
M v[204:207], a[124:127], a[164:167], v[204:207]
 v_cvt_pk_bf16_f32 v114, v116, v117
 v_cvt_pk_bf16_f32 v115, v118, v119
M v[204:207], a[120:123], a[160:163], v[204:207]
 v_cvt_pk_bf16_f32 v120, v120, v121
 v_cvt_pk_bf16_f32 v121, v122, v123
M v[208:211], a[128:131], a[160:163], v[208:211]
 v_cvt_pk_bf16_f32 v122, v124, v125
 v_cvt_pk_bf16_f32 v123, v126, v127
M v[208:211], a[132:135], a[164:167], v[208:211]
 v_cvt_pk_bf16_f32 v128, v128, v129
 v_cvt_pk_bf16_f32 v129, v130, v131
M v[212:215], a[140:143], a[164:167], v[212:215]
 v_cvt_pk_bf16_f32 v130, v132, v133
 v_cvt_pk_bf16_f32 v131, v134, v135
M v[212:215], a[136:139], a[160:163], v[212:215]
 v_cvt_pk_bf16_f32 v136, v136, v137
 v_cvt_pk_bf16_f32 v137, v138, v139
M v[216:219], a[144:147], a[160:163], v[216:219]
 v_cvt_pk_bf16_f32 v138, v140, v141
 v_cvt_pk_bf16_f32 v139, v142, v143
M v[216:219], a[148:151], a[164:167], v[216:219]
 s_waitcnt lgkmcnt(2)
 v_cvt_pk_bf16_f32 v144, v144, v145
 v_cvt_pk_bf16_f32 v145, v146, v147
M v[220:223], a[156:159], a[164:167], v[220:223]
 s_waitcnt vmcnt(24) lgkmcnt(0)
 v_cvt_pk_bf16_f32 v146, v148, v149
 v_cvt_pk_bf16_f32 v147, v150, v151
M v[220:223], a[152:155], a[160:163], v[220:223]
 s_barrier
M v[224:227], a[96:99], a[168:171], v[224:227]
 ds_read_b128 a[160:163], v5 offset:0
 ds_read_b128 a[164:167], v6 offset:0
M v[224:227], a[100:103], a[172:175], v[224:227]
 v_cvt_pk_bf16_f32 v152, v152, v153
 v_cvt_pk_bf16_f32 v153, v154, v155
M v[228:231], a[108:111], a[172:175], v[228:231]
 v_cvt_pk_bf16_f32 v154, v156, v157
 v_cvt_pk_bf16_f32 v155, v158, v159
M v[228:231], a[104:107], a[168:171], v[228:231]
 v_cvt_pk_bf16_f32 v160, v160, v161
 v_cvt_pk_bf16_f32 v161, v162, v163
M v[232:235], a[112:115], a[168:171], v[232:235]
 v_cvt_pk_bf16_f32 v162, v164, v165
 v_cvt_pk_bf16_f32 v163, v166, v167
M v[232:235], a[116:119], a[172:175], v[232:235]
 v_cvt_pk_bf16_f32 v168, v168, v169
 v_cvt_pk_bf16_f32 v169, v170, v171
M v[236:239], a[124:127], a[172:175], v[236:239]
 v_cvt_pk_bf16_f32 v170, v172, v173
 v_cvt_pk_bf16_f32 v171, v174, v175
M v[236:239], a[120:123], a[168:171], v[236:239]
 v_cvt_pk_bf16_f32 v176, v176, v177
 v_cvt_pk_bf16_f32 v177, v178, v179
M v[240:243], a[128:131], a[168:171], v[240:243]
 v_cvt_pk_bf16_f32 v178, v180, v181
 v_cvt_pk_bf16_f32 v179, v182, v183
M v[240:243], a[132:135], a[172:175], v[240:243]
 v_cvt_pk_bf16_f32 v184, v184, v185
 v_cvt_pk_bf16_f32 v185, v186, v187
M v[244:247], a[140:143], a[172:175], v[244:247]
 v_cvt_pk_bf16_f32 v186, v188, v189
 v_cvt_pk_bf16_f32 v187, v190, v191
M v[244:247], a[136:139], a[168:171], v[244:247]
 v_cvt_pk_bf16_f32 v192, v192, v193
 v_cvt_pk_bf16_f32 v193, v194, v195
M v[248:251], a[144:147], a[168:171], v[248:251]
 v_cvt_pk_bf16_f32 v194, v196, v197
 v_cvt_pk_bf16_f32 v195, v198, v199
M v[248:251], a[148:151], a[172:175], v[248:251]
 s_waitcnt lgkmcnt(0)
 v_cvt_pk_bf16_f32 v200, v200, v201
 v_cvt_pk_bf16_f32 v201, v202, v203
M v[252:255], a[156:159], a[172:175], v[252:255]
 v_cvt_pk_bf16_f32 v202, v204, v205
 v_cvt_pk_bf16_f32 v203, v206, v207
M v[252:255], a[152:155], a[168:171], v[252:255]
 v_cvt_pk_bf16_f32 v208, v208, v209
 v_cvt_pk_bf16_f32 v209, v210, v211
M v[32:35], a[32:35], a[160:163], 0
 s_add_u32 m0, s23, 16384
 ds_read_b128 a[168:171], v5 offset:2048
 ds_read_b128 a[172:175], v6 offset:2048
M v[32:35], a[36:39], a[164:167], v[32:35]
 ds_read_b64_tr_b16 a[96:97], v1 offset:32768
 ds_read_b64_tr_b16 a[98:99], v1 offset:33792
M v[36:39], a[44:47], a[164:167], 0
 buffer_load_dwordx4 v8, s[52:55], s28 offen offset:0   lds
M v[36:39], a[40:43], a[160:163], v[36:39]
 v_cvt_pk_bf16_f32 v210, v212, v213
 v_cvt_pk_bf16_f32 v211, v214, v215
M v[40:43], a[48:51], a[160:163], 0
 ds_read_b64_tr_b16 a[100:101], v1 offset:40960
 ds_read_b64_tr_b16 a[102:103], v1 offset:41984
M v[40:43], a[52:55], a[164:167], v[40:43]
 buffer_load_dwordx4 v9, s[52:55], s28 offen offset:1024   lds
M v[44:47], a[60:63], a[164:167], 0
 v_cvt_pk_bf16_f32 v216, v216, v217
 v_cvt_pk_bf16_f32 v217, v218, v219
M v[44:47], a[56:59], a[160:163], v[44:47]
 ds_read_b64_tr_b16 a[104:105], v2 offset:32768
 ds_read_b64_tr_b16 a[106:107], v2 offset:33792
M v[48:51], a[64:67], a[160:163], 0
 v_cvt_pk_bf16_f32 v218, v220, v221
 v_cvt_pk_bf16_f32 v219, v222, v223
M v[48:51], a[68:71], a[164:167], v[48:51]
 v_cvt_pk_bf16_f32 v224, v224, v225
 v_cvt_pk_bf16_f32 v225, v226, v227
M v[52:55], a[76:79], a[164:167], 0
 ds_read_b64_tr_b16 a[108:109], v2 offset:40960
 ds_read_b64_tr_b16 a[110:111], v2 offset:41984
M v[52:55], a[72:75], a[160:163], v[52:55]
 buffer_load_dwordx4 v10, s[52:55], s28 offen offset:2048   lds
M v[56:59], a[80:83], a[160:163], 0
 v_cvt_pk_bf16_f32 v226, v228, v229
 v_cvt_pk_bf16_f32 v227, v230, v231
M v[56:59], a[84:87], a[164:167], v[56:59]
 s_waitcnt lgkmcnt(8)
 ds_read_b64_tr_b16 a[112:113], v3 offset:32768
 ds_read_b64_tr_b16 a[114:115], v3 offset:33792
M v[60:63], a[92:95], a[164:167], 0
 v_cvt_pk_bf16_f32 v232, v232, v233
 v_cvt_pk_bf16_f32 v233, v234, v235
M v[60:63], a[88:91], a[160:163], v[60:63]
 buffer_load_dwordx4 v11, s[52:55], s28 offen offset:3072   lds
M v[68:71], a[32:35], a[168:171], 0
 s_add_u32 s28, s28, 524160
 ds_read_b128 a[160:163], v5 offset:4096
 ds_read_b128 a[164:167], v6 offset:4096
M v[68:71], a[36:39], a[172:175], v[68:71]
 ds_read_b64_tr_b16 a[116:117], v3 offset:40960
 ds_read_b64_tr_b16 a[118:119], v3 offset:41984
M v[76:79], a[44:47], a[172:175], 0
 v_cvt_pk_bf16_f32 v234, v236, v237
 v_cvt_pk_bf16_f32 v235, v238, v239
M v[76:79], a[40:43], a[168:171], v[76:79]
 s_add_u32 m0, s24, 49152
 ds_read_b64_tr_b16 a[120:121], v4 offset:32768
 ds_read_b64_tr_b16 a[122:123], v4 offset:33792
M v[84:87], a[48:51], a[168:171], 0
 buffer_load_dwordx4 v16, s[56:59], s29 offen offset:0   lds
M v[84:87], a[52:55], a[172:175], v[84:87]
 v_cvt_pk_bf16_f32 v240, v240, v241
 v_cvt_pk_bf16_f32 v241, v242, v243
M v[92:95], a[60:63], a[172:175], 0
 ds_read_b64_tr_b16 a[124:125], v4 offset:40960
 ds_read_b64_tr_b16 a[126:127], v4 offset:41984
M v[92:95], a[56:59], a[168:171], v[92:95]
 v_cvt_pk_bf16_f32 v242, v244, v245
 v_cvt_pk_bf16_f32 v243, v246, v247
M v[100:103], a[64:67], a[168:171], 0
 v_cvt_pk_bf16_f32 v248, v248, v249
 v_cvt_pk_bf16_f32 v249, v250, v251
M v[100:103], a[68:71], a[172:175], v[100:103]
 buffer_load_dwordx4 v17, s[56:59], s29 offen offset:1024   lds
M v[108:111], a[76:79], a[172:175], 0
 v_cvt_pk_bf16_f32 v250, v252, v253
 v_cvt_pk_bf16_f32 v251, v254, v255
M v[108:111], a[72:75], a[168:171], v[108:111]
 s_add_u32 s3, s93, 8192
 v_mov_b32 v12, 1
 v_or_b32 v15, s20, v0
M v[116:119], a[80:83], a[168:171], 0
 v_min_u32 v15, 1, v15
 v_lshlrev_b32 v15, 29, v15
M v[116:119], a[84:87], a[172:175], v[116:119]
 s_waitcnt lgkmcnt(6)
 buffer_store_dwordx4 a[4:7], v7, s[8:11], s3 offen offset:0 sc1
M v[124:127], a[92:95], a[172:175], 0
 s_waitcnt vmcnt(17) lgkmcnt(0)
 buffer_load_dwordx4 v18, s[56:59], s29 offen offset:2048   lds
M v[124:127], a[88:91], a[168:171], v[124:127]
 s_barrier
M v[132:135], a[32:35], a[160:163], 0
 ds_read_b128 a[168:171], v5 offset:6144
 ds_read_b128 a[172:175], v6 offset:6144
M v[132:135], a[36:39], a[164:167], v[132:135]
 ds_read_b64_tr_b16 a[128:129], v1 offset:49152
 ds_read_b64_tr_b16 a[130:131], v1 offset:50176
M v[140:143], a[44:47], a[164:167], 0
M v[140:143], a[40:43], a[160:163], v[140:143]
 buffer_load_dwordx4 v19, s[56:59], s29 offen offset:3072   lds
M v[148:151], a[48:51], a[160:163], 0
 s_add_u32 s29, s29, 128
 ds_read_b64_tr_b16 a[132:133], v1 offset:57344
 ds_read_b64_tr_b16 a[134:135], v1 offset:58368
M v[148:151], a[52:55], a[164:167], v[148:151]
 buffer_store_dwordx4 a[12:15], v7, s[8:11], s3 offen offset:1024 sc1
M v[156:159], a[60:63], a[164:167], 0
M v[156:159], a[56:59], a[160:163], v[156:159]
 s_add_u32 m0, s23, 32768
 ds_read_b64_tr_b16 a[136:137], v2 offset:49152
 ds_read_b64_tr_b16 a[138:139], v2 offset:50176
M v[164:167], a[64:67], a[160:163], 0
 buffer_load_dwordx4 v8, s[52:55], s28 offen offset:0   lds
M v[164:167], a[68:71], a[164:167], v[164:167]
M v[172:175], a[76:79], a[164:167], 0
 ds_read_b64_tr_b16 a[140:141], v2 offset:57344
 ds_read_b64_tr_b16 a[142:143], v2 offset:58368
M v[172:175], a[72:75], a[160:163], v[172:175]
M v[180:183], a[80:83], a[160:163], 0
M v[180:183], a[84:87], a[164:167], v[180:183]
 s_waitcnt lgkmcnt(8)
 ds_read_b64_tr_b16 a[144:145], v3 offset:49152
 ds_read_b64_tr_b16 a[146:147], v3 offset:50176
M v[188:191], a[92:95], a[164:167], 0
 buffer_load_dwordx4 v9, s[52:55], s28 offen offset:1024   lds
M v[188:191], a[88:91], a[160:163], v[188:191]
M v[196:199], a[32:35], a[168:171], 0
 ds_read_b128 a[160:163], v5 offset:16384
 ds_read_b128 a[164:167], v6 offset:16384
M v[196:199], a[36:39], a[172:175], v[196:199]
 ds_read_b64_tr_b16 a[148:149], v3 offset:57344
 ds_read_b64_tr_b16 a[150:151], v3 offset:58368
M v[204:207], a[44:47], a[172:175], 0
 buffer_load_dwordx4 v10, s[52:55], s28 offen offset:2048   lds
M v[204:207], a[40:43], a[168:171], v[204:207]
 ds_read_b64_tr_b16 a[152:153], v4 offset:49152
 ds_read_b64_tr_b16 a[154:155], v4 offset:50176
M v[212:215], a[48:51], a[168:171], 0
M v[212:215], a[52:55], a[172:175], v[212:215]
M v[220:223], a[60:63], a[172:175], 0
 ds_read_b64_tr_b16 a[156:157], v4 offset:57344
 ds_read_b64_tr_b16 a[158:159], v4 offset:58368
M v[220:223], a[56:59], a[168:171], v[220:223]
 buffer_load_dwordx4 v11, s[52:55], s28 offen offset:3072   lds
M v[228:231], a[64:67], a[168:171], 0
 s_add_u32 s28, s28, 128
M v[228:231], a[68:71], a[172:175], v[228:231]
M v[236:239], a[76:79], a[172:175], 0
M v[236:239], a[72:75], a[168:171], v[236:239]
M v[244:247], a[80:83], a[168:171], 0
M v[244:247], a[84:87], a[172:175], v[244:247]
 s_waitcnt lgkmcnt(6)
M v[252:255], a[92:95], a[172:175], 0
 s_waitcnt lgkmcnt(0)
M v[252:255], a[88:91], a[168:171], v[252:255]
 s_barrier
M v[32:35], a[96:99], a[160:163], v[32:35]
 s_add_u32 m0, s23, 49152
 ds_read_b128 a[168:171], v5 offset:18432
 ds_read_b128 a[172:175], v6 offset:18432
M v[32:35], a[100:103], a[164:167], v[32:35]
 ds_read_b64_tr_b16 a[32:33], v20 offset:0
 ds_read_b64_tr_b16 a[34:35], v20 offset:1024
M v[36:39], a[108:111], a[164:167], v[36:39]
 s_mov_b32 s39, 1280
 buffer_load_dwordx4 v8, s[52:55], s28 offen offset:0   lds
M v[36:39], a[104:107], a[160:163], v[36:39]
 s_cmp_ge_u32 s42, 10
M v[40:43], a[112:115], a[160:163], v[40:43]
 s_cselect_b32 s64, 0xf000000, 0
 ds_read_b64_tr_b16 a[36:37], v20 offset:8192
 ds_read_b64_tr_b16 a[38:39], v20 offset:9216
M v[40:43], a[116:119], a[164:167], v[40:43]
 s_or_b32 s39, s39, s64
 buffer_load_dwordx4 v9, s[52:55], s28 offen offset:1024   lds
M v[44:47], a[124:127], a[164:167], v[44:47]
 s_lshl_b32 s64, s20, 14
M v[44:47], a[120:123], a[160:163], v[44:47]
 s_add_u32 s12, s64, s34
 ds_read_b64_tr_b16 a[40:41], v21 offset:0
 ds_read_b64_tr_b16 a[42:43], v21 offset:1024
M v[48:51], a[128:131], a[160:163], v[48:51]
 s_add_u32 s13, s12, 4096
 buffer_store_dwordx4 a[20:23], v7, s[8:11], s3 offen offset:2048 sc1
M v[48:51], a[132:135], a[164:167], v[48:51]
 s_add_u32 s14, s12, 8192
M v[52:55], a[140:143], a[164:167], v[52:55]
 s_add_u32 s15, s12, 12288
 ds_read_b64_tr_b16 a[44:45], v21 offset:8192
 ds_read_b64_tr_b16 a[46:47], v21 offset:9216
M v[52:55], a[136:139], a[160:163], v[52:55]
 buffer_load_dwordx4 v10, s[52:55], s28 offen offset:2048   lds
M v[56:59], a[144:147], a[160:163], v[56:59]
M v[56:59], a[148:151], a[164:167], v[56:59]
 s_waitcnt lgkmcnt(8)
 ds_read_b64_tr_b16 a[48:49], v22 offset:0
 ds_read_b64_tr_b16 a[50:51], v22 offset:1024
M v[60:63], a[156:159], a[164:167], v[60:63]
M v[60:63], a[152:155], a[160:163], v[60:63]
 buffer_load_dwordx4 v11, s[52:55], s28 offen offset:3072   lds
M v[68:71], a[96:99], a[168:171], v[68:71]
 s_add_u32 s28, s28, 524160
 ds_read_b128 a[160:163], v5 offset:20480
 ds_read_b128 a[164:167], v6 offset:20480
M v[68:71], a[100:103], a[172:175], v[68:71]
 ds_read_b64_tr_b16 a[52:53], v22 offset:8192
 ds_read_b64_tr_b16 a[54:55], v22 offset:9216
M v[76:79], a[108:111], a[172:175], v[76:79]
M v[76:79], a[104:107], a[168:171], v[76:79]
 s_add_u32 m0, s24, 0
 ds_read_b64_tr_b16 a[56:57], v23 offset:0
 ds_read_b64_tr_b16 a[58:59], v23 offset:1024
M v[84:87], a[112:115], a[168:171], v[84:87]
 buffer_load_dwordx4 v16, s[56:59], s29 offen offset:0   lds
M v[84:87], a[116:119], a[172:175], v[84:87]
M v[92:95], a[124:127], a[172:175], v[92:95]
 ds_read_b64_tr_b16 a[60:61], v23 offset:8192
 ds_read_b64_tr_b16 a[62:63], v23 offset:9216
M v[92:95], a[120:123], a[168:171], v[92:95]
M v[100:103], a[128:131], a[168:171], v[100:103]
M v[100:103], a[132:135], a[172:175], v[100:103]
 buffer_load_dwordx4 v17, s[56:59], s29 offen offset:1024   lds
M v[108:111], a[140:143], a[172:175], v[108:111]
M v[108:111], a[136:139], a[168:171], v[108:111]
M v[116:119], a[144:147], a[168:171], v[116:119]
M v[116:119], a[148:151], a[172:175], v[116:119]
 s_waitcnt lgkmcnt(6)
M v[124:127], a[156:159], a[172:175], v[124:127]
 s_waitcnt vmcnt(25) lgkmcnt(0)
 buffer_load_dwordx4 v18, s[56:59], s29 offen offset:2048   lds
M v[124:127], a[152:155], a[168:171], v[124:127]
 s_barrier
M v[132:135], a[96:99], a[160:163], v[132:135]
 ds_read_b128 a[168:171], v5 offset:22528
 ds_read_b128 a[172:175], v6 offset:22528
M v[132:135], a[100:103], a[164:167], v[132:135]
 ds_read_b64_tr_b16 a[64:65], v20 offset:16384
 ds_read_b64_tr_b16 a[66:67], v20 offset:17408
M v[140:143], a[108:111], a[164:167], v[140:143]
M v[140:143], a[104:107], a[160:163], v[140:143]
 buffer_load_dwordx4 v19, s[56:59], s29 offen offset:3072   lds
M v[148:151], a[112:115], a[160:163], v[148:151]
 s_add_u32 s29, s29, 128
 ds_read_b64_tr_b16 a[68:69], v20 offset:24576
 ds_read_b64_tr_b16 a[70:71], v20 offset:25600
M v[148:151], a[116:119], a[164:167], v[148:151]
 buffer_store_dwordx4 a[28:31], v7, s[8:11], s3 offen offset:3072 sc1
M v[156:159], a[124:127], a[164:167], v[156:159]
M v[156:159], a[120:123], a[160:163], v[156:159]
 s_add_u32 m0, s23, 131072
 ds_read_b64_tr_b16 a[72:73], v21 offset:16384
 ds_read_b64_tr_b16 a[74:75], v21 offset:17408
M v[164:167], a[128:131], a[160:163], v[164:167]
 buffer_load_dwordx4 v8, s[52:55], s28 offen offset:0   lds
M v[164:167], a[132:135], a[164:167], v[164:167]
M v[172:175], a[140:143], a[164:167], v[172:175]
 ds_read_b64_tr_b16 a[76:77], v21 offset:24576
 ds_read_b64_tr_b16 a[78:79], v21 offset:25600
M v[172:175], a[136:139], a[160:163], v[172:175]
M v[180:183], a[144:147], a[160:163], v[180:183]
M v[180:183], a[148:151], a[164:167], v[180:183]
 s_waitcnt lgkmcnt(8)
 ds_read_b64_tr_b16 a[80:81], v22 offset:16384
 ds_read_b64_tr_b16 a[82:83], v22 offset:17408
M v[188:191], a[156:159], a[164:167], v[188:191]
 buffer_load_dwordx4 v9, s[52:55], s28 offen offset:1024   lds
M v[188:191], a[152:155], a[160:163], v[188:191]
M v[196:199], a[96:99], a[168:171], v[196:199]
 ds_read_b128 a[160:163], v5 offset:32768
 ds_read_b128 a[164:167], v6 offset:32768
M v[196:199], a[100:103], a[172:175], v[196:199]
 ds_read_b64_tr_b16 a[84:85], v22 offset:24576
 ds_read_b64_tr_b16 a[86:87], v22 offset:25600
M v[204:207], a[108:111], a[172:175], v[204:207]
 buffer_load_dwordx4 v10, s[52:55], s28 offen offset:2048   lds
M v[204:207], a[104:107], a[168:171], v[204:207]
 ds_read_b64_tr_b16 a[88:89], v23 offset:16384
 ds_read_b64_tr_b16 a[90:91], v23 offset:17408
M v[212:215], a[112:115], a[168:171], v[212:215]
M v[212:215], a[116:119], a[172:175], v[212:215]
M v[220:223], a[124:127], a[172:175], v[220:223]
 ds_read_b64_tr_b16 a[92:93], v23 offset:24576
 ds_read_b64_tr_b16 a[94:95], v23 offset:25600
M v[220:223], a[120:123], a[168:171], v[220:223]
 buffer_load_dwordx4 v11, s[52:55], s28 offen offset:3072   lds
M v[228:231], a[128:131], a[168:171], v[228:231]
 s_add_u32 s28, s28, 128
M v[228:231], a[132:135], a[172:175], v[228:231]
M v[236:239], a[140:143], a[172:175], v[236:239]
M v[236:239], a[136:139], a[168:171], v[236:239]
M v[244:247], a[144:147], a[168:171], v[244:247]
M v[244:247], a[148:151], a[172:175], v[244:247]
 s_waitcnt lgkmcnt(6)
M v[252:255], a[156:159], a[172:175], v[252:255]
 s_waitcnt vmcnt(28) lgkmcnt(0)
M v[252:255], a[152:155], a[168:171], v[252:255]
 s_barrier
M v[32:35], a[32:35], a[160:163], v[32:35]
 s_add_u32 m0, s23, 147456
 ds_read_b128 a[168:171], v5 offset:34816
 ds_read_b128 a[172:175], v6 offset:34816
M v[32:35], a[36:39], a[164:167], v[32:35]
 ds_read_b64_tr_b16 a[96:97], v1 offset:0
 ds_read_b64_tr_b16 a[98:99], v1 offset:1024
M v[36:39], a[44:47], a[164:167], v[36:39]
 buffer_load_dwordx4 v8, s[52:55], s28 offen offset:0   lds
M v[36:39], a[40:43], a[160:163], v[36:39]
M v[40:43], a[48:51], a[160:163], v[40:43]
 ds_read_b64_tr_b16 a[100:101], v1 offset:8192
 ds_read_b64_tr_b16 a[102:103], v1 offset:9216
M v[40:43], a[52:55], a[164:167], v[40:43]
 buffer_load_dwordx4 v9, s[52:55], s28 offen offset:1024   lds
M v[44:47], a[60:63], a[164:167], v[44:47]
M v[44:47], a[56:59], a[160:163], v[44:47]
 ds_read_b64_tr_b16 a[104:105], v2 offset:0
 ds_read_b64_tr_b16 a[106:107], v2 offset:1024
M v[48:51], a[64:67], a[160:163], v[48:51]
M v[48:51], a[68:71], a[164:167], v[48:51]
M v[52:55], a[76:79], a[164:167], v[52:55]
 ds_read_b64_tr_b16 a[108:109], v2 offset:8192
 ds_read_b64_tr_b16 a[110:111], v2 offset:9216
M v[52:55], a[72:75], a[160:163], v[52:55]
 buffer_load_dwordx4 v10, s[52:55], s28 offen offset:2048   lds
M v[56:59], a[80:83], a[160:163], v[56:59]
M v[56:59], a[84:87], a[164:167], v[56:59]
 s_waitcnt lgkmcnt(8)
 ds_read_b64_tr_b16 a[112:113], v3 offset:0
 ds_read_b64_tr_b16 a[114:115], v3 offset:1024
M v[60:63], a[92:95], a[164:167], v[60:63]
M v[60:63], a[88:91], a[160:163], v[60:63]
 buffer_load_dwordx4 v11, s[52:55], s28 offen offset:3072   lds
M v[68:71], a[32:35], a[168:171], v[68:71]
 s_add_u32 s28, s28, 524160
 ds_read_b128 a[160:163], v5 offset:36864
 ds_read_b128 a[164:167], v6 offset:36864
M v[68:71], a[36:39], a[172:175], v[68:71]
 ds_read_b64_tr_b16 a[116:117], v3 offset:8192
 ds_read_b64_tr_b16 a[118:119], v3 offset:9216
M v[76:79], a[44:47], a[172:175], v[76:79]
M v[76:79], a[40:43], a[168:171], v[76:79]
 s_add_u32 m0, s24, 16384
 ds_read_b64_tr_b16 a[120:121], v4 offset:0
 ds_read_b64_tr_b16 a[122:123], v4 offset:1024
M v[84:87], a[48:51], a[168:171], v[84:87]
 buffer_load_dwordx4 v16, s[56:59], s29 offen offset:0   lds
M v[84:87], a[52:55], a[172:175], v[84:87]
M v[92:95], a[60:63], a[172:175], v[92:95]
 ds_read_b64_tr_b16 a[124:125], v4 offset:8192
 ds_read_b64_tr_b16 a[126:127], v4 offset:9216
M v[92:95], a[56:59], a[168:171], v[92:95]
M v[100:103], a[64:67], a[168:171], v[100:103]
M v[100:103], a[68:71], a[172:175], v[100:103]
 buffer_load_dwordx4 v17, s[56:59], s29 offen offset:1024   lds
M v[108:111], a[76:79], a[172:175], v[108:111]
M v[108:111], a[72:75], a[168:171], v[108:111]
M v[116:119], a[80:83], a[168:171], v[116:119]
M v[116:119], a[84:87], a[172:175], v[116:119]
 s_waitcnt lgkmcnt(6)
M v[124:127], a[92:95], a[172:175], v[124:127]
 s_waitcnt vmcnt(25) lgkmcnt(0)
 buffer_load_dwordx4 v18, s[56:59], s29 offen offset:2048   lds
M v[124:127], a[88:91], a[168:171], v[124:127]
 s_barrier
M v[132:135], a[32:35], a[160:163], v[132:135]
 ds_read_b128 a[168:171], v5 offset:38912
 ds_read_b128 a[172:175], v6 offset:38912
M v[132:135], a[36:39], a[164:167], v[132:135]
 ds_read_b64_tr_b16 a[128:129], v1 offset:16384
 ds_read_b64_tr_b16 a[130:131], v1 offset:17408
M v[140:143], a[44:47], a[164:167], v[140:143]
M v[140:143], a[40:43], a[160:163], v[140:143]
 buffer_load_dwordx4 v19, s[56:59], s29 offen offset:3072   lds
M v[148:151], a[48:51], a[160:163], v[148:151]
 s_add_u32 s29, s29, 128
 ds_read_b64_tr_b16 a[132:133], v1 offset:24576
 ds_read_b64_tr_b16 a[134:135], v1 offset:25600
M v[148:151], a[52:55], a[164:167], v[148:151]
M v[156:159], a[60:63], a[164:167], v[156:159]
M v[156:159], a[56:59], a[160:163], v[156:159]
 s_add_u32 m0, s23, 0
 ds_read_b64_tr_b16 a[136:137], v2 offset:16384
 ds_read_b64_tr_b16 a[138:139], v2 offset:17408
M v[164:167], a[64:67], a[160:163], v[164:167]
 buffer_load_dwordx4 v8, s[52:55], s28 offen offset:0   lds
M v[164:167], a[68:71], a[164:167], v[164:167]
M v[172:175], a[76:79], a[164:167], v[172:175]
 ds_read_b64_tr_b16 a[140:141], v2 offset:24576
 ds_read_b64_tr_b16 a[142:143], v2 offset:25600
M v[172:175], a[72:75], a[160:163], v[172:175]
M v[180:183], a[80:83], a[160:163], v[180:183]
M v[180:183], a[84:87], a[164:167], v[180:183]
 s_waitcnt lgkmcnt(8)
 ds_read_b64_tr_b16 a[144:145], v3 offset:16384
 ds_read_b64_tr_b16 a[146:147], v3 offset:17408
M v[188:191], a[92:95], a[164:167], v[188:191]
 buffer_load_dwordx4 v9, s[52:55], s28 offen offset:1024   lds
M v[188:191], a[88:91], a[160:163], v[188:191]
M v[196:199], a[32:35], a[168:171], v[196:199]
 ds_read_b128 a[160:163], v5 offset:49152
 ds_read_b128 a[164:167], v6 offset:49152
M v[196:199], a[36:39], a[172:175], v[196:199]
 ds_read_b64_tr_b16 a[148:149], v3 offset:24576
 ds_read_b64_tr_b16 a[150:151], v3 offset:25600
M v[204:207], a[44:47], a[172:175], v[204:207]
 buffer_load_dwordx4 v10, s[52:55], s28 offen offset:2048   lds
M v[204:207], a[40:43], a[168:171], v[204:207]
 ds_read_b64_tr_b16 a[152:153], v4 offset:16384
 ds_read_b64_tr_b16 a[154:155], v4 offset:17408
M v[212:215], a[48:51], a[168:171], v[212:215]
M v[212:215], a[52:55], a[172:175], v[212:215]
M v[220:223], a[60:63], a[172:175], v[220:223]
 ds_read_b64_tr_b16 a[156:157], v4 offset:24576
 ds_read_b64_tr_b16 a[158:159], v4 offset:25600
M v[220:223], a[56:59], a[168:171], v[220:223]
 buffer_load_dwordx4 v11, s[52:55], s28 offen offset:3072   lds
M v[228:231], a[64:67], a[168:171], v[228:231]
 s_add_u32 s28, s28, 128
M v[228:231], a[68:71], a[172:175], v[228:231]
M v[236:239], a[76:79], a[172:175], v[236:239]
M v[236:239], a[72:75], a[168:171], v[236:239]
M v[244:247], a[80:83], a[168:171], v[244:247]
M v[244:247], a[84:87], a[172:175], v[244:247]
 s_waitcnt lgkmcnt(6)
M v[252:255], a[92:95], a[172:175], v[252:255]
 s_waitcnt vmcnt(16) lgkmcnt(0)
M v[252:255], a[88:91], a[168:171], v[252:255]
 s_barrier
M v[32:35], a[96:99], a[160:163], v[32:35]
 s_add_u32 m0, s23, 16384
 ds_read_b128 a[168:171], v5 offset:51200
 ds_read_b128 a[172:175], v6 offset:51200
M v[32:35], a[100:103], a[164:167], v[32:35]
 ds_read_b64_tr_b16 a[32:33], v1 offset:32768
 ds_read_b64_tr_b16 a[34:35], v1 offset:33792
M v[36:39], a[108:111], a[164:167], v[36:39]
 buffer_load_dwordx4 v8, s[52:55], s28 offen offset:0   lds
M v[36:39], a[104:107], a[160:163], v[36:39]
 buffer_store_dword v12, v15, s[8:11], s45 offen sc1
M v[40:43], a[112:115], a[160:163], v[40:43]
 s_add_u32 s3, s93, 262144
 ds_read_b64_tr_b16 a[36:37], v1 offset:40960
 ds_read_b64_tr_b16 a[38:39], v1 offset:41984
M v[40:43], a[116:119], a[164:167], v[40:43]
 v_min_u32 v25, 15, v0
 v_lshlrev_b32 v25, 7, v25
M v[44:47], a[124:127], a[164:167], v[44:47]
 v_max_u32 v13, 1024, v25
M v[44:47], a[120:123], a[160:163], v[44:47]
 ds_read_b64_tr_b16 a[40:41], v2 offset:32768
 ds_read_b64_tr_b16 a[42:43], v2 offset:33792
M v[48:51], a[128:131], a[160:163], v[48:51]
 buffer_load_dwordx4 v9, s[52:55], s28 offen offset:1024   lds
M v[48:51], a[132:135], a[164:167], v[48:51]
 buffer_store_dwordx4 v[64:67], v7, s[8:11], s3 offen offset:0 sc1
M v[52:55], a[140:143], a[164:167], v[52:55]
 ds_read_b64_tr_b16 a[44:45], v2 offset:40960
 ds_read_b64_tr_b16 a[46:47], v2 offset:41984
M v[52:55], a[136:139], a[160:163], v[52:55]
M v[56:59], a[144:147], a[160:163], v[56:59]
M v[56:59], a[148:151], a[164:167], v[56:59]
 s_waitcnt lgkmcnt(8)
 ds_read_b64_tr_b16 a[48:49], v3 offset:32768
 ds_read_b64_tr_b16 a[50:51], v3 offset:33792
M v[60:63], a[156:159], a[164:167], v[60:63]
 buffer_load_dwordx4 v10, s[52:55], s28 offen offset:2048   lds
M v[60:63], a[152:155], a[160:163], v[60:63]
M v[68:71], a[96:99], a[168:171], v[68:71]
 ds_read_b128 a[160:163], v5 offset:53248
 ds_read_b128 a[164:167], v6 offset:53248
M v[68:71], a[100:103], a[172:175], v[68:71]
 ds_read_b64_tr_b16 a[52:53], v3 offset:40960
 ds_read_b64_tr_b16 a[54:55], v3 offset:41984
M v[76:79], a[108:111], a[172:175], v[76:79]
 buffer_store_dwordx4 v[72:75], v7, s[8:11], s3 offen offset:1024 sc1
M v[76:79], a[104:107], a[168:171], v[76:79]
 ds_read_b64_tr_b16 a[56:57], v4 offset:32768
 ds_read_b64_tr_b16 a[58:59], v4 offset:33792
M v[84:87], a[112:115], a[168:171], v[84:87]
M v[84:87], a[116:119], a[172:175], v[84:87]
 buffer_load_dwordx4 v11, s[52:55], s28 offen offset:3072   lds
M v[92:95], a[124:127], a[172:175], v[92:95]
 s_add_u32 s28, s28, 524160
 ds_read_b64_tr_b16 a[60:61], v4 offset:40960
 ds_read_b64_tr_b16 a[62:63], v4 offset:41984
M v[92:95], a[120:123], a[168:171], v[92:95]
M v[100:103], a[128:131], a[168:171], v[100:103]
M v[100:103], a[132:135], a[172:175], v[100:103]
M v[108:111], a[140:143], a[172:175], v[108:111]
M v[108:111], a[136:139], a[168:171], v[108:111]
M v[116:119], a[144:147], a[168:171], v[116:119]
M v[116:119], a[148:151], a[172:175], v[116:119]
 s_waitcnt lgkmcnt(6)
M v[124:127], a[156:159], a[172:175], v[124:127]
 s_waitcnt lgkmcnt(0)
M v[124:127], a[152:155], a[168:171], v[124:127]
 s_barrier
M v[132:135], a[96:99], a[160:163], v[132:135]
 ds_read_b128 a[168:171], v5 offset:55296
 ds_read_b128 a[172:175], v6 offset:55296
M v[132:135], a[100:103], a[164:167], v[132:135]
 ds_read_b64_tr_b16 a[64:65], v1 offset:49152
 ds_read_b64_tr_b16 a[66:67], v1 offset:50176
M v[140:143], a[108:111], a[164:167], v[140:143]
 buffer_store_dwordx4 v[80:83], v7, s[8:11], s3 offen offset:2048 sc1
M v[140:143], a[104:107], a[160:163], v[140:143]
M v[148:151], a[112:115], a[160:163], v[148:151]
 ds_read_b64_tr_b16 a[68:69], v1 offset:57344
 ds_read_b64_tr_b16 a[70:71], v1 offset:58368
M v[148:151], a[116:119], a[164:167], v[148:151]
M v[156:159], a[124:127], a[164:167], v[156:159]
M v[156:159], a[120:123], a[160:163], v[156:159]
 ds_read_b64_tr_b16 a[72:73], v2 offset:49152
 ds_read_b64_tr_b16 a[74:75], v2 offset:50176
M v[164:167], a[128:131], a[160:163], v[164:167]
M v[164:167], a[132:135], a[164:167], v[164:167]
M v[172:175], a[140:143], a[164:167], v[172:175]
 ds_read_b64_tr_b16 a[76:77], v2 offset:57344
 ds_read_b64_tr_b16 a[78:79], v2 offset:58368
M v[172:175], a[136:139], a[160:163], v[172:175]
M v[180:183], a[144:147], a[160:163], v[180:183]
M v[180:183], a[148:151], a[164:167], v[180:183]
 s_waitcnt lgkmcnt(8)
 ds_read_b64_tr_b16 a[80:81], v3 offset:49152
 ds_read_b64_tr_b16 a[82:83], v3 offset:50176
M v[188:191], a[156:159], a[164:167], v[188:191]
 buffer_store_dwordx4 v[88:91], v7, s[8:11], s3 offen offset:3072 sc1
M v[188:191], a[152:155], a[160:163], v[188:191]
M v[196:199], a[96:99], a[168:171], v[196:199]
 ds_read_b128 a[160:163], v5 offset:0
 ds_read_b128 a[164:167], v6 offset:0
M v[196:199], a[100:103], a[172:175], v[196:199]
 ds_read_b64_tr_b16 a[84:85], v3 offset:57344
 ds_read_b64_tr_b16 a[86:87], v3 offset:58368
M v[204:207], a[108:111], a[172:175], v[204:207]
M v[204:207], a[104:107], a[168:171], v[204:207]
 ds_read_b64_tr_b16 a[88:89], v4 offset:49152
 ds_read_b64_tr_b16 a[90:91], v4 offset:50176
M v[212:215], a[112:115], a[168:171], v[212:215]
M v[212:215], a[116:119], a[172:175], v[212:215]
M v[220:223], a[124:127], a[172:175], v[220:223]
 ds_read_b64_tr_b16 a[92:93], v4 offset:57344
 ds_read_b64_tr_b16 a[94:95], v4 offset:58368
M v[220:223], a[120:123], a[168:171], v[220:223]
M v[228:231], a[128:131], a[168:171], v[228:231]
M v[228:231], a[132:135], a[172:175], v[228:231]
M v[236:239], a[140:143], a[172:175], v[236:239]
M v[236:239], a[136:139], a[168:171], v[236:239]
M v[244:247], a[144:147], a[168:171], v[244:247]
M v[244:247], a[148:151], a[172:175], v[244:247]
 s_waitcnt lgkmcnt(6)
M v[252:255], a[156:159], a[172:175], v[252:255]
 s_waitcnt vmcnt(21) lgkmcnt(0)
M v[252:255], a[152:155], a[168:171], v[252:255]
 s_barrier
M v[32:35], a[32:35], a[160:163], v[32:35]
 s_add_u32 m0, s23, 32768
 ds_read_b128 a[168:171], v5 offset:2048
 ds_read_b128 a[172:175], v6 offset:2048
M v[32:35], a[36:39], a[164:167], v[32:35]
 ds_read_b64_tr_b16 a[96:97], v20 offset:0
 ds_read_b64_tr_b16 a[98:99], v20 offset:1024
M v[36:39], a[44:47], a[164:167], v[36:39]
 buffer_load_dwordx4 v16, s[56:59], s29 offen offset:0   lds
M v[36:39], a[40:43], a[160:163], v[36:39]
M v[40:43], a[48:51], a[160:163], v[40:43]
 s_add_u32 s3, s93, 270336
 ds_read_b64_tr_b16 a[100:101], v20 offset:8192
 ds_read_b64_tr_b16 a[102:103], v20 offset:9216
M v[40:43], a[52:55], a[164:167], v[40:43]
 buffer_load_dwordx4 v17, s[56:59], s29 offen offset:1024   lds
M v[44:47], a[60:63], a[164:167], v[44:47]
 buffer_store_dwordx4 v[96:99], v7, s[8:11], s3 offen offset:0 sc1
M v[44:47], a[56:59], a[160:163], v[44:47]
 ds_read_b64_tr_b16 a[104:105], v21 offset:0
 ds_read_b64_tr_b16 a[106:107], v21 offset:1024
M v[48:51], a[64:67], a[160:163], v[48:51]
M v[48:51], a[68:71], a[164:167], v[48:51]
 buffer_load_dwordx4 v18, s[56:59], s29 offen offset:2048   lds
M v[52:55], a[76:79], a[164:167], v[52:55]
 ds_read_b64_tr_b16 a[108:109], v21 offset:8192
 ds_read_b64_tr_b16 a[110:111], v21 offset:9216
M v[52:55], a[72:75], a[160:163], v[52:55]
M v[56:59], a[80:83], a[160:163], v[56:59]
M v[56:59], a[84:87], a[164:167], v[56:59]
 s_waitcnt lgkmcnt(8)
 ds_read_b64_tr_b16 a[112:113], v22 offset:0
 ds_read_b64_tr_b16 a[114:115], v22 offset:1024
M v[60:63], a[92:95], a[164:167], v[60:63]
 buffer_load_dwordx4 v19, s[56:59], s29 offen offset:3072   lds
M v[60:63], a[88:91], a[160:163], v[60:63]
 s_add_u32 s29, s29, 128
M v[68:71], a[32:35], a[168:171], v[68:71]
 ds_read_b128 a[160:163], v5 offset:4096
 ds_read_b128 a[164:167], v6 offset:4096
M v[68:71], a[36:39], a[172:175], v[68:71]
 ds_read_b64_tr_b16 a[116:117], v22 offset:8192
 ds_read_b64_tr_b16 a[118:119], v22 offset:9216
M v[76:79], a[44:47], a[172:175], v[76:79]
 s_lshl_b32 s28, s20, 13
 buffer_store_dwordx4 v[104:107], v7, s[8:11], s3 offen offset:1024 sc1
M v[76:79], a[40:43], a[168:171], v[76:79]
 s_lshl_b32 s21, s41, 20
 ds_read_b64_tr_b16 a[120:121], v23 offset:0
 ds_read_b64_tr_b16 a[122:123], v23 offset:1024
M v[84:87], a[48:51], a[168:171], v[84:87]
 s_mov_b32 s22, 0
M v[84:87], a[52:55], a[172:175], v[84:87]
 s_lshl_b32 s7, s41, 18
M v[92:95], a[60:63], a[172:175], v[92:95]
 s_add_u32 s7, s7, 100663296
 ds_read_b64_tr_b16 a[124:125], v23 offset:8192
 ds_read_b64_tr_b16 a[126:127], v23 offset:9216
M v[92:95], a[56:59], a[168:171], v[92:95]
 s_add_u32 s38, s7, 65536
M v[100:103], a[64:67], a[168:171], v[100:103]
 s_add_u32 s64, s42, 1
M v[100:103], a[68:71], a[172:175], v[100:103]
 s_min_u32 s64, s64, 10
M v[108:111], a[76:79], a[172:175], v[108:111]
 s_sub_u32 s27, s64, 3
 buffer_load_dword v24, v13, s[8:11], s46 offen sc1
M v[108:111], a[72:75], a[168:171], v[108:111]
 s_lshl_b32 s6, s64, 1
M v[116:119], a[80:83], a[168:171], v[116:119]
 s_sub_u32 s43, s6, 2
 s_lshl_b32 s64, s42, 16
 s_add_u32 s4, s21, s64
M v[116:119], a[84:87], a[172:175], v[116:119]
 s_waitcnt lgkmcnt(6)
 s_sub_u32 s26, 1114112, s64
 s_add_u32 s26, s26, s21
M v[124:127], a[92:95], a[172:175], v[124:127]
 s_waitcnt vmcnt(20) lgkmcnt(0)
 s_lshl_b32 s64, s42, 1
 s_sub_u32 s64, 32, s64
M v[124:127], a[88:91], a[168:171], v[124:127]
 s_barrier
M v[132:135], a[32:35], a[160:163], v[132:135]
 s_cmp_ge_u32 s42, 10
 ds_read_b128 a[168:171], v5 offset:6144
 ds_read_b128 a[172:175], v6 offset:6144
M v[132:135], a[36:39], a[164:167], v[132:135]
 s_cselect_b32 s25, s64, 32767
 ds_read_b64_tr_b16 a[128:129], v20 offset:16384
 ds_read_b64_tr_b16 a[130:131], v20 offset:17408
M v[140:143], a[44:47], a[164:167], v[140:143]
 s_mov_b32 s23, 0
 buffer_store_dwordx4 v[112:115], v7, s[8:11], s3 offen offset:2048 sc1
M v[140:143], a[40:43], a[160:163], v[140:143]
M v[148:151], a[48:51], a[160:163], v[148:151]
 ds_read_b64_tr_b16 a[132:133], v20 offset:24576
 ds_read_b64_tr_b16 a[134:135], v20 offset:25600
M v[148:151], a[52:55], a[164:167], v[148:151]
M v[156:159], a[60:63], a[164:167], v[156:159]
M v[156:159], a[56:59], a[160:163], v[156:159]
 ds_read_b64_tr_b16 a[136:137], v21 offset:16384
 ds_read_b64_tr_b16 a[138:139], v21 offset:17408
M v[164:167], a[64:67], a[160:163], v[164:167]
M v[164:167], a[68:71], a[164:167], v[164:167]
M v[172:175], a[76:79], a[164:167], v[172:175]
 ds_read_b64_tr_b16 a[140:141], v21 offset:24576
 ds_read_b64_tr_b16 a[142:143], v21 offset:25600
M v[172:175], a[72:75], a[160:163], v[172:175]
M v[180:183], a[80:83], a[160:163], v[180:183]
M v[180:183], a[84:87], a[164:167], v[180:183]
 s_waitcnt lgkmcnt(8)
 ds_read_b64_tr_b16 a[144:145], v22 offset:16384
 ds_read_b64_tr_b16 a[146:147], v22 offset:17408
M v[188:191], a[92:95], a[164:167], v[188:191]
 buffer_store_dwordx4 v[120:123], v7, s[8:11], s3 offen offset:3072 sc1
M v[188:191], a[88:91], a[160:163], v[188:191]
M v[196:199], a[32:35], a[168:171], v[196:199]
 ds_read_b128 a[160:163], v5 offset:16384
 ds_read_b128 a[164:167], v6 offset:16384
M v[196:199], a[36:39], a[172:175], v[196:199]
 ds_read_b64_tr_b16 a[148:149], v22 offset:24576
 ds_read_b64_tr_b16 a[150:151], v22 offset:25600
M v[204:207], a[44:47], a[172:175], v[204:207]
M v[204:207], a[40:43], a[168:171], v[204:207]
 ds_read_b64_tr_b16 a[152:153], v23 offset:16384
 ds_read_b64_tr_b16 a[154:155], v23 offset:17408
M v[212:215], a[48:51], a[168:171], v[212:215]
M v[212:215], a[52:55], a[172:175], v[212:215]
M v[220:223], a[60:63], a[172:175], v[220:223]
 ds_read_b64_tr_b16 a[156:157], v23 offset:24576
 ds_read_b64_tr_b16 a[158:159], v23 offset:25600
M v[220:223], a[56:59], a[168:171], v[220:223]
M v[228:231], a[64:67], a[168:171], v[228:231]
M v[228:231], a[68:71], a[172:175], v[228:231]
M v[236:239], a[76:79], a[172:175], v[236:239]
M v[236:239], a[72:75], a[168:171], v[236:239]
M v[244:247], a[80:83], a[168:171], v[244:247]
M v[244:247], a[84:87], a[172:175], v[244:247]
 s_waitcnt lgkmcnt(6)
M v[252:255], a[92:95], a[172:175], v[252:255]
 s_waitcnt vmcnt(18) lgkmcnt(0)
M v[252:255], a[88:91], a[168:171], v[252:255]
 s_barrier
M v[32:35], a[96:99], a[160:163], v[32:35]
 ds_read_b128 a[168:171], v5 offset:18432
 ds_read_b128 a[172:175], v6 offset:18432
M v[32:35], a[100:103], a[164:167], v[32:35]
 ds_read_b64_tr_b16 a[32:33], v1 offset:0
 ds_read_b64_tr_b16 a[34:35], v1 offset:1024
M v[36:39], a[108:111], a[164:167], v[36:39]
 v_add_u32 v10, s28, v7
 v_add_u32 v11, 0x1000, v10
M v[36:39], a[104:107], a[160:163], v[36:39]
 s_waitcnt vmcnt(2)
 v_cmp_eq_u32 vcc, 0, v24
 s_add_u32 s3, s93, 524288
M v[40:43], a[112:115], a[160:163], v[40:43]
 s_lshl_b32 s64, s20, 10
 ds_read_b64_tr_b16 a[36:37], v1 offset:8192
 ds_read_b64_tr_b16 a[38:39], v1 offset:9216
M v[40:43], a[116:119], a[164:167], v[40:43]
 s_cbranch_vccnz L_f1s14
L_f1r14:
M v[44:47], a[124:127], a[164:167], v[44:47]
 s_add_u32 m0, s28, 98304
 s_nop 0
 buffer_load_dwordx4 v10, s[8:11], s21 offen offset:0 sc1 lds
M v[44:47], a[120:123], a[160:163], v[44:47]
 ds_read_b64_tr_b16 a[40:41], v2 offset:0
 ds_read_b64_tr_b16 a[42:43], v2 offset:1024
M v[48:51], a[128:131], a[160:163], v[48:51]
 buffer_store_dwordx4 v[128:131], v7, s[8:11], s3 offen offset:0 sc1
M v[48:51], a[132:135], a[164:167], v[48:51]
M v[52:55], a[140:143], a[164:167], v[52:55]
 ds_read_b64_tr_b16 a[44:45], v2 offset:8192
 ds_read_b64_tr_b16 a[46:47], v2 offset:9216
M v[52:55], a[136:139], a[160:163], v[52:55]
 buffer_load_dwordx4 v10, s[8:11], s21 offen offset:1024 sc1 lds
M v[56:59], a[144:147], a[160:163], v[56:59]
M v[56:59], a[148:151], a[164:167], v[56:59]
 s_waitcnt lgkmcnt(8)
 ds_read_b64_tr_b16 a[48:49], v3 offset:0
 ds_read_b64_tr_b16 a[50:51], v3 offset:1024
M v[60:63], a[156:159], a[164:167], v[60:63]
M v[60:63], a[152:155], a[160:163], v[60:63]
 buffer_load_dwordx4 v10, s[8:11], s21 offen offset:2048 sc1 lds
M v[68:71], a[96:99], a[168:171], v[68:71]
 ds_read_b128 a[160:163], v5 offset:20480
 ds_read_b128 a[164:167], v6 offset:20480
M v[68:71], a[100:103], a[172:175], v[68:71]
 ds_read_b64_tr_b16 a[52:53], v3 offset:8192
 ds_read_b64_tr_b16 a[54:55], v3 offset:9216
M v[76:79], a[108:111], a[172:175], v[76:79]
 buffer_store_dwordx4 v[136:139], v7, s[8:11], s3 offen offset:1024 sc1
M v[76:79], a[104:107], a[168:171], v[76:79]
 ds_read_b64_tr_b16 a[56:57], v4 offset:0
 ds_read_b64_tr_b16 a[58:59], v4 offset:1024
M v[84:87], a[112:115], a[168:171], v[84:87]
 buffer_load_dwordx4 v10, s[8:11], s21 offen offset:3072 sc1 lds
M v[84:87], a[116:119], a[172:175], v[84:87]
 s_add_u32 m0, s28, 102400
M v[92:95], a[124:127], a[172:175], v[92:95]
 ds_read_b64_tr_b16 a[60:61], v4 offset:8192
 ds_read_b64_tr_b16 a[62:63], v4 offset:9216
M v[92:95], a[120:123], a[168:171], v[92:95]
M v[100:103], a[128:131], a[168:171], v[100:103]
 buffer_load_dwordx4 v11, s[8:11], s21 offen offset:0 sc1 lds
M v[100:103], a[132:135], a[172:175], v[100:103]
M v[108:111], a[140:143], a[172:175], v[108:111]
M v[108:111], a[136:139], a[168:171], v[108:111]
M v[116:119], a[144:147], a[168:171], v[116:119]
 buffer_load_dwordx4 v11, s[8:11], s21 offen offset:1024 sc1 lds
M v[116:119], a[148:151], a[172:175], v[116:119]
 s_waitcnt lgkmcnt(6)
M v[124:127], a[156:159], a[172:175], v[124:127]
 s_waitcnt lgkmcnt(0)
 buffer_load_dwordx4 v11, s[8:11], s21 offen offset:2048 sc1 lds
M v[124:127], a[152:155], a[168:171], v[124:127]
 s_barrier
M v[132:135], a[96:99], a[160:163], v[132:135]
 ds_read_b128 a[168:171], v5 offset:22528
 ds_read_b128 a[172:175], v6 offset:22528
M v[132:135], a[100:103], a[164:167], v[132:135]
 ds_read_b64_tr_b16 a[64:65], v1 offset:16384
 ds_read_b64_tr_b16 a[66:67], v1 offset:17408
M v[140:143], a[108:111], a[164:167], v[140:143]
 buffer_load_dwordx4 v11, s[8:11], s21 offen offset:3072 sc1 lds
M v[140:143], a[104:107], a[160:163], v[140:143]
 s_add_u32 s24, s23, 16777216
 buffer_store_dwordx4 v[144:147], v7, s[8:11], s3 offen offset:2048 sc1
M v[148:151], a[112:115], a[160:163], v[148:151]
 s_mov_b32 s23, s21
 ds_read_b64_tr_b16 a[68:69], v1 offset:24576
 ds_read_b64_tr_b16 a[70:71], v1 offset:25600
M v[148:151], a[116:119], a[164:167], v[148:151]
 s_add_u32 s21, s21, 32768
M v[156:159], a[124:127], a[164:167], v[156:159]
 s_add_u32 s22, s22, 1
M v[156:159], a[120:123], a[160:163], v[156:159]
 s_cmp_eq_u32 s22, s25
 ds_read_b64_tr_b16 a[72:73], v2 offset:16384
 ds_read_b64_tr_b16 a[74:75], v2 offset:17408
M v[164:167], a[128:131], a[160:163], v[164:167]
 s_cselect_b32 s21, s26, s21
 v_subrev_u32 v5, 0x10000, v5
 v_subrev_u32 v6, 0x10000, v6
M v[164:167], a[132:135], a[164:167], v[164:167]
 s_cmp_eq_u32 s22, s43
M v[172:175], a[140:143], a[164:167], v[172:175]
 s_cselect_b32 s21, s4, s21
 ds_read_b64_tr_b16 a[76:77], v2 offset:24576
 ds_read_b64_tr_b16 a[78:79], v2 offset:25600
M v[172:175], a[136:139], a[160:163], v[172:175]
 s_cmp_eq_u32 s22, s6
M v[180:183], a[144:147], a[160:163], v[180:183]
 s_cselect_b32 s21, s7, s21
 v_mov_b32 v9, v25
 v_lshrrev_b32 v24, 4, v0
M v[180:183], a[148:151], a[164:167], v[180:183]
 s_waitcnt lgkmcnt(8)
 ds_read_b64_tr_b16 a[80:81], v3 offset:16384
 ds_read_b64_tr_b16 a[82:83], v3 offset:17408
M v[188:191], a[156:159], a[164:167], v[188:191]
 v_lshlrev_b32 v24, 2, v24
 v_and_b32 v25, 15, v0
M v[188:191], a[152:155], a[160:163], v[188:191]
 v_sub_u32 v24, v24, v25
M v[196:199], a[96:99], a[168:171], v[196:199]
 s_add_u32 s64, s64, s34
 ds_read_b128 a[160:163], v5 offset:32768
 ds_read_b128 a[164:167], v6 offset:32768
M v[196:199], a[100:103], a[172:175], v[196:199]
 s_add_u32 s52, s64, 65536
 ds_read_b64_tr_b16 a[84:85], v3 offset:24576
 ds_read_b64_tr_b16 a[86:87], v3 offset:25600
M v[204:207], a[108:111], a[172:175], v[204:207]
 s_mov_b32 s55, 0x21800000
 buffer_store_dwordx4 v[152:155], v7, s[8:11], s3 offen offset:3072 sc1
M v[204:207], a[104:107], a[168:171], v[204:207]
 s_and_b32 s65, s39, 0xf000000
 ds_read_b64_tr_b16 a[88:89], v4 offset:16384
 ds_read_b64_tr_b16 a[90:91], v4 offset:17408
M v[212:215], a[112:115], a[168:171], v[212:215]
 s_cmp_eq_u32 s20, 0
M v[212:215], a[116:119], a[172:175], v[212:215]
 s_cselect_b32 s54, s39, s65
M v[220:223], a[124:127], a[172:175], v[220:223]
 s_lshr_b32 s64, s20, 1
 ds_read_b64_tr_b16 a[92:93], v4 offset:24576
 ds_read_b64_tr_b16 a[94:95], v4 offset:25600
M v[220:223], a[120:123], a[168:171], v[220:223]
 s_lshl_b32 s64, s64, 17
M v[228:231], a[128:131], a[168:171], v[228:231]
 s_and_b32 s65, s20, 1
M v[228:231], a[132:135], a[172:175], v[228:231]
 s_lshl_b32 s65, s65, 12
M v[236:239], a[140:143], a[172:175], v[236:239]
 s_add_u32 s64, s64, s65
 v_add_u32 v14, s64, v7
 v_mov_b32 v8, 0xff800000
M v[236:239], a[136:139], a[168:171], v[236:239]
 v_cmp_lt_i32 s[16:17], 0, v24
 v_cmp_lt_i32 s[18:19], -1, v24
M v[244:247], a[144:147], a[168:171], v[244:247]
 v_cmp_lt_i32 s[48:49], -2, v24
 v_cmp_lt_i32 s[50:51], -3, v24
M v[244:247], a[148:151], a[172:175], v[244:247]
 s_waitcnt lgkmcnt(6)
M v[252:255], a[156:159], a[172:175], v[252:255]
 s_waitcnt lgkmcnt(0)
M v[252:255], a[152:155], a[168:171], v[252:255]
 s_barrier
M v[32:35], a[32:35], a[160:163], v[32:35]
 ds_read_b128 a[168:171], v5 offset:34816
 ds_read_b128 a[172:175], v6 offset:34816
M v[32:35], a[36:39], a[164:167], v[32:35]
 buffer_load_dword v24, v9, s[8:11], s46 offen sc1
M v[36:39], a[44:47], a[164:167], v[36:39]
 v_mov_b32 v1, v15
 v_add_u32 v2, 0x10000, v7
M v[36:39], a[40:43], a[160:163], v[36:39]
 v_mov_b32 v3, v10
 v_mov_b32 v4, v11
M v[40:43], a[48:51], a[160:163], v[40:43]
 s_mov_b64 s[60:61], s[76:77]
M v[40:43], a[52:55], a[164:167], v[40:43]
 s_mov_b32 s62, s78
M v[44:47], a[60:63], a[164:167], v[44:47]
 s_mov_b32 s63, 0x20000
 v_lshl_add_u32 v10, v0, 7, s95
 v_and_b32 v0, 48, v0
M v[44:47], a[56:59], a[160:163], v[44:47]
 v_lshl_add_u32 v0, v0, 24, v10
 v_mul_f32 v32, s5, v32
M v[48:51], a[64:67], a[160:163], v[48:51]
 v_mul_f32 v33, s5, v33
 v_mul_f32 v34, s5, v34
M v[48:51], a[68:71], a[164:167], v[48:51]
 v_mul_f32 v35, s5, v35
 v_mul_f32 v36, s5, v36
M v[52:55], a[76:79], a[164:167], v[52:55]
 v_mul_f32 v37, s5, v37
 v_mul_f32 v38, s5, v38
M v[52:55], a[72:75], a[160:163], v[52:55]
 v_mul_f32 v39, s5, v39
 v_cvt_pk_bf16_f32 v32, v32, v33
M v[56:59], a[80:83], a[160:163], v[56:59]
 v_cvt_pk_bf16_f32 v33, v34, v35
 v_cvt_pk_bf16_f32 v34, v36, v37
M v[56:59], a[84:87], a[164:167], v[56:59]
 s_waitcnt lgkmcnt(0)
 v_cvt_pk_bf16_f32 v35, v38, v39
 ds_write_b128 v14, v[32:35] offset:0
M v[60:63], a[92:95], a[164:167], v[60:63]
 s_add_u32 s3, s93, 532480
 buffer_store_dwordx4 v[160:163], v7, s[8:11], s3 offen offset:0 sc1
M v[60:63], a[88:91], a[160:163], v[60:63]
 v_mul_f32 v40, s5, v40
 v_mul_f32 v41, s5, v41
M v[68:71], a[32:35], a[168:171], v[68:71]
 ds_read_b128 a[160:163], v5 offset:36864
 ds_read_b128 a[164:167], v6 offset:36864
M v[68:71], a[36:39], a[172:175], v[68:71]
 v_mul_f32 v42, s5, v42
 v_mul_f32 v43, s5, v43
M v[76:79], a[44:47], a[172:175], v[76:79]
 v_mul_f32 v44, s5, v44
 v_mul_f32 v45, s5, v45
M v[76:79], a[40:43], a[168:171], v[76:79]
 v_mul_f32 v46, s5, v46
 v_mul_f32 v47, s5, v47
M v[84:87], a[48:51], a[168:171], v[84:87]
 v_cvt_pk_bf16_f32 v40, v40, v41
 v_cvt_pk_bf16_f32 v41, v42, v43
M v[84:87], a[52:55], a[172:175], v[84:87]
 v_cvt_pk_bf16_f32 v42, v44, v45
 v_cvt_pk_bf16_f32 v43, v46, v47
M v[92:95], a[60:63], a[172:175], v[92:95]
 ds_write_b128 v14, v[40:43] offset:1024
M v[92:95], a[56:59], a[168:171], v[92:95]
 buffer_store_dwordx4 v[168:171], v7, s[8:11], s3 offen offset:1024 sc1
M v[100:103], a[64:67], a[168:171], v[100:103]
 v_mul_f32 v48, s5, v48
 v_mul_f32 v49, s5, v49
M v[100:103], a[68:71], a[172:175], v[100:103]
 v_mul_f32 v50, s5, v50
 v_mul_f32 v51, s5, v51
M v[108:111], a[76:79], a[172:175], v[108:111]
 v_mul_f32 v52, s5, v52
 v_mul_f32 v53, s5, v53
M v[108:111], a[72:75], a[168:171], v[108:111]
 v_mul_f32 v54, s5, v54
 v_mul_f32 v55, s5, v55
M v[116:119], a[80:83], a[168:171], v[116:119]
 v_cvt_pk_bf16_f32 v48, v48, v49
 v_cvt_pk_bf16_f32 v49, v50, v51
M v[116:119], a[84:87], a[172:175], v[116:119]
 s_waitcnt lgkmcnt(1)
 v_cvt_pk_bf16_f32 v50, v52, v53
 v_cvt_pk_bf16_f32 v51, v54, v55
M v[124:127], a[92:95], a[172:175], v[124:127]
 ds_write_b128 v14, v[48:51] offset:2048
M v[124:127], a[88:91], a[168:171], v[124:127]
 buffer_store_dwordx4 v[176:179], v7, s[8:11], s3 offen offset:2048 sc1
M v[132:135], a[32:35], a[160:163], v[132:135]
 ds_read_b128 a[168:171], v5 offset:38912
 ds_read_b128 a[172:175], v6 offset:38912
M v[132:135], a[36:39], a[164:167], v[132:135]
 v_mul_f32 v56, s5, v56
 v_mul_f32 v57, s5, v57
M v[140:143], a[44:47], a[164:167], v[140:143]
 v_mul_f32 v58, s5, v58
 v_mul_f32 v59, s5, v59
M v[140:143], a[40:43], a[160:163], v[140:143]
 v_mul_f32 v60, s5, v60
 v_mul_f32 v61, s5, v61
M v[148:151], a[48:51], a[160:163], v[148:151]
 v_mul_f32 v62, s5, v62
 v_mul_f32 v63, s5, v63
M v[148:151], a[52:55], a[164:167], v[148:151]
 v_cvt_pk_bf16_f32 v56, v56, v57
 v_cvt_pk_bf16_f32 v57, v58, v59
M v[156:159], a[60:63], a[164:167], v[156:159]
 v_cvt_pk_bf16_f32 v58, v60, v61
 v_cvt_pk_bf16_f32 v59, v62, v63
M v[156:159], a[56:59], a[160:163], v[156:159]
 s_waitcnt lgkmcnt(0)
 ds_write_b128 v14, v[56:59] offset:3072
M v[164:167], a[64:67], a[160:163], v[164:167]
 s_barrier
M v[164:167], a[68:71], a[164:167], v[164:167]
M v[172:175], a[76:79], a[164:167], v[172:175]
 s_add_u32 m0, s28, 32768
 s_nop 0
 buffer_load_dwordx4 v3, s[8:11], s21 offen offset:0 sc1 lds
M v[172:175], a[72:75], a[160:163], v[172:175]
M v[180:183], a[80:83], a[160:163], v[180:183]
 buffer_store_dwordx4 v[184:187], v7, s[8:11], s3 offen offset:3072 sc1
M v[180:183], a[84:87], a[164:167], v[180:183]
 v_mul_f32 v68, s5, v68
 v_mul_f32 v69, s5, v69
M v[188:191], a[92:95], a[164:167], v[188:191]
 buffer_load_dwordx4 v3, s[8:11], s21 offen offset:1024 sc1 lds
M v[188:191], a[88:91], a[160:163], v[188:191]
 v_mul_f32 v70, s5, v70
 v_mul_f32 v71, s5, v71
M v[196:199], a[32:35], a[168:171], v[196:199]
 v_mul_f32 v76, s5, v76
 v_mul_f32 v77, s5, v77
M v[196:199], a[36:39], a[172:175], v[196:199]
 v_mul_f32 v78, s5, v78
 v_mul_f32 v79, s5, v79
M v[204:207], a[44:47], a[172:175], v[204:207]
 buffer_load_dwordx4 v3, s[8:11], s21 offen offset:2048 sc1 lds
M v[204:207], a[40:43], a[168:171], v[204:207]
 v_cvt_pk_bf16_f32 v68, v68, v69
 v_cvt_pk_bf16_f32 v69, v70, v71
M v[212:215], a[48:51], a[168:171], v[212:215]
 v_cvt_pk_bf16_f32 v70, v76, v77
 v_cvt_pk_bf16_f32 v71, v78, v79
M v[212:215], a[52:55], a[172:175], v[212:215]
 ds_write_b128 v14, v[68:71] offset:8192
 v_mul_f32 v84, s5, v84
M v[220:223], a[60:63], a[172:175], v[220:223]
 buffer_load_dwordx4 v3, s[8:11], s21 offen offset:3072 sc1 lds
M v[220:223], a[56:59], a[168:171], v[220:223]
 s_add_u32 m0, s28, 36864
 v_mul_f32 v85, s5, v85
 v_mul_f32 v86, s5, v86
M v[228:231], a[64:67], a[168:171], v[228:231]
 v_mul_f32 v87, s5, v87
 v_mul_f32 v92, s5, v92
M v[228:231], a[68:71], a[172:175], v[228:231]
 v_mul_f32 v93, s5, v93
 v_mul_f32 v94, s5, v94
M v[236:239], a[76:79], a[172:175], v[236:239]
 buffer_load_dwordx4 v4, s[8:11], s21 offen offset:0 sc1 lds
M v[236:239], a[72:75], a[168:171], v[236:239]
 v_mul_f32 v95, s5, v95
 v_cvt_pk_bf16_f32 v84, v84, v85
M v[244:247], a[80:83], a[168:171], v[244:247]
 v_cvt_pk_bf16_f32 v85, v86, v87
 v_cvt_pk_bf16_f32 v86, v92, v93
M v[244:247], a[84:87], a[172:175], v[244:247]
 v_cvt_pk_bf16_f32 v87, v94, v95
 ds_write_b128 v14, v[84:87] offset:9216
M v[252:255], a[92:95], a[172:175], v[252:255]
 buffer_load_dwordx4 v4, s[8:11], s21 offen offset:1024 sc1 lds
M v[252:255], a[88:91], a[168:171], v[252:255]
 buffer_load_dwordx4 v4, s[8:11], s21 offen offset:2048 sc1 lds
 buffer_load_dwordx4 v4, s[8:11], s21 offen offset:3072 sc1 lds
 s_add_u32 s24, s23, 16777216
 s_mov_b32 s23, s21
 s_add_u32 s21, s21, 32768
 s_add_u32 s22, s22, 1
 s_cmp_eq_u32 s22, s25
 s_cselect_b32 s21, s26, s21
 s_cmp_eq_u32 s22, s43
 s_cselect_b32 s21, s4, s21
 s_cmp_eq_u32 s22, s6
 s_cselect_b32 s21, s7, s21
 v_mul_f32 v100, s5, v100
 v_mul_f32 v101, s5, v101
 v_mul_f32 v102, s5, v102
 v_mul_f32 v103, s5, v103
 v_mul_f32 v108, s5, v108
 v_mul_f32 v109, s5, v109
 v_mul_f32 v110, s5, v110
 v_mul_f32 v111, s5, v111
 v_cvt_pk_bf16_f32 v100, v100, v101
 v_cvt_pk_bf16_f32 v101, v102, v103
 v_cvt_pk_bf16_f32 v102, v108, v109
 v_cvt_pk_bf16_f32 v103, v110, v111
 ds_write_b128 v14, v[100:103] offset:10240
 v_pk_mul_f32 v[116:117], v[116:117], s[4:5] op_sel:[0,1] op_sel_hi:[1,1]
 v_pk_mul_f32 v[118:119], v[118:119], s[4:5] op_sel:[0,1] op_sel_hi:[1,1]
 v_pk_mul_f32 v[124:125], v[124:125], s[4:5] op_sel:[0,1] op_sel_hi:[1,1]
 v_pk_mul_f32 v[126:127], v[126:127], s[4:5] op_sel:[0,1] op_sel_hi:[1,1]
 v_cvt_pk_bf16_f32 v116, v116, v117
 v_cvt_pk_bf16_f32 v117, v118, v119
 v_cvt_pk_bf16_f32 v118, v124, v125
 v_cvt_pk_bf16_f32 v119, v126, v127
 ds_write_b128 v14, v[116:119] offset:11264
 v_pk_mul_f32 v[132:133], v[132:133], s[4:5] op_sel:[0,1] op_sel_hi:[1,1]
 v_pk_mul_f32 v[134:135], v[134:135], s[4:5] op_sel:[0,1] op_sel_hi:[1,1]
 v_pk_mul_f32 v[140:141], v[140:141], s[4:5] op_sel:[0,1] op_sel_hi:[1,1]
 v_pk_mul_f32 v[142:143], v[142:143], s[4:5] op_sel:[0,1] op_sel_hi:[1,1]
 v_cvt_pk_bf16_f32 v132, v132, v133
 v_cvt_pk_bf16_f32 v133, v134, v135
 v_cvt_pk_bf16_f32 v134, v140, v141
 v_cvt_pk_bf16_f32 v135, v142, v143
 ds_write_b128 v14, v[132:135] offset:16384
 v_pk_mul_f32 v[148:149], v[148:149], s[4:5] op_sel:[0,1] op_sel_hi:[1,1]
 v_pk_mul_f32 v[150:151], v[150:151], s[4:5] op_sel:[0,1] op_sel_hi:[1,1]
 v_pk_mul_f32 v[156:157], v[156:157], s[4:5] op_sel:[0,1] op_sel_hi:[1,1]
 v_pk_mul_f32 v[158:159], v[158:159], s[4:5] op_sel:[0,1] op_sel_hi:[1,1]
 v_cvt_pk_bf16_f32 v148, v148, v149
 v_cvt_pk_bf16_f32 v149, v150, v151
 v_cvt_pk_bf16_f32 v150, v156, v157
 v_cvt_pk_bf16_f32 v151, v158, v159
 ds_write_b128 v14, v[148:151] offset:17408
 v_pk_mul_f32 v[164:165], v[164:165], s[4:5] op_sel:[0,1] op_sel_hi:[1,1]
 v_pk_mul_f32 v[166:167], v[166:167], s[4:5] op_sel:[0,1] op_sel_hi:[1,1]
 v_pk_mul_f32 v[172:173], v[172:173], s[4:5] op_sel:[0,1] op_sel_hi:[1,1]
 v_pk_mul_f32 v[174:175], v[174:175], s[4:5] op_sel:[0,1] op_sel_hi:[1,1]
 v_cvt_pk_bf16_f32 v164, v164, v165
 v_cvt_pk_bf16_f32 v165, v166, v167
 v_cvt_pk_bf16_f32 v166, v172, v173
 v_cvt_pk_bf16_f32 v167, v174, v175
 ds_write_b128 v14, v[164:167] offset:18432
 v_pk_mul_f32 v[180:181], v[180:181], s[4:5] op_sel:[0,1] op_sel_hi:[1,1]
 v_pk_mul_f32 v[182:183], v[182:183], s[4:5] op_sel:[0,1] op_sel_hi:[1,1]
 v_pk_mul_f32 v[188:189], v[188:189], s[4:5] op_sel:[0,1] op_sel_hi:[1,1]
 v_pk_mul_f32 v[190:191], v[190:191], s[4:5] op_sel:[0,1] op_sel_hi:[1,1]
 v_cvt_pk_bf16_f32 v180, v180, v181
 v_cvt_pk_bf16_f32 v181, v182, v183
 v_cvt_pk_bf16_f32 v182, v188, v189
 v_cvt_pk_bf16_f32 v183, v190, v191
 ds_write_b128 v14, v[180:183] offset:19456
 v_pk_mul_f32 v[196:197], v[196:197], s[4:5] op_sel:[0,1] op_sel_hi:[1,1]
 v_pk_mul_f32 v[198:199], v[198:199], s[4:5] op_sel:[0,1] op_sel_hi:[1,1]
 v_pk_mul_f32 v[204:205], v[204:205], s[4:5] op_sel:[0,1] op_sel_hi:[1,1]
 v_pk_mul_f32 v[206:207], v[206:207], s[4:5] op_sel:[0,1] op_sel_hi:[1,1]
 v_cvt_pk_bf16_f32 v196, v196, v197
 v_cvt_pk_bf16_f32 v197, v198, v199
 v_cvt_pk_bf16_f32 v198, v204, v205
 v_cvt_pk_bf16_f32 v199, v206, v207
 ds_write_b128 v14, v[196:199] offset:24576
 v_pk_mul_f32 v[212:213], v[212:213], s[4:5] op_sel:[0,1] op_sel_hi:[1,1]
 v_pk_mul_f32 v[214:215], v[214:215], s[4:5] op_sel:[0,1] op_sel_hi:[1,1]
 v_pk_mul_f32 v[220:221], v[220:221], s[4:5] op_sel:[0,1] op_sel_hi:[1,1]
 v_pk_mul_f32 v[222:223], v[222:223], s[4:5] op_sel:[0,1] op_sel_hi:[1,1]
 v_cvt_pk_bf16_f32 v212, v212, v213
 v_cvt_pk_bf16_f32 v213, v214, v215
 v_cvt_pk_bf16_f32 v214, v220, v221
 v_cvt_pk_bf16_f32 v215, v222, v223
 ds_write_b128 v14, v[212:215] offset:25600
 v_pk_mul_f32 v[228:229], v[228:229], s[4:5] op_sel:[0,1] op_sel_hi:[1,1]
 v_pk_mul_f32 v[230:231], v[230:231], s[4:5] op_sel:[0,1] op_sel_hi:[1,1]
 v_pk_mul_f32 v[236:237], v[236:237], s[4:5] op_sel:[0,1] op_sel_hi:[1,1]
 v_pk_mul_f32 v[238:239], v[238:239], s[4:5] op_sel:[0,1] op_sel_hi:[1,1]
 v_cvt_pk_bf16_f32 v228, v228, v229
 v_cvt_pk_bf16_f32 v229, v230, v231
 v_cvt_pk_bf16_f32 v230, v236, v237
 v_cvt_pk_bf16_f32 v231, v238, v239
 ds_write_b128 v14, v[228:231] offset:26624
 v_pk_mul_f32 v[244:245], v[244:245], s[4:5] op_sel:[0,1] op_sel_hi:[1,1]
 v_pk_mul_f32 v[246:247], v[246:247], s[4:5] op_sel:[0,1] op_sel_hi:[1,1]
 v_pk_mul_f32 v[252:253], v[252:253], s[4:5] op_sel:[0,1] op_sel_hi:[1,1]
 v_pk_mul_f32 v[254:255], v[254:255], s[4:5] op_sel:[0,1] op_sel_hi:[1,1]
 v_cvt_pk_bf16_f32 v244, v244, v245
 v_cvt_pk_bf16_f32 v245, v246, v247
 v_cvt_pk_bf16_f32 v246, v252, v253
 v_cvt_pk_bf16_f32 v247, v254, v255
 ds_write_b128 v14, v[244:247] offset:27648
 s_waitcnt vmcnt(15) lgkmcnt(0)
 s_barrier
 ds_read_b128 a[64:67], v2 offset:32768
 ds_read_b128 a[68:71], v2 offset:33792
 ds_read_b128 a[72:75], v2 offset:34816
 ds_read_b128 a[76:79], v2 offset:35840
 ds_read_b128 a[80:83], v2 offset:36864
 ds_read_b128 a[84:87], v2 offset:37888
 ds_read_b128 a[88:91], v2 offset:38912
 ds_read_b128 a[92:95], v2 offset:39936
 s_lshl_b32 s64, s20, 13
 s_sub_u32 s65, 155648, s64
 v_add_u32 v10, s64, v7
 v_add_u32 v11, s65, v7
 ds_read_b128 a[0:3], v10 offset:0
 ds_read_b128 a[4:7], v10 offset:1024
 ds_read_b128 a[8:11], v10 offset:2048
 ds_read_b128 a[12:15], v10 offset:3072
 ds_read_b128 a[16:19], v10 offset:4096
 ds_read_b128 a[20:23], v10 offset:5120
 ds_read_b128 a[24:27], v10 offset:6144
 ds_read_b128 a[28:31], v10 offset:7168
 ds_read_b128 a[32:35], v11 offset:0
 ds_read_b128 a[36:39], v11 offset:1024
 ds_read_b128 a[40:43], v11 offset:2048
 ds_read_b128 a[44:47], v11 offset:3072
 ds_read_b128 a[48:51], v11 offset:4096
 ds_read_b128 a[52:55], v11 offset:5120
 ds_read_b128 a[56:59], v11 offset:6144
 ds_read_b128 a[60:63], v11 offset:7168
 s_waitcnt vmcnt(12)
 v_cmp_eq_u32 vcc, 0, v24
 v_mov_b32 v17, 3
 v_or_b32 v6, s35, v7
 s_cbranch_vccnz L_f1s15
L_f1r15:
 s_mov_b32 s30, s93
 s_mov_b32 s29, s94
 s_cmp_eq_u32 s20, 0
 s_cselect_b32 s5, 5, 0
 v_mov_b32 v32, 0xc1800000
 v_mov_b32 v33, 0xc1800000
 v_mov_b32 v34, 0xc1800000
 v_mov_b32 v35, 0xc1800000
 v_mov_b32 v36, 0xc1800000
 v_mov_b32 v37, 0xc1800000
 v_mov_b32 v38, 0xc1800000
 v_mov_b32 v39, 0xc1800000
 s_waitcnt lgkmcnt(0)
M v[64:67], a[64:67], a[0:3], v[32:35]
 ds_read_b128 a[96:99], v2 offset:40960
 v_mov_b32 v30, 0
M v[64:67], a[68:71], a[4:7], v[64:67]
 s_add_u32 m0, s28, 65536
 ds_read_b128 a[100:103], v2 offset:41984
 v_mov_b32 v31, 0
M v[64:67], a[72:75], a[8:11], v[64:67]
 buffer_load_dwordx4 v3, s[8:11], s24 offen offset:0 sc1 lds
M v[64:67], a[76:79], a[12:15], v[64:67]
 ds_read_b128 a[104:107], v2 offset:43008
 v_accvgpr_write_b32 a128, v192
M v[64:67], a[80:83], a[16:19], v[64:67]
 ds_read_b128 a[108:111], v2 offset:44032
 v_accvgpr_write_b32 a129, v193
M v[64:67], a[84:87], a[20:23], v[64:67]
 buffer_load_dwordx4 v3, s[8:11], s24 offen offset:1024 sc1 lds
M v[64:67], a[88:91], a[24:27], v[64:67]
 ds_read_b128 a[112:115], v2 offset:45056
 v_accvgpr_write_b32 a130, v194
M v[64:67], a[92:95], a[28:31], v[64:67]
 ds_read_b128 a[116:119], v2 offset:46080
 v_accvgpr_write_b32 a131, v195
M v[68:71], a[92:95], a[60:63], v[36:39]
 v_accvgpr_write_b32 a132, v200
 v_accvgpr_write_b32 a133, v201
M v[68:71], a[88:91], a[56:59], v[68:71]
 ds_read_b128 a[120:123], v2 offset:47104
 v_accvgpr_write_b32 a134, v202
M v[68:71], a[84:87], a[52:55], v[68:71]
 ds_read_b128 a[124:127], v2 offset:48128
 v_accvgpr_write_b32 a135, v203
M v[68:71], a[80:83], a[48:51], v[68:71]
 buffer_load_dwordx4 v3, s[8:11], s24 offen offset:2048 sc1 lds
M v[68:71], a[76:79], a[44:47], v[68:71]
 v_accvgpr_write_b32 a136, v208
 v_accvgpr_write_b32 a137, v209
M v[68:71], a[72:75], a[40:43], v[68:71]
 v_accvgpr_write_b32 a138, v210
 v_accvgpr_write_b32 a139, v211
M v[68:71], a[68:71], a[36:39], v[68:71]
 v_exp_f32 v18, v64
M v[68:71], a[64:67], a[32:35], v[68:71]
 s_waitcnt lgkmcnt(0)
 v_exp_f32 v19, v65
M v[72:75], a[96:99], a[0:3], v[32:35]
 ds_read_b128 a[64:67], v2 offset:49152
 v_add_f32 v26, v18, v19
M v[72:75], a[100:103], a[4:7], v[72:75]
 ds_read_b128 a[68:71], v2 offset:50176
 v_cvt_pk_bf16_f32 v40, v18, v19
M v[72:75], a[104:107], a[8:11], v[72:75]
 buffer_load_dwordx4 v3, s[8:11], s24 offen offset:3072 sc1 lds
M v[72:75], a[108:111], a[12:15], v[72:75]
 ds_read_b128 a[72:75], v2 offset:51200
 v_accvgpr_write_b32 a140, v216
M v[72:75], a[112:115], a[16:19], v[72:75]
 s_add_u32 m0, s28, 69632
 ds_read_b128 a[76:79], v2 offset:52224
 v_accvgpr_write_b32 a141, v217
M v[72:75], a[116:119], a[20:23], v[72:75]
 buffer_load_dwordx4 v4, s[8:11], s24 offen offset:0 sc1 lds
M v[72:75], a[120:123], a[24:27], v[72:75]
 ds_read_b128 a[80:83], v2 offset:53248
 v_accvgpr_write_b32 a142, v218
M v[72:75], a[124:127], a[28:31], v[72:75]
 s_add_u32 s3, s32, 0
 ds_read_b128 a[84:87], v2 offset:54272
 v_accvgpr_write_b32 a143, v219
M v[76:79], a[124:127], a[60:63], v[36:39]
 buffer_store_dwordx4 a[0:3], v6, s[8:11], s3 offen offset:0 sc1
M v[76:79], a[120:123], a[56:59], v[76:79]
 ds_read_b128 a[88:91], v2 offset:55296
 v_accvgpr_write_b32 a144, v224
M v[76:79], a[116:119], a[52:55], v[76:79]
 ds_read_b128 a[92:95], v2 offset:56320
 v_accvgpr_write_b32 a145, v225
M v[76:79], a[112:115], a[48:51], v[76:79]
 buffer_load_dwordx4 v4, s[8:11], s24 offen offset:1024 sc1 lds
M v[76:79], a[108:111], a[44:47], v[76:79]
 v_exp_f32 v20, v66
M v[76:79], a[104:107], a[40:43], v[76:79]
 buffer_store_dwordx4 a[4:7], v6, s[8:11], s3 offen offset:1024 sc1
M v[76:79], a[100:103], a[36:39], v[76:79]
 v_exp_f32 v21, v67
M v[76:79], a[96:99], a[32:35], v[76:79]
 s_waitcnt lgkmcnt(0)
 v_exp_f32 v22, v68
M v[80:83], a[64:67], a[0:3], v[32:35]
 ds_read_b128 a[96:99], v2 offset:57344
 v_add_f32 v26, v20, v26
M v[80:83], a[68:71], a[4:7], v[80:83]
 ds_read_b128 a[100:103], v2 offset:58368
 v_cvt_pk_bf16_f32 v41, v20, v21
M v[80:83], a[72:75], a[8:11], v[80:83]
 buffer_load_dwordx4 v4, s[8:11], s24 offen offset:2048 sc1 lds
M v[80:83], a[76:79], a[12:15], v[80:83]
 ds_read_b128 a[104:107], v2 offset:59392
 v_add_f32 v26, v21, v26
M v[80:83], a[80:83], a[16:19], v[80:83]
 ds_read_b128 a[108:111], v2 offset:60416
 v_accvgpr_write_b32 a146, v226
M v[80:83], a[84:87], a[20:23], v[80:83]
 buffer_store_dwordx4 a[8:11], v6, s[8:11], s3 offen offset:2048 sc1
M v[80:83], a[88:91], a[24:27], v[80:83]
 ds_read_b128 a[112:115], v2 offset:61440
 v_accvgpr_write_b32 a147, v227
M v[80:83], a[92:95], a[28:31], v[80:83]
 ds_read_b128 a[116:119], v2 offset:62464
 v_accvgpr_write_b32 a148, v232
M v[84:87], a[92:95], a[60:63], v[36:39]
 buffer_load_dwordx4 v4, s[8:11], s24 offen offset:3072 sc1 lds
M v[84:87], a[88:91], a[56:59], v[84:87]
 ds_read_b128 a[120:123], v2 offset:63488
 v_accvgpr_write_b32 a149, v233
M v[84:87], a[84:87], a[52:55], v[84:87]
 ds_read_b128 a[124:127], v2 offset:64512
 v_accvgpr_write_b32 a150, v234
M v[84:87], a[80:83], a[48:51], v[84:87]
 buffer_store_dwordx4 a[12:15], v6, s[8:11], s3 offen offset:3072 sc1
M v[84:87], a[76:79], a[44:47], v[84:87]
 s_add_u32 s3, s32, 4096
 v_exp_f32 v23, v69
M v[84:87], a[72:75], a[40:43], v[84:87]
 buffer_store_dwordx4 a[16:19], v6, s[8:11], s3 offen offset:0 sc1
M v[84:87], a[68:71], a[36:39], v[84:87]
 s_waitcnt vmcnt(13) lgkmcnt(0)
 v_exp_f32 v24, v70
M v[84:87], a[64:67], a[32:35], v[84:87]
 s_barrier
M v[88:91], a[96:99], a[0:3], v[32:35]
 ds_read_b128 a[64:67], v7 offset:32768
 v_add_f32 v27, v22, v23
M v[88:91], a[100:103], a[4:7], v[88:91]
 ds_read_b128 a[68:71], v7 offset:33792
 v_cvt_pk_bf16_f32 v44, v22, v23
M v[88:91], a[104:107], a[8:11], v[88:91]
 buffer_store_dword v17, v1, s[8:11], s45 offen sc1
M v[88:91], a[108:111], a[12:15], v[88:91]
 ds_read_b128 a[72:75], v7 offset:34816
 v_accvgpr_write_b32 a151, v235
M v[88:91], a[112:115], a[16:19], v[88:91]
 ds_read_b128 a[76:79], v7 offset:35840
 v_accvgpr_write_b32 a152, v240
M v[88:91], a[116:119], a[20:23], v[88:91]
 buffer_store_dwordx4 a[20:23], v6, s[8:11], s3 offen offset:1024 sc1
M v[88:91], a[120:123], a[24:27], v[88:91]
 ds_read_b128 a[80:83], v7 offset:36864
 v_accvgpr_write_b32 a153, v241
M v[88:91], a[124:127], a[28:31], v[88:91]
 ds_read_b128 a[84:87], v7 offset:37888
 v_accvgpr_write_b32 a154, v242
M v[92:95], a[124:127], a[60:63], v[36:39]
 buffer_store_dwordx4 a[24:27], v6, s[8:11], s3 offen offset:2048 sc1
M v[92:95], a[120:123], a[56:59], v[92:95]
 ds_read_b128 a[88:91], v7 offset:38912
 v_accvgpr_write_b32 a155, v243
M v[92:95], a[116:119], a[52:55], v[92:95]
 ds_read_b128 a[92:95], v7 offset:39936
 v_accvgpr_write_b32 a156, v248
M v[92:95], a[112:115], a[48:51], v[92:95]
 buffer_store_dwordx4 a[28:31], v6, s[8:11], s3 offen offset:3072 sc1
M v[92:95], a[108:111], a[44:47], v[92:95]
 v_exp_f32 v25, v71
M v[92:95], a[104:107], a[40:43], v[92:95]
 v_exp_f32 v18, v72
M v[92:95], a[100:103], a[36:39], v[92:95]
 s_waitcnt lgkmcnt(0)
 v_exp_f32 v19, v73
M v[92:95], a[96:99], a[32:35], v[92:95]
 v_exp_f32 v20, v74
M v[96:99], a[64:67], a[0:3], v[32:35]
 s_add_u32 m0, s28, 98304
 ds_read_b128 a[96:99], v7 offset:40960
 ds_read_b128 a[100:103], v7 offset:41984
M v[96:99], a[68:71], a[4:7], v[96:99]
 buffer_load_dwordx4 v3, s[8:11], s21 offen offset:0 sc1 lds
M v[96:99], a[72:75], a[8:11], v[96:99]
 v_exp_f32 v21, v75
M v[96:99], a[76:79], a[12:15], v[96:99]
 s_add_u32 s3, s32, 8192
 ds_read_b128 a[104:107], v7 offset:43008
 ds_read_b128 a[108:111], v7 offset:44032
M v[96:99], a[80:83], a[16:19], v[96:99]
 buffer_store_dwordx4 a[32:35], v6, s[8:11], s3 offen offset:0 sc1
M v[96:99], a[84:87], a[20:23], v[96:99]
 v_exp_f32 v22, v76
M v[96:99], a[88:91], a[24:27], v[96:99]
 ds_read_b128 a[112:115], v7 offset:45056
 ds_read_b128 a[116:119], v7 offset:46080
M v[96:99], a[92:95], a[28:31], v[96:99]
 buffer_load_dwordx4 v3, s[8:11], s21 offen offset:1024 sc1 lds
M v[100:103], a[92:95], a[60:63], v[36:39]
 v_exp_f32 v23, v77
M v[100:103], a[88:91], a[56:59], v[100:103]
 ds_read_b128 a[120:123], v7 offset:47104
 ds_read_b128 a[124:127], v7 offset:48128
M v[100:103], a[84:87], a[52:55], v[100:103]
 buffer_store_dwordx4 a[36:39], v6, s[8:11], s3 offen offset:1024 sc1
M v[100:103], a[80:83], a[48:51], v[100:103]
 v_add_f32 v27, v24, v27
 v_cvt_pk_bf16_f32 v45, v24, v25
M v[100:103], a[76:79], a[44:47], v[100:103]
 buffer_load_dwordx4 v3, s[8:11], s21 offen offset:2048 sc1 lds
M v[100:103], a[72:75], a[40:43], v[100:103]
 v_add_f32 v27, v25, v27
 v_add_f32 v26, v18, v26
M v[100:103], a[68:71], a[36:39], v[100:103]
 v_exp_f32 v24, v78
M v[100:103], a[64:67], a[32:35], v[100:103]
 s_waitcnt lgkmcnt(0)
 v_exp_f32 v25, v79
M v[108:111], a[96:99], a[32:35], v[36:39]
 ds_read_b128 a[64:67], v7 offset:49152
 ds_read_b128 a[68:71], v7 offset:50176
M v[108:111], a[100:103], a[36:39], v[108:111]
 buffer_load_dwordx4 v3, s[8:11], s21 offen offset:3072 sc1 lds
M v[108:111], a[104:107], a[40:43], v[108:111]
 v_cvt_pk_bf16_f32 v42, v18, v19
 v_add_f32 v26, v19, v26
M v[108:111], a[108:111], a[44:47], v[108:111]
 ds_read_b128 a[72:75], v7 offset:51200
 ds_read_b128 a[76:79], v7 offset:52224
M v[108:111], a[112:115], a[48:51], v[108:111]
 buffer_store_dwordx4 a[40:43], v6, s[8:11], s3 offen offset:2048 sc1
M v[108:111], a[116:119], a[52:55], v[108:111]
 v_exp_f32 v18, v80
M v[108:111], a[120:123], a[56:59], v[108:111]
 s_add_u32 m0, s28, 102400
 ds_read_b128 a[80:83], v7 offset:53248
 ds_read_b128 a[84:87], v7 offset:54272
M v[108:111], a[124:127], a[60:63], v[108:111]
 buffer_load_dwordx4 v4, s[8:11], s21 offen offset:0 sc1 lds
M v[104:107], a[124:127], a[28:31], v[32:35]
 v_exp_f32 v19, v81
M v[104:107], a[120:123], a[24:27], v[104:107]
 ds_read_b128 a[88:91], v7 offset:55296
 ds_read_b128 a[92:95], v7 offset:56320
M v[104:107], a[116:119], a[20:23], v[104:107]
 buffer_store_dwordx4 a[44:47], v6, s[8:11], s3 offen offset:3072 sc1
M v[104:107], a[112:115], a[16:19], v[104:107]
 v_add_f32 v26, v20, v26
 v_cvt_pk_bf16_f32 v43, v20, v21
M v[104:107], a[108:111], a[12:15], v[104:107]
 buffer_load_dwordx4 v4, s[8:11], s21 offen offset:1024 sc1 lds
M v[104:107], a[104:107], a[8:11], v[104:107]
 s_add_u32 s3, s32, 12288
 v_add_f32 v26, v21, v26
 v_add_f32 v27, v22, v27
M v[104:107], a[100:103], a[4:7], v[104:107]
 buffer_store_dwordx4 a[48:51], v6, s[8:11], s3 offen offset:0 sc1
M v[104:107], a[96:99], a[0:3], v[104:107]
 s_waitcnt lgkmcnt(0)
 v_exp_f32 v20, v82
M v[112:115], a[64:67], a[0:3], v[32:35]
 ds_read_b128 a[96:99], v7 offset:57344
 ds_read_b128 a[100:103], v7 offset:58368
M v[112:115], a[68:71], a[4:7], v[112:115]
 buffer_load_dwordx4 v4, s[8:11], s21 offen offset:2048 sc1 lds
M v[112:115], a[72:75], a[8:11], v[112:115]
 v_exp_f32 v21, v83
M v[112:115], a[76:79], a[12:15], v[112:115]
 ds_read_b128 a[104:107], v7 offset:59392
 ds_read_b128 a[108:111], v7 offset:60416
M v[112:115], a[80:83], a[16:19], v[112:115]
 buffer_load_dwordx4 v4, s[8:11], s21 offen offset:3072 sc1 lds
M v[112:115], a[84:87], a[20:23], v[112:115]
 s_add_u32 s24, s23, 16777216
 v_cvt_pk_bf16_f32 v46, v22, v23
 v_add_f32 v27, v23, v27
M v[112:115], a[88:91], a[24:27], v[112:115]
 s_mov_b32 s23, s21
 ds_read_b128 a[112:115], v7 offset:61440
 ds_read_b128 a[116:119], v7 offset:62464
M v[112:115], a[92:95], a[28:31], v[112:115]
 buffer_store_dwordx4 a[52:55], v6, s[8:11], s3 offen offset:1024 sc1
M v[116:119], a[92:95], a[60:63], v[36:39]
 s_add_u32 s21, s21, 32768
 v_add_f32 v27, v24, v27
M v[116:119], a[88:91], a[56:59], v[116:119]
 s_add_u32 s22, s22, 1
 ds_read_b128 a[120:123], v7 offset:63488
 ds_read_b128 a[124:127], v7 offset:64512
M v[116:119], a[84:87], a[52:55], v[116:119]
 s_cmp_eq_u32 s22, s25
 v_exp_f32 v22, v88
M v[116:119], a[80:83], a[48:51], v[116:119]
 s_cselect_b32 s21, s26, s21
 v_exp_f32 v23, v89
M v[116:119], a[76:79], a[44:47], v[116:119]
 buffer_store_dwordx4 a[56:59], v6, s[8:11], s3 offen offset:2048 sc1
M v[116:119], a[72:75], a[40:43], v[116:119]
 s_cmp_eq_u32 s22, s43
 v_cvt_pk_bf16_f32 v47, v24, v25
 v_add_f32 v27, v25, v27
M v[116:119], a[68:71], a[36:39], v[116:119]
 s_waitcnt vmcnt(21) lgkmcnt(0)
 v_exp_f32 v24, v90
M v[116:119], a[64:67], a[32:35], v[116:119]
 s_barrier
M v[124:127], a[96:99], a[32:35], v[36:39]
 s_cselect_b32 s21, s4, s21
 ds_read_b128 a[64:67], v2 offset:0
 ds_read_b128 a[68:71], v2 offset:1024
M v[124:127], a[100:103], a[36:39], v[124:127]
 s_cmp_eq_u32 s22, s6
 v_exp_f32 v25, v91
M v[124:127], a[104:107], a[40:43], v[124:127]
 s_cselect_b32 s21, s7, s21
 v_add_f32 v26, v18, v26
 v_cvt_pk_bf16_f32 v56, v18, v19
M v[124:127], a[108:111], a[44:47], v[124:127]
 ds_read_b128 a[72:75], v2 offset:2048
 ds_read_b128 a[76:79], v2 offset:3072
M v[124:127], a[112:115], a[48:51], v[124:127]
 buffer_store_dwordx4 a[60:63], v6, s[8:11], s3 offen offset:3072 sc1
M v[124:127], a[116:119], a[52:55], v[124:127]
 v_add_f32 v26, v19, v26
 v_add_f32 v26, v20, v26
M v[124:127], a[120:123], a[56:59], v[124:127]
 ds_read_b128 a[80:83], v2 offset:4096
 ds_read_b128 a[84:87], v2 offset:5120
M v[124:127], a[124:127], a[60:63], v[124:127]
 v_exp_f32 v18, v84
M v[120:123], a[124:127], a[28:31], v[32:35]
 v_exp_f32 v19, v85
M v[120:123], a[120:123], a[24:27], v[120:123]
 ds_read_b128 a[88:91], v2 offset:6144
 ds_read_b128 a[92:95], v2 offset:7168
M v[120:123], a[116:119], a[20:23], v[120:123]
 v_cvt_pk_bf16_f32 v57, v20, v21
 v_add_f32 v26, v21, v26
M v[120:123], a[112:115], a[16:19], v[120:123]
 v_exp_f32 v20, v86
M v[120:123], a[108:111], a[12:15], v[120:123]
 v_exp_f32 v21, v87
M v[120:123], a[104:107], a[8:11], v[120:123]
 v_add_f32 v26, v22, v26
 v_cvt_pk_bf16_f32 v58, v22, v23
M v[120:123], a[100:103], a[4:7], v[120:123]
 s_waitcnt lgkmcnt(0)
 v_add_f32 v26, v23, v26
 v_add_f32 v26, v24, v26
M v[120:123], a[96:99], a[0:3], v[120:123]
 v_exp_f32 v22, v92
 v_cvt_pk_bf16_f32 v59, v24, v25
 v_add_f32 v26, v25, v26
 v_add_f32 v27, v18, v27
 v_cvt_pk_bf16_f32 v60, v18, v19
 v_add_f32 v27, v19, v27
 v_exp_f32 v23, v93
 v_add_f32 v27, v20, v27
 v_cvt_pk_bf16_f32 v61, v20, v21
 v_add_f32 v27, v21, v27
 v_exp_f32 v24, v94
 v_add_f32 v27, v22, v27
 v_cvt_pk_bf16_f32 v62, v22, v23
 v_exp_f32 v25, v95
 v_add_f32 v27, v23, v27
 v_add_f32 v27, v24, v27
 v_cvt_pk_bf16_f32 v63, v24, v25
 v_add_f32 v27, v25, v27
 v_max_f32 v10, v26, v27
 v_min_f32 v11, v26, v27
 v_cmp_lt_f32 s[36:37], s31, v10
 v_cmp_gt_f32 vcc, s55, v11
 s_nop 0
 s_or_b64 vcc, vcc, s[36:37]
 s_cbranch_vccnz L_st8
L_rt8:
M v[128:131], a[64:67], v[40:43], 0
 s_add_u32 m0, s28, 0
 ds_read_b128 a[96:99], v2 offset:8192
 ds_read_b128 a[100:103], v2 offset:9216
M v[128:131], a[68:71], v[56:59], v[128:131]
 buffer_load_dwordx4 v3, s[8:11], s24 offen offset:0 sc1 lds
M v[132:135], a[68:71], v[60:63], 0
 v_accvgpr_write_b32 a157, v249
 v_accvgpr_write_b32 a158, v250
M v[132:135], a[64:67], v[44:47], v[132:135]
 ds_read_b128 a[104:107], v2 offset:10240
 ds_read_b128 a[108:111], v2 offset:11264
M v[140:143], a[72:75], v[44:47], 0
 buffer_load_dwordx4 v3, s[8:11], s24 offen offset:1024 sc1 lds
M v[140:143], a[76:79], v[60:63], v[140:143]
 v_accvgpr_write_b32 a159, v251
 v_add_f32 v30, v26, v30
M v[136:139], a[76:79], v[56:59], 0
 ds_read_b128 a[112:115], v2 offset:12288
 ds_read_b128 a[116:119], v2 offset:13312
M v[136:139], a[72:75], v[40:43], v[136:139]
 buffer_load_dwordx4 v3, s[8:11], s24 offen offset:2048 sc1 lds
M v[144:147], a[80:83], v[40:43], 0
 v_exp_f32 v18, v96
M v[144:147], a[84:87], v[56:59], v[144:147]
 ds_read_b128 a[120:123], v2 offset:14336
 ds_read_b128 a[124:127], v2 offset:15360
M v[148:151], a[84:87], v[60:63], 0
 buffer_load_dwordx4 v3, s[8:11], s24 offen offset:3072 sc1 lds
M v[148:151], a[80:83], v[44:47], v[148:151]
 s_add_u32 m0, s28, 4096
 v_exp_f32 v19, v97
M v[156:159], a[88:91], v[44:47], 0
 buffer_load_dwordx4 v4, s[8:11], s24 offen offset:0 sc1 lds
M v[156:159], a[92:95], v[60:63], v[156:159]
 v_exp_f32 v20, v98
M v[152:155], a[92:95], v[56:59], 0
 v_exp_f32 v21, v99
M v[152:155], a[88:91], v[40:43], v[152:155]
 s_waitcnt lgkmcnt(0)
 v_exp_f32 v22, v104
M v[160:163], a[96:99], v[40:43], 0
 ds_read_b128 a[64:67], v2 offset:16384
 ds_read_b128 a[68:71], v2 offset:17408
M v[160:163], a[100:103], v[56:59], v[160:163]
 buffer_load_dwordx4 v4, s[8:11], s24 offen offset:1024 sc1 lds
M v[164:167], a[100:103], v[60:63], 0
 v_exp_f32 v23, v105
M v[164:167], a[96:99], v[44:47], v[164:167]
 ds_read_b128 a[72:75], v2 offset:18432
 ds_read_b128 a[76:79], v2 offset:19456
M v[172:175], a[104:107], v[44:47], 0
 buffer_load_dwordx4 v4, s[8:11], s24 offen offset:2048 sc1 lds
M v[172:175], a[108:111], v[60:63], v[172:175]
 v_add_f32 v31, v27, v31
 v_add_f32 v28, v18, v19
M v[168:171], a[108:111], v[56:59], 0
 ds_read_b128 a[80:83], v2 offset:20480
 ds_read_b128 a[84:87], v2 offset:21504
M v[168:171], a[104:107], v[40:43], v[168:171]
 buffer_load_dwordx4 v4, s[8:11], s24 offen offset:3072 sc1 lds
M v[176:179], a[112:115], v[40:43], 0
 v_exp_f32 v24, v106
M v[176:179], a[116:119], v[56:59], v[176:179]
 s_add_u32 m0, s28, 32768
 ds_read_b128 a[88:91], v2 offset:22528
 ds_read_b128 a[92:95], v2 offset:23552
M v[180:183], a[116:119], v[60:63], 0
 buffer_load_dwordx4 v3, s[8:11], s21 offen offset:0 sc1 lds
M v[180:183], a[112:115], v[44:47], v[180:183]
 v_exp_f32 v25, v107
M v[188:191], a[120:123], v[44:47], 0
 buffer_load_dwordx4 v3, s[8:11], s21 offen offset:1024 sc1 lds
M v[188:191], a[124:127], v[60:63], v[188:191]
 v_cvt_pk_bf16_f32 v48, v18, v19
 v_add_f32 v28, v20, v28
M v[184:187], a[124:127], v[56:59], 0
 buffer_load_dwordx4 v3, s[8:11], s21 offen offset:2048 sc1 lds
M v[184:187], a[120:123], v[40:43], v[184:187]
 s_waitcnt lgkmcnt(0)
 v_exp_f32 v18, v100
M v[192:195], a[64:67], v[40:43], 0
 ds_read_b128 a[96:99], v2 offset:24576
 ds_read_b128 a[100:103], v2 offset:25600
M v[192:195], a[68:71], v[56:59], v[192:195]
 buffer_load_dwordx4 v3, s[8:11], s21 offen offset:3072 sc1 lds
M v[196:199], a[68:71], v[60:63], 0
 v_exp_f32 v19, v101
M v[196:199], a[64:67], v[44:47], v[196:199]
 s_add_u32 m0, s28, 36864
 ds_read_b128 a[104:107], v2 offset:26624
 ds_read_b128 a[108:111], v2 offset:27648
M v[204:207], a[72:75], v[44:47], 0
 buffer_load_dwordx4 v4, s[8:11], s21 offen offset:0 sc1 lds
M v[204:207], a[76:79], v[60:63], v[204:207]
 v_cvt_pk_bf16_f32 v49, v20, v21
 v_add_f32 v28, v21, v28
M v[200:203], a[76:79], v[56:59], 0
 ds_read_b128 a[112:115], v2 offset:28672
 ds_read_b128 a[116:119], v2 offset:29696
M v[200:203], a[72:75], v[40:43], v[200:203]
 buffer_load_dwordx4 v4, s[8:11], s21 offen offset:1024 sc1 lds
M v[208:211], a[80:83], v[40:43], 0
 v_exp_f32 v20, v102
M v[208:211], a[84:87], v[56:59], v[208:211]
 ds_read_b128 a[120:123], v2 offset:30720
 ds_read_b128 a[124:127], v2 offset:31744
M v[212:215], a[84:87], v[60:63], 0
 buffer_load_dwordx4 v4, s[8:11], s21 offen offset:2048 sc1 lds
M v[212:215], a[80:83], v[44:47], v[212:215]
 v_exp_f32 v21, v103
M v[220:223], a[88:91], v[44:47], 0
 v_add_f32 v28, v22, v28
 v_cvt_pk_bf16_f32 v50, v22, v23
M v[220:223], a[92:95], v[60:63], v[220:223]
 buffer_load_dwordx4 v4, s[8:11], s21 offen offset:3072 sc1 lds
M v[216:219], a[92:95], v[56:59], 0
 s_waitcnt vmcnt(16) lgkmcnt(0)
 s_add_u32 s24, s23, 16777216
 s_mov_b32 s23, s21
M v[216:219], a[88:91], v[40:43], v[216:219]
 s_barrier
M v[224:227], a[96:99], v[40:43], 0
 ds_read_b128 a[64:67], v2 offset:32768
 ds_read_b128 a[68:71], v2 offset:33792
M v[224:227], a[100:103], v[56:59], v[224:227]
 s_xor_b32 s3, s47, 64
 v_mov_b32 v5, 1
M v[228:231], a[100:103], v[60:63], 0
 v_min_u32 v6, 1, v7
 v_lshlrev_b32 v6, 29, v6
M v[228:231], a[96:99], v[44:47], v[228:231]
 ds_read_b128 a[72:75], v2 offset:34816
 ds_read_b128 a[76:79], v2 offset:35840
M v[236:239], a[104:107], v[44:47], 0
 v_or_b32 v6, s35, v6
 s_add_u32 s21, s21, 32768
M v[236:239], a[108:111], v[60:63], v[236:239]
 buffer_store_dword v5, v6, s[8:11], s3 offen sc1
M v[232:235], a[108:111], v[56:59], 0
 ds_read_b128 a[80:83], v2 offset:36864
 ds_read_b128 a[84:87], v2 offset:37888
M v[232:235], a[104:107], v[40:43], v[232:235]
 s_add_u32 s22, s22, 1
 v_add_f32 v28, v23, v28
M v[240:243], a[112:115], v[40:43], 0
 s_cmp_eq_u32 s22, s25
 v_exp_f32 v22, v108
M v[240:243], a[116:119], v[56:59], v[240:243]
 s_cselect_b32 s21, s26, s21
 ds_read_b128 a[88:91], v2 offset:38912
 ds_read_b128 a[92:95], v2 offset:39936
M v[244:247], a[116:119], v[60:63], 0
 s_cmp_eq_u32 s22, s43
 v_exp_f32 v23, v109
M v[244:247], a[112:115], v[44:47], v[244:247]
 s_cselect_b32 s21, s4, s21
 v_add_f32 v28, v24, v28
 v_cvt_pk_bf16_f32 v51, v24, v25
M v[252:255], a[120:123], v[44:47], 0
 s_cmp_eq_u32 s22, s6
 v_add_f32 v28, v25, v28
 v_add_f32 v29, v18, v19
M v[252:255], a[124:127], v[60:63], v[252:255]
 s_cselect_b32 s21, s7, s21
 v_exp_f32 v24, v110
M v[248:251], a[124:127], v[56:59], 0
 s_waitcnt lgkmcnt(0)
 v_exp_f32 v25, v111
M v[248:251], a[120:123], v[40:43], v[248:251]
 v_cvt_pk_bf16_f32 v52, v18, v19
 v_add_f32 v29, v20, v29
 v_cvt_pk_bf16_f32 v53, v20, v21
 v_add_f32 v29, v21, v29
 v_add_f32 v29, v22, v29
 v_cvt_pk_bf16_f32 v54, v22, v23
 v_add_f32 v29, v23, v29
 v_add_f32 v29, v24, v29
 v_cvt_pk_bf16_f32 v55, v24, v25
 v_add_f32 v29, v25, v29
M v[64:67], a[64:67], a[0:3], v[32:35]
 s_add_u32 m0, s28, 65536
 ds_read_b128 a[96:99], v2 offset:40960
 ds_read_b128 a[100:103], v2 offset:41984
M v[64:67], a[68:71], a[4:7], v[64:67]
 buffer_load_dwordx4 v3, s[8:11], s24 offen offset:0 sc1 lds
M v[64:67], a[72:75], a[8:11], v[64:67]
 v_exp_f32 v18, v112
M v[64:67], a[76:79], a[12:15], v[64:67]
 s_add_u32 s3, s30, 786432
 ds_read_b128 a[104:107], v2 offset:43008
 ds_read_b128 a[108:111], v2 offset:44032
M v[64:67], a[80:83], a[16:19], v[64:67]
 buffer_store_dwordx4 a[128:131], v7, s[8:11], s3 offen offset:0 sc1
M v[64:67], a[84:87], a[20:23], v[64:67]
 v_exp_f32 v19, v113
M v[64:67], a[88:91], a[24:27], v[64:67]
 ds_read_b128 a[112:115], v2 offset:45056
 ds_read_b128 a[116:119], v2 offset:46080
M v[64:67], a[92:95], a[28:31], v[64:67]
 buffer_load_dwordx4 v3, s[8:11], s24 offen offset:1024 sc1 lds
M v[68:71], a[92:95], a[60:63], v[36:39]
 v_exp_f32 v20, v114
M v[68:71], a[88:91], a[56:59], v[68:71]
 ds_read_b128 a[120:123], v2 offset:47104
 ds_read_b128 a[124:127], v2 offset:48128
M v[68:71], a[84:87], a[52:55], v[68:71]
 v_exp_f32 v21, v115
M v[68:71], a[80:83], a[48:51], v[68:71]
 v_add_f32 v28, v18, v28
 v_cvt_pk_bf16_f32 v56, v18, v19
M v[68:71], a[76:79], a[44:47], v[68:71]
 v_add_f32 v28, v19, v28
 v_add_f32 v28, v20, v28
M v[68:71], a[72:75], a[40:43], v[68:71]
 buffer_load_dwordx4 v3, s[8:11], s24 offen offset:2048 sc1 lds
M v[68:71], a[68:71], a[36:39], v[68:71]
 v_exp_f32 v22, v120
M v[68:71], a[64:67], a[32:35], v[68:71]
 s_waitcnt lgkmcnt(0)
 v_cvt_pk_bf16_f32 v57, v20, v21
 v_add_f32 v28, v21, v28
M v[76:79], a[96:99], a[32:35], v[36:39]
 ds_read_b128 a[64:67], v2 offset:49152
 ds_read_b128 a[68:71], v2 offset:50176
M v[76:79], a[100:103], a[36:39], v[76:79]
 buffer_store_dwordx4 a[132:135], v7, s[8:11], s3 offen offset:1024 sc1
M v[76:79], a[104:107], a[40:43], v[76:79]
 v_exp_f32 v23, v121
M v[76:79], a[108:111], a[44:47], v[76:79]
 ds_read_b128 a[72:75], v2 offset:51200
 ds_read_b128 a[76:79], v2 offset:52224
M v[76:79], a[112:115], a[48:51], v[76:79]
 buffer_load_dwordx4 v3, s[8:11], s24 offen offset:3072 sc1 lds
M v[76:79], a[116:119], a[52:55], v[76:79]
 v_exp_f32 v24, v122
M v[76:79], a[120:123], a[56:59], v[76:79]
 ds_read_b128 a[80:83], v2 offset:53248
 ds_read_b128 a[84:87], v2 offset:54272
M v[76:79], a[124:127], a[60:63], v[76:79]
 v_add_f32 v28, v22, v28
 v_cvt_pk_bf16_f32 v58, v22, v23
M v[72:75], a[124:127], a[28:31], v[32:35]
 v_exp_f32 v25, v123
M v[72:75], a[120:123], a[24:27], v[72:75]
 s_add_u32 m0, s28, 69632
 ds_read_b128 a[88:91], v2 offset:55296
 ds_read_b128 a[92:95], v2 offset:56320
M v[72:75], a[116:119], a[20:23], v[72:75]
 buffer_load_dwordx4 v4, s[8:11], s24 offen offset:0 sc1 lds
M v[72:75], a[112:115], a[16:19], v[72:75]
 v_add_f32 v28, v23, v28
 v_add_f32 v28, v24, v28
M v[72:75], a[108:111], a[12:15], v[72:75]
 v_exp_f32 v18, v116
M v[72:75], a[104:107], a[8:11], v[72:75]
 v_cvt_pk_bf16_f32 v59, v24, v25
 v_add_f32 v28, v25, v28
M v[72:75], a[100:103], a[4:7], v[72:75]
M v[72:75], a[96:99], a[0:3], v[72:75]
 s_waitcnt lgkmcnt(0)
 v_exp_f32 v19, v117
M v[80:83], a[64:67], a[0:3], v[32:35]
 ds_read_b128 a[96:99], v2 offset:57344
 ds_read_b128 a[100:103], v2 offset:58368
M v[80:83], a[68:71], a[4:7], v[80:83]
 buffer_store_dwordx4 a[136:139], v7, s[8:11], s3 offen offset:2048 sc1
M v[80:83], a[72:75], a[8:11], v[80:83]
 v_add_f32 v29, v18, v29
 v_cvt_pk_bf16_f32 v60, v18, v19
M v[80:83], a[76:79], a[12:15], v[80:83]
 ds_read_b128 a[104:107], v2 offset:59392
 ds_read_b128 a[108:111], v2 offset:60416
M v[80:83], a[80:83], a[16:19], v[80:83]
 buffer_load_dwordx4 v4, s[8:11], s24 offen offset:1024 sc1 lds
M v[80:83], a[84:87], a[20:23], v[80:83]
 v_exp_f32 v20, v118
M v[80:83], a[88:91], a[24:27], v[80:83]
 ds_read_b128 a[112:115], v2 offset:61440
 ds_read_b128 a[116:119], v2 offset:62464
M v[80:83], a[92:95], a[28:31], v[80:83]
 buffer_load_dwordx4 v4, s[8:11], s24 offen offset:2048 sc1 lds
M v[84:87], a[92:95], a[60:63], v[36:39]
 v_exp_f32 v21, v119
M v[84:87], a[88:91], a[56:59], v[84:87]
 ds_read_b128 a[120:123], v2 offset:63488
 ds_read_b128 a[124:127], v2 offset:64512
M v[84:87], a[84:87], a[52:55], v[84:87]
 v_exp_f32 v22, v124
M v[84:87], a[80:83], a[48:51], v[84:87]
 buffer_load_dwordx4 v4, s[8:11], s24 offen offset:3072 sc1 lds
M v[84:87], a[76:79], a[44:47], v[84:87]
 v_add_f32 v29, v19, v29
 v_add_f32 v29, v20, v29
M v[84:87], a[72:75], a[40:43], v[84:87]
 buffer_store_dwordx4 a[140:143], v7, s[8:11], s3 offen offset:3072 sc1
M v[84:87], a[68:71], a[36:39], v[84:87]
 s_waitcnt vmcnt(21) lgkmcnt(0)
 v_exp_f32 v23, v125
M v[84:87], a[64:67], a[32:35], v[84:87]
 s_barrier
M v[92:95], a[96:99], a[32:35], v[36:39]
 ds_read_b128 a[64:67], v7 offset:0
 ds_read_b128 a[68:71], v7 offset:1024
M v[92:95], a[100:103], a[36:39], v[92:95]
 v_exp_f32 v24, v126
M v[92:95], a[104:107], a[40:43], v[92:95]
 v_cvt_pk_bf16_f32 v61, v20, v21
 v_add_f32 v29, v21, v29
M v[92:95], a[108:111], a[44:47], v[92:95]
 ds_read_b128 a[72:75], v7 offset:2048
 ds_read_b128 a[76:79], v7 offset:3072
M v[92:95], a[112:115], a[48:51], v[92:95]
 v_exp_f32 v25, v127
M v[92:95], a[116:119], a[52:55], v[92:95]
 v_add_f32 v29, v22, v29
 v_cvt_pk_bf16_f32 v62, v22, v23
M v[92:95], a[120:123], a[56:59], v[92:95]
 ds_read_b128 a[80:83], v7 offset:4096
 ds_read_b128 a[84:87], v7 offset:5120
M v[92:95], a[124:127], a[60:63], v[92:95]
 v_add_f32 v29, v23, v29
 v_add_f32 v29, v24, v29
M v[88:91], a[124:127], a[28:31], v[32:35]
 v_cvt_pk_bf16_f32 v63, v24, v25
 v_add_f32 v29, v25, v29
M v[88:91], a[120:123], a[24:27], v[88:91]
 ds_read_b128 a[88:91], v7 offset:6144
 ds_read_b128 a[92:95], v7 offset:7168
M v[88:91], a[116:119], a[20:23], v[88:91]
 v_max_f32 v10, v28, v29
M v[88:91], a[112:115], a[16:19], v[88:91]
 v_cmp_lt_f32 vcc, s31, v10
M v[88:91], a[108:111], a[12:15], v[88:91]
M v[88:91], a[104:107], a[8:11], v[88:91]
M v[88:91], a[100:103], a[4:7], v[88:91]
 s_waitcnt lgkmcnt(0)
M v[88:91], a[96:99], a[0:3], v[88:91]
 s_cbranch_vccnz L_st9
L_rt9:
M v[128:131], a[64:67], v[48:51], v[128:131]
 s_add_u32 m0, s28, 98304
 ds_read_b128 a[96:99], v7 offset:8192
 ds_read_b128 a[100:103], v7 offset:9216
M v[128:131], a[68:71], v[56:59], v[128:131]
 buffer_load_dwordx4 v3, s[8:11], s21 offen offset:0 sc1 lds
M v[132:135], a[68:71], v[60:63], v[132:135]
 v_exp_f32 v18, v64
M v[132:135], a[64:67], v[52:55], v[132:135]
 s_add_u32 s3, s30, 794624
 ds_read_b128 a[104:107], v7 offset:10240
 ds_read_b128 a[108:111], v7 offset:11264
M v[140:143], a[72:75], v[52:55], v[140:143]
 buffer_store_dwordx4 a[144:147], v7, s[8:11], s3 offen offset:0 sc1
M v[140:143], a[76:79], v[60:63], v[140:143]
 v_exp_f32 v19, v65
M v[136:139], a[76:79], v[56:59], v[136:139]
 ds_read_b128 a[112:115], v7 offset:12288
 ds_read_b128 a[116:119], v7 offset:13312
M v[136:139], a[72:75], v[48:51], v[136:139]
 buffer_load_dwordx4 v3, s[8:11], s21 offen offset:1024 sc1 lds
M v[144:147], a[80:83], v[48:51], v[144:147]
 v_exp_f32 v20, v66
M v[144:147], a[84:87], v[56:59], v[144:147]
 ds_read_b128 a[120:123], v7 offset:14336
 ds_read_b128 a[124:127], v7 offset:15360
M v[148:151], a[84:87], v[60:63], v[148:151]
 v_add_f32 v30, v28, v30
 v_add_f32 v31, v29, v31
M v[148:151], a[80:83], v[52:55], v[148:151]
 buffer_load_dwordx4 v3, s[8:11], s21 offen offset:2048 sc1 lds
M v[156:159], a[88:91], v[52:55], v[156:159]
 v_exp_f32 v21, v67
M v[156:159], a[92:95], v[60:63], v[156:159]
 v_add_f32 v26, v18, v19
 v_cvt_pk_bf16_f32 v40, v18, v19
M v[152:155], a[92:95], v[56:59], v[152:155]
 v_exp_f32 v22, v72
M v[152:155], a[88:91], v[48:51], v[152:155]
 s_waitcnt lgkmcnt(0)
 v_add_f32 v26, v20, v26
 v_cvt_pk_bf16_f32 v41, v20, v21
M v[160:163], a[96:99], v[48:51], v[160:163]
 ds_read_b128 a[64:67], v7 offset:16384
 ds_read_b128 a[68:71], v7 offset:17408
M v[160:163], a[100:103], v[56:59], v[160:163]
 buffer_store_dwordx4 a[148:151], v7, s[8:11], s3 offen offset:1024 sc1
M v[164:167], a[100:103], v[60:63], v[164:167]
 v_exp_f32 v23, v73
M v[164:167], a[96:99], v[52:55], v[164:167]
 ds_read_b128 a[72:75], v7 offset:18432
 ds_read_b128 a[76:79], v7 offset:19456
M v[172:175], a[104:107], v[52:55], v[172:175]
 buffer_load_dwordx4 v3, s[8:11], s21 offen offset:3072 sc1 lds
M v[172:175], a[108:111], v[60:63], v[172:175]
 v_add_f32 v26, v21, v26
 v_add_f32 v26, v22, v26
M v[168:171], a[108:111], v[56:59], v[168:171]
 s_add_u32 m0, s28, 102400
 ds_read_b128 a[80:83], v7 offset:20480
 ds_read_b128 a[84:87], v7 offset:21504
M v[168:171], a[104:107], v[48:51], v[168:171]
 buffer_load_dwordx4 v4, s[8:11], s21 offen offset:0 sc1 lds
M v[176:179], a[112:115], v[48:51], v[176:179]
 v_exp_f32 v24, v74
M v[176:179], a[116:119], v[56:59], v[176:179]
 ds_read_b128 a[88:91], v7 offset:22528
 ds_read_b128 a[92:95], v7 offset:23552
M v[180:183], a[116:119], v[60:63], v[180:183]
 v_exp_f32 v25, v75
M v[180:183], a[112:115], v[52:55], v[180:183]
 buffer_load_dwordx4 v4, s[8:11], s21 offen offset:1024 sc1 lds
M v[188:191], a[120:123], v[52:55], v[188:191]
 v_cvt_pk_bf16_f32 v42, v22, v23
 v_add_f32 v26, v23, v26
M v[188:191], a[124:127], v[60:63], v[188:191]
 v_exp_f32 v18, v68
M v[184:187], a[124:127], v[56:59], v[184:187]
 v_add_f32 v26, v24, v26
 v_cvt_pk_bf16_f32 v43, v24, v25
M v[184:187], a[120:123], v[48:51], v[184:187]
 s_waitcnt lgkmcnt(0)
 v_add_f32 v26, v25, v26
M v[192:195], a[64:67], v[48:51], v[192:195]
 ds_read_b128 a[96:99], v7 offset:24576
 ds_read_b128 a[100:103], v7 offset:25600
M v[192:195], a[68:71], v[56:59], v[192:195]
 buffer_store_dwordx4 a[152:155], v7, s[8:11], s3 offen offset:2048 sc1
M v[196:199], a[68:71], v[60:63], v[196:199]
 v_exp_f32 v19, v69
M v[196:199], a[64:67], v[52:55], v[196:199]
 ds_read_b128 a[104:107], v7 offset:26624
 ds_read_b128 a[108:111], v7 offset:27648
M v[204:207], a[72:75], v[52:55], v[204:207]
 buffer_load_dwordx4 v4, s[8:11], s21 offen offset:2048 sc1 lds
M v[204:207], a[76:79], v[60:63], v[204:207]
 v_exp_f32 v20, v70
M v[200:203], a[76:79], v[56:59], v[200:203]
 ds_read_b128 a[112:115], v7 offset:28672
 ds_read_b128 a[116:119], v7 offset:29696
M v[200:203], a[72:75], v[48:51], v[200:203]
 buffer_load_dwordx4 v4, s[8:11], s21 offen offset:3072 sc1 lds
M v[208:211], a[80:83], v[48:51], v[208:211]
 s_add_u32 s24, s23, 16777216
 v_exp_f32 v21, v71
M v[208:211], a[84:87], v[56:59], v[208:211]
 s_mov_b32 s23, s21
 ds_read_b128 a[120:123], v7 offset:30720
 ds_read_b128 a[124:127], v7 offset:31744
M v[212:215], a[84:87], v[60:63], v[212:215]
 s_add_u32 s21, s21, 32768
 v_add_f32 v27, v18, v19
 v_cvt_pk_bf16_f32 v44, v18, v19
M v[212:215], a[80:83], v[52:55], v[212:215]
 s_add_u32 s22, s22, 1
 v_add_f32 v27, v20, v27
 v_cvt_pk_bf16_f32 v45, v20, v21
M v[220:223], a[88:91], v[52:55], v[220:223]
 s_cmp_eq_u32 s22, s25
 v_exp_f32 v22, v76
M v[220:223], a[92:95], v[60:63], v[220:223]
 buffer_store_dwordx4 a[156:159], v7, s[8:11], s3 offen offset:3072 sc1
M v[216:219], a[92:95], v[56:59], v[216:219]
 s_waitcnt vmcnt(25) lgkmcnt(0)
 v_add_f32 v27, v21, v27
M v[216:219], a[88:91], v[48:51], v[216:219]
 s_barrier
M v[224:227], a[96:99], v[48:51], v[224:227]
 s_cselect_b32 s21, s26, s21
 ds_read_b128 a[64:67], v7 offset:32768
 ds_read_b128 a[68:71], v7 offset:33792
M v[224:227], a[100:103], v[56:59], v[224:227]
 s_cmp_eq_u32 s22, s43
 v_exp_f32 v23, v77
M v[228:231], a[100:103], v[60:63], v[228:231]
 s_cselect_b32 s21, s4, s21
 v_add_f32 v27, v22, v27
 v_cvt_pk_bf16_f32 v46, v22, v23
M v[228:231], a[96:99], v[52:55], v[228:231]
 s_cmp_eq_u32 s22, s6
 ds_read_b128 a[72:75], v7 offset:34816
 ds_read_b128 a[76:79], v7 offset:35840
M v[236:239], a[104:107], v[52:55], v[236:239]
 s_cselect_b32 s21, s7, s21
 v_exp_f32 v24, v78
M v[236:239], a[108:111], v[60:63], v[236:239]
 v_add_f32 v27, v23, v27
M v[232:235], a[108:111], v[56:59], v[232:235]
 ds_read_b128 a[80:83], v7 offset:36864
 ds_read_b128 a[84:87], v7 offset:37888
M v[232:235], a[104:107], v[48:51], v[232:235]
 v_exp_f32 v25, v79
M v[240:243], a[112:115], v[48:51], v[240:243]
 v_add_f32 v27, v24, v27
 v_cvt_pk_bf16_f32 v47, v24, v25
M v[240:243], a[116:119], v[56:59], v[240:243]
 ds_read_b128 a[88:91], v7 offset:38912
 ds_read_b128 a[92:95], v7 offset:39936
M v[244:247], a[116:119], v[60:63], v[244:247]
 v_add_f32 v27, v25, v27
M v[244:247], a[112:115], v[52:55], v[244:247]
M v[252:255], a[120:123], v[52:55], v[252:255]
M v[252:255], a[124:127], v[60:63], v[252:255]
M v[248:251], a[124:127], v[56:59], v[248:251]
 s_waitcnt lgkmcnt(0)
M v[248:251], a[120:123], v[48:51], v[248:251]
M v[96:99], a[64:67], a[0:3], v[32:35]
 s_add_u32 m0, s28, 0
 ds_read_b128 a[96:99], v7 offset:40960
M v[96:99], a[68:71], a[4:7], v[96:99]
 ds_read_b128 a[100:103], v7 offset:41984
M v[96:99], a[72:75], a[8:11], v[96:99]
 buffer_load_dword v6, v9, s[8:11], s46 offen sc1
M v[96:99], a[76:79], a[12:15], v[96:99]
 s_cmp_eq_u32 s20, 0
 ds_read_b128 a[104:107], v7 offset:43008
M v[96:99], a[80:83], a[16:19], v[96:99]
 s_cselect_b64 s[64:65], s[16:17], 0
 ds_read_b128 a[108:111], v7 offset:44032
M v[96:99], a[84:87], a[20:23], v[96:99]
 buffer_load_dwordx4 v3, s[8:11], s24 offen offset:0 sc1 lds
M v[96:99], a[88:91], a[24:27], v[96:99]
 s_cselect_b64 s[66:67], s[18:19], 0
 ds_read_b128 a[112:115], v7 offset:45056
M v[96:99], a[92:95], a[28:31], v[96:99]
 s_cselect_b64 s[68:69], s[48:49], 0
 ds_read_b128 a[116:119], v7 offset:46080
M v[100:103], a[92:95], a[60:63], v[36:39]
 buffer_load_dwordx4 v3, s[8:11], s24 offen offset:1024 sc1 lds
M v[100:103], a[88:91], a[56:59], v[100:103]
 s_cselect_b64 s[70:71], s[50:51], 0
 ds_read_b128 a[120:123], v7 offset:47104
M v[100:103], a[84:87], a[52:55], v[100:103]
 s_cmp_lt_u32 s20, 1
 ds_read_b128 a[124:127], v7 offset:48128
M v[100:103], a[80:83], a[48:51], v[100:103]
 s_cselect_b64 s[78:79], -1, 0
 v_exp_f32 v18, v80
M v[100:103], a[76:79], a[44:47], v[100:103]
 buffer_load_dwordx4 v3, s[8:11], s24 offen offset:2048 sc1 lds
M v[100:103], a[72:75], a[40:43], v[100:103]
 s_cmp_eq_u32 s20, 1
 v_exp_f32 v19, v81
M v[100:103], a[68:71], a[36:39], v[100:103]
 s_cselect_b64 s[72:73], s[16:17], s[78:79]
 v_exp_f32 v20, v82
M v[100:103], a[64:67], a[32:35], v[100:103]
 s_waitcnt lgkmcnt(0)
 v_exp_f32 v21, v83
M v[108:111], a[96:99], a[32:35], v[36:39]
 s_cselect_b64 s[74:75], s[18:19], s[78:79]
 ds_read_b128 a[64:67], v7 offset:49152
 v_add_f32 v26, v18, v26
M v[108:111], a[100:103], a[36:39], v[108:111]
 s_cselect_b64 s[76:77], s[48:49], s[78:79]
 ds_read_b128 a[68:71], v7 offset:50176
 v_cvt_pk_bf16_f32 v56, v18, v19
M v[108:111], a[104:107], a[40:43], v[108:111]
 buffer_load_dwordx4 v3, s[8:11], s24 offen offset:3072 sc1 lds
M v[108:111], a[108:111], a[44:47], v[108:111]
 s_cselect_b64 s[78:79], s[50:51], s[78:79]
 ds_read_b128 a[72:75], v7 offset:51200
 v_add_f32 v26, v19, v26
M v[108:111], a[112:115], a[48:51], v[108:111]
 s_add_u32 s3, s29, 0
 ds_read_b128 a[76:79], v7 offset:52224
 v_add_f32 v26, v20, v26
M v[108:111], a[116:119], a[52:55], v[108:111]
 buffer_store_dwordx4 a[192:195], v7, s[8:11], s3 offen sc1
M v[108:111], a[120:123], a[56:59], v[108:111]
 s_add_u32 m0, s28, 4096
 ds_read_b128 a[80:83], v7 offset:53248
 v_cvt_pk_bf16_f32 v57, v20, v21
M v[108:111], a[124:127], a[60:63], v[108:111]
 ds_read_b128 a[84:87], v7 offset:54272
 v_add_f32 v26, v21, v26
M v[104:107], a[124:127], a[28:31], v[32:35]
 buffer_load_dwordx4 v4, s[8:11], s24 offen offset:0 sc1 lds
M v[104:107], a[120:123], a[24:27], v[104:107]
 ds_read_b128 a[88:91], v7 offset:55296
M v[104:107], a[116:119], a[20:23], v[104:107]
 ds_read_b128 a[92:95], v7 offset:56320
M v[104:107], a[112:115], a[16:19], v[104:107]
 v_exp_f32 v22, v88
M v[104:107], a[108:111], a[12:15], v[104:107]
 buffer_load_dwordx4 v4, s[8:11], s24 offen offset:1024 sc1 lds
M v[104:107], a[104:107], a[8:11], v[104:107]
 v_exp_f32 v23, v89
M v[104:107], a[100:103], a[4:7], v[104:107]
 v_exp_f32 v24, v90
M v[104:107], a[96:99], a[0:3], v[104:107]
 s_waitcnt lgkmcnt(0)
 v_exp_f32 v25, v91
M v[112:115], a[64:67], a[0:3], v[32:35]
 s_add_u32 s3, s29, 32768
 ds_read_b128 a[96:99], v7 offset:57344
 v_add_f32 v26, v22, v26
M v[112:115], a[68:71], a[4:7], v[112:115]
 ds_read_b128 a[100:103], v7 offset:58368
 v_cvt_pk_bf16_f32 v58, v22, v23
M v[112:115], a[72:75], a[8:11], v[112:115]
 buffer_load_dwordx4 v4, s[8:11], s24 offen offset:2048 sc1 lds
M v[112:115], a[76:79], a[12:15], v[112:115]
 ds_read_b128 a[104:107], v7 offset:59392
 v_add_f32 v26, v23, v26
M v[112:115], a[80:83], a[16:19], v[112:115]
 ds_read_b128 a[108:111], v7 offset:60416
 v_add_f32 v26, v24, v26
M v[112:115], a[84:87], a[20:23], v[112:115]
 buffer_store_dwordx4 a[196:199], v7, s[8:11], s3 offen sc1
M v[112:115], a[88:91], a[24:27], v[112:115]
 ds_read_b128 a[112:115], v7 offset:61440
 v_cvt_pk_bf16_f32 v59, v24, v25
M v[112:115], a[92:95], a[28:31], v[112:115]
 ds_read_b128 a[116:119], v7 offset:62464
 v_add_f32 v26, v25, v26
M v[116:119], a[92:95], a[60:63], v[36:39]
 buffer_load_dwordx4 v4, s[8:11], s24 offen offset:3072 sc1 lds
M v[116:119], a[88:91], a[56:59], v[116:119]
 ds_read_b128 a[120:123], v7 offset:63488
M v[116:119], a[84:87], a[52:55], v[116:119]
 ds_read_b128 a[124:127], v7 offset:64512
M v[116:119], a[80:83], a[48:51], v[116:119]
 v_exp_f32 v18, v84
M v[116:119], a[76:79], a[44:47], v[116:119]
 v_exp_f32 v19, v85
M v[116:119], a[72:75], a[40:43], v[116:119]
 v_exp_f32 v20, v86
M v[116:119], a[68:71], a[36:39], v[116:119]
 s_waitcnt vmcnt(24) lgkmcnt(0)
 v_exp_f32 v21, v87
M v[116:119], a[64:67], a[32:35], v[116:119]
 s_barrier
M v[124:127], a[96:99], a[32:35], v[36:39]
 ds_read_b128 a[64:67], v2 offset:0
 v_add_f32 v27, v18, v27
M v[124:127], a[100:103], a[36:39], v[124:127]
 ds_read_b128 a[68:71], v2 offset:1024
 v_cvt_pk_bf16_f32 v60, v18, v19
M v[124:127], a[104:107], a[40:43], v[124:127]
 v_exp_f32 v22, v92
M v[124:127], a[108:111], a[44:47], v[124:127]
 ds_read_b128 a[72:75], v2 offset:2048
 v_add_f32 v27, v19, v27
M v[124:127], a[112:115], a[48:51], v[124:127]
 ds_read_b128 a[76:79], v2 offset:3072
 v_add_f32 v27, v20, v27
M v[124:127], a[116:119], a[52:55], v[124:127]
 v_exp_f32 v23, v93
M v[124:127], a[120:123], a[56:59], v[124:127]
 ds_read_b128 a[80:83], v2 offset:4096
 v_cvt_pk_bf16_f32 v61, v20, v21
M v[124:127], a[124:127], a[60:63], v[124:127]
 ds_read_b128 a[84:87], v2 offset:5120
 v_add_f32 v27, v21, v27
M v[120:123], a[124:127], a[28:31], v[32:35]
 v_exp_f32 v24, v94
M v[120:123], a[120:123], a[24:27], v[120:123]
 ds_read_b128 a[88:91], v2 offset:6144
 v_add_f32 v27, v22, v27
M v[120:123], a[116:119], a[20:23], v[120:123]
 ds_read_b128 a[92:95], v2 offset:7168
 v_cvt_pk_bf16_f32 v62, v22, v23
M v[120:123], a[112:115], a[16:19], v[120:123]
 v_exp_f32 v25, v95
M v[120:123], a[108:111], a[12:15], v[120:123]
 v_add_f32 v27, v23, v27
 v_add_f32 v27, v24, v27
M v[120:123], a[104:107], a[8:11], v[120:123]
 v_cvt_pk_bf16_f32 v63, v24, v25
 v_add_f32 v27, v25, v27
M v[120:123], a[100:103], a[4:7], v[120:123]
 s_waitcnt lgkmcnt(0)
M v[120:123], a[96:99], a[0:3], v[120:123]
 v_max_f32 v10, v26, v27
 v_cmp_lt_f32 vcc, s31, v10
 s_nop 0
 s_cbranch_vccnz L_st12
L_rt12:
M v[128:131], a[64:67], v[40:43], v[128:131]
 s_add_u32 m0, s28, 32768
 ds_read_b128 a[96:99], v2 offset:8192
 v_add_f32 v30, v26, v30
M v[128:131], a[68:71], v[56:59], v[128:131]
 ds_read_b128 a[100:103], v2 offset:9216
 v_add_f32 v31, v27, v31
M v[132:135], a[68:71], v[60:63], v[132:135]
 buffer_load_dwordx4 v3, s[8:11], s21 offen offset:0 sc1 lds
M v[132:135], a[64:67], v[44:47], v[132:135]
 s_add_u32 s3, s29, 65536
 ds_read_b128 a[104:107], v2 offset:10240
M v[140:143], a[72:75], v[44:47], v[140:143]
 ds_read_b128 a[108:111], v2 offset:11264
M v[140:143], a[76:79], v[60:63], v[140:143]
 buffer_load_dwordx4 v3, s[8:11], s21 offen offset:1024 sc1 lds
M v[136:139], a[76:79], v[56:59], v[136:139]
 ds_read_b128 a[112:115], v2 offset:12288
M v[136:139], a[72:75], v[40:43], v[136:139]
 ds_read_b128 a[116:119], v2 offset:13312
M v[144:147], a[80:83], v[40:43], v[144:147]
 buffer_store_dwordx4 a[200:203], v7, s[8:11], s3 offen sc1
M v[144:147], a[84:87], v[56:59], v[144:147]
 ds_read_b128 a[120:123], v2 offset:14336
M v[148:151], a[84:87], v[60:63], v[148:151]
 ds_read_b128 a[124:127], v2 offset:15360
M v[148:151], a[80:83], v[44:47], v[148:151]
 buffer_load_dwordx4 v3, s[8:11], s21 offen offset:2048 sc1 lds
M v[156:159], a[88:91], v[44:47], v[156:159]
 v_exp_f32 v18, v96
M v[156:159], a[92:95], v[60:63], v[156:159]
 v_exp_f32 v19, v97
M v[152:155], a[92:95], v[56:59], v[152:155]
 buffer_load_dwordx4 v3, s[8:11], s21 offen offset:3072 sc1 lds
M v[152:155], a[88:91], v[40:43], v[152:155]
 s_waitcnt lgkmcnt(0)
 v_exp_f32 v20, v98
M v[160:163], a[96:99], v[40:43], v[160:163]
 ds_read_b128 a[64:67], v2 offset:16384
 v_add_f32 v28, v18, v19
M v[160:163], a[100:103], v[56:59], v[160:163]
 s_add_u32 m0, s28, 36864
 ds_read_b128 a[68:71], v2 offset:17408
 v_cvt_pk_bf16_f32 v48, v18, v19
M v[164:167], a[100:103], v[60:63], v[164:167]
 buffer_load_dwordx4 v4, s[8:11], s21 offen offset:0 sc1 lds
M v[164:167], a[96:99], v[44:47], v[164:167]
 ds_read_b128 a[72:75], v2 offset:18432
M v[172:175], a[104:107], v[44:47], v[172:175]
 ds_read_b128 a[76:79], v2 offset:19456
M v[172:175], a[108:111], v[60:63], v[172:175]
 v_exp_f32 v21, v99
M v[168:171], a[108:111], v[56:59], v[168:171]
 ds_read_b128 a[80:83], v2 offset:20480
 v_add_f32 v28, v20, v28
M v[168:171], a[104:107], v[40:43], v[168:171]
 s_add_u32 s3, s29, 98304
 ds_read_b128 a[84:87], v2 offset:21504
 v_cvt_pk_bf16_f32 v49, v20, v21
M v[176:179], a[112:115], v[40:43], v[176:179]
 buffer_load_dwordx4 v4, s[8:11], s21 offen offset:1024 sc1 lds
M v[176:179], a[116:119], v[56:59], v[176:179]
 ds_read_b128 a[88:91], v2 offset:22528
 v_add_f32 v28, v21, v28
M v[180:183], a[116:119], v[60:63], v[180:183]
 ds_read_b128 a[92:95], v2 offset:23552
M v[180:183], a[112:115], v[44:47], v[180:183]
 buffer_load_dwordx4 v4, s[8:11], s21 offen offset:2048 sc1 lds
M v[188:191], a[120:123], v[44:47], v[188:191]
 buffer_store_dwordx4 a[204:207], v7, s[8:11], s3 offen sc1
M v[188:191], a[124:127], v[60:63], v[188:191]
 v_exp_f32 v22, v104
M v[184:187], a[124:127], v[56:59], v[184:187]
 v_exp_f32 v23, v105
M v[184:187], a[120:123], v[40:43], v[184:187]
 s_waitcnt lgkmcnt(0)
 v_exp_f32 v24, v106
M v[192:195], a[64:67], v[40:43], v[192:195]
 ds_read_b128 a[96:99], v2 offset:24576
 v_add_f32 v28, v22, v28
M v[192:195], a[68:71], v[56:59], v[192:195]
 ds_read_b128 a[100:103], v2 offset:25600
 v_cvt_pk_bf16_f32 v50, v22, v23
M v[196:199], a[68:71], v[60:63], v[196:199]
 buffer_load_dwordx4 v4, s[8:11], s21 offen offset:3072 sc1 lds
M v[196:199], a[64:67], v[44:47], v[196:199]
 s_add_u32 s24, s23, 16777216
 ds_read_b128 a[104:107], v2 offset:26624
 v_add_f32 v28, v23, v28
M v[204:207], a[72:75], v[44:47], v[204:207]
 s_mov_b32 s23, s21
 ds_read_b128 a[108:111], v2 offset:27648
M v[204:207], a[76:79], v[60:63], v[204:207]
 s_add_u32 s21, s21, 32768
 v_exp_f32 v25, v107
M v[200:203], a[76:79], v[56:59], v[200:203]
 s_add_u32 s22, s22, 1
 ds_read_b128 a[112:115], v2 offset:28672
 v_add_f32 v28, v24, v28
M v[200:203], a[72:75], v[40:43], v[200:203]
 s_cmp_eq_u32 s22, s25
 ds_read_b128 a[116:119], v2 offset:29696
 v_cvt_pk_bf16_f32 v51, v24, v25
M v[208:211], a[80:83], v[40:43], v[208:211]
 s_cselect_b32 s21, s26, s21
 v_exp_f32 v18, v100
M v[208:211], a[84:87], v[56:59], v[208:211]
 s_cmp_eq_u32 s22, s43
 ds_read_b128 a[120:123], v2 offset:30720
 v_add_f32 v28, v25, v28
M v[212:215], a[84:87], v[60:63], v[212:215]
 s_cselect_b32 s21, s4, s21
 ds_read_b128 a[124:127], v2 offset:31744
M v[212:215], a[80:83], v[44:47], v[212:215]
 s_cmp_eq_u32 s22, s6
 v_exp_f32 v19, v101
M v[220:223], a[88:91], v[44:47], v[220:223]
 s_cselect_b32 s21, s7, s21
 v_exp_f32 v20, v102
M v[220:223], a[92:95], v[60:63], v[220:223]
 v_exp_f32 v21, v103
M v[216:219], a[92:95], v[56:59], v[216:219]
 s_waitcnt vmcnt(21) lgkmcnt(0)
 v_exp_f32 v22, v108
M v[216:219], a[88:91], v[40:43], v[216:219]
 s_barrier
M v[224:227], a[96:99], v[40:43], v[224:227]
 ds_read_b128 a[64:67], v2 offset:32768
 v_add_f32 v29, v18, v19
M v[224:227], a[100:103], v[56:59], v[224:227]
 ds_read_b128 a[68:71], v2 offset:33792
 v_mov_b32 v17, 4
M v[228:231], a[100:103], v[60:63], v[228:231]
 s_waitcnt vmcnt(20)
 v_cmp_gt_u32 vcc, 3, v6
 v_cvt_pk_bf16_f32 v52, v18, v19
M v[228:231], a[96:99], v[44:47], v[228:231]
 ds_read_b128 a[72:75], v2 offset:34816
 v_add_f32 v29, v20, v29
M v[236:239], a[104:107], v[44:47], v[236:239]
 ds_read_b128 a[76:79], v2 offset:35840
 v_cvt_pk_bf16_f32 v53, v20, v21
M v[236:239], a[108:111], v[60:63], v[236:239]
 s_cbranch_vccnz L_f4s
L_f4r:
 v_exp_f32 v23, v109
M v[232:235], a[108:111], v[56:59], v[232:235]
 ds_read_b128 a[80:83], v2 offset:36864
 v_add_f32 v29, v21, v29
M v[232:235], a[104:107], v[40:43], v[232:235]
 ds_read_b128 a[84:87], v2 offset:37888
 v_add_f32 v29, v22, v29
M v[240:243], a[112:115], v[40:43], v[240:243]
 buffer_store_dword v17, v1, s[8:11], s45 offen sc1
M v[240:243], a[116:119], v[56:59], v[240:243]
 ds_read_b128 a[88:91], v2 offset:38912
 v_cvt_pk_bf16_f32 v54, v22, v23
M v[244:247], a[116:119], v[60:63], v[244:247]
 ds_read_b128 a[92:95], v2 offset:39936
 v_add_f32 v29, v23, v29
M v[244:247], a[112:115], v[44:47], v[244:247]
 v_exp_f32 v24, v110
M v[252:255], a[120:123], v[44:47], v[252:255]
 v_exp_f32 v25, v111
M v[252:255], a[124:127], v[60:63], v[252:255]
 v_add_f32 v29, v24, v29
 v_cvt_pk_bf16_f32 v55, v24, v25
M v[248:251], a[124:127], v[56:59], v[248:251]
 s_waitcnt lgkmcnt(0)
 v_add_f32 v29, v25, v29
M v[248:251], a[120:123], v[40:43], v[248:251]
M v[64:67], a[64:67], a[0:3], v[32:35]
 s_add_u32 m0, s28, 65536
 ds_read_b128 a[96:99], v2 offset:40960
M v[64:67], a[68:71], a[4:7], v[64:67]
 ds_read_b128 a[100:103], v2 offset:41984
M v[64:67], a[72:75], a[8:11], v[64:67]
 buffer_load_dwordx4 v3, s[8:11], s24 offen offset:0 sc1 lds
M v[64:67], a[76:79], a[12:15], v[64:67]
 s_cmp_lt_u32 s20, 2
 ds_read_b128 a[104:107], v2 offset:43008
M v[64:67], a[80:83], a[16:19], v[64:67]
 s_cselect_b64 s[86:87], -1, 0
 ds_read_b128 a[108:111], v2 offset:44032
M v[64:67], a[84:87], a[20:23], v[64:67]
 s_cmp_eq_u32 s20, 2
 v_exp_f32 v18, v112
M v[64:67], a[88:91], a[24:27], v[64:67]
 s_cselect_b64 s[80:81], s[16:17], s[86:87]
 ds_read_b128 a[112:115], v2 offset:45056
M v[64:67], a[92:95], a[28:31], v[64:67]
 s_cselect_b64 s[82:83], s[18:19], s[86:87]
 ds_read_b128 a[116:119], v2 offset:46080
M v[68:71], a[92:95], a[60:63], v[36:39]
 buffer_load_dwordx4 v3, s[8:11], s24 offen offset:1024 sc1 lds
M v[68:71], a[88:91], a[56:59], v[68:71]
 s_cselect_b64 s[84:85], s[48:49], s[86:87]
 ds_read_b128 a[120:123], v2 offset:47104
M v[68:71], a[84:87], a[52:55], v[68:71]
 s_cselect_b64 s[86:87], s[50:51], s[86:87]
 ds_read_b128 a[124:127], v2 offset:48128
M v[68:71], a[80:83], a[48:51], v[68:71]
 s_cmp_eq_u32 s20, 3
 v_exp_f32 v19, v113
M v[68:71], a[76:79], a[44:47], v[68:71]
 buffer_load_dwordx4 v3, s[8:11], s24 offen offset:2048 sc1 lds
M v[68:71], a[72:75], a[40:43], v[68:71]
 s_cselect_b64 s[88:89], s[16:17], -1
 v_exp_f32 v20, v114
M v[68:71], a[68:71], a[36:39], v[68:71]
 s_cselect_b64 s[90:91], s[18:19], -1
 v_exp_f32 v21, v115
M v[68:71], a[64:67], a[32:35], v[68:71]
 s_waitcnt lgkmcnt(0)
 v_exp_f32 v22, v120
M v[76:79], a[96:99], a[32:35], v[36:39]
 s_cselect_b64 s[92:93], s[48:49], -1
 ds_read_b128 a[64:67], v2 offset:49152
 v_add_f32 v28, v18, v28
M v[76:79], a[100:103], a[36:39], v[76:79]
 s_cselect_b64 s[94:95], s[50:51], -1
 ds_read_b128 a[68:71], v2 offset:50176
 v_cvt_pk_bf16_f32 v56, v18, v19
M v[76:79], a[104:107], a[40:43], v[76:79]
 buffer_load_dwordx4 v3, s[8:11], s24 offen offset:3072 sc1 lds
M v[76:79], a[108:111], a[44:47], v[76:79]
 s_add_u32 s3, s29, 131072
 ds_read_b128 a[72:75], v2 offset:51200
 v_add_f32 v28, v19, v28
M v[76:79], a[112:115], a[48:51], v[76:79]
 ds_read_b128 a[76:79], v2 offset:52224
 v_add_f32 v28, v20, v28
M v[76:79], a[116:119], a[52:55], v[76:79]
 buffer_store_dwordx4 a[208:211], v7, s[8:11], s3 offen sc1
M v[76:79], a[120:123], a[56:59], v[76:79]
 s_add_u32 m0, s28, 69632
 ds_read_b128 a[80:83], v2 offset:53248
 v_cvt_pk_bf16_f32 v57, v20, v21
M v[76:79], a[124:127], a[60:63], v[76:79]
 ds_read_b128 a[84:87], v2 offset:54272
 v_add_f32 v28, v21, v28
M v[72:75], a[124:127], a[28:31], v[32:35]
 buffer_load_dwordx4 v4, s[8:11], s24 offen offset:0 sc1 lds
M v[72:75], a[120:123], a[24:27], v[72:75]
 ds_read_b128 a[88:91], v2 offset:55296
M v[72:75], a[116:119], a[20:23], v[72:75]
 ds_read_b128 a[92:95], v2 offset:56320
M v[72:75], a[112:115], a[16:19], v[72:75]
 v_exp_f32 v23, v121
M v[72:75], a[108:111], a[12:15], v[72:75]
 buffer_load_dwordx4 v4, s[8:11], s24 offen offset:1024 sc1 lds
M v[72:75], a[104:107], a[8:11], v[72:75]
 v_exp_f32 v24, v122
M v[72:75], a[100:103], a[4:7], v[72:75]
 s_add_u32 s3, s29, 163840
 v_exp_f32 v25, v123
M v[72:75], a[96:99], a[0:3], v[72:75]
 s_waitcnt lgkmcnt(0)
 v_exp_f32 v18, v116
M v[80:83], a[64:67], a[0:3], v[32:35]
 ds_read_b128 a[96:99], v2 offset:57344
 v_add_f32 v28, v22, v28
M v[80:83], a[68:71], a[4:7], v[80:83]
 ds_read_b128 a[100:103], v2 offset:58368
 v_cvt_pk_bf16_f32 v58, v22, v23
M v[80:83], a[72:75], a[8:11], v[80:83]
 buffer_load_dwordx4 v4, s[8:11], s24 offen offset:2048 sc1 lds
M v[80:83], a[76:79], a[12:15], v[80:83]
 ds_read_b128 a[104:107], v2 offset:59392
 v_add_f32 v28, v23, v28
M v[80:83], a[80:83], a[16:19], v[80:83]
 ds_read_b128 a[108:111], v2 offset:60416
 v_add_f32 v28, v24, v28
M v[80:83], a[84:87], a[20:23], v[80:83]
 buffer_store_dwordx4 a[212:215], v7, s[8:11], s3 offen sc1
M v[80:83], a[88:91], a[24:27], v[80:83]
 ds_read_b128 a[112:115], v2 offset:61440
 v_cvt_pk_bf16_f32 v59, v24, v25
M v[80:83], a[92:95], a[28:31], v[80:83]
 ds_read_b128 a[116:119], v2 offset:62464
 v_add_f32 v28, v25, v28
M v[84:87], a[92:95], a[60:63], v[36:39]
 buffer_load_dwordx4 v4, s[8:11], s24 offen offset:3072 sc1 lds
M v[84:87], a[88:91], a[56:59], v[84:87]
 ds_read_b128 a[120:123], v2 offset:63488
M v[84:87], a[84:87], a[52:55], v[84:87]
 ds_read_b128 a[124:127], v2 offset:64512
M v[84:87], a[80:83], a[48:51], v[84:87]
 v_exp_f32 v19, v117
M v[84:87], a[76:79], a[44:47], v[84:87]
 v_exp_f32 v20, v118
M v[84:87], a[72:75], a[40:43], v[84:87]
 v_exp_f32 v21, v119
M v[84:87], a[68:71], a[36:39], v[84:87]
 s_waitcnt vmcnt(21) lgkmcnt(0)
 v_exp_f32 v22, v124
M v[84:87], a[64:67], a[32:35], v[84:87]
 s_barrier
M v[92:95], a[96:99], a[32:35], v[36:39]
 ds_read_b128 a[64:67], v7 offset:0
 v_add_f32 v29, v18, v29
M v[92:95], a[100:103], a[36:39], v[92:95]
 ds_read_b128 a[68:71], v7 offset:1024
 v_cvt_pk_bf16_f32 v60, v18, v19
M v[92:95], a[104:107], a[40:43], v[92:95]
 v_exp_f32 v23, v125
M v[92:95], a[108:111], a[44:47], v[92:95]
 ds_read_b128 a[72:75], v7 offset:2048
 v_add_f32 v29, v19, v29
M v[92:95], a[112:115], a[48:51], v[92:95]
 ds_read_b128 a[76:79], v7 offset:3072
 v_add_f32 v29, v20, v29
M v[92:95], a[116:119], a[52:55], v[92:95]
 v_exp_f32 v24, v126
M v[92:95], a[120:123], a[56:59], v[92:95]
 ds_read_b128 a[80:83], v7 offset:4096
 v_cvt_pk_bf16_f32 v61, v20, v21
M v[92:95], a[124:127], a[60:63], v[92:95]
 ds_read_b128 a[84:87], v7 offset:5120
 v_add_f32 v29, v21, v29
M v[88:91], a[124:127], a[28:31], v[32:35]
 v_exp_f32 v25, v127
M v[88:91], a[120:123], a[24:27], v[88:91]
 ds_read_b128 a[88:91], v7 offset:6144
 v_add_f32 v29, v22, v29
M v[88:91], a[116:119], a[20:23], v[88:91]
 ds_read_b128 a[92:95], v7 offset:7168
 v_cvt_pk_bf16_f32 v62, v22, v23
M v[88:91], a[112:115], a[16:19], v[88:91]
 v_add_f32 v29, v23, v29
 v_add_f32 v29, v24, v29
M v[88:91], a[108:111], a[12:15], v[88:91]
 v_cvt_pk_bf16_f32 v63, v24, v25
 v_add_f32 v29, v25, v29
M v[88:91], a[104:107], a[8:11], v[88:91]
M v[88:91], a[100:103], a[4:7], v[88:91]
 s_waitcnt lgkmcnt(0)
M v[88:91], a[96:99], a[0:3], v[88:91]
 v_max_f32 v10, v28, v29
 v_cmp_lt_f32 vcc, s31, v10
 s_nop 0
 s_cbranch_vccnz L_st13
L_rt13:
M v[128:131], a[64:67], v[48:51], v[128:131]
 s_add_u32 m0, s28, 98304
 ds_read_b128 a[96:99], v7 offset:8192
 v_add_f32 v30, v28, v30
M v[128:131], a[68:71], v[56:59], v[128:131]
 s_add_u32 s3, s29, 196608
 ds_read_b128 a[100:103], v7 offset:9216
 v_add_f32 v31, v29, v31
M v[132:135], a[68:71], v[60:63], v[132:135]
 buffer_load_dwordx4 v3, s[8:11], s21 offen offset:0 sc1 lds
M v[132:135], a[64:67], v[52:55], v[132:135]
 ds_read_b128 a[104:107], v7 offset:10240
M v[140:143], a[72:75], v[52:55], v[140:143]
 ds_read_b128 a[108:111], v7 offset:11264
M v[140:143], a[76:79], v[60:63], v[140:143]
 buffer_load_dwordx4 v3, s[8:11], s21 offen offset:1024 sc1 lds
M v[136:139], a[76:79], v[56:59], v[136:139]
 ds_read_b128 a[112:115], v7 offset:12288
M v[136:139], a[72:75], v[48:51], v[136:139]
 ds_read_b128 a[116:119], v7 offset:13312
M v[144:147], a[80:83], v[48:51], v[144:147]
 buffer_store_dwordx4 a[216:219], v7, s[8:11], s3 offen sc1
M v[144:147], a[84:87], v[56:59], v[144:147]
 ds_read_b128 a[120:123], v7 offset:14336
M v[148:151], a[84:87], v[60:63], v[148:151]
 ds_read_b128 a[124:127], v7 offset:15360
M v[148:151], a[80:83], v[52:55], v[148:151]
 buffer_load_dwordx4 v3, s[8:11], s21 offen offset:2048 sc1 lds
M v[156:159], a[88:91], v[52:55], v[156:159]
 v_exp_f32 v18, v64
M v[156:159], a[92:95], v[60:63], v[156:159]
 v_exp_f32 v19, v65
M v[152:155], a[92:95], v[56:59], v[152:155]
 buffer_load_dwordx4 v3, s[8:11], s21 offen offset:3072 sc1 lds
M v[152:155], a[88:91], v[48:51], v[152:155]
 s_waitcnt lgkmcnt(0)
 v_exp_f32 v20, v66
M v[160:163], a[96:99], v[48:51], v[160:163]
 ds_read_b128 a[64:67], v7 offset:16384
 v_add_f32 v26, v18, v19
M v[160:163], a[100:103], v[56:59], v[160:163]
 s_add_u32 m0, s28, 102400
 ds_read_b128 a[68:71], v7 offset:17408
 v_cvt_pk_bf16_f32 v40, v18, v19
M v[164:167], a[100:103], v[60:63], v[164:167]
 buffer_load_dwordx4 v4, s[8:11], s21 offen offset:0 sc1 lds
M v[164:167], a[96:99], v[52:55], v[164:167]
 ds_read_b128 a[72:75], v7 offset:18432
M v[172:175], a[104:107], v[52:55], v[172:175]
 ds_read_b128 a[76:79], v7 offset:19456
M v[172:175], a[108:111], v[60:63], v[172:175]
 v_exp_f32 v21, v67
M v[168:171], a[108:111], v[56:59], v[168:171]
 ds_read_b128 a[80:83], v7 offset:20480
 v_add_f32 v26, v20, v26
M v[168:171], a[104:107], v[48:51], v[168:171]
 ds_read_b128 a[84:87], v7 offset:21504
 v_cvt_pk_bf16_f32 v41, v20, v21
M v[176:179], a[112:115], v[48:51], v[176:179]
 buffer_load_dwordx4 v4, s[8:11], s21 offen offset:1024 sc1 lds
M v[176:179], a[116:119], v[56:59], v[176:179]
 ds_read_b128 a[88:91], v7 offset:22528
 v_add_f32 v26, v21, v26
M v[180:183], a[116:119], v[60:63], v[180:183]
 ds_read_b128 a[92:95], v7 offset:23552
M v[180:183], a[112:115], v[52:55], v[180:183]
 buffer_load_dwordx4 v4, s[8:11], s21 offen offset:2048 sc1 lds
M v[188:191], a[120:123], v[52:55], v[188:191]
 v_exp_f32 v22, v72
M v[188:191], a[124:127], v[60:63], v[188:191]
 v_exp_f32 v23, v73
M v[184:187], a[124:127], v[56:59], v[184:187]
 v_exp_f32 v24, v74
M v[184:187], a[120:123], v[48:51], v[184:187]
 s_waitcnt lgkmcnt(0)
 v_exp_f32 v25, v75
M v[192:195], a[64:67], v[48:51], v[192:195]
 ds_read_b128 a[96:99], v7 offset:24576
 v_add_f32 v26, v22, v26
M v[192:195], a[68:71], v[56:59], v[192:195]
 ds_read_b128 a[100:103], v7 offset:25600
 v_cvt_pk_bf16_f32 v42, v22, v23
M v[196:199], a[68:71], v[60:63], v[196:199]
 buffer_load_dwordx4 v4, s[8:11], s21 offen offset:3072 sc1 lds
M v[196:199], a[64:67], v[52:55], v[196:199]
 s_add_u32 s24, s23, 16777216
 ds_read_b128 a[104:107], v7 offset:26624
 v_add_f32 v26, v23, v26
M v[204:207], a[72:75], v[52:55], v[204:207]
 s_mov_b32 s23, s21
 ds_read_b128 a[108:111], v7 offset:27648
 v_add_f32 v26, v24, v26
M v[204:207], a[76:79], v[60:63], v[204:207]
 s_add_u32 s21, s21, 32768
 v_exp_f32 v18, v68
M v[200:203], a[76:79], v[56:59], v[200:203]
 s_add_u32 s22, s22, 1
 ds_read_b128 a[112:115], v7 offset:28672
 v_cvt_pk_bf16_f32 v43, v24, v25
M v[200:203], a[72:75], v[48:51], v[200:203]
 s_cmp_eq_u32 s22, s25
 ds_read_b128 a[116:119], v7 offset:29696
 v_add_f32 v26, v25, v26
M v[208:211], a[80:83], v[48:51], v[208:211]
 s_cselect_b32 s21, s26, s21
 v_exp_f32 v19, v69
M v[208:211], a[84:87], v[56:59], v[208:211]
 s_cmp_eq_u32 s22, s43
 ds_read_b128 a[120:123], v7 offset:30720
 v_add_f32 v27, v18, v19
M v[212:215], a[84:87], v[60:63], v[212:215]
 s_cselect_b32 s21, s4, s21
 ds_read_b128 a[124:127], v7 offset:31744
 v_cvt_pk_bf16_f32 v44, v18, v19
M v[212:215], a[80:83], v[52:55], v[212:215]
 s_cmp_eq_u32 s22, s6
 v_exp_f32 v20, v70
M v[220:223], a[88:91], v[52:55], v[220:223]
 s_cselect_b32 s21, s7, s21
 v_exp_f32 v21, v71
M v[220:223], a[92:95], v[60:63], v[220:223]
 v_exp_f32 v22, v76
M v[216:219], a[92:95], v[56:59], v[216:219]
 s_waitcnt vmcnt(20) lgkmcnt(0)
 v_add_f32 v27, v20, v27
 v_cvt_pk_bf16_f32 v45, v20, v21
M v[216:219], a[88:91], v[48:51], v[216:219]
 s_barrier
M v[224:227], a[96:99], v[48:51], v[224:227]
 ds_read_b128 a[64:67], v7 offset:32768
 v_add_f32 v27, v21, v27
M v[224:227], a[100:103], v[56:59], v[224:227]
 ds_read_b128 a[68:71], v7 offset:33792
M v[228:231], a[100:103], v[60:63], v[228:231]
 v_exp_f32 v23, v77
M v[228:231], a[96:99], v[52:55], v[228:231]
 ds_read_b128 a[72:75], v7 offset:34816
 v_add_f32 v27, v22, v27
M v[236:239], a[104:107], v[52:55], v[236:239]
 ds_read_b128 a[76:79], v7 offset:35840
 v_cvt_pk_bf16_f32 v46, v22, v23
M v[236:239], a[108:111], v[60:63], v[236:239]
 v_exp_f32 v24, v78
M v[232:235], a[108:111], v[56:59], v[232:235]
 ds_read_b128 a[80:83], v7 offset:36864
 v_add_f32 v27, v23, v27
M v[232:235], a[104:107], v[48:51], v[232:235]
 ds_read_b128 a[84:87], v7 offset:37888
M v[240:243], a[112:115], v[48:51], v[240:243]
 v_exp_f32 v25, v79
M v[240:243], a[116:119], v[56:59], v[240:243]
 ds_read_b128 a[88:91], v7 offset:38912
 v_add_f32 v27, v24, v27
M v[244:247], a[116:119], v[60:63], v[244:247]
 ds_read_b128 a[92:95], v7 offset:39936
 v_cvt_pk_bf16_f32 v47, v24, v25
M v[244:247], a[112:115], v[52:55], v[244:247]
 v_add_f32 v27, v25, v27
M v[252:255], a[120:123], v[52:55], v[252:255]
M v[252:255], a[124:127], v[60:63], v[252:255]
M v[248:251], a[124:127], v[56:59], v[248:251]
 s_waitcnt lgkmcnt(0)
M v[248:251], a[120:123], v[48:51], v[248:251]
 s_branch L_loop_mid
L_zs0:
 s_mov_b32 s64, 65536
L_zs0_l:
 s_sleep 2
 buffer_load_dword v17, v16, s[12:15], 0 offen offset:64 sc1
 s_sub_u32 s64, s64, 1
 s_cbranch_scc1 L_zs0_x
 s_waitcnt vmcnt(0)
 v_cmp_ne_u32 vcc, 1, v17
 s_nop 0
 s_cbranch_vccnz L_zs0_l
L_zs0_x:
 s_waitcnt vmcnt(0)
 s_branch L_zr0
L_zs1:
 s_mov_b32 s64, 65536
L_zs1_l:
 s_sleep 2
 buffer_load_dword v17, v16, s[12:15], 0 offen offset:64 sc1
 s_sub_u32 s64, s64, 1
 s_cbranch_scc1 L_zs1_x
 s_waitcnt vmcnt(0)
 v_cmp_ne_u32 vcc, 1, v17
 s_nop 0
 s_cbranch_vccnz L_zs1_l
L_zs1_x:
 s_waitcnt vmcnt(0)
 s_branch L_zr1
L_hs:
 s_mov_b32 s91, 65536
L_hs_l:
 buffer_load_dwordx4 v[16:19], v7, s[8:11], s67 offen offset:0 sc1
 buffer_load_dwordx4 v[20:23], v7, s[8:11], s67 offen offset:1024 sc1
 s_waitcnt vmcnt(0)
 s_sub_u32 s91, s91, 1
 s_cbranch_scc1 L_hr
 v_min3_u32 v28, v16, v17, v18
 v_min3_u32 v28, v28, v19, v20
 v_min3_u32 v28, v28, v21, v22
 v_min_u32 v28, v28, v23
 v_cmp_eq_u32 vcc, 0, v28
 s_nop 0
 s_cbranch_vccnz L_hs_l
 s_branch L_hr
L_f1s04:
 s_mov_b32 s91, 65536
L_f1s04_l:
 s_sleep 2
 buffer_load_dword v24, v13, s[8:11], s46 offen sc1
 s_sub_u32 s91, s91, 1
 s_cbranch_scc1 L_f1s04_x
 s_waitcnt vmcnt(0)
 v_cmp_eq_u32 vcc, 0, v24
 s_nop 0
 s_cbranch_vccnz L_f1s04_l
L_f1s04_x:
 s_waitcnt vmcnt(0)
 s_branch L_f1r04
L_f1s05:
 s_mov_b32 s91, 65536
L_f1s05_l:
 s_sleep 2
 buffer_load_dword v24, v9, s[8:11], s46 offen sc1
 s_sub_u32 s91, s91, 1
 s_cbranch_scc1 L_f1s05_x
 s_waitcnt vmcnt(0)
 v_cmp_eq_u32 vcc, 0, v24
 s_nop 0
 s_cbranch_vccnz L_f1s05_l
L_f1s05_x:
 s_waitcnt vmcnt(0)
 s_branch L_f1r05
L_f1s14:
 s_mov_b32 s91, 65536
L_f1s14_l:
 s_sleep 2
 buffer_load_dword v24, v13, s[8:11], s46 offen sc1
 s_sub_u32 s91, s91, 1
 s_cbranch_scc1 L_f1s14_x
 s_waitcnt vmcnt(0)
 v_cmp_eq_u32 vcc, 0, v24
 s_nop 0
 s_cbranch_vccnz L_f1s14_l
L_f1s14_x:
 s_waitcnt vmcnt(0)
 s_branch L_f1r14
L_f1s15:
 s_mov_b32 s91, 65536
L_f1s15_l:
 s_sleep 2
 buffer_load_dword v24, v9, s[8:11], s46 offen sc1
 s_sub_u32 s91, s91, 1
 s_cbranch_scc1 L_f1s15_x
 s_waitcnt vmcnt(0)
 v_cmp_eq_u32 vcc, 0, v24
 s_nop 0
 s_cbranch_vccnz L_f1s15_l
L_f1s15_x:
 s_waitcnt vmcnt(0)
 s_branch L_f1r15
.p2align 6
L_loop_top:
M v[64:67], a[64:67], a[0:3], v[32:35]
 s_add_u32 m0, s28, 65536
 ds_read_b128 a[96:99], v2 offset:40960
M v[64:67], a[68:71], a[4:7], v[64:67]
 ds_read_b128 a[100:103], v2 offset:41984
M v[64:67], a[72:75], a[8:11], v[64:67]
 buffer_load_dword a240, v0, s[60:63], 0 offen offset:0
M v[64:67], a[76:79], a[12:15], v[64:67]
 ds_read_b128 a[104:107], v2 offset:43008
M v[64:67], a[80:83], a[16:19], v[64:67]
 ds_read_b128 a[108:111], v2 offset:44032
M v[64:67], a[84:87], a[20:23], v[64:67]
 buffer_load_dwordx4 v3, s[8:11], s24 offen offset:0 sc1 lds
M v[64:67], a[88:91], a[24:27], v[64:67]
 ds_read_b128 a[112:115], v2 offset:45056
M v[64:67], a[92:95], a[28:31], v[64:67]
 ds_read_b128 a[116:119], v2 offset:46080
M v[68:71], a[92:95], a[60:63], v[36:39]
 buffer_load_dwordx4 v3, s[8:11], s24 offen offset:1024 sc1 lds
M v[68:71], a[88:91], a[56:59], v[68:71]
 ds_read_b128 a[120:123], v2 offset:47104
M v[68:71], a[84:87], a[52:55], v[68:71]
 ds_read_b128 a[124:127], v2 offset:48128
M v[68:71], a[80:83], a[48:51], v[68:71]
 v_exp_f32 v18, v112
M v[68:71], a[76:79], a[44:47], v[68:71]
 buffer_load_dwordx4 v3, s[8:11], s24 offen offset:2048 sc1 lds
M v[68:71], a[72:75], a[40:43], v[68:71]
 v_exp_f32 v19, v113
M v[68:71], a[68:71], a[36:39], v[68:71]
 v_exp_f32 v20, v114
M v[68:71], a[64:67], a[32:35], v[68:71]
 s_waitcnt lgkmcnt(0)
 v_exp_f32 v21, v115
M v[76:79], a[96:99], a[32:35], v[36:39]
 ds_read_b128 a[64:67], v2 offset:49152
 v_add_f32 v28, v18, v28
M v[76:79], a[100:103], a[36:39], v[76:79]
 ds_read_b128 a[68:71], v2 offset:50176
 v_cvt_pk_bf16_f32 v56, v18, v19
M v[76:79], a[104:107], a[40:43], v[76:79]
 buffer_load_dwordx4 v3, s[8:11], s24 offen offset:3072 sc1 lds
M v[76:79], a[108:111], a[44:47], v[76:79]
 ds_read_b128 a[72:75], v2 offset:51200
 v_add_f32 v28, v19, v28
M v[76:79], a[112:115], a[48:51], v[76:79]
 ds_read_b128 a[76:79], v2 offset:52224
 v_add_f32 v28, v20, v28
M v[76:79], a[116:119], a[52:55], v[76:79]
 v_exp_f32 v22, v120
M v[76:79], a[120:123], a[56:59], v[76:79]
 s_add_u32 m0, s28, 69632
 ds_read_b128 a[80:83], v2 offset:53248
 v_cvt_pk_bf16_f32 v57, v20, v21
M v[76:79], a[124:127], a[60:63], v[76:79]
 ds_read_b128 a[84:87], v2 offset:54272
 v_add_f32 v28, v21, v28
M v[72:75], a[124:127], a[28:31], v[32:35]
 buffer_load_dwordx4 v4, s[8:11], s24 offen offset:0 sc1 lds
M v[72:75], a[120:123], a[24:27], v[72:75]
 ds_read_b128 a[88:91], v2 offset:55296
M v[72:75], a[116:119], a[20:23], v[72:75]
 ds_read_b128 a[92:95], v2 offset:56320
M v[72:75], a[112:115], a[16:19], v[72:75]
 v_exp_f32 v23, v121
M v[72:75], a[108:111], a[12:15], v[72:75]
 buffer_load_dwordx4 v4, s[8:11], s24 offen offset:1024 sc1 lds
M v[72:75], a[104:107], a[8:11], v[72:75]
 v_exp_f32 v24, v122
M v[72:75], a[100:103], a[4:7], v[72:75]
 v_exp_f32 v25, v123
M v[72:75], a[96:99], a[0:3], v[72:75]
 s_waitcnt lgkmcnt(0)
 v_exp_f32 v18, v116
M v[80:83], a[64:67], a[0:3], v[32:35]
 ds_read_b128 a[96:99], v2 offset:57344
 v_add_f32 v28, v22, v28
M v[80:83], a[68:71], a[4:7], v[80:83]
 ds_read_b128 a[100:103], v2 offset:58368
 v_cvt_pk_bf16_f32 v58, v22, v23
M v[80:83], a[72:75], a[8:11], v[80:83]
 buffer_load_dwordx4 v4, s[8:11], s24 offen offset:2048 sc1 lds
M v[80:83], a[76:79], a[12:15], v[80:83]
 ds_read_b128 a[104:107], v2 offset:59392
 v_add_f32 v28, v23, v28
M v[80:83], a[80:83], a[16:19], v[80:83]
 ds_read_b128 a[108:111], v2 offset:60416
 v_add_f32 v28, v24, v28
M v[80:83], a[84:87], a[20:23], v[80:83]
 v_exp_f32 v19, v117
M v[80:83], a[88:91], a[24:27], v[80:83]
 ds_read_b128 a[112:115], v2 offset:61440
 v_cvt_pk_bf16_f32 v59, v24, v25
M v[80:83], a[92:95], a[28:31], v[80:83]
 ds_read_b128 a[116:119], v2 offset:62464
 v_add_f32 v28, v25, v28
M v[84:87], a[92:95], a[60:63], v[36:39]
 buffer_load_dwordx4 v4, s[8:11], s24 offen offset:3072 sc1 lds
M v[84:87], a[88:91], a[56:59], v[84:87]
 ds_read_b128 a[120:123], v2 offset:63488
 v_add_f32 v29, v18, v29
M v[84:87], a[84:87], a[52:55], v[84:87]
 ds_read_b128 a[124:127], v2 offset:64512
 v_cvt_pk_bf16_f32 v60, v18, v19
M v[84:87], a[80:83], a[48:51], v[84:87]
 v_exp_f32 v20, v118
M v[84:87], a[76:79], a[44:47], v[84:87]
 v_exp_f32 v21, v119
M v[84:87], a[72:75], a[40:43], v[84:87]
 v_exp_f32 v22, v124
M v[84:87], a[68:71], a[36:39], v[84:87]
 s_waitcnt vmcnt(17) lgkmcnt(0)
 v_exp_f32 v23, v125
M v[84:87], a[64:67], a[32:35], v[84:87]
 s_barrier
M v[92:95], a[96:99], a[32:35], v[36:39]
 ds_read_b128 a[64:67], v7 offset:0
 v_add_f32 v29, v19, v29
M v[92:95], a[100:103], a[36:39], v[92:95]
 ds_read_b128 a[68:71], v7 offset:1024
 v_add_f32 v29, v20, v29
M v[92:95], a[104:107], a[40:43], v[92:95]
 v_exp_f32 v24, v126
M v[92:95], a[108:111], a[44:47], v[92:95]
 ds_read_b128 a[72:75], v7 offset:2048
 v_cvt_pk_bf16_f32 v61, v20, v21
M v[92:95], a[112:115], a[48:51], v[92:95]
 ds_read_b128 a[76:79], v7 offset:3072
 v_add_f32 v29, v21, v29
M v[92:95], a[116:119], a[52:55], v[92:95]
 v_exp_f32 v25, v127
M v[92:95], a[120:123], a[56:59], v[92:95]
 ds_read_b128 a[80:83], v7 offset:4096
 v_add_f32 v29, v22, v29
M v[92:95], a[124:127], a[60:63], v[92:95]
 ds_read_b128 a[84:87], v7 offset:5120
 v_cvt_pk_bf16_f32 v62, v22, v23
M v[88:91], a[124:127], a[28:31], v[32:35]
 v_add_f32 v29, v23, v29
 v_add_f32 v29, v24, v29
M v[88:91], a[120:123], a[24:27], v[88:91]
 ds_read_b128 a[88:91], v7 offset:6144
 v_cvt_pk_bf16_f32 v63, v24, v25
M v[88:91], a[116:119], a[20:23], v[88:91]
 ds_read_b128 a[92:95], v7 offset:7168
 v_add_f32 v29, v25, v29
M v[88:91], a[112:115], a[16:19], v[88:91]
 v_max_f32 v10, v28, v29
M v[88:91], a[108:111], a[12:15], v[88:91]
 v_cmp_lt_f32 vcc, s31, v10
M v[88:91], a[104:107], a[8:11], v[88:91]
M v[88:91], a[100:103], a[4:7], v[88:91]
 s_waitcnt lgkmcnt(0)
M v[88:91], a[96:99], a[0:3], v[88:91]
 s_cbranch_vccnz L_st1
L_rt1:
M v[128:131], a[64:67], v[48:51], v[128:131]
 s_add_u32 m0, s28, 98304
 ds_read_b128 a[96:99], v7 offset:8192
 v_add_f32 v30, v28, v30
M v[128:131], a[68:71], v[56:59], v[128:131]
 ds_read_b128 a[100:103], v7 offset:9216
 v_add_f32 v31, v29, v31
M v[132:135], a[68:71], v[60:63], v[132:135]
 buffer_load_dwordx4 v3, s[8:11], s21 offen offset:0 sc1 lds
M v[132:135], a[64:67], v[52:55], v[132:135]
 ds_read_b128 a[104:107], v7 offset:10240
M v[140:143], a[72:75], v[52:55], v[140:143]
 ds_read_b128 a[108:111], v7 offset:11264
M v[140:143], a[76:79], v[60:63], v[140:143]
 buffer_load_dwordx4 v3, s[8:11], s21 offen offset:1024 sc1 lds
M v[136:139], a[76:79], v[56:59], v[136:139]
 ds_read_b128 a[112:115], v7 offset:12288
M v[136:139], a[72:75], v[48:51], v[136:139]
 ds_read_b128 a[116:119], v7 offset:13312
M v[144:147], a[80:83], v[48:51], v[144:147]
 v_exp_f32 v18, v64
M v[144:147], a[84:87], v[56:59], v[144:147]
 ds_read_b128 a[120:123], v7 offset:14336
M v[148:151], a[84:87], v[60:63], v[148:151]
 ds_read_b128 a[124:127], v7 offset:15360
M v[148:151], a[80:83], v[52:55], v[148:151]
 buffer_load_dwordx4 v3, s[8:11], s21 offen offset:2048 sc1 lds
M v[156:159], a[88:91], v[52:55], v[156:159]
 v_exp_f32 v19, v65
M v[156:159], a[92:95], v[60:63], v[156:159]
 v_exp_f32 v20, v66
M v[152:155], a[92:95], v[56:59], v[152:155]
 buffer_load_dwordx4 v3, s[8:11], s21 offen offset:3072 sc1 lds
M v[152:155], a[88:91], v[48:51], v[152:155]
 s_waitcnt lgkmcnt(0)
 v_exp_f32 v21, v67
M v[160:163], a[96:99], v[48:51], v[160:163]
 ds_read_b128 a[64:67], v7 offset:16384
 v_add_f32 v26, v18, v19
M v[160:163], a[100:103], v[56:59], v[160:163]
 s_add_u32 m0, s28, 102400
 ds_read_b128 a[68:71], v7 offset:17408
 v_cvt_pk_bf16_f32 v40, v18, v19
M v[164:167], a[100:103], v[60:63], v[164:167]
 buffer_load_dwordx4 v4, s[8:11], s21 offen offset:0 sc1 lds
M v[164:167], a[96:99], v[52:55], v[164:167]
 ds_read_b128 a[72:75], v7 offset:18432
 v_add_f32 v26, v20, v26
M v[172:175], a[104:107], v[52:55], v[172:175]
 ds_read_b128 a[76:79], v7 offset:19456
 v_cvt_pk_bf16_f32 v41, v20, v21
M v[172:175], a[108:111], v[60:63], v[172:175]
 v_exp_f32 v22, v72
M v[168:171], a[108:111], v[56:59], v[168:171]
 ds_read_b128 a[80:83], v7 offset:20480
 v_add_f32 v26, v21, v26
M v[168:171], a[104:107], v[48:51], v[168:171]
 ds_read_b128 a[84:87], v7 offset:21504
M v[176:179], a[112:115], v[48:51], v[176:179]
 buffer_load_dwordx4 v4, s[8:11], s21 offen offset:1024 sc1 lds
M v[176:179], a[116:119], v[56:59], v[176:179]
 ds_read_b128 a[88:91], v7 offset:22528
M v[180:183], a[116:119], v[60:63], v[180:183]
 ds_read_b128 a[92:95], v7 offset:23552
M v[180:183], a[112:115], v[52:55], v[180:183]
 buffer_load_dwordx4 v4, s[8:11], s21 offen offset:2048 sc1 lds
M v[188:191], a[120:123], v[52:55], v[188:191]
 v_exp_f32 v23, v73
M v[188:191], a[124:127], v[60:63], v[188:191]
 v_exp_f32 v24, v74
M v[184:187], a[124:127], v[56:59], v[184:187]
 v_exp_f32 v25, v75
M v[184:187], a[120:123], v[48:51], v[184:187]
 s_waitcnt lgkmcnt(0)
 v_exp_f32 v18, v68
M v[192:195], a[64:67], v[48:51], v[192:195]
 ds_read_b128 a[96:99], v7 offset:24576
 v_add_f32 v26, v22, v26
M v[192:195], a[68:71], v[56:59], v[192:195]
 ds_read_b128 a[100:103], v7 offset:25600
 v_cvt_pk_bf16_f32 v42, v22, v23
M v[196:199], a[68:71], v[60:63], v[196:199]
 buffer_load_dwordx4 v4, s[8:11], s21 offen offset:3072 sc1 lds
M v[196:199], a[64:67], v[52:55], v[196:199]
 s_add_u32 s24, s23, 16777216
 ds_read_b128 a[104:107], v7 offset:26624
 v_add_f32 v26, v23, v26
M v[204:207], a[72:75], v[52:55], v[204:207]
 s_mov_b32 s23, s21
 ds_read_b128 a[108:111], v7 offset:27648
 v_add_f32 v26, v24, v26
M v[204:207], a[76:79], v[60:63], v[204:207]
 s_add_u32 s21, s21, 32768
 v_exp_f32 v19, v69
M v[200:203], a[76:79], v[56:59], v[200:203]
 s_add_u32 s22, s22, 1
 ds_read_b128 a[112:115], v7 offset:28672
 v_cvt_pk_bf16_f32 v43, v24, v25
M v[200:203], a[72:75], v[48:51], v[200:203]
 s_cmp_eq_u32 s22, s25
 ds_read_b128 a[116:119], v7 offset:29696
 v_add_f32 v26, v25, v26
M v[208:211], a[80:83], v[48:51], v[208:211]
 s_cselect_b32 s21, s26, s21
 v_exp_f32 v20, v70
M v[208:211], a[84:87], v[56:59], v[208:211]
 s_cmp_eq_u32 s22, s43
 ds_read_b128 a[120:123], v7 offset:30720
 v_add_f32 v27, v18, v19
M v[212:215], a[84:87], v[60:63], v[212:215]
 s_cselect_b32 s21, s4, s21
 ds_read_b128 a[124:127], v7 offset:31744
 v_cvt_pk_bf16_f32 v44, v18, v19
M v[212:215], a[80:83], v[52:55], v[212:215]
 s_cmp_eq_u32 s22, s6
 v_exp_f32 v21, v71
M v[220:223], a[88:91], v[52:55], v[220:223]
 s_cselect_b32 s21, s7, s21
 v_exp_f32 v22, v76
M v[220:223], a[92:95], v[60:63], v[220:223]
 v_add_f32 v27, v20, v27
 v_cvt_pk_bf16_f32 v45, v20, v21
M v[216:219], a[92:95], v[56:59], v[216:219]
 s_waitcnt vmcnt(17) lgkmcnt(0)
 v_add_f32 v27, v21, v27
M v[216:219], a[88:91], v[48:51], v[216:219]
 s_barrier
M v[224:227], a[96:99], v[48:51], v[224:227]
 ds_read_b128 a[64:67], v7 offset:32768
M v[224:227], a[100:103], v[56:59], v[224:227]
 ds_read_b128 a[68:71], v7 offset:33792
M v[228:231], a[100:103], v[60:63], v[228:231]
 v_exp_f32 v23, v77
M v[228:231], a[96:99], v[52:55], v[228:231]
 ds_read_b128 a[72:75], v7 offset:34816
 v_add_f32 v27, v22, v27
M v[236:239], a[104:107], v[52:55], v[236:239]
 ds_read_b128 a[76:79], v7 offset:35840
 v_cvt_pk_bf16_f32 v46, v22, v23
M v[236:239], a[108:111], v[60:63], v[236:239]
 v_exp_f32 v24, v78
M v[232:235], a[108:111], v[56:59], v[232:235]
 ds_read_b128 a[80:83], v7 offset:36864
 v_add_f32 v27, v23, v27
M v[232:235], a[104:107], v[48:51], v[232:235]
 ds_read_b128 a[84:87], v7 offset:37888
M v[240:243], a[112:115], v[48:51], v[240:243]
 v_exp_f32 v25, v79
M v[240:243], a[116:119], v[56:59], v[240:243]
 ds_read_b128 a[88:91], v7 offset:38912
 v_add_f32 v27, v24, v27
M v[244:247], a[116:119], v[60:63], v[244:247]
 ds_read_b128 a[92:95], v7 offset:39936
 v_cvt_pk_bf16_f32 v47, v24, v25
M v[244:247], a[112:115], v[52:55], v[244:247]
 v_add_f32 v27, v25, v27
M v[252:255], a[120:123], v[52:55], v[252:255]
M v[252:255], a[124:127], v[60:63], v[252:255]
M v[248:251], a[124:127], v[56:59], v[248:251]
 s_waitcnt lgkmcnt(0)
M v[248:251], a[120:123], v[48:51], v[248:251]
L_loop_mid:
M v[96:99], a[64:67], a[0:3], v[32:35]
 s_and_b32 s39, s54, 15
 ds_read_b128 a[96:99], v7 offset:40960
M v[96:99], a[68:71], a[4:7], v[96:99]
 s_cbranch_scc1 L_fll
L_fllr:
 ds_read_b128 a[100:103], v7 offset:41984
M v[96:99], a[72:75], a[8:11], v[96:99]
 s_lshr_b32 s54, s54, 4
 v_exp_f32 v18, v80
M v[96:99], a[76:79], a[12:15], v[96:99]
 s_add_u32 m0, s28, 0
 ds_read_b128 a[104:107], v7 offset:43008
M v[96:99], a[80:83], a[16:19], v[96:99]
 ds_read_b128 a[108:111], v7 offset:44032
M v[96:99], a[84:87], a[20:23], v[96:99]
 buffer_load_dwordx4 v3, s[8:11], s24 offen offset:0 sc1 lds
M v[96:99], a[88:91], a[24:27], v[96:99]
 ds_read_b128 a[112:115], v7 offset:45056
M v[96:99], a[92:95], a[28:31], v[96:99]
 ds_read_b128 a[116:119], v7 offset:46080
M v[100:103], a[92:95], a[60:63], v[36:39]
 v_exp_f32 v19, v81
M v[100:103], a[88:91], a[56:59], v[100:103]
 ds_read_b128 a[120:123], v7 offset:47104
 v_add_f32 v26, v18, v26
M v[100:103], a[84:87], a[52:55], v[100:103]
 ds_read_b128 a[124:127], v7 offset:48128
 v_cvt_pk_bf16_f32 v56, v18, v19
M v[100:103], a[80:83], a[48:51], v[100:103]
 buffer_load_dwordx4 v3, s[8:11], s24 offen offset:1024 sc1 lds
M v[100:103], a[76:79], a[44:47], v[100:103]
 v_exp_f32 v20, v82
M v[100:103], a[72:75], a[40:43], v[100:103]
 v_exp_f32 v21, v83
M v[100:103], a[68:71], a[36:39], v[100:103]
 buffer_load_dwordx4 v3, s[8:11], s24 offen offset:2048 sc1 lds
M v[100:103], a[64:67], a[32:35], v[100:103]
 s_waitcnt lgkmcnt(0)
 v_exp_f32 v22, v88
M v[108:111], a[96:99], a[32:35], v[36:39]
 ds_read_b128 a[64:67], v7 offset:49152
 v_add_f32 v26, v19, v26
M v[108:111], a[100:103], a[36:39], v[108:111]
 ds_read_b128 a[68:71], v7 offset:50176
 v_add_f32 v26, v20, v26
M v[108:111], a[104:107], a[40:43], v[108:111]
 v_exp_f32 v23, v89
M v[108:111], a[108:111], a[44:47], v[108:111]
 ds_read_b128 a[72:75], v7 offset:51200
 v_cvt_pk_bf16_f32 v57, v20, v21
M v[108:111], a[112:115], a[48:51], v[108:111]
 ds_read_b128 a[76:79], v7 offset:52224
 v_add_f32 v26, v21, v26
M v[108:111], a[116:119], a[52:55], v[108:111]
 buffer_load_dwordx4 v3, s[8:11], s24 offen offset:3072 sc1 lds
M v[108:111], a[120:123], a[56:59], v[108:111]
 ds_read_b128 a[80:83], v7 offset:53248
 v_add_f32 v26, v22, v26
M v[108:111], a[124:127], a[60:63], v[108:111]
 s_add_u32 m0, s28, 4096
 ds_read_b128 a[84:87], v7 offset:54272
 v_cvt_pk_bf16_f32 v58, v22, v23
M v[104:107], a[124:127], a[28:31], v[32:35]
 buffer_load_dwordx4 v4, s[8:11], s24 offen offset:0 sc1 lds
M v[104:107], a[120:123], a[24:27], v[104:107]
 ds_read_b128 a[88:91], v7 offset:55296
 v_add_f32 v26, v23, v26
M v[104:107], a[116:119], a[20:23], v[104:107]
 ds_read_b128 a[92:95], v7 offset:56320
M v[104:107], a[112:115], a[16:19], v[104:107]
 v_exp_f32 v24, v90
M v[104:107], a[108:111], a[12:15], v[104:107]
 v_exp_f32 v25, v91
M v[104:107], a[104:107], a[8:11], v[104:107]
 buffer_load_dwordx4 v4, s[8:11], s24 offen offset:1024 sc1 lds
M v[104:107], a[100:103], a[4:7], v[104:107]
 v_exp_f32 v18, v84
M v[104:107], a[96:99], a[0:3], v[104:107]
 s_waitcnt lgkmcnt(0)
 v_exp_f32 v19, v85
M v[112:115], a[64:67], a[0:3], v[32:35]
 ds_read_b128 a[96:99], v7 offset:57344
 v_add_f32 v26, v24, v26
M v[112:115], a[68:71], a[4:7], v[112:115]
 ds_read_b128 a[100:103], v7 offset:58368
 v_cvt_pk_bf16_f32 v59, v24, v25
M v[112:115], a[72:75], a[8:11], v[112:115]
 buffer_load_dwordx4 v4, s[8:11], s24 offen offset:2048 sc1 lds
M v[112:115], a[76:79], a[12:15], v[112:115]
 ds_read_b128 a[104:107], v7 offset:59392
 v_add_f32 v26, v25, v26
M v[112:115], a[80:83], a[16:19], v[112:115]
 ds_read_b128 a[108:111], v7 offset:60416
 v_add_f32 v27, v18, v27
M v[112:115], a[84:87], a[20:23], v[112:115]
 v_exp_f32 v20, v86
M v[112:115], a[88:91], a[24:27], v[112:115]
 ds_read_b128 a[112:115], v7 offset:61440
 v_cvt_pk_bf16_f32 v60, v18, v19
M v[112:115], a[92:95], a[28:31], v[112:115]
 ds_read_b128 a[116:119], v7 offset:62464
 v_add_f32 v27, v19, v27
M v[116:119], a[92:95], a[60:63], v[36:39]
 buffer_load_dwordx4 v4, s[8:11], s24 offen offset:3072 sc1 lds
M v[116:119], a[88:91], a[56:59], v[116:119]
 ds_read_b128 a[120:123], v7 offset:63488
M v[116:119], a[84:87], a[52:55], v[116:119]
 ds_read_b128 a[124:127], v7 offset:64512
M v[116:119], a[80:83], a[48:51], v[116:119]
 v_exp_f32 v21, v87
M v[116:119], a[76:79], a[44:47], v[116:119]
 v_exp_f32 v22, v92
M v[116:119], a[72:75], a[40:43], v[116:119]
 v_exp_f32 v23, v93
M v[116:119], a[68:71], a[36:39], v[116:119]
 s_waitcnt vmcnt(16) lgkmcnt(0)
 v_add_f32 v27, v20, v27
 v_cvt_pk_bf16_f32 v61, v20, v21
M v[116:119], a[64:67], a[32:35], v[116:119]
 s_barrier
M v[124:127], a[96:99], a[32:35], v[36:39]
 ds_read_b128 a[64:67], v2 offset:0
 v_add_f32 v27, v21, v27
M v[124:127], a[100:103], a[36:39], v[124:127]
 ds_read_b128 a[68:71], v2 offset:1024
 v_add_f32 v27, v22, v27
M v[124:127], a[104:107], a[40:43], v[124:127]
 v_exp_f32 v24, v94
M v[124:127], a[108:111], a[44:47], v[124:127]
 ds_read_b128 a[72:75], v2 offset:2048
 v_cvt_pk_bf16_f32 v62, v22, v23
M v[124:127], a[112:115], a[48:51], v[124:127]
 ds_read_b128 a[76:79], v2 offset:3072
 v_add_f32 v27, v23, v27
M v[124:127], a[116:119], a[52:55], v[124:127]
 v_exp_f32 v25, v95
M v[124:127], a[120:123], a[56:59], v[124:127]
 ds_read_b128 a[80:83], v2 offset:4096
 v_add_f32 v27, v24, v27
M v[124:127], a[124:127], a[60:63], v[124:127]
 ds_read_b128 a[84:87], v2 offset:5120
 v_cvt_pk_bf16_f32 v63, v24, v25
M v[120:123], a[124:127], a[28:31], v[32:35]
 v_add_f32 v27, v25, v27
M v[120:123], a[120:123], a[24:27], v[120:123]
 ds_read_b128 a[88:91], v2 offset:6144
M v[120:123], a[116:119], a[20:23], v[120:123]
 ds_read_b128 a[92:95], v2 offset:7168
 v_max_f32 v10, v26, v27
M v[120:123], a[112:115], a[16:19], v[120:123]
 v_cmp_lt_f32 vcc, s31, v10
M v[120:123], a[108:111], a[12:15], v[120:123]
M v[120:123], a[104:107], a[8:11], v[120:123]
M v[120:123], a[100:103], a[4:7], v[120:123]
 s_waitcnt lgkmcnt(0)
M v[120:123], a[96:99], a[0:3], v[120:123]
 s_cbranch_vccnz L_st0
L_rt0:
M v[128:131], a[64:67], v[40:43], v[128:131]
 s_add_u32 m0, s28, 32768
 ds_read_b128 a[96:99], v2 offset:8192
 v_add_f32 v30, v26, v30
M v[128:131], a[68:71], v[56:59], v[128:131]
 ds_read_b128 a[100:103], v2 offset:9216
 v_add_f32 v31, v27, v31
M v[132:135], a[68:71], v[60:63], v[132:135]
 buffer_load_dwordx4 v3, s[8:11], s21 offen offset:0 sc1 lds
M v[132:135], a[64:67], v[44:47], v[132:135]
 ds_read_b128 a[104:107], v2 offset:10240
M v[140:143], a[72:75], v[44:47], v[140:143]
 ds_read_b128 a[108:111], v2 offset:11264
M v[140:143], a[76:79], v[60:63], v[140:143]
 buffer_load_dwordx4 v3, s[8:11], s21 offen offset:1024 sc1 lds
M v[136:139], a[76:79], v[56:59], v[136:139]
 ds_read_b128 a[112:115], v2 offset:12288
M v[136:139], a[72:75], v[40:43], v[136:139]
 ds_read_b128 a[116:119], v2 offset:13312
M v[144:147], a[80:83], v[40:43], v[144:147]
 v_exp_f32 v18, v96
M v[144:147], a[84:87], v[56:59], v[144:147]
 ds_read_b128 a[120:123], v2 offset:14336
M v[148:151], a[84:87], v[60:63], v[148:151]
 ds_read_b128 a[124:127], v2 offset:15360
M v[148:151], a[80:83], v[44:47], v[148:151]
 buffer_load_dwordx4 v3, s[8:11], s21 offen offset:2048 sc1 lds
M v[156:159], a[88:91], v[44:47], v[156:159]
 v_exp_f32 v19, v97
M v[156:159], a[92:95], v[60:63], v[156:159]
 v_exp_f32 v20, v98
M v[152:155], a[92:95], v[56:59], v[152:155]
 buffer_load_dwordx4 v3, s[8:11], s21 offen offset:3072 sc1 lds
M v[152:155], a[88:91], v[40:43], v[152:155]
 s_waitcnt lgkmcnt(0)
 v_exp_f32 v21, v99
M v[160:163], a[96:99], v[40:43], v[160:163]
 ds_read_b128 a[64:67], v2 offset:16384
 v_add_f32 v28, v18, v19
M v[160:163], a[100:103], v[56:59], v[160:163]
 s_add_u32 m0, s28, 36864
 ds_read_b128 a[68:71], v2 offset:17408
 v_cvt_pk_bf16_f32 v48, v18, v19
M v[164:167], a[100:103], v[60:63], v[164:167]
 buffer_load_dwordx4 v4, s[8:11], s21 offen offset:0 sc1 lds
M v[164:167], a[96:99], v[44:47], v[164:167]
 ds_read_b128 a[72:75], v2 offset:18432
 v_add_f32 v28, v20, v28
M v[172:175], a[104:107], v[44:47], v[172:175]
 ds_read_b128 a[76:79], v2 offset:19456
 v_cvt_pk_bf16_f32 v49, v20, v21
M v[172:175], a[108:111], v[60:63], v[172:175]
 v_exp_f32 v22, v104
M v[168:171], a[108:111], v[56:59], v[168:171]
 ds_read_b128 a[80:83], v2 offset:20480
 v_add_f32 v28, v21, v28
M v[168:171], a[104:107], v[40:43], v[168:171]
 ds_read_b128 a[84:87], v2 offset:21504
M v[176:179], a[112:115], v[40:43], v[176:179]
 buffer_load_dwordx4 v4, s[8:11], s21 offen offset:1024 sc1 lds
M v[176:179], a[116:119], v[56:59], v[176:179]
 ds_read_b128 a[88:91], v2 offset:22528
M v[180:183], a[116:119], v[60:63], v[180:183]
 ds_read_b128 a[92:95], v2 offset:23552
M v[180:183], a[112:115], v[44:47], v[180:183]
 buffer_load_dwordx4 v4, s[8:11], s21 offen offset:2048 sc1 lds
M v[188:191], a[120:123], v[44:47], v[188:191]
 v_exp_f32 v23, v105
M v[188:191], a[124:127], v[60:63], v[188:191]
 v_exp_f32 v24, v106
M v[184:187], a[124:127], v[56:59], v[184:187]
 v_exp_f32 v25, v107
M v[184:187], a[120:123], v[40:43], v[184:187]
 s_waitcnt lgkmcnt(0)
 v_exp_f32 v18, v100
M v[192:195], a[64:67], v[40:43], v[192:195]
 ds_read_b128 a[96:99], v2 offset:24576
 v_add_f32 v28, v22, v28
M v[192:195], a[68:71], v[56:59], v[192:195]
 ds_read_b128 a[100:103], v2 offset:25600
 v_cvt_pk_bf16_f32 v50, v22, v23
M v[196:199], a[68:71], v[60:63], v[196:199]
 buffer_load_dwordx4 v4, s[8:11], s21 offen offset:3072 sc1 lds
M v[196:199], a[64:67], v[44:47], v[196:199]
 s_add_u32 s24, s23, 16777216
 ds_read_b128 a[104:107], v2 offset:26624
 v_add_f32 v28, v23, v28
M v[204:207], a[72:75], v[44:47], v[204:207]
 s_mov_b32 s23, s21
 ds_read_b128 a[108:111], v2 offset:27648
 v_add_f32 v28, v24, v28
M v[204:207], a[76:79], v[60:63], v[204:207]
 s_add_u32 s21, s21, 32768
 v_exp_f32 v19, v101
M v[200:203], a[76:79], v[56:59], v[200:203]
 s_add_u32 s22, s22, 1
 ds_read_b128 a[112:115], v2 offset:28672
 v_cvt_pk_bf16_f32 v51, v24, v25
M v[200:203], a[72:75], v[40:43], v[200:203]
 s_cmp_eq_u32 s22, s25
 ds_read_b128 a[116:119], v2 offset:29696
 v_add_f32 v28, v25, v28
M v[208:211], a[80:83], v[40:43], v[208:211]
 s_cselect_b32 s21, s26, s21
 v_exp_f32 v20, v102
M v[208:211], a[84:87], v[56:59], v[208:211]
 s_cmp_eq_u32 s22, s43
 ds_read_b128 a[120:123], v2 offset:30720
 v_add_f32 v29, v18, v19
M v[212:215], a[84:87], v[60:63], v[212:215]
 s_cselect_b32 s21, s4, s21
 ds_read_b128 a[124:127], v2 offset:31744
 v_cvt_pk_bf16_f32 v52, v18, v19
M v[212:215], a[80:83], v[44:47], v[212:215]
 s_cmp_eq_u32 s22, s6
 v_exp_f32 v21, v103
M v[220:223], a[88:91], v[44:47], v[220:223]
 s_cselect_b32 s21, s7, s21
 v_exp_f32 v22, v108
M v[220:223], a[92:95], v[60:63], v[220:223]
 v_add_f32 v29, v20, v29
 v_cvt_pk_bf16_f32 v53, v20, v21
M v[216:219], a[92:95], v[56:59], v[216:219]
 s_waitcnt vmcnt(16) lgkmcnt(0)
 v_exp_f32 v23, v109
M v[216:219], a[88:91], v[40:43], v[216:219]
 s_barrier
M v[224:227], a[96:99], v[40:43], v[224:227]
 ds_read_b128 a[64:67], v2 offset:32768
 v_add_f32 v29, v21, v29
M v[224:227], a[100:103], v[56:59], v[224:227]
 ds_read_b128 a[68:71], v2 offset:33792
 v_add_f32 v29, v22, v29
M v[228:231], a[100:103], v[60:63], v[228:231]
 v_cmp_gt_u32 vcc, s39, v6
 v_cvt_pk_bf16_f32 v54, v22, v23
M v[228:231], a[96:99], v[44:47], v[228:231]
 ds_read_b128 a[72:75], v2 offset:34816
 v_add_f32 v29, v23, v29
M v[236:239], a[104:107], v[44:47], v[236:239]
 ds_read_b128 a[76:79], v2 offset:35840
M v[236:239], a[108:111], v[60:63], v[236:239]
 s_cbranch_vccnz L_fls0
L_flr0:
 v_exp_f32 v24, v110
M v[232:235], a[108:111], v[56:59], v[232:235]
 s_and_b32 s3, s5, 15
 ds_read_b128 a[80:83], v2 offset:36864
M v[232:235], a[104:107], v[40:43], v[232:235]
 s_cbranch_scc1 L_pub3
L_pub3r:
 ds_read_b128 a[84:87], v2 offset:37888
M v[240:243], a[112:115], v[40:43], v[240:243]
 s_lshr_b32 s5, s5, 4
 v_exp_f32 v25, v111
M v[240:243], a[116:119], v[56:59], v[240:243]
 ds_read_b128 a[88:91], v2 offset:38912
 v_add_f32 v29, v24, v29
M v[244:247], a[116:119], v[60:63], v[244:247]
 ds_read_b128 a[92:95], v2 offset:39936
 v_cvt_pk_bf16_f32 v55, v24, v25
M v[244:247], a[112:115], v[44:47], v[244:247]
 v_add_f32 v29, v25, v29
M v[252:255], a[120:123], v[44:47], v[252:255]
 s_sub_u32 s27, s27, 1
M v[252:255], a[124:127], v[60:63], v[252:255]
 s_cmp_lg_u32 s27, 0
M v[248:251], a[124:127], v[56:59], v[248:251]
 s_waitcnt lgkmcnt(0)
M v[248:251], a[120:123], v[40:43], v[248:251]
 s_cbranch_scc1 L_loop_top
L_p1:
 s_cmp_eq_u32 s40, 0
 s_cbranch_scc1 L_final_h
 s_cmp_ge_u32 s42, 10
 s_cbranch_scc1 L_p1c
 v_cndmask_b32 v64, v32, v8, s[64:65]
 v_cndmask_b32 v65, v32, v8, s[66:67]
 v_cndmask_b32 v66, v32, v8, s[68:69]
 v_cndmask_b32 v67, v32, v8, s[70:71]
 s_nop 1
M v[64:67], a[64:67], a[0:3], v[64:67]
 s_add_u32 m0, s28, 65536
 ds_read_b128 a[96:99], v2 offset:40960
 v_cndmask_b32 v72, v32, v8, s[72:73]
M v[64:67], a[68:71], a[4:7], v[64:67]
 ds_read_b128 a[100:103], v2 offset:41984
 v_cndmask_b32 v73, v32, v8, s[74:75]
M v[64:67], a[72:75], a[8:11], v[64:67]
 buffer_load_dwordx4 v3, s[8:11], s24 offen offset:0 sc1 lds
M v[64:67], a[76:79], a[12:15], v[64:67]
 ds_read_b128 a[104:107], v2 offset:43008
 v_cndmask_b32 v74, v32, v8, s[76:77]
M v[64:67], a[80:83], a[16:19], v[64:67]
 ds_read_b128 a[108:111], v2 offset:44032
 v_cndmask_b32 v75, v32, v8, s[78:79]
M v[64:67], a[84:87], a[20:23], v[64:67]
 v_exp_f32 v18, v112
M v[64:67], a[88:91], a[24:27], v[64:67]
 ds_read_b128 a[112:115], v2 offset:45056
M v[64:67], a[92:95], a[28:31], v[64:67]
 ds_read_b128 a[116:119], v2 offset:46080
M v[68:71], a[92:95], a[60:63], v[36:39]
 buffer_load_dwordx4 v3, s[8:11], s24 offen offset:1024 sc1 lds
M v[68:71], a[88:91], a[56:59], v[68:71]
 ds_read_b128 a[120:123], v2 offset:47104
M v[68:71], a[84:87], a[52:55], v[68:71]
 ds_read_b128 a[124:127], v2 offset:48128
M v[68:71], a[80:83], a[48:51], v[68:71]
 v_exp_f32 v19, v113
M v[68:71], a[76:79], a[44:47], v[68:71]
 buffer_load_dwordx4 v3, s[8:11], s24 offen offset:2048 sc1 lds
M v[68:71], a[72:75], a[40:43], v[68:71]
 v_exp_f32 v20, v114
M v[68:71], a[68:71], a[36:39], v[68:71]
 v_exp_f32 v21, v115
M v[68:71], a[64:67], a[32:35], v[68:71]
 s_waitcnt lgkmcnt(0)
 v_exp_f32 v22, v120
M v[72:75], a[96:99], a[0:3], v[72:75]
 ds_read_b128 a[64:67], v2 offset:49152
 v_cndmask_b32 v80, v32, v8, s[80:81]
M v[72:75], a[100:103], a[4:7], v[72:75]
 ds_read_b128 a[68:71], v2 offset:50176
 v_cndmask_b32 v81, v32, v8, s[82:83]
M v[72:75], a[104:107], a[8:11], v[72:75]
 buffer_load_dwordx4 v3, s[8:11], s24 offen offset:3072 sc1 lds
M v[72:75], a[108:111], a[12:15], v[72:75]
 ds_read_b128 a[72:75], v2 offset:51200
 v_cndmask_b32 v82, v32, v8, s[84:85]
M v[72:75], a[112:115], a[16:19], v[72:75]
 ds_read_b128 a[76:79], v2 offset:52224
 v_cndmask_b32 v83, v32, v8, s[86:87]
M v[72:75], a[116:119], a[20:23], v[72:75]
 v_exp_f32 v23, v121
M v[72:75], a[120:123], a[24:27], v[72:75]
 s_add_u32 m0, s28, 69632
 ds_read_b128 a[80:83], v2 offset:53248
 v_add_f32 v28, v18, v28
M v[72:75], a[124:127], a[28:31], v[72:75]
 ds_read_b128 a[84:87], v2 offset:54272
 v_cvt_pk_bf16_f32 v56, v18, v19
M v[76:79], a[124:127], a[60:63], v[36:39]
 buffer_load_dwordx4 v4, s[8:11], s24 offen offset:0 sc1 lds
M v[76:79], a[120:123], a[56:59], v[76:79]
 ds_read_b128 a[88:91], v2 offset:55296
 v_add_f32 v28, v19, v28
M v[76:79], a[116:119], a[52:55], v[76:79]
 ds_read_b128 a[92:95], v2 offset:56320
 v_add_f32 v28, v20, v28
M v[76:79], a[112:115], a[48:51], v[76:79]
 v_exp_f32 v24, v122
M v[76:79], a[108:111], a[44:47], v[76:79]
 buffer_load_dwordx4 v4, s[8:11], s24 offen offset:1024 sc1 lds
M v[76:79], a[104:107], a[40:43], v[76:79]
 v_exp_f32 v25, v123
M v[76:79], a[100:103], a[36:39], v[76:79]
 v_exp_f32 v18, v116
M v[76:79], a[96:99], a[32:35], v[76:79]
 s_waitcnt lgkmcnt(0)
 v_exp_f32 v19, v117
M v[80:83], a[64:67], a[0:3], v[80:83]
 ds_read_b128 a[96:99], v2 offset:57344
 v_cndmask_b32 v88, v32, v8, s[88:89]
M v[80:83], a[68:71], a[4:7], v[80:83]
 ds_read_b128 a[100:103], v2 offset:58368
 v_cndmask_b32 v89, v32, v8, s[90:91]
M v[80:83], a[72:75], a[8:11], v[80:83]
 buffer_load_dwordx4 v4, s[8:11], s24 offen offset:2048 sc1 lds
M v[80:83], a[76:79], a[12:15], v[80:83]
 ds_read_b128 a[104:107], v2 offset:59392
 v_cndmask_b32 v90, v32, v8, s[92:93]
M v[80:83], a[80:83], a[16:19], v[80:83]
 ds_read_b128 a[108:111], v2 offset:60416
 v_cndmask_b32 v91, v32, v8, s[94:95]
M v[80:83], a[84:87], a[20:23], v[80:83]
 v_cvt_pk_bf16_f32 v57, v20, v21
 v_add_f32 v28, v21, v28
M v[80:83], a[88:91], a[24:27], v[80:83]
 ds_read_b128 a[112:115], v2 offset:61440
 v_add_f32 v28, v22, v28
M v[80:83], a[92:95], a[28:31], v[80:83]
 ds_read_b128 a[116:119], v2 offset:62464
 v_cvt_pk_bf16_f32 v58, v22, v23
M v[84:87], a[92:95], a[60:63], v[36:39]
 buffer_load_dwordx4 v4, s[8:11], s24 offen offset:3072 sc1 lds
M v[84:87], a[88:91], a[56:59], v[84:87]
 ds_read_b128 a[120:123], v2 offset:63488
 v_add_f32 v28, v23, v28
M v[84:87], a[84:87], a[52:55], v[84:87]
 ds_read_b128 a[124:127], v2 offset:64512
 v_add_f32 v28, v24, v28
M v[84:87], a[80:83], a[48:51], v[84:87]
 v_exp_f32 v20, v118
M v[84:87], a[76:79], a[44:47], v[84:87]
 v_exp_f32 v21, v119
M v[84:87], a[72:75], a[40:43], v[84:87]
 v_exp_f32 v22, v124
M v[84:87], a[68:71], a[36:39], v[84:87]
 s_waitcnt vmcnt(16) lgkmcnt(0)
 v_exp_f32 v23, v125
M v[84:87], a[64:67], a[32:35], v[84:87]
 s_barrier
M v[88:91], a[96:99], a[0:3], v[88:91]
 ds_read_b128 a[64:67], v7 offset:0
 v_cvt_pk_bf16_f32 v59, v24, v25
M v[88:91], a[100:103], a[4:7], v[88:91]
 ds_read_b128 a[68:71], v7 offset:1024
 v_add_f32 v28, v25, v28
M v[88:91], a[104:107], a[8:11], v[88:91]
 v_exp_f32 v24, v126
M v[88:91], a[108:111], a[12:15], v[88:91]
 ds_read_b128 a[72:75], v7 offset:2048
 v_add_f32 v29, v18, v29
M v[88:91], a[112:115], a[16:19], v[88:91]
 ds_read_b128 a[76:79], v7 offset:3072
 v_cvt_pk_bf16_f32 v60, v18, v19
M v[88:91], a[116:119], a[20:23], v[88:91]
 v_exp_f32 v25, v127
M v[88:91], a[120:123], a[24:27], v[88:91]
 ds_read_b128 a[80:83], v7 offset:4096
 v_add_f32 v29, v19, v29
M v[88:91], a[124:127], a[28:31], v[88:91]
 ds_read_b128 a[84:87], v7 offset:5120
 v_add_f32 v29, v20, v29
M v[92:95], a[124:127], a[60:63], v[36:39]
 v_cvt_pk_bf16_f32 v61, v20, v21
 v_add_f32 v29, v21, v29
M v[92:95], a[120:123], a[56:59], v[92:95]
 ds_read_b128 a[88:91], v7 offset:6144
 v_add_f32 v29, v22, v29
M v[92:95], a[116:119], a[52:55], v[92:95]
 ds_read_b128 a[92:95], v7 offset:7168
 v_cvt_pk_bf16_f32 v62, v22, v23
M v[92:95], a[112:115], a[48:51], v[92:95]
 v_add_f32 v29, v23, v29
 v_add_f32 v29, v24, v29
M v[92:95], a[108:111], a[44:47], v[92:95]
 v_cvt_pk_bf16_f32 v63, v24, v25
 v_add_f32 v29, v25, v29
M v[92:95], a[104:107], a[40:43], v[92:95]
M v[92:95], a[100:103], a[36:39], v[92:95]
 s_waitcnt lgkmcnt(0)
M v[92:95], a[96:99], a[32:35], v[92:95]
 v_max_f32 v10, v28, v29
 v_cmp_lt_f32 vcc, s31, v10
 s_nop 0
 s_cbranch_vccnz L_st5
L_rt5:
M v[128:131], a[64:67], v[48:51], v[128:131]
 s_add_u32 m0, s28, 98304
 ds_read_b128 a[96:99], v7 offset:8192
 v_add_f32 v30, v28, v30
M v[128:131], a[68:71], v[56:59], v[128:131]
 ds_read_b128 a[100:103], v7 offset:9216
 v_add_f32 v31, v29, v31
M v[132:135], a[68:71], v[60:63], v[132:135]
 buffer_load_dwordx4 v3, s[8:11], s21 offen offset:0 sc1 lds
M v[132:135], a[64:67], v[52:55], v[132:135]
 s_cmp_eq_u32 s20, 3
 ds_read_b128 a[104:107], v7 offset:10240
M v[140:143], a[72:75], v[52:55], v[140:143]
 s_cselect_b64 s[64:65], s[16:17], 0
 ds_read_b128 a[108:111], v7 offset:11264
M v[140:143], a[76:79], v[60:63], v[140:143]
 buffer_load_dwordx4 v3, s[8:11], s21 offen offset:1024 sc1 lds
M v[136:139], a[76:79], v[56:59], v[136:139]
 s_cselect_b64 s[66:67], s[18:19], 0
 ds_read_b128 a[112:115], v7 offset:12288
M v[136:139], a[72:75], v[48:51], v[136:139]
 s_cselect_b64 s[68:69], s[48:49], 0
 ds_read_b128 a[116:119], v7 offset:13312
M v[144:147], a[80:83], v[48:51], v[144:147]
 s_cselect_b64 s[70:71], s[50:51], 0
 v_exp_f32 v18, v64
M v[144:147], a[84:87], v[56:59], v[144:147]
 s_cmp_gt_u32 s20, 2
 ds_read_b128 a[120:123], v7 offset:14336
M v[148:151], a[84:87], v[60:63], v[148:151]
 s_cselect_b64 s[78:79], -1, 0
 ds_read_b128 a[124:127], v7 offset:15360
M v[148:151], a[80:83], v[52:55], v[148:151]
 buffer_load_dwordx4 v3, s[8:11], s21 offen offset:2048 sc1 lds
M v[156:159], a[88:91], v[52:55], v[156:159]
 v_exp_f32 v19, v65
M v[156:159], a[92:95], v[60:63], v[156:159]
 v_exp_f32 v20, v66
M v[152:155], a[92:95], v[56:59], v[152:155]
 buffer_load_dwordx4 v3, s[8:11], s21 offen offset:3072 sc1 lds
M v[152:155], a[88:91], v[48:51], v[152:155]
 s_waitcnt lgkmcnt(0)
 v_exp_f32 v21, v67
M v[160:163], a[96:99], v[48:51], v[160:163]
 ds_read_b128 a[64:67], v7 offset:16384
 v_add_f32 v26, v18, v19
M v[160:163], a[100:103], v[56:59], v[160:163]
 s_add_u32 m0, s28, 102400
 ds_read_b128 a[68:71], v7 offset:17408
 v_cvt_pk_bf16_f32 v40, v18, v19
M v[164:167], a[100:103], v[60:63], v[164:167]
 buffer_load_dwordx4 v4, s[8:11], s21 offen offset:0 sc1 lds
M v[164:167], a[96:99], v[52:55], v[164:167]
 s_cmp_eq_u32 s20, 2
 ds_read_b128 a[72:75], v7 offset:18432
 v_add_f32 v26, v20, v26
M v[172:175], a[104:107], v[52:55], v[172:175]
 s_cselect_b64 s[72:73], s[16:17], s[78:79]
 ds_read_b128 a[76:79], v7 offset:19456
 v_cvt_pk_bf16_f32 v41, v20, v21
M v[172:175], a[108:111], v[60:63], v[172:175]
 s_cselect_b64 s[74:75], s[18:19], s[78:79]
 v_exp_f32 v22, v72
M v[168:171], a[108:111], v[56:59], v[168:171]
 s_cselect_b64 s[76:77], s[48:49], s[78:79]
 ds_read_b128 a[80:83], v7 offset:20480
 v_add_f32 v26, v21, v26
M v[168:171], a[104:107], v[48:51], v[168:171]
 s_cselect_b64 s[78:79], s[50:51], s[78:79]
 ds_read_b128 a[84:87], v7 offset:21504
M v[176:179], a[112:115], v[48:51], v[176:179]
 buffer_load_dwordx4 v4, s[8:11], s21 offen offset:1024 sc1 lds
M v[176:179], a[116:119], v[56:59], v[176:179]
 s_cmp_gt_u32 s20, 1
 ds_read_b128 a[88:91], v7 offset:22528
M v[180:183], a[116:119], v[60:63], v[180:183]
 s_cselect_b64 s[86:87], -1, 0
 ds_read_b128 a[92:95], v7 offset:23552
M v[180:183], a[112:115], v[52:55], v[180:183]
 buffer_load_dwordx4 v4, s[8:11], s21 offen offset:2048 sc1 lds
M v[188:191], a[120:123], v[52:55], v[188:191]
 s_cmp_eq_u32 s20, 1
 v_exp_f32 v23, v73
M v[188:191], a[124:127], v[60:63], v[188:191]
 s_cselect_b64 s[80:81], s[16:17], s[86:87]
 v_exp_f32 v24, v74
M v[184:187], a[124:127], v[56:59], v[184:187]
 s_cselect_b64 s[82:83], s[18:19], s[86:87]
 v_exp_f32 v25, v75
M v[184:187], a[120:123], v[48:51], v[184:187]
 s_waitcnt lgkmcnt(0)
 v_exp_f32 v18, v68
M v[192:195], a[64:67], v[48:51], v[192:195]
 s_cselect_b64 s[84:85], s[48:49], s[86:87]
 ds_read_b128 a[96:99], v7 offset:24576
 v_add_f32 v26, v22, v26
M v[192:195], a[68:71], v[56:59], v[192:195]
 s_cselect_b64 s[86:87], s[50:51], s[86:87]
 ds_read_b128 a[100:103], v7 offset:25600
 v_cvt_pk_bf16_f32 v42, v22, v23
M v[196:199], a[68:71], v[60:63], v[196:199]
 buffer_load_dwordx4 v4, s[8:11], s21 offen offset:3072 sc1 lds
M v[196:199], a[64:67], v[52:55], v[196:199]
 s_add_u32 s24, s23, 16777216
 ds_read_b128 a[104:107], v7 offset:26624
 v_add_f32 v26, v23, v26
M v[204:207], a[72:75], v[52:55], v[204:207]
 s_mov_b32 s23, s21
 ds_read_b128 a[108:111], v7 offset:27648
 v_add_f32 v26, v24, v26
M v[204:207], a[76:79], v[60:63], v[204:207]
 s_add_u32 s21, s21, 32768
 v_exp_f32 v19, v69
M v[200:203], a[76:79], v[56:59], v[200:203]
 s_add_u32 s22, s22, 1
 ds_read_b128 a[112:115], v7 offset:28672
 v_cvt_pk_bf16_f32 v43, v24, v25
M v[200:203], a[72:75], v[48:51], v[200:203]
 s_cmp_eq_u32 s22, s25
 ds_read_b128 a[116:119], v7 offset:29696
 v_add_f32 v26, v25, v26
M v[208:211], a[80:83], v[48:51], v[208:211]
 s_cselect_b32 s21, s26, s21
 v_exp_f32 v20, v70
M v[208:211], a[84:87], v[56:59], v[208:211]
 s_cmp_eq_u32 s22, s43
 ds_read_b128 a[120:123], v7 offset:30720
 v_add_f32 v27, v18, v19
M v[212:215], a[84:87], v[60:63], v[212:215]
 s_cselect_b32 s21, s4, s21
 ds_read_b128 a[124:127], v7 offset:31744
 v_cvt_pk_bf16_f32 v44, v18, v19
M v[212:215], a[80:83], v[52:55], v[212:215]
 s_cmp_eq_u32 s22, s6
 v_exp_f32 v21, v71
M v[220:223], a[88:91], v[52:55], v[220:223]
 s_cselect_b32 s21, s7, s21
 v_exp_f32 v22, v76
M v[220:223], a[92:95], v[60:63], v[220:223]
 s_cmp_eq_u32 s20, 0
 v_exp_f32 v23, v77
M v[216:219], a[92:95], v[56:59], v[216:219]
 s_waitcnt vmcnt(16) lgkmcnt(0)
 v_exp_f32 v24, v78
M v[216:219], a[88:91], v[48:51], v[216:219]
 s_barrier
M v[224:227], a[96:99], v[48:51], v[224:227]
 s_cselect_b64 s[88:89], s[16:17], -1
 ds_read_b128 a[64:67], v7 offset:32768
 v_add_f32 v27, v20, v27
M v[224:227], a[100:103], v[56:59], v[224:227]
 s_cselect_b64 s[90:91], s[18:19], -1
 ds_read_b128 a[68:71], v7 offset:33792
 v_cvt_pk_bf16_f32 v45, v20, v21
M v[228:231], a[100:103], v[60:63], v[228:231]
 buffer_load_dword v5, off, s[8:11], s47 sc1
M v[228:231], a[96:99], v[52:55], v[228:231]
 s_cselect_b64 s[92:93], s[48:49], -1
 ds_read_b128 a[72:75], v7 offset:34816
 v_add_f32 v27, v21, v27
M v[236:239], a[104:107], v[52:55], v[236:239]
 s_cselect_b64 s[94:95], s[50:51], -1
 ds_read_b128 a[76:79], v7 offset:35840
 v_add_f32 v27, v22, v27
M v[236:239], a[108:111], v[60:63], v[236:239]
 v_cndmask_b32 v100, v36, v8, s[64:65]
 v_cndmask_b32 v101, v36, v8, s[66:67]
M v[232:235], a[108:111], v[56:59], v[232:235]
 ds_read_b128 a[80:83], v7 offset:36864
 v_cndmask_b32 v102, v36, v8, s[68:69]
M v[232:235], a[104:107], v[48:51], v[232:235]
 ds_read_b128 a[84:87], v7 offset:37888
 v_cndmask_b32 v103, v36, v8, s[70:71]
M v[240:243], a[112:115], v[48:51], v[240:243]
 v_cndmask_b32 v108, v36, v8, s[72:73]
 v_cndmask_b32 v109, v36, v8, s[74:75]
M v[240:243], a[116:119], v[56:59], v[240:243]
 ds_read_b128 a[88:91], v7 offset:38912
 v_cndmask_b32 v110, v36, v8, s[76:77]
M v[244:247], a[116:119], v[60:63], v[244:247]
 ds_read_b128 a[92:95], v7 offset:39936
 v_cndmask_b32 v111, v36, v8, s[78:79]
M v[244:247], a[112:115], v[52:55], v[244:247]
 v_cndmask_b32 v116, v36, v8, s[80:81]
 v_cndmask_b32 v117, v36, v8, s[82:83]
M v[252:255], a[120:123], v[52:55], v[252:255]
 v_cndmask_b32 v118, v36, v8, s[84:85]
 v_cndmask_b32 v119, v36, v8, s[86:87]
M v[252:255], a[124:127], v[60:63], v[252:255]
 v_cndmask_b32 v124, v36, v8, s[88:89]
 v_cndmask_b32 v125, v36, v8, s[90:91]
M v[248:251], a[124:127], v[56:59], v[248:251]
 s_waitcnt lgkmcnt(0)
 v_cndmask_b32 v126, v36, v8, s[92:93]
 v_cndmask_b32 v127, v36, v8, s[94:95]
M v[248:251], a[120:123], v[48:51], v[248:251]
 v_exp_f32 v25, v79
 v_cvt_pk_bf16_f32 v46, v22, v23
 v_add_f32 v27, v23, v27
 v_add_f32 v27, v24, v27
 v_cvt_pk_bf16_f32 v47, v24, v25
 v_add_f32 v27, v25, v27
L_p2:
M v[100:103], a[64:67], a[32:35], v[100:103]
 ds_read_b128 a[96:99], v7 offset:40960
 ds_read_b128 a[100:103], v7 offset:41984
 v_exp_f32 v18, v80
M v[100:103], a[68:71], a[36:39], v[100:103]
 ds_read_b128 a[104:107], v7 offset:43008
 v_exp_f32 v19, v81
M v[100:103], a[72:75], a[40:43], v[100:103]
 ds_read_b128 a[108:111], v7 offset:44032
 ds_read_b128 a[112:115], v7 offset:45056
 v_exp_f32 v20, v82
 v_add_f32 v26, v18, v26
M v[100:103], a[76:79], a[44:47], v[100:103]
 ds_read_b128 a[116:119], v7 offset:46080
 v_cvt_pk_bf16_f32 v56, v18, v19
 v_exp_f32 v21, v83
M v[100:103], a[80:83], a[48:51], v[100:103]
 s_add_u32 m0, s28, 0
 ds_read_b128 a[120:123], v7 offset:47104
 ds_read_b128 a[124:127], v7 offset:48128
 v_add_f32 v26, v19, v26
M v[100:103], a[84:87], a[52:55], v[100:103]
 buffer_load_dwordx4 v3, s[8:11], s24 offen offset:0 sc1 lds
M v[100:103], a[88:91], a[56:59], v[100:103]
 ds_read_b128 a[128:131], v7 offset:49152
 ds_read_b128 a[132:135], v7 offset:50176
 v_exp_f32 v22, v88
 v_add_f32 v26, v20, v26
 v_cvt_pk_bf16_f32 v57, v20, v21
M v[100:103], a[92:95], a[60:63], v[100:103]
 s_waitcnt lgkmcnt(2)
 ds_read_b128 a[136:139], v7 offset:51200
 v_exp_f32 v23, v89
 v_add_f32 v26, v21, v26
M v[108:111], a[124:127], a[60:63], v[108:111]
 ds_read_b128 a[140:143], v7 offset:52224
 ds_read_b128 a[144:147], v7 offset:53248
 v_exp_f32 v24, v90
M v[108:111], a[120:123], a[56:59], v[108:111]
 buffer_load_dwordx4 v3, s[8:11], s24 offen offset:1024 sc1 lds
M v[108:111], a[116:119], a[52:55], v[108:111]
 ds_read_b128 a[148:151], v7 offset:54272
 ds_read_b128 a[152:155], v7 offset:55296
 v_add_f32 v26, v22, v26
 v_cvt_pk_bf16_f32 v58, v22, v23
M v[108:111], a[112:115], a[48:51], v[108:111]
 ds_read_b128 a[156:159], v7 offset:56320
 v_exp_f32 v25, v91
 v_add_f32 v26, v23, v26
M v[108:111], a[108:111], a[44:47], v[108:111]
 ds_read_b128 a[160:163], v7 offset:57344
 ds_read_b128 a[164:167], v7 offset:58368
 v_exp_f32 v18, v84
M v[108:111], a[104:107], a[40:43], v[108:111]
 buffer_load_dwordx4 v3, s[8:11], s24 offen offset:2048 sc1 lds
M v[108:111], a[100:103], a[36:39], v[108:111]
 ds_read_b128 a[168:171], v7 offset:59392
 ds_read_b128 a[172:175], v7 offset:60416
 v_add_f32 v26, v24, v26
 v_cvt_pk_bf16_f32 v59, v24, v25
M v[108:111], a[96:99], a[32:35], v[108:111]
 s_waitcnt lgkmcnt(4)
 ds_read_b128 a[176:179], v7 offset:61440
 v_exp_f32 v19, v85
 v_add_f32 v26, v25, v26
M v[116:119], a[128:131], a[32:35], v[116:119]
 ds_read_b128 a[180:183], v7 offset:62464
 ds_read_b128 a[184:187], v7 offset:63488
 v_exp_f32 v20, v86
M v[116:119], a[132:135], a[36:39], v[116:119]
 ds_read_b128 a[188:191], v7 offset:64512
 v_add_f32 v27, v18, v27
 v_cvt_pk_bf16_f32 v60, v18, v19
M v[116:119], a[136:139], a[40:43], v[116:119]
 buffer_load_dwordx4 v3, s[8:11], s24 offen offset:3072 sc1 lds
M v[116:119], a[140:143], a[44:47], v[116:119]
 s_add_u32 m0, s28, 4096
 v_exp_f32 v21, v87
 v_add_f32 v27, v19, v27
 v_exp_f32 v22, v92
M v[116:119], a[144:147], a[48:51], v[116:119]
 buffer_load_dwordx4 v4, s[8:11], s24 offen offset:0 sc1 lds
M v[116:119], a[148:151], a[52:55], v[116:119]
 s_waitcnt vmcnt(14) lgkmcnt(0)
 v_add_f32 v27, v20, v27
 v_cvt_pk_bf16_f32 v61, v20, v21
 v_exp_f32 v23, v93
 v_add_f32 v27, v21, v27
M v[116:119], a[152:155], a[56:59], v[116:119]
 s_barrier
M v[116:119], a[156:159], a[60:63], v[116:119]
 ds_read_b128 a[64:67], v2 offset:0
 ds_read_b128 a[68:71], v2 offset:1024
 v_exp_f32 v24, v94
M v[124:127], a[188:191], a[60:63], v[124:127]
 ds_read_b128 a[72:75], v2 offset:2048
 v_add_f32 v27, v22, v27
 v_cvt_pk_bf16_f32 v62, v22, v23
M v[124:127], a[184:187], a[56:59], v[124:127]
 ds_read_b128 a[76:79], v2 offset:3072
 ds_read_b128 a[80:83], v2 offset:4096
 v_exp_f32 v25, v95
 v_add_f32 v27, v23, v27
M v[124:127], a[180:183], a[52:55], v[124:127]
 ds_read_b128 a[84:87], v2 offset:5120
 v_add_f32 v27, v24, v27
 v_cvt_pk_bf16_f32 v63, v24, v25
 v_add_f32 v27, v25, v27
M v[124:127], a[176:179], a[48:51], v[124:127]
 ds_read_b128 a[88:91], v2 offset:6144
 ds_read_b128 a[92:95], v2 offset:7168
 v_max_f32 v10, v26, v27
 v_cmp_lt_f32 vcc, s31, v10
M v[124:127], a[172:175], a[44:47], v[124:127]
 buffer_load_dwordx4 v4, s[8:11], s24 offen offset:1024 sc1 lds
M v[124:127], a[168:171], a[40:43], v[124:127]
 buffer_load_dwordx4 v4, s[8:11], s24 offen offset:2048 sc1 lds
M v[124:127], a[164:167], a[36:39], v[124:127]
 buffer_load_dwordx4 v4, s[8:11], s24 offen offset:3072 sc1 lds
M v[124:127], a[160:163], a[32:35], v[124:127]
 s_waitcnt lgkmcnt(0)
 s_cbranch_vccnz L_st6
L_rt6:
 s_cmp_le_u32 s42, 5
 s_cbranch_scc1 L_p3k
L_p3o:
M v[128:131], a[64:67], v[40:43], v[128:131]
 s_add_u32 m0, s28, 32768
 ds_read_b128 a[96:99], v2 offset:8192
 v_add_f32 v30, v26, v30
M v[128:131], a[68:71], v[56:59], v[128:131]
 ds_read_b128 a[100:103], v2 offset:9216
 v_add_f32 v31, v27, v31
M v[132:135], a[68:71], v[60:63], v[132:135]
 buffer_load_dwordx4 v3, s[8:11], s21 offen offset:0 sc1 lds
M v[132:135], a[64:67], v[44:47], v[132:135]
 ds_read_b128 a[104:107], v2 offset:10240
M v[140:143], a[72:75], v[44:47], v[140:143]
 ds_read_b128 a[108:111], v2 offset:11264
M v[140:143], a[76:79], v[60:63], v[140:143]
 buffer_load_dwordx4 v3, s[8:11], s21 offen offset:1024 sc1 lds
M v[136:139], a[76:79], v[56:59], v[136:139]
 ds_read_b128 a[112:115], v2 offset:12288
M v[136:139], a[72:75], v[40:43], v[136:139]
 ds_read_b128 a[116:119], v2 offset:13312
M v[144:147], a[80:83], v[40:43], v[144:147]
 v_exp_f32 v18, v100
M v[144:147], a[84:87], v[56:59], v[144:147]
 ds_read_b128 a[120:123], v2 offset:14336
M v[148:151], a[84:87], v[60:63], v[148:151]
 ds_read_b128 a[124:127], v2 offset:15360
M v[148:151], a[80:83], v[44:47], v[148:151]
 buffer_load_dwordx4 v3, s[8:11], s21 offen offset:2048 sc1 lds
M v[156:159], a[88:91], v[44:47], v[156:159]
 v_exp_f32 v19, v101
M v[156:159], a[92:95], v[60:63], v[156:159]
 v_exp_f32 v20, v102
M v[152:155], a[92:95], v[56:59], v[152:155]
 buffer_load_dwordx4 v3, s[8:11], s21 offen offset:3072 sc1 lds
M v[152:155], a[88:91], v[40:43], v[152:155]
 s_waitcnt lgkmcnt(0)
 v_exp_f32 v21, v103
M v[160:163], a[96:99], v[40:43], v[160:163]
 ds_read_b128 a[64:67], v2 offset:16384
 v_add_f32 v29, v18, v19
M v[160:163], a[100:103], v[56:59], v[160:163]
 s_add_u32 m0, s28, 36864
 ds_read_b128 a[68:71], v2 offset:17408
 v_cvt_pk_bf16_f32 v52, v18, v19
M v[164:167], a[100:103], v[60:63], v[164:167]
 buffer_load_dwordx4 v4, s[8:11], s21 offen offset:0 sc1 lds
M v[164:167], a[96:99], v[44:47], v[164:167]
 ds_read_b128 a[72:75], v2 offset:18432
 v_add_f32 v29, v20, v29
M v[172:175], a[104:107], v[44:47], v[172:175]
 ds_read_b128 a[76:79], v2 offset:19456
 v_cvt_pk_bf16_f32 v53, v20, v21
M v[172:175], a[108:111], v[60:63], v[172:175]
 v_exp_f32 v22, v108
M v[168:171], a[108:111], v[56:59], v[168:171]
 ds_read_b128 a[80:83], v2 offset:20480
 v_add_f32 v29, v21, v29
M v[168:171], a[104:107], v[40:43], v[168:171]
 ds_read_b128 a[84:87], v2 offset:21504
M v[176:179], a[112:115], v[40:43], v[176:179]
 buffer_load_dwordx4 v4, s[8:11], s21 offen offset:1024 sc1 lds
M v[176:179], a[116:119], v[56:59], v[176:179]
 ds_read_b128 a[88:91], v2 offset:22528
M v[180:183], a[116:119], v[60:63], v[180:183]
 ds_read_b128 a[92:95], v2 offset:23552
M v[180:183], a[112:115], v[44:47], v[180:183]
 buffer_load_dwordx4 v4, s[8:11], s21 offen offset:2048 sc1 lds
M v[188:191], a[120:123], v[44:47], v[188:191]
 v_exp_f32 v23, v109
M v[188:191], a[124:127], v[60:63], v[188:191]
 v_exp_f32 v24, v110
M v[184:187], a[124:127], v[56:59], v[184:187]
 v_exp_f32 v25, v111
M v[184:187], a[120:123], v[40:43], v[184:187]
 s_waitcnt lgkmcnt(0)
 v_exp_f32 v18, v116
M v[192:195], a[64:67], v[40:43], v[192:195]
 ds_read_b128 a[96:99], v2 offset:24576
 v_add_f32 v29, v22, v29
M v[192:195], a[68:71], v[56:59], v[192:195]
 ds_read_b128 a[100:103], v2 offset:25600
 v_cvt_pk_bf16_f32 v54, v22, v23
M v[196:199], a[68:71], v[60:63], v[196:199]
 buffer_load_dwordx4 v4, s[8:11], s21 offen offset:3072 sc1 lds
M v[196:199], a[64:67], v[44:47], v[196:199]
 s_add_u32 s24, s23, 16777216
 ds_read_b128 a[104:107], v2 offset:26624
 v_add_f32 v29, v23, v29
M v[204:207], a[72:75], v[44:47], v[204:207]
 s_mov_b32 s23, s21
 ds_read_b128 a[108:111], v2 offset:27648
 v_add_f32 v29, v24, v29
M v[204:207], a[76:79], v[60:63], v[204:207]
 s_add_u32 s21, s21, 32768
 v_exp_f32 v19, v117
M v[200:203], a[76:79], v[56:59], v[200:203]
 s_add_u32 s22, s22, 1
 ds_read_b128 a[112:115], v2 offset:28672
 v_cvt_pk_bf16_f32 v55, v24, v25
M v[200:203], a[72:75], v[40:43], v[200:203]
 s_cmp_eq_u32 s22, s25
 ds_read_b128 a[116:119], v2 offset:29696
 v_add_f32 v29, v25, v29
M v[208:211], a[80:83], v[40:43], v[208:211]
 s_cselect_b32 s21, s26, s21
 v_exp_f32 v20, v118
M v[208:211], a[84:87], v[56:59], v[208:211]
 s_cmp_eq_u32 s22, s43
 ds_read_b128 a[120:123], v2 offset:30720
 v_add_f32 v29, v18, v29
M v[212:215], a[84:87], v[60:63], v[212:215]
 s_cselect_b32 s21, s4, s21
 ds_read_b128 a[124:127], v2 offset:31744
 v_cvt_pk_bf16_f32 v48, v18, v19
M v[212:215], a[80:83], v[44:47], v[212:215]
 s_cmp_eq_u32 s22, s6
 v_exp_f32 v21, v119
M v[220:223], a[88:91], v[44:47], v[220:223]
 s_cselect_b32 s21, s7, s21
 v_exp_f32 v22, v124
M v[220:223], a[92:95], v[60:63], v[220:223]
 v_exp_f32 v23, v125
M v[216:219], a[92:95], v[56:59], v[216:219]
 s_waitcnt vmcnt(8) lgkmcnt(0)
 v_add_f32 v29, v19, v29
 v_add_f32 v29, v20, v29
M v[216:219], a[88:91], v[40:43], v[216:219]
 s_barrier
M v[224:227], a[96:99], v[40:43], v[224:227]
 ds_read_b128 a[64:67], v7 offset:0
 v_cvt_pk_bf16_f32 v49, v20, v21
M v[224:227], a[100:103], v[56:59], v[224:227]
 ds_read_b128 a[68:71], v7 offset:1024
 v_add_f32 v29, v21, v29
M v[228:231], a[100:103], v[60:63], v[228:231]
 v_exp_f32 v24, v126
M v[228:231], a[96:99], v[44:47], v[228:231]
 ds_read_b128 a[72:75], v7 offset:2048
 v_add_f32 v29, v22, v29
M v[236:239], a[104:107], v[44:47], v[236:239]
 ds_read_b128 a[76:79], v7 offset:3072
 v_cvt_pk_bf16_f32 v50, v22, v23
M v[236:239], a[108:111], v[60:63], v[236:239]
 v_exp_f32 v25, v127
M v[232:235], a[108:111], v[56:59], v[232:235]
 ds_read_b128 a[80:83], v7 offset:4096
 v_add_f32 v29, v23, v29
M v[232:235], a[104:107], v[40:43], v[232:235]
 ds_read_b128 a[84:87], v7 offset:5120
 v_add_f32 v29, v24, v29
M v[240:243], a[112:115], v[40:43], v[240:243]
 v_cvt_pk_bf16_f32 v51, v24, v25
 v_add_f32 v29, v25, v29
M v[240:243], a[116:119], v[56:59], v[240:243]
 ds_read_b128 a[88:91], v7 offset:6144
M v[244:247], a[116:119], v[60:63], v[244:247]
 ds_read_b128 a[92:95], v7 offset:7168
M v[244:247], a[112:115], v[44:47], v[244:247]
 v_cmp_lt_f32 vcc, s31, v29
M v[252:255], a[120:123], v[44:47], v[252:255]
M v[252:255], a[124:127], v[60:63], v[252:255]
M v[248:251], a[124:127], v[56:59], v[248:251]
 s_waitcnt lgkmcnt(0)
M v[248:251], a[120:123], v[40:43], v[248:251]
 s_cbranch_vccnz L_st2
L_rt2:
L_pBo:
M v[132:135], a[64:67], v[52:55], v[132:135]
 ds_read_b128 a[96:99], v7 offset:8192
 ds_read_b128 a[100:103], v7 offset:9216
M v[132:135], a[68:71], v[48:51], v[132:135]
 ds_read_b128 a[104:107], v7 offset:10240
 v_cvt_pk_bf16_f32 v128, v128, v129
 v_cvt_pk_bf16_f32 v129, v130, v131
M v[140:143], a[76:79], v[48:51], v[140:143]
 ds_read_b128 a[108:111], v7 offset:11264
 ds_read_b128 a[112:115], v7 offset:12288
 v_cvt_pk_bf16_f32 v130, v136, v137
M v[140:143], a[72:75], v[52:55], v[140:143]
 ds_read_b128 a[116:119], v7 offset:13312
 v_cvt_pk_bf16_f32 v131, v138, v139
 v_cvt_pk_bf16_f32 v144, v144, v145
M v[148:151], a[80:83], v[52:55], v[148:151]
 s_add_u32 m0, s28, 65536
 ds_read_b128 a[120:123], v7 offset:14336
 ds_read_b128 a[124:127], v7 offset:15360
M v[148:151], a[84:87], v[48:51], v[148:151]
 buffer_load_dwordx4 v3, s[8:11], s38 offen offset:0 sc1 lds
M v[156:159], a[92:95], v[48:51], v[156:159]
 ds_read_b128 a[128:131], v7 offset:16384
 ds_read_b128 a[132:135], v7 offset:17408
 v_cvt_pk_bf16_f32 v145, v146, v147
M v[156:159], a[88:91], v[52:55], v[156:159]
 s_waitcnt lgkmcnt(2)
 ds_read_b128 a[136:139], v7 offset:18432
 v_cvt_pk_bf16_f32 v146, v152, v153
 v_cvt_pk_bf16_f32 v147, v154, v155
M v[164:167], a[96:99], v[52:55], v[164:167]
 ds_read_b128 a[140:143], v7 offset:19456
 ds_read_b128 a[144:147], v7 offset:20480
 v_cvt_pk_bf16_f32 v160, v160, v161
M v[164:167], a[100:103], v[48:51], v[164:167]
 buffer_load_dwordx4 v3, s[8:11], s38 offen offset:1024 sc1 lds
M v[172:175], a[108:111], v[48:51], v[172:175]
 ds_read_b128 a[148:151], v7 offset:21504
 ds_read_b128 a[152:155], v7 offset:22528
 v_cvt_pk_bf16_f32 v161, v162, v163
M v[172:175], a[104:107], v[52:55], v[172:175]
 ds_read_b128 a[156:159], v7 offset:23552
 v_cvt_pk_bf16_f32 v162, v168, v169
 v_cvt_pk_bf16_f32 v163, v170, v171
M v[180:183], a[112:115], v[52:55], v[180:183]
 ds_read_b128 a[160:163], v7 offset:24576
 ds_read_b128 a[164:167], v7 offset:25600
 v_cvt_pk_bf16_f32 v176, v176, v177
M v[180:183], a[116:119], v[48:51], v[180:183]
 buffer_load_dwordx4 v3, s[8:11], s38 offen offset:2048 sc1 lds
M v[188:191], a[124:127], v[48:51], v[188:191]
 ds_read_b128 a[168:171], v7 offset:26624
 ds_read_b128 a[172:175], v7 offset:27648
 v_cvt_pk_bf16_f32 v177, v178, v179
M v[188:191], a[120:123], v[52:55], v[188:191]
 s_waitcnt lgkmcnt(4)
 ds_read_b128 a[176:179], v7 offset:28672
 v_cvt_pk_bf16_f32 v178, v184, v185
M v[196:199], a[128:131], v[52:55], v[196:199]
 ds_read_b128 a[180:183], v7 offset:29696
 ds_read_b128 a[184:187], v7 offset:30720
 v_cvt_pk_bf16_f32 v179, v186, v187
M v[196:199], a[132:135], v[48:51], v[196:199]
 ds_read_b128 a[188:191], v7 offset:31744
 v_cvt_pk_bf16_f32 v192, v192, v193
 v_cvt_pk_bf16_f32 v193, v194, v195
M v[204:207], a[140:143], v[48:51], v[204:207]
 buffer_load_dwordx4 v3, s[8:11], s38 offen offset:3072 sc1 lds
M v[204:207], a[136:139], v[52:55], v[204:207]
 s_add_u32 m0, s28, 69632
 v_cvt_pk_bf16_f32 v194, v200, v201
 v_cvt_pk_bf16_f32 v195, v202, v203
 v_cvt_pk_bf16_f32 v208, v208, v209
M v[212:215], a[144:147], v[52:55], v[212:215]
 buffer_load_dwordx4 v4, s[8:11], s38 offen offset:0 sc1 lds
M v[212:215], a[148:151], v[48:51], v[212:215]
 s_waitcnt lgkmcnt(0)
 v_cvt_pk_bf16_f32 v209, v210, v211
 v_cvt_pk_bf16_f32 v210, v216, v217
 v_cvt_pk_bf16_f32 v211, v218, v219
M v[220:223], a[156:159], v[48:51], v[220:223]
 s_barrier
M v[220:223], a[152:155], v[52:55], v[220:223]
 ds_read_b128 a[64:67], v2 offset:32768
 ds_read_b128 a[68:71], v2 offset:33792
 v_cvt_pk_bf16_f32 v224, v224, v225
M v[228:231], a[160:163], v[52:55], v[228:231]
 ds_read_b128 a[72:75], v2 offset:34816
 v_cvt_pk_bf16_f32 v225, v226, v227
 v_cvt_pk_bf16_f32 v226, v232, v233
M v[228:231], a[164:167], v[48:51], v[228:231]
 ds_read_b128 a[76:79], v2 offset:35840
 ds_read_b128 a[80:83], v2 offset:36864
M v[236:239], a[172:175], v[48:51], v[236:239]
 ds_read_b128 a[84:87], v2 offset:37888
 v_cvt_pk_bf16_f32 v227, v234, v235
 v_cvt_pk_bf16_f32 v240, v240, v241
M v[236:239], a[168:171], v[52:55], v[236:239]
 ds_read_b128 a[88:91], v2 offset:38912
 ds_read_b128 a[92:95], v2 offset:39936
 v_cvt_pk_bf16_f32 v241, v242, v243
M v[244:247], a[176:179], v[52:55], v[244:247]
 buffer_load_dwordx4 v4, s[8:11], s38 offen offset:1024 sc1 lds
M v[244:247], a[180:183], v[48:51], v[244:247]
 buffer_load_dwordx4 v4, s[8:11], s38 offen offset:2048 sc1 lds
M v[252:255], a[188:191], v[48:51], v[252:255]
 buffer_load_dwordx4 v4, s[8:11], s38 offen offset:3072 sc1 lds
M v[252:255], a[184:187], v[52:55], v[252:255]
 s_waitcnt lgkmcnt(0)
 s_add_u32 s38, s38, 32768
 v_cvt_pk_bf16_f32 v242, v248, v249
 v_cvt_pk_bf16_f32 v243, v250, v251
 s_branch L_op1
L_p1c:
 v_cndmask_b32 v64, v32, v8, s[64:65]
 v_cndmask_b32 v65, v32, v8, s[66:67]
 v_cndmask_b32 v66, v32, v8, s[68:69]
 v_cndmask_b32 v67, v32, v8, s[70:71]
 s_nop 1
M v[64:67], a[64:67], a[0:3], v[64:67]
 s_add_u32 m0, s28, 65536
 ds_read_b128 a[96:99], v2 offset:40960
 ds_read_b128 a[100:103], v2 offset:41984
M v[64:67], a[68:71], a[4:7], v[64:67]
 buffer_load_dwordx4 v3, s[8:11], s24 offen offset:0 sc1 lds
M v[64:67], a[72:75], a[8:11], v[64:67]
 v_exp_f32 v18, v112
M v[64:67], a[76:79], a[12:15], v[64:67]
 ds_read_b128 a[104:107], v2 offset:43008
 ds_read_b128 a[108:111], v2 offset:44032
M v[64:67], a[80:83], a[16:19], v[64:67]
 buffer_load_dwordx4 v[14:17], v7, s[8:11], s52 offen sc1
M v[64:67], a[84:87], a[20:23], v[64:67]
 s_cmp_eq_u32 s20, 3
 v_exp_f32 v19, v113
M v[64:67], a[88:91], a[24:27], v[64:67]
 s_cselect_b64 s[64:65], s[16:17], 0
 ds_read_b128 a[112:115], v2 offset:45056
 ds_read_b128 a[116:119], v2 offset:46080
M v[64:67], a[92:95], a[28:31], v[64:67]
 s_cselect_b64 s[66:67], s[18:19], 0
 v_exp_f32 v20, v114
M v[68:71], a[92:95], a[60:63], v[36:39]
 s_cselect_b64 s[68:69], s[48:49], 0
 v_add_f32 v28, v18, v28
 v_cvt_pk_bf16_f32 v56, v18, v19
M v[68:71], a[88:91], a[56:59], v[68:71]
 s_cselect_b64 s[70:71], s[50:51], 0
 ds_read_b128 a[120:123], v2 offset:47104
 ds_read_b128 a[124:127], v2 offset:48128
M v[68:71], a[84:87], a[52:55], v[68:71]
 buffer_load_dwordx4 v3, s[8:11], s24 offen offset:1024 sc1 lds
M v[68:71], a[80:83], a[48:51], v[68:71]
 v_cndmask_b32 v72, v32, v8, s[72:73]
 v_cndmask_b32 v73, v32, v8, s[74:75]
M v[68:71], a[76:79], a[44:47], v[68:71]
 v_cndmask_b32 v74, v32, v8, s[76:77]
 v_cndmask_b32 v75, v32, v8, s[78:79]
M v[68:71], a[72:75], a[40:43], v[68:71]
 buffer_load_dwordx4 a[128:131], v7, s[8:11], s12 offen offset:0 sc1
M v[68:71], a[68:71], a[36:39], v[68:71]
 buffer_load_dwordx4 a[132:135], v7, s[8:11], s12 offen offset:1024 sc1
M v[68:71], a[64:67], a[32:35], v[68:71]
 s_waitcnt lgkmcnt(0)
 v_exp_f32 v21, v115
M v[72:75], a[96:99], a[0:3], v[72:75]
 ds_read_b128 a[64:67], v2 offset:49152
 ds_read_b128 a[68:71], v2 offset:50176
M v[72:75], a[100:103], a[4:7], v[72:75]
 buffer_load_dwordx4 v3, s[8:11], s24 offen offset:2048 sc1 lds
M v[72:75], a[104:107], a[8:11], v[72:75]
 v_exp_f32 v22, v120
M v[72:75], a[108:111], a[12:15], v[72:75]
 ds_read_b128 a[72:75], v2 offset:51200
 ds_read_b128 a[76:79], v2 offset:52224
M v[72:75], a[112:115], a[16:19], v[72:75]
 buffer_load_dwordx4 v3, s[8:11], s24 offen offset:3072 sc1 lds
M v[72:75], a[116:119], a[20:23], v[72:75]
 s_cmp_gt_u32 s20, 2
 v_exp_f32 v23, v121
M v[72:75], a[120:123], a[24:27], v[72:75]
 s_cselect_b64 s[78:79], -1, 0
 ds_read_b128 a[80:83], v2 offset:53248
 ds_read_b128 a[84:87], v2 offset:54272
M v[72:75], a[124:127], a[28:31], v[72:75]
 s_cmp_eq_u32 s20, 2
 v_exp_f32 v24, v122
M v[76:79], a[124:127], a[60:63], v[36:39]
 s_cselect_b64 s[72:73], s[16:17], s[78:79]
 v_exp_f32 v25, v123
M v[76:79], a[120:123], a[56:59], v[76:79]
 s_cselect_b64 s[74:75], s[18:19], s[78:79]
 ds_read_b128 a[88:91], v2 offset:55296
 ds_read_b128 a[92:95], v2 offset:56320
M v[76:79], a[116:119], a[52:55], v[76:79]
 s_cselect_b64 s[76:77], s[48:49], s[78:79]
 v_add_f32 v28, v19, v28
 v_add_f32 v28, v20, v28
M v[76:79], a[112:115], a[48:51], v[76:79]
 s_cselect_b64 s[78:79], s[50:51], s[78:79]
 v_cndmask_b32 v80, v32, v8, s[80:81]
 v_cndmask_b32 v81, v32, v8, s[82:83]
M v[76:79], a[108:111], a[44:47], v[76:79]
 s_add_u32 m0, s28, 69632
 v_cndmask_b32 v82, v32, v8, s[84:85]
 v_cndmask_b32 v83, v32, v8, s[86:87]
M v[76:79], a[104:107], a[40:43], v[76:79]
 buffer_load_dwordx4 a[136:139], v7, s[8:11], s12 offen offset:2048 sc1
M v[76:79], a[100:103], a[36:39], v[76:79]
 buffer_load_dwordx4 v4, s[8:11], s24 offen offset:0 sc1 lds
M v[76:79], a[96:99], a[32:35], v[76:79]
 s_waitcnt lgkmcnt(0)
 v_exp_f32 v18, v116
M v[80:83], a[64:67], a[0:3], v[80:83]
 ds_read_b128 a[96:99], v2 offset:57344
 ds_read_b128 a[100:103], v2 offset:58368
M v[80:83], a[68:71], a[4:7], v[80:83]
 buffer_load_dwordx4 a[140:143], v7, s[8:11], s12 offen offset:3072 sc1
M v[80:83], a[72:75], a[8:11], v[80:83]
 buffer_load_dwordx4 v4, s[8:11], s24 offen offset:1024 sc1 lds
M v[80:83], a[76:79], a[12:15], v[80:83]
 ds_read_b128 a[104:107], v2 offset:59392
 ds_read_b128 a[108:111], v2 offset:60416
M v[80:83], a[80:83], a[16:19], v[80:83]
 buffer_load_dwordx4 a[144:147], v7, s[8:11], s13 offen offset:0 sc1
M v[80:83], a[84:87], a[20:23], v[80:83]
 s_cmp_gt_u32 s20, 1
 v_exp_f32 v19, v117
M v[80:83], a[88:91], a[24:27], v[80:83]
 s_cselect_b64 s[86:87], -1, 0
 ds_read_b128 a[112:115], v2 offset:61440
 ds_read_b128 a[116:119], v2 offset:62464
M v[80:83], a[92:95], a[28:31], v[80:83]
 s_cmp_eq_u32 s20, 1
 v_cvt_pk_bf16_f32 v57, v20, v21
 v_add_f32 v28, v21, v28
M v[84:87], a[92:95], a[60:63], v[36:39]
 s_cselect_b64 s[80:81], s[16:17], s[86:87]
 v_exp_f32 v20, v118
M v[84:87], a[88:91], a[56:59], v[84:87]
 s_cselect_b64 s[82:83], s[18:19], s[86:87]
 ds_read_b128 a[120:123], v2 offset:63488
 ds_read_b128 a[124:127], v2 offset:64512
M v[84:87], a[84:87], a[52:55], v[84:87]
 s_cselect_b64 s[84:85], s[48:49], s[86:87]
 v_exp_f32 v21, v119
M v[84:87], a[80:83], a[48:51], v[84:87]
 s_cselect_b64 s[86:87], s[50:51], s[86:87]
 v_cndmask_b32 v88, v32, v8, s[88:89]
 v_cndmask_b32 v89, v32, v8, s[90:91]
M v[84:87], a[76:79], a[44:47], v[84:87]
 v_cndmask_b32 v90, v32, v8, s[92:93]
 v_cndmask_b32 v91, v32, v8, s[94:95]
M v[84:87], a[72:75], a[40:43], v[84:87]
 buffer_load_dwordx4 v4, s[8:11], s24 offen offset:2048 sc1 lds
M v[84:87], a[68:71], a[36:39], v[84:87]
 s_waitcnt vmcnt(21) lgkmcnt(0)
 v_add_f32 v28, v22, v28
 v_cvt_pk_bf16_f32 v58, v22, v23
M v[84:87], a[64:67], a[32:35], v[84:87]
 s_barrier
M v[88:91], a[96:99], a[0:3], v[88:91]
 ds_read_b128 a[64:67], v7 offset:0
 ds_read_b128 a[68:71], v7 offset:1024
M v[88:91], a[100:103], a[4:7], v[88:91]
 s_cmp_eq_u32 s20, 0
 v_add_f32 v28, v23, v28
 v_add_f32 v28, v24, v28
M v[88:91], a[104:107], a[8:11], v[88:91]
 s_cselect_b64 s[88:89], s[16:17], -1
 v_exp_f32 v22, v124
M v[88:91], a[108:111], a[12:15], v[88:91]
 s_cselect_b64 s[90:91], s[18:19], -1
 ds_read_b128 a[72:75], v7 offset:2048
 ds_read_b128 a[76:79], v7 offset:3072
M v[88:91], a[112:115], a[16:19], v[88:91]
 s_cselect_b64 s[92:93], s[48:49], -1
 v_exp_f32 v23, v125
M v[88:91], a[116:119], a[20:23], v[88:91]
 s_cselect_b64 s[94:95], s[50:51], -1
 v_cvt_pk_bf16_f32 v59, v24, v25
 v_add_f32 v28, v25, v28
M v[88:91], a[120:123], a[24:27], v[88:91]
 ds_read_b128 a[80:83], v7 offset:4096
 ds_read_b128 a[84:87], v7 offset:5120
M v[88:91], a[124:127], a[28:31], v[88:91]
 buffer_load_dwordx4 a[148:151], v7, s[8:11], s13 offen offset:1024 sc1
M v[92:95], a[124:127], a[60:63], v[36:39]
 buffer_load_dwordx4 v4, s[8:11], s24 offen offset:3072 sc1 lds
M v[92:95], a[120:123], a[56:59], v[92:95]
 ds_read_b128 a[88:91], v7 offset:6144
 ds_read_b128 a[92:95], v7 offset:7168
M v[92:95], a[116:119], a[52:55], v[92:95]
 buffer_load_dwordx4 a[152:155], v7, s[8:11], s13 offen offset:2048 sc1
M v[92:95], a[112:115], a[48:51], v[92:95]
 v_exp_f32 v24, v126
M v[92:95], a[108:111], a[44:47], v[92:95]
 buffer_load_dwordx4 a[156:159], v7, s[8:11], s13 offen offset:3072 sc1
M v[92:95], a[104:107], a[40:43], v[92:95]
 v_exp_f32 v25, v127
M v[92:95], a[100:103], a[36:39], v[92:95]
 s_waitcnt lgkmcnt(0)
 v_add_f32 v29, v18, v29
 v_cvt_pk_bf16_f32 v60, v18, v19
M v[92:95], a[96:99], a[32:35], v[92:95]
 v_add_f32 v29, v19, v29
 v_add_f32 v29, v20, v29
 v_cvt_pk_bf16_f32 v61, v20, v21
 v_add_f32 v29, v21, v29
 v_add_f32 v29, v22, v29
 v_cvt_pk_bf16_f32 v62, v22, v23
 v_add_f32 v29, v23, v29
 v_add_f32 v29, v24, v29
 v_cvt_pk_bf16_f32 v63, v24, v25
 v_add_f32 v29, v25, v29
 v_max_f32 v10, v28, v29
 v_cmp_lt_f32 vcc, s31, v10
 s_nop 0
 s_cbranch_vccnz L_st3
L_rt3:
M v[128:131], a[64:67], v[48:51], v[128:131]
 s_add_u32 m0, s28, 98304
 ds_read_b128 a[96:99], v7 offset:8192
 ds_read_b128 a[100:103], v7 offset:9216
M v[128:131], a[68:71], v[56:59], v[128:131]
 buffer_load_dwordx4 v3, s[8:11], s21 offen offset:0 sc1 lds
M v[132:135], a[68:71], v[60:63], v[132:135]
 v_exp_f32 v18, v64
M v[132:135], a[64:67], v[52:55], v[132:135]
 ds_read_b128 a[104:107], v7 offset:10240
 ds_read_b128 a[108:111], v7 offset:11264
M v[140:143], a[72:75], v[52:55], v[140:143]
 buffer_load_dwordx4 a[160:163], v7, s[8:11], s14 offen offset:0 sc1
M v[140:143], a[76:79], v[60:63], v[140:143]
 v_cndmask_b32 v100, v36, v8, s[64:65]
 v_add_f32 v30, v28, v30
M v[136:139], a[76:79], v[56:59], v[136:139]
 ds_read_b128 a[112:115], v7 offset:12288
 ds_read_b128 a[116:119], v7 offset:13312
M v[136:139], a[72:75], v[48:51], v[136:139]
 buffer_load_dwordx4 v3, s[8:11], s21 offen offset:1024 sc1 lds
M v[144:147], a[80:83], v[48:51], v[144:147]
 v_cndmask_b32 v101, v36, v8, s[66:67]
 v_add_f32 v31, v29, v31
M v[144:147], a[84:87], v[56:59], v[144:147]
 ds_read_b128 a[120:123], v7 offset:14336
 ds_read_b128 a[124:127], v7 offset:15360
M v[148:151], a[84:87], v[60:63], v[148:151]
 buffer_load_dwordx4 a[164:167], v7, s[8:11], s14 offen offset:1024 sc1
M v[148:151], a[80:83], v[52:55], v[148:151]
 v_cndmask_b32 v102, v36, v8, s[68:69]
M v[156:159], a[88:91], v[52:55], v[156:159]
 buffer_load_dwordx4 v3, s[8:11], s21 offen offset:2048 sc1 lds
M v[156:159], a[92:95], v[60:63], v[156:159]
 v_exp_f32 v19, v65
M v[152:155], a[92:95], v[56:59], v[152:155]
 buffer_load_dwordx4 a[168:171], v7, s[8:11], s14 offen offset:2048 sc1
M v[152:155], a[88:91], v[48:51], v[152:155]
 s_waitcnt lgkmcnt(0)
 v_cndmask_b32 v103, v36, v8, s[70:71]
 v_add_f32 v26, v18, v19
M v[160:163], a[96:99], v[48:51], v[160:163]
 ds_read_b128 a[64:67], v7 offset:16384
 ds_read_b128 a[68:71], v7 offset:17408
M v[160:163], a[100:103], v[56:59], v[160:163]
 buffer_load_dwordx4 v3, s[8:11], s21 offen offset:3072 sc1 lds
M v[164:167], a[100:103], v[60:63], v[164:167]
 v_cndmask_b32 v108, v36, v8, s[72:73]
 v_cvt_pk_bf16_f32 v40, v18, v19
M v[164:167], a[96:99], v[52:55], v[164:167]
 ds_read_b128 a[72:75], v7 offset:18432
 ds_read_b128 a[76:79], v7 offset:19456
M v[172:175], a[104:107], v[52:55], v[172:175]
 buffer_load_dwordx4 a[172:175], v7, s[8:11], s14 offen offset:3072 sc1
M v[172:175], a[108:111], v[60:63], v[172:175]
 v_exp_f32 v20, v66
M v[168:171], a[108:111], v[56:59], v[168:171]
 s_add_u32 m0, s28, 102400
 ds_read_b128 a[80:83], v7 offset:20480
 ds_read_b128 a[84:87], v7 offset:21504
M v[168:171], a[104:107], v[48:51], v[168:171]
 buffer_load_dwordx4 v4, s[8:11], s21 offen offset:0 sc1 lds
M v[176:179], a[112:115], v[48:51], v[176:179]
 v_cndmask_b32 v109, v36, v8, s[74:75]
M v[176:179], a[116:119], v[56:59], v[176:179]
 ds_read_b128 a[88:91], v7 offset:22528
 ds_read_b128 a[92:95], v7 offset:23552
M v[180:183], a[116:119], v[60:63], v[180:183]
 buffer_load_dwordx4 a[176:179], v7, s[8:11], s15 offen offset:0 sc1
M v[180:183], a[112:115], v[52:55], v[180:183]
 v_cndmask_b32 v110, v36, v8, s[76:77]
M v[188:191], a[120:123], v[52:55], v[188:191]
 buffer_load_dwordx4 v4, s[8:11], s21 offen offset:1024 sc1 lds
M v[188:191], a[124:127], v[60:63], v[188:191]
 v_cndmask_b32 v111, v36, v8, s[78:79]
M v[184:187], a[124:127], v[56:59], v[184:187]
 buffer_load_dwordx4 a[180:183], v7, s[8:11], s15 offen offset:1024 sc1
M v[184:187], a[120:123], v[48:51], v[184:187]
 s_waitcnt lgkmcnt(0)
 v_exp_f32 v21, v67
M v[192:195], a[64:67], v[48:51], v[192:195]
 ds_read_b128 a[96:99], v7 offset:24576
 ds_read_b128 a[100:103], v7 offset:25600
M v[192:195], a[68:71], v[56:59], v[192:195]
 buffer_load_dwordx4 v4, s[8:11], s21 offen offset:2048 sc1 lds
M v[196:199], a[68:71], v[60:63], v[196:199]
 v_cndmask_b32 v116, v36, v8, s[80:81]
 v_add_f32 v26, v20, v26
M v[196:199], a[64:67], v[52:55], v[196:199]
 ds_read_b128 a[104:107], v7 offset:26624
 ds_read_b128 a[108:111], v7 offset:27648
M v[204:207], a[72:75], v[52:55], v[204:207]
 buffer_load_dwordx4 a[184:187], v7, s[8:11], s15 offen offset:2048 sc1
M v[204:207], a[76:79], v[60:63], v[204:207]
 v_cndmask_b32 v117, v36, v8, s[82:83]
 v_cvt_pk_bf16_f32 v41, v20, v21
M v[200:203], a[76:79], v[56:59], v[200:203]
 ds_read_b128 a[112:115], v7 offset:28672
 ds_read_b128 a[116:119], v7 offset:29696
M v[200:203], a[72:75], v[48:51], v[200:203]
 buffer_load_dwordx4 v4, s[8:11], s21 offen offset:3072 sc1 lds
M v[208:211], a[80:83], v[48:51], v[208:211]
 s_add_u32 s24, s23, 16777216
 v_cndmask_b32 v118, v36, v8, s[84:85]
 v_add_f32 v26, v21, v26
M v[208:211], a[84:87], v[56:59], v[208:211]
 s_mov_b32 s23, s21
 ds_read_b128 a[120:123], v7 offset:30720
 ds_read_b128 a[124:127], v7 offset:31744
M v[212:215], a[84:87], v[60:63], v[212:215]
 buffer_load_dwordx4 a[188:191], v7, s[8:11], s15 offen offset:3072 sc1
M v[212:215], a[80:83], v[52:55], v[212:215]
 s_add_u32 s21, s21, 32768
 v_cndmask_b32 v119, v36, v8, s[86:87]
M v[220:223], a[88:91], v[52:55], v[220:223]
 s_add_u32 s22, s22, 1
 v_exp_f32 v22, v72
M v[220:223], a[92:95], v[60:63], v[220:223]
 s_cmp_eq_u32 s22, s25
 v_exp_f32 v23, v73
M v[216:219], a[92:95], v[56:59], v[216:219]
 s_waitcnt vmcnt(33) lgkmcnt(0)
 v_exp_f32 v24, v74
M v[216:219], a[88:91], v[48:51], v[216:219]
 s_barrier
M v[224:227], a[96:99], v[48:51], v[224:227]
 s_cselect_b32 s21, s26, s21
 ds_read_b128 a[64:67], v7 offset:32768
 ds_read_b128 a[68:71], v7 offset:33792
M v[224:227], a[100:103], v[56:59], v[224:227]
 s_cmp_eq_u32 s22, s43
 v_cndmask_b32 v124, v36, v8, s[88:89]
 v_add_f32 v26, v22, v26
M v[228:231], a[100:103], v[60:63], v[228:231]
 s_cselect_b32 s21, s4, s21
 v_exp_f32 v25, v75
M v[228:231], a[96:99], v[52:55], v[228:231]
 s_cmp_eq_u32 s22, s6
 ds_read_b128 a[72:75], v7 offset:34816
 ds_read_b128 a[76:79], v7 offset:35840
M v[236:239], a[104:107], v[52:55], v[236:239]
 s_cselect_b32 s21, s7, s21
 v_cndmask_b32 v125, v36, v8, s[90:91]
 v_cvt_pk_bf16_f32 v42, v22, v23
M v[236:239], a[108:111], v[60:63], v[236:239]
 v_exp_f32 v18, v68
M v[232:235], a[108:111], v[56:59], v[232:235]
 ds_read_b128 a[80:83], v7 offset:36864
 ds_read_b128 a[84:87], v7 offset:37888
M v[232:235], a[104:107], v[48:51], v[232:235]
 v_cndmask_b32 v126, v36, v8, s[92:93]
 v_add_f32 v26, v23, v26
M v[240:243], a[112:115], v[48:51], v[240:243]
 v_exp_f32 v19, v69
M v[240:243], a[116:119], v[56:59], v[240:243]
 ds_read_b128 a[88:91], v7 offset:38912
 ds_read_b128 a[92:95], v7 offset:39936
M v[244:247], a[116:119], v[60:63], v[244:247]
 v_cndmask_b32 v127, v36, v8, s[94:95]
 v_add_f32 v26, v24, v26
M v[244:247], a[112:115], v[52:55], v[244:247]
 v_exp_f32 v20, v70
M v[252:255], a[120:123], v[52:55], v[252:255]
 v_exp_f32 v21, v71
M v[252:255], a[124:127], v[60:63], v[252:255]
 v_exp_f32 v22, v76
M v[248:251], a[124:127], v[56:59], v[248:251]
 s_waitcnt lgkmcnt(0)
 v_exp_f32 v23, v77
M v[248:251], a[120:123], v[48:51], v[248:251]
 v_cvt_pk_bf16_f32 v43, v24, v25
 v_add_f32 v26, v25, v26
 v_add_f32 v27, v18, v19
 v_cvt_pk_bf16_f32 v44, v18, v19
 v_add_f32 v27, v20, v27
 v_cvt_pk_bf16_f32 v45, v20, v21
 v_add_f32 v27, v21, v27
 v_exp_f32 v24, v78
 v_add_f32 v27, v22, v27
 v_cvt_pk_bf16_f32 v46, v22, v23
 v_exp_f32 v25, v79
 v_add_f32 v27, v23, v27
 v_add_f32 v27, v24, v27
 v_cvt_pk_bf16_f32 v47, v24, v25
 v_add_f32 v27, v25, v27
 s_waitcnt vmcnt(31)
 v_cmp_neq_f32 vcc, v32, v14
 v_cmp_neq_f32 s[64:65], v36, v15
 s_nop 0
 s_or_b64 vcc, vcc, s[64:65]
 s_cbranch_vccnz L_comb
 v_add_f32 v30, v16, v30
 v_add_f32 v31, v17, v31
M v[100:103], a[64:67], a[32:35], v[100:103]
 ds_read_b128 a[96:99], v7 offset:40960
 ds_read_b128 a[100:103], v7 offset:41984
M v[100:103], a[68:71], a[36:39], v[100:103]
 ds_read_b128 a[104:107], v7 offset:43008
M v[100:103], a[72:75], a[40:43], v[100:103]
 ds_read_b128 a[108:111], v7 offset:44032
 ds_read_b128 a[112:115], v7 offset:45056
M v[100:103], a[76:79], a[44:47], v[100:103]
 ds_read_b128 a[116:119], v7 offset:46080
M v[100:103], a[80:83], a[48:51], v[100:103]
 s_add_u32 m0, s28, 0
 ds_read_b128 a[120:123], v7 offset:47104
 ds_read_b128 a[124:127], v7 offset:48128
M v[100:103], a[84:87], a[52:55], v[100:103]
 buffer_load_dwordx4 v3, s[8:11], s24 offen offset:0 sc1 lds
M v[100:103], a[88:91], a[56:59], v[100:103]
 ds_read_b128 a[0:3], v7 offset:49152
 ds_read_b128 a[4:7], v7 offset:50176
M v[100:103], a[92:95], a[60:63], v[100:103]
 s_waitcnt lgkmcnt(2)
 ds_read_b128 a[8:11], v7 offset:51200
M v[108:111], a[124:127], a[60:63], v[108:111]
 ds_read_b128 a[12:15], v7 offset:52224
 ds_read_b128 a[16:19], v7 offset:53248
M v[108:111], a[120:123], a[56:59], v[108:111]
 buffer_load_dwordx4 v3, s[8:11], s24 offen offset:1024 sc1 lds
M v[108:111], a[116:119], a[52:55], v[108:111]
 ds_read_b128 a[20:23], v7 offset:54272
 ds_read_b128 a[24:27], v7 offset:55296
M v[108:111], a[112:115], a[48:51], v[108:111]
 ds_read_b128 a[28:31], v7 offset:56320
M v[108:111], a[108:111], a[44:47], v[108:111]
 ds_read_b128 a[192:195], v7 offset:57344
 ds_read_b128 a[196:199], v7 offset:58368
M v[108:111], a[104:107], a[40:43], v[108:111]
 v_exp_f32 v18, v80
M v[108:111], a[100:103], a[36:39], v[108:111]
 ds_read_b128 a[200:203], v7 offset:59392
 ds_read_b128 a[204:207], v7 offset:60416
M v[108:111], a[96:99], a[32:35], v[108:111]
 s_waitcnt lgkmcnt(4)
 ds_read_b128 a[208:211], v7 offset:61440
M v[116:119], a[0:3], a[32:35], v[116:119]
 ds_read_b128 a[212:215], v7 offset:62464
 ds_read_b128 a[216:219], v7 offset:63488
M v[116:119], a[4:7], a[36:39], v[116:119]
 ds_read_b128 a[220:223], v7 offset:64512
M v[116:119], a[8:11], a[40:43], v[116:119]
 buffer_load_dwordx4 v3, s[8:11], s24 offen offset:2048 sc1 lds
M v[116:119], a[12:15], a[44:47], v[116:119]
 v_exp_f32 v19, v81
M v[116:119], a[16:19], a[48:51], v[116:119]
 buffer_load_dwordx4 v3, s[8:11], s24 offen offset:3072 sc1 lds
M v[116:119], a[20:23], a[52:55], v[116:119]
 v_exp_f32 v20, v82
M v[116:119], a[24:27], a[56:59], v[116:119]
 s_add_u32 m0, s28, 4096
 v_exp_f32 v21, v83
M v[116:119], a[28:31], a[60:63], v[116:119]
 s_waitcnt lgkmcnt(0)
 v_exp_f32 v22, v88
M v[124:127], a[220:223], a[60:63], v[124:127]
 buffer_load_dwordx4 v4, s[8:11], s24 offen offset:0 sc1 lds
M v[124:127], a[216:219], a[56:59], v[124:127]
 v_exp_f32 v23, v89
M v[124:127], a[212:215], a[52:55], v[124:127]
 v_exp_f32 v24, v90
M v[124:127], a[208:211], a[48:51], v[124:127]
 v_exp_f32 v25, v91
M v[124:127], a[204:207], a[44:47], v[124:127]
 v_add_f32 v26, v18, v26
 v_cvt_pk_bf16_f32 v56, v18, v19
M v[124:127], a[200:203], a[40:43], v[124:127]
 buffer_load_dwordx4 v4, s[8:11], s24 offen offset:1024 sc1 lds
M v[124:127], a[196:199], a[36:39], v[124:127]
 v_add_f32 v26, v19, v26
 v_add_f32 v26, v20, v26
M v[124:127], a[192:195], a[32:35], v[124:127]
 s_waitcnt vmcnt(22)
 v_exp_f32 v18, v84
M v[128:131], a[246:249], a[128:131], v[128:131]
 v_exp_f32 v19, v85
M v[136:139], a[244:247], a[128:131], v[136:139]
 v_cvt_pk_bf16_f32 v57, v20, v21
 v_add_f32 v26, v21, v26
M v[144:147], a[246:249], a[132:135], v[144:147]
 buffer_load_dwordx4 v4, s[8:11], s24 offen offset:2048 sc1 lds
M v[152:155], a[244:247], a[132:135], v[152:155]
 v_exp_f32 v20, v86
M v[160:163], a[246:249], a[136:139], v[160:163]
 v_add_f32 v26, v22, v26
 v_cvt_pk_bf16_f32 v58, v22, v23
M v[168:171], a[244:247], a[136:139], v[168:171]
 v_add_f32 v26, v23, v26
 v_add_f32 v26, v24, v26
M v[176:179], a[246:249], a[140:143], v[176:179]
 v_exp_f32 v21, v87
M v[184:187], a[244:247], a[140:143], v[184:187]
 buffer_load_dwordx4 v4, s[8:11], s24 offen offset:3072 sc1 lds
M v[192:195], a[246:249], a[144:147], v[192:195]
 v_cvt_pk_bf16_f32 v59, v24, v25
 v_add_f32 v26, v25, v26
M v[200:203], a[244:247], a[144:147], v[200:203]
 v_add_f32 v27, v18, v27
 v_cvt_pk_bf16_f32 v60, v18, v19
M v[208:211], a[246:249], a[148:151], v[208:211]
 v_exp_f32 v22, v92
M v[216:219], a[244:247], a[148:151], v[216:219]
 v_add_f32 v27, v19, v27
 v_add_f32 v27, v20, v27
M v[224:227], a[246:249], a[152:155], v[224:227]
 v_cvt_pk_bf16_f32 v61, v20, v21
 v_add_f32 v27, v21, v27
M v[232:235], a[244:247], a[152:155], v[232:235]
 s_waitcnt vmcnt(8)
 v_exp_f32 v23, v93
M v[240:243], a[246:249], a[156:159], v[240:243]
 v_add_f32 v27, v22, v27
 v_cvt_pk_bf16_f32 v62, v22, v23
M v[248:251], a[244:247], a[156:159], v[248:251]
 s_barrier
M v[132:135], a[246:249], a[160:163], v[132:135]
 ds_read_b128 a[64:67], v2 offset:0
 v_add_f32 v27, v23, v27
M v[140:143], a[244:247], a[160:163], v[140:143]
 ds_read_b128 a[68:71], v2 offset:1024
M v[148:151], a[246:249], a[164:167], v[148:151]
 v_exp_f32 v24, v94
M v[156:159], a[244:247], a[164:167], v[156:159]
 ds_read_b128 a[72:75], v2 offset:2048
M v[164:167], a[246:249], a[168:171], v[164:167]
 ds_read_b128 a[76:79], v2 offset:3072
M v[172:175], a[244:247], a[168:171], v[172:175]
 v_exp_f32 v25, v95
M v[180:183], a[246:249], a[172:175], v[180:183]
 ds_read_b128 a[80:83], v2 offset:4096
 v_add_f32 v27, v24, v27
M v[188:191], a[244:247], a[172:175], v[188:191]
 ds_read_b128 a[84:87], v2 offset:5120
 v_cvt_pk_bf16_f32 v63, v24, v25
M v[196:199], a[246:249], a[176:179], v[196:199]
 v_add_f32 v27, v25, v27
M v[204:207], a[244:247], a[176:179], v[204:207]
 ds_read_b128 a[88:91], v2 offset:6144
M v[212:215], a[246:249], a[180:183], v[212:215]
 ds_read_b128 a[92:95], v2 offset:7168
 v_max_f32 v10, v26, v27
M v[220:223], a[244:247], a[180:183], v[220:223]
 v_cmp_lt_f32 vcc, s31, v10
M v[228:231], a[246:249], a[184:187], v[228:231]
M v[236:239], a[244:247], a[184:187], v[236:239]
M v[244:247], a[246:249], a[188:191], v[244:247]
 s_waitcnt lgkmcnt(0)
M v[252:255], a[244:247], a[188:191], v[252:255]
 s_cbranch_vccnz L_st14
L_rt14:
 s_branch L_p3o
L_op1:
M v[64:67], a[64:67], v[128:131], 0
 ds_read_b128 a[96:99], v2 offset:40960
 ds_read_b128 a[100:103], v2 offset:41984
M v[64:67], a[68:71], v[144:147], v[64:67]
 ds_read_b128 a[104:107], v2 offset:43008
 v_cvt_pk_bf16_f32 v132, v132, v133
 v_cvt_pk_bf16_f32 v133, v134, v135
M v[64:67], a[72:75], v[160:163], v[64:67]
 ds_read_b128 a[108:111], v2 offset:44032
 ds_read_b128 a[112:115], v2 offset:45056
M v[64:67], a[76:79], v[176:179], v[64:67]
 ds_read_b128 a[116:119], v2 offset:46080
 v_cvt_pk_bf16_f32 v134, v140, v141
 v_cvt_pk_bf16_f32 v135, v142, v143
M v[64:67], a[80:83], v[192:195], v[64:67]
 s_add_u32 m0, s28, 0
 ds_read_b128 a[120:123], v2 offset:47104
 ds_read_b128 a[124:127], v2 offset:48128
M v[64:67], a[84:87], v[208:211], v[64:67]
 buffer_load_dwordx4 v3, s[8:11], s38 offen offset:0 sc1 lds
M v[64:67], a[88:91], v[224:227], v[64:67]
 ds_read_b128 a[128:131], v2 offset:49152
 ds_read_b128 a[132:135], v2 offset:50176
 v_cvt_pk_bf16_f32 v148, v148, v149
M v[64:67], a[92:95], v[240:243], v[64:67]
 s_waitcnt lgkmcnt(2)
 ds_read_b128 a[136:139], v2 offset:51200
 v_cvt_pk_bf16_f32 v149, v150, v151
M v[72:75], a[96:99], v[128:131], 0
 ds_read_b128 a[140:143], v2 offset:52224
 ds_read_b128 a[144:147], v2 offset:53248
M v[72:75], a[100:103], v[144:147], v[72:75]
 buffer_load_dwordx4 v3, s[8:11], s38 offen offset:1024 sc1 lds
M v[72:75], a[104:107], v[160:163], v[72:75]
 ds_read_b128 a[148:151], v2 offset:54272
 ds_read_b128 a[152:155], v2 offset:55296
 v_cvt_pk_bf16_f32 v150, v156, v157
M v[72:75], a[108:111], v[176:179], v[72:75]
 ds_read_b128 a[156:159], v2 offset:56320
 v_cvt_pk_bf16_f32 v151, v158, v159
M v[72:75], a[112:115], v[192:195], v[72:75]
 ds_read_b128 a[160:163], v2 offset:57344
 ds_read_b128 a[164:167], v2 offset:58368
 v_cvt_pk_bf16_f32 v164, v164, v165
M v[72:75], a[116:119], v[208:211], v[72:75]
 buffer_load_dwordx4 v3, s[8:11], s38 offen offset:2048 sc1 lds
M v[72:75], a[120:123], v[224:227], v[72:75]
 ds_read_b128 a[168:171], v2 offset:59392
 ds_read_b128 a[172:175], v2 offset:60416
M v[72:75], a[124:127], v[240:243], v[72:75]
 s_waitcnt lgkmcnt(4)
 ds_read_b128 a[176:179], v2 offset:61440
 v_cvt_pk_bf16_f32 v165, v166, v167
 v_cvt_pk_bf16_f32 v166, v172, v173
M v[80:83], a[128:131], v[128:131], 0
 ds_read_b128 a[180:183], v2 offset:62464
 ds_read_b128 a[184:187], v2 offset:63488
M v[80:83], a[132:135], v[144:147], v[80:83]
 ds_read_b128 a[188:191], v2 offset:64512
 v_cvt_pk_bf16_f32 v167, v174, v175
 v_cvt_pk_bf16_f32 v180, v180, v181
M v[80:83], a[136:139], v[160:163], v[80:83]
 buffer_load_dwordx4 v3, s[8:11], s38 offen offset:3072 sc1 lds
M v[80:83], a[140:143], v[176:179], v[80:83]
 s_add_u32 m0, s28, 4096
 v_cvt_pk_bf16_f32 v181, v182, v183
 v_cvt_pk_bf16_f32 v182, v188, v189
M v[80:83], a[144:147], v[192:195], v[80:83]
 buffer_load_dwordx4 v4, s[8:11], s38 offen offset:0 sc1 lds
M v[80:83], a[148:151], v[208:211], v[80:83]
 v_cvt_pk_bf16_f32 v183, v190, v191
 v_cvt_pk_bf16_f32 v196, v196, v197
M v[80:83], a[152:155], v[224:227], v[80:83]
 buffer_load_dwordx4 v4, s[8:11], s38 offen offset:1024 sc1 lds
M v[80:83], a[156:159], v[240:243], v[80:83]
 s_waitcnt lgkmcnt(0)
 v_cvt_pk_bf16_f32 v197, v198, v199
 v_cvt_pk_bf16_f32 v198, v204, v205
 v_cvt_pk_bf16_f32 v199, v206, v207
M v[88:91], a[160:163], v[128:131], 0
 v_cvt_pk_bf16_f32 v212, v212, v213
 v_cvt_pk_bf16_f32 v213, v214, v215
M v[88:91], a[164:167], v[144:147], v[88:91]
 v_cvt_pk_bf16_f32 v214, v220, v221
 v_cvt_pk_bf16_f32 v215, v222, v223
 v_cvt_pk_bf16_f32 v228, v228, v229
M v[88:91], a[168:171], v[160:163], v[88:91]
 buffer_load_dwordx4 v4, s[8:11], s38 offen offset:2048 sc1 lds
M v[88:91], a[172:175], v[176:179], v[88:91]
 v_cvt_pk_bf16_f32 v229, v230, v231
 v_cvt_pk_bf16_f32 v230, v236, v237
M v[88:91], a[176:179], v[192:195], v[88:91]
 v_cvt_pk_bf16_f32 v231, v238, v239
 v_cvt_pk_bf16_f32 v244, v244, v245
 v_cvt_pk_bf16_f32 v245, v246, v247
M v[88:91], a[180:183], v[208:211], v[88:91]
 buffer_load_dwordx4 v4, s[8:11], s38 offen offset:3072 sc1 lds
M v[88:91], a[184:187], v[224:227], v[88:91]
 v_cvt_pk_bf16_f32 v246, v252, v253
 v_cvt_pk_bf16_f32 v247, v254, v255
M v[88:91], a[188:191], v[240:243], v[88:91]
 s_add_u32 s38, s38, 32768
 v_add_f32 v31, v29, v31
 v_mov_b32 v10, v30
M v[68:71], a[64:67], v[132:135], 0
 s_add_u32 m0, s28, 131072
 v_mov_b32 v11, v31
 v_permlane16_swap_b32 v10, v30
M v[68:71], a[68:71], v[148:151], v[68:71]
 buffer_load_dwordx4 v3, s[8:11], s38 offen offset:0 sc1 lds
M v[68:71], a[72:75], v[164:167], v[68:71]
 v_permlane16_swap_b32 v11, v31
 v_add_f32 v30, v10, v30
M v[68:71], a[76:79], v[180:183], v[68:71]
 v_add_f32 v31, v11, v31
 v_mov_b32 v10, v30
M v[68:71], a[80:83], v[196:199], v[68:71]
 buffer_load_dwordx4 v3, s[8:11], s38 offen offset:1024 sc1 lds
M v[68:71], a[84:87], v[212:215], v[68:71]
 v_mov_b32 v11, v31
 v_permlane32_swap_b32 v10, v30
M v[68:71], a[88:91], v[228:231], v[68:71]
 v_permlane32_swap_b32 v11, v31
 v_add_f32 v30, v10, v30
M v[68:71], a[92:95], v[244:247], v[68:71]
 v_add_f32 v31, v11, v31
M v[76:79], a[96:99], v[132:135], 0
 buffer_load_dwordx4 v3, s[8:11], s38 offen offset:2048 sc1 lds
M v[76:79], a[100:103], v[148:151], v[76:79]
 v_rcp_f32 v5, v30
M v[76:79], a[104:107], v[164:167], v[76:79]
 v_rcp_f32 v6, v31
M v[76:79], a[108:111], v[180:183], v[76:79]
 buffer_load_dwordx4 v3, s[8:11], s38 offen offset:3072 sc1 lds
M v[76:79], a[112:115], v[196:199], v[76:79]
 v_max3_f32 v32, |v64|, |v65|, |v66|
M v[76:79], a[116:119], v[212:215], v[76:79]
 v_max3_f32 v32, |v67|, |v72|, v32
 v_max3_f32 v32, |v73|, |v74|, v32
M v[76:79], a[120:123], v[228:231], v[76:79]
 s_waitcnt vmcnt(20)
 v_mul_f32 v32, 2.0, v32
 v_mov_b32 v33, v32
M v[76:79], a[124:127], v[244:247], v[76:79]
 s_barrier
M v[84:87], a[128:131], v[132:135], 0
 ds_read_b128 a[64:67], v7 offset:32768
 v_mov_b32 v34, v32
M v[84:87], a[132:135], v[148:151], v[84:87]
 s_add_u32 m0, s28, 135168
 ds_read_b128 a[68:71], v7 offset:33792
M v[84:87], a[136:139], v[164:167], v[84:87]
 buffer_load_dwordx4 v4, s[8:11], s38 offen offset:0 sc1 lds
M v[84:87], a[140:143], v[180:183], v[84:87]
 ds_read_b128 a[72:75], v7 offset:34816
 v_mov_b32 v35, v32
M v[84:87], a[144:147], v[196:199], v[84:87]
 ds_read_b128 a[76:79], v7 offset:35840
 v_max3_f32 v36, |v68|, |v69|, |v70|
M v[84:87], a[148:151], v[212:215], v[84:87]
 buffer_load_dwordx4 v4, s[8:11], s38 offen offset:1024 sc1 lds
M v[84:87], a[152:155], v[228:231], v[84:87]
 ds_read_b128 a[80:83], v7 offset:36864
M v[84:87], a[156:159], v[244:247], v[84:87]
 ds_read_b128 a[84:87], v7 offset:37888
 v_max3_f32 v36, |v71|, |v76|, v36
M v[92:95], a[160:163], v[132:135], 0
 buffer_load_dwordx4 v4, s[8:11], s38 offen offset:2048 sc1 lds
M v[92:95], a[164:167], v[148:151], v[92:95]
 ds_read_b128 a[88:91], v7 offset:38912
 v_max3_f32 v36, |v77|, |v78|, v36
M v[92:95], a[168:171], v[164:167], v[92:95]
 ds_read_b128 a[92:95], v7 offset:39936
 v_mul_f32 v36, 2.0, v36
M v[92:95], a[172:175], v[180:183], v[92:95]
 buffer_load_dwordx4 v4, s[8:11], s38 offen offset:3072 sc1 lds
M v[92:95], a[176:179], v[196:199], v[92:95]
 s_add_u32 s38, s38, 32768
 v_mov_b32 v37, v36
M v[92:95], a[180:183], v[212:215], v[92:95]
 v_mov_b32 v38, v36
 v_mov_b32 v39, v36
M v[92:95], a[184:187], v[228:231], v[92:95]
 s_waitcnt lgkmcnt(0)
 s_cmp_eq_u32 s42, 6
M v[92:95], a[188:191], v[244:247], v[92:95]
 s_cbranch_scc1 L_y1
L_y1r:
M v[96:99], a[64:67], v[128:131], v[32:35]
 s_add_u32 m0, s28, 98304
 ds_read_b128 a[96:99], v7 offset:40960
M v[96:99], a[68:71], v[144:147], v[96:99]
 ds_read_b128 a[100:103], v7 offset:41984
M v[96:99], a[72:75], v[160:163], v[96:99]
 buffer_load_dwordx4 v3, s[8:11], s38 offen offset:0 sc1 lds
M v[96:99], a[76:79], v[176:179], v[96:99]
 ds_read_b128 a[104:107], v7 offset:43008
 s_add_u32 s29, s33, 0
M v[96:99], a[80:83], v[192:195], v[96:99]
 ds_read_b128 a[108:111], v7 offset:44032
 s_add_u32 s30, s33, 14336
M v[96:99], a[84:87], v[208:211], v[96:99]
 buffer_load_dwordx4 v3, s[8:11], s38 offen offset:1024 sc1 lds
M v[96:99], a[88:91], v[224:227], v[96:99]
 ds_read_b128 a[112:115], v7 offset:45056
 v_mul_f32 v28, -v32, v5
M v[96:99], a[92:95], v[240:243], v[96:99]
 ds_read_b128 a[116:119], v7 offset:46080
 v_mul_f32 v64, v5, v64
M v[100:103], a[92:95], v[244:247], v[36:39]
 buffer_load_dwordx4 v3, s[8:11], s38 offen offset:2048 sc1 lds
M v[100:103], a[88:91], v[228:231], v[100:103]
 ds_read_b128 a[120:123], v7 offset:47104
 v_mul_f32 v65, v5, v65
M v[100:103], a[84:87], v[212:215], v[100:103]
 ds_read_b128 a[124:127], v7 offset:48128
 v_mul_f32 v66, v5, v66
M v[100:103], a[80:83], v[196:199], v[100:103]
 buffer_load_dwordx4 v3, s[8:11], s38 offen offset:3072 sc1 lds
M v[100:103], a[76:79], v[180:183], v[100:103]
 s_add_u32 m0, s28, 102400
 v_mul_f32 v67, v5, v67
 v_mul_f32 v72, v5, v72
M v[100:103], a[72:75], v[164:167], v[100:103]
 buffer_load_dwordx4 v4, s[8:11], s38 offen offset:0 sc1 lds
M v[100:103], a[68:71], v[148:151], v[100:103]
 v_mul_f32 v73, v5, v73
 v_mul_f32 v74, v5, v74
M v[100:103], a[64:67], v[132:135], v[100:103]
 s_waitcnt lgkmcnt(0)
 v_mul_f32 v75, v5, v75
 v_cvt_pk_bf16_f32 v64, v64, v65
M v[108:111], a[96:99], v[132:135], v[36:39]
 ds_read_b128 a[64:67], v7 offset:49152
 v_cvt_pk_bf16_f32 v65, v66, v67
M v[108:111], a[100:103], v[148:151], v[108:111]
 ds_read_b128 a[68:71], v7 offset:50176
 v_cvt_pk_bf16_f32 v66, v72, v73
M v[108:111], a[104:107], v[164:167], v[108:111]
 buffer_load_dwordx4 v4, s[8:11], s38 offen offset:1024 sc1 lds
M v[108:111], a[108:111], v[180:183], v[108:111]
 ds_read_b128 a[72:75], v7 offset:51200
 v_cvt_pk_bf16_f32 v67, v74, v75
M v[108:111], a[112:115], v[196:199], v[108:111]
 ds_read_b128 a[76:79], v7 offset:52224
M v[108:111], a[116:119], v[212:215], v[108:111]
 buffer_load_dwordx4 v4, s[8:11], s38 offen offset:2048 sc1 lds
M v[108:111], a[120:123], v[228:231], v[108:111]
 ds_read_b128 a[80:83], v7 offset:53248
M v[108:111], a[124:127], v[244:247], v[108:111]
 ds_read_b128 a[84:87], v7 offset:54272
M v[104:107], a[124:127], v[240:243], v[32:35]
 buffer_load_dwordx4 v4, s[8:11], s38 offen offset:3072 sc1 lds
M v[104:107], a[120:123], v[224:227], v[104:107]
 s_add_u32 s38, s38, 32768
 ds_read_b128 a[88:91], v7 offset:55296
M v[104:107], a[116:119], v[208:211], v[104:107]
 ds_read_b128 a[92:95], v7 offset:56320
M v[104:107], a[112:115], v[192:195], v[104:107]
 buffer_store_dwordx4 v[64:67], v7, s[8:11], s29 offen offset:0 sc1
M v[104:107], a[108:111], v[176:179], v[104:107]
 v_mul_f32 v29, -v36, v6
 v_mul_f32 v68, v6, v68
M v[104:107], a[104:107], v[160:163], v[104:107]
 v_mul_f32 v69, v6, v69
 v_mul_f32 v70, v6, v70
M v[104:107], a[100:103], v[144:147], v[104:107]
 v_mul_f32 v71, v6, v71
 v_mul_f32 v76, v6, v76
M v[104:107], a[96:99], v[128:131], v[104:107]
 s_waitcnt lgkmcnt(0)
 v_mul_f32 v77, v6, v77
 v_mul_f32 v78, v6, v78
M v[112:115], a[64:67], v[128:131], v[32:35]
 ds_read_b128 a[96:99], v7 offset:57344
 v_mul_f32 v79, v6, v79
M v[112:115], a[68:71], v[144:147], v[112:115]
 ds_read_b128 a[100:103], v7 offset:58368
 v_cvt_pk_bf16_f32 v68, v68, v69
M v[112:115], a[72:75], v[160:163], v[112:115]
 v_cvt_pk_bf16_f32 v69, v70, v71
 v_cvt_pk_bf16_f32 v70, v76, v77
M v[112:115], a[76:79], v[176:179], v[112:115]
 ds_read_b128 a[104:107], v7 offset:59392
 v_cvt_pk_bf16_f32 v71, v78, v79
M v[112:115], a[80:83], v[192:195], v[112:115]
 ds_read_b128 a[108:111], v7 offset:60416
M v[112:115], a[84:87], v[208:211], v[112:115]
 buffer_store_dwordx4 v[68:71], v7, s[8:11], s30 offen offset:0 sc1
M v[112:115], a[88:91], v[224:227], v[112:115]
 ds_read_b128 a[112:115], v7 offset:61440
 v_mul_f32 v80, v5, v80
M v[112:115], a[92:95], v[240:243], v[112:115]
 ds_read_b128 a[116:119], v7 offset:62464
 v_mul_f32 v81, v5, v81
M v[116:119], a[92:95], v[244:247], v[36:39]
 v_mul_f32 v82, v5, v82
 v_mul_f32 v83, v5, v83
M v[116:119], a[88:91], v[228:231], v[116:119]
 ds_read_b128 a[120:123], v7 offset:63488
 v_mul_f32 v88, v5, v88
M v[116:119], a[84:87], v[212:215], v[116:119]
 ds_read_b128 a[124:127], v7 offset:64512
 v_mul_f32 v89, v5, v89
M v[116:119], a[80:83], v[196:199], v[116:119]
 v_mul_f32 v90, v5, v90
 v_mul_f32 v91, v5, v91
M v[116:119], a[76:79], v[180:183], v[116:119]
 v_cvt_pk_bf16_f32 v80, v80, v81
 v_cvt_pk_bf16_f32 v81, v82, v83
M v[116:119], a[72:75], v[164:167], v[116:119]
 v_cvt_pk_bf16_f32 v82, v88, v89
 v_cvt_pk_bf16_f32 v83, v90, v91
M v[116:119], a[68:71], v[148:151], v[116:119]
 s_waitcnt vmcnt(26) lgkmcnt(0)
M v[116:119], a[64:67], v[132:135], v[116:119]
 s_barrier
M v[124:127], a[96:99], v[132:135], v[36:39]
 ds_read_b128 a[64:67], v2 offset:0
M v[124:127], a[100:103], v[148:151], v[124:127]
 ds_read_b128 a[68:71], v2 offset:1024
M v[124:127], a[104:107], v[164:167], v[124:127]
 buffer_store_dwordx4 v[80:83], v7, s[8:11], s29 offen offset:1024 sc1
M v[124:127], a[108:111], v[180:183], v[124:127]
 ds_read_b128 a[72:75], v2 offset:2048
 v_mul_f32 v84, v6, v84
M v[124:127], a[112:115], v[196:199], v[124:127]
 ds_read_b128 a[76:79], v2 offset:3072
 v_mul_f32 v85, v6, v85
M v[124:127], a[116:119], v[212:215], v[124:127]
 v_mul_f32 v86, v6, v86
 v_mul_f32 v87, v6, v87
M v[124:127], a[120:123], v[228:231], v[124:127]
 ds_read_b128 a[80:83], v2 offset:4096
 v_mul_f32 v92, v6, v92
M v[124:127], a[124:127], v[244:247], v[124:127]
 ds_read_b128 a[84:87], v2 offset:5120
 v_mul_f32 v93, v6, v93
M v[120:123], a[124:127], v[240:243], v[32:35]
 v_mul_f32 v94, v6, v94
 v_mul_f32 v95, v6, v95
M v[120:123], a[120:123], v[224:227], v[120:123]
 ds_read_b128 a[88:91], v2 offset:6144
 v_cvt_pk_bf16_f32 v84, v84, v85
M v[120:123], a[116:119], v[208:211], v[120:123]
 ds_read_b128 a[92:95], v2 offset:7168
 v_cvt_pk_bf16_f32 v85, v86, v87
M v[120:123], a[112:115], v[192:195], v[120:123]
 v_cvt_pk_bf16_f32 v86, v92, v93
 v_cvt_pk_bf16_f32 v87, v94, v95
M v[120:123], a[108:111], v[176:179], v[120:123]
 buffer_store_dwordx4 v[84:87], v7, s[8:11], s30 offen offset:1024 sc1
M v[120:123], a[104:107], v[160:163], v[120:123]
M v[120:123], a[100:103], v[144:147], v[120:123]
 s_waitcnt lgkmcnt(0)
M v[120:123], a[96:99], v[128:131], v[120:123]
M v[64:67], a[64:67], v[128:131], v[32:35]
 s_add_u32 m0, s28, 32768
 ds_read_b128 a[96:99], v2 offset:8192
M v[64:67], a[68:71], v[144:147], v[64:67]
 ds_read_b128 a[100:103], v2 offset:9216
 s_mov_b32 s79, 104923136
M v[64:67], a[72:75], v[160:163], v[64:67]
 buffer_load_dwordx4 v3, s[8:11], s38 offen offset:0 sc1 lds
M v[64:67], a[76:79], v[176:179], v[64:67]
 ds_read_b128 a[104:107], v2 offset:10240
 s_add_u32 s29, s33, 2048
M v[64:67], a[80:83], v[192:195], v[64:67]
 ds_read_b128 a[108:111], v2 offset:11264
 s_add_u32 s30, s33, 16384
M v[64:67], a[84:87], v[208:211], v[64:67]
 buffer_load_dwordx4 v3, s[8:11], s38 offen offset:1024 sc1 lds
M v[64:67], a[88:91], v[224:227], v[64:67]
 ds_read_b128 a[112:115], v2 offset:12288
 v_fma_f32 v96, v96, v5, v28
M v[64:67], a[92:95], v[240:243], v[64:67]
 ds_read_b128 a[116:119], v2 offset:13312
 v_fma_f32 v97, v97, v5, v28
M v[68:71], a[92:95], v[244:247], v[36:39]
 buffer_load_dwordx4 v3, s[8:11], s38 offen offset:2048 sc1 lds
M v[68:71], a[88:91], v[228:231], v[68:71]
 ds_read_b128 a[120:123], v2 offset:14336
 v_fma_f32 v98, v98, v5, v28
M v[68:71], a[84:87], v[212:215], v[68:71]
 ds_read_b128 a[124:127], v2 offset:15360
 v_fma_f32 v99, v99, v5, v28
M v[68:71], a[80:83], v[196:199], v[68:71]
 buffer_load_dwordx4 v3, s[8:11], s38 offen offset:3072 sc1 lds
M v[68:71], a[76:79], v[180:183], v[68:71]
 s_add_u32 m0, s28, 36864
 v_fma_f32 v104, v104, v5, v28
 v_fma_f32 v105, v105, v5, v28
M v[68:71], a[72:75], v[164:167], v[68:71]
 buffer_load_dwordx4 v4, s[8:11], s38 offen offset:0 sc1 lds
M v[68:71], a[68:71], v[148:151], v[68:71]
 buffer_load_dword v24, off, s[8:11], s79 sc1
M v[68:71], a[64:67], v[132:135], v[68:71]
 s_waitcnt lgkmcnt(0)
 v_lshrrev_b32 v0, 4, v7
 v_and_b32 v14, 15, v0
M v[76:79], a[96:99], v[132:135], v[36:39]
 ds_read_b128 a[64:67], v2 offset:16384
 v_lshlrev_b32 v14, 2, v14
M v[76:79], a[100:103], v[148:151], v[76:79]
 ds_read_b128 a[68:71], v2 offset:17408
 v_lshrrev_b32 v11, 4, v0
M v[76:79], a[104:107], v[164:167], v[76:79]
 buffer_load_dwordx4 v4, s[8:11], s38 offen offset:1024 sc1 lds
M v[76:79], a[108:111], v[180:183], v[76:79]
 ds_read_b128 a[72:75], v2 offset:18432
 s_mov_b32 s52, s96
M v[76:79], a[112:115], v[196:199], v[76:79]
 s_and_b32 s53, s97, 0xffff
 ds_read_b128 a[76:79], v2 offset:19456
 s_mov_b32 s54, 1835008
M v[76:79], a[116:119], v[212:215], v[76:79]
 buffer_load_dwordx4 v4, s[8:11], s38 offen offset:2048 sc1 lds
M v[76:79], a[120:123], v[228:231], v[76:79]
 ds_read_b128 a[80:83], v2 offset:20480
 s_mov_b32 s55, 0x20000
M v[76:79], a[124:127], v[244:247], v[76:79]
 s_lshr_b32 s74, s41, 3
 ds_read_b128 a[84:87], v2 offset:21504
 s_xor_b32 s74, s74, 0
M v[72:75], a[124:127], v[240:243], v[32:35]
 buffer_load_dwordx4 v4, s[8:11], s38 offen offset:3072 sc1 lds
M v[72:75], a[120:123], v[224:227], v[72:75]
 s_add_u32 s38, s38, 32768
 ds_read_b128 a[88:91], v2 offset:22528
 s_mul_i32 s67, s74, -2
M v[72:75], a[116:119], v[208:211], v[72:75]
 s_mul_i32 s74, s74, 8
 ds_read_b128 a[92:95], v2 offset:23552
 v_fma_f32 v106, v106, v5, v28
M v[72:75], a[112:115], v[192:195], v[72:75]
 s_add_u32 s74, s74, s20
 v_fma_f32 v107, v107, v5, v28
 v_cvt_pk_bf16_f32 v96, v96, v97
M v[72:75], a[108:111], v[176:179], v[72:75]
 s_lshl_b32 s75, s74, 6
 v_cvt_pk_bf16_f32 v97, v98, v99
 v_cvt_pk_bf16_f32 v98, v104, v105
M v[72:75], a[104:107], v[160:163], v[72:75]
 s_add_u32 s76, s75, 256
 v_cvt_pk_bf16_f32 v99, v106, v107
M v[72:75], a[100:103], v[144:147], v[72:75]
 s_add_u32 s67, s67, 3
 v_add_u32 v43, 0x20000, v7
 s_sub_u32 s67, s67, s20
M v[72:75], a[96:99], v[128:131], v[72:75]
 s_waitcnt lgkmcnt(0)
 s_and_b32 s67, s67, 536870912
M v[80:83], a[64:67], v[128:131], v[32:35]
 s_or_b32 s76, s76, s67
 ds_read_b128 a[96:99], v2 offset:24576
 v_or_b32 v27, s67, v7
M v[80:83], a[68:71], v[144:147], v[80:83]
 ds_read_b128 a[100:103], v2 offset:25600
 v_add_u32 v27, 4096, v27
M v[80:83], a[72:75], v[160:163], v[80:83]
 buffer_store_dwordx4 v[96:99], v7, s[8:11], s29 offen offset:0 sc1
M v[80:83], a[76:79], v[176:179], v[80:83]
 ds_read_b128 a[104:107], v2 offset:26624
 v_fma_f32 v100, v100, v6, v29
M v[80:83], a[80:83], v[192:195], v[80:83]
 ds_read_b128 a[108:111], v2 offset:27648
 v_fma_f32 v101, v101, v6, v29
M v[80:83], a[84:87], v[208:211], v[80:83]
 v_fma_f32 v102, v102, v6, v29
 v_fma_f32 v103, v103, v6, v29
M v[80:83], a[88:91], v[224:227], v[80:83]
 ds_read_b128 a[112:115], v2 offset:28672
 v_fma_f32 v108, v108, v6, v29
M v[80:83], a[92:95], v[240:243], v[80:83]
 ds_read_b128 a[116:119], v2 offset:29696
 v_fma_f32 v109, v109, v6, v29
M v[84:87], a[92:95], v[244:247], v[36:39]
 v_fma_f32 v110, v110, v6, v29
 v_fma_f32 v111, v111, v6, v29
M v[84:87], a[88:91], v[228:231], v[84:87]
 ds_read_b128 a[120:123], v2 offset:30720
 v_cvt_pk_bf16_f32 v100, v100, v101
M v[84:87], a[84:87], v[212:215], v[84:87]
 ds_read_b128 a[124:127], v2 offset:31744
 v_cvt_pk_bf16_f32 v101, v102, v103
M v[84:87], a[80:83], v[196:199], v[84:87]
 v_cvt_pk_bf16_f32 v102, v108, v109
 v_cvt_pk_bf16_f32 v103, v110, v111
M v[84:87], a[76:79], v[180:183], v[84:87]
 buffer_store_dwordx4 v[100:103], v7, s[8:11], s30 offen offset:0 sc1
M v[84:87], a[72:75], v[164:167], v[84:87]
 v_fma_f32 v112, v112, v5, v28
 v_fma_f32 v113, v113, v5, v28
M v[84:87], a[68:71], v[148:151], v[84:87]
 s_waitcnt vmcnt(31) lgkmcnt(0)
 v_fma_f32 v114, v114, v5, v28
 v_fma_f32 v115, v115, v5, v28
M v[84:87], a[64:67], v[132:135], v[84:87]
 s_barrier
M v[92:95], a[96:99], v[132:135], v[36:39]
 ds_read_b128 a[64:67], v7 offset:0
 v_fma_f32 v120, v120, v5, v28
M v[92:95], a[100:103], v[148:151], v[92:95]
 ds_read_b128 a[68:71], v7 offset:1024
 v_fma_f32 v121, v121, v5, v28
M v[92:95], a[104:107], v[164:167], v[92:95]
 v_fma_f32 v122, v122, v5, v28
 v_fma_f32 v123, v123, v5, v28
M v[92:95], a[108:111], v[180:183], v[92:95]
 ds_read_b128 a[72:75], v7 offset:2048
 v_cvt_pk_bf16_f32 v112, v112, v113
M v[92:95], a[112:115], v[196:199], v[92:95]
 ds_read_b128 a[76:79], v7 offset:3072
 v_cvt_pk_bf16_f32 v113, v114, v115
M v[92:95], a[116:119], v[212:215], v[92:95]
 v_cvt_pk_bf16_f32 v114, v120, v121
 v_cvt_pk_bf16_f32 v115, v122, v123
M v[92:95], a[120:123], v[228:231], v[92:95]
 ds_read_b128 a[80:83], v7 offset:4096
M v[92:95], a[124:127], v[244:247], v[92:95]
 ds_read_b128 a[84:87], v7 offset:5120
M v[88:91], a[124:127], v[240:243], v[32:35]
 buffer_store_dwordx4 v[112:115], v7, s[8:11], s29 offen offset:1024 sc1
M v[88:91], a[120:123], v[224:227], v[88:91]
 ds_read_b128 a[88:91], v7 offset:6144
 v_fma_f32 v116, v116, v6, v29
M v[88:91], a[116:119], v[208:211], v[88:91]
 ds_read_b128 a[92:95], v7 offset:7168
 v_fma_f32 v117, v117, v6, v29
M v[88:91], a[112:115], v[192:195], v[88:91]
 v_fma_f32 v118, v118, v6, v29
 v_fma_f32 v119, v119, v6, v29
M v[88:91], a[108:111], v[176:179], v[88:91]
 v_fma_f32 v124, v124, v6, v29
 v_fma_f32 v125, v125, v6, v29
M v[88:91], a[104:107], v[160:163], v[88:91]
 v_fma_f32 v126, v126, v6, v29
 v_fma_f32 v127, v127, v6, v29
M v[88:91], a[100:103], v[144:147], v[88:91]
 s_waitcnt lgkmcnt(0)
 v_cvt_pk_bf16_f32 v116, v116, v117
 v_cvt_pk_bf16_f32 v117, v118, v119
M v[88:91], a[96:99], v[128:131], v[88:91]
 v_cvt_pk_bf16_f32 v118, v124, v125
 v_cvt_pk_bf16_f32 v119, v126, v127
 buffer_store_dwordx4 v[116:119], v7, s[8:11], s30 offen offset:1024 sc1
M v[96:99], a[64:67], v[128:131], v[32:35]
 ds_read_b128 a[96:99], v7 offset:8192
M v[96:99], a[68:71], v[144:147], v[96:99]
 ds_read_b128 a[100:103], v7 offset:9216
M v[96:99], a[72:75], v[160:163], v[96:99]
 s_sub_u32 s64, 15, s42
M v[96:99], a[76:79], v[176:179], v[96:99]
 s_min_u32 s64, s64, s42
 ds_read_b128 a[104:107], v7 offset:10240
 s_add_u32 s29, s33, 4096
M v[96:99], a[80:83], v[192:195], v[96:99]
 s_mul_i32 s45, s64, 8704
 ds_read_b128 a[108:111], v7 offset:11264
 s_add_u32 s30, s33, 18432
M v[96:99], a[84:87], v[208:211], v[96:99]
 s_lshl_b32 s64, s20, 6
 v_fma_f32 v64, v64, v5, v28
 v_fma_f32 v65, v65, v5, v28
M v[96:99], a[88:91], v[224:227], v[96:99]
 s_add_u32 s64, s64, s41
 ds_read_b128 a[112:115], v7 offset:12288
 v_fma_f32 v66, v66, v5, v28
M v[96:99], a[92:95], v[240:243], v[96:99]
 s_lshl2_add_u32 s45, s64, s45
 ds_read_b128 a[116:119], v7 offset:13312
 v_fma_f32 v67, v67, v5, v28
M v[100:103], a[92:95], v[244:247], v[36:39]
 s_add_u32 s45, s45, 104992768
 v_fma_f32 v72, v72, v5, v28
M v[100:103], a[88:91], v[228:231], v[100:103]
 s_movk_i32 s65, 1024
 ds_read_b128 a[120:123], v7 offset:14336
 v_fma_f32 v73, v73, v5, v28
M v[100:103], a[84:87], v[212:215], v[100:103]
 s_cmp_lt_u32 s42, 8
 ds_read_b128 a[124:127], v7 offset:15360
 v_fma_f32 v74, v74, v5, v28
M v[100:103], a[80:83], v[196:199], v[100:103]
 s_cselect_b32 s64, 4352, s65
 v_fma_f32 v75, v75, v5, v28
M v[100:103], a[76:79], v[180:183], v[100:103]
 s_cselect_b32 s65, 0, 64
 v_cvt_pk_bf16_f32 v64, v64, v65
M v[100:103], a[72:75], v[164:167], v[100:103]
 s_cselect_b32 s66, 32, 64
 v_cvt_pk_bf16_f32 v65, v66, v67
M v[100:103], a[68:71], v[148:151], v[100:103]
 s_add_u32 s3, s45, s64
 s_add_u32 s45, s45, s65
 v_lshrrev_b32 v42, 5, v7
M v[100:103], a[64:67], v[132:135], v[100:103]
 s_waitcnt lgkmcnt(0)
 v_mul_u32_u24 v42, 4352, v42
 v_and_b32 v41, 16, v7
M v[108:111], a[96:99], v[132:135], v[36:39]
 ds_read_b128 a[64:67], v7 offset:16384
 v_lshl_add_u32 v41, v41, 3, v42
M v[108:111], a[100:103], v[148:151], v[108:111]
 ds_read_b128 a[68:71], v7 offset:17408
 v_mov_b32 v42, 536870912
M v[108:111], a[104:107], v[164:167], v[108:111]
 v_cmp_gt_u32 vcc, s66, v7
 v_mov_b32 v40, 1
M v[108:111], a[108:111], v[180:183], v[108:111]
 s_nop 0
 ds_read_b128 a[72:75], v7 offset:18432
 v_cndmask_b32 v41, v42, v41, vcc
M v[108:111], a[112:115], v[196:199], v[108:111]
 ds_read_b128 a[76:79], v7 offset:19456
 v_cvt_pk_bf16_f32 v66, v72, v73
M v[108:111], a[116:119], v[212:215], v[108:111]
 v_cvt_pk_bf16_f32 v67, v74, v75
M v[108:111], a[120:123], v[228:231], v[108:111]
 ds_read_b128 a[80:83], v7 offset:20480
M v[108:111], a[124:127], v[244:247], v[108:111]
 ds_read_b128 a[84:87], v7 offset:21504
M v[104:107], a[124:127], v[240:243], v[32:35]
 buffer_store_dwordx4 v[64:67], v7, s[8:11], s29 offen offset:0 sc1
M v[104:107], a[120:123], v[224:227], v[104:107]
 ds_read_b128 a[88:91], v7 offset:22528
 v_fma_f32 v68, v68, v6, v29
M v[104:107], a[116:119], v[208:211], v[104:107]
 ds_read_b128 a[92:95], v7 offset:23552
 v_fma_f32 v69, v69, v6, v29
M v[104:107], a[112:115], v[192:195], v[104:107]
 v_fma_f32 v70, v70, v6, v29
 v_fma_f32 v71, v71, v6, v29
M v[104:107], a[108:111], v[176:179], v[104:107]
 v_fma_f32 v76, v76, v6, v29
 v_fma_f32 v77, v77, v6, v29
M v[104:107], a[104:107], v[160:163], v[104:107]
 v_fma_f32 v78, v78, v6, v29
 v_fma_f32 v79, v79, v6, v29
M v[104:107], a[100:103], v[144:147], v[104:107]
 v_cvt_pk_bf16_f32 v68, v68, v69
 v_cvt_pk_bf16_f32 v69, v70, v71
M v[104:107], a[96:99], v[128:131], v[104:107]
 s_waitcnt lgkmcnt(0)
 v_cvt_pk_bf16_f32 v70, v76, v77
 v_cvt_pk_bf16_f32 v71, v78, v79
M v[112:115], a[64:67], v[128:131], v[32:35]
 ds_read_b128 a[96:99], v7 offset:24576
M v[112:115], a[68:71], v[144:147], v[112:115]
 ds_read_b128 a[100:103], v7 offset:25600
M v[112:115], a[72:75], v[160:163], v[112:115]
 buffer_store_dwordx4 v[68:71], v7, s[8:11], s30 offen offset:0 sc1
M v[112:115], a[76:79], v[176:179], v[112:115]
 ds_read_b128 a[104:107], v7 offset:26624
 v_fma_f32 v80, v80, v5, v28
M v[112:115], a[80:83], v[192:195], v[112:115]
 ds_read_b128 a[108:111], v7 offset:27648
 v_fma_f32 v81, v81, v5, v28
M v[112:115], a[84:87], v[208:211], v[112:115]
 v_fma_f32 v82, v82, v5, v28
 v_fma_f32 v83, v83, v5, v28
M v[112:115], a[88:91], v[224:227], v[112:115]
 ds_read_b128 a[112:115], v7 offset:28672
 v_fma_f32 v88, v88, v5, v28
M v[112:115], a[92:95], v[240:243], v[112:115]
 ds_read_b128 a[116:119], v7 offset:29696
 v_fma_f32 v89, v89, v5, v28
M v[116:119], a[92:95], v[244:247], v[36:39]
 v_fma_f32 v90, v90, v5, v28
 v_fma_f32 v91, v91, v5, v28
M v[116:119], a[88:91], v[228:231], v[116:119]
 ds_read_b128 a[120:123], v7 offset:30720
 v_cvt_pk_bf16_f32 v80, v80, v81
M v[116:119], a[84:87], v[212:215], v[116:119]
 ds_read_b128 a[124:127], v7 offset:31744
 v_cvt_pk_bf16_f32 v81, v82, v83
M v[116:119], a[80:83], v[196:199], v[116:119]
 v_cvt_pk_bf16_f32 v82, v88, v89
 v_cvt_pk_bf16_f32 v83, v90, v91
M v[116:119], a[76:79], v[180:183], v[116:119]
 buffer_store_dwordx4 v[80:83], v7, s[8:11], s29 offen offset:1024 sc1
M v[116:119], a[72:75], v[164:167], v[116:119]
 v_fma_f32 v84, v84, v6, v29
 v_fma_f32 v85, v85, v6, v29
M v[116:119], a[68:71], v[148:151], v[116:119]
 s_waitcnt vmcnt(28) lgkmcnt(0)
 v_fma_f32 v86, v86, v6, v29
M v[116:119], a[64:67], v[132:135], v[116:119]
 s_barrier
M v[124:127], a[96:99], v[132:135], v[36:39]
 ds_read_b128 a[64:67], v43 offset:0
 v_fma_f32 v87, v87, v6, v29
M v[124:127], a[100:103], v[148:151], v[124:127]
 ds_read_b128 a[68:71], v43 offset:1024
 v_fma_f32 v92, v92, v6, v29
M v[124:127], a[104:107], v[164:167], v[124:127]
 v_fma_f32 v93, v93, v6, v29
 v_fma_f32 v94, v94, v6, v29
M v[124:127], a[108:111], v[180:183], v[124:127]
 ds_read_b128 a[72:75], v43 offset:2048
 v_fma_f32 v95, v95, v6, v29
M v[124:127], a[112:115], v[196:199], v[124:127]
 ds_read_b128 a[76:79], v43 offset:3072
 v_cvt_pk_bf16_f32 v84, v84, v85
M v[124:127], a[116:119], v[212:215], v[124:127]
 v_cvt_pk_bf16_f32 v85, v86, v87
M v[124:127], a[120:123], v[228:231], v[124:127]
 ds_read_b128 a[80:83], v43 offset:4096
 v_cvt_pk_bf16_f32 v86, v92, v93
M v[124:127], a[124:127], v[244:247], v[124:127]
 ds_read_b128 a[84:87], v43 offset:5120
 v_cvt_pk_bf16_f32 v87, v94, v95
M v[120:123], a[124:127], v[240:243], v[32:35]
 buffer_store_dwordx4 v[84:87], v7, s[8:11], s30 offen offset:1024 sc1
M v[120:123], a[120:123], v[224:227], v[120:123]
 ds_read_b128 a[88:91], v43 offset:6144
M v[120:123], a[116:119], v[208:211], v[120:123]
 ds_read_b128 a[92:95], v43 offset:7168
M v[120:123], a[112:115], v[192:195], v[120:123]
M v[120:123], a[108:111], v[176:179], v[120:123]
M v[120:123], a[104:107], v[160:163], v[120:123]
M v[120:123], a[100:103], v[144:147], v[120:123]
 s_waitcnt lgkmcnt(0)
 s_cmp_eq_u32 s42, 6
M v[120:123], a[96:99], v[128:131], v[120:123]
 s_cbranch_scc1 L_y2
L_y2r:
M v[64:67], a[64:67], v[128:131], v[32:35]
 ds_read_b128 a[96:99], v43 offset:8192
M v[64:67], a[68:71], v[144:147], v[64:67]
 ds_read_b128 a[100:103], v43 offset:9216
M v[64:67], a[72:75], v[160:163], v[64:67]
 s_waitcnt vmcnt(11)
 v_cmp_gt_u32 vcc, 1, v24
M v[64:67], a[76:79], v[176:179], v[64:67]
 s_mov_b32 s65, 104890368
 ds_read_b128 a[104:107], v43 offset:10240
 s_add_u32 s29, s33, 6144
M v[64:67], a[80:83], v[192:195], v[64:67]
 s_cbranch_vccnz L_fhs1
L_fhr1:
 ds_read_b128 a[108:111], v43 offset:11264
 s_add_u32 s30, s33, 20480
M v[64:67], a[84:87], v[208:211], v[64:67]
 buffer_load_dword v25, v14, s[8:11], s65 offen sc1
M v[64:67], a[88:91], v[224:227], v[64:67]
 ds_read_b128 a[112:115], v43 offset:12288
 v_fma_f32 v96, v96, v5, v28
M v[64:67], a[92:95], v[240:243], v[64:67]
 ds_read_b128 a[116:119], v43 offset:13312
 v_fma_f32 v97, v97, v5, v28
M v[68:71], a[92:95], v[244:247], v[36:39]
 v_fma_f32 v98, v98, v5, v28
 v_fma_f32 v99, v99, v5, v28
M v[68:71], a[88:91], v[228:231], v[68:71]
 ds_read_b128 a[120:123], v43 offset:14336
 v_fma_f32 v104, v104, v5, v28
M v[68:71], a[84:87], v[212:215], v[68:71]
 ds_read_b128 a[124:127], v43 offset:15360
 v_fma_f32 v105, v105, v5, v28
M v[68:71], a[80:83], v[196:199], v[68:71]
 v_fma_f32 v106, v106, v5, v28
 v_fma_f32 v107, v107, v5, v28
M v[68:71], a[76:79], v[180:183], v[68:71]
 v_cvt_pk_bf16_f32 v96, v96, v97
M v[68:71], a[72:75], v[164:167], v[68:71]
 v_cvt_pk_bf16_f32 v97, v98, v99
M v[68:71], a[68:71], v[148:151], v[68:71]
 v_cvt_pk_bf16_f32 v98, v104, v105
M v[68:71], a[64:67], v[132:135], v[68:71]
 s_waitcnt lgkmcnt(0)
 v_cvt_pk_bf16_f32 v99, v106, v107
M v[76:79], a[96:99], v[132:135], v[36:39]
 ds_read_b128 a[64:67], v43 offset:16384
M v[76:79], a[100:103], v[148:151], v[76:79]
 ds_read_b128 a[68:71], v43 offset:17408
M v[76:79], a[104:107], v[164:167], v[76:79]
 buffer_store_dwordx4 v[96:99], v7, s[8:11], s29 offen offset:0 sc1
M v[76:79], a[108:111], v[180:183], v[76:79]
 ds_read_b128 a[72:75], v43 offset:18432
 v_fma_f32 v100, v100, v6, v29
M v[76:79], a[112:115], v[196:199], v[76:79]
 ds_read_b128 a[76:79], v43 offset:19456
 v_fma_f32 v101, v101, v6, v29
M v[76:79], a[116:119], v[212:215], v[76:79]
 v_fma_f32 v102, v102, v6, v29
 v_fma_f32 v103, v103, v6, v29
M v[76:79], a[120:123], v[228:231], v[76:79]
 ds_read_b128 a[80:83], v43 offset:20480
 v_fma_f32 v108, v108, v6, v29
M v[76:79], a[124:127], v[244:247], v[76:79]
 ds_read_b128 a[84:87], v43 offset:21504
 v_fma_f32 v109, v109, v6, v29
M v[72:75], a[124:127], v[240:243], v[32:35]
 v_fma_f32 v110, v110, v6, v29
 v_fma_f32 v111, v111, v6, v29
M v[72:75], a[120:123], v[224:227], v[72:75]
 ds_read_b128 a[88:91], v43 offset:22528
 v_cvt_pk_bf16_f32 v100, v100, v101
M v[72:75], a[116:119], v[208:211], v[72:75]
 ds_read_b128 a[92:95], v43 offset:23552
 v_cvt_pk_bf16_f32 v101, v102, v103
M v[72:75], a[112:115], v[192:195], v[72:75]
 v_cvt_pk_bf16_f32 v102, v108, v109
M v[72:75], a[108:111], v[176:179], v[72:75]
 v_cvt_pk_bf16_f32 v103, v110, v111
M v[72:75], a[104:107], v[160:163], v[72:75]
 buffer_store_dwordx4 v[100:103], v7, s[8:11], s30 offen offset:0 sc1
M v[72:75], a[100:103], v[144:147], v[72:75]
M v[72:75], a[96:99], v[128:131], v[72:75]
 s_waitcnt lgkmcnt(0)
 v_fma_f32 v112, v112, v5, v28
M v[80:83], a[64:67], v[128:131], v[32:35]
 ds_read_b128 a[96:99], v43 offset:24576
 v_fma_f32 v113, v113, v5, v28
M v[80:83], a[68:71], v[144:147], v[80:83]
 ds_read_b128 a[100:103], v43 offset:25600
 v_fma_f32 v114, v114, v5, v28
M v[80:83], a[72:75], v[160:163], v[80:83]
 v_fma_f32 v115, v115, v5, v28
M v[80:83], a[76:79], v[176:179], v[80:83]
 ds_read_b128 a[104:107], v43 offset:26624
 v_fma_f32 v120, v120, v5, v28
M v[80:83], a[80:83], v[192:195], v[80:83]
 ds_read_b128 a[108:111], v43 offset:27648
 v_fma_f32 v121, v121, v5, v28
M v[80:83], a[84:87], v[208:211], v[80:83]
 v_fma_f32 v122, v122, v5, v28
M v[80:83], a[88:91], v[224:227], v[80:83]
 ds_read_b128 a[112:115], v43 offset:28672
 v_fma_f32 v123, v123, v5, v28
M v[80:83], a[92:95], v[240:243], v[80:83]
 ds_read_b128 a[116:119], v43 offset:29696
 v_cvt_pk_bf16_f32 v112, v112, v113
M v[84:87], a[92:95], v[244:247], v[36:39]
 v_cvt_pk_bf16_f32 v113, v114, v115
 v_cvt_pk_bf16_f32 v114, v120, v121
M v[84:87], a[88:91], v[228:231], v[84:87]
 ds_read_b128 a[120:123], v43 offset:30720
 v_cvt_pk_bf16_f32 v115, v122, v123
M v[84:87], a[84:87], v[212:215], v[84:87]
 ds_read_b128 a[124:127], v43 offset:31744
M v[84:87], a[80:83], v[196:199], v[84:87]
 buffer_store_dwordx4 v[112:115], v7, s[8:11], s29 offen offset:1024 sc1
M v[84:87], a[76:79], v[180:183], v[84:87]
 v_fma_f32 v116, v116, v6, v29
M v[84:87], a[72:75], v[164:167], v[84:87]
 v_fma_f32 v117, v117, v6, v29
M v[84:87], a[68:71], v[148:151], v[84:87]
 s_waitcnt lgkmcnt(0)
 v_fma_f32 v118, v118, v6, v29
M v[84:87], a[64:67], v[132:135], v[84:87]
 s_barrier
M v[92:95], a[96:99], v[132:135], v[36:39]
 ds_read_b128 a[64:67], v2 offset:32768
 v_fma_f32 v119, v119, v6, v29
M v[92:95], a[100:103], v[148:151], v[92:95]
 ds_read_b128 a[68:71], v2 offset:33792
 v_fma_f32 v124, v124, v6, v29
M v[92:95], a[104:107], v[164:167], v[92:95]
 v_fma_f32 v125, v125, v6, v29
 v_fma_f32 v126, v126, v6, v29
M v[92:95], a[108:111], v[180:183], v[92:95]
 ds_read_b128 a[72:75], v2 offset:34816
 v_fma_f32 v127, v127, v6, v29
M v[92:95], a[112:115], v[196:199], v[92:95]
 ds_read_b128 a[76:79], v2 offset:35840
 v_cvt_pk_bf16_f32 v116, v116, v117
M v[92:95], a[116:119], v[212:215], v[92:95]
 v_cvt_pk_bf16_f32 v117, v118, v119
M v[92:95], a[120:123], v[228:231], v[92:95]
 ds_read_b128 a[80:83], v2 offset:36864
 v_cvt_pk_bf16_f32 v118, v124, v125
M v[92:95], a[124:127], v[244:247], v[92:95]
 ds_read_b128 a[84:87], v2 offset:37888
 v_cvt_pk_bf16_f32 v119, v126, v127
M v[88:91], a[124:127], v[240:243], v[32:35]
 buffer_store_dwordx4 v[116:119], v7, s[8:11], s30 offen offset:1024 sc1
M v[88:91], a[120:123], v[224:227], v[88:91]
 ds_read_b128 a[88:91], v2 offset:38912
M v[88:91], a[116:119], v[208:211], v[88:91]
 ds_read_b128 a[92:95], v2 offset:39936
M v[88:91], a[112:115], v[192:195], v[88:91]
M v[88:91], a[108:111], v[176:179], v[88:91]
M v[88:91], a[104:107], v[160:163], v[88:91]
M v[88:91], a[100:103], v[144:147], v[88:91]
 s_waitcnt lgkmcnt(0)
M v[88:91], a[96:99], v[128:131], v[88:91]
M v[96:99], a[64:67], v[128:131], v[32:35]
 ds_read_b128 a[96:99], v2 offset:40960
M v[96:99], a[68:71], v[144:147], v[96:99]
 ds_read_b128 a[100:103], v2 offset:41984
M v[96:99], a[72:75], v[160:163], v[96:99]
M v[96:99], a[76:79], v[176:179], v[96:99]
 ds_read_b128 a[104:107], v2 offset:43008
 s_add_u32 s29, s33, 8192
M v[96:99], a[80:83], v[192:195], v[96:99]
 ds_read_b128 a[108:111], v2 offset:44032
 s_add_u32 s30, s33, 22528
M v[96:99], a[84:87], v[208:211], v[96:99]
 v_fma_f32 v64, v64, v5, v28
 v_fma_f32 v65, v65, v5, v28
M v[96:99], a[88:91], v[224:227], v[96:99]
 ds_read_b128 a[112:115], v2 offset:45056
 v_fma_f32 v66, v66, v5, v28
M v[96:99], a[92:95], v[240:243], v[96:99]
 ds_read_b128 a[116:119], v2 offset:46080
 v_fma_f32 v67, v67, v5, v28
M v[100:103], a[92:95], v[244:247], v[36:39]
 v_fma_f32 v72, v72, v5, v28
M v[100:103], a[88:91], v[228:231], v[100:103]
 ds_read_b128 a[120:123], v2 offset:47104
 v_fma_f32 v73, v73, v5, v28
M v[100:103], a[84:87], v[212:215], v[100:103]
 ds_read_b128 a[124:127], v2 offset:48128
 v_fma_f32 v74, v74, v5, v28
M v[100:103], a[80:83], v[196:199], v[100:103]
 v_fma_f32 v75, v75, v5, v28
M v[100:103], a[76:79], v[180:183], v[100:103]
 v_cvt_pk_bf16_f32 v64, v64, v65
M v[100:103], a[72:75], v[164:167], v[100:103]
 v_cvt_pk_bf16_f32 v65, v66, v67
M v[100:103], a[68:71], v[148:151], v[100:103]
 v_cvt_pk_bf16_f32 v66, v72, v73
M v[100:103], a[64:67], v[132:135], v[100:103]
 s_waitcnt lgkmcnt(0)
 v_cvt_pk_bf16_f32 v67, v74, v75
M v[108:111], a[96:99], v[132:135], v[36:39]
 ds_read_b128 a[64:67], v2 offset:49152
M v[108:111], a[100:103], v[148:151], v[108:111]
 ds_read_b128 a[68:71], v2 offset:50176
M v[108:111], a[104:107], v[164:167], v[108:111]
 buffer_store_dwordx4 v[64:67], v7, s[8:11], s29 offen offset:0 sc1
M v[108:111], a[108:111], v[180:183], v[108:111]
 ds_read_b128 a[72:75], v2 offset:51200
 v_fma_f32 v68, v68, v6, v29
M v[108:111], a[112:115], v[196:199], v[108:111]
 ds_read_b128 a[76:79], v2 offset:52224
 v_fma_f32 v69, v69, v6, v29
M v[108:111], a[116:119], v[212:215], v[108:111]
 v_fma_f32 v70, v70, v6, v29
 v_fma_f32 v71, v71, v6, v29
M v[108:111], a[120:123], v[228:231], v[108:111]
 ds_read_b128 a[80:83], v2 offset:53248
 v_fma_f32 v76, v76, v6, v29
M v[108:111], a[124:127], v[244:247], v[108:111]
 ds_read_b128 a[84:87], v2 offset:54272
 v_fma_f32 v77, v77, v6, v29
M v[104:107], a[124:127], v[240:243], v[32:35]
 v_fma_f32 v78, v78, v6, v29
 v_fma_f32 v79, v79, v6, v29
M v[104:107], a[120:123], v[224:227], v[104:107]
 ds_read_b128 a[88:91], v2 offset:55296
 v_cvt_pk_bf16_f32 v68, v68, v69
M v[104:107], a[116:119], v[208:211], v[104:107]
 ds_read_b128 a[92:95], v2 offset:56320
 v_cvt_pk_bf16_f32 v69, v70, v71
M v[104:107], a[112:115], v[192:195], v[104:107]
 v_cvt_pk_bf16_f32 v70, v76, v77
M v[104:107], a[108:111], v[176:179], v[104:107]
 v_cvt_pk_bf16_f32 v71, v78, v79
M v[104:107], a[104:107], v[160:163], v[104:107]
 buffer_store_dwordx4 v[68:71], v7, s[8:11], s30 offen offset:0 sc1
M v[104:107], a[100:103], v[144:147], v[104:107]
M v[104:107], a[96:99], v[128:131], v[104:107]
 s_waitcnt lgkmcnt(0)
 v_fma_f32 v80, v80, v5, v28
M v[112:115], a[64:67], v[128:131], v[32:35]
 ds_read_b128 a[96:99], v2 offset:57344
 v_fma_f32 v81, v81, v5, v28
M v[112:115], a[68:71], v[144:147], v[112:115]
 ds_read_b128 a[100:103], v2 offset:58368
 v_fma_f32 v82, v82, v5, v28
M v[112:115], a[72:75], v[160:163], v[112:115]
 v_fma_f32 v83, v83, v5, v28
M v[112:115], a[76:79], v[176:179], v[112:115]
 ds_read_b128 a[104:107], v2 offset:59392
 v_fma_f32 v88, v88, v5, v28
M v[112:115], a[80:83], v[192:195], v[112:115]
 ds_read_b128 a[108:111], v2 offset:60416
 v_fma_f32 v89, v89, v5, v28
M v[112:115], a[84:87], v[208:211], v[112:115]
 v_fma_f32 v90, v90, v5, v28
M v[112:115], a[88:91], v[224:227], v[112:115]
 ds_read_b128 a[112:115], v2 offset:61440
 v_fma_f32 v91, v91, v5, v28
M v[112:115], a[92:95], v[240:243], v[112:115]
 ds_read_b128 a[116:119], v2 offset:62464
 v_cvt_pk_bf16_f32 v80, v80, v81
M v[116:119], a[92:95], v[244:247], v[36:39]
 s_waitcnt vmcnt(6)
 v_readlane_b32 s84, v25, 0
 v_readlane_b32 s85, v25, 1
M v[116:119], a[88:91], v[228:231], v[116:119]
 ds_read_b128 a[120:123], v2 offset:63488
 v_mov_b32 v24, 0x3f80
M v[116:119], a[84:87], v[212:215], v[116:119]
 ds_read_b128 a[124:127], v2 offset:64512
 v_mov_b32 v25, 0x3f800000
M v[116:119], a[80:83], v[196:199], v[116:119]
 v_cvt_pk_bf16_f32 v81, v82, v83
 v_cvt_pk_bf16_f32 v82, v88, v89
M v[116:119], a[76:79], v[180:183], v[116:119]
 v_cvt_pk_bf16_f32 v83, v90, v91
M v[116:119], a[72:75], v[164:167], v[116:119]
 buffer_store_dwordx4 v[80:83], v7, s[8:11], s29 offen offset:1024 sc1
M v[116:119], a[68:71], v[148:151], v[116:119]
 s_waitcnt lgkmcnt(0)
 v_fma_f32 v84, v84, v6, v29
 v_fma_f32 v85, v85, v6, v29
M v[116:119], a[64:67], v[132:135], v[116:119]
 s_barrier
M v[124:127], a[96:99], v[132:135], v[36:39]
 ds_read_b128 a[64:67], v7 offset:32768
 v_fma_f32 v86, v86, v6, v29
M v[124:127], a[100:103], v[148:151], v[124:127]
 ds_read_b128 a[68:71], v7 offset:33792
 v_fma_f32 v87, v87, v6, v29
M v[124:127], a[104:107], v[164:167], v[124:127]
 v_fma_f32 v92, v92, v6, v29
 v_fma_f32 v93, v93, v6, v29
M v[124:127], a[108:111], v[180:183], v[124:127]
 ds_read_b128 a[72:75], v7 offset:34816
 v_fma_f32 v94, v94, v6, v29
M v[124:127], a[112:115], v[196:199], v[124:127]
 ds_read_b128 a[76:79], v7 offset:35840
 v_fma_f32 v95, v95, v6, v29
M v[124:127], a[116:119], v[212:215], v[124:127]
 s_waitcnt vmcnt(3)
 v_cvt_pk_bf16_f32 v84, v84, v85
 v_cvt_pk_bf16_f32 v85, v86, v87
M v[124:127], a[120:123], v[228:231], v[124:127]
 ds_read_b128 a[80:83], v7 offset:36864
 v_cvt_pk_bf16_f32 v86, v92, v93
M v[124:127], a[124:127], v[244:247], v[124:127]
 ds_read_b128 a[84:87], v7 offset:37888
 v_cvt_pk_bf16_f32 v87, v94, v95
M v[120:123], a[124:127], v[240:243], v[32:35]
 buffer_store_dword v40, v41, s[8:11], s45 offen sc1
M v[120:123], a[120:123], v[224:227], v[120:123]
 ds_read_b128 a[88:91], v7 offset:38912
M v[120:123], a[116:119], v[208:211], v[120:123]
 ds_read_b128 a[92:95], v7 offset:39936
M v[120:123], a[112:115], v[192:195], v[120:123]
 buffer_store_dwordx4 v[84:87], v7, s[8:11], s30 offen offset:1024 sc1
M v[120:123], a[108:111], v[176:179], v[120:123]
M v[120:123], a[104:107], v[160:163], v[120:123]
M v[120:123], a[100:103], v[144:147], v[120:123]
 s_waitcnt lgkmcnt(0)
 s_cmp_eq_u32 s42, 6
M v[120:123], a[96:99], v[128:131], v[120:123]
 s_cbranch_scc1 L_y3
L_y3r:
M v[64:67], a[64:67], v[128:131], v[32:35]
 ds_read_b128 a[96:99], v7 offset:40960
M v[64:67], a[68:71], v[144:147], v[64:67]
 ds_read_b128 a[100:103], v7 offset:41984
M v[64:67], a[72:75], v[160:163], v[64:67]
M v[64:67], a[76:79], v[176:179], v[64:67]
 ds_read_b128 a[104:107], v7 offset:43008
 s_add_u32 s29, s33, 10240
M v[64:67], a[80:83], v[192:195], v[64:67]
 ds_read_b128 a[108:111], v7 offset:44032
 s_add_u32 s30, s33, 24576
M v[64:67], a[84:87], v[208:211], v[64:67]
 v_fma_f32 v96, v96, v5, v28
 v_fma_f32 v97, v97, v5, v28
M v[64:67], a[88:91], v[224:227], v[64:67]
 ds_read_b128 a[112:115], v7 offset:45056
 v_fma_f32 v98, v98, v5, v28
M v[64:67], a[92:95], v[240:243], v[64:67]
 ds_read_b128 a[116:119], v7 offset:46080
 v_fma_f32 v99, v99, v5, v28
M v[68:71], a[92:95], v[244:247], v[36:39]
 v_fma_f32 v104, v104, v5, v28
 v_fma_f32 v105, v105, v5, v28
M v[68:71], a[88:91], v[228:231], v[68:71]
 ds_read_b128 a[120:123], v7 offset:47104
 v_fma_f32 v106, v106, v5, v28
M v[68:71], a[84:87], v[212:215], v[68:71]
 ds_read_b128 a[124:127], v7 offset:48128
 v_fma_f32 v107, v107, v5, v28
M v[68:71], a[80:83], v[196:199], v[68:71]
 v_cvt_pk_bf16_f32 v96, v96, v97
 v_cvt_pk_bf16_f32 v97, v98, v99
M v[68:71], a[76:79], v[180:183], v[68:71]
 v_cvt_pk_bf16_f32 v98, v104, v105
 v_cvt_pk_bf16_f32 v99, v106, v107
M v[68:71], a[72:75], v[164:167], v[68:71]
 buffer_store_dwordx4 v[96:99], v7, s[8:11], s29 offen offset:0 sc1
M v[68:71], a[68:71], v[148:151], v[68:71]
 v_fma_f32 v100, v100, v6, v29
 v_fma_f32 v101, v101, v6, v29
M v[68:71], a[64:67], v[132:135], v[68:71]
 s_waitcnt lgkmcnt(0)
 v_fma_f32 v102, v102, v6, v29
 v_fma_f32 v103, v103, v6, v29
M v[72:75], a[96:99], v[128:131], v[32:35]
 ds_read_b128 a[64:67], v7 offset:49152
 v_fma_f32 v108, v108, v6, v29
M v[72:75], a[100:103], v[144:147], v[72:75]
 ds_read_b128 a[68:71], v7 offset:50176
 v_fma_f32 v109, v109, v6, v29
M v[72:75], a[104:107], v[160:163], v[72:75]
 v_fma_f32 v110, v110, v6, v29
 v_fma_f32 v111, v111, v6, v29
M v[72:75], a[108:111], v[176:179], v[72:75]
 ds_read_b128 a[72:75], v7 offset:51200
 v_cvt_pk_bf16_f32 v100, v100, v101
M v[72:75], a[112:115], v[192:195], v[72:75]
 ds_read_b128 a[76:79], v7 offset:52224
 v_cvt_pk_bf16_f32 v101, v102, v103
M v[72:75], a[116:119], v[208:211], v[72:75]
 v_cvt_pk_bf16_f32 v102, v108, v109
 v_cvt_pk_bf16_f32 v103, v110, v111
M v[72:75], a[120:123], v[224:227], v[72:75]
 ds_read_b128 a[80:83], v7 offset:53248
M v[72:75], a[124:127], v[240:243], v[72:75]
 ds_read_b128 a[84:87], v7 offset:54272
M v[76:79], a[124:127], v[244:247], v[36:39]
 buffer_store_dwordx4 v[100:103], v7, s[8:11], s30 offen offset:0 sc1
M v[76:79], a[120:123], v[228:231], v[76:79]
 ds_read_b128 a[88:91], v7 offset:55296
 v_fma_f32 v112, v112, v5, v28
M v[76:79], a[116:119], v[212:215], v[76:79]
 ds_read_b128 a[92:95], v7 offset:56320
 v_fma_f32 v113, v113, v5, v28
M v[76:79], a[112:115], v[196:199], v[76:79]
 v_fma_f32 v114, v114, v5, v28
 v_fma_f32 v115, v115, v5, v28
M v[76:79], a[108:111], v[180:183], v[76:79]
 v_fma_f32 v120, v120, v5, v28
 v_fma_f32 v121, v121, v5, v28
M v[76:79], a[104:107], v[164:167], v[76:79]
 v_fma_f32 v122, v122, v5, v28
 v_fma_f32 v123, v123, v5, v28
M v[76:79], a[100:103], v[148:151], v[76:79]
 v_cvt_pk_bf16_f32 v112, v112, v113
 v_cvt_pk_bf16_f32 v113, v114, v115
M v[76:79], a[96:99], v[132:135], v[76:79]
 s_waitcnt lgkmcnt(0)
 v_cvt_pk_bf16_f32 v114, v120, v121
 v_cvt_pk_bf16_f32 v115, v122, v123
M v[80:83], a[64:67], v[128:131], v[32:35]
 ds_read_b128 a[96:99], v7 offset:57344
M v[80:83], a[68:71], v[144:147], v[80:83]
 ds_read_b128 a[100:103], v7 offset:58368
M v[80:83], a[72:75], v[160:163], v[80:83]
 buffer_store_dwordx4 v[112:115], v7, s[8:11], s29 offen offset:1024 sc1
M v[80:83], a[76:79], v[176:179], v[80:83]
 ds_read_b128 a[104:107], v7 offset:59392
 v_fma_f32 v116, v116, v6, v29
M v[80:83], a[80:83], v[192:195], v[80:83]
 ds_read_b128 a[108:111], v7 offset:60416
 v_fma_f32 v117, v117, v6, v29
M v[80:83], a[84:87], v[208:211], v[80:83]
 v_fma_f32 v118, v118, v6, v29
 v_fma_f32 v119, v119, v6, v29
M v[80:83], a[88:91], v[224:227], v[80:83]
 ds_read_b128 a[112:115], v7 offset:61440
 v_fma_f32 v124, v124, v6, v29
M v[80:83], a[92:95], v[240:243], v[80:83]
 ds_read_b128 a[116:119], v7 offset:62464
 v_fma_f32 v125, v125, v6, v29
M v[84:87], a[92:95], v[244:247], v[36:39]
 v_fma_f32 v126, v126, v6, v29
 v_fma_f32 v127, v127, v6, v29
M v[84:87], a[88:91], v[228:231], v[84:87]
 ds_read_b128 a[120:123], v7 offset:63488
 v_cvt_pk_bf16_f32 v116, v116, v117
M v[84:87], a[84:87], v[212:215], v[84:87]
 ds_read_b128 a[124:127], v7 offset:64512
 v_cvt_pk_bf16_f32 v117, v118, v119
M v[84:87], a[80:83], v[196:199], v[84:87]
 v_cvt_pk_bf16_f32 v118, v124, v125
 v_cvt_pk_bf16_f32 v119, v126, v127
M v[84:87], a[76:79], v[180:183], v[84:87]
 buffer_store_dwordx4 v[116:119], v7, s[8:11], s30 offen offset:1024 sc1
M v[84:87], a[72:75], v[164:167], v[84:87]
 s_add_u32 s29, s33, 12288
M v[84:87], a[68:71], v[148:151], v[84:87]
 s_add_u32 s30, s33, 26624
 v_fma_f32 v64, v64, v5, v28
 v_fma_f32 v65, v65, v5, v28
M v[84:87], a[64:67], v[132:135], v[84:87]
 s_waitcnt lgkmcnt(0)
 v_fma_f32 v66, v66, v5, v28
 v_fma_f32 v67, v67, v5, v28
M v[88:91], a[96:99], v[128:131], v[32:35]
 v_fma_f32 v72, v72, v5, v28
 v_fma_f32 v73, v73, v5, v28
M v[88:91], a[100:103], v[144:147], v[88:91]
 v_fma_f32 v74, v74, v5, v28
 v_fma_f32 v75, v75, v5, v28
M v[88:91], a[104:107], v[160:163], v[88:91]
 v_cvt_pk_bf16_f32 v64, v64, v65
 v_cvt_pk_bf16_f32 v65, v66, v67
M v[88:91], a[108:111], v[176:179], v[88:91]
 v_cvt_pk_bf16_f32 v66, v72, v73
 v_cvt_pk_bf16_f32 v67, v74, v75
M v[88:91], a[112:115], v[192:195], v[88:91]
 buffer_store_dwordx4 v[64:67], v7, s[8:11], s29 offen offset:0 sc1
M v[88:91], a[116:119], v[208:211], v[88:91]
 v_fma_f32 v68, v68, v6, v29
 v_fma_f32 v69, v69, v6, v29
M v[88:91], a[120:123], v[224:227], v[88:91]
 v_fma_f32 v70, v70, v6, v29
 v_fma_f32 v71, v71, v6, v29
M v[88:91], a[124:127], v[240:243], v[88:91]
 v_fma_f32 v76, v76, v6, v29
 v_fma_f32 v77, v77, v6, v29
M v[92:95], a[124:127], v[244:247], v[36:39]
 v_fma_f32 v78, v78, v6, v29
 v_fma_f32 v79, v79, v6, v29
M v[92:95], a[120:123], v[228:231], v[92:95]
 v_cvt_pk_bf16_f32 v68, v68, v69
 v_cvt_pk_bf16_f32 v69, v70, v71
M v[92:95], a[116:119], v[212:215], v[92:95]
 v_cvt_pk_bf16_f32 v70, v76, v77
 v_cvt_pk_bf16_f32 v71, v78, v79
M v[92:95], a[112:115], v[196:199], v[92:95]
 buffer_store_dwordx4 v[68:71], v7, s[8:11], s30 offen offset:0 sc1
M v[92:95], a[108:111], v[180:183], v[92:95]
M v[92:95], a[104:107], v[164:167], v[92:95]
M v[92:95], a[100:103], v[148:151], v[92:95]
M v[92:95], a[96:99], v[132:135], v[92:95]
 v_fma_f32 v80, v80, v5, v28
 v_fma_f32 v81, v81, v5, v28
 v_fma_f32 v82, v82, v5, v28
 v_fma_f32 v83, v83, v5, v28
 v_fma_f32 v88, v88, v5, v28
 v_fma_f32 v89, v89, v5, v28
 v_fma_f32 v90, v90, v5, v28
 v_fma_f32 v91, v91, v5, v28
 v_cvt_pk_bf16_f32 v80, v80, v81
 v_cvt_pk_bf16_f32 v81, v82, v83
 v_cvt_pk_bf16_f32 v82, v88, v89
 v_cvt_pk_bf16_f32 v83, v90, v91
 buffer_store_dwordx4 v[80:83], v7, s[8:11], s29 offen offset:1024 sc1
 v_fma_f32 v84, v84, v6, v29
 v_fma_f32 v85, v85, v6, v29
 v_fma_f32 v86, v86, v6, v29
 v_fma_f32 v87, v87, v6, v29
 v_fma_f32 v92, v92, v6, v29
 v_fma_f32 v93, v93, v6, v29
 v_fma_f32 v94, v94, v6, v29
 v_fma_f32 v95, v95, v6, v29
 v_cvt_pk_bf16_f32 v84, v84, v85
 v_cvt_pk_bf16_f32 v85, v86, v87
 v_cvt_pk_bf16_f32 v86, v92, v93
 v_cvt_pk_bf16_f32 v87, v94, v95
 buffer_store_dwordx4 v[84:87], v7, s[8:11], s30 offen offset:1024 sc1
 s_cmp_lt_u32 s42, 8
 s_cbranch_scc1 L_red
 s_cmp_eq_u32 s20, 3
 s_cbranch_scc1 L_vend3
 s_sub_u32 s64, 15, s42
 s_lshl_b32 s64, s64, 1
 s_lshr_b32 s65, s41, 3
 s_add_u32 s46, s64, s65
 s_mul_i32 s46, s46, 4352
 s_and_b32 s72, s41, 7
 s_lshl_b32 s66, s72, 7
 s_add_u32 s46, s46, s66
 s_add_u32 s46, s46, 104993792
 v_and_b32 v14, 15, v0
 v_lshlrev_b32 v14, 2, v14
 buffer_load_dword v9, v14, s[8:11], s46 offen sc1
 s_mul_i32 s86, s65, 3
 s_add_u32 s86, s86, s20
 s_add_u32 s86, s86, 8
 s_mul_i32 s77, s42, 1835008
 s_mul_i32 s78, s72, 14336
 s_add_u32 s77, s77, s78
 s_add_u32 s77, s77, 67108864
 s_lshl_b32 s78, s86, 10
 s_add_u32 s77, s77, s78
 s_lshl_b32 s86, s86, 6
 s_lshr_b32 s73, s72, 1
 s_sub_u32 s65, 7, s73
 s_bitcmp1_b32 s72, 0
 s_cselect_b32 s73, s65, s73
 s_lshl_b32 s73, s73, 4
 s_lshl_b32 s65, s42, 7
 s_add_u32 s73, s73, s65
 v_and_b32 v10, 15, v0
 v_add_u32 v10, s73, v10
 s_mov_b32 s64, 104857664
 v_mul_u32_u24 v12, 896, v10
 v_lshl_add_u32 v12, v11, 4, v12
 v_lshrrev_b32 v13, 4, v10
 v_lshlrev_b32 v13, 5, v13
 v_and_b32 v104, 15, v10
 v_add_lshl_u32 v13, v13, v104, 2
 buffer_load_dword v15, v13, s[8:11], s64 offen sc1
 buffer_load_dwordx4 v[16:19], v12, s[56:59], s86 offen
 v_mov_b32 v48, 0
 v_mov_b32 v49, 0
 v_mov_b32 v50, 0
 v_mov_b32 v51, 0
 v_mov_b32 v52, 0
 v_mov_b32 v53, 0
 v_mov_b32 v54, 0
 v_mov_b32 v55, 0
 s_waitcnt vmcnt(3)
 buffer_store_dword v40, v41, s[8:11], s3 offen sc1
 s_waitcnt vmcnt(3)
 v_cmp_eq_u32 vcc, 1, v9
 s_mov_b32 s91, 65536
 s_mov_b32 s69, 0
 s_and_b32 s70, vcc_lo, 0xffff
 s_or_b32 s68, s70, 0xffff0000
 s_cmp_lg_u32 s70, 0
 s_cbranch_scc1 L_vk0
 s_call_b64 s[36:37], L_rpoll
L_vk0:
 s_ff1_i32_b32 s71, s70
 s_bitset0_b32 s70, s71
 s_mul_i32 s71, s71, 114688
 s_add_u32 s12, s71, s77
 buffer_load_dwordx4 v[128:131], v7, s[8:11], s12 offen sc1
 s_cmp_lg_u32 s70, 0
 s_cbranch_scc1 L_vk1
 s_call_b64 s[36:37], L_rpoll
L_vk1:
 s_ff1_i32_b32 s71, s70
 s_bitset0_b32 s70, s71
 s_mul_i32 s71, s71, 114688
 s_add_u32 s13, s71, s77
 buffer_load_dwordx4 v[132:135], v7, s[8:11], s13 offen sc1
 s_waitcnt vmcnt(3)
 v_lshlrev_b32 v32, 16, v16
 v_and_b32 v33, 0xffff0000, v16
 v_lshlrev_b32 v34, 16, v17
 v_and_b32 v35, 0xffff0000, v17
 v_lshlrev_b32 v36, 16, v18
 v_and_b32 v37, 0xffff0000, v18
 v_lshlrev_b32 v38, 16, v19
 v_and_b32 v39, 0xffff0000, v19
 v_sub_f32 v13, 1.0, v15
 v_cmp_eq_u32 s[80:81], s84, v10
 v_cmp_eq_u32 s[82:83], s85, v10
 s_nop 0
 s_or_b64 vcc, s[80:81], s[82:83]
 s_cbranch_vccnz L_moe2
L_moe_ret2:
 v_mul_f32 v32, v13, v32
 v_mul_f32 v33, v13, v33
 v_mul_f32 v34, v13, v34
 v_mul_f32 v35, v13, v35
 v_mul_f32 v36, v13, v36
 v_mul_f32 v37, v13, v37
 v_mul_f32 v38, v13, v38
 v_mul_f32 v39, v13, v39
 s_cmp_lg_u32 s70, 0
 s_cbranch_scc1 L_vk2
 s_call_b64 s[36:37], L_rpoll
L_vk2:
 s_ff1_i32_b32 s71, s70
 s_bitset0_b32 s70, s71
 s_mul_i32 s71, s71, 114688
 s_add_u32 s14, s71, s77
 buffer_load_dwordx4 v[136:139], v7, s[8:11], s14 offen sc1
 s_cmp_lg_u32 s70, 0
 s_cbranch_scc1 L_vk3
 s_call_b64 s[36:37], L_rpoll
L_vk3:
 s_ff1_i32_b32 s71, s70
 s_bitset0_b32 s70, s71
 s_mul_i32 s71, s71, 114688
 s_add_u32 s15, s71, s77
 buffer_load_dwordx4 v[140:143], v7, s[8:11], s15 offen sc1
 s_cmp_lg_u32 s70, 0
 s_cbranch_scc1 L_vk4
 s_call_b64 s[36:37], L_rpoll
L_vk4:
 s_ff1_i32_b32 s71, s70
 s_bitset0_b32 s70, s71
 s_mul_i32 s71, s71, 114688
 s_add_u32 s16, s71, s77
 buffer_load_dwordx4 v[144:147], v7, s[8:11], s16 offen sc1
 s_cmp_lg_u32 s70, 0
 s_cbranch_scc1 L_vk5
 s_call_b64 s[36:37], L_rpoll
L_vk5:
 s_ff1_i32_b32 s71, s70
 s_bitset0_b32 s70, s71
 s_mul_i32 s71, s71, 114688
 s_add_u32 s17, s71, s77
 buffer_load_dwordx4 v[148:151], v7, s[8:11], s17 offen sc1
 s_cmp_lg_u32 s70, 0
 s_cbranch_scc1 L_vk6
 s_call_b64 s[36:37], L_rpoll
L_vk6:
 s_ff1_i32_b32 s71, s70
 s_bitset0_b32 s70, s71
 s_mul_i32 s71, s71, 114688
 s_add_u32 s18, s71, s77
 buffer_load_dwordx4 v[152:155], v7, s[8:11], s18 offen sc1
 s_cmp_lg_u32 s70, 0
 s_cbranch_scc1 L_vk7
 s_call_b64 s[36:37], L_rpoll
L_vk7:
 s_ff1_i32_b32 s71, s70
 s_bitset0_b32 s70, s71
 s_mul_i32 s71, s71, 114688
 s_add_u32 s19, s71, s77
 buffer_load_dwordx4 v[156:159], v7, s[8:11], s19 offen sc1
 s_cmp_lg_u32 s70, 0
 s_cbranch_scc1 L_vk8
 s_call_b64 s[36:37], L_rpoll
L_vk8:
 s_ff1_i32_b32 s71, s70
 s_bitset0_b32 s70, s71
 s_mul_i32 s71, s71, 114688
 s_add_u32 s21, s71, s77
 buffer_load_dwordx4 v[160:163], v7, s[8:11], s21 offen sc1
 s_cmp_lg_u32 s70, 0
 s_cbranch_scc1 L_vk9
 s_call_b64 s[36:37], L_rpoll
L_vk9:
 s_ff1_i32_b32 s71, s70
 s_bitset0_b32 s70, s71
 s_mul_i32 s71, s71, 114688
 s_add_u32 s22, s71, s77
 buffer_load_dwordx4 v[164:167], v7, s[8:11], s22 offen sc1
 s_cmp_lg_u32 s70, 0
 s_cbranch_scc1 L_vk10
 s_call_b64 s[36:37], L_rpoll
L_vk10:
 s_ff1_i32_b32 s71, s70
 s_bitset0_b32 s70, s71
 s_mul_i32 s71, s71, 114688
 s_add_u32 s23, s71, s77
 buffer_load_dwordx4 v[168:171], v7, s[8:11], s23 offen sc1
 s_cmp_lg_u32 s70, 0
 s_cbranch_scc1 L_vk11
 s_call_b64 s[36:37], L_rpoll
L_vk11:
 s_ff1_i32_b32 s71, s70
 s_bitset0_b32 s70, s71
 s_mul_i32 s71, s71, 114688
 s_add_u32 s24, s71, s77
 buffer_load_dwordx4 v[172:175], v7, s[8:11], s24 offen sc1
 s_cmp_lg_u32 s70, 0
 s_cbranch_scc1 L_vk12
 s_call_b64 s[36:37], L_rpoll
L_vk12:
 s_ff1_i32_b32 s71, s70
 s_bitset0_b32 s70, s71
 s_mul_i32 s71, s71, 114688
 s_add_u32 s48, s71, s77
 buffer_load_dwordx4 v[176:179], v7, s[8:11], s48 offen sc1
 s_cmp_lg_u32 s70, 0
 s_cbranch_scc1 L_vk13
 s_call_b64 s[36:37], L_rpoll
L_vk13:
 s_ff1_i32_b32 s71, s70
 s_bitset0_b32 s70, s71
 s_mul_i32 s71, s71, 114688
 s_add_u32 s49, s71, s77
 buffer_load_dwordx4 v[180:183], v7, s[8:11], s49 offen sc1
 s_cmp_lg_u32 s70, 0
 s_cbranch_scc1 L_vk14
 s_call_b64 s[36:37], L_rpoll
L_vk14:
 s_ff1_i32_b32 s71, s70
 s_bitset0_b32 s70, s71
 s_mul_i32 s71, s71, 114688
 s_add_u32 s50, s71, s77
 buffer_load_dwordx4 v[184:187], v7, s[8:11], s50 offen sc1
 s_cmp_lg_u32 s70, 0
 s_cbranch_scc1 L_vk15
 s_call_b64 s[36:37], L_rpoll
L_vk15:
 s_ff1_i32_b32 s71, s70
 s_bitset0_b32 s70, s71
 s_mul_i32 s71, s71, 114688
 s_add_u32 s51, s71, s77
 buffer_load_dwordx4 v[188:191], v7, s[8:11], s51 offen sc1
 s_waitcnt vmcnt(15)
 v_dot2c_f32_bf16 v48, v128, v24
 v_dot2c_f32_bf16 v49, v128, v25
 v_dot2c_f32_bf16 v50, v129, v24
 v_dot2c_f32_bf16 v51, v129, v25
 v_dot2c_f32_bf16 v52, v130, v24
 v_dot2c_f32_bf16 v53, v130, v25
 v_dot2c_f32_bf16 v54, v131, v24
 v_dot2c_f32_bf16 v55, v131, v25
 s_waitcnt vmcnt(14)
 v_dot2c_f32_bf16 v48, v132, v24
 v_dot2c_f32_bf16 v49, v132, v25
 v_dot2c_f32_bf16 v50, v133, v24
 v_dot2c_f32_bf16 v51, v133, v25
 v_dot2c_f32_bf16 v52, v134, v24
 v_dot2c_f32_bf16 v53, v134, v25
 v_dot2c_f32_bf16 v54, v135, v24
 v_dot2c_f32_bf16 v55, v135, v25
 s_waitcnt vmcnt(13)
 v_dot2c_f32_bf16 v48, v136, v24
 v_dot2c_f32_bf16 v49, v136, v25
 v_dot2c_f32_bf16 v50, v137, v24
 v_dot2c_f32_bf16 v51, v137, v25
 v_dot2c_f32_bf16 v52, v138, v24
 v_dot2c_f32_bf16 v53, v138, v25
 v_dot2c_f32_bf16 v54, v139, v24
 v_dot2c_f32_bf16 v55, v139, v25
 s_waitcnt vmcnt(12)
 v_dot2c_f32_bf16 v48, v140, v24
 v_dot2c_f32_bf16 v49, v140, v25
 v_dot2c_f32_bf16 v50, v141, v24
 v_dot2c_f32_bf16 v51, v141, v25
 v_dot2c_f32_bf16 v52, v142, v24
 v_dot2c_f32_bf16 v53, v142, v25
 v_dot2c_f32_bf16 v54, v143, v24
 v_dot2c_f32_bf16 v55, v143, v25
 s_waitcnt vmcnt(11)
 v_dot2c_f32_bf16 v48, v144, v24
 v_dot2c_f32_bf16 v49, v144, v25
 v_dot2c_f32_bf16 v50, v145, v24
 v_dot2c_f32_bf16 v51, v145, v25
 v_dot2c_f32_bf16 v52, v146, v24
 v_dot2c_f32_bf16 v53, v146, v25
 v_dot2c_f32_bf16 v54, v147, v24
 v_dot2c_f32_bf16 v55, v147, v25
 s_waitcnt vmcnt(10)
 v_dot2c_f32_bf16 v48, v148, v24
 v_dot2c_f32_bf16 v49, v148, v25
 v_dot2c_f32_bf16 v50, v149, v24
 v_dot2c_f32_bf16 v51, v149, v25
 v_dot2c_f32_bf16 v52, v150, v24
 v_dot2c_f32_bf16 v53, v150, v25
 v_dot2c_f32_bf16 v54, v151, v24
 v_dot2c_f32_bf16 v55, v151, v25
 s_waitcnt vmcnt(9)
 v_dot2c_f32_bf16 v48, v152, v24
 v_dot2c_f32_bf16 v49, v152, v25
 v_dot2c_f32_bf16 v50, v153, v24
 v_dot2c_f32_bf16 v51, v153, v25
 v_dot2c_f32_bf16 v52, v154, v24
 v_dot2c_f32_bf16 v53, v154, v25
 v_dot2c_f32_bf16 v54, v155, v24
 v_dot2c_f32_bf16 v55, v155, v25
 s_waitcnt vmcnt(8)
 v_dot2c_f32_bf16 v48, v156, v24
 v_dot2c_f32_bf16 v49, v156, v25
 v_dot2c_f32_bf16 v50, v157, v24
 v_dot2c_f32_bf16 v51, v157, v25
 v_dot2c_f32_bf16 v52, v158, v24
 v_dot2c_f32_bf16 v53, v158, v25
 v_dot2c_f32_bf16 v54, v159, v24
 v_dot2c_f32_bf16 v55, v159, v25
 s_waitcnt vmcnt(7)
 v_dot2c_f32_bf16 v48, v160, v24
 v_dot2c_f32_bf16 v49, v160, v25
 v_dot2c_f32_bf16 v50, v161, v24
 v_dot2c_f32_bf16 v51, v161, v25
 v_dot2c_f32_bf16 v52, v162, v24
 v_dot2c_f32_bf16 v53, v162, v25
 v_dot2c_f32_bf16 v54, v163, v24
 v_dot2c_f32_bf16 v55, v163, v25
 s_waitcnt vmcnt(6)
 v_dot2c_f32_bf16 v48, v164, v24
 v_dot2c_f32_bf16 v49, v164, v25
 v_dot2c_f32_bf16 v50, v165, v24
 v_dot2c_f32_bf16 v51, v165, v25
 v_dot2c_f32_bf16 v52, v166, v24
 v_dot2c_f32_bf16 v53, v166, v25
 v_dot2c_f32_bf16 v54, v167, v24
 v_dot2c_f32_bf16 v55, v167, v25
 s_waitcnt vmcnt(5)
 v_dot2c_f32_bf16 v48, v168, v24
 v_dot2c_f32_bf16 v49, v168, v25
 v_dot2c_f32_bf16 v50, v169, v24
 v_dot2c_f32_bf16 v51, v169, v25
 v_dot2c_f32_bf16 v52, v170, v24
 v_dot2c_f32_bf16 v53, v170, v25
 v_dot2c_f32_bf16 v54, v171, v24
 v_dot2c_f32_bf16 v55, v171, v25
 s_waitcnt vmcnt(4)
 v_dot2c_f32_bf16 v48, v172, v24
 v_dot2c_f32_bf16 v49, v172, v25
 v_dot2c_f32_bf16 v50, v173, v24
 v_dot2c_f32_bf16 v51, v173, v25
 v_dot2c_f32_bf16 v52, v174, v24
 v_dot2c_f32_bf16 v53, v174, v25
 v_dot2c_f32_bf16 v54, v175, v24
 v_dot2c_f32_bf16 v55, v175, v25
 s_waitcnt vmcnt(3)
 v_dot2c_f32_bf16 v48, v176, v24
 v_dot2c_f32_bf16 v49, v176, v25
 v_dot2c_f32_bf16 v50, v177, v24
 v_dot2c_f32_bf16 v51, v177, v25
 v_dot2c_f32_bf16 v52, v178, v24
 v_dot2c_f32_bf16 v53, v178, v25
 v_dot2c_f32_bf16 v54, v179, v24
 v_dot2c_f32_bf16 v55, v179, v25
 s_waitcnt vmcnt(2)
 v_dot2c_f32_bf16 v48, v180, v24
 v_dot2c_f32_bf16 v49, v180, v25
 v_dot2c_f32_bf16 v50, v181, v24
 v_dot2c_f32_bf16 v51, v181, v25
 v_dot2c_f32_bf16 v52, v182, v24
 v_dot2c_f32_bf16 v53, v182, v25
 v_dot2c_f32_bf16 v54, v183, v24
 v_dot2c_f32_bf16 v55, v183, v25
 s_waitcnt vmcnt(1)
 v_dot2c_f32_bf16 v48, v184, v24
 v_dot2c_f32_bf16 v49, v184, v25
 v_dot2c_f32_bf16 v50, v185, v24
 v_dot2c_f32_bf16 v51, v185, v25
 v_dot2c_f32_bf16 v52, v186, v24
 v_dot2c_f32_bf16 v53, v186, v25
 v_dot2c_f32_bf16 v54, v187, v24
 v_dot2c_f32_bf16 v55, v187, v25
 s_waitcnt vmcnt(0)
 v_dot2c_f32_bf16 v48, v188, v24
 v_dot2c_f32_bf16 v49, v188, v25
 v_dot2c_f32_bf16 v50, v189, v24
 v_dot2c_f32_bf16 v51, v189, v25
 v_dot2c_f32_bf16 v52, v190, v24
 v_dot2c_f32_bf16 v53, v190, v25
 v_dot2c_f32_bf16 v54, v191, v24
 v_dot2c_f32_bf16 v55, v191, v25
 s_nop 1
 v_fmac_f32 v32, v15, v48
 v_fmac_f32 v33, v15, v49
 v_fmac_f32 v34, v15, v50
 v_fmac_f32 v35, v15, v51
 v_fmac_f32 v36, v15, v52
 v_fmac_f32 v37, v15, v53
 v_fmac_f32 v38, v15, v54
 v_fmac_f32 v39, v15, v55
 v_cvt_pk_bf16_f32 v16, v32, v33
 v_cvt_pk_bf16_f32 v17, v34, v35
 v_cvt_pk_bf16_f32 v18, v36, v37
 v_cvt_pk_bf16_f32 v19, v38, v39
 buffer_store_dwordx4 v[16:19], v12, s[52:55], s86 offen sc1
L_vend:
 s_endpgm
L_vend3:
 s_waitcnt vmcnt(0)
 buffer_store_dword v40, v41, s[8:11], s3 offen sc1
 s_branch L_vend
 s_waitcnt vmcnt(0)
L_p3k:
 s_mov_b32 s72, s32
 s_add_u32 s73, s72, 4096
 s_add_u32 s74, s72, 8192
 s_add_u32 s75, s72, 12288
 s_waitcnt vmcnt(8)
 v_cmp_ne_u32 vcc, 1, v5
 s_nop 0
 s_cbranch_vccnz L_fps1
L_fpr1:
M v[128:131], a[64:67], v[40:43], v[128:131]
 ds_read_b128 a[96:99], v2 offset:8192
 ds_read_b128 a[100:103], v2 offset:9216
M v[128:131], a[68:71], v[56:59], v[128:131]
 buffer_load_dwordx4 a[0:3], v7, s[8:11], s72 offen offset:0 sc1
M v[132:135], a[68:71], v[60:63], v[132:135]
 v_exp_f32 v18, v100
M v[132:135], a[64:67], v[44:47], v[132:135]
 ds_read_b128 a[104:107], v2 offset:10240
 ds_read_b128 a[108:111], v2 offset:11264
M v[140:143], a[72:75], v[44:47], v[140:143]
 buffer_load_dwordx4 a[4:7], v7, s[8:11], s72 offen offset:1024 sc1
M v[140:143], a[76:79], v[60:63], v[140:143]
 v_exp_f32 v19, v101
M v[136:139], a[76:79], v[56:59], v[136:139]
 ds_read_b128 a[112:115], v2 offset:12288
 ds_read_b128 a[116:119], v2 offset:13312
M v[136:139], a[72:75], v[40:43], v[136:139]
 buffer_load_dwordx4 a[8:11], v7, s[8:11], s72 offen offset:2048 sc1
M v[144:147], a[80:83], v[40:43], v[144:147]
 v_exp_f32 v20, v102
M v[144:147], a[84:87], v[56:59], v[144:147]
 ds_read_b128 a[120:123], v2 offset:14336
 ds_read_b128 a[124:127], v2 offset:15360
M v[148:151], a[84:87], v[60:63], v[148:151]
 v_exp_f32 v21, v103
M v[148:151], a[80:83], v[44:47], v[148:151]
 buffer_load_dwordx4 a[12:15], v7, s[8:11], s72 offen offset:3072 sc1
M v[156:159], a[88:91], v[44:47], v[156:159]
 v_add_f32 v30, v26, v30
 v_add_f32 v31, v27, v31
M v[156:159], a[92:95], v[60:63], v[156:159]
 v_add_f32 v29, v18, v19
 v_cvt_pk_bf16_f32 v52, v18, v19
M v[152:155], a[92:95], v[56:59], v[152:155]
 v_exp_f32 v22, v108
M v[152:155], a[88:91], v[40:43], v[152:155]
 s_waitcnt lgkmcnt(0)
 v_add_f32 v29, v20, v29
 v_cvt_pk_bf16_f32 v53, v20, v21
M v[160:163], a[96:99], v[40:43], v[160:163]
 ds_read_b128 a[64:67], v2 offset:16384
 ds_read_b128 a[68:71], v2 offset:17408
M v[160:163], a[100:103], v[56:59], v[160:163]
 buffer_load_dwordx4 a[16:19], v7, s[8:11], s73 offen offset:0 sc1
M v[164:167], a[100:103], v[60:63], v[164:167]
 v_exp_f32 v23, v109
M v[164:167], a[96:99], v[44:47], v[164:167]
 ds_read_b128 a[72:75], v2 offset:18432
 ds_read_b128 a[76:79], v2 offset:19456
M v[172:175], a[104:107], v[44:47], v[172:175]
 buffer_load_dwordx4 a[20:23], v7, s[8:11], s73 offen offset:1024 sc1
M v[172:175], a[108:111], v[60:63], v[172:175]
 v_exp_f32 v24, v110
M v[168:171], a[108:111], v[56:59], v[168:171]
 ds_read_b128 a[80:83], v2 offset:20480
 ds_read_b128 a[84:87], v2 offset:21504
M v[168:171], a[104:107], v[40:43], v[168:171]
 buffer_load_dwordx4 a[24:27], v7, s[8:11], s73 offen offset:2048 sc1
M v[176:179], a[112:115], v[40:43], v[176:179]
 v_exp_f32 v25, v111
M v[176:179], a[116:119], v[56:59], v[176:179]
 ds_read_b128 a[88:91], v2 offset:22528
 ds_read_b128 a[92:95], v2 offset:23552
M v[180:183], a[116:119], v[60:63], v[180:183]
 buffer_load_dwordx4 a[28:31], v7, s[8:11], s73 offen offset:3072 sc1
M v[180:183], a[112:115], v[44:47], v[180:183]
 v_add_f32 v29, v21, v29
 v_add_f32 v29, v22, v29
M v[188:191], a[120:123], v[44:47], v[188:191]
 v_exp_f32 v18, v116
M v[188:191], a[124:127], v[60:63], v[188:191]
 v_cvt_pk_bf16_f32 v54, v22, v23
 v_add_f32 v29, v23, v29
M v[184:187], a[124:127], v[56:59], v[184:187]
 buffer_load_dwordx4 a[32:35], v7, s[8:11], s74 offen offset:0 sc1
M v[184:187], a[120:123], v[40:43], v[184:187]
 s_waitcnt lgkmcnt(0)
 v_exp_f32 v19, v117
M v[192:195], a[64:67], v[40:43], v[192:195]
 ds_read_b128 a[96:99], v2 offset:24576
 ds_read_b128 a[100:103], v2 offset:25600
M v[192:195], a[68:71], v[56:59], v[192:195]
 buffer_load_dwordx4 a[36:39], v7, s[8:11], s74 offen offset:1024 sc1
M v[196:199], a[68:71], v[60:63], v[196:199]
 v_add_f32 v29, v24, v29
 v_cvt_pk_bf16_f32 v55, v24, v25
M v[196:199], a[64:67], v[44:47], v[196:199]
 ds_read_b128 a[104:107], v2 offset:26624
 ds_read_b128 a[108:111], v2 offset:27648
M v[204:207], a[72:75], v[44:47], v[204:207]
 v_exp_f32 v20, v118
M v[204:207], a[76:79], v[60:63], v[204:207]
 buffer_load_dwordx4 a[40:43], v7, s[8:11], s74 offen offset:2048 sc1
M v[200:203], a[76:79], v[56:59], v[200:203]
 ds_read_b128 a[112:115], v2 offset:28672
 ds_read_b128 a[116:119], v2 offset:29696
M v[200:203], a[72:75], v[40:43], v[200:203]
 v_exp_f32 v21, v119
M v[208:211], a[80:83], v[40:43], v[208:211]
 v_add_f32 v29, v25, v29
 v_add_f32 v29, v18, v29
M v[208:211], a[84:87], v[56:59], v[208:211]
 ds_read_b128 a[120:123], v2 offset:30720
 ds_read_b128 a[124:127], v2 offset:31744
M v[212:215], a[84:87], v[60:63], v[212:215]
 buffer_load_dwordx4 a[44:47], v7, s[8:11], s74 offen offset:3072 sc1
M v[212:215], a[80:83], v[44:47], v[212:215]
 v_exp_f32 v22, v124
M v[220:223], a[88:91], v[44:47], v[220:223]
 v_cvt_pk_bf16_f32 v48, v18, v19
 v_add_f32 v29, v19, v29
M v[220:223], a[92:95], v[60:63], v[220:223]
 buffer_load_dwordx4 a[48:51], v7, s[8:11], s75 offen offset:0 sc1
M v[216:219], a[92:95], v[56:59], v[216:219]
 s_waitcnt vmcnt(13) lgkmcnt(0)
 v_exp_f32 v23, v125
M v[216:219], a[88:91], v[40:43], v[216:219]
 s_barrier
M v[224:227], a[96:99], v[40:43], v[224:227]
 ds_read_b128 a[64:67], v7 offset:0
 ds_read_b128 a[68:71], v7 offset:1024
M v[224:227], a[100:103], v[56:59], v[224:227]
 buffer_load_dwordx4 a[52:55], v7, s[8:11], s75 offen offset:1024 sc1
M v[228:231], a[100:103], v[60:63], v[228:231]
 v_exp_f32 v24, v126
M v[228:231], a[96:99], v[44:47], v[228:231]
 ds_read_b128 a[72:75], v7 offset:2048
 ds_read_b128 a[76:79], v7 offset:3072
M v[236:239], a[104:107], v[44:47], v[236:239]
 buffer_load_dwordx4 a[56:59], v7, s[8:11], s75 offen offset:2048 sc1
M v[236:239], a[108:111], v[60:63], v[236:239]
 v_exp_f32 v25, v127
M v[232:235], a[108:111], v[56:59], v[232:235]
 ds_read_b128 a[80:83], v7 offset:4096
 ds_read_b128 a[84:87], v7 offset:5120
M v[232:235], a[104:107], v[40:43], v[232:235]
 v_add_f32 v29, v20, v29
 v_cvt_pk_bf16_f32 v49, v20, v21
M v[240:243], a[112:115], v[40:43], v[240:243]
 buffer_load_dwordx4 a[60:63], v7, s[8:11], s75 offen offset:3072 sc1
M v[240:243], a[116:119], v[56:59], v[240:243]
 ds_read_b128 a[88:91], v7 offset:6144
 ds_read_b128 a[92:95], v7 offset:7168
M v[244:247], a[116:119], v[60:63], v[244:247]
 v_add_f32 v29, v21, v29
 v_add_f32 v29, v22, v29
M v[244:247], a[112:115], v[44:47], v[244:247]
 v_cvt_pk_bf16_f32 v50, v22, v23
 v_add_f32 v29, v23, v29
M v[252:255], a[120:123], v[44:47], v[252:255]
 v_add_f32 v29, v24, v29
 v_cvt_pk_bf16_f32 v51, v24, v25
M v[252:255], a[124:127], v[60:63], v[252:255]
 v_add_f32 v29, v25, v29
M v[248:251], a[124:127], v[56:59], v[248:251]
 s_waitcnt lgkmcnt(0)
M v[248:251], a[120:123], v[40:43], v[248:251]
 v_cmp_lt_f32 vcc, s31, v29
 s_nop 0
 s_cbranch_vccnz L_st7
L_rt7:
M v[132:135], a[64:67], v[52:55], v[132:135]
 ds_read_b128 a[96:99], v7 offset:8192
 ds_read_b128 a[100:103], v7 offset:9216
M v[132:135], a[68:71], v[48:51], v[132:135]
 ds_read_b128 a[104:107], v7 offset:10240
 v_add_f32 v31, v29, v31
M v[140:143], a[76:79], v[48:51], v[140:143]
 s_sub_u32 s27, 5, s42
 ds_read_b128 a[108:111], v7 offset:11264
 ds_read_b128 a[112:115], v7 offset:12288
M v[140:143], a[72:75], v[52:55], v[140:143]
 s_mov_b32 s40, 0
 ds_read_b128 a[116:119], v7 offset:13312
 v_mov_b32 v10, v30
M v[148:151], a[80:83], v[52:55], v[148:151]
 s_add_u32 m0, s28, 32768
 ds_read_b128 a[120:123], v7 offset:14336
 ds_read_b128 a[124:127], v7 offset:15360
M v[148:151], a[84:87], v[48:51], v[148:151]
 buffer_load_dwordx4 v3, s[8:11], s21 offen offset:0 sc1 lds
M v[156:159], a[92:95], v[48:51], v[156:159]
 ds_read_b128 a[128:131], v7 offset:16384
 ds_read_b128 a[132:135], v7 offset:17408
M v[156:159], a[88:91], v[52:55], v[156:159]
 s_waitcnt lgkmcnt(2)
 ds_read_b128 a[136:139], v7 offset:18432
 v_mov_b32 v11, v31
M v[164:167], a[96:99], v[52:55], v[164:167]
 ds_read_b128 a[140:143], v7 offset:19456
 ds_read_b128 a[144:147], v7 offset:20480
M v[164:167], a[100:103], v[48:51], v[164:167]
 buffer_load_dwordx4 v3, s[8:11], s21 offen offset:1024 sc1 lds
M v[172:175], a[108:111], v[48:51], v[172:175]
 ds_read_b128 a[148:151], v7 offset:21504
 ds_read_b128 a[152:155], v7 offset:22528
M v[172:175], a[104:107], v[52:55], v[172:175]
 ds_read_b128 a[156:159], v7 offset:23552
 v_permlane16_swap_b32 v10, v30
M v[180:183], a[112:115], v[52:55], v[180:183]
 ds_read_b128 a[160:163], v7 offset:24576
 ds_read_b128 a[164:167], v7 offset:25600
M v[180:183], a[116:119], v[48:51], v[180:183]
 buffer_load_dwordx4 v3, s[8:11], s21 offen offset:2048 sc1 lds
M v[188:191], a[124:127], v[48:51], v[188:191]
 ds_read_b128 a[168:171], v7 offset:26624
 ds_read_b128 a[172:175], v7 offset:27648
M v[188:191], a[120:123], v[52:55], v[188:191]
 s_waitcnt lgkmcnt(4)
 ds_read_b128 a[176:179], v7 offset:28672
 v_permlane16_swap_b32 v11, v31
M v[196:199], a[128:131], v[52:55], v[196:199]
 ds_read_b128 a[180:183], v7 offset:29696
 ds_read_b128 a[184:187], v7 offset:30720
M v[196:199], a[132:135], v[48:51], v[196:199]
 ds_read_b128 a[188:191], v7 offset:31744
 v_add_f32 v30, v10, v30
M v[204:207], a[140:143], v[48:51], v[204:207]
 buffer_load_dwordx4 v3, s[8:11], s21 offen offset:3072 sc1 lds
M v[204:207], a[136:139], v[52:55], v[204:207]
 s_add_u32 m0, s28, 36864
 v_add_f32 v31, v11, v31
 v_mov_b32 v10, v30
M v[212:215], a[144:147], v[52:55], v[212:215]
 buffer_load_dwordx4 v4, s[8:11], s21 offen offset:0 sc1 lds
M v[212:215], a[148:151], v[48:51], v[212:215]
 s_waitcnt lgkmcnt(0)
 v_mov_b32 v11, v31
 v_permlane32_swap_b32 v10, v30
M v[220:223], a[156:159], v[48:51], v[220:223]
 s_barrier
M v[220:223], a[152:155], v[52:55], v[220:223]
 ds_read_b128 a[64:67], v2 offset:32768
 ds_read_b128 a[68:71], v2 offset:33792
M v[228:231], a[160:163], v[52:55], v[228:231]
 ds_read_b128 a[72:75], v2 offset:34816
 v_permlane32_swap_b32 v11, v31
M v[228:231], a[164:167], v[48:51], v[228:231]
 ds_read_b128 a[76:79], v2 offset:35840
 ds_read_b128 a[80:83], v2 offset:36864
M v[236:239], a[172:175], v[48:51], v[236:239]
 ds_read_b128 a[84:87], v2 offset:37888
 v_add_f32 v30, v10, v30
M v[236:239], a[168:171], v[52:55], v[236:239]
 ds_read_b128 a[88:91], v2 offset:38912
 ds_read_b128 a[92:95], v2 offset:39936
M v[244:247], a[176:179], v[52:55], v[244:247]
 buffer_load_dwordx4 v4, s[8:11], s21 offen offset:1024 sc1 lds
M v[244:247], a[180:183], v[48:51], v[244:247]
 buffer_load_dwordx4 v4, s[8:11], s21 offen offset:2048 sc1 lds
M v[252:255], a[188:191], v[48:51], v[252:255]
 buffer_load_dwordx4 v4, s[8:11], s21 offen offset:3072 sc1 lds
M v[252:255], a[184:187], v[52:55], v[252:255]
 s_waitcnt lgkmcnt(0)
 s_add_u32 s24, s23, 16777216
 s_mov_b32 s23, s21
 s_add_u32 s21, s21, 32768
 s_add_u32 s22, s22, 1
 s_cmp_eq_u32 s22, s25
 s_cselect_b32 s21, s26, s21
 s_cmp_eq_u32 s22, s43
 s_cselect_b32 s21, s4, s21
 s_cmp_eq_u32 s22, s6
 s_cselect_b32 s21, s7, s21
 v_add_f32 v31, v11, v31
 v_rcp_f32 v5, v30
 v_rcp_f32 v6, v31
 v_accvgpr_write_b32 a192, v5
 v_accvgpr_write_b32 a193, v6
 v_mov_b32 v30, 0
 v_mov_b32 v31, 0
 v_mov_b32 v32, 0xc1800000
 v_mov_b32 v33, 0xc1800000
 v_mov_b32 v34, 0xc1800000
 v_mov_b32 v35, 0xc1800000
 v_mov_b32 v36, 0xc1800000
 v_mov_b32 v37, 0xc1800000
 v_mov_b32 v38, 0xc1800000
 v_mov_b32 v39, 0xc1800000
 s_waitcnt vmcnt(8)
M v[64:67], a[64:67], a[0:3], v[32:35]
 ds_read_b128 a[96:99], v2 offset:40960
 v_cvt_pk_bf16_f32 v128, v128, v129
M v[64:67], a[68:71], a[4:7], v[64:67]
 ds_read_b128 a[100:103], v2 offset:41984
 v_cvt_pk_bf16_f32 v129, v130, v131
M v[64:67], a[72:75], a[8:11], v[64:67]
 buffer_load_dword v6, v9, s[8:11], s46 offen sc1
M v[64:67], a[76:79], a[12:15], v[64:67]
 ds_read_b128 a[104:107], v2 offset:43008
 v_cvt_pk_bf16_f32 v130, v136, v137
M v[64:67], a[80:83], a[16:19], v[64:67]
 s_add_u32 m0, s28, 65536
 ds_read_b128 a[108:111], v2 offset:44032
 v_cvt_pk_bf16_f32 v131, v138, v139
M v[64:67], a[84:87], a[20:23], v[64:67]
 buffer_load_dwordx4 v3, s[8:11], s24 offen offset:0 sc1 lds
M v[64:67], a[88:91], a[24:27], v[64:67]
 ds_read_b128 a[112:115], v2 offset:45056
 v_accvgpr_write_b32 a128, v128
M v[64:67], a[92:95], a[28:31], v[64:67]
 ds_read_b128 a[116:119], v2 offset:46080
 v_accvgpr_write_b32 a129, v129
M v[68:71], a[92:95], a[60:63], v[36:39]
 buffer_load_dwordx4 v3, s[8:11], s24 offen offset:1024 sc1 lds
M v[68:71], a[88:91], a[56:59], v[68:71]
 ds_read_b128 a[120:123], v2 offset:47104
 v_accvgpr_write_b32 a130, v130
M v[68:71], a[84:87], a[52:55], v[68:71]
 ds_read_b128 a[124:127], v2 offset:48128
 v_accvgpr_write_b32 a131, v131
M v[68:71], a[80:83], a[48:51], v[68:71]
 v_exp_f32 v18, v64
M v[68:71], a[76:79], a[44:47], v[68:71]
 v_exp_f32 v19, v65
M v[68:71], a[72:75], a[40:43], v[68:71]
 buffer_load_dwordx4 v3, s[8:11], s24 offen offset:2048 sc1 lds
M v[68:71], a[68:71], a[36:39], v[68:71]
 v_exp_f32 v20, v66
M v[68:71], a[64:67], a[32:35], v[68:71]
 s_waitcnt lgkmcnt(0)
 v_exp_f32 v21, v67
M v[72:75], a[96:99], a[0:3], v[32:35]
 ds_read_b128 a[64:67], v2 offset:49152
 v_add_f32 v26, v18, v19
M v[72:75], a[100:103], a[4:7], v[72:75]
 ds_read_b128 a[68:71], v2 offset:50176
 v_cvt_pk_bf16_f32 v40, v18, v19
M v[72:75], a[104:107], a[8:11], v[72:75]
 buffer_load_dwordx4 v3, s[8:11], s24 offen offset:3072 sc1 lds
M v[72:75], a[108:111], a[12:15], v[72:75]
 ds_read_b128 a[72:75], v2 offset:51200
 v_add_f32 v26, v20, v26
M v[72:75], a[112:115], a[16:19], v[72:75]
 ds_read_b128 a[76:79], v2 offset:52224
 v_cvt_pk_bf16_f32 v41, v20, v21
M v[72:75], a[116:119], a[20:23], v[72:75]
 v_exp_f32 v22, v68
M v[72:75], a[120:123], a[24:27], v[72:75]
 ds_read_b128 a[80:83], v2 offset:53248
 v_add_f32 v26, v21, v26
M v[72:75], a[124:127], a[28:31], v[72:75]
 s_add_u32 m0, s28, 69632
 ds_read_b128 a[84:87], v2 offset:54272
 v_cvt_pk_bf16_f32 v132, v132, v133
M v[76:79], a[124:127], a[60:63], v[36:39]
 buffer_load_dwordx4 v4, s[8:11], s24 offen offset:0 sc1 lds
M v[76:79], a[120:123], a[56:59], v[76:79]
 ds_read_b128 a[88:91], v2 offset:55296
 v_cvt_pk_bf16_f32 v133, v134, v135
M v[76:79], a[116:119], a[52:55], v[76:79]
 ds_read_b128 a[92:95], v2 offset:56320
 v_cvt_pk_bf16_f32 v134, v140, v141
M v[76:79], a[112:115], a[48:51], v[76:79]
 v_exp_f32 v23, v69
M v[76:79], a[108:111], a[44:47], v[76:79]
 buffer_load_dwordx4 v4, s[8:11], s24 offen offset:1024 sc1 lds
M v[76:79], a[104:107], a[40:43], v[76:79]
 v_exp_f32 v24, v70
M v[76:79], a[100:103], a[36:39], v[76:79]
 v_exp_f32 v25, v71
M v[76:79], a[96:99], a[32:35], v[76:79]
 s_waitcnt lgkmcnt(0)
 v_exp_f32 v18, v72
M v[80:83], a[64:67], a[0:3], v[32:35]
 ds_read_b128 a[96:99], v2 offset:57344
 v_add_f32 v27, v22, v23
M v[80:83], a[68:71], a[4:7], v[80:83]
 ds_read_b128 a[100:103], v2 offset:58368
 v_cvt_pk_bf16_f32 v44, v22, v23
M v[80:83], a[72:75], a[8:11], v[80:83]
 buffer_load_dwordx4 v4, s[8:11], s24 offen offset:2048 sc1 lds
M v[80:83], a[76:79], a[12:15], v[80:83]
 ds_read_b128 a[104:107], v2 offset:59392
 v_add_f32 v27, v24, v27
M v[80:83], a[80:83], a[16:19], v[80:83]
 ds_read_b128 a[108:111], v2 offset:60416
 v_cvt_pk_bf16_f32 v45, v24, v25
M v[80:83], a[84:87], a[20:23], v[80:83]
 v_exp_f32 v19, v73
M v[80:83], a[88:91], a[24:27], v[80:83]
 ds_read_b128 a[112:115], v2 offset:61440
 v_add_f32 v27, v25, v27
M v[80:83], a[92:95], a[28:31], v[80:83]
 ds_read_b128 a[116:119], v2 offset:62464
 v_add_f32 v26, v18, v26
M v[84:87], a[92:95], a[60:63], v[36:39]
 s_waitcnt vmcnt(7)
 v_cmp_gt_u32 vcc, 3, v6
 v_cvt_pk_bf16_f32 v42, v18, v19
M v[84:87], a[88:91], a[56:59], v[84:87]
 ds_read_b128 a[120:123], v2 offset:63488
 v_add_f32 v26, v19, v26
M v[84:87], a[84:87], a[52:55], v[84:87]
 ds_read_b128 a[124:127], v2 offset:64512
 v_cvt_pk_bf16_f32 v135, v142, v143
M v[84:87], a[80:83], a[48:51], v[84:87]
 s_cbranch_vccnz L_f2s
L_f2r:
 v_exp_f32 v20, v74
M v[84:87], a[76:79], a[44:47], v[84:87]
 buffer_load_dwordx4 v4, s[8:11], s24 offen offset:3072 sc1 lds
M v[84:87], a[72:75], a[40:43], v[84:87]
 v_exp_f32 v21, v75
M v[84:87], a[68:71], a[36:39], v[84:87]
 s_waitcnt lgkmcnt(0)
 v_exp_f32 v22, v76
M v[84:87], a[64:67], a[32:35], v[84:87]
 s_barrier
M v[88:91], a[96:99], a[0:3], v[32:35]
 ds_read_b128 a[64:67], v7 offset:32768
 v_add_f32 v26, v20, v26
M v[88:91], a[100:103], a[4:7], v[88:91]
 ds_read_b128 a[68:71], v7 offset:33792
 v_cvt_pk_bf16_f32 v43, v20, v21
M v[88:91], a[104:107], a[8:11], v[88:91]
 v_exp_f32 v23, v77
M v[88:91], a[108:111], a[12:15], v[88:91]
 ds_read_b128 a[72:75], v7 offset:34816
 v_add_f32 v26, v21, v26
M v[88:91], a[112:115], a[16:19], v[88:91]
 ds_read_b128 a[76:79], v7 offset:35840
 v_add_f32 v27, v22, v27
M v[88:91], a[116:119], a[20:23], v[88:91]
 v_exp_f32 v24, v78
M v[88:91], a[120:123], a[24:27], v[88:91]
 ds_read_b128 a[80:83], v7 offset:36864
 v_cvt_pk_bf16_f32 v46, v22, v23
M v[88:91], a[124:127], a[28:31], v[88:91]
 ds_read_b128 a[84:87], v7 offset:37888
 v_add_f32 v27, v23, v27
M v[92:95], a[124:127], a[60:63], v[36:39]
 v_exp_f32 v25, v79
M v[92:95], a[120:123], a[56:59], v[92:95]
 ds_read_b128 a[88:91], v7 offset:38912
 v_add_f32 v27, v24, v27
M v[92:95], a[116:119], a[52:55], v[92:95]
 ds_read_b128 a[92:95], v7 offset:39936
 v_cvt_pk_bf16_f32 v47, v24, v25
M v[92:95], a[112:115], a[48:51], v[92:95]
 v_add_f32 v27, v25, v27
 v_accvgpr_write_b32 a160, v132
M v[92:95], a[108:111], a[44:47], v[92:95]
 v_accvgpr_write_b32 a161, v133
 v_accvgpr_write_b32 a162, v134
M v[92:95], a[104:107], a[40:43], v[92:95]
 v_accvgpr_write_b32 a163, v135
 v_cvt_pk_bf16_f32 v144, v144, v145
M v[92:95], a[100:103], a[36:39], v[92:95]
 s_waitcnt lgkmcnt(0)
 v_cvt_pk_bf16_f32 v145, v146, v147
 v_cvt_pk_bf16_f32 v146, v152, v153
M v[92:95], a[96:99], a[32:35], v[92:95]
 v_cvt_pk_bf16_f32 v147, v154, v155
 v_accvgpr_write_b32 a132, v144
M v[96:99], a[64:67], a[0:3], v[32:35]
 s_add_u32 m0, s28, 98304
 ds_read_b128 a[96:99], v7 offset:40960
 v_accvgpr_write_b32 a133, v145
M v[96:99], a[68:71], a[4:7], v[96:99]
 ds_read_b128 a[100:103], v7 offset:41984
 v_accvgpr_write_b32 a134, v146
M v[96:99], a[72:75], a[8:11], v[96:99]
 buffer_load_dwordx4 v3, s[8:11], s21 offen offset:0 sc1 lds
M v[96:99], a[76:79], a[12:15], v[96:99]
 ds_read_b128 a[104:107], v7 offset:43008
 v_accvgpr_write_b32 a135, v147
M v[96:99], a[80:83], a[16:19], v[96:99]
 ds_read_b128 a[108:111], v7 offset:44032
 v_cvt_pk_bf16_f32 v148, v148, v149
M v[96:99], a[84:87], a[20:23], v[96:99]
 buffer_load_dwordx4 v3, s[8:11], s21 offen offset:1024 sc1 lds
M v[96:99], a[88:91], a[24:27], v[96:99]
 ds_read_b128 a[112:115], v7 offset:45056
 v_cvt_pk_bf16_f32 v149, v150, v151
M v[96:99], a[92:95], a[28:31], v[96:99]
 ds_read_b128 a[116:119], v7 offset:46080
 v_cvt_pk_bf16_f32 v150, v156, v157
M v[100:103], a[92:95], a[60:63], v[36:39]
 v_exp_f32 v18, v80
M v[100:103], a[88:91], a[56:59], v[100:103]
 ds_read_b128 a[120:123], v7 offset:47104
 v_cvt_pk_bf16_f32 v151, v158, v159
M v[100:103], a[84:87], a[52:55], v[100:103]
 ds_read_b128 a[124:127], v7 offset:48128
 v_accvgpr_write_b32 a164, v148
M v[100:103], a[80:83], a[48:51], v[100:103]
 buffer_load_dwordx4 v3, s[8:11], s21 offen offset:2048 sc1 lds
M v[100:103], a[76:79], a[44:47], v[100:103]
 v_exp_f32 v19, v81
M v[100:103], a[72:75], a[40:43], v[100:103]
 v_exp_f32 v20, v82
M v[100:103], a[68:71], a[36:39], v[100:103]
 v_exp_f32 v21, v83
M v[100:103], a[64:67], a[32:35], v[100:103]
 s_waitcnt lgkmcnt(0)
 v_exp_f32 v22, v88
M v[108:111], a[96:99], a[32:35], v[36:39]
 ds_read_b128 a[64:67], v7 offset:49152
 v_add_f32 v26, v18, v26
M v[108:111], a[100:103], a[36:39], v[108:111]
 ds_read_b128 a[68:71], v7 offset:50176
 v_cvt_pk_bf16_f32 v56, v18, v19
M v[108:111], a[104:107], a[40:43], v[108:111]
 buffer_load_dwordx4 v3, s[8:11], s21 offen offset:3072 sc1 lds
M v[108:111], a[108:111], a[44:47], v[108:111]
 s_add_u32 m0, s28, 102400
 ds_read_b128 a[72:75], v7 offset:51200
 v_add_f32 v26, v19, v26
M v[108:111], a[112:115], a[48:51], v[108:111]
 ds_read_b128 a[76:79], v7 offset:52224
 v_add_f32 v26, v20, v26
M v[108:111], a[116:119], a[52:55], v[108:111]
 buffer_load_dwordx4 v4, s[8:11], s21 offen offset:0 sc1 lds
M v[108:111], a[120:123], a[56:59], v[108:111]
 ds_read_b128 a[80:83], v7 offset:53248
 v_cvt_pk_bf16_f32 v57, v20, v21
M v[108:111], a[124:127], a[60:63], v[108:111]
 ds_read_b128 a[84:87], v7 offset:54272
 v_add_f32 v26, v21, v26
M v[104:107], a[124:127], a[28:31], v[32:35]
 v_exp_f32 v23, v89
M v[104:107], a[120:123], a[24:27], v[104:107]
 ds_read_b128 a[88:91], v7 offset:55296
 v_add_f32 v26, v22, v26
M v[104:107], a[116:119], a[20:23], v[104:107]
 ds_read_b128 a[92:95], v7 offset:56320
 v_cvt_pk_bf16_f32 v58, v22, v23
M v[104:107], a[112:115], a[16:19], v[104:107]
 buffer_load_dwordx4 v4, s[8:11], s21 offen offset:1024 sc1 lds
M v[104:107], a[108:111], a[12:15], v[104:107]
 v_exp_f32 v24, v90
M v[104:107], a[104:107], a[8:11], v[104:107]
 v_exp_f32 v25, v91
M v[104:107], a[100:103], a[4:7], v[104:107]
 buffer_load_dwordx4 v4, s[8:11], s21 offen offset:2048 sc1 lds
M v[104:107], a[96:99], a[0:3], v[104:107]
 s_waitcnt lgkmcnt(0)
 v_exp_f32 v18, v84
M v[112:115], a[64:67], a[0:3], v[32:35]
 ds_read_b128 a[96:99], v7 offset:57344
 v_add_f32 v26, v23, v26
M v[112:115], a[68:71], a[4:7], v[112:115]
 ds_read_b128 a[100:103], v7 offset:58368
 v_add_f32 v26, v24, v26
M v[112:115], a[72:75], a[8:11], v[112:115]
 v_exp_f32 v19, v85
M v[112:115], a[76:79], a[12:15], v[112:115]
 ds_read_b128 a[104:107], v7 offset:59392
 v_cvt_pk_bf16_f32 v59, v24, v25
M v[112:115], a[80:83], a[16:19], v[112:115]
 ds_read_b128 a[108:111], v7 offset:60416
 v_add_f32 v26, v25, v26
M v[112:115], a[84:87], a[20:23], v[112:115]
 buffer_load_dwordx4 v4, s[8:11], s21 offen offset:3072 sc1 lds
M v[112:115], a[88:91], a[24:27], v[112:115]
 s_add_u32 s24, s23, 16777216
 ds_read_b128 a[112:115], v7 offset:61440
 v_add_f32 v27, v18, v27
M v[112:115], a[92:95], a[28:31], v[112:115]
 s_mov_b32 s23, s21
 ds_read_b128 a[116:119], v7 offset:62464
 v_cvt_pk_bf16_f32 v60, v18, v19
M v[116:119], a[92:95], a[60:63], v[36:39]
 s_add_u32 s21, s21, 32768
 v_exp_f32 v20, v86
M v[116:119], a[88:91], a[56:59], v[116:119]
 s_add_u32 s22, s22, 1
 ds_read_b128 a[120:123], v7 offset:63488
 v_add_f32 v27, v19, v27
M v[116:119], a[84:87], a[52:55], v[116:119]
 s_cmp_eq_u32 s22, s25
 ds_read_b128 a[124:127], v7 offset:64512
 v_accvgpr_write_b32 a165, v149
M v[116:119], a[80:83], a[48:51], v[116:119]
 s_cselect_b32 s21, s26, s21
 v_exp_f32 v21, v87
M v[116:119], a[76:79], a[44:47], v[116:119]
 s_cmp_eq_u32 s22, s43
 v_exp_f32 v22, v92
M v[116:119], a[72:75], a[40:43], v[116:119]
 s_cselect_b32 s21, s4, s21
 v_exp_f32 v23, v93
M v[116:119], a[68:71], a[36:39], v[116:119]
 s_waitcnt vmcnt(8) lgkmcnt(0)
 v_add_f32 v27, v20, v27
 v_cvt_pk_bf16_f32 v61, v20, v21
M v[116:119], a[64:67], a[32:35], v[116:119]
 s_barrier
M v[124:127], a[96:99], a[32:35], v[36:39]
 s_cmp_eq_u32 s22, s6
 ds_read_b128 a[64:67], v2 offset:0
 v_add_f32 v27, v21, v27
M v[124:127], a[100:103], a[36:39], v[124:127]
 s_cselect_b32 s21, s7, s21
 ds_read_b128 a[68:71], v2 offset:1024
 v_add_f32 v27, v22, v27
M v[124:127], a[104:107], a[40:43], v[124:127]
 v_exp_f32 v24, v94
M v[124:127], a[108:111], a[44:47], v[124:127]
 ds_read_b128 a[72:75], v2 offset:2048
 v_cvt_pk_bf16_f32 v62, v22, v23
M v[124:127], a[112:115], a[48:51], v[124:127]
 ds_read_b128 a[76:79], v2 offset:3072
 v_add_f32 v27, v23, v27
M v[124:127], a[116:119], a[52:55], v[124:127]
 v_exp_f32 v25, v95
M v[124:127], a[120:123], a[56:59], v[124:127]
 ds_read_b128 a[80:83], v2 offset:4096
 v_add_f32 v27, v24, v27
M v[124:127], a[124:127], a[60:63], v[124:127]
 ds_read_b128 a[84:87], v2 offset:5120
 v_cvt_pk_bf16_f32 v63, v24, v25
M v[120:123], a[124:127], a[28:31], v[32:35]
 v_add_f32 v27, v25, v27
 v_accvgpr_write_b32 a166, v150
M v[120:123], a[120:123], a[24:27], v[120:123]
 ds_read_b128 a[88:91], v2 offset:6144
 v_max_f32 v10, v26, v27
M v[120:123], a[116:119], a[20:23], v[120:123]
 ds_read_b128 a[92:95], v2 offset:7168
 v_min_f32 v11, v26, v27
M v[120:123], a[112:115], a[16:19], v[120:123]
 v_cmp_lt_f32 s[36:37], s31, v10
 v_accvgpr_write_b32 a167, v151
M v[120:123], a[108:111], a[12:15], v[120:123]
 v_cmp_gt_f32 vcc, s55, v11
 v_cvt_pk_bf16_f32 v160, v160, v161
M v[120:123], a[104:107], a[8:11], v[120:123]
 v_cvt_pk_bf16_f32 v161, v162, v163
 v_cvt_pk_bf16_f32 v162, v168, v169
M v[120:123], a[100:103], a[4:7], v[120:123]
 s_waitcnt lgkmcnt(0)
 s_or_b64 vcc, vcc, s[36:37]
M v[120:123], a[96:99], a[0:3], v[120:123]
 s_cbranch_vccnz L_st11
L_rt11:
 v_cvt_pk_bf16_f32 v163, v170, v171
 v_accvgpr_write_b32 a136, v160
 v_accvgpr_write_b32 a137, v161
 v_accvgpr_write_b32 a138, v162
 v_accvgpr_write_b32 a139, v163
 v_cvt_pk_bf16_f32 v164, v164, v165
 v_cvt_pk_bf16_f32 v165, v166, v167
 v_cvt_pk_bf16_f32 v166, v172, v173
 v_cvt_pk_bf16_f32 v167, v174, v175
 v_accvgpr_write_b32 a168, v164
 v_accvgpr_write_b32 a169, v165
 v_accvgpr_write_b32 a170, v166
 v_accvgpr_write_b32 a171, v167
 v_cvt_pk_bf16_f32 v176, v176, v177
 v_cvt_pk_bf16_f32 v177, v178, v179
 v_cvt_pk_bf16_f32 v178, v184, v185
 v_cvt_pk_bf16_f32 v179, v186, v187
 v_accvgpr_write_b32 a140, v176
 v_accvgpr_write_b32 a141, v177
 v_accvgpr_write_b32 a142, v178
 v_accvgpr_write_b32 a143, v179
 v_cvt_pk_bf16_f32 v180, v180, v181
 v_cvt_pk_bf16_f32 v181, v182, v183
 v_cvt_pk_bf16_f32 v182, v188, v189
 v_cvt_pk_bf16_f32 v183, v190, v191
 v_accvgpr_write_b32 a172, v180
 v_accvgpr_write_b32 a173, v181
 v_accvgpr_write_b32 a174, v182
 v_accvgpr_write_b32 a175, v183
 v_cvt_pk_bf16_f32 v192, v192, v193
 v_cvt_pk_bf16_f32 v193, v194, v195
 v_cvt_pk_bf16_f32 v194, v200, v201
 v_cvt_pk_bf16_f32 v195, v202, v203
 v_accvgpr_write_b32 a144, v192
 v_accvgpr_write_b32 a145, v193
 v_accvgpr_write_b32 a146, v194
 v_accvgpr_write_b32 a147, v195
 v_cvt_pk_bf16_f32 v196, v196, v197
 v_cvt_pk_bf16_f32 v197, v198, v199
 v_cvt_pk_bf16_f32 v198, v204, v205
 v_cvt_pk_bf16_f32 v199, v206, v207
 v_accvgpr_write_b32 a176, v196
 v_accvgpr_write_b32 a177, v197
 v_accvgpr_write_b32 a178, v198
 v_accvgpr_write_b32 a179, v199
 v_cvt_pk_bf16_f32 v208, v208, v209
 v_cvt_pk_bf16_f32 v209, v210, v211
 v_cvt_pk_bf16_f32 v210, v216, v217
 v_cvt_pk_bf16_f32 v211, v218, v219
 v_accvgpr_write_b32 a148, v208
 v_accvgpr_write_b32 a149, v209
 v_accvgpr_write_b32 a150, v210
 v_accvgpr_write_b32 a151, v211
 v_cvt_pk_bf16_f32 v212, v212, v213
 v_cvt_pk_bf16_f32 v213, v214, v215
 v_cvt_pk_bf16_f32 v214, v220, v221
 v_cvt_pk_bf16_f32 v215, v222, v223
 v_accvgpr_write_b32 a180, v212
 v_accvgpr_write_b32 a181, v213
 v_accvgpr_write_b32 a182, v214
 v_accvgpr_write_b32 a183, v215
 v_cvt_pk_bf16_f32 v224, v224, v225
 v_cvt_pk_bf16_f32 v225, v226, v227
 v_cvt_pk_bf16_f32 v226, v232, v233
 v_cvt_pk_bf16_f32 v227, v234, v235
 v_accvgpr_write_b32 a152, v224
 v_accvgpr_write_b32 a153, v225
 v_accvgpr_write_b32 a154, v226
 v_accvgpr_write_b32 a155, v227
 v_cvt_pk_bf16_f32 v228, v228, v229
 v_cvt_pk_bf16_f32 v229, v230, v231
 v_cvt_pk_bf16_f32 v230, v236, v237
 v_cvt_pk_bf16_f32 v231, v238, v239
 v_accvgpr_write_b32 a184, v228
 v_accvgpr_write_b32 a185, v229
 v_accvgpr_write_b32 a186, v230
 v_accvgpr_write_b32 a187, v231
M v[128:131], a[64:67], v[40:43], 0
 s_add_u32 m0, s28, 0
 ds_read_b128 a[96:99], v2 offset:8192
 ds_read_b128 a[100:103], v2 offset:9216
M v[128:131], a[68:71], v[56:59], v[128:131]
 buffer_load_dwordx4 v3, s[8:11], s24 offen offset:0 sc1 lds
M v[132:135], a[68:71], v[60:63], 0
 v_cvt_pk_bf16_f32 v240, v240, v241
 v_cvt_pk_bf16_f32 v241, v242, v243
M v[132:135], a[64:67], v[44:47], v[132:135]
 ds_read_b128 a[104:107], v2 offset:10240
 ds_read_b128 a[108:111], v2 offset:11264
M v[140:143], a[72:75], v[44:47], 0
 buffer_load_dwordx4 v3, s[8:11], s24 offen offset:1024 sc1 lds
M v[140:143], a[76:79], v[60:63], v[140:143]
 v_cvt_pk_bf16_f32 v242, v248, v249
 v_cvt_pk_bf16_f32 v243, v250, v251
M v[136:139], a[76:79], v[56:59], 0
 ds_read_b128 a[112:115], v2 offset:12288
 ds_read_b128 a[116:119], v2 offset:13312
M v[136:139], a[72:75], v[40:43], v[136:139]
 buffer_load_dwordx4 v3, s[8:11], s24 offen offset:2048 sc1 lds
M v[144:147], a[80:83], v[40:43], 0
 v_accvgpr_write_b32 a156, v240
 v_accvgpr_write_b32 a157, v241
M v[144:147], a[84:87], v[56:59], v[144:147]
 ds_read_b128 a[120:123], v2 offset:14336
 ds_read_b128 a[124:127], v2 offset:15360
M v[148:151], a[84:87], v[60:63], 0
 buffer_load_dwordx4 v3, s[8:11], s24 offen offset:3072 sc1 lds
M v[148:151], a[80:83], v[44:47], v[148:151]
 s_add_u32 m0, s28, 4096
 v_accvgpr_write_b32 a158, v242
 v_accvgpr_write_b32 a159, v243
M v[156:159], a[88:91], v[44:47], 0
 buffer_load_dwordx4 v4, s[8:11], s24 offen offset:0 sc1 lds
M v[156:159], a[92:95], v[60:63], v[156:159]
 v_cvt_pk_bf16_f32 v244, v244, v245
 v_cvt_pk_bf16_f32 v245, v246, v247
M v[152:155], a[92:95], v[56:59], 0
 v_cvt_pk_bf16_f32 v246, v252, v253
 v_cvt_pk_bf16_f32 v247, v254, v255
M v[152:155], a[88:91], v[40:43], v[152:155]
 s_waitcnt lgkmcnt(0)
 v_accvgpr_write_b32 a188, v244
 v_accvgpr_write_b32 a189, v245
M v[160:163], a[96:99], v[40:43], 0
 ds_read_b128 a[64:67], v2 offset:16384
 ds_read_b128 a[68:71], v2 offset:17408
M v[160:163], a[100:103], v[56:59], v[160:163]
 buffer_load_dwordx4 v4, s[8:11], s24 offen offset:1024 sc1 lds
M v[164:167], a[100:103], v[60:63], 0
 v_accvgpr_write_b32 a190, v246
 v_accvgpr_write_b32 a191, v247
M v[164:167], a[96:99], v[44:47], v[164:167]
 ds_read_b128 a[72:75], v2 offset:18432
 ds_read_b128 a[76:79], v2 offset:19456
M v[172:175], a[104:107], v[44:47], 0
 buffer_load_dwordx4 v4, s[8:11], s24 offen offset:2048 sc1 lds
M v[172:175], a[108:111], v[60:63], v[172:175]
 v_exp_f32 v18, v96
M v[168:171], a[108:111], v[56:59], 0
 ds_read_b128 a[80:83], v2 offset:20480
 ds_read_b128 a[84:87], v2 offset:21504
M v[168:171], a[104:107], v[40:43], v[168:171]
 buffer_load_dwordx4 v4, s[8:11], s24 offen offset:3072 sc1 lds
M v[176:179], a[112:115], v[40:43], 0
 v_exp_f32 v19, v97
M v[176:179], a[116:119], v[56:59], v[176:179]
 s_add_u32 m0, s28, 32768
 ds_read_b128 a[88:91], v2 offset:22528
 ds_read_b128 a[92:95], v2 offset:23552
M v[180:183], a[116:119], v[60:63], 0
 buffer_load_dwordx4 v3, s[8:11], s21 offen offset:0 sc1 lds
M v[180:183], a[112:115], v[44:47], v[180:183]
 v_exp_f32 v20, v98
M v[188:191], a[120:123], v[44:47], 0
 buffer_load_dwordx4 v3, s[8:11], s21 offen offset:1024 sc1 lds
M v[188:191], a[124:127], v[60:63], v[188:191]
 v_exp_f32 v21, v99
M v[184:187], a[124:127], v[56:59], 0
 buffer_load_dwordx4 v3, s[8:11], s21 offen offset:2048 sc1 lds
M v[184:187], a[120:123], v[40:43], v[184:187]
 s_waitcnt lgkmcnt(0)
 v_exp_f32 v22, v104
M v[192:195], a[64:67], v[40:43], 0
 ds_read_b128 a[96:99], v2 offset:24576
 ds_read_b128 a[100:103], v2 offset:25600
M v[192:195], a[68:71], v[56:59], v[192:195]
 buffer_load_dwordx4 v3, s[8:11], s21 offen offset:3072 sc1 lds
M v[196:199], a[68:71], v[60:63], 0
 v_exp_f32 v23, v105
M v[196:199], a[64:67], v[44:47], v[196:199]
 s_add_u32 m0, s28, 36864
 ds_read_b128 a[104:107], v2 offset:26624
 ds_read_b128 a[108:111], v2 offset:27648
M v[204:207], a[72:75], v[44:47], 0
 buffer_load_dwordx4 v4, s[8:11], s21 offen offset:0 sc1 lds
M v[204:207], a[76:79], v[60:63], v[204:207]
 v_add_f32 v30, v26, v30
 v_add_f32 v31, v27, v31
M v[200:203], a[76:79], v[56:59], 0
 ds_read_b128 a[112:115], v2 offset:28672
 ds_read_b128 a[116:119], v2 offset:29696
M v[200:203], a[72:75], v[40:43], v[200:203]
 buffer_load_dwordx4 v4, s[8:11], s21 offen offset:1024 sc1 lds
M v[208:211], a[80:83], v[40:43], 0
 v_exp_f32 v24, v106
M v[208:211], a[84:87], v[56:59], v[208:211]
 ds_read_b128 a[120:123], v2 offset:30720
 ds_read_b128 a[124:127], v2 offset:31744
M v[212:215], a[84:87], v[60:63], 0
 buffer_load_dwordx4 v4, s[8:11], s21 offen offset:2048 sc1 lds
M v[212:215], a[80:83], v[44:47], v[212:215]
 v_exp_f32 v25, v107
M v[220:223], a[88:91], v[44:47], 0
 v_add_f32 v28, v18, v19
 v_cvt_pk_bf16_f32 v48, v18, v19
M v[220:223], a[92:95], v[60:63], v[220:223]
 buffer_load_dwordx4 v4, s[8:11], s21 offen offset:3072 sc1 lds
M v[216:219], a[92:95], v[56:59], 0
 s_waitcnt vmcnt(16) lgkmcnt(0)
 s_add_u32 s24, s23, 16777216
 s_mov_b32 s23, s21
M v[216:219], a[88:91], v[40:43], v[216:219]
 s_barrier
M v[224:227], a[96:99], v[40:43], 0
 ds_read_b128 a[64:67], v2 offset:32768
 ds_read_b128 a[68:71], v2 offset:33792
M v[224:227], a[100:103], v[56:59], v[224:227]
 s_add_u32 s21, s21, 32768
 v_add_f32 v28, v20, v28
M v[228:231], a[100:103], v[60:63], 0
 s_add_u32 s22, s22, 1
 v_exp_f32 v18, v100
M v[228:231], a[96:99], v[44:47], v[228:231]
 s_cmp_eq_u32 s22, s25
 ds_read_b128 a[72:75], v2 offset:34816
 ds_read_b128 a[76:79], v2 offset:35840
M v[236:239], a[104:107], v[44:47], 0
 s_cselect_b32 s21, s26, s21
 v_exp_f32 v19, v101
M v[236:239], a[108:111], v[60:63], v[236:239]
 s_cmp_eq_u32 s22, s43
 v_cvt_pk_bf16_f32 v49, v20, v21
 v_add_f32 v28, v21, v28
M v[232:235], a[108:111], v[56:59], 0
 s_cselect_b32 s21, s4, s21
 ds_read_b128 a[80:83], v2 offset:36864
 ds_read_b128 a[84:87], v2 offset:37888
M v[232:235], a[104:107], v[40:43], v[232:235]
 s_cmp_eq_u32 s22, s6
 v_exp_f32 v20, v102
M v[240:243], a[112:115], v[40:43], 0
 s_cselect_b32 s21, s7, s21
 v_exp_f32 v21, v103
M v[240:243], a[116:119], v[56:59], v[240:243]
 ds_read_b128 a[88:91], v2 offset:38912
 ds_read_b128 a[92:95], v2 offset:39936
M v[244:247], a[116:119], v[60:63], 0
 v_add_f32 v28, v22, v28
 v_cvt_pk_bf16_f32 v50, v22, v23
M v[244:247], a[112:115], v[44:47], v[244:247]
 v_add_f32 v28, v23, v28
 v_add_f32 v28, v24, v28
M v[252:255], a[120:123], v[44:47], 0
 v_exp_f32 v22, v108
M v[252:255], a[124:127], v[60:63], v[252:255]
 s_cmp_lg_u32 s27, 0
 v_exp_f32 v23, v109
M v[248:251], a[124:127], v[56:59], 0
 s_waitcnt lgkmcnt(0)
 v_cvt_pk_bf16_f32 v51, v24, v25
 v_add_f32 v28, v25, v28
M v[248:251], a[120:123], v[40:43], v[248:251]
 v_exp_f32 v24, v110
 v_add_f32 v29, v18, v19
 v_cvt_pk_bf16_f32 v52, v18, v19
 v_add_f32 v29, v20, v29
 v_cvt_pk_bf16_f32 v53, v20, v21
 v_add_f32 v29, v21, v29
 v_exp_f32 v25, v111
 v_add_f32 v29, v22, v29
 v_cvt_pk_bf16_f32 v54, v22, v23
 v_add_f32 v29, v23, v29
 v_add_f32 v29, v24, v29
 v_cvt_pk_bf16_f32 v55, v24, v25
 v_add_f32 v29, v25, v29
 s_cbranch_scc1 L_loop_top
L_final_h:
 s_waitcnt vmcnt(8)
 s_barrier
 ds_read_b128 a[64:67], v7 offset:0
 ds_read_b128 a[68:71], v7 offset:1024
 ds_read_b128 a[72:75], v7 offset:2048
 ds_read_b128 a[76:79], v7 offset:3072
 ds_read_b128 a[80:83], v7 offset:4096
 ds_read_b128 a[84:87], v7 offset:5120
 ds_read_b128 a[88:91], v7 offset:6144
 ds_read_b128 a[92:95], v7 offset:7168
 s_add_u32 m0, s28, 65536
 v_exp_f32 v18, v112
 buffer_load_dwordx4 v3, s[8:11], s38 offen offset:0 sc1 lds
 v_exp_f32 v19, v113
 v_exp_f32 v20, v114
 v_add_f32 v28, v18, v28
 v_cvt_pk_bf16_f32 v56, v18, v19
 buffer_load_dwordx4 v3, s[8:11], s38 offen offset:1024 sc1 lds
 v_exp_f32 v21, v115
 v_add_f32 v28, v19, v28
 v_exp_f32 v22, v120
 v_add_f32 v28, v20, v28
 v_cvt_pk_bf16_f32 v57, v20, v21
 buffer_load_dwordx4 v3, s[8:11], s38 offen offset:2048 sc1 lds
 v_exp_f32 v23, v121
 v_add_f32 v28, v21, v28
 v_exp_f32 v24, v122
 v_add_f32 v28, v22, v28
 v_cvt_pk_bf16_f32 v58, v22, v23
 buffer_load_dwordx4 v3, s[8:11], s38 offen offset:3072 sc1 lds
 v_exp_f32 v25, v123
 v_add_f32 v28, v23, v28
 v_exp_f32 v18, v116
 v_add_f32 v28, v24, v28
 s_add_u32 m0, s28, 69632
 v_cvt_pk_bf16_f32 v59, v24, v25
 buffer_load_dwordx4 v4, s[8:11], s38 offen offset:0 sc1 lds
 v_exp_f32 v19, v117
 v_add_f32 v28, v25, v28
 v_exp_f32 v20, v118
 v_add_f32 v29, v18, v29
 v_cvt_pk_bf16_f32 v60, v18, v19
 buffer_load_dwordx4 v4, s[8:11], s38 offen offset:1024 sc1 lds
 v_exp_f32 v21, v119
 v_add_f32 v29, v19, v29
 v_exp_f32 v22, v124
 v_add_f32 v29, v20, v29
 v_cvt_pk_bf16_f32 v61, v20, v21
 buffer_load_dwordx4 v4, s[8:11], s38 offen offset:2048 sc1 lds
 v_exp_f32 v23, v125
 v_add_f32 v29, v21, v29
 v_exp_f32 v24, v126
 v_add_f32 v29, v22, v29
 v_cvt_pk_bf16_f32 v62, v22, v23
 buffer_load_dwordx4 v4, s[8:11], s38 offen offset:3072 sc1 lds
 s_add_u32 s38, s38, 32768
 v_exp_f32 v25, v127
 v_add_f32 v29, v23, v29
 v_add_f32 v29, v24, v29
 v_cvt_pk_bf16_f32 v63, v24, v25
 v_add_f32 v29, v25, v29
 v_max_f32 v10, v28, v29
 v_cmp_lt_f32 vcc, s31, v10
 s_nop 0
 s_cbranch_vccnz L_st4
L_rt4:
 v_add_f32 v30, v28, v30
 v_add_f32 v31, v29, v31
 v_mov_b32 v12, v32
 v_mov_b32 v13, v36
 v_mov_b32 v14, v30
 v_mov_b32 v15, v31
 buffer_store_dwordx4 v[12:15], v7, s[8:11], s52 offen sc1
 s_waitcnt lgkmcnt(0)
M v[128:131], a[64:67], v[48:51], v[128:131]
 ds_read_b128 a[96:99], v7 offset:8192
M v[128:131], a[68:71], v[56:59], v[128:131]
 ds_read_b128 a[100:103], v7 offset:9216
M v[132:135], a[68:71], v[60:63], v[132:135]
M v[132:135], a[64:67], v[52:55], v[132:135]
 ds_read_b128 a[104:107], v7 offset:10240
M v[140:143], a[72:75], v[52:55], v[140:143]
 ds_read_b128 a[108:111], v7 offset:11264
M v[140:143], a[76:79], v[60:63], v[140:143]
M v[136:139], a[76:79], v[56:59], v[136:139]
 ds_read_b128 a[112:115], v7 offset:12288
M v[136:139], a[72:75], v[48:51], v[136:139]
 ds_read_b128 a[116:119], v7 offset:13312
M v[144:147], a[80:83], v[48:51], v[144:147]
M v[144:147], a[84:87], v[56:59], v[144:147]
 ds_read_b128 a[120:123], v7 offset:14336
M v[148:151], a[84:87], v[60:63], v[148:151]
 ds_read_b128 a[124:127], v7 offset:15360
M v[148:151], a[80:83], v[52:55], v[148:151]
 v_cvt_pk_bf16_f32 v128, v128, v129
 v_cvt_pk_bf16_f32 v129, v130, v131
M v[156:159], a[88:91], v[52:55], v[156:159]
 v_cvt_pk_bf16_f32 v130, v136, v137
 v_cvt_pk_bf16_f32 v131, v138, v139
M v[156:159], a[92:95], v[60:63], v[156:159]
 buffer_store_dwordx4 v[128:131], v7, s[8:11], s12 offen offset:0 sc1
M v[152:155], a[92:95], v[56:59], v[152:155]
 v_cvt_pk_bf16_f32 v132, v132, v133
 v_cvt_pk_bf16_f32 v133, v134, v135
M v[152:155], a[88:91], v[48:51], v[152:155]
 s_waitcnt lgkmcnt(0)
 v_cvt_pk_bf16_f32 v134, v140, v141
 v_cvt_pk_bf16_f32 v135, v142, v143
M v[160:163], a[96:99], v[48:51], v[160:163]
 ds_read_b128 a[64:67], v7 offset:16384
M v[160:163], a[100:103], v[56:59], v[160:163]
 ds_read_b128 a[68:71], v7 offset:17408
M v[164:167], a[100:103], v[60:63], v[164:167]
 buffer_store_dwordx4 v[132:135], v7, s[8:11], s14 offen offset:0 sc1
M v[164:167], a[96:99], v[52:55], v[164:167]
 ds_read_b128 a[72:75], v7 offset:18432
 v_cvt_pk_bf16_f32 v144, v144, v145
M v[172:175], a[104:107], v[52:55], v[172:175]
 ds_read_b128 a[76:79], v7 offset:19456
 v_cvt_pk_bf16_f32 v145, v146, v147
M v[172:175], a[108:111], v[60:63], v[172:175]
 v_cvt_pk_bf16_f32 v146, v152, v153
 v_cvt_pk_bf16_f32 v147, v154, v155
M v[168:171], a[108:111], v[56:59], v[168:171]
 ds_read_b128 a[80:83], v7 offset:20480
M v[168:171], a[104:107], v[48:51], v[168:171]
 ds_read_b128 a[84:87], v7 offset:21504
M v[176:179], a[112:115], v[48:51], v[176:179]
 buffer_store_dwordx4 v[144:147], v7, s[8:11], s12 offen offset:1024 sc1
M v[176:179], a[116:119], v[56:59], v[176:179]
 ds_read_b128 a[88:91], v7 offset:22528
 v_cvt_pk_bf16_f32 v148, v148, v149
M v[180:183], a[116:119], v[60:63], v[180:183]
 ds_read_b128 a[92:95], v7 offset:23552
 v_cvt_pk_bf16_f32 v149, v150, v151
M v[180:183], a[112:115], v[52:55], v[180:183]
 v_cvt_pk_bf16_f32 v150, v156, v157
 v_cvt_pk_bf16_f32 v151, v158, v159
M v[188:191], a[120:123], v[52:55], v[188:191]
 buffer_store_dwordx4 v[148:151], v7, s[8:11], s14 offen offset:1024 sc1
M v[188:191], a[124:127], v[60:63], v[188:191]
 v_cvt_pk_bf16_f32 v160, v160, v161
 v_cvt_pk_bf16_f32 v161, v162, v163
M v[184:187], a[124:127], v[56:59], v[184:187]
 v_cvt_pk_bf16_f32 v162, v168, v169
 v_cvt_pk_bf16_f32 v163, v170, v171
M v[184:187], a[120:123], v[48:51], v[184:187]
 s_waitcnt lgkmcnt(0)
M v[192:195], a[64:67], v[48:51], v[192:195]
 ds_read_b128 a[96:99], v7 offset:24576
M v[192:195], a[68:71], v[56:59], v[192:195]
 ds_read_b128 a[100:103], v7 offset:25600
M v[196:199], a[68:71], v[60:63], v[196:199]
 buffer_store_dwordx4 v[160:163], v7, s[8:11], s12 offen offset:2048 sc1
M v[196:199], a[64:67], v[52:55], v[196:199]
 ds_read_b128 a[104:107], v7 offset:26624
 v_cvt_pk_bf16_f32 v164, v164, v165
M v[204:207], a[72:75], v[52:55], v[204:207]
 ds_read_b128 a[108:111], v7 offset:27648
 v_cvt_pk_bf16_f32 v165, v166, v167
M v[204:207], a[76:79], v[60:63], v[204:207]
 v_cvt_pk_bf16_f32 v166, v172, v173
 v_cvt_pk_bf16_f32 v167, v174, v175
M v[200:203], a[76:79], v[56:59], v[200:203]
 ds_read_b128 a[112:115], v7 offset:28672
M v[200:203], a[72:75], v[48:51], v[200:203]
 ds_read_b128 a[116:119], v7 offset:29696
M v[208:211], a[80:83], v[48:51], v[208:211]
 buffer_store_dwordx4 v[164:167], v7, s[8:11], s14 offen offset:2048 sc1
M v[208:211], a[84:87], v[56:59], v[208:211]
 ds_read_b128 a[120:123], v7 offset:30720
 v_cvt_pk_bf16_f32 v176, v176, v177
M v[212:215], a[84:87], v[60:63], v[212:215]
 ds_read_b128 a[124:127], v7 offset:31744
 v_cvt_pk_bf16_f32 v177, v178, v179
M v[212:215], a[80:83], v[52:55], v[212:215]
 v_cvt_pk_bf16_f32 v178, v184, v185
 v_cvt_pk_bf16_f32 v179, v186, v187
M v[220:223], a[88:91], v[52:55], v[220:223]
 buffer_store_dwordx4 v[176:179], v7, s[8:11], s12 offen offset:3072 sc1
M v[220:223], a[92:95], v[60:63], v[220:223]
 v_cvt_pk_bf16_f32 v180, v180, v181
 v_cvt_pk_bf16_f32 v181, v182, v183
M v[216:219], a[92:95], v[56:59], v[216:219]
 s_waitcnt lgkmcnt(0)
 v_cvt_pk_bf16_f32 v182, v188, v189
 v_cvt_pk_bf16_f32 v183, v190, v191
M v[216:219], a[88:91], v[48:51], v[216:219]
 s_barrier
M v[224:227], a[96:99], v[48:51], v[224:227]
 ds_read_b128 a[64:67], v2 offset:32768
M v[224:227], a[100:103], v[56:59], v[224:227]
 ds_read_b128 a[68:71], v2 offset:33792
M v[228:231], a[100:103], v[60:63], v[228:231]
 buffer_store_dwordx4 v[180:183], v7, s[8:11], s14 offen offset:3072 sc1
M v[228:231], a[96:99], v[52:55], v[228:231]
 ds_read_b128 a[72:75], v2 offset:34816
 v_cvt_pk_bf16_f32 v192, v192, v193
M v[236:239], a[104:107], v[52:55], v[236:239]
 ds_read_b128 a[76:79], v2 offset:35840
 v_cvt_pk_bf16_f32 v193, v194, v195
M v[236:239], a[108:111], v[60:63], v[236:239]
 v_cvt_pk_bf16_f32 v194, v200, v201
 v_cvt_pk_bf16_f32 v195, v202, v203
M v[232:235], a[108:111], v[56:59], v[232:235]
 ds_read_b128 a[80:83], v2 offset:36864
M v[232:235], a[104:107], v[48:51], v[232:235]
 ds_read_b128 a[84:87], v2 offset:37888
M v[240:243], a[112:115], v[48:51], v[240:243]
 buffer_store_dwordx4 v[192:195], v7, s[8:11], s13 offen offset:0 sc1
M v[240:243], a[116:119], v[56:59], v[240:243]
 ds_read_b128 a[88:91], v2 offset:38912
 v_cvt_pk_bf16_f32 v196, v196, v197
M v[244:247], a[116:119], v[60:63], v[244:247]
 ds_read_b128 a[92:95], v2 offset:39936
 v_cvt_pk_bf16_f32 v197, v198, v199
M v[244:247], a[112:115], v[52:55], v[244:247]
 v_cvt_pk_bf16_f32 v198, v204, v205
 v_cvt_pk_bf16_f32 v199, v206, v207
M v[252:255], a[120:123], v[52:55], v[252:255]
 buffer_store_dwordx4 v[196:199], v7, s[8:11], s15 offen offset:0 sc1
M v[252:255], a[124:127], v[60:63], v[252:255]
 v_cvt_pk_bf16_f32 v208, v208, v209
 v_cvt_pk_bf16_f32 v209, v210, v211
M v[248:251], a[124:127], v[56:59], v[248:251]
 s_waitcnt lgkmcnt(0)
 v_cvt_pk_bf16_f32 v210, v216, v217
 v_cvt_pk_bf16_f32 v211, v218, v219
M v[248:251], a[120:123], v[48:51], v[248:251]
 buffer_store_dwordx4 v[208:211], v7, s[8:11], s13 offen offset:1024 sc1
 v_cvt_pk_bf16_f32 v212, v212, v213
 v_cvt_pk_bf16_f32 v213, v214, v215
 v_cvt_pk_bf16_f32 v214, v220, v221
 v_cvt_pk_bf16_f32 v215, v222, v223
 buffer_store_dwordx4 v[212:215], v7, s[8:11], s15 offen offset:1024 sc1
 v_cvt_pk_bf16_f32 v224, v224, v225
 v_cvt_pk_bf16_f32 v225, v226, v227
 v_cvt_pk_bf16_f32 v226, v232, v233
 v_cvt_pk_bf16_f32 v227, v234, v235
 buffer_store_dwordx4 v[224:227], v7, s[8:11], s13 offen offset:2048 sc1
 v_cvt_pk_bf16_f32 v228, v228, v229
 v_cvt_pk_bf16_f32 v229, v230, v231
 v_cvt_pk_bf16_f32 v230, v236, v237
 v_cvt_pk_bf16_f32 v231, v238, v239
 buffer_store_dwordx4 v[228:231], v7, s[8:11], s15 offen offset:2048 sc1
 v_cvt_pk_bf16_f32 v240, v240, v241
 v_cvt_pk_bf16_f32 v241, v242, v243
 v_cvt_pk_bf16_f32 v242, v248, v249
 v_cvt_pk_bf16_f32 v243, v250, v251
 buffer_store_dwordx4 v[240:243], v7, s[8:11], s13 offen offset:3072 sc1
 v_cvt_pk_bf16_f32 v244, v244, v245
 v_cvt_pk_bf16_f32 v245, v246, v247
 v_cvt_pk_bf16_f32 v246, v252, v253
 v_cvt_pk_bf16_f32 v247, v254, v255
 buffer_store_dwordx4 v[244:247], v7, s[8:11], s15 offen offset:3072 sc1
M v[64:67], a[64:67], a[128:131], 0
 ds_read_b128 a[96:99], v2 offset:40960
M v[64:67], a[68:71], a[132:135], v[64:67]
 s_add_u32 m0, s28, 0
 ds_read_b128 a[100:103], v2 offset:41984
M v[64:67], a[72:75], a[136:139], v[64:67]
 buffer_load_dwordx4 v3, s[8:11], s38 offen offset:0 sc1 lds
M v[64:67], a[76:79], a[140:143], v[64:67]
 ds_read_b128 a[104:107], v2 offset:43008
 v_accvgpr_read_b32 v5, a192
M v[64:67], a[80:83], a[144:147], v[64:67]
 ds_read_b128 a[108:111], v2 offset:44032
 v_accvgpr_read_b32 v6, a193
M v[64:67], a[84:87], a[148:151], v[64:67]
 buffer_load_dwordx4 v3, s[8:11], s38 offen offset:1024 sc1 lds
M v[64:67], a[88:91], a[152:155], v[64:67]
 ds_read_b128 a[112:115], v2 offset:45056
M v[64:67], a[92:95], a[156:159], v[64:67]
 ds_read_b128 a[116:119], v2 offset:46080
M v[68:71], a[92:95], a[188:191], 0
 buffer_load_dwordx4 v3, s[8:11], s38 offen offset:2048 sc1 lds
M v[68:71], a[88:91], a[184:187], v[68:71]
 ds_read_b128 a[120:123], v2 offset:47104
M v[68:71], a[84:87], a[180:183], v[68:71]
 ds_read_b128 a[124:127], v2 offset:48128
M v[68:71], a[80:83], a[176:179], v[68:71]
M v[68:71], a[76:79], a[172:175], v[68:71]
 buffer_load_dwordx4 v3, s[8:11], s38 offen offset:3072 sc1 lds
M v[68:71], a[72:75], a[168:171], v[68:71]
M v[68:71], a[68:71], a[164:167], v[68:71]
M v[68:71], a[64:67], a[160:163], v[68:71]
 s_waitcnt lgkmcnt(0)
M v[76:79], a[96:99], a[160:163], 0
 ds_read_b128 a[64:67], v2 offset:49152
M v[76:79], a[100:103], a[164:167], v[76:79]
 s_add_u32 m0, s28, 4096
 ds_read_b128 a[68:71], v2 offset:50176
M v[76:79], a[104:107], a[168:171], v[76:79]
 buffer_load_dwordx4 v4, s[8:11], s38 offen offset:0 sc1 lds
M v[76:79], a[108:111], a[172:175], v[76:79]
 ds_read_b128 a[72:75], v2 offset:51200
M v[76:79], a[112:115], a[176:179], v[76:79]
 s_xor_b32 s47, s47, 64
 ds_read_b128 a[76:79], v2 offset:52224
M v[76:79], a[116:119], a[180:183], v[76:79]
 v_mov_b32 v18, 1
 v_min_u32 v19, 1, v7
M v[76:79], a[120:123], a[184:187], v[76:79]
 ds_read_b128 a[80:83], v2 offset:53248
 v_lshlrev_b32 v19, 29, v19
M v[76:79], a[124:127], a[188:191], v[76:79]
 s_waitcnt vmcnt(5)
 ds_read_b128 a[84:87], v2 offset:54272
M v[72:75], a[124:127], a[156:159], 0
 buffer_store_dword v18, v19, s[8:11], s47 offen sc1
M v[72:75], a[120:123], a[152:155], v[72:75]
 ds_read_b128 a[88:91], v2 offset:55296
M v[72:75], a[116:119], a[148:151], v[72:75]
 ds_read_b128 a[92:95], v2 offset:56320
M v[72:75], a[112:115], a[144:147], v[72:75]
 buffer_load_dwordx4 v4, s[8:11], s38 offen offset:1024 sc1 lds
M v[72:75], a[108:111], a[140:143], v[72:75]
M v[72:75], a[104:107], a[136:139], v[72:75]
 buffer_load_dwordx4 v4, s[8:11], s38 offen offset:2048 sc1 lds
M v[72:75], a[100:103], a[132:135], v[72:75]
M v[72:75], a[96:99], a[128:131], v[72:75]
 s_waitcnt lgkmcnt(0)
M v[80:83], a[64:67], a[128:131], 0
 ds_read_b128 a[96:99], v2 offset:57344
M v[80:83], a[68:71], a[132:135], v[80:83]
 ds_read_b128 a[100:103], v2 offset:58368
M v[80:83], a[72:75], a[136:139], v[80:83]
 buffer_load_dwordx4 v4, s[8:11], s38 offen offset:3072 sc1 lds
M v[80:83], a[76:79], a[140:143], v[80:83]
 s_add_u32 s38, s38, 32768
 ds_read_b128 a[104:107], v2 offset:59392
M v[80:83], a[80:83], a[144:147], v[80:83]
 s_add_u32 m0, s28, 131072
 ds_read_b128 a[108:111], v2 offset:60416
 v_max3_f32 v32, |v64|, |v65|, |v66|
M v[80:83], a[84:87], a[148:151], v[80:83]
 buffer_load_dwordx4 v3, s[8:11], s38 offen offset:0 sc1 lds
M v[80:83], a[88:91], a[152:155], v[80:83]
 ds_read_b128 a[112:115], v2 offset:61440
M v[80:83], a[92:95], a[156:159], v[80:83]
 ds_read_b128 a[116:119], v2 offset:62464
 v_max3_f32 v32, |v67|, |v72|, v32
M v[84:87], a[92:95], a[188:191], 0
 buffer_load_dwordx4 v3, s[8:11], s38 offen offset:1024 sc1 lds
M v[84:87], a[88:91], a[184:187], v[84:87]
 ds_read_b128 a[120:123], v2 offset:63488
M v[84:87], a[84:87], a[180:183], v[84:87]
 ds_read_b128 a[124:127], v2 offset:64512
 v_max3_f32 v32, |v73|, |v74|, v32
M v[84:87], a[80:83], a[176:179], v[84:87]
 buffer_load_dwordx4 v3, s[8:11], s38 offen offset:2048 sc1 lds
M v[84:87], a[76:79], a[172:175], v[84:87]
 v_mul_f32 v32, 2.0, v32
 v_mov_b32 v33, v32
M v[84:87], a[72:75], a[168:171], v[84:87]
 buffer_load_dwordx4 v3, s[8:11], s38 offen offset:3072 sc1 lds
M v[84:87], a[68:71], a[164:167], v[84:87]
 s_waitcnt lgkmcnt(0)
 v_mov_b32 v34, v32
M v[84:87], a[64:67], a[160:163], v[84:87]
 s_barrier
M v[92:95], a[96:99], a[160:163], 0
 ds_read_b128 a[64:67], v7 offset:32768
 v_mov_b32 v35, v32
M v[92:95], a[100:103], a[164:167], v[92:95]
 s_add_u32 m0, s28, 135168
 ds_read_b128 a[68:71], v7 offset:33792
M v[92:95], a[104:107], a[168:171], v[92:95]
 buffer_load_dwordx4 v4, s[8:11], s38 offen offset:0 sc1 lds
M v[92:95], a[108:111], a[172:175], v[92:95]
 ds_read_b128 a[72:75], v7 offset:34816
 v_max3_f32 v36, |v68|, |v69|, |v70|
M v[92:95], a[112:115], a[176:179], v[92:95]
 ds_read_b128 a[76:79], v7 offset:35840
M v[92:95], a[116:119], a[180:183], v[92:95]
 buffer_load_dwordx4 v4, s[8:11], s38 offen offset:1024 sc1 lds
M v[92:95], a[120:123], a[184:187], v[92:95]
 ds_read_b128 a[80:83], v7 offset:36864
 v_max3_f32 v36, |v71|, |v76|, v36
M v[92:95], a[124:127], a[188:191], v[92:95]
 ds_read_b128 a[84:87], v7 offset:37888
 v_max3_f32 v36, |v77|, |v78|, v36
M v[88:91], a[124:127], a[156:159], 0
 buffer_load_dwordx4 v4, s[8:11], s38 offen offset:2048 sc1 lds
M v[88:91], a[120:123], a[152:155], v[88:91]
 ds_read_b128 a[88:91], v7 offset:38912
M v[88:91], a[116:119], a[148:151], v[88:91]
 ds_read_b128 a[92:95], v7 offset:39936
 v_mul_f32 v36, 2.0, v36
M v[88:91], a[112:115], a[144:147], v[88:91]
 buffer_load_dwordx4 v4, s[8:11], s38 offen offset:3072 sc1 lds
M v[88:91], a[108:111], a[140:143], v[88:91]
 s_add_u32 s38, s38, 32768
 v_mov_b32 v37, v36
M v[88:91], a[104:107], a[136:139], v[88:91]
 v_mov_b32 v38, v36
 v_mov_b32 v39, v36
M v[88:91], a[100:103], a[132:135], v[88:91]
 s_waitcnt lgkmcnt(0)
M v[88:91], a[96:99], a[128:131], v[88:91]
M v[96:99], a[64:67], a[128:131], v[32:35]
 s_add_u32 m0, s28, 98304
 ds_read_b128 a[96:99], v7 offset:40960
M v[96:99], a[68:71], a[132:135], v[96:99]
 ds_read_b128 a[100:103], v7 offset:41984
M v[96:99], a[72:75], a[136:139], v[96:99]
 buffer_load_dwordx4 v3, s[8:11], s38 offen offset:0 sc1 lds
M v[96:99], a[76:79], a[140:143], v[96:99]
 ds_read_b128 a[104:107], v7 offset:43008
 s_add_u32 s29, s33, 0
M v[96:99], a[80:83], a[144:147], v[96:99]
 ds_read_b128 a[108:111], v7 offset:44032
 s_add_u32 s30, s33, 14336
M v[96:99], a[84:87], a[148:151], v[96:99]
 buffer_load_dwordx4 v3, s[8:11], s38 offen offset:1024 sc1 lds
M v[96:99], a[88:91], a[152:155], v[96:99]
 ds_read_b128 a[112:115], v7 offset:45056
 v_mul_f32 v28, -v32, v5
M v[96:99], a[92:95], a[156:159], v[96:99]
 ds_read_b128 a[116:119], v7 offset:46080
 v_mul_f32 v64, v5, v64
M v[100:103], a[92:95], a[188:191], v[36:39]
 buffer_load_dwordx4 v3, s[8:11], s38 offen offset:2048 sc1 lds
M v[100:103], a[88:91], a[184:187], v[100:103]
 ds_read_b128 a[120:123], v7 offset:47104
 v_mul_f32 v65, v5, v65
M v[100:103], a[84:87], a[180:183], v[100:103]
 ds_read_b128 a[124:127], v7 offset:48128
 v_mul_f32 v66, v5, v66
M v[100:103], a[80:83], a[176:179], v[100:103]
 buffer_load_dwordx4 v3, s[8:11], s38 offen offset:3072 sc1 lds
M v[100:103], a[76:79], a[172:175], v[100:103]
 s_add_u32 m0, s28, 102400
 v_mul_f32 v67, v5, v67
 v_mul_f32 v72, v5, v72
M v[100:103], a[72:75], a[168:171], v[100:103]
 buffer_load_dwordx4 v4, s[8:11], s38 offen offset:0 sc1 lds
M v[100:103], a[68:71], a[164:167], v[100:103]
 v_mul_f32 v73, v5, v73
 v_mul_f32 v74, v5, v74
M v[100:103], a[64:67], a[160:163], v[100:103]
 s_waitcnt lgkmcnt(0)
 v_mul_f32 v75, v5, v75
 v_cvt_pk_bf16_f32 v64, v64, v65
M v[108:111], a[96:99], a[160:163], v[36:39]
 ds_read_b128 a[64:67], v7 offset:49152
 v_cvt_pk_bf16_f32 v65, v66, v67
M v[108:111], a[100:103], a[164:167], v[108:111]
 ds_read_b128 a[68:71], v7 offset:50176
 v_cvt_pk_bf16_f32 v66, v72, v73
M v[108:111], a[104:107], a[168:171], v[108:111]
 buffer_load_dwordx4 v4, s[8:11], s38 offen offset:1024 sc1 lds
M v[108:111], a[108:111], a[172:175], v[108:111]
 ds_read_b128 a[72:75], v7 offset:51200
 v_cvt_pk_bf16_f32 v67, v74, v75
M v[108:111], a[112:115], a[176:179], v[108:111]
 ds_read_b128 a[76:79], v7 offset:52224
M v[108:111], a[116:119], a[180:183], v[108:111]
 buffer_load_dwordx4 v4, s[8:11], s38 offen offset:2048 sc1 lds
M v[108:111], a[120:123], a[184:187], v[108:111]
 ds_read_b128 a[80:83], v7 offset:53248
M v[108:111], a[124:127], a[188:191], v[108:111]
 ds_read_b128 a[84:87], v7 offset:54272
M v[104:107], a[124:127], a[156:159], v[32:35]
 buffer_load_dwordx4 v4, s[8:11], s38 offen offset:3072 sc1 lds
M v[104:107], a[120:123], a[152:155], v[104:107]
 s_add_u32 s38, s38, 32768
 ds_read_b128 a[88:91], v7 offset:55296
M v[104:107], a[116:119], a[148:151], v[104:107]
 ds_read_b128 a[92:95], v7 offset:56320
M v[104:107], a[112:115], a[144:147], v[104:107]
 buffer_store_dwordx4 v[64:67], v7, s[8:11], s29 offen offset:0 sc1
M v[104:107], a[108:111], a[140:143], v[104:107]
 v_mul_f32 v29, -v36, v6
 v_mul_f32 v68, v6, v68
M v[104:107], a[104:107], a[136:139], v[104:107]
 v_mul_f32 v69, v6, v69
 v_mul_f32 v70, v6, v70
M v[104:107], a[100:103], a[132:135], v[104:107]
 v_mul_f32 v71, v6, v71
 v_mul_f32 v76, v6, v76
M v[104:107], a[96:99], a[128:131], v[104:107]
 s_waitcnt lgkmcnt(0)
 v_mul_f32 v77, v6, v77
 v_mul_f32 v78, v6, v78
M v[112:115], a[64:67], a[128:131], v[32:35]
 ds_read_b128 a[96:99], v7 offset:57344
 v_mul_f32 v79, v6, v79
M v[112:115], a[68:71], a[132:135], v[112:115]
 ds_read_b128 a[100:103], v7 offset:58368
 v_cvt_pk_bf16_f32 v68, v68, v69
M v[112:115], a[72:75], a[136:139], v[112:115]
 v_cvt_pk_bf16_f32 v69, v70, v71
 v_cvt_pk_bf16_f32 v70, v76, v77
M v[112:115], a[76:79], a[140:143], v[112:115]
 ds_read_b128 a[104:107], v7 offset:59392
 v_cvt_pk_bf16_f32 v71, v78, v79
M v[112:115], a[80:83], a[144:147], v[112:115]
 ds_read_b128 a[108:111], v7 offset:60416
M v[112:115], a[84:87], a[148:151], v[112:115]
 buffer_store_dwordx4 v[68:71], v7, s[8:11], s30 offen offset:0 sc1
M v[112:115], a[88:91], a[152:155], v[112:115]
 ds_read_b128 a[112:115], v7 offset:61440
 v_mul_f32 v80, v5, v80
M v[112:115], a[92:95], a[156:159], v[112:115]
 ds_read_b128 a[116:119], v7 offset:62464
 v_mul_f32 v81, v5, v81
M v[116:119], a[92:95], a[188:191], v[36:39]
 v_mul_f32 v82, v5, v82
 v_mul_f32 v83, v5, v83
M v[116:119], a[88:91], a[184:187], v[116:119]
 ds_read_b128 a[120:123], v7 offset:63488
 v_mul_f32 v88, v5, v88
M v[116:119], a[84:87], a[180:183], v[116:119]
 ds_read_b128 a[124:127], v7 offset:64512
 v_mul_f32 v89, v5, v89
M v[116:119], a[80:83], a[176:179], v[116:119]
 v_mul_f32 v90, v5, v90
 v_mul_f32 v91, v5, v91
M v[116:119], a[76:79], a[172:175], v[116:119]
 v_cvt_pk_bf16_f32 v80, v80, v81
 v_cvt_pk_bf16_f32 v81, v82, v83
M v[116:119], a[72:75], a[168:171], v[116:119]
 v_cvt_pk_bf16_f32 v82, v88, v89
 v_cvt_pk_bf16_f32 v83, v90, v91
M v[116:119], a[68:71], a[164:167], v[116:119]
 s_waitcnt lgkmcnt(0)
M v[116:119], a[64:67], a[160:163], v[116:119]
 s_barrier
M v[124:127], a[96:99], a[160:163], v[36:39]
 ds_read_b128 a[64:67], v2 offset:0
M v[124:127], a[100:103], a[164:167], v[124:127]
 ds_read_b128 a[68:71], v2 offset:1024
M v[124:127], a[104:107], a[168:171], v[124:127]
 buffer_store_dwordx4 v[80:83], v7, s[8:11], s29 offen offset:1024 sc1
M v[124:127], a[108:111], a[172:175], v[124:127]
 ds_read_b128 a[72:75], v2 offset:2048
 v_mul_f32 v84, v6, v84
M v[124:127], a[112:115], a[176:179], v[124:127]
 ds_read_b128 a[76:79], v2 offset:3072
 v_mul_f32 v85, v6, v85
M v[124:127], a[116:119], a[180:183], v[124:127]
 v_mul_f32 v86, v6, v86
 v_mul_f32 v87, v6, v87
M v[124:127], a[120:123], a[184:187], v[124:127]
 ds_read_b128 a[80:83], v2 offset:4096
 v_mul_f32 v92, v6, v92
M v[124:127], a[124:127], a[188:191], v[124:127]
 ds_read_b128 a[84:87], v2 offset:5120
 v_mul_f32 v93, v6, v93
M v[120:123], a[124:127], a[156:159], v[32:35]
 v_mul_f32 v94, v6, v94
 v_mul_f32 v95, v6, v95
M v[120:123], a[120:123], a[152:155], v[120:123]
 ds_read_b128 a[88:91], v2 offset:6144
 v_cvt_pk_bf16_f32 v84, v84, v85
M v[120:123], a[116:119], a[148:151], v[120:123]
 ds_read_b128 a[92:95], v2 offset:7168
 v_cvt_pk_bf16_f32 v85, v86, v87
M v[120:123], a[112:115], a[144:147], v[120:123]
 v_cvt_pk_bf16_f32 v86, v92, v93
 v_cvt_pk_bf16_f32 v87, v94, v95
M v[120:123], a[108:111], a[140:143], v[120:123]
 buffer_store_dwordx4 v[84:87], v7, s[8:11], s30 offen offset:1024 sc1
M v[120:123], a[104:107], a[136:139], v[120:123]
M v[120:123], a[100:103], a[132:135], v[120:123]
 s_waitcnt lgkmcnt(0)
M v[120:123], a[96:99], a[128:131], v[120:123]
M v[64:67], a[64:67], a[128:131], v[32:35]
 s_add_u32 m0, s28, 32768
 ds_read_b128 a[96:99], v2 offset:8192
M v[64:67], a[68:71], a[132:135], v[64:67]
 ds_read_b128 a[100:103], v2 offset:9216
 s_mov_b32 s79, 104923136
M v[64:67], a[72:75], a[136:139], v[64:67]
 buffer_load_dwordx4 v3, s[8:11], s38 offen offset:0 sc1 lds
M v[64:67], a[76:79], a[140:143], v[64:67]
 ds_read_b128 a[104:107], v2 offset:10240
 s_add_u32 s29, s33, 2048
M v[64:67], a[80:83], a[144:147], v[64:67]
 ds_read_b128 a[108:111], v2 offset:11264
 s_add_u32 s30, s33, 16384
M v[64:67], a[84:87], a[148:151], v[64:67]
 buffer_load_dwordx4 v3, s[8:11], s38 offen offset:1024 sc1 lds
M v[64:67], a[88:91], a[152:155], v[64:67]
 ds_read_b128 a[112:115], v2 offset:12288
 v_fma_f32 v96, v96, v5, v28
M v[64:67], a[92:95], a[156:159], v[64:67]
 ds_read_b128 a[116:119], v2 offset:13312
 v_fma_f32 v97, v97, v5, v28
M v[68:71], a[92:95], a[188:191], v[36:39]
 buffer_load_dwordx4 v3, s[8:11], s38 offen offset:2048 sc1 lds
M v[68:71], a[88:91], a[184:187], v[68:71]
 ds_read_b128 a[120:123], v2 offset:14336
 v_fma_f32 v98, v98, v5, v28
M v[68:71], a[84:87], a[180:183], v[68:71]
 ds_read_b128 a[124:127], v2 offset:15360
 v_fma_f32 v99, v99, v5, v28
M v[68:71], a[80:83], a[176:179], v[68:71]
 buffer_load_dwordx4 v3, s[8:11], s38 offen offset:3072 sc1 lds
M v[68:71], a[76:79], a[172:175], v[68:71]
 s_add_u32 m0, s28, 36864
 v_fma_f32 v104, v104, v5, v28
 v_fma_f32 v105, v105, v5, v28
M v[68:71], a[72:75], a[168:171], v[68:71]
 buffer_load_dwordx4 v4, s[8:11], s38 offen offset:0 sc1 lds
M v[68:71], a[68:71], a[164:167], v[68:71]
 buffer_load_dword v24, off, s[8:11], s79 sc1
M v[68:71], a[64:67], a[160:163], v[68:71]
 s_waitcnt lgkmcnt(0)
 v_lshrrev_b32 v0, 4, v7
 v_and_b32 v14, 15, v0
M v[76:79], a[96:99], a[160:163], v[36:39]
 ds_read_b128 a[64:67], v2 offset:16384
 v_lshlrev_b32 v14, 2, v14
M v[76:79], a[100:103], a[164:167], v[76:79]
 ds_read_b128 a[68:71], v2 offset:17408
 v_lshrrev_b32 v11, 4, v0
M v[76:79], a[104:107], a[168:171], v[76:79]
 buffer_load_dwordx4 v4, s[8:11], s38 offen offset:1024 sc1 lds
M v[76:79], a[108:111], a[172:175], v[76:79]
 ds_read_b128 a[72:75], v2 offset:18432
 s_mov_b32 s52, s96
M v[76:79], a[112:115], a[176:179], v[76:79]
 s_and_b32 s53, s97, 0xffff
 ds_read_b128 a[76:79], v2 offset:19456
 s_mov_b32 s54, 1835008
M v[76:79], a[116:119], a[180:183], v[76:79]
 buffer_load_dwordx4 v4, s[8:11], s38 offen offset:2048 sc1 lds
M v[76:79], a[120:123], a[184:187], v[76:79]
 ds_read_b128 a[80:83], v2 offset:20480
 s_mov_b32 s55, 0x20000
M v[76:79], a[124:127], a[188:191], v[76:79]
 s_lshr_b32 s74, s41, 3
 ds_read_b128 a[84:87], v2 offset:21504
 s_xor_b32 s74, s74, 0
M v[72:75], a[124:127], a[156:159], v[32:35]
 buffer_load_dwordx4 v4, s[8:11], s38 offen offset:3072 sc1 lds
M v[72:75], a[120:123], a[152:155], v[72:75]
 s_add_u32 s38, s38, 32768
 ds_read_b128 a[88:91], v2 offset:22528
 s_mul_i32 s67, s74, -2
M v[72:75], a[116:119], a[148:151], v[72:75]
 s_mul_i32 s74, s74, 8
 ds_read_b128 a[92:95], v2 offset:23552
 v_fma_f32 v106, v106, v5, v28
M v[72:75], a[112:115], a[144:147], v[72:75]
 s_add_u32 s74, s74, s20
 v_fma_f32 v107, v107, v5, v28
 v_cvt_pk_bf16_f32 v96, v96, v97
M v[72:75], a[108:111], a[140:143], v[72:75]
 s_lshl_b32 s75, s74, 6
 v_cvt_pk_bf16_f32 v97, v98, v99
 v_cvt_pk_bf16_f32 v98, v104, v105
M v[72:75], a[104:107], a[136:139], v[72:75]
 s_add_u32 s76, s75, 256
 v_cvt_pk_bf16_f32 v99, v106, v107
M v[72:75], a[100:103], a[132:135], v[72:75]
 s_add_u32 s67, s67, 3
 v_add_u32 v43, 0x20000, v7
 s_sub_u32 s67, s67, s20
M v[72:75], a[96:99], a[128:131], v[72:75]
 s_waitcnt lgkmcnt(0)
 s_and_b32 s67, s67, 536870912
M v[80:83], a[64:67], a[128:131], v[32:35]
 s_or_b32 s76, s76, s67
 ds_read_b128 a[96:99], v2 offset:24576
 v_or_b32 v27, s67, v7
M v[80:83], a[68:71], a[132:135], v[80:83]
 ds_read_b128 a[100:103], v2 offset:25600
 v_add_u32 v27, 4096, v27
M v[80:83], a[72:75], a[136:139], v[80:83]
 buffer_store_dwordx4 v[96:99], v7, s[8:11], s29 offen offset:0 sc1
M v[80:83], a[76:79], a[140:143], v[80:83]
 ds_read_b128 a[104:107], v2 offset:26624
 v_fma_f32 v100, v100, v6, v29
M v[80:83], a[80:83], a[144:147], v[80:83]
 ds_read_b128 a[108:111], v2 offset:27648
 v_fma_f32 v101, v101, v6, v29
M v[80:83], a[84:87], a[148:151], v[80:83]
 v_fma_f32 v102, v102, v6, v29
 v_fma_f32 v103, v103, v6, v29
M v[80:83], a[88:91], a[152:155], v[80:83]
 ds_read_b128 a[112:115], v2 offset:28672
 v_fma_f32 v108, v108, v6, v29
M v[80:83], a[92:95], a[156:159], v[80:83]
 ds_read_b128 a[116:119], v2 offset:29696
 v_fma_f32 v109, v109, v6, v29
M v[84:87], a[92:95], a[188:191], v[36:39]
 v_fma_f32 v110, v110, v6, v29
 v_fma_f32 v111, v111, v6, v29
M v[84:87], a[88:91], a[184:187], v[84:87]
 ds_read_b128 a[120:123], v2 offset:30720
 v_cvt_pk_bf16_f32 v100, v100, v101
M v[84:87], a[84:87], a[180:183], v[84:87]
 ds_read_b128 a[124:127], v2 offset:31744
 v_cvt_pk_bf16_f32 v101, v102, v103
M v[84:87], a[80:83], a[176:179], v[84:87]
 v_cvt_pk_bf16_f32 v102, v108, v109
 v_cvt_pk_bf16_f32 v103, v110, v111
M v[84:87], a[76:79], a[172:175], v[84:87]
 buffer_store_dwordx4 v[100:103], v7, s[8:11], s30 offen offset:0 sc1
M v[84:87], a[72:75], a[168:171], v[84:87]
 v_fma_f32 v112, v112, v5, v28
 v_fma_f32 v113, v113, v5, v28
M v[84:87], a[68:71], a[164:167], v[84:87]
 s_waitcnt vmcnt(31) lgkmcnt(0)
 v_fma_f32 v114, v114, v5, v28
 v_fma_f32 v115, v115, v5, v28
M v[84:87], a[64:67], a[160:163], v[84:87]
 s_barrier
M v[92:95], a[96:99], a[160:163], v[36:39]
 ds_read_b128 a[64:67], v7 offset:0
 v_fma_f32 v120, v120, v5, v28
M v[92:95], a[100:103], a[164:167], v[92:95]
 ds_read_b128 a[68:71], v7 offset:1024
 v_fma_f32 v121, v121, v5, v28
M v[92:95], a[104:107], a[168:171], v[92:95]
 v_fma_f32 v122, v122, v5, v28
 v_fma_f32 v123, v123, v5, v28
M v[92:95], a[108:111], a[172:175], v[92:95]
 ds_read_b128 a[72:75], v7 offset:2048
 v_cvt_pk_bf16_f32 v112, v112, v113
M v[92:95], a[112:115], a[176:179], v[92:95]
 ds_read_b128 a[76:79], v7 offset:3072
 v_cvt_pk_bf16_f32 v113, v114, v115
M v[92:95], a[116:119], a[180:183], v[92:95]
 v_cvt_pk_bf16_f32 v114, v120, v121
 v_cvt_pk_bf16_f32 v115, v122, v123
M v[92:95], a[120:123], a[184:187], v[92:95]
 ds_read_b128 a[80:83], v7 offset:4096
M v[92:95], a[124:127], a[188:191], v[92:95]
 ds_read_b128 a[84:87], v7 offset:5120
M v[88:91], a[124:127], a[156:159], v[32:35]
 buffer_store_dwordx4 v[112:115], v7, s[8:11], s29 offen offset:1024 sc1
M v[88:91], a[120:123], a[152:155], v[88:91]
 ds_read_b128 a[88:91], v7 offset:6144
 v_fma_f32 v116, v116, v6, v29
M v[88:91], a[116:119], a[148:151], v[88:91]
 ds_read_b128 a[92:95], v7 offset:7168
 v_fma_f32 v117, v117, v6, v29
M v[88:91], a[112:115], a[144:147], v[88:91]
 v_fma_f32 v118, v118, v6, v29
 v_fma_f32 v119, v119, v6, v29
M v[88:91], a[108:111], a[140:143], v[88:91]
 v_fma_f32 v124, v124, v6, v29
 v_fma_f32 v125, v125, v6, v29
M v[88:91], a[104:107], a[136:139], v[88:91]
 v_fma_f32 v126, v126, v6, v29
 v_fma_f32 v127, v127, v6, v29
M v[88:91], a[100:103], a[132:135], v[88:91]
 s_waitcnt lgkmcnt(0)
 v_cvt_pk_bf16_f32 v116, v116, v117
 v_cvt_pk_bf16_f32 v117, v118, v119
M v[88:91], a[96:99], a[128:131], v[88:91]
 v_cvt_pk_bf16_f32 v118, v124, v125
 v_cvt_pk_bf16_f32 v119, v126, v127
 buffer_store_dwordx4 v[116:119], v7, s[8:11], s30 offen offset:1024 sc1
M v[96:99], a[64:67], a[128:131], v[32:35]
 ds_read_b128 a[96:99], v7 offset:8192
M v[96:99], a[68:71], a[132:135], v[96:99]
 ds_read_b128 a[100:103], v7 offset:9216
M v[96:99], a[72:75], a[136:139], v[96:99]
 s_sub_u32 s64, 15, s42
M v[96:99], a[76:79], a[140:143], v[96:99]
 s_min_u32 s64, s64, s42
 ds_read_b128 a[104:107], v7 offset:10240
 s_add_u32 s29, s33, 4096
M v[96:99], a[80:83], a[144:147], v[96:99]
 s_mul_i32 s45, s64, 8704
 ds_read_b128 a[108:111], v7 offset:11264
 s_add_u32 s30, s33, 18432
M v[96:99], a[84:87], a[148:151], v[96:99]
 s_lshl_b32 s64, s20, 6
 v_fma_f32 v64, v64, v5, v28
 v_fma_f32 v65, v65, v5, v28
M v[96:99], a[88:91], a[152:155], v[96:99]
 s_add_u32 s64, s64, s41
 ds_read_b128 a[112:115], v7 offset:12288
 v_fma_f32 v66, v66, v5, v28
M v[96:99], a[92:95], a[156:159], v[96:99]
 s_lshl2_add_u32 s45, s64, s45
 ds_read_b128 a[116:119], v7 offset:13312
 v_fma_f32 v67, v67, v5, v28
M v[100:103], a[92:95], a[188:191], v[36:39]
 s_add_u32 s45, s45, 104992768
 v_fma_f32 v72, v72, v5, v28
M v[100:103], a[88:91], a[184:187], v[100:103]
 s_movk_i32 s65, 1024
 ds_read_b128 a[120:123], v7 offset:14336
 v_fma_f32 v73, v73, v5, v28
M v[100:103], a[84:87], a[180:183], v[100:103]
 s_cmp_lt_u32 s42, 8
 ds_read_b128 a[124:127], v7 offset:15360
 v_fma_f32 v74, v74, v5, v28
M v[100:103], a[80:83], a[176:179], v[100:103]
 s_cselect_b32 s64, 4352, s65
 v_fma_f32 v75, v75, v5, v28
M v[100:103], a[76:79], a[172:175], v[100:103]
 s_cselect_b32 s65, 0, 64
 v_cvt_pk_bf16_f32 v64, v64, v65
M v[100:103], a[72:75], a[168:171], v[100:103]
 s_cselect_b32 s66, 32, 64
 v_cvt_pk_bf16_f32 v65, v66, v67
M v[100:103], a[68:71], a[164:167], v[100:103]
 s_add_u32 s3, s45, s64
 s_add_u32 s45, s45, s65
 v_lshrrev_b32 v42, 5, v7
M v[100:103], a[64:67], a[160:163], v[100:103]
 s_waitcnt lgkmcnt(0)
 v_mul_u32_u24 v42, 4352, v42
 v_and_b32 v41, 16, v7
M v[108:111], a[96:99], a[160:163], v[36:39]
 ds_read_b128 a[64:67], v7 offset:16384
 v_lshl_add_u32 v41, v41, 3, v42
M v[108:111], a[100:103], a[164:167], v[108:111]
 ds_read_b128 a[68:71], v7 offset:17408
 v_mov_b32 v42, 536870912
M v[108:111], a[104:107], a[168:171], v[108:111]
 v_cmp_gt_u32 vcc, s66, v7
 v_mov_b32 v40, 1
M v[108:111], a[108:111], a[172:175], v[108:111]
 s_nop 0
 ds_read_b128 a[72:75], v7 offset:18432
 v_cndmask_b32 v41, v42, v41, vcc
M v[108:111], a[112:115], a[176:179], v[108:111]
 ds_read_b128 a[76:79], v7 offset:19456
 v_cvt_pk_bf16_f32 v66, v72, v73
M v[108:111], a[116:119], a[180:183], v[108:111]
 v_cvt_pk_bf16_f32 v67, v74, v75
M v[108:111], a[120:123], a[184:187], v[108:111]
 ds_read_b128 a[80:83], v7 offset:20480
M v[108:111], a[124:127], a[188:191], v[108:111]
 ds_read_b128 a[84:87], v7 offset:21504
M v[104:107], a[124:127], a[156:159], v[32:35]
 buffer_store_dwordx4 v[64:67], v7, s[8:11], s29 offen offset:0 sc1
M v[104:107], a[120:123], a[152:155], v[104:107]
 ds_read_b128 a[88:91], v7 offset:22528
 v_fma_f32 v68, v68, v6, v29
M v[104:107], a[116:119], a[148:151], v[104:107]
 ds_read_b128 a[92:95], v7 offset:23552
 v_fma_f32 v69, v69, v6, v29
M v[104:107], a[112:115], a[144:147], v[104:107]
 v_fma_f32 v70, v70, v6, v29
 v_fma_f32 v71, v71, v6, v29
M v[104:107], a[108:111], a[140:143], v[104:107]
 v_fma_f32 v76, v76, v6, v29
 v_fma_f32 v77, v77, v6, v29
M v[104:107], a[104:107], a[136:139], v[104:107]
 v_fma_f32 v78, v78, v6, v29
 v_fma_f32 v79, v79, v6, v29
M v[104:107], a[100:103], a[132:135], v[104:107]
 v_cvt_pk_bf16_f32 v68, v68, v69
 v_cvt_pk_bf16_f32 v69, v70, v71
M v[104:107], a[96:99], a[128:131], v[104:107]
 s_waitcnt lgkmcnt(0)
 v_cvt_pk_bf16_f32 v70, v76, v77
 v_cvt_pk_bf16_f32 v71, v78, v79
M v[112:115], a[64:67], a[128:131], v[32:35]
 ds_read_b128 a[96:99], v7 offset:24576
M v[112:115], a[68:71], a[132:135], v[112:115]
 ds_read_b128 a[100:103], v7 offset:25600
M v[112:115], a[72:75], a[136:139], v[112:115]
 buffer_store_dwordx4 v[68:71], v7, s[8:11], s30 offen offset:0 sc1
M v[112:115], a[76:79], a[140:143], v[112:115]
 ds_read_b128 a[104:107], v7 offset:26624
 v_fma_f32 v80, v80, v5, v28
M v[112:115], a[80:83], a[144:147], v[112:115]
 ds_read_b128 a[108:111], v7 offset:27648
 v_fma_f32 v81, v81, v5, v28
M v[112:115], a[84:87], a[148:151], v[112:115]
 v_fma_f32 v82, v82, v5, v28
 v_fma_f32 v83, v83, v5, v28
M v[112:115], a[88:91], a[152:155], v[112:115]
 ds_read_b128 a[112:115], v7 offset:28672
 v_fma_f32 v88, v88, v5, v28
M v[112:115], a[92:95], a[156:159], v[112:115]
 ds_read_b128 a[116:119], v7 offset:29696
 v_fma_f32 v89, v89, v5, v28
M v[116:119], a[92:95], a[188:191], v[36:39]
 v_fma_f32 v90, v90, v5, v28
 v_fma_f32 v91, v91, v5, v28
M v[116:119], a[88:91], a[184:187], v[116:119]
 ds_read_b128 a[120:123], v7 offset:30720
 v_cvt_pk_bf16_f32 v80, v80, v81
M v[116:119], a[84:87], a[180:183], v[116:119]
 ds_read_b128 a[124:127], v7 offset:31744
 v_cvt_pk_bf16_f32 v81, v82, v83
M v[116:119], a[80:83], a[176:179], v[116:119]
 v_cvt_pk_bf16_f32 v82, v88, v89
 v_cvt_pk_bf16_f32 v83, v90, v91
M v[116:119], a[76:79], a[172:175], v[116:119]
 buffer_store_dwordx4 v[80:83], v7, s[8:11], s29 offen offset:1024 sc1
M v[116:119], a[72:75], a[168:171], v[116:119]
 v_fma_f32 v84, v84, v6, v29
 v_fma_f32 v85, v85, v6, v29
M v[116:119], a[68:71], a[164:167], v[116:119]
 s_waitcnt vmcnt(28) lgkmcnt(0)
 v_fma_f32 v86, v86, v6, v29
M v[116:119], a[64:67], a[160:163], v[116:119]
 s_barrier
M v[124:127], a[96:99], a[160:163], v[36:39]
 ds_read_b128 a[64:67], v43 offset:0
 v_fma_f32 v87, v87, v6, v29
M v[124:127], a[100:103], a[164:167], v[124:127]
 ds_read_b128 a[68:71], v43 offset:1024
 v_fma_f32 v92, v92, v6, v29
M v[124:127], a[104:107], a[168:171], v[124:127]
 v_fma_f32 v93, v93, v6, v29
 v_fma_f32 v94, v94, v6, v29
M v[124:127], a[108:111], a[172:175], v[124:127]
 ds_read_b128 a[72:75], v43 offset:2048
 v_fma_f32 v95, v95, v6, v29
M v[124:127], a[112:115], a[176:179], v[124:127]
 ds_read_b128 a[76:79], v43 offset:3072
 v_cvt_pk_bf16_f32 v84, v84, v85
M v[124:127], a[116:119], a[180:183], v[124:127]
 v_cvt_pk_bf16_f32 v85, v86, v87
M v[124:127], a[120:123], a[184:187], v[124:127]
 ds_read_b128 a[80:83], v43 offset:4096
 v_cvt_pk_bf16_f32 v86, v92, v93
M v[124:127], a[124:127], a[188:191], v[124:127]
 ds_read_b128 a[84:87], v43 offset:5120
 v_cvt_pk_bf16_f32 v87, v94, v95
M v[120:123], a[124:127], a[156:159], v[32:35]
 buffer_store_dwordx4 v[84:87], v7, s[8:11], s30 offen offset:1024 sc1
M v[120:123], a[120:123], a[152:155], v[120:123]
 ds_read_b128 a[88:91], v43 offset:6144
M v[120:123], a[116:119], a[148:151], v[120:123]
 ds_read_b128 a[92:95], v43 offset:7168
M v[120:123], a[112:115], a[144:147], v[120:123]
M v[120:123], a[108:111], a[140:143], v[120:123]
M v[120:123], a[104:107], a[136:139], v[120:123]
M v[120:123], a[100:103], a[132:135], v[120:123]
 s_waitcnt lgkmcnt(0)
M v[120:123], a[96:99], a[128:131], v[120:123]
M v[64:67], a[64:67], a[128:131], v[32:35]
 ds_read_b128 a[96:99], v43 offset:8192
M v[64:67], a[68:71], a[132:135], v[64:67]
 ds_read_b128 a[100:103], v43 offset:9216
M v[64:67], a[72:75], a[136:139], v[64:67]
 s_waitcnt vmcnt(11)
 v_cmp_gt_u32 vcc, 1, v24
M v[64:67], a[76:79], a[140:143], v[64:67]
 s_mov_b32 s65, 104890368
 ds_read_b128 a[104:107], v43 offset:10240
 s_add_u32 s29, s33, 6144
M v[64:67], a[80:83], a[144:147], v[64:67]
 s_cbranch_vccnz L_fhs0
L_fhr0:
 ds_read_b128 a[108:111], v43 offset:11264
 s_add_u32 s30, s33, 20480
M v[64:67], a[84:87], a[148:151], v[64:67]
 buffer_load_dword v25, v14, s[8:11], s65 offen sc1
M v[64:67], a[88:91], a[152:155], v[64:67]
 ds_read_b128 a[112:115], v43 offset:12288
 v_fma_f32 v96, v96, v5, v28
M v[64:67], a[92:95], a[156:159], v[64:67]
 ds_read_b128 a[116:119], v43 offset:13312
 v_fma_f32 v97, v97, v5, v28
M v[68:71], a[92:95], a[188:191], v[36:39]
 v_fma_f32 v98, v98, v5, v28
 v_fma_f32 v99, v99, v5, v28
M v[68:71], a[88:91], a[184:187], v[68:71]
 ds_read_b128 a[120:123], v43 offset:14336
 v_fma_f32 v104, v104, v5, v28
M v[68:71], a[84:87], a[180:183], v[68:71]
 ds_read_b128 a[124:127], v43 offset:15360
 v_fma_f32 v105, v105, v5, v28
M v[68:71], a[80:83], a[176:179], v[68:71]
 v_fma_f32 v106, v106, v5, v28
 v_fma_f32 v107, v107, v5, v28
M v[68:71], a[76:79], a[172:175], v[68:71]
 v_cvt_pk_bf16_f32 v96, v96, v97
M v[68:71], a[72:75], a[168:171], v[68:71]
 v_cvt_pk_bf16_f32 v97, v98, v99
M v[68:71], a[68:71], a[164:167], v[68:71]
 v_cvt_pk_bf16_f32 v98, v104, v105
M v[68:71], a[64:67], a[160:163], v[68:71]
 s_waitcnt lgkmcnt(0)
 v_cvt_pk_bf16_f32 v99, v106, v107
M v[76:79], a[96:99], a[160:163], v[36:39]
 ds_read_b128 a[64:67], v43 offset:16384
M v[76:79], a[100:103], a[164:167], v[76:79]
 ds_read_b128 a[68:71], v43 offset:17408
M v[76:79], a[104:107], a[168:171], v[76:79]
 buffer_store_dwordx4 v[96:99], v7, s[8:11], s29 offen offset:0 sc1
M v[76:79], a[108:111], a[172:175], v[76:79]
 ds_read_b128 a[72:75], v43 offset:18432
 v_fma_f32 v100, v100, v6, v29
M v[76:79], a[112:115], a[176:179], v[76:79]
 ds_read_b128 a[76:79], v43 offset:19456
 v_fma_f32 v101, v101, v6, v29
M v[76:79], a[116:119], a[180:183], v[76:79]
 v_fma_f32 v102, v102, v6, v29
 v_fma_f32 v103, v103, v6, v29
M v[76:79], a[120:123], a[184:187], v[76:79]
 ds_read_b128 a[80:83], v43 offset:20480
 v_fma_f32 v108, v108, v6, v29
M v[76:79], a[124:127], a[188:191], v[76:79]
 ds_read_b128 a[84:87], v43 offset:21504
 v_fma_f32 v109, v109, v6, v29
M v[72:75], a[124:127], a[156:159], v[32:35]
 v_fma_f32 v110, v110, v6, v29
 v_fma_f32 v111, v111, v6, v29
M v[72:75], a[120:123], a[152:155], v[72:75]
 ds_read_b128 a[88:91], v43 offset:22528
 v_cvt_pk_bf16_f32 v100, v100, v101
M v[72:75], a[116:119], a[148:151], v[72:75]
 ds_read_b128 a[92:95], v43 offset:23552
 v_cvt_pk_bf16_f32 v101, v102, v103
M v[72:75], a[112:115], a[144:147], v[72:75]
 v_cvt_pk_bf16_f32 v102, v108, v109
M v[72:75], a[108:111], a[140:143], v[72:75]
 v_cvt_pk_bf16_f32 v103, v110, v111
M v[72:75], a[104:107], a[136:139], v[72:75]
 buffer_store_dwordx4 v[100:103], v7, s[8:11], s30 offen offset:0 sc1
M v[72:75], a[100:103], a[132:135], v[72:75]
M v[72:75], a[96:99], a[128:131], v[72:75]
 s_waitcnt lgkmcnt(0)
 v_fma_f32 v112, v112, v5, v28
M v[80:83], a[64:67], a[128:131], v[32:35]
 ds_read_b128 a[96:99], v43 offset:24576
 v_fma_f32 v113, v113, v5, v28
M v[80:83], a[68:71], a[132:135], v[80:83]
 ds_read_b128 a[100:103], v43 offset:25600
 v_fma_f32 v114, v114, v5, v28
M v[80:83], a[72:75], a[136:139], v[80:83]
 v_fma_f32 v115, v115, v5, v28
M v[80:83], a[76:79], a[140:143], v[80:83]
 ds_read_b128 a[104:107], v43 offset:26624
 v_fma_f32 v120, v120, v5, v28
M v[80:83], a[80:83], a[144:147], v[80:83]
 ds_read_b128 a[108:111], v43 offset:27648
 v_fma_f32 v121, v121, v5, v28
M v[80:83], a[84:87], a[148:151], v[80:83]
 v_fma_f32 v122, v122, v5, v28
M v[80:83], a[88:91], a[152:155], v[80:83]
 ds_read_b128 a[112:115], v43 offset:28672
 v_fma_f32 v123, v123, v5, v28
M v[80:83], a[92:95], a[156:159], v[80:83]
 ds_read_b128 a[116:119], v43 offset:29696
 v_cvt_pk_bf16_f32 v112, v112, v113
M v[84:87], a[92:95], a[188:191], v[36:39]
 v_cvt_pk_bf16_f32 v113, v114, v115
 v_cvt_pk_bf16_f32 v114, v120, v121
M v[84:87], a[88:91], a[184:187], v[84:87]
 ds_read_b128 a[120:123], v43 offset:30720
 v_cvt_pk_bf16_f32 v115, v122, v123
M v[84:87], a[84:87], a[180:183], v[84:87]
 ds_read_b128 a[124:127], v43 offset:31744
M v[84:87], a[80:83], a[176:179], v[84:87]
 buffer_store_dwordx4 v[112:115], v7, s[8:11], s29 offen offset:1024 sc1
M v[84:87], a[76:79], a[172:175], v[84:87]
 v_fma_f32 v116, v116, v6, v29
M v[84:87], a[72:75], a[168:171], v[84:87]
 v_fma_f32 v117, v117, v6, v29
M v[84:87], a[68:71], a[164:167], v[84:87]
 s_waitcnt lgkmcnt(0)
 v_fma_f32 v118, v118, v6, v29
M v[84:87], a[64:67], a[160:163], v[84:87]
 s_barrier
M v[92:95], a[96:99], a[160:163], v[36:39]
 ds_read_b128 a[64:67], v2 offset:32768
 v_fma_f32 v119, v119, v6, v29
M v[92:95], a[100:103], a[164:167], v[92:95]
 ds_read_b128 a[68:71], v2 offset:33792
 v_fma_f32 v124, v124, v6, v29
M v[92:95], a[104:107], a[168:171], v[92:95]
 v_fma_f32 v125, v125, v6, v29
 v_fma_f32 v126, v126, v6, v29
M v[92:95], a[108:111], a[172:175], v[92:95]
 ds_read_b128 a[72:75], v2 offset:34816
 v_fma_f32 v127, v127, v6, v29
M v[92:95], a[112:115], a[176:179], v[92:95]
 ds_read_b128 a[76:79], v2 offset:35840
 v_cvt_pk_bf16_f32 v116, v116, v117
M v[92:95], a[116:119], a[180:183], v[92:95]
 v_cvt_pk_bf16_f32 v117, v118, v119
M v[92:95], a[120:123], a[184:187], v[92:95]
 ds_read_b128 a[80:83], v2 offset:36864
 v_cvt_pk_bf16_f32 v118, v124, v125
M v[92:95], a[124:127], a[188:191], v[92:95]
 ds_read_b128 a[84:87], v2 offset:37888
 v_cvt_pk_bf16_f32 v119, v126, v127
M v[88:91], a[124:127], a[156:159], v[32:35]
 buffer_store_dwordx4 v[116:119], v7, s[8:11], s30 offen offset:1024 sc1
M v[88:91], a[120:123], a[152:155], v[88:91]
 ds_read_b128 a[88:91], v2 offset:38912
M v[88:91], a[116:119], a[148:151], v[88:91]
 ds_read_b128 a[92:95], v2 offset:39936
M v[88:91], a[112:115], a[144:147], v[88:91]
M v[88:91], a[108:111], a[140:143], v[88:91]
M v[88:91], a[104:107], a[136:139], v[88:91]
M v[88:91], a[100:103], a[132:135], v[88:91]
 s_waitcnt lgkmcnt(0)
M v[88:91], a[96:99], a[128:131], v[88:91]
M v[96:99], a[64:67], a[128:131], v[32:35]
 ds_read_b128 a[96:99], v2 offset:40960
M v[96:99], a[68:71], a[132:135], v[96:99]
 ds_read_b128 a[100:103], v2 offset:41984
M v[96:99], a[72:75], a[136:139], v[96:99]
M v[96:99], a[76:79], a[140:143], v[96:99]
 ds_read_b128 a[104:107], v2 offset:43008
 s_add_u32 s29, s33, 8192
M v[96:99], a[80:83], a[144:147], v[96:99]
 ds_read_b128 a[108:111], v2 offset:44032
 s_add_u32 s30, s33, 22528
M v[96:99], a[84:87], a[148:151], v[96:99]
 v_fma_f32 v64, v64, v5, v28
 v_fma_f32 v65, v65, v5, v28
M v[96:99], a[88:91], a[152:155], v[96:99]
 ds_read_b128 a[112:115], v2 offset:45056
 v_fma_f32 v66, v66, v5, v28
M v[96:99], a[92:95], a[156:159], v[96:99]
 ds_read_b128 a[116:119], v2 offset:46080
 v_fma_f32 v67, v67, v5, v28
M v[100:103], a[92:95], a[188:191], v[36:39]
 v_fma_f32 v72, v72, v5, v28
M v[100:103], a[88:91], a[184:187], v[100:103]
 ds_read_b128 a[120:123], v2 offset:47104
 v_fma_f32 v73, v73, v5, v28
M v[100:103], a[84:87], a[180:183], v[100:103]
 ds_read_b128 a[124:127], v2 offset:48128
 v_fma_f32 v74, v74, v5, v28
M v[100:103], a[80:83], a[176:179], v[100:103]
 v_fma_f32 v75, v75, v5, v28
M v[100:103], a[76:79], a[172:175], v[100:103]
 v_cvt_pk_bf16_f32 v64, v64, v65
M v[100:103], a[72:75], a[168:171], v[100:103]
 v_cvt_pk_bf16_f32 v65, v66, v67
M v[100:103], a[68:71], a[164:167], v[100:103]
 v_cvt_pk_bf16_f32 v66, v72, v73
M v[100:103], a[64:67], a[160:163], v[100:103]
 s_waitcnt lgkmcnt(0)
 v_cvt_pk_bf16_f32 v67, v74, v75
M v[108:111], a[96:99], a[160:163], v[36:39]
 ds_read_b128 a[64:67], v2 offset:49152
M v[108:111], a[100:103], a[164:167], v[108:111]
 ds_read_b128 a[68:71], v2 offset:50176
M v[108:111], a[104:107], a[168:171], v[108:111]
 buffer_store_dwordx4 v[64:67], v7, s[8:11], s29 offen offset:0 sc1
M v[108:111], a[108:111], a[172:175], v[108:111]
 ds_read_b128 a[72:75], v2 offset:51200
 v_fma_f32 v68, v68, v6, v29
M v[108:111], a[112:115], a[176:179], v[108:111]
 ds_read_b128 a[76:79], v2 offset:52224
 v_fma_f32 v69, v69, v6, v29
M v[108:111], a[116:119], a[180:183], v[108:111]
 v_fma_f32 v70, v70, v6, v29
 v_fma_f32 v71, v71, v6, v29
M v[108:111], a[120:123], a[184:187], v[108:111]
 ds_read_b128 a[80:83], v2 offset:53248
 v_fma_f32 v76, v76, v6, v29
M v[108:111], a[124:127], a[188:191], v[108:111]
 ds_read_b128 a[84:87], v2 offset:54272
 v_fma_f32 v77, v77, v6, v29
M v[104:107], a[124:127], a[156:159], v[32:35]
 v_fma_f32 v78, v78, v6, v29
 v_fma_f32 v79, v79, v6, v29
M v[104:107], a[120:123], a[152:155], v[104:107]
 ds_read_b128 a[88:91], v2 offset:55296
 v_cvt_pk_bf16_f32 v68, v68, v69
M v[104:107], a[116:119], a[148:151], v[104:107]
 ds_read_b128 a[92:95], v2 offset:56320
 v_cvt_pk_bf16_f32 v69, v70, v71
M v[104:107], a[112:115], a[144:147], v[104:107]
 v_cvt_pk_bf16_f32 v70, v76, v77
M v[104:107], a[108:111], a[140:143], v[104:107]
 v_cvt_pk_bf16_f32 v71, v78, v79
M v[104:107], a[104:107], a[136:139], v[104:107]
 buffer_store_dwordx4 v[68:71], v7, s[8:11], s30 offen offset:0 sc1
M v[104:107], a[100:103], a[132:135], v[104:107]
M v[104:107], a[96:99], a[128:131], v[104:107]
 s_waitcnt lgkmcnt(0)
 v_fma_f32 v80, v80, v5, v28
M v[112:115], a[64:67], a[128:131], v[32:35]
 ds_read_b128 a[96:99], v2 offset:57344
 v_fma_f32 v81, v81, v5, v28
M v[112:115], a[68:71], a[132:135], v[112:115]
 ds_read_b128 a[100:103], v2 offset:58368
 v_fma_f32 v82, v82, v5, v28
M v[112:115], a[72:75], a[136:139], v[112:115]
 v_fma_f32 v83, v83, v5, v28
M v[112:115], a[76:79], a[140:143], v[112:115]
 ds_read_b128 a[104:107], v2 offset:59392
 v_fma_f32 v88, v88, v5, v28
M v[112:115], a[80:83], a[144:147], v[112:115]
 ds_read_b128 a[108:111], v2 offset:60416
 v_fma_f32 v89, v89, v5, v28
M v[112:115], a[84:87], a[148:151], v[112:115]
 v_fma_f32 v90, v90, v5, v28
M v[112:115], a[88:91], a[152:155], v[112:115]
 ds_read_b128 a[112:115], v2 offset:61440
 v_fma_f32 v91, v91, v5, v28
M v[112:115], a[92:95], a[156:159], v[112:115]
 ds_read_b128 a[116:119], v2 offset:62464
 v_cvt_pk_bf16_f32 v80, v80, v81
M v[116:119], a[92:95], a[188:191], v[36:39]
 s_waitcnt vmcnt(6)
 v_readlane_b32 s84, v25, 0
 v_readlane_b32 s85, v25, 1
M v[116:119], a[88:91], a[184:187], v[116:119]
 ds_read_b128 a[120:123], v2 offset:63488
 v_mov_b32 v24, 0x3f80
M v[116:119], a[84:87], a[180:183], v[116:119]
 ds_read_b128 a[124:127], v2 offset:64512
 v_mov_b32 v25, 0x3f800000
M v[116:119], a[80:83], a[176:179], v[116:119]
 v_cvt_pk_bf16_f32 v81, v82, v83
 v_cvt_pk_bf16_f32 v82, v88, v89
M v[116:119], a[76:79], a[172:175], v[116:119]
 v_cvt_pk_bf16_f32 v83, v90, v91
M v[116:119], a[72:75], a[168:171], v[116:119]
 buffer_store_dwordx4 v[80:83], v7, s[8:11], s29 offen offset:1024 sc1
M v[116:119], a[68:71], a[164:167], v[116:119]
 s_waitcnt lgkmcnt(0)
 v_fma_f32 v84, v84, v6, v29
 v_fma_f32 v85, v85, v6, v29
M v[116:119], a[64:67], a[160:163], v[116:119]
 s_barrier
M v[124:127], a[96:99], a[160:163], v[36:39]
 ds_read_b128 a[64:67], v7 offset:32768
 v_fma_f32 v86, v86, v6, v29
M v[124:127], a[100:103], a[164:167], v[124:127]
 ds_read_b128 a[68:71], v7 offset:33792
 v_fma_f32 v87, v87, v6, v29
M v[124:127], a[104:107], a[168:171], v[124:127]
 v_fma_f32 v92, v92, v6, v29
 v_fma_f32 v93, v93, v6, v29
M v[124:127], a[108:111], a[172:175], v[124:127]
 ds_read_b128 a[72:75], v7 offset:34816
 v_fma_f32 v94, v94, v6, v29
M v[124:127], a[112:115], a[176:179], v[124:127]
 ds_read_b128 a[76:79], v7 offset:35840
 v_fma_f32 v95, v95, v6, v29
M v[124:127], a[116:119], a[180:183], v[124:127]
 s_waitcnt vmcnt(3)
 v_cvt_pk_bf16_f32 v84, v84, v85
 v_cvt_pk_bf16_f32 v85, v86, v87
M v[124:127], a[120:123], a[184:187], v[124:127]
 ds_read_b128 a[80:83], v7 offset:36864
 v_cvt_pk_bf16_f32 v86, v92, v93
M v[124:127], a[124:127], a[188:191], v[124:127]
 ds_read_b128 a[84:87], v7 offset:37888
 v_cvt_pk_bf16_f32 v87, v94, v95
M v[120:123], a[124:127], a[156:159], v[32:35]
 buffer_store_dword v40, v41, s[8:11], s45 offen sc1
M v[120:123], a[120:123], a[152:155], v[120:123]
 ds_read_b128 a[88:91], v7 offset:38912
M v[120:123], a[116:119], a[148:151], v[120:123]
 ds_read_b128 a[92:95], v7 offset:39936
M v[120:123], a[112:115], a[144:147], v[120:123]
 buffer_store_dwordx4 v[84:87], v7, s[8:11], s30 offen offset:1024 sc1
M v[120:123], a[108:111], a[140:143], v[120:123]
M v[120:123], a[104:107], a[136:139], v[120:123]
M v[120:123], a[100:103], a[132:135], v[120:123]
 s_waitcnt lgkmcnt(0)
M v[120:123], a[96:99], a[128:131], v[120:123]
M v[64:67], a[64:67], a[128:131], v[32:35]
 ds_read_b128 a[96:99], v7 offset:40960
M v[64:67], a[68:71], a[132:135], v[64:67]
 ds_read_b128 a[100:103], v7 offset:41984
M v[64:67], a[72:75], a[136:139], v[64:67]
M v[64:67], a[76:79], a[140:143], v[64:67]
 ds_read_b128 a[104:107], v7 offset:43008
 s_add_u32 s29, s33, 10240
M v[64:67], a[80:83], a[144:147], v[64:67]
 ds_read_b128 a[108:111], v7 offset:44032
 s_add_u32 s30, s33, 24576
M v[64:67], a[84:87], a[148:151], v[64:67]
 v_fma_f32 v96, v96, v5, v28
 v_fma_f32 v97, v97, v5, v28
M v[64:67], a[88:91], a[152:155], v[64:67]
 ds_read_b128 a[112:115], v7 offset:45056
 v_fma_f32 v98, v98, v5, v28
M v[64:67], a[92:95], a[156:159], v[64:67]
 ds_read_b128 a[116:119], v7 offset:46080
 v_fma_f32 v99, v99, v5, v28
M v[68:71], a[92:95], a[188:191], v[36:39]
 v_fma_f32 v104, v104, v5, v28
 v_fma_f32 v105, v105, v5, v28
M v[68:71], a[88:91], a[184:187], v[68:71]
 ds_read_b128 a[120:123], v7 offset:47104
 v_fma_f32 v106, v106, v5, v28
M v[68:71], a[84:87], a[180:183], v[68:71]
 ds_read_b128 a[124:127], v7 offset:48128
 v_fma_f32 v107, v107, v5, v28
M v[68:71], a[80:83], a[176:179], v[68:71]
 v_cvt_pk_bf16_f32 v96, v96, v97
 v_cvt_pk_bf16_f32 v97, v98, v99
M v[68:71], a[76:79], a[172:175], v[68:71]
 v_cvt_pk_bf16_f32 v98, v104, v105
 v_cvt_pk_bf16_f32 v99, v106, v107
M v[68:71], a[72:75], a[168:171], v[68:71]
 buffer_store_dwordx4 v[96:99], v7, s[8:11], s29 offen offset:0 sc1
M v[68:71], a[68:71], a[164:167], v[68:71]
 v_fma_f32 v100, v100, v6, v29
 v_fma_f32 v101, v101, v6, v29
M v[68:71], a[64:67], a[160:163], v[68:71]
 s_waitcnt lgkmcnt(0)
 v_fma_f32 v102, v102, v6, v29
 v_fma_f32 v103, v103, v6, v29
M v[72:75], a[96:99], a[128:131], v[32:35]
 ds_read_b128 a[64:67], v7 offset:49152
 v_fma_f32 v108, v108, v6, v29
M v[72:75], a[100:103], a[132:135], v[72:75]
 ds_read_b128 a[68:71], v7 offset:50176
 v_fma_f32 v109, v109, v6, v29
M v[72:75], a[104:107], a[136:139], v[72:75]
 v_fma_f32 v110, v110, v6, v29
 v_fma_f32 v111, v111, v6, v29
M v[72:75], a[108:111], a[140:143], v[72:75]
 ds_read_b128 a[72:75], v7 offset:51200
 v_cvt_pk_bf16_f32 v100, v100, v101
M v[72:75], a[112:115], a[144:147], v[72:75]
 ds_read_b128 a[76:79], v7 offset:52224
 v_cvt_pk_bf16_f32 v101, v102, v103
M v[72:75], a[116:119], a[148:151], v[72:75]
 v_cvt_pk_bf16_f32 v102, v108, v109
 v_cvt_pk_bf16_f32 v103, v110, v111
M v[72:75], a[120:123], a[152:155], v[72:75]
 ds_read_b128 a[80:83], v7 offset:53248
M v[72:75], a[124:127], a[156:159], v[72:75]
 ds_read_b128 a[84:87], v7 offset:54272
M v[76:79], a[124:127], a[188:191], v[36:39]
 buffer_store_dwordx4 v[100:103], v7, s[8:11], s30 offen offset:0 sc1
M v[76:79], a[120:123], a[184:187], v[76:79]
 ds_read_b128 a[88:91], v7 offset:55296
 v_fma_f32 v112, v112, v5, v28
M v[76:79], a[116:119], a[180:183], v[76:79]
 ds_read_b128 a[92:95], v7 offset:56320
 v_fma_f32 v113, v113, v5, v28
M v[76:79], a[112:115], a[176:179], v[76:79]
 v_fma_f32 v114, v114, v5, v28
 v_fma_f32 v115, v115, v5, v28
M v[76:79], a[108:111], a[172:175], v[76:79]
 v_fma_f32 v120, v120, v5, v28
 v_fma_f32 v121, v121, v5, v28
M v[76:79], a[104:107], a[168:171], v[76:79]
 v_fma_f32 v122, v122, v5, v28
 v_fma_f32 v123, v123, v5, v28
M v[76:79], a[100:103], a[164:167], v[76:79]
 v_cvt_pk_bf16_f32 v112, v112, v113
 v_cvt_pk_bf16_f32 v113, v114, v115
M v[76:79], a[96:99], a[160:163], v[76:79]
 s_waitcnt lgkmcnt(0)
 v_cvt_pk_bf16_f32 v114, v120, v121
 v_cvt_pk_bf16_f32 v115, v122, v123
M v[80:83], a[64:67], a[128:131], v[32:35]
 ds_read_b128 a[96:99], v7 offset:57344
M v[80:83], a[68:71], a[132:135], v[80:83]
 ds_read_b128 a[100:103], v7 offset:58368
M v[80:83], a[72:75], a[136:139], v[80:83]
 buffer_store_dwordx4 v[112:115], v7, s[8:11], s29 offen offset:1024 sc1
M v[80:83], a[76:79], a[140:143], v[80:83]
 ds_read_b128 a[104:107], v7 offset:59392
 v_fma_f32 v116, v116, v6, v29
M v[80:83], a[80:83], a[144:147], v[80:83]
 ds_read_b128 a[108:111], v7 offset:60416
 v_fma_f32 v117, v117, v6, v29
M v[80:83], a[84:87], a[148:151], v[80:83]
 v_fma_f32 v118, v118, v6, v29
 v_fma_f32 v119, v119, v6, v29
M v[80:83], a[88:91], a[152:155], v[80:83]
 ds_read_b128 a[112:115], v7 offset:61440
 v_fma_f32 v124, v124, v6, v29
M v[80:83], a[92:95], a[156:159], v[80:83]
 ds_read_b128 a[116:119], v7 offset:62464
 v_fma_f32 v125, v125, v6, v29
M v[84:87], a[92:95], a[188:191], v[36:39]
 v_fma_f32 v126, v126, v6, v29
 v_fma_f32 v127, v127, v6, v29
M v[84:87], a[88:91], a[184:187], v[84:87]
 ds_read_b128 a[120:123], v7 offset:63488
 v_cvt_pk_bf16_f32 v116, v116, v117
M v[84:87], a[84:87], a[180:183], v[84:87]
 ds_read_b128 a[124:127], v7 offset:64512
 v_cvt_pk_bf16_f32 v117, v118, v119
M v[84:87], a[80:83], a[176:179], v[84:87]
 v_cvt_pk_bf16_f32 v118, v124, v125
 v_cvt_pk_bf16_f32 v119, v126, v127
M v[84:87], a[76:79], a[172:175], v[84:87]
 buffer_store_dwordx4 v[116:119], v7, s[8:11], s30 offen offset:1024 sc1
M v[84:87], a[72:75], a[168:171], v[84:87]
 s_add_u32 s29, s33, 12288
M v[84:87], a[68:71], a[164:167], v[84:87]
 s_add_u32 s30, s33, 26624
 v_fma_f32 v64, v64, v5, v28
 v_fma_f32 v65, v65, v5, v28
M v[84:87], a[64:67], a[160:163], v[84:87]
 s_waitcnt lgkmcnt(0)
 v_fma_f32 v66, v66, v5, v28
 v_fma_f32 v67, v67, v5, v28
M v[88:91], a[96:99], a[128:131], v[32:35]
 v_fma_f32 v72, v72, v5, v28
 v_fma_f32 v73, v73, v5, v28
M v[88:91], a[100:103], a[132:135], v[88:91]
 v_fma_f32 v74, v74, v5, v28
 v_fma_f32 v75, v75, v5, v28
M v[88:91], a[104:107], a[136:139], v[88:91]
 v_cvt_pk_bf16_f32 v64, v64, v65
 v_cvt_pk_bf16_f32 v65, v66, v67
M v[88:91], a[108:111], a[140:143], v[88:91]
 v_cvt_pk_bf16_f32 v66, v72, v73
 v_cvt_pk_bf16_f32 v67, v74, v75
M v[88:91], a[112:115], a[144:147], v[88:91]
 buffer_store_dwordx4 v[64:67], v7, s[8:11], s29 offen offset:0 sc1
M v[88:91], a[116:119], a[148:151], v[88:91]
 v_fma_f32 v68, v68, v6, v29
 v_fma_f32 v69, v69, v6, v29
M v[88:91], a[120:123], a[152:155], v[88:91]
 v_fma_f32 v70, v70, v6, v29
 v_fma_f32 v71, v71, v6, v29
M v[88:91], a[124:127], a[156:159], v[88:91]
 v_fma_f32 v76, v76, v6, v29
 v_fma_f32 v77, v77, v6, v29
M v[92:95], a[124:127], a[188:191], v[36:39]
 v_fma_f32 v78, v78, v6, v29
 v_fma_f32 v79, v79, v6, v29
M v[92:95], a[120:123], a[184:187], v[92:95]
 v_cvt_pk_bf16_f32 v68, v68, v69
 v_cvt_pk_bf16_f32 v69, v70, v71
M v[92:95], a[116:119], a[180:183], v[92:95]
 v_cvt_pk_bf16_f32 v70, v76, v77
 v_cvt_pk_bf16_f32 v71, v78, v79
M v[92:95], a[112:115], a[176:179], v[92:95]
 buffer_store_dwordx4 v[68:71], v7, s[8:11], s30 offen offset:0 sc1
M v[92:95], a[108:111], a[172:175], v[92:95]
M v[92:95], a[104:107], a[168:171], v[92:95]
M v[92:95], a[100:103], a[164:167], v[92:95]
M v[92:95], a[96:99], a[160:163], v[92:95]
 v_fma_f32 v80, v80, v5, v28
 v_fma_f32 v81, v81, v5, v28
 v_fma_f32 v82, v82, v5, v28
 v_fma_f32 v83, v83, v5, v28
 v_fma_f32 v88, v88, v5, v28
 v_fma_f32 v89, v89, v5, v28
 v_fma_f32 v90, v90, v5, v28
 v_fma_f32 v91, v91, v5, v28
 v_cvt_pk_bf16_f32 v80, v80, v81
 v_cvt_pk_bf16_f32 v81, v82, v83
 v_cvt_pk_bf16_f32 v82, v88, v89
 v_cvt_pk_bf16_f32 v83, v90, v91
 buffer_store_dwordx4 v[80:83], v7, s[8:11], s29 offen offset:1024 sc1
 v_fma_f32 v84, v84, v6, v29
 v_fma_f32 v85, v85, v6, v29
 v_fma_f32 v86, v86, v6, v29
 v_fma_f32 v87, v87, v6, v29
 v_fma_f32 v92, v92, v6, v29
 v_fma_f32 v93, v93, v6, v29
 v_fma_f32 v94, v94, v6, v29
 v_fma_f32 v95, v95, v6, v29
 v_cvt_pk_bf16_f32 v84, v84, v85
 v_cvt_pk_bf16_f32 v85, v86, v87
 v_cvt_pk_bf16_f32 v86, v92, v93
 v_cvt_pk_bf16_f32 v87, v94, v95
 buffer_store_dwordx4 v[84:87], v7, s[8:11], s30 offen offset:1024 sc1
L_red:
 s_lshl_b32 s64, s42, 1
 s_lshr_b32 s65, s41, 3
 s_add_u32 s46, s64, s65
 s_mul_i32 s46, s46, 4352
 s_and_b32 s72, s41, 7
 s_lshl_b32 s66, s72, 7
 s_add_u32 s46, s46, s66
 s_add_u32 s46, s46, 104992768
 v_and_b32 v14, 31, v0
 v_lshlrev_b32 v14, 2, v14
 buffer_load_dword v9, v14, s[8:11], s46 offen sc1
 s_mul_i32 s86, s65, 4
 s_add_u32 s86, s86, s20
 s_mul_i32 s77, s42, 1835008
 s_mul_i32 s78, s72, 14336
 s_add_u32 s77, s77, s78
 s_add_u32 s77, s77, 67108864
 s_sub_u32 s64, 15, s64
 s_sub_u32 s78, s64, 1
 s_mul_i32 s78, s78, 1835008
 s_add_u32 s78, s78, s77
 s_lshl_b32 s66, s86, 10
 s_add_u32 s78, s78, s66
 s_lshl_b32 s66, s74, 10
 s_add_u32 s77, s77, s66
 s_lshl_b32 s66, s64, 7
 s_lshl_b32 s86, s86, 6
 s_lshr_b32 s73, s72, 1
 s_sub_u32 s65, 7, s73
 s_bitcmp1_b32 s72, 0
 s_cselect_b32 s73, s65, s73
 s_lshl_b32 s73, s73, 4
 s_lshl_b32 s65, s42, 7
 s_add_u32 s73, s73, s65
 v_and_b32 v10, 15, v0
 v_add_u32 v10, s73, v10
 v_add_u32 v29, s66, v10
 s_mov_b32 s64, 104857664
 v_mul_u32_u24 v12, 896, v10
 v_lshl_add_u32 v12, v11, 4, v12
 v_lshrrev_b32 v13, 4, v10
 v_lshlrev_b32 v13, 5, v13
 v_and_b32 v104, 15, v10
 v_add_lshl_u32 v13, v13, v104, 2
 buffer_load_dword v15, v13, s[8:11], s64 offen sc1
 buffer_load_dwordx4 v[16:19], v12, s[56:59], s75 offen
 buffer_load_dwordx4 v[20:23], v12, s[56:59], s76 offen
 v_mov_b32 v48, 0
 v_mov_b32 v49, 0
 v_mov_b32 v50, 0
 v_mov_b32 v51, 0
 v_mov_b32 v52, 0
 v_mov_b32 v53, 0
 v_mov_b32 v54, 0
 v_mov_b32 v55, 0
 v_mov_b32 v56, 0
 v_mov_b32 v57, 0
 v_mov_b32 v58, 0
 v_mov_b32 v59, 0
 v_mov_b32 v60, 0
 v_mov_b32 v61, 0
 v_mov_b32 v62, 0
 v_mov_b32 v63, 0
 v_mul_u32_u24 v28, 896, v29
 v_lshl_add_u32 v28, v11, 4, v28
 v_lshrrev_b32 v13, 4, v29
 v_lshlrev_b32 v13, 5, v13
 v_and_b32 v104, 15, v29
 v_add_lshl_u32 v13, v13, v104, 2
 buffer_load_dword v26, v13, s[8:11], s64 offen sc1
 buffer_load_dwordx4 v[96:99], v28, s[56:59], s86 offen
 v_mov_b32 v64, 0
 v_mov_b32 v65, 0
 v_mov_b32 v66, 0
 v_mov_b32 v67, 0
 v_mov_b32 v68, 0
 v_mov_b32 v69, 0
 v_mov_b32 v70, 0
 v_mov_b32 v71, 0
 s_waitcnt vmcnt(6)
 buffer_store_dword v40, v41, s[8:11], s3 offen sc1
 s_waitcnt vmcnt(6)
 v_cmp_eq_u32 vcc, 1, v9
 s_mov_b32 s91, 65536
 s_mov_b32 s69, 0
 s_mov_b32 s70, vcc_lo
 s_mov_b32 s68, vcc_lo
 s_cmp_lg_u32 s70, 0
 s_cbranch_scc1 L_rk0
 s_call_b64 s[36:37], L_rpoll
L_rk0:
 s_ff1_i32_b32 s71, s70
 s_bitset0_b32 s70, s71
 s_cmp_ge_u32 s71, 16
 s_cselect_b32 s72, s78, s77
 s_cselect_b32 s73, 0x1, 0
 s_cselect_b32 s87, 536870912, 0
 s_mul_i32 s71, s71, 114688
 s_add_u32 s71, s71, s72
 buffer_load_dwordx4 v[128:131], v7, s[8:11], s71 offen sc1
 s_or_b32 s69, s69, s73
 s_or_b32 s71, s71, s87
 buffer_load_dwordx4 v[132:135], v27, s[8:11], s71 offen sc1
 s_cmp_lg_u32 s70, 0
 s_cbranch_scc1 L_rk1
 s_call_b64 s[36:37], L_rpoll
L_rk1:
 s_ff1_i32_b32 s71, s70
 s_bitset0_b32 s70, s71
 s_cmp_ge_u32 s71, 16
 s_cselect_b32 s72, s78, s77
 s_cselect_b32 s73, 0x2, 0
 s_cselect_b32 s87, 536870912, 0
 s_mul_i32 s71, s71, 114688
 s_add_u32 s71, s71, s72
 buffer_load_dwordx4 v[136:139], v7, s[8:11], s71 offen sc1
 s_or_b32 s69, s69, s73
 s_or_b32 s71, s71, s87
 buffer_load_dwordx4 v[140:143], v27, s[8:11], s71 offen sc1
 s_waitcnt vmcnt(8)
 v_lshlrev_b32 v32, 16, v16
 v_and_b32 v33, 0xffff0000, v16
 v_lshlrev_b32 v34, 16, v17
 v_and_b32 v35, 0xffff0000, v17
 v_lshlrev_b32 v36, 16, v18
 v_and_b32 v37, 0xffff0000, v18
 v_lshlrev_b32 v38, 16, v19
 v_and_b32 v39, 0xffff0000, v19
 s_waitcnt vmcnt(7)
 v_lshlrev_b32 v40, 16, v20
 v_and_b32 v41, 0xffff0000, v20
 v_lshlrev_b32 v42, 16, v21
 v_and_b32 v43, 0xffff0000, v21
 v_lshlrev_b32 v44, 16, v22
 v_and_b32 v45, 0xffff0000, v22
 v_lshlrev_b32 v46, 16, v23
 v_and_b32 v47, 0xffff0000, v23
 v_sub_f32 v13, 1.0, v15
 v_cmp_eq_u32 s[80:81], s84, v10
 v_cmp_eq_u32 s[82:83], s85, v10
 s_nop 0
 s_or_b64 vcc, s[80:81], s[82:83]
 s_cbranch_vccnz L_moe0
L_moe_ret0:
 v_mul_f32 v32, v13, v32
 v_mul_f32 v33, v13, v33
 v_mul_f32 v34, v13, v34
 v_mul_f32 v35, v13, v35
 v_mul_f32 v36, v13, v36
 v_mul_f32 v37, v13, v37
 v_mul_f32 v38, v13, v38
 v_mul_f32 v39, v13, v39
 v_mul_f32 v40, v13, v40
 v_mul_f32 v41, v13, v41
 v_mul_f32 v42, v13, v42
 v_mul_f32 v43, v13, v43
 v_mul_f32 v44, v13, v44
 v_mul_f32 v45, v13, v45
 v_mul_f32 v46, v13, v46
 v_mul_f32 v47, v13, v47
 s_cmp_lg_u32 s70, 0
 s_cbranch_scc1 L_rk2
 s_call_b64 s[36:37], L_rpoll
L_rk2:
 s_ff1_i32_b32 s71, s70
 s_bitset0_b32 s70, s71
 s_cmp_ge_u32 s71, 16
 s_cselect_b32 s72, s78, s77
 s_cselect_b32 s73, 0x4, 0
 s_cselect_b32 s87, 536870912, 0
 s_mul_i32 s71, s71, 114688
 s_add_u32 s71, s71, s72
 buffer_load_dwordx4 v[144:147], v7, s[8:11], s71 offen sc1
 s_or_b32 s69, s69, s73
 s_or_b32 s71, s71, s87
 buffer_load_dwordx4 v[148:151], v27, s[8:11], s71 offen sc1
 s_waitcnt vmcnt(7)
 v_lshlrev_b32 v80, 16, v96
 v_and_b32 v81, 0xffff0000, v96
 v_lshlrev_b32 v82, 16, v97
 v_and_b32 v83, 0xffff0000, v97
 v_lshlrev_b32 v84, 16, v98
 v_and_b32 v85, 0xffff0000, v98
 v_lshlrev_b32 v86, 16, v99
 v_and_b32 v87, 0xffff0000, v99
 v_sub_f32 v13, 1.0, v26
 v_cmp_eq_u32 s[80:81], s84, v29
 v_cmp_eq_u32 s[82:83], s85, v29
 s_nop 0
 s_or_b64 vcc, s[80:81], s[82:83]
 s_cbranch_vccnz L_moe1
L_moe_ret1:
 v_mul_f32 v80, v13, v80
 v_mul_f32 v81, v13, v81
 v_mul_f32 v82, v13, v82
 v_mul_f32 v83, v13, v83
 v_mul_f32 v84, v13, v84
 v_mul_f32 v85, v13, v85
 v_mul_f32 v86, v13, v86
 v_mul_f32 v87, v13, v87
 s_cmp_lg_u32 s70, 0
 s_cbranch_scc1 L_rk3
 s_call_b64 s[36:37], L_rpoll
L_rk3:
 s_ff1_i32_b32 s71, s70
 s_bitset0_b32 s70, s71
 s_cmp_ge_u32 s71, 16
 s_cselect_b32 s72, s78, s77
 s_cselect_b32 s73, 0x8, 0
 s_cselect_b32 s87, 536870912, 0
 s_mul_i32 s71, s71, 114688
 s_add_u32 s71, s71, s72
 buffer_load_dwordx4 v[152:155], v7, s[8:11], s71 offen sc1
 s_or_b32 s69, s69, s73
 s_or_b32 s71, s71, s87
 buffer_load_dwordx4 v[156:159], v27, s[8:11], s71 offen sc1
 s_cmp_lg_u32 s70, 0
 s_cbranch_scc1 L_rk4
 s_call_b64 s[36:37], L_rpoll
L_rk4:
 s_ff1_i32_b32 s71, s70
 s_bitset0_b32 s70, s71
 s_cmp_ge_u32 s71, 16
 s_cselect_b32 s72, s78, s77
 s_cselect_b32 s73, 0x10, 0
 s_cselect_b32 s87, 536870912, 0
 s_mul_i32 s71, s71, 114688
 s_add_u32 s71, s71, s72
 buffer_load_dwordx4 v[160:163], v7, s[8:11], s71 offen sc1
 s_or_b32 s69, s69, s73
 s_or_b32 s71, s71, s87
 buffer_load_dwordx4 v[164:167], v27, s[8:11], s71 offen sc1
 s_cmp_lg_u32 s70, 0
 s_cbranch_scc1 L_rk5
 s_call_b64 s[36:37], L_rpoll
L_rk5:
 s_ff1_i32_b32 s71, s70
 s_bitset0_b32 s70, s71
 s_cmp_ge_u32 s71, 16
 s_cselect_b32 s72, s78, s77
 s_cselect_b32 s73, 0x20, 0
 s_cselect_b32 s87, 536870912, 0
 s_mul_i32 s71, s71, 114688
 s_add_u32 s71, s71, s72
 buffer_load_dwordx4 v[168:171], v7, s[8:11], s71 offen sc1
 s_or_b32 s69, s69, s73
 s_or_b32 s71, s71, s87
 buffer_load_dwordx4 v[172:175], v27, s[8:11], s71 offen sc1
 s_cmp_lg_u32 s70, 0
 s_cbranch_scc1 L_rk6
 s_call_b64 s[36:37], L_rpoll
L_rk6:
 s_ff1_i32_b32 s71, s70
 s_bitset0_b32 s70, s71
 s_cmp_ge_u32 s71, 16
 s_cselect_b32 s72, s78, s77
 s_cselect_b32 s73, 0x40, 0
 s_cselect_b32 s87, 536870912, 0
 s_mul_i32 s71, s71, 114688
 s_add_u32 s71, s71, s72
 buffer_load_dwordx4 v[176:179], v7, s[8:11], s71 offen sc1
 s_or_b32 s69, s69, s73
 s_or_b32 s71, s71, s87
 buffer_load_dwordx4 v[180:183], v27, s[8:11], s71 offen sc1
 s_cmp_lg_u32 s70, 0
 s_cbranch_scc1 L_rk7
 s_call_b64 s[36:37], L_rpoll
L_rk7:
 s_ff1_i32_b32 s71, s70
 s_bitset0_b32 s70, s71
 s_cmp_ge_u32 s71, 16
 s_cselect_b32 s72, s78, s77
 s_cselect_b32 s73, 0x80, 0
 s_cselect_b32 s87, 536870912, 0
 s_mul_i32 s71, s71, 114688
 s_add_u32 s71, s71, s72
 buffer_load_dwordx4 v[184:187], v7, s[8:11], s71 offen sc1
 s_or_b32 s69, s69, s73
 s_or_b32 s71, s71, s87
 buffer_load_dwordx4 v[188:191], v27, s[8:11], s71 offen sc1
 s_cmp_lg_u32 s70, 0
 s_cbranch_scc1 L_rk8
 s_call_b64 s[36:37], L_rpoll
L_rk8:
 s_ff1_i32_b32 s71, s70
 s_bitset0_b32 s70, s71
 s_cmp_ge_u32 s71, 16
 s_cselect_b32 s72, s78, s77
 s_cselect_b32 s73, 0x100, 0
 s_cselect_b32 s87, 536870912, 0
 s_mul_i32 s71, s71, 114688
 s_add_u32 s71, s71, s72
 buffer_load_dwordx4 v[192:195], v7, s[8:11], s71 offen sc1
 s_or_b32 s69, s69, s73
 s_or_b32 s71, s71, s87
 buffer_load_dwordx4 v[196:199], v27, s[8:11], s71 offen sc1
 s_waitcnt vmcnt(16)
 s_bitcmp1_b32 s69, 0
 s_cbranch_scc1 L_rx0
 v_dot2c_f32_bf16 v48, v128, v24
 v_dot2c_f32_bf16 v49, v128, v25
 v_dot2c_f32_bf16 v50, v129, v24
 v_dot2c_f32_bf16 v51, v129, v25
 v_dot2c_f32_bf16 v52, v130, v24
 v_dot2c_f32_bf16 v53, v130, v25
 v_dot2c_f32_bf16 v54, v131, v24
 v_dot2c_f32_bf16 v55, v131, v25
 v_dot2c_f32_bf16 v56, v132, v24
 v_dot2c_f32_bf16 v57, v132, v25
 v_dot2c_f32_bf16 v58, v133, v24
 v_dot2c_f32_bf16 v59, v133, v25
 v_dot2c_f32_bf16 v60, v134, v24
 v_dot2c_f32_bf16 v61, v134, v25
 v_dot2c_f32_bf16 v62, v135, v24
 v_dot2c_f32_bf16 v63, v135, v25
L_ry0:
 s_cmp_lg_u32 s70, 0
 s_cbranch_scc1 L_rk9
 s_call_b64 s[36:37], L_rpoll
L_rk9:
 s_ff1_i32_b32 s71, s70
 s_bitset0_b32 s70, s71
 s_cmp_ge_u32 s71, 16
 s_cselect_b32 s72, s78, s77
 s_cselect_b32 s73, 0x200, 0
 s_cselect_b32 s87, 536870912, 0
 s_mul_i32 s71, s71, 114688
 s_add_u32 s71, s71, s72
 buffer_load_dwordx4 v[200:203], v7, s[8:11], s71 offen sc1
 s_or_b32 s69, s69, s73
 s_or_b32 s71, s71, s87
 buffer_load_dwordx4 v[204:207], v27, s[8:11], s71 offen sc1
 s_waitcnt vmcnt(16)
 s_bitcmp1_b32 s69, 1
 s_cbranch_scc1 L_rx1
 v_dot2c_f32_bf16 v48, v136, v24
 v_dot2c_f32_bf16 v49, v136, v25
 v_dot2c_f32_bf16 v50, v137, v24
 v_dot2c_f32_bf16 v51, v137, v25
 v_dot2c_f32_bf16 v52, v138, v24
 v_dot2c_f32_bf16 v53, v138, v25
 v_dot2c_f32_bf16 v54, v139, v24
 v_dot2c_f32_bf16 v55, v139, v25
 v_dot2c_f32_bf16 v56, v140, v24
 v_dot2c_f32_bf16 v57, v140, v25
 v_dot2c_f32_bf16 v58, v141, v24
 v_dot2c_f32_bf16 v59, v141, v25
 v_dot2c_f32_bf16 v60, v142, v24
 v_dot2c_f32_bf16 v61, v142, v25
 v_dot2c_f32_bf16 v62, v143, v24
 v_dot2c_f32_bf16 v63, v143, v25
L_ry1:
 s_cmp_lg_u32 s70, 0
 s_cbranch_scc1 L_rk10
 s_call_b64 s[36:37], L_rpoll
L_rk10:
 s_ff1_i32_b32 s71, s70
 s_bitset0_b32 s70, s71
 s_cmp_ge_u32 s71, 16
 s_cselect_b32 s72, s78, s77
 s_cselect_b32 s73, 0x400, 0
 s_cselect_b32 s87, 536870912, 0
 s_mul_i32 s71, s71, 114688
 s_add_u32 s71, s71, s72
 buffer_load_dwordx4 v[208:211], v7, s[8:11], s71 offen sc1
 s_or_b32 s69, s69, s73
 s_or_b32 s71, s71, s87
 buffer_load_dwordx4 v[212:215], v27, s[8:11], s71 offen sc1
 s_waitcnt vmcnt(16)
 s_bitcmp1_b32 s69, 2
 s_cbranch_scc1 L_rx2
 v_dot2c_f32_bf16 v48, v144, v24
 v_dot2c_f32_bf16 v49, v144, v25
 v_dot2c_f32_bf16 v50, v145, v24
 v_dot2c_f32_bf16 v51, v145, v25
 v_dot2c_f32_bf16 v52, v146, v24
 v_dot2c_f32_bf16 v53, v146, v25
 v_dot2c_f32_bf16 v54, v147, v24
 v_dot2c_f32_bf16 v55, v147, v25
 v_dot2c_f32_bf16 v56, v148, v24
 v_dot2c_f32_bf16 v57, v148, v25
 v_dot2c_f32_bf16 v58, v149, v24
 v_dot2c_f32_bf16 v59, v149, v25
 v_dot2c_f32_bf16 v60, v150, v24
 v_dot2c_f32_bf16 v61, v150, v25
 v_dot2c_f32_bf16 v62, v151, v24
 v_dot2c_f32_bf16 v63, v151, v25
L_ry2:
 s_cmp_lg_u32 s70, 0
 s_cbranch_scc1 L_rk11
 s_call_b64 s[36:37], L_rpoll
L_rk11:
 s_ff1_i32_b32 s71, s70
 s_bitset0_b32 s70, s71
 s_cmp_ge_u32 s71, 16
 s_cselect_b32 s72, s78, s77
 s_cselect_b32 s73, 0x800, 0
 s_cselect_b32 s87, 536870912, 0
 s_mul_i32 s71, s71, 114688
 s_add_u32 s71, s71, s72
 buffer_load_dwordx4 v[216:219], v7, s[8:11], s71 offen sc1
 s_or_b32 s69, s69, s73
 s_or_b32 s71, s71, s87
 buffer_load_dwordx4 v[220:223], v27, s[8:11], s71 offen sc1
 s_waitcnt vmcnt(16)
 s_bitcmp1_b32 s69, 3
 s_cbranch_scc1 L_rx3
 v_dot2c_f32_bf16 v48, v152, v24
 v_dot2c_f32_bf16 v49, v152, v25
 v_dot2c_f32_bf16 v50, v153, v24
 v_dot2c_f32_bf16 v51, v153, v25
 v_dot2c_f32_bf16 v52, v154, v24
 v_dot2c_f32_bf16 v53, v154, v25
 v_dot2c_f32_bf16 v54, v155, v24
 v_dot2c_f32_bf16 v55, v155, v25
 v_dot2c_f32_bf16 v56, v156, v24
 v_dot2c_f32_bf16 v57, v156, v25
 v_dot2c_f32_bf16 v58, v157, v24
 v_dot2c_f32_bf16 v59, v157, v25
 v_dot2c_f32_bf16 v60, v158, v24
 v_dot2c_f32_bf16 v61, v158, v25
 v_dot2c_f32_bf16 v62, v159, v24
 v_dot2c_f32_bf16 v63, v159, v25
L_ry3:
 s_cmp_lg_u32 s70, 0
 s_cbranch_scc1 L_rk12
 s_call_b64 s[36:37], L_rpoll
L_rk12:
 s_ff1_i32_b32 s71, s70
 s_bitset0_b32 s70, s71
 s_cmp_ge_u32 s71, 16
 s_cselect_b32 s72, s78, s77
 s_cselect_b32 s73, 0x1000, 0
 s_cselect_b32 s87, 536870912, 0
 s_mul_i32 s71, s71, 114688
 s_add_u32 s71, s71, s72
 buffer_load_dwordx4 v[224:227], v7, s[8:11], s71 offen sc1
 s_or_b32 s69, s69, s73
 s_or_b32 s71, s71, s87
 buffer_load_dwordx4 v[228:231], v27, s[8:11], s71 offen sc1
 s_waitcnt vmcnt(16)
 s_bitcmp1_b32 s69, 4
 s_cbranch_scc1 L_rx4
 v_dot2c_f32_bf16 v48, v160, v24
 v_dot2c_f32_bf16 v49, v160, v25
 v_dot2c_f32_bf16 v50, v161, v24
 v_dot2c_f32_bf16 v51, v161, v25
 v_dot2c_f32_bf16 v52, v162, v24
 v_dot2c_f32_bf16 v53, v162, v25
 v_dot2c_f32_bf16 v54, v163, v24
 v_dot2c_f32_bf16 v55, v163, v25
 v_dot2c_f32_bf16 v56, v164, v24
 v_dot2c_f32_bf16 v57, v164, v25
 v_dot2c_f32_bf16 v58, v165, v24
 v_dot2c_f32_bf16 v59, v165, v25
 v_dot2c_f32_bf16 v60, v166, v24
 v_dot2c_f32_bf16 v61, v166, v25
 v_dot2c_f32_bf16 v62, v167, v24
 v_dot2c_f32_bf16 v63, v167, v25
L_ry4:
 s_cmp_lg_u32 s70, 0
 s_cbranch_scc1 L_rk13
 s_call_b64 s[36:37], L_rpoll
L_rk13:
 s_ff1_i32_b32 s71, s70
 s_bitset0_b32 s70, s71
 s_cmp_ge_u32 s71, 16
 s_cselect_b32 s72, s78, s77
 s_cselect_b32 s73, 0x2000, 0
 s_cselect_b32 s87, 536870912, 0
 s_mul_i32 s71, s71, 114688
 s_add_u32 s71, s71, s72
 buffer_load_dwordx4 v[232:235], v7, s[8:11], s71 offen sc1
 s_or_b32 s69, s69, s73
 s_or_b32 s71, s71, s87
 buffer_load_dwordx4 v[236:239], v27, s[8:11], s71 offen sc1
 s_waitcnt vmcnt(16)
 s_bitcmp1_b32 s69, 5
 s_cbranch_scc1 L_rx5
 v_dot2c_f32_bf16 v48, v168, v24
 v_dot2c_f32_bf16 v49, v168, v25
 v_dot2c_f32_bf16 v50, v169, v24
 v_dot2c_f32_bf16 v51, v169, v25
 v_dot2c_f32_bf16 v52, v170, v24
 v_dot2c_f32_bf16 v53, v170, v25
 v_dot2c_f32_bf16 v54, v171, v24
 v_dot2c_f32_bf16 v55, v171, v25
 v_dot2c_f32_bf16 v56, v172, v24
 v_dot2c_f32_bf16 v57, v172, v25
 v_dot2c_f32_bf16 v58, v173, v24
 v_dot2c_f32_bf16 v59, v173, v25
 v_dot2c_f32_bf16 v60, v174, v24
 v_dot2c_f32_bf16 v61, v174, v25
 v_dot2c_f32_bf16 v62, v175, v24
 v_dot2c_f32_bf16 v63, v175, v25
L_ry5:
 s_cmp_lg_u32 s70, 0
 s_cbranch_scc1 L_rk14
 s_call_b64 s[36:37], L_rpoll
L_rk14:
 s_ff1_i32_b32 s71, s70
 s_bitset0_b32 s70, s71
 s_cmp_ge_u32 s71, 16
 s_cselect_b32 s72, s78, s77
 s_cselect_b32 s73, 0x4000, 0
 s_cselect_b32 s87, 536870912, 0
 s_mul_i32 s71, s71, 114688
 s_add_u32 s71, s71, s72
 buffer_load_dwordx4 v[240:243], v7, s[8:11], s71 offen sc1
 s_or_b32 s69, s69, s73
 s_or_b32 s71, s71, s87
 buffer_load_dwordx4 v[244:247], v27, s[8:11], s71 offen sc1
 s_waitcnt vmcnt(16)
 s_bitcmp1_b32 s69, 6
 s_cbranch_scc1 L_rx6
 v_dot2c_f32_bf16 v48, v176, v24
 v_dot2c_f32_bf16 v49, v176, v25
 v_dot2c_f32_bf16 v50, v177, v24
 v_dot2c_f32_bf16 v51, v177, v25
 v_dot2c_f32_bf16 v52, v178, v24
 v_dot2c_f32_bf16 v53, v178, v25
 v_dot2c_f32_bf16 v54, v179, v24
 v_dot2c_f32_bf16 v55, v179, v25
 v_dot2c_f32_bf16 v56, v180, v24
 v_dot2c_f32_bf16 v57, v180, v25
 v_dot2c_f32_bf16 v58, v181, v24
 v_dot2c_f32_bf16 v59, v181, v25
 v_dot2c_f32_bf16 v60, v182, v24
 v_dot2c_f32_bf16 v61, v182, v25
 v_dot2c_f32_bf16 v62, v183, v24
 v_dot2c_f32_bf16 v63, v183, v25
L_ry6:
 s_cmp_lg_u32 s70, 0
 s_cbranch_scc1 L_rk15
 s_call_b64 s[36:37], L_rpoll
L_rk15:
 s_ff1_i32_b32 s71, s70
 s_bitset0_b32 s70, s71
 s_cmp_ge_u32 s71, 16
 s_cselect_b32 s72, s78, s77
 s_cselect_b32 s73, 0x8000, 0
 s_cselect_b32 s87, 536870912, 0
 s_mul_i32 s71, s71, 114688
 s_add_u32 s71, s71, s72
 buffer_load_dwordx4 v[248:251], v7, s[8:11], s71 offen sc1
 s_or_b32 s69, s69, s73
 s_or_b32 s71, s71, s87
 buffer_load_dwordx4 v[252:255], v27, s[8:11], s71 offen sc1
 s_waitcnt vmcnt(16)
 s_bitcmp1_b32 s69, 7
 s_cbranch_scc1 L_rx7
 v_dot2c_f32_bf16 v48, v184, v24
 v_dot2c_f32_bf16 v49, v184, v25
 v_dot2c_f32_bf16 v50, v185, v24
 v_dot2c_f32_bf16 v51, v185, v25
 v_dot2c_f32_bf16 v52, v186, v24
 v_dot2c_f32_bf16 v53, v186, v25
 v_dot2c_f32_bf16 v54, v187, v24
 v_dot2c_f32_bf16 v55, v187, v25
 v_dot2c_f32_bf16 v56, v188, v24
 v_dot2c_f32_bf16 v57, v188, v25
 v_dot2c_f32_bf16 v58, v189, v24
 v_dot2c_f32_bf16 v59, v189, v25
 v_dot2c_f32_bf16 v60, v190, v24
 v_dot2c_f32_bf16 v61, v190, v25
 v_dot2c_f32_bf16 v62, v191, v24
 v_dot2c_f32_bf16 v63, v191, v25
L_ry7:
 s_cmp_lg_u32 s70, 0
 s_cbranch_scc1 L_rk16
 s_call_b64 s[36:37], L_rpoll
L_rk16:
 s_ff1_i32_b32 s71, s70
 s_bitset0_b32 s70, s71
 s_cmp_ge_u32 s71, 16
 s_cselect_b32 s72, s78, s77
 s_cselect_b32 s73, 0x10000, 0
 s_cselect_b32 s87, 536870912, 0
 s_mul_i32 s71, s71, 114688
 s_add_u32 s71, s71, s72
 buffer_load_dwordx4 v[128:131], v7, s[8:11], s71 offen sc1
 s_or_b32 s69, s69, s73
 s_or_b32 s71, s71, s87
 buffer_load_dwordx4 v[132:135], v27, s[8:11], s71 offen sc1
 s_waitcnt vmcnt(16)
 s_bitcmp1_b32 s69, 8
 s_cbranch_scc1 L_rx8
 v_dot2c_f32_bf16 v48, v192, v24
 v_dot2c_f32_bf16 v49, v192, v25
 v_dot2c_f32_bf16 v50, v193, v24
 v_dot2c_f32_bf16 v51, v193, v25
 v_dot2c_f32_bf16 v52, v194, v24
 v_dot2c_f32_bf16 v53, v194, v25
 v_dot2c_f32_bf16 v54, v195, v24
 v_dot2c_f32_bf16 v55, v195, v25
 v_dot2c_f32_bf16 v56, v196, v24
 v_dot2c_f32_bf16 v57, v196, v25
 v_dot2c_f32_bf16 v58, v197, v24
 v_dot2c_f32_bf16 v59, v197, v25
 v_dot2c_f32_bf16 v60, v198, v24
 v_dot2c_f32_bf16 v61, v198, v25
 v_dot2c_f32_bf16 v62, v199, v24
 v_dot2c_f32_bf16 v63, v199, v25
L_ry8:
 s_cmp_lg_u32 s70, 0
 s_cbranch_scc1 L_rk17
 s_call_b64 s[36:37], L_rpoll
L_rk17:
 s_ff1_i32_b32 s71, s70
 s_bitset0_b32 s70, s71
 s_cmp_ge_u32 s71, 16
 s_cselect_b32 s72, s78, s77
 s_cselect_b32 s73, 0x20000, 0
 s_cselect_b32 s87, 536870912, 0
 s_mul_i32 s71, s71, 114688
 s_add_u32 s71, s71, s72
 buffer_load_dwordx4 v[136:139], v7, s[8:11], s71 offen sc1
 s_or_b32 s69, s69, s73
 s_or_b32 s71, s71, s87
 buffer_load_dwordx4 v[140:143], v27, s[8:11], s71 offen sc1
 s_waitcnt vmcnt(16)
 s_bitcmp1_b32 s69, 9
 s_cbranch_scc1 L_rx9
 v_dot2c_f32_bf16 v48, v200, v24
 v_dot2c_f32_bf16 v49, v200, v25
 v_dot2c_f32_bf16 v50, v201, v24
 v_dot2c_f32_bf16 v51, v201, v25
 v_dot2c_f32_bf16 v52, v202, v24
 v_dot2c_f32_bf16 v53, v202, v25
 v_dot2c_f32_bf16 v54, v203, v24
 v_dot2c_f32_bf16 v55, v203, v25
 v_dot2c_f32_bf16 v56, v204, v24
 v_dot2c_f32_bf16 v57, v204, v25
 v_dot2c_f32_bf16 v58, v205, v24
 v_dot2c_f32_bf16 v59, v205, v25
 v_dot2c_f32_bf16 v60, v206, v24
 v_dot2c_f32_bf16 v61, v206, v25
 v_dot2c_f32_bf16 v62, v207, v24
 v_dot2c_f32_bf16 v63, v207, v25
L_ry9:
 s_cmp_lg_u32 s70, 0
 s_cbranch_scc1 L_rk18
 s_call_b64 s[36:37], L_rpoll
L_rk18:
 s_ff1_i32_b32 s71, s70
 s_bitset0_b32 s70, s71
 s_cmp_ge_u32 s71, 16
 s_cselect_b32 s72, s78, s77
 s_cselect_b32 s73, 0x40000, 0
 s_cselect_b32 s87, 536870912, 0
 s_mul_i32 s71, s71, 114688
 s_add_u32 s71, s71, s72
 buffer_load_dwordx4 v[144:147], v7, s[8:11], s71 offen sc1
 s_or_b32 s69, s69, s73
 s_or_b32 s71, s71, s87
 buffer_load_dwordx4 v[148:151], v27, s[8:11], s71 offen sc1
 s_waitcnt vmcnt(16)
 s_bitcmp1_b32 s69, 10
 s_cbranch_scc1 L_rx10
 v_dot2c_f32_bf16 v48, v208, v24
 v_dot2c_f32_bf16 v49, v208, v25
 v_dot2c_f32_bf16 v50, v209, v24
 v_dot2c_f32_bf16 v51, v209, v25
 v_dot2c_f32_bf16 v52, v210, v24
 v_dot2c_f32_bf16 v53, v210, v25
 v_dot2c_f32_bf16 v54, v211, v24
 v_dot2c_f32_bf16 v55, v211, v25
 v_dot2c_f32_bf16 v56, v212, v24
 v_dot2c_f32_bf16 v57, v212, v25
 v_dot2c_f32_bf16 v58, v213, v24
 v_dot2c_f32_bf16 v59, v213, v25
 v_dot2c_f32_bf16 v60, v214, v24
 v_dot2c_f32_bf16 v61, v214, v25
 v_dot2c_f32_bf16 v62, v215, v24
 v_dot2c_f32_bf16 v63, v215, v25
L_ry10:
 s_cmp_lg_u32 s70, 0
 s_cbranch_scc1 L_rk19
 s_call_b64 s[36:37], L_rpoll
L_rk19:
 s_ff1_i32_b32 s71, s70
 s_bitset0_b32 s70, s71
 s_cmp_ge_u32 s71, 16
 s_cselect_b32 s72, s78, s77
 s_cselect_b32 s73, 0x80000, 0
 s_cselect_b32 s87, 536870912, 0
 s_mul_i32 s71, s71, 114688
 s_add_u32 s71, s71, s72
 buffer_load_dwordx4 v[152:155], v7, s[8:11], s71 offen sc1
 s_or_b32 s69, s69, s73
 s_or_b32 s71, s71, s87
 buffer_load_dwordx4 v[156:159], v27, s[8:11], s71 offen sc1
 s_waitcnt vmcnt(16)
 s_bitcmp1_b32 s69, 11
 s_cbranch_scc1 L_rx11
 v_dot2c_f32_bf16 v48, v216, v24
 v_dot2c_f32_bf16 v49, v216, v25
 v_dot2c_f32_bf16 v50, v217, v24
 v_dot2c_f32_bf16 v51, v217, v25
 v_dot2c_f32_bf16 v52, v218, v24
 v_dot2c_f32_bf16 v53, v218, v25
 v_dot2c_f32_bf16 v54, v219, v24
 v_dot2c_f32_bf16 v55, v219, v25
 v_dot2c_f32_bf16 v56, v220, v24
 v_dot2c_f32_bf16 v57, v220, v25
 v_dot2c_f32_bf16 v58, v221, v24
 v_dot2c_f32_bf16 v59, v221, v25
 v_dot2c_f32_bf16 v60, v222, v24
 v_dot2c_f32_bf16 v61, v222, v25
 v_dot2c_f32_bf16 v62, v223, v24
 v_dot2c_f32_bf16 v63, v223, v25
L_ry11:
 s_cmp_lg_u32 s70, 0
 s_cbranch_scc1 L_rk20
 s_call_b64 s[36:37], L_rpoll
L_rk20:
 s_ff1_i32_b32 s71, s70
 s_bitset0_b32 s70, s71
 s_cmp_ge_u32 s71, 16
 s_cselect_b32 s72, s78, s77
 s_cselect_b32 s73, 0x100000, 0
 s_cselect_b32 s87, 536870912, 0
 s_mul_i32 s71, s71, 114688
 s_add_u32 s71, s71, s72
 buffer_load_dwordx4 v[160:163], v7, s[8:11], s71 offen sc1
 s_or_b32 s69, s69, s73
 s_or_b32 s71, s71, s87
 buffer_load_dwordx4 v[164:167], v27, s[8:11], s71 offen sc1
 s_waitcnt vmcnt(16)
 s_bitcmp1_b32 s69, 12
 s_cbranch_scc1 L_rx12
 v_dot2c_f32_bf16 v48, v224, v24
 v_dot2c_f32_bf16 v49, v224, v25
 v_dot2c_f32_bf16 v50, v225, v24
 v_dot2c_f32_bf16 v51, v225, v25
 v_dot2c_f32_bf16 v52, v226, v24
 v_dot2c_f32_bf16 v53, v226, v25
 v_dot2c_f32_bf16 v54, v227, v24
 v_dot2c_f32_bf16 v55, v227, v25
 v_dot2c_f32_bf16 v56, v228, v24
 v_dot2c_f32_bf16 v57, v228, v25
 v_dot2c_f32_bf16 v58, v229, v24
 v_dot2c_f32_bf16 v59, v229, v25
 v_dot2c_f32_bf16 v60, v230, v24
 v_dot2c_f32_bf16 v61, v230, v25
 v_dot2c_f32_bf16 v62, v231, v24
 v_dot2c_f32_bf16 v63, v231, v25
L_ry12:
 s_cmp_lg_u32 s70, 0
 s_cbranch_scc1 L_rk21
 s_call_b64 s[36:37], L_rpoll
L_rk21:
 s_ff1_i32_b32 s71, s70
 s_bitset0_b32 s70, s71
 s_cmp_ge_u32 s71, 16
 s_cselect_b32 s72, s78, s77
 s_cselect_b32 s73, 0x200000, 0
 s_cselect_b32 s87, 536870912, 0
 s_mul_i32 s71, s71, 114688
 s_add_u32 s71, s71, s72
 buffer_load_dwordx4 v[168:171], v7, s[8:11], s71 offen sc1
 s_or_b32 s69, s69, s73
 s_or_b32 s71, s71, s87
 buffer_load_dwordx4 v[172:175], v27, s[8:11], s71 offen sc1
 s_waitcnt vmcnt(16)
 s_bitcmp1_b32 s69, 13
 s_cbranch_scc1 L_rx13
 v_dot2c_f32_bf16 v48, v232, v24
 v_dot2c_f32_bf16 v49, v232, v25
 v_dot2c_f32_bf16 v50, v233, v24
 v_dot2c_f32_bf16 v51, v233, v25
 v_dot2c_f32_bf16 v52, v234, v24
 v_dot2c_f32_bf16 v53, v234, v25
 v_dot2c_f32_bf16 v54, v235, v24
 v_dot2c_f32_bf16 v55, v235, v25
 v_dot2c_f32_bf16 v56, v236, v24
 v_dot2c_f32_bf16 v57, v236, v25
 v_dot2c_f32_bf16 v58, v237, v24
 v_dot2c_f32_bf16 v59, v237, v25
 v_dot2c_f32_bf16 v60, v238, v24
 v_dot2c_f32_bf16 v61, v238, v25
 v_dot2c_f32_bf16 v62, v239, v24
 v_dot2c_f32_bf16 v63, v239, v25
L_ry13:
 s_cmp_lg_u32 s70, 0
 s_cbranch_scc1 L_rk22
 s_call_b64 s[36:37], L_rpoll
L_rk22:
 s_ff1_i32_b32 s71, s70
 s_bitset0_b32 s70, s71
 s_cmp_ge_u32 s71, 16
 s_cselect_b32 s72, s78, s77
 s_cselect_b32 s73, 0x400000, 0
 s_cselect_b32 s87, 536870912, 0
 s_mul_i32 s71, s71, 114688
 s_add_u32 s71, s71, s72
 buffer_load_dwordx4 v[176:179], v7, s[8:11], s71 offen sc1
 s_or_b32 s69, s69, s73
 s_or_b32 s71, s71, s87
 buffer_load_dwordx4 v[180:183], v27, s[8:11], s71 offen sc1
 s_waitcnt vmcnt(16)
 s_bitcmp1_b32 s69, 14
 s_cbranch_scc1 L_rx14
 v_dot2c_f32_bf16 v48, v240, v24
 v_dot2c_f32_bf16 v49, v240, v25
 v_dot2c_f32_bf16 v50, v241, v24
 v_dot2c_f32_bf16 v51, v241, v25
 v_dot2c_f32_bf16 v52, v242, v24
 v_dot2c_f32_bf16 v53, v242, v25
 v_dot2c_f32_bf16 v54, v243, v24
 v_dot2c_f32_bf16 v55, v243, v25
 v_dot2c_f32_bf16 v56, v244, v24
 v_dot2c_f32_bf16 v57, v244, v25
 v_dot2c_f32_bf16 v58, v245, v24
 v_dot2c_f32_bf16 v59, v245, v25
 v_dot2c_f32_bf16 v60, v246, v24
 v_dot2c_f32_bf16 v61, v246, v25
 v_dot2c_f32_bf16 v62, v247, v24
 v_dot2c_f32_bf16 v63, v247, v25
L_ry14:
 s_cmp_lg_u32 s70, 0
 s_cbranch_scc1 L_rk23
 s_call_b64 s[36:37], L_rpoll
L_rk23:
 s_ff1_i32_b32 s71, s70
 s_bitset0_b32 s70, s71
 s_cmp_ge_u32 s71, 16
 s_cselect_b32 s72, s78, s77
 s_cselect_b32 s73, 0x800000, 0
 s_cselect_b32 s87, 536870912, 0
 s_mul_i32 s71, s71, 114688
 s_add_u32 s71, s71, s72
 buffer_load_dwordx4 v[184:187], v7, s[8:11], s71 offen sc1
 s_or_b32 s69, s69, s73
 s_or_b32 s71, s71, s87
 buffer_load_dwordx4 v[188:191], v27, s[8:11], s71 offen sc1
 s_waitcnt vmcnt(16)
 s_bitcmp1_b32 s69, 15
 s_cbranch_scc1 L_rx15
 v_dot2c_f32_bf16 v48, v248, v24
 v_dot2c_f32_bf16 v49, v248, v25
 v_dot2c_f32_bf16 v50, v249, v24
 v_dot2c_f32_bf16 v51, v249, v25
 v_dot2c_f32_bf16 v52, v250, v24
 v_dot2c_f32_bf16 v53, v250, v25
 v_dot2c_f32_bf16 v54, v251, v24
 v_dot2c_f32_bf16 v55, v251, v25
 v_dot2c_f32_bf16 v56, v252, v24
 v_dot2c_f32_bf16 v57, v252, v25
 v_dot2c_f32_bf16 v58, v253, v24
 v_dot2c_f32_bf16 v59, v253, v25
 v_dot2c_f32_bf16 v60, v254, v24
 v_dot2c_f32_bf16 v61, v254, v25
 v_dot2c_f32_bf16 v62, v255, v24
 v_dot2c_f32_bf16 v63, v255, v25
L_ry15:
 s_cmp_lg_u32 s70, 0
 s_cbranch_scc1 L_rk24
 s_call_b64 s[36:37], L_rpoll
L_rk24:
 s_ff1_i32_b32 s71, s70
 s_bitset0_b32 s70, s71
 s_cmp_ge_u32 s71, 16
 s_cselect_b32 s72, s78, s77
 s_cselect_b32 s73, 0x1000000, 0
 s_cselect_b32 s87, 536870912, 0
 s_mul_i32 s71, s71, 114688
 s_add_u32 s71, s71, s72
 buffer_load_dwordx4 v[192:195], v7, s[8:11], s71 offen sc1
 s_or_b32 s69, s69, s73
 s_or_b32 s71, s71, s87
 buffer_load_dwordx4 v[196:199], v27, s[8:11], s71 offen sc1
 s_waitcnt vmcnt(16)
 s_bitcmp0_b32 s69, 16
 s_cbranch_scc1 L_rx16
 v_dot2c_f32_bf16 v64, v128, v24
 v_dot2c_f32_bf16 v65, v128, v25
 v_dot2c_f32_bf16 v66, v129, v24
 v_dot2c_f32_bf16 v67, v129, v25
 v_dot2c_f32_bf16 v68, v130, v24
 v_dot2c_f32_bf16 v69, v130, v25
 v_dot2c_f32_bf16 v70, v131, v24
 v_dot2c_f32_bf16 v71, v131, v25
L_ry16:
 s_cmp_lg_u32 s70, 0
 s_cbranch_scc1 L_rk25
 s_call_b64 s[36:37], L_rpoll
L_rk25:
 s_ff1_i32_b32 s71, s70
 s_bitset0_b32 s70, s71
 s_cmp_ge_u32 s71, 16
 s_cselect_b32 s72, s78, s77
 s_cselect_b32 s73, 0x2000000, 0
 s_cselect_b32 s87, 536870912, 0
 s_mul_i32 s71, s71, 114688
 s_add_u32 s71, s71, s72
 buffer_load_dwordx4 v[200:203], v7, s[8:11], s71 offen sc1
 s_or_b32 s69, s69, s73
 s_or_b32 s71, s71, s87
 buffer_load_dwordx4 v[204:207], v27, s[8:11], s71 offen sc1
 s_waitcnt vmcnt(16)
 s_bitcmp0_b32 s69, 17
 s_cbranch_scc1 L_rx17
 v_dot2c_f32_bf16 v64, v136, v24
 v_dot2c_f32_bf16 v65, v136, v25
 v_dot2c_f32_bf16 v66, v137, v24
 v_dot2c_f32_bf16 v67, v137, v25
 v_dot2c_f32_bf16 v68, v138, v24
 v_dot2c_f32_bf16 v69, v138, v25
 v_dot2c_f32_bf16 v70, v139, v24
 v_dot2c_f32_bf16 v71, v139, v25
L_ry17:
 s_cmp_lg_u32 s70, 0
 s_cbranch_scc1 L_rk26
 s_call_b64 s[36:37], L_rpoll
L_rk26:
 s_ff1_i32_b32 s71, s70
 s_bitset0_b32 s70, s71
 s_cmp_ge_u32 s71, 16
 s_cselect_b32 s72, s78, s77
 s_cselect_b32 s73, 0x4000000, 0
 s_cselect_b32 s87, 536870912, 0
 s_mul_i32 s71, s71, 114688
 s_add_u32 s71, s71, s72
 buffer_load_dwordx4 v[208:211], v7, s[8:11], s71 offen sc1
 s_or_b32 s69, s69, s73
 s_or_b32 s71, s71, s87
 buffer_load_dwordx4 v[212:215], v27, s[8:11], s71 offen sc1
 s_waitcnt vmcnt(16)
 s_bitcmp0_b32 s69, 18
 s_cbranch_scc1 L_rx18
 v_dot2c_f32_bf16 v64, v144, v24
 v_dot2c_f32_bf16 v65, v144, v25
 v_dot2c_f32_bf16 v66, v145, v24
 v_dot2c_f32_bf16 v67, v145, v25
 v_dot2c_f32_bf16 v68, v146, v24
 v_dot2c_f32_bf16 v69, v146, v25
 v_dot2c_f32_bf16 v70, v147, v24
 v_dot2c_f32_bf16 v71, v147, v25
L_ry18:
 s_cmp_lg_u32 s70, 0
 s_cbranch_scc1 L_rk27
 s_call_b64 s[36:37], L_rpoll
L_rk27:
 s_ff1_i32_b32 s71, s70
 s_bitset0_b32 s70, s71
 s_cmp_ge_u32 s71, 16
 s_cselect_b32 s72, s78, s77
 s_cselect_b32 s73, 0x8000000, 0
 s_cselect_b32 s87, 536870912, 0
 s_mul_i32 s71, s71, 114688
 s_add_u32 s71, s71, s72
 buffer_load_dwordx4 v[216:219], v7, s[8:11], s71 offen sc1
 s_or_b32 s69, s69, s73
 s_or_b32 s71, s71, s87
 buffer_load_dwordx4 v[220:223], v27, s[8:11], s71 offen sc1
 s_waitcnt vmcnt(16)
 s_bitcmp0_b32 s69, 19
 s_cbranch_scc1 L_rx19
 v_dot2c_f32_bf16 v64, v152, v24
 v_dot2c_f32_bf16 v65, v152, v25
 v_dot2c_f32_bf16 v66, v153, v24
 v_dot2c_f32_bf16 v67, v153, v25
 v_dot2c_f32_bf16 v68, v154, v24
 v_dot2c_f32_bf16 v69, v154, v25
 v_dot2c_f32_bf16 v70, v155, v24
 v_dot2c_f32_bf16 v71, v155, v25
L_ry19:
 s_and_b32 s71, s69, 0xfffff
 s_bcnt1_i32_b32 s71, s71
 s_cmp_eq_u32 s71, 4
 s_cselect_b32 s66, 1, 0
 s_cbranch_scc0 L_rne
 v_fmac_f32 v32, v15, v48
 v_fmac_f32 v33, v15, v49
 v_fmac_f32 v34, v15, v50
 v_fmac_f32 v35, v15, v51
 v_fmac_f32 v36, v15, v52
 v_fmac_f32 v37, v15, v53
 v_fmac_f32 v38, v15, v54
 v_fmac_f32 v39, v15, v55
 v_cvt_pk_bf16_f32 v16, v32, v33
 v_cvt_pk_bf16_f32 v17, v34, v35
 v_cvt_pk_bf16_f32 v18, v36, v37
 v_cvt_pk_bf16_f32 v19, v38, v39
 buffer_store_dwordx4 v[16:19], v12, s[52:55], s75 offen sc1
 v_fmac_f32 v40, v15, v56
 v_fmac_f32 v41, v15, v57
 v_fmac_f32 v42, v15, v58
 v_fmac_f32 v43, v15, v59
 v_fmac_f32 v44, v15, v60
 v_fmac_f32 v45, v15, v61
 v_fmac_f32 v46, v15, v62
 v_fmac_f32 v47, v15, v63
 v_cvt_pk_bf16_f32 v20, v40, v41
 v_cvt_pk_bf16_f32 v21, v42, v43
 v_cvt_pk_bf16_f32 v22, v44, v45
 v_cvt_pk_bf16_f32 v23, v46, v47
 buffer_store_dwordx4 v[20:23], v12, s[52:55], s76 offen sc1
L_rne:
 s_cmp_lg_u32 s70, 0
 s_cbranch_scc1 L_rk28
 s_call_b64 s[36:37], L_rpoll
L_rk28:
 s_ff1_i32_b32 s71, s70
 s_bitset0_b32 s70, s71
 s_cmp_ge_u32 s71, 16
 s_cselect_b32 s72, s78, s77
 s_cselect_b32 s73, 0x10000000, 0
 s_cselect_b32 s87, 536870912, 0
 s_mul_i32 s71, s71, 114688
 s_add_u32 s71, s71, s72
 buffer_load_dwordx4 v[224:227], v7, s[8:11], s71 offen sc1
 s_or_b32 s69, s69, s73
 s_or_b32 s71, s71, s87
 buffer_load_dwordx4 v[228:231], v27, s[8:11], s71 offen sc1
 s_waitcnt vmcnt(16)
 s_bitcmp0_b32 s69, 20
 s_cbranch_scc1 L_rx20
 v_dot2c_f32_bf16 v64, v160, v24
 v_dot2c_f32_bf16 v65, v160, v25
 v_dot2c_f32_bf16 v66, v161, v24
 v_dot2c_f32_bf16 v67, v161, v25
 v_dot2c_f32_bf16 v68, v162, v24
 v_dot2c_f32_bf16 v69, v162, v25
 v_dot2c_f32_bf16 v70, v163, v24
 v_dot2c_f32_bf16 v71, v163, v25
L_ry20:
 s_cmp_lg_u32 s70, 0
 s_cbranch_scc1 L_rk29
 s_call_b64 s[36:37], L_rpoll
L_rk29:
 s_ff1_i32_b32 s71, s70
 s_bitset0_b32 s70, s71
 s_cmp_ge_u32 s71, 16
 s_cselect_b32 s72, s78, s77
 s_cselect_b32 s73, 0x20000000, 0
 s_cselect_b32 s87, 536870912, 0
 s_mul_i32 s71, s71, 114688
 s_add_u32 s71, s71, s72
 buffer_load_dwordx4 v[232:235], v7, s[8:11], s71 offen sc1
 s_or_b32 s69, s69, s73
 s_or_b32 s71, s71, s87
 buffer_load_dwordx4 v[236:239], v27, s[8:11], s71 offen sc1
 s_waitcnt vmcnt(16)
 s_bitcmp0_b32 s69, 21
 s_cbranch_scc1 L_rx21
 v_dot2c_f32_bf16 v64, v168, v24
 v_dot2c_f32_bf16 v65, v168, v25
 v_dot2c_f32_bf16 v66, v169, v24
 v_dot2c_f32_bf16 v67, v169, v25
 v_dot2c_f32_bf16 v68, v170, v24
 v_dot2c_f32_bf16 v69, v170, v25
 v_dot2c_f32_bf16 v70, v171, v24
 v_dot2c_f32_bf16 v71, v171, v25
L_ry21:
 s_cmp_lg_u32 s70, 0
 s_cbranch_scc1 L_rk30
 s_call_b64 s[36:37], L_rpoll
L_rk30:
 s_ff1_i32_b32 s71, s70
 s_bitset0_b32 s70, s71
 s_cmp_ge_u32 s71, 16
 s_cselect_b32 s72, s78, s77
 s_cselect_b32 s73, 0x40000000, 0
 s_cselect_b32 s87, 536870912, 0
 s_mul_i32 s71, s71, 114688
 s_add_u32 s71, s71, s72
 buffer_load_dwordx4 v[240:243], v7, s[8:11], s71 offen sc1
 s_or_b32 s69, s69, s73
 s_or_b32 s71, s71, s87
 buffer_load_dwordx4 v[244:247], v27, s[8:11], s71 offen sc1
 s_waitcnt vmcnt(16)
 s_bitcmp0_b32 s69, 22
 s_cbranch_scc1 L_rx22
 v_dot2c_f32_bf16 v64, v176, v24
 v_dot2c_f32_bf16 v65, v176, v25
 v_dot2c_f32_bf16 v66, v177, v24
 v_dot2c_f32_bf16 v67, v177, v25
 v_dot2c_f32_bf16 v68, v178, v24
 v_dot2c_f32_bf16 v69, v178, v25
 v_dot2c_f32_bf16 v70, v179, v24
 v_dot2c_f32_bf16 v71, v179, v25
L_ry22:
 s_cmp_lg_u32 s70, 0
 s_cbranch_scc1 L_rk31
 s_call_b64 s[36:37], L_rpoll
L_rk31:
 s_ff1_i32_b32 s71, s70
 s_bitset0_b32 s70, s71
 s_cmp_ge_u32 s71, 16
 s_cselect_b32 s72, s78, s77
 s_cselect_b32 s73, 0x80000000, 0
 s_cselect_b32 s87, 536870912, 0
 s_mul_i32 s71, s71, 114688
 s_add_u32 s71, s71, s72
 buffer_load_dwordx4 v[248:251], v7, s[8:11], s71 offen sc1
 s_or_b32 s69, s69, s73
 s_or_b32 s71, s71, s87
 buffer_load_dwordx4 v[252:255], v27, s[8:11], s71 offen sc1
 s_waitcnt vmcnt(16)
 s_bitcmp0_b32 s69, 23
 s_cbranch_scc1 L_rx23
 v_dot2c_f32_bf16 v64, v184, v24
 v_dot2c_f32_bf16 v65, v184, v25
 v_dot2c_f32_bf16 v66, v185, v24
 v_dot2c_f32_bf16 v67, v185, v25
 v_dot2c_f32_bf16 v68, v186, v24
 v_dot2c_f32_bf16 v69, v186, v25
 v_dot2c_f32_bf16 v70, v187, v24
 v_dot2c_f32_bf16 v71, v187, v25
L_ry23:
 s_waitcnt vmcnt(14)
 s_bitcmp0_b32 s69, 24
 s_cbranch_scc1 L_rx24
 v_dot2c_f32_bf16 v64, v192, v24
 v_dot2c_f32_bf16 v65, v192, v25
 v_dot2c_f32_bf16 v66, v193, v24
 v_dot2c_f32_bf16 v67, v193, v25
 v_dot2c_f32_bf16 v68, v194, v24
 v_dot2c_f32_bf16 v69, v194, v25
 v_dot2c_f32_bf16 v70, v195, v24
 v_dot2c_f32_bf16 v71, v195, v25
L_ry24:
 s_waitcnt vmcnt(12)
 s_bitcmp0_b32 s69, 25
 s_cbranch_scc1 L_rx25
 v_dot2c_f32_bf16 v64, v200, v24
 v_dot2c_f32_bf16 v65, v200, v25
 v_dot2c_f32_bf16 v66, v201, v24
 v_dot2c_f32_bf16 v67, v201, v25
 v_dot2c_f32_bf16 v68, v202, v24
 v_dot2c_f32_bf16 v69, v202, v25
 v_dot2c_f32_bf16 v70, v203, v24
 v_dot2c_f32_bf16 v71, v203, v25
L_ry25:
 s_waitcnt vmcnt(10)
 s_bitcmp0_b32 s69, 26
 s_cbranch_scc1 L_rx26
 v_dot2c_f32_bf16 v64, v208, v24
 v_dot2c_f32_bf16 v65, v208, v25
 v_dot2c_f32_bf16 v66, v209, v24
 v_dot2c_f32_bf16 v67, v209, v25
 v_dot2c_f32_bf16 v68, v210, v24
 v_dot2c_f32_bf16 v69, v210, v25
 v_dot2c_f32_bf16 v70, v211, v24
 v_dot2c_f32_bf16 v71, v211, v25
L_ry26:
 s_waitcnt vmcnt(8)
 s_bitcmp0_b32 s69, 27
 s_cbranch_scc1 L_rx27
 v_dot2c_f32_bf16 v64, v216, v24
 v_dot2c_f32_bf16 v65, v216, v25
 v_dot2c_f32_bf16 v66, v217, v24
 v_dot2c_f32_bf16 v67, v217, v25
 v_dot2c_f32_bf16 v68, v218, v24
 v_dot2c_f32_bf16 v69, v218, v25
 v_dot2c_f32_bf16 v70, v219, v24
 v_dot2c_f32_bf16 v71, v219, v25
L_ry27:
 s_waitcnt vmcnt(6)
 s_bitcmp0_b32 s69, 28
 s_cbranch_scc1 L_rx28
 v_dot2c_f32_bf16 v64, v224, v24
 v_dot2c_f32_bf16 v65, v224, v25
 v_dot2c_f32_bf16 v66, v225, v24
 v_dot2c_f32_bf16 v67, v225, v25
 v_dot2c_f32_bf16 v68, v226, v24
 v_dot2c_f32_bf16 v69, v226, v25
 v_dot2c_f32_bf16 v70, v227, v24
 v_dot2c_f32_bf16 v71, v227, v25
L_ry28:
 s_waitcnt vmcnt(4)
 s_bitcmp0_b32 s69, 29
 s_cbranch_scc1 L_rx29
 v_dot2c_f32_bf16 v64, v232, v24
 v_dot2c_f32_bf16 v65, v232, v25
 v_dot2c_f32_bf16 v66, v233, v24
 v_dot2c_f32_bf16 v67, v233, v25
 v_dot2c_f32_bf16 v68, v234, v24
 v_dot2c_f32_bf16 v69, v234, v25
 v_dot2c_f32_bf16 v70, v235, v24
 v_dot2c_f32_bf16 v71, v235, v25
L_ry29:
 s_waitcnt vmcnt(2)
 s_bitcmp0_b32 s69, 30
 s_cbranch_scc1 L_rx30
 v_dot2c_f32_bf16 v64, v240, v24
 v_dot2c_f32_bf16 v65, v240, v25
 v_dot2c_f32_bf16 v66, v241, v24
 v_dot2c_f32_bf16 v67, v241, v25
 v_dot2c_f32_bf16 v68, v242, v24
 v_dot2c_f32_bf16 v69, v242, v25
 v_dot2c_f32_bf16 v70, v243, v24
 v_dot2c_f32_bf16 v71, v243, v25
L_ry30:
 s_waitcnt vmcnt(0)
 s_bitcmp0_b32 s69, 31
 s_cbranch_scc1 L_rx31
 v_dot2c_f32_bf16 v64, v248, v24
 v_dot2c_f32_bf16 v65, v248, v25
 v_dot2c_f32_bf16 v66, v249, v24
 v_dot2c_f32_bf16 v67, v249, v25
 v_dot2c_f32_bf16 v68, v250, v24
 v_dot2c_f32_bf16 v69, v250, v25
 v_dot2c_f32_bf16 v70, v251, v24
 v_dot2c_f32_bf16 v71, v251, v25
L_ry31:
 s_nop 1
 v_fmac_f32 v80, v26, v64
 v_fmac_f32 v81, v26, v65
 v_fmac_f32 v82, v26, v66
 v_fmac_f32 v83, v26, v67
 v_fmac_f32 v84, v26, v68
 v_fmac_f32 v85, v26, v69
 v_fmac_f32 v86, v26, v70
 v_fmac_f32 v87, v26, v71
 v_cvt_pk_bf16_f32 v96, v80, v81
 v_cvt_pk_bf16_f32 v97, v82, v83
 v_cvt_pk_bf16_f32 v98, v84, v85
 v_cvt_pk_bf16_f32 v99, v86, v87
 buffer_store_dwordx4 v[96:99], v28, s[52:55], s86 offen sc1
 s_cmp_eq_u32 s66, 1
 s_cbranch_scc1 L_rdone
 v_fmac_f32 v32, v15, v48
 v_fmac_f32 v33, v15, v49
 v_fmac_f32 v34, v15, v50
 v_fmac_f32 v35, v15, v51
 v_fmac_f32 v36, v15, v52
 v_fmac_f32 v37, v15, v53
 v_fmac_f32 v38, v15, v54
 v_fmac_f32 v39, v15, v55
 v_cvt_pk_bf16_f32 v16, v32, v33
 v_cvt_pk_bf16_f32 v17, v34, v35
 v_cvt_pk_bf16_f32 v18, v36, v37
 v_cvt_pk_bf16_f32 v19, v38, v39
 buffer_store_dwordx4 v[16:19], v12, s[52:55], s75 offen sc1
 v_fmac_f32 v40, v15, v56
 v_fmac_f32 v41, v15, v57
 v_fmac_f32 v42, v15, v58
 v_fmac_f32 v43, v15, v59
 v_fmac_f32 v44, v15, v60
 v_fmac_f32 v45, v15, v61
 v_fmac_f32 v46, v15, v62
 v_fmac_f32 v47, v15, v63
 v_cvt_pk_bf16_f32 v20, v40, v41
 v_cvt_pk_bf16_f32 v21, v42, v43
 v_cvt_pk_bf16_f32 v22, v44, v45
 v_cvt_pk_bf16_f32 v23, v46, v47
 buffer_store_dwordx4 v[20:23], v12, s[52:55], s76 offen sc1
L_rdone:
 s_endpgm
L_rx0:
 v_dot2c_f32_bf16 v64, v128, v24
 v_dot2c_f32_bf16 v65, v128, v25
 v_dot2c_f32_bf16 v66, v129, v24
 v_dot2c_f32_bf16 v67, v129, v25
 v_dot2c_f32_bf16 v68, v130, v24
 v_dot2c_f32_bf16 v69, v130, v25
 v_dot2c_f32_bf16 v70, v131, v24
 v_dot2c_f32_bf16 v71, v131, v25
 s_branch L_ry0
L_rx1:
 v_dot2c_f32_bf16 v64, v136, v24
 v_dot2c_f32_bf16 v65, v136, v25
 v_dot2c_f32_bf16 v66, v137, v24
 v_dot2c_f32_bf16 v67, v137, v25
 v_dot2c_f32_bf16 v68, v138, v24
 v_dot2c_f32_bf16 v69, v138, v25
 v_dot2c_f32_bf16 v70, v139, v24
 v_dot2c_f32_bf16 v71, v139, v25
 s_branch L_ry1
L_rx2:
 v_dot2c_f32_bf16 v64, v144, v24
 v_dot2c_f32_bf16 v65, v144, v25
 v_dot2c_f32_bf16 v66, v145, v24
 v_dot2c_f32_bf16 v67, v145, v25
 v_dot2c_f32_bf16 v68, v146, v24
 v_dot2c_f32_bf16 v69, v146, v25
 v_dot2c_f32_bf16 v70, v147, v24
 v_dot2c_f32_bf16 v71, v147, v25
 s_branch L_ry2
L_rx3:
 v_dot2c_f32_bf16 v64, v152, v24
 v_dot2c_f32_bf16 v65, v152, v25
 v_dot2c_f32_bf16 v66, v153, v24
 v_dot2c_f32_bf16 v67, v153, v25
 v_dot2c_f32_bf16 v68, v154, v24
 v_dot2c_f32_bf16 v69, v154, v25
 v_dot2c_f32_bf16 v70, v155, v24
 v_dot2c_f32_bf16 v71, v155, v25
 s_branch L_ry3
L_rx4:
 v_dot2c_f32_bf16 v64, v160, v24
 v_dot2c_f32_bf16 v65, v160, v25
 v_dot2c_f32_bf16 v66, v161, v24
 v_dot2c_f32_bf16 v67, v161, v25
 v_dot2c_f32_bf16 v68, v162, v24
 v_dot2c_f32_bf16 v69, v162, v25
 v_dot2c_f32_bf16 v70, v163, v24
 v_dot2c_f32_bf16 v71, v163, v25
 s_branch L_ry4
L_rx5:
 v_dot2c_f32_bf16 v64, v168, v24
 v_dot2c_f32_bf16 v65, v168, v25
 v_dot2c_f32_bf16 v66, v169, v24
 v_dot2c_f32_bf16 v67, v169, v25
 v_dot2c_f32_bf16 v68, v170, v24
 v_dot2c_f32_bf16 v69, v170, v25
 v_dot2c_f32_bf16 v70, v171, v24
 v_dot2c_f32_bf16 v71, v171, v25
 s_branch L_ry5
L_rx6:
 v_dot2c_f32_bf16 v64, v176, v24
 v_dot2c_f32_bf16 v65, v176, v25
 v_dot2c_f32_bf16 v66, v177, v24
 v_dot2c_f32_bf16 v67, v177, v25
 v_dot2c_f32_bf16 v68, v178, v24
 v_dot2c_f32_bf16 v69, v178, v25
 v_dot2c_f32_bf16 v70, v179, v24
 v_dot2c_f32_bf16 v71, v179, v25
 s_branch L_ry6
L_rx7:
 v_dot2c_f32_bf16 v64, v184, v24
 v_dot2c_f32_bf16 v65, v184, v25
 v_dot2c_f32_bf16 v66, v185, v24
 v_dot2c_f32_bf16 v67, v185, v25
 v_dot2c_f32_bf16 v68, v186, v24
 v_dot2c_f32_bf16 v69, v186, v25
 v_dot2c_f32_bf16 v70, v187, v24
 v_dot2c_f32_bf16 v71, v187, v25
 s_branch L_ry7
L_rx8:
 v_dot2c_f32_bf16 v64, v192, v24
 v_dot2c_f32_bf16 v65, v192, v25
 v_dot2c_f32_bf16 v66, v193, v24
 v_dot2c_f32_bf16 v67, v193, v25
 v_dot2c_f32_bf16 v68, v194, v24
 v_dot2c_f32_bf16 v69, v194, v25
 v_dot2c_f32_bf16 v70, v195, v24
 v_dot2c_f32_bf16 v71, v195, v25
 s_branch L_ry8
L_rx9:
 v_dot2c_f32_bf16 v64, v200, v24
 v_dot2c_f32_bf16 v65, v200, v25
 v_dot2c_f32_bf16 v66, v201, v24
 v_dot2c_f32_bf16 v67, v201, v25
 v_dot2c_f32_bf16 v68, v202, v24
 v_dot2c_f32_bf16 v69, v202, v25
 v_dot2c_f32_bf16 v70, v203, v24
 v_dot2c_f32_bf16 v71, v203, v25
 s_branch L_ry9
L_rx10:
 v_dot2c_f32_bf16 v64, v208, v24
 v_dot2c_f32_bf16 v65, v208, v25
 v_dot2c_f32_bf16 v66, v209, v24
 v_dot2c_f32_bf16 v67, v209, v25
 v_dot2c_f32_bf16 v68, v210, v24
 v_dot2c_f32_bf16 v69, v210, v25
 v_dot2c_f32_bf16 v70, v211, v24
 v_dot2c_f32_bf16 v71, v211, v25
 s_branch L_ry10
L_rx11:
 v_dot2c_f32_bf16 v64, v216, v24
 v_dot2c_f32_bf16 v65, v216, v25
 v_dot2c_f32_bf16 v66, v217, v24
 v_dot2c_f32_bf16 v67, v217, v25
 v_dot2c_f32_bf16 v68, v218, v24
 v_dot2c_f32_bf16 v69, v218, v25
 v_dot2c_f32_bf16 v70, v219, v24
 v_dot2c_f32_bf16 v71, v219, v25
 s_branch L_ry11
L_rx12:
 v_dot2c_f32_bf16 v64, v224, v24
 v_dot2c_f32_bf16 v65, v224, v25
 v_dot2c_f32_bf16 v66, v225, v24
 v_dot2c_f32_bf16 v67, v225, v25
 v_dot2c_f32_bf16 v68, v226, v24
 v_dot2c_f32_bf16 v69, v226, v25
 v_dot2c_f32_bf16 v70, v227, v24
 v_dot2c_f32_bf16 v71, v227, v25
 s_branch L_ry12
L_rx13:
 v_dot2c_f32_bf16 v64, v232, v24
 v_dot2c_f32_bf16 v65, v232, v25
 v_dot2c_f32_bf16 v66, v233, v24
 v_dot2c_f32_bf16 v67, v233, v25
 v_dot2c_f32_bf16 v68, v234, v24
 v_dot2c_f32_bf16 v69, v234, v25
 v_dot2c_f32_bf16 v70, v235, v24
 v_dot2c_f32_bf16 v71, v235, v25
 s_branch L_ry13
L_rx14:
 v_dot2c_f32_bf16 v64, v240, v24
 v_dot2c_f32_bf16 v65, v240, v25
 v_dot2c_f32_bf16 v66, v241, v24
 v_dot2c_f32_bf16 v67, v241, v25
 v_dot2c_f32_bf16 v68, v242, v24
 v_dot2c_f32_bf16 v69, v242, v25
 v_dot2c_f32_bf16 v70, v243, v24
 v_dot2c_f32_bf16 v71, v243, v25
 s_branch L_ry14
L_rx15:
 v_dot2c_f32_bf16 v64, v248, v24
 v_dot2c_f32_bf16 v65, v248, v25
 v_dot2c_f32_bf16 v66, v249, v24
 v_dot2c_f32_bf16 v67, v249, v25
 v_dot2c_f32_bf16 v68, v250, v24
 v_dot2c_f32_bf16 v69, v250, v25
 v_dot2c_f32_bf16 v70, v251, v24
 v_dot2c_f32_bf16 v71, v251, v25
 s_branch L_ry15
L_rx16:
 v_dot2c_f32_bf16 v48, v128, v24
 v_dot2c_f32_bf16 v49, v128, v25
 v_dot2c_f32_bf16 v50, v129, v24
 v_dot2c_f32_bf16 v51, v129, v25
 v_dot2c_f32_bf16 v52, v130, v24
 v_dot2c_f32_bf16 v53, v130, v25
 v_dot2c_f32_bf16 v54, v131, v24
 v_dot2c_f32_bf16 v55, v131, v25
 v_dot2c_f32_bf16 v56, v132, v24
 v_dot2c_f32_bf16 v57, v132, v25
 v_dot2c_f32_bf16 v58, v133, v24
 v_dot2c_f32_bf16 v59, v133, v25
 v_dot2c_f32_bf16 v60, v134, v24
 v_dot2c_f32_bf16 v61, v134, v25
 v_dot2c_f32_bf16 v62, v135, v24
 v_dot2c_f32_bf16 v63, v135, v25
 s_branch L_ry16
L_rx17:
 v_dot2c_f32_bf16 v48, v136, v24
 v_dot2c_f32_bf16 v49, v136, v25
 v_dot2c_f32_bf16 v50, v137, v24
 v_dot2c_f32_bf16 v51, v137, v25
 v_dot2c_f32_bf16 v52, v138, v24
 v_dot2c_f32_bf16 v53, v138, v25
 v_dot2c_f32_bf16 v54, v139, v24
 v_dot2c_f32_bf16 v55, v139, v25
 v_dot2c_f32_bf16 v56, v140, v24
 v_dot2c_f32_bf16 v57, v140, v25
 v_dot2c_f32_bf16 v58, v141, v24
 v_dot2c_f32_bf16 v59, v141, v25
 v_dot2c_f32_bf16 v60, v142, v24
 v_dot2c_f32_bf16 v61, v142, v25
 v_dot2c_f32_bf16 v62, v143, v24
 v_dot2c_f32_bf16 v63, v143, v25
 s_branch L_ry17
L_rx18:
 v_dot2c_f32_bf16 v48, v144, v24
 v_dot2c_f32_bf16 v49, v144, v25
 v_dot2c_f32_bf16 v50, v145, v24
 v_dot2c_f32_bf16 v51, v145, v25
 v_dot2c_f32_bf16 v52, v146, v24
 v_dot2c_f32_bf16 v53, v146, v25
 v_dot2c_f32_bf16 v54, v147, v24
 v_dot2c_f32_bf16 v55, v147, v25
 v_dot2c_f32_bf16 v56, v148, v24
 v_dot2c_f32_bf16 v57, v148, v25
 v_dot2c_f32_bf16 v58, v149, v24
 v_dot2c_f32_bf16 v59, v149, v25
 v_dot2c_f32_bf16 v60, v150, v24
 v_dot2c_f32_bf16 v61, v150, v25
 v_dot2c_f32_bf16 v62, v151, v24
 v_dot2c_f32_bf16 v63, v151, v25
 s_branch L_ry18
L_rx19:
 v_dot2c_f32_bf16 v48, v152, v24
 v_dot2c_f32_bf16 v49, v152, v25
 v_dot2c_f32_bf16 v50, v153, v24
 v_dot2c_f32_bf16 v51, v153, v25
 v_dot2c_f32_bf16 v52, v154, v24
 v_dot2c_f32_bf16 v53, v154, v25
 v_dot2c_f32_bf16 v54, v155, v24
 v_dot2c_f32_bf16 v55, v155, v25
 v_dot2c_f32_bf16 v56, v156, v24
 v_dot2c_f32_bf16 v57, v156, v25
 v_dot2c_f32_bf16 v58, v157, v24
 v_dot2c_f32_bf16 v59, v157, v25
 v_dot2c_f32_bf16 v60, v158, v24
 v_dot2c_f32_bf16 v61, v158, v25
 v_dot2c_f32_bf16 v62, v159, v24
 v_dot2c_f32_bf16 v63, v159, v25
 s_branch L_ry19
L_rx20:
 v_dot2c_f32_bf16 v48, v160, v24
 v_dot2c_f32_bf16 v49, v160, v25
 v_dot2c_f32_bf16 v50, v161, v24
 v_dot2c_f32_bf16 v51, v161, v25
 v_dot2c_f32_bf16 v52, v162, v24
 v_dot2c_f32_bf16 v53, v162, v25
 v_dot2c_f32_bf16 v54, v163, v24
 v_dot2c_f32_bf16 v55, v163, v25
 v_dot2c_f32_bf16 v56, v164, v24
 v_dot2c_f32_bf16 v57, v164, v25
 v_dot2c_f32_bf16 v58, v165, v24
 v_dot2c_f32_bf16 v59, v165, v25
 v_dot2c_f32_bf16 v60, v166, v24
 v_dot2c_f32_bf16 v61, v166, v25
 v_dot2c_f32_bf16 v62, v167, v24
 v_dot2c_f32_bf16 v63, v167, v25
 s_branch L_ry20
L_rx21:
 v_dot2c_f32_bf16 v48, v168, v24
 v_dot2c_f32_bf16 v49, v168, v25
 v_dot2c_f32_bf16 v50, v169, v24
 v_dot2c_f32_bf16 v51, v169, v25
 v_dot2c_f32_bf16 v52, v170, v24
 v_dot2c_f32_bf16 v53, v170, v25
 v_dot2c_f32_bf16 v54, v171, v24
 v_dot2c_f32_bf16 v55, v171, v25
 v_dot2c_f32_bf16 v56, v172, v24
 v_dot2c_f32_bf16 v57, v172, v25
 v_dot2c_f32_bf16 v58, v173, v24
 v_dot2c_f32_bf16 v59, v173, v25
 v_dot2c_f32_bf16 v60, v174, v24
 v_dot2c_f32_bf16 v61, v174, v25
 v_dot2c_f32_bf16 v62, v175, v24
 v_dot2c_f32_bf16 v63, v175, v25
 s_branch L_ry21
L_rx22:
 v_dot2c_f32_bf16 v48, v176, v24
 v_dot2c_f32_bf16 v49, v176, v25
 v_dot2c_f32_bf16 v50, v177, v24
 v_dot2c_f32_bf16 v51, v177, v25
 v_dot2c_f32_bf16 v52, v178, v24
 v_dot2c_f32_bf16 v53, v178, v25
 v_dot2c_f32_bf16 v54, v179, v24
 v_dot2c_f32_bf16 v55, v179, v25
 v_dot2c_f32_bf16 v56, v180, v24
 v_dot2c_f32_bf16 v57, v180, v25
 v_dot2c_f32_bf16 v58, v181, v24
 v_dot2c_f32_bf16 v59, v181, v25
 v_dot2c_f32_bf16 v60, v182, v24
 v_dot2c_f32_bf16 v61, v182, v25
 v_dot2c_f32_bf16 v62, v183, v24
 v_dot2c_f32_bf16 v63, v183, v25
 s_branch L_ry22
L_rx23:
 v_dot2c_f32_bf16 v48, v184, v24
 v_dot2c_f32_bf16 v49, v184, v25
 v_dot2c_f32_bf16 v50, v185, v24
 v_dot2c_f32_bf16 v51, v185, v25
 v_dot2c_f32_bf16 v52, v186, v24
 v_dot2c_f32_bf16 v53, v186, v25
 v_dot2c_f32_bf16 v54, v187, v24
 v_dot2c_f32_bf16 v55, v187, v25
 v_dot2c_f32_bf16 v56, v188, v24
 v_dot2c_f32_bf16 v57, v188, v25
 v_dot2c_f32_bf16 v58, v189, v24
 v_dot2c_f32_bf16 v59, v189, v25
 v_dot2c_f32_bf16 v60, v190, v24
 v_dot2c_f32_bf16 v61, v190, v25
 v_dot2c_f32_bf16 v62, v191, v24
 v_dot2c_f32_bf16 v63, v191, v25
 s_branch L_ry23
L_rx24:
 v_dot2c_f32_bf16 v48, v192, v24
 v_dot2c_f32_bf16 v49, v192, v25
 v_dot2c_f32_bf16 v50, v193, v24
 v_dot2c_f32_bf16 v51, v193, v25
 v_dot2c_f32_bf16 v52, v194, v24
 v_dot2c_f32_bf16 v53, v194, v25
 v_dot2c_f32_bf16 v54, v195, v24
 v_dot2c_f32_bf16 v55, v195, v25
 v_dot2c_f32_bf16 v56, v196, v24
 v_dot2c_f32_bf16 v57, v196, v25
 v_dot2c_f32_bf16 v58, v197, v24
 v_dot2c_f32_bf16 v59, v197, v25
 v_dot2c_f32_bf16 v60, v198, v24
 v_dot2c_f32_bf16 v61, v198, v25
 v_dot2c_f32_bf16 v62, v199, v24
 v_dot2c_f32_bf16 v63, v199, v25
 s_branch L_ry24
L_rx25:
 v_dot2c_f32_bf16 v48, v200, v24
 v_dot2c_f32_bf16 v49, v200, v25
 v_dot2c_f32_bf16 v50, v201, v24
 v_dot2c_f32_bf16 v51, v201, v25
 v_dot2c_f32_bf16 v52, v202, v24
 v_dot2c_f32_bf16 v53, v202, v25
 v_dot2c_f32_bf16 v54, v203, v24
 v_dot2c_f32_bf16 v55, v203, v25
 v_dot2c_f32_bf16 v56, v204, v24
 v_dot2c_f32_bf16 v57, v204, v25
 v_dot2c_f32_bf16 v58, v205, v24
 v_dot2c_f32_bf16 v59, v205, v25
 v_dot2c_f32_bf16 v60, v206, v24
 v_dot2c_f32_bf16 v61, v206, v25
 v_dot2c_f32_bf16 v62, v207, v24
 v_dot2c_f32_bf16 v63, v207, v25
 s_branch L_ry25
L_rx26:
 v_dot2c_f32_bf16 v48, v208, v24
 v_dot2c_f32_bf16 v49, v208, v25
 v_dot2c_f32_bf16 v50, v209, v24
 v_dot2c_f32_bf16 v51, v209, v25
 v_dot2c_f32_bf16 v52, v210, v24
 v_dot2c_f32_bf16 v53, v210, v25
 v_dot2c_f32_bf16 v54, v211, v24
 v_dot2c_f32_bf16 v55, v211, v25
 v_dot2c_f32_bf16 v56, v212, v24
 v_dot2c_f32_bf16 v57, v212, v25
 v_dot2c_f32_bf16 v58, v213, v24
 v_dot2c_f32_bf16 v59, v213, v25
 v_dot2c_f32_bf16 v60, v214, v24
 v_dot2c_f32_bf16 v61, v214, v25
 v_dot2c_f32_bf16 v62, v215, v24
 v_dot2c_f32_bf16 v63, v215, v25
 s_branch L_ry26
L_rx27:
 v_dot2c_f32_bf16 v48, v216, v24
 v_dot2c_f32_bf16 v49, v216, v25
 v_dot2c_f32_bf16 v50, v217, v24
 v_dot2c_f32_bf16 v51, v217, v25
 v_dot2c_f32_bf16 v52, v218, v24
 v_dot2c_f32_bf16 v53, v218, v25
 v_dot2c_f32_bf16 v54, v219, v24
 v_dot2c_f32_bf16 v55, v219, v25
 v_dot2c_f32_bf16 v56, v220, v24
 v_dot2c_f32_bf16 v57, v220, v25
 v_dot2c_f32_bf16 v58, v221, v24
 v_dot2c_f32_bf16 v59, v221, v25
 v_dot2c_f32_bf16 v60, v222, v24
 v_dot2c_f32_bf16 v61, v222, v25
 v_dot2c_f32_bf16 v62, v223, v24
 v_dot2c_f32_bf16 v63, v223, v25
 s_branch L_ry27
L_rx28:
 v_dot2c_f32_bf16 v48, v224, v24
 v_dot2c_f32_bf16 v49, v224, v25
 v_dot2c_f32_bf16 v50, v225, v24
 v_dot2c_f32_bf16 v51, v225, v25
 v_dot2c_f32_bf16 v52, v226, v24
 v_dot2c_f32_bf16 v53, v226, v25
 v_dot2c_f32_bf16 v54, v227, v24
 v_dot2c_f32_bf16 v55, v227, v25
 v_dot2c_f32_bf16 v56, v228, v24
 v_dot2c_f32_bf16 v57, v228, v25
 v_dot2c_f32_bf16 v58, v229, v24
 v_dot2c_f32_bf16 v59, v229, v25
 v_dot2c_f32_bf16 v60, v230, v24
 v_dot2c_f32_bf16 v61, v230, v25
 v_dot2c_f32_bf16 v62, v231, v24
 v_dot2c_f32_bf16 v63, v231, v25
 s_branch L_ry28
L_rx29:
 v_dot2c_f32_bf16 v48, v232, v24
 v_dot2c_f32_bf16 v49, v232, v25
 v_dot2c_f32_bf16 v50, v233, v24
 v_dot2c_f32_bf16 v51, v233, v25
 v_dot2c_f32_bf16 v52, v234, v24
 v_dot2c_f32_bf16 v53, v234, v25
 v_dot2c_f32_bf16 v54, v235, v24
 v_dot2c_f32_bf16 v55, v235, v25
 v_dot2c_f32_bf16 v56, v236, v24
 v_dot2c_f32_bf16 v57, v236, v25
 v_dot2c_f32_bf16 v58, v237, v24
 v_dot2c_f32_bf16 v59, v237, v25
 v_dot2c_f32_bf16 v60, v238, v24
 v_dot2c_f32_bf16 v61, v238, v25
 v_dot2c_f32_bf16 v62, v239, v24
 v_dot2c_f32_bf16 v63, v239, v25
 s_branch L_ry29
L_rx30:
 v_dot2c_f32_bf16 v48, v240, v24
 v_dot2c_f32_bf16 v49, v240, v25
 v_dot2c_f32_bf16 v50, v241, v24
 v_dot2c_f32_bf16 v51, v241, v25
 v_dot2c_f32_bf16 v52, v242, v24
 v_dot2c_f32_bf16 v53, v242, v25
 v_dot2c_f32_bf16 v54, v243, v24
 v_dot2c_f32_bf16 v55, v243, v25
 v_dot2c_f32_bf16 v56, v244, v24
 v_dot2c_f32_bf16 v57, v244, v25
 v_dot2c_f32_bf16 v58, v245, v24
 v_dot2c_f32_bf16 v59, v245, v25
 v_dot2c_f32_bf16 v60, v246, v24
 v_dot2c_f32_bf16 v61, v246, v25
 v_dot2c_f32_bf16 v62, v247, v24
 v_dot2c_f32_bf16 v63, v247, v25
 s_branch L_ry30
L_rx31:
 v_dot2c_f32_bf16 v48, v248, v24
 v_dot2c_f32_bf16 v49, v248, v25
 v_dot2c_f32_bf16 v50, v249, v24
 v_dot2c_f32_bf16 v51, v249, v25
 v_dot2c_f32_bf16 v52, v250, v24
 v_dot2c_f32_bf16 v53, v250, v25
 v_dot2c_f32_bf16 v54, v251, v24
 v_dot2c_f32_bf16 v55, v251, v25
 v_dot2c_f32_bf16 v56, v252, v24
 v_dot2c_f32_bf16 v57, v252, v25
 v_dot2c_f32_bf16 v58, v253, v24
 v_dot2c_f32_bf16 v59, v253, v25
 v_dot2c_f32_bf16 v60, v254, v24
 v_dot2c_f32_bf16 v61, v254, v25
 v_dot2c_f32_bf16 v62, v255, v24
 v_dot2c_f32_bf16 v63, v255, v25
 s_branch L_ry31
L_rpoll0:
 s_sleep 1
L_rpoll:
 buffer_load_dword v9, v14, s[8:11], s46 offen sc1
 s_waitcnt vmcnt(0)
 v_cmp_eq_u32 vcc, 1, v9
 s_sub_u32 s91, s91, 1
 s_cselect_b32 s70, -1, 0
 s_or_b32 s70, s70, vcc_lo
 s_andn2_b32 s70, s70, s68
 s_cbranch_scc0 L_rpoll0
 s_or_b32 s68, s68, s70
 s_setpc_b64 s[36:37]
L_comb:
 buffer_load_dwordx4 v[14:17], v7, s[8:11], s52 offen sc1
 s_waitcnt vmcnt(0)
 s_nop 7
 v_sub_f32 v10, v32, v14
 v_sub_f32 v11, v36, v15
 v_max_f32 v10, 0, v10
 v_max_f32 v11, 0, v11
 v_sub_f32 v100, v100, v11
 v_sub_f32 v101, v101, v11
 v_sub_f32 v102, v102, v11
 v_sub_f32 v103, v103, v11
 v_sub_f32 v108, v108, v11
 v_sub_f32 v109, v109, v11
 v_sub_f32 v110, v110, v11
 v_sub_f32 v111, v111, v11
 v_sub_f32 v116, v116, v11
 v_sub_f32 v117, v117, v11
 v_sub_f32 v118, v118, v11
 v_sub_f32 v119, v119, v11
 v_sub_f32 v124, v124, v11
 v_sub_f32 v125, v125, v11
 v_sub_f32 v126, v126, v11
 v_sub_f32 v127, v127, v11
 v_sub_f32 v64, v64, v10
 v_sub_f32 v65, v65, v10
 v_sub_f32 v66, v66, v10
 v_sub_f32 v67, v67, v10
 v_sub_f32 v68, v68, v11
 v_sub_f32 v69, v69, v11
 v_sub_f32 v70, v70, v11
 v_sub_f32 v71, v71, v11
 v_sub_f32 v72, v72, v10
 v_sub_f32 v73, v73, v10
 v_sub_f32 v74, v74, v10
 v_sub_f32 v75, v75, v10
 v_sub_f32 v76, v76, v11
 v_sub_f32 v77, v77, v11
 v_sub_f32 v78, v78, v11
 v_sub_f32 v79, v79, v11
 v_sub_f32 v80, v80, v10
 v_sub_f32 v81, v81, v10
 v_sub_f32 v82, v82, v10
 v_sub_f32 v83, v83, v10
 v_sub_f32 v84, v84, v11
 v_sub_f32 v85, v85, v11
 v_sub_f32 v86, v86, v11
 v_sub_f32 v87, v87, v11
 v_sub_f32 v88, v88, v10
 v_sub_f32 v89, v89, v10
 v_sub_f32 v90, v90, v10
 v_sub_f32 v91, v91, v10
 v_sub_f32 v92, v92, v11
 v_sub_f32 v93, v93, v11
 v_sub_f32 v94, v94, v11
 v_sub_f32 v95, v95, v11
 v_sub_f32 v32, v32, v10
 v_sub_f32 v33, v33, v10
 v_sub_f32 v34, v34, v10
 v_sub_f32 v35, v35, v10
 v_sub_f32 v36, v36, v11
 v_sub_f32 v37, v37, v11
 v_sub_f32 v38, v38, v11
 v_sub_f32 v39, v39, v11
 v_exp_f32 v12, -v10
 v_exp_f32 v13, -v11
 v_mul_f32 v30, v12, v30
 v_mul_f32 v31, v13, v31
 v_mul_f32 v128, v12, v128
 v_mul_f32 v129, v12, v129
 v_mul_f32 v130, v12, v130
 v_mul_f32 v131, v12, v131
 v_mul_f32 v132, v13, v132
 v_mul_f32 v133, v13, v133
 v_mul_f32 v134, v13, v134
 v_mul_f32 v135, v13, v135
 v_mul_f32 v136, v12, v136
 v_mul_f32 v137, v12, v137
 v_mul_f32 v138, v12, v138
 v_mul_f32 v139, v12, v139
 v_mul_f32 v140, v13, v140
 v_mul_f32 v141, v13, v141
 v_mul_f32 v142, v13, v142
 v_mul_f32 v143, v13, v143
 v_mul_f32 v144, v12, v144
 v_mul_f32 v145, v12, v145
 v_mul_f32 v146, v12, v146
 v_mul_f32 v147, v12, v147
 v_mul_f32 v148, v13, v148
 v_mul_f32 v149, v13, v149
 v_mul_f32 v150, v13, v150
 v_mul_f32 v151, v13, v151
 v_mul_f32 v152, v12, v152
 v_mul_f32 v153, v12, v153
 v_mul_f32 v154, v12, v154
 v_mul_f32 v155, v12, v155
 v_mul_f32 v156, v13, v156
 v_mul_f32 v157, v13, v157
 v_mul_f32 v158, v13, v158
 v_mul_f32 v159, v13, v159
 v_mul_f32 v160, v12, v160
 v_mul_f32 v161, v12, v161
 v_mul_f32 v162, v12, v162
 v_mul_f32 v163, v12, v163
 v_mul_f32 v164, v13, v164
 v_mul_f32 v165, v13, v165
 v_mul_f32 v166, v13, v166
 v_mul_f32 v167, v13, v167
 v_mul_f32 v168, v12, v168
 v_mul_f32 v169, v12, v169
 v_mul_f32 v170, v12, v170
 v_mul_f32 v171, v12, v171
 v_mul_f32 v172, v13, v172
 v_mul_f32 v173, v13, v173
 v_mul_f32 v174, v13, v174
 v_mul_f32 v175, v13, v175
 v_mul_f32 v176, v12, v176
 v_mul_f32 v177, v12, v177
 v_mul_f32 v178, v12, v178
 v_mul_f32 v179, v12, v179
 v_mul_f32 v180, v13, v180
 v_mul_f32 v181, v13, v181
 v_mul_f32 v182, v13, v182
 v_mul_f32 v183, v13, v183
 v_mul_f32 v184, v12, v184
 v_mul_f32 v185, v12, v185
 v_mul_f32 v186, v12, v186
 v_mul_f32 v187, v12, v187
 v_mul_f32 v188, v13, v188
 v_mul_f32 v189, v13, v189
 v_mul_f32 v190, v13, v190
 v_mul_f32 v191, v13, v191
 v_mul_f32 v192, v12, v192
 v_mul_f32 v193, v12, v193
 v_mul_f32 v194, v12, v194
 v_mul_f32 v195, v12, v195
 v_mul_f32 v196, v13, v196
 v_mul_f32 v197, v13, v197
 v_mul_f32 v198, v13, v198
 v_mul_f32 v199, v13, v199
 v_mul_f32 v200, v12, v200
 v_mul_f32 v201, v12, v201
 v_mul_f32 v202, v12, v202
 v_mul_f32 v203, v12, v203
 v_mul_f32 v204, v13, v204
 v_mul_f32 v205, v13, v205
 v_mul_f32 v206, v13, v206
 v_mul_f32 v207, v13, v207
 v_mul_f32 v208, v12, v208
 v_mul_f32 v209, v12, v209
 v_mul_f32 v210, v12, v210
 v_mul_f32 v211, v12, v211
 v_mul_f32 v212, v13, v212
 v_mul_f32 v213, v13, v213
 v_mul_f32 v214, v13, v214
 v_mul_f32 v215, v13, v215
 v_mul_f32 v216, v12, v216
 v_mul_f32 v217, v12, v217
 v_mul_f32 v218, v12, v218
 v_mul_f32 v219, v12, v219
 v_mul_f32 v220, v13, v220
 v_mul_f32 v221, v13, v221
 v_mul_f32 v222, v13, v222
 v_mul_f32 v223, v13, v223
 v_mul_f32 v224, v12, v224
 v_mul_f32 v225, v12, v225
 v_mul_f32 v226, v12, v226
 v_mul_f32 v227, v12, v227
 v_mul_f32 v228, v13, v228
 v_mul_f32 v229, v13, v229
 v_mul_f32 v230, v13, v230
 v_mul_f32 v231, v13, v231
 v_mul_f32 v232, v12, v232
 v_mul_f32 v233, v12, v233
 v_mul_f32 v234, v12, v234
 v_mul_f32 v235, v12, v235
 v_mul_f32 v236, v13, v236
 v_mul_f32 v237, v13, v237
 v_mul_f32 v238, v13, v238
 v_mul_f32 v239, v13, v239
 v_mul_f32 v240, v12, v240
 v_mul_f32 v241, v12, v241
 v_mul_f32 v242, v12, v242
 v_mul_f32 v243, v12, v243
 v_mul_f32 v244, v13, v244
 v_mul_f32 v245, v13, v245
 v_mul_f32 v246, v13, v246
 v_mul_f32 v247, v13, v247
 v_mul_f32 v248, v12, v248
 v_mul_f32 v249, v12, v249
 v_mul_f32 v250, v12, v250
 v_mul_f32 v251, v12, v251
 v_mul_f32 v252, v13, v252
 v_mul_f32 v253, v13, v253
 v_mul_f32 v254, v13, v254
 v_mul_f32 v255, v13, v255
 v_exp_f32 v18, v64
 v_exp_f32 v19, v65
 v_exp_f32 v20, v66
 v_add_f32 v26, v18, v19
 v_cvt_pk_bf16_f32 v40, v18, v19
 v_exp_f32 v21, v67
 v_exp_f32 v22, v72
 v_add_f32 v26, v20, v26
 v_cvt_pk_bf16_f32 v41, v20, v21
 v_exp_f32 v23, v73
 v_add_f32 v26, v21, v26
 v_exp_f32 v24, v74
 v_add_f32 v26, v22, v26
 v_cvt_pk_bf16_f32 v42, v22, v23
 v_exp_f32 v25, v75
 v_add_f32 v26, v23, v26
 v_exp_f32 v18, v68
 v_add_f32 v26, v24, v26
 v_cvt_pk_bf16_f32 v43, v24, v25
 v_exp_f32 v19, v69
 v_add_f32 v26, v25, v26
 v_exp_f32 v20, v70
 v_add_f32 v27, v18, v19
 v_cvt_pk_bf16_f32 v44, v18, v19
 v_exp_f32 v21, v71
 v_exp_f32 v22, v76
 v_add_f32 v27, v20, v27
 v_cvt_pk_bf16_f32 v45, v20, v21
 v_exp_f32 v23, v77
 v_add_f32 v27, v21, v27
 v_exp_f32 v24, v78
 v_add_f32 v27, v22, v27
 v_cvt_pk_bf16_f32 v46, v22, v23
 v_exp_f32 v25, v79
 v_add_f32 v27, v23, v27
 v_add_f32 v27, v24, v27
 v_cvt_pk_bf16_f32 v47, v24, v25
 v_add_f32 v27, v25, v27
 v_sub_f32 v10, v32, v14
 v_sub_f32 v11, v36, v15
 v_cvt_i32_f32 v10, v10
 v_cvt_i32_f32 v11, v11
 v_ldexp_f32 v10, 1.0, v10
 v_ldexp_f32 v11, 1.0, v11
 v_and_b32 v10, 0xffff0000, v10
 v_and_b32 v11, 0xffff0000, v11
 v_fmac_f32 v30, v10, v16
 v_fmac_f32 v31, v11, v17
 v_lshrrev_b32 v12, 16, v10
 v_lshrrev_b32 v13, 16, v11
 v_accvgpr_read_b32 v18, a128
 v_dot2c_f32_bf16 v128, v18, v12
 v_dot2c_f32_bf16 v129, v18, v10
 v_accvgpr_read_b32 v19, a129
 v_dot2c_f32_bf16 v130, v19, v12
 v_dot2c_f32_bf16 v131, v19, v10
 v_accvgpr_read_b32 v20, a130
 v_dot2c_f32_bf16 v136, v20, v12
 v_dot2c_f32_bf16 v137, v20, v10
 v_accvgpr_read_b32 v21, a131
 v_dot2c_f32_bf16 v138, v21, v12
 v_dot2c_f32_bf16 v139, v21, v10
 v_accvgpr_read_b32 v22, a132
 v_dot2c_f32_bf16 v144, v22, v12
 v_dot2c_f32_bf16 v145, v22, v10
 v_accvgpr_read_b32 v23, a133
 v_dot2c_f32_bf16 v146, v23, v12
 v_dot2c_f32_bf16 v147, v23, v10
 v_accvgpr_read_b32 v24, a134
 v_dot2c_f32_bf16 v152, v24, v12
 v_dot2c_f32_bf16 v153, v24, v10
 v_accvgpr_read_b32 v25, a135
 v_dot2c_f32_bf16 v154, v25, v12
 v_dot2c_f32_bf16 v155, v25, v10
 v_accvgpr_read_b32 v18, a136
 v_dot2c_f32_bf16 v160, v18, v12
 v_dot2c_f32_bf16 v161, v18, v10
 v_accvgpr_read_b32 v19, a137
 v_dot2c_f32_bf16 v162, v19, v12
 v_dot2c_f32_bf16 v163, v19, v10
 v_accvgpr_read_b32 v20, a138
 v_dot2c_f32_bf16 v168, v20, v12
 v_dot2c_f32_bf16 v169, v20, v10
 v_accvgpr_read_b32 v21, a139
 v_dot2c_f32_bf16 v170, v21, v12
 v_dot2c_f32_bf16 v171, v21, v10
 v_accvgpr_read_b32 v22, a140
 v_dot2c_f32_bf16 v176, v22, v12
 v_dot2c_f32_bf16 v177, v22, v10
 v_accvgpr_read_b32 v23, a141
 v_dot2c_f32_bf16 v178, v23, v12
 v_dot2c_f32_bf16 v179, v23, v10
 v_accvgpr_read_b32 v24, a142
 v_dot2c_f32_bf16 v184, v24, v12
 v_dot2c_f32_bf16 v185, v24, v10
 v_accvgpr_read_b32 v25, a143
 v_dot2c_f32_bf16 v186, v25, v12
 v_dot2c_f32_bf16 v187, v25, v10
 v_accvgpr_read_b32 v18, a144
 v_dot2c_f32_bf16 v192, v18, v12
 v_dot2c_f32_bf16 v193, v18, v10
 v_accvgpr_read_b32 v19, a145
 v_dot2c_f32_bf16 v194, v19, v12
 v_dot2c_f32_bf16 v195, v19, v10
 v_accvgpr_read_b32 v20, a146
 v_dot2c_f32_bf16 v200, v20, v12
 v_dot2c_f32_bf16 v201, v20, v10
 v_accvgpr_read_b32 v21, a147
 v_dot2c_f32_bf16 v202, v21, v12
 v_dot2c_f32_bf16 v203, v21, v10
 v_accvgpr_read_b32 v22, a148
 v_dot2c_f32_bf16 v208, v22, v12
 v_dot2c_f32_bf16 v209, v22, v10
 v_accvgpr_read_b32 v23, a149
 v_dot2c_f32_bf16 v210, v23, v12
 v_dot2c_f32_bf16 v211, v23, v10
 v_accvgpr_read_b32 v24, a150
 v_dot2c_f32_bf16 v216, v24, v12
 v_dot2c_f32_bf16 v217, v24, v10
 v_accvgpr_read_b32 v25, a151
 v_dot2c_f32_bf16 v218, v25, v12
 v_dot2c_f32_bf16 v219, v25, v10
 v_accvgpr_read_b32 v18, a152
 v_dot2c_f32_bf16 v224, v18, v12
 v_dot2c_f32_bf16 v225, v18, v10
 v_accvgpr_read_b32 v19, a153
 v_dot2c_f32_bf16 v226, v19, v12
 v_dot2c_f32_bf16 v227, v19, v10
 v_accvgpr_read_b32 v20, a154
 v_dot2c_f32_bf16 v232, v20, v12
 v_dot2c_f32_bf16 v233, v20, v10
 v_accvgpr_read_b32 v21, a155
 v_dot2c_f32_bf16 v234, v21, v12
 v_dot2c_f32_bf16 v235, v21, v10
 v_accvgpr_read_b32 v22, a156
 v_dot2c_f32_bf16 v240, v22, v12
 v_dot2c_f32_bf16 v241, v22, v10
 v_accvgpr_read_b32 v23, a157
 v_dot2c_f32_bf16 v242, v23, v12
 v_dot2c_f32_bf16 v243, v23, v10
 v_accvgpr_read_b32 v24, a158
 v_dot2c_f32_bf16 v248, v24, v12
 v_dot2c_f32_bf16 v249, v24, v10
 v_accvgpr_read_b32 v25, a159
 v_dot2c_f32_bf16 v250, v25, v12
 v_dot2c_f32_bf16 v251, v25, v10
 v_accvgpr_read_b32 v18, a160
 v_dot2c_f32_bf16 v132, v18, v13
 v_dot2c_f32_bf16 v133, v18, v11
 v_accvgpr_read_b32 v19, a161
 v_dot2c_f32_bf16 v134, v19, v13
 v_dot2c_f32_bf16 v135, v19, v11
 v_accvgpr_read_b32 v20, a162
 v_dot2c_f32_bf16 v140, v20, v13
 v_dot2c_f32_bf16 v141, v20, v11
 v_accvgpr_read_b32 v21, a163
 v_dot2c_f32_bf16 v142, v21, v13
 v_dot2c_f32_bf16 v143, v21, v11
 v_accvgpr_read_b32 v22, a164
 v_dot2c_f32_bf16 v148, v22, v13
 v_dot2c_f32_bf16 v149, v22, v11
 v_accvgpr_read_b32 v23, a165
 v_dot2c_f32_bf16 v150, v23, v13
 v_dot2c_f32_bf16 v151, v23, v11
 v_accvgpr_read_b32 v24, a166
 v_dot2c_f32_bf16 v156, v24, v13
 v_dot2c_f32_bf16 v157, v24, v11
 v_accvgpr_read_b32 v25, a167
 v_dot2c_f32_bf16 v158, v25, v13
 v_dot2c_f32_bf16 v159, v25, v11
 v_accvgpr_read_b32 v18, a168
 v_dot2c_f32_bf16 v164, v18, v13
 v_dot2c_f32_bf16 v165, v18, v11
 v_accvgpr_read_b32 v19, a169
 v_dot2c_f32_bf16 v166, v19, v13
 v_dot2c_f32_bf16 v167, v19, v11
 v_accvgpr_read_b32 v20, a170
 v_dot2c_f32_bf16 v172, v20, v13
 v_dot2c_f32_bf16 v173, v20, v11
 v_accvgpr_read_b32 v21, a171
 v_dot2c_f32_bf16 v174, v21, v13
 v_dot2c_f32_bf16 v175, v21, v11
 v_accvgpr_read_b32 v22, a172
 v_dot2c_f32_bf16 v180, v22, v13
 v_dot2c_f32_bf16 v181, v22, v11
 v_accvgpr_read_b32 v23, a173
 v_dot2c_f32_bf16 v182, v23, v13
 v_dot2c_f32_bf16 v183, v23, v11
 v_accvgpr_read_b32 v24, a174
 v_dot2c_f32_bf16 v188, v24, v13
 v_dot2c_f32_bf16 v189, v24, v11
 v_accvgpr_read_b32 v25, a175
 v_dot2c_f32_bf16 v190, v25, v13
 v_dot2c_f32_bf16 v191, v25, v11
 v_accvgpr_read_b32 v18, a176
 v_dot2c_f32_bf16 v196, v18, v13
 v_dot2c_f32_bf16 v197, v18, v11
 v_accvgpr_read_b32 v19, a177
 v_dot2c_f32_bf16 v198, v19, v13
 v_dot2c_f32_bf16 v199, v19, v11
 v_accvgpr_read_b32 v20, a178
 v_dot2c_f32_bf16 v204, v20, v13
 v_dot2c_f32_bf16 v205, v20, v11
 v_accvgpr_read_b32 v21, a179
 v_dot2c_f32_bf16 v206, v21, v13
 v_dot2c_f32_bf16 v207, v21, v11
 v_accvgpr_read_b32 v22, a180
 v_dot2c_f32_bf16 v212, v22, v13
 v_dot2c_f32_bf16 v213, v22, v11
 v_accvgpr_read_b32 v23, a181
 v_dot2c_f32_bf16 v214, v23, v13
 v_dot2c_f32_bf16 v215, v23, v11
 v_accvgpr_read_b32 v24, a182
 v_dot2c_f32_bf16 v220, v24, v13
 v_dot2c_f32_bf16 v221, v24, v11
 v_accvgpr_read_b32 v25, a183
 v_dot2c_f32_bf16 v222, v25, v13
 v_dot2c_f32_bf16 v223, v25, v11
 v_accvgpr_read_b32 v18, a184
 v_dot2c_f32_bf16 v228, v18, v13
 v_dot2c_f32_bf16 v229, v18, v11
 v_accvgpr_read_b32 v19, a185
 v_dot2c_f32_bf16 v230, v19, v13
 v_dot2c_f32_bf16 v231, v19, v11
 v_accvgpr_read_b32 v20, a186
 v_dot2c_f32_bf16 v236, v20, v13
 v_dot2c_f32_bf16 v237, v20, v11
 v_accvgpr_read_b32 v21, a187
 v_dot2c_f32_bf16 v238, v21, v13
 v_dot2c_f32_bf16 v239, v21, v11
 v_accvgpr_read_b32 v22, a188
 v_dot2c_f32_bf16 v244, v22, v13
 v_dot2c_f32_bf16 v245, v22, v11
 v_accvgpr_read_b32 v23, a189
 v_dot2c_f32_bf16 v246, v23, v13
 v_dot2c_f32_bf16 v247, v23, v11
 v_accvgpr_read_b32 v24, a190
 v_dot2c_f32_bf16 v252, v24, v13
 v_dot2c_f32_bf16 v253, v24, v11
 v_accvgpr_read_b32 v25, a191
 v_dot2c_f32_bf16 v254, v25, v13
 v_dot2c_f32_bf16 v255, v25, v11
 s_nop 3
 s_branch L_p2
L_st0:
 s_call_b64 s[36:37], L_slow0
 s_branch L_rt0
L_st1:
 s_call_b64 s[36:37], L_slow1
 s_branch L_rt1
L_st2:
 s_call_b64 s[36:37], L_slowB
 s_branch L_rt2
L_st3:
 s_call_b64 s[36:37], L_slow1
 s_branch L_rt3
L_st4:
 s_call_b64 s[36:37], L_slow1n
 s_branch L_rt4
L_st5:
 s_call_b64 s[36:37], L_slow1
 s_branch L_rt5
L_st6:
 s_call_b64 s[36:37], L_slow0B
 s_branch L_rt6
L_st7:
 s_call_b64 s[36:37], L_slowB
 s_branch L_rt7
L_st8:
 s_call_b64 s[36:37], L_slowf
 s_branch L_rt8
L_st9:
 s_call_b64 s[36:37], L_slow1
 s_branch L_rt9
L_st10:
 s_call_b64 s[36:37], L_slowf
 s_branch L_rt10
L_st11:
 s_call_b64 s[36:37], L_slowf
 s_branch L_rt11
L_st14:
 s_call_b64 s[36:37], L_slow0B
 s_branch L_rt14
L_st12:
 s_call_b64 s[36:37], L_slow0
 s_branch L_rt12
L_st13:
 s_call_b64 s[36:37], L_slow1
 s_branch L_rt13
L_slow0:
 s_nop 7
 s_nop 3
 v_max3_f32 v10, v64, v65, v66
 v_max3_f32 v10, v67, v72, v10
 v_max3_f32 v10, v73, v74, v10
 v_max3_f32 v10, v75, v80, v10
 v_max3_f32 v10, v81, v82, v10
 v_max3_f32 v10, v83, v88, v10
 v_max3_f32 v10, v89, v90, v10
 v_max_f32 v10, v91, v10
 v_max3_f32 v11, v68, v69, v70
 v_max3_f32 v11, v71, v76, v11
 v_max3_f32 v11, v77, v78, v11
 v_max3_f32 v11, v79, v84, v11
 v_max3_f32 v11, v85, v86, v11
 v_max3_f32 v11, v87, v92, v11
 v_max3_f32 v11, v93, v94, v11
 v_max_f32 v11, v95, v11
 v_mov_b32 v12, v10
 v_mov_b32 v13, v11
 s_nop 0
 v_permlane16_swap_b32 v12, v10
 v_permlane16_swap_b32 v13, v11
 v_max_f32 v10, v12, v10
 v_max_f32 v11, v13, v11
 v_mov_b32 v12, v10
 v_mov_b32 v13, v11
 s_nop 0
 v_permlane32_swap_b32 v12, v10
 v_permlane32_swap_b32 v13, v11
 v_max_f32 v10, v12, v10
 v_max_f32 v11, v13, v11
 v_ceil_f32 v10, v10
 v_ceil_f32 v11, v11
 v_max_f32 v10, 0, v10
 v_max_f32 v11, 0, v11
 v_sub_f32 v64, v64, v10
 v_sub_f32 v65, v65, v10
 v_sub_f32 v66, v66, v10
 v_sub_f32 v67, v67, v10
 v_sub_f32 v68, v68, v11
 v_sub_f32 v69, v69, v11
 v_sub_f32 v70, v70, v11
 v_sub_f32 v71, v71, v11
 v_sub_f32 v72, v72, v10
 v_sub_f32 v73, v73, v10
 v_sub_f32 v74, v74, v10
 v_sub_f32 v75, v75, v10
 v_sub_f32 v76, v76, v11
 v_sub_f32 v77, v77, v11
 v_sub_f32 v78, v78, v11
 v_sub_f32 v79, v79, v11
 v_sub_f32 v80, v80, v10
 v_sub_f32 v81, v81, v10
 v_sub_f32 v82, v82, v10
 v_sub_f32 v83, v83, v10
 v_sub_f32 v84, v84, v11
 v_sub_f32 v85, v85, v11
 v_sub_f32 v86, v86, v11
 v_sub_f32 v87, v87, v11
 v_sub_f32 v88, v88, v10
 v_sub_f32 v89, v89, v10
 v_sub_f32 v90, v90, v10
 v_sub_f32 v91, v91, v10
 v_sub_f32 v92, v92, v11
 v_sub_f32 v93, v93, v11
 v_sub_f32 v94, v94, v11
 v_sub_f32 v95, v95, v11
 v_sub_f32 v96, v96, v10
 v_sub_f32 v97, v97, v10
 v_sub_f32 v98, v98, v10
 v_sub_f32 v99, v99, v10
 v_sub_f32 v100, v100, v11
 v_sub_f32 v101, v101, v11
 v_sub_f32 v102, v102, v11
 v_sub_f32 v103, v103, v11
 v_sub_f32 v104, v104, v10
 v_sub_f32 v105, v105, v10
 v_sub_f32 v106, v106, v10
 v_sub_f32 v107, v107, v10
 v_sub_f32 v108, v108, v11
 v_sub_f32 v109, v109, v11
 v_sub_f32 v110, v110, v11
 v_sub_f32 v111, v111, v11
 v_sub_f32 v112, v112, v10
 v_sub_f32 v113, v113, v10
 v_sub_f32 v114, v114, v10
 v_sub_f32 v115, v115, v10
 v_sub_f32 v116, v116, v11
 v_sub_f32 v117, v117, v11
 v_sub_f32 v118, v118, v11
 v_sub_f32 v119, v119, v11
 v_sub_f32 v120, v120, v10
 v_sub_f32 v121, v121, v10
 v_sub_f32 v122, v122, v10
 v_sub_f32 v123, v123, v10
 v_sub_f32 v124, v124, v11
 v_sub_f32 v125, v125, v11
 v_sub_f32 v126, v126, v11
 v_sub_f32 v127, v127, v11
 v_sub_f32 v32, v32, v10
 v_sub_f32 v33, v33, v10
 v_sub_f32 v34, v34, v10
 v_sub_f32 v35, v35, v10
 v_sub_f32 v36, v36, v11
 v_sub_f32 v37, v37, v11
 v_sub_f32 v38, v38, v11
 v_sub_f32 v39, v39, v11
 v_exp_f32 v12, -v10
 v_exp_f32 v13, -v11
 v_mul_f32 v30, v12, v30
 v_mul_f32 v31, v13, v31
 v_mul_f32 v128, v12, v128
 v_mul_f32 v129, v12, v129
 v_mul_f32 v130, v12, v130
 v_mul_f32 v131, v12, v131
 v_mul_f32 v132, v13, v132
 v_mul_f32 v133, v13, v133
 v_mul_f32 v134, v13, v134
 v_mul_f32 v135, v13, v135
 v_mul_f32 v136, v12, v136
 v_mul_f32 v137, v12, v137
 v_mul_f32 v138, v12, v138
 v_mul_f32 v139, v12, v139
 v_mul_f32 v140, v13, v140
 v_mul_f32 v141, v13, v141
 v_mul_f32 v142, v13, v142
 v_mul_f32 v143, v13, v143
 v_mul_f32 v144, v12, v144
 v_mul_f32 v145, v12, v145
 v_mul_f32 v146, v12, v146
 v_mul_f32 v147, v12, v147
 v_mul_f32 v148, v13, v148
 v_mul_f32 v149, v13, v149
 v_mul_f32 v150, v13, v150
 v_mul_f32 v151, v13, v151
 v_mul_f32 v152, v12, v152
 v_mul_f32 v153, v12, v153
 v_mul_f32 v154, v12, v154
 v_mul_f32 v155, v12, v155
 v_mul_f32 v156, v13, v156
 v_mul_f32 v157, v13, v157
 v_mul_f32 v158, v13, v158
 v_mul_f32 v159, v13, v159
 v_mul_f32 v160, v12, v160
 v_mul_f32 v161, v12, v161
 v_mul_f32 v162, v12, v162
 v_mul_f32 v163, v12, v163
 v_mul_f32 v164, v13, v164
 v_mul_f32 v165, v13, v165
 v_mul_f32 v166, v13, v166
 v_mul_f32 v167, v13, v167
 v_mul_f32 v168, v12, v168
 v_mul_f32 v169, v12, v169
 v_mul_f32 v170, v12, v170
 v_mul_f32 v171, v12, v171
 v_mul_f32 v172, v13, v172
 v_mul_f32 v173, v13, v173
 v_mul_f32 v174, v13, v174
 v_mul_f32 v175, v13, v175
 v_mul_f32 v176, v12, v176
 v_mul_f32 v177, v12, v177
 v_mul_f32 v178, v12, v178
 v_mul_f32 v179, v12, v179
 v_mul_f32 v180, v13, v180
 v_mul_f32 v181, v13, v181
 v_mul_f32 v182, v13, v182
 v_mul_f32 v183, v13, v183
 v_mul_f32 v184, v12, v184
 v_mul_f32 v185, v12, v185
 v_mul_f32 v186, v12, v186
 v_mul_f32 v187, v12, v187
 v_mul_f32 v188, v13, v188
 v_mul_f32 v189, v13, v189
 v_mul_f32 v190, v13, v190
 v_mul_f32 v191, v13, v191
 v_mul_f32 v192, v12, v192
 v_mul_f32 v193, v12, v193
 v_mul_f32 v194, v12, v194
 v_mul_f32 v195, v12, v195
 v_mul_f32 v196, v13, v196
 v_mul_f32 v197, v13, v197
 v_mul_f32 v198, v13, v198
 v_mul_f32 v199, v13, v199
 v_mul_f32 v200, v12, v200
 v_mul_f32 v201, v12, v201
 v_mul_f32 v202, v12, v202
 v_mul_f32 v203, v12, v203
 v_mul_f32 v204, v13, v204
 v_mul_f32 v205, v13, v205
 v_mul_f32 v206, v13, v206
 v_mul_f32 v207, v13, v207
 v_mul_f32 v208, v12, v208
 v_mul_f32 v209, v12, v209
 v_mul_f32 v210, v12, v210
 v_mul_f32 v211, v12, v211
 v_mul_f32 v212, v13, v212
 v_mul_f32 v213, v13, v213
 v_mul_f32 v214, v13, v214
 v_mul_f32 v215, v13, v215
 v_mul_f32 v216, v12, v216
 v_mul_f32 v217, v12, v217
 v_mul_f32 v218, v12, v218
 v_mul_f32 v219, v12, v219
 v_mul_f32 v220, v13, v220
 v_mul_f32 v221, v13, v221
 v_mul_f32 v222, v13, v222
 v_mul_f32 v223, v13, v223
 v_mul_f32 v224, v12, v224
 v_mul_f32 v225, v12, v225
 v_mul_f32 v226, v12, v226
 v_mul_f32 v227, v12, v227
 v_mul_f32 v228, v13, v228
 v_mul_f32 v229, v13, v229
 v_mul_f32 v230, v13, v230
 v_mul_f32 v231, v13, v231
 v_mul_f32 v232, v12, v232
 v_mul_f32 v233, v12, v233
 v_mul_f32 v234, v12, v234
 v_mul_f32 v235, v12, v235
 v_mul_f32 v236, v13, v236
 v_mul_f32 v237, v13, v237
 v_mul_f32 v238, v13, v238
 v_mul_f32 v239, v13, v239
 v_mul_f32 v240, v12, v240
 v_mul_f32 v241, v12, v241
 v_mul_f32 v242, v12, v242
 v_mul_f32 v243, v12, v243
 v_mul_f32 v244, v13, v244
 v_mul_f32 v245, v13, v245
 v_mul_f32 v246, v13, v246
 v_mul_f32 v247, v13, v247
 v_mul_f32 v248, v12, v248
 v_mul_f32 v249, v12, v249
 v_mul_f32 v250, v12, v250
 v_mul_f32 v251, v12, v251
 v_mul_f32 v252, v13, v252
 v_mul_f32 v253, v13, v253
 v_mul_f32 v254, v13, v254
 v_mul_f32 v255, v13, v255
 v_exp_f32 v18, v64
 v_exp_f32 v19, v65
 v_exp_f32 v20, v66
 v_add_f32 v26, v18, v19
 v_cvt_pk_bf16_f32 v40, v18, v19
 v_exp_f32 v21, v67
 v_exp_f32 v22, v72
 v_add_f32 v26, v20, v26
 v_cvt_pk_bf16_f32 v41, v20, v21
 v_exp_f32 v23, v73
 v_add_f32 v26, v21, v26
 v_exp_f32 v24, v74
 v_add_f32 v26, v22, v26
 v_cvt_pk_bf16_f32 v42, v22, v23
 v_exp_f32 v25, v75
 v_add_f32 v26, v23, v26
 v_exp_f32 v18, v68
 v_add_f32 v26, v24, v26
 v_cvt_pk_bf16_f32 v43, v24, v25
 v_exp_f32 v19, v69
 v_add_f32 v26, v25, v26
 v_exp_f32 v20, v70
 v_add_f32 v27, v18, v19
 v_cvt_pk_bf16_f32 v44, v18, v19
 v_exp_f32 v21, v71
 v_exp_f32 v22, v76
 v_add_f32 v27, v20, v27
 v_cvt_pk_bf16_f32 v45, v20, v21
 v_exp_f32 v23, v77
 v_add_f32 v27, v21, v27
 v_exp_f32 v24, v78
 v_add_f32 v27, v22, v27
 v_cvt_pk_bf16_f32 v46, v22, v23
 v_exp_f32 v25, v79
 v_add_f32 v27, v23, v27
 v_add_f32 v27, v24, v27
 v_cvt_pk_bf16_f32 v47, v24, v25
 v_add_f32 v27, v25, v27
 v_exp_f32 v18, v80
 v_exp_f32 v19, v81
 v_exp_f32 v20, v82
 v_add_f32 v26, v18, v26
 v_cvt_pk_bf16_f32 v56, v18, v19
 v_exp_f32 v21, v83
 v_add_f32 v26, v19, v26
 v_exp_f32 v22, v88
 v_add_f32 v26, v20, v26
 v_cvt_pk_bf16_f32 v57, v20, v21
 v_exp_f32 v23, v89
 v_add_f32 v26, v21, v26
 v_exp_f32 v24, v90
 v_add_f32 v26, v22, v26
 v_cvt_pk_bf16_f32 v58, v22, v23
 v_exp_f32 v25, v91
 v_add_f32 v26, v23, v26
 v_exp_f32 v18, v84
 v_add_f32 v26, v24, v26
 v_cvt_pk_bf16_f32 v59, v24, v25
 v_exp_f32 v19, v85
 v_add_f32 v26, v25, v26
 v_exp_f32 v20, v86
 v_add_f32 v27, v18, v27
 v_cvt_pk_bf16_f32 v60, v18, v19
 v_exp_f32 v21, v87
 v_add_f32 v27, v19, v27
 v_exp_f32 v22, v92
 v_add_f32 v27, v20, v27
 v_cvt_pk_bf16_f32 v61, v20, v21
 v_exp_f32 v23, v93
 v_add_f32 v27, v21, v27
 v_exp_f32 v24, v94
 v_add_f32 v27, v22, v27
 v_cvt_pk_bf16_f32 v62, v22, v23
 v_exp_f32 v25, v95
 v_add_f32 v27, v23, v27
 v_add_f32 v27, v24, v27
 v_cvt_pk_bf16_f32 v63, v24, v25
 v_add_f32 v27, v25, v27
 s_nop 3
 s_setpc_b64 s[36:37]
L_slow1:
 s_nop 7
 s_nop 3
 v_max3_f32 v10, v96, v97, v98
 v_max3_f32 v10, v99, v104, v10
 v_max3_f32 v10, v105, v106, v10
 v_max3_f32 v10, v107, v112, v10
 v_max3_f32 v10, v113, v114, v10
 v_max3_f32 v10, v115, v120, v10
 v_max3_f32 v10, v121, v122, v10
 v_max_f32 v10, v123, v10
 v_max3_f32 v11, v100, v101, v102
 v_max3_f32 v11, v103, v108, v11
 v_max3_f32 v11, v109, v110, v11
 v_max3_f32 v11, v111, v116, v11
 v_max3_f32 v11, v117, v118, v11
 v_max3_f32 v11, v119, v124, v11
 v_max3_f32 v11, v125, v126, v11
 v_max_f32 v11, v127, v11
 v_mov_b32 v12, v10
 v_mov_b32 v13, v11
 s_nop 0
 v_permlane16_swap_b32 v12, v10
 v_permlane16_swap_b32 v13, v11
 v_max_f32 v10, v12, v10
 v_max_f32 v11, v13, v11
 v_mov_b32 v12, v10
 v_mov_b32 v13, v11
 s_nop 0
 v_permlane32_swap_b32 v12, v10
 v_permlane32_swap_b32 v13, v11
 v_max_f32 v10, v12, v10
 v_max_f32 v11, v13, v11
 v_ceil_f32 v10, v10
 v_ceil_f32 v11, v11
 v_max_f32 v10, 0, v10
 v_max_f32 v11, 0, v11
 v_sub_f32 v96, v96, v10
 v_sub_f32 v97, v97, v10
 v_sub_f32 v98, v98, v10
 v_sub_f32 v99, v99, v10
 v_sub_f32 v100, v100, v11
 v_sub_f32 v101, v101, v11
 v_sub_f32 v102, v102, v11
 v_sub_f32 v103, v103, v11
 v_sub_f32 v104, v104, v10
 v_sub_f32 v105, v105, v10
 v_sub_f32 v106, v106, v10
 v_sub_f32 v107, v107, v10
 v_sub_f32 v108, v108, v11
 v_sub_f32 v109, v109, v11
 v_sub_f32 v110, v110, v11
 v_sub_f32 v111, v111, v11
 v_sub_f32 v112, v112, v10
 v_sub_f32 v113, v113, v10
 v_sub_f32 v114, v114, v10
 v_sub_f32 v115, v115, v10
 v_sub_f32 v116, v116, v11
 v_sub_f32 v117, v117, v11
 v_sub_f32 v118, v118, v11
 v_sub_f32 v119, v119, v11
 v_sub_f32 v120, v120, v10
 v_sub_f32 v121, v121, v10
 v_sub_f32 v122, v122, v10
 v_sub_f32 v123, v123, v10
 v_sub_f32 v124, v124, v11
 v_sub_f32 v125, v125, v11
 v_sub_f32 v126, v126, v11
 v_sub_f32 v127, v127, v11
 v_sub_f32 v64, v64, v10
 v_sub_f32 v65, v65, v10
 v_sub_f32 v66, v66, v10
 v_sub_f32 v67, v67, v10
 v_sub_f32 v68, v68, v11
 v_sub_f32 v69, v69, v11
 v_sub_f32 v70, v70, v11
 v_sub_f32 v71, v71, v11
 v_sub_f32 v72, v72, v10
 v_sub_f32 v73, v73, v10
 v_sub_f32 v74, v74, v10
 v_sub_f32 v75, v75, v10
 v_sub_f32 v76, v76, v11
 v_sub_f32 v77, v77, v11
 v_sub_f32 v78, v78, v11
 v_sub_f32 v79, v79, v11
 v_sub_f32 v80, v80, v10
 v_sub_f32 v81, v81, v10
 v_sub_f32 v82, v82, v10
 v_sub_f32 v83, v83, v10
 v_sub_f32 v84, v84, v11
 v_sub_f32 v85, v85, v11
 v_sub_f32 v86, v86, v11
 v_sub_f32 v87, v87, v11
 v_sub_f32 v88, v88, v10
 v_sub_f32 v89, v89, v10
 v_sub_f32 v90, v90, v10
 v_sub_f32 v91, v91, v10
 v_sub_f32 v92, v92, v11
 v_sub_f32 v93, v93, v11
 v_sub_f32 v94, v94, v11
 v_sub_f32 v95, v95, v11
 v_sub_f32 v32, v32, v10
 v_sub_f32 v33, v33, v10
 v_sub_f32 v34, v34, v10
 v_sub_f32 v35, v35, v10
 v_sub_f32 v36, v36, v11
 v_sub_f32 v37, v37, v11
 v_sub_f32 v38, v38, v11
 v_sub_f32 v39, v39, v11
 v_exp_f32 v12, -v10
 v_exp_f32 v13, -v11
 v_mul_f32 v30, v12, v30
 v_mul_f32 v31, v13, v31
 v_mul_f32 v128, v12, v128
 v_mul_f32 v129, v12, v129
 v_mul_f32 v130, v12, v130
 v_mul_f32 v131, v12, v131
 v_mul_f32 v132, v13, v132
 v_mul_f32 v133, v13, v133
 v_mul_f32 v134, v13, v134
 v_mul_f32 v135, v13, v135
 v_mul_f32 v136, v12, v136
 v_mul_f32 v137, v12, v137
 v_mul_f32 v138, v12, v138
 v_mul_f32 v139, v12, v139
 v_mul_f32 v140, v13, v140
 v_mul_f32 v141, v13, v141
 v_mul_f32 v142, v13, v142
 v_mul_f32 v143, v13, v143
 v_mul_f32 v144, v12, v144
 v_mul_f32 v145, v12, v145
 v_mul_f32 v146, v12, v146
 v_mul_f32 v147, v12, v147
 v_mul_f32 v148, v13, v148
 v_mul_f32 v149, v13, v149
 v_mul_f32 v150, v13, v150
 v_mul_f32 v151, v13, v151
 v_mul_f32 v152, v12, v152
 v_mul_f32 v153, v12, v153
 v_mul_f32 v154, v12, v154
 v_mul_f32 v155, v12, v155
 v_mul_f32 v156, v13, v156
 v_mul_f32 v157, v13, v157
 v_mul_f32 v158, v13, v158
 v_mul_f32 v159, v13, v159
 v_mul_f32 v160, v12, v160
 v_mul_f32 v161, v12, v161
 v_mul_f32 v162, v12, v162
 v_mul_f32 v163, v12, v163
 v_mul_f32 v164, v13, v164
 v_mul_f32 v165, v13, v165
 v_mul_f32 v166, v13, v166
 v_mul_f32 v167, v13, v167
 v_mul_f32 v168, v12, v168
 v_mul_f32 v169, v12, v169
 v_mul_f32 v170, v12, v170
 v_mul_f32 v171, v12, v171
 v_mul_f32 v172, v13, v172
 v_mul_f32 v173, v13, v173
 v_mul_f32 v174, v13, v174
 v_mul_f32 v175, v13, v175
 v_mul_f32 v176, v12, v176
 v_mul_f32 v177, v12, v177
 v_mul_f32 v178, v12, v178
 v_mul_f32 v179, v12, v179
 v_mul_f32 v180, v13, v180
 v_mul_f32 v181, v13, v181
 v_mul_f32 v182, v13, v182
 v_mul_f32 v183, v13, v183
 v_mul_f32 v184, v12, v184
 v_mul_f32 v185, v12, v185
 v_mul_f32 v186, v12, v186
 v_mul_f32 v187, v12, v187
 v_mul_f32 v188, v13, v188
 v_mul_f32 v189, v13, v189
 v_mul_f32 v190, v13, v190
 v_mul_f32 v191, v13, v191
 v_mul_f32 v192, v12, v192
 v_mul_f32 v193, v12, v193
 v_mul_f32 v194, v12, v194
 v_mul_f32 v195, v12, v195
 v_mul_f32 v196, v13, v196
 v_mul_f32 v197, v13, v197
 v_mul_f32 v198, v13, v198
 v_mul_f32 v199, v13, v199
 v_mul_f32 v200, v12, v200
 v_mul_f32 v201, v12, v201
 v_mul_f32 v202, v12, v202
 v_mul_f32 v203, v12, v203
 v_mul_f32 v204, v13, v204
 v_mul_f32 v205, v13, v205
 v_mul_f32 v206, v13, v206
 v_mul_f32 v207, v13, v207
 v_mul_f32 v208, v12, v208
 v_mul_f32 v209, v12, v209
 v_mul_f32 v210, v12, v210
 v_mul_f32 v211, v12, v211
 v_mul_f32 v212, v13, v212
 v_mul_f32 v213, v13, v213
 v_mul_f32 v214, v13, v214
 v_mul_f32 v215, v13, v215
 v_mul_f32 v216, v12, v216
 v_mul_f32 v217, v12, v217
 v_mul_f32 v218, v12, v218
 v_mul_f32 v219, v12, v219
 v_mul_f32 v220, v13, v220
 v_mul_f32 v221, v13, v221
 v_mul_f32 v222, v13, v222
 v_mul_f32 v223, v13, v223
 v_mul_f32 v224, v12, v224
 v_mul_f32 v225, v12, v225
 v_mul_f32 v226, v12, v226
 v_mul_f32 v227, v12, v227
 v_mul_f32 v228, v13, v228
 v_mul_f32 v229, v13, v229
 v_mul_f32 v230, v13, v230
 v_mul_f32 v231, v13, v231
 v_mul_f32 v232, v12, v232
 v_mul_f32 v233, v12, v233
 v_mul_f32 v234, v12, v234
 v_mul_f32 v235, v12, v235
 v_mul_f32 v236, v13, v236
 v_mul_f32 v237, v13, v237
 v_mul_f32 v238, v13, v238
 v_mul_f32 v239, v13, v239
 v_mul_f32 v240, v12, v240
 v_mul_f32 v241, v12, v241
 v_mul_f32 v242, v12, v242
 v_mul_f32 v243, v12, v243
 v_mul_f32 v244, v13, v244
 v_mul_f32 v245, v13, v245
 v_mul_f32 v246, v13, v246
 v_mul_f32 v247, v13, v247
 v_mul_f32 v248, v12, v248
 v_mul_f32 v249, v12, v249
 v_mul_f32 v250, v12, v250
 v_mul_f32 v251, v12, v251
 v_mul_f32 v252, v13, v252
 v_mul_f32 v253, v13, v253
 v_mul_f32 v254, v13, v254
 v_mul_f32 v255, v13, v255
 v_exp_f32 v18, v96
 v_exp_f32 v19, v97
 v_exp_f32 v20, v98
 v_add_f32 v28, v18, v19
 v_cvt_pk_bf16_f32 v48, v18, v19
 v_exp_f32 v21, v99
 v_exp_f32 v22, v104
 v_add_f32 v28, v20, v28
 v_cvt_pk_bf16_f32 v49, v20, v21
 v_exp_f32 v23, v105
 v_add_f32 v28, v21, v28
 v_exp_f32 v24, v106
 v_add_f32 v28, v22, v28
 v_cvt_pk_bf16_f32 v50, v22, v23
 v_exp_f32 v25, v107
 v_add_f32 v28, v23, v28
 v_exp_f32 v18, v100
 v_add_f32 v28, v24, v28
 v_cvt_pk_bf16_f32 v51, v24, v25
 v_exp_f32 v19, v101
 v_add_f32 v28, v25, v28
 v_exp_f32 v20, v102
 v_add_f32 v29, v18, v19
 v_cvt_pk_bf16_f32 v52, v18, v19
 v_exp_f32 v21, v103
 v_exp_f32 v22, v108
 v_add_f32 v29, v20, v29
 v_cvt_pk_bf16_f32 v53, v20, v21
 v_exp_f32 v23, v109
 v_add_f32 v29, v21, v29
 v_exp_f32 v24, v110
 v_add_f32 v29, v22, v29
 v_cvt_pk_bf16_f32 v54, v22, v23
 v_exp_f32 v25, v111
 v_add_f32 v29, v23, v29
 v_add_f32 v29, v24, v29
 v_cvt_pk_bf16_f32 v55, v24, v25
 v_add_f32 v29, v25, v29
 v_exp_f32 v18, v112
 v_exp_f32 v19, v113
 v_exp_f32 v20, v114
 v_add_f32 v28, v18, v28
 v_cvt_pk_bf16_f32 v56, v18, v19
 v_exp_f32 v21, v115
 v_add_f32 v28, v19, v28
 v_exp_f32 v22, v120
 v_add_f32 v28, v20, v28
 v_cvt_pk_bf16_f32 v57, v20, v21
 v_exp_f32 v23, v121
 v_add_f32 v28, v21, v28
 v_exp_f32 v24, v122
 v_add_f32 v28, v22, v28
 v_cvt_pk_bf16_f32 v58, v22, v23
 v_exp_f32 v25, v123
 v_add_f32 v28, v23, v28
 v_exp_f32 v18, v116
 v_add_f32 v28, v24, v28
 v_cvt_pk_bf16_f32 v59, v24, v25
 v_exp_f32 v19, v117
 v_add_f32 v28, v25, v28
 v_exp_f32 v20, v118
 v_add_f32 v29, v18, v29
 v_cvt_pk_bf16_f32 v60, v18, v19
 v_exp_f32 v21, v119
 v_add_f32 v29, v19, v29
 v_exp_f32 v22, v124
 v_add_f32 v29, v20, v29
 v_cvt_pk_bf16_f32 v61, v20, v21
 v_exp_f32 v23, v125
 v_add_f32 v29, v21, v29
 v_exp_f32 v24, v126
 v_add_f32 v29, v22, v29
 v_cvt_pk_bf16_f32 v62, v22, v23
 v_exp_f32 v25, v127
 v_add_f32 v29, v23, v29
 v_add_f32 v29, v24, v29
 v_cvt_pk_bf16_f32 v63, v24, v25
 v_add_f32 v29, v25, v29
 s_nop 3
 s_setpc_b64 s[36:37]
L_slow1n:
 s_nop 7
 s_nop 3
 v_max3_f32 v10, v96, v97, v98
 v_max3_f32 v10, v99, v104, v10
 v_max3_f32 v10, v105, v106, v10
 v_max3_f32 v10, v107, v112, v10
 v_max3_f32 v10, v113, v114, v10
 v_max3_f32 v10, v115, v120, v10
 v_max3_f32 v10, v121, v122, v10
 v_max_f32 v10, v123, v10
 v_max3_f32 v11, v100, v101, v102
 v_max3_f32 v11, v103, v108, v11
 v_max3_f32 v11, v109, v110, v11
 v_max3_f32 v11, v111, v116, v11
 v_max3_f32 v11, v117, v118, v11
 v_max3_f32 v11, v119, v124, v11
 v_max3_f32 v11, v125, v126, v11
 v_max_f32 v11, v127, v11
 v_mov_b32 v12, v10
 v_mov_b32 v13, v11
 s_nop 0
 v_permlane16_swap_b32 v12, v10
 v_permlane16_swap_b32 v13, v11
 v_max_f32 v10, v12, v10
 v_max_f32 v11, v13, v11
 v_mov_b32 v12, v10
 v_mov_b32 v13, v11
 s_nop 0
 v_permlane32_swap_b32 v12, v10
 v_permlane32_swap_b32 v13, v11
 v_max_f32 v10, v12, v10
 v_max_f32 v11, v13, v11
 v_ceil_f32 v10, v10
 v_ceil_f32 v11, v11
 v_max_f32 v10, 0, v10
 v_max_f32 v11, 0, v11
 v_sub_f32 v96, v96, v10
 v_sub_f32 v97, v97, v10
 v_sub_f32 v98, v98, v10
 v_sub_f32 v99, v99, v10
 v_sub_f32 v100, v100, v11
 v_sub_f32 v101, v101, v11
 v_sub_f32 v102, v102, v11
 v_sub_f32 v103, v103, v11
 v_sub_f32 v104, v104, v10
 v_sub_f32 v105, v105, v10
 v_sub_f32 v106, v106, v10
 v_sub_f32 v107, v107, v10
 v_sub_f32 v108, v108, v11
 v_sub_f32 v109, v109, v11
 v_sub_f32 v110, v110, v11
 v_sub_f32 v111, v111, v11
 v_sub_f32 v112, v112, v10
 v_sub_f32 v113, v113, v10
 v_sub_f32 v114, v114, v10
 v_sub_f32 v115, v115, v10
 v_sub_f32 v116, v116, v11
 v_sub_f32 v117, v117, v11
 v_sub_f32 v118, v118, v11
 v_sub_f32 v119, v119, v11
 v_sub_f32 v120, v120, v10
 v_sub_f32 v121, v121, v10
 v_sub_f32 v122, v122, v10
 v_sub_f32 v123, v123, v10
 v_sub_f32 v124, v124, v11
 v_sub_f32 v125, v125, v11
 v_sub_f32 v126, v126, v11
 v_sub_f32 v127, v127, v11
 v_sub_f32 v32, v32, v10
 v_sub_f32 v33, v33, v10
 v_sub_f32 v34, v34, v10
 v_sub_f32 v35, v35, v10
 v_sub_f32 v36, v36, v11
 v_sub_f32 v37, v37, v11
 v_sub_f32 v38, v38, v11
 v_sub_f32 v39, v39, v11
 v_exp_f32 v12, -v10
 v_exp_f32 v13, -v11
 v_mul_f32 v30, v12, v30
 v_mul_f32 v31, v13, v31
 v_mul_f32 v128, v12, v128
 v_mul_f32 v129, v12, v129
 v_mul_f32 v130, v12, v130
 v_mul_f32 v131, v12, v131
 v_mul_f32 v132, v13, v132
 v_mul_f32 v133, v13, v133
 v_mul_f32 v134, v13, v134
 v_mul_f32 v135, v13, v135
 v_mul_f32 v136, v12, v136
 v_mul_f32 v137, v12, v137
 v_mul_f32 v138, v12, v138
 v_mul_f32 v139, v12, v139
 v_mul_f32 v140, v13, v140
 v_mul_f32 v141, v13, v141
 v_mul_f32 v142, v13, v142
 v_mul_f32 v143, v13, v143
 v_mul_f32 v144, v12, v144
 v_mul_f32 v145, v12, v145
 v_mul_f32 v146, v12, v146
 v_mul_f32 v147, v12, v147
 v_mul_f32 v148, v13, v148
 v_mul_f32 v149, v13, v149
 v_mul_f32 v150, v13, v150
 v_mul_f32 v151, v13, v151
 v_mul_f32 v152, v12, v152
 v_mul_f32 v153, v12, v153
 v_mul_f32 v154, v12, v154
 v_mul_f32 v155, v12, v155
 v_mul_f32 v156, v13, v156
 v_mul_f32 v157, v13, v157
 v_mul_f32 v158, v13, v158
 v_mul_f32 v159, v13, v159
 v_mul_f32 v160, v12, v160
 v_mul_f32 v161, v12, v161
 v_mul_f32 v162, v12, v162
 v_mul_f32 v163, v12, v163
 v_mul_f32 v164, v13, v164
 v_mul_f32 v165, v13, v165
 v_mul_f32 v166, v13, v166
 v_mul_f32 v167, v13, v167
 v_mul_f32 v168, v12, v168
 v_mul_f32 v169, v12, v169
 v_mul_f32 v170, v12, v170
 v_mul_f32 v171, v12, v171
 v_mul_f32 v172, v13, v172
 v_mul_f32 v173, v13, v173
 v_mul_f32 v174, v13, v174
 v_mul_f32 v175, v13, v175
 v_mul_f32 v176, v12, v176
 v_mul_f32 v177, v12, v177
 v_mul_f32 v178, v12, v178
 v_mul_f32 v179, v12, v179
 v_mul_f32 v180, v13, v180
 v_mul_f32 v181, v13, v181
 v_mul_f32 v182, v13, v182
 v_mul_f32 v183, v13, v183
 v_mul_f32 v184, v12, v184
 v_mul_f32 v185, v12, v185
 v_mul_f32 v186, v12, v186
 v_mul_f32 v187, v12, v187
 v_mul_f32 v188, v13, v188
 v_mul_f32 v189, v13, v189
 v_mul_f32 v190, v13, v190
 v_mul_f32 v191, v13, v191
 v_mul_f32 v192, v12, v192
 v_mul_f32 v193, v12, v193
 v_mul_f32 v194, v12, v194
 v_mul_f32 v195, v12, v195
 v_mul_f32 v196, v13, v196
 v_mul_f32 v197, v13, v197
 v_mul_f32 v198, v13, v198
 v_mul_f32 v199, v13, v199
 v_mul_f32 v200, v12, v200
 v_mul_f32 v201, v12, v201
 v_mul_f32 v202, v12, v202
 v_mul_f32 v203, v12, v203
 v_mul_f32 v204, v13, v204
 v_mul_f32 v205, v13, v205
 v_mul_f32 v206, v13, v206
 v_mul_f32 v207, v13, v207
 v_mul_f32 v208, v12, v208
 v_mul_f32 v209, v12, v209
 v_mul_f32 v210, v12, v210
 v_mul_f32 v211, v12, v211
 v_mul_f32 v212, v13, v212
 v_mul_f32 v213, v13, v213
 v_mul_f32 v214, v13, v214
 v_mul_f32 v215, v13, v215
 v_mul_f32 v216, v12, v216
 v_mul_f32 v217, v12, v217
 v_mul_f32 v218, v12, v218
 v_mul_f32 v219, v12, v219
 v_mul_f32 v220, v13, v220
 v_mul_f32 v221, v13, v221
 v_mul_f32 v222, v13, v222
 v_mul_f32 v223, v13, v223
 v_mul_f32 v224, v12, v224
 v_mul_f32 v225, v12, v225
 v_mul_f32 v226, v12, v226
 v_mul_f32 v227, v12, v227
 v_mul_f32 v228, v13, v228
 v_mul_f32 v229, v13, v229
 v_mul_f32 v230, v13, v230
 v_mul_f32 v231, v13, v231
 v_mul_f32 v232, v12, v232
 v_mul_f32 v233, v12, v233
 v_mul_f32 v234, v12, v234
 v_mul_f32 v235, v12, v235
 v_mul_f32 v236, v13, v236
 v_mul_f32 v237, v13, v237
 v_mul_f32 v238, v13, v238
 v_mul_f32 v239, v13, v239
 v_mul_f32 v240, v12, v240
 v_mul_f32 v241, v12, v241
 v_mul_f32 v242, v12, v242
 v_mul_f32 v243, v12, v243
 v_mul_f32 v244, v13, v244
 v_mul_f32 v245, v13, v245
 v_mul_f32 v246, v13, v246
 v_mul_f32 v247, v13, v247
 v_mul_f32 v248, v12, v248
 v_mul_f32 v249, v12, v249
 v_mul_f32 v250, v12, v250
 v_mul_f32 v251, v12, v251
 v_mul_f32 v252, v13, v252
 v_mul_f32 v253, v13, v253
 v_mul_f32 v254, v13, v254
 v_mul_f32 v255, v13, v255
 v_exp_f32 v18, v96
 v_exp_f32 v19, v97
 v_exp_f32 v20, v98
 v_add_f32 v28, v18, v19
 v_cvt_pk_bf16_f32 v48, v18, v19
 v_exp_f32 v21, v99
 v_exp_f32 v22, v104
 v_add_f32 v28, v20, v28
 v_cvt_pk_bf16_f32 v49, v20, v21
 v_exp_f32 v23, v105
 v_add_f32 v28, v21, v28
 v_exp_f32 v24, v106
 v_add_f32 v28, v22, v28
 v_cvt_pk_bf16_f32 v50, v22, v23
 v_exp_f32 v25, v107
 v_add_f32 v28, v23, v28
 v_exp_f32 v18, v100
 v_add_f32 v28, v24, v28
 v_cvt_pk_bf16_f32 v51, v24, v25
 v_exp_f32 v19, v101
 v_add_f32 v28, v25, v28
 v_exp_f32 v20, v102
 v_add_f32 v29, v18, v19
 v_cvt_pk_bf16_f32 v52, v18, v19
 v_exp_f32 v21, v103
 v_exp_f32 v22, v108
 v_add_f32 v29, v20, v29
 v_cvt_pk_bf16_f32 v53, v20, v21
 v_exp_f32 v23, v109
 v_add_f32 v29, v21, v29
 v_exp_f32 v24, v110
 v_add_f32 v29, v22, v29
 v_cvt_pk_bf16_f32 v54, v22, v23
 v_exp_f32 v25, v111
 v_add_f32 v29, v23, v29
 v_add_f32 v29, v24, v29
 v_cvt_pk_bf16_f32 v55, v24, v25
 v_add_f32 v29, v25, v29
 v_exp_f32 v18, v112
 v_exp_f32 v19, v113
 v_exp_f32 v20, v114
 v_add_f32 v28, v18, v28
 v_cvt_pk_bf16_f32 v56, v18, v19
 v_exp_f32 v21, v115
 v_add_f32 v28, v19, v28
 v_exp_f32 v22, v120
 v_add_f32 v28, v20, v28
 v_cvt_pk_bf16_f32 v57, v20, v21
 v_exp_f32 v23, v121
 v_add_f32 v28, v21, v28
 v_exp_f32 v24, v122
 v_add_f32 v28, v22, v28
 v_cvt_pk_bf16_f32 v58, v22, v23
 v_exp_f32 v25, v123
 v_add_f32 v28, v23, v28
 v_exp_f32 v18, v116
 v_add_f32 v28, v24, v28
 v_cvt_pk_bf16_f32 v59, v24, v25
 v_exp_f32 v19, v117
 v_add_f32 v28, v25, v28
 v_exp_f32 v20, v118
 v_add_f32 v29, v18, v29
 v_cvt_pk_bf16_f32 v60, v18, v19
 v_exp_f32 v21, v119
 v_add_f32 v29, v19, v29
 v_exp_f32 v22, v124
 v_add_f32 v29, v20, v29
 v_cvt_pk_bf16_f32 v61, v20, v21
 v_exp_f32 v23, v125
 v_add_f32 v29, v21, v29
 v_exp_f32 v24, v126
 v_add_f32 v29, v22, v29
 v_cvt_pk_bf16_f32 v62, v22, v23
 v_exp_f32 v25, v127
 v_add_f32 v29, v23, v29
 v_add_f32 v29, v24, v29
 v_cvt_pk_bf16_f32 v63, v24, v25
 v_add_f32 v29, v25, v29
 s_nop 3
 s_setpc_b64 s[36:37]
L_slow0B:
 s_nop 7
 s_nop 3
 v_max3_f32 v10, v64, v65, v66
 v_max3_f32 v10, v67, v72, v10
 v_max3_f32 v10, v73, v74, v10
 v_max3_f32 v10, v75, v80, v10
 v_max3_f32 v10, v81, v82, v10
 v_max3_f32 v10, v83, v88, v10
 v_max3_f32 v10, v89, v90, v10
 v_max_f32 v10, v91, v10
 v_max3_f32 v11, v68, v69, v70
 v_max3_f32 v11, v71, v76, v11
 v_max3_f32 v11, v77, v78, v11
 v_max3_f32 v11, v79, v84, v11
 v_max3_f32 v11, v85, v86, v11
 v_max3_f32 v11, v87, v92, v11
 v_max3_f32 v11, v93, v94, v11
 v_max_f32 v11, v95, v11
 v_mov_b32 v12, v10
 v_mov_b32 v13, v11
 s_nop 0
 v_permlane16_swap_b32 v12, v10
 v_permlane16_swap_b32 v13, v11
 v_max_f32 v10, v12, v10
 v_max_f32 v11, v13, v11
 v_mov_b32 v12, v10
 v_mov_b32 v13, v11
 s_nop 0
 v_permlane32_swap_b32 v12, v10
 v_permlane32_swap_b32 v13, v11
 v_max_f32 v10, v12, v10
 v_max_f32 v11, v13, v11
 v_ceil_f32 v10, v10
 v_ceil_f32 v11, v11
 v_max_f32 v10, 0, v10
 v_max_f32 v11, 0, v11
 v_sub_f32 v64, v64, v10
 v_sub_f32 v65, v65, v10
 v_sub_f32 v66, v66, v10
 v_sub_f32 v67, v67, v10
 v_sub_f32 v68, v68, v11
 v_sub_f32 v69, v69, v11
 v_sub_f32 v70, v70, v11
 v_sub_f32 v71, v71, v11
 v_sub_f32 v72, v72, v10
 v_sub_f32 v73, v73, v10
 v_sub_f32 v74, v74, v10
 v_sub_f32 v75, v75, v10
 v_sub_f32 v76, v76, v11
 v_sub_f32 v77, v77, v11
 v_sub_f32 v78, v78, v11
 v_sub_f32 v79, v79, v11
 v_sub_f32 v80, v80, v10
 v_sub_f32 v81, v81, v10
 v_sub_f32 v82, v82, v10
 v_sub_f32 v83, v83, v10
 v_sub_f32 v84, v84, v11
 v_sub_f32 v85, v85, v11
 v_sub_f32 v86, v86, v11
 v_sub_f32 v87, v87, v11
 v_sub_f32 v88, v88, v10
 v_sub_f32 v89, v89, v10
 v_sub_f32 v90, v90, v10
 v_sub_f32 v91, v91, v10
 v_sub_f32 v92, v92, v11
 v_sub_f32 v93, v93, v11
 v_sub_f32 v94, v94, v11
 v_sub_f32 v95, v95, v11
 v_sub_f32 v100, v100, v11
 v_sub_f32 v101, v101, v11
 v_sub_f32 v102, v102, v11
 v_sub_f32 v103, v103, v11
 v_sub_f32 v108, v108, v11
 v_sub_f32 v109, v109, v11
 v_sub_f32 v110, v110, v11
 v_sub_f32 v111, v111, v11
 v_sub_f32 v116, v116, v11
 v_sub_f32 v117, v117, v11
 v_sub_f32 v118, v118, v11
 v_sub_f32 v119, v119, v11
 v_sub_f32 v124, v124, v11
 v_sub_f32 v125, v125, v11
 v_sub_f32 v126, v126, v11
 v_sub_f32 v127, v127, v11
 v_sub_f32 v32, v32, v10
 v_sub_f32 v33, v33, v10
 v_sub_f32 v34, v34, v10
 v_sub_f32 v35, v35, v10
 v_sub_f32 v36, v36, v11
 v_sub_f32 v37, v37, v11
 v_sub_f32 v38, v38, v11
 v_sub_f32 v39, v39, v11
 v_exp_f32 v12, -v10
 v_exp_f32 v13, -v11
 v_mul_f32 v30, v12, v30
 v_mul_f32 v31, v13, v31
 v_mul_f32 v128, v12, v128
 v_mul_f32 v129, v12, v129
 v_mul_f32 v130, v12, v130
 v_mul_f32 v131, v12, v131
 v_mul_f32 v132, v13, v132
 v_mul_f32 v133, v13, v133
 v_mul_f32 v134, v13, v134
 v_mul_f32 v135, v13, v135
 v_mul_f32 v136, v12, v136
 v_mul_f32 v137, v12, v137
 v_mul_f32 v138, v12, v138
 v_mul_f32 v139, v12, v139
 v_mul_f32 v140, v13, v140
 v_mul_f32 v141, v13, v141
 v_mul_f32 v142, v13, v142
 v_mul_f32 v143, v13, v143
 v_mul_f32 v144, v12, v144
 v_mul_f32 v145, v12, v145
 v_mul_f32 v146, v12, v146
 v_mul_f32 v147, v12, v147
 v_mul_f32 v148, v13, v148
 v_mul_f32 v149, v13, v149
 v_mul_f32 v150, v13, v150
 v_mul_f32 v151, v13, v151
 v_mul_f32 v152, v12, v152
 v_mul_f32 v153, v12, v153
 v_mul_f32 v154, v12, v154
 v_mul_f32 v155, v12, v155
 v_mul_f32 v156, v13, v156
 v_mul_f32 v157, v13, v157
 v_mul_f32 v158, v13, v158
 v_mul_f32 v159, v13, v159
 v_mul_f32 v160, v12, v160
 v_mul_f32 v161, v12, v161
 v_mul_f32 v162, v12, v162
 v_mul_f32 v163, v12, v163
 v_mul_f32 v164, v13, v164
 v_mul_f32 v165, v13, v165
 v_mul_f32 v166, v13, v166
 v_mul_f32 v167, v13, v167
 v_mul_f32 v168, v12, v168
 v_mul_f32 v169, v12, v169
 v_mul_f32 v170, v12, v170
 v_mul_f32 v171, v12, v171
 v_mul_f32 v172, v13, v172
 v_mul_f32 v173, v13, v173
 v_mul_f32 v174, v13, v174
 v_mul_f32 v175, v13, v175
 v_mul_f32 v176, v12, v176
 v_mul_f32 v177, v12, v177
 v_mul_f32 v178, v12, v178
 v_mul_f32 v179, v12, v179
 v_mul_f32 v180, v13, v180
 v_mul_f32 v181, v13, v181
 v_mul_f32 v182, v13, v182
 v_mul_f32 v183, v13, v183
 v_mul_f32 v184, v12, v184
 v_mul_f32 v185, v12, v185
 v_mul_f32 v186, v12, v186
 v_mul_f32 v187, v12, v187
 v_mul_f32 v188, v13, v188
 v_mul_f32 v189, v13, v189
 v_mul_f32 v190, v13, v190
 v_mul_f32 v191, v13, v191
 v_mul_f32 v192, v12, v192
 v_mul_f32 v193, v12, v193
 v_mul_f32 v194, v12, v194
 v_mul_f32 v195, v12, v195
 v_mul_f32 v196, v13, v196
 v_mul_f32 v197, v13, v197
 v_mul_f32 v198, v13, v198
 v_mul_f32 v199, v13, v199
 v_mul_f32 v200, v12, v200
 v_mul_f32 v201, v12, v201
 v_mul_f32 v202, v12, v202
 v_mul_f32 v203, v12, v203
 v_mul_f32 v204, v13, v204
 v_mul_f32 v205, v13, v205
 v_mul_f32 v206, v13, v206
 v_mul_f32 v207, v13, v207
 v_mul_f32 v208, v12, v208
 v_mul_f32 v209, v12, v209
 v_mul_f32 v210, v12, v210
 v_mul_f32 v211, v12, v211
 v_mul_f32 v212, v13, v212
 v_mul_f32 v213, v13, v213
 v_mul_f32 v214, v13, v214
 v_mul_f32 v215, v13, v215
 v_mul_f32 v216, v12, v216
 v_mul_f32 v217, v12, v217
 v_mul_f32 v218, v12, v218
 v_mul_f32 v219, v12, v219
 v_mul_f32 v220, v13, v220
 v_mul_f32 v221, v13, v221
 v_mul_f32 v222, v13, v222
 v_mul_f32 v223, v13, v223
 v_mul_f32 v224, v12, v224
 v_mul_f32 v225, v12, v225
 v_mul_f32 v226, v12, v226
 v_mul_f32 v227, v12, v227
 v_mul_f32 v228, v13, v228
 v_mul_f32 v229, v13, v229
 v_mul_f32 v230, v13, v230
 v_mul_f32 v231, v13, v231
 v_mul_f32 v232, v12, v232
 v_mul_f32 v233, v12, v233
 v_mul_f32 v234, v12, v234
 v_mul_f32 v235, v12, v235
 v_mul_f32 v236, v13, v236
 v_mul_f32 v237, v13, v237
 v_mul_f32 v238, v13, v238
 v_mul_f32 v239, v13, v239
 v_mul_f32 v240, v12, v240
 v_mul_f32 v241, v12, v241
 v_mul_f32 v242, v12, v242
 v_mul_f32 v243, v12, v243
 v_mul_f32 v244, v13, v244
 v_mul_f32 v245, v13, v245
 v_mul_f32 v246, v13, v246
 v_mul_f32 v247, v13, v247
 v_mul_f32 v248, v12, v248
 v_mul_f32 v249, v12, v249
 v_mul_f32 v250, v12, v250
 v_mul_f32 v251, v12, v251
 v_mul_f32 v252, v13, v252
 v_mul_f32 v253, v13, v253
 v_mul_f32 v254, v13, v254
 v_mul_f32 v255, v13, v255
 v_exp_f32 v18, v64
 v_exp_f32 v19, v65
 v_exp_f32 v20, v66
 v_add_f32 v26, v18, v19
 v_cvt_pk_bf16_f32 v40, v18, v19
 v_exp_f32 v21, v67
 v_exp_f32 v22, v72
 v_add_f32 v26, v20, v26
 v_cvt_pk_bf16_f32 v41, v20, v21
 v_exp_f32 v23, v73
 v_add_f32 v26, v21, v26
 v_exp_f32 v24, v74
 v_add_f32 v26, v22, v26
 v_cvt_pk_bf16_f32 v42, v22, v23
 v_exp_f32 v25, v75
 v_add_f32 v26, v23, v26
 v_exp_f32 v18, v68
 v_add_f32 v26, v24, v26
 v_cvt_pk_bf16_f32 v43, v24, v25
 v_exp_f32 v19, v69
 v_add_f32 v26, v25, v26
 v_exp_f32 v20, v70
 v_add_f32 v27, v18, v19
 v_cvt_pk_bf16_f32 v44, v18, v19
 v_exp_f32 v21, v71
 v_exp_f32 v22, v76
 v_add_f32 v27, v20, v27
 v_cvt_pk_bf16_f32 v45, v20, v21
 v_exp_f32 v23, v77
 v_add_f32 v27, v21, v27
 v_exp_f32 v24, v78
 v_add_f32 v27, v22, v27
 v_cvt_pk_bf16_f32 v46, v22, v23
 v_exp_f32 v25, v79
 v_add_f32 v27, v23, v27
 v_add_f32 v27, v24, v27
 v_cvt_pk_bf16_f32 v47, v24, v25
 v_add_f32 v27, v25, v27
 v_exp_f32 v18, v80
 v_exp_f32 v19, v81
 v_exp_f32 v20, v82
 v_add_f32 v26, v18, v26
 v_cvt_pk_bf16_f32 v56, v18, v19
 v_exp_f32 v21, v83
 v_add_f32 v26, v19, v26
 v_exp_f32 v22, v88
 v_add_f32 v26, v20, v26
 v_cvt_pk_bf16_f32 v57, v20, v21
 v_exp_f32 v23, v89
 v_add_f32 v26, v21, v26
 v_exp_f32 v24, v90
 v_add_f32 v26, v22, v26
 v_cvt_pk_bf16_f32 v58, v22, v23
 v_exp_f32 v25, v91
 v_add_f32 v26, v23, v26
 v_exp_f32 v18, v84
 v_add_f32 v26, v24, v26
 v_cvt_pk_bf16_f32 v59, v24, v25
 v_exp_f32 v19, v85
 v_add_f32 v26, v25, v26
 v_exp_f32 v20, v86
 v_add_f32 v27, v18, v27
 v_cvt_pk_bf16_f32 v60, v18, v19
 v_exp_f32 v21, v87
 v_add_f32 v27, v19, v27
 v_exp_f32 v22, v92
 v_add_f32 v27, v20, v27
 v_cvt_pk_bf16_f32 v61, v20, v21
 v_exp_f32 v23, v93
 v_add_f32 v27, v21, v27
 v_exp_f32 v24, v94
 v_add_f32 v27, v22, v27
 v_cvt_pk_bf16_f32 v62, v22, v23
 v_exp_f32 v25, v95
 v_add_f32 v27, v23, v27
 v_add_f32 v27, v24, v27
 v_cvt_pk_bf16_f32 v63, v24, v25
 v_add_f32 v27, v25, v27
 s_nop 3
 s_setpc_b64 s[36:37]
L_slowB:
 s_nop 7
 s_nop 3
 v_max3_f32 v11, v100, v101, v102
 v_max3_f32 v11, v103, v108, v11
 v_max3_f32 v11, v109, v110, v11
 v_max3_f32 v11, v111, v116, v11
 v_max3_f32 v11, v117, v118, v11
 v_max3_f32 v11, v119, v124, v11
 v_max3_f32 v11, v125, v126, v11
 v_max_f32 v11, v127, v11
 v_mov_b32 v13, v11
 s_nop 1
 v_permlane16_swap_b32 v13, v11
 v_max_f32 v11, v13, v11
 v_mov_b32 v13, v11
 s_nop 1
 v_permlane32_swap_b32 v13, v11
 v_max_f32 v11, v13, v11
 v_ceil_f32 v11, v11
 v_max_f32 v11, 0, v11
 v_sub_f32 v100, v100, v11
 v_sub_f32 v101, v101, v11
 v_sub_f32 v102, v102, v11
 v_sub_f32 v103, v103, v11
 v_sub_f32 v108, v108, v11
 v_sub_f32 v109, v109, v11
 v_sub_f32 v110, v110, v11
 v_sub_f32 v111, v111, v11
 v_sub_f32 v116, v116, v11
 v_sub_f32 v117, v117, v11
 v_sub_f32 v118, v118, v11
 v_sub_f32 v119, v119, v11
 v_sub_f32 v124, v124, v11
 v_sub_f32 v125, v125, v11
 v_sub_f32 v126, v126, v11
 v_sub_f32 v127, v127, v11
 v_sub_f32 v36, v36, v11
 v_sub_f32 v37, v37, v11
 v_sub_f32 v38, v38, v11
 v_sub_f32 v39, v39, v11
 v_exp_f32 v13, -v11
 s_nop 0
 v_mul_f32 v31, v13, v31
 v_mul_f32 v132, v13, v132
 v_mul_f32 v133, v13, v133
 v_mul_f32 v134, v13, v134
 v_mul_f32 v135, v13, v135
 v_mul_f32 v140, v13, v140
 v_mul_f32 v141, v13, v141
 v_mul_f32 v142, v13, v142
 v_mul_f32 v143, v13, v143
 v_mul_f32 v148, v13, v148
 v_mul_f32 v149, v13, v149
 v_mul_f32 v150, v13, v150
 v_mul_f32 v151, v13, v151
 v_mul_f32 v156, v13, v156
 v_mul_f32 v157, v13, v157
 v_mul_f32 v158, v13, v158
 v_mul_f32 v159, v13, v159
 v_mul_f32 v164, v13, v164
 v_mul_f32 v165, v13, v165
 v_mul_f32 v166, v13, v166
 v_mul_f32 v167, v13, v167
 v_mul_f32 v172, v13, v172
 v_mul_f32 v173, v13, v173
 v_mul_f32 v174, v13, v174
 v_mul_f32 v175, v13, v175
 v_mul_f32 v180, v13, v180
 v_mul_f32 v181, v13, v181
 v_mul_f32 v182, v13, v182
 v_mul_f32 v183, v13, v183
 v_mul_f32 v188, v13, v188
 v_mul_f32 v189, v13, v189
 v_mul_f32 v190, v13, v190
 v_mul_f32 v191, v13, v191
 v_mul_f32 v196, v13, v196
 v_mul_f32 v197, v13, v197
 v_mul_f32 v198, v13, v198
 v_mul_f32 v199, v13, v199
 v_mul_f32 v204, v13, v204
 v_mul_f32 v205, v13, v205
 v_mul_f32 v206, v13, v206
 v_mul_f32 v207, v13, v207
 v_mul_f32 v212, v13, v212
 v_mul_f32 v213, v13, v213
 v_mul_f32 v214, v13, v214
 v_mul_f32 v215, v13, v215
 v_mul_f32 v220, v13, v220
 v_mul_f32 v221, v13, v221
 v_mul_f32 v222, v13, v222
 v_mul_f32 v223, v13, v223
 v_mul_f32 v228, v13, v228
 v_mul_f32 v229, v13, v229
 v_mul_f32 v230, v13, v230
 v_mul_f32 v231, v13, v231
 v_mul_f32 v236, v13, v236
 v_mul_f32 v237, v13, v237
 v_mul_f32 v238, v13, v238
 v_mul_f32 v239, v13, v239
 v_mul_f32 v244, v13, v244
 v_mul_f32 v245, v13, v245
 v_mul_f32 v246, v13, v246
 v_mul_f32 v247, v13, v247
 v_mul_f32 v252, v13, v252
 v_mul_f32 v253, v13, v253
 v_mul_f32 v254, v13, v254
 v_mul_f32 v255, v13, v255
 v_exp_f32 v18, v100
 v_exp_f32 v19, v101
 v_exp_f32 v20, v102
 v_add_f32 v29, v18, v19
 v_cvt_pk_bf16_f32 v52, v18, v19
 v_exp_f32 v21, v103
 v_exp_f32 v22, v108
 v_add_f32 v29, v20, v29
 v_cvt_pk_bf16_f32 v53, v20, v21
 v_exp_f32 v23, v109
 v_add_f32 v29, v21, v29
 v_exp_f32 v24, v110
 v_add_f32 v29, v22, v29
 v_cvt_pk_bf16_f32 v54, v22, v23
 v_exp_f32 v25, v111
 v_add_f32 v29, v23, v29
 v_exp_f32 v18, v116
 v_add_f32 v29, v24, v29
 v_cvt_pk_bf16_f32 v55, v24, v25
 v_exp_f32 v19, v117
 v_add_f32 v29, v25, v29
 v_exp_f32 v20, v118
 v_add_f32 v29, v18, v29
 v_cvt_pk_bf16_f32 v48, v18, v19
 v_exp_f32 v21, v119
 v_add_f32 v29, v19, v29
 v_exp_f32 v22, v124
 v_add_f32 v29, v20, v29
 v_cvt_pk_bf16_f32 v49, v20, v21
 v_exp_f32 v23, v125
 v_add_f32 v29, v21, v29
 v_exp_f32 v24, v126
 v_add_f32 v29, v22, v29
 v_cvt_pk_bf16_f32 v50, v22, v23
 v_exp_f32 v25, v127
 v_add_f32 v29, v23, v29
 v_add_f32 v29, v24, v29
 v_cvt_pk_bf16_f32 v51, v24, v25
 v_add_f32 v29, v25, v29
 s_nop 3
 s_setpc_b64 s[36:37]
L_slowf:
 s_nop 7
 s_nop 3
 v_max3_f32 v10, v64, v65, v66
 v_max3_f32 v10, v67, v72, v10
 v_max3_f32 v10, v73, v74, v10
 v_max3_f32 v10, v75, v80, v10
 v_max3_f32 v10, v81, v82, v10
 v_max3_f32 v10, v83, v88, v10
 v_max3_f32 v10, v89, v90, v10
 v_max_f32 v10, v91, v10
 v_max3_f32 v11, v68, v69, v70
 v_max3_f32 v11, v71, v76, v11
 v_max3_f32 v11, v77, v78, v11
 v_max3_f32 v11, v79, v84, v11
 v_max3_f32 v11, v85, v86, v11
 v_max3_f32 v11, v87, v92, v11
 v_max3_f32 v11, v93, v94, v11
 v_max_f32 v11, v95, v11
 v_mov_b32 v12, v10
 v_mov_b32 v13, v11
 s_nop 0
 v_permlane16_swap_b32 v12, v10
 v_permlane16_swap_b32 v13, v11
 v_max_f32 v10, v12, v10
 v_max_f32 v11, v13, v11
 v_mov_b32 v12, v10
 v_mov_b32 v13, v11
 s_nop 0
 v_permlane32_swap_b32 v12, v10
 v_permlane32_swap_b32 v13, v11
 v_max_f32 v10, v12, v10
 v_max_f32 v11, v13, v11
 v_ceil_f32 v10, v10
 v_ceil_f32 v11, v11
 v_sub_f32 v64, v64, v10
 v_sub_f32 v65, v65, v10
 v_sub_f32 v66, v66, v10
 v_sub_f32 v67, v67, v10
 v_sub_f32 v68, v68, v11
 v_sub_f32 v69, v69, v11
 v_sub_f32 v70, v70, v11
 v_sub_f32 v71, v71, v11
 v_sub_f32 v72, v72, v10
 v_sub_f32 v73, v73, v10
 v_sub_f32 v74, v74, v10
 v_sub_f32 v75, v75, v10
 v_sub_f32 v76, v76, v11
 v_sub_f32 v77, v77, v11
 v_sub_f32 v78, v78, v11
 v_sub_f32 v79, v79, v11
 v_sub_f32 v80, v80, v10
 v_sub_f32 v81, v81, v10
 v_sub_f32 v82, v82, v10
 v_sub_f32 v83, v83, v10
 v_sub_f32 v84, v84, v11
 v_sub_f32 v85, v85, v11
 v_sub_f32 v86, v86, v11
 v_sub_f32 v87, v87, v11
 v_sub_f32 v88, v88, v10
 v_sub_f32 v89, v89, v10
 v_sub_f32 v90, v90, v10
 v_sub_f32 v91, v91, v10
 v_sub_f32 v92, v92, v11
 v_sub_f32 v93, v93, v11
 v_sub_f32 v94, v94, v11
 v_sub_f32 v95, v95, v11
 v_sub_f32 v96, v96, v10
 v_sub_f32 v97, v97, v10
 v_sub_f32 v98, v98, v10
 v_sub_f32 v99, v99, v10
 v_sub_f32 v100, v100, v11
 v_sub_f32 v101, v101, v11
 v_sub_f32 v102, v102, v11
 v_sub_f32 v103, v103, v11
 v_sub_f32 v104, v104, v10
 v_sub_f32 v105, v105, v10
 v_sub_f32 v106, v106, v10
 v_sub_f32 v107, v107, v10
 v_sub_f32 v108, v108, v11
 v_sub_f32 v109, v109, v11
 v_sub_f32 v110, v110, v11
 v_sub_f32 v111, v111, v11
 v_sub_f32 v112, v112, v10
 v_sub_f32 v113, v113, v10
 v_sub_f32 v114, v114, v10
 v_sub_f32 v115, v115, v10
 v_sub_f32 v116, v116, v11
 v_sub_f32 v117, v117, v11
 v_sub_f32 v118, v118, v11
 v_sub_f32 v119, v119, v11
 v_sub_f32 v120, v120, v10
 v_sub_f32 v121, v121, v10
 v_sub_f32 v122, v122, v10
 v_sub_f32 v123, v123, v10
 v_sub_f32 v124, v124, v11
 v_sub_f32 v125, v125, v11
 v_sub_f32 v126, v126, v11
 v_sub_f32 v127, v127, v11
 v_sub_f32 v32, v32, v10
 v_sub_f32 v33, v33, v10
 v_sub_f32 v34, v34, v10
 v_sub_f32 v35, v35, v10
 v_sub_f32 v36, v36, v11
 v_sub_f32 v37, v37, v11
 v_sub_f32 v38, v38, v11
 v_sub_f32 v39, v39, v11
 v_exp_f32 v18, v64
 v_exp_f32 v19, v65
 v_exp_f32 v20, v66
 v_add_f32 v26, v18, v19
 v_cvt_pk_bf16_f32 v40, v18, v19
 v_exp_f32 v21, v67
 v_exp_f32 v22, v72
 v_add_f32 v26, v20, v26
 v_cvt_pk_bf16_f32 v41, v20, v21
 v_exp_f32 v23, v73
 v_add_f32 v26, v21, v26
 v_exp_f32 v24, v74
 v_add_f32 v26, v22, v26
 v_cvt_pk_bf16_f32 v42, v22, v23
 v_exp_f32 v25, v75
 v_add_f32 v26, v23, v26
 v_exp_f32 v18, v68
 v_add_f32 v26, v24, v26
 v_cvt_pk_bf16_f32 v43, v24, v25
 v_exp_f32 v19, v69
 v_add_f32 v26, v25, v26
 v_exp_f32 v20, v70
 v_add_f32 v27, v18, v19
 v_cvt_pk_bf16_f32 v44, v18, v19
 v_exp_f32 v21, v71
 v_exp_f32 v22, v76
 v_add_f32 v27, v20, v27
 v_cvt_pk_bf16_f32 v45, v20, v21
 v_exp_f32 v23, v77
 v_add_f32 v27, v21, v27
 v_exp_f32 v24, v78
 v_add_f32 v27, v22, v27
 v_cvt_pk_bf16_f32 v46, v22, v23
 v_exp_f32 v25, v79
 v_add_f32 v27, v23, v27
 v_add_f32 v27, v24, v27
 v_cvt_pk_bf16_f32 v47, v24, v25
 v_add_f32 v27, v25, v27
 v_exp_f32 v18, v80
 v_exp_f32 v19, v81
 v_exp_f32 v20, v82
 v_add_f32 v26, v18, v26
 v_cvt_pk_bf16_f32 v56, v18, v19
 v_exp_f32 v21, v83
 v_add_f32 v26, v19, v26
 v_exp_f32 v22, v88
 v_add_f32 v26, v20, v26
 v_cvt_pk_bf16_f32 v57, v20, v21
 v_exp_f32 v23, v89
 v_add_f32 v26, v21, v26
 v_exp_f32 v24, v90
 v_add_f32 v26, v22, v26
 v_cvt_pk_bf16_f32 v58, v22, v23
 v_exp_f32 v25, v91
 v_add_f32 v26, v23, v26
 v_exp_f32 v18, v84
 v_add_f32 v26, v24, v26
 v_cvt_pk_bf16_f32 v59, v24, v25
 v_exp_f32 v19, v85
 v_add_f32 v26, v25, v26
 v_exp_f32 v20, v86
 v_add_f32 v27, v18, v27
 v_cvt_pk_bf16_f32 v60, v18, v19
 v_exp_f32 v21, v87
 v_add_f32 v27, v19, v27
 v_exp_f32 v22, v92
 v_add_f32 v27, v20, v27
 v_cvt_pk_bf16_f32 v61, v20, v21
 v_exp_f32 v23, v93
 v_add_f32 v27, v21, v27
 v_exp_f32 v24, v94
 v_add_f32 v27, v22, v27
 v_cvt_pk_bf16_f32 v62, v22, v23
 v_exp_f32 v25, v95
 v_add_f32 v27, v23, v27
 v_add_f32 v27, v24, v27
 v_cvt_pk_bf16_f32 v63, v24, v25
 v_add_f32 v27, v25, v27
 s_nop 3
 s_setpc_b64 s[36:37]
L_moe0:
 s_lshl_b32 s88, s75, 1
 s_call_b64 s[36:37], L_moe
 v_add_f32 v32, v108, v32
 v_add_f32 v33, v109, v33
 v_add_f32 v34, v110, v34
 v_add_f32 v35, v111, v35
 v_add_f32 v36, v112, v36
 v_add_f32 v37, v113, v37
 v_add_f32 v38, v114, v38
 v_add_f32 v39, v115, v39
 v_add_f32 v40, v116, v40
 v_add_f32 v41, v117, v41
 v_add_f32 v42, v118, v42
 v_add_f32 v43, v119, v43
 v_add_f32 v44, v120, v44
 v_add_f32 v45, v121, v45
 v_add_f32 v46, v122, v46
 v_add_f32 v47, v123, v47
 s_mov_b64 exec, -1
 s_branch L_moe_ret0
L_moe1:
 s_lshl_b32 s88, s86, 1
 s_call_b64 s[36:37], L_moe
 v_add_f32 v80, v108, v80
 v_add_f32 v81, v109, v81
 v_add_f32 v82, v110, v82
 v_add_f32 v83, v111, v83
 v_add_f32 v84, v112, v84
 v_add_f32 v85, v113, v85
 v_add_f32 v86, v114, v86
 v_add_f32 v87, v115, v87
 s_mov_b64 exec, -1
 s_branch L_moe_ret1
L_moe2:
 s_lshl_b32 s88, s86, 1
 s_call_b64 s[36:37], L_moe
 v_add_f32 v32, v108, v32
 v_add_f32 v33, v109, v33
 v_add_f32 v34, v110, v34
 v_add_f32 v35, v111, v35
 v_add_f32 v36, v112, v36
 v_add_f32 v37, v113, v37
 v_add_f32 v38, v114, v38
 v_add_f32 v39, v115, v39
 s_mov_b64 exec, -1
 s_branch L_moe_ret2
L_moe:
 v_min_u32 v104, 27, v0
 v_lshlrev_b32 v104, 2, v104
 s_mov_b32 s64, 105062912
 s_mov_b32 s65, 65536
 s_mov_b32 exec_lo, 0xffffffff
 s_mov_b32 exec_hi, 0xffffffff
L_pfy:
 buffer_load_dword v105, v104, s[8:11], s64 offen sc1
 s_sub_u32 s65, s65, 1
 s_cbranch_scc1 L_pfy_x
 s_waitcnt vmcnt(0)
 v_cmp_ne_u32 vcc, 1, v105
 s_nop 0
 s_cbranch_vccz L_pfy_x
 s_sleep 2
 s_branch L_pfy
L_pfy_x:
 s_waitcnt vmcnt(0)
 s_mov_b64 exec, -1
 s_or_b64 exec, s[80:81], s[82:83]
 v_mov_b32 v104, 1792
 v_cndmask_b32 v104, v104, 0, s[80:81]
 v_lshl_add_u32 v104, v11, 5, v104
 s_add_u32 s88, s88, 104898560
 buffer_load_dwordx4 v[108:111], v104, s[8:11], s88 offen sc1
 buffer_load_dwordx4 v[112:115], v104, s[8:11], s88 offen offset:16 sc1
 buffer_load_dwordx4 v[116:119], v104, s[8:11], s88 offen offset:512 sc1
 buffer_load_dwordx4 v[120:123], v104, s[8:11], s88 offen offset:528 sc1
 s_waitcnt vmcnt(0)
 s_setpc_b64 s[36:37]
L_y1:
 s_lshl_b32 s89, s41, 1
 s_add_u32 s89, s89, s20
 s_cmp_ge_u32 s20, 2
 s_cselect_b32 s89, 28, s89
 s_cmp_ge_u32 s89, 28
 s_cbranch_scc1 L_y1r
 v_lshrrev_b32 v50, 4, v7
 v_lshrrev_b32 v51, 3, v50
 v_mul_u32_u24 v51, 4352, v51
 v_and_b32 v52, 7, v50
 v_lshl_add_u32 v51, v52, 7, v51
 s_mov_b32 s90, 104923136
 s_mov_b32 s88, 104957952
 s_mov_b32 s91, 65536
L_yp:
 buffer_load_dword v52, v51, s[8:11], s90 offen sc1
 buffer_load_dword v53, v51, s[8:11], s88 offen sc1
 s_waitcnt vmcnt(0)
 v_min_u32 v52, v52, v53
 v_cmp_gt_u32 vcc, 4, v52
 s_sub_u32 s91, s91, 1
 s_cbranch_scc1 L_ypx
 s_cbranch_vccnz L_yp
L_ypx:
 s_cmp_lt_u32 s89, 14
 s_cselect_b32 s90, 8, 12
 s_add_u32 s90, s90, 104890368
 buffer_load_dword v53, off, s[8:11], s90 sc1
 v_lshrrev_b32 v51, 3, v50
 v_mul_u32_u24 v51, 3584, v51
 v_and_b32 v52, 7, v50
 v_lshl_add_u32 v51, v52, 4, v51
 s_lshl_b32 s88, s89, 7
 s_add_u32 s90, s88, 104898560
 s_add_u32 s88, s88, 105906176
 buffer_load_dwordx4 v[136:139], v51, s[8:11], s88 offen sc1
 s_add_u32 s88, s88, 28672
 buffer_load_dwordx4 v[140:143], v51, s[8:11], s88 offen sc1
 s_add_u32 s88, s88, 28672
 buffer_load_dwordx4 v[152:155], v51, s[8:11], s88 offen sc1
 s_add_u32 s88, s88, 28672
 buffer_load_dwordx4 v[156:159], v51, s[8:11], s88 offen sc1
 s_add_u32 s88, s88, 28672
 buffer_load_dwordx4 v[168:171], v51, s[8:11], s88 offen sc1
 s_add_u32 s88, s88, 28672
 buffer_load_dwordx4 v[172:175], v51, s[8:11], s88 offen sc1
 s_add_u32 s88, s88, 28672
 buffer_load_dwordx4 v[184:187], v51, s[8:11], s88 offen sc1
 s_add_u32 s88, s88, 28672
 buffer_load_dwordx4 v[188:191], v51, s[8:11], s88 offen sc1
 s_add_u32 s88, s88, 28672
 buffer_load_dwordx4 v[200:203], v51, s[8:11], s88 offen sc1
 s_add_u32 s88, s88, 28672
 buffer_load_dwordx4 v[204:207], v51, s[8:11], s88 offen sc1
 s_add_u32 s88, s88, 28672
 buffer_load_dwordx4 v[216:219], v51, s[8:11], s88 offen sc1
 s_add_u32 s88, s88, 28672
 buffer_load_dwordx4 v[220:223], v51, s[8:11], s88 offen sc1
 s_add_u32 s88, s88, 28672
 buffer_load_dwordx4 v[232:235], v51, s[8:11], s88 offen sc1
 s_add_u32 s88, s88, 28672
 buffer_load_dwordx4 v[236:239], v51, s[8:11], s88 offen sc1
 s_add_u32 s88, s88, 28672
 s_branch L_y1r
L_y2:
 s_cmp_ge_u32 s89, 28
 s_cbranch_scc1 L_y2r
 s_waitcnt vmcnt(24)
 s_waitcnt vmcnt(12)
 v_add_f32 v136, v140, v136
 v_add_f32 v137, v141, v137
 v_add_f32 v138, v142, v138
 v_add_f32 v139, v143, v139
 s_waitcnt vmcnt(11)
 v_add_f32 v136, v152, v136
 v_add_f32 v137, v153, v137
 v_add_f32 v138, v154, v138
 v_add_f32 v139, v155, v139
 s_waitcnt vmcnt(10)
 v_add_f32 v136, v156, v136
 v_add_f32 v137, v157, v137
 v_add_f32 v138, v158, v138
 v_add_f32 v139, v159, v139
 s_waitcnt vmcnt(9)
 v_add_f32 v136, v168, v136
 v_add_f32 v137, v169, v137
 v_add_f32 v138, v170, v138
 v_add_f32 v139, v171, v139
 s_waitcnt vmcnt(8)
 v_add_f32 v136, v172, v136
 v_add_f32 v137, v173, v137
 v_add_f32 v138, v174, v138
 v_add_f32 v139, v175, v139
 s_waitcnt vmcnt(7)
 v_add_f32 v136, v184, v136
 v_add_f32 v137, v185, v137
 v_add_f32 v138, v186, v138
 v_add_f32 v139, v187, v139
 s_waitcnt vmcnt(6)
 v_add_f32 v136, v188, v136
 v_add_f32 v137, v189, v137
 v_add_f32 v138, v190, v138
 v_add_f32 v139, v191, v139
 s_waitcnt vmcnt(5)
 v_add_f32 v136, v200, v136
 v_add_f32 v137, v201, v137
 v_add_f32 v138, v202, v138
 v_add_f32 v139, v203, v139
 s_waitcnt vmcnt(4)
 v_add_f32 v136, v204, v136
 v_add_f32 v137, v205, v137
 v_add_f32 v138, v206, v138
 v_add_f32 v139, v207, v139
 s_waitcnt vmcnt(3)
 v_add_f32 v136, v216, v136
 v_add_f32 v137, v217, v137
 v_add_f32 v138, v218, v138
 v_add_f32 v139, v219, v139
 s_waitcnt vmcnt(2)
 v_add_f32 v136, v220, v136
 v_add_f32 v137, v221, v137
 v_add_f32 v138, v222, v138
 v_add_f32 v139, v223, v139
 s_waitcnt vmcnt(1)
 v_add_f32 v136, v232, v136
 v_add_f32 v137, v233, v137
 v_add_f32 v138, v234, v138
 v_add_f32 v139, v235, v139
 s_waitcnt vmcnt(0)
 v_add_f32 v136, v236, v136
 v_add_f32 v137, v237, v137
 v_add_f32 v138, v238, v138
 v_add_f32 v139, v239, v139
 v_add_f32 v136, v136, v136 row_ror:8 row_mask:0xf bank_mask:0xf
 v_add_f32 v137, v137, v137 row_ror:8 row_mask:0xf bank_mask:0xf
 v_add_f32 v138, v138, v138 row_ror:8 row_mask:0xf bank_mask:0xf
 v_add_f32 v139, v139, v139 row_ror:8 row_mask:0xf bank_mask:0xf
 v_mov_b32 v140, v136
 v_mov_b32 v141, v137
 v_mov_b32 v142, v138
 v_mov_b32 v143, v139
 v_permlane16_swap_b32 v140, v136
 v_permlane16_swap_b32 v141, v137
 v_permlane16_swap_b32 v142, v138
 v_permlane16_swap_b32 v143, v139
 v_add_f32 v136, v140, v136
 v_add_f32 v137, v141, v137
 v_add_f32 v138, v142, v138
 v_add_f32 v139, v143, v139
 v_mov_b32 v140, v136
 v_mov_b32 v141, v137
 v_mov_b32 v142, v138
 v_mov_b32 v143, v139
 v_permlane32_swap_b32 v140, v136
 v_permlane32_swap_b32 v141, v137
 v_permlane32_swap_b32 v142, v138
 v_permlane32_swap_b32 v143, v139
 v_add_f32 v136, v140, v136
 v_add_f32 v137, v141, v137
 v_add_f32 v138, v142, v138
 v_add_f32 v139, v143, v139
 v_cvt_pk_bf16_f32 v51, v136, v137
 v_lshlrev_b32 v136, 16, v51
 v_and_b32 v137, 0xffff0000, v51
 v_cvt_pk_bf16_f32 v51, v138, v139
 v_lshlrev_b32 v138, 16, v51
 v_and_b32 v139, 0xffff0000, v51
 v_mul_f32 v136, v53, v136
 v_mul_f32 v137, v53, v137
 v_mul_f32 v138, v53, v138
 v_mul_f32 v139, v53, v139
 v_cvt_pk_bf16_f32 v51, v136, v137
 v_lshlrev_b32 v136, 16, v51
 v_and_b32 v137, 0xffff0000, v51
 v_cvt_pk_bf16_f32 v51, v138, v139
 v_lshlrev_b32 v138, 16, v51
 v_and_b32 v139, 0xffff0000, v51
 s_mov_b64 exec, 0xff
 buffer_store_dwordx4 v[136:139], v7, s[8:11], s90 offen sc1
 s_mov_b64 exec, -1
 s_branch L_y2r
L_y3:
 s_cmp_ge_u32 s89, 28
 s_cbranch_scc1 L_y3r
 v_mov_b32 v52, 1
 s_lshl_b32 s89, s89, 2
 s_add_u32 s89, s89, 105062912
 s_mov_b64 exec, 1
 s_waitcnt vmcnt(5)
 buffer_store_dword v52, off, s[8:11], s89 sc1
 s_mov_b64 exec, -1
 s_branch L_y3r
L_fll:
 s_cmp_lg_u32 s39, 15
 s_cbranch_scc1 L_fll1
 v_mov_b32 v9, 0
 s_mov_b32 s46, s47
 s_mov_b32 s39, 1
L_fll1:
 buffer_load_dword v6, v9, s[8:11], s46 offen sc1
 s_branch L_fllr
L_pub3:
 v_mov_b32 v17, s3
 buffer_store_dword v17, v1, s[8:11], s45 offen sc1
 s_branch L_pub3r
L_fhs0:
 s_mov_b32 s91, 65536
L_fhs0_l:
 s_sleep 2
 buffer_load_dword v24, off, s[8:11], s79 sc1
 s_sub_u32 s91, s91, 1
 s_cbranch_scc1 L_fhs0_x
 s_waitcnt vmcnt(0)
 v_cmp_gt_u32 vcc, 1, v24
 s_nop 0
 s_cbranch_vccnz L_fhs0_l
L_fhs0_x:
 s_waitcnt vmcnt(0)
 s_branch L_fhr0
L_fhs1:
 s_mov_b32 s91, 65536
L_fhs1_l:
 s_sleep 2
 buffer_load_dword v24, off, s[8:11], s79 sc1
 s_sub_u32 s91, s91, 1
 s_cbranch_scc1 L_fhs1_x
 s_waitcnt vmcnt(0)
 v_cmp_gt_u32 vcc, 1, v24
 s_nop 0
 s_cbranch_vccnz L_fhs1_l
L_fhs1_x:
 s_waitcnt vmcnt(0)
 s_branch L_fhr1
L_fps1:
 s_mov_b32 s53, 65536
L_fps1_l:
 s_sleep 2
 buffer_load_dword v5, off, s[8:11], s47 sc1
 s_sub_u32 s53, s53, 1
 s_cbranch_scc1 L_fps1_x
 s_waitcnt vmcnt(0)
 v_cmp_ne_u32 vcc, 1, v5
 s_nop 0
 s_cbranch_vccnz L_fps1_l
L_fps1_x:
 s_waitcnt vmcnt(0)
 s_branch L_fpr1
L_f4s:
 s_mov_b32 s53, 65536
L_f4s_l:
 s_sleep 2
 buffer_load_dword v6, v9, s[8:11], s46 offen sc1
 s_sub_u32 s53, s53, 1
 s_cbranch_scc1 L_f4s_x
 s_waitcnt vmcnt(0)
 v_cmp_gt_u32 vcc, 3, v6
 s_nop 0
 s_cbranch_vccnz L_f4s_l
L_f4s_x:
 s_waitcnt vmcnt(0)
 s_branch L_f4r
L_f2s:
 s_mov_b32 s53, 65536
L_f2s_l:
 s_sleep 2
 buffer_load_dword v6, v9, s[8:11], s46 offen sc1
 s_sub_u32 s53, s53, 1
 s_cbranch_scc1 L_f2s_x
 s_waitcnt vmcnt(0)
 v_cmp_gt_u32 vcc, 3, v6
 s_nop 0
 s_cbranch_vccnz L_f2s_l
L_f2s_x:
 s_waitcnt vmcnt(0)
 s_branch L_f2r
L_fls0:
 s_mov_b32 s53, 65536
L_fls0_l:
 s_sleep 2
 buffer_load_dword v6, v9, s[8:11], s46 offen sc1
 s_sub_u32 s53, s53, 1
 s_cbranch_scc1 L_fls0_x
 s_waitcnt vmcnt(0)
 v_cmp_gt_u32 vcc, s39, v6
 s_nop 0
 s_cbranch_vccnz L_fls0_l
L_fls0_x:
 s_waitcnt vmcnt(0)
 s_branch L_flr0
L_code_end:
.section .rodata,"a"
.p2align 6
.amdhsa_kernel gated_mix__compressed_kv_cla__moe_arch_mod__prompt_kernel
  .amdhsa_next_free_vgpr 512
  .amdhsa_next_free_sgpr 102
  .amdhsa_accum_offset 256
  .amdhsa_group_segment_fixed_size 0
  .amdhsa_kernarg_size 120
  .amdhsa_user_sgpr_count 2
  .amdhsa_user_sgpr_kernarg_segment_ptr 1
  .amdhsa_system_sgpr_workgroup_id_x 1
  .amdhsa_float_denorm_mode_32 3
.end_amdhsa_kernel
```

```asm
; @launch grid=(256,1,1) block=(256,1,1) lds=163840
.amdgcn_target "amdgcn-amd-amdhsa--gfx950"
.text
.macro M d, a, b, c
v_mfma_f32_16x16x32_bf16 \d, \a, \b, \c
.endm
.globl gated_mix__compressed_kv_cla__moe_arch_mod__prompt_kernel
.p2align 8
.type gated_mix__compressed_kv_cla__moe_arch_mod__prompt_kernel,@function
gated_mix__compressed_kv_cla__moe_arch_mod__prompt_kernel:
 s_cmp_lt_u32 s2, 256
 s_cbranch_scc1 L_go
 s_endpgm
L_go:
 s_load_dwordx8 s[80:87], s[0:1], 0
 s_load_dwordx4 s[88:91], s[0:1], 32
 s_load_dwordx2 s[92:93], s[0:1], 56
 s_load_dwordx2 s[30:31], s[0:1], 88
 s_load_dwordx4 s[4:7], s[0:1], 104
 v_lshrrev_b32 v24, 6, v0
 v_and_b32 v0, 63, v0
 v_readfirstlane_b32 s20, v24
 s_getpc_b64 s[76:77]
L_pc0:
 s_and_b32 s77, s77, 0xffff
 s_mov_b32 s78, L_code_end-L_pc0
 s_mov_b32 s79, 0x20000
 s_lshr_b32 s64, s2, 3
 s_lshl_b32 s64, s64, 2
 s_add_u32 s64, s64, s20
 s_lshl_b32 s95, s64, 11
 v_lshl_add_u32 v29, v0, 7, s95
 v_and_b32 v28, 48, v0
 v_lshl_add_u32 v28, v28, 24, v29
 buffer_load_dword a240, v28, s[76:79], 0 offen offset:0
 s_and_b32 s41, s2, 7
 s_lshr_b32 s42, s2, 3
 s_lshr_b32 s64, s42, 4
 s_lshl_b32 s64, s64, 3
 s_add_u32 s41, s41, s64
 s_and_b32 s42, s42, 15
 s_lshr_b32 s45, s42, 3
 s_xor_b32 s45, s45, 1
 s_mov_b32 s44, 0
 v_accvgpr_write_b32 a250, 0
 v_accvgpr_write_b32 a251, 0
 v_and_b32 v24, 15, v0
 v_lshrrev_b32 v25, 4, v0
 v_lshlrev_b32 v7, 4, v0
 s_and_b32 s65, s20, 1
 s_lshr_b32 s66, s20, 1
 v_or_b32 v28, 0, v25
 v_lshlrev_b32 v28, 1, v28
 v_xor_b32 v28, v28, v24
 v_lshrrev_b32 v29, 3, v28
 v_lshlrev_b32 v29, 8, v29
 v_and_b32 v28, 7, v28
 v_lshl_add_u32 v28, v28, 4, v29
 v_lshl_add_u32 v28, v25, 13, v28
 s_lshl_b32 s64, s20, 17
 s_add_u32 s64, s64, 0
 v_add_u32 v8, s64, v28
 v_add_u32 v9, 31744, v8
 v_or_b32 v28, 4, v25
 v_lshlrev_b32 v28, 1, v28
 v_xor_b32 v28, v28, v24
 v_lshrrev_b32 v29, 3, v28
 v_lshlrev_b32 v29, 8, v29
 v_and_b32 v28, 7, v28
 v_lshl_add_u32 v28, v28, 4, v29
 v_lshl_add_u32 v28, v25, 13, v28
 s_lshl_b32 s64, s20, 17
 s_add_u32 s64, s64, 63488
 v_add_u32 v10, s64, v28
 v_add_u32 v11, 31744, v10
 v_add_u32 v28, 0, v25
 v_and_b32 v29, 7, v0
 v_xor_b32 v28, v28, v29
 v_lshlrev_b32 v28, 4, v28
 v_lshrrev_b32 v29, 3, v0
 v_lshl_add_u32 v30, v29, 11, v28
 s_lshl_b32 s64, s66, 19
 s_lshl_b32 s67, s65, 20
 s_add_u32 s64, s64, s67
 s_add_u32 s64, s64, 0
 v_add_u32 v12, s64, v30
 v_add_u32 v14, 30720, v12
 v_add_u32 v28, 4, v25
 v_and_b32 v29, 7, v0
 v_xor_b32 v28, v28, v29
 v_lshlrev_b32 v28, 4, v28
 v_lshrrev_b32 v29, 3, v0
 v_lshl_add_u32 v30, v29, 11, v28
 s_lshl_b32 s64, s66, 19
 s_lshl_b32 s67, s65, 20
 s_add_u32 s64, s64, s67
 s_add_u32 s64, s64, 15360
 v_add_u32 v13, s64, v30
 v_add_u32 v15, 30720, v13
 s_mov_b32 s21, 0
 s_mov_b32 s22, 0
 s_lshl_b32 s23, s20, 12
 s_add_u32 s24, s23, 65536
 s_lshl_b32 s74, s41, 9
 s_sub_u32 s18, 8388608, s74
 s_mov_b32 s19, 0x20000
 s_and_b32 s75, s42, 7
 s_lshl_b32 s75, s75, 16
 s_sub_u32 s50, 4194304, s75
 s_mov_b32 s51, 0x20000
 s_mov_b32 m0, s23
 s_cmp_eq_u32 s45, 0
 s_waitcnt lgkmcnt(0)
 s_cselect_b64 s[72:73], s[86:87], s[88:89]
 s_add_u32 s16, s72, s74
 s_addc_u32 s17, s73, 0
 s_and_b32 s17, s17, 0xffff
 buffer_load_dwordx4 v8, s[16:19], s21 offen offset:0  nt lds
 buffer_load_dwordx4 v9, s[16:19], s21 offen offset:1024  nt lds
 buffer_load_dwordx4 v10, s[16:19], s21 offen offset:2048  nt lds
 buffer_load_dwordx4 v11, s[16:19], s21 offen offset:3072  nt lds
 s_add_u32 s21, s21, 128
 s_add_u32 s48, s82, s75
 s_addc_u32 s49, s83, 0
 s_and_b32 s49, s49, 0xffff
 s_add_u32 m0, s24, 0
 s_nop 0
 buffer_load_dwordx4 v12, s[48:51], s22 offen offset:0   lds
 buffer_load_dwordx4 v13, s[48:51], s22 offen offset:1024   lds
 buffer_load_dwordx4 v14, s[48:51], s22 offen offset:2048   lds
 buffer_load_dwordx4 v15, s[48:51], s22 offen offset:3072   lds
 s_add_u32 s22, s22, 2097152
 s_add_u32 m0, s23, 16384
 s_nop 0
 buffer_load_dwordx4 v8, s[16:19], s21 offen offset:0  nt lds
 buffer_load_dwordx4 v9, s[16:19], s21 offen offset:1024  nt lds
 buffer_load_dwordx4 v10, s[16:19], s21 offen offset:2048  nt lds
 buffer_load_dwordx4 v11, s[16:19], s21 offen offset:3072  nt lds
 s_add_u32 s21, s21, 524160
 v_lshrrev_b32 v26, 2, v24
 v_and_b32 v28, 1, v25
 v_lshl_or_b32 v28, v28, 2, v26
 v_lshl_add_u32 v29, v25, 3, v26
 v_lshlrev_b32 v29, 8, v29
 v_and_b32 v30, 3, v0
 v_lshl_add_u32 v29, v30, 3, v29
 s_lshl_b32 s64, s65, 2
 s_add_u32 s64, s64, 0
 v_xor_b32 v30, s64, v28
 v_lshl_add_u32 v1, v30, 5, v29
 s_lshl_b32 s64, s65, 2
 s_add_u32 s64, s64, 1
 v_xor_b32 v30, s64, v28
 v_lshl_add_u32 v2, v30, 5, v29
 s_lshl_b32 s64, s65, 2
 s_add_u32 s64, s64, 2
 v_xor_b32 v30, s64, v28
 v_lshl_add_u32 v3, v30, 5, v29
 s_lshl_b32 s64, s65, 2
 s_add_u32 s64, s64, 3
 v_xor_b32 v30, s64, v28
 v_lshl_add_u32 v4, v30, 5, v29
 v_add_u32 v28, 0, v25
 v_lshrrev_b32 v29, 1, v24
 v_xor_b32 v28, v28, v29
 v_lshlrev_b32 v28, 4, v28
 v_lshl_add_u32 v28, v24, 7, v28
 s_lshl_b32 s64, s66, 13
 s_add_u32 s64, s64, 65536
 v_add_u32 v5, s64, v28
 v_add_u32 v28, 4, v25
 v_lshrrev_b32 v29, 1, v24
 v_xor_b32 v28, v28, v29
 v_lshlrev_b32 v28, 4, v28
 v_lshl_add_u32 v28, v24, 7, v28
 s_lshl_b32 s64, s66, 13
 s_add_u32 s64, s64, 65536
 v_add_u32 v6, s64, v28
 s_lshl_b32 s64, s2, 2
 s_add_u32 s64, s64, s20
 s_lshl_b32 s64, s64, 12
 v_lshrrev_b32 v28, 2, v0
 v_and_b32 v29, 3, v0
 v_lshlrev_b32 v29, 7, v29
 v_lshl_add_u32 v28, v28, 11, v29
 v_add_u32 v24, s64, v28
 v_and_b32 v28, 56, v0
 v_lshl_add_u32 v24, v28, 24, v24
 s_mov_b32 s32, s82
 s_and_b32 s33, s83, 0xffff
 s_mov_b32 s34, 4194304
 s_mov_b32 s35, 0x20000
 s_mov_b32 s56, s80
 s_and_b32 s57, s81, 0xffff
 s_mov_b32 s58, 1835008
 s_mov_b32 s59, 0x20000
 s_mov_b32 s60, s92
 s_and_b32 s61, s93, 0xffff
 s_mov_b32 s62, 896
 s_mov_b32 s63, 0x20000
 s_mov_b32 s68, s30
 s_and_b32 s69, s31, 0xffff
 s_mov_b32 s70, 896
 s_mov_b32 s71, 0x20000
 s_mov_b32 s8, s6
 s_and_b32 s9, s7, 0xffff
 s_mov_b32 s10, 268435456
 s_mov_b32 s11, 0x20000
 s_mov_b32 s12, s4
 s_and_b32 s13, s5, 0xffff
 s_mov_b32 s14, 256
 s_mov_b32 s15, 0x20000
 s_add_u32 s72, s84, s74
 s_addc_u32 s73, s85, 0
 s_sub_u32 s75, 3670016, s74
 s_mov_b32 s52, s72
 s_and_b32 s53, s73, 0xffff
 s_mov_b32 s54, s75
 s_mov_b32 s55, 0x20000
 s_mov_b32 s5, 0x3db8aa3b
 s_mov_b32 s28, 0
 s_mul_i32 s29, s42, 114688
 s_lshl_b32 s72, s45, 24
 s_lshl_b32 s73, s41, 20
 s_add_u32 s72, s72, s73
 s_bfe_u32 s64, s42, 0x20001
 s_lshl_b32 s64, s64, 15
 s_add_u32 s72, s72, s64
 s_lshl_b32 s64, s66, 17
 s_add_u32 s72, s72, s64
 s_and_b32 s67, s42, 1
 s_cmp_eq_u32 s45, 0
 s_cselect_b32 s64, 12, 14
 s_cselect_b32 s75, 14, 10
 s_lshl_b32 s67, s67, s75
 s_add_u32 s72, s72, s67
 s_lshl_b32 s64, s65, s64
 s_add_u32 s93, s72, s64
 s_load_dwordx4 s[80:83], s[0:1], 64
 s_load_dwordx2 s[84:85], s[0:1], 80
 s_load_dwordx2 s[96:97], s[0:1], 96
 s_cmp_lt_u32 s42, 8
 s_cbranch_scc0 L_kv1
L_kv0:
 s_lshl_b32 s64, s42, 4
 s_add_u32 s64, s64, s41
 s_lshl_b32 s64, s64, 2
 s_add_u32 s64, s64, s20
 s_cmp_lt_u32 s64, 41
 s_cselect_b32 s39, 0, 536870912
 s_min_u32 s64, s64, 41
 s_lshl_b32 s38, s64, 2
 s_max_u32 s67, s64, 8
 s_sub_u32 s67, s67, 8
 s_mul_i32 s67, s67, 3328
 s_lshl_b32 s64, s64, 10
 s_add_u32 s64, s64, s67
 s_add_u32 s73, s64, 104914944
 v_or_b32 v64, s39, v7
 v_mov_b32 v68, 0
 v_mov_b32 v69, 0
 v_mov_b32 v70, 0
 v_mov_b32 v71, 0
 s_lshl_b32 s30, s41, 3
 s_add_u32 s30, s30, s42
 s_lshl_b32 s64, s30, 2
 s_add_u32 s64, s64, s20
 s_mul_i32 s72, s64, 3584
 v_mov_b32 v32, 536870912
 v_cmp_gt_u32 vcc, 56, v0
 s_lshl_b32 s67, s64, 2
 s_nop 0
 v_cndmask_b32 v32, v32, v7, vcc
 buffer_load_dwordx4 v[40:43], v32, s[56:59], s72 offen offset:0
 buffer_load_dwordx4 v[44:47], v32, s[56:59], s72 offen offset:896
 buffer_load_dwordx4 v[48:51], v32, s[56:59], s72 offen offset:1792
 buffer_load_dwordx4 v[52:55], v32, s[56:59], s72 offen offset:2688
 buffer_load_dwordx4 v[56:59], v32, s[60:63], 0 offen
 buffer_load_dwordx4 v[60:63], v32, s[68:71], 0 offen
 buffer_store_dwordx4 v[68:71], v64, s[8:11], s73 offen offset:0 sc1
 buffer_store_dwordx4 v[68:71], v64, s[8:11], s73 offen offset:1024 sc1
 buffer_store_dwordx4 v[68:71], v64, s[8:11], s73 offen offset:2048 sc1
 s_waitcnt vmcnt(13) lgkmcnt(0)
 s_barrier
 ds_read_b128 a[160:163], v5 offset:0
 ds_read_b128 a[164:167], v6 offset:0
 ds_read_b64_tr_b16 a[32:33], v1 offset:0
 ds_read_b64_tr_b16 a[34:35], v1 offset:1024
 ds_read_b64_tr_b16 a[36:37], v1 offset:8192
 ds_read_b64_tr_b16 a[38:39], v1 offset:9216
 ds_read_b64_tr_b16 a[40:41], v2 offset:0
 ds_read_b64_tr_b16 a[42:43], v2 offset:1024
 ds_read_b64_tr_b16 a[44:45], v2 offset:8192
 ds_read_b64_tr_b16 a[46:47], v2 offset:9216
 ds_read_b128 a[168:171], v5 offset:2048
 ds_read_b128 a[172:175], v6 offset:2048
 ds_read_b64_tr_b16 a[48:49], v3 offset:0
 ds_read_b64_tr_b16 a[50:51], v3 offset:1024
 ds_read_b64_tr_b16 a[52:53], v3 offset:8192
 ds_read_b64_tr_b16 a[54:55], v3 offset:9216
 ds_read_b64_tr_b16 a[56:57], v4 offset:0
 ds_read_b64_tr_b16 a[58:59], v4 offset:1024
 ds_read_b64_tr_b16 a[60:61], v4 offset:8192
 ds_read_b64_tr_b16 a[62:63], v4 offset:9216
 ds_read_b128 a[176:179], v5 offset:4096
 ds_read_b128 a[180:183], v6 offset:4096
 ds_read_b128 a[184:187], v5 offset:6144
 ds_read_b128 a[188:191], v6 offset:6144
 s_add_u32 m0, s24, 16384
 s_nop 0
 buffer_load_dwordx4 v12, s[48:51], s22 offen offset:0   lds
 buffer_load_dwordx4 v13, s[48:51], s22 offen offset:1024   lds
 buffer_load_dwordx4 v14, s[48:51], s22 offen offset:2048   lds
 buffer_load_dwordx4 v15, s[48:51], s22 offen offset:3072   lds
 s_sub_u32 s22, s22, 2097024
 s_add_u32 m0, s23, 32768
 s_nop 0
 buffer_load_dwordx4 v8, s[16:19], s21 offen offset:0  nt lds
 buffer_load_dwordx4 v9, s[16:19], s21 offen offset:1024  nt lds
 buffer_load_dwordx4 v10, s[16:19], s21 offen offset:2048  nt lds
 buffer_load_dwordx4 v11, s[16:19], s21 offen offset:3072  nt lds
 s_add_u32 s21, s21, 128
 v_mov_b32 v72, 0
 v_mov_b32 v73, 0
 v_mov_b32 v74, 0
 v_mov_b32 v75, 0
 v_mov_b32 v76, 0
 v_mov_b32 v77, 0
 v_mov_b32 v78, 0
 v_mov_b32 v79, 0
 s_waitcnt vmcnt(12)
 v_dot2c_f32_bf16 v72, v40, v56
 v_dot2c_f32_bf16 v73, v44, v56
 v_dot2c_f32_bf16 v74, v48, v56
 v_dot2c_f32_bf16 v75, v52, v56
 s_waitcnt vmcnt(11)
 v_dot2c_f32_bf16 v76, v40, v60
 v_dot2c_f32_bf16 v77, v44, v60
 v_dot2c_f32_bf16 v78, v48, v60
 v_dot2c_f32_bf16 v79, v52, v60
 v_dot2c_f32_bf16 v72, v41, v57
 v_dot2c_f32_bf16 v73, v45, v57
 v_dot2c_f32_bf16 v74, v49, v57
 v_dot2c_f32_bf16 v75, v53, v57
 v_dot2c_f32_bf16 v76, v41, v61
 v_dot2c_f32_bf16 v77, v45, v61
 v_dot2c_f32_bf16 v78, v49, v61
 v_dot2c_f32_bf16 v79, v53, v61
 v_dot2c_f32_bf16 v72, v42, v58
 v_dot2c_f32_bf16 v73, v46, v58
 v_dot2c_f32_bf16 v74, v50, v58
 v_dot2c_f32_bf16 v75, v54, v58
 v_dot2c_f32_bf16 v76, v42, v62
 v_dot2c_f32_bf16 v77, v46, v62
 v_dot2c_f32_bf16 v78, v50, v62
 v_dot2c_f32_bf16 v79, v54, v62
 v_dot2c_f32_bf16 v72, v43, v59
 v_dot2c_f32_bf16 v73, v47, v59
 v_dot2c_f32_bf16 v74, v51, v59
 v_dot2c_f32_bf16 v75, v55, v59
 v_dot2c_f32_bf16 v76, v43, v63
 v_dot2c_f32_bf16 v77, v47, v63
 v_dot2c_f32_bf16 v78, v51, v63
 v_dot2c_f32_bf16 v79, v55, v63
 v_permlane32_swap_b32 v72, v74
 v_permlane32_swap_b32 v73, v75
 v_permlane32_swap_b32 v76, v78
 v_permlane32_swap_b32 v77, v79
 v_add_f32 v72, v72, v74
 v_add_f32 v73, v73, v75
 v_add_f32 v76, v76, v78
 v_add_f32 v77, v77, v79
 v_lshrrev_b32 v80, 4, v0
 v_permlane16_swap_b32 v72, v73
 v_permlane16_swap_b32 v76, v77
 v_add_f32 v72, v72, v73
 v_add_f32 v76, v76, v77
 v_add_u32 v81, s67, v80
 v_add_f32 v72, v72, v72 row_ror:8 row_mask:0xf bank_mask:0xf
 v_add_f32 v76, v76, v76 row_ror:8 row_mask:0xf bank_mask:0xf
 s_nop 0
 v_add_f32 v72, v72, v72 row_ror:4 row_mask:0xf bank_mask:0xf
 v_add_f32 v76, v76, v76 row_ror:4 row_mask:0xf bank_mask:0xf
 s_nop 0
 v_add_f32 v72, v72, v72 row_ror:2 row_mask:0xf bank_mask:0xf
 v_add_f32 v76, v76, v76 row_ror:2 row_mask:0xf bank_mask:0xf
 s_nop 0
 v_add_f32 v72, v72, v72 row_ror:1 row_mask:0xf bank_mask:0xf
 v_add_f32 v76, v76, v76 row_ror:1 row_mask:0xf bank_mask:0xf
 v_ashrrev_i32 v82, 31, v72
 v_or_b32 v82, 0x80000000, v82
 v_xor_b32 v82, v82, v72
 v_and_b32 v82, 0xfffff800, v82
 v_sub_u32 v81, 2047, v81
 v_or_b32 v82, v82, v81
 v_max_u32 v82, 1, v82
 v_mul_f32 v77, 0xbfb8aa3b, v76
 v_exp_f32 v77, v77
 s_nop 0
 v_add_f32 v77, 1.0, v77
 v_rcp_f32 v76, v77
 s_lshl_b32 s72, s20, 4
 s_add_u32 s72, s72, 163584
 v_lshl_add_u32 v80, v80, 2, s72
 ds_write_b32 v80, v82
 ds_write_b32 v80, v72 offset:64
 ds_write_b32 v80, v76 offset:128
 s_waitcnt lgkmcnt(15)
M a[0:3], a[160:163], a[32:35], 0
M a[0:3], a[164:167], a[36:39], a[0:3]
M a[4:7], a[164:167], a[44:47], 0
M a[4:7], a[160:163], a[40:43], a[4:7]
 s_waitcnt lgkmcnt(11)
M a[8:11], a[160:163], a[48:51], 0
M a[8:11], a[164:167], a[52:55], a[8:11]
 s_waitcnt lgkmcnt(7)
M a[12:15], a[164:167], a[60:63], 0
 s_add_u32 m0, s23, 49152
M a[12:15], a[160:163], a[56:59], a[12:15]
 buffer_load_dwordx4 v8, s[16:19], s21 offen offset:0  nt lds
M v[32:35], a[168:171], a[32:35], 0
 buffer_load_dwordx4 v9, s[16:19], s21 offen offset:1024  nt lds
M v[32:35], a[172:175], a[36:39], v[32:35]
M v[36:39], a[172:175], a[44:47], 0
 buffer_load_dwordx4 v10, s[16:19], s21 offen offset:2048  nt lds
M v[36:39], a[168:171], a[40:43], v[36:39]
M v[40:43], a[168:171], a[48:51], 0
 buffer_load_dwordx4 v11, s[16:19], s21 offen offset:3072  nt lds
M v[40:43], a[172:175], a[52:55], v[40:43]
 s_add_u32 s21, s21, 524160
M v[44:47], a[172:175], a[60:63], 0
 s_waitcnt lgkmcnt(0)
M v[44:47], a[168:171], a[56:59], v[44:47]
 s_barrier
M v[64:67], a[176:179], a[32:35], 0
 s_add_u32 m0, s24, 32768
 ds_read_b64_tr_b16 a[64:65], v1 offset:16384
 ds_read_b64_tr_b16 a[66:67], v1 offset:17408
M v[64:67], a[180:183], a[36:39], v[64:67]
 ds_read_b64_tr_b16 a[68:69], v1 offset:24576
 ds_read_b64_tr_b16 a[70:71], v1 offset:25600
M v[68:71], a[180:183], a[44:47], 0
 buffer_load_dwordx4 v12, s[48:51], s22 offen offset:0   lds
M v[68:71], a[176:179], a[40:43], v[68:71]
 ds_read_b64_tr_b16 a[72:73], v2 offset:16384
 ds_read_b64_tr_b16 a[74:75], v2 offset:17408
M v[72:75], a[176:179], a[48:51], 0
 ds_read_b64_tr_b16 a[76:77], v2 offset:24576
 ds_read_b64_tr_b16 a[78:79], v2 offset:25600
M v[72:75], a[180:183], a[52:55], v[72:75]
 buffer_load_dwordx4 v13, s[48:51], s22 offen offset:1024   lds
M v[76:79], a[180:183], a[60:63], 0
 ds_read_b64_tr_b16 a[80:81], v3 offset:16384
 ds_read_b64_tr_b16 a[82:83], v3 offset:17408
M v[76:79], a[176:179], a[56:59], v[76:79]
 ds_read_b64_tr_b16 a[84:85], v3 offset:24576
 ds_read_b64_tr_b16 a[86:87], v3 offset:25600
M v[96:99], a[184:187], a[32:35], 0
 buffer_load_dwordx4 v14, s[48:51], s22 offen offset:2048   lds
M v[96:99], a[188:191], a[36:39], v[96:99]
 ds_read_b64_tr_b16 a[88:89], v4 offset:16384
 ds_read_b64_tr_b16 a[90:91], v4 offset:17408
M v[100:103], a[188:191], a[44:47], 0
 ds_read_b64_tr_b16 a[92:93], v4 offset:24576
 ds_read_b64_tr_b16 a[94:95], v4 offset:25600
M v[100:103], a[184:187], a[40:43], v[100:103]
 buffer_load_dwordx4 v15, s[48:51], s22 offen offset:3072   lds
M v[104:107], a[184:187], a[48:51], 0
 s_add_u32 s22, s22, 2097152
 v_max3_f32 v20, |v32|, |v33|, |v34|
 v_max3_f32 v20, |v35|, |v36|, v20
M v[104:107], a[188:191], a[52:55], v[104:107]
 v_max3_f32 v20, |v37|, |v38|, v20
 v_max3_f32 v21, |v64|, |v65|, |v66|
M v[108:111], a[188:191], a[60:63], 0
 s_add_u32 m0, s23, 0
 v_max3_f32 v21, |v67|, |v68|, v21
 v_max3_f32 v21, |v69|, |v70|, v21
M v[108:111], a[184:187], a[56:59], v[108:111]
 s_waitcnt lgkmcnt(0)
 v_min_f32 v20, v20, v21
 v_mul_f32 v20, 0x41000000, v20
M a[16:19], a[160:163], a[64:67], 0
 buffer_load_dwordx4 v8, s[16:19], s21 offen offset:0  nt lds
M a[16:19], a[164:167], a[68:71], a[16:19]
 v_mov_b32 v21, v20
 v_mov_b32 v22, v20
M a[20:23], a[164:167], a[76:79], 0
 buffer_load_dwordx4 v9, s[16:19], s21 offen offset:1024  nt lds
M a[20:23], a[160:163], a[72:75], a[20:23]
 v_mov_b32 v23, v20
 v_accvgpr_write_b32 a241, v20
M a[24:27], a[160:163], a[80:83], 0
M a[24:27], a[164:167], a[84:87], a[24:27]
M a[28:31], a[164:167], a[92:95], 0
 buffer_load_dwordx4 v10, s[16:19], s21 offen offset:2048  nt lds
M a[28:31], a[160:163], a[88:91], a[28:31]
M v[48:51], a[168:171], a[64:67], v[20:23]
M v[48:51], a[172:175], a[68:71], v[48:51]
 buffer_load_dwordx4 v11, s[16:19], s21 offen offset:3072  nt lds
M v[52:55], a[172:175], a[76:79], v[20:23]
 s_add_u32 s21, s21, 128
M v[52:55], a[168:171], a[72:75], v[52:55]
M v[56:59], a[168:171], a[80:83], v[20:23]
M v[56:59], a[172:175], a[84:87], v[56:59]
M v[60:63], a[172:175], a[92:95], v[20:23]
 s_waitcnt vmcnt(12)
M v[60:63], a[168:171], a[88:91], v[60:63]
 s_barrier
M v[80:83], a[176:179], a[64:67], v[20:23]
 s_add_u32 m0, s24, 49152
 ds_read_b128 a[160:163], v5 offset:16384
 ds_read_b128 a[164:167], v6 offset:16384
M v[80:83], a[180:183], a[68:71], v[80:83]
 buffer_load_dwordx4 v12, s[48:51], s22 offen offset:0   lds
M v[84:87], a[180:183], a[76:79], v[20:23]
 ds_read_b64_tr_b16 a[96:97], v1 offset:32768
 ds_read_b64_tr_b16 a[98:99], v1 offset:33792
M v[84:87], a[176:179], a[72:75], v[84:87]
M v[88:91], a[176:179], a[80:83], v[20:23]
 buffer_load_dwordx4 v13, s[48:51], s22 offen offset:1024   lds
M v[88:91], a[180:183], a[84:87], v[88:91]
 ds_read_b64_tr_b16 a[100:101], v1 offset:40960
 ds_read_b64_tr_b16 a[102:103], v1 offset:41984
M v[92:95], a[180:183], a[92:95], v[20:23]
M v[92:95], a[176:179], a[88:91], v[92:95]
M v[112:115], a[184:187], a[64:67], v[20:23]
 ds_read_b64_tr_b16 a[104:105], v2 offset:32768
 ds_read_b64_tr_b16 a[106:107], v2 offset:33792
M v[112:115], a[188:191], a[68:71], v[112:115]
 buffer_load_dwordx4 v14, s[48:51], s22 offen offset:2048   lds
M v[116:119], a[188:191], a[76:79], v[20:23]
M v[116:119], a[184:187], a[72:75], v[116:119]
 ds_read_b64_tr_b16 a[108:109], v2 offset:40960
 ds_read_b64_tr_b16 a[110:111], v2 offset:41984
M v[120:123], a[184:187], a[80:83], v[20:23]
 buffer_load_dwordx4 v15, s[48:51], s22 offen offset:3072   lds
M v[120:123], a[188:191], a[84:87], v[120:123]
 s_waitcnt lgkmcnt(8)
M v[124:127], a[188:191], a[92:95], v[20:23]
 s_sub_u32 s22, s22, 2097024
M v[124:127], a[184:187], a[88:91], v[124:127]
 s_add_u32 m0, s23, 16384
 ds_read_b64_tr_b16 a[112:113], v3 offset:32768
 ds_read_b64_tr_b16 a[114:115], v3 offset:33792
M v[128:131], a[160:163], a[32:35], v[20:23]
 ds_read_b128 a[168:171], v5 offset:18432
 ds_read_b128 a[172:175], v6 offset:18432
M v[128:131], a[164:167], a[36:39], v[128:131]
 buffer_load_dwordx4 v8, s[16:19], s21 offen offset:0  nt lds
M v[132:135], a[164:167], a[44:47], v[20:23]
 ds_read_b64_tr_b16 a[116:117], v3 offset:40960
 ds_read_b64_tr_b16 a[118:119], v3 offset:41984
M v[132:135], a[160:163], a[40:43], v[132:135]
 buffer_load_dwordx4 v9, s[16:19], s21 offen offset:1024  nt lds
M v[136:139], a[160:163], a[48:51], v[20:23]
M v[136:139], a[164:167], a[52:55], v[136:139]
 ds_read_b64_tr_b16 a[120:121], v4 offset:32768
 ds_read_b64_tr_b16 a[122:123], v4 offset:33792
M v[140:143], a[164:167], a[60:63], v[20:23]
 buffer_load_dwordx4 v10, s[16:19], s21 offen offset:2048  nt lds
M v[140:143], a[160:163], a[56:59], v[140:143]
M v[144:147], a[160:163], a[64:67], v[20:23]
 ds_read_b64_tr_b16 a[124:125], v4 offset:40960
 ds_read_b64_tr_b16 a[126:127], v4 offset:41984
M v[144:147], a[164:167], a[68:71], v[144:147]
 buffer_load_dwordx4 v11, s[16:19], s21 offen offset:3072  nt lds
M v[148:151], a[164:167], a[76:79], v[20:23]
 s_add_u32 s21, s21, 524160
M v[148:151], a[160:163], a[72:75], v[148:151]
M v[152:155], a[160:163], a[80:83], v[20:23]
M v[152:155], a[164:167], a[84:87], v[152:155]
 s_waitcnt lgkmcnt(6)
M v[156:159], a[164:167], a[92:95], v[20:23]
 s_waitcnt vmcnt(16) lgkmcnt(0)
M v[156:159], a[160:163], a[88:91], v[156:159]
 s_barrier
M v[160:163], a[168:171], a[32:35], v[20:23]
 s_add_u32 m0, s24, 0
 ds_read_b128 a[160:163], v5 offset:20480
 ds_read_b128 a[164:167], v6 offset:20480
M v[160:163], a[172:175], a[36:39], v[160:163]
 buffer_load_dwordx4 v12, s[48:51], s22 offen offset:0   lds
M v[164:167], a[172:175], a[44:47], v[20:23]
 ds_read_b64_tr_b16 a[128:129], v1 offset:49152
 ds_read_b64_tr_b16 a[130:131], v1 offset:50176
M v[164:167], a[168:171], a[40:43], v[164:167]
M v[168:171], a[168:171], a[48:51], v[20:23]
 buffer_load_dwordx4 v13, s[48:51], s22 offen offset:1024   lds
M v[168:171], a[172:175], a[52:55], v[168:171]
 ds_read_b64_tr_b16 a[132:133], v1 offset:57344
 ds_read_b64_tr_b16 a[134:135], v1 offset:58368
M v[172:175], a[172:175], a[60:63], v[20:23]
M v[172:175], a[168:171], a[56:59], v[172:175]
M v[176:179], a[168:171], a[64:67], v[20:23]
 ds_read_b64_tr_b16 a[136:137], v2 offset:49152
 ds_read_b64_tr_b16 a[138:139], v2 offset:50176
M v[176:179], a[172:175], a[68:71], v[176:179]
 buffer_load_dwordx4 v14, s[48:51], s22 offen offset:2048   lds
M v[180:183], a[172:175], a[76:79], v[20:23]
M v[180:183], a[168:171], a[72:75], v[180:183]
 ds_read_b64_tr_b16 a[140:141], v2 offset:57344
 ds_read_b64_tr_b16 a[142:143], v2 offset:58368
M v[184:187], a[168:171], a[80:83], v[20:23]
 buffer_load_dwordx4 v15, s[48:51], s22 offen offset:3072   lds
M v[184:187], a[172:175], a[84:87], v[184:187]
 s_waitcnt lgkmcnt(8)
M v[188:191], a[172:175], a[92:95], v[20:23]
 s_add_u32 s22, s22, 2097152
M v[188:191], a[168:171], a[88:91], v[188:191]
 s_add_u32 m0, s23, 32768
 ds_read_b64_tr_b16 a[144:145], v3 offset:49152
 ds_read_b64_tr_b16 a[146:147], v3 offset:50176
M v[192:195], a[160:163], a[32:35], v[20:23]
 ds_read_b128 a[168:171], v5 offset:22528
 ds_read_b128 a[172:175], v6 offset:22528
M v[192:195], a[164:167], a[36:39], v[192:195]
 buffer_load_dwordx4 v8, s[16:19], s21 offen offset:0  nt lds
M v[196:199], a[164:167], a[44:47], v[20:23]
 ds_read_b64_tr_b16 a[148:149], v3 offset:57344
 ds_read_b64_tr_b16 a[150:151], v3 offset:58368
M v[196:199], a[160:163], a[40:43], v[196:199]
 buffer_load_dwordx4 v9, s[16:19], s21 offen offset:1024  nt lds
M v[200:203], a[160:163], a[48:51], v[20:23]
M v[200:203], a[164:167], a[52:55], v[200:203]
 ds_read_b64_tr_b16 a[152:153], v4 offset:49152
 ds_read_b64_tr_b16 a[154:155], v4 offset:50176
M v[204:207], a[164:167], a[60:63], v[20:23]
 buffer_load_dwordx4 v10, s[16:19], s21 offen offset:2048  nt lds
M v[204:207], a[160:163], a[56:59], v[204:207]
M v[208:211], a[160:163], a[64:67], v[20:23]
 ds_read_b64_tr_b16 a[156:157], v4 offset:57344
 ds_read_b64_tr_b16 a[158:159], v4 offset:58368
M v[208:211], a[164:167], a[68:71], v[208:211]
 buffer_load_dwordx4 v11, s[16:19], s21 offen offset:3072  nt lds
M v[212:215], a[164:167], a[76:79], v[20:23]
 s_add_u32 s21, s21, 128
M v[212:215], a[160:163], a[72:75], v[212:215]
M v[216:219], a[160:163], a[80:83], v[20:23]
M v[216:219], a[164:167], a[84:87], v[216:219]
 s_waitcnt lgkmcnt(6)
M v[220:223], a[164:167], a[92:95], v[20:23]
 s_waitcnt vmcnt(16) lgkmcnt(0)
M v[220:223], a[160:163], a[88:91], v[220:223]
 s_barrier
M v[224:227], a[168:171], a[32:35], v[20:23]
 ds_read_b128 a[160:163], v5 offset:32768
 ds_read_b128 a[164:167], v6 offset:32768
M v[224:227], a[172:175], a[36:39], v[224:227]
 buffer_load_dword a240, v24, s[32:35], 0 offen offset:512
M v[228:231], a[172:175], a[44:47], v[20:23]
M v[228:231], a[168:171], a[40:43], v[228:231]
M v[232:235], a[168:171], a[48:51], v[20:23]
M v[232:235], a[172:175], a[52:55], v[232:235]
M v[236:239], a[172:175], a[60:63], v[20:23]
M v[236:239], a[168:171], a[56:59], v[236:239]
M v[240:243], a[168:171], a[64:67], v[20:23]
M v[240:243], a[172:175], a[68:71], v[240:243]
M v[244:247], a[172:175], a[76:79], v[20:23]
M v[244:247], a[168:171], a[72:75], v[244:247]
M v[248:251], a[168:171], a[80:83], v[20:23]
M v[248:251], a[172:175], a[84:87], v[248:251]
 s_waitcnt lgkmcnt(0)
M v[252:255], a[172:175], a[92:95], v[20:23]
M v[252:255], a[168:171], a[88:91], v[252:255]
M a[0:3], a[160:163], a[96:99], a[0:3]
 ds_read_b128 a[168:171], v5 offset:34816
 ds_read_b128 a[172:175], v6 offset:34816
M a[0:3], a[164:167], a[100:103], a[0:3]
 ds_read_b64_tr_b16 a[32:33], v1 offset:0
 ds_read_b64_tr_b16 a[34:35], v1 offset:1024
M a[4:7], a[164:167], a[108:111], a[4:7]
 s_add_u32 m0, s24, 16384
M a[4:7], a[160:163], a[104:107], a[4:7]
 buffer_load_dwordx4 v12, s[48:51], s22 offen offset:0   lds
M a[8:11], a[160:163], a[112:115], a[8:11]
M a[8:11], a[164:167], a[116:119], a[8:11]
M a[12:15], a[164:167], a[124:127], a[12:15]
 ds_read_b64_tr_b16 a[36:37], v1 offset:8192
 ds_read_b64_tr_b16 a[38:39], v1 offset:9216
M a[12:15], a[160:163], a[120:123], a[12:15]
M a[16:19], a[160:163], a[128:131], a[16:19]
 buffer_load_dwordx4 v13, s[48:51], s22 offen offset:1024   lds
M a[16:19], a[164:167], a[132:135], a[16:19]
M a[20:23], a[164:167], a[140:143], a[20:23]
M a[20:23], a[160:163], a[136:139], a[20:23]
 ds_read_b64_tr_b16 a[40:41], v2 offset:0
 ds_read_b64_tr_b16 a[42:43], v2 offset:1024
M a[24:27], a[160:163], a[144:147], a[24:27]
M a[24:27], a[164:167], a[148:151], a[24:27]
 s_waitcnt lgkmcnt(6)
M a[28:31], a[164:167], a[156:159], a[28:31]
 buffer_load_dwordx4 v14, s[48:51], s22 offen offset:2048   lds
M a[28:31], a[160:163], a[152:155], a[28:31]
M v[60:63], a[168:171], a[152:155], v[60:63]
 ds_read_b128 a[160:163], v5 offset:36864
 ds_read_b128 a[164:167], v6 offset:36864
M v[60:63], a[172:175], a[156:159], v[60:63]
 ds_read_b64_tr_b16 a[44:45], v2 offset:8192
 ds_read_b64_tr_b16 a[46:47], v2 offset:9216
M v[56:59], a[172:175], a[148:151], v[56:59]
 buffer_load_dwordx4 v15, s[48:51], s22 offen offset:3072   lds
M v[56:59], a[168:171], a[144:147], v[56:59]
 s_sub_u32 s22, s22, 2097024
M v[52:55], a[168:171], a[136:139], v[52:55]
M v[52:55], a[172:175], a[140:143], v[52:55]
 ds_read_b64_tr_b16 a[48:49], v3 offset:0
 ds_read_b64_tr_b16 a[50:51], v3 offset:1024
M v[48:51], a[172:175], a[132:135], v[48:51]
 s_add_u32 m0, s23, 49152
M v[48:51], a[168:171], a[128:131], v[48:51]
 buffer_load_dwordx4 v8, s[16:19], s21 offen offset:0  nt lds
M v[44:47], a[168:171], a[120:123], v[44:47]
M v[44:47], a[172:175], a[124:127], v[44:47]
M v[40:43], a[172:175], a[116:119], v[40:43]
 ds_read_b64_tr_b16 a[52:53], v3 offset:8192
 ds_read_b64_tr_b16 a[54:55], v3 offset:9216
M v[40:43], a[168:171], a[112:115], v[40:43]
M v[36:39], a[168:171], a[104:107], v[36:39]
 buffer_load_dwordx4 v9, s[16:19], s21 offen offset:1024  nt lds
M v[36:39], a[172:175], a[108:111], v[36:39]
 s_waitcnt lgkmcnt(6)
M v[32:35], a[172:175], a[100:103], v[32:35]
M v[32:35], a[168:171], a[96:99], v[32:35]
 ds_read_b64_tr_b16 a[56:57], v4 offset:0
 ds_read_b64_tr_b16 a[58:59], v4 offset:1024
M v[64:67], a[160:163], a[96:99], v[64:67]
 ds_read_b128 a[168:171], v5 offset:38912
 ds_read_b128 a[172:175], v6 offset:38912
M v[64:67], a[164:167], a[100:103], v[64:67]
 buffer_load_dwordx4 v10, s[16:19], s21 offen offset:2048  nt lds
M v[68:71], a[164:167], a[108:111], v[68:71]
M v[68:71], a[160:163], a[104:107], v[68:71]
M v[72:75], a[160:163], a[112:115], v[72:75]
 ds_read_b64_tr_b16 a[60:61], v4 offset:8192
 ds_read_b64_tr_b16 a[62:63], v4 offset:9216
M v[72:75], a[164:167], a[116:119], v[72:75]
M v[76:79], a[164:167], a[124:127], v[76:79]
 buffer_load_dwordx4 v11, s[16:19], s21 offen offset:3072  nt lds
M v[76:79], a[160:163], a[120:123], v[76:79]
 s_add_u32 s21, s21, 524160
M v[80:83], a[160:163], a[128:131], v[80:83]
M v[80:83], a[164:167], a[132:135], v[80:83]
M v[84:87], a[164:167], a[140:143], v[84:87]
M v[84:87], a[160:163], a[136:139], v[84:87]
M v[88:91], a[160:163], a[144:147], v[88:91]
M v[88:91], a[164:167], a[148:151], v[88:91]
 s_waitcnt lgkmcnt(2)
M v[92:95], a[164:167], a[156:159], v[92:95]
 s_waitcnt vmcnt(17) lgkmcnt(0)
M v[92:95], a[160:163], a[152:155], v[92:95]
 s_barrier
M v[124:127], a[168:171], a[152:155], v[124:127]
 ds_read_b128 a[160:163], v5 offset:49152
 ds_read_b128 a[164:167], v6 offset:49152
M v[124:127], a[172:175], a[156:159], v[124:127]
M v[120:123], a[172:175], a[148:151], v[120:123]
 s_add_u32 m0, s24, 32768
 ds_read_b64_tr_b16 a[64:65], v1 offset:16384
 ds_read_b64_tr_b16 a[66:67], v1 offset:17408
M v[120:123], a[168:171], a[144:147], v[120:123]
 buffer_load_dwordx4 v12, s[48:51], s22 offen offset:0   lds
M v[116:119], a[168:171], a[136:139], v[116:119]
M v[116:119], a[172:175], a[140:143], v[116:119]
M v[112:115], a[172:175], a[132:135], v[112:115]
M v[112:115], a[168:171], a[128:131], v[112:115]
M v[108:111], a[168:171], a[120:123], v[108:111]
M v[108:111], a[172:175], a[124:127], v[108:111]
 ds_read_b64_tr_b16 a[68:69], v1 offset:24576
 ds_read_b64_tr_b16 a[70:71], v1 offset:25600
M v[104:107], a[172:175], a[116:119], v[104:107]
 buffer_load_dwordx4 v13, s[48:51], s22 offen offset:1024   lds
M v[104:107], a[168:171], a[112:115], v[104:107]
M v[100:103], a[168:171], a[104:107], v[100:103]
M v[100:103], a[172:175], a[108:111], v[100:103]
 s_waitcnt lgkmcnt(4)
M v[96:99], a[172:175], a[100:103], v[96:99]
M v[96:99], a[168:171], a[96:99], v[96:99]
M v[128:131], a[160:163], a[96:99], v[128:131]
 ds_read_b128 a[168:171], v5 offset:51200
 ds_read_b128 a[172:175], v6 offset:51200
M v[128:131], a[164:167], a[100:103], v[128:131]
 ds_read_b64_tr_b16 a[72:73], v2 offset:16384
 ds_read_b64_tr_b16 a[74:75], v2 offset:17408
M v[132:135], a[164:167], a[108:111], v[132:135]
 buffer_load_dwordx4 v14, s[48:51], s22 offen offset:2048   lds
M v[132:135], a[160:163], a[104:107], v[132:135]
M v[136:139], a[160:163], a[112:115], v[136:139]
M v[136:139], a[164:167], a[116:119], v[136:139]
M v[140:143], a[164:167], a[124:127], v[140:143]
M v[140:143], a[160:163], a[120:123], v[140:143]
 ds_read_b64_tr_b16 a[76:77], v2 offset:24576
 ds_read_b64_tr_b16 a[78:79], v2 offset:25600
M v[144:147], a[160:163], a[128:131], v[144:147]
 buffer_load_dwordx4 v15, s[48:51], s22 offen offset:3072   lds
M v[144:147], a[164:167], a[132:135], v[144:147]
 s_add_u32 s22, s22, 2097152
M v[148:151], a[164:167], a[140:143], v[148:151]
M v[148:151], a[160:163], a[136:139], v[148:151]
M v[152:155], a[160:163], a[144:147], v[152:155]
M v[152:155], a[164:167], a[148:151], v[152:155]
 s_waitcnt lgkmcnt(4)
M v[156:159], a[164:167], a[156:159], v[156:159]
 s_add_u32 m0, s23, 0
 ds_read_b64_tr_b16 a[80:81], v3 offset:16384
 ds_read_b64_tr_b16 a[82:83], v3 offset:17408
M v[156:159], a[160:163], a[152:155], v[156:159]
 buffer_load_dwordx4 v8, s[16:19], s21 offen offset:0  nt lds
M v[188:191], a[168:171], a[152:155], v[188:191]
 ds_read_b128 a[160:163], v5 offset:53248
 ds_read_b128 a[164:167], v6 offset:53248
M v[188:191], a[172:175], a[156:159], v[188:191]
M v[184:187], a[172:175], a[148:151], v[184:187]
M v[184:187], a[168:171], a[144:147], v[184:187]
M v[180:183], a[168:171], a[136:139], v[180:183]
M v[180:183], a[172:175], a[140:143], v[180:183]
 ds_read_b64_tr_b16 a[84:85], v3 offset:24576
 ds_read_b64_tr_b16 a[86:87], v3 offset:25600
M v[176:179], a[172:175], a[132:135], v[176:179]
 buffer_load_dwordx4 v9, s[16:19], s21 offen offset:1024  nt lds
M v[176:179], a[168:171], a[128:131], v[176:179]
M v[172:175], a[168:171], a[120:123], v[172:175]
M v[172:175], a[172:175], a[124:127], v[172:175]
M v[168:171], a[172:175], a[116:119], v[168:171]
M v[168:171], a[168:171], a[112:115], v[168:171]
M v[164:167], a[168:171], a[104:107], v[164:167]
 ds_read_b64_tr_b16 a[88:89], v4 offset:16384
 ds_read_b64_tr_b16 a[90:91], v4 offset:17408
M v[164:167], a[172:175], a[108:111], v[164:167]
 s_waitcnt lgkmcnt(4)
M v[160:163], a[172:175], a[100:103], v[160:163]
 buffer_load_dwordx4 v10, s[16:19], s21 offen offset:2048  nt lds
M v[160:163], a[168:171], a[96:99], v[160:163]
M v[192:195], a[160:163], a[96:99], v[192:195]
 ds_read_b128 a[168:171], v5 offset:55296
 ds_read_b128 a[172:175], v6 offset:55296
M v[192:195], a[164:167], a[100:103], v[192:195]
M v[196:199], a[164:167], a[108:111], v[196:199]
M v[196:199], a[160:163], a[104:107], v[196:199]
 ds_read_b64_tr_b16 a[92:93], v4 offset:24576
 ds_read_b64_tr_b16 a[94:95], v4 offset:25600
M v[200:203], a[160:163], a[112:115], v[200:203]
 buffer_load_dwordx4 v11, s[16:19], s21 offen offset:3072  nt lds
M v[200:203], a[164:167], a[116:119], v[200:203]
 s_add_u32 s21, s21, 128
M v[204:207], a[164:167], a[124:127], v[204:207]
M v[204:207], a[160:163], a[120:123], v[204:207]
M v[208:211], a[160:163], a[128:131], v[208:211]
M v[208:211], a[164:167], a[132:135], v[208:211]
M v[212:215], a[164:167], a[140:143], v[212:215]
M v[212:215], a[160:163], a[136:139], v[212:215]
M v[216:219], a[160:163], a[144:147], v[216:219]
M v[216:219], a[164:167], a[148:151], v[216:219]
 s_waitcnt lgkmcnt(2)
M v[220:223], a[164:167], a[156:159], v[220:223]
 s_waitcnt vmcnt(17) lgkmcnt(0)
M v[220:223], a[160:163], a[152:155], v[220:223]
 s_barrier
M v[252:255], a[168:171], a[152:155], v[252:255]
 ds_read_b128 a[160:163], v5 offset:0
 ds_read_b128 a[164:167], v6 offset:0
M v[252:255], a[172:175], a[156:159], v[252:255]
 v_min_u32 v16, 1, v0
 v_lshlrev_b32 v16, 29, v16
M v[248:251], a[172:175], a[148:151], v[248:251]
 v_or_b32 v16, s39, v16
 v_mov_b32 v17, 1
M v[248:251], a[168:171], a[144:147], v[248:251]
M v[244:247], a[168:171], a[136:139], v[244:247]
 buffer_store_dword v17, v16, s[12:15], s38 offen offset:64 sc1
M v[244:247], a[172:175], a[140:143], v[244:247]
M v[240:243], a[172:175], a[132:135], v[240:243]
M v[240:243], a[168:171], a[128:131], v[240:243]
M v[236:239], a[168:171], a[120:123], v[236:239]
M v[236:239], a[172:175], a[124:127], v[236:239]
M v[232:235], a[172:175], a[116:119], v[232:235]
M v[232:235], a[168:171], a[112:115], v[232:235]
M v[228:231], a[168:171], a[104:107], v[228:231]
M v[228:231], a[172:175], a[108:111], v[228:231]
 s_waitcnt lgkmcnt(0)
M v[224:227], a[172:175], a[100:103], v[224:227]
M v[224:227], a[168:171], a[96:99], v[224:227]
M a[0:3], a[160:163], a[32:35], a[0:3]
 ds_read_b128 a[168:171], v5 offset:2048
 ds_read_b128 a[172:175], v6 offset:2048
M a[0:3], a[164:167], a[36:39], a[0:3]
 ds_read_b64_tr_b16 a[96:97], v1 offset:32768
 ds_read_b64_tr_b16 a[98:99], v1 offset:33792
M a[4:7], a[164:167], a[44:47], a[4:7]
 s_add_u32 m0, s24, 49152
M a[4:7], a[160:163], a[40:43], a[4:7]
 buffer_load_dwordx4 v12, s[48:51], s22 offen offset:0   lds
M a[8:11], a[160:163], a[48:51], a[8:11]
 v_and_b32 v20, 31, v0
M a[8:11], a[164:167], a[52:55], a[8:11]
 v_lshlrev_b32 v20, 2, v20
M a[12:15], a[164:167], a[60:63], a[12:15]
 ds_read_b64_tr_b16 a[100:101], v1 offset:40960
 ds_read_b64_tr_b16 a[102:103], v1 offset:41984
M a[12:15], a[160:163], a[56:59], a[12:15]
 v_add_u32 v21, 163584, v20
M a[16:19], a[160:163], a[64:67], a[16:19]
 buffer_load_dwordx4 v13, s[48:51], s22 offen offset:1024   lds
M a[16:19], a[164:167], a[68:71], a[16:19]
 ds_read_b32 v19, v21
M a[20:23], a[164:167], a[76:79], a[20:23]
 ds_read_b32 v21, v21 offset:64
M a[20:23], a[160:163], a[72:75], a[20:23]
 s_min_u32 s64, s20, 1
 ds_read_b64_tr_b16 a[104:105], v2 offset:32768
 ds_read_b64_tr_b16 a[106:107], v2 offset:33792
M a[24:27], a[160:163], a[80:83], a[24:27]
 s_lshl_b32 s64, s64, 29
 v_and_b32 v22, 32, v0
M a[24:27], a[164:167], a[84:87], a[24:27]
 s_waitcnt lgkmcnt(8)
 v_lshl_or_b32 v20, v22, 24, v20
M a[28:31], a[164:167], a[92:95], a[28:31]
 buffer_load_dwordx4 v14, s[48:51], s22 offen offset:2048   lds
M a[28:31], a[160:163], a[88:91], a[28:31]
 v_or_b32 v20, s64, v20
M v[60:63], a[168:171], a[88:91], v[60:63]
 ds_read_b128 a[160:163], v5 offset:4096
 ds_read_b128 a[164:167], v6 offset:4096
M v[60:63], a[172:175], a[92:95], v[60:63]
 ds_read_b64_tr_b16 a[108:109], v2 offset:40960
 ds_read_b64_tr_b16 a[110:111], v2 offset:41984
M v[56:59], a[172:175], a[84:87], v[56:59]
 buffer_load_dwordx4 v15, s[48:51], s22 offen offset:3072   lds
M v[56:59], a[168:171], a[80:83], v[56:59]
 s_sub_u32 s22, s22, 2097024
 v_and_b32 v22, 16, v0
M v[52:55], a[168:171], a[72:75], v[52:55]
 v_lshl_or_b32 v18, v22, 25, v20
M v[52:55], a[172:175], a[76:79], v[52:55]
 s_lshl_b32 s72, s30, 7
 ds_read_b64_tr_b16 a[112:113], v3 offset:32768
 ds_read_b64_tr_b16 a[114:115], v3 offset:33792
M v[48:51], a[172:175], a[68:71], v[48:51]
 s_add_u32 m0, s23, 16384
 s_add_u32 s72, s72, 104857600
M v[48:51], a[168:171], a[64:67], v[48:51]
 buffer_load_dwordx4 v8, s[16:19], s21 offen offset:0  nt lds
M v[44:47], a[168:171], a[56:59], v[44:47]
M v[44:47], a[172:175], a[60:63], v[44:47]
M v[40:43], a[172:175], a[52:55], v[40:43]
 ds_read_b64_tr_b16 a[116:117], v3 offset:40960
 ds_read_b64_tr_b16 a[118:119], v3 offset:41984
M v[40:43], a[168:171], a[48:51], v[40:43]
M v[36:39], a[168:171], a[40:43], v[36:39]
 buffer_load_dwordx4 v9, s[16:19], s21 offen offset:1024  nt lds
M v[36:39], a[172:175], a[44:47], v[36:39]
 s_waitcnt lgkmcnt(6)
M v[32:35], a[172:175], a[36:39], v[32:35]
 buffer_store_dword v21, v20, s[8:11], s72 offen sc1
M v[32:35], a[168:171], a[32:35], v[32:35]
 ds_read_b64_tr_b16 a[120:121], v4 offset:32768
 ds_read_b64_tr_b16 a[122:123], v4 offset:33792
M v[64:67], a[160:163], a[32:35], v[64:67]
 ds_read_b128 a[168:171], v5 offset:6144
 ds_read_b128 a[172:175], v6 offset:6144
M v[64:67], a[164:167], a[36:39], v[64:67]
 buffer_load_dwordx4 v10, s[16:19], s21 offen offset:2048  nt lds
M v[68:71], a[164:167], a[44:47], v[68:71]
M v[68:71], a[160:163], a[40:43], v[68:71]
M v[72:75], a[160:163], a[48:51], v[72:75]
 ds_read_b64_tr_b16 a[124:125], v4 offset:40960
 ds_read_b64_tr_b16 a[126:127], v4 offset:41984
M v[72:75], a[164:167], a[52:55], v[72:75]
M v[76:79], a[164:167], a[60:63], v[76:79]
 buffer_load_dwordx4 v11, s[16:19], s21 offen offset:3072  nt lds
M v[76:79], a[160:163], a[56:59], v[76:79]
 s_add_u32 s21, s21, 524160
M v[80:83], a[160:163], a[64:67], v[80:83]
M v[80:83], a[164:167], a[68:71], v[80:83]
M v[84:87], a[164:167], a[76:79], v[84:87]
M v[84:87], a[160:163], a[72:75], v[84:87]
 s_and_b32 s86, s41, 7
M v[88:91], a[160:163], a[80:83], v[88:91]
 s_mul_i32 s86, s86, 14
 s_lshr_b32 s64, s41, 3
 s_mul_i32 s64, s64, 7
M v[88:91], a[164:167], a[84:87], v[88:91]
 s_waitcnt lgkmcnt(2)
 s_add_u32 s86, s86, s64
 s_min_u32 s64, s42, 6
M v[92:95], a[164:167], a[92:95], v[92:95]
 s_waitcnt vmcnt(18) lgkmcnt(0)
 s_add_u32 s86, s86, s64
 s_sub_u32 s64, 6, s42
M v[92:95], a[160:163], a[88:91], v[92:95]
 s_barrier
M v[124:127], a[168:171], a[88:91], v[124:127]
 ds_read_b128 a[160:163], v5 offset:16384
 ds_read_b128 a[164:167], v6 offset:16384
M v[124:127], a[172:175], a[92:95], v[124:127]
 s_and_b32 s88, s64, 536870912
 s_mul_i32 s87, s20, 7168
M v[120:123], a[172:175], a[84:87], v[120:123]
 s_add_u32 m0, s24, 0
 ds_read_b64_tr_b16 a[128:129], v1 offset:49152
 ds_read_b64_tr_b16 a[130:131], v1 offset:50176
M v[120:123], a[168:171], a[80:83], v[120:123]
 buffer_load_dwordx4 v12, s[48:51], s22 offen offset:0   lds
M v[116:119], a[168:171], a[72:75], v[116:119]
 s_add_u32 s87, s87, 131072
M v[116:119], a[172:175], a[76:79], v[116:119]
 s_cmp_lt_u32 s20, 2
M v[112:115], a[172:175], a[68:71], v[112:115]
 s_cselect_b64 s[72:73], s[80:81], s[82:83]
M v[112:115], a[168:171], a[64:67], v[112:115]
 s_mov_b32 s60, s72
M v[108:111], a[168:171], a[56:59], v[108:111]
 s_and_b32 s61, s73, 0xffff
M v[108:111], a[172:175], a[60:63], v[108:111]
 s_mov_b32 s62, 1605632
 ds_read_b64_tr_b16 a[132:133], v1 offset:57344
 ds_read_b64_tr_b16 a[134:135], v1 offset:58368
M v[104:107], a[172:175], a[52:55], v[104:107]
 buffer_load_dwordx4 v13, s[48:51], s22 offen offset:1024   lds
M v[104:107], a[168:171], a[48:51], v[104:107]
 s_mov_b32 s63, 0x20000
M v[100:103], a[168:171], a[40:43], v[100:103]
 s_mov_b32 s68, s84
 s_and_b32 s69, s85, 0xffff
 s_mov_b32 s70, 1605632
M v[100:103], a[172:175], a[44:47], v[100:103]
 s_waitcnt lgkmcnt(4)
 s_mov_b32 s71, 0x20000
M v[96:99], a[172:175], a[36:39], v[96:99]
 s_lshl_b32 s89, s86, 5
 s_and_b32 s64, s20, 1
 s_mul_i32 s64, s64, 802816
M v[96:99], a[168:171], a[32:35], v[96:99]
 buffer_load_dwordx4 v14, s[48:51], s22 offen offset:2048   lds
M v[128:131], a[160:163], a[32:35], v[128:131]
 ds_read_b128 a[168:171], v5 offset:18432
 ds_read_b128 a[172:175], v6 offset:18432
M v[128:131], a[164:167], a[36:39], v[128:131]
 ds_read_b64_tr_b16 a[136:137], v2 offset:49152
 ds_read_b64_tr_b16 a[138:139], v2 offset:50176
M v[132:135], a[164:167], a[44:47], v[132:135]
 s_add_u32 s89, s89, s64
 v_lshrrev_b32 v28, 1, v0
M v[132:135], a[160:163], a[40:43], v[132:135]
 v_mul_u32_u24 v28, 3584, v28
 v_and_b32 v29, 1, v0
M v[136:139], a[160:163], a[48:51], v[136:139]
 v_lshl_add_u32 v25, v29, 4, v28
 v_or_b32 v25, s88, v25
M v[136:139], a[164:167], a[52:55], v[136:139]
M v[140:143], a[164:167], a[60:63], v[140:143]
 buffer_load_dwordx4 v15, s[48:51], s22 offen offset:3072   lds
M v[140:143], a[160:163], a[56:59], v[140:143]
 s_add_u32 s22, s22, 2097152
 ds_read_b64_tr_b16 a[140:141], v2 offset:57344
 ds_read_b64_tr_b16 a[142:143], v2 offset:58368
M v[144:147], a[160:163], a[64:67], v[144:147]
M v[144:147], a[164:167], a[68:71], v[144:147]
M v[148:151], a[164:167], a[76:79], v[148:151]
M v[148:151], a[160:163], a[72:75], v[148:151]
 s_add_u32 m0, s23, 32768
M v[152:155], a[160:163], a[80:83], v[152:155]
 buffer_load_dwordx4 v8, s[16:19], s21 offen offset:0  nt lds
M v[152:155], a[164:167], a[84:87], v[152:155]
 s_waitcnt lgkmcnt(4)
M v[156:159], a[164:167], a[92:95], v[156:159]
 ds_read_b64_tr_b16 a[144:145], v3 offset:49152
 ds_read_b64_tr_b16 a[146:147], v3 offset:50176
M v[156:159], a[160:163], a[88:91], v[156:159]
M v[188:191], a[168:171], a[88:91], v[188:191]
 ds_read_b128 a[160:163], v5 offset:20480
 ds_read_b128 a[164:167], v6 offset:20480
M v[188:191], a[172:175], a[92:95], v[188:191]
M v[184:187], a[172:175], a[84:87], v[184:187]
 buffer_load_dwordx4 v9, s[16:19], s21 offen offset:1024  nt lds
M v[184:187], a[168:171], a[80:83], v[184:187]
M v[180:183], a[168:171], a[72:75], v[180:183]
M v[180:183], a[172:175], a[76:79], v[180:183]
 ds_read_b64_tr_b16 a[148:149], v3 offset:57344
 ds_read_b64_tr_b16 a[150:151], v3 offset:58368
M v[176:179], a[172:175], a[68:71], v[176:179]
M v[176:179], a[168:171], a[64:67], v[176:179]
M v[172:175], a[168:171], a[56:59], v[172:175]
M v[172:175], a[172:175], a[60:63], v[172:175]
 buffer_load_dwordx4 v10, s[16:19], s21 offen offset:2048  nt lds
M v[168:171], a[172:175], a[52:55], v[168:171]
M v[168:171], a[168:171], a[48:51], v[168:171]
M v[164:167], a[168:171], a[40:43], v[164:167]
 ds_read_b64_tr_b16 a[152:153], v4 offset:49152
 ds_read_b64_tr_b16 a[154:155], v4 offset:50176
M v[164:167], a[172:175], a[44:47], v[164:167]
 s_waitcnt lgkmcnt(4)
M v[160:163], a[172:175], a[36:39], v[160:163]
M v[160:163], a[168:171], a[32:35], v[160:163]
 buffer_load_dwordx4 v11, s[16:19], s21 offen offset:3072  nt lds
M v[192:195], a[160:163], a[32:35], v[192:195]
 s_add_u32 s21, s21, 128
 ds_read_b128 a[168:171], v5 offset:22528
 ds_read_b128 a[172:175], v6 offset:22528
M v[192:195], a[164:167], a[36:39], v[192:195]
M v[196:199], a[164:167], a[44:47], v[196:199]
M v[196:199], a[160:163], a[40:43], v[196:199]
 ds_read_b64_tr_b16 a[156:157], v4 offset:57344
 ds_read_b64_tr_b16 a[158:159], v4 offset:58368
M v[200:203], a[160:163], a[48:51], v[200:203]
 s_add_u32 m0, s87, 0
M v[200:203], a[164:167], a[52:55], v[200:203]
 buffer_load_dwordx4 v25, s[60:63], s89 offen offset:0 nt lds
M v[204:207], a[164:167], a[60:63], v[204:207]
 s_add_u32 s89, s89, 114688
M v[204:207], a[160:163], a[56:59], v[204:207]
M v[208:211], a[160:163], a[64:67], v[208:211]
M v[208:211], a[164:167], a[68:71], v[208:211]
M v[212:215], a[164:167], a[76:79], v[212:215]
M v[212:215], a[160:163], a[72:75], v[212:215]
M v[216:219], a[160:163], a[80:83], v[216:219]
M v[216:219], a[164:167], a[84:87], v[216:219]
 s_waitcnt lgkmcnt(2)
M v[220:223], a[164:167], a[92:95], v[220:223]
 s_waitcnt vmcnt(19) lgkmcnt(0)
M v[220:223], a[160:163], a[88:91], v[220:223]
 s_barrier
M v[252:255], a[168:171], a[88:91], v[252:255]
 ds_read_b128 a[160:163], v5 offset:32768
 ds_read_b128 a[164:167], v6 offset:32768
M v[252:255], a[172:175], a[92:95], v[252:255]
M v[248:251], a[172:175], a[84:87], v[248:251]
M v[248:251], a[168:171], a[80:83], v[248:251]
M v[244:247], a[168:171], a[72:75], v[244:247]
M v[244:247], a[172:175], a[76:79], v[244:247]
M v[240:243], a[172:175], a[68:71], v[240:243]
M v[240:243], a[168:171], a[64:67], v[240:243]
M v[236:239], a[168:171], a[56:59], v[236:239]
M v[236:239], a[172:175], a[60:63], v[236:239]
M v[232:235], a[172:175], a[52:55], v[232:235]
M v[232:235], a[168:171], a[48:51], v[232:235]
M v[228:231], a[168:171], a[40:43], v[228:231]
M v[228:231], a[172:175], a[44:47], v[228:231]
 s_waitcnt lgkmcnt(0)
M v[224:227], a[172:175], a[36:39], v[224:227]
M v[224:227], a[168:171], a[32:35], v[224:227]
M a[0:3], a[160:163], a[96:99], a[0:3]
 ds_read_b128 a[168:171], v5 offset:34816
 ds_read_b128 a[172:175], v6 offset:34816
M a[0:3], a[164:167], a[100:103], a[0:3]
 ds_read_b64_tr_b16 a[32:33], v1 offset:0
 ds_read_b64_tr_b16 a[34:35], v1 offset:1024
M a[4:7], a[164:167], a[108:111], a[4:7]
 s_add_u32 m0, s24, 16384
M a[4:7], a[160:163], a[104:107], a[4:7]
 buffer_load_dwordx4 v12, s[48:51], s22 offen offset:0   lds
M a[8:11], a[160:163], a[112:115], a[8:11]
M a[8:11], a[164:167], a[116:119], a[8:11]
M a[12:15], a[164:167], a[124:127], a[12:15]
 ds_read_b64_tr_b16 a[36:37], v1 offset:8192
 ds_read_b64_tr_b16 a[38:39], v1 offset:9216
M a[12:15], a[160:163], a[120:123], a[12:15]
M a[16:19], a[160:163], a[128:131], a[16:19]
 buffer_load_dwordx4 v13, s[48:51], s22 offen offset:1024   lds
M a[16:19], a[164:167], a[132:135], a[16:19]
M a[20:23], a[164:167], a[140:143], a[20:23]
M a[20:23], a[160:163], a[136:139], a[20:23]
 ds_read_b64_tr_b16 a[40:41], v2 offset:0
 ds_read_b64_tr_b16 a[42:43], v2 offset:1024
M a[24:27], a[160:163], a[144:147], a[24:27]
M a[24:27], a[164:167], a[148:151], a[24:27]
 s_waitcnt lgkmcnt(6)
M a[28:31], a[164:167], a[156:159], a[28:31]
 buffer_load_dwordx4 v14, s[48:51], s22 offen offset:2048   lds
M a[28:31], a[160:163], a[152:155], a[28:31]
M v[60:63], a[168:171], a[152:155], v[60:63]
 ds_read_b128 a[160:163], v5 offset:36864
 ds_read_b128 a[164:167], v6 offset:36864
M v[60:63], a[172:175], a[156:159], v[60:63]
 ds_read_b64_tr_b16 a[44:45], v2 offset:8192
 ds_read_b64_tr_b16 a[46:47], v2 offset:9216
M v[56:59], a[172:175], a[148:151], v[56:59]
 buffer_load_dwordx4 v15, s[48:51], s22 offen offset:3072   lds
M v[56:59], a[168:171], a[144:147], v[56:59]
 s_sub_u32 s22, s22, 2097024
M v[52:55], a[168:171], a[136:139], v[52:55]
M v[52:55], a[172:175], a[140:143], v[52:55]
 ds_read_b64_tr_b16 a[48:49], v3 offset:0
 ds_read_b64_tr_b16 a[50:51], v3 offset:1024
M v[48:51], a[172:175], a[132:135], v[48:51]
 s_add_u32 m0, s23, 49152
M v[48:51], a[168:171], a[128:131], v[48:51]
 buffer_load_dwordx4 v8, s[16:19], s21 offen offset:0  nt lds
M v[44:47], a[168:171], a[120:123], v[44:47]
M v[44:47], a[172:175], a[124:127], v[44:47]
M v[40:43], a[172:175], a[116:119], v[40:43]
 ds_read_b64_tr_b16 a[52:53], v3 offset:8192
 ds_read_b64_tr_b16 a[54:55], v3 offset:9216
M v[40:43], a[168:171], a[112:115], v[40:43]
M v[36:39], a[168:171], a[104:107], v[36:39]
 buffer_load_dwordx4 v9, s[16:19], s21 offen offset:1024  nt lds
M v[36:39], a[172:175], a[108:111], v[36:39]
 s_waitcnt lgkmcnt(6)
M v[32:35], a[172:175], a[100:103], v[32:35]
M v[32:35], a[168:171], a[96:99], v[32:35]
 ds_read_b64_tr_b16 a[56:57], v4 offset:0
 ds_read_b64_tr_b16 a[58:59], v4 offset:1024
M v[64:67], a[160:163], a[96:99], v[64:67]
 ds_read_b128 a[168:171], v5 offset:38912
 ds_read_b128 a[172:175], v6 offset:38912
M v[64:67], a[164:167], a[100:103], v[64:67]
 buffer_load_dwordx4 v10, s[16:19], s21 offen offset:2048  nt lds
M v[68:71], a[164:167], a[108:111], v[68:71]
M v[68:71], a[160:163], a[104:107], v[68:71]
M v[72:75], a[160:163], a[112:115], v[72:75]
 ds_read_b64_tr_b16 a[60:61], v4 offset:8192
 ds_read_b64_tr_b16 a[62:63], v4 offset:9216
M v[72:75], a[164:167], a[116:119], v[72:75]
M v[76:79], a[164:167], a[124:127], v[76:79]
 buffer_load_dwordx4 v11, s[16:19], s21 offen offset:3072  nt lds
M v[76:79], a[160:163], a[120:123], v[76:79]
 s_add_u32 s21, s21, 524160
M v[80:83], a[160:163], a[128:131], v[80:83]
M v[80:83], a[164:167], a[132:135], v[80:83]
M v[84:87], a[164:167], a[140:143], v[84:87]
M v[84:87], a[160:163], a[136:139], v[84:87]
M v[88:91], a[160:163], a[144:147], v[88:91]
M v[88:91], a[164:167], a[148:151], v[88:91]
 s_waitcnt lgkmcnt(2)
M v[92:95], a[164:167], a[156:159], v[92:95]
 s_waitcnt vmcnt(17) lgkmcnt(0)
M v[92:95], a[160:163], a[152:155], v[92:95]
 s_barrier
M v[124:127], a[168:171], a[152:155], v[124:127]
 ds_read_b128 a[160:163], v5 offset:49152
 ds_read_b128 a[164:167], v6 offset:49152
M v[124:127], a[172:175], a[156:159], v[124:127]
M v[120:123], a[172:175], a[148:151], v[120:123]
 s_add_u32 m0, s24, 32768
 ds_read_b64_tr_b16 a[64:65], v1 offset:16384
 ds_read_b64_tr_b16 a[66:67], v1 offset:17408
M v[120:123], a[168:171], a[144:147], v[120:123]
 buffer_load_dwordx4 v12, s[48:51], s22 offen offset:0   lds
M v[116:119], a[168:171], a[136:139], v[116:119]
 v_min_u32 v16, 40, v0
 v_lshlrev_b32 v16, 2, v16
M v[116:119], a[172:175], a[140:143], v[116:119]
 buffer_load_dword v17, v16, s[12:15], 0 offen offset:64 sc1
M v[112:115], a[172:175], a[132:135], v[112:115]
M v[112:115], a[168:171], a[128:131], v[112:115]
M v[108:111], a[168:171], a[120:123], v[108:111]
M v[108:111], a[172:175], a[124:127], v[108:111]
 ds_read_b64_tr_b16 a[68:69], v1 offset:24576
 ds_read_b64_tr_b16 a[70:71], v1 offset:25600
M v[104:107], a[172:175], a[116:119], v[104:107]
 buffer_load_dwordx4 v13, s[48:51], s22 offen offset:1024   lds
M v[104:107], a[168:171], a[112:115], v[104:107]
M v[100:103], a[168:171], a[104:107], v[100:103]
M v[100:103], a[172:175], a[108:111], v[100:103]
 s_waitcnt lgkmcnt(4)
M v[96:99], a[172:175], a[100:103], v[96:99]
M v[96:99], a[168:171], a[96:99], v[96:99]
 buffer_load_dwordx4 v14, s[48:51], s22 offen offset:2048   lds
M v[128:131], a[160:163], a[96:99], v[128:131]
 ds_read_b128 a[168:171], v5 offset:51200
 ds_read_b128 a[172:175], v6 offset:51200
M v[128:131], a[164:167], a[100:103], v[128:131]
 ds_read_b64_tr_b16 a[72:73], v2 offset:16384
 ds_read_b64_tr_b16 a[74:75], v2 offset:17408
M v[132:135], a[164:167], a[108:111], v[132:135]
M v[132:135], a[160:163], a[104:107], v[132:135]
M v[136:139], a[160:163], a[112:115], v[136:139]
M v[136:139], a[164:167], a[116:119], v[136:139]
M v[140:143], a[164:167], a[124:127], v[140:143]
 buffer_load_dwordx4 v15, s[48:51], s22 offen offset:3072   lds
M v[140:143], a[160:163], a[120:123], v[140:143]
 s_add_u32 s22, s22, 2097152
 ds_read_b64_tr_b16 a[76:77], v2 offset:24576
 ds_read_b64_tr_b16 a[78:79], v2 offset:25600
M v[144:147], a[160:163], a[128:131], v[144:147]
M v[144:147], a[164:167], a[132:135], v[144:147]
M v[148:151], a[164:167], a[140:143], v[148:151]
M v[148:151], a[160:163], a[136:139], v[148:151]
 s_add_u32 m0, s23, 0
M v[152:155], a[160:163], a[144:147], v[152:155]
 buffer_load_dwordx4 v8, s[16:19], s21 offen offset:0  nt lds
M v[152:155], a[164:167], a[148:151], v[152:155]
 s_waitcnt lgkmcnt(4)
M v[156:159], a[164:167], a[156:159], v[156:159]
 ds_read_b64_tr_b16 a[80:81], v3 offset:16384
 ds_read_b64_tr_b16 a[82:83], v3 offset:17408
M v[156:159], a[160:163], a[152:155], v[156:159]
M v[188:191], a[168:171], a[152:155], v[188:191]
 ds_read_b128 a[160:163], v5 offset:53248
 ds_read_b128 a[164:167], v6 offset:53248
M v[188:191], a[172:175], a[156:159], v[188:191]
M v[184:187], a[172:175], a[148:151], v[184:187]
 buffer_load_dwordx4 v9, s[16:19], s21 offen offset:1024  nt lds
M v[184:187], a[168:171], a[144:147], v[184:187]
M v[180:183], a[168:171], a[136:139], v[180:183]
M v[180:183], a[172:175], a[140:143], v[180:183]
 ds_read_b64_tr_b16 a[84:85], v3 offset:24576
 ds_read_b64_tr_b16 a[86:87], v3 offset:25600
M v[176:179], a[172:175], a[132:135], v[176:179]
M v[176:179], a[168:171], a[128:131], v[176:179]
M v[172:175], a[168:171], a[120:123], v[172:175]
M v[172:175], a[172:175], a[124:127], v[172:175]
 buffer_load_dwordx4 v10, s[16:19], s21 offen offset:2048  nt lds
M v[168:171], a[172:175], a[116:119], v[168:171]
M v[168:171], a[168:171], a[112:115], v[168:171]
M v[164:167], a[168:171], a[104:107], v[164:167]
 ds_read_b64_tr_b16 a[88:89], v4 offset:16384
 ds_read_b64_tr_b16 a[90:91], v4 offset:17408
M v[164:167], a[172:175], a[108:111], v[164:167]
 s_waitcnt lgkmcnt(4)
M v[160:163], a[172:175], a[100:103], v[160:163]
M v[160:163], a[168:171], a[96:99], v[160:163]
 buffer_load_dwordx4 v11, s[16:19], s21 offen offset:3072  nt lds
M v[192:195], a[160:163], a[96:99], v[192:195]
 s_add_u32 s21, s21, 128
 ds_read_b128 a[168:171], v5 offset:55296
 ds_read_b128 a[172:175], v6 offset:55296
M v[192:195], a[164:167], a[100:103], v[192:195]
M v[196:199], a[164:167], a[108:111], v[196:199]
M v[196:199], a[160:163], a[104:107], v[196:199]
 ds_read_b64_tr_b16 a[92:93], v4 offset:24576
 ds_read_b64_tr_b16 a[94:95], v4 offset:25600
M v[200:203], a[160:163], a[112:115], v[200:203]
 s_add_u32 m0, s87, 1024
M v[200:203], a[164:167], a[116:119], v[200:203]
 buffer_load_dwordx4 v25, s[60:63], s89 offen offset:0 nt lds
M v[204:207], a[164:167], a[124:127], v[204:207]
 s_add_u32 s89, s89, 114688
M v[204:207], a[160:163], a[120:123], v[204:207]
M v[208:211], a[160:163], a[128:131], v[208:211]
M v[208:211], a[164:167], a[132:135], v[208:211]
M v[212:215], a[164:167], a[140:143], v[212:215]
M v[212:215], a[160:163], a[136:139], v[212:215]
M v[216:219], a[160:163], a[144:147], v[216:219]
M v[216:219], a[164:167], a[148:151], v[216:219]
 s_waitcnt lgkmcnt(2)
M v[220:223], a[164:167], a[156:159], v[220:223]
 s_waitcnt vmcnt(19) lgkmcnt(0)
M v[220:223], a[160:163], a[152:155], v[220:223]
 s_barrier
M v[252:255], a[168:171], a[152:155], v[252:255]
 ds_read_b128 a[160:163], v5 offset:0
 ds_read_b128 a[164:167], v6 offset:0
M v[252:255], a[172:175], a[156:159], v[252:255]
M v[248:251], a[172:175], a[148:151], v[248:251]
M v[248:251], a[168:171], a[144:147], v[248:251]
M v[244:247], a[168:171], a[136:139], v[244:247]
M v[244:247], a[172:175], a[140:143], v[244:247]
M v[240:243], a[172:175], a[132:135], v[240:243]
M v[240:243], a[168:171], a[128:131], v[240:243]
M v[236:239], a[168:171], a[120:123], v[236:239]
M v[236:239], a[172:175], a[124:127], v[236:239]
M v[232:235], a[172:175], a[116:119], v[232:235]
M v[232:235], a[168:171], a[112:115], v[232:235]
M v[228:231], a[168:171], a[104:107], v[228:231]
M v[228:231], a[172:175], a[108:111], v[228:231]
 s_waitcnt lgkmcnt(0)
M v[224:227], a[172:175], a[100:103], v[224:227]
M v[224:227], a[168:171], a[96:99], v[224:227]
M a[0:3], a[160:163], a[32:35], a[0:3]
 ds_read_b128 a[168:171], v5 offset:2048
 ds_read_b128 a[172:175], v6 offset:2048
M a[0:3], a[164:167], a[36:39], a[0:3]
 ds_read_b64_tr_b16 a[96:97], v1 offset:32768
 ds_read_b64_tr_b16 a[98:99], v1 offset:33792
M a[4:7], a[164:167], a[44:47], a[4:7]
 s_add_u32 m0, s24, 49152
M a[4:7], a[160:163], a[40:43], a[4:7]
 buffer_load_dwordx4 v12, s[48:51], s22 offen offset:0   lds
M a[8:11], a[160:163], a[48:51], a[8:11]
M a[8:11], a[164:167], a[52:55], a[8:11]
M a[12:15], a[164:167], a[60:63], a[12:15]
 ds_read_b64_tr_b16 a[100:101], v1 offset:40960
 ds_read_b64_tr_b16 a[102:103], v1 offset:41984
M a[12:15], a[160:163], a[56:59], a[12:15]
M a[16:19], a[160:163], a[64:67], a[16:19]
 buffer_load_dwordx4 v13, s[48:51], s22 offen offset:1024   lds
M a[16:19], a[164:167], a[68:71], a[16:19]
M a[20:23], a[164:167], a[76:79], a[20:23]
M a[20:23], a[160:163], a[72:75], a[20:23]
 ds_read_b64_tr_b16 a[104:105], v2 offset:32768
 ds_read_b64_tr_b16 a[106:107], v2 offset:33792
M a[24:27], a[160:163], a[80:83], a[24:27]
M a[24:27], a[164:167], a[84:87], a[24:27]
 s_waitcnt lgkmcnt(6)
M a[28:31], a[164:167], a[92:95], a[28:31]
 buffer_load_dwordx4 v14, s[48:51], s22 offen offset:2048   lds
M a[28:31], a[160:163], a[88:91], a[28:31]
M v[60:63], a[168:171], a[88:91], v[60:63]
 ds_read_b128 a[160:163], v5 offset:4096
 ds_read_b128 a[164:167], v6 offset:4096
M v[60:63], a[172:175], a[92:95], v[60:63]
 ds_read_b64_tr_b16 a[108:109], v2 offset:40960
 ds_read_b64_tr_b16 a[110:111], v2 offset:41984
M v[56:59], a[172:175], a[84:87], v[56:59]
 buffer_load_dwordx4 v15, s[48:51], s22 offen offset:3072   lds
M v[56:59], a[168:171], a[80:83], v[56:59]
 s_sub_u32 s22, s22, 2097024
M v[52:55], a[168:171], a[72:75], v[52:55]
M v[52:55], a[172:175], a[76:79], v[52:55]
 ds_read_b64_tr_b16 a[112:113], v3 offset:32768
 ds_read_b64_tr_b16 a[114:115], v3 offset:33792
M v[48:51], a[172:175], a[68:71], v[48:51]
 s_add_u32 m0, s23, 16384
M v[48:51], a[168:171], a[64:67], v[48:51]
 buffer_load_dwordx4 v8, s[16:19], s21 offen offset:0  nt lds
M v[44:47], a[168:171], a[56:59], v[44:47]
M v[44:47], a[172:175], a[60:63], v[44:47]
M v[40:43], a[172:175], a[52:55], v[40:43]
 ds_read_b64_tr_b16 a[116:117], v3 offset:40960
 ds_read_b64_tr_b16 a[118:119], v3 offset:41984
M v[40:43], a[168:171], a[48:51], v[40:43]
M v[36:39], a[168:171], a[40:43], v[36:39]
 buffer_load_dwordx4 v9, s[16:19], s21 offen offset:1024  nt lds
M v[36:39], a[172:175], a[44:47], v[36:39]
 s_waitcnt lgkmcnt(6)
M v[32:35], a[172:175], a[36:39], v[32:35]
M v[32:35], a[168:171], a[32:35], v[32:35]
 ds_read_b64_tr_b16 a[120:121], v4 offset:32768
 ds_read_b64_tr_b16 a[122:123], v4 offset:33792
M v[64:67], a[160:163], a[32:35], v[64:67]
 ds_read_b128 a[168:171], v5 offset:6144
 ds_read_b128 a[172:175], v6 offset:6144
M v[64:67], a[164:167], a[36:39], v[64:67]
 buffer_load_dwordx4 v10, s[16:19], s21 offen offset:2048  nt lds
M v[68:71], a[164:167], a[44:47], v[68:71]
M v[68:71], a[160:163], a[40:43], v[68:71]
M v[72:75], a[160:163], a[48:51], v[72:75]
 ds_read_b64_tr_b16 a[124:125], v4 offset:40960
 ds_read_b64_tr_b16 a[126:127], v4 offset:41984
M v[72:75], a[164:167], a[52:55], v[72:75]
M v[76:79], a[164:167], a[60:63], v[76:79]
 buffer_load_dwordx4 v11, s[16:19], s21 offen offset:3072  nt lds
M v[76:79], a[160:163], a[56:59], v[76:79]
 s_add_u32 s21, s21, 524160
M v[80:83], a[160:163], a[64:67], v[80:83]
M v[80:83], a[164:167], a[68:71], v[80:83]
M v[84:87], a[164:167], a[76:79], v[84:87]
M v[84:87], a[160:163], a[72:75], v[84:87]
M v[88:91], a[160:163], a[80:83], v[88:91]
M v[88:91], a[164:167], a[84:87], v[88:91]
 s_waitcnt lgkmcnt(2)
M v[92:95], a[164:167], a[92:95], v[92:95]
 s_waitcnt vmcnt(18) lgkmcnt(0)
M v[92:95], a[160:163], a[88:91], v[92:95]
 s_barrier
M v[124:127], a[168:171], a[88:91], v[124:127]
 ds_read_b128 a[160:163], v5 offset:16384
 ds_read_b128 a[164:167], v6 offset:16384
M v[124:127], a[172:175], a[92:95], v[124:127]
M v[120:123], a[172:175], a[84:87], v[120:123]
 s_add_u32 m0, s24, 0
 ds_read_b64_tr_b16 a[128:129], v1 offset:49152
 ds_read_b64_tr_b16 a[130:131], v1 offset:50176
M v[120:123], a[168:171], a[80:83], v[120:123]
 buffer_load_dwordx4 v12, s[48:51], s22 offen offset:0   lds
M v[116:119], a[168:171], a[72:75], v[116:119]
M v[116:119], a[172:175], a[76:79], v[116:119]
M v[112:115], a[172:175], a[68:71], v[112:115]
M v[112:115], a[168:171], a[64:67], v[112:115]
M v[108:111], a[168:171], a[56:59], v[108:111]
M v[108:111], a[172:175], a[60:63], v[108:111]
 ds_read_b64_tr_b16 a[132:133], v1 offset:57344
 ds_read_b64_tr_b16 a[134:135], v1 offset:58368
M v[104:107], a[172:175], a[52:55], v[104:107]
 buffer_load_dwordx4 v13, s[48:51], s22 offen offset:1024   lds
M v[104:107], a[168:171], a[48:51], v[104:107]
M v[100:103], a[168:171], a[40:43], v[100:103]
M v[100:103], a[172:175], a[44:47], v[100:103]
 s_waitcnt lgkmcnt(4)
M v[96:99], a[172:175], a[36:39], v[96:99]
M v[96:99], a[168:171], a[32:35], v[96:99]
 buffer_load_dwordx4 v14, s[48:51], s22 offen offset:2048   lds
M v[128:131], a[160:163], a[32:35], v[128:131]
 ds_read_b128 a[168:171], v5 offset:18432
 ds_read_b128 a[172:175], v6 offset:18432
M v[128:131], a[164:167], a[36:39], v[128:131]
 ds_read_b64_tr_b16 a[136:137], v2 offset:49152
 ds_read_b64_tr_b16 a[138:139], v2 offset:50176
M v[132:135], a[164:167], a[44:47], v[132:135]
M v[132:135], a[160:163], a[40:43], v[132:135]
M v[136:139], a[160:163], a[48:51], v[136:139]
M v[136:139], a[164:167], a[52:55], v[136:139]
M v[140:143], a[164:167], a[60:63], v[140:143]
 buffer_load_dwordx4 v15, s[48:51], s22 offen offset:3072   lds
M v[140:143], a[160:163], a[56:59], v[140:143]
 s_add_u32 s22, s22, 2097152
 ds_read_b64_tr_b16 a[140:141], v2 offset:57344
 ds_read_b64_tr_b16 a[142:143], v2 offset:58368
M v[144:147], a[160:163], a[64:67], v[144:147]
M v[144:147], a[164:167], a[68:71], v[144:147]
M v[148:151], a[164:167], a[76:79], v[148:151]
M v[148:151], a[160:163], a[72:75], v[148:151]
 s_add_u32 m0, s23, 32768
M v[152:155], a[160:163], a[80:83], v[152:155]
 buffer_load_dwordx4 v8, s[16:19], s21 offen offset:0  nt lds
M v[152:155], a[164:167], a[84:87], v[152:155]
 s_waitcnt lgkmcnt(4)
M v[156:159], a[164:167], a[92:95], v[156:159]
 ds_read_b64_tr_b16 a[144:145], v3 offset:49152
 ds_read_b64_tr_b16 a[146:147], v3 offset:50176
M v[156:159], a[160:163], a[88:91], v[156:159]
M v[188:191], a[168:171], a[88:91], v[188:191]
 ds_read_b128 a[160:163], v5 offset:20480
 ds_read_b128 a[164:167], v6 offset:20480
M v[188:191], a[172:175], a[92:95], v[188:191]
M v[184:187], a[172:175], a[84:87], v[184:187]
 buffer_load_dwordx4 v9, s[16:19], s21 offen offset:1024  nt lds
M v[184:187], a[168:171], a[80:83], v[184:187]
M v[180:183], a[168:171], a[72:75], v[180:183]
M v[180:183], a[172:175], a[76:79], v[180:183]
 ds_read_b64_tr_b16 a[148:149], v3 offset:57344
 ds_read_b64_tr_b16 a[150:151], v3 offset:58368
M v[176:179], a[172:175], a[68:71], v[176:179]
M v[176:179], a[168:171], a[64:67], v[176:179]
M v[172:175], a[168:171], a[56:59], v[172:175]
M v[172:175], a[172:175], a[60:63], v[172:175]
 buffer_load_dwordx4 v10, s[16:19], s21 offen offset:2048  nt lds
M v[168:171], a[172:175], a[52:55], v[168:171]
M v[168:171], a[168:171], a[48:51], v[168:171]
M v[164:167], a[168:171], a[40:43], v[164:167]
 ds_read_b64_tr_b16 a[152:153], v4 offset:49152
 ds_read_b64_tr_b16 a[154:155], v4 offset:50176
M v[164:167], a[172:175], a[44:47], v[164:167]
 s_waitcnt lgkmcnt(4)
M v[160:163], a[172:175], a[36:39], v[160:163]
M v[160:163], a[168:171], a[32:35], v[160:163]
 buffer_load_dwordx4 v11, s[16:19], s21 offen offset:3072  nt lds
M v[192:195], a[160:163], a[32:35], v[192:195]
 s_add_u32 s21, s21, 128
 ds_read_b128 a[168:171], v5 offset:22528
 ds_read_b128 a[172:175], v6 offset:22528
M v[192:195], a[164:167], a[36:39], v[192:195]
M v[196:199], a[164:167], a[44:47], v[196:199]
M v[196:199], a[160:163], a[40:43], v[196:199]
 ds_read_b64_tr_b16 a[156:157], v4 offset:57344
 ds_read_b64_tr_b16 a[158:159], v4 offset:58368
M v[200:203], a[160:163], a[48:51], v[200:203]
 s_add_u32 m0, s87, 2048
M v[200:203], a[164:167], a[52:55], v[200:203]
 buffer_load_dwordx4 v25, s[60:63], s89 offen offset:0 nt lds
M v[204:207], a[164:167], a[60:63], v[204:207]
 s_add_u32 s89, s89, 114688
M v[204:207], a[160:163], a[56:59], v[204:207]
M v[208:211], a[160:163], a[64:67], v[208:211]
M v[208:211], a[164:167], a[68:71], v[208:211]
M v[212:215], a[164:167], a[76:79], v[212:215]
M v[212:215], a[160:163], a[72:75], v[212:215]
M v[216:219], a[160:163], a[80:83], v[216:219]
M v[216:219], a[164:167], a[84:87], v[216:219]
 s_waitcnt lgkmcnt(2)
M v[220:223], a[164:167], a[92:95], v[220:223]
 s_waitcnt vmcnt(18) lgkmcnt(0)
M v[220:223], a[160:163], a[88:91], v[220:223]
 s_barrier
M v[252:255], a[168:171], a[88:91], v[252:255]
 ds_read_b128 a[160:163], v5 offset:32768
 ds_read_b128 a[164:167], v6 offset:32768
M v[252:255], a[172:175], a[92:95], v[252:255]
 v_cmp_ne_u32 vcc, 1, v17
M v[248:251], a[172:175], a[84:87], v[248:251]
 s_nop 0
M v[248:251], a[168:171], a[80:83], v[248:251]
 s_cbranch_vccnz L_zs0
L_zr0:
M v[244:247], a[168:171], a[72:75], v[244:247]
 buffer_load_dword a240, v24, s[32:35], 0 offen offset:1024
M v[244:247], a[172:175], a[76:79], v[244:247]
 s_lshl_b32 s72, s30, 6
M v[240:243], a[172:175], a[68:71], v[240:243]
 s_add_u32 s72, s72, 104914944
M v[240:243], a[168:171], a[64:67], v[240:243]
M v[236:239], a[168:171], a[56:59], v[236:239]
 buffer_store_dword v19, v18, s[8:11], s72 offen sc1
M v[236:239], a[172:175], a[60:63], v[236:239]
M v[232:235], a[172:175], a[52:55], v[232:235]
M v[232:235], a[168:171], a[48:51], v[232:235]
M v[228:231], a[168:171], a[40:43], v[228:231]
M v[228:231], a[172:175], a[44:47], v[228:231]
 s_waitcnt lgkmcnt(0)
M v[224:227], a[172:175], a[36:39], v[224:227]
M v[224:227], a[168:171], a[32:35], v[224:227]
M a[0:3], a[160:163], a[96:99], a[0:3]
 ds_read_b128 a[168:171], v5 offset:34816
 ds_read_b128 a[172:175], v6 offset:34816
M a[0:3], a[164:167], a[100:103], a[0:3]
 ds_read_b64_tr_b16 a[32:33], v1 offset:0
 ds_read_b64_tr_b16 a[34:35], v1 offset:1024
M a[4:7], a[164:167], a[108:111], a[4:7]
 s_add_u32 m0, s24, 16384
M a[4:7], a[160:163], a[104:107], a[4:7]
 buffer_load_dwordx4 v12, s[48:51], s22 offen offset:0   lds
M a[8:11], a[160:163], a[112:115], a[8:11]
M a[8:11], a[164:167], a[116:119], a[8:11]
M a[12:15], a[164:167], a[124:127], a[12:15]
 ds_read_b64_tr_b16 a[36:37], v1 offset:8192
 ds_read_b64_tr_b16 a[38:39], v1 offset:9216
M a[12:15], a[160:163], a[120:123], a[12:15]
M a[16:19], a[160:163], a[128:131], a[16:19]
 buffer_load_dwordx4 v13, s[48:51], s22 offen offset:1024   lds
M a[16:19], a[164:167], a[132:135], a[16:19]
M a[20:23], a[164:167], a[140:143], a[20:23]
M a[20:23], a[160:163], a[136:139], a[20:23]
 ds_read_b64_tr_b16 a[40:41], v2 offset:0
 ds_read_b64_tr_b16 a[42:43], v2 offset:1024
M a[24:27], a[160:163], a[144:147], a[24:27]
M a[24:27], a[164:167], a[148:151], a[24:27]
 s_waitcnt lgkmcnt(6)
M a[28:31], a[164:167], a[156:159], a[28:31]
 buffer_load_dwordx4 v14, s[48:51], s22 offen offset:2048   lds
M a[28:31], a[160:163], a[152:155], a[28:31]
M v[60:63], a[168:171], a[152:155], v[60:63]
 ds_read_b128 a[160:163], v5 offset:36864
 ds_read_b128 a[164:167], v6 offset:36864
M v[60:63], a[172:175], a[156:159], v[60:63]
 ds_read_b64_tr_b16 a[44:45], v2 offset:8192
 ds_read_b64_tr_b16 a[46:47], v2 offset:9216
M v[56:59], a[172:175], a[148:151], v[56:59]
 buffer_load_dwordx4 v15, s[48:51], s22 offen offset:3072   lds
M v[56:59], a[168:171], a[144:147], v[56:59]
 s_sub_u32 s22, s22, 2097024
M v[52:55], a[168:171], a[136:139], v[52:55]
M v[52:55], a[172:175], a[140:143], v[52:55]
 ds_read_b64_tr_b16 a[48:49], v3 offset:0
 ds_read_b64_tr_b16 a[50:51], v3 offset:1024
M v[48:51], a[172:175], a[132:135], v[48:51]
 s_add_u32 m0, s23, 49152
M v[48:51], a[168:171], a[128:131], v[48:51]
 buffer_load_dwordx4 v8, s[16:19], s21 offen offset:0  nt lds
M v[44:47], a[168:171], a[120:123], v[44:47]
M v[44:47], a[172:175], a[124:127], v[44:47]
M v[40:43], a[172:175], a[116:119], v[40:43]
 ds_read_b64_tr_b16 a[52:53], v3 offset:8192
 ds_read_b64_tr_b16 a[54:55], v3 offset:9216
M v[40:43], a[168:171], a[112:115], v[40:43]
M v[36:39], a[168:171], a[104:107], v[36:39]
 buffer_load_dwordx4 v9, s[16:19], s21 offen offset:1024  nt lds
M v[36:39], a[172:175], a[108:111], v[36:39]
 s_waitcnt lgkmcnt(6)
M v[32:35], a[172:175], a[100:103], v[32:35]
M v[32:35], a[168:171], a[96:99], v[32:35]
 ds_read_b64_tr_b16 a[56:57], v4 offset:0
 ds_read_b64_tr_b16 a[58:59], v4 offset:1024
M v[64:67], a[160:163], a[96:99], v[64:67]
 ds_read_b128 a[168:171], v5 offset:38912
 ds_read_b128 a[172:175], v6 offset:38912
M v[64:67], a[164:167], a[100:103], v[64:67]
 buffer_load_dwordx4 v10, s[16:19], s21 offen offset:2048  nt lds
M v[68:71], a[164:167], a[108:111], v[68:71]
M v[68:71], a[160:163], a[104:107], v[68:71]
M v[72:75], a[160:163], a[112:115], v[72:75]
 ds_read_b64_tr_b16 a[60:61], v4 offset:8192
 ds_read_b64_tr_b16 a[62:63], v4 offset:9216
M v[72:75], a[164:167], a[116:119], v[72:75]
M v[76:79], a[164:167], a[124:127], v[76:79]
 buffer_load_dwordx4 v11, s[16:19], s21 offen offset:3072  nt lds
M v[76:79], a[160:163], a[120:123], v[76:79]
 s_add_u32 s21, s21, 524160
M v[80:83], a[160:163], a[128:131], v[80:83]
M v[80:83], a[164:167], a[132:135], v[80:83]
M v[84:87], a[164:167], a[140:143], v[84:87]
M v[84:87], a[160:163], a[136:139], v[84:87]
M v[88:91], a[160:163], a[144:147], v[88:91]
M v[88:91], a[164:167], a[148:151], v[88:91]
 s_waitcnt lgkmcnt(2)
M v[92:95], a[164:167], a[156:159], v[92:95]
 s_waitcnt vmcnt(19) lgkmcnt(0)
M v[92:95], a[160:163], a[152:155], v[92:95]
 s_barrier
M v[124:127], a[168:171], a[152:155], v[124:127]
 ds_read_b128 a[160:163], v5 offset:49152
 ds_read_b128 a[164:167], v6 offset:49152
M v[124:127], a[172:175], a[156:159], v[124:127]
M v[120:123], a[172:175], a[148:151], v[120:123]
 s_add_u32 m0, s24, 32768
 ds_read_b64_tr_b16 a[64:65], v1 offset:16384
 ds_read_b64_tr_b16 a[66:67], v1 offset:17408
M v[120:123], a[168:171], a[144:147], v[120:123]
 buffer_load_dwordx4 v12, s[48:51], s22 offen offset:0   lds
M v[116:119], a[168:171], a[136:139], v[116:119]
M v[116:119], a[172:175], a[140:143], v[116:119]
M v[112:115], a[172:175], a[132:135], v[112:115]
M v[112:115], a[168:171], a[128:131], v[112:115]
M v[108:111], a[168:171], a[120:123], v[108:111]
M v[108:111], a[172:175], a[124:127], v[108:111]
 ds_read_b64_tr_b16 a[68:69], v1 offset:24576
 ds_read_b64_tr_b16 a[70:71], v1 offset:25600
M v[104:107], a[172:175], a[116:119], v[104:107]
 buffer_load_dwordx4 v13, s[48:51], s22 offen offset:1024   lds
M v[104:107], a[168:171], a[112:115], v[104:107]
M v[100:103], a[168:171], a[104:107], v[100:103]
M v[100:103], a[172:175], a[108:111], v[100:103]
 s_waitcnt lgkmcnt(4)
M v[96:99], a[172:175], a[100:103], v[96:99]
M v[96:99], a[168:171], a[96:99], v[96:99]
 buffer_load_dwordx4 v14, s[48:51], s22 offen offset:2048   lds
M v[128:131], a[160:163], a[96:99], v[128:131]
 ds_read_b128 a[168:171], v5 offset:51200
 ds_read_b128 a[172:175], v6 offset:51200
M v[128:131], a[164:167], a[100:103], v[128:131]
 ds_read_b64_tr_b16 a[72:73], v2 offset:16384
 ds_read_b64_tr_b16 a[74:75], v2 offset:17408
M v[132:135], a[164:167], a[108:111], v[132:135]
M v[132:135], a[160:163], a[104:107], v[132:135]
M v[136:139], a[160:163], a[112:115], v[136:139]
M v[136:139], a[164:167], a[116:119], v[136:139]
M v[140:143], a[164:167], a[124:127], v[140:143]
 buffer_load_dwordx4 v15, s[48:51], s22 offen offset:3072   lds
M v[140:143], a[160:163], a[120:123], v[140:143]
 s_add_u32 s22, s22, 2097152
 ds_read_b64_tr_b16 a[76:77], v2 offset:24576
 ds_read_b64_tr_b16 a[78:79], v2 offset:25600
M v[144:147], a[160:163], a[128:131], v[144:147]
M v[144:147], a[164:167], a[132:135], v[144:147]
M v[148:151], a[164:167], a[140:143], v[148:151]
M v[148:151], a[160:163], a[136:139], v[148:151]
 s_add_u32 m0, s23, 0
M v[152:155], a[160:163], a[144:147], v[152:155]
 buffer_load_dwordx4 v8, s[16:19], s21 offen offset:0  nt lds
M v[152:155], a[164:167], a[148:151], v[152:155]
 s_waitcnt lgkmcnt(4)
M v[156:159], a[164:167], a[156:159], v[156:159]
 ds_read_b64_tr_b16 a[80:81], v3 offset:16384
 ds_read_b64_tr_b16 a[82:83], v3 offset:17408
M v[156:159], a[160:163], a[152:155], v[156:159]
M v[188:191], a[168:171], a[152:155], v[188:191]
 ds_read_b128 a[160:163], v5 offset:53248
 ds_read_b128 a[164:167], v6 offset:53248
M v[188:191], a[172:175], a[156:159], v[188:191]
M v[184:187], a[172:175], a[148:151], v[184:187]
 buffer_load_dwordx4 v9, s[16:19], s21 offen offset:1024  nt lds
M v[184:187], a[168:171], a[144:147], v[184:187]
M v[180:183], a[168:171], a[136:139], v[180:183]
M v[180:183], a[172:175], a[140:143], v[180:183]
 ds_read_b64_tr_b16 a[84:85], v3 offset:24576
 ds_read_b64_tr_b16 a[86:87], v3 offset:25600
M v[176:179], a[172:175], a[132:135], v[176:179]
M v[176:179], a[168:171], a[128:131], v[176:179]
M v[172:175], a[168:171], a[120:123], v[172:175]
M v[172:175], a[172:175], a[124:127], v[172:175]
 buffer_load_dwordx4 v10, s[16:19], s21 offen offset:2048  nt lds
M v[168:171], a[172:175], a[116:119], v[168:171]
M v[168:171], a[168:171], a[112:115], v[168:171]
M v[164:167], a[168:171], a[104:107], v[164:167]
 ds_read_b64_tr_b16 a[88:89], v4 offset:16384
 ds_read_b64_tr_b16 a[90:91], v4 offset:17408
M v[164:167], a[172:175], a[108:111], v[164:167]
 s_waitcnt lgkmcnt(4)
M v[160:163], a[172:175], a[100:103], v[160:163]
M v[160:163], a[168:171], a[96:99], v[160:163]
 buffer_load_dwordx4 v11, s[16:19], s21 offen offset:3072  nt lds
M v[192:195], a[160:163], a[96:99], v[192:195]
 s_add_u32 s21, s21, 128
 ds_read_b128 a[168:171], v5 offset:55296
 ds_read_b128 a[172:175], v6 offset:55296
M v[192:195], a[164:167], a[100:103], v[192:195]
M v[196:199], a[164:167], a[108:111], v[196:199]
M v[196:199], a[160:163], a[104:107], v[196:199]
 ds_read_b64_tr_b16 a[92:93], v4 offset:24576
 ds_read_b64_tr_b16 a[94:95], v4 offset:25600
M v[200:203], a[160:163], a[112:115], v[200:203]
 s_add_u32 m0, s87, 3072
M v[200:203], a[164:167], a[116:119], v[200:203]
 buffer_load_dwordx4 v25, s[60:63], s89 offen offset:0 nt lds
M v[204:207], a[164:167], a[124:127], v[204:207]
 s_add_u32 s89, s89, 114688
M v[204:207], a[160:163], a[120:123], v[204:207]
M v[208:211], a[160:163], a[128:131], v[208:211]
M v[208:211], a[164:167], a[132:135], v[208:211]
M v[212:215], a[164:167], a[140:143], v[212:215]
M v[212:215], a[160:163], a[136:139], v[212:215]
M v[216:219], a[160:163], a[144:147], v[216:219]
M v[216:219], a[164:167], a[148:151], v[216:219]
 s_waitcnt lgkmcnt(2)
M v[220:223], a[164:167], a[156:159], v[220:223]
 s_waitcnt vmcnt(20) lgkmcnt(0)
M v[220:223], a[160:163], a[152:155], v[220:223]
 s_barrier
M v[252:255], a[168:171], a[152:155], v[252:255]
 ds_read_b128 a[160:163], v5 offset:0
 ds_read_b128 a[164:167], v6 offset:0
M v[252:255], a[172:175], a[156:159], v[252:255]
M v[248:251], a[172:175], a[148:151], v[248:251]
M v[248:251], a[168:171], a[144:147], v[248:251]
M v[244:247], a[168:171], a[136:139], v[244:247]
M v[244:247], a[172:175], a[140:143], v[244:247]
M v[240:243], a[172:175], a[132:135], v[240:243]
M v[240:243], a[168:171], a[128:131], v[240:243]
M v[236:239], a[168:171], a[120:123], v[236:239]
M v[236:239], a[172:175], a[124:127], v[236:239]
M v[232:235], a[172:175], a[116:119], v[232:235]
M v[232:235], a[168:171], a[112:115], v[232:235]
M v[228:231], a[168:171], a[104:107], v[228:231]
M v[228:231], a[172:175], a[108:111], v[228:231]
 s_waitcnt lgkmcnt(0)
M v[224:227], a[172:175], a[100:103], v[224:227]
M v[224:227], a[168:171], a[96:99], v[224:227]
M a[0:3], a[160:163], a[32:35], a[0:3]
 ds_read_b128 a[168:171], v5 offset:2048
 ds_read_b128 a[172:175], v6 offset:2048
M a[0:3], a[164:167], a[36:39], a[0:3]
 ds_read_b64_tr_b16 a[96:97], v1 offset:32768
 ds_read_b64_tr_b16 a[98:99], v1 offset:33792
M a[4:7], a[164:167], a[44:47], a[4:7]
 s_add_u32 m0, s24, 49152
M a[4:7], a[160:163], a[40:43], a[4:7]
 buffer_load_dwordx4 v12, s[48:51], s22 offen offset:0   lds
M a[8:11], a[160:163], a[48:51], a[8:11]
M a[8:11], a[164:167], a[52:55], a[8:11]
M a[12:15], a[164:167], a[60:63], a[12:15]
 ds_read_b64_tr_b16 a[100:101], v1 offset:40960
 ds_read_b64_tr_b16 a[102:103], v1 offset:41984
M a[12:15], a[160:163], a[56:59], a[12:15]
M a[16:19], a[160:163], a[64:67], a[16:19]
 buffer_load_dwordx4 v13, s[48:51], s22 offen offset:1024   lds
M a[16:19], a[164:167], a[68:71], a[16:19]
M a[20:23], a[164:167], a[76:79], a[20:23]
M a[20:23], a[160:163], a[72:75], a[20:23]
 ds_read_b64_tr_b16 a[104:105], v2 offset:32768
 ds_read_b64_tr_b16 a[106:107], v2 offset:33792
M a[24:27], a[160:163], a[80:83], a[24:27]
M a[24:27], a[164:167], a[84:87], a[24:27]
 s_waitcnt lgkmcnt(6)
M a[28:31], a[164:167], a[92:95], a[28:31]
 buffer_load_dwordx4 v14, s[48:51], s22 offen offset:2048   lds
M a[28:31], a[160:163], a[88:91], a[28:31]
M v[60:63], a[168:171], a[88:91], v[60:63]
 ds_read_b128 a[160:163], v5 offset:4096
 ds_read_b128 a[164:167], v6 offset:4096
M v[60:63], a[172:175], a[92:95], v[60:63]
 ds_read_b64_tr_b16 a[108:109], v2 offset:40960
 ds_read_b64_tr_b16 a[110:111], v2 offset:41984
M v[56:59], a[172:175], a[84:87], v[56:59]
 buffer_load_dwordx4 v15, s[48:51], s22 offen offset:3072   lds
M v[56:59], a[168:171], a[80:83], v[56:59]
 s_sub_u32 s22, s22, 2097024
M v[52:55], a[168:171], a[72:75], v[52:55]
M v[52:55], a[172:175], a[76:79], v[52:55]
 ds_read_b64_tr_b16 a[112:113], v3 offset:32768
 ds_read_b64_tr_b16 a[114:115], v3 offset:33792
M v[48:51], a[172:175], a[68:71], v[48:51]
 s_add_u32 m0, s23, 16384
M v[48:51], a[168:171], a[64:67], v[48:51]
 buffer_load_dwordx4 v8, s[16:19], s21 offen offset:0  nt lds
M v[44:47], a[168:171], a[56:59], v[44:47]
M v[44:47], a[172:175], a[60:63], v[44:47]
M v[40:43], a[172:175], a[52:55], v[40:43]
 ds_read_b64_tr_b16 a[116:117], v3 offset:40960
 ds_read_b64_tr_b16 a[118:119], v3 offset:41984
M v[40:43], a[168:171], a[48:51], v[40:43]
M v[36:39], a[168:171], a[40:43], v[36:39]
 buffer_load_dwordx4 v9, s[16:19], s21 offen offset:1024  nt lds
M v[36:39], a[172:175], a[44:47], v[36:39]
 s_waitcnt lgkmcnt(6)
M v[32:35], a[172:175], a[36:39], v[32:35]
M v[32:35], a[168:171], a[32:35], v[32:35]
 ds_read_b64_tr_b16 a[120:121], v4 offset:32768
 ds_read_b64_tr_b16 a[122:123], v4 offset:33792
M v[64:67], a[160:163], a[32:35], v[64:67]
 ds_read_b128 a[168:171], v5 offset:6144
 ds_read_b128 a[172:175], v6 offset:6144
M v[64:67], a[164:167], a[36:39], v[64:67]
 buffer_load_dwordx4 v10, s[16:19], s21 offen offset:2048  nt lds
M v[68:71], a[164:167], a[44:47], v[68:71]
M v[68:71], a[160:163], a[40:43], v[68:71]
M v[72:75], a[160:163], a[48:51], v[72:75]
 ds_read_b64_tr_b16 a[124:125], v4 offset:40960
 ds_read_b64_tr_b16 a[126:127], v4 offset:41984
M v[72:75], a[164:167], a[52:55], v[72:75]
M v[76:79], a[164:167], a[60:63], v[76:79]
 buffer_load_dwordx4 v11, s[16:19], s21 offen offset:3072  nt lds
M v[76:79], a[160:163], a[56:59], v[76:79]
 s_add_u32 s21, s21, 524160
M v[80:83], a[160:163], a[64:67], v[80:83]
M v[80:83], a[164:167], a[68:71], v[80:83]
M v[84:87], a[164:167], a[76:79], v[84:87]
M v[84:87], a[160:163], a[72:75], v[84:87]
M v[88:91], a[160:163], a[80:83], v[88:91]
M v[88:91], a[164:167], a[84:87], v[88:91]
 s_waitcnt lgkmcnt(2)
M v[92:95], a[164:167], a[92:95], v[92:95]
 s_waitcnt vmcnt(17) lgkmcnt(0)
M v[92:95], a[160:163], a[88:91], v[92:95]
 s_barrier
M v[124:127], a[168:171], a[88:91], v[124:127]
 ds_read_b128 a[160:163], v5 offset:16384
 ds_read_b128 a[164:167], v6 offset:16384
M v[124:127], a[172:175], a[92:95], v[124:127]
M v[120:123], a[172:175], a[84:87], v[120:123]
 s_add_u32 m0, s24, 0
 ds_read_b64_tr_b16 a[128:129], v1 offset:49152
 ds_read_b64_tr_b16 a[130:131], v1 offset:50176
M v[120:123], a[168:171], a[80:83], v[120:123]
 buffer_load_dwordx4 v12, s[48:51], s22 offen offset:0   lds
M v[116:119], a[168:171], a[72:75], v[116:119]
M v[116:119], a[172:175], a[76:79], v[116:119]
M v[112:115], a[172:175], a[68:71], v[112:115]
M v[112:115], a[168:171], a[64:67], v[112:115]
M v[108:111], a[168:171], a[56:59], v[108:111]
M v[108:111], a[172:175], a[60:63], v[108:111]
 ds_read_b64_tr_b16 a[132:133], v1 offset:57344
 ds_read_b64_tr_b16 a[134:135], v1 offset:58368
M v[104:107], a[172:175], a[52:55], v[104:107]
 buffer_load_dwordx4 v13, s[48:51], s22 offen offset:1024   lds
M v[104:107], a[168:171], a[48:51], v[104:107]
M v[100:103], a[168:171], a[40:43], v[100:103]
M v[100:103], a[172:175], a[44:47], v[100:103]
 s_waitcnt lgkmcnt(4)
M v[96:99], a[172:175], a[36:39], v[96:99]
M v[96:99], a[168:171], a[32:35], v[96:99]
 buffer_load_dwordx4 v14, s[48:51], s22 offen offset:2048   lds
M v[128:131], a[160:163], a[32:35], v[128:131]
 ds_read_b128 a[168:171], v5 offset:18432
 ds_read_b128 a[172:175], v6 offset:18432
M v[128:131], a[164:167], a[36:39], v[128:131]
 ds_read_b64_tr_b16 a[136:137], v2 offset:49152
 ds_read_b64_tr_b16 a[138:139], v2 offset:50176
M v[132:135], a[164:167], a[44:47], v[132:135]
M v[132:135], a[160:163], a[40:43], v[132:135]
M v[136:139], a[160:163], a[48:51], v[136:139]
M v[136:139], a[164:167], a[52:55], v[136:139]
M v[140:143], a[164:167], a[60:63], v[140:143]
 buffer_load_dwordx4 v15, s[48:51], s22 offen offset:3072   lds
M v[140:143], a[160:163], a[56:59], v[140:143]
 s_add_u32 s22, s22, 2097152
 ds_read_b64_tr_b16 a[140:141], v2 offset:57344
 ds_read_b64_tr_b16 a[142:143], v2 offset:58368
M v[144:147], a[160:163], a[64:67], v[144:147]
M v[144:147], a[164:167], a[68:71], v[144:147]
M v[148:151], a[164:167], a[76:79], v[148:151]
M v[148:151], a[160:163], a[72:75], v[148:151]
 s_add_u32 m0, s23, 32768
M v[152:155], a[160:163], a[80:83], v[152:155]
 buffer_load_dwordx4 v8, s[16:19], s21 offen offset:0  nt lds
M v[152:155], a[164:167], a[84:87], v[152:155]
 s_waitcnt lgkmcnt(4)
M v[156:159], a[164:167], a[92:95], v[156:159]
 ds_read_b64_tr_b16 a[144:145], v3 offset:49152
 ds_read_b64_tr_b16 a[146:147], v3 offset:50176
M v[156:159], a[160:163], a[88:91], v[156:159]
M v[188:191], a[168:171], a[88:91], v[188:191]
 ds_read_b128 a[160:163], v5 offset:20480
 ds_read_b128 a[164:167], v6 offset:20480
M v[188:191], a[172:175], a[92:95], v[188:191]
M v[184:187], a[172:175], a[84:87], v[184:187]
 buffer_load_dwordx4 v9, s[16:19], s21 offen offset:1024  nt lds
M v[184:187], a[168:171], a[80:83], v[184:187]
M v[180:183], a[168:171], a[72:75], v[180:183]
M v[180:183], a[172:175], a[76:79], v[180:183]
 ds_read_b64_tr_b16 a[148:149], v3 offset:57344
 ds_read_b64_tr_b16 a[150:151], v3 offset:58368
M v[176:179], a[172:175], a[68:71], v[176:179]
M v[176:179], a[168:171], a[64:67], v[176:179]
M v[172:175], a[168:171], a[56:59], v[172:175]
M v[172:175], a[172:175], a[60:63], v[172:175]
 buffer_load_dwordx4 v10, s[16:19], s21 offen offset:2048  nt lds
M v[168:171], a[172:175], a[52:55], v[168:171]
M v[168:171], a[168:171], a[48:51], v[168:171]
M v[164:167], a[168:171], a[40:43], v[164:167]
 ds_read_b64_tr_b16 a[152:153], v4 offset:49152
 ds_read_b64_tr_b16 a[154:155], v4 offset:50176
M v[164:167], a[172:175], a[44:47], v[164:167]
 s_waitcnt lgkmcnt(4)
M v[160:163], a[172:175], a[36:39], v[160:163]
M v[160:163], a[168:171], a[32:35], v[160:163]
 buffer_load_dwordx4 v11, s[16:19], s21 offen offset:3072  nt lds
M v[192:195], a[160:163], a[32:35], v[192:195]
 s_add_u32 s21, s21, 128
 ds_read_b128 a[168:171], v5 offset:22528
 ds_read_b128 a[172:175], v6 offset:22528
M v[192:195], a[164:167], a[36:39], v[192:195]
M v[196:199], a[164:167], a[44:47], v[196:199]
M v[196:199], a[160:163], a[40:43], v[196:199]
 ds_read_b64_tr_b16 a[156:157], v4 offset:57344
 ds_read_b64_tr_b16 a[158:159], v4 offset:58368
M v[200:203], a[160:163], a[48:51], v[200:203]
 s_add_u32 m0, s87, 4096
M v[200:203], a[164:167], a[52:55], v[200:203]
 buffer_load_dwordx4 v25, s[60:63], s89 offen offset:0 nt lds
M v[204:207], a[164:167], a[60:63], v[204:207]
 s_add_u32 s89, s89, 114688
M v[204:207], a[160:163], a[56:59], v[204:207]
M v[208:211], a[160:163], a[64:67], v[208:211]
M v[208:211], a[164:167], a[68:71], v[208:211]
M v[212:215], a[164:167], a[76:79], v[212:215]
M v[212:215], a[160:163], a[72:75], v[212:215]
M v[216:219], a[160:163], a[80:83], v[216:219]
M v[216:219], a[164:167], a[84:87], v[216:219]
 s_waitcnt lgkmcnt(2)
M v[220:223], a[164:167], a[92:95], v[220:223]
 s_waitcnt vmcnt(18) lgkmcnt(0)
M v[220:223], a[160:163], a[88:91], v[220:223]
 s_barrier
M v[252:255], a[168:171], a[88:91], v[252:255]
 ds_read_b128 a[160:163], v5 offset:32768
 ds_read_b128 a[164:167], v6 offset:32768
M v[252:255], a[172:175], a[92:95], v[252:255]
 v_and_b32 v26, 48, v0
 v_lshlrev_b32 v26, 17, v26
M v[248:251], a[172:175], a[84:87], v[248:251]
 v_or_b32 v26, v26, v0
 v_lshl_add_u32 v26, v26, 7, s95
M v[248:251], a[168:171], a[80:83], v[248:251]
 buffer_load_dword a240, v26, s[76:79], 0 offen offset:0
M v[244:247], a[168:171], a[72:75], v[244:247]
M v[244:247], a[172:175], a[76:79], v[244:247]
M v[240:243], a[172:175], a[68:71], v[240:243]
M v[240:243], a[168:171], a[64:67], v[240:243]
M v[236:239], a[168:171], a[56:59], v[236:239]
M v[236:239], a[172:175], a[60:63], v[236:239]
M v[232:235], a[172:175], a[52:55], v[232:235]
M v[232:235], a[168:171], a[48:51], v[232:235]
M v[228:231], a[168:171], a[40:43], v[228:231]
M v[228:231], a[172:175], a[44:47], v[228:231]
 s_waitcnt lgkmcnt(0)
M v[224:227], a[172:175], a[36:39], v[224:227]
M v[224:227], a[168:171], a[32:35], v[224:227]
M a[0:3], a[160:163], a[96:99], a[0:3]
 ds_read_b128 a[168:171], v5 offset:34816
 ds_read_b128 a[172:175], v6 offset:34816
M a[0:3], a[164:167], a[100:103], a[0:3]
 ds_read_b64_tr_b16 a[32:33], v1 offset:0
 ds_read_b64_tr_b16 a[34:35], v1 offset:1024
M a[4:7], a[164:167], a[108:111], a[4:7]
 s_add_u32 m0, s24, 16384
M a[4:7], a[160:163], a[104:107], a[4:7]
 buffer_load_dwordx4 v12, s[48:51], s22 offen offset:0   lds
M a[8:11], a[160:163], a[112:115], a[8:11]
M a[8:11], a[164:167], a[116:119], a[8:11]
 s_lshl_b32 s67, s20, 11
M a[12:15], a[164:167], a[124:127], a[12:15]
 s_add_u32 s67, s67, 104914944
 ds_read_b64_tr_b16 a[36:37], v1 offset:8192
 ds_read_b64_tr_b16 a[38:39], v1 offset:9216
M a[12:15], a[160:163], a[120:123], a[12:15]
M a[16:19], a[160:163], a[128:131], a[16:19]
 buffer_load_dwordx4 v13, s[48:51], s22 offen offset:1024   lds
M a[16:19], a[164:167], a[132:135], a[16:19]
M a[20:23], a[164:167], a[140:143], a[20:23]
 buffer_load_dwordx4 v[16:19], v7, s[8:11], s67 offen offset:0 sc1
M a[20:23], a[160:163], a[136:139], a[20:23]
 ds_read_b64_tr_b16 a[40:41], v2 offset:0
 ds_read_b64_tr_b16 a[42:43], v2 offset:1024
M a[24:27], a[160:163], a[144:147], a[24:27]
 buffer_load_dwordx4 v[20:23], v7, s[8:11], s67 offen offset:1024 sc1
M a[24:27], a[164:167], a[148:151], a[24:27]
 s_waitcnt lgkmcnt(6)
M a[28:31], a[164:167], a[156:159], a[28:31]
 buffer_load_dwordx4 v14, s[48:51], s22 offen offset:2048   lds
M a[28:31], a[160:163], a[152:155], a[28:31]
M v[60:63], a[168:171], a[152:155], v[60:63]
 ds_read_b128 a[160:163], v5 offset:36864
 ds_read_b128 a[164:167], v6 offset:36864
M v[60:63], a[172:175], a[156:159], v[60:63]
 ds_read_b64_tr_b16 a[44:45], v2 offset:8192
 ds_read_b64_tr_b16 a[46:47], v2 offset:9216
M v[56:59], a[172:175], a[148:151], v[56:59]
 buffer_load_dwordx4 v15, s[48:51], s22 offen offset:3072   lds
M v[56:59], a[168:171], a[144:147], v[56:59]
 s_sub_u32 s22, s22, 2097024
M v[52:55], a[168:171], a[136:139], v[52:55]
M v[52:55], a[172:175], a[140:143], v[52:55]
 ds_read_b64_tr_b16 a[48:49], v3 offset:0
 ds_read_b64_tr_b16 a[50:51], v3 offset:1024
M v[48:51], a[172:175], a[132:135], v[48:51]
 s_add_u32 m0, s23, 49152
M v[48:51], a[168:171], a[128:131], v[48:51]
 buffer_load_dwordx4 v8, s[16:19], s21 offen offset:0  nt lds
M v[44:47], a[168:171], a[120:123], v[44:47]
M v[44:47], a[172:175], a[124:127], v[44:47]
M v[40:43], a[172:175], a[116:119], v[40:43]
 ds_read_b64_tr_b16 a[52:53], v3 offset:8192
 ds_read_b64_tr_b16 a[54:55], v3 offset:9216
M v[40:43], a[168:171], a[112:115], v[40:43]
M v[36:39], a[168:171], a[104:107], v[36:39]
 buffer_load_dwordx4 v9, s[16:19], s21 offen offset:1024  nt lds
M v[36:39], a[172:175], a[108:111], v[36:39]
 s_waitcnt lgkmcnt(6)
M v[32:35], a[172:175], a[100:103], v[32:35]
M v[32:35], a[168:171], a[96:99], v[32:35]
 ds_read_b64_tr_b16 a[56:57], v4 offset:0
 ds_read_b64_tr_b16 a[58:59], v4 offset:1024
M v[64:67], a[160:163], a[96:99], v[64:67]
 ds_read_b128 a[168:171], v5 offset:38912
 ds_read_b128 a[172:175], v6 offset:38912
M v[64:67], a[164:167], a[100:103], v[64:67]
 buffer_load_dwordx4 v10, s[16:19], s21 offen offset:2048  nt lds
M v[68:71], a[164:167], a[108:111], v[68:71]
M v[68:71], a[160:163], a[104:107], v[68:71]
M v[72:75], a[160:163], a[112:115], v[72:75]
 ds_read_b64_tr_b16 a[60:61], v4 offset:8192
 ds_read_b64_tr_b16 a[62:63], v4 offset:9216
M v[72:75], a[164:167], a[116:119], v[72:75]
M v[76:79], a[164:167], a[124:127], v[76:79]
 buffer_load_dwordx4 v11, s[16:19], s21 offen offset:3072  nt lds
M v[76:79], a[160:163], a[120:123], v[76:79]
 s_add_u32 s21, s21, 524160
M v[80:83], a[160:163], a[128:131], v[80:83]
M v[80:83], a[164:167], a[132:135], v[80:83]
M v[84:87], a[164:167], a[140:143], v[84:87]
M v[84:87], a[160:163], a[136:139], v[84:87]
M v[88:91], a[160:163], a[144:147], v[88:91]
M v[88:91], a[164:167], a[148:151], v[88:91]
 s_waitcnt lgkmcnt(2)
M v[92:95], a[164:167], a[156:159], v[92:95]
 s_waitcnt vmcnt(20) lgkmcnt(0)
M v[92:95], a[160:163], a[152:155], v[92:95]
 s_barrier
M v[124:127], a[168:171], a[152:155], v[124:127]
 ds_read_b128 a[160:163], v5 offset:49152
 ds_read_b128 a[164:167], v6 offset:49152
M v[124:127], a[172:175], a[156:159], v[124:127]
M v[120:123], a[172:175], a[148:151], v[120:123]
 s_add_u32 m0, s24, 32768
 ds_read_b64_tr_b16 a[64:65], v1 offset:16384
 ds_read_b64_tr_b16 a[66:67], v1 offset:17408
M v[120:123], a[168:171], a[144:147], v[120:123]
 buffer_load_dwordx4 v12, s[48:51], s22 offen offset:0   lds
M v[116:119], a[168:171], a[136:139], v[116:119]
M v[116:119], a[172:175], a[140:143], v[116:119]
M v[112:115], a[172:175], a[132:135], v[112:115]
M v[112:115], a[168:171], a[128:131], v[112:115]
M v[108:111], a[168:171], a[120:123], v[108:111]
M v[108:111], a[172:175], a[124:127], v[108:111]
 ds_read_b64_tr_b16 a[68:69], v1 offset:24576
 ds_read_b64_tr_b16 a[70:71], v1 offset:25600
M v[104:107], a[172:175], a[116:119], v[104:107]
 buffer_load_dwordx4 v13, s[48:51], s22 offen offset:1024   lds
M v[104:107], a[168:171], a[112:115], v[104:107]
M v[100:103], a[168:171], a[104:107], v[100:103]
M v[100:103], a[172:175], a[108:111], v[100:103]
 s_waitcnt lgkmcnt(4)
M v[96:99], a[172:175], a[100:103], v[96:99]
M v[96:99], a[168:171], a[96:99], v[96:99]
 buffer_load_dwordx4 v14, s[48:51], s22 offen offset:2048   lds
M v[128:131], a[160:163], a[96:99], v[128:131]
 ds_read_b128 a[168:171], v5 offset:51200
 ds_read_b128 a[172:175], v6 offset:51200
M v[128:131], a[164:167], a[100:103], v[128:131]
 ds_read_b64_tr_b16 a[72:73], v2 offset:16384
 ds_read_b64_tr_b16 a[74:75], v2 offset:17408
M v[132:135], a[164:167], a[108:111], v[132:135]
M v[132:135], a[160:163], a[104:107], v[132:135]
M v[136:139], a[160:163], a[112:115], v[136:139]
M v[136:139], a[164:167], a[116:119], v[136:139]
M v[140:143], a[164:167], a[124:127], v[140:143]
 buffer_load_dwordx4 v15, s[48:51], s22 offen offset:3072   lds
M v[140:143], a[160:163], a[120:123], v[140:143]
 s_add_u32 s22, s22, 2097152
 ds_read_b64_tr_b16 a[76:77], v2 offset:24576
 ds_read_b64_tr_b16 a[78:79], v2 offset:25600
M v[144:147], a[160:163], a[128:131], v[144:147]
M v[144:147], a[164:167], a[132:135], v[144:147]
M v[148:151], a[164:167], a[140:143], v[148:151]
M v[148:151], a[160:163], a[136:139], v[148:151]
 s_add_u32 m0, s23, 0
M v[152:155], a[160:163], a[144:147], v[152:155]
 buffer_load_dwordx4 v8, s[16:19], s21 offen offset:0  nt lds
M v[152:155], a[164:167], a[148:151], v[152:155]
 s_waitcnt lgkmcnt(4)
M v[156:159], a[164:167], a[156:159], v[156:159]
 ds_read_b64_tr_b16 a[80:81], v3 offset:16384
 ds_read_b64_tr_b16 a[82:83], v3 offset:17408
M v[156:159], a[160:163], a[152:155], v[156:159]
M v[188:191], a[168:171], a[152:155], v[188:191]
 ds_read_b128 a[160:163], v5 offset:53248
 ds_read_b128 a[164:167], v6 offset:53248
M v[188:191], a[172:175], a[156:159], v[188:191]
M v[184:187], a[172:175], a[148:151], v[184:187]
 buffer_load_dwordx4 v9, s[16:19], s21 offen offset:1024  nt lds
M v[184:187], a[168:171], a[144:147], v[184:187]
M v[180:183], a[168:171], a[136:139], v[180:183]
M v[180:183], a[172:175], a[140:143], v[180:183]
 ds_read_b64_tr_b16 a[84:85], v3 offset:24576
 ds_read_b64_tr_b16 a[86:87], v3 offset:25600
M v[176:179], a[172:175], a[132:135], v[176:179]
M v[176:179], a[168:171], a[128:131], v[176:179]
M v[172:175], a[168:171], a[120:123], v[172:175]
M v[172:175], a[172:175], a[124:127], v[172:175]
 buffer_load_dwordx4 v10, s[16:19], s21 offen offset:2048  nt lds
M v[168:171], a[172:175], a[116:119], v[168:171]
M v[168:171], a[168:171], a[112:115], v[168:171]
M v[164:167], a[168:171], a[104:107], v[164:167]
 ds_read_b64_tr_b16 a[88:89], v4 offset:16384
 ds_read_b64_tr_b16 a[90:91], v4 offset:17408
M v[164:167], a[172:175], a[108:111], v[164:167]
 s_waitcnt lgkmcnt(4)
M v[160:163], a[172:175], a[100:103], v[160:163]
M v[160:163], a[168:171], a[96:99], v[160:163]
 buffer_load_dwordx4 v11, s[16:19], s21 offen offset:3072  nt lds
M v[192:195], a[160:163], a[96:99], v[192:195]
 s_add_u32 s21, s21, 128
 ds_read_b128 a[168:171], v5 offset:55296
 ds_read_b128 a[172:175], v6 offset:55296
M v[192:195], a[164:167], a[100:103], v[192:195]
M v[196:199], a[164:167], a[108:111], v[196:199]
M v[196:199], a[160:163], a[104:107], v[196:199]
 ds_read_b64_tr_b16 a[92:93], v4 offset:24576
 ds_read_b64_tr_b16 a[94:95], v4 offset:25600
M v[200:203], a[160:163], a[112:115], v[200:203]
 s_add_u32 m0, s87, 5120
M v[200:203], a[164:167], a[116:119], v[200:203]
 buffer_load_dwordx4 v25, s[60:63], s89 offen offset:0 nt lds
M v[204:207], a[164:167], a[124:127], v[204:207]
 s_add_u32 s89, s89, 114688
M v[204:207], a[160:163], a[120:123], v[204:207]
M v[208:211], a[160:163], a[128:131], v[208:211]
M v[208:211], a[164:167], a[132:135], v[208:211]
M v[212:215], a[164:167], a[140:143], v[212:215]
M v[212:215], a[160:163], a[136:139], v[212:215]
M v[216:219], a[160:163], a[144:147], v[216:219]
M v[216:219], a[164:167], a[148:151], v[216:219]
 s_waitcnt lgkmcnt(2)
M v[220:223], a[164:167], a[156:159], v[220:223]
 s_waitcnt vmcnt(21) lgkmcnt(0)
M v[220:223], a[160:163], a[152:155], v[220:223]
 s_barrier
M v[252:255], a[168:171], a[152:155], v[252:255]
 ds_read_b128 a[160:163], v5 offset:0
 ds_read_b128 a[164:167], v6 offset:0
M v[252:255], a[172:175], a[156:159], v[252:255]
M v[248:251], a[172:175], a[148:151], v[248:251]
M v[248:251], a[168:171], a[144:147], v[248:251]
M v[244:247], a[168:171], a[136:139], v[244:247]
M v[244:247], a[172:175], a[140:143], v[244:247]
M v[240:243], a[172:175], a[132:135], v[240:243]
M v[240:243], a[168:171], a[128:131], v[240:243]
M v[236:239], a[168:171], a[120:123], v[236:239]
M v[236:239], a[172:175], a[124:127], v[236:239]
M v[232:235], a[172:175], a[116:119], v[232:235]
M v[232:235], a[168:171], a[112:115], v[232:235]
M v[228:231], a[168:171], a[104:107], v[228:231]
M v[228:231], a[172:175], a[108:111], v[228:231]
 s_waitcnt lgkmcnt(0)
M v[224:227], a[172:175], a[100:103], v[224:227]
M v[224:227], a[168:171], a[96:99], v[224:227]
M a[0:3], a[160:163], a[32:35], a[0:3]
 ds_read_b128 a[168:171], v5 offset:2048
 ds_read_b128 a[172:175], v6 offset:2048
M a[0:3], a[164:167], a[36:39], a[0:3]
 ds_read_b64_tr_b16 a[96:97], v1 offset:32768
 ds_read_b64_tr_b16 a[98:99], v1 offset:33792
M a[4:7], a[164:167], a[44:47], a[4:7]
 s_add_u32 m0, s24, 49152
M a[4:7], a[160:163], a[40:43], a[4:7]
 buffer_load_dwordx4 v12, s[48:51], s22 offen offset:0   lds
M a[8:11], a[160:163], a[48:51], a[8:11]
M a[8:11], a[164:167], a[52:55], a[8:11]
M a[12:15], a[164:167], a[60:63], a[12:15]
 ds_read_b64_tr_b16 a[100:101], v1 offset:40960
 ds_read_b64_tr_b16 a[102:103], v1 offset:41984
M a[12:15], a[160:163], a[56:59], a[12:15]
M a[16:19], a[160:163], a[64:67], a[16:19]
 buffer_load_dwordx4 v13, s[48:51], s22 offen offset:1024   lds
M a[16:19], a[164:167], a[68:71], a[16:19]
M a[20:23], a[164:167], a[76:79], a[20:23]
 s_waitcnt vmcnt(18)
 v_min3_u32 v28, v16, v17, v18
M a[20:23], a[160:163], a[72:75], a[20:23]
 ds_read_b64_tr_b16 a[104:105], v2 offset:32768
 ds_read_b64_tr_b16 a[106:107], v2 offset:33792
M a[24:27], a[160:163], a[80:83], a[24:27]
 s_waitcnt vmcnt(17)
 v_min3_u32 v28, v28, v19, v20
M a[24:27], a[164:167], a[84:87], a[24:27]
 s_waitcnt lgkmcnt(6)
 v_min3_u32 v28, v28, v21, v22
M a[28:31], a[164:167], a[92:95], a[28:31]
 buffer_load_dwordx4 v14, s[48:51], s22 offen offset:2048   lds
M a[28:31], a[160:163], a[88:91], a[28:31]
 v_min_u32 v28, v28, v23
M v[60:63], a[168:171], a[88:91], v[60:63]
 ds_read_b128 a[160:163], v5 offset:4096
 ds_read_b128 a[164:167], v6 offset:4096
M v[60:63], a[172:175], a[92:95], v[60:63]
 ds_read_b64_tr_b16 a[108:109], v2 offset:40960
 ds_read_b64_tr_b16 a[110:111], v2 offset:41984
M v[56:59], a[172:175], a[84:87], v[56:59]
 buffer_load_dwordx4 v15, s[48:51], s22 offen offset:3072   lds
M v[56:59], a[168:171], a[80:83], v[56:59]
 s_sub_u32 s22, s22, 2097024
 v_cmp_eq_u32 vcc, 0, v28
M v[52:55], a[168:171], a[72:75], v[52:55]
 s_nop 0
M v[52:55], a[172:175], a[76:79], v[52:55]
 s_cbranch_vccnz L_hs
L_hr:
 ds_read_b64_tr_b16 a[112:113], v3 offset:32768
 ds_read_b64_tr_b16 a[114:115], v3 offset:33792
M v[48:51], a[172:175], a[68:71], v[48:51]
 s_add_u32 m0, s23, 16384
 v_max_u32 v28, v16, v17
M v[48:51], a[168:171], a[64:67], v[48:51]
 buffer_load_dwordx4 v8, s[16:19], s21 offen offset:0  nt lds
M v[44:47], a[168:171], a[56:59], v[44:47]
 v_min_u32 v29, v16, v17
M v[44:47], a[172:175], a[60:63], v[44:47]
 v_med3_u32 v29, v28, v29, v18
M v[40:43], a[172:175], a[52:55], v[40:43]
 ds_read_b64_tr_b16 a[116:117], v3 offset:40960
 ds_read_b64_tr_b16 a[118:119], v3 offset:41984
M v[40:43], a[168:171], a[48:51], v[40:43]
 v_max_u32 v28, v28, v18
M v[36:39], a[168:171], a[40:43], v[36:39]
 buffer_load_dwordx4 v9, s[16:19], s21 offen offset:1024  nt lds
M v[36:39], a[172:175], a[44:47], v[36:39]
 s_waitcnt lgkmcnt(6)
 v_med3_u32 v29, v28, v29, v19
M v[32:35], a[172:175], a[36:39], v[32:35]
 v_max_u32 v28, v28, v19
M v[32:35], a[168:171], a[32:35], v[32:35]
 ds_read_b64_tr_b16 a[120:121], v4 offset:32768
 ds_read_b64_tr_b16 a[122:123], v4 offset:33792
M v[64:67], a[160:163], a[32:35], v[64:67]
 ds_read_b128 a[168:171], v5 offset:6144
 ds_read_b128 a[172:175], v6 offset:6144
M v[64:67], a[164:167], a[36:39], v[64:67]
 buffer_load_dwordx4 v10, s[16:19], s21 offen offset:2048  nt lds
M v[68:71], a[164:167], a[44:47], v[68:71]
 v_med3_u32 v29, v28, v29, v20
M v[68:71], a[160:163], a[40:43], v[68:71]
 v_max_u32 v28, v28, v20
M v[72:75], a[160:163], a[48:51], v[72:75]
 ds_read_b64_tr_b16 a[124:125], v4 offset:40960
 ds_read_b64_tr_b16 a[126:127], v4 offset:41984
M v[72:75], a[164:167], a[52:55], v[72:75]
 v_med3_u32 v29, v28, v29, v21
M v[76:79], a[164:167], a[60:63], v[76:79]
 buffer_load_dwordx4 v11, s[16:19], s21 offen offset:3072  nt lds
M v[76:79], a[160:163], a[56:59], v[76:79]
 s_add_u32 s21, s21, 524160
 v_max_u32 v28, v28, v21
M v[80:83], a[160:163], a[64:67], v[80:83]
 v_med3_u32 v29, v28, v29, v22
M v[80:83], a[164:167], a[68:71], v[80:83]
 v_max_u32 v28, v28, v22
M v[84:87], a[164:167], a[76:79], v[84:87]
 v_med3_u32 v29, v28, v29, v23
M v[84:87], a[160:163], a[72:75], v[84:87]
 v_max_u32 v28, v28, v23
M v[88:91], a[160:163], a[80:83], v[88:91]
 s_nop 0
 v_mov_b32 v30, v28 row_ror:8 row_mask:0xf bank_mask:0xf
M v[88:91], a[164:167], a[84:87], v[88:91]
 s_waitcnt lgkmcnt(2)
 v_mov_b32 v31, v29 row_ror:8 row_mask:0xf bank_mask:0xf
M v[92:95], a[164:167], a[92:95], v[92:95]
 s_waitcnt vmcnt(17) lgkmcnt(0)
 v_min_u32 v16, v28, v30
M v[92:95], a[160:163], a[88:91], v[92:95]
 s_barrier
M v[124:127], a[168:171], a[88:91], v[124:127]
 ds_read_b128 a[160:163], v5 offset:16384
 ds_read_b128 a[164:167], v6 offset:16384
M v[124:127], a[172:175], a[92:95], v[124:127]
 v_max_u32 v28, v28, v30
M v[120:123], a[172:175], a[84:87], v[120:123]
 s_add_u32 m0, s24, 0
 ds_read_b64_tr_b16 a[128:129], v1 offset:49152
 ds_read_b64_tr_b16 a[130:131], v1 offset:50176
M v[120:123], a[168:171], a[80:83], v[120:123]
 buffer_load_dwordx4 v12, s[48:51], s22 offen offset:0   lds
M v[116:119], a[168:171], a[72:75], v[116:119]
 v_max3_u32 v29, v29, v31, v16
M v[116:119], a[172:175], a[76:79], v[116:119]
 v_mov_b32 v30, v28 row_ror:4 row_mask:0xf bank_mask:0xf
M v[112:115], a[172:175], a[68:71], v[112:115]
 v_mov_b32 v31, v29 row_ror:4 row_mask:0xf bank_mask:0xf
M v[112:115], a[168:171], a[64:67], v[112:115]
 v_min_u32 v16, v28, v30
M v[108:111], a[168:171], a[56:59], v[108:111]
 v_max_u32 v28, v28, v30
M v[108:111], a[172:175], a[60:63], v[108:111]
 ds_read_b64_tr_b16 a[132:133], v1 offset:57344
 ds_read_b64_tr_b16 a[134:135], v1 offset:58368
M v[104:107], a[172:175], a[52:55], v[104:107]
 buffer_load_dwordx4 v13, s[48:51], s22 offen offset:1024   lds
M v[104:107], a[168:171], a[48:51], v[104:107]
 v_max3_u32 v29, v29, v31, v16
M v[100:103], a[168:171], a[40:43], v[100:103]
 v_mov_b32 v30, v28 row_ror:2 row_mask:0xf bank_mask:0xf
M v[100:103], a[172:175], a[44:47], v[100:103]
 s_waitcnt lgkmcnt(4)
 v_mov_b32 v31, v29 row_ror:2 row_mask:0xf bank_mask:0xf
M v[96:99], a[172:175], a[36:39], v[96:99]
 v_min_u32 v16, v28, v30
M v[96:99], a[168:171], a[32:35], v[96:99]
 buffer_load_dwordx4 v14, s[48:51], s22 offen offset:2048   lds
M v[128:131], a[160:163], a[32:35], v[128:131]
 ds_read_b128 a[168:171], v5 offset:18432
 ds_read_b128 a[172:175], v6 offset:18432
M v[128:131], a[164:167], a[36:39], v[128:131]
 ds_read_b64_tr_b16 a[136:137], v2 offset:49152
 ds_read_b64_tr_b16 a[138:139], v2 offset:50176
M v[132:135], a[164:167], a[44:47], v[132:135]
 v_max_u32 v28, v28, v30
M v[132:135], a[160:163], a[40:43], v[132:135]
 v_max3_u32 v29, v29, v31, v16
M v[136:139], a[160:163], a[48:51], v[136:139]
 v_mov_b32 v30, v28 row_ror:1 row_mask:0xf bank_mask:0xf
M v[136:139], a[164:167], a[52:55], v[136:139]
 v_mov_b32 v31, v29 row_ror:1 row_mask:0xf bank_mask:0xf
M v[140:143], a[164:167], a[60:63], v[140:143]
 buffer_load_dwordx4 v15, s[48:51], s22 offen offset:3072   lds
M v[140:143], a[160:163], a[56:59], v[140:143]
 s_add_u32 s22, s22, 2097152
 ds_read_b64_tr_b16 a[140:141], v2 offset:57344
 ds_read_b64_tr_b16 a[142:143], v2 offset:58368
M v[144:147], a[160:163], a[64:67], v[144:147]
 v_min_u32 v16, v28, v30
M v[144:147], a[164:167], a[68:71], v[144:147]
 v_max_u32 v28, v28, v30
M v[148:151], a[164:167], a[76:79], v[148:151]
 v_max3_u32 v29, v29, v31, v16
M v[148:151], a[160:163], a[72:75], v[148:151]
 s_add_u32 m0, s23, 32768
 v_mov_b32 v30, v28
M v[152:155], a[160:163], a[80:83], v[152:155]
 buffer_load_dwordx4 v8, s[16:19], s21 offen offset:0  nt lds
M v[152:155], a[164:167], a[84:87], v[152:155]
 s_waitcnt lgkmcnt(4)
 v_mov_b32 v31, v29
M v[156:159], a[164:167], a[92:95], v[156:159]
 ds_read_b64_tr_b16 a[144:145], v3 offset:49152
 ds_read_b64_tr_b16 a[146:147], v3 offset:50176
M v[156:159], a[160:163], a[88:91], v[156:159]
 v_permlane16_swap_b32 v30, v28
M v[188:191], a[168:171], a[88:91], v[188:191]
 ds_read_b128 a[160:163], v5 offset:20480
 ds_read_b128 a[164:167], v6 offset:20480
M v[188:191], a[172:175], a[92:95], v[188:191]
 v_permlane16_swap_b32 v31, v29
M v[184:187], a[172:175], a[84:87], v[184:187]
 buffer_load_dwordx4 v9, s[16:19], s21 offen offset:1024  nt lds
M v[184:187], a[168:171], a[80:83], v[184:187]
 v_min_u32 v16, v28, v30
M v[180:183], a[168:171], a[72:75], v[180:183]
 v_max_u32 v28, v28, v30
M v[180:183], a[172:175], a[76:79], v[180:183]
 ds_read_b64_tr_b16 a[148:149], v3 offset:57344
 ds_read_b64_tr_b16 a[150:151], v3 offset:58368
M v[176:179], a[172:175], a[68:71], v[176:179]
 v_max3_u32 v29, v29, v31, v16
M v[176:179], a[168:171], a[64:67], v[176:179]
 v_mov_b32 v30, v28
M v[172:175], a[168:171], a[56:59], v[172:175]
 v_mov_b32 v31, v29
M v[172:175], a[172:175], a[60:63], v[172:175]
 buffer_load_dwordx4 v10, s[16:19], s21 offen offset:2048  nt lds
M v[168:171], a[172:175], a[52:55], v[168:171]
 v_permlane32_swap_b32 v30, v28
M v[168:171], a[168:171], a[48:51], v[168:171]
 v_permlane32_swap_b32 v31, v29
M v[164:167], a[168:171], a[40:43], v[164:167]
 ds_read_b64_tr_b16 a[152:153], v4 offset:49152
 ds_read_b64_tr_b16 a[154:155], v4 offset:50176
M v[164:167], a[172:175], a[44:47], v[164:167]
 s_waitcnt lgkmcnt(4)
 v_min_u32 v16, v28, v30
M v[160:163], a[172:175], a[36:39], v[160:163]
 v_max_u32 v28, v28, v30
M v[160:163], a[168:171], a[32:35], v[160:163]
 buffer_load_dwordx4 v11, s[16:19], s21 offen offset:3072  nt lds
M v[192:195], a[160:163], a[32:35], v[192:195]
 s_add_u32 s21, s21, 128
 ds_read_b128 a[168:171], v5 offset:22528
 ds_read_b128 a[172:175], v6 offset:22528
M v[192:195], a[164:167], a[36:39], v[192:195]
 v_max3_u32 v29, v29, v31, v16
M v[196:199], a[164:167], a[44:47], v[196:199]
 s_lshl_b32 s64, s20, 3
M v[196:199], a[160:163], a[40:43], v[196:199]
 s_add_u32 s64, s64, 159744
 ds_read_b64_tr_b16 a[156:157], v4 offset:57344
 ds_read_b64_tr_b16 a[158:159], v4 offset:58368
M v[200:203], a[160:163], a[48:51], v[200:203]
 s_add_u32 m0, s87, 6144
 v_mov_b32 v16, s64
M v[200:203], a[164:167], a[52:55], v[200:203]
 buffer_load_dwordx4 v25, s[60:63], s89 offen offset:0 nt lds
M v[204:207], a[164:167], a[60:63], v[204:207]
 s_add_u32 s89, s89, 114688
 ds_write_b64 v16, v[28:29]
M v[204:207], a[160:163], a[56:59], v[204:207]
M v[208:211], a[160:163], a[64:67], v[208:211]
M v[208:211], a[164:167], a[68:71], v[208:211]
M v[212:215], a[164:167], a[76:79], v[212:215]
M v[212:215], a[160:163], a[72:75], v[212:215]
M v[216:219], a[160:163], a[80:83], v[216:219]
M v[216:219], a[164:167], a[84:87], v[216:219]
 s_waitcnt lgkmcnt(3)
M v[220:223], a[164:167], a[92:95], v[220:223]
 s_waitcnt vmcnt(18) lgkmcnt(0)
M v[220:223], a[160:163], a[88:91], v[220:223]
 s_barrier
M v[252:255], a[168:171], a[88:91], v[252:255]
 ds_read_b128 a[160:163], v5 offset:32768
 ds_read_b128 a[164:167], v6 offset:32768
M v[252:255], a[172:175], a[92:95], v[252:255]
 buffer_load_dword a240, v24, s[32:35], 0 offen offset:1536
M v[248:251], a[172:175], a[84:87], v[248:251]
M v[248:251], a[168:171], a[80:83], v[248:251]
M v[244:247], a[168:171], a[72:75], v[244:247]
M v[244:247], a[172:175], a[76:79], v[244:247]
M v[240:243], a[172:175], a[68:71], v[240:243]
M v[240:243], a[168:171], a[64:67], v[240:243]
M v[236:239], a[168:171], a[56:59], v[236:239]
M v[236:239], a[172:175], a[60:63], v[236:239]
M v[232:235], a[172:175], a[52:55], v[232:235]
M v[232:235], a[168:171], a[48:51], v[232:235]
M v[228:231], a[168:171], a[40:43], v[228:231]
M v[228:231], a[172:175], a[44:47], v[228:231]
 s_waitcnt lgkmcnt(0)
M v[224:227], a[172:175], a[36:39], v[224:227]
M v[224:227], a[168:171], a[32:35], v[224:227]
M a[0:3], a[160:163], a[96:99], a[0:3]
 ds_read_b128 a[168:171], v5 offset:34816
 ds_read_b128 a[172:175], v6 offset:34816
M a[0:3], a[164:167], a[100:103], a[0:3]
 ds_read_b64_tr_b16 a[32:33], v1 offset:0
 ds_read_b64_tr_b16 a[34:35], v1 offset:1024
M a[4:7], a[164:167], a[108:111], a[4:7]
 s_add_u32 m0, s24, 16384
M a[4:7], a[160:163], a[104:107], a[4:7]
 buffer_load_dwordx4 v12, s[48:51], s22 offen offset:0   lds
M a[8:11], a[160:163], a[112:115], a[8:11]
 v_mov_b32 v28, 159744
M a[8:11], a[164:167], a[116:119], a[8:11]
 ds_read_b128 v[16:19], v28
M a[12:15], a[164:167], a[124:127], a[12:15]
 ds_read_b64_tr_b16 a[36:37], v1 offset:8192
 ds_read_b64_tr_b16 a[38:39], v1 offset:9216
M a[12:15], a[160:163], a[120:123], a[12:15]
 ds_read_b128 v[20:23], v28 offset:16
M a[16:19], a[160:163], a[128:131], a[16:19]
 buffer_load_dwordx4 v13, s[48:51], s22 offen offset:1024   lds
M a[16:19], a[164:167], a[132:135], a[16:19]
M a[20:23], a[164:167], a[140:143], a[20:23]
M a[20:23], a[160:163], a[136:139], a[20:23]
 ds_read_b64_tr_b16 a[40:41], v2 offset:0
 ds_read_b64_tr_b16 a[42:43], v2 offset:1024
M a[24:27], a[160:163], a[144:147], a[24:27]
M a[24:27], a[164:167], a[148:151], a[24:27]
 s_waitcnt lgkmcnt(8)
M a[28:31], a[164:167], a[156:159], a[28:31]
 buffer_load_dwordx4 v14, s[48:51], s22 offen offset:2048   lds
M a[28:31], a[160:163], a[152:155], a[28:31]
M v[60:63], a[168:171], a[152:155], v[60:63]
 ds_read_b128 a[160:163], v5 offset:36864
 ds_read_b128 a[164:167], v6 offset:36864
M v[60:63], a[172:175], a[156:159], v[60:63]
 ds_read_b64_tr_b16 a[44:45], v2 offset:8192
 ds_read_b64_tr_b16 a[46:47], v2 offset:9216
M v[56:59], a[172:175], a[148:151], v[56:59]
 buffer_load_dwordx4 v15, s[48:51], s22 offen offset:3072   lds
M v[56:59], a[168:171], a[144:147], v[56:59]
 s_sub_u32 s22, s22, 2097024
 s_waitcnt lgkmcnt(9)
 v_min_u32 v28, v16, v18
M v[52:55], a[168:171], a[136:139], v[52:55]
 v_max_u32 v16, v16, v18
M v[52:55], a[172:175], a[140:143], v[52:55]
 ds_read_b64_tr_b16 a[48:49], v3 offset:0
 ds_read_b64_tr_b16 a[50:51], v3 offset:1024
M v[48:51], a[172:175], a[132:135], v[48:51]
 s_add_u32 m0, s23, 49152
 v_max3_u32 v17, v17, v19, v28
M v[48:51], a[168:171], a[128:131], v[48:51]
 buffer_load_dwordx4 v8, s[16:19], s21 offen offset:0  nt lds
M v[44:47], a[168:171], a[120:123], v[44:47]
 s_waitcnt lgkmcnt(8)
 v_min_u32 v29, v20, v22
M v[44:47], a[172:175], a[124:127], v[44:47]
 v_max_u32 v20, v20, v22
M v[40:43], a[172:175], a[116:119], v[40:43]
 ds_read_b64_tr_b16 a[52:53], v3 offset:8192
 ds_read_b64_tr_b16 a[54:55], v3 offset:9216
M v[40:43], a[168:171], a[112:115], v[40:43]
 v_max3_u32 v21, v21, v23, v29
M v[36:39], a[168:171], a[104:107], v[36:39]
 buffer_load_dwordx4 v9, s[16:19], s21 offen offset:1024  nt lds
M v[36:39], a[172:175], a[108:111], v[36:39]
 s_waitcnt lgkmcnt(6)
 v_min_u32 v28, v16, v20
M v[32:35], a[172:175], a[100:103], v[32:35]
 v_max_u32 v16, v16, v20
M v[32:35], a[168:171], a[96:99], v[32:35]
 ds_read_b64_tr_b16 a[56:57], v4 offset:0
 ds_read_b64_tr_b16 a[58:59], v4 offset:1024
M v[64:67], a[160:163], a[96:99], v[64:67]
 ds_read_b128 a[168:171], v5 offset:38912
 ds_read_b128 a[172:175], v6 offset:38912
M v[64:67], a[164:167], a[100:103], v[64:67]
 buffer_load_dwordx4 v10, s[16:19], s21 offen offset:2048  nt lds
M v[68:71], a[164:167], a[108:111], v[68:71]
 v_max3_u32 v17, v17, v21, v28
M v[68:71], a[160:163], a[104:107], v[68:71]
 v_and_b32 v28, 1, v0
M v[72:75], a[160:163], a[112:115], v[72:75]
 ds_read_b64_tr_b16 a[60:61], v4 offset:8192
 ds_read_b64_tr_b16 a[62:63], v4 offset:9216
M v[72:75], a[164:167], a[116:119], v[72:75]
 v_cmp_eq_u32 vcc, 0, v28
M v[76:79], a[164:167], a[124:127], v[76:79]
 buffer_load_dwordx4 v11, s[16:19], s21 offen offset:3072  nt lds
M v[76:79], a[160:163], a[120:123], v[76:79]
 s_add_u32 s21, s21, 524160
 s_and_b32 s64, s20, 1
M v[80:83], a[160:163], a[128:131], v[80:83]
 s_mul_i32 s64, s64, 448
 v_cndmask_b32 v24, v17, v16, vcc
M v[80:83], a[164:167], a[132:135], v[80:83]
 v_and_b32 v24, 0x7ff, v24
M v[84:87], a[164:167], a[140:143], v[84:87]
 v_sub_u32 v24, 2047, v24
M v[84:87], a[160:163], a[136:139], v[84:87]
 v_mul_u32_u24 v28, 896, v24
M v[88:91], a[160:163], a[144:147], v[88:91]
 v_lshrrev_b32 v29, 4, v0
M v[88:91], a[164:167], a[148:151], v[88:91]
 s_waitcnt lgkmcnt(2)
 v_lshl_add_u32 v28, v29, 4, v28
M v[92:95], a[164:167], a[156:159], v[92:95]
 s_waitcnt vmcnt(18) lgkmcnt(0)
 v_bfe_u32 v30, v0, 1, 3
M v[92:95], a[160:163], a[152:155], v[92:95]
 s_barrier
M v[124:127], a[168:171], a[152:155], v[124:127]
 ds_read_b128 a[160:163], v5 offset:49152
 ds_read_b128 a[164:167], v6 offset:49152
M v[124:127], a[172:175], a[156:159], v[124:127]
 v_lshl_or_b32 v28, v30, 26, v28
M v[120:123], a[172:175], a[148:151], v[120:123]
 s_add_u32 m0, s24, 32768
 ds_read_b64_tr_b16 a[64:65], v1 offset:16384
 ds_read_b64_tr_b16 a[66:67], v1 offset:17408
M v[120:123], a[168:171], a[144:147], v[120:123]
 buffer_load_dwordx4 v12, s[48:51], s22 offen offset:0   lds
M v[116:119], a[168:171], a[136:139], v[116:119]
M v[116:119], a[172:175], a[140:143], v[116:119]
M v[112:115], a[172:175], a[132:135], v[112:115]
 buffer_load_dwordx4 a[208:211], v28, s[56:59], s64 offen offset:0
M v[112:115], a[168:171], a[128:131], v[112:115]
M v[108:111], a[168:171], a[120:123], v[108:111]
 buffer_load_dwordx4 a[212:215], v28, s[56:59], s64 offen offset:64
M v[108:111], a[172:175], a[124:127], v[108:111]
 ds_read_b64_tr_b16 a[68:69], v1 offset:24576
 ds_read_b64_tr_b16 a[70:71], v1 offset:25600
M v[104:107], a[172:175], a[116:119], v[104:107]
 buffer_load_dwordx4 v13, s[48:51], s22 offen offset:1024   lds
M v[104:107], a[168:171], a[112:115], v[104:107]
M v[100:103], a[168:171], a[104:107], v[100:103]
M v[100:103], a[172:175], a[108:111], v[100:103]
 s_waitcnt lgkmcnt(4)
M v[96:99], a[172:175], a[100:103], v[96:99]
 buffer_load_dwordx4 a[216:219], v28, s[56:59], s64 offen offset:128
M v[96:99], a[168:171], a[96:99], v[96:99]
M v[128:131], a[160:163], a[96:99], v[128:131]
 ds_read_b128 a[168:171], v5 offset:51200
 ds_read_b128 a[172:175], v6 offset:51200
M v[128:131], a[164:167], a[100:103], v[128:131]
 ds_read_b64_tr_b16 a[72:73], v2 offset:16384
 ds_read_b64_tr_b16 a[74:75], v2 offset:17408
M v[132:135], a[164:167], a[108:111], v[132:135]
 buffer_load_dwordx4 v14, s[48:51], s22 offen offset:2048   lds
M v[132:135], a[160:163], a[104:107], v[132:135]
M v[136:139], a[160:163], a[112:115], v[136:139]
 buffer_load_dwordx4 a[220:223], v28, s[56:59], s64 offen offset:192
M v[136:139], a[164:167], a[116:119], v[136:139]
M v[140:143], a[164:167], a[124:127], v[140:143]
 buffer_load_dwordx4 a[224:227], v28, s[56:59], s64 offen offset:256
M v[140:143], a[160:163], a[120:123], v[140:143]
 ds_read_b64_tr_b16 a[76:77], v2 offset:24576
 ds_read_b64_tr_b16 a[78:79], v2 offset:25600
M v[144:147], a[160:163], a[128:131], v[144:147]
 buffer_load_dwordx4 v15, s[48:51], s22 offen offset:3072   lds
M v[144:147], a[164:167], a[132:135], v[144:147]
 s_add_u32 s22, s22, 2097152
M v[148:151], a[164:167], a[140:143], v[148:151]
M v[148:151], a[160:163], a[136:139], v[148:151]
 buffer_load_dwordx4 a[228:231], v28, s[56:59], s64 offen offset:320
M v[152:155], a[160:163], a[144:147], v[152:155]
M v[152:155], a[164:167], a[148:151], v[152:155]
 s_waitcnt lgkmcnt(4)
M v[156:159], a[164:167], a[156:159], v[156:159]
 s_add_u32 m0, s23, 0
 ds_read_b64_tr_b16 a[80:81], v3 offset:16384
 ds_read_b64_tr_b16 a[82:83], v3 offset:17408
M v[156:159], a[160:163], a[152:155], v[156:159]
 buffer_load_dwordx4 v8, s[16:19], s21 offen offset:0  nt lds
M v[188:191], a[168:171], a[152:155], v[188:191]
 ds_read_b128 a[160:163], v5 offset:53248
 ds_read_b128 a[164:167], v6 offset:53248
M v[188:191], a[172:175], a[156:159], v[188:191]
 buffer_load_dwordx4 a[232:235], v28, s[56:59], s64 offen offset:384
M v[184:187], a[172:175], a[148:151], v[184:187]
 v_lshrrev_b32 v28, 4, v24
M v[184:187], a[168:171], a[144:147], v[184:187]
 v_lshlrev_b32 v28, 5, v28
M v[180:183], a[168:171], a[136:139], v[180:183]
 v_and_b32 v30, 15, v24
M v[180:183], a[172:175], a[140:143], v[180:183]
 ds_read_b64_tr_b16 a[84:85], v3 offset:24576
 ds_read_b64_tr_b16 a[86:87], v3 offset:25600
M v[176:179], a[172:175], a[132:135], v[176:179]
 buffer_load_dwordx4 v9, s[16:19], s21 offen offset:1024  nt lds
M v[176:179], a[168:171], a[128:131], v[176:179]
 v_add_lshl_u32 v28, v28, v30, 2
M v[172:175], a[168:171], a[120:123], v[172:175]
 v_lshrrev_b32 v30, 1, v0
M v[172:175], a[172:175], a[124:127], v[172:175]
 v_min_u32 v30, 1, v30
M v[168:171], a[172:175], a[116:119], v[168:171]
 v_lshl_or_b32 v28, v30, 29, v28
M v[168:171], a[168:171], a[112:115], v[168:171]
 s_mov_b32 s64, 104857600
M v[164:167], a[168:171], a[104:107], v[164:167]
 ds_read_b64_tr_b16 a[88:89], v4 offset:16384
 ds_read_b64_tr_b16 a[90:91], v4 offset:17408
M v[164:167], a[172:175], a[108:111], v[164:167]
 s_waitcnt lgkmcnt(4)
M v[160:163], a[172:175], a[100:103], v[160:163]
 buffer_load_dwordx4 v10, s[16:19], s21 offen offset:2048  nt lds
M v[160:163], a[168:171], a[96:99], v[160:163]
 buffer_load_dword v23, v28, s[8:11], s64 offen sc1
M v[192:195], a[160:163], a[96:99], v[192:195]
 ds_read_b128 a[168:171], v5 offset:55296
 ds_read_b128 a[172:175], v6 offset:55296
M v[192:195], a[164:167], a[100:103], v[192:195]
 v_bfe_u32 v28, v0, 2, 2
M v[196:199], a[164:167], a[108:111], v[196:199]
 v_lshl_add_u32 v28, v29, 3, v28
M v[196:199], a[160:163], a[104:107], v[196:199]
 ds_read_b64_tr_b16 a[92:93], v4 offset:24576
 ds_read_b64_tr_b16 a[94:95], v4 offset:25600
M v[200:203], a[160:163], a[112:115], v[200:203]
 buffer_load_dwordx4 v11, s[16:19], s21 offen offset:3072  nt lds
M v[200:203], a[164:167], a[116:119], v[200:203]
 s_add_u32 s21, s21, 128
 v_lshlrev_b32 v28, 5, v28
M v[204:207], a[164:167], a[124:127], v[204:207]
 v_and_b32 v30, 3, v0
M v[204:207], a[160:163], a[120:123], v[204:207]
 v_lshl_add_u32 v28, v30, 3, v28
M v[208:211], a[160:163], a[128:131], v[208:211]
 v_add_u32 v22, s87, v28
M v[208:211], a[164:167], a[132:135], v[208:211]
M v[212:215], a[164:167], a[140:143], v[212:215]
M v[212:215], a[160:163], a[136:139], v[212:215]
M v[216:219], a[160:163], a[144:147], v[216:219]
M v[216:219], a[164:167], a[148:151], v[216:219]
 s_waitcnt lgkmcnt(2)
M v[220:223], a[164:167], a[156:159], v[220:223]
 s_waitcnt vmcnt(26) lgkmcnt(0)
M v[220:223], a[160:163], a[152:155], v[220:223]
 s_barrier
M v[252:255], a[168:171], a[152:155], v[252:255]
 ds_read_b128 a[160:163], v5 offset:0
 ds_read_b128 a[164:167], v6 offset:0
M v[252:255], a[172:175], a[156:159], v[252:255]
M v[248:251], a[172:175], a[148:151], v[248:251]
M v[248:251], a[168:171], a[144:147], v[248:251]
M v[244:247], a[168:171], a[136:139], v[244:247]
M v[244:247], a[172:175], a[140:143], v[244:247]
M v[240:243], a[172:175], a[132:135], v[240:243]
M v[240:243], a[168:171], a[128:131], v[240:243]
M v[236:239], a[168:171], a[120:123], v[236:239]
M v[236:239], a[172:175], a[124:127], v[236:239]
M v[232:235], a[172:175], a[116:119], v[232:235]
M v[232:235], a[168:171], a[112:115], v[232:235]
M v[228:231], a[168:171], a[104:107], v[228:231]
M v[228:231], a[172:175], a[108:111], v[228:231]
 s_waitcnt lgkmcnt(0)
M v[224:227], a[172:175], a[100:103], v[224:227]
M v[224:227], a[168:171], a[96:99], v[224:227]
M a[0:3], a[160:163], a[32:35], a[0:3]
 ds_read_b128 a[168:171], v5 offset:2048
 ds_read_b128 a[172:175], v6 offset:2048
M a[0:3], a[164:167], a[36:39], a[0:3]
 ds_read_b64_tr_b16 a[96:97], v1 offset:32768
 ds_read_b64_tr_b16 a[98:99], v1 offset:33792
M a[4:7], a[164:167], a[44:47], a[4:7]
 s_add_u32 m0, s24, 49152
M a[4:7], a[160:163], a[40:43], a[4:7]
 buffer_load_dwordx4 v12, s[48:51], s22 offen offset:0   lds
M a[8:11], a[160:163], a[48:51], a[8:11]
M a[8:11], a[164:167], a[52:55], a[8:11]
M a[12:15], a[164:167], a[60:63], a[12:15]
 ds_read_b64_tr_b16 a[100:101], v1 offset:40960
 ds_read_b64_tr_b16 a[102:103], v1 offset:41984
M a[12:15], a[160:163], a[56:59], a[12:15]
M a[16:19], a[160:163], a[64:67], a[16:19]
 buffer_load_dwordx4 v13, s[48:51], s22 offen offset:1024   lds
M a[16:19], a[164:167], a[68:71], a[16:19]
M a[20:23], a[164:167], a[76:79], a[20:23]
M a[20:23], a[160:163], a[72:75], a[20:23]
 ds_read_b64_tr_b16 a[104:105], v2 offset:32768
 ds_read_b64_tr_b16 a[106:107], v2 offset:33792
M a[24:27], a[160:163], a[80:83], a[24:27]
M a[24:27], a[164:167], a[84:87], a[24:27]
 s_waitcnt lgkmcnt(6)
M a[28:31], a[164:167], a[92:95], a[28:31]
 buffer_load_dwordx4 v14, s[48:51], s22 offen offset:2048   lds
M a[28:31], a[160:163], a[88:91], a[28:31]
M v[60:63], a[168:171], a[88:91], v[60:63]
 ds_read_b128 a[160:163], v5 offset:4096
 ds_read_b128 a[164:167], v6 offset:4096
M v[60:63], a[172:175], a[92:95], v[60:63]
 ds_read_b64_tr_b16 a[108:109], v2 offset:40960
 ds_read_b64_tr_b16 a[110:111], v2 offset:41984
M v[56:59], a[172:175], a[84:87], v[56:59]
 buffer_load_dwordx4 v15, s[48:51], s22 offen offset:3072   lds
M v[56:59], a[168:171], a[80:83], v[56:59]
 s_sub_u32 s22, s22, 2097024
M v[52:55], a[168:171], a[72:75], v[52:55]
M v[52:55], a[172:175], a[76:79], v[52:55]
 ds_read_b64_tr_b16 a[112:113], v3 offset:32768
 ds_read_b64_tr_b16 a[114:115], v3 offset:33792
M v[48:51], a[172:175], a[68:71], v[48:51]
 s_add_u32 m0, s23, 16384
M v[48:51], a[168:171], a[64:67], v[48:51]
 buffer_load_dwordx4 v8, s[16:19], s21 offen offset:0  nt lds
M v[44:47], a[168:171], a[56:59], v[44:47]
M v[44:47], a[172:175], a[60:63], v[44:47]
M v[40:43], a[172:175], a[52:55], v[40:43]
 ds_read_b64_tr_b16 a[116:117], v3 offset:40960
 ds_read_b64_tr_b16 a[118:119], v3 offset:41984
M v[40:43], a[168:171], a[48:51], v[40:43]
M v[36:39], a[168:171], a[40:43], v[36:39]
 buffer_load_dwordx4 v9, s[16:19], s21 offen offset:1024  nt lds
M v[36:39], a[172:175], a[44:47], v[36:39]
 s_waitcnt lgkmcnt(6)
M v[32:35], a[172:175], a[36:39], v[32:35]
M v[32:35], a[168:171], a[32:35], v[32:35]
 ds_read_b64_tr_b16 a[120:121], v4 offset:32768
 ds_read_b64_tr_b16 a[122:123], v4 offset:33792
M v[64:67], a[160:163], a[32:35], v[64:67]
 ds_read_b128 a[168:171], v5 offset:6144
 ds_read_b128 a[172:175], v6 offset:6144
M v[64:67], a[164:167], a[36:39], v[64:67]
 buffer_load_dwordx4 v10, s[16:19], s21 offen offset:2048  nt lds
M v[68:71], a[164:167], a[44:47], v[68:71]
M v[68:71], a[160:163], a[40:43], v[68:71]
M v[72:75], a[160:163], a[48:51], v[72:75]
 ds_read_b64_tr_b16 a[124:125], v4 offset:40960
 ds_read_b64_tr_b16 a[126:127], v4 offset:41984
M v[72:75], a[164:167], a[52:55], v[72:75]
M v[76:79], a[164:167], a[60:63], v[76:79]
 buffer_load_dwordx4 v11, s[16:19], s21 offen offset:3072  nt lds
M v[76:79], a[160:163], a[56:59], v[76:79]
 s_add_u32 s21, s21, 524160
M v[80:83], a[160:163], a[64:67], v[80:83]
M v[80:83], a[164:167], a[68:71], v[80:83]
M v[84:87], a[164:167], a[76:79], v[84:87]
M v[84:87], a[160:163], a[72:75], v[84:87]
M v[88:91], a[160:163], a[80:83], v[88:91]
M v[88:91], a[164:167], a[84:87], v[88:91]
 s_waitcnt lgkmcnt(2)
M v[92:95], a[164:167], a[92:95], v[92:95]
 s_waitcnt vmcnt(24) lgkmcnt(0)
M v[92:95], a[160:163], a[88:91], v[92:95]
 s_barrier
M v[124:127], a[168:171], a[88:91], v[124:127]
 ds_read_b128 a[160:163], v5 offset:16384
 ds_read_b128 a[164:167], v6 offset:16384
M v[124:127], a[172:175], a[92:95], v[124:127]
M v[120:123], a[172:175], a[84:87], v[120:123]
 s_add_u32 m0, s24, 0
 ds_read_b64_tr_b16 a[128:129], v1 offset:49152
 ds_read_b64_tr_b16 a[130:131], v1 offset:50176
M v[120:123], a[168:171], a[80:83], v[120:123]
 buffer_load_dwordx4 v12, s[48:51], s22 offen offset:0   lds
M v[116:119], a[168:171], a[72:75], v[116:119]
 ds_read_b64_tr_b16 a[176:177], v22 offset:0
M v[116:119], a[172:175], a[76:79], v[116:119]
 ds_read_b64_tr_b16 a[178:179], v22 offset:128
 ds_read_b64_tr_b16 a[180:181], v22 offset:1024
M v[112:115], a[172:175], a[68:71], v[112:115]
 ds_read_b64_tr_b16 a[182:183], v22 offset:1152
M v[112:115], a[168:171], a[64:67], v[112:115]
 ds_read_b64_tr_b16 a[184:185], v22 offset:2048
 ds_read_b64_tr_b16 a[186:187], v22 offset:2176
M v[108:111], a[168:171], a[56:59], v[108:111]
 ds_read_b64_tr_b16 a[188:189], v22 offset:3072
M v[108:111], a[172:175], a[60:63], v[108:111]
 ds_read_b64_tr_b16 a[132:133], v1 offset:57344
 ds_read_b64_tr_b16 a[134:135], v1 offset:58368
M v[104:107], a[172:175], a[52:55], v[104:107]
 buffer_load_dwordx4 v13, s[48:51], s22 offen offset:1024   lds
M v[104:107], a[168:171], a[48:51], v[104:107]
 ds_read_b64_tr_b16 a[190:191], v22 offset:3200
M v[100:103], a[168:171], a[40:43], v[100:103]
M v[100:103], a[172:175], a[44:47], v[100:103]
 s_waitcnt lgkmcnt(12)
M v[96:99], a[172:175], a[36:39], v[96:99]
M v[96:99], a[168:171], a[32:35], v[96:99]
M v[128:131], a[160:163], a[32:35], v[128:131]
 ds_read_b128 a[168:171], v5 offset:18432
 ds_read_b128 a[172:175], v6 offset:18432
M v[128:131], a[164:167], a[36:39], v[128:131]
 ds_read_b64_tr_b16 a[136:137], v2 offset:49152
 ds_read_b64_tr_b16 a[138:139], v2 offset:50176
M v[132:135], a[164:167], a[44:47], v[132:135]
 buffer_load_dwordx4 v14, s[48:51], s22 offen offset:2048   lds
M v[132:135], a[160:163], a[40:43], v[132:135]
M v[136:139], a[160:163], a[48:51], v[136:139]
M v[136:139], a[164:167], a[52:55], v[136:139]
M v[140:143], a[164:167], a[60:63], v[140:143]
M v[140:143], a[160:163], a[56:59], v[140:143]
 ds_read_b64_tr_b16 a[140:141], v2 offset:57344
 ds_read_b64_tr_b16 a[142:143], v2 offset:58368
M v[144:147], a[160:163], a[64:67], v[144:147]
 buffer_load_dwordx4 v15, s[48:51], s22 offen offset:3072   lds
M v[144:147], a[164:167], a[68:71], v[144:147]
 s_add_u32 s22, s22, 2097152
M v[148:151], a[164:167], a[76:79], v[148:151]
M v[148:151], a[160:163], a[72:75], v[148:151]
M v[152:155], a[160:163], a[80:83], v[152:155]
M v[152:155], a[164:167], a[84:87], v[152:155]
 s_waitcnt lgkmcnt(4)
M v[156:159], a[164:167], a[92:95], v[156:159]
 s_add_u32 m0, s23, 32768
 ds_read_b64_tr_b16 a[144:145], v3 offset:49152
 ds_read_b64_tr_b16 a[146:147], v3 offset:50176
M v[156:159], a[160:163], a[88:91], v[156:159]
 buffer_load_dwordx4 v8, s[16:19], s21 offen offset:0  nt lds
 s_waitcnt vmcnt(27)
M v[16:19], a[176:179], a[208:211], 0
 s_waitcnt vmcnt(26)
M v[16:19], a[180:183], a[212:215], v[16:19]
 s_waitcnt vmcnt(24)
M v[16:19], a[184:187], a[216:219], v[16:19]
 s_waitcnt vmcnt(22)
M v[16:19], a[188:191], a[220:223], v[16:19]
M v[188:191], a[168:171], a[88:91], v[188:191]
 ds_read_b128 a[160:163], v5 offset:20480
 ds_read_b128 a[164:167], v6 offset:20480
M v[188:191], a[172:175], a[92:95], v[188:191]
 ds_read_b64_tr_b16 a[176:177], v22 offset:4096
M v[184:187], a[172:175], a[84:87], v[184:187]
 ds_read_b64_tr_b16 a[178:179], v22 offset:4224
 ds_read_b64_tr_b16 a[180:181], v22 offset:5120
M v[184:187], a[168:171], a[80:83], v[184:187]
 ds_read_b64_tr_b16 a[182:183], v22 offset:5248
M v[180:183], a[168:171], a[72:75], v[180:183]
 ds_read_b64_tr_b16 a[184:185], v22 offset:6144
M v[180:183], a[172:175], a[76:79], v[180:183]
 ds_read_b64_tr_b16 a[148:149], v3 offset:57344
 ds_read_b64_tr_b16 a[150:151], v3 offset:58368
M v[176:179], a[172:175], a[68:71], v[176:179]
 buffer_load_dwordx4 v9, s[16:19], s21 offen offset:1024  nt lds
M v[176:179], a[168:171], a[64:67], v[176:179]
 ds_read_b64_tr_b16 a[186:187], v22 offset:6272
M v[172:175], a[168:171], a[56:59], v[172:175]
M v[172:175], a[172:175], a[60:63], v[172:175]
M v[168:171], a[172:175], a[52:55], v[168:171]
M v[168:171], a[168:171], a[48:51], v[168:171]
M v[164:167], a[168:171], a[40:43], v[164:167]
 ds_read_b64_tr_b16 a[152:153], v4 offset:49152
 ds_read_b64_tr_b16 a[154:155], v4 offset:50176
M v[164:167], a[172:175], a[44:47], v[164:167]
 s_waitcnt lgkmcnt(10)
M v[160:163], a[172:175], a[36:39], v[160:163]
 buffer_load_dwordx4 v10, s[16:19], s21 offen offset:2048  nt lds
M v[160:163], a[168:171], a[32:35], v[160:163]
M v[192:195], a[160:163], a[32:35], v[192:195]
 ds_read_b128 a[168:171], v5 offset:22528
 ds_read_b128 a[172:175], v6 offset:22528
M v[192:195], a[164:167], a[36:39], v[192:195]
M v[196:199], a[164:167], a[44:47], v[196:199]
M v[196:199], a[160:163], a[40:43], v[196:199]
 ds_read_b64_tr_b16 a[156:157], v4 offset:57344
 ds_read_b64_tr_b16 a[158:159], v4 offset:58368
M v[200:203], a[160:163], a[48:51], v[200:203]
 buffer_load_dwordx4 v11, s[16:19], s21 offen offset:3072  nt lds
M v[200:203], a[164:167], a[52:55], v[200:203]
 s_add_u32 s21, s21, 128
M v[204:207], a[164:167], a[60:63], v[204:207]
M v[204:207], a[160:163], a[56:59], v[204:207]
M v[208:211], a[160:163], a[64:67], v[208:211]
M v[208:211], a[164:167], a[68:71], v[208:211]
M v[212:215], a[164:167], a[76:79], v[212:215]
M v[212:215], a[160:163], a[72:75], v[212:215]
M v[216:219], a[160:163], a[80:83], v[216:219]
M v[216:219], a[164:167], a[84:87], v[216:219]
 s_waitcnt lgkmcnt(2)
M v[220:223], a[164:167], a[92:95], v[220:223]
 s_waitcnt vmcnt(16) lgkmcnt(0)
M v[220:223], a[160:163], a[88:91], v[220:223]
 s_barrier
M v[16:19], a[176:179], a[224:227], v[16:19]
M v[16:19], a[180:183], a[228:231], v[16:19]
M v[16:19], a[184:187], a[232:235], v[16:19]
M v[252:255], a[168:171], a[88:91], v[252:255]
 ds_read_b128 a[160:163], v5 offset:32768
 ds_read_b128 a[164:167], v6 offset:32768
M v[252:255], a[172:175], a[92:95], v[252:255]
M v[248:251], a[172:175], a[84:87], v[248:251]
M v[248:251], a[168:171], a[80:83], v[248:251]
M v[244:247], a[168:171], a[72:75], v[244:247]
M v[244:247], a[172:175], a[76:79], v[244:247]
M v[240:243], a[172:175], a[68:71], v[240:243]
M v[240:243], a[168:171], a[64:67], v[240:243]
M v[236:239], a[168:171], a[56:59], v[236:239]
M v[236:239], a[172:175], a[60:63], v[236:239]
M v[232:235], a[172:175], a[52:55], v[232:235]
M v[232:235], a[168:171], a[48:51], v[232:235]
M v[228:231], a[168:171], a[40:43], v[228:231]
M v[228:231], a[172:175], a[44:47], v[228:231]
 s_waitcnt lgkmcnt(0)
M v[224:227], a[172:175], a[36:39], v[224:227]
M v[224:227], a[168:171], a[32:35], v[224:227]
M a[0:3], a[160:163], a[96:99], a[0:3]
 ds_read_b128 a[168:171], v5 offset:34816
 ds_read_b128 a[172:175], v6 offset:34816
M a[0:3], a[164:167], a[100:103], a[0:3]
 ds_read_b64_tr_b16 a[32:33], v1 offset:0
 ds_read_b64_tr_b16 a[34:35], v1 offset:1024
M a[4:7], a[164:167], a[108:111], a[4:7]
 s_add_u32 m0, s24, 16384
M a[4:7], a[160:163], a[104:107], a[4:7]
 buffer_load_dwordx4 v12, s[48:51], s22 offen offset:0   lds
M a[8:11], a[160:163], a[112:115], a[8:11]
M a[8:11], a[164:167], a[116:119], a[8:11]
 s_lshl_b32 s64, s20, 10
M a[12:15], a[164:167], a[124:127], a[12:15]
 s_add_u32 s64, s64, 159744
 ds_read_b64_tr_b16 a[36:37], v1 offset:8192
 ds_read_b64_tr_b16 a[38:39], v1 offset:9216
M a[12:15], a[160:163], a[120:123], a[12:15]
 v_add_u32 v21, s64, v7
 ds_write_b128 v21, v[16:19]
M a[16:19], a[160:163], a[128:131], a[16:19]
 buffer_load_dwordx4 v13, s[48:51], s22 offen offset:1024   lds
M a[16:19], a[164:167], a[132:135], a[16:19]
 s_mul_i32 s67, s86, 14336
M a[20:23], a[164:167], a[140:143], a[20:23]
 s_mul_i32 s64, s20, 224
M a[20:23], a[160:163], a[136:139], a[20:23]
 s_add_u32 s67, s67, s64
 ds_read_b64_tr_b16 a[40:41], v2 offset:0
 ds_read_b64_tr_b16 a[42:43], v2 offset:1024
M a[24:27], a[160:163], a[144:147], a[24:27]
 v_lshrrev_b32 v28, 4, v0
 v_mul_u32_u24 v28, 896, v28
M a[24:27], a[164:167], a[148:151], a[24:27]
 s_waitcnt lgkmcnt(7)
 v_and_b32 v29, 15, v0
 v_lshl_add_u32 v28, v29, 4, v28
M a[28:31], a[164:167], a[156:159], a[28:31]
 buffer_load_dwordx4 v14, s[48:51], s22 offen offset:2048   lds
M a[28:31], a[160:163], a[152:155], a[28:31]
 v_mov_b32 v30, 536870912
 v_cmp_gt_u32 vcc, 14, v29
M v[60:63], a[168:171], a[152:155], v[60:63]
 s_nop 0
 ds_read_b128 a[160:163], v5 offset:36864
 ds_read_b128 a[164:167], v6 offset:36864
M v[60:63], a[172:175], a[156:159], v[60:63]
 s_nop 0
 ds_read_b64_tr_b16 a[44:45], v2 offset:8192
 ds_read_b64_tr_b16 a[46:47], v2 offset:9216
M v[56:59], a[172:175], a[148:151], v[56:59]
 buffer_load_dwordx4 v15, s[48:51], s22 offen offset:3072   lds
M v[56:59], a[168:171], a[144:147], v[56:59]
 s_sub_u32 s22, s22, 2097024
 v_cndmask_b32 v28, v30, v28, vcc
 v_add_u32 v29, 2560, v28
M v[52:55], a[168:171], a[136:139], v[52:55]
 v_add_u32 v30, 5120, v28
 v_add_u32 v31, 7680, v28
M v[52:55], a[172:175], a[140:143], v[52:55]
 ds_read_b64_tr_b16 a[48:49], v3 offset:0
 ds_read_b64_tr_b16 a[50:51], v3 offset:1024
M v[48:51], a[172:175], a[132:135], v[48:51]
 s_add_u32 m0, s23, 49152
M v[48:51], a[168:171], a[128:131], v[48:51]
 buffer_load_dwordx4 v8, s[16:19], s21 offen offset:0  nt lds
M v[44:47], a[168:171], a[120:123], v[44:47]
M v[44:47], a[172:175], a[124:127], v[44:47]
M v[40:43], a[172:175], a[116:119], v[40:43]
 ds_read_b64_tr_b16 a[52:53], v3 offset:8192
 ds_read_b64_tr_b16 a[54:55], v3 offset:9216
M v[40:43], a[168:171], a[112:115], v[40:43]
M v[36:39], a[168:171], a[104:107], v[36:39]
 buffer_load_dwordx4 v9, s[16:19], s21 offen offset:1024  nt lds
M v[36:39], a[172:175], a[108:111], v[36:39]
 s_waitcnt lgkmcnt(6)
M v[32:35], a[172:175], a[100:103], v[32:35]
M v[32:35], a[168:171], a[96:99], v[32:35]
 ds_read_b64_tr_b16 a[56:57], v4 offset:0
 ds_read_b64_tr_b16 a[58:59], v4 offset:1024
M v[64:67], a[160:163], a[96:99], v[64:67]
 ds_read_b128 a[168:171], v5 offset:38912
 ds_read_b128 a[172:175], v6 offset:38912
M v[64:67], a[164:167], a[100:103], v[64:67]
 buffer_load_dwordx4 v10, s[16:19], s21 offen offset:2048  nt lds
M v[68:71], a[164:167], a[108:111], v[68:71]
M v[68:71], a[160:163], a[104:107], v[68:71]
M v[72:75], a[160:163], a[112:115], v[72:75]
 ds_read_b64_tr_b16 a[60:61], v4 offset:8192
 ds_read_b64_tr_b16 a[62:63], v4 offset:9216
M v[72:75], a[164:167], a[116:119], v[72:75]
M v[76:79], a[164:167], a[124:127], v[76:79]
 buffer_load_dwordx4 v11, s[16:19], s21 offen offset:3072  nt lds
M v[76:79], a[160:163], a[120:123], v[76:79]
 s_add_u32 s21, s21, 524160
M v[80:83], a[160:163], a[128:131], v[80:83]
M v[80:83], a[164:167], a[132:135], v[80:83]
M v[84:87], a[164:167], a[140:143], v[84:87]
M v[84:87], a[160:163], a[136:139], v[84:87]
M v[88:91], a[160:163], a[144:147], v[88:91]
M v[88:91], a[164:167], a[148:151], v[88:91]
 s_waitcnt lgkmcnt(2)
M v[92:95], a[164:167], a[156:159], v[92:95]
 s_waitcnt vmcnt(16) lgkmcnt(0)
M v[92:95], a[160:163], a[152:155], v[92:95]
 s_barrier
M v[124:127], a[168:171], a[152:155], v[124:127]
 ds_read_b128 a[160:163], v5 offset:49152
 ds_read_b128 a[164:167], v6 offset:49152
M v[124:127], a[172:175], a[156:159], v[124:127]
M v[120:123], a[172:175], a[148:151], v[120:123]
 s_add_u32 m0, s24, 32768
 ds_read_b64_tr_b16 a[64:65], v1 offset:16384
 ds_read_b64_tr_b16 a[66:67], v1 offset:17408
M v[120:123], a[168:171], a[144:147], v[120:123]
 buffer_load_dwordx4 v12, s[48:51], s22 offen offset:0   lds
M v[116:119], a[168:171], a[136:139], v[116:119]
M v[116:119], a[172:175], a[140:143], v[116:119]
M v[112:115], a[172:175], a[132:135], v[112:115]
M v[112:115], a[168:171], a[128:131], v[112:115]
 buffer_load_dwordx4 v13, s[48:51], s22 offen offset:1024   lds
M v[108:111], a[168:171], a[120:123], v[108:111]
M v[108:111], a[172:175], a[124:127], v[108:111]
 ds_read_b64_tr_b16 a[68:69], v1 offset:24576
 ds_read_b64_tr_b16 a[70:71], v1 offset:25600
M v[104:107], a[172:175], a[116:119], v[104:107]
M v[104:107], a[168:171], a[112:115], v[104:107]
M v[100:103], a[168:171], a[104:107], v[100:103]
 buffer_load_dwordx4 v14, s[48:51], s22 offen offset:2048   lds
M v[100:103], a[172:175], a[108:111], v[100:103]
 s_waitcnt lgkmcnt(4)
M v[96:99], a[172:175], a[100:103], v[96:99]
M v[96:99], a[168:171], a[96:99], v[96:99]
M v[128:131], a[160:163], a[96:99], v[128:131]
 ds_read_b128 a[168:171], v5 offset:51200
 ds_read_b128 a[172:175], v6 offset:51200
M v[128:131], a[164:167], a[100:103], v[128:131]
 ds_read_b64_tr_b16 a[72:73], v2 offset:16384
 ds_read_b64_tr_b16 a[74:75], v2 offset:17408
M v[132:135], a[164:167], a[108:111], v[132:135]
 buffer_load_dwordx4 v15, s[48:51], s22 offen offset:3072   lds
M v[132:135], a[160:163], a[104:107], v[132:135]
 s_add_u32 s22, s22, 2097152
M v[136:139], a[160:163], a[112:115], v[136:139]
M v[136:139], a[164:167], a[116:119], v[136:139]
 s_add_u32 m0, s23, 0
M v[140:143], a[164:167], a[124:127], v[140:143]
 buffer_load_dwordx4 v8, s[16:19], s21 offen offset:0  nt lds
M v[140:143], a[160:163], a[120:123], v[140:143]
 ds_read_b64_tr_b16 a[76:77], v2 offset:24576
 ds_read_b64_tr_b16 a[78:79], v2 offset:25600
M v[144:147], a[160:163], a[128:131], v[144:147]
M v[144:147], a[164:167], a[132:135], v[144:147]
M v[148:151], a[164:167], a[140:143], v[148:151]
 buffer_load_dwordx4 v9, s[16:19], s21 offen offset:1024  nt lds
M v[148:151], a[160:163], a[136:139], v[148:151]
M v[152:155], a[160:163], a[144:147], v[152:155]
M v[152:155], a[164:167], a[148:151], v[152:155]
 s_waitcnt lgkmcnt(4)
M v[156:159], a[164:167], a[156:159], v[156:159]
 ds_read_b64_tr_b16 a[80:81], v3 offset:16384
 ds_read_b64_tr_b16 a[82:83], v3 offset:17408
M v[156:159], a[160:163], a[152:155], v[156:159]
 buffer_load_dwordx4 v10, s[16:19], s21 offen offset:2048  nt lds
M v[188:191], a[168:171], a[152:155], v[188:191]
 ds_read_b128 a[160:163], v5 offset:53248
 ds_read_b128 a[164:167], v6 offset:53248
M v[188:191], a[172:175], a[156:159], v[188:191]
M v[184:187], a[172:175], a[148:151], v[184:187]
M v[184:187], a[168:171], a[144:147], v[184:187]
M v[180:183], a[168:171], a[136:139], v[180:183]
 buffer_load_dwordx4 v11, s[16:19], s21 offen offset:3072  nt lds
M v[180:183], a[172:175], a[140:143], v[180:183]
 s_add_u32 s21, s21, 128
 ds_read_b64_tr_b16 a[84:85], v3 offset:24576
 ds_read_b64_tr_b16 a[86:87], v3 offset:25600
M v[176:179], a[172:175], a[132:135], v[176:179]
M v[176:179], a[168:171], a[128:131], v[176:179]
M v[172:175], a[168:171], a[120:123], v[172:175]
 s_add_u32 m0, s87, 0
M v[172:175], a[172:175], a[124:127], v[172:175]
 buffer_load_dwordx4 v28, s[68:71], s67 offen offset:0 nt lds
M v[168:171], a[172:175], a[116:119], v[168:171]
M v[168:171], a[168:171], a[112:115], v[168:171]
M v[164:167], a[168:171], a[104:107], v[164:167]
 ds_read_b64_tr_b16 a[88:89], v4 offset:16384
 ds_read_b64_tr_b16 a[90:91], v4 offset:17408
M v[164:167], a[172:175], a[108:111], v[164:167]
 s_waitcnt lgkmcnt(4)
M v[160:163], a[172:175], a[100:103], v[160:163]
 buffer_load_dwordx4 v29, s[68:71], s67 offen offset:1024 nt lds
M v[160:163], a[168:171], a[96:99], v[160:163]
M v[192:195], a[160:163], a[96:99], v[192:195]
 ds_read_b128 a[168:171], v5 offset:55296
 ds_read_b128 a[172:175], v6 offset:55296
M v[192:195], a[164:167], a[100:103], v[192:195]
M v[196:199], a[164:167], a[108:111], v[196:199]
 buffer_load_dwordx4 v30, s[68:71], s67 offen offset:2048 nt lds
M v[196:199], a[160:163], a[104:107], v[196:199]
 ds_read_b64_tr_b16 a[92:93], v4 offset:24576
 ds_read_b64_tr_b16 a[94:95], v4 offset:25600
M v[200:203], a[160:163], a[112:115], v[200:203]
M v[200:203], a[164:167], a[116:119], v[200:203]
M v[204:207], a[164:167], a[124:127], v[204:207]
M v[204:207], a[160:163], a[120:123], v[204:207]
 buffer_load_dwordx4 v31, s[68:71], s67 offen offset:3072 nt lds
M v[208:211], a[160:163], a[128:131], v[208:211]
 s_add_u32 s67, s67, 0
M v[208:211], a[164:167], a[132:135], v[208:211]
M v[212:215], a[164:167], a[140:143], v[212:215]
M v[212:215], a[160:163], a[136:139], v[212:215]
M v[216:219], a[160:163], a[144:147], v[216:219]
M v[216:219], a[164:167], a[148:151], v[216:219]
 s_waitcnt lgkmcnt(2)
M v[220:223], a[164:167], a[156:159], v[220:223]
 s_waitcnt vmcnt(20) lgkmcnt(0)
M v[220:223], a[160:163], a[152:155], v[220:223]
 s_barrier
M v[252:255], a[168:171], a[152:155], v[252:255]
 ds_read_b128 a[160:163], v5 offset:0
 ds_read_b128 a[164:167], v6 offset:0
M v[252:255], a[172:175], a[156:159], v[252:255]
M v[248:251], a[172:175], a[148:151], v[248:251]
M v[248:251], a[168:171], a[144:147], v[248:251]
M v[244:247], a[168:171], a[136:139], v[244:247]
M v[244:247], a[172:175], a[140:143], v[244:247]
M v[240:243], a[172:175], a[132:135], v[240:243]
M v[240:243], a[168:171], a[128:131], v[240:243]
M v[236:239], a[168:171], a[120:123], v[236:239]
M v[236:239], a[172:175], a[124:127], v[236:239]
M v[232:235], a[172:175], a[116:119], v[232:235]
M v[232:235], a[168:171], a[112:115], v[232:235]
M v[228:231], a[168:171], a[104:107], v[228:231]
M v[228:231], a[172:175], a[108:111], v[228:231]
 s_waitcnt lgkmcnt(0)
M v[224:227], a[172:175], a[100:103], v[224:227]
M v[224:227], a[168:171], a[96:99], v[224:227]
M a[0:3], a[160:163], a[32:35], a[0:3]
 ds_read_b128 a[168:171], v5 offset:2048
 ds_read_b128 a[172:175], v6 offset:2048
M a[0:3], a[164:167], a[36:39], a[0:3]
 ds_read_b64_tr_b16 a[96:97], v1 offset:32768
 ds_read_b64_tr_b16 a[98:99], v1 offset:33792
M a[4:7], a[164:167], a[44:47], a[4:7]
 s_add_u32 m0, s24, 49152
 v_cvt_pk_bf16_f32 v23, v23, v23
 v_accvgpr_read_b32 v27, a241
M a[4:7], a[160:163], a[40:43], a[4:7]
 buffer_load_dwordx4 v12, s[48:51], s22 offen offset:0   lds
M a[8:11], a[160:163], a[48:51], a[8:11]
 v_and_b32 v23, 0xffff0000, v23
M a[8:11], a[164:167], a[52:55], a[8:11]
 v_mul_f32 v22, 0xbfb8aa3b, v23
M a[12:15], a[164:167], a[60:63], a[12:15]
 ds_read_b64_tr_b16 a[100:101], v1 offset:40960
 ds_read_b64_tr_b16 a[102:103], v1 offset:41984
M a[12:15], a[160:163], a[56:59], a[12:15]
 v_exp_f32 v22, v22
M a[16:19], a[160:163], a[64:67], a[16:19]
 buffer_load_dwordx4 v13, s[48:51], s22 offen offset:1024   lds
M a[16:19], a[164:167], a[68:71], a[16:19]
 v_add_f32 v22, 1.0, v22
M a[20:23], a[164:167], a[76:79], a[20:23]
 v_rcp_f32 v23, v22
M a[20:23], a[160:163], a[72:75], a[20:23]
 s_or_b32 s64, s86, s20
 ds_read_b64_tr_b16 a[104:105], v2 offset:32768
 ds_read_b64_tr_b16 a[106:107], v2 offset:33792
M a[24:27], a[160:163], a[80:83], a[24:27]
 s_min_u32 s64, s64, 1
 s_lshl_b32 s64, s64, 29
 v_lshrrev_b32 v22, 1, v0
M a[24:27], a[164:167], a[84:87], a[24:27]
 s_waitcnt lgkmcnt(6)
 v_min_u32 v22, 1, v22
M a[28:31], a[164:167], a[92:95], a[28:31]
 buffer_load_dwordx4 v14, s[48:51], s22 offen offset:2048   lds
M a[28:31], a[160:163], a[88:91], a[28:31]
 v_lshlrev_b32 v22, 29, v22
M v[60:63], a[168:171], a[88:91], v[60:63]
 ds_read_b128 a[160:163], v5 offset:4096
 ds_read_b128 a[164:167], v6 offset:4096
M v[60:63], a[172:175], a[92:95], v[60:63]
 ds_read_b64_tr_b16 a[108:109], v2 offset:40960
 ds_read_b64_tr_b16 a[110:111], v2 offset:41984
M v[56:59], a[172:175], a[84:87], v[56:59]
 buffer_load_dwordx4 v15, s[48:51], s22 offen offset:3072   lds
M v[56:59], a[168:171], a[80:83], v[56:59]
 s_sub_u32 s22, s22, 2097024
 v_lshl_or_b32 v22, v0, 2, v22
M v[52:55], a[168:171], a[72:75], v[52:55]
 v_or_b32 v22, s64, v22
M v[52:55], a[172:175], a[76:79], v[52:55]
 ds_read_b64_tr_b16 a[112:113], v3 offset:32768
 ds_read_b64_tr_b16 a[114:115], v3 offset:33792
M v[48:51], a[172:175], a[68:71], v[48:51]
 s_add_u32 m0, s23, 16384
 v_cvt_pk_bf16_f32 v23, v23, v23
M v[48:51], a[168:171], a[64:67], v[48:51]
 buffer_load_dwordx4 v8, s[16:19], s21 offen offset:0  nt lds
M v[44:47], a[168:171], a[56:59], v[44:47]
 v_and_b32 v23, 0xffff0000, v23
M v[44:47], a[172:175], a[60:63], v[44:47]
 s_mov_b32 s64, 104890368
M v[40:43], a[172:175], a[52:55], v[40:43]
 ds_read_b64_tr_b16 a[116:117], v3 offset:40960
 ds_read_b64_tr_b16 a[118:119], v3 offset:41984
M v[40:43], a[168:171], a[48:51], v[40:43]
 buffer_store_dword v24, v22, s[8:11], s64 offen sc1
M v[36:39], a[168:171], a[40:43], v[36:39]
 buffer_load_dwordx4 v9, s[16:19], s21 offen offset:1024  nt lds
M v[36:39], a[172:175], a[44:47], v[36:39]
 s_waitcnt lgkmcnt(6)
M v[32:35], a[172:175], a[36:39], v[32:35]
 buffer_store_dword v23, v22, s[8:11], s64 offen offset:8 sc1
M v[32:35], a[168:171], a[32:35], v[32:35]
 ds_read_b64_tr_b16 a[120:121], v4 offset:32768
 ds_read_b64_tr_b16 a[122:123], v4 offset:33792
M v[64:67], a[160:163], a[32:35], v[64:67]
 ds_read_b128 a[168:171], v5 offset:6144
 ds_read_b128 a[172:175], v6 offset:6144
M v[64:67], a[164:167], a[36:39], v[64:67]
 buffer_load_dwordx4 v10, s[16:19], s21 offen offset:2048  nt lds
M v[68:71], a[164:167], a[44:47], v[68:71]
 v_add_u32 v25, 159744, v7
M v[68:71], a[160:163], a[40:43], v[68:71]
 ds_read_b128 v[16:19], v25
M v[72:75], a[160:163], a[48:51], v[72:75]
 ds_read_b64_tr_b16 a[124:125], v4 offset:40960
 ds_read_b64_tr_b16 a[126:127], v4 offset:41984
M v[72:75], a[164:167], a[52:55], v[72:75]
 ds_read_b128 v[28:31], v25 offset:1024
 v_sub_f32 v48, v48, v27
M v[76:79], a[164:167], a[60:63], v[76:79]
 buffer_load_dwordx4 v11, s[16:19], s21 offen offset:3072  nt lds
M v[76:79], a[160:163], a[56:59], v[76:79]
 s_add_u32 s21, s21, 524160
 ds_read_b128 v[20:23], v25 offset:2048
 v_sub_f32 v49, v49, v27
M v[80:83], a[160:163], a[64:67], v[80:83]
 v_sub_f32 v50, v50, v27
 v_sub_f32 v51, v51, v27
M v[80:83], a[164:167], a[68:71], v[80:83]
 v_sub_f32 v52, v52, v27
 v_sub_f32 v53, v53, v27
M v[84:87], a[164:167], a[76:79], v[84:87]
 v_sub_f32 v54, v54, v27
 v_sub_f32 v55, v55, v27
M v[84:87], a[160:163], a[72:75], v[84:87]
 v_sub_f32 v56, v56, v27
 v_sub_f32 v57, v57, v27
M v[88:91], a[160:163], a[80:83], v[88:91]
 v_sub_f32 v58, v58, v27
 v_sub_f32 v59, v59, v27
M v[88:91], a[164:167], a[84:87], v[88:91]
 s_waitcnt lgkmcnt(5)
 v_sub_f32 v60, v60, v27
 v_sub_f32 v61, v61, v27
M v[92:95], a[164:167], a[92:95], v[92:95]
 s_waitcnt vmcnt(22) lgkmcnt(0)
 v_sub_f32 v62, v62, v27
 v_sub_f32 v63, v63, v27
M v[92:95], a[160:163], a[88:91], v[92:95]
 s_barrier
M v[124:127], a[168:171], a[88:91], v[124:127]
 ds_read_b128 a[160:163], v5 offset:16384
 ds_read_b128 a[164:167], v6 offset:16384
M v[124:127], a[172:175], a[92:95], v[124:127]
 v_add_f32 v16, v28, v16
M v[120:123], a[172:175], a[84:87], v[120:123]
 s_add_u32 m0, s24, 0
 ds_read_b64_tr_b16 a[128:129], v1 offset:49152
 ds_read_b64_tr_b16 a[130:131], v1 offset:50176
M v[120:123], a[168:171], a[80:83], v[120:123]
 buffer_load_dwordx4 v12, s[48:51], s22 offen offset:0   lds
M v[116:119], a[168:171], a[72:75], v[116:119]
 v_add_f32 v17, v29, v17
 v_sub_f32 v80, v80, v27
M v[116:119], a[172:175], a[76:79], v[116:119]
 v_add_f32 v18, v30, v18
 v_sub_f32 v81, v81, v27
M v[112:115], a[172:175], a[68:71], v[112:115]
 v_add_f32 v19, v31, v19
 v_sub_f32 v82, v82, v27
M v[112:115], a[168:171], a[64:67], v[112:115]
 ds_read_b128 v[28:31], v25 offset:3072
 v_sub_f32 v83, v83, v27
M v[108:111], a[168:171], a[56:59], v[108:111]
 v_cvt_pk_bf16_f32 v25, v16, v17
 v_sub_f32 v84, v84, v27
M v[108:111], a[172:175], a[60:63], v[108:111]
 ds_read_b64_tr_b16 a[132:133], v1 offset:57344
 ds_read_b64_tr_b16 a[134:135], v1 offset:58368
M v[104:107], a[172:175], a[52:55], v[104:107]
 buffer_load_dwordx4 v13, s[48:51], s22 offen offset:1024   lds
M v[104:107], a[168:171], a[48:51], v[104:107]
 v_lshlrev_b32 v16, 16, v25
 v_sub_f32 v85, v85, v27
M v[100:103], a[168:171], a[40:43], v[100:103]
 v_and_b32 v17, 0xffff0000, v25
 v_sub_f32 v86, v86, v27
M v[100:103], a[172:175], a[44:47], v[100:103]
 s_waitcnt lgkmcnt(5)
 v_cvt_pk_bf16_f32 v25, v18, v19
 v_sub_f32 v87, v87, v27
M v[96:99], a[172:175], a[36:39], v[96:99]
 v_lshlrev_b32 v18, 16, v25
 v_sub_f32 v88, v88, v27
M v[96:99], a[168:171], a[32:35], v[96:99]
 v_and_b32 v19, 0xffff0000, v25
 v_sub_f32 v89, v89, v27
M v[128:131], a[160:163], a[32:35], v[128:131]
 ds_read_b128 a[168:171], v5 offset:18432
 ds_read_b128 a[172:175], v6 offset:18432
M v[128:131], a[164:167], a[36:39], v[128:131]
 ds_read_b64_tr_b16 a[136:137], v2 offset:49152
 ds_read_b64_tr_b16 a[138:139], v2 offset:50176
M v[132:135], a[164:167], a[44:47], v[132:135]
 buffer_load_dwordx4 v14, s[48:51], s22 offen offset:2048   lds
M v[132:135], a[160:163], a[40:43], v[132:135]
 s_waitcnt lgkmcnt(6)
 v_add_f32 v20, v28, v20
 v_sub_f32 v90, v90, v27
M v[136:139], a[160:163], a[48:51], v[136:139]
 v_add_f32 v21, v29, v21
 v_sub_f32 v91, v91, v27
M v[136:139], a[164:167], a[52:55], v[136:139]
 v_add_f32 v22, v30, v22
 v_sub_f32 v92, v92, v27
M v[140:143], a[164:167], a[60:63], v[140:143]
 v_add_f32 v23, v31, v23
 v_sub_f32 v93, v93, v27
M v[140:143], a[160:163], a[56:59], v[140:143]
 ds_read_b64_tr_b16 a[140:141], v2 offset:57344
 ds_read_b64_tr_b16 a[142:143], v2 offset:58368
M v[144:147], a[160:163], a[64:67], v[144:147]
 buffer_load_dwordx4 v15, s[48:51], s22 offen offset:3072   lds
M v[144:147], a[164:167], a[68:71], v[144:147]
 s_add_u32 s22, s22, 2097152
 v_mul_f32 v28, 0xbfb8aa3b, v16
 v_sub_f32 v94, v94, v27
M v[148:151], a[164:167], a[76:79], v[148:151]
 v_mul_f32 v29, 0xbfb8aa3b, v17
 v_sub_f32 v95, v95, v27
M v[148:151], a[160:163], a[72:75], v[148:151]
 v_mul_f32 v30, 0xbfb8aa3b, v18
 v_sub_f32 v112, v112, v27
M v[152:155], a[160:163], a[80:83], v[152:155]
 v_mul_f32 v31, 0xbfb8aa3b, v19
 v_sub_f32 v113, v113, v27
M v[152:155], a[164:167], a[84:87], v[152:155]
 s_waitcnt lgkmcnt(4)
 v_exp_f32 v28, v28
M v[156:159], a[164:167], a[92:95], v[156:159]
 s_add_u32 m0, s23, 32768
 ds_read_b64_tr_b16 a[144:145], v3 offset:49152
 ds_read_b64_tr_b16 a[146:147], v3 offset:50176
M v[156:159], a[160:163], a[88:91], v[156:159]
 buffer_load_dwordx4 v8, s[16:19], s21 offen offset:0  nt lds
M v[188:191], a[168:171], a[88:91], v[188:191]
 ds_read_b128 a[160:163], v5 offset:20480
 ds_read_b128 a[164:167], v6 offset:20480
M v[188:191], a[172:175], a[92:95], v[188:191]
 v_exp_f32 v29, v29
M v[184:187], a[172:175], a[84:87], v[184:187]
 v_exp_f32 v30, v30
M v[184:187], a[168:171], a[80:83], v[184:187]
 v_exp_f32 v31, v31
M v[180:183], a[168:171], a[72:75], v[180:183]
 v_cvt_pk_bf16_f32 v25, v20, v21
 v_sub_f32 v114, v114, v27
M v[180:183], a[172:175], a[76:79], v[180:183]
 ds_read_b64_tr_b16 a[148:149], v3 offset:57344
 ds_read_b64_tr_b16 a[150:151], v3 offset:58368
M v[176:179], a[172:175], a[68:71], v[176:179]
 buffer_load_dwordx4 v9, s[16:19], s21 offen offset:1024  nt lds
M v[176:179], a[168:171], a[64:67], v[176:179]
 v_lshlrev_b32 v20, 16, v25
 v_sub_f32 v115, v115, v27
M v[172:175], a[168:171], a[56:59], v[172:175]
 v_and_b32 v21, 0xffff0000, v25
 v_sub_f32 v116, v116, v27
M v[172:175], a[172:175], a[60:63], v[172:175]
 v_cvt_pk_bf16_f32 v25, v22, v23
 v_sub_f32 v117, v117, v27
M v[168:171], a[172:175], a[52:55], v[168:171]
 v_lshlrev_b32 v22, 16, v25
 v_sub_f32 v118, v118, v27
M v[168:171], a[168:171], a[48:51], v[168:171]
 v_and_b32 v23, 0xffff0000, v25
 v_sub_f32 v119, v119, v27
M v[164:167], a[168:171], a[40:43], v[164:167]
 ds_read_b64_tr_b16 a[152:153], v4 offset:49152
 ds_read_b64_tr_b16 a[154:155], v4 offset:50176
M v[164:167], a[172:175], a[44:47], v[164:167]
 s_waitcnt lgkmcnt(4)
 v_add_f32 v28, 1.0, v28
 v_sub_f32 v120, v120, v27
M v[160:163], a[172:175], a[36:39], v[160:163]
 buffer_load_dwordx4 v10, s[16:19], s21 offen offset:2048  nt lds
M v[160:163], a[168:171], a[32:35], v[160:163]
 v_add_f32 v29, 1.0, v29
 v_sub_f32 v121, v121, v27
M v[192:195], a[160:163], a[32:35], v[192:195]
 ds_read_b128 a[168:171], v5 offset:22528
 ds_read_b128 a[172:175], v6 offset:22528
M v[192:195], a[164:167], a[36:39], v[192:195]
 v_add_f32 v30, 1.0, v30
 v_sub_f32 v122, v122, v27
M v[196:199], a[164:167], a[44:47], v[196:199]
 v_add_f32 v31, 1.0, v31
 v_sub_f32 v123, v123, v27
M v[196:199], a[160:163], a[40:43], v[196:199]
 ds_read_b64_tr_b16 a[156:157], v4 offset:57344
 ds_read_b64_tr_b16 a[158:159], v4 offset:58368
M v[200:203], a[160:163], a[48:51], v[200:203]
 buffer_load_dwordx4 v11, s[16:19], s21 offen offset:3072  nt lds
M v[200:203], a[164:167], a[52:55], v[200:203]
 s_add_u32 s21, s21, 128
 v_rcp_f32 v28, v28
M v[204:207], a[164:167], a[60:63], v[204:207]
 v_rcp_f32 v29, v29
M v[204:207], a[160:163], a[56:59], v[204:207]
 v_rcp_f32 v30, v30
M v[208:211], a[160:163], a[64:67], v[208:211]
 v_rcp_f32 v31, v31
M v[208:211], a[164:167], a[68:71], v[208:211]
 v_mul_f32 v16, v28, v16
 v_sub_f32 v124, v124, v27
M v[212:215], a[164:167], a[76:79], v[212:215]
 v_mul_f32 v17, v29, v17
 v_sub_f32 v125, v125, v27
M v[212:215], a[160:163], a[72:75], v[212:215]
 v_mul_f32 v18, v30, v18
 v_sub_f32 v126, v126, v27
M v[216:219], a[160:163], a[80:83], v[216:219]
 v_mul_f32 v19, v31, v19
 v_sub_f32 v127, v127, v27
M v[216:219], a[164:167], a[84:87], v[216:219]
 s_waitcnt lgkmcnt(2)
 v_cvt_pk_bf16_f32 v25, v16, v17
 v_sub_f32 v128, v128, v27
M v[220:223], a[164:167], a[92:95], v[220:223]
 s_waitcnt vmcnt(22) lgkmcnt(0)
 v_lshlrev_b32 v16, 16, v25
 v_sub_f32 v129, v129, v27
M v[220:223], a[160:163], a[88:91], v[220:223]
 s_barrier
M v[252:255], a[168:171], a[88:91], v[252:255]
 ds_read_b128 a[160:163], v5 offset:32768
 ds_read_b128 a[164:167], v6 offset:32768
M v[252:255], a[172:175], a[92:95], v[252:255]
 v_and_b32 v17, 0xffff0000, v25
 v_sub_f32 v130, v130, v27
M v[248:251], a[172:175], a[84:87], v[248:251]
 v_cvt_pk_bf16_f32 v25, v18, v19
 v_sub_f32 v131, v131, v27
M v[248:251], a[168:171], a[80:83], v[248:251]
 v_lshlrev_b32 v18, 16, v25
 v_sub_f32 v132, v132, v27
M v[244:247], a[168:171], a[72:75], v[244:247]
 v_and_b32 v19, 0xffff0000, v25
 v_sub_f32 v133, v133, v27
M v[244:247], a[172:175], a[76:79], v[244:247]
 v_mul_f32 v16, v20, v16
 v_sub_f32 v134, v134, v27
M v[240:243], a[172:175], a[68:71], v[240:243]
 v_mul_f32 v17, v21, v17
 v_sub_f32 v135, v135, v27
M v[240:243], a[168:171], a[64:67], v[240:243]
 v_mul_f32 v18, v22, v18
 v_sub_f32 v136, v136, v27
M v[236:239], a[168:171], a[56:59], v[236:239]
 v_mul_f32 v19, v23, v19
 v_sub_f32 v137, v137, v27
M v[236:239], a[172:175], a[60:63], v[236:239]
 v_cvt_pk_bf16_f32 v16, v16, v17
 v_sub_f32 v138, v138, v27
M v[232:235], a[172:175], a[52:55], v[232:235]
 v_cvt_pk_bf16_f32 v17, v18, v19
 v_sub_f32 v139, v139, v27
M v[232:235], a[168:171], a[48:51], v[232:235]
 v_sub_f32 v140, v140, v27
 v_sub_f32 v141, v141, v27
M v[228:231], a[168:171], a[40:43], v[228:231]
 v_sub_f32 v142, v142, v27
 v_sub_f32 v143, v143, v27
M v[228:231], a[172:175], a[44:47], v[228:231]
 s_waitcnt lgkmcnt(0)
 v_sub_f32 v144, v144, v27
 v_sub_f32 v145, v145, v27
M v[224:227], a[172:175], a[36:39], v[224:227]
 v_sub_f32 v146, v146, v27
 v_sub_f32 v147, v147, v27
M v[224:227], a[168:171], a[32:35], v[224:227]
 v_sub_f32 v148, v148, v27
 v_sub_f32 v149, v149, v27
M a[0:3], a[160:163], a[96:99], a[0:3]
 ds_read_b128 a[168:171], v5 offset:34816
 ds_read_b128 a[172:175], v6 offset:34816
M a[0:3], a[164:167], a[100:103], a[0:3]
 ds_read_b64_tr_b16 a[32:33], v1 offset:0
 ds_read_b64_tr_b16 a[34:35], v1 offset:1024
M a[4:7], a[164:167], a[108:111], a[4:7]
 s_add_u32 m0, s24, 16384
 v_lshrrev_b32 v28, 2, v0
 v_lshlrev_b32 v28, 8, v28
M a[4:7], a[160:163], a[104:107], a[4:7]
 buffer_load_dwordx4 v12, s[48:51], s22 offen offset:0   lds
M a[8:11], a[160:163], a[112:115], a[8:11]
 v_and_b32 v29, 3, v0
 v_lshl_add_u32 v28, v29, 3, v28
M a[8:11], a[164:167], a[116:119], a[8:11]
 v_add_u32 v28, s87, v28
 v_sub_f32 v150, v150, v27
M a[12:15], a[164:167], a[124:127], a[12:15]
 s_waitcnt vmcnt(19)
 ds_read_b64_tr_b16 a[36:37], v1 offset:8192
 ds_read_b64_tr_b16 a[38:39], v1 offset:9216
M a[12:15], a[160:163], a[120:123], a[12:15]
 ds_read_b64_tr_b16 a[176:177], v28 offset:0
 v_sub_f32 v151, v151, v27
M a[16:19], a[160:163], a[128:131], a[16:19]
 buffer_load_dwordx4 v13, s[48:51], s22 offen offset:1024   lds
M a[16:19], a[164:167], a[132:135], a[16:19]
 ds_read_b64_tr_b16 a[178:179], v28 offset:32
 ds_read_b64_tr_b16 a[180:181], v28 offset:64
M a[20:23], a[164:167], a[140:143], a[20:23]
 ds_read_b64_tr_b16 a[182:183], v28 offset:96
 v_sub_f32 v152, v152, v27
M a[20:23], a[160:163], a[136:139], a[20:23]
 ds_read_b64_tr_b16 a[40:41], v2 offset:0
 ds_read_b64_tr_b16 a[42:43], v2 offset:1024
M a[24:27], a[160:163], a[144:147], a[24:27]
 ds_read_b64_tr_b16 a[184:185], v28 offset:128
 v_sub_f32 v153, v153, v27
M a[24:27], a[164:167], a[148:151], a[24:27]
 s_waitcnt lgkmcnt(11)
 ds_read_b64_tr_b16 a[186:187], v28 offset:160
 ds_read_b64_tr_b16 a[188:189], v28 offset:192
M a[28:31], a[164:167], a[156:159], a[28:31]
 buffer_load_dwordx4 v14, s[48:51], s22 offen offset:2048   lds
M a[28:31], a[160:163], a[152:155], a[28:31]
 v_sub_f32 v154, v154, v27
 v_sub_f32 v155, v155, v27
M v[60:63], a[168:171], a[152:155], v[60:63]
 ds_read_b128 a[160:163], v5 offset:36864
 ds_read_b128 a[164:167], v6 offset:36864
M v[60:63], a[172:175], a[156:159], v[60:63]
 ds_read_b64_tr_b16 a[44:45], v2 offset:8192
 ds_read_b64_tr_b16 a[46:47], v2 offset:9216
M v[56:59], a[172:175], a[148:151], v[56:59]
 buffer_load_dwordx4 v15, s[48:51], s22 offen offset:3072   lds
M v[56:59], a[168:171], a[144:147], v[56:59]
 s_sub_u32 s22, s22, 2097024
 v_sub_f32 v156, v156, v27
 v_sub_f32 v157, v157, v27
M v[52:55], a[168:171], a[136:139], v[52:55]
 v_sub_f32 v158, v158, v27
 v_sub_f32 v159, v159, v27
M v[52:55], a[172:175], a[140:143], v[52:55]
 ds_read_b64_tr_b16 a[48:49], v3 offset:0
 ds_read_b64_tr_b16 a[50:51], v3 offset:1024
M v[48:51], a[172:175], a[132:135], v[48:51]
 s_add_u32 m0, s23, 49152
M v[48:51], a[168:171], a[128:131], v[48:51]
 buffer_load_dwordx4 v8, s[16:19], s21 offen offset:0  nt lds
M v[44:47], a[168:171], a[120:123], v[44:47]
M v[44:47], a[172:175], a[124:127], v[44:47]
M v[40:43], a[172:175], a[116:119], v[40:43]
 ds_read_b64_tr_b16 a[52:53], v3 offset:8192
 ds_read_b64_tr_b16 a[54:55], v3 offset:9216
M v[40:43], a[168:171], a[112:115], v[40:43]
M v[36:39], a[168:171], a[104:107], v[36:39]
 buffer_load_dwordx4 v9, s[16:19], s21 offen offset:1024  nt lds
M v[36:39], a[172:175], a[108:111], v[36:39]
 s_waitcnt lgkmcnt(6)
M v[32:35], a[172:175], a[100:103], v[32:35]
M v[32:35], a[168:171], a[96:99], v[32:35]
 ds_read_b64_tr_b16 a[56:57], v4 offset:0
 ds_read_b64_tr_b16 a[58:59], v4 offset:1024
M v[64:67], a[160:163], a[96:99], v[64:67]
 ds_read_b128 a[168:171], v5 offset:38912
 ds_read_b128 a[172:175], v6 offset:38912
M v[64:67], a[164:167], a[100:103], v[64:67]
 buffer_load_dwordx4 v10, s[16:19], s21 offen offset:2048  nt lds
M v[68:71], a[164:167], a[108:111], v[68:71]
M v[68:71], a[160:163], a[104:107], v[68:71]
M v[72:75], a[160:163], a[112:115], v[72:75]
 ds_read_b64_tr_b16 a[60:61], v4 offset:8192
 ds_read_b64_tr_b16 a[62:63], v4 offset:9216
M v[72:75], a[164:167], a[116:119], v[72:75]
M v[76:79], a[164:167], a[124:127], v[76:79]
 buffer_load_dwordx4 v11, s[16:19], s21 offen offset:3072  nt lds
M v[76:79], a[160:163], a[120:123], v[76:79]
 s_add_u32 s21, s21, 524160
M v[80:83], a[160:163], a[128:131], v[80:83]
M v[80:83], a[164:167], a[132:135], v[80:83]
M v[84:87], a[164:167], a[140:143], v[84:87]
M v[84:87], a[160:163], a[136:139], v[84:87]
M v[88:91], a[160:163], a[144:147], v[88:91]
M v[88:91], a[164:167], a[148:151], v[88:91]
 s_waitcnt lgkmcnt(2)
M v[92:95], a[164:167], a[156:159], v[92:95]
 s_waitcnt vmcnt(16) lgkmcnt(0)
M v[92:95], a[160:163], a[152:155], v[92:95]
 s_barrier
 v_mfma_f32_16x16x16_bf16 a[208:211], a[176:177], v[16:17], 0
 v_mfma_f32_16x16x16_bf16 a[212:215], a[178:179], v[16:17], 0
 v_mfma_f32_16x16x16_bf16 a[216:219], a[180:181], v[16:17], 0
 v_mfma_f32_16x16x16_bf16 a[220:223], a[182:183], v[16:17], 0
 v_mfma_f32_16x16x16_bf16 a[224:227], a[184:185], v[16:17], 0
 v_mfma_f32_16x16x16_bf16 a[228:231], a[186:187], v[16:17], 0
 v_mfma_f32_16x16x16_bf16 a[232:235], a[188:189], v[16:17], 0
M v[124:127], a[168:171], a[152:155], v[124:127]
 ds_read_b128 a[160:163], v5 offset:49152
 ds_read_b128 a[164:167], v6 offset:49152
M v[124:127], a[172:175], a[156:159], v[124:127]
M v[120:123], a[172:175], a[148:151], v[120:123]
 s_add_u32 m0, s24, 32768
 ds_read_b64_tr_b16 a[64:65], v1 offset:16384
 ds_read_b64_tr_b16 a[66:67], v1 offset:17408
M v[120:123], a[168:171], a[144:147], v[120:123]
 buffer_load_dwordx4 v12, s[48:51], s22 offen offset:0   lds
M v[116:119], a[168:171], a[136:139], v[116:119]
M v[116:119], a[172:175], a[140:143], v[116:119]
M v[112:115], a[172:175], a[132:135], v[112:115]
M v[112:115], a[168:171], a[128:131], v[112:115]
M v[108:111], a[168:171], a[120:123], v[108:111]
M v[108:111], a[172:175], a[124:127], v[108:111]
 ds_read_b64_tr_b16 a[68:69], v1 offset:24576
 ds_read_b64_tr_b16 a[70:71], v1 offset:25600
M v[104:107], a[172:175], a[116:119], v[104:107]
 buffer_load_dwordx4 v13, s[48:51], s22 offen offset:1024   lds
M v[104:107], a[168:171], a[112:115], v[104:107]
M v[100:103], a[168:171], a[104:107], v[100:103]
M v[100:103], a[172:175], a[108:111], v[100:103]
 s_waitcnt lgkmcnt(4)
M v[96:99], a[172:175], a[100:103], v[96:99]
M v[96:99], a[168:171], a[96:99], v[96:99]
M v[128:131], a[160:163], a[96:99], v[128:131]
 ds_read_b128 a[168:171], v5 offset:51200
 ds_read_b128 a[172:175], v6 offset:51200
M v[128:131], a[164:167], a[100:103], v[128:131]
 ds_read_b64_tr_b16 a[72:73], v2 offset:16384
 ds_read_b64_tr_b16 a[74:75], v2 offset:17408
M v[132:135], a[164:167], a[108:111], v[132:135]
 buffer_load_dwordx4 v14, s[48:51], s22 offen offset:2048   lds
M v[132:135], a[160:163], a[104:107], v[132:135]
M v[136:139], a[160:163], a[112:115], v[136:139]
M v[136:139], a[164:167], a[116:119], v[136:139]
M v[140:143], a[164:167], a[124:127], v[140:143]
M v[140:143], a[160:163], a[120:123], v[140:143]
 ds_read_b64_tr_b16 a[76:77], v2 offset:24576
 ds_read_b64_tr_b16 a[78:79], v2 offset:25600
M v[144:147], a[160:163], a[128:131], v[144:147]
 buffer_load_dwordx4 v15, s[48:51], s22 offen offset:3072   lds
M v[144:147], a[164:167], a[132:135], v[144:147]
 s_add_u32 s22, s22, 2097152
M v[148:151], a[164:167], a[140:143], v[148:151]
M v[148:151], a[160:163], a[136:139], v[148:151]
M v[152:155], a[160:163], a[144:147], v[152:155]
M v[152:155], a[164:167], a[148:151], v[152:155]
 s_waitcnt lgkmcnt(4)
M v[156:159], a[164:167], a[156:159], v[156:159]
 s_add_u32 m0, s23, 0
 ds_read_b64_tr_b16 a[80:81], v3 offset:16384
 ds_read_b64_tr_b16 a[82:83], v3 offset:17408
M v[156:159], a[160:163], a[152:155], v[156:159]
 buffer_load_dwordx4 v8, s[52:55], s28 offen offset:0   lds
M v[188:191], a[168:171], a[152:155], v[188:191]
 ds_read_b128 a[160:163], v5 offset:53248
 ds_read_b128 a[164:167], v6 offset:53248
M v[188:191], a[172:175], a[156:159], v[188:191]
M v[184:187], a[172:175], a[148:151], v[184:187]
M v[184:187], a[168:171], a[144:147], v[184:187]
M v[180:183], a[168:171], a[136:139], v[180:183]
M v[180:183], a[172:175], a[140:143], v[180:183]
 ds_read_b64_tr_b16 a[84:85], v3 offset:24576
 ds_read_b64_tr_b16 a[86:87], v3 offset:25600
M v[176:179], a[172:175], a[132:135], v[176:179]
 buffer_load_dwordx4 v9, s[52:55], s28 offen offset:1024   lds
M v[176:179], a[168:171], a[128:131], v[176:179]
M v[172:175], a[168:171], a[120:123], v[172:175]
M v[172:175], a[172:175], a[124:127], v[172:175]
M v[168:171], a[172:175], a[116:119], v[168:171]
M v[168:171], a[168:171], a[112:115], v[168:171]
M v[164:167], a[168:171], a[104:107], v[164:167]
 ds_read_b64_tr_b16 a[88:89], v4 offset:16384
 ds_read_b64_tr_b16 a[90:91], v4 offset:17408
M v[164:167], a[172:175], a[108:111], v[164:167]
 s_waitcnt lgkmcnt(4)
M v[160:163], a[172:175], a[100:103], v[160:163]
 buffer_load_dwordx4 v10, s[52:55], s28 offen offset:2048   lds
M v[160:163], a[168:171], a[96:99], v[160:163]
M v[192:195], a[160:163], a[96:99], v[192:195]
 ds_read_b128 a[168:171], v5 offset:55296
 ds_read_b128 a[172:175], v6 offset:55296
M v[192:195], a[164:167], a[100:103], v[192:195]
M v[196:199], a[164:167], a[108:111], v[196:199]
M v[196:199], a[160:163], a[104:107], v[196:199]
 ds_read_b64_tr_b16 a[92:93], v4 offset:24576
 ds_read_b64_tr_b16 a[94:95], v4 offset:25600
M v[200:203], a[160:163], a[112:115], v[200:203]
 buffer_load_dwordx4 v11, s[52:55], s28 offen offset:3072   lds
M v[200:203], a[164:167], a[116:119], v[200:203]
 s_add_u32 s28, s28, 128
 v_sub_f32 v160, v160, v27
 v_sub_f32 v161, v161, v27
M v[204:207], a[164:167], a[124:127], v[204:207]
 v_sub_f32 v162, v162, v27
 v_sub_f32 v163, v163, v27
M v[204:207], a[160:163], a[120:123], v[204:207]
 v_sub_f32 v164, v164, v27
 v_sub_f32 v165, v165, v27
M v[208:211], a[160:163], a[128:131], v[208:211]
 v_sub_f32 v166, v166, v27
 v_sub_f32 v167, v167, v27
M v[208:211], a[164:167], a[132:135], v[208:211]
 v_sub_f32 v168, v168, v27
 v_sub_f32 v169, v169, v27
M v[212:215], a[164:167], a[140:143], v[212:215]
 v_sub_f32 v170, v170, v27
 v_sub_f32 v171, v171, v27
M v[212:215], a[160:163], a[136:139], v[212:215]
 v_sub_f32 v172, v172, v27
 v_sub_f32 v173, v173, v27
M v[216:219], a[160:163], a[144:147], v[216:219]
 v_sub_f32 v174, v174, v27
 v_sub_f32 v175, v175, v27
M v[216:219], a[164:167], a[148:151], v[216:219]
 s_waitcnt lgkmcnt(2)
 v_sub_f32 v176, v176, v27
 v_sub_f32 v177, v177, v27
M v[220:223], a[164:167], a[156:159], v[220:223]
 s_waitcnt vmcnt(16) lgkmcnt(0)
 v_sub_f32 v178, v178, v27
 v_sub_f32 v179, v179, v27
M v[220:223], a[160:163], a[152:155], v[220:223]
 s_barrier
M v[252:255], a[168:171], a[152:155], v[252:255]
 ds_read_b128 a[160:163], v5 offset:0
 ds_read_b128 a[164:167], v6 offset:0
M v[252:255], a[172:175], a[156:159], v[252:255]
 v_and_b32 v26, 48, v0
 v_lshlrev_b32 v26, 17, v26
M v[248:251], a[172:175], a[148:151], v[248:251]
 v_or_b32 v26, v26, v0
 v_lshl_add_u32 v26, v26, 7, s95
M v[248:251], a[168:171], a[144:147], v[248:251]
 buffer_load_dword a240, v26, s[76:79], 0 offen offset:0
M v[244:247], a[168:171], a[136:139], v[244:247]
 v_sub_f32 v180, v180, v27
 v_sub_f32 v181, v181, v27
M v[244:247], a[172:175], a[140:143], v[244:247]
 v_sub_f32 v182, v182, v27
 v_sub_f32 v183, v183, v27
M v[240:243], a[172:175], a[132:135], v[240:243]
 v_sub_f32 v184, v184, v27
 v_sub_f32 v185, v185, v27
M v[240:243], a[168:171], a[128:131], v[240:243]
 v_sub_f32 v186, v186, v27
 v_sub_f32 v187, v187, v27
M v[236:239], a[168:171], a[120:123], v[236:239]
 v_sub_f32 v188, v188, v27
 v_sub_f32 v189, v189, v27
M v[236:239], a[172:175], a[124:127], v[236:239]
 v_sub_f32 v190, v190, v27
 v_sub_f32 v191, v191, v27
M v[232:235], a[172:175], a[116:119], v[232:235]
 v_sub_f32 v192, v192, v27
 v_sub_f32 v193, v193, v27
M v[232:235], a[168:171], a[112:115], v[232:235]
 v_sub_f32 v194, v194, v27
 v_sub_f32 v195, v195, v27
M v[228:231], a[168:171], a[104:107], v[228:231]
 v_sub_f32 v196, v196, v27
 v_sub_f32 v197, v197, v27
M v[228:231], a[172:175], a[108:111], v[228:231]
 s_waitcnt lgkmcnt(0)
 v_sub_f32 v198, v198, v27
 v_sub_f32 v199, v199, v27
M v[224:227], a[172:175], a[100:103], v[224:227]
 v_sub_f32 v200, v200, v27
 v_sub_f32 v201, v201, v27
M v[224:227], a[168:171], a[96:99], v[224:227]
 v_sub_f32 v202, v202, v27
 v_sub_f32 v203, v203, v27
M a[0:3], a[160:163], a[32:35], a[0:3]
 ds_read_b128 a[168:171], v5 offset:2048
 ds_read_b128 a[172:175], v6 offset:2048
M a[0:3], a[164:167], a[36:39], a[0:3]
 ds_read_b64_tr_b16 a[96:97], v1 offset:32768
 ds_read_b64_tr_b16 a[98:99], v1 offset:33792
M a[4:7], a[164:167], a[44:47], a[4:7]
 s_add_u32 m0, s24, 49152
 v_lshrrev_b32 v28, 4, v0
 v_add_u32 v28, 0, v28
M a[4:7], a[160:163], a[40:43], a[4:7]
 buffer_load_dwordx4 v12, s[48:51], s22 offen offset:0   lds
M a[8:11], a[160:163], a[48:51], a[8:11]
 v_and_b32 v29, 7, v0
 v_xor_b32 v28, v28, v29
M a[8:11], a[164:167], a[52:55], a[8:11]
 v_lshlrev_b32 v28, 4, v28
 v_lshrrev_b32 v29, 3, v0
M a[12:15], a[164:167], a[60:63], a[12:15]
 ds_read_b64_tr_b16 a[100:101], v1 offset:40960
 ds_read_b64_tr_b16 a[102:103], v1 offset:41984
M a[12:15], a[160:163], a[56:59], a[12:15]
 buffer_load_dwordx4 v13, s[48:51], s22 offen offset:1024   lds
M a[16:19], a[160:163], a[64:67], a[16:19]
 v_mul_u32_u24 v29, 896, v29
 s_mul_i32 s64, s20, 28672
M a[16:19], a[164:167], a[68:71], a[16:19]
 buffer_load_dwordx4 v14, s[48:51], s22 offen offset:2048   lds
M a[20:23], a[164:167], a[76:79], a[20:23]
 s_add_u32 s64, s64, 0
 v_add3_u32 v16, v29, v28, s64
M a[20:23], a[160:163], a[72:75], a[20:23]
 ds_read_b64_tr_b16 a[104:105], v2 offset:32768
 ds_read_b64_tr_b16 a[106:107], v2 offset:33792
M a[24:27], a[160:163], a[80:83], a[24:27]
 v_add_u32 v18, 12288, v16
 v_lshrrev_b32 v28, 4, v0
M a[24:27], a[164:167], a[84:87], a[24:27]
 s_waitcnt lgkmcnt(6)
 v_add_u32 v28, 4, v28
 v_and_b32 v29, 7, v0
M a[28:31], a[164:167], a[92:95], a[28:31]
 buffer_load_dwordx4 v15, s[48:51], s22 offen offset:3072   lds
M a[28:31], a[160:163], a[88:91], a[28:31]
 s_sub_u32 s22, s22, 2097024
 v_xor_b32 v28, v28, v29
 v_lshlrev_b32 v28, 4, v28
M v[60:63], a[168:171], a[88:91], v[60:63]
 s_add_u32 m0, s23, 16384
 ds_read_b128 a[160:163], v5 offset:4096
 ds_read_b128 a[164:167], v6 offset:4096
M v[60:63], a[172:175], a[92:95], v[60:63]
 ds_read_b64_tr_b16 a[108:109], v2 offset:40960
 ds_read_b64_tr_b16 a[110:111], v2 offset:41984
M v[56:59], a[172:175], a[84:87], v[56:59]
 buffer_load_dwordx4 v8, s[52:55], s28 offen offset:0   lds
M v[56:59], a[168:171], a[80:83], v[56:59]
 v_lshrrev_b32 v29, 3, v0
 v_mul_u32_u24 v29, 896, v29
M v[52:55], a[168:171], a[72:75], v[52:55]
 buffer_load_dwordx4 v9, s[52:55], s28 offen offset:1024   lds
M v[52:55], a[172:175], a[76:79], v[52:55]
 ds_read_b64_tr_b16 a[112:113], v3 offset:32768
 ds_read_b64_tr_b16 a[114:115], v3 offset:33792
M v[48:51], a[172:175], a[68:71], v[48:51]
 s_mul_i32 s64, s20, 28672
 s_add_u32 s64, s64, 6144
M v[48:51], a[168:171], a[64:67], v[48:51]
 buffer_load_dwordx4 v10, s[52:55], s28 offen offset:2048   lds
M v[44:47], a[168:171], a[56:59], v[44:47]
 v_add3_u32 v17, v29, v28, s64
 v_add_u32 v19, 12288, v17
M v[44:47], a[172:175], a[60:63], v[44:47]
 v_add_u32 v20, 0x20000, v1
 v_add_u32 v21, 0x20000, v2
M v[40:43], a[172:175], a[52:55], v[40:43]
 ds_read_b64_tr_b16 a[116:117], v3 offset:40960
 ds_read_b64_tr_b16 a[118:119], v3 offset:41984
M v[40:43], a[168:171], a[48:51], v[40:43]
 buffer_load_dwordx4 v11, s[52:55], s28 offen offset:3072   lds
M v[36:39], a[168:171], a[40:43], v[36:39]
 s_add_u32 s28, s28, 1048448
 v_add_u32 v22, 0x20000, v3
 v_add_u32 v23, 0x20000, v4
M v[36:39], a[172:175], a[44:47], v[36:39]
 s_waitcnt lgkmcnt(6)
 v_sub_f32 v204, v204, v27
 v_sub_f32 v205, v205, v27
M v[32:35], a[172:175], a[36:39], v[32:35]
 s_add_u32 m0, s23, 131072
 v_sub_f32 v206, v206, v27
 v_sub_f32 v207, v207, v27
M v[32:35], a[168:171], a[32:35], v[32:35]
 ds_read_b64_tr_b16 a[120:121], v4 offset:32768
 ds_read_b64_tr_b16 a[122:123], v4 offset:33792
M v[64:67], a[160:163], a[32:35], v[64:67]
 ds_read_b128 a[168:171], v5 offset:6144
 ds_read_b128 a[172:175], v6 offset:6144
M v[64:67], a[164:167], a[36:39], v[64:67]
 buffer_load_dwordx4 v8, s[52:55], s28 offen offset:0   lds
M v[68:71], a[164:167], a[44:47], v[68:71]
 buffer_load_dwordx4 v9, s[52:55], s28 offen offset:1024   lds
M v[68:71], a[160:163], a[40:43], v[68:71]
 v_sub_f32 v208, v208, v27
 v_sub_f32 v209, v209, v27
M v[72:75], a[160:163], a[48:51], v[72:75]
 ds_read_b64_tr_b16 a[124:125], v4 offset:40960
 ds_read_b64_tr_b16 a[126:127], v4 offset:41984
M v[72:75], a[164:167], a[52:55], v[72:75]
 buffer_load_dwordx4 v10, s[52:55], s28 offen offset:2048   lds
M v[76:79], a[164:167], a[60:63], v[76:79]
 v_sub_f32 v210, v210, v27
 v_sub_f32 v211, v211, v27
M v[76:79], a[160:163], a[56:59], v[76:79]
 v_sub_f32 v212, v212, v27
 v_sub_f32 v213, v213, v27
M v[80:83], a[160:163], a[64:67], v[80:83]
 buffer_load_dwordx4 v11, s[52:55], s28 offen offset:3072   lds
M v[80:83], a[164:167], a[68:71], v[80:83]
 s_sub_u32 s28, s28, 524288
 v_sub_f32 v214, v214, v27
 v_sub_f32 v215, v215, v27
M v[84:87], a[164:167], a[76:79], v[84:87]
 v_sub_f32 v216, v216, v27
 v_sub_f32 v217, v217, v27
M v[84:87], a[160:163], a[72:75], v[84:87]
 v_sub_f32 v218, v218, v27
 v_sub_f32 v219, v219, v27
M v[88:91], a[160:163], a[80:83], v[88:91]
 v_sub_f32 v220, v220, v27
 v_sub_f32 v221, v221, v27
M v[88:91], a[164:167], a[84:87], v[88:91]
 s_waitcnt lgkmcnt(2)
 v_sub_f32 v222, v222, v27
 v_sub_f32 v223, v223, v27
M v[92:95], a[164:167], a[92:95], v[92:95]
 s_waitcnt vmcnt(21) lgkmcnt(0)
 v_sub_f32 v224, v224, v27
 v_sub_f32 v225, v225, v27
M v[92:95], a[160:163], a[88:91], v[92:95]
 s_barrier
M v[124:127], a[168:171], a[88:91], v[124:127]
 ds_read_b128 a[160:163], v5 offset:16384
 ds_read_b128 a[164:167], v6 offset:16384
M v[124:127], a[172:175], a[92:95], v[124:127]
 v_sub_f32 v226, v226, v27
 v_sub_f32 v227, v227, v27
M v[120:123], a[172:175], a[84:87], v[120:123]
 s_add_u32 m0, s24, 0
 ds_read_b64_tr_b16 a[128:129], v1 offset:49152
 ds_read_b64_tr_b16 a[130:131], v1 offset:50176
M v[120:123], a[168:171], a[80:83], v[120:123]
 buffer_load_dwordx4 v16, s[56:59], s29 offen offset:0   lds
M v[116:119], a[168:171], a[72:75], v[116:119]
 s_mul_i32 s72, s41, 4352
 v_sub_f32 v228, v228, v27
M v[116:119], a[172:175], a[76:79], v[116:119]
 s_add_u32 s46, s72, 104923136
 v_sub_f32 v229, v229, v27
 v_sub_f32 v230, v230, v27
M v[112:115], a[172:175], a[68:71], v[112:115]
 s_lshl_b32 s45, s42, 7
 s_add_u32 s45, s45, s46
 s_sub_u32 s66, 15, s42
M v[112:115], a[168:171], a[64:67], v[112:115]
 buffer_load_dwordx4 v17, s[56:59], s29 offen offset:1024   lds
M v[108:111], a[168:171], a[56:59], v[108:111]
 s_min_u32 s66, s66, s42
 v_sub_f32 v231, v231, v27
M v[108:111], a[172:175], a[60:63], v[108:111]
 s_lshl_b32 s47, s66, 7
 ds_read_b64_tr_b16 a[132:133], v1 offset:57344
 ds_read_b64_tr_b16 a[134:135], v1 offset:58368
M v[104:107], a[172:175], a[52:55], v[104:107]
 s_add_u32 s47, s47, s46
 v_sub_f32 v232, v232, v27
 v_sub_f32 v233, v233, v27
M v[104:107], a[168:171], a[48:51], v[104:107]
 s_add_u32 s47, s47, 2112
 s_lshl2_add_u32 s47, s20, s47
 s_lshl_b32 s65, s41, 3
M v[100:103], a[168:171], a[40:43], v[100:103]
 buffer_load_dwordx4 v18, s[56:59], s29 offen offset:2048   lds
M v[100:103], a[172:175], a[44:47], v[100:103]
 s_waitcnt lgkmcnt(4)
 s_add_u32 s65, s65, s66
 v_sub_f32 v234, v234, v27
M v[96:99], a[172:175], a[36:39], v[96:99]
 s_mul_i32 s34, s65, 73728
 v_sub_f32 v235, v235, v27
 v_sub_f32 v236, v236, v27
M v[96:99], a[168:171], a[32:35], v[96:99]
 s_add_u32 s34, s34, 50331648
 v_sub_f32 v237, v237, v27
 v_sub_f32 v238, v238, v27
M v[128:131], a[160:163], a[32:35], v[128:131]
 s_lshl_b32 s65, s42, 4
 ds_read_b128 a[168:171], v5 offset:18432
 ds_read_b128 a[172:175], v6 offset:18432
M v[128:131], a[164:167], a[36:39], v[128:131]
 s_add_u32 s65, s65, s41
 ds_read_b64_tr_b16 a[136:137], v2 offset:49152
 ds_read_b64_tr_b16 a[138:139], v2 offset:50176
M v[132:135], a[164:167], a[44:47], v[132:135]
 buffer_load_dwordx4 v19, s[56:59], s29 offen offset:3072   lds
M v[132:135], a[160:163], a[40:43], v[132:135]
 s_add_u32 s29, s29, 128
 s_mul_i32 s33, s65, 114688
 v_sub_f32 v239, v239, v27
M v[136:139], a[160:163], a[48:51], v[136:139]
 s_mul_i32 s65, s20, 28672
 s_add_u32 s33, s33, s65
 s_add_u32 s33, s33, 67108864
M v[136:139], a[164:167], a[52:55], v[136:139]
 s_add_u32 m0, s23, 32768
 s_sub_u32 s65, 15, s66
 s_lshl_b32 s65, s65, 16
M v[140:143], a[164:167], a[60:63], v[140:143]
 buffer_load_dwordx4 v8, s[52:55], s28 offen offset:0   lds
M v[140:143], a[160:163], a[56:59], v[140:143]
 ds_read_b64_tr_b16 a[140:141], v2 offset:57344
 ds_read_b64_tr_b16 a[142:143], v2 offset:58368
M v[144:147], a[160:163], a[64:67], v[144:147]
 s_lshl_b32 s64, s41, 20
 v_sub_f32 v240, v240, v27
M v[144:147], a[164:167], a[68:71], v[144:147]
 s_add_u32 s32, s64, s65
 s_lshl_b32 s65, s20, 14
 s_add_u32 s32, s32, s65
M v[148:151], a[164:167], a[76:79], v[148:151]
 buffer_load_dwordx4 v9, s[52:55], s28 offen offset:1024   lds
M v[148:151], a[160:163], a[72:75], v[148:151]
 s_add_u32 s32, s32, 33554432
 v_sub_f32 v241, v241, v27
M v[152:155], a[160:163], a[80:83], v[152:155]
 s_mov_b32 s31, 0x53800000
 s_mov_b32 s40, 1
 s_sub_u32 s64, s42, 10
M v[152:155], a[164:167], a[84:87], v[152:155]
 s_waitcnt lgkmcnt(4)
 s_and_b32 s35, s64, 536870912
 v_sub_f32 v242, v242, v27
M v[156:159], a[164:167], a[92:95], v[156:159]
 ds_read_b64_tr_b16 a[144:145], v3 offset:49152
 ds_read_b64_tr_b16 a[146:147], v3 offset:50176
M v[156:159], a[160:163], a[88:91], v[156:159]
 buffer_load_dwordx4 v10, s[52:55], s28 offen offset:2048   lds
M v[188:191], a[168:171], a[88:91], v[188:191]
 ds_read_b128 a[160:163], v5 offset:20480
 ds_read_b128 a[164:167], v6 offset:20480
M v[188:191], a[172:175], a[92:95], v[188:191]
 v_sub_f32 v243, v243, v27
 v_sub_f32 v244, v244, v27
M v[184:187], a[172:175], a[84:87], v[184:187]
 v_sub_f32 v245, v245, v27
 v_sub_f32 v246, v246, v27
M v[184:187], a[168:171], a[80:83], v[184:187]
 v_sub_f32 v247, v247, v27
 v_sub_f32 v248, v248, v27
M v[180:183], a[168:171], a[72:75], v[180:183]
 buffer_load_dwordx4 v11, s[52:55], s28 offen offset:3072   lds
M v[180:183], a[172:175], a[76:79], v[180:183]
 s_add_u32 s28, s28, 524416
 ds_read_b64_tr_b16 a[148:149], v3 offset:57344
 ds_read_b64_tr_b16 a[150:151], v3 offset:58368
M v[176:179], a[172:175], a[68:71], v[176:179]
 v_sub_f32 v249, v249, v27
 v_sub_f32 v250, v250, v27
M v[176:179], a[168:171], a[64:67], v[176:179]
 v_sub_f32 v251, v251, v27
 v_sub_f32 v252, v252, v27
M v[172:175], a[168:171], a[56:59], v[172:175]
 s_add_u32 m0, s23, 147456
 v_sub_f32 v253, v253, v27
 v_sub_f32 v254, v254, v27
M v[172:175], a[172:175], a[60:63], v[172:175]
 buffer_load_dwordx4 v8, s[52:55], s28 offen offset:0   lds
M v[168:171], a[172:175], a[52:55], v[168:171]
 v_sub_f32 v255, v255, v27
M v[168:171], a[168:171], a[48:51], v[168:171]
M v[164:167], a[168:171], a[40:43], v[164:167]
 ds_read_b64_tr_b16 a[152:153], v4 offset:49152
 ds_read_b64_tr_b16 a[154:155], v4 offset:50176
M v[164:167], a[172:175], a[44:47], v[164:167]
 s_waitcnt lgkmcnt(4)
M v[160:163], a[172:175], a[36:39], v[160:163]
 buffer_load_dwordx4 v9, s[52:55], s28 offen offset:1024   lds
M v[160:163], a[168:171], a[32:35], v[160:163]
M v[192:195], a[160:163], a[32:35], v[192:195]
 ds_read_b128 a[168:171], v5 offset:22528
 ds_read_b128 a[172:175], v6 offset:22528
M v[192:195], a[164:167], a[36:39], v[192:195]
M v[196:199], a[164:167], a[44:47], v[196:199]
 buffer_load_dwordx4 v10, s[52:55], s28 offen offset:2048   lds
M v[196:199], a[160:163], a[40:43], v[196:199]
 ds_read_b64_tr_b16 a[156:157], v4 offset:57344
 ds_read_b64_tr_b16 a[158:159], v4 offset:58368
M v[200:203], a[160:163], a[48:51], v[200:203]
M v[200:203], a[164:167], a[52:55], v[200:203]
M v[204:207], a[164:167], a[60:63], v[204:207]
M v[204:207], a[160:163], a[56:59], v[204:207]
 buffer_load_dwordx4 v11, s[52:55], s28 offen offset:3072   lds
M v[208:211], a[160:163], a[64:67], v[208:211]
 s_sub_u32 s28, s28, 524288
M v[208:211], a[164:167], a[68:71], v[208:211]
M v[212:215], a[164:167], a[76:79], v[212:215]
M v[212:215], a[160:163], a[72:75], v[212:215]
M v[216:219], a[160:163], a[80:83], v[216:219]
M v[216:219], a[164:167], a[84:87], v[216:219]
 s_waitcnt lgkmcnt(2)
M v[220:223], a[164:167], a[92:95], v[220:223]
 s_waitcnt vmcnt(25) lgkmcnt(0)
M v[220:223], a[160:163], a[88:91], v[220:223]
 s_barrier
M v[252:255], a[168:171], a[88:91], v[252:255]
 ds_read_b128 a[160:163], v5 offset:32768
 ds_read_b128 a[164:167], v6 offset:32768
M v[252:255], a[172:175], a[92:95], v[252:255]
M v[248:251], a[172:175], a[84:87], v[248:251]
M v[248:251], a[168:171], a[80:83], v[248:251]
M v[244:247], a[168:171], a[72:75], v[244:247]
M v[244:247], a[172:175], a[76:79], v[244:247]
M v[240:243], a[172:175], a[68:71], v[240:243]
M v[240:243], a[168:171], a[64:67], v[240:243]
M v[236:239], a[168:171], a[56:59], v[236:239]
M v[236:239], a[172:175], a[60:63], v[236:239]
M v[232:235], a[172:175], a[52:55], v[232:235]
M v[232:235], a[168:171], a[48:51], v[232:235]
M v[228:231], a[168:171], a[40:43], v[228:231]
M v[228:231], a[172:175], a[44:47], v[228:231]
 s_waitcnt lgkmcnt(0)
M v[224:227], a[172:175], a[36:39], v[224:227]
M v[224:227], a[168:171], a[32:35], v[224:227]
M a[0:3], a[160:163], a[96:99], a[0:3]
 ds_read_b128 a[168:171], v5 offset:34816
 ds_read_b128 a[172:175], v6 offset:34816
M a[0:3], a[164:167], a[100:103], a[0:3]
 ds_read_b64_tr_b16 a[32:33], v1 offset:0
 ds_read_b64_tr_b16 a[34:35], v1 offset:1024
M a[4:7], a[164:167], a[108:111], a[4:7]
 s_add_u32 m0, s24, 16384
M a[4:7], a[160:163], a[104:107], a[4:7]
 buffer_load_dwordx4 v16, s[56:59], s29 offen offset:0   lds
M a[8:11], a[160:163], a[112:115], a[8:11]
M a[8:11], a[164:167], a[116:119], a[8:11]
M a[12:15], a[164:167], a[124:127], a[12:15]
 ds_read_b64_tr_b16 a[36:37], v1 offset:8192
 ds_read_b64_tr_b16 a[38:39], v1 offset:9216
M a[12:15], a[160:163], a[120:123], a[12:15]
M a[16:19], a[160:163], a[128:131], a[16:19]
 buffer_load_dwordx4 v17, s[56:59], s29 offen offset:1024   lds
M a[16:19], a[164:167], a[132:135], a[16:19]
M a[20:23], a[164:167], a[140:143], a[20:23]
M a[20:23], a[160:163], a[136:139], a[20:23]
 ds_read_b64_tr_b16 a[40:41], v2 offset:0
 ds_read_b64_tr_b16 a[42:43], v2 offset:1024
M a[24:27], a[160:163], a[144:147], a[24:27]
M a[24:27], a[164:167], a[148:151], a[24:27]
 s_waitcnt lgkmcnt(6)
 buffer_load_dwordx4 v18, s[56:59], s29 offen offset:2048   lds
M a[28:31], a[164:167], a[156:159], a[28:31]
M a[28:31], a[160:163], a[152:155], a[28:31]
M v[32:35], a[168:171], a[96:99], v[32:35]
 ds_read_b128 a[160:163], v5 offset:36864
 ds_read_b128 a[164:167], v6 offset:36864
M v[32:35], a[172:175], a[100:103], v[32:35]
 ds_read_b64_tr_b16 a[44:45], v2 offset:8192
 ds_read_b64_tr_b16 a[46:47], v2 offset:9216
M v[36:39], a[172:175], a[108:111], v[36:39]
 buffer_load_dwordx4 v19, s[56:59], s29 offen offset:3072   lds
M v[36:39], a[168:171], a[104:107], v[36:39]
 s_add_u32 s29, s29, 128
M v[40:43], a[168:171], a[112:115], v[40:43]
M v[40:43], a[172:175], a[116:119], v[40:43]
 ds_read_b64_tr_b16 a[48:49], v3 offset:0
 ds_read_b64_tr_b16 a[50:51], v3 offset:1024
M v[44:47], a[172:175], a[124:127], v[44:47]
 s_add_u32 m0, s23, 49152
 v_accvgpr_read_b32 v24, a0
 v_accvgpr_read_b32 v25, a1
M v[44:47], a[168:171], a[120:123], v[44:47]
 buffer_load_dwordx4 v8, s[52:55], s28 offen offset:0   lds
M v[48:51], a[168:171], a[128:131], v[48:51]
 v_accvgpr_read_b32 v26, a2
 v_accvgpr_read_b32 v27, a3
M v[48:51], a[172:175], a[132:135], v[48:51]
 v_cvt_pk_bf16_f32 v24, v24, v25
 v_cvt_pk_bf16_f32 v25, v26, v27
M v[52:55], a[172:175], a[140:143], v[52:55]
 ds_read_b64_tr_b16 a[52:53], v3 offset:8192
 ds_read_b64_tr_b16 a[54:55], v3 offset:9216
M v[52:55], a[168:171], a[136:139], v[52:55]
 v_cvt_pk_bf16_f32 v26, v32, v33
 v_cvt_pk_bf16_f32 v27, v34, v35
M v[56:59], a[168:171], a[144:147], v[56:59]
 s_add_u32 s3, s93, 0
 buffer_load_dwordx4 v9, s[52:55], s28 offen offset:1024   lds
M v[56:59], a[172:175], a[148:151], v[56:59]
 s_waitcnt lgkmcnt(6)
M v[60:63], a[172:175], a[156:159], v[60:63]
 buffer_store_dwordx4 v[24:27], v7, s[8:11], s3 offen offset:0 sc1
M v[60:63], a[168:171], a[152:155], v[60:63]
 ds_read_b64_tr_b16 a[56:57], v4 offset:0
 ds_read_b64_tr_b16 a[58:59], v4 offset:1024
M v[64:67], a[160:163], a[96:99], v[64:67]
 ds_read_b128 a[168:171], v5 offset:38912
 ds_read_b128 a[172:175], v6 offset:38912
M v[64:67], a[164:167], a[100:103], v[64:67]
 buffer_load_dwordx4 v10, s[52:55], s28 offen offset:2048   lds
M v[68:71], a[164:167], a[108:111], v[68:71]
 v_accvgpr_read_b32 v24, a4
 v_accvgpr_read_b32 v25, a5
M v[68:71], a[160:163], a[104:107], v[68:71]
 v_accvgpr_read_b32 v26, a6
 v_accvgpr_read_b32 v27, a7
M v[72:75], a[160:163], a[112:115], v[72:75]
 ds_read_b64_tr_b16 a[60:61], v4 offset:8192
 ds_read_b64_tr_b16 a[62:63], v4 offset:9216
M v[72:75], a[164:167], a[116:119], v[72:75]
 v_cvt_pk_bf16_f32 v24, v24, v25
 v_cvt_pk_bf16_f32 v25, v26, v27
M v[76:79], a[164:167], a[124:127], v[76:79]
 buffer_load_dwordx4 v11, s[52:55], s28 offen offset:3072   lds
M v[76:79], a[160:163], a[120:123], v[76:79]
 s_add_u32 s28, s28, 1048448
 v_cvt_pk_bf16_f32 v26, v36, v37
 v_cvt_pk_bf16_f32 v27, v38, v39
M v[80:83], a[160:163], a[128:131], v[80:83]
M v[80:83], a[164:167], a[132:135], v[80:83]
M v[84:87], a[164:167], a[140:143], v[84:87]
 buffer_store_dwordx4 v[24:27], v7, s[8:11], s3 offen offset:2048 sc1
M v[84:87], a[160:163], a[136:139], v[84:87]
M v[88:91], a[160:163], a[144:147], v[88:91]
M v[88:91], a[164:167], a[148:151], v[88:91]
 s_waitcnt lgkmcnt(2)
M v[92:95], a[164:167], a[156:159], v[92:95]
 s_waitcnt vmcnt(26) lgkmcnt(0)
 v_accvgpr_read_b32 v24, a8
 v_accvgpr_read_b32 v25, a9
M v[92:95], a[160:163], a[152:155], v[92:95]
 s_barrier
M v[96:99], a[168:171], a[96:99], v[96:99]
 ds_read_b128 a[160:163], v5 offset:49152
 ds_read_b128 a[164:167], v6 offset:49152
M v[96:99], a[172:175], a[100:103], v[96:99]
 v_accvgpr_read_b32 v26, a10
 v_accvgpr_read_b32 v27, a11
M v[100:103], a[172:175], a[108:111], v[100:103]
 s_add_u32 m0, s24, 32768
 ds_read_b64_tr_b16 a[64:65], v1 offset:16384
 ds_read_b64_tr_b16 a[66:67], v1 offset:17408
M v[100:103], a[168:171], a[104:107], v[100:103]
 buffer_load_dwordx4 v16, s[56:59], s29 offen offset:0   lds
M v[104:107], a[168:171], a[112:115], v[104:107]
 v_cvt_pk_bf16_f32 v24, v24, v25
 v_cvt_pk_bf16_f32 v25, v26, v27
M v[104:107], a[172:175], a[116:119], v[104:107]
 v_cvt_pk_bf16_f32 v26, v40, v41
 v_cvt_pk_bf16_f32 v27, v42, v43
M v[108:111], a[172:175], a[124:127], v[108:111]
 s_add_u32 s3, s93, 4096
 buffer_store_dwordx4 v[24:27], v7, s[8:11], s3 offen offset:0 sc1
M v[108:111], a[168:171], a[120:123], v[108:111]
 v_cvt_pk_bf16_f32 v64, v64, v65
 v_cvt_pk_bf16_f32 v65, v66, v67
M v[112:115], a[168:171], a[128:131], v[112:115]
 v_cvt_pk_bf16_f32 v66, v96, v97
 v_cvt_pk_bf16_f32 v67, v98, v99
M v[112:115], a[172:175], a[132:135], v[112:115]
 ds_read_b64_tr_b16 a[68:69], v1 offset:24576
 ds_read_b64_tr_b16 a[70:71], v1 offset:25600
M v[116:119], a[172:175], a[140:143], v[116:119]
 buffer_load_dwordx4 v17, s[56:59], s29 offen offset:1024   lds
M v[116:119], a[168:171], a[136:139], v[116:119]
 v_accvgpr_read_b32 v24, a12
 v_accvgpr_read_b32 v25, a13
M v[120:123], a[168:171], a[144:147], v[120:123]
 v_accvgpr_read_b32 v26, a14
 v_accvgpr_read_b32 v27, a15
M v[120:123], a[172:175], a[148:151], v[120:123]
 s_waitcnt lgkmcnt(4)
 v_cvt_pk_bf16_f32 v24, v24, v25
 v_cvt_pk_bf16_f32 v25, v26, v27
M v[124:127], a[172:175], a[156:159], v[124:127]
 v_cvt_pk_bf16_f32 v26, v44, v45
 v_cvt_pk_bf16_f32 v27, v46, v47
M v[124:127], a[168:171], a[152:155], v[124:127]
 buffer_store_dwordx4 v[24:27], v7, s[8:11], s3 offen offset:2048 sc1
M v[128:131], a[160:163], a[96:99], v[128:131]
 ds_read_b128 a[168:171], v5 offset:51200
 ds_read_b128 a[172:175], v6 offset:51200
M v[128:131], a[164:167], a[100:103], v[128:131]
 ds_read_b64_tr_b16 a[72:73], v2 offset:16384
 ds_read_b64_tr_b16 a[74:75], v2 offset:17408
M v[132:135], a[164:167], a[108:111], v[132:135]
 buffer_load_dwordx4 v18, s[56:59], s29 offen offset:2048   lds
M v[132:135], a[160:163], a[104:107], v[132:135]
 v_cvt_pk_bf16_f32 v68, v68, v69
 v_cvt_pk_bf16_f32 v69, v70, v71
M v[136:139], a[160:163], a[112:115], v[136:139]
 v_cvt_pk_bf16_f32 v70, v100, v101
 v_cvt_pk_bf16_f32 v71, v102, v103
M v[136:139], a[164:167], a[116:119], v[136:139]
 v_cvt_pk_bf16_f32 v72, v72, v73
 v_cvt_pk_bf16_f32 v73, v74, v75
M v[140:143], a[164:167], a[124:127], v[140:143]
 v_accvgpr_read_b32 v24, a16
 v_accvgpr_read_b32 v25, a17
M v[140:143], a[160:163], a[120:123], v[140:143]
 ds_read_b64_tr_b16 a[76:77], v2 offset:24576
 ds_read_b64_tr_b16 a[78:79], v2 offset:25600
M v[144:147], a[160:163], a[128:131], v[144:147]
 buffer_load_dwordx4 v19, s[56:59], s29 offen offset:3072   lds
M v[144:147], a[164:167], a[132:135], v[144:147]
 s_add_u32 s29, s29, 128
 v_accvgpr_read_b32 v26, a18
 v_accvgpr_read_b32 v27, a19
M v[148:151], a[164:167], a[140:143], v[148:151]
 v_cvt_pk_bf16_f32 v24, v24, v25
 v_cvt_pk_bf16_f32 v25, v26, v27
M v[148:151], a[160:163], a[136:139], v[148:151]
 v_cvt_pk_bf16_f32 v26, v48, v49
 v_cvt_pk_bf16_f32 v27, v50, v51
M v[152:155], a[160:163], a[144:147], v[152:155]
 s_add_u32 s3, s93, 8192
 buffer_store_dwordx4 v[24:27], v7, s[8:11], s3 offen offset:0 sc1
M v[152:155], a[164:167], a[148:151], v[152:155]
 s_waitcnt lgkmcnt(4)
 v_cvt_pk_bf16_f32 v74, v104, v105
 v_cvt_pk_bf16_f32 v75, v106, v107
M v[156:159], a[164:167], a[156:159], v[156:159]
 s_add_u32 m0, s23, 0
 ds_read_b64_tr_b16 a[80:81], v3 offset:16384
 ds_read_b64_tr_b16 a[82:83], v3 offset:17408
M v[156:159], a[160:163], a[152:155], v[156:159]
 buffer_load_dwordx4 v8, s[52:55], s28 offen offset:0   lds
M v[160:163], a[168:171], a[96:99], v[160:163]
 ds_read_b128 a[160:163], v5 offset:53248
 ds_read_b128 a[164:167], v6 offset:53248
M v[160:163], a[172:175], a[100:103], v[160:163]
 v_cvt_pk_bf16_f32 v76, v76, v77
 v_cvt_pk_bf16_f32 v77, v78, v79
M v[164:167], a[172:175], a[108:111], v[164:167]
 v_accvgpr_read_b32 v24, a20
 v_accvgpr_read_b32 v25, a21
M v[164:167], a[168:171], a[104:107], v[164:167]
 v_accvgpr_read_b32 v26, a22
 v_accvgpr_read_b32 v27, a23
M v[168:171], a[168:171], a[112:115], v[168:171]
 v_cvt_pk_bf16_f32 v24, v24, v25
 v_cvt_pk_bf16_f32 v25, v26, v27
M v[168:171], a[172:175], a[116:119], v[168:171]
 ds_read_b64_tr_b16 a[84:85], v3 offset:24576
 ds_read_b64_tr_b16 a[86:87], v3 offset:25600
M v[172:175], a[172:175], a[124:127], v[172:175]
 buffer_load_dwordx4 v9, s[52:55], s28 offen offset:1024   lds
M v[172:175], a[168:171], a[120:123], v[172:175]
 v_cvt_pk_bf16_f32 v26, v52, v53
 v_cvt_pk_bf16_f32 v27, v54, v55
M v[176:179], a[168:171], a[128:131], v[176:179]
 v_cvt_pk_bf16_f32 v78, v108, v109
 v_cvt_pk_bf16_f32 v79, v110, v111
M v[176:179], a[172:175], a[132:135], v[176:179]
 buffer_store_dwordx4 v[24:27], v7, s[8:11], s3 offen offset:2048 sc1
M v[180:183], a[172:175], a[140:143], v[180:183]
 v_cvt_pk_bf16_f32 v80, v80, v81
 v_cvt_pk_bf16_f32 v81, v82, v83
M v[180:183], a[168:171], a[136:139], v[180:183]
 v_cvt_pk_bf16_f32 v82, v112, v113
 v_cvt_pk_bf16_f32 v83, v114, v115
M v[184:187], a[168:171], a[144:147], v[184:187]
 ds_read_b64_tr_b16 a[88:89], v4 offset:16384
 ds_read_b64_tr_b16 a[90:91], v4 offset:17408
M v[184:187], a[172:175], a[148:151], v[184:187]
 s_waitcnt lgkmcnt(4)
 buffer_load_dwordx4 v10, s[52:55], s28 offen offset:2048   lds
M v[188:191], a[172:175], a[156:159], v[188:191]
 v_accvgpr_read_b32 v24, a24
 v_accvgpr_read_b32 v25, a25
M v[188:191], a[168:171], a[152:155], v[188:191]
 v_accvgpr_read_b32 v26, a26
 v_accvgpr_read_b32 v27, a27
M v[192:195], a[160:163], a[96:99], v[192:195]
 ds_read_b128 a[168:171], v5 offset:55296
 ds_read_b128 a[172:175], v6 offset:55296
M v[192:195], a[164:167], a[100:103], v[192:195]
 v_cvt_pk_bf16_f32 v24, v24, v25
 v_cvt_pk_bf16_f32 v25, v26, v27
M v[196:199], a[164:167], a[108:111], v[196:199]
 v_cvt_pk_bf16_f32 v26, v56, v57
 v_cvt_pk_bf16_f32 v27, v58, v59
M v[196:199], a[160:163], a[104:107], v[196:199]
 s_add_u32 s3, s93, 12288
 ds_read_b64_tr_b16 a[92:93], v4 offset:24576
 ds_read_b64_tr_b16 a[94:95], v4 offset:25600
M v[200:203], a[160:163], a[112:115], v[200:203]
 buffer_load_dwordx4 v11, s[52:55], s28 offen offset:3072   lds
M v[200:203], a[164:167], a[116:119], v[200:203]
 s_add_u32 s28, s28, 128
 v_cvt_pk_bf16_f32 v84, v84, v85
 v_cvt_pk_bf16_f32 v85, v86, v87
M v[204:207], a[164:167], a[124:127], v[204:207]
 v_cvt_pk_bf16_f32 v86, v116, v117
 v_cvt_pk_bf16_f32 v87, v118, v119
M v[204:207], a[160:163], a[120:123], v[204:207]
 v_cvt_pk_bf16_f32 v88, v88, v89
 v_cvt_pk_bf16_f32 v89, v90, v91
M v[208:211], a[160:163], a[128:131], v[208:211]
 buffer_store_dwordx4 v[24:27], v7, s[8:11], s3 offen offset:0 sc1
M v[208:211], a[164:167], a[132:135], v[208:211]
 v_cvt_pk_bf16_f32 v90, v120, v121
 v_cvt_pk_bf16_f32 v91, v122, v123
M v[212:215], a[164:167], a[140:143], v[212:215]
 v_accvgpr_read_b32 v24, a28
 v_accvgpr_read_b32 v25, a29
M v[212:215], a[160:163], a[136:139], v[212:215]
 v_accvgpr_read_b32 v26, a30
 v_accvgpr_read_b32 v27, a31
M v[216:219], a[160:163], a[144:147], v[216:219]
 v_cvt_pk_bf16_f32 v24, v24, v25
 v_cvt_pk_bf16_f32 v25, v26, v27
M v[216:219], a[164:167], a[148:151], v[216:219]
 s_waitcnt lgkmcnt(2)
 v_cvt_pk_bf16_f32 v26, v60, v61
 v_cvt_pk_bf16_f32 v27, v62, v63
M v[220:223], a[164:167], a[156:159], v[220:223]
 s_waitcnt vmcnt(27) lgkmcnt(0)
 buffer_store_dwordx4 v[24:27], v7, s[8:11], s3 offen offset:2048 sc1
M v[220:223], a[160:163], a[152:155], v[220:223]
 s_barrier
M v[224:227], a[168:171], a[96:99], v[224:227]
 ds_read_b128 a[160:163], v5 offset:0
 ds_read_b128 a[164:167], v6 offset:0
M v[224:227], a[172:175], a[100:103], v[224:227]
 v_cvt_pk_bf16_f32 v92, v92, v93
 v_cvt_pk_bf16_f32 v93, v94, v95
M v[228:231], a[172:175], a[108:111], v[228:231]
 v_cvt_pk_bf16_f32 v94, v124, v125
 v_cvt_pk_bf16_f32 v95, v126, v127
M v[228:231], a[168:171], a[104:107], v[228:231]
 v_cvt_pk_bf16_f32 v128, v128, v129
 v_cvt_pk_bf16_f32 v129, v130, v131
M v[232:235], a[168:171], a[112:115], v[232:235]
 v_cvt_pk_bf16_f32 v130, v160, v161
 v_cvt_pk_bf16_f32 v131, v162, v163
M v[232:235], a[172:175], a[116:119], v[232:235]
 v_cvt_pk_bf16_f32 v132, v132, v133
 v_cvt_pk_bf16_f32 v133, v134, v135
M v[236:239], a[172:175], a[124:127], v[236:239]
 v_cvt_pk_bf16_f32 v134, v164, v165
 v_cvt_pk_bf16_f32 v135, v166, v167
M v[236:239], a[168:171], a[120:123], v[236:239]
 v_cvt_pk_bf16_f32 v136, v136, v137
 v_cvt_pk_bf16_f32 v137, v138, v139
M v[240:243], a[168:171], a[128:131], v[240:243]
 v_cvt_pk_bf16_f32 v138, v168, v169
 v_cvt_pk_bf16_f32 v139, v170, v171
M v[240:243], a[172:175], a[132:135], v[240:243]
 v_cvt_pk_bf16_f32 v140, v140, v141
 v_cvt_pk_bf16_f32 v141, v142, v143
M v[244:247], a[172:175], a[140:143], v[244:247]
 v_cvt_pk_bf16_f32 v142, v172, v173
 v_cvt_pk_bf16_f32 v143, v174, v175
M v[244:247], a[168:171], a[136:139], v[244:247]
 v_cvt_pk_bf16_f32 v144, v144, v145
 v_cvt_pk_bf16_f32 v145, v146, v147
M v[248:251], a[168:171], a[144:147], v[248:251]
 v_cvt_pk_bf16_f32 v146, v176, v177
 v_cvt_pk_bf16_f32 v147, v178, v179
M v[248:251], a[172:175], a[148:151], v[248:251]
 s_waitcnt lgkmcnt(0)
 v_cvt_pk_bf16_f32 v148, v148, v149
 v_cvt_pk_bf16_f32 v149, v150, v151
M v[252:255], a[172:175], a[156:159], v[252:255]
 v_cvt_pk_bf16_f32 v150, v180, v181
 v_cvt_pk_bf16_f32 v151, v182, v183
M v[252:255], a[168:171], a[152:155], v[252:255]
 v_cvt_pk_bf16_f32 v152, v152, v153
 v_cvt_pk_bf16_f32 v153, v154, v155
M v[32:35], a[32:35], a[160:163], 0
 s_add_u32 m0, s23, 16384
 ds_read_b128 a[168:171], v5 offset:2048
 ds_read_b128 a[172:175], v6 offset:2048
M v[32:35], a[36:39], a[164:167], v[32:35]
 ds_read_b64_tr_b16 a[96:97], v1 offset:32768
 ds_read_b64_tr_b16 a[98:99], v1 offset:33792
M v[36:39], a[44:47], a[164:167], 0
 buffer_load_dwordx4 v8, s[52:55], s28 offen offset:0   lds
M v[36:39], a[40:43], a[160:163], v[36:39]
 v_cvt_pk_bf16_f32 v154, v184, v185
 v_cvt_pk_bf16_f32 v155, v186, v187
M v[40:43], a[48:51], a[160:163], 0
 ds_read_b64_tr_b16 a[100:101], v1 offset:40960
 ds_read_b64_tr_b16 a[102:103], v1 offset:41984
M v[40:43], a[52:55], a[164:167], v[40:43]
 buffer_load_dwordx4 v9, s[52:55], s28 offen offset:1024   lds
M v[44:47], a[60:63], a[164:167], 0
 v_cvt_pk_bf16_f32 v156, v156, v157
 v_cvt_pk_bf16_f32 v157, v158, v159
M v[44:47], a[56:59], a[160:163], v[44:47]
 ds_read_b64_tr_b16 a[104:105], v2 offset:32768
 ds_read_b64_tr_b16 a[106:107], v2 offset:33792
M v[48:51], a[64:67], a[160:163], 0
 v_cvt_pk_bf16_f32 v158, v188, v189
 v_cvt_pk_bf16_f32 v159, v190, v191
M v[48:51], a[68:71], a[164:167], v[48:51]
 v_cvt_pk_bf16_f32 v192, v192, v193
 v_cvt_pk_bf16_f32 v193, v194, v195
M v[52:55], a[76:79], a[164:167], 0
 ds_read_b64_tr_b16 a[108:109], v2 offset:40960
 ds_read_b64_tr_b16 a[110:111], v2 offset:41984
M v[52:55], a[72:75], a[160:163], v[52:55]
 buffer_load_dwordx4 v10, s[52:55], s28 offen offset:2048   lds
M v[56:59], a[80:83], a[160:163], 0
 v_cvt_pk_bf16_f32 v194, v224, v225
 v_cvt_pk_bf16_f32 v195, v226, v227
M v[56:59], a[84:87], a[164:167], v[56:59]
 s_waitcnt lgkmcnt(8)
 ds_read_b64_tr_b16 a[112:113], v3 offset:32768
 ds_read_b64_tr_b16 a[114:115], v3 offset:33792
M v[60:63], a[92:95], a[164:167], 0
 v_cvt_pk_bf16_f32 v196, v196, v197
 v_cvt_pk_bf16_f32 v197, v198, v199
M v[60:63], a[88:91], a[160:163], v[60:63]
 buffer_load_dwordx4 v11, s[52:55], s28 offen offset:3072   lds
M v[96:99], a[32:35], a[168:171], 0
 s_add_u32 s28, s28, 524160
 ds_read_b128 a[160:163], v5 offset:4096
 ds_read_b128 a[164:167], v6 offset:4096
M v[96:99], a[36:39], a[172:175], v[96:99]
 ds_read_b64_tr_b16 a[116:117], v3 offset:40960
 ds_read_b64_tr_b16 a[118:119], v3 offset:41984
M v[100:103], a[44:47], a[172:175], 0
 v_cvt_pk_bf16_f32 v198, v228, v229
 v_cvt_pk_bf16_f32 v199, v230, v231
M v[100:103], a[40:43], a[168:171], v[100:103]
 s_add_u32 m0, s24, 49152
 ds_read_b64_tr_b16 a[120:121], v4 offset:32768
 ds_read_b64_tr_b16 a[122:123], v4 offset:33792
M v[104:107], a[48:51], a[168:171], 0
 buffer_load_dwordx4 v16, s[56:59], s29 offen offset:0   lds
M v[104:107], a[52:55], a[172:175], v[104:107]
 v_cvt_pk_bf16_f32 v200, v200, v201
 v_cvt_pk_bf16_f32 v201, v202, v203
M v[108:111], a[60:63], a[172:175], 0
 ds_read_b64_tr_b16 a[124:125], v4 offset:40960
 ds_read_b64_tr_b16 a[126:127], v4 offset:41984
M v[108:111], a[56:59], a[168:171], v[108:111]
 v_cvt_pk_bf16_f32 v202, v232, v233
 v_cvt_pk_bf16_f32 v203, v234, v235
M v[112:115], a[64:67], a[168:171], 0
 v_cvt_pk_bf16_f32 v204, v204, v205
 v_cvt_pk_bf16_f32 v205, v206, v207
M v[112:115], a[68:71], a[172:175], v[112:115]
 buffer_load_dwordx4 v17, s[56:59], s29 offen offset:1024   lds
M v[116:119], a[76:79], a[172:175], 0
 v_cvt_pk_bf16_f32 v206, v236, v237
 v_cvt_pk_bf16_f32 v207, v238, v239
M v[116:119], a[72:75], a[168:171], v[116:119]
 v_cvt_pk_bf16_f32 v208, v208, v209
 v_cvt_pk_bf16_f32 v209, v210, v211
M v[120:123], a[80:83], a[168:171], 0
 v_cvt_pk_bf16_f32 v210, v240, v241
 v_cvt_pk_bf16_f32 v211, v242, v243
M v[120:123], a[84:87], a[172:175], v[120:123]
 s_waitcnt lgkmcnt(6)
 v_cvt_pk_bf16_f32 v212, v212, v213
 v_cvt_pk_bf16_f32 v213, v214, v215
M v[124:127], a[92:95], a[172:175], 0
 s_waitcnt vmcnt(21) lgkmcnt(0)
 buffer_load_dwordx4 v18, s[56:59], s29 offen offset:2048   lds
M v[124:127], a[88:91], a[168:171], v[124:127]
 s_barrier
M v[160:163], a[32:35], a[160:163], 0
 ds_read_b128 a[168:171], v5 offset:6144
 ds_read_b128 a[172:175], v6 offset:6144
M v[160:163], a[36:39], a[164:167], v[160:163]
 ds_read_b64_tr_b16 a[128:129], v1 offset:49152
 ds_read_b64_tr_b16 a[130:131], v1 offset:50176
M v[164:167], a[44:47], a[164:167], 0
 v_cvt_pk_bf16_f32 v214, v244, v245
 v_cvt_pk_bf16_f32 v215, v246, v247
M v[164:167], a[40:43], a[160:163], v[164:167]
 buffer_load_dwordx4 v19, s[56:59], s29 offen offset:3072   lds
M v[168:171], a[48:51], a[160:163], 0
 s_add_u32 s29, s29, 128
 ds_read_b64_tr_b16 a[132:133], v1 offset:57344
 ds_read_b64_tr_b16 a[134:135], v1 offset:58368
M v[168:171], a[52:55], a[164:167], v[168:171]
 v_cvt_pk_bf16_f32 v216, v216, v217
 v_cvt_pk_bf16_f32 v217, v218, v219
M v[172:175], a[60:63], a[164:167], 0
 v_cvt_pk_bf16_f32 v218, v248, v249
 v_cvt_pk_bf16_f32 v219, v250, v251
M v[172:175], a[56:59], a[160:163], v[172:175]
 s_add_u32 m0, s23, 32768
 ds_read_b64_tr_b16 a[136:137], v2 offset:49152
 ds_read_b64_tr_b16 a[138:139], v2 offset:50176
M v[176:179], a[64:67], a[160:163], 0
 buffer_load_dwordx4 v8, s[52:55], s28 offen offset:0   lds
M v[176:179], a[68:71], a[164:167], v[176:179]
 v_cvt_pk_bf16_f32 v220, v220, v221
 v_cvt_pk_bf16_f32 v221, v222, v223
M v[180:183], a[76:79], a[164:167], 0
 ds_read_b64_tr_b16 a[140:141], v2 offset:57344
 ds_read_b64_tr_b16 a[142:143], v2 offset:58368
M v[180:183], a[72:75], a[160:163], v[180:183]
 v_cvt_pk_bf16_f32 v222, v252, v253
 v_cvt_pk_bf16_f32 v223, v254, v255
M v[184:187], a[80:83], a[160:163], 0
 s_add_u32 s3, s93, 262144
 v_mov_b32 v12, 1
 v_or_b32 v15, s20, v0
M v[184:187], a[84:87], a[164:167], v[184:187]
 s_waitcnt lgkmcnt(8)
 ds_read_b64_tr_b16 a[144:145], v3 offset:49152
 ds_read_b64_tr_b16 a[146:147], v3 offset:50176
M v[188:191], a[92:95], a[164:167], 0
 buffer_load_dwordx4 v9, s[52:55], s28 offen offset:1024   lds
M v[188:191], a[88:91], a[160:163], v[188:191]
 v_min_u32 v15, 1, v15
 v_lshlrev_b32 v15, 29, v15
M v[224:227], a[32:35], a[168:171], 0
 ds_read_b128 a[160:163], v5 offset:16384
 ds_read_b128 a[164:167], v6 offset:16384
M v[224:227], a[36:39], a[172:175], v[224:227]
 ds_read_b64_tr_b16 a[148:149], v3 offset:57344
 ds_read_b64_tr_b16 a[150:151], v3 offset:58368
M v[228:231], a[44:47], a[172:175], 0
 buffer_load_dwordx4 v10, s[52:55], s28 offen offset:2048   lds
M v[228:231], a[40:43], a[168:171], v[228:231]
 ds_read_b64_tr_b16 a[152:153], v4 offset:49152
 ds_read_b64_tr_b16 a[154:155], v4 offset:50176
M v[232:235], a[48:51], a[168:171], 0
 buffer_store_dwordx4 v[64:67], v7, s[8:11], s3 offen offset:0 sc1
M v[232:235], a[52:55], a[172:175], v[232:235]
M v[236:239], a[60:63], a[172:175], 0
 ds_read_b64_tr_b16 a[156:157], v4 offset:57344
 ds_read_b64_tr_b16 a[158:159], v4 offset:58368
M v[236:239], a[56:59], a[168:171], v[236:239]
 buffer_load_dwordx4 v11, s[52:55], s28 offen offset:3072   lds
M v[240:243], a[64:67], a[168:171], 0
 s_add_u32 s28, s28, 128
M v[240:243], a[68:71], a[172:175], v[240:243]
 buffer_store_dwordx4 v[68:71], v7, s[8:11], s3 offen offset:2048 sc1
M v[244:247], a[76:79], a[172:175], 0
M v[244:247], a[72:75], a[168:171], v[244:247]
M v[248:251], a[80:83], a[168:171], 0
M v[248:251], a[84:87], a[172:175], v[248:251]
 s_waitcnt lgkmcnt(6)
M v[252:255], a[92:95], a[172:175], 0
 s_waitcnt vmcnt(14) lgkmcnt(0)
M v[252:255], a[88:91], a[168:171], v[252:255]
 s_barrier
M v[32:35], a[96:99], a[160:163], v[32:35]
 s_add_u32 m0, s23, 49152
 ds_read_b128 a[168:171], v5 offset:18432
 ds_read_b128 a[172:175], v6 offset:18432
M v[32:35], a[100:103], a[164:167], v[32:35]
 ds_read_b64_tr_b16 a[32:33], v20 offset:0
 ds_read_b64_tr_b16 a[34:35], v20 offset:1024
M v[36:39], a[108:111], a[164:167], v[36:39]
 s_mov_b32 s39, 1347
 buffer_load_dwordx4 v8, s[52:55], s28 offen offset:0   lds
M v[36:39], a[104:107], a[160:163], v[36:39]
 s_cmp_lt_u32 s42, 2
 buffer_store_dword v12, v15, s[8:11], s45 offen sc1
M v[40:43], a[112:115], a[160:163], v[40:43]
 s_cselect_b32 s39, 1284, s39
 ds_read_b64_tr_b16 a[36:37], v20 offset:8192
 ds_read_b64_tr_b16 a[38:39], v20 offset:9216
M v[40:43], a[116:119], a[164:167], v[40:43]
 s_lshl_b32 s64, s20, 14
 buffer_load_dwordx4 v9, s[52:55], s28 offen offset:1024   lds
M v[44:47], a[124:127], a[164:167], v[44:47]
 s_add_u32 s12, s64, s34
 s_add_u32 s3, s93, 266240
M v[44:47], a[120:123], a[160:163], v[44:47]
 s_add_u32 s13, s12, 4096
 ds_read_b64_tr_b16 a[40:41], v21 offset:0
 ds_read_b64_tr_b16 a[42:43], v21 offset:1024
M v[48:51], a[128:131], a[160:163], v[48:51]
 s_add_u32 s14, s12, 8192
 buffer_store_dwordx4 v[72:75], v7, s[8:11], s3 offen offset:0 sc1
M v[48:51], a[132:135], a[164:167], v[48:51]
 s_add_u32 s15, s12, 12288
M v[52:55], a[140:143], a[164:167], v[52:55]
 ds_read_b64_tr_b16 a[44:45], v21 offset:8192
 ds_read_b64_tr_b16 a[46:47], v21 offset:9216
M v[52:55], a[136:139], a[160:163], v[52:55]
 buffer_load_dwordx4 v10, s[52:55], s28 offen offset:2048   lds
M v[56:59], a[144:147], a[160:163], v[56:59]
M v[56:59], a[148:151], a[164:167], v[56:59]
 s_waitcnt lgkmcnt(8)
 ds_read_b64_tr_b16 a[48:49], v22 offset:0
 ds_read_b64_tr_b16 a[50:51], v22 offset:1024
M v[60:63], a[156:159], a[164:167], v[60:63]
M v[60:63], a[152:155], a[160:163], v[60:63]
 buffer_load_dwordx4 v11, s[52:55], s28 offen offset:3072   lds
M v[96:99], a[96:99], a[168:171], v[96:99]
 s_add_u32 s28, s28, 524160
 ds_read_b128 a[160:163], v5 offset:20480
 ds_read_b128 a[164:167], v6 offset:20480
M v[96:99], a[100:103], a[172:175], v[96:99]
 ds_read_b64_tr_b16 a[52:53], v22 offset:8192
 ds_read_b64_tr_b16 a[54:55], v22 offset:9216
M v[100:103], a[108:111], a[172:175], v[100:103]
M v[100:103], a[104:107], a[168:171], v[100:103]
 s_add_u32 m0, s24, 0
 ds_read_b64_tr_b16 a[56:57], v23 offset:0
 ds_read_b64_tr_b16 a[58:59], v23 offset:1024
M v[104:107], a[112:115], a[168:171], v[104:107]
 buffer_load_dwordx4 v16, s[56:59], s29 offen offset:0   lds
M v[104:107], a[116:119], a[172:175], v[104:107]
M v[108:111], a[124:127], a[172:175], v[108:111]
 ds_read_b64_tr_b16 a[60:61], v23 offset:8192
 ds_read_b64_tr_b16 a[62:63], v23 offset:9216
M v[108:111], a[120:123], a[168:171], v[108:111]
M v[112:115], a[128:131], a[168:171], v[112:115]
M v[112:115], a[132:135], a[172:175], v[112:115]
 buffer_load_dwordx4 v17, s[56:59], s29 offen offset:1024   lds
M v[116:119], a[140:143], a[172:175], v[116:119]
M v[116:119], a[136:139], a[168:171], v[116:119]
M v[120:123], a[144:147], a[168:171], v[120:123]
M v[120:123], a[148:151], a[172:175], v[120:123]
 s_waitcnt lgkmcnt(6)
M v[124:127], a[156:159], a[172:175], v[124:127]
 s_waitcnt lgkmcnt(0)
 buffer_load_dwordx4 v18, s[56:59], s29 offen offset:2048   lds
M v[124:127], a[152:155], a[168:171], v[124:127]
 s_barrier
M v[160:163], a[96:99], a[160:163], v[160:163]
 ds_read_b128 a[168:171], v5 offset:22528
 ds_read_b128 a[172:175], v6 offset:22528
M v[160:163], a[100:103], a[164:167], v[160:163]
 ds_read_b64_tr_b16 a[64:65], v20 offset:16384
 ds_read_b64_tr_b16 a[66:67], v20 offset:17408
M v[164:167], a[108:111], a[164:167], v[164:167]
M v[164:167], a[104:107], a[160:163], v[164:167]
 buffer_load_dwordx4 v19, s[56:59], s29 offen offset:3072   lds
M v[168:171], a[112:115], a[160:163], v[168:171]
 s_add_u32 s29, s29, 128
 ds_read_b64_tr_b16 a[68:69], v20 offset:24576
 ds_read_b64_tr_b16 a[70:71], v20 offset:25600
M v[168:171], a[116:119], a[164:167], v[168:171]
 buffer_store_dwordx4 v[76:79], v7, s[8:11], s3 offen offset:2048 sc1
M v[172:175], a[124:127], a[164:167], v[172:175]
M v[172:175], a[120:123], a[160:163], v[172:175]
 s_add_u32 m0, s23, 131072
 ds_read_b64_tr_b16 a[72:73], v21 offset:16384
 ds_read_b64_tr_b16 a[74:75], v21 offset:17408
M v[176:179], a[128:131], a[160:163], v[176:179]
 buffer_load_dwordx4 v8, s[52:55], s28 offen offset:0   lds
M v[176:179], a[132:135], a[164:167], v[176:179]
M v[180:183], a[140:143], a[164:167], v[180:183]
 ds_read_b64_tr_b16 a[76:77], v21 offset:24576
 ds_read_b64_tr_b16 a[78:79], v21 offset:25600
M v[180:183], a[136:139], a[160:163], v[180:183]
M v[184:187], a[144:147], a[160:163], v[184:187]
M v[184:187], a[148:151], a[164:167], v[184:187]
 s_waitcnt lgkmcnt(8)
 ds_read_b64_tr_b16 a[80:81], v22 offset:16384
 ds_read_b64_tr_b16 a[82:83], v22 offset:17408
M v[188:191], a[156:159], a[164:167], v[188:191]
 buffer_load_dwordx4 v9, s[52:55], s28 offen offset:1024   lds
M v[188:191], a[152:155], a[160:163], v[188:191]
M v[224:227], a[96:99], a[168:171], v[224:227]
 ds_read_b128 a[160:163], v5 offset:32768
 ds_read_b128 a[164:167], v6 offset:32768
M v[224:227], a[100:103], a[172:175], v[224:227]
 ds_read_b64_tr_b16 a[84:85], v22 offset:24576
 ds_read_b64_tr_b16 a[86:87], v22 offset:25600
M v[228:231], a[108:111], a[172:175], v[228:231]
 buffer_load_dwordx4 v10, s[52:55], s28 offen offset:2048   lds
M v[228:231], a[104:107], a[168:171], v[228:231]
 ds_read_b64_tr_b16 a[88:89], v23 offset:16384
 ds_read_b64_tr_b16 a[90:91], v23 offset:17408
M v[232:235], a[112:115], a[168:171], v[232:235]
M v[232:235], a[116:119], a[172:175], v[232:235]
M v[236:239], a[124:127], a[172:175], v[236:239]
 ds_read_b64_tr_b16 a[92:93], v23 offset:24576
 ds_read_b64_tr_b16 a[94:95], v23 offset:25600
M v[236:239], a[120:123], a[168:171], v[236:239]
 buffer_load_dwordx4 v11, s[52:55], s28 offen offset:3072   lds
M v[240:243], a[128:131], a[168:171], v[240:243]
 s_add_u32 s28, s28, 128
M v[240:243], a[132:135], a[172:175], v[240:243]
M v[244:247], a[140:143], a[172:175], v[244:247]
M v[244:247], a[136:139], a[168:171], v[244:247]
M v[248:251], a[144:147], a[168:171], v[248:251]
M v[248:251], a[148:151], a[172:175], v[248:251]
 s_waitcnt lgkmcnt(6)
M v[252:255], a[156:159], a[172:175], v[252:255]
 s_waitcnt lgkmcnt(0)
M v[252:255], a[152:155], a[168:171], v[252:255]
 s_barrier
M v[32:35], a[32:35], a[160:163], v[32:35]
 s_add_u32 m0, s23, 147456
 ds_read_b128 a[168:171], v5 offset:34816
 ds_read_b128 a[172:175], v6 offset:34816
M v[32:35], a[36:39], a[164:167], v[32:35]
 ds_read_b64_tr_b16 a[96:97], v1 offset:0
 ds_read_b64_tr_b16 a[98:99], v1 offset:1024
M v[36:39], a[44:47], a[164:167], v[36:39]
 buffer_load_dwordx4 v8, s[52:55], s28 offen offset:0   lds
M v[36:39], a[40:43], a[160:163], v[36:39]
 v_and_b32 v29, 15, v0
 v_mul_u32_u24 v30, 1792, v29
M v[40:43], a[48:51], a[160:163], v[40:43]
 s_add_u32 s3, s93, 270336
 ds_read_b64_tr_b16 a[100:101], v1 offset:8192
 ds_read_b64_tr_b16 a[102:103], v1 offset:9216
M v[40:43], a[52:55], a[164:167], v[40:43]
 buffer_load_dwordx4 v9, s[52:55], s28 offen offset:1024   lds
M v[44:47], a[60:63], a[164:167], v[44:47]
 v_lshrrev_b32 v31, 4, v0
 v_lshl_add_u32 v30, v31, 4, v30
M v[44:47], a[56:59], a[160:163], v[44:47]
 ds_read_b64_tr_b16 a[104:105], v2 offset:0
 ds_read_b64_tr_b16 a[106:107], v2 offset:1024
M v[48:51], a[64:67], a[160:163], v[48:51]
 v_lshrrev_b32 v29, 1, v29
 v_min_u32 v29, 1, v29
M v[48:51], a[68:71], a[164:167], v[48:51]
 v_lshl_or_b32 v30, v29, 29, v30
 v_or_b32 v30, s88, v30
M v[52:55], a[76:79], a[164:167], v[52:55]
 s_mul_i32 s89, s86, 3584
 ds_read_b64_tr_b16 a[108:109], v2 offset:8192
 ds_read_b64_tr_b16 a[110:111], v2 offset:9216
M v[52:55], a[72:75], a[160:163], v[52:55]
 s_mul_i32 s64, s20, 448
 buffer_load_dwordx4 v10, s[52:55], s28 offen offset:2048   lds
M v[56:59], a[80:83], a[160:163], v[56:59]
 s_add_u32 s89, s89, s64
 s_add_u32 s89, s89, 105906176
M v[56:59], a[84:87], a[164:167], v[56:59]
 s_waitcnt lgkmcnt(8)
 ds_read_b64_tr_b16 a[112:113], v3 offset:0
 ds_read_b64_tr_b16 a[114:115], v3 offset:1024
M v[60:63], a[92:95], a[164:167], v[60:63]
 buffer_store_dwordx4 v[80:83], v7, s[8:11], s3 offen offset:0 sc1
M v[60:63], a[88:91], a[160:163], v[60:63]
 buffer_load_dwordx4 v11, s[52:55], s28 offen offset:3072   lds
M v[96:99], a[32:35], a[168:171], v[96:99]
 s_add_u32 s28, s28, 524160
 ds_read_b128 a[160:163], v5 offset:36864
 ds_read_b128 a[164:167], v6 offset:36864
M v[96:99], a[36:39], a[172:175], v[96:99]
 ds_read_b64_tr_b16 a[116:117], v3 offset:8192
 ds_read_b64_tr_b16 a[118:119], v3 offset:9216
M v[100:103], a[44:47], a[172:175], v[100:103]
M v[100:103], a[40:43], a[168:171], v[100:103]
 s_add_u32 m0, s24, 16384
 ds_read_b64_tr_b16 a[120:121], v4 offset:0
 ds_read_b64_tr_b16 a[122:123], v4 offset:1024
M v[104:107], a[48:51], a[168:171], v[104:107]
 buffer_load_dwordx4 v16, s[56:59], s29 offen offset:0   lds
M v[104:107], a[52:55], a[172:175], v[104:107]
M v[108:111], a[60:63], a[172:175], v[108:111]
 ds_read_b64_tr_b16 a[124:125], v4 offset:8192
 ds_read_b64_tr_b16 a[126:127], v4 offset:9216
M v[108:111], a[56:59], a[168:171], v[108:111]
M v[112:115], a[64:67], a[168:171], v[112:115]
M v[112:115], a[68:71], a[172:175], v[112:115]
 buffer_load_dwordx4 v17, s[56:59], s29 offen offset:1024   lds
M v[116:119], a[76:79], a[172:175], v[116:119]
M v[116:119], a[72:75], a[168:171], v[116:119]
M v[120:123], a[80:83], a[168:171], v[120:123]
M v[120:123], a[84:87], a[172:175], v[120:123]
 s_waitcnt lgkmcnt(6)
M v[124:127], a[92:95], a[172:175], v[124:127]
 s_waitcnt vmcnt(28) lgkmcnt(0)
 buffer_load_dwordx4 v18, s[56:59], s29 offen offset:2048   lds
M v[124:127], a[88:91], a[168:171], v[124:127]
 s_barrier
M v[160:163], a[32:35], a[160:163], v[160:163]
 ds_read_b128 a[168:171], v5 offset:38912
 ds_read_b128 a[172:175], v6 offset:38912
M v[160:163], a[36:39], a[164:167], v[160:163]
 ds_read_b64_tr_b16 a[128:129], v1 offset:16384
 ds_read_b64_tr_b16 a[130:131], v1 offset:17408
M v[164:167], a[44:47], a[164:167], v[164:167]
M v[164:167], a[40:43], a[160:163], v[164:167]
 buffer_load_dwordx4 v19, s[56:59], s29 offen offset:3072   lds
M v[168:171], a[48:51], a[160:163], v[168:171]
 s_add_u32 s29, s29, 128
 ds_read_b64_tr_b16 a[132:133], v1 offset:24576
 ds_read_b64_tr_b16 a[134:135], v1 offset:25600
M v[168:171], a[52:55], a[164:167], v[168:171]
 buffer_store_dwordx4 v[84:87], v7, s[8:11], s3 offen offset:2048 sc1
M v[172:175], a[60:63], a[164:167], v[172:175]
M v[172:175], a[56:59], a[160:163], v[172:175]
 s_add_u32 m0, s23, 0
 ds_read_b64_tr_b16 a[136:137], v2 offset:16384
 ds_read_b64_tr_b16 a[138:139], v2 offset:17408
M v[176:179], a[64:67], a[160:163], v[176:179]
 buffer_load_dwordx4 v8, s[52:55], s28 offen offset:0   lds
M v[176:179], a[68:71], a[164:167], v[176:179]
M v[180:183], a[76:79], a[164:167], v[180:183]
 ds_read_b64_tr_b16 a[140:141], v2 offset:24576
 ds_read_b64_tr_b16 a[142:143], v2 offset:25600
M v[180:183], a[72:75], a[160:163], v[180:183]
M v[184:187], a[80:83], a[160:163], v[184:187]
M v[184:187], a[84:87], a[164:167], v[184:187]
 s_waitcnt lgkmcnt(8)
 ds_read_b64_tr_b16 a[144:145], v3 offset:16384
 ds_read_b64_tr_b16 a[146:147], v3 offset:17408
M v[188:191], a[92:95], a[164:167], v[188:191]
 buffer_load_dwordx4 v9, s[52:55], s28 offen offset:1024   lds
M v[188:191], a[88:91], a[160:163], v[188:191]
M v[224:227], a[32:35], a[168:171], v[224:227]
 ds_read_b128 a[160:163], v5 offset:49152
 ds_read_b128 a[164:167], v6 offset:49152
M v[224:227], a[36:39], a[172:175], v[224:227]
 ds_read_b64_tr_b16 a[148:149], v3 offset:24576
 ds_read_b64_tr_b16 a[150:151], v3 offset:25600
M v[228:231], a[44:47], a[172:175], v[228:231]
 buffer_load_dwordx4 v10, s[52:55], s28 offen offset:2048   lds
M v[228:231], a[40:43], a[168:171], v[228:231]
 ds_read_b64_tr_b16 a[152:153], v4 offset:16384
 ds_read_b64_tr_b16 a[154:155], v4 offset:17408
M v[232:235], a[48:51], a[168:171], v[232:235]
M v[232:235], a[52:55], a[172:175], v[232:235]
M v[236:239], a[60:63], a[172:175], v[236:239]
 ds_read_b64_tr_b16 a[156:157], v4 offset:24576
 ds_read_b64_tr_b16 a[158:159], v4 offset:25600
M v[236:239], a[56:59], a[168:171], v[236:239]
 buffer_load_dwordx4 v11, s[52:55], s28 offen offset:3072   lds
M v[240:243], a[64:67], a[168:171], v[240:243]
 s_add_u32 s28, s28, 128
M v[240:243], a[68:71], a[172:175], v[240:243]
M v[244:247], a[76:79], a[172:175], v[244:247]
M v[244:247], a[72:75], a[168:171], v[244:247]
M v[248:251], a[80:83], a[168:171], v[248:251]
M v[248:251], a[84:87], a[172:175], v[248:251]
 s_waitcnt lgkmcnt(6)
M v[252:255], a[92:95], a[172:175], v[252:255]
 s_waitcnt vmcnt(30) lgkmcnt(0)
M v[252:255], a[88:91], a[168:171], v[252:255]
 s_barrier
M v[32:35], a[96:99], a[160:163], v[32:35]
 s_add_u32 m0, s23, 16384
 ds_read_b128 a[168:171], v5 offset:51200
 ds_read_b128 a[172:175], v6 offset:51200
M v[32:35], a[100:103], a[164:167], v[32:35]
 ds_read_b64_tr_b16 a[32:33], v1 offset:32768
 ds_read_b64_tr_b16 a[34:35], v1 offset:33792
M v[36:39], a[108:111], a[164:167], v[36:39]
 buffer_load_dwordx4 v8, s[52:55], s28 offen offset:0   lds
M v[36:39], a[104:107], a[160:163], v[36:39]
 v_min_u32 v25, 15, v0
 v_lshlrev_b32 v25, 7, v25
M v[40:43], a[112:115], a[160:163], v[40:43]
 s_add_u32 s3, s93, 274432
 ds_read_b64_tr_b16 a[36:37], v1 offset:40960
 ds_read_b64_tr_b16 a[38:39], v1 offset:41984
M v[40:43], a[116:119], a[164:167], v[40:43]
 v_max_u32 v13, 1024, v25
M v[44:47], a[124:127], a[164:167], v[44:47]
 buffer_store_dwordx4 v[88:91], v7, s[8:11], s3 offen offset:0 sc1
M v[44:47], a[120:123], a[160:163], v[44:47]
 ds_read_b64_tr_b16 a[40:41], v2 offset:32768
 ds_read_b64_tr_b16 a[42:43], v2 offset:33792
M v[48:51], a[128:131], a[160:163], v[48:51]
 buffer_load_dwordx4 v9, s[52:55], s28 offen offset:1024   lds
M v[48:51], a[132:135], a[164:167], v[48:51]
M v[52:55], a[140:143], a[164:167], v[52:55]
 ds_read_b64_tr_b16 a[44:45], v2 offset:40960
 ds_read_b64_tr_b16 a[46:47], v2 offset:41984
M v[52:55], a[136:139], a[160:163], v[52:55]
M v[56:59], a[144:147], a[160:163], v[56:59]
M v[56:59], a[148:151], a[164:167], v[56:59]
 s_waitcnt lgkmcnt(8)
 ds_read_b64_tr_b16 a[48:49], v3 offset:32768
 ds_read_b64_tr_b16 a[50:51], v3 offset:33792
M v[60:63], a[156:159], a[164:167], v[60:63]
 buffer_load_dwordx4 v10, s[52:55], s28 offen offset:2048   lds
M v[60:63], a[152:155], a[160:163], v[60:63]
M v[96:99], a[96:99], a[168:171], v[96:99]
 ds_read_b128 a[160:163], v5 offset:53248
 ds_read_b128 a[164:167], v6 offset:53248
M v[96:99], a[100:103], a[172:175], v[96:99]
 ds_read_b64_tr_b16 a[52:53], v3 offset:40960
 ds_read_b64_tr_b16 a[54:55], v3 offset:41984
M v[100:103], a[108:111], a[172:175], v[100:103]
 buffer_store_dwordx4 v[92:95], v7, s[8:11], s3 offen offset:2048 sc1
M v[100:103], a[104:107], a[168:171], v[100:103]
 ds_read_b64_tr_b16 a[56:57], v4 offset:32768
 ds_read_b64_tr_b16 a[58:59], v4 offset:33792
M v[104:107], a[112:115], a[168:171], v[104:107]
M v[104:107], a[116:119], a[172:175], v[104:107]
 buffer_load_dwordx4 v11, s[52:55], s28 offen offset:3072   lds
M v[108:111], a[124:127], a[172:175], v[108:111]
 s_add_u32 s28, s28, 524160
 ds_read_b64_tr_b16 a[60:61], v4 offset:40960
 ds_read_b64_tr_b16 a[62:63], v4 offset:41984
M v[108:111], a[120:123], a[168:171], v[108:111]
M v[112:115], a[128:131], a[168:171], v[112:115]
M v[112:115], a[132:135], a[172:175], v[112:115]
M v[116:119], a[140:143], a[172:175], v[116:119]
M v[116:119], a[136:139], a[168:171], v[116:119]
M v[120:123], a[144:147], a[168:171], v[120:123]
M v[120:123], a[148:151], a[172:175], v[120:123]
 s_waitcnt lgkmcnt(6)
M v[124:127], a[156:159], a[172:175], v[124:127]
 s_waitcnt vmcnt(25) lgkmcnt(0)
M v[124:127], a[152:155], a[168:171], v[124:127]
 s_barrier
M v[160:163], a[96:99], a[160:163], v[160:163]
 ds_read_b128 a[168:171], v5 offset:55296
 ds_read_b128 a[172:175], v6 offset:55296
M v[160:163], a[100:103], a[164:167], v[160:163]
 ds_read_b64_tr_b16 a[64:65], v1 offset:49152
 ds_read_b64_tr_b16 a[66:67], v1 offset:50176
M v[164:167], a[108:111], a[164:167], v[164:167]
 buffer_store_dwordx4 a[208:211], v30, s[8:11], s89 offen offset:0 sc1
M v[164:167], a[104:107], a[160:163], v[164:167]
M v[168:171], a[112:115], a[160:163], v[168:171]
 ds_read_b64_tr_b16 a[68:69], v1 offset:57344
 ds_read_b64_tr_b16 a[70:71], v1 offset:58368
M v[168:171], a[116:119], a[164:167], v[168:171]
M v[172:175], a[124:127], a[164:167], v[172:175]
M v[172:175], a[120:123], a[160:163], v[172:175]
 ds_read_b64_tr_b16 a[72:73], v2 offset:49152
 ds_read_b64_tr_b16 a[74:75], v2 offset:50176
M v[176:179], a[128:131], a[160:163], v[176:179]
M v[176:179], a[132:135], a[164:167], v[176:179]
M v[180:183], a[140:143], a[164:167], v[180:183]
 ds_read_b64_tr_b16 a[76:77], v2 offset:57344
 ds_read_b64_tr_b16 a[78:79], v2 offset:58368
M v[180:183], a[136:139], a[160:163], v[180:183]
M v[184:187], a[144:147], a[160:163], v[184:187]
M v[184:187], a[148:151], a[164:167], v[184:187]
 s_waitcnt lgkmcnt(8)
 ds_read_b64_tr_b16 a[80:81], v3 offset:49152
 ds_read_b64_tr_b16 a[82:83], v3 offset:50176
M v[188:191], a[156:159], a[164:167], v[188:191]
 buffer_store_dwordx4 a[212:215], v30, s[8:11], s89 offen offset:64 sc1
M v[188:191], a[152:155], a[160:163], v[188:191]
M v[224:227], a[96:99], a[168:171], v[224:227]
 ds_read_b128 a[160:163], v5 offset:0
 ds_read_b128 a[164:167], v6 offset:0
M v[224:227], a[100:103], a[172:175], v[224:227]
 ds_read_b64_tr_b16 a[84:85], v3 offset:57344
 ds_read_b64_tr_b16 a[86:87], v3 offset:58368
M v[228:231], a[108:111], a[172:175], v[228:231]
M v[228:231], a[104:107], a[168:171], v[228:231]
 ds_read_b64_tr_b16 a[88:89], v4 offset:49152
 ds_read_b64_tr_b16 a[90:91], v4 offset:50176
M v[232:235], a[112:115], a[168:171], v[232:235]
M v[232:235], a[116:119], a[172:175], v[232:235]
M v[236:239], a[124:127], a[172:175], v[236:239]
 ds_read_b64_tr_b16 a[92:93], v4 offset:57344
 ds_read_b64_tr_b16 a[94:95], v4 offset:58368
M v[236:239], a[120:123], a[168:171], v[236:239]
M v[240:243], a[128:131], a[168:171], v[240:243]
M v[240:243], a[132:135], a[172:175], v[240:243]
M v[244:247], a[140:143], a[172:175], v[244:247]
M v[244:247], a[136:139], a[168:171], v[244:247]
M v[248:251], a[144:147], a[168:171], v[248:251]
M v[248:251], a[148:151], a[172:175], v[248:251]
 s_waitcnt lgkmcnt(6)
M v[252:255], a[156:159], a[172:175], v[252:255]
 s_waitcnt vmcnt(22) lgkmcnt(0)
M v[252:255], a[152:155], a[168:171], v[252:255]
 s_barrier
M v[32:35], a[32:35], a[160:163], v[32:35]
 s_add_u32 m0, s23, 32768
 ds_read_b128 a[168:171], v5 offset:2048
 ds_read_b128 a[172:175], v6 offset:2048
M v[32:35], a[36:39], a[164:167], v[32:35]
 ds_read_b64_tr_b16 a[96:97], v20 offset:0
 ds_read_b64_tr_b16 a[98:99], v20 offset:1024
M v[36:39], a[44:47], a[164:167], v[36:39]
 buffer_load_dwordx4 v16, s[56:59], s29 offen offset:0   lds
M v[36:39], a[40:43], a[160:163], v[36:39]
 buffer_store_dwordx4 a[216:219], v30, s[8:11], s89 offen offset:128 sc1
M v[40:43], a[48:51], a[160:163], v[40:43]
 ds_read_b64_tr_b16 a[100:101], v20 offset:8192
 ds_read_b64_tr_b16 a[102:103], v20 offset:9216
M v[40:43], a[52:55], a[164:167], v[40:43]
 buffer_load_dwordx4 v17, s[56:59], s29 offen offset:1024   lds
M v[44:47], a[60:63], a[164:167], v[44:47]
M v[44:47], a[56:59], a[160:163], v[44:47]
 ds_read_b64_tr_b16 a[104:105], v21 offset:0
 ds_read_b64_tr_b16 a[106:107], v21 offset:1024
M v[48:51], a[64:67], a[160:163], v[48:51]
M v[48:51], a[68:71], a[164:167], v[48:51]
 buffer_load_dwordx4 v18, s[56:59], s29 offen offset:2048   lds
M v[52:55], a[76:79], a[164:167], v[52:55]
 ds_read_b64_tr_b16 a[108:109], v21 offset:8192
 ds_read_b64_tr_b16 a[110:111], v21 offset:9216
M v[52:55], a[72:75], a[160:163], v[52:55]
 buffer_store_dwordx4 a[220:223], v30, s[8:11], s89 offen offset:192 sc1
M v[56:59], a[80:83], a[160:163], v[56:59]
M v[56:59], a[84:87], a[164:167], v[56:59]
 s_waitcnt lgkmcnt(8)
 ds_read_b64_tr_b16 a[112:113], v22 offset:0
 ds_read_b64_tr_b16 a[114:115], v22 offset:1024
M v[60:63], a[92:95], a[164:167], v[60:63]
 buffer_load_dwordx4 v19, s[56:59], s29 offen offset:3072   lds
M v[60:63], a[88:91], a[160:163], v[60:63]
 s_add_u32 s29, s29, 128
M v[96:99], a[32:35], a[168:171], v[96:99]
 ds_read_b128 a[160:163], v5 offset:4096
 ds_read_b128 a[164:167], v6 offset:4096
M v[96:99], a[36:39], a[172:175], v[96:99]
 ds_read_b64_tr_b16 a[116:117], v22 offset:8192
 ds_read_b64_tr_b16 a[118:119], v22 offset:9216
M v[100:103], a[44:47], a[172:175], v[100:103]
 s_lshl_b32 s28, s20, 13
 buffer_store_dwordx4 a[224:227], v30, s[8:11], s89 offen offset:256 sc1
M v[100:103], a[40:43], a[168:171], v[100:103]
 s_lshl_b32 s21, s41, 20
 ds_read_b64_tr_b16 a[120:121], v23 offset:0
 ds_read_b64_tr_b16 a[122:123], v23 offset:1024
M v[104:107], a[48:51], a[168:171], v[104:107]
 s_mov_b32 s22, 0
M v[104:107], a[52:55], a[172:175], v[104:107]
 s_lshl_b32 s7, s41, 18
M v[108:111], a[60:63], a[172:175], v[108:111]
 s_add_u32 s7, s7, 100663296
 ds_read_b64_tr_b16 a[124:125], v23 offset:8192
 ds_read_b64_tr_b16 a[126:127], v23 offset:9216
M v[108:111], a[56:59], a[168:171], v[108:111]
 s_add_u32 s38, s7, 65536
 buffer_store_dwordx4 a[228:231], v30, s[8:11], s89 offen offset:320 sc1
M v[112:115], a[64:67], a[168:171], v[112:115]
 s_sub_u32 s27, s42, 1
M v[112:115], a[68:71], a[172:175], v[112:115]
 s_mov_b32 s43, 32767
M v[116:119], a[76:79], a[172:175], v[116:119]
 s_mov_b32 s4, 0
 buffer_load_dword v24, v13, s[8:11], s46 offen sc1
M v[116:119], a[72:75], a[168:171], v[116:119]
 s_add_u32 s26, s21, 655360
 buffer_store_dwordx4 a[232:235], v30, s[8:11], s89 offen offset:384 sc1
M v[120:123], a[80:83], a[168:171], v[120:123]
 s_lshl_b32 s64, s42, 1
 s_add_u32 s65, s64, 4
 s_add_u32 s64, s64, 2
M v[120:123], a[84:87], a[172:175], v[120:123]
 s_waitcnt lgkmcnt(6)
 s_add_u32 s3, s93, 524288
M v[124:127], a[92:95], a[172:175], v[124:127]
 s_waitcnt vmcnt(23) lgkmcnt(0)
M v[124:127], a[88:91], a[168:171], v[124:127]
 s_barrier
M v[160:163], a[32:35], a[160:163], v[160:163]
 s_cmp_le_u32 s42, 5
 ds_read_b128 a[168:171], v5 offset:6144
 ds_read_b128 a[172:175], v6 offset:6144
M v[160:163], a[36:39], a[164:167], v[160:163]
 s_cselect_b32 s25, s65, 32767
 ds_read_b64_tr_b16 a[128:129], v20 offset:16384
 ds_read_b64_tr_b16 a[130:131], v20 offset:17408
M v[164:167], a[44:47], a[164:167], v[164:167]
 s_cselect_b32 s6, 14, s64
 buffer_store_dwordx4 v[128:131], v7, s[8:11], s3 offen offset:0 sc1
M v[164:167], a[40:43], a[160:163], v[164:167]
 s_mov_b32 s23, 0
M v[168:171], a[48:51], a[160:163], v[168:171]
 ds_read_b64_tr_b16 a[132:133], v20 offset:24576
 ds_read_b64_tr_b16 a[134:135], v20 offset:25600
M v[168:171], a[52:55], a[164:167], v[168:171]
M v[172:175], a[60:63], a[164:167], v[172:175]
 buffer_store_dwordx4 v[132:135], v7, s[8:11], s3 offen offset:2048 sc1
M v[172:175], a[56:59], a[160:163], v[172:175]
 s_add_u32 s3, s93, 528384
 ds_read_b64_tr_b16 a[136:137], v21 offset:16384
 ds_read_b64_tr_b16 a[138:139], v21 offset:17408
M v[176:179], a[64:67], a[160:163], v[176:179]
M v[176:179], a[68:71], a[164:167], v[176:179]
M v[180:183], a[76:79], a[164:167], v[180:183]
 ds_read_b64_tr_b16 a[140:141], v21 offset:24576
 ds_read_b64_tr_b16 a[142:143], v21 offset:25600
M v[180:183], a[72:75], a[160:163], v[180:183]
 buffer_store_dwordx4 v[136:139], v7, s[8:11], s3 offen offset:0 sc1
M v[184:187], a[80:83], a[160:163], v[184:187]
M v[184:187], a[84:87], a[164:167], v[184:187]
 s_waitcnt lgkmcnt(8)
 ds_read_b64_tr_b16 a[144:145], v22 offset:16384
 ds_read_b64_tr_b16 a[146:147], v22 offset:17408
M v[188:191], a[92:95], a[164:167], v[188:191]
M v[188:191], a[88:91], a[160:163], v[188:191]
 buffer_store_dwordx4 v[140:143], v7, s[8:11], s3 offen offset:2048 sc1
M v[224:227], a[32:35], a[168:171], v[224:227]
 ds_read_b128 a[160:163], v5 offset:16384
 ds_read_b128 a[164:167], v6 offset:16384
M v[224:227], a[36:39], a[172:175], v[224:227]
 s_add_u32 s3, s93, 532480
 ds_read_b64_tr_b16 a[148:149], v22 offset:24576
 ds_read_b64_tr_b16 a[150:151], v22 offset:25600
M v[228:231], a[44:47], a[172:175], v[228:231]
M v[228:231], a[40:43], a[168:171], v[228:231]
 ds_read_b64_tr_b16 a[152:153], v23 offset:16384
 ds_read_b64_tr_b16 a[154:155], v23 offset:17408
M v[232:235], a[48:51], a[168:171], v[232:235]
 buffer_store_dwordx4 v[144:147], v7, s[8:11], s3 offen offset:0 sc1
M v[232:235], a[52:55], a[172:175], v[232:235]
M v[236:239], a[60:63], a[172:175], v[236:239]
 ds_read_b64_tr_b16 a[156:157], v23 offset:24576
 ds_read_b64_tr_b16 a[158:159], v23 offset:25600
M v[236:239], a[56:59], a[168:171], v[236:239]
M v[240:243], a[64:67], a[168:171], v[240:243]
M v[240:243], a[68:71], a[172:175], v[240:243]
M v[244:247], a[76:79], a[172:175], v[244:247]
M v[244:247], a[72:75], a[168:171], v[244:247]
M v[248:251], a[80:83], a[168:171], v[248:251]
M v[248:251], a[84:87], a[172:175], v[248:251]
 s_waitcnt lgkmcnt(6)
M v[252:255], a[92:95], a[172:175], v[252:255]
 s_waitcnt vmcnt(23) lgkmcnt(0)
M v[252:255], a[88:91], a[168:171], v[252:255]
 s_barrier
M v[32:35], a[96:99], a[160:163], v[32:35]
 ds_read_b128 a[168:171], v5 offset:18432
 ds_read_b128 a[172:175], v6 offset:18432
M v[32:35], a[100:103], a[164:167], v[32:35]
 ds_read_b64_tr_b16 a[32:33], v1 offset:0
 ds_read_b64_tr_b16 a[34:35], v1 offset:1024
M v[36:39], a[108:111], a[164:167], v[36:39]
 v_add_u32 v10, s28, v7
 v_add_u32 v11, 0x1000, v10
M v[36:39], a[104:107], a[160:163], v[36:39]
 s_waitcnt vmcnt(6)
 v_cmp_eq_u32 vcc, 0, v24
M v[40:43], a[112:115], a[160:163], v[40:43]
 s_lshl_b32 s64, s20, 10
 ds_read_b64_tr_b16 a[36:37], v1 offset:8192
 ds_read_b64_tr_b16 a[38:39], v1 offset:9216
M v[40:43], a[116:119], a[164:167], v[40:43]
 s_cbranch_vccnz L_f1s04
L_f1r04:
M v[44:47], a[124:127], a[164:167], v[44:47]
 s_add_u32 m0, s28, 98304
 s_nop 0
 buffer_load_dwordx4 v10, s[8:11], s21 offen offset:0 sc1 lds
M v[44:47], a[120:123], a[160:163], v[44:47]
 ds_read_b64_tr_b16 a[40:41], v2 offset:0
 ds_read_b64_tr_b16 a[42:43], v2 offset:1024
M v[48:51], a[128:131], a[160:163], v[48:51]
 buffer_store_dwordx4 v[148:151], v7, s[8:11], s3 offen offset:2048 sc1
M v[48:51], a[132:135], a[164:167], v[48:51]
M v[52:55], a[140:143], a[164:167], v[52:55]
 ds_read_b64_tr_b16 a[44:45], v2 offset:8192
 ds_read_b64_tr_b16 a[46:47], v2 offset:9216
M v[52:55], a[136:139], a[160:163], v[52:55]
 buffer_load_dwordx4 v10, s[8:11], s21 offen offset:1024 sc1 lds
M v[56:59], a[144:147], a[160:163], v[56:59]
M v[56:59], a[148:151], a[164:167], v[56:59]
 s_waitcnt lgkmcnt(8)
 ds_read_b64_tr_b16 a[48:49], v3 offset:0
 ds_read_b64_tr_b16 a[50:51], v3 offset:1024
M v[60:63], a[156:159], a[164:167], v[60:63]
M v[60:63], a[152:155], a[160:163], v[60:63]
 s_add_u32 s3, s93, 536576
 buffer_load_dwordx4 v10, s[8:11], s21 offen offset:2048 sc1 lds
M v[96:99], a[96:99], a[168:171], v[96:99]
 ds_read_b128 a[160:163], v5 offset:20480
 ds_read_b128 a[164:167], v6 offset:20480
M v[96:99], a[100:103], a[172:175], v[96:99]
 ds_read_b64_tr_b16 a[52:53], v3 offset:8192
 ds_read_b64_tr_b16 a[54:55], v3 offset:9216
M v[100:103], a[108:111], a[172:175], v[100:103]
 buffer_store_dwordx4 v[152:155], v7, s[8:11], s3 offen offset:0 sc1
M v[100:103], a[104:107], a[168:171], v[100:103]
 ds_read_b64_tr_b16 a[56:57], v4 offset:0
 ds_read_b64_tr_b16 a[58:59], v4 offset:1024
M v[104:107], a[112:115], a[168:171], v[104:107]
 buffer_load_dwordx4 v10, s[8:11], s21 offen offset:3072 sc1 lds
M v[104:107], a[116:119], a[172:175], v[104:107]
 s_add_u32 m0, s28, 102400
M v[108:111], a[124:127], a[172:175], v[108:111]
 ds_read_b64_tr_b16 a[60:61], v4 offset:8192
 ds_read_b64_tr_b16 a[62:63], v4 offset:9216
M v[108:111], a[120:123], a[168:171], v[108:111]
M v[112:115], a[128:131], a[168:171], v[112:115]
 buffer_load_dwordx4 v11, s[8:11], s21 offen offset:0 sc1 lds
M v[112:115], a[132:135], a[172:175], v[112:115]
M v[116:119], a[140:143], a[172:175], v[116:119]
 buffer_store_dwordx4 v[156:159], v7, s[8:11], s3 offen offset:2048 sc1
M v[116:119], a[136:139], a[168:171], v[116:119]
M v[120:123], a[144:147], a[168:171], v[120:123]
 buffer_load_dwordx4 v11, s[8:11], s21 offen offset:1024 sc1 lds
M v[120:123], a[148:151], a[172:175], v[120:123]
 s_waitcnt lgkmcnt(6)
M v[124:127], a[156:159], a[172:175], v[124:127]
 s_waitcnt lgkmcnt(0)
 buffer_load_dwordx4 v11, s[8:11], s21 offen offset:2048 sc1 lds
M v[124:127], a[152:155], a[168:171], v[124:127]
 s_barrier
M v[160:163], a[96:99], a[160:163], v[160:163]
 ds_read_b128 a[168:171], v5 offset:22528
 ds_read_b128 a[172:175], v6 offset:22528
M v[160:163], a[100:103], a[164:167], v[160:163]
 ds_read_b64_tr_b16 a[64:65], v1 offset:16384
 ds_read_b64_tr_b16 a[66:67], v1 offset:17408
M v[164:167], a[108:111], a[164:167], v[164:167]
 buffer_load_dwordx4 v11, s[8:11], s21 offen offset:3072 sc1 lds
M v[164:167], a[104:107], a[160:163], v[164:167]
 s_add_u32 s24, s23, 16777216
M v[168:171], a[112:115], a[160:163], v[168:171]
 s_mov_b32 s23, s21
 ds_read_b64_tr_b16 a[68:69], v1 offset:24576
 ds_read_b64_tr_b16 a[70:71], v1 offset:25600
M v[168:171], a[116:119], a[164:167], v[168:171]
 s_add_u32 s21, s21, 32768
 s_add_u32 s3, s93, 786432
M v[172:175], a[124:127], a[164:167], v[172:175]
 s_add_u32 s22, s22, 1
 buffer_store_dwordx4 v[192:195], v7, s[8:11], s3 offen offset:0 sc1
M v[172:175], a[120:123], a[160:163], v[172:175]
 s_cmp_eq_u32 s22, s25
 ds_read_b64_tr_b16 a[72:73], v2 offset:16384
 ds_read_b64_tr_b16 a[74:75], v2 offset:17408
M v[176:179], a[128:131], a[160:163], v[176:179]
 s_cselect_b32 s21, s26, s21
 v_subrev_u32 v5, 0x10000, v5
 v_subrev_u32 v6, 0x10000, v6
M v[176:179], a[132:135], a[164:167], v[176:179]
 s_cmp_eq_u32 s22, s43
M v[180:183], a[140:143], a[164:167], v[180:183]
 s_cselect_b32 s21, s4, s21
 ds_read_b64_tr_b16 a[76:77], v2 offset:24576
 ds_read_b64_tr_b16 a[78:79], v2 offset:25600
M v[180:183], a[136:139], a[160:163], v[180:183]
 s_cmp_eq_u32 s22, s6
M v[184:187], a[144:147], a[160:163], v[184:187]
 s_cselect_b32 s21, s7, s21
 v_mov_b32 v9, v25
 v_lshrrev_b32 v24, 4, v0
M v[184:187], a[148:151], a[164:167], v[184:187]
 s_waitcnt lgkmcnt(8)
 ds_read_b64_tr_b16 a[80:81], v3 offset:16384
 ds_read_b64_tr_b16 a[82:83], v3 offset:17408
M v[188:191], a[156:159], a[164:167], v[188:191]
 v_lshlrev_b32 v24, 2, v24
 v_and_b32 v25, 15, v0
M v[188:191], a[152:155], a[160:163], v[188:191]
 v_sub_u32 v24, v24, v25
M v[224:227], a[96:99], a[168:171], v[224:227]
 s_add_u32 s64, s64, s34
 ds_read_b128 a[160:163], v5 offset:32768
 ds_read_b128 a[164:167], v6 offset:32768
M v[224:227], a[100:103], a[172:175], v[224:227]
 s_add_u32 s52, s64, 65536
 ds_read_b64_tr_b16 a[84:85], v3 offset:24576
 ds_read_b64_tr_b16 a[86:87], v3 offset:25600
M v[228:231], a[108:111], a[172:175], v[228:231]
 s_mov_b32 s55, 0x21800000
 buffer_store_dwordx4 v[196:199], v7, s[8:11], s3 offen offset:2048 sc1
M v[228:231], a[104:107], a[168:171], v[228:231]
 s_and_b32 s65, s39, 0
 ds_read_b64_tr_b16 a[88:89], v4 offset:16384
 ds_read_b64_tr_b16 a[90:91], v4 offset:17408
M v[232:235], a[112:115], a[168:171], v[232:235]
 s_cmp_eq_u32 s20, 0
M v[232:235], a[116:119], a[172:175], v[232:235]
 s_cselect_b32 s54, s39, s65
M v[236:239], a[124:127], a[172:175], v[236:239]
 s_lshr_b32 s64, s20, 1
 ds_read_b64_tr_b16 a[92:93], v4 offset:24576
 ds_read_b64_tr_b16 a[94:95], v4 offset:25600
M v[236:239], a[120:123], a[168:171], v[236:239]
 s_lshl_b32 s64, s64, 17
M v[240:243], a[128:131], a[168:171], v[240:243]
 s_and_b32 s65, s20, 1
M v[240:243], a[132:135], a[172:175], v[240:243]
 s_lshl_b32 s65, s65, 12
M v[244:247], a[140:143], a[172:175], v[244:247]
 s_add_u32 s64, s64, s65
 v_add_u32 v14, s64, v7
 v_mov_b32 v8, 0xff800000
M v[244:247], a[136:139], a[168:171], v[244:247]
 v_cmp_lt_i32 s[16:17], 0, v24
 v_cmp_lt_i32 s[18:19], -1, v24
M v[248:251], a[144:147], a[168:171], v[248:251]
 v_cmp_lt_i32 s[48:49], -2, v24
 v_cmp_lt_i32 s[50:51], -3, v24
M v[248:251], a[148:151], a[172:175], v[248:251]
 s_waitcnt lgkmcnt(6)
M v[252:255], a[156:159], a[172:175], v[252:255]
 s_waitcnt lgkmcnt(0)
M v[252:255], a[152:155], a[168:171], v[252:255]
 s_barrier
M v[32:35], a[32:35], a[160:163], v[32:35]
 ds_read_b128 a[168:171], v5 offset:34816
 ds_read_b128 a[172:175], v6 offset:34816
M v[32:35], a[36:39], a[164:167], v[32:35]
 buffer_load_dword v24, v9, s[8:11], s46 offen sc1
M v[36:39], a[44:47], a[164:167], v[36:39]
 v_mov_b32 v1, v15
 v_add_u32 v2, 0x10000, v7
M v[36:39], a[40:43], a[160:163], v[36:39]
 v_mov_b32 v3, v10
 v_mov_b32 v4, v11
M v[40:43], a[48:51], a[160:163], v[40:43]
 s_mov_b64 s[60:61], s[76:77]
M v[40:43], a[52:55], a[164:167], v[40:43]
 s_mov_b32 s62, s78
M v[44:47], a[60:63], a[164:167], v[44:47]
 s_mov_b32 s63, 0x20000
 v_lshl_add_u32 v10, v0, 7, s95
 v_and_b32 v0, 48, v0
M v[44:47], a[56:59], a[160:163], v[44:47]
 v_lshl_add_u32 v0, v0, 24, v10
 v_mul_f32 v32, s5, v32
M v[48:51], a[64:67], a[160:163], v[48:51]
 v_mul_f32 v33, s5, v33
 v_mul_f32 v34, s5, v34
M v[48:51], a[68:71], a[164:167], v[48:51]
 v_mul_f32 v35, s5, v35
 v_mul_f32 v36, s5, v36
M v[52:55], a[76:79], a[164:167], v[52:55]
 v_mul_f32 v37, s5, v37
 v_mul_f32 v38, s5, v38
M v[52:55], a[72:75], a[160:163], v[52:55]
 v_mul_f32 v39, s5, v39
 v_cvt_pk_bf16_f32 v32, v32, v33
M v[56:59], a[80:83], a[160:163], v[56:59]
 v_cvt_pk_bf16_f32 v33, v34, v35
 v_cvt_pk_bf16_f32 v34, v36, v37
M v[56:59], a[84:87], a[164:167], v[56:59]
 s_waitcnt lgkmcnt(0)
 v_cvt_pk_bf16_f32 v35, v38, v39
 ds_write_b128 v14, v[32:35] offset:0
M v[60:63], a[92:95], a[164:167], v[60:63]
 s_add_u32 s3, s93, 790528
 buffer_store_dwordx4 v[200:203], v7, s[8:11], s3 offen offset:0 sc1
M v[60:63], a[88:91], a[160:163], v[60:63]
 v_mul_f32 v40, s5, v40
 v_mul_f32 v41, s5, v41
M v[96:99], a[32:35], a[168:171], v[96:99]
 ds_read_b128 a[160:163], v5 offset:36864
 ds_read_b128 a[164:167], v6 offset:36864
M v[96:99], a[36:39], a[172:175], v[96:99]
 v_mul_f32 v42, s5, v42
 v_mul_f32 v43, s5, v43
M v[100:103], a[44:47], a[172:175], v[100:103]
 v_mul_f32 v44, s5, v44
 v_mul_f32 v45, s5, v45
M v[100:103], a[40:43], a[168:171], v[100:103]
 v_mul_f32 v46, s5, v46
 v_mul_f32 v47, s5, v47
M v[104:107], a[48:51], a[168:171], v[104:107]
 v_cvt_pk_bf16_f32 v40, v40, v41
 v_cvt_pk_bf16_f32 v41, v42, v43
M v[104:107], a[52:55], a[172:175], v[104:107]
 v_cvt_pk_bf16_f32 v42, v44, v45
 v_cvt_pk_bf16_f32 v43, v46, v47
M v[108:111], a[60:63], a[172:175], v[108:111]
 ds_write_b128 v14, v[40:43] offset:1024
M v[108:111], a[56:59], a[168:171], v[108:111]
 buffer_store_dwordx4 v[204:207], v7, s[8:11], s3 offen offset:2048 sc1
M v[112:115], a[64:67], a[168:171], v[112:115]
 v_mul_f32 v48, s5, v48
 v_mul_f32 v49, s5, v49
M v[112:115], a[68:71], a[172:175], v[112:115]
 v_mul_f32 v50, s5, v50
 v_mul_f32 v51, s5, v51
M v[116:119], a[76:79], a[172:175], v[116:119]
 v_mul_f32 v52, s5, v52
 v_mul_f32 v53, s5, v53
M v[116:119], a[72:75], a[168:171], v[116:119]
 v_mul_f32 v54, s5, v54
 v_mul_f32 v55, s5, v55
M v[120:123], a[80:83], a[168:171], v[120:123]
 v_cvt_pk_bf16_f32 v48, v48, v49
 v_cvt_pk_bf16_f32 v49, v50, v51
M v[120:123], a[84:87], a[172:175], v[120:123]
 s_waitcnt lgkmcnt(1)
 v_cvt_pk_bf16_f32 v50, v52, v53
 v_cvt_pk_bf16_f32 v51, v54, v55
M v[124:127], a[92:95], a[172:175], v[124:127]
 ds_write_b128 v14, v[48:51] offset:2048
M v[124:127], a[88:91], a[168:171], v[124:127]
 s_add_u32 s3, s93, 794624
 buffer_store_dwordx4 v[208:211], v7, s[8:11], s3 offen offset:0 sc1
M v[160:163], a[32:35], a[160:163], v[160:163]
 ds_read_b128 a[168:171], v5 offset:38912
 ds_read_b128 a[172:175], v6 offset:38912
M v[160:163], a[36:39], a[164:167], v[160:163]
 v_mul_f32 v56, s5, v56
 v_mul_f32 v57, s5, v57
M v[164:167], a[44:47], a[164:167], v[164:167]
 v_mul_f32 v58, s5, v58
 v_mul_f32 v59, s5, v59
M v[164:167], a[40:43], a[160:163], v[164:167]
 v_mul_f32 v60, s5, v60
 v_mul_f32 v61, s5, v61
M v[168:171], a[48:51], a[160:163], v[168:171]
 v_mul_f32 v62, s5, v62
 v_mul_f32 v63, s5, v63
M v[168:171], a[52:55], a[164:167], v[168:171]
 v_cvt_pk_bf16_f32 v56, v56, v57
 v_cvt_pk_bf16_f32 v57, v58, v59
M v[172:175], a[60:63], a[164:167], v[172:175]
 v_cvt_pk_bf16_f32 v58, v60, v61
 v_cvt_pk_bf16_f32 v59, v62, v63
M v[172:175], a[56:59], a[160:163], v[172:175]
 s_waitcnt lgkmcnt(0)
 ds_write_b128 v14, v[56:59] offset:3072
M v[176:179], a[64:67], a[160:163], v[176:179]
 s_barrier
M v[176:179], a[68:71], a[164:167], v[176:179]
M v[180:183], a[76:79], a[164:167], v[180:183]
 s_add_u32 m0, s28, 32768
 s_nop 0
 buffer_load_dwordx4 v3, s[8:11], s21 offen offset:0 sc1 lds
M v[180:183], a[72:75], a[160:163], v[180:183]
M v[184:187], a[80:83], a[160:163], v[184:187]
 buffer_store_dwordx4 v[212:215], v7, s[8:11], s3 offen offset:2048 sc1
M v[184:187], a[84:87], a[164:167], v[184:187]
 v_mul_f32 v96, s5, v96
 v_mul_f32 v97, s5, v97
M v[188:191], a[92:95], a[164:167], v[188:191]
 buffer_load_dwordx4 v3, s[8:11], s21 offen offset:1024 sc1 lds
M v[188:191], a[88:91], a[160:163], v[188:191]
 v_mul_f32 v98, s5, v98
 v_mul_f32 v99, s5, v99
M v[224:227], a[32:35], a[168:171], v[224:227]
 v_mul_f32 v100, s5, v100
 v_mul_f32 v101, s5, v101
M v[224:227], a[36:39], a[172:175], v[224:227]
 v_mul_f32 v102, s5, v102
 v_mul_f32 v103, s5, v103
M v[228:231], a[44:47], a[172:175], v[228:231]
 buffer_load_dwordx4 v3, s[8:11], s21 offen offset:2048 sc1 lds
M v[228:231], a[40:43], a[168:171], v[228:231]
 v_cvt_pk_bf16_f32 v96, v96, v97
 v_cvt_pk_bf16_f32 v97, v98, v99
M v[232:235], a[48:51], a[168:171], v[232:235]
 v_cvt_pk_bf16_f32 v98, v100, v101
 v_cvt_pk_bf16_f32 v99, v102, v103
M v[232:235], a[52:55], a[172:175], v[232:235]
 ds_write_b128 v14, v[96:99] offset:8192
M v[236:239], a[60:63], a[172:175], v[236:239]
 s_add_u32 s3, s93, 798720
 buffer_load_dwordx4 v3, s[8:11], s21 offen offset:3072 sc1 lds
M v[236:239], a[56:59], a[168:171], v[236:239]
 s_add_u32 m0, s28, 36864
M v[240:243], a[64:67], a[168:171], v[240:243]
 buffer_store_dwordx4 v[216:219], v7, s[8:11], s3 offen offset:0 sc1
M v[240:243], a[68:71], a[172:175], v[240:243]
 v_mul_f32 v104, s5, v104
 v_mul_f32 v105, s5, v105
M v[244:247], a[76:79], a[172:175], v[244:247]
 buffer_load_dwordx4 v4, s[8:11], s21 offen offset:0 sc1 lds
M v[244:247], a[72:75], a[168:171], v[244:247]
 v_mul_f32 v106, s5, v106
 v_mul_f32 v107, s5, v107
M v[248:251], a[80:83], a[168:171], v[248:251]
 v_mul_f32 v108, s5, v108
 v_mul_f32 v109, s5, v109
M v[248:251], a[84:87], a[172:175], v[248:251]
 v_mul_f32 v110, s5, v110
 v_mul_f32 v111, s5, v111
M v[252:255], a[92:95], a[172:175], v[252:255]
 buffer_load_dwordx4 v4, s[8:11], s21 offen offset:1024 sc1 lds
M v[252:255], a[88:91], a[168:171], v[252:255]
 buffer_load_dwordx4 v4, s[8:11], s21 offen offset:2048 sc1 lds
 buffer_load_dwordx4 v4, s[8:11], s21 offen offset:3072 sc1 lds
 s_add_u32 s24, s23, 16777216
 s_mov_b32 s23, s21
 s_add_u32 s21, s21, 32768
 s_add_u32 s22, s22, 1
 s_cmp_eq_u32 s22, s25
 s_cselect_b32 s21, s26, s21
 s_cmp_eq_u32 s22, s43
 s_cselect_b32 s21, s4, s21
 s_cmp_eq_u32 s22, s6
 s_cselect_b32 s21, s7, s21
 v_cvt_pk_bf16_f32 v104, v104, v105
 v_cvt_pk_bf16_f32 v105, v106, v107
 v_cvt_pk_bf16_f32 v106, v108, v109
 v_cvt_pk_bf16_f32 v107, v110, v111
 ds_write_b128 v14, v[104:107] offset:9216
 buffer_store_dwordx4 v[220:223], v7, s[8:11], s3 offen offset:2048 sc1
 v_pk_mul_f32 v[112:113], v[112:113], s[4:5] op_sel:[0,1] op_sel_hi:[1,1]
 v_pk_mul_f32 v[114:115], v[114:115], s[4:5] op_sel:[0,1] op_sel_hi:[1,1]
 v_pk_mul_f32 v[116:117], v[116:117], s[4:5] op_sel:[0,1] op_sel_hi:[1,1]
 v_pk_mul_f32 v[118:119], v[118:119], s[4:5] op_sel:[0,1] op_sel_hi:[1,1]
 v_cvt_pk_bf16_f32 v112, v112, v113
 v_cvt_pk_bf16_f32 v113, v114, v115
 v_cvt_pk_bf16_f32 v114, v116, v117
 v_cvt_pk_bf16_f32 v115, v118, v119
 ds_write_b128 v14, v[112:115] offset:10240
 v_pk_mul_f32 v[120:121], v[120:121], s[4:5] op_sel:[0,1] op_sel_hi:[1,1]
 v_pk_mul_f32 v[122:123], v[122:123], s[4:5] op_sel:[0,1] op_sel_hi:[1,1]
 v_pk_mul_f32 v[124:125], v[124:125], s[4:5] op_sel:[0,1] op_sel_hi:[1,1]
 v_pk_mul_f32 v[126:127], v[126:127], s[4:5] op_sel:[0,1] op_sel_hi:[1,1]
 v_cvt_pk_bf16_f32 v120, v120, v121
 v_cvt_pk_bf16_f32 v121, v122, v123
 v_cvt_pk_bf16_f32 v122, v124, v125
 v_cvt_pk_bf16_f32 v123, v126, v127
 ds_write_b128 v14, v[120:123] offset:11264
 v_pk_mul_f32 v[160:161], v[160:161], s[4:5] op_sel:[0,1] op_sel_hi:[1,1]
 v_pk_mul_f32 v[162:163], v[162:163], s[4:5] op_sel:[0,1] op_sel_hi:[1,1]
 v_pk_mul_f32 v[164:165], v[164:165], s[4:5] op_sel:[0,1] op_sel_hi:[1,1]
 v_pk_mul_f32 v[166:167], v[166:167], s[4:5] op_sel:[0,1] op_sel_hi:[1,1]
 v_cvt_pk_bf16_f32 v160, v160, v161
 v_cvt_pk_bf16_f32 v161, v162, v163
 v_cvt_pk_bf16_f32 v162, v164, v165
 v_cvt_pk_bf16_f32 v163, v166, v167
 ds_write_b128 v14, v[160:163] offset:16384
 v_pk_mul_f32 v[168:169], v[168:169], s[4:5] op_sel:[0,1] op_sel_hi:[1,1]
 v_pk_mul_f32 v[170:171], v[170:171], s[4:5] op_sel:[0,1] op_sel_hi:[1,1]
 v_pk_mul_f32 v[172:173], v[172:173], s[4:5] op_sel:[0,1] op_sel_hi:[1,1]
 v_pk_mul_f32 v[174:175], v[174:175], s[4:5] op_sel:[0,1] op_sel_hi:[1,1]
 v_cvt_pk_bf16_f32 v168, v168, v169
 v_cvt_pk_bf16_f32 v169, v170, v171
 v_cvt_pk_bf16_f32 v170, v172, v173
 v_cvt_pk_bf16_f32 v171, v174, v175
 ds_write_b128 v14, v[168:171] offset:17408
 v_pk_mul_f32 v[176:177], v[176:177], s[4:5] op_sel:[0,1] op_sel_hi:[1,1]
 v_pk_mul_f32 v[178:179], v[178:179], s[4:5] op_sel:[0,1] op_sel_hi:[1,1]
 v_pk_mul_f32 v[180:181], v[180:181], s[4:5] op_sel:[0,1] op_sel_hi:[1,1]
 v_pk_mul_f32 v[182:183], v[182:183], s[4:5] op_sel:[0,1] op_sel_hi:[1,1]
 v_cvt_pk_bf16_f32 v176, v176, v177
 v_cvt_pk_bf16_f32 v177, v178, v179
 v_cvt_pk_bf16_f32 v178, v180, v181
 v_cvt_pk_bf16_f32 v179, v182, v183
 ds_write_b128 v14, v[176:179] offset:18432
 v_pk_mul_f32 v[184:185], v[184:185], s[4:5] op_sel:[0,1] op_sel_hi:[1,1]
 v_pk_mul_f32 v[186:187], v[186:187], s[4:5] op_sel:[0,1] op_sel_hi:[1,1]
 v_pk_mul_f32 v[188:189], v[188:189], s[4:5] op_sel:[0,1] op_sel_hi:[1,1]
 v_pk_mul_f32 v[190:191], v[190:191], s[4:5] op_sel:[0,1] op_sel_hi:[1,1]
 v_cvt_pk_bf16_f32 v184, v184, v185
 v_cvt_pk_bf16_f32 v185, v186, v187
 v_cvt_pk_bf16_f32 v186, v188, v189
 v_cvt_pk_bf16_f32 v187, v190, v191
 ds_write_b128 v14, v[184:187] offset:19456
 v_pk_mul_f32 v[224:225], v[224:225], s[4:5] op_sel:[0,1] op_sel_hi:[1,1]
 v_pk_mul_f32 v[226:227], v[226:227], s[4:5] op_sel:[0,1] op_sel_hi:[1,1]
 v_pk_mul_f32 v[228:229], v[228:229], s[4:5] op_sel:[0,1] op_sel_hi:[1,1]
 v_pk_mul_f32 v[230:231], v[230:231], s[4:5] op_sel:[0,1] op_sel_hi:[1,1]
 v_cvt_pk_bf16_f32 v224, v224, v225
 v_cvt_pk_bf16_f32 v225, v226, v227
 v_cvt_pk_bf16_f32 v226, v228, v229
 v_cvt_pk_bf16_f32 v227, v230, v231
 ds_write_b128 v14, v[224:227] offset:24576
 v_pk_mul_f32 v[232:233], v[232:233], s[4:5] op_sel:[0,1] op_sel_hi:[1,1]
 v_pk_mul_f32 v[234:235], v[234:235], s[4:5] op_sel:[0,1] op_sel_hi:[1,1]
 v_pk_mul_f32 v[236:237], v[236:237], s[4:5] op_sel:[0,1] op_sel_hi:[1,1]
 v_pk_mul_f32 v[238:239], v[238:239], s[4:5] op_sel:[0,1] op_sel_hi:[1,1]
 v_cvt_pk_bf16_f32 v232, v232, v233
 v_cvt_pk_bf16_f32 v233, v234, v235
 v_cvt_pk_bf16_f32 v234, v236, v237
 v_cvt_pk_bf16_f32 v235, v238, v239
 ds_write_b128 v14, v[232:235] offset:25600
 v_pk_mul_f32 v[240:241], v[240:241], s[4:5] op_sel:[0,1] op_sel_hi:[1,1]
 v_pk_mul_f32 v[242:243], v[242:243], s[4:5] op_sel:[0,1] op_sel_hi:[1,1]
 v_pk_mul_f32 v[244:245], v[244:245], s[4:5] op_sel:[0,1] op_sel_hi:[1,1]
 v_pk_mul_f32 v[246:247], v[246:247], s[4:5] op_sel:[0,1] op_sel_hi:[1,1]
 v_cvt_pk_bf16_f32 v240, v240, v241
 v_cvt_pk_bf16_f32 v241, v242, v243
 v_cvt_pk_bf16_f32 v242, v244, v245
 v_cvt_pk_bf16_f32 v243, v246, v247
 ds_write_b128 v14, v[240:243] offset:26624
 v_pk_mul_f32 v[248:249], v[248:249], s[4:5] op_sel:[0,1] op_sel_hi:[1,1]
 v_pk_mul_f32 v[250:251], v[250:251], s[4:5] op_sel:[0,1] op_sel_hi:[1,1]
 v_pk_mul_f32 v[252:253], v[252:253], s[4:5] op_sel:[0,1] op_sel_hi:[1,1]
 v_pk_mul_f32 v[254:255], v[254:255], s[4:5] op_sel:[0,1] op_sel_hi:[1,1]
 v_cvt_pk_bf16_f32 v248, v248, v249
 v_cvt_pk_bf16_f32 v249, v250, v251
 v_cvt_pk_bf16_f32 v250, v252, v253
 v_cvt_pk_bf16_f32 v251, v254, v255
 ds_write_b128 v14, v[248:251] offset:27648
 s_waitcnt vmcnt(17) lgkmcnt(0)
 s_barrier
 ds_read_b128 a[64:67], v2 offset:32768
 ds_read_b128 a[68:71], v2 offset:33792
 ds_read_b128 a[72:75], v2 offset:34816
 ds_read_b128 a[76:79], v2 offset:35840
 ds_read_b128 a[80:83], v2 offset:36864
 ds_read_b128 a[84:87], v2 offset:37888
 ds_read_b128 a[88:91], v2 offset:38912
 ds_read_b128 a[92:95], v2 offset:39936
 s_lshl_b32 s64, s20, 13
 s_sub_u32 s65, 155648, s64
 v_add_u32 v10, s64, v7
 v_add_u32 v11, s65, v7
 ds_read_b128 a[0:3], v10 offset:0
 ds_read_b128 a[4:7], v10 offset:1024
 ds_read_b128 a[8:11], v10 offset:2048
 ds_read_b128 a[12:15], v10 offset:3072
 ds_read_b128 a[16:19], v10 offset:4096
 ds_read_b128 a[20:23], v10 offset:5120
 ds_read_b128 a[24:27], v10 offset:6144
 ds_read_b128 a[28:31], v10 offset:7168
 ds_read_b128 a[32:35], v11 offset:0
 ds_read_b128 a[36:39], v11 offset:1024
 ds_read_b128 a[40:43], v11 offset:2048
 ds_read_b128 a[44:47], v11 offset:3072
 ds_read_b128 a[48:51], v11 offset:4096
 ds_read_b128 a[52:55], v11 offset:5120
 ds_read_b128 a[56:59], v11 offset:6144
 ds_read_b128 a[60:63], v11 offset:7168
 s_waitcnt vmcnt(14)
 v_cmp_eq_u32 vcc, 0, v24
 v_mov_b32 v17, 5
 v_or_b32 v6, s35, v7
 s_cbranch_vccnz L_f1s05
L_f1r05:
 s_mov_b32 s30, s93
 s_mov_b32 s29, s94
 s_cmp_eq_u32 s20, 0
 s_cselect_b32 s5, 0, 0
 v_mov_b32 v32, 0xc1800000
 v_mov_b32 v33, 0xc1800000
 v_mov_b32 v34, 0xc1800000
 v_mov_b32 v35, 0xc1800000
 v_mov_b32 v36, 0xc1800000
 v_mov_b32 v37, 0xc1800000
 v_mov_b32 v38, 0xc1800000
 v_mov_b32 v39, 0xc1800000
 s_waitcnt lgkmcnt(0)
M v[64:67], a[64:67], a[0:3], v[32:35]
 ds_read_b128 a[96:99], v2 offset:40960
 v_mov_b32 v30, 0
M v[64:67], a[68:71], a[4:7], v[64:67]
 s_add_u32 m0, s28, 65536
 ds_read_b128 a[100:103], v2 offset:41984
 v_mov_b32 v31, 0
M v[64:67], a[72:75], a[8:11], v[64:67]
 buffer_load_dwordx4 v3, s[8:11], s24 offen offset:0 sc1 lds
M v[64:67], a[76:79], a[12:15], v[64:67]
 ds_read_b128 a[104:107], v2 offset:43008
M v[64:67], a[80:83], a[16:19], v[64:67]
 ds_read_b128 a[108:111], v2 offset:44032
M v[64:67], a[84:87], a[20:23], v[64:67]
 buffer_load_dwordx4 v3, s[8:11], s24 offen offset:1024 sc1 lds
M v[64:67], a[88:91], a[24:27], v[64:67]
 ds_read_b128 a[112:115], v2 offset:45056
M v[64:67], a[92:95], a[28:31], v[64:67]
 ds_read_b128 a[116:119], v2 offset:46080
M v[68:71], a[92:95], a[60:63], v[36:39]
M v[68:71], a[88:91], a[56:59], v[68:71]
 ds_read_b128 a[120:123], v2 offset:47104
M v[68:71], a[84:87], a[52:55], v[68:71]
 ds_read_b128 a[124:127], v2 offset:48128
M v[68:71], a[80:83], a[48:51], v[68:71]
 buffer_load_dwordx4 v3, s[8:11], s24 offen offset:2048 sc1 lds
M v[68:71], a[76:79], a[44:47], v[68:71]
 v_exp_f32 v18, v64
M v[68:71], a[72:75], a[40:43], v[68:71]
 v_exp_f32 v19, v65
M v[68:71], a[68:71], a[36:39], v[68:71]
 v_exp_f32 v20, v66
M v[68:71], a[64:67], a[32:35], v[68:71]
 s_waitcnt lgkmcnt(0)
 v_exp_f32 v21, v67
M v[72:75], a[96:99], a[0:3], v[32:35]
 ds_read_b128 a[64:67], v2 offset:49152
 v_add_f32 v26, v18, v19
M v[72:75], a[100:103], a[4:7], v[72:75]
 ds_read_b128 a[68:71], v2 offset:50176
 v_cvt_pk_bf16_f32 v40, v18, v19
M v[72:75], a[104:107], a[8:11], v[72:75]
 buffer_load_dwordx4 v3, s[8:11], s24 offen offset:3072 sc1 lds
M v[72:75], a[108:111], a[12:15], v[72:75]
 ds_read_b128 a[72:75], v2 offset:51200
 v_add_f32 v26, v20, v26
M v[72:75], a[112:115], a[16:19], v[72:75]
 s_add_u32 m0, s28, 69632
 ds_read_b128 a[76:79], v2 offset:52224
 v_cvt_pk_bf16_f32 v41, v20, v21
M v[72:75], a[116:119], a[20:23], v[72:75]
 buffer_load_dwordx4 v4, s[8:11], s24 offen offset:0 sc1 lds
M v[72:75], a[120:123], a[24:27], v[72:75]
 ds_read_b128 a[80:83], v2 offset:53248
 v_add_f32 v26, v21, v26
M v[72:75], a[124:127], a[28:31], v[72:75]
 ds_read_b128 a[84:87], v2 offset:54272
M v[76:79], a[124:127], a[60:63], v[36:39]
 v_exp_f32 v22, v68
M v[76:79], a[120:123], a[56:59], v[76:79]
 ds_read_b128 a[88:91], v2 offset:55296
M v[76:79], a[116:119], a[52:55], v[76:79]
 ds_read_b128 a[92:95], v2 offset:56320
M v[76:79], a[112:115], a[48:51], v[76:79]
 buffer_load_dwordx4 v4, s[8:11], s24 offen offset:1024 sc1 lds
M v[76:79], a[108:111], a[44:47], v[76:79]
 v_exp_f32 v23, v69
M v[76:79], a[104:107], a[40:43], v[76:79]
 v_exp_f32 v24, v70
M v[76:79], a[100:103], a[36:39], v[76:79]
 buffer_load_dwordx4 v4, s[8:11], s24 offen offset:2048 sc1 lds
M v[76:79], a[96:99], a[32:35], v[76:79]
 s_waitcnt lgkmcnt(0)
 v_exp_f32 v25, v71
M v[80:83], a[64:67], a[0:3], v[32:35]
 ds_read_b128 a[96:99], v2 offset:57344
 v_add_f32 v27, v22, v23
M v[80:83], a[68:71], a[4:7], v[80:83]
 ds_read_b128 a[100:103], v2 offset:58368
 v_cvt_pk_bf16_f32 v44, v22, v23
M v[80:83], a[72:75], a[8:11], v[80:83]
 v_exp_f32 v18, v72
M v[80:83], a[76:79], a[12:15], v[80:83]
 ds_read_b128 a[104:107], v2 offset:59392
 v_add_f32 v27, v24, v27
M v[80:83], a[80:83], a[16:19], v[80:83]
 ds_read_b128 a[108:111], v2 offset:60416
 v_cvt_pk_bf16_f32 v45, v24, v25
M v[80:83], a[84:87], a[20:23], v[80:83]
 buffer_load_dwordx4 v4, s[8:11], s24 offen offset:3072 sc1 lds
M v[80:83], a[88:91], a[24:27], v[80:83]
 ds_read_b128 a[112:115], v2 offset:61440
 v_add_f32 v27, v25, v27
M v[80:83], a[92:95], a[28:31], v[80:83]
 ds_read_b128 a[116:119], v2 offset:62464
M v[84:87], a[92:95], a[60:63], v[36:39]
 v_exp_f32 v19, v73
M v[84:87], a[88:91], a[56:59], v[84:87]
 ds_read_b128 a[120:123], v2 offset:63488
 v_add_f32 v26, v18, v26
M v[84:87], a[84:87], a[52:55], v[84:87]
 ds_read_b128 a[124:127], v2 offset:64512
 v_cvt_pk_bf16_f32 v42, v18, v19
M v[84:87], a[80:83], a[48:51], v[84:87]
 v_exp_f32 v20, v74
M v[84:87], a[76:79], a[44:47], v[84:87]
 v_exp_f32 v21, v75
M v[84:87], a[72:75], a[40:43], v[84:87]
 v_exp_f32 v22, v76
M v[84:87], a[68:71], a[36:39], v[84:87]
 s_waitcnt vmcnt(8) lgkmcnt(0)
 v_exp_f32 v23, v77
M v[84:87], a[64:67], a[32:35], v[84:87]
 s_barrier
M v[88:91], a[96:99], a[0:3], v[32:35]
 ds_read_b128 a[64:67], v7 offset:32768
 v_add_f32 v26, v19, v26
M v[88:91], a[100:103], a[4:7], v[88:91]
 ds_read_b128 a[68:71], v7 offset:33792
 v_add_f32 v26, v20, v26
M v[88:91], a[104:107], a[8:11], v[88:91]
 buffer_store_dword v17, v1, s[8:11], s45 offen sc1
M v[88:91], a[108:111], a[12:15], v[88:91]
 ds_read_b128 a[72:75], v7 offset:34816
 v_cvt_pk_bf16_f32 v43, v20, v21
M v[88:91], a[112:115], a[16:19], v[88:91]
 ds_read_b128 a[76:79], v7 offset:35840
 v_add_f32 v26, v21, v26
M v[88:91], a[116:119], a[20:23], v[88:91]
 v_exp_f32 v24, v78
M v[88:91], a[120:123], a[24:27], v[88:91]
 ds_read_b128 a[80:83], v7 offset:36864
 v_add_f32 v27, v22, v27
M v[88:91], a[124:127], a[28:31], v[88:91]
 ds_read_b128 a[84:87], v7 offset:37888
 v_cvt_pk_bf16_f32 v46, v22, v23
M v[92:95], a[124:127], a[60:63], v[36:39]
 v_exp_f32 v25, v79
M v[92:95], a[120:123], a[56:59], v[92:95]
 ds_read_b128 a[88:91], v7 offset:38912
 v_add_f32 v27, v23, v27
M v[92:95], a[116:119], a[52:55], v[92:95]
 ds_read_b128 a[92:95], v7 offset:39936
 v_add_f32 v27, v24, v27
M v[92:95], a[112:115], a[48:51], v[92:95]
 v_cvt_pk_bf16_f32 v47, v24, v25
 v_add_f32 v27, v25, v27
M v[92:95], a[108:111], a[44:47], v[92:95]
M v[92:95], a[104:107], a[40:43], v[92:95]
M v[92:95], a[100:103], a[36:39], v[92:95]
 s_waitcnt lgkmcnt(0)
M v[92:95], a[96:99], a[32:35], v[92:95]
 s_cmp_eq_u32 s42, 0
 s_cbranch_scc1 L_j0
M v[96:99], a[64:67], a[0:3], v[32:35]
 s_add_u32 m0, s28, 98304
 ds_read_b128 a[96:99], v7 offset:40960
M v[96:99], a[68:71], a[4:7], v[96:99]
 ds_read_b128 a[100:103], v7 offset:41984
M v[96:99], a[72:75], a[8:11], v[96:99]
 buffer_load_dwordx4 v3, s[8:11], s21 offen offset:0 sc1 lds
M v[96:99], a[76:79], a[12:15], v[96:99]
 s_cmp_eq_u32 s20, 0
 ds_read_b128 a[104:107], v7 offset:43008
M v[96:99], a[80:83], a[16:19], v[96:99]
 s_cselect_b64 s[64:65], s[16:17], 0
 ds_read_b128 a[108:111], v7 offset:44032
M v[96:99], a[84:87], a[20:23], v[96:99]
 buffer_load_dwordx4 v3, s[8:11], s21 offen offset:1024 sc1 lds
M v[96:99], a[88:91], a[24:27], v[96:99]
 s_cselect_b64 s[66:67], s[18:19], 0
 ds_read_b128 a[112:115], v7 offset:45056
M v[96:99], a[92:95], a[28:31], v[96:99]
 s_cselect_b64 s[68:69], s[48:49], 0
 ds_read_b128 a[116:119], v7 offset:46080
M v[100:103], a[92:95], a[60:63], v[36:39]
 s_cselect_b64 s[70:71], s[50:51], 0
 v_exp_f32 v18, v80
M v[100:103], a[88:91], a[56:59], v[100:103]
 s_cmp_lt_u32 s20, 1
 ds_read_b128 a[120:123], v7 offset:47104
M v[100:103], a[84:87], a[52:55], v[100:103]
 s_cselect_b64 s[78:79], -1, 0
 ds_read_b128 a[124:127], v7 offset:48128
M v[100:103], a[80:83], a[48:51], v[100:103]
 buffer_load_dwordx4 v3, s[8:11], s21 offen offset:2048 sc1 lds
M v[100:103], a[76:79], a[44:47], v[100:103]
 s_cmp_eq_u32 s20, 1
 v_exp_f32 v19, v81
M v[100:103], a[72:75], a[40:43], v[100:103]
 s_cselect_b64 s[72:73], s[16:17], s[78:79]
 v_exp_f32 v20, v82
M v[100:103], a[68:71], a[36:39], v[100:103]
 s_cselect_b64 s[74:75], s[18:19], s[78:79]
 v_exp_f32 v21, v83
M v[100:103], a[64:67], a[32:35], v[100:103]
 s_waitcnt lgkmcnt(0)
 v_exp_f32 v22, v88
M v[108:111], a[96:99], a[32:35], v[36:39]
 s_cselect_b64 s[76:77], s[48:49], s[78:79]
 ds_read_b128 a[64:67], v7 offset:49152
 v_add_f32 v26, v18, v26
M v[108:111], a[100:103], a[36:39], v[108:111]
 s_cselect_b64 s[78:79], s[50:51], s[78:79]
 ds_read_b128 a[68:71], v7 offset:50176
 v_cvt_pk_bf16_f32 v56, v18, v19
M v[108:111], a[104:107], a[40:43], v[108:111]
 buffer_load_dwordx4 v3, s[8:11], s21 offen offset:3072 sc1 lds
M v[108:111], a[108:111], a[44:47], v[108:111]
 s_add_u32 m0, s28, 102400
 ds_read_b128 a[72:75], v7 offset:51200
 v_add_f32 v26, v19, v26
M v[108:111], a[112:115], a[48:51], v[108:111]
 s_cmp_lt_u32 s20, 2
 ds_read_b128 a[76:79], v7 offset:52224
 v_add_f32 v26, v20, v26
M v[108:111], a[116:119], a[52:55], v[108:111]
 buffer_load_dwordx4 v4, s[8:11], s21 offen offset:0 sc1 lds
M v[108:111], a[120:123], a[56:59], v[108:111]
 s_cselect_b64 s[86:87], -1, 0
 ds_read_b128 a[80:83], v7 offset:53248
 v_cvt_pk_bf16_f32 v57, v20, v21
M v[108:111], a[124:127], a[60:63], v[108:111]
 s_cmp_eq_u32 s20, 2
 ds_read_b128 a[84:87], v7 offset:54272
 v_add_f32 v26, v21, v26
M v[104:107], a[124:127], a[28:31], v[32:35]
 s_cselect_b64 s[80:81], s[16:17], s[86:87]
 v_exp_f32 v23, v89
M v[104:107], a[120:123], a[24:27], v[104:107]
 s_cselect_b64 s[82:83], s[18:19], s[86:87]
 ds_read_b128 a[88:91], v7 offset:55296
 v_add_f32 v26, v22, v26
M v[104:107], a[116:119], a[20:23], v[104:107]
 s_cselect_b64 s[84:85], s[48:49], s[86:87]
 ds_read_b128 a[92:95], v7 offset:56320
 v_cvt_pk_bf16_f32 v58, v22, v23
M v[104:107], a[112:115], a[16:19], v[104:107]
 buffer_load_dwordx4 v4, s[8:11], s21 offen offset:1024 sc1 lds
M v[104:107], a[108:111], a[12:15], v[104:107]
 s_cselect_b64 s[86:87], s[50:51], s[86:87]
 v_exp_f32 v24, v90
M v[104:107], a[104:107], a[8:11], v[104:107]
 s_cmp_eq_u32 s20, 3
 v_exp_f32 v25, v91
M v[104:107], a[100:103], a[4:7], v[104:107]
 buffer_load_dwordx4 v4, s[8:11], s21 offen offset:2048 sc1 lds
M v[104:107], a[96:99], a[0:3], v[104:107]
 s_waitcnt lgkmcnt(0)
 v_exp_f32 v18, v84
M v[112:115], a[64:67], a[0:3], v[32:35]
 s_cselect_b64 s[88:89], s[16:17], -1
 ds_read_b128 a[96:99], v7 offset:57344
 v_add_f32 v26, v23, v26
M v[112:115], a[68:71], a[4:7], v[112:115]
 s_cselect_b64 s[90:91], s[18:19], -1
 ds_read_b128 a[100:103], v7 offset:58368
 v_add_f32 v26, v24, v26
M v[112:115], a[72:75], a[8:11], v[112:115]
 s_cselect_b64 s[92:93], s[48:49], -1
 v_exp_f32 v19, v85
M v[112:115], a[76:79], a[12:15], v[112:115]
 s_cselect_b64 s[94:95], s[50:51], -1
 ds_read_b128 a[104:107], v7 offset:59392
 v_cvt_pk_bf16_f32 v59, v24, v25
M v[112:115], a[80:83], a[16:19], v[112:115]
 ds_read_b128 a[108:111], v7 offset:60416
 v_add_f32 v26, v25, v26
M v[112:115], a[84:87], a[20:23], v[112:115]
 buffer_load_dwordx4 v4, s[8:11], s21 offen offset:3072 sc1 lds
M v[112:115], a[88:91], a[24:27], v[112:115]
 s_add_u32 s24, s23, 16777216
 ds_read_b128 a[112:115], v7 offset:61440
 v_add_f32 v27, v18, v27
M v[112:115], a[92:95], a[28:31], v[112:115]
 s_mov_b32 s23, s21
 ds_read_b128 a[116:119], v7 offset:62464
 v_cvt_pk_bf16_f32 v60, v18, v19
M v[116:119], a[92:95], a[60:63], v[36:39]
 s_add_u32 s21, s21, 32768
 v_exp_f32 v20, v86
M v[116:119], a[88:91], a[56:59], v[116:119]
 s_add_u32 s22, s22, 1
 ds_read_b128 a[120:123], v7 offset:63488
 v_add_f32 v27, v19, v27
M v[116:119], a[84:87], a[52:55], v[116:119]
 s_cmp_eq_u32 s22, s25
 ds_read_b128 a[124:127], v7 offset:64512
M v[116:119], a[80:83], a[48:51], v[116:119]
 s_cselect_b32 s21, s26, s21
 v_exp_f32 v21, v87
M v[116:119], a[76:79], a[44:47], v[116:119]
 s_cmp_eq_u32 s22, s43
 v_exp_f32 v22, v92
M v[116:119], a[72:75], a[40:43], v[116:119]
 s_cselect_b32 s21, s4, s21
 v_exp_f32 v23, v93
M v[116:119], a[68:71], a[36:39], v[116:119]
 s_waitcnt vmcnt(9) lgkmcnt(0)
 v_add_f32 v27, v20, v27
 v_cvt_pk_bf16_f32 v61, v20, v21
M v[116:119], a[64:67], a[32:35], v[116:119]
 s_barrier
M v[124:127], a[96:99], a[32:35], v[36:39]
 s_cmp_eq_u32 s22, s6
 ds_read_b128 a[64:67], v2 offset:0
 v_add_f32 v27, v21, v27
M v[124:127], a[100:103], a[36:39], v[124:127]
 s_cselect_b32 s21, s7, s21
 ds_read_b128 a[68:71], v2 offset:1024
 v_add_f32 v27, v22, v27
M v[124:127], a[104:107], a[40:43], v[124:127]
 v_exp_f32 v24, v94
M v[124:127], a[108:111], a[44:47], v[124:127]
 ds_read_b128 a[72:75], v2 offset:2048
 v_cvt_pk_bf16_f32 v62, v22, v23
M v[124:127], a[112:115], a[48:51], v[124:127]
 ds_read_b128 a[76:79], v2 offset:3072
 v_add_f32 v27, v23, v27
M v[124:127], a[116:119], a[52:55], v[124:127]
 v_exp_f32 v25, v95
M v[124:127], a[120:123], a[56:59], v[124:127]
 ds_read_b128 a[80:83], v2 offset:4096
 v_add_f32 v27, v24, v27
M v[124:127], a[124:127], a[60:63], v[124:127]
 ds_read_b128 a[84:87], v2 offset:5120
 v_cvt_pk_bf16_f32 v63, v24, v25
M v[120:123], a[124:127], a[28:31], v[32:35]
 v_add_f32 v27, v25, v27
M v[120:123], a[120:123], a[24:27], v[120:123]
 ds_read_b128 a[88:91], v2 offset:6144
 v_max_f32 v10, v26, v27
M v[120:123], a[116:119], a[20:23], v[120:123]
 ds_read_b128 a[92:95], v2 offset:7168
 v_min_f32 v11, v26, v27
M v[120:123], a[112:115], a[16:19], v[120:123]
 v_cmp_lt_f32 s[36:37], s31, v10
M v[120:123], a[108:111], a[12:15], v[120:123]
 v_cmp_gt_f32 vcc, s55, v11
M v[120:123], a[104:107], a[8:11], v[120:123]
M v[120:123], a[100:103], a[4:7], v[120:123]
 s_waitcnt lgkmcnt(0)
 s_or_b64 vcc, vcc, s[36:37]
M v[120:123], a[96:99], a[0:3], v[120:123]
 s_cbranch_vccnz L_st10
L_rt10:
M v[128:131], a[64:67], v[40:43], 0
 s_add_u32 m0, s28, 0
 ds_read_b128 a[96:99], v2 offset:8192
 ds_read_b128 a[100:103], v2 offset:9216
M v[128:131], a[68:71], v[56:59], v[128:131]
 buffer_load_dwordx4 v3, s[8:11], s24 offen offset:0 sc1 lds
M v[132:135], a[68:71], v[60:63], 0
 v_exp_f32 v18, v96
M v[132:135], a[64:67], v[44:47], v[132:135]
 ds_read_b128 a[104:107], v2 offset:10240
 ds_read_b128 a[108:111], v2 offset:11264
M v[140:143], a[72:75], v[44:47], 0
 buffer_load_dwordx4 v3, s[8:11], s24 offen offset:1024 sc1 lds
M v[140:143], a[76:79], v[60:63], v[140:143]
 v_exp_f32 v19, v97
M v[136:139], a[76:79], v[56:59], 0
 ds_read_b128 a[112:115], v2 offset:12288
 ds_read_b128 a[116:119], v2 offset:13312
M v[136:139], a[72:75], v[40:43], v[136:139]
 buffer_load_dwordx4 v3, s[8:11], s24 offen offset:2048 sc1 lds
M v[144:147], a[80:83], v[40:43], 0
 v_exp_f32 v20, v98
M v[144:147], a[84:87], v[56:59], v[144:147]
 ds_read_b128 a[120:123], v2 offset:14336
 ds_read_b128 a[124:127], v2 offset:15360
M v[148:151], a[84:87], v[60:63], 0
 buffer_load_dwordx4 v3, s[8:11], s24 offen offset:3072 sc1 lds
M v[148:151], a[80:83], v[44:47], v[148:151]
 s_add_u32 m0, s28, 4096
 v_exp_f32 v21, v99
M v[156:159], a[88:91], v[44:47], 0
 buffer_load_dwordx4 v4, s[8:11], s24 offen offset:0 sc1 lds
M v[156:159], a[92:95], v[60:63], v[156:159]
 v_add_f32 v30, v26, v30
 v_add_f32 v31, v27, v31
M v[152:155], a[92:95], v[56:59], 0
 v_exp_f32 v22, v104
M v[152:155], a[88:91], v[40:43], v[152:155]
 s_waitcnt lgkmcnt(0)
 v_add_f32 v28, v18, v19
 v_cvt_pk_bf16_f32 v48, v18, v19
M v[160:163], a[96:99], v[40:43], 0
 ds_read_b128 a[64:67], v2 offset:16384
 ds_read_b128 a[68:71], v2 offset:17408
M v[160:163], a[100:103], v[56:59], v[160:163]
 buffer_load_dwordx4 v4, s[8:11], s24 offen offset:1024 sc1 lds
M v[164:167], a[100:103], v[60:63], 0
 v_exp_f32 v23, v105
M v[164:167], a[96:99], v[44:47], v[164:167]
 ds_read_b128 a[72:75], v2 offset:18432
 ds_read_b128 a[76:79], v2 offset:19456
M v[172:175], a[104:107], v[44:47], 0
 buffer_load_dwordx4 v4, s[8:11], s24 offen offset:2048 sc1 lds
M v[172:175], a[108:111], v[60:63], v[172:175]
 v_add_f32 v28, v20, v28
 v_cvt_pk_bf16_f32 v49, v20, v21
M v[168:171], a[108:111], v[56:59], 0
 ds_read_b128 a[80:83], v2 offset:20480
 ds_read_b128 a[84:87], v2 offset:21504
M v[168:171], a[104:107], v[40:43], v[168:171]
 buffer_load_dwordx4 v4, s[8:11], s24 offen offset:3072 sc1 lds
M v[176:179], a[112:115], v[40:43], 0
 v_exp_f32 v24, v106
M v[176:179], a[116:119], v[56:59], v[176:179]
 s_add_u32 m0, s28, 32768
 ds_read_b128 a[88:91], v2 offset:22528
 ds_read_b128 a[92:95], v2 offset:23552
M v[180:183], a[116:119], v[60:63], 0
 buffer_load_dwordx4 v3, s[8:11], s21 offen offset:0 sc1 lds
M v[180:183], a[112:115], v[44:47], v[180:183]
 v_exp_f32 v25, v107
M v[188:191], a[120:123], v[44:47], 0
 buffer_load_dwordx4 v3, s[8:11], s21 offen offset:1024 sc1 lds
M v[188:191], a[124:127], v[60:63], v[188:191]
 v_exp_f32 v18, v100
M v[184:187], a[124:127], v[56:59], 0
 buffer_load_dwordx4 v3, s[8:11], s21 offen offset:2048 sc1 lds
M v[184:187], a[120:123], v[40:43], v[184:187]
 s_waitcnt lgkmcnt(0)
 v_add_f32 v28, v21, v28
 v_add_f32 v28, v22, v28
M v[192:195], a[64:67], v[40:43], 0
 ds_read_b128 a[96:99], v2 offset:24576
 ds_read_b128 a[100:103], v2 offset:25600
M v[192:195], a[68:71], v[56:59], v[192:195]
 buffer_load_dwordx4 v3, s[8:11], s21 offen offset:3072 sc1 lds
M v[196:199], a[68:71], v[60:63], 0
 v_exp_f32 v19, v101
M v[196:199], a[64:67], v[44:47], v[196:199]
 s_add_u32 m0, s28, 36864
 ds_read_b128 a[104:107], v2 offset:26624
 ds_read_b128 a[108:111], v2 offset:27648
M v[204:207], a[72:75], v[44:47], 0
 buffer_load_dwordx4 v4, s[8:11], s21 offen offset:0 sc1 lds
M v[204:207], a[76:79], v[60:63], v[204:207]
 v_exp_f32 v20, v102
M v[200:203], a[76:79], v[56:59], 0
 ds_read_b128 a[112:115], v2 offset:28672
 ds_read_b128 a[116:119], v2 offset:29696
M v[200:203], a[72:75], v[40:43], v[200:203]
 buffer_load_dwordx4 v4, s[8:11], s21 offen offset:1024 sc1 lds
M v[208:211], a[80:83], v[40:43], 0
 v_exp_f32 v21, v103
M v[208:211], a[84:87], v[56:59], v[208:211]
 ds_read_b128 a[120:123], v2 offset:30720
 ds_read_b128 a[124:127], v2 offset:31744
M v[212:215], a[84:87], v[60:63], 0
 buffer_load_dwordx4 v4, s[8:11], s21 offen offset:2048 sc1 lds
M v[212:215], a[80:83], v[44:47], v[212:215]
 v_cvt_pk_bf16_f32 v50, v22, v23
 v_add_f32 v28, v23, v28
M v[220:223], a[88:91], v[44:47], 0
 v_exp_f32 v22, v108
M v[220:223], a[92:95], v[60:63], v[220:223]
 buffer_load_dwordx4 v4, s[8:11], s21 offen offset:3072 sc1 lds
M v[216:219], a[92:95], v[56:59], 0
 s_waitcnt vmcnt(16) lgkmcnt(0)
 s_add_u32 s24, s23, 16777216
 s_mov_b32 s23, s21
M v[216:219], a[88:91], v[40:43], v[216:219]
 s_barrier
M v[224:227], a[96:99], v[40:43], 0
 ds_read_b128 a[64:67], v2 offset:32768
 ds_read_b128 a[68:71], v2 offset:33792
M v[224:227], a[100:103], v[56:59], v[224:227]
 s_add_u32 s21, s21, 32768
 v_add_f32 v28, v24, v28
M v[228:231], a[100:103], v[60:63], 0
 s_add_u32 s22, s22, 1
 v_exp_f32 v23, v109
M v[228:231], a[96:99], v[44:47], v[228:231]
 s_cmp_eq_u32 s22, s25
 ds_read_b128 a[72:75], v2 offset:34816
 ds_read_b128 a[76:79], v2 offset:35840
M v[236:239], a[104:107], v[44:47], 0
 s_cselect_b32 s21, s26, s21
 v_cvt_pk_bf16_f32 v51, v24, v25
 v_add_f32 v28, v25, v28
M v[236:239], a[108:111], v[60:63], v[236:239]
 s_cmp_eq_u32 s22, s43
 v_exp_f32 v24, v110
M v[232:235], a[108:111], v[56:59], 0
 s_cselect_b32 s21, s4, s21
 ds_read_b128 a[80:83], v2 offset:36864
 ds_read_b128 a[84:87], v2 offset:37888
M v[232:235], a[104:107], v[40:43], v[232:235]
 s_cmp_eq_u32 s22, s6
 v_exp_f32 v25, v111
M v[240:243], a[112:115], v[40:43], 0
 s_cselect_b32 s21, s7, s21
 v_add_f32 v29, v18, v19
 v_cvt_pk_bf16_f32 v52, v18, v19
M v[240:243], a[116:119], v[56:59], v[240:243]
 ds_read_b128 a[88:91], v2 offset:38912
 ds_read_b128 a[92:95], v2 offset:39936
M v[244:247], a[116:119], v[60:63], 0
 v_add_f32 v29, v20, v29
 v_cvt_pk_bf16_f32 v53, v20, v21
M v[244:247], a[112:115], v[44:47], v[244:247]
 v_add_f32 v29, v21, v29
 v_add_f32 v29, v22, v29
M v[252:255], a[120:123], v[44:47], 0
 v_cvt_pk_bf16_f32 v54, v22, v23
 v_add_f32 v29, v23, v29
M v[252:255], a[124:127], v[60:63], v[252:255]
 s_cmp_lg_u32 s27, 0
 v_add_f32 v29, v24, v29
 v_cvt_pk_bf16_f32 v55, v24, v25
M v[248:251], a[124:127], v[56:59], 0
 s_waitcnt lgkmcnt(0)
 v_add_f32 v29, v25, v29
M v[248:251], a[120:123], v[40:43], v[248:251]
 s_cbranch_scc1 L_loop_top
 s_branch L_p1
L_j0:
 s_cmp_eq_u32 s20, 0
 s_cselect_b64 s[64:65], s[16:17], 0
 s_cselect_b64 s[66:67], s[18:19], 0
 s_cselect_b64 s[68:69], s[48:49], 0
 s_cselect_b64 s[70:71], s[50:51], 0
 s_cmp_lt_u32 s20, 1
 s_cselect_b64 s[78:79], -1, 0
 s_cmp_eq_u32 s20, 1
 s_cselect_b64 s[72:73], s[16:17], s[78:79]
 s_cselect_b64 s[74:75], s[18:19], s[78:79]
 s_cselect_b64 s[76:77], s[48:49], s[78:79]
 s_cselect_b64 s[78:79], s[50:51], s[78:79]
 s_cmp_lt_u32 s20, 2
 s_cselect_b64 s[86:87], -1, 0
 s_cmp_eq_u32 s20, 2
 s_cselect_b64 s[80:81], s[16:17], s[86:87]
 s_cselect_b64 s[82:83], s[18:19], s[86:87]
 s_cselect_b64 s[84:85], s[48:49], s[86:87]
 s_cselect_b64 s[86:87], s[50:51], s[86:87]
 s_cmp_eq_u32 s20, 3
 s_cselect_b64 s[88:89], s[16:17], -1
 s_cselect_b64 s[90:91], s[18:19], -1
 s_cselect_b64 s[92:93], s[48:49], -1
 s_cselect_b64 s[94:95], s[50:51], -1
 v_mov_b32 v56, 0
 v_mov_b32 v57, 0
 v_mov_b32 v58, 0
 v_mov_b32 v59, 0
 v_accvgpr_write_b32 a242, 0
 v_accvgpr_write_b32 a243, 0
 v_cndmask_b32 v64, v64, v8, s[64:65]
 v_cndmask_b32 v65, v65, v8, s[66:67]
 v_cndmask_b32 v66, v66, v8, s[68:69]
 v_cndmask_b32 v67, v67, v8, s[70:71]
 v_cndmask_b32 v72, v72, v8, s[72:73]
 v_cndmask_b32 v73, v73, v8, s[74:75]
 v_cndmask_b32 v74, v74, v8, s[76:77]
 v_cndmask_b32 v75, v75, v8, s[78:79]
 v_cndmask_b32 v80, v80, v8, s[80:81]
 v_cndmask_b32 v81, v81, v8, s[82:83]
 v_cndmask_b32 v82, v82, v8, s[84:85]
 v_cndmask_b32 v83, v83, v8, s[86:87]
 v_cndmask_b32 v88, v88, v8, s[88:89]
 v_cndmask_b32 v89, v89, v8, s[90:91]
 v_cndmask_b32 v90, v90, v8, s[92:93]
 v_cndmask_b32 v91, v91, v8, s[94:95]
 s_cmp_eq_u32 s20, 3
 s_cselect_b64 s[64:65], s[16:17], 0
 s_cselect_b64 s[66:67], s[18:19], 0
 s_cselect_b64 s[68:69], s[48:49], 0
 s_cselect_b64 s[70:71], s[50:51], 0
 s_cmp_gt_u32 s20, 2
 s_cselect_b64 s[78:79], -1, 0
 s_cmp_eq_u32 s20, 2
 s_cselect_b64 s[72:73], s[16:17], s[78:79]
 s_cselect_b64 s[74:75], s[18:19], s[78:79]
 s_cselect_b64 s[76:77], s[48:49], s[78:79]
 s_cselect_b64 s[78:79], s[50:51], s[78:79]
 s_cmp_gt_u32 s20, 1
 s_cselect_b64 s[86:87], -1, 0
 s_cmp_eq_u32 s20, 1
 s_cselect_b64 s[80:81], s[16:17], s[86:87]
 s_cselect_b64 s[82:83], s[18:19], s[86:87]
 s_cselect_b64 s[84:85], s[48:49], s[86:87]
 s_cselect_b64 s[86:87], s[50:51], s[86:87]
 s_cmp_eq_u32 s20, 0
 s_cselect_b64 s[88:89], s[16:17], -1
 s_cselect_b64 s[90:91], s[18:19], -1
 s_cselect_b64 s[92:93], s[48:49], -1
 s_cselect_b64 s[94:95], s[50:51], -1
 s_add_u32 m0, s28, 98304
 v_max3_f32 v10, v64, v65, v66
 buffer_load_dwordx4 v3, s[8:11], s21 offen offset:0 sc1 lds
 v_max3_f32 v10, v67, v72, v10
 v_max3_f32 v10, v73, v74, v10
 v_max3_f32 v10, v75, v80, v10
 v_max3_f32 v10, v81, v82, v10
 v_max3_f32 v10, v83, v88, v10
 v_max3_f32 v10, v89, v90, v10
 v_max_f32 v10, v91, v10
 v_max3_f32 v11, v68, v69, v70
 v_max3_f32 v11, v71, v76, v11
 v_max3_f32 v11, v77, v78, v11
 v_max3_f32 v11, v79, v84, v11
 v_mfma_f32_32x32x16_bf16 v[128:143], v[56:59], v[56:59], 0
 buffer_load_dwordx4 v3, s[8:11], s21 offen offset:1024 sc1 lds
 v_max3_f32 v11, v85, v86, v11
 v_max3_f32 v11, v87, v92, v11
 v_max3_f32 v11, v93, v94, v11
 v_max_f32 v11, v95, v11
 v_mov_b32 v12, v10
 v_mov_b32 v13, v11
 s_nop 0
 v_permlane16_swap_b32 v12, v10
 v_permlane16_swap_b32 v13, v11
 v_max_f32 v10, v12, v10
 v_max_f32 v11, v13, v11
 v_mov_b32 v12, v10
 buffer_load_dwordx4 v3, s[8:11], s21 offen offset:2048 sc1 lds
 v_mov_b32 v13, v11
 v_mfma_f32_32x32x16_bf16 v[144:159], v[56:59], v[56:59], 0
 v_permlane32_swap_b32 v12, v10
 v_permlane32_swap_b32 v13, v11
 v_max_f32 v10, v12, v10
 v_max_f32 v11, v13, v11
 v_ceil_f32 v10, v10
 v_ceil_f32 v11, v11
 v_sub_f32 v32, v32, v10
 v_sub_f32 v33, v33, v10
 v_sub_f32 v34, v34, v10
 v_sub_f32 v35, v35, v10
 buffer_load_dwordx4 v3, s[8:11], s21 offen offset:3072 sc1 lds
 v_sub_f32 v36, v36, v11
 v_sub_f32 v37, v37, v11
 v_sub_f32 v38, v38, v11
 v_mfma_f32_32x32x16_bf16 v[160:175], v[56:59], v[56:59], 0
 v_sub_f32 v39, v39, v11
 v_sub_f32 v64, v64, v10
 v_sub_f32 v65, v65, v10
 v_sub_f32 v66, v66, v10
 v_sub_f32 v67, v67, v10
 v_sub_f32 v68, v68, v11
 v_sub_f32 v69, v69, v11
 s_add_u32 m0, s28, 102400
 v_sub_f32 v70, v70, v11
 buffer_load_dwordx4 v4, s[8:11], s21 offen offset:0 sc1 lds
 v_sub_f32 v71, v71, v11
 v_sub_f32 v72, v72, v10
 v_sub_f32 v73, v73, v10
 v_sub_f32 v74, v74, v10
 v_mfma_f32_32x32x16_bf16 v[176:191], v[56:59], v[56:59], 0
 v_sub_f32 v75, v75, v10
 v_sub_f32 v76, v76, v11
 v_sub_f32 v77, v77, v11
 v_sub_f32 v78, v78, v11
 v_sub_f32 v79, v79, v11
 v_sub_f32 v80, v80, v10
 v_sub_f32 v81, v81, v10
 buffer_load_dwordx4 v4, s[8:11], s21 offen offset:1024 sc1 lds
 v_sub_f32 v82, v82, v10
 v_sub_f32 v83, v83, v10
 v_sub_f32 v84, v84, v11
 v_sub_f32 v85, v85, v11
 v_sub_f32 v86, v86, v11
 v_sub_f32 v87, v87, v11
 v_mfma_f32_32x32x16_bf16 v[192:207], v[56:59], v[56:59], 0
 v_sub_f32 v88, v88, v10
 v_sub_f32 v89, v89, v10
 v_sub_f32 v90, v90, v10
 v_sub_f32 v91, v91, v10
 v_sub_f32 v92, v92, v11
 buffer_load_dwordx4 v4, s[8:11], s21 offen offset:2048 sc1 lds
 v_sub_f32 v93, v93, v11
 v_sub_f32 v94, v94, v11
 v_sub_f32 v95, v95, v11
 v_exp_f32 v18, v64
 v_exp_f32 v19, v65
 v_exp_f32 v20, v66
 v_add_f32 v26, v18, v19
 v_cvt_pk_bf16_f32 v40, v18, v19
 v_mfma_f32_32x32x16_bf16 v[208:223], v[56:59], v[56:59], 0
 v_exp_f32 v21, v67
 v_exp_f32 v22, v72
 v_add_f32 v26, v20, v26
 buffer_load_dwordx4 v4, s[8:11], s21 offen offset:3072 sc1 lds
 v_cvt_pk_bf16_f32 v41, v20, v21
 v_exp_f32 v23, v73
 v_add_f32 v26, v21, v26
 v_exp_f32 v24, v74
 v_add_f32 v26, v22, v26
 v_cvt_pk_bf16_f32 v42, v22, v23
 v_exp_f32 v25, v75
 v_add_f32 v26, v23, v26
 v_exp_f32 v18, v68
 v_add_f32 v26, v24, v26
 v_mfma_f32_32x32x16_bf16 v[224:239], v[56:59], v[56:59], 0
 s_add_u32 s24, s23, 16777216
 s_mov_b32 s23, s21
 s_add_u32 s21, s21, 32768
 s_add_u32 s22, s22, 1
 s_cmp_eq_u32 s22, s25
 s_cselect_b32 s21, s26, s21
 s_cmp_eq_u32 s22, s43
 s_cselect_b32 s21, s4, s21
 s_cmp_eq_u32 s22, s6
 s_cselect_b32 s21, s7, s21
 v_cvt_pk_bf16_f32 v43, v24, v25
 buffer_load_dword v5, off, s[8:11], s47 sc1
 v_exp_f32 v19, v69
 v_add_f32 v26, v25, v26
 v_mfma_f32_32x32x16_bf16 v[240:255], v[56:59], v[56:59], 0
 v_exp_f32 v20, v70
 v_add_f32 v27, v18, v19
 v_cvt_pk_bf16_f32 v44, v18, v19
 v_exp_f32 v21, v71
 v_exp_f32 v22, v76
 v_add_f32 v27, v20, v27
 v_cvt_pk_bf16_f32 v45, v20, v21
 v_exp_f32 v23, v77
 v_add_f32 v27, v21, v27
 v_exp_f32 v24, v78
 v_add_f32 v27, v22, v27
 v_cvt_pk_bf16_f32 v46, v22, v23
 v_exp_f32 v25, v79
 v_add_f32 v27, v23, v27
 v_add_f32 v27, v24, v27
 v_cvt_pk_bf16_f32 v47, v24, v25
 v_add_f32 v27, v25, v27
 v_cndmask_b32 v100, v36, v8, s[64:65]
 v_cndmask_b32 v101, v36, v8, s[66:67]
 v_cndmask_b32 v102, v36, v8, s[68:69]
 v_cndmask_b32 v103, v36, v8, s[70:71]
 v_cndmask_b32 v108, v36, v8, s[72:73]
 v_cndmask_b32 v109, v36, v8, s[74:75]
 v_cndmask_b32 v110, v36, v8, s[76:77]
 v_cndmask_b32 v111, v36, v8, s[78:79]
 v_cndmask_b32 v116, v36, v8, s[80:81]
 v_cndmask_b32 v117, v36, v8, s[82:83]
 v_cndmask_b32 v118, v36, v8, s[84:85]
 v_cndmask_b32 v119, v36, v8, s[86:87]
 v_cndmask_b32 v124, v36, v8, s[88:89]
 v_cndmask_b32 v125, v36, v8, s[90:91]
 v_cndmask_b32 v126, v36, v8, s[92:93]
 v_cndmask_b32 v127, v36, v8, s[94:95]
 s_branch L_p2
L_kv1:
 s_mov_b32 s60, s90
 s_and_b32 s61, s91, 0xffff
 s_mov_b32 s62, 3670016
 s_mov_b32 s63, 0x20000
 s_waitcnt vmcnt(4) lgkmcnt(0)
 s_barrier
 ds_read_b128 a[160:163], v5 offset:0
 ds_read_b128 a[164:167], v6 offset:0
 ds_read_b64_tr_b16 a[32:33], v1 offset:0
 ds_read_b64_tr_b16 a[34:35], v1 offset:1024
 ds_read_b64_tr_b16 a[36:37], v1 offset:8192
 ds_read_b64_tr_b16 a[38:39], v1 offset:9216
 ds_read_b64_tr_b16 a[40:41], v2 offset:0
 ds_read_b64_tr_b16 a[42:43], v2 offset:1024
 ds_read_b64_tr_b16 a[44:45], v2 offset:8192
 ds_read_b64_tr_b16 a[46:47], v2 offset:9216
 ds_read_b128 a[168:171], v5 offset:2048
 ds_read_b128 a[172:175], v6 offset:2048
 ds_read_b64_tr_b16 a[48:49], v3 offset:0
 ds_read_b64_tr_b16 a[50:51], v3 offset:1024
 ds_read_b64_tr_b16 a[52:53], v3 offset:8192
 ds_read_b64_tr_b16 a[54:55], v3 offset:9216
 ds_read_b64_tr_b16 a[56:57], v4 offset:0
 ds_read_b64_tr_b16 a[58:59], v4 offset:1024
 ds_read_b64_tr_b16 a[60:61], v4 offset:8192
 ds_read_b64_tr_b16 a[62:63], v4 offset:9216
 ds_read_b128 a[176:179], v5 offset:4096
 ds_read_b128 a[180:183], v6 offset:4096
 ds_read_b128 a[184:187], v5 offset:6144
 ds_read_b128 a[188:191], v6 offset:6144
 s_add_u32 m0, s24, 16384
 s_nop 0
 buffer_load_dwordx4 v12, s[48:51], s22 offen offset:0   lds
 buffer_load_dwordx4 v13, s[48:51], s22 offen offset:1024   lds
 buffer_load_dwordx4 v14, s[48:51], s22 offen offset:2048   lds
 buffer_load_dwordx4 v15, s[48:51], s22 offen offset:3072   lds
 s_sub_u32 s22, s22, 2097024
 s_add_u32 m0, s23, 32768
 s_nop 0
 buffer_load_dwordx4 v8, s[16:19], s21 offen offset:0  nt lds
 buffer_load_dwordx4 v9, s[16:19], s21 offen offset:1024  nt lds
 buffer_load_dwordx4 v10, s[16:19], s21 offen offset:2048  nt lds
 buffer_load_dwordx4 v11, s[16:19], s21 offen offset:3072  nt lds
 s_add_u32 s21, s21, 128
 s_waitcnt lgkmcnt(15)
M a[0:3], a[32:35], a[160:163], 0
M a[0:3], a[36:39], a[164:167], a[0:3]
 s_waitcnt lgkmcnt(14)
M a[4:7], a[44:47], a[164:167], 0
M a[4:7], a[40:43], a[160:163], a[4:7]
 s_waitcnt lgkmcnt(8)
M a[8:11], a[48:51], a[160:163], 0
M a[8:11], a[52:55], a[164:167], a[8:11]
 s_waitcnt lgkmcnt(4)
M a[12:15], a[60:63], a[164:167], 0
 s_add_u32 m0, s23, 49152
M a[12:15], a[56:59], a[160:163], a[12:15]
 buffer_load_dwordx4 v8, s[16:19], s21 offen offset:0  nt lds
M v[32:35], a[32:35], a[168:171], 0
 buffer_load_dwordx4 v9, s[16:19], s21 offen offset:1024  nt lds
M v[32:35], a[36:39], a[172:175], v[32:35]
M v[36:39], a[44:47], a[172:175], 0
 buffer_load_dwordx4 v10, s[16:19], s21 offen offset:2048  nt lds
M v[36:39], a[40:43], a[168:171], v[36:39]
M v[40:43], a[48:51], a[168:171], 0
 buffer_load_dwordx4 v11, s[16:19], s21 offen offset:3072  nt lds
M v[40:43], a[52:55], a[172:175], v[40:43]
 s_add_u32 s21, s21, 524160
M v[44:47], a[60:63], a[172:175], 0
 s_waitcnt vmcnt(12) lgkmcnt(0)
M v[44:47], a[56:59], a[168:171], v[44:47]
 s_barrier
M v[64:67], a[32:35], a[176:179], 0
 s_add_u32 m0, s24, 32768
 ds_read_b64_tr_b16 a[64:65], v1 offset:16384
 ds_read_b64_tr_b16 a[66:67], v1 offset:17408
M v[64:67], a[36:39], a[180:183], v[64:67]
 ds_read_b64_tr_b16 a[68:69], v1 offset:24576
 ds_read_b64_tr_b16 a[70:71], v1 offset:25600
M v[68:71], a[44:47], a[180:183], 0
 buffer_load_dwordx4 v12, s[48:51], s22 offen offset:0   lds
M v[68:71], a[40:43], a[176:179], v[68:71]
 ds_read_b64_tr_b16 a[72:73], v2 offset:16384
 ds_read_b64_tr_b16 a[74:75], v2 offset:17408
M v[72:75], a[48:51], a[176:179], 0
 ds_read_b64_tr_b16 a[76:77], v2 offset:24576
 ds_read_b64_tr_b16 a[78:79], v2 offset:25600
M v[72:75], a[52:55], a[180:183], v[72:75]
 buffer_load_dwordx4 v13, s[48:51], s22 offen offset:1024   lds
M v[76:79], a[60:63], a[180:183], 0
 ds_read_b64_tr_b16 a[80:81], v3 offset:16384
 ds_read_b64_tr_b16 a[82:83], v3 offset:17408
M v[76:79], a[56:59], a[176:179], v[76:79]
 ds_read_b64_tr_b16 a[84:85], v3 offset:24576
 ds_read_b64_tr_b16 a[86:87], v3 offset:25600
M v[96:99], a[32:35], a[184:187], 0
 buffer_load_dwordx4 v14, s[48:51], s22 offen offset:2048   lds
M v[96:99], a[36:39], a[188:191], v[96:99]
 ds_read_b64_tr_b16 a[88:89], v4 offset:16384
 ds_read_b64_tr_b16 a[90:91], v4 offset:17408
M v[100:103], a[44:47], a[188:191], 0
 ds_read_b64_tr_b16 a[92:93], v4 offset:24576
 ds_read_b64_tr_b16 a[94:95], v4 offset:25600
M v[100:103], a[40:43], a[184:187], v[100:103]
 buffer_load_dwordx4 v15, s[48:51], s22 offen offset:3072   lds
M v[104:107], a[48:51], a[184:187], 0
 s_add_u32 s22, s22, 2097152
 v_max3_f32 v20, |v32|, |v33|, |v34|
 v_max3_f32 v20, |v35|, |v36|, v20
M v[104:107], a[52:55], a[188:191], v[104:107]
 v_max3_f32 v20, |v37|, |v38|, v20
 v_max3_f32 v21, |v64|, |v65|, |v66|
M v[108:111], a[60:63], a[188:191], 0
 s_add_u32 m0, s23, 0
 v_max3_f32 v21, |v67|, |v68|, v21
 v_max3_f32 v21, |v69|, |v70|, v21
M v[108:111], a[56:59], a[184:187], v[108:111]
 s_waitcnt lgkmcnt(0)
 v_min_f32 v20, v20, v21
 v_mul_f32 v20, 0x41000000, v20
M a[16:19], a[64:67], a[160:163], 0
 buffer_load_dwordx4 v8, s[16:19], s21 offen offset:0  nt lds
M a[16:19], a[68:71], a[164:167], a[16:19]
 v_mov_b32 v21, v20
 v_mov_b32 v22, v20
M a[20:23], a[76:79], a[164:167], 0
 buffer_load_dwordx4 v9, s[16:19], s21 offen offset:1024  nt lds
M a[20:23], a[72:75], a[160:163], a[20:23]
 v_mov_b32 v23, v20
 v_accvgpr_write_b32 a241, v20
M a[24:27], a[80:83], a[160:163], 0
M a[24:27], a[84:87], a[164:167], a[24:27]
M a[28:31], a[92:95], a[164:167], 0
 buffer_load_dwordx4 v10, s[16:19], s21 offen offset:2048  nt lds
M a[28:31], a[88:91], a[160:163], a[28:31]
M v[48:51], a[64:67], a[168:171], v[20:23]
M v[48:51], a[68:71], a[172:175], v[48:51]
 buffer_load_dwordx4 v11, s[16:19], s21 offen offset:3072  nt lds
M v[52:55], a[76:79], a[172:175], v[20:23]
 s_add_u32 s21, s21, 128
M v[52:55], a[72:75], a[168:171], v[52:55]
M v[56:59], a[80:83], a[168:171], v[20:23]
M v[56:59], a[84:87], a[172:175], v[56:59]
M v[60:63], a[92:95], a[172:175], v[20:23]
 s_waitcnt vmcnt(12)
M v[60:63], a[88:91], a[168:171], v[60:63]
 s_barrier
M v[80:83], a[64:67], a[176:179], v[20:23]
 s_add_u32 m0, s24, 49152
 ds_read_b128 a[160:163], v5 offset:16384
 ds_read_b128 a[164:167], v6 offset:16384
M v[80:83], a[68:71], a[180:183], v[80:83]
 buffer_load_dwordx4 v12, s[48:51], s22 offen offset:0   lds
M v[84:87], a[76:79], a[180:183], v[20:23]
 ds_read_b64_tr_b16 a[96:97], v1 offset:32768
 ds_read_b64_tr_b16 a[98:99], v1 offset:33792
M v[84:87], a[72:75], a[176:179], v[84:87]
M v[88:91], a[80:83], a[176:179], v[20:23]
 buffer_load_dwordx4 v13, s[48:51], s22 offen offset:1024   lds
M v[88:91], a[84:87], a[180:183], v[88:91]
 ds_read_b64_tr_b16 a[100:101], v1 offset:40960
 ds_read_b64_tr_b16 a[102:103], v1 offset:41984
M v[92:95], a[92:95], a[180:183], v[20:23]
M v[92:95], a[88:91], a[176:179], v[92:95]
M v[112:115], a[64:67], a[184:187], v[20:23]
 ds_read_b64_tr_b16 a[104:105], v2 offset:32768
 ds_read_b64_tr_b16 a[106:107], v2 offset:33792
M v[112:115], a[68:71], a[188:191], v[112:115]
 buffer_load_dwordx4 v14, s[48:51], s22 offen offset:2048   lds
M v[116:119], a[76:79], a[188:191], v[20:23]
M v[116:119], a[72:75], a[184:187], v[116:119]
 ds_read_b64_tr_b16 a[108:109], v2 offset:40960
 ds_read_b64_tr_b16 a[110:111], v2 offset:41984
M v[120:123], a[80:83], a[184:187], v[20:23]
 buffer_load_dwordx4 v15, s[48:51], s22 offen offset:3072   lds
M v[120:123], a[84:87], a[188:191], v[120:123]
 s_waitcnt lgkmcnt(8)
M v[124:127], a[92:95], a[188:191], v[20:23]
 s_sub_u32 s22, s22, 2097024
M v[124:127], a[88:91], a[184:187], v[124:127]
 s_add_u32 m0, s23, 16384
 ds_read_b64_tr_b16 a[112:113], v3 offset:32768
 ds_read_b64_tr_b16 a[114:115], v3 offset:33792
M v[128:131], a[32:35], a[160:163], v[20:23]
 ds_read_b128 a[168:171], v5 offset:18432
 ds_read_b128 a[172:175], v6 offset:18432
M v[128:131], a[36:39], a[164:167], v[128:131]
 buffer_load_dwordx4 v8, s[16:19], s21 offen offset:0  nt lds
M v[132:135], a[44:47], a[164:167], v[20:23]
 ds_read_b64_tr_b16 a[116:117], v3 offset:40960
 ds_read_b64_tr_b16 a[118:119], v3 offset:41984
M v[132:135], a[40:43], a[160:163], v[132:135]
 buffer_load_dwordx4 v9, s[16:19], s21 offen offset:1024  nt lds
M v[136:139], a[48:51], a[160:163], v[20:23]
M v[136:139], a[52:55], a[164:167], v[136:139]
 ds_read_b64_tr_b16 a[120:121], v4 offset:32768
 ds_read_b64_tr_b16 a[122:123], v4 offset:33792
M v[140:143], a[60:63], a[164:167], v[20:23]
 buffer_load_dwordx4 v10, s[16:19], s21 offen offset:2048  nt lds
M v[140:143], a[56:59], a[160:163], v[140:143]
M v[144:147], a[64:67], a[160:163], v[20:23]
 ds_read_b64_tr_b16 a[124:125], v4 offset:40960
 ds_read_b64_tr_b16 a[126:127], v4 offset:41984
M v[144:147], a[68:71], a[164:167], v[144:147]
 buffer_load_dwordx4 v11, s[16:19], s21 offen offset:3072  nt lds
M v[148:151], a[76:79], a[164:167], v[20:23]
 s_add_u32 s21, s21, 524160
M v[148:151], a[72:75], a[160:163], v[148:151]
M v[152:155], a[80:83], a[160:163], v[20:23]
M v[152:155], a[84:87], a[164:167], v[152:155]
 s_waitcnt lgkmcnt(6)
M v[156:159], a[92:95], a[164:167], v[20:23]
 s_waitcnt vmcnt(16) lgkmcnt(0)
M v[156:159], a[88:91], a[160:163], v[156:159]
 s_barrier
M v[160:163], a[32:35], a[168:171], v[20:23]
 s_add_u32 m0, s24, 0
 ds_read_b128 a[160:163], v5 offset:20480
 ds_read_b128 a[164:167], v6 offset:20480
M v[160:163], a[36:39], a[172:175], v[160:163]
 buffer_load_dwordx4 v12, s[48:51], s22 offen offset:0   lds
M v[164:167], a[44:47], a[172:175], v[20:23]
 ds_read_b64_tr_b16 a[128:129], v1 offset:49152
 ds_read_b64_tr_b16 a[130:131], v1 offset:50176
M v[164:167], a[40:43], a[168:171], v[164:167]
M v[168:171], a[48:51], a[168:171], v[20:23]
 buffer_load_dwordx4 v13, s[48:51], s22 offen offset:1024   lds
M v[168:171], a[52:55], a[172:175], v[168:171]
 ds_read_b64_tr_b16 a[132:133], v1 offset:57344
 ds_read_b64_tr_b16 a[134:135], v1 offset:58368
M v[172:175], a[60:63], a[172:175], v[20:23]
M v[172:175], a[56:59], a[168:171], v[172:175]
M v[176:179], a[64:67], a[168:171], v[20:23]
 ds_read_b64_tr_b16 a[136:137], v2 offset:49152
 ds_read_b64_tr_b16 a[138:139], v2 offset:50176
M v[176:179], a[68:71], a[172:175], v[176:179]
 buffer_load_dwordx4 v14, s[48:51], s22 offen offset:2048   lds
M v[180:183], a[76:79], a[172:175], v[20:23]
M v[180:183], a[72:75], a[168:171], v[180:183]
 ds_read_b64_tr_b16 a[140:141], v2 offset:57344
 ds_read_b64_tr_b16 a[142:143], v2 offset:58368
M v[184:187], a[80:83], a[168:171], v[20:23]
 buffer_load_dwordx4 v15, s[48:51], s22 offen offset:3072   lds
M v[184:187], a[84:87], a[172:175], v[184:187]
 s_waitcnt lgkmcnt(8)
M v[188:191], a[92:95], a[172:175], v[20:23]
 s_add_u32 s22, s22, 2097152
M v[188:191], a[88:91], a[168:171], v[188:191]
 s_add_u32 m0, s23, 32768
 ds_read_b64_tr_b16 a[144:145], v3 offset:49152
 ds_read_b64_tr_b16 a[146:147], v3 offset:50176
M v[192:195], a[32:35], a[160:163], v[20:23]
 ds_read_b128 a[168:171], v5 offset:22528
 ds_read_b128 a[172:175], v6 offset:22528
M v[192:195], a[36:39], a[164:167], v[192:195]
 buffer_load_dwordx4 v8, s[16:19], s21 offen offset:0  nt lds
M v[196:199], a[44:47], a[164:167], v[20:23]
 ds_read_b64_tr_b16 a[148:149], v3 offset:57344
 ds_read_b64_tr_b16 a[150:151], v3 offset:58368
M v[196:199], a[40:43], a[160:163], v[196:199]
 buffer_load_dwordx4 v9, s[16:19], s21 offen offset:1024  nt lds
M v[200:203], a[48:51], a[160:163], v[20:23]
M v[200:203], a[52:55], a[164:167], v[200:203]
 ds_read_b64_tr_b16 a[152:153], v4 offset:49152
 ds_read_b64_tr_b16 a[154:155], v4 offset:50176
M v[204:207], a[60:63], a[164:167], v[20:23]
 buffer_load_dwordx4 v10, s[16:19], s21 offen offset:2048  nt lds
M v[204:207], a[56:59], a[160:163], v[204:207]
M v[208:211], a[64:67], a[160:163], v[20:23]
 ds_read_b64_tr_b16 a[156:157], v4 offset:57344
 ds_read_b64_tr_b16 a[158:159], v4 offset:58368
M v[208:211], a[68:71], a[164:167], v[208:211]
 buffer_load_dwordx4 v11, s[16:19], s21 offen offset:3072  nt lds
M v[212:215], a[76:79], a[164:167], v[20:23]
 s_add_u32 s21, s21, 128
M v[212:215], a[72:75], a[160:163], v[212:215]
M v[216:219], a[80:83], a[160:163], v[20:23]
M v[216:219], a[84:87], a[164:167], v[216:219]
 s_waitcnt lgkmcnt(6)
M v[220:223], a[92:95], a[164:167], v[20:23]
 s_waitcnt vmcnt(16) lgkmcnt(0)
M v[220:223], a[88:91], a[160:163], v[220:223]
 s_barrier
M v[224:227], a[32:35], a[168:171], v[20:23]
 ds_read_b128 a[160:163], v5 offset:32768
 ds_read_b128 a[164:167], v6 offset:32768
M v[224:227], a[36:39], a[172:175], v[224:227]
 buffer_load_dword a240, v24, s[32:35], 0 offen offset:512
M v[228:231], a[44:47], a[172:175], v[20:23]
M v[228:231], a[40:43], a[168:171], v[228:231]
M v[232:235], a[48:51], a[168:171], v[20:23]
M v[232:235], a[52:55], a[172:175], v[232:235]
M v[236:239], a[60:63], a[172:175], v[20:23]
M v[236:239], a[56:59], a[168:171], v[236:239]
M v[240:243], a[64:67], a[168:171], v[20:23]
M v[240:243], a[68:71], a[172:175], v[240:243]
M v[244:247], a[76:79], a[172:175], v[20:23]
M v[244:247], a[72:75], a[168:171], v[244:247]
M v[248:251], a[80:83], a[168:171], v[20:23]
M v[248:251], a[84:87], a[172:175], v[248:251]
 s_waitcnt lgkmcnt(0)
M v[252:255], a[92:95], a[172:175], v[20:23]
M v[252:255], a[88:91], a[168:171], v[252:255]
M a[0:3], a[96:99], a[160:163], a[0:3]
 ds_read_b128 a[168:171], v5 offset:34816
 ds_read_b128 a[172:175], v6 offset:34816
M a[0:3], a[100:103], a[164:167], a[0:3]
 ds_read_b64_tr_b16 a[32:33], v1 offset:0
 ds_read_b64_tr_b16 a[34:35], v1 offset:1024
M a[4:7], a[108:111], a[164:167], a[4:7]
 s_add_u32 m0, s24, 16384
M a[4:7], a[104:107], a[160:163], a[4:7]
 buffer_load_dwordx4 v12, s[48:51], s22 offen offset:0   lds
M a[8:11], a[112:115], a[160:163], a[8:11]
M a[8:11], a[116:119], a[164:167], a[8:11]
M a[12:15], a[124:127], a[164:167], a[12:15]
 ds_read_b64_tr_b16 a[36:37], v1 offset:8192
 ds_read_b64_tr_b16 a[38:39], v1 offset:9216
M a[12:15], a[120:123], a[160:163], a[12:15]
M a[16:19], a[128:131], a[160:163], a[16:19]
 buffer_load_dwordx4 v13, s[48:51], s22 offen offset:1024   lds
M a[16:19], a[132:135], a[164:167], a[16:19]
M a[20:23], a[140:143], a[164:167], a[20:23]
M a[20:23], a[136:139], a[160:163], a[20:23]
 ds_read_b64_tr_b16 a[40:41], v2 offset:0
 ds_read_b64_tr_b16 a[42:43], v2 offset:1024
M a[24:27], a[144:147], a[160:163], a[24:27]
M a[24:27], a[148:151], a[164:167], a[24:27]
 s_waitcnt lgkmcnt(6)
M a[28:31], a[156:159], a[164:167], a[28:31]
 buffer_load_dwordx4 v14, s[48:51], s22 offen offset:2048   lds
M a[28:31], a[152:155], a[160:163], a[28:31]
M v[60:63], a[152:155], a[168:171], v[60:63]
 ds_read_b128 a[160:163], v5 offset:36864
 ds_read_b128 a[164:167], v6 offset:36864
M v[60:63], a[156:159], a[172:175], v[60:63]
 ds_read_b64_tr_b16 a[44:45], v2 offset:8192
 ds_read_b64_tr_b16 a[46:47], v2 offset:9216
M v[56:59], a[148:151], a[172:175], v[56:59]
 buffer_load_dwordx4 v15, s[48:51], s22 offen offset:3072   lds
M v[56:59], a[144:147], a[168:171], v[56:59]
 s_sub_u32 s22, s22, 2097024
M v[52:55], a[136:139], a[168:171], v[52:55]
M v[52:55], a[140:143], a[172:175], v[52:55]
 ds_read_b64_tr_b16 a[48:49], v3 offset:0
 ds_read_b64_tr_b16 a[50:51], v3 offset:1024
M v[48:51], a[132:135], a[172:175], v[48:51]
 s_add_u32 m0, s23, 49152
M v[48:51], a[128:131], a[168:171], v[48:51]
 buffer_load_dwordx4 v8, s[16:19], s21 offen offset:0  nt lds
M v[44:47], a[120:123], a[168:171], v[44:47]
M v[44:47], a[124:127], a[172:175], v[44:47]
M v[40:43], a[116:119], a[172:175], v[40:43]
 ds_read_b64_tr_b16 a[52:53], v3 offset:8192
 ds_read_b64_tr_b16 a[54:55], v3 offset:9216
M v[40:43], a[112:115], a[168:171], v[40:43]
M v[36:39], a[104:107], a[168:171], v[36:39]
 buffer_load_dwordx4 v9, s[16:19], s21 offen offset:1024  nt lds
M v[36:39], a[108:111], a[172:175], v[36:39]
 s_waitcnt lgkmcnt(6)
M v[32:35], a[100:103], a[172:175], v[32:35]
M v[32:35], a[96:99], a[168:171], v[32:35]
 ds_read_b64_tr_b16 a[56:57], v4 offset:0
 ds_read_b64_tr_b16 a[58:59], v4 offset:1024
M v[64:67], a[96:99], a[160:163], v[64:67]
 ds_read_b128 a[168:171], v5 offset:38912
 ds_read_b128 a[172:175], v6 offset:38912
M v[64:67], a[100:103], a[164:167], v[64:67]
 buffer_load_dwordx4 v10, s[16:19], s21 offen offset:2048  nt lds
M v[68:71], a[108:111], a[164:167], v[68:71]
M v[68:71], a[104:107], a[160:163], v[68:71]
M v[72:75], a[112:115], a[160:163], v[72:75]
 ds_read_b64_tr_b16 a[60:61], v4 offset:8192
 ds_read_b64_tr_b16 a[62:63], v4 offset:9216
M v[72:75], a[116:119], a[164:167], v[72:75]
M v[76:79], a[124:127], a[164:167], v[76:79]
 buffer_load_dwordx4 v11, s[16:19], s21 offen offset:3072  nt lds
M v[76:79], a[120:123], a[160:163], v[76:79]
 s_add_u32 s21, s21, 524160
M v[80:83], a[128:131], a[160:163], v[80:83]
M v[80:83], a[132:135], a[164:167], v[80:83]
M v[84:87], a[140:143], a[164:167], v[84:87]
M v[84:87], a[136:139], a[160:163], v[84:87]
M v[88:91], a[144:147], a[160:163], v[88:91]
M v[88:91], a[148:151], a[164:167], v[88:91]
 s_waitcnt lgkmcnt(2)
M v[92:95], a[156:159], a[164:167], v[92:95]
 s_waitcnt vmcnt(17) lgkmcnt(0)
M v[92:95], a[152:155], a[160:163], v[92:95]
 s_barrier
M v[124:127], a[152:155], a[168:171], v[124:127]
 ds_read_b128 a[160:163], v5 offset:49152
 ds_read_b128 a[164:167], v6 offset:49152
M v[124:127], a[156:159], a[172:175], v[124:127]
M v[120:123], a[148:151], a[172:175], v[120:123]
 s_add_u32 m0, s24, 32768
 ds_read_b64_tr_b16 a[64:65], v1 offset:16384
 ds_read_b64_tr_b16 a[66:67], v1 offset:17408
M v[120:123], a[144:147], a[168:171], v[120:123]
 buffer_load_dwordx4 v12, s[48:51], s22 offen offset:0   lds
M v[116:119], a[136:139], a[168:171], v[116:119]
M v[116:119], a[140:143], a[172:175], v[116:119]
M v[112:115], a[132:135], a[172:175], v[112:115]
M v[112:115], a[128:131], a[168:171], v[112:115]
M v[108:111], a[120:123], a[168:171], v[108:111]
M v[108:111], a[124:127], a[172:175], v[108:111]
 ds_read_b64_tr_b16 a[68:69], v1 offset:24576
 ds_read_b64_tr_b16 a[70:71], v1 offset:25600
M v[104:107], a[116:119], a[172:175], v[104:107]
 buffer_load_dwordx4 v13, s[48:51], s22 offen offset:1024   lds
M v[104:107], a[112:115], a[168:171], v[104:107]
M v[100:103], a[104:107], a[168:171], v[100:103]
M v[100:103], a[108:111], a[172:175], v[100:103]
 s_waitcnt lgkmcnt(4)
M v[96:99], a[100:103], a[172:175], v[96:99]
M v[96:99], a[96:99], a[168:171], v[96:99]
M v[128:131], a[96:99], a[160:163], v[128:131]
 ds_read_b128 a[168:171], v5 offset:51200
 ds_read_b128 a[172:175], v6 offset:51200
M v[128:131], a[100:103], a[164:167], v[128:131]
 ds_read_b64_tr_b16 a[72:73], v2 offset:16384
 ds_read_b64_tr_b16 a[74:75], v2 offset:17408
M v[132:135], a[108:111], a[164:167], v[132:135]
 buffer_load_dwordx4 v14, s[48:51], s22 offen offset:2048   lds
M v[132:135], a[104:107], a[160:163], v[132:135]
M v[136:139], a[112:115], a[160:163], v[136:139]
M v[136:139], a[116:119], a[164:167], v[136:139]
M v[140:143], a[124:127], a[164:167], v[140:143]
M v[140:143], a[120:123], a[160:163], v[140:143]
 ds_read_b64_tr_b16 a[76:77], v2 offset:24576
 ds_read_b64_tr_b16 a[78:79], v2 offset:25600
M v[144:147], a[128:131], a[160:163], v[144:147]
 buffer_load_dwordx4 v15, s[48:51], s22 offen offset:3072   lds
M v[144:147], a[132:135], a[164:167], v[144:147]
 s_add_u32 s22, s22, 2097152
M v[148:151], a[140:143], a[164:167], v[148:151]
M v[148:151], a[136:139], a[160:163], v[148:151]
M v[152:155], a[144:147], a[160:163], v[152:155]
M v[152:155], a[148:151], a[164:167], v[152:155]
 s_waitcnt lgkmcnt(4)
M v[156:159], a[156:159], a[164:167], v[156:159]
 s_add_u32 m0, s23, 0
 ds_read_b64_tr_b16 a[80:81], v3 offset:16384
 ds_read_b64_tr_b16 a[82:83], v3 offset:17408
M v[156:159], a[152:155], a[160:163], v[156:159]
 buffer_load_dwordx4 v8, s[16:19], s21 offen offset:0  nt lds
M v[188:191], a[152:155], a[168:171], v[188:191]
 ds_read_b128 a[160:163], v5 offset:53248
 ds_read_b128 a[164:167], v6 offset:53248
M v[188:191], a[156:159], a[172:175], v[188:191]
M v[184:187], a[148:151], a[172:175], v[184:187]
M v[184:187], a[144:147], a[168:171], v[184:187]
M v[180:183], a[136:139], a[168:171], v[180:183]
M v[180:183], a[140:143], a[172:175], v[180:183]
 ds_read_b64_tr_b16 a[84:85], v3 offset:24576
 ds_read_b64_tr_b16 a[86:87], v3 offset:25600
M v[176:179], a[132:135], a[172:175], v[176:179]
 buffer_load_dwordx4 v9, s[16:19], s21 offen offset:1024  nt lds
M v[176:179], a[128:131], a[168:171], v[176:179]
M v[172:175], a[120:123], a[168:171], v[172:175]
M v[172:175], a[124:127], a[172:175], v[172:175]
M v[168:171], a[116:119], a[172:175], v[168:171]
M v[168:171], a[112:115], a[168:171], v[168:171]
M v[164:167], a[104:107], a[168:171], v[164:167]
 ds_read_b64_tr_b16 a[88:89], v4 offset:16384
 ds_read_b64_tr_b16 a[90:91], v4 offset:17408
M v[164:167], a[108:111], a[172:175], v[164:167]
 s_waitcnt lgkmcnt(4)
M v[160:163], a[100:103], a[172:175], v[160:163]
 buffer_load_dwordx4 v10, s[16:19], s21 offen offset:2048  nt lds
M v[160:163], a[96:99], a[168:171], v[160:163]
M v[192:195], a[96:99], a[160:163], v[192:195]
 ds_read_b128 a[168:171], v5 offset:55296
 ds_read_b128 a[172:175], v6 offset:55296
M v[192:195], a[100:103], a[164:167], v[192:195]
M v[196:199], a[108:111], a[164:167], v[196:199]
M v[196:199], a[104:107], a[160:163], v[196:199]
 ds_read_b64_tr_b16 a[92:93], v4 offset:24576
 ds_read_b64_tr_b16 a[94:95], v4 offset:25600
M v[200:203], a[112:115], a[160:163], v[200:203]
 buffer_load_dwordx4 v11, s[16:19], s21 offen offset:3072  nt lds
M v[200:203], a[116:119], a[164:167], v[200:203]
 s_add_u32 s21, s21, 128
M v[204:207], a[124:127], a[164:167], v[204:207]
M v[204:207], a[120:123], a[160:163], v[204:207]
M v[208:211], a[128:131], a[160:163], v[208:211]
M v[208:211], a[132:135], a[164:167], v[208:211]
M v[212:215], a[140:143], a[164:167], v[212:215]
M v[212:215], a[136:139], a[160:163], v[212:215]
M v[216:219], a[144:147], a[160:163], v[216:219]
M v[216:219], a[148:151], a[164:167], v[216:219]
 s_waitcnt lgkmcnt(2)
M v[220:223], a[156:159], a[164:167], v[220:223]
 s_waitcnt vmcnt(17) lgkmcnt(0)
M v[220:223], a[152:155], a[160:163], v[220:223]
 s_barrier
M v[252:255], a[152:155], a[168:171], v[252:255]
 ds_read_b128 a[160:163], v5 offset:0
 ds_read_b128 a[164:167], v6 offset:0
M v[252:255], a[156:159], a[172:175], v[252:255]
M v[248:251], a[148:151], a[172:175], v[248:251]
M v[248:251], a[144:147], a[168:171], v[248:251]
M v[244:247], a[136:139], a[168:171], v[244:247]
M v[244:247], a[140:143], a[172:175], v[244:247]
M v[240:243], a[132:135], a[172:175], v[240:243]
M v[240:243], a[128:131], a[168:171], v[240:243]
M v[236:239], a[120:123], a[168:171], v[236:239]
M v[236:239], a[124:127], a[172:175], v[236:239]
M v[232:235], a[116:119], a[172:175], v[232:235]
M v[232:235], a[112:115], a[168:171], v[232:235]
M v[228:231], a[104:107], a[168:171], v[228:231]
M v[228:231], a[108:111], a[172:175], v[228:231]
 s_waitcnt lgkmcnt(0)
M v[224:227], a[100:103], a[172:175], v[224:227]
M v[224:227], a[96:99], a[168:171], v[224:227]
M a[0:3], a[32:35], a[160:163], a[0:3]
 ds_read_b128 a[168:171], v5 offset:2048
 ds_read_b128 a[172:175], v6 offset:2048
M a[0:3], a[36:39], a[164:167], a[0:3]
 ds_read_b64_tr_b16 a[96:97], v1 offset:32768
 ds_read_b64_tr_b16 a[98:99], v1 offset:33792
M a[4:7], a[44:47], a[164:167], a[4:7]
 s_add_u32 m0, s24, 49152
M a[4:7], a[40:43], a[160:163], a[4:7]
 buffer_load_dwordx4 v12, s[48:51], s22 offen offset:0   lds
M a[8:11], a[48:51], a[160:163], a[8:11]
M a[8:11], a[52:55], a[164:167], a[8:11]
M a[12:15], a[60:63], a[164:167], a[12:15]
 ds_read_b64_tr_b16 a[100:101], v1 offset:40960
 ds_read_b64_tr_b16 a[102:103], v1 offset:41984
M a[12:15], a[56:59], a[160:163], a[12:15]
M a[16:19], a[64:67], a[160:163], a[16:19]
 buffer_load_dwordx4 v13, s[48:51], s22 offen offset:1024   lds
M a[16:19], a[68:71], a[164:167], a[16:19]
M a[20:23], a[76:79], a[164:167], a[20:23]
 v_mov_b32 v16, 0x3f80
M a[20:23], a[72:75], a[160:163], a[20:23]
 ds_read_b64_tr_b16 a[104:105], v2 offset:32768
 ds_read_b64_tr_b16 a[106:107], v2 offset:33792
M a[24:27], a[80:83], a[160:163], a[24:27]
 v_lshrrev_b32 v17, 8, v7
M a[24:27], a[84:87], a[164:167], a[24:27]
 s_waitcnt lgkmcnt(6)
 v_bfe_u32 v18, v7, 6, 2
M a[28:31], a[92:95], a[164:167], a[28:31]
 buffer_load_dwordx4 v14, s[48:51], s22 offen offset:2048   lds
M a[28:31], a[88:91], a[160:163], a[28:31]
 v_and_b32 v19, 16, v7
M v[60:63], a[88:91], a[168:171], v[60:63]
 ds_read_b128 a[160:163], v5 offset:4096
 ds_read_b128 a[164:167], v6 offset:4096
M v[60:63], a[92:95], a[172:175], v[60:63]
 ds_read_b64_tr_b16 a[108:109], v2 offset:40960
 ds_read_b64_tr_b16 a[110:111], v2 offset:41984
M v[56:59], a[84:87], a[172:175], v[56:59]
 buffer_load_dwordx4 v15, s[48:51], s22 offen offset:3072   lds
M v[56:59], a[80:83], a[168:171], v[56:59]
 s_sub_u32 s22, s22, 2097024
 v_lshlrev_b32 v19, v19, v16
M v[52:55], a[72:75], a[168:171], v[52:55]
 v_cmp_eq_u32 vcc, v17, v18
M v[52:55], a[76:79], a[172:175], v[52:55]
 ds_read_b64_tr_b16 a[112:113], v3 offset:32768
 ds_read_b64_tr_b16 a[114:115], v3 offset:33792
M v[48:51], a[68:71], a[172:175], v[48:51]
 s_add_u32 m0, s23, 16384
 v_and_b32 v16, 32, v7
M v[48:51], a[64:67], a[168:171], v[48:51]
 buffer_load_dwordx4 v8, s[16:19], s21 offen offset:0  nt lds
M v[44:47], a[56:59], a[168:171], v[44:47]
 v_accvgpr_write_b32 a244, 0
M v[44:47], a[60:63], a[172:175], v[44:47]
 v_accvgpr_write_b32 a245, 0
M v[40:43], a[52:55], a[172:175], v[40:43]
 ds_read_b64_tr_b16 a[116:117], v3 offset:40960
 ds_read_b64_tr_b16 a[118:119], v3 offset:41984
M v[40:43], a[48:51], a[168:171], v[40:43]
 v_cndmask_b32 v19, 0, v19, vcc
M v[36:39], a[40:43], a[168:171], v[36:39]
 buffer_load_dwordx4 v9, s[16:19], s21 offen offset:1024  nt lds
M v[36:39], a[44:47], a[172:175], v[36:39]
 s_waitcnt lgkmcnt(6)
 v_cmp_eq_u32 vcc, 0, v16
M v[32:35], a[36:39], a[172:175], v[32:35]
 v_accvgpr_write_b32 a248, 0
M v[32:35], a[32:35], a[168:171], v[32:35]
 ds_read_b64_tr_b16 a[120:121], v4 offset:32768
 ds_read_b64_tr_b16 a[122:123], v4 offset:33792
M v[64:67], a[32:35], a[160:163], v[64:67]
 ds_read_b128 a[168:171], v5 offset:6144
 ds_read_b128 a[172:175], v6 offset:6144
M v[64:67], a[36:39], a[164:167], v[64:67]
 buffer_load_dwordx4 v10, s[16:19], s21 offen offset:2048  nt lds
M v[68:71], a[44:47], a[164:167], v[68:71]
 v_accvgpr_write_b32 a249, 0
M v[68:71], a[40:43], a[160:163], v[68:71]
 v_cndmask_b32 v17, 0, v19, vcc
M v[72:75], a[48:51], a[160:163], v[72:75]
 ds_read_b64_tr_b16 a[124:125], v4 offset:40960
 ds_read_b64_tr_b16 a[126:127], v4 offset:41984
M v[72:75], a[52:55], a[164:167], v[72:75]
 v_sub_u32 v18, v19, v17
M v[76:79], a[60:63], a[164:167], v[76:79]
 buffer_load_dwordx4 v11, s[16:19], s21 offen offset:3072  nt lds
M v[76:79], a[56:59], a[160:163], v[76:79]
 s_add_u32 s21, s21, 524160
 v_accvgpr_write_b32 a246, v17
M v[80:83], a[64:67], a[160:163], v[80:83]
 v_accvgpr_write_b32 a247, v18
M v[80:83], a[68:71], a[164:167], v[80:83]
M v[84:87], a[76:79], a[164:167], v[84:87]
M v[84:87], a[72:75], a[160:163], v[84:87]
M v[88:91], a[80:83], a[160:163], v[88:91]
M v[88:91], a[84:87], a[164:167], v[88:91]
 s_waitcnt lgkmcnt(2)
M v[92:95], a[92:95], a[164:167], v[92:95]
 s_waitcnt vmcnt(16) lgkmcnt(0)
M v[92:95], a[88:91], a[160:163], v[92:95]
 s_barrier
M v[124:127], a[88:91], a[168:171], v[124:127]
 ds_read_b128 a[160:163], v5 offset:16384
 ds_read_b128 a[164:167], v6 offset:16384
M v[124:127], a[92:95], a[172:175], v[124:127]
M v[120:123], a[84:87], a[172:175], v[120:123]
 s_add_u32 m0, s24, 0
 ds_read_b64_tr_b16 a[128:129], v1 offset:49152
 ds_read_b64_tr_b16 a[130:131], v1 offset:50176
M v[120:123], a[80:83], a[168:171], v[120:123]
 buffer_load_dwordx4 v12, s[48:51], s22 offen offset:0   lds
M v[116:119], a[72:75], a[168:171], v[116:119]
M v[116:119], a[76:79], a[172:175], v[116:119]
M v[112:115], a[68:71], a[172:175], v[112:115]
M v[112:115], a[64:67], a[168:171], v[112:115]
M v[108:111], a[56:59], a[168:171], v[108:111]
M v[108:111], a[60:63], a[172:175], v[108:111]
 ds_read_b64_tr_b16 a[132:133], v1 offset:57344
 ds_read_b64_tr_b16 a[134:135], v1 offset:58368
M v[104:107], a[52:55], a[172:175], v[104:107]
 buffer_load_dwordx4 v13, s[48:51], s22 offen offset:1024   lds
M v[104:107], a[48:51], a[168:171], v[104:107]
M v[100:103], a[40:43], a[168:171], v[100:103]
M v[100:103], a[44:47], a[172:175], v[100:103]
 s_waitcnt lgkmcnt(4)
M v[96:99], a[36:39], a[172:175], v[96:99]
M v[96:99], a[32:35], a[168:171], v[96:99]
M v[128:131], a[32:35], a[160:163], v[128:131]
 ds_read_b128 a[168:171], v5 offset:18432
 ds_read_b128 a[172:175], v6 offset:18432
M v[128:131], a[36:39], a[164:167], v[128:131]
 ds_read_b64_tr_b16 a[136:137], v2 offset:49152
 ds_read_b64_tr_b16 a[138:139], v2 offset:50176
M v[132:135], a[44:47], a[164:167], v[132:135]
 buffer_load_dwordx4 v14, s[48:51], s22 offen offset:2048   lds
M v[132:135], a[40:43], a[160:163], v[132:135]
M v[136:139], a[48:51], a[160:163], v[136:139]
M v[136:139], a[52:55], a[164:167], v[136:139]
M v[140:143], a[60:63], a[164:167], v[140:143]
M v[140:143], a[56:59], a[160:163], v[140:143]
 ds_read_b64_tr_b16 a[140:141], v2 offset:57344
 ds_read_b64_tr_b16 a[142:143], v2 offset:58368
M v[144:147], a[64:67], a[160:163], v[144:147]
 buffer_load_dwordx4 v15, s[48:51], s22 offen offset:3072   lds
M v[144:147], a[68:71], a[164:167], v[144:147]
 s_add_u32 s22, s22, 2097152
M v[148:151], a[76:79], a[164:167], v[148:151]
M v[148:151], a[72:75], a[160:163], v[148:151]
M v[152:155], a[80:83], a[160:163], v[152:155]
M v[152:155], a[84:87], a[164:167], v[152:155]
 s_waitcnt lgkmcnt(4)
M v[156:159], a[92:95], a[164:167], v[156:159]
 s_add_u32 m0, s23, 32768
 ds_read_b64_tr_b16 a[144:145], v3 offset:49152
 ds_read_b64_tr_b16 a[146:147], v3 offset:50176
M v[156:159], a[88:91], a[160:163], v[156:159]
 buffer_load_dwordx4 v8, s[16:19], s21 offen offset:0  nt lds
M v[188:191], a[88:91], a[168:171], v[188:191]
 ds_read_b128 a[160:163], v5 offset:20480
 ds_read_b128 a[164:167], v6 offset:20480
M v[188:191], a[92:95], a[172:175], v[188:191]
M v[184:187], a[84:87], a[172:175], v[184:187]
M v[184:187], a[80:83], a[168:171], v[184:187]
M v[180:183], a[72:75], a[168:171], v[180:183]
M v[180:183], a[76:79], a[172:175], v[180:183]
 ds_read_b64_tr_b16 a[148:149], v3 offset:57344
 ds_read_b64_tr_b16 a[150:151], v3 offset:58368
M v[176:179], a[68:71], a[172:175], v[176:179]
 buffer_load_dwordx4 v9, s[16:19], s21 offen offset:1024  nt lds
M v[176:179], a[64:67], a[168:171], v[176:179]
M v[172:175], a[56:59], a[168:171], v[172:175]
M v[172:175], a[60:63], a[172:175], v[172:175]
M v[168:171], a[52:55], a[172:175], v[168:171]
M v[168:171], a[48:51], a[168:171], v[168:171]
M v[164:167], a[40:43], a[168:171], v[164:167]
 ds_read_b64_tr_b16 a[152:153], v4 offset:49152
 ds_read_b64_tr_b16 a[154:155], v4 offset:50176
M v[164:167], a[44:47], a[172:175], v[164:167]
 s_waitcnt lgkmcnt(4)
M v[160:163], a[36:39], a[172:175], v[160:163]
 buffer_load_dwordx4 v10, s[16:19], s21 offen offset:2048  nt lds
M v[160:163], a[32:35], a[168:171], v[160:163]
M v[192:195], a[32:35], a[160:163], v[192:195]
 ds_read_b128 a[168:171], v5 offset:22528
 ds_read_b128 a[172:175], v6 offset:22528
M v[192:195], a[36:39], a[164:167], v[192:195]
M v[196:199], a[44:47], a[164:167], v[196:199]
M v[196:199], a[40:43], a[160:163], v[196:199]
 ds_read_b64_tr_b16 a[156:157], v4 offset:57344
 ds_read_b64_tr_b16 a[158:159], v4 offset:58368
M v[200:203], a[48:51], a[160:163], v[200:203]
 buffer_load_dwordx4 v11, s[16:19], s21 offen offset:3072  nt lds
M v[200:203], a[52:55], a[164:167], v[200:203]
 s_add_u32 s21, s21, 128
M v[204:207], a[60:63], a[164:167], v[204:207]
M v[204:207], a[56:59], a[160:163], v[204:207]
M v[208:211], a[64:67], a[160:163], v[208:211]
M v[208:211], a[68:71], a[164:167], v[208:211]
M v[212:215], a[76:79], a[164:167], v[212:215]
M v[212:215], a[72:75], a[160:163], v[212:215]
M v[216:219], a[80:83], a[160:163], v[216:219]
M v[216:219], a[84:87], a[164:167], v[216:219]
 s_waitcnt lgkmcnt(2)
M v[220:223], a[92:95], a[164:167], v[220:223]
 s_waitcnt vmcnt(16) lgkmcnt(0)
M v[220:223], a[88:91], a[160:163], v[220:223]
 s_barrier
M v[252:255], a[88:91], a[168:171], v[252:255]
 ds_read_b128 a[160:163], v5 offset:32768
 ds_read_b128 a[164:167], v6 offset:32768
M v[252:255], a[92:95], a[172:175], v[252:255]
M v[248:251], a[84:87], a[172:175], v[248:251]
M v[248:251], a[80:83], a[168:171], v[248:251]
M v[244:247], a[72:75], a[168:171], v[244:247]
M v[244:247], a[76:79], a[172:175], v[244:247]
M v[240:243], a[68:71], a[172:175], v[240:243]
M v[240:243], a[64:67], a[168:171], v[240:243]
M v[236:239], a[56:59], a[168:171], v[236:239]
M v[236:239], a[60:63], a[172:175], v[236:239]
M v[232:235], a[52:55], a[172:175], v[232:235]
M v[232:235], a[48:51], a[168:171], v[232:235]
M v[228:231], a[40:43], a[168:171], v[228:231]
M v[228:231], a[44:47], a[172:175], v[228:231]
 s_waitcnt lgkmcnt(0)
M v[224:227], a[36:39], a[172:175], v[224:227]
M v[224:227], a[32:35], a[168:171], v[224:227]
M a[0:3], a[96:99], a[160:163], a[0:3]
 ds_read_b128 a[168:171], v5 offset:34816
 ds_read_b128 a[172:175], v6 offset:34816
M a[0:3], a[100:103], a[164:167], a[0:3]
 ds_read_b64_tr_b16 a[32:33], v1 offset:0
 ds_read_b64_tr_b16 a[34:35], v1 offset:1024
M a[4:7], a[108:111], a[164:167], a[4:7]
 s_add_u32 m0, s24, 16384
M a[4:7], a[104:107], a[160:163], a[4:7]
 buffer_load_dwordx4 v12, s[48:51], s22 offen offset:0   lds
M a[8:11], a[112:115], a[160:163], a[8:11]
M a[8:11], a[116:119], a[164:167], a[8:11]
M a[12:15], a[124:127], a[164:167], a[12:15]
 ds_read_b64_tr_b16 a[36:37], v1 offset:8192
 ds_read_b64_tr_b16 a[38:39], v1 offset:9216
M a[12:15], a[120:123], a[160:163], a[12:15]
M a[16:19], a[128:131], a[160:163], a[16:19]
 buffer_load_dwordx4 v13, s[48:51], s22 offen offset:1024   lds
M a[16:19], a[132:135], a[164:167], a[16:19]
M a[20:23], a[140:143], a[164:167], a[20:23]
M a[20:23], a[136:139], a[160:163], a[20:23]
 ds_read_b64_tr_b16 a[40:41], v2 offset:0
 ds_read_b64_tr_b16 a[42:43], v2 offset:1024
M a[24:27], a[144:147], a[160:163], a[24:27]
M a[24:27], a[148:151], a[164:167], a[24:27]
 s_waitcnt lgkmcnt(6)
M a[28:31], a[156:159], a[164:167], a[28:31]
 buffer_load_dwordx4 v14, s[48:51], s22 offen offset:2048   lds
M a[28:31], a[152:155], a[160:163], a[28:31]
M v[60:63], a[152:155], a[168:171], v[60:63]
 ds_read_b128 a[160:163], v5 offset:36864
 ds_read_b128 a[164:167], v6 offset:36864
M v[60:63], a[156:159], a[172:175], v[60:63]
 ds_read_b64_tr_b16 a[44:45], v2 offset:8192
 ds_read_b64_tr_b16 a[46:47], v2 offset:9216
M v[56:59], a[148:151], a[172:175], v[56:59]
 buffer_load_dwordx4 v15, s[48:51], s22 offen offset:3072   lds
M v[56:59], a[144:147], a[168:171], v[56:59]
 s_sub_u32 s22, s22, 2097024
M v[52:55], a[136:139], a[168:171], v[52:55]
M v[52:55], a[140:143], a[172:175], v[52:55]
 ds_read_b64_tr_b16 a[48:49], v3 offset:0
 ds_read_b64_tr_b16 a[50:51], v3 offset:1024
M v[48:51], a[132:135], a[172:175], v[48:51]
 s_add_u32 m0, s23, 49152
M v[48:51], a[128:131], a[168:171], v[48:51]
 buffer_load_dwordx4 v8, s[16:19], s21 offen offset:0  nt lds
M v[44:47], a[120:123], a[168:171], v[44:47]
M v[44:47], a[124:127], a[172:175], v[44:47]
M v[40:43], a[116:119], a[172:175], v[40:43]
 ds_read_b64_tr_b16 a[52:53], v3 offset:8192
 ds_read_b64_tr_b16 a[54:55], v3 offset:9216
M v[40:43], a[112:115], a[168:171], v[40:43]
M v[36:39], a[104:107], a[168:171], v[36:39]
 buffer_load_dwordx4 v9, s[16:19], s21 offen offset:1024  nt lds
M v[36:39], a[108:111], a[172:175], v[36:39]
 s_waitcnt lgkmcnt(6)
M v[32:35], a[100:103], a[172:175], v[32:35]
M v[32:35], a[96:99], a[168:171], v[32:35]
 ds_read_b64_tr_b16 a[56:57], v4 offset:0
 ds_read_b64_tr_b16 a[58:59], v4 offset:1024
M v[64:67], a[96:99], a[160:163], v[64:67]
 ds_read_b128 a[168:171], v5 offset:38912
 ds_read_b128 a[172:175], v6 offset:38912
M v[64:67], a[100:103], a[164:167], v[64:67]
 buffer_load_dwordx4 v10, s[16:19], s21 offen offset:2048  nt lds
M v[68:71], a[108:111], a[164:167], v[68:71]
M v[68:71], a[104:107], a[160:163], v[68:71]
M v[72:75], a[112:115], a[160:163], v[72:75]
 ds_read_b64_tr_b16 a[60:61], v4 offset:8192
 ds_read_b64_tr_b16 a[62:63], v4 offset:9216
M v[72:75], a[116:119], a[164:167], v[72:75]
M v[76:79], a[124:127], a[164:167], v[76:79]
 buffer_load_dwordx4 v11, s[16:19], s21 offen offset:3072  nt lds
M v[76:79], a[120:123], a[160:163], v[76:79]
 s_add_u32 s21, s21, 524160
M v[80:83], a[128:131], a[160:163], v[80:83]
M v[80:83], a[132:135], a[164:167], v[80:83]
M v[84:87], a[140:143], a[164:167], v[84:87]
M v[84:87], a[136:139], a[160:163], v[84:87]
M v[88:91], a[144:147], a[160:163], v[88:91]
M v[88:91], a[148:151], a[164:167], v[88:91]
 s_waitcnt lgkmcnt(2)
M v[92:95], a[156:159], a[164:167], v[92:95]
 s_waitcnt vmcnt(16) lgkmcnt(0)
M v[92:95], a[152:155], a[160:163], v[92:95]
 s_barrier
M v[124:127], a[152:155], a[168:171], v[124:127]
 ds_read_b128 a[160:163], v5 offset:49152
 ds_read_b128 a[164:167], v6 offset:49152
M v[124:127], a[156:159], a[172:175], v[124:127]
M v[120:123], a[148:151], a[172:175], v[120:123]
 s_add_u32 m0, s24, 32768
 ds_read_b64_tr_b16 a[64:65], v1 offset:16384
 ds_read_b64_tr_b16 a[66:67], v1 offset:17408
M v[120:123], a[144:147], a[168:171], v[120:123]
 buffer_load_dwordx4 v12, s[48:51], s22 offen offset:0   lds
M v[116:119], a[136:139], a[168:171], v[116:119]
 v_min_u32 v16, 40, v0
 v_lshlrev_b32 v16, 2, v16
M v[116:119], a[140:143], a[172:175], v[116:119]
 buffer_load_dword v17, v16, s[12:15], 0 offen offset:64 sc1
M v[112:115], a[132:135], a[172:175], v[112:115]
M v[112:115], a[128:131], a[168:171], v[112:115]
M v[108:111], a[120:123], a[168:171], v[108:111]
M v[108:111], a[124:127], a[172:175], v[108:111]
 ds_read_b64_tr_b16 a[68:69], v1 offset:24576
 ds_read_b64_tr_b16 a[70:71], v1 offset:25600
M v[104:107], a[116:119], a[172:175], v[104:107]
 buffer_load_dwordx4 v13, s[48:51], s22 offen offset:1024   lds
M v[104:107], a[112:115], a[168:171], v[104:107]
M v[100:103], a[104:107], a[168:171], v[100:103]
M v[100:103], a[108:111], a[172:175], v[100:103]
 s_waitcnt lgkmcnt(4)
M v[96:99], a[100:103], a[172:175], v[96:99]
M v[96:99], a[96:99], a[168:171], v[96:99]
M v[128:131], a[96:99], a[160:163], v[128:131]
 ds_read_b128 a[168:171], v5 offset:51200
 ds_read_b128 a[172:175], v6 offset:51200
M v[128:131], a[100:103], a[164:167], v[128:131]
 ds_read_b64_tr_b16 a[72:73], v2 offset:16384
 ds_read_b64_tr_b16 a[74:75], v2 offset:17408
M v[132:135], a[108:111], a[164:167], v[132:135]
 buffer_load_dwordx4 v14, s[48:51], s22 offen offset:2048   lds
M v[132:135], a[104:107], a[160:163], v[132:135]
M v[136:139], a[112:115], a[160:163], v[136:139]
M v[136:139], a[116:119], a[164:167], v[136:139]
M v[140:143], a[124:127], a[164:167], v[140:143]
M v[140:143], a[120:123], a[160:163], v[140:143]
 ds_read_b64_tr_b16 a[76:77], v2 offset:24576
 ds_read_b64_tr_b16 a[78:79], v2 offset:25600
M v[144:147], a[128:131], a[160:163], v[144:147]
 buffer_load_dwordx4 v15, s[48:51], s22 offen offset:3072   lds
M v[144:147], a[132:135], a[164:167], v[144:147]
 s_add_u32 s22, s22, 2097152
M v[148:151], a[140:143], a[164:167], v[148:151]
M v[148:151], a[136:139], a[160:163], v[148:151]
M v[152:155], a[144:147], a[160:163], v[152:155]
M v[152:155], a[148:151], a[164:167], v[152:155]
 s_waitcnt lgkmcnt(4)
M v[156:159], a[156:159], a[164:167], v[156:159]
 s_add_u32 m0, s23, 0
 ds_read_b64_tr_b16 a[80:81], v3 offset:16384
 ds_read_b64_tr_b16 a[82:83], v3 offset:17408
M v[156:159], a[152:155], a[160:163], v[156:159]
 buffer_load_dwordx4 v8, s[16:19], s21 offen offset:0  nt lds
M v[188:191], a[152:155], a[168:171], v[188:191]
 ds_read_b128 a[160:163], v5 offset:53248
 ds_read_b128 a[164:167], v6 offset:53248
M v[188:191], a[156:159], a[172:175], v[188:191]
M v[184:187], a[148:151], a[172:175], v[184:187]
M v[184:187], a[144:147], a[168:171], v[184:187]
M v[180:183], a[136:139], a[168:171], v[180:183]
M v[180:183], a[140:143], a[172:175], v[180:183]
 ds_read_b64_tr_b16 a[84:85], v3 offset:24576
 ds_read_b64_tr_b16 a[86:87], v3 offset:25600
M v[176:179], a[132:135], a[172:175], v[176:179]
 buffer_load_dwordx4 v9, s[16:19], s21 offen offset:1024  nt lds
M v[176:179], a[128:131], a[168:171], v[176:179]
M v[172:175], a[120:123], a[168:171], v[172:175]
M v[172:175], a[124:127], a[172:175], v[172:175]
M v[168:171], a[116:119], a[172:175], v[168:171]
M v[168:171], a[112:115], a[168:171], v[168:171]
M v[164:167], a[104:107], a[168:171], v[164:167]
 ds_read_b64_tr_b16 a[88:89], v4 offset:16384
 ds_read_b64_tr_b16 a[90:91], v4 offset:17408
M v[164:167], a[108:111], a[172:175], v[164:167]
 s_waitcnt lgkmcnt(4)
M v[160:163], a[100:103], a[172:175], v[160:163]
 buffer_load_dwordx4 v10, s[16:19], s21 offen offset:2048  nt lds
M v[160:163], a[96:99], a[168:171], v[160:163]
M v[192:195], a[96:99], a[160:163], v[192:195]
 ds_read_b128 a[168:171], v5 offset:55296
 ds_read_b128 a[172:175], v6 offset:55296
M v[192:195], a[100:103], a[164:167], v[192:195]
M v[196:199], a[108:111], a[164:167], v[196:199]
M v[196:199], a[104:107], a[160:163], v[196:199]
 ds_read_b64_tr_b16 a[92:93], v4 offset:24576
 ds_read_b64_tr_b16 a[94:95], v4 offset:25600
M v[200:203], a[112:115], a[160:163], v[200:203]
 buffer_load_dwordx4 v11, s[16:19], s21 offen offset:3072  nt lds
M v[200:203], a[116:119], a[164:167], v[200:203]
 s_add_u32 s21, s21, 128
M v[204:207], a[124:127], a[164:167], v[204:207]
M v[204:207], a[120:123], a[160:163], v[204:207]
M v[208:211], a[128:131], a[160:163], v[208:211]
M v[208:211], a[132:135], a[164:167], v[208:211]
M v[212:215], a[140:143], a[164:167], v[212:215]
M v[212:215], a[136:139], a[160:163], v[212:215]
M v[216:219], a[144:147], a[160:163], v[216:219]
M v[216:219], a[148:151], a[164:167], v[216:219]
 s_waitcnt lgkmcnt(2)
M v[220:223], a[156:159], a[164:167], v[220:223]
 s_waitcnt vmcnt(17) lgkmcnt(0)
M v[220:223], a[152:155], a[160:163], v[220:223]
 s_barrier
M v[252:255], a[152:155], a[168:171], v[252:255]
 ds_read_b128 a[160:163], v5 offset:0
 ds_read_b128 a[164:167], v6 offset:0
M v[252:255], a[156:159], a[172:175], v[252:255]
M v[248:251], a[148:151], a[172:175], v[248:251]
M v[248:251], a[144:147], a[168:171], v[248:251]
M v[244:247], a[136:139], a[168:171], v[244:247]
M v[244:247], a[140:143], a[172:175], v[244:247]
M v[240:243], a[132:135], a[172:175], v[240:243]
M v[240:243], a[128:131], a[168:171], v[240:243]
M v[236:239], a[120:123], a[168:171], v[236:239]
M v[236:239], a[124:127], a[172:175], v[236:239]
M v[232:235], a[116:119], a[172:175], v[232:235]
M v[232:235], a[112:115], a[168:171], v[232:235]
M v[228:231], a[104:107], a[168:171], v[228:231]
M v[228:231], a[108:111], a[172:175], v[228:231]
 s_waitcnt lgkmcnt(0)
M v[224:227], a[100:103], a[172:175], v[224:227]
M v[224:227], a[96:99], a[168:171], v[224:227]
M a[0:3], a[32:35], a[160:163], a[0:3]
 ds_read_b128 a[168:171], v5 offset:2048
 ds_read_b128 a[172:175], v6 offset:2048
M a[0:3], a[36:39], a[164:167], a[0:3]
 ds_read_b64_tr_b16 a[96:97], v1 offset:32768
 ds_read_b64_tr_b16 a[98:99], v1 offset:33792
M a[4:7], a[44:47], a[164:167], a[4:7]
 s_add_u32 m0, s24, 49152
M a[4:7], a[40:43], a[160:163], a[4:7]
 buffer_load_dwordx4 v12, s[48:51], s22 offen offset:0   lds
M a[8:11], a[48:51], a[160:163], a[8:11]
M a[8:11], a[52:55], a[164:167], a[8:11]
M a[12:15], a[60:63], a[164:167], a[12:15]
 ds_read_b64_tr_b16 a[100:101], v1 offset:40960
 ds_read_b64_tr_b16 a[102:103], v1 offset:41984
M a[12:15], a[56:59], a[160:163], a[12:15]
M a[16:19], a[64:67], a[160:163], a[16:19]
 buffer_load_dwordx4 v13, s[48:51], s22 offen offset:1024   lds
M a[16:19], a[68:71], a[164:167], a[16:19]
M a[20:23], a[76:79], a[164:167], a[20:23]
M a[20:23], a[72:75], a[160:163], a[20:23]
 ds_read_b64_tr_b16 a[104:105], v2 offset:32768
 ds_read_b64_tr_b16 a[106:107], v2 offset:33792
M a[24:27], a[80:83], a[160:163], a[24:27]
M a[24:27], a[84:87], a[164:167], a[24:27]
 s_waitcnt lgkmcnt(6)
M a[28:31], a[92:95], a[164:167], a[28:31]
 buffer_load_dwordx4 v14, s[48:51], s22 offen offset:2048   lds
M a[28:31], a[88:91], a[160:163], a[28:31]
M v[60:63], a[88:91], a[168:171], v[60:63]
 ds_read_b128 a[160:163], v5 offset:4096
 ds_read_b128 a[164:167], v6 offset:4096
M v[60:63], a[92:95], a[172:175], v[60:63]
 ds_read_b64_tr_b16 a[108:109], v2 offset:40960
 ds_read_b64_tr_b16 a[110:111], v2 offset:41984
M v[56:59], a[84:87], a[172:175], v[56:59]
 buffer_load_dwordx4 v15, s[48:51], s22 offen offset:3072   lds
M v[56:59], a[80:83], a[168:171], v[56:59]
 s_sub_u32 s22, s22, 2097024
M v[52:55], a[72:75], a[168:171], v[52:55]
M v[52:55], a[76:79], a[172:175], v[52:55]
 ds_read_b64_tr_b16 a[112:113], v3 offset:32768
 ds_read_b64_tr_b16 a[114:115], v3 offset:33792
M v[48:51], a[68:71], a[172:175], v[48:51]
 s_add_u32 m0, s23, 16384
M v[48:51], a[64:67], a[168:171], v[48:51]
 buffer_load_dwordx4 v8, s[16:19], s21 offen offset:0  nt lds
M v[44:47], a[56:59], a[168:171], v[44:47]
M v[44:47], a[60:63], a[172:175], v[44:47]
M v[40:43], a[52:55], a[172:175], v[40:43]
 ds_read_b64_tr_b16 a[116:117], v3 offset:40960
 ds_read_b64_tr_b16 a[118:119], v3 offset:41984
M v[40:43], a[48:51], a[168:171], v[40:43]
M v[36:39], a[40:43], a[168:171], v[36:39]
 buffer_load_dwordx4 v9, s[16:19], s21 offen offset:1024  nt lds
M v[36:39], a[44:47], a[172:175], v[36:39]
 s_waitcnt lgkmcnt(6)
M v[32:35], a[36:39], a[172:175], v[32:35]
M v[32:35], a[32:35], a[168:171], v[32:35]
 ds_read_b64_tr_b16 a[120:121], v4 offset:32768
 ds_read_b64_tr_b16 a[122:123], v4 offset:33792
M v[64:67], a[32:35], a[160:163], v[64:67]
 ds_read_b128 a[168:171], v5 offset:6144
 ds_read_b128 a[172:175], v6 offset:6144
M v[64:67], a[36:39], a[164:167], v[64:67]
 buffer_load_dwordx4 v10, s[16:19], s21 offen offset:2048  nt lds
M v[68:71], a[44:47], a[164:167], v[68:71]
M v[68:71], a[40:43], a[160:163], v[68:71]
M v[72:75], a[48:51], a[160:163], v[72:75]
 ds_read_b64_tr_b16 a[124:125], v4 offset:40960
 ds_read_b64_tr_b16 a[126:127], v4 offset:41984
M v[72:75], a[52:55], a[164:167], v[72:75]
M v[76:79], a[60:63], a[164:167], v[76:79]
 buffer_load_dwordx4 v11, s[16:19], s21 offen offset:3072  nt lds
M v[76:79], a[56:59], a[160:163], v[76:79]
 s_add_u32 s21, s21, 524160
M v[80:83], a[64:67], a[160:163], v[80:83]
M v[80:83], a[68:71], a[164:167], v[80:83]
M v[84:87], a[76:79], a[164:167], v[84:87]
M v[84:87], a[72:75], a[160:163], v[84:87]
M v[88:91], a[80:83], a[160:163], v[88:91]
M v[88:91], a[84:87], a[164:167], v[88:91]
 s_waitcnt lgkmcnt(2)
M v[92:95], a[92:95], a[164:167], v[92:95]
 s_waitcnt vmcnt(17) lgkmcnt(0)
M v[92:95], a[88:91], a[160:163], v[92:95]
 s_barrier
M v[124:127], a[88:91], a[168:171], v[124:127]
 ds_read_b128 a[160:163], v5 offset:16384
 ds_read_b128 a[164:167], v6 offset:16384
M v[124:127], a[92:95], a[172:175], v[124:127]
M v[120:123], a[84:87], a[172:175], v[120:123]
 s_add_u32 m0, s24, 0
 ds_read_b64_tr_b16 a[128:129], v1 offset:49152
 ds_read_b64_tr_b16 a[130:131], v1 offset:50176
M v[120:123], a[80:83], a[168:171], v[120:123]
 buffer_load_dwordx4 v12, s[48:51], s22 offen offset:0   lds
M v[116:119], a[72:75], a[168:171], v[116:119]
M v[116:119], a[76:79], a[172:175], v[116:119]
M v[112:115], a[68:71], a[172:175], v[112:115]
M v[112:115], a[64:67], a[168:171], v[112:115]
M v[108:111], a[56:59], a[168:171], v[108:111]
M v[108:111], a[60:63], a[172:175], v[108:111]
 ds_read_b64_tr_b16 a[132:133], v1 offset:57344
 ds_read_b64_tr_b16 a[134:135], v1 offset:58368
M v[104:107], a[52:55], a[172:175], v[104:107]
 buffer_load_dwordx4 v13, s[48:51], s22 offen offset:1024   lds
M v[104:107], a[48:51], a[168:171], v[104:107]
M v[100:103], a[40:43], a[168:171], v[100:103]
M v[100:103], a[44:47], a[172:175], v[100:103]
 s_waitcnt lgkmcnt(4)
M v[96:99], a[36:39], a[172:175], v[96:99]
M v[96:99], a[32:35], a[168:171], v[96:99]
M v[128:131], a[32:35], a[160:163], v[128:131]
 ds_read_b128 a[168:171], v5 offset:18432
 ds_read_b128 a[172:175], v6 offset:18432
M v[128:131], a[36:39], a[164:167], v[128:131]
 ds_read_b64_tr_b16 a[136:137], v2 offset:49152
 ds_read_b64_tr_b16 a[138:139], v2 offset:50176
M v[132:135], a[44:47], a[164:167], v[132:135]
 buffer_load_dwordx4 v14, s[48:51], s22 offen offset:2048   lds
M v[132:135], a[40:43], a[160:163], v[132:135]
M v[136:139], a[48:51], a[160:163], v[136:139]
M v[136:139], a[52:55], a[164:167], v[136:139]
M v[140:143], a[60:63], a[164:167], v[140:143]
M v[140:143], a[56:59], a[160:163], v[140:143]
 ds_read_b64_tr_b16 a[140:141], v2 offset:57344
 ds_read_b64_tr_b16 a[142:143], v2 offset:58368
M v[144:147], a[64:67], a[160:163], v[144:147]
 buffer_load_dwordx4 v15, s[48:51], s22 offen offset:3072   lds
M v[144:147], a[68:71], a[164:167], v[144:147]
 s_add_u32 s22, s22, 2097152
M v[148:151], a[76:79], a[164:167], v[148:151]
M v[148:151], a[72:75], a[160:163], v[148:151]
M v[152:155], a[80:83], a[160:163], v[152:155]
M v[152:155], a[84:87], a[164:167], v[152:155]
 s_waitcnt lgkmcnt(4)
M v[156:159], a[92:95], a[164:167], v[156:159]
 s_add_u32 m0, s23, 32768
 ds_read_b64_tr_b16 a[144:145], v3 offset:49152
 ds_read_b64_tr_b16 a[146:147], v3 offset:50176
M v[156:159], a[88:91], a[160:163], v[156:159]
 buffer_load_dwordx4 v8, s[16:19], s21 offen offset:0  nt lds
M v[188:191], a[88:91], a[168:171], v[188:191]
 ds_read_b128 a[160:163], v5 offset:20480
 ds_read_b128 a[164:167], v6 offset:20480
M v[188:191], a[92:95], a[172:175], v[188:191]
M v[184:187], a[84:87], a[172:175], v[184:187]
M v[184:187], a[80:83], a[168:171], v[184:187]
M v[180:183], a[72:75], a[168:171], v[180:183]
M v[180:183], a[76:79], a[172:175], v[180:183]
 ds_read_b64_tr_b16 a[148:149], v3 offset:57344
 ds_read_b64_tr_b16 a[150:151], v3 offset:58368
M v[176:179], a[68:71], a[172:175], v[176:179]
 buffer_load_dwordx4 v9, s[16:19], s21 offen offset:1024  nt lds
M v[176:179], a[64:67], a[168:171], v[176:179]
M v[172:175], a[56:59], a[168:171], v[172:175]
M v[172:175], a[60:63], a[172:175], v[172:175]
M v[168:171], a[52:55], a[172:175], v[168:171]
M v[168:171], a[48:51], a[168:171], v[168:171]
M v[164:167], a[40:43], a[168:171], v[164:167]
 ds_read_b64_tr_b16 a[152:153], v4 offset:49152
 ds_read_b64_tr_b16 a[154:155], v4 offset:50176
M v[164:167], a[44:47], a[172:175], v[164:167]
 s_waitcnt lgkmcnt(4)
M v[160:163], a[36:39], a[172:175], v[160:163]
 buffer_load_dwordx4 v10, s[16:19], s21 offen offset:2048  nt lds
M v[160:163], a[32:35], a[168:171], v[160:163]
M v[192:195], a[32:35], a[160:163], v[192:195]
 ds_read_b128 a[168:171], v5 offset:22528
 ds_read_b128 a[172:175], v6 offset:22528
M v[192:195], a[36:39], a[164:167], v[192:195]
M v[196:199], a[44:47], a[164:167], v[196:199]
M v[196:199], a[40:43], a[160:163], v[196:199]
 ds_read_b64_tr_b16 a[156:157], v4 offset:57344
 ds_read_b64_tr_b16 a[158:159], v4 offset:58368
M v[200:203], a[48:51], a[160:163], v[200:203]
 buffer_load_dwordx4 v11, s[16:19], s21 offen offset:3072  nt lds
M v[200:203], a[52:55], a[164:167], v[200:203]
 s_add_u32 s21, s21, 128
M v[204:207], a[60:63], a[164:167], v[204:207]
M v[204:207], a[56:59], a[160:163], v[204:207]
M v[208:211], a[64:67], a[160:163], v[208:211]
M v[208:211], a[68:71], a[164:167], v[208:211]
M v[212:215], a[76:79], a[164:167], v[212:215]
M v[212:215], a[72:75], a[160:163], v[212:215]
M v[216:219], a[80:83], a[160:163], v[216:219]
M v[216:219], a[84:87], a[164:167], v[216:219]
 s_waitcnt lgkmcnt(2)
M v[220:223], a[92:95], a[164:167], v[220:223]
 s_waitcnt vmcnt(16) lgkmcnt(0)
M v[220:223], a[88:91], a[160:163], v[220:223]
 s_barrier
M v[252:255], a[88:91], a[168:171], v[252:255]
 ds_read_b128 a[160:163], v5 offset:32768
 ds_read_b128 a[164:167], v6 offset:32768
M v[252:255], a[92:95], a[172:175], v[252:255]
 v_cmp_ne_u32 vcc, 1, v17
M v[248:251], a[84:87], a[172:175], v[248:251]
 s_nop 0
M v[248:251], a[80:83], a[168:171], v[248:251]
 s_cbranch_vccnz L_zs1
L_zr1:
M v[244:247], a[72:75], a[168:171], v[244:247]
 buffer_load_dword a240, v24, s[32:35], 0 offen offset:1024
M v[244:247], a[76:79], a[172:175], v[244:247]
M v[240:243], a[68:71], a[172:175], v[240:243]
M v[240:243], a[64:67], a[168:171], v[240:243]
M v[236:239], a[56:59], a[168:171], v[236:239]
M v[236:239], a[60:63], a[172:175], v[236:239]
M v[232:235], a[52:55], a[172:175], v[232:235]
M v[232:235], a[48:51], a[168:171], v[232:235]
M v[228:231], a[40:43], a[168:171], v[228:231]
M v[228:231], a[44:47], a[172:175], v[228:231]
 s_waitcnt lgkmcnt(0)
M v[224:227], a[36:39], a[172:175], v[224:227]
M v[224:227], a[32:35], a[168:171], v[224:227]
M a[0:3], a[96:99], a[160:163], a[0:3]
 ds_read_b128 a[168:171], v5 offset:34816
 ds_read_b128 a[172:175], v6 offset:34816
M a[0:3], a[100:103], a[164:167], a[0:3]
 ds_read_b64_tr_b16 a[32:33], v1 offset:0
 ds_read_b64_tr_b16 a[34:35], v1 offset:1024
M a[4:7], a[108:111], a[164:167], a[4:7]
 s_add_u32 m0, s24, 16384
M a[4:7], a[104:107], a[160:163], a[4:7]
 buffer_load_dwordx4 v12, s[48:51], s22 offen offset:0   lds
M a[8:11], a[112:115], a[160:163], a[8:11]
M a[8:11], a[116:119], a[164:167], a[8:11]
M a[12:15], a[124:127], a[164:167], a[12:15]
 ds_read_b64_tr_b16 a[36:37], v1 offset:8192
 ds_read_b64_tr_b16 a[38:39], v1 offset:9216
M a[12:15], a[120:123], a[160:163], a[12:15]
M a[16:19], a[128:131], a[160:163], a[16:19]
 buffer_load_dwordx4 v13, s[48:51], s22 offen offset:1024   lds
M a[16:19], a[132:135], a[164:167], a[16:19]
M a[20:23], a[140:143], a[164:167], a[20:23]
M a[20:23], a[136:139], a[160:163], a[20:23]
 ds_read_b64_tr_b16 a[40:41], v2 offset:0
 ds_read_b64_tr_b16 a[42:43], v2 offset:1024
M a[24:27], a[144:147], a[160:163], a[24:27]
M a[24:27], a[148:151], a[164:167], a[24:27]
 s_waitcnt lgkmcnt(6)
M a[28:31], a[156:159], a[164:167], a[28:31]
 buffer_load_dwordx4 v14, s[48:51], s22 offen offset:2048   lds
M a[28:31], a[152:155], a[160:163], a[28:31]
M v[60:63], a[152:155], a[168:171], v[60:63]
 ds_read_b128 a[160:163], v5 offset:36864
 ds_read_b128 a[164:167], v6 offset:36864
M v[60:63], a[156:159], a[172:175], v[60:63]
 ds_read_b64_tr_b16 a[44:45], v2 offset:8192
 ds_read_b64_tr_b16 a[46:47], v2 offset:9216
M v[56:59], a[148:151], a[172:175], v[56:59]
 buffer_load_dwordx4 v15, s[48:51], s22 offen offset:3072   lds
M v[56:59], a[144:147], a[168:171], v[56:59]
 s_sub_u32 s22, s22, 2097024
M v[52:55], a[136:139], a[168:171], v[52:55]
M v[52:55], a[140:143], a[172:175], v[52:55]
 ds_read_b64_tr_b16 a[48:49], v3 offset:0
 ds_read_b64_tr_b16 a[50:51], v3 offset:1024
M v[48:51], a[132:135], a[172:175], v[48:51]
 s_add_u32 m0, s23, 49152
M v[48:51], a[128:131], a[168:171], v[48:51]
 buffer_load_dwordx4 v8, s[16:19], s21 offen offset:0  nt lds
M v[44:47], a[120:123], a[168:171], v[44:47]
M v[44:47], a[124:127], a[172:175], v[44:47]
M v[40:43], a[116:119], a[172:175], v[40:43]
 ds_read_b64_tr_b16 a[52:53], v3 offset:8192
 ds_read_b64_tr_b16 a[54:55], v3 offset:9216
M v[40:43], a[112:115], a[168:171], v[40:43]
M v[36:39], a[104:107], a[168:171], v[36:39]
 buffer_load_dwordx4 v9, s[16:19], s21 offen offset:1024  nt lds
M v[36:39], a[108:111], a[172:175], v[36:39]
 s_waitcnt lgkmcnt(6)
M v[32:35], a[100:103], a[172:175], v[32:35]
M v[32:35], a[96:99], a[168:171], v[32:35]
 ds_read_b64_tr_b16 a[56:57], v4 offset:0
 ds_read_b64_tr_b16 a[58:59], v4 offset:1024
M v[64:67], a[96:99], a[160:163], v[64:67]
 ds_read_b128 a[168:171], v5 offset:38912
 ds_read_b128 a[172:175], v6 offset:38912
M v[64:67], a[100:103], a[164:167], v[64:67]
 buffer_load_dwordx4 v10, s[16:19], s21 offen offset:2048  nt lds
M v[68:71], a[108:111], a[164:167], v[68:71]
M v[68:71], a[104:107], a[160:163], v[68:71]
M v[72:75], a[112:115], a[160:163], v[72:75]
 ds_read_b64_tr_b16 a[60:61], v4 offset:8192
 ds_read_b64_tr_b16 a[62:63], v4 offset:9216
M v[72:75], a[116:119], a[164:167], v[72:75]
M v[76:79], a[124:127], a[164:167], v[76:79]
 buffer_load_dwordx4 v11, s[16:19], s21 offen offset:3072  nt lds
M v[76:79], a[120:123], a[160:163], v[76:79]
 s_add_u32 s21, s21, 524160
M v[80:83], a[128:131], a[160:163], v[80:83]
M v[80:83], a[132:135], a[164:167], v[80:83]
M v[84:87], a[140:143], a[164:167], v[84:87]
M v[84:87], a[136:139], a[160:163], v[84:87]
 s_and_b32 s64, s42, 7
M v[88:91], a[144:147], a[160:163], v[88:91]
 s_lshl_b32 s72, s41, 3
 s_add_u32 s64, s64, s72
 s_lshl_b32 s64, s64, 2
M v[88:91], a[148:151], a[164:167], v[88:91]
 s_waitcnt lgkmcnt(2)
 s_add_u32 s64, s64, s20
 s_mul_i32 s67, s64, 7168
M v[92:95], a[156:159], a[164:167], v[92:95]
 s_waitcnt vmcnt(17) lgkmcnt(0)
 s_mul_i32 s86, s20, 7168
 s_add_u32 s86, s86, 131072
M v[92:95], a[152:155], a[160:163], v[92:95]
 s_barrier
M v[124:127], a[152:155], a[168:171], v[124:127]
 ds_read_b128 a[160:163], v5 offset:49152
 ds_read_b128 a[164:167], v6 offset:49152
M v[124:127], a[156:159], a[172:175], v[124:127]
M v[120:123], a[148:151], a[172:175], v[120:123]
 s_add_u32 m0, s24, 32768
 ds_read_b64_tr_b16 a[64:65], v1 offset:16384
 ds_read_b64_tr_b16 a[66:67], v1 offset:17408
M v[120:123], a[144:147], a[168:171], v[120:123]
 buffer_load_dwordx4 v12, s[48:51], s22 offen offset:0   lds
M v[116:119], a[136:139], a[168:171], v[116:119]
M v[116:119], a[140:143], a[172:175], v[116:119]
M v[112:115], a[132:135], a[172:175], v[112:115]
M v[112:115], a[128:131], a[168:171], v[112:115]
 buffer_load_dwordx4 v13, s[48:51], s22 offen offset:1024   lds
M v[108:111], a[120:123], a[168:171], v[108:111]
M v[108:111], a[124:127], a[172:175], v[108:111]
 ds_read_b64_tr_b16 a[68:69], v1 offset:24576
 ds_read_b64_tr_b16 a[70:71], v1 offset:25600
M v[104:107], a[116:119], a[172:175], v[104:107]
M v[104:107], a[112:115], a[168:171], v[104:107]
M v[100:103], a[104:107], a[168:171], v[100:103]
 buffer_load_dwordx4 v14, s[48:51], s22 offen offset:2048   lds
M v[100:103], a[108:111], a[172:175], v[100:103]
 s_waitcnt lgkmcnt(4)
M v[96:99], a[100:103], a[172:175], v[96:99]
M v[96:99], a[96:99], a[168:171], v[96:99]
M v[128:131], a[96:99], a[160:163], v[128:131]
 ds_read_b128 a[168:171], v5 offset:51200
 ds_read_b128 a[172:175], v6 offset:51200
M v[128:131], a[100:103], a[164:167], v[128:131]
 ds_read_b64_tr_b16 a[72:73], v2 offset:16384
 ds_read_b64_tr_b16 a[74:75], v2 offset:17408
M v[132:135], a[108:111], a[164:167], v[132:135]
 buffer_load_dwordx4 v15, s[48:51], s22 offen offset:3072   lds
M v[132:135], a[104:107], a[160:163], v[132:135]
 s_add_u32 s22, s22, 2097152
M v[136:139], a[112:115], a[160:163], v[136:139]
M v[136:139], a[116:119], a[164:167], v[136:139]
 s_add_u32 m0, s23, 0
M v[140:143], a[124:127], a[164:167], v[140:143]
 buffer_load_dwordx4 v8, s[16:19], s21 offen offset:0  nt lds
M v[140:143], a[120:123], a[160:163], v[140:143]
 ds_read_b64_tr_b16 a[76:77], v2 offset:24576
 ds_read_b64_tr_b16 a[78:79], v2 offset:25600
M v[144:147], a[128:131], a[160:163], v[144:147]
M v[144:147], a[132:135], a[164:167], v[144:147]
M v[148:151], a[140:143], a[164:167], v[148:151]
 buffer_load_dwordx4 v9, s[16:19], s21 offen offset:1024  nt lds
M v[148:151], a[136:139], a[160:163], v[148:151]
M v[152:155], a[144:147], a[160:163], v[152:155]
M v[152:155], a[148:151], a[164:167], v[152:155]
 s_waitcnt lgkmcnt(4)
M v[156:159], a[156:159], a[164:167], v[156:159]
 ds_read_b64_tr_b16 a[80:81], v3 offset:16384
 ds_read_b64_tr_b16 a[82:83], v3 offset:17408
M v[156:159], a[152:155], a[160:163], v[156:159]
 buffer_load_dwordx4 v10, s[16:19], s21 offen offset:2048  nt lds
M v[188:191], a[152:155], a[168:171], v[188:191]
 ds_read_b128 a[160:163], v5 offset:53248
 ds_read_b128 a[164:167], v6 offset:53248
M v[188:191], a[156:159], a[172:175], v[188:191]
M v[184:187], a[148:151], a[172:175], v[184:187]
M v[184:187], a[144:147], a[168:171], v[184:187]
M v[180:183], a[136:139], a[168:171], v[180:183]
 buffer_load_dwordx4 v11, s[16:19], s21 offen offset:3072  nt lds
M v[180:183], a[140:143], a[172:175], v[180:183]
 s_add_u32 s21, s21, 128
 ds_read_b64_tr_b16 a[84:85], v3 offset:24576
 ds_read_b64_tr_b16 a[86:87], v3 offset:25600
M v[176:179], a[132:135], a[172:175], v[176:179]
M v[176:179], a[128:131], a[168:171], v[176:179]
M v[172:175], a[120:123], a[168:171], v[172:175]
 s_add_u32 m0, s86, 0
M v[172:175], a[124:127], a[172:175], v[172:175]
 buffer_load_dwordx4 v7, s[60:63], s67 offen offset:0 nt lds
M v[168:171], a[116:119], a[172:175], v[168:171]
M v[168:171], a[112:115], a[168:171], v[168:171]
M v[164:167], a[104:107], a[168:171], v[164:167]
 ds_read_b64_tr_b16 a[88:89], v4 offset:16384
 ds_read_b64_tr_b16 a[90:91], v4 offset:17408
M v[164:167], a[108:111], a[172:175], v[164:167]
 s_waitcnt lgkmcnt(4)
M v[160:163], a[100:103], a[172:175], v[160:163]
 buffer_load_dwordx4 v7, s[60:63], s67 offen offset:1024 nt lds
M v[160:163], a[96:99], a[168:171], v[160:163]
M v[192:195], a[96:99], a[160:163], v[192:195]
 ds_read_b128 a[168:171], v5 offset:55296
 ds_read_b128 a[172:175], v6 offset:55296
M v[192:195], a[100:103], a[164:167], v[192:195]
M v[196:199], a[108:111], a[164:167], v[196:199]
 buffer_load_dwordx4 v7, s[60:63], s67 offen offset:2048 nt lds
M v[196:199], a[104:107], a[160:163], v[196:199]
 ds_read_b64_tr_b16 a[92:93], v4 offset:24576
 ds_read_b64_tr_b16 a[94:95], v4 offset:25600
M v[200:203], a[112:115], a[160:163], v[200:203]
M v[200:203], a[116:119], a[164:167], v[200:203]
M v[204:207], a[124:127], a[164:167], v[204:207]
M v[204:207], a[120:123], a[160:163], v[204:207]
 buffer_load_dwordx4 v7, s[60:63], s67 offen offset:3072 nt lds
M v[208:211], a[128:131], a[160:163], v[208:211]
 s_add_u32 s67, s67, 4096
M v[208:211], a[132:135], a[164:167], v[208:211]
M v[212:215], a[140:143], a[164:167], v[212:215]
M v[212:215], a[136:139], a[160:163], v[212:215]
M v[216:219], a[144:147], a[160:163], v[216:219]
M v[216:219], a[148:151], a[164:167], v[216:219]
 s_waitcnt lgkmcnt(2)
M v[220:223], a[156:159], a[164:167], v[220:223]
 s_waitcnt vmcnt(21) lgkmcnt(0)
M v[220:223], a[152:155], a[160:163], v[220:223]
 s_barrier
M v[252:255], a[152:155], a[168:171], v[252:255]
 ds_read_b128 a[160:163], v5 offset:0
 ds_read_b128 a[164:167], v6 offset:0
M v[252:255], a[156:159], a[172:175], v[252:255]
M v[248:251], a[148:151], a[172:175], v[248:251]
M v[248:251], a[144:147], a[168:171], v[248:251]
M v[244:247], a[136:139], a[168:171], v[244:247]
M v[244:247], a[140:143], a[172:175], v[244:247]
M v[240:243], a[132:135], a[172:175], v[240:243]
M v[240:243], a[128:131], a[168:171], v[240:243]
M v[236:239], a[120:123], a[168:171], v[236:239]
M v[236:239], a[124:127], a[172:175], v[236:239]
M v[232:235], a[116:119], a[172:175], v[232:235]
M v[232:235], a[112:115], a[168:171], v[232:235]
M v[228:231], a[104:107], a[168:171], v[228:231]
M v[228:231], a[108:111], a[172:175], v[228:231]
 s_waitcnt lgkmcnt(0)
M v[224:227], a[100:103], a[172:175], v[224:227]
M v[224:227], a[96:99], a[168:171], v[224:227]
M a[0:3], a[32:35], a[160:163], a[0:3]
 ds_read_b128 a[168:171], v5 offset:2048
 ds_read_b128 a[172:175], v6 offset:2048
M a[0:3], a[36:39], a[164:167], a[0:3]
 ds_read_b64_tr_b16 a[96:97], v1 offset:32768
 ds_read_b64_tr_b16 a[98:99], v1 offset:33792
M a[4:7], a[44:47], a[164:167], a[4:7]
 s_add_u32 m0, s24, 49152
M a[4:7], a[40:43], a[160:163], a[4:7]
 buffer_load_dwordx4 v12, s[48:51], s22 offen offset:0   lds
M a[8:11], a[48:51], a[160:163], a[8:11]
M a[8:11], a[52:55], a[164:167], a[8:11]
M a[12:15], a[60:63], a[164:167], a[12:15]
 ds_read_b64_tr_b16 a[100:101], v1 offset:40960
 ds_read_b64_tr_b16 a[102:103], v1 offset:41984
M a[12:15], a[56:59], a[160:163], a[12:15]
M a[16:19], a[64:67], a[160:163], a[16:19]
 buffer_load_dwordx4 v13, s[48:51], s22 offen offset:1024   lds
M a[16:19], a[68:71], a[164:167], a[16:19]
M a[20:23], a[76:79], a[164:167], a[20:23]
M a[20:23], a[72:75], a[160:163], a[20:23]
 ds_read_b64_tr_b16 a[104:105], v2 offset:32768
 ds_read_b64_tr_b16 a[106:107], v2 offset:33792
M a[24:27], a[80:83], a[160:163], a[24:27]
M a[24:27], a[84:87], a[164:167], a[24:27]
 s_waitcnt lgkmcnt(6)
M a[28:31], a[92:95], a[164:167], a[28:31]
 buffer_load_dwordx4 v14, s[48:51], s22 offen offset:2048   lds
M a[28:31], a[88:91], a[160:163], a[28:31]
M v[60:63], a[88:91], a[168:171], v[60:63]
 ds_read_b128 a[160:163], v5 offset:4096
 ds_read_b128 a[164:167], v6 offset:4096
M v[60:63], a[92:95], a[172:175], v[60:63]
 ds_read_b64_tr_b16 a[108:109], v2 offset:40960
 ds_read_b64_tr_b16 a[110:111], v2 offset:41984
M v[56:59], a[84:87], a[172:175], v[56:59]
 buffer_load_dwordx4 v15, s[48:51], s22 offen offset:3072   lds
M v[56:59], a[80:83], a[168:171], v[56:59]
 s_sub_u32 s22, s22, 2097024
M v[52:55], a[72:75], a[168:171], v[52:55]
M v[52:55], a[76:79], a[172:175], v[52:55]
 ds_read_b64_tr_b16 a[112:113], v3 offset:32768
 ds_read_b64_tr_b16 a[114:115], v3 offset:33792
M v[48:51], a[68:71], a[172:175], v[48:51]
 s_add_u32 m0, s23, 16384
M v[48:51], a[64:67], a[168:171], v[48:51]
 buffer_load_dwordx4 v8, s[16:19], s21 offen offset:0  nt lds
M v[44:47], a[56:59], a[168:171], v[44:47]
M v[44:47], a[60:63], a[172:175], v[44:47]
M v[40:43], a[52:55], a[172:175], v[40:43]
 ds_read_b64_tr_b16 a[116:117], v3 offset:40960
 ds_read_b64_tr_b16 a[118:119], v3 offset:41984
M v[40:43], a[48:51], a[168:171], v[40:43]
M v[36:39], a[40:43], a[168:171], v[36:39]
 buffer_load_dwordx4 v9, s[16:19], s21 offen offset:1024  nt lds
M v[36:39], a[44:47], a[172:175], v[36:39]
 s_waitcnt lgkmcnt(6)
M v[32:35], a[36:39], a[172:175], v[32:35]
M v[32:35], a[32:35], a[168:171], v[32:35]
 ds_read_b64_tr_b16 a[120:121], v4 offset:32768
 ds_read_b64_tr_b16 a[122:123], v4 offset:33792
M v[64:67], a[32:35], a[160:163], v[64:67]
 ds_read_b128 a[168:171], v5 offset:6144
 ds_read_b128 a[172:175], v6 offset:6144
M v[64:67], a[36:39], a[164:167], v[64:67]
 buffer_load_dwordx4 v10, s[16:19], s21 offen offset:2048  nt lds
M v[68:71], a[44:47], a[164:167], v[68:71]
M v[68:71], a[40:43], a[160:163], v[68:71]
M v[72:75], a[48:51], a[160:163], v[72:75]
 ds_read_b64_tr_b16 a[124:125], v4 offset:40960
 ds_read_b64_tr_b16 a[126:127], v4 offset:41984
M v[72:75], a[52:55], a[164:167], v[72:75]
M v[76:79], a[60:63], a[164:167], v[76:79]
 buffer_load_dwordx4 v11, s[16:19], s21 offen offset:3072  nt lds
M v[76:79], a[56:59], a[160:163], v[76:79]
 s_add_u32 s21, s21, 524160
M v[80:83], a[64:67], a[160:163], v[80:83]
M v[80:83], a[68:71], a[164:167], v[80:83]
M v[84:87], a[76:79], a[164:167], v[84:87]
M v[84:87], a[72:75], a[160:163], v[84:87]
M v[88:91], a[80:83], a[160:163], v[88:91]
M v[88:91], a[84:87], a[164:167], v[88:91]
 s_waitcnt lgkmcnt(2)
M v[92:95], a[92:95], a[164:167], v[92:95]
 s_waitcnt vmcnt(20) lgkmcnt(0)
M v[92:95], a[88:91], a[160:163], v[92:95]
 s_barrier
M v[124:127], a[88:91], a[168:171], v[124:127]
 ds_read_b128 a[160:163], v5 offset:16384
 ds_read_b128 a[164:167], v6 offset:16384
M v[124:127], a[92:95], a[172:175], v[124:127]
M v[120:123], a[84:87], a[172:175], v[120:123]
 s_add_u32 m0, s24, 0
 ds_read_b64_tr_b16 a[128:129], v1 offset:49152
 ds_read_b64_tr_b16 a[130:131], v1 offset:50176
M v[120:123], a[80:83], a[168:171], v[120:123]
 buffer_load_dwordx4 v12, s[48:51], s22 offen offset:0   lds
M v[116:119], a[72:75], a[168:171], v[116:119]
M v[116:119], a[76:79], a[172:175], v[116:119]
M v[112:115], a[68:71], a[172:175], v[112:115]
M v[112:115], a[64:67], a[168:171], v[112:115]
M v[108:111], a[56:59], a[168:171], v[108:111]
 buffer_load_dwordx4 v13, s[48:51], s22 offen offset:1024   lds
M v[108:111], a[60:63], a[172:175], v[108:111]
 ds_read_b64_tr_b16 a[132:133], v1 offset:57344
 ds_read_b64_tr_b16 a[134:135], v1 offset:58368
M v[104:107], a[52:55], a[172:175], v[104:107]
M v[104:107], a[48:51], a[168:171], v[104:107]
M v[100:103], a[40:43], a[168:171], v[100:103]
M v[100:103], a[44:47], a[172:175], v[100:103]
 s_waitcnt lgkmcnt(4)
M v[96:99], a[36:39], a[172:175], v[96:99]
 buffer_load_dwordx4 v14, s[48:51], s22 offen offset:2048   lds
M v[96:99], a[32:35], a[168:171], v[96:99]
M v[128:131], a[32:35], a[160:163], v[128:131]
 ds_read_b128 a[168:171], v5 offset:18432
 ds_read_b128 a[172:175], v6 offset:18432
M v[128:131], a[36:39], a[164:167], v[128:131]
 ds_read_b64_tr_b16 a[136:137], v2 offset:49152
 ds_read_b64_tr_b16 a[138:139], v2 offset:50176
M v[132:135], a[44:47], a[164:167], v[132:135]
 buffer_load_dwordx4 v15, s[48:51], s22 offen offset:3072   lds
M v[132:135], a[40:43], a[160:163], v[132:135]
 s_add_u32 s22, s22, 2097152
M v[136:139], a[48:51], a[160:163], v[136:139]
M v[136:139], a[52:55], a[164:167], v[136:139]
M v[140:143], a[60:63], a[164:167], v[140:143]
 s_add_u32 m0, s23, 32768
M v[140:143], a[56:59], a[160:163], v[140:143]
 ds_read_b64_tr_b16 a[140:141], v2 offset:57344
 ds_read_b64_tr_b16 a[142:143], v2 offset:58368
M v[144:147], a[64:67], a[160:163], v[144:147]
 buffer_load_dwordx4 v8, s[16:19], s21 offen offset:0  nt lds
M v[144:147], a[68:71], a[164:167], v[144:147]
M v[148:151], a[76:79], a[164:167], v[148:151]
M v[148:151], a[72:75], a[160:163], v[148:151]
M v[152:155], a[80:83], a[160:163], v[152:155]
 buffer_load_dwordx4 v9, s[16:19], s21 offen offset:1024  nt lds
M v[152:155], a[84:87], a[164:167], v[152:155]
 s_waitcnt lgkmcnt(4)
M v[156:159], a[92:95], a[164:167], v[156:159]
 ds_read_b64_tr_b16 a[144:145], v3 offset:49152
 ds_read_b64_tr_b16 a[146:147], v3 offset:50176
M v[156:159], a[88:91], a[160:163], v[156:159]
M v[188:191], a[88:91], a[168:171], v[188:191]
 ds_read_b128 a[160:163], v5 offset:20480
 ds_read_b128 a[164:167], v6 offset:20480
M v[188:191], a[92:95], a[172:175], v[188:191]
M v[184:187], a[84:87], a[172:175], v[184:187]
 buffer_load_dwordx4 v10, s[16:19], s21 offen offset:2048  nt lds
M v[184:187], a[80:83], a[168:171], v[184:187]
M v[180:183], a[72:75], a[168:171], v[180:183]
M v[180:183], a[76:79], a[172:175], v[180:183]
 ds_read_b64_tr_b16 a[148:149], v3 offset:57344
 ds_read_b64_tr_b16 a[150:151], v3 offset:58368
M v[176:179], a[68:71], a[172:175], v[176:179]
M v[176:179], a[64:67], a[168:171], v[176:179]
 buffer_load_dwordx4 v11, s[16:19], s21 offen offset:3072  nt lds
M v[172:175], a[56:59], a[168:171], v[172:175]
 s_add_u32 s21, s21, 128
M v[172:175], a[60:63], a[172:175], v[172:175]
M v[168:171], a[52:55], a[172:175], v[168:171]
M v[168:171], a[48:51], a[168:171], v[168:171]
 s_add_u32 m0, s86, 4096
M v[164:167], a[40:43], a[168:171], v[164:167]
 ds_read_b64_tr_b16 a[152:153], v4 offset:49152
 ds_read_b64_tr_b16 a[154:155], v4 offset:50176
M v[164:167], a[44:47], a[172:175], v[164:167]
 s_waitcnt lgkmcnt(4)
M v[160:163], a[36:39], a[172:175], v[160:163]
 buffer_load_dwordx4 v7, s[60:63], s67 offen offset:0 nt lds
M v[160:163], a[32:35], a[168:171], v[160:163]
M v[192:195], a[32:35], a[160:163], v[192:195]
 ds_read_b128 a[168:171], v5 offset:22528
 ds_read_b128 a[172:175], v6 offset:22528
M v[192:195], a[36:39], a[164:167], v[192:195]
 buffer_load_dwordx4 v7, s[60:63], s67 offen offset:1024 nt lds
M v[196:199], a[44:47], a[164:167], v[196:199]
M v[196:199], a[40:43], a[160:163], v[196:199]
 ds_read_b64_tr_b16 a[156:157], v4 offset:57344
 ds_read_b64_tr_b16 a[158:159], v4 offset:58368
M v[200:203], a[48:51], a[160:163], v[200:203]
M v[200:203], a[52:55], a[164:167], v[200:203]
M v[204:207], a[60:63], a[164:167], v[204:207]
 buffer_load_dwordx4 v7, s[60:63], s67 offen offset:2048 nt lds
M v[204:207], a[56:59], a[160:163], v[204:207]
 s_add_u32 s67, s67, 4096
M v[208:211], a[64:67], a[160:163], v[208:211]
M v[208:211], a[68:71], a[164:167], v[208:211]
M v[212:215], a[76:79], a[164:167], v[212:215]
M v[212:215], a[72:75], a[160:163], v[212:215]
M v[216:219], a[80:83], a[160:163], v[216:219]
M v[216:219], a[84:87], a[164:167], v[216:219]
 s_waitcnt lgkmcnt(2)
M v[220:223], a[92:95], a[164:167], v[220:223]
 s_waitcnt vmcnt(23) lgkmcnt(0)
M v[220:223], a[88:91], a[160:163], v[220:223]
 s_barrier
M v[252:255], a[88:91], a[168:171], v[252:255]
 ds_read_b128 a[160:163], v5 offset:32768
 ds_read_b128 a[164:167], v6 offset:32768
M v[252:255], a[92:95], a[172:175], v[252:255]
 v_and_b32 v26, 48, v0
 v_lshlrev_b32 v26, 17, v26
M v[248:251], a[84:87], a[172:175], v[248:251]
 v_or_b32 v26, v26, v0
 v_lshl_add_u32 v26, v26, 7, s95
M v[248:251], a[80:83], a[168:171], v[248:251]
 buffer_load_dword a240, v26, s[76:79], 0 offen offset:0
M v[244:247], a[72:75], a[168:171], v[244:247]
M v[244:247], a[76:79], a[172:175], v[244:247]
M v[240:243], a[68:71], a[172:175], v[240:243]
M v[240:243], a[64:67], a[168:171], v[240:243]
M v[236:239], a[56:59], a[168:171], v[236:239]
M v[236:239], a[60:63], a[172:175], v[236:239]
M v[232:235], a[52:55], a[172:175], v[232:235]
M v[232:235], a[48:51], a[168:171], v[232:235]
M v[228:231], a[40:43], a[168:171], v[228:231]
M v[228:231], a[44:47], a[172:175], v[228:231]
 s_waitcnt lgkmcnt(0)
M v[224:227], a[36:39], a[172:175], v[224:227]
M v[224:227], a[32:35], a[168:171], v[224:227]
M a[0:3], a[96:99], a[160:163], a[0:3]
 ds_read_b128 a[168:171], v5 offset:34816
 ds_read_b128 a[172:175], v6 offset:34816
M a[0:3], a[100:103], a[164:167], a[0:3]
 ds_read_b64_tr_b16 a[32:33], v1 offset:0
 ds_read_b64_tr_b16 a[34:35], v1 offset:1024
M a[4:7], a[108:111], a[164:167], a[4:7]
 s_add_u32 m0, s24, 16384
M a[4:7], a[104:107], a[160:163], a[4:7]
 buffer_load_dwordx4 v12, s[48:51], s22 offen offset:0   lds
M a[8:11], a[112:115], a[160:163], a[8:11]
M a[8:11], a[116:119], a[164:167], a[8:11]
M a[12:15], a[124:127], a[164:167], a[12:15]
 ds_read_b64_tr_b16 a[36:37], v1 offset:8192
 ds_read_b64_tr_b16 a[38:39], v1 offset:9216
M a[12:15], a[120:123], a[160:163], a[12:15]
M a[16:19], a[128:131], a[160:163], a[16:19]
 buffer_load_dwordx4 v13, s[48:51], s22 offen offset:1024   lds
M a[16:19], a[132:135], a[164:167], a[16:19]
M a[20:23], a[140:143], a[164:167], a[20:23]
M a[20:23], a[136:139], a[160:163], a[20:23]
 ds_read_b64_tr_b16 a[40:41], v2 offset:0
 ds_read_b64_tr_b16 a[42:43], v2 offset:1024
M a[24:27], a[144:147], a[160:163], a[24:27]
M a[24:27], a[148:151], a[164:167], a[24:27]
 s_waitcnt lgkmcnt(6)
M a[28:31], a[156:159], a[164:167], a[28:31]
 buffer_load_dwordx4 v14, s[48:51], s22 offen offset:2048   lds
M a[28:31], a[152:155], a[160:163], a[28:31]
M v[60:63], a[152:155], a[168:171], v[60:63]
 ds_read_b128 a[160:163], v5 offset:36864
 ds_read_b128 a[164:167], v6 offset:36864
M v[60:63], a[156:159], a[172:175], v[60:63]
 ds_read_b64_tr_b16 a[44:45], v2 offset:8192
 ds_read_b64_tr_b16 a[46:47], v2 offset:9216
M v[56:59], a[148:151], a[172:175], v[56:59]
 buffer_load_dwordx4 v15, s[48:51], s22 offen offset:3072   lds
M v[56:59], a[144:147], a[168:171], v[56:59]
 s_sub_u32 s22, s22, 2097024
M v[52:55], a[136:139], a[168:171], v[52:55]
M v[52:55], a[140:143], a[172:175], v[52:55]
 ds_read_b64_tr_b16 a[48:49], v3 offset:0
 ds_read_b64_tr_b16 a[50:51], v3 offset:1024
M v[48:51], a[132:135], a[172:175], v[48:51]
 s_add_u32 m0, s23, 49152
M v[48:51], a[128:131], a[168:171], v[48:51]
 buffer_load_dwordx4 v8, s[16:19], s21 offen offset:0  nt lds
M v[44:47], a[120:123], a[168:171], v[44:47]
M v[44:47], a[124:127], a[172:175], v[44:47]
M v[40:43], a[116:119], a[172:175], v[40:43]
 ds_read_b64_tr_b16 a[52:53], v3 offset:8192
 ds_read_b64_tr_b16 a[54:55], v3 offset:9216
M v[40:43], a[112:115], a[168:171], v[40:43]
M v[36:39], a[104:107], a[168:171], v[36:39]
 buffer_load_dwordx4 v9, s[16:19], s21 offen offset:1024  nt lds
M v[36:39], a[108:111], a[172:175], v[36:39]
 s_waitcnt lgkmcnt(6)
M v[32:35], a[100:103], a[172:175], v[32:35]
M v[32:35], a[96:99], a[168:171], v[32:35]
 ds_read_b64_tr_b16 a[56:57], v4 offset:0
 ds_read_b64_tr_b16 a[58:59], v4 offset:1024
M v[64:67], a[96:99], a[160:163], v[64:67]
 ds_read_b128 a[168:171], v5 offset:38912
 ds_read_b128 a[172:175], v6 offset:38912
M v[64:67], a[100:103], a[164:167], v[64:67]
 buffer_load_dwordx4 v10, s[16:19], s21 offen offset:2048  nt lds
M v[68:71], a[108:111], a[164:167], v[68:71]
M v[68:71], a[104:107], a[160:163], v[68:71]
M v[72:75], a[112:115], a[160:163], v[72:75]
 ds_read_b64_tr_b16 a[60:61], v4 offset:8192
 ds_read_b64_tr_b16 a[62:63], v4 offset:9216
M v[72:75], a[116:119], a[164:167], v[72:75]
M v[76:79], a[124:127], a[164:167], v[76:79]
 buffer_load_dwordx4 v11, s[16:19], s21 offen offset:3072  nt lds
M v[76:79], a[120:123], a[160:163], v[76:79]
 s_add_u32 s21, s21, 524160
M v[80:83], a[128:131], a[160:163], v[80:83]
M v[80:83], a[132:135], a[164:167], v[80:83]
M v[84:87], a[140:143], a[164:167], v[84:87]
M v[84:87], a[136:139], a[160:163], v[84:87]
M v[88:91], a[144:147], a[160:163], v[88:91]
M v[88:91], a[148:151], a[164:167], v[88:91]
 s_waitcnt lgkmcnt(2)
M v[92:95], a[156:159], a[164:167], v[92:95]
 s_waitcnt vmcnt(20) lgkmcnt(0)
M v[92:95], a[152:155], a[160:163], v[92:95]
 s_barrier
M v[124:127], a[152:155], a[168:171], v[124:127]
 ds_read_b128 a[160:163], v5 offset:49152
 ds_read_b128 a[164:167], v6 offset:49152
M v[124:127], a[156:159], a[172:175], v[124:127]
M v[120:123], a[148:151], a[172:175], v[120:123]
 s_add_u32 m0, s24, 32768
 ds_read_b64_tr_b16 a[64:65], v1 offset:16384
 ds_read_b64_tr_b16 a[66:67], v1 offset:17408
M v[120:123], a[144:147], a[168:171], v[120:123]
 buffer_load_dwordx4 v12, s[48:51], s22 offen offset:0   lds
M v[116:119], a[136:139], a[168:171], v[116:119]
M v[116:119], a[140:143], a[172:175], v[116:119]
M v[112:115], a[132:135], a[172:175], v[112:115]
M v[112:115], a[128:131], a[168:171], v[112:115]
M v[108:111], a[120:123], a[168:171], v[108:111]
M v[108:111], a[124:127], a[172:175], v[108:111]
 ds_read_b64_tr_b16 a[68:69], v1 offset:24576
 ds_read_b64_tr_b16 a[70:71], v1 offset:25600
M v[104:107], a[116:119], a[172:175], v[104:107]
 buffer_load_dwordx4 v13, s[48:51], s22 offen offset:1024   lds
M v[104:107], a[112:115], a[168:171], v[104:107]
M v[100:103], a[104:107], a[168:171], v[100:103]
M v[100:103], a[108:111], a[172:175], v[100:103]
 s_waitcnt lgkmcnt(4)
M v[96:99], a[100:103], a[172:175], v[96:99]
M v[96:99], a[96:99], a[168:171], v[96:99]
M v[128:131], a[96:99], a[160:163], v[128:131]
 ds_read_b128 a[168:171], v5 offset:51200
 ds_read_b128 a[172:175], v6 offset:51200
M v[128:131], a[100:103], a[164:167], v[128:131]
 ds_read_b64_tr_b16 a[72:73], v2 offset:16384
 ds_read_b64_tr_b16 a[74:75], v2 offset:17408
M v[132:135], a[108:111], a[164:167], v[132:135]
 buffer_load_dwordx4 v14, s[48:51], s22 offen offset:2048   lds
M v[132:135], a[104:107], a[160:163], v[132:135]
M v[136:139], a[112:115], a[160:163], v[136:139]
M v[136:139], a[116:119], a[164:167], v[136:139]
M v[140:143], a[124:127], a[164:167], v[140:143]
M v[140:143], a[120:123], a[160:163], v[140:143]
 ds_read_b64_tr_b16 a[76:77], v2 offset:24576
 ds_read_b64_tr_b16 a[78:79], v2 offset:25600
M v[144:147], a[128:131], a[160:163], v[144:147]
 buffer_load_dwordx4 v15, s[48:51], s22 offen offset:3072   lds
M v[144:147], a[132:135], a[164:167], v[144:147]
 s_add_u32 s22, s22, 2097152
M v[148:151], a[140:143], a[164:167], v[148:151]
M v[148:151], a[136:139], a[160:163], v[148:151]
M v[152:155], a[144:147], a[160:163], v[152:155]
M v[152:155], a[148:151], a[164:167], v[152:155]
 s_waitcnt lgkmcnt(4)
M v[156:159], a[156:159], a[164:167], v[156:159]
 s_add_u32 m0, s23, 0
 ds_read_b64_tr_b16 a[80:81], v3 offset:16384
 ds_read_b64_tr_b16 a[82:83], v3 offset:17408
M v[156:159], a[152:155], a[160:163], v[156:159]
 buffer_load_dwordx4 v8, s[16:19], s21 offen offset:0  nt lds
M v[188:191], a[152:155], a[168:171], v[188:191]
 ds_read_b128 a[160:163], v5 offset:53248
 ds_read_b128 a[164:167], v6 offset:53248
M v[188:191], a[156:159], a[172:175], v[188:191]
M v[184:187], a[148:151], a[172:175], v[184:187]
M v[184:187], a[144:147], a[168:171], v[184:187]
M v[180:183], a[136:139], a[168:171], v[180:183]
M v[180:183], a[140:143], a[172:175], v[180:183]
 ds_read_b64_tr_b16 a[84:85], v3 offset:24576
 ds_read_b64_tr_b16 a[86:87], v3 offset:25600
M v[176:179], a[132:135], a[172:175], v[176:179]
 buffer_load_dwordx4 v9, s[16:19], s21 offen offset:1024  nt lds
M v[176:179], a[128:131], a[168:171], v[176:179]
M v[172:175], a[120:123], a[168:171], v[172:175]
M v[172:175], a[124:127], a[172:175], v[172:175]
M v[168:171], a[116:119], a[172:175], v[168:171]
M v[168:171], a[112:115], a[168:171], v[168:171]
M v[164:167], a[104:107], a[168:171], v[164:167]
 ds_read_b64_tr_b16 a[88:89], v4 offset:16384
 ds_read_b64_tr_b16 a[90:91], v4 offset:17408
M v[164:167], a[108:111], a[172:175], v[164:167]
 s_waitcnt lgkmcnt(4)
M v[160:163], a[100:103], a[172:175], v[160:163]
 buffer_load_dwordx4 v10, s[16:19], s21 offen offset:2048  nt lds
M v[160:163], a[96:99], a[168:171], v[160:163]
M v[192:195], a[96:99], a[160:163], v[192:195]
 ds_read_b128 a[168:171], v5 offset:55296
 ds_read_b128 a[172:175], v6 offset:55296
M v[192:195], a[100:103], a[164:167], v[192:195]
M v[196:199], a[108:111], a[164:167], v[196:199]
M v[196:199], a[104:107], a[160:163], v[196:199]
 ds_read_b64_tr_b16 a[92:93], v4 offset:24576
 ds_read_b64_tr_b16 a[94:95], v4 offset:25600
M v[200:203], a[112:115], a[160:163], v[200:203]
 buffer_load_dwordx4 v11, s[16:19], s21 offen offset:3072  nt lds
M v[200:203], a[116:119], a[164:167], v[200:203]
 s_add_u32 s21, s21, 128
M v[204:207], a[124:127], a[164:167], v[204:207]
M v[204:207], a[120:123], a[160:163], v[204:207]
M v[208:211], a[128:131], a[160:163], v[208:211]
M v[208:211], a[132:135], a[164:167], v[208:211]
M v[212:215], a[140:143], a[164:167], v[212:215]
M v[212:215], a[136:139], a[160:163], v[212:215]
M v[216:219], a[144:147], a[160:163], v[216:219]
M v[216:219], a[148:151], a[164:167], v[216:219]
 s_waitcnt lgkmcnt(2)
M v[220:223], a[156:159], a[164:167], v[220:223]
 s_waitcnt vmcnt(17) lgkmcnt(0)
M v[220:223], a[152:155], a[160:163], v[220:223]
 s_barrier
M v[252:255], a[152:155], a[168:171], v[252:255]
 ds_read_b128 a[160:163], v5 offset:0
 ds_read_b128 a[164:167], v6 offset:0
M v[252:255], a[156:159], a[172:175], v[252:255]
M v[248:251], a[148:151], a[172:175], v[248:251]
M v[248:251], a[144:147], a[168:171], v[248:251]
M v[244:247], a[136:139], a[168:171], v[244:247]
M v[244:247], a[140:143], a[172:175], v[244:247]
M v[240:243], a[132:135], a[172:175], v[240:243]
M v[240:243], a[128:131], a[168:171], v[240:243]
M v[236:239], a[120:123], a[168:171], v[236:239]
M v[236:239], a[124:127], a[172:175], v[236:239]
M v[232:235], a[116:119], a[172:175], v[232:235]
M v[232:235], a[112:115], a[168:171], v[232:235]
M v[228:231], a[104:107], a[168:171], v[228:231]
M v[228:231], a[108:111], a[172:175], v[228:231]
 s_waitcnt lgkmcnt(0)
M v[224:227], a[100:103], a[172:175], v[224:227]
M v[224:227], a[96:99], a[168:171], v[224:227]
M a[0:3], a[32:35], a[160:163], a[0:3]
 ds_read_b128 a[168:171], v5 offset:2048
 ds_read_b128 a[172:175], v6 offset:2048
M a[0:3], a[36:39], a[164:167], a[0:3]
 ds_read_b64_tr_b16 a[96:97], v1 offset:32768
 ds_read_b64_tr_b16 a[98:99], v1 offset:33792
M a[4:7], a[44:47], a[164:167], a[4:7]
 s_add_u32 m0, s24, 49152
 v_lshrrev_b32 v28, 2, v0
M a[4:7], a[40:43], a[160:163], a[4:7]
 buffer_load_dwordx4 v12, s[48:51], s22 offen offset:0   lds
M a[8:11], a[48:51], a[160:163], a[8:11]
 v_mul_u32_u24 v28, 896, v28
M a[8:11], a[52:55], a[164:167], a[8:11]
M a[12:15], a[60:63], a[164:167], a[12:15]
 ds_read_b64_tr_b16 a[100:101], v1 offset:40960
 ds_read_b64_tr_b16 a[102:103], v1 offset:41984
M a[12:15], a[56:59], a[160:163], a[12:15]
 v_and_b32 v29, 3, v0
M a[16:19], a[64:67], a[160:163], a[16:19]
 buffer_load_dwordx4 v13, s[48:51], s22 offen offset:1024   lds
M a[16:19], a[68:71], a[164:167], a[16:19]
 v_lshl_add_u32 v28, v29, 4, v28
M a[20:23], a[76:79], a[164:167], a[20:23]
M a[20:23], a[72:75], a[160:163], a[20:23]
 s_lshr_b32 s64, s20, 1
 ds_read_b64_tr_b16 a[104:105], v2 offset:32768
 ds_read_b64_tr_b16 a[106:107], v2 offset:33792
M a[24:27], a[80:83], a[160:163], a[24:27]
 s_lshl_b32 s64, s64, 6
 s_and_b32 s72, s20, 1
 s_lshl_b32 s72, s72, 3
M a[24:27], a[84:87], a[164:167], a[24:27]
 s_waitcnt lgkmcnt(6)
 s_add_u32 s64, s64, s72
 s_add_u32 s64, s64, 131072
M a[28:31], a[92:95], a[164:167], a[28:31]
 buffer_load_dwordx4 v14, s[48:51], s22 offen offset:2048   lds
M a[28:31], a[88:91], a[160:163], a[28:31]
 v_add_u32 v28, s64, v28
M v[60:63], a[88:91], a[168:171], v[60:63]
 ds_read_b128 a[160:163], v5 offset:4096
 ds_read_b128 a[164:167], v6 offset:4096
M v[60:63], a[92:95], a[172:175], v[60:63]
 s_lshl_b32 s94, s41, 18
 ds_read_b64_tr_b16 a[108:109], v2 offset:40960
 ds_read_b64_tr_b16 a[110:111], v2 offset:41984
M v[56:59], a[84:87], a[172:175], v[56:59]
 buffer_load_dwordx4 v15, s[48:51], s22 offen offset:3072   lds
M v[56:59], a[80:83], a[168:171], v[56:59]
 s_sub_u32 s22, s22, 2097024
 s_and_b32 s64, s42, 7
M v[52:55], a[72:75], a[168:171], v[52:55]
 s_lshl_b32 s64, s64, 10
M v[52:55], a[76:79], a[172:175], v[52:55]
 s_add_u32 s94, s94, s64
 ds_read_b64_tr_b16 a[112:113], v3 offset:32768
 ds_read_b64_tr_b16 a[114:115], v3 offset:33792
M v[48:51], a[68:71], a[172:175], v[48:51]
 s_add_u32 m0, s23, 16384
 s_lshl_b32 s64, s20, 13
 s_add_u32 s94, s94, s64
M v[48:51], a[64:67], a[168:171], v[48:51]
 buffer_load_dwordx4 v8, s[16:19], s21 offen offset:0  nt lds
M v[44:47], a[56:59], a[168:171], v[44:47]
 s_add_u32 s94, s94, 100663296
 ds_read_b64_tr_b16 a[192:193], v28 offset:0
M v[44:47], a[60:63], a[172:175], v[44:47]
M v[40:43], a[52:55], a[172:175], v[40:43]
 ds_read_b64_tr_b16 a[116:117], v3 offset:40960
 ds_read_b64_tr_b16 a[118:119], v3 offset:41984
M v[40:43], a[48:51], a[168:171], v[40:43]
 ds_read_b64_tr_b16 a[194:195], v28 offset:14336
M v[36:39], a[40:43], a[168:171], v[36:39]
 buffer_load_dwordx4 v9, s[16:19], s21 offen offset:1024  nt lds
M v[36:39], a[44:47], a[172:175], v[36:39]
 s_waitcnt lgkmcnt(8)
 ds_read_b64_tr_b16 a[196:197], v28 offset:128
M v[32:35], a[36:39], a[172:175], v[32:35]
M v[32:35], a[32:35], a[168:171], v[32:35]
 ds_read_b64_tr_b16 a[120:121], v4 offset:32768
 ds_read_b64_tr_b16 a[122:123], v4 offset:33792
M v[64:67], a[32:35], a[160:163], v[64:67]
 ds_read_b128 a[168:171], v5 offset:6144
 ds_read_b128 a[172:175], v6 offset:6144
M v[64:67], a[36:39], a[164:167], v[64:67]
 buffer_load_dwordx4 v10, s[16:19], s21 offen offset:2048  nt lds
M v[68:71], a[44:47], a[164:167], v[68:71]
 ds_read_b64_tr_b16 a[198:199], v28 offset:14464
M v[68:71], a[40:43], a[160:163], v[68:71]
M v[72:75], a[48:51], a[160:163], v[72:75]
 ds_read_b64_tr_b16 a[124:125], v4 offset:40960
 ds_read_b64_tr_b16 a[126:127], v4 offset:41984
M v[72:75], a[52:55], a[164:167], v[72:75]
 ds_read_b64_tr_b16 a[200:201], v28 offset:256
M v[76:79], a[60:63], a[164:167], v[76:79]
 buffer_load_dwordx4 v11, s[16:19], s21 offen offset:3072  nt lds
M v[76:79], a[56:59], a[160:163], v[76:79]
 s_add_u32 s21, s21, 524160
 ds_read_b64_tr_b16 a[202:203], v28 offset:14592
M v[80:83], a[64:67], a[160:163], v[80:83]
M v[80:83], a[68:71], a[164:167], v[80:83]
 ds_read_b64_tr_b16 a[204:205], v28 offset:384
M v[84:87], a[76:79], a[164:167], v[84:87]
M v[84:87], a[72:75], a[160:163], v[84:87]
 ds_read_b64_tr_b16 a[206:207], v28 offset:14720
M v[88:91], a[80:83], a[160:163], v[88:91]
M v[88:91], a[84:87], a[164:167], v[88:91]
 s_waitcnt lgkmcnt(7)
 ds_read_b64_tr_b16 a[208:209], v28 offset:512
M v[92:95], a[92:95], a[164:167], v[92:95]
 s_waitcnt vmcnt(16) lgkmcnt(0)
M v[92:95], a[88:91], a[160:163], v[92:95]
 s_barrier
M v[124:127], a[88:91], a[168:171], v[124:127]
 ds_read_b128 a[160:163], v5 offset:16384
 ds_read_b128 a[164:167], v6 offset:16384
M v[124:127], a[92:95], a[172:175], v[124:127]
 ds_read_b64_tr_b16 a[210:211], v28 offset:14848
M v[120:123], a[84:87], a[172:175], v[120:123]
 s_add_u32 m0, s24, 0
 ds_read_b64_tr_b16 a[128:129], v1 offset:49152
 ds_read_b64_tr_b16 a[130:131], v1 offset:50176
M v[120:123], a[80:83], a[168:171], v[120:123]
 buffer_load_dwordx4 v12, s[48:51], s22 offen offset:0   lds
M v[116:119], a[72:75], a[168:171], v[116:119]
 ds_read_b64_tr_b16 a[212:213], v28 offset:640
M v[116:119], a[76:79], a[172:175], v[116:119]
M v[112:115], a[68:71], a[172:175], v[112:115]
 ds_read_b64_tr_b16 a[214:215], v28 offset:14976
M v[112:115], a[64:67], a[168:171], v[112:115]
M v[108:111], a[56:59], a[168:171], v[108:111]
 ds_read_b64_tr_b16 a[216:217], v28 offset:768
M v[108:111], a[60:63], a[172:175], v[108:111]
 ds_read_b64_tr_b16 a[132:133], v1 offset:57344
 ds_read_b64_tr_b16 a[134:135], v1 offset:58368
M v[104:107], a[52:55], a[172:175], v[104:107]
 buffer_load_dwordx4 v13, s[48:51], s22 offen offset:1024   lds
M v[104:107], a[48:51], a[168:171], v[104:107]
 ds_read_b64_tr_b16 a[218:219], v28 offset:15104
M v[100:103], a[40:43], a[168:171], v[100:103]
M v[100:103], a[44:47], a[172:175], v[100:103]
 s_waitcnt lgkmcnt(9)
M v[96:99], a[36:39], a[172:175], v[96:99]
M v[96:99], a[32:35], a[168:171], v[96:99]
M v[128:131], a[32:35], a[160:163], v[128:131]
 ds_read_b128 a[168:171], v5 offset:18432
 ds_read_b128 a[172:175], v6 offset:18432
M v[128:131], a[36:39], a[164:167], v[128:131]
 ds_read_b64_tr_b16 a[136:137], v2 offset:49152
 ds_read_b64_tr_b16 a[138:139], v2 offset:50176
M v[132:135], a[44:47], a[164:167], v[132:135]
 buffer_load_dwordx4 v14, s[48:51], s22 offen offset:2048   lds
M v[132:135], a[40:43], a[160:163], v[132:135]
M v[136:139], a[48:51], a[160:163], v[136:139]
M v[136:139], a[52:55], a[164:167], v[136:139]
M v[140:143], a[60:63], a[164:167], v[140:143]
M v[140:143], a[56:59], a[160:163], v[140:143]
 ds_read_b64_tr_b16 a[140:141], v2 offset:57344
 ds_read_b64_tr_b16 a[142:143], v2 offset:58368
M v[144:147], a[64:67], a[160:163], v[144:147]
 buffer_load_dwordx4 v15, s[48:51], s22 offen offset:3072   lds
M v[144:147], a[68:71], a[164:167], v[144:147]
 s_add_u32 s22, s22, 2097152
M v[148:151], a[76:79], a[164:167], v[148:151]
M v[148:151], a[72:75], a[160:163], v[148:151]
M v[152:155], a[80:83], a[160:163], v[152:155]
M v[152:155], a[84:87], a[164:167], v[152:155]
 s_waitcnt lgkmcnt(4)
M v[156:159], a[92:95], a[164:167], v[156:159]
 s_add_u32 m0, s23, 32768
 ds_read_b64_tr_b16 a[144:145], v3 offset:49152
 ds_read_b64_tr_b16 a[146:147], v3 offset:50176
M v[156:159], a[88:91], a[160:163], v[156:159]
 buffer_load_dwordx4 v8, s[16:19], s21 offen offset:0  nt lds
M v[188:191], a[88:91], a[168:171], v[188:191]
 ds_read_b128 a[160:163], v5 offset:20480
 ds_read_b128 a[164:167], v6 offset:20480
M v[188:191], a[92:95], a[172:175], v[188:191]
M v[184:187], a[84:87], a[172:175], v[184:187]
M v[184:187], a[80:83], a[168:171], v[184:187]
M v[180:183], a[72:75], a[168:171], v[180:183]
M v[180:183], a[76:79], a[172:175], v[180:183]
 ds_read_b64_tr_b16 a[148:149], v3 offset:57344
 ds_read_b64_tr_b16 a[150:151], v3 offset:58368
M v[176:179], a[68:71], a[172:175], v[176:179]
 buffer_load_dwordx4 v9, s[16:19], s21 offen offset:1024  nt lds
M v[176:179], a[64:67], a[168:171], v[176:179]
M v[172:175], a[56:59], a[168:171], v[172:175]
M v[172:175], a[60:63], a[172:175], v[172:175]
M v[168:171], a[52:55], a[172:175], v[168:171]
M v[168:171], a[48:51], a[168:171], v[168:171]
M v[164:167], a[40:43], a[168:171], v[164:167]
 ds_read_b64_tr_b16 a[152:153], v4 offset:49152
 ds_read_b64_tr_b16 a[154:155], v4 offset:50176
M v[164:167], a[44:47], a[172:175], v[164:167]
 s_waitcnt lgkmcnt(4)
M v[160:163], a[36:39], a[172:175], v[160:163]
 buffer_load_dwordx4 v10, s[16:19], s21 offen offset:2048  nt lds
M v[160:163], a[32:35], a[168:171], v[160:163]
M v[192:195], a[32:35], a[160:163], v[192:195]
 ds_read_b128 a[168:171], v5 offset:22528
 ds_read_b128 a[172:175], v6 offset:22528
M v[192:195], a[36:39], a[164:167], v[192:195]
M v[196:199], a[44:47], a[164:167], v[196:199]
M v[196:199], a[40:43], a[160:163], v[196:199]
 ds_read_b64_tr_b16 a[156:157], v4 offset:57344
 ds_read_b64_tr_b16 a[158:159], v4 offset:58368
M v[200:203], a[48:51], a[160:163], v[200:203]
 buffer_load_dwordx4 v11, s[16:19], s21 offen offset:3072  nt lds
M v[200:203], a[52:55], a[164:167], v[200:203]
 s_add_u32 s21, s21, 128
M v[204:207], a[60:63], a[164:167], v[204:207]
M v[204:207], a[56:59], a[160:163], v[204:207]
M v[208:211], a[64:67], a[160:163], v[208:211]
M v[208:211], a[68:71], a[164:167], v[208:211]
M v[212:215], a[76:79], a[164:167], v[212:215]
M v[212:215], a[72:75], a[160:163], v[212:215]
M v[216:219], a[80:83], a[160:163], v[216:219]
M v[216:219], a[84:87], a[164:167], v[216:219]
 s_waitcnt lgkmcnt(2)
M v[220:223], a[92:95], a[164:167], v[220:223]
 s_waitcnt vmcnt(16) lgkmcnt(0)
M v[220:223], a[88:91], a[160:163], v[220:223]
 s_barrier
M v[252:255], a[88:91], a[168:171], v[252:255]
 ds_read_b128 a[160:163], v5 offset:32768
 ds_read_b128 a[164:167], v6 offset:32768
M v[252:255], a[92:95], a[172:175], v[252:255]
 buffer_load_dword a240, v24, s[32:35], 0 offen offset:1536
M v[248:251], a[84:87], a[172:175], v[248:251]
M v[248:251], a[80:83], a[168:171], v[248:251]
M v[244:247], a[72:75], a[168:171], v[244:247]
M v[244:247], a[76:79], a[172:175], v[244:247]
M v[240:243], a[68:71], a[172:175], v[240:243]
M v[240:243], a[64:67], a[168:171], v[240:243]
M v[236:239], a[56:59], a[168:171], v[236:239]
M v[236:239], a[60:63], a[172:175], v[236:239]
M v[232:235], a[52:55], a[172:175], v[232:235]
M v[232:235], a[48:51], a[168:171], v[232:235]
M v[228:231], a[40:43], a[168:171], v[228:231]
M v[228:231], a[44:47], a[172:175], v[228:231]
 s_waitcnt lgkmcnt(0)
M v[224:227], a[36:39], a[172:175], v[224:227]
M v[224:227], a[32:35], a[168:171], v[224:227]
M a[0:3], a[96:99], a[160:163], a[0:3]
 ds_read_b128 a[168:171], v5 offset:34816
 ds_read_b128 a[172:175], v6 offset:34816
M a[0:3], a[100:103], a[164:167], a[0:3]
 ds_read_b64_tr_b16 a[32:33], v1 offset:0
 ds_read_b64_tr_b16 a[34:35], v1 offset:1024
M a[4:7], a[108:111], a[164:167], a[4:7]
 s_add_u32 m0, s24, 16384
M a[4:7], a[104:107], a[160:163], a[4:7]
 buffer_load_dwordx4 v12, s[48:51], s22 offen offset:0   lds
M a[8:11], a[112:115], a[160:163], a[8:11]
M a[8:11], a[116:119], a[164:167], a[8:11]
M a[12:15], a[124:127], a[164:167], a[12:15]
 ds_read_b64_tr_b16 a[36:37], v1 offset:8192
 ds_read_b64_tr_b16 a[38:39], v1 offset:9216
M a[12:15], a[120:123], a[160:163], a[12:15]
M a[16:19], a[128:131], a[160:163], a[16:19]
 buffer_load_dwordx4 v13, s[48:51], s22 offen offset:1024   lds
M a[16:19], a[132:135], a[164:167], a[16:19]
M a[20:23], a[140:143], a[164:167], a[20:23]
M a[20:23], a[136:139], a[160:163], a[20:23]
 ds_read_b64_tr_b16 a[40:41], v2 offset:0
 ds_read_b64_tr_b16 a[42:43], v2 offset:1024
M a[24:27], a[144:147], a[160:163], a[24:27]
M a[24:27], a[148:151], a[164:167], a[24:27]
 s_waitcnt lgkmcnt(6)
M a[28:31], a[156:159], a[164:167], a[28:31]
 buffer_load_dwordx4 v14, s[48:51], s22 offen offset:2048   lds
M a[28:31], a[152:155], a[160:163], a[28:31]
M v[60:63], a[152:155], a[168:171], v[60:63]
 ds_read_b128 a[160:163], v5 offset:36864
 ds_read_b128 a[164:167], v6 offset:36864
M v[60:63], a[156:159], a[172:175], v[60:63]
 ds_read_b64_tr_b16 a[44:45], v2 offset:8192
 ds_read_b64_tr_b16 a[46:47], v2 offset:9216
M v[56:59], a[148:151], a[172:175], v[56:59]
 buffer_load_dwordx4 v15, s[48:51], s22 offen offset:3072   lds
M v[56:59], a[144:147], a[168:171], v[56:59]
 s_sub_u32 s22, s22, 2097024
M v[52:55], a[136:139], a[168:171], v[52:55]
M v[52:55], a[140:143], a[172:175], v[52:55]
 ds_read_b64_tr_b16 a[48:49], v3 offset:0
 ds_read_b64_tr_b16 a[50:51], v3 offset:1024
M v[48:51], a[132:135], a[172:175], v[48:51]
 s_add_u32 m0, s23, 49152
M v[48:51], a[128:131], a[168:171], v[48:51]
 buffer_load_dwordx4 v8, s[16:19], s21 offen offset:0  nt lds
M v[44:47], a[120:123], a[168:171], v[44:47]
M v[44:47], a[124:127], a[172:175], v[44:47]
M v[40:43], a[116:119], a[172:175], v[40:43]
 ds_read_b64_tr_b16 a[52:53], v3 offset:8192
 ds_read_b64_tr_b16 a[54:55], v3 offset:9216
M v[40:43], a[112:115], a[168:171], v[40:43]
M v[36:39], a[104:107], a[168:171], v[36:39]
 buffer_load_dwordx4 v9, s[16:19], s21 offen offset:1024  nt lds
M v[36:39], a[108:111], a[172:175], v[36:39]
 s_waitcnt lgkmcnt(6)
M v[32:35], a[100:103], a[172:175], v[32:35]
M v[32:35], a[96:99], a[168:171], v[32:35]
 ds_read_b64_tr_b16 a[56:57], v4 offset:0
 ds_read_b64_tr_b16 a[58:59], v4 offset:1024
M v[64:67], a[96:99], a[160:163], v[64:67]
 ds_read_b128 a[168:171], v5 offset:38912
 ds_read_b128 a[172:175], v6 offset:38912
M v[64:67], a[100:103], a[164:167], v[64:67]
 buffer_load_dwordx4 v10, s[16:19], s21 offen offset:2048  nt lds
M v[68:71], a[108:111], a[164:167], v[68:71]
M v[68:71], a[104:107], a[160:163], v[68:71]
M v[72:75], a[112:115], a[160:163], v[72:75]
 ds_read_b64_tr_b16 a[60:61], v4 offset:8192
 ds_read_b64_tr_b16 a[62:63], v4 offset:9216
M v[72:75], a[116:119], a[164:167], v[72:75]
M v[76:79], a[124:127], a[164:167], v[76:79]
 buffer_load_dwordx4 v11, s[16:19], s21 offen offset:3072  nt lds
M v[76:79], a[120:123], a[160:163], v[76:79]
 s_add_u32 s21, s21, 524160
M v[80:83], a[128:131], a[160:163], v[80:83]
M v[80:83], a[132:135], a[164:167], v[80:83]
M v[84:87], a[140:143], a[164:167], v[84:87]
M v[84:87], a[136:139], a[160:163], v[84:87]
M v[88:91], a[144:147], a[160:163], v[88:91]
M v[88:91], a[148:151], a[164:167], v[88:91]
 s_waitcnt lgkmcnt(2)
M v[92:95], a[156:159], a[164:167], v[92:95]
 s_waitcnt vmcnt(17) lgkmcnt(0)
M v[92:95], a[152:155], a[160:163], v[92:95]
 s_barrier
M v[124:127], a[152:155], a[168:171], v[124:127]
 ds_read_b128 a[160:163], v5 offset:49152
 ds_read_b128 a[164:167], v6 offset:49152
M v[124:127], a[156:159], a[172:175], v[124:127]
M v[120:123], a[148:151], a[172:175], v[120:123]
 s_add_u32 m0, s24, 32768
 ds_read_b64_tr_b16 a[64:65], v1 offset:16384
 ds_read_b64_tr_b16 a[66:67], v1 offset:17408
M v[120:123], a[144:147], a[168:171], v[120:123]
 buffer_load_dwordx4 v12, s[48:51], s22 offen offset:0   lds
M v[116:119], a[136:139], a[168:171], v[116:119]
M v[116:119], a[140:143], a[172:175], v[116:119]
M v[112:115], a[132:135], a[172:175], v[112:115]
M v[112:115], a[128:131], a[168:171], v[112:115]
M v[108:111], a[120:123], a[168:171], v[108:111]
M v[108:111], a[124:127], a[172:175], v[108:111]
 ds_read_b64_tr_b16 a[68:69], v1 offset:24576
 ds_read_b64_tr_b16 a[70:71], v1 offset:25600
M v[104:107], a[116:119], a[172:175], v[104:107]
 buffer_load_dwordx4 v13, s[48:51], s22 offen offset:1024   lds
M v[104:107], a[112:115], a[168:171], v[104:107]
M v[100:103], a[104:107], a[168:171], v[100:103]
 s_and_b32 s64, s42, 7
 s_lshl_b32 s64, s64, 2
M v[100:103], a[108:111], a[172:175], v[100:103]
 s_waitcnt lgkmcnt(4)
 s_add_u32 s64, s64, s20
M v[96:99], a[100:103], a[172:175], v[96:99]
 s_mul_i32 s64, s64, 114688
 v_bfe_u32 v28, v0, 2, 2
 v_and_b32 v29, 3, v0
M v[96:99], a[96:99], a[168:171], v[96:99]
 v_lshlrev_b32 v29, 7, v29
 v_lshl_add_u32 v28, v28, 13, v29
M v[128:131], a[96:99], a[160:163], v[128:131]
 ds_read_b128 a[168:171], v5 offset:51200
 ds_read_b128 a[172:175], v6 offset:51200
M v[128:131], a[100:103], a[164:167], v[128:131]
 ds_read_b64_tr_b16 a[72:73], v2 offset:16384
 ds_read_b64_tr_b16 a[74:75], v2 offset:17408
M v[132:135], a[108:111], a[164:167], v[132:135]
 buffer_load_dwordx4 v14, s[48:51], s22 offen offset:2048   lds
M v[132:135], a[104:107], a[160:163], v[132:135]
 v_add_u32 v23, s64, v28
 v_and_b32 v28, 48, v0
M v[136:139], a[112:115], a[160:163], v[136:139]
 v_lshl_add_u32 v23, v28, 24, v23
M v[136:139], a[116:119], a[164:167], v[136:139]
M v[140:143], a[124:127], a[164:167], v[140:143]
M v[140:143], a[120:123], a[160:163], v[140:143]
 ds_read_b64_tr_b16 a[76:77], v2 offset:24576
 ds_read_b64_tr_b16 a[78:79], v2 offset:25600
M v[144:147], a[128:131], a[160:163], v[144:147]
 buffer_load_dwordx4 v15, s[48:51], s22 offen offset:3072   lds
M v[144:147], a[132:135], a[164:167], v[144:147]
 s_add_u32 s22, s22, 2097152
M v[148:151], a[140:143], a[164:167], v[148:151]
M v[148:151], a[136:139], a[160:163], v[148:151]
M v[152:155], a[144:147], a[160:163], v[152:155]
M v[152:155], a[148:151], a[164:167], v[152:155]
 s_waitcnt lgkmcnt(4)
M v[156:159], a[156:159], a[164:167], v[156:159]
 s_add_u32 m0, s23, 0
 ds_read_b64_tr_b16 a[80:81], v3 offset:16384
 ds_read_b64_tr_b16 a[82:83], v3 offset:17408
M v[156:159], a[152:155], a[160:163], v[156:159]
 buffer_load_dwordx4 v8, s[16:19], s21 offen offset:0  nt lds
M v[188:191], a[152:155], a[168:171], v[188:191]
 ds_read_b128 a[160:163], v5 offset:53248
 ds_read_b128 a[164:167], v6 offset:53248
M v[188:191], a[156:159], a[172:175], v[188:191]
M v[184:187], a[148:151], a[172:175], v[184:187]
M v[184:187], a[144:147], a[168:171], v[184:187]
M v[180:183], a[136:139], a[168:171], v[180:183]
M v[180:183], a[140:143], a[172:175], v[180:183]
 ds_read_b64_tr_b16 a[84:85], v3 offset:24576
 ds_read_b64_tr_b16 a[86:87], v3 offset:25600
M v[176:179], a[132:135], a[172:175], v[176:179]
 buffer_load_dwordx4 v9, s[16:19], s21 offen offset:1024  nt lds
M v[176:179], a[128:131], a[168:171], v[176:179]
M v[172:175], a[120:123], a[168:171], v[172:175]
M v[172:175], a[124:127], a[172:175], v[172:175]
M v[168:171], a[116:119], a[172:175], v[168:171]
M v[168:171], a[112:115], a[168:171], v[168:171]
M v[164:167], a[104:107], a[168:171], v[164:167]
 ds_read_b64_tr_b16 a[88:89], v4 offset:16384
 ds_read_b64_tr_b16 a[90:91], v4 offset:17408
M v[164:167], a[108:111], a[172:175], v[164:167]
 s_waitcnt lgkmcnt(4)
M v[160:163], a[100:103], a[172:175], v[160:163]
 buffer_load_dwordx4 v10, s[16:19], s21 offen offset:2048  nt lds
M v[160:163], a[96:99], a[168:171], v[160:163]
M v[192:195], a[96:99], a[160:163], v[192:195]
 ds_read_b128 a[168:171], v5 offset:55296
 ds_read_b128 a[172:175], v6 offset:55296
M v[192:195], a[100:103], a[164:167], v[192:195]
M v[196:199], a[108:111], a[164:167], v[196:199]
M v[196:199], a[104:107], a[160:163], v[196:199]
 ds_read_b64_tr_b16 a[92:93], v4 offset:24576
 ds_read_b64_tr_b16 a[94:95], v4 offset:25600
M v[200:203], a[112:115], a[160:163], v[200:203]
 buffer_load_dwordx4 v11, s[16:19], s21 offen offset:3072  nt lds
M v[200:203], a[116:119], a[164:167], v[200:203]
 s_add_u32 s21, s21, 128
M v[204:207], a[124:127], a[164:167], v[204:207]
M v[204:207], a[120:123], a[160:163], v[204:207]
M v[208:211], a[128:131], a[160:163], v[208:211]
M v[208:211], a[132:135], a[164:167], v[208:211]
M v[212:215], a[140:143], a[164:167], v[212:215]
M v[212:215], a[136:139], a[160:163], v[212:215]
M v[216:219], a[144:147], a[160:163], v[216:219]
M v[216:219], a[148:151], a[164:167], v[216:219]
 s_waitcnt lgkmcnt(2)
M v[220:223], a[156:159], a[164:167], v[220:223]
 s_waitcnt vmcnt(17) lgkmcnt(0)
M v[220:223], a[152:155], a[160:163], v[220:223]
 s_barrier
M v[252:255], a[152:155], a[168:171], v[252:255]
 ds_read_b128 a[160:163], v5 offset:0
 ds_read_b128 a[164:167], v6 offset:0
M v[252:255], a[156:159], a[172:175], v[252:255]
 buffer_load_dword a240, v23, s[52:55], 0 offen offset:0
M v[248:251], a[148:151], a[172:175], v[248:251]
 v_add_u32 v23, 32768, v23
M v[248:251], a[144:147], a[168:171], v[248:251]
M v[244:247], a[136:139], a[168:171], v[244:247]
M v[244:247], a[140:143], a[172:175], v[244:247]
M v[240:243], a[132:135], a[172:175], v[240:243]
M v[240:243], a[128:131], a[168:171], v[240:243]
M v[236:239], a[120:123], a[168:171], v[236:239]
M v[236:239], a[124:127], a[172:175], v[236:239]
M v[232:235], a[116:119], a[172:175], v[232:235]
M v[232:235], a[112:115], a[168:171], v[232:235]
M v[228:231], a[104:107], a[168:171], v[228:231]
M v[228:231], a[108:111], a[172:175], v[228:231]
 s_waitcnt lgkmcnt(0)
M v[224:227], a[100:103], a[172:175], v[224:227]
M v[224:227], a[96:99], a[168:171], v[224:227]
M a[0:3], a[32:35], a[160:163], a[0:3]
 ds_read_b128 a[168:171], v5 offset:2048
 ds_read_b128 a[172:175], v6 offset:2048
M a[0:3], a[36:39], a[164:167], a[0:3]
 ds_read_b64_tr_b16 a[96:97], v1 offset:32768
 ds_read_b64_tr_b16 a[98:99], v1 offset:33792
M a[4:7], a[44:47], a[164:167], a[4:7]
 s_add_u32 m0, s24, 49152
M a[4:7], a[40:43], a[160:163], a[4:7]
 buffer_load_dwordx4 v12, s[48:51], s22 offen offset:0   lds
M a[8:11], a[48:51], a[160:163], a[8:11]
M a[8:11], a[52:55], a[164:167], a[8:11]
M a[12:15], a[60:63], a[164:167], a[12:15]
 ds_read_b64_tr_b16 a[100:101], v1 offset:40960
 ds_read_b64_tr_b16 a[102:103], v1 offset:41984
M a[12:15], a[56:59], a[160:163], a[12:15]
M a[16:19], a[64:67], a[160:163], a[16:19]
 buffer_load_dwordx4 v13, s[48:51], s22 offen offset:1024   lds
M a[16:19], a[68:71], a[164:167], a[16:19]
M a[20:23], a[76:79], a[164:167], a[20:23]
M a[20:23], a[72:75], a[160:163], a[20:23]
 ds_read_b64_tr_b16 a[104:105], v2 offset:32768
 ds_read_b64_tr_b16 a[106:107], v2 offset:33792
M a[24:27], a[80:83], a[160:163], a[24:27]
M a[24:27], a[84:87], a[164:167], a[24:27]
 s_waitcnt lgkmcnt(6)
M a[28:31], a[92:95], a[164:167], a[28:31]
 buffer_load_dwordx4 v14, s[48:51], s22 offen offset:2048   lds
M a[28:31], a[88:91], a[160:163], a[28:31]
M v[60:63], a[88:91], a[168:171], v[60:63]
 ds_read_b128 a[160:163], v5 offset:4096
 ds_read_b128 a[164:167], v6 offset:4096
M v[60:63], a[92:95], a[172:175], v[60:63]
 ds_read_b64_tr_b16 a[108:109], v2 offset:40960
 ds_read_b64_tr_b16 a[110:111], v2 offset:41984
M v[56:59], a[84:87], a[172:175], v[56:59]
 buffer_load_dwordx4 v15, s[48:51], s22 offen offset:3072   lds
M v[56:59], a[80:83], a[168:171], v[56:59]
 s_sub_u32 s22, s22, 2097024
M v[52:55], a[72:75], a[168:171], v[52:55]
M v[52:55], a[76:79], a[172:175], v[52:55]
 ds_read_b64_tr_b16 a[112:113], v3 offset:32768
 ds_read_b64_tr_b16 a[114:115], v3 offset:33792
M v[48:51], a[68:71], a[172:175], v[48:51]
 s_add_u32 m0, s23, 16384
M v[48:51], a[64:67], a[168:171], v[48:51]
 buffer_load_dwordx4 v8, s[16:19], s21 offen offset:0  nt lds
M v[44:47], a[56:59], a[168:171], v[44:47]
M v[44:47], a[60:63], a[172:175], v[44:47]
M v[40:43], a[52:55], a[172:175], v[40:43]
 ds_read_b64_tr_b16 a[116:117], v3 offset:40960
 ds_read_b64_tr_b16 a[118:119], v3 offset:41984
M v[40:43], a[48:51], a[168:171], v[40:43]
M v[36:39], a[40:43], a[168:171], v[36:39]
 buffer_load_dwordx4 v9, s[16:19], s21 offen offset:1024  nt lds
M v[36:39], a[44:47], a[172:175], v[36:39]
 s_waitcnt lgkmcnt(6)
M v[32:35], a[36:39], a[172:175], v[32:35]
M v[32:35], a[32:35], a[168:171], v[32:35]
 ds_read_b64_tr_b16 a[120:121], v4 offset:32768
 ds_read_b64_tr_b16 a[122:123], v4 offset:33792
M v[64:67], a[32:35], a[160:163], v[64:67]
 ds_read_b128 a[168:171], v5 offset:6144
 ds_read_b128 a[172:175], v6 offset:6144
M v[64:67], a[36:39], a[164:167], v[64:67]
 buffer_load_dwordx4 v10, s[16:19], s21 offen offset:2048  nt lds
M v[68:71], a[44:47], a[164:167], v[68:71]
M v[68:71], a[40:43], a[160:163], v[68:71]
M v[72:75], a[48:51], a[160:163], v[72:75]
 ds_read_b64_tr_b16 a[124:125], v4 offset:40960
 ds_read_b64_tr_b16 a[126:127], v4 offset:41984
M v[72:75], a[52:55], a[164:167], v[72:75]
M v[76:79], a[60:63], a[164:167], v[76:79]
 buffer_load_dwordx4 v11, s[16:19], s21 offen offset:3072  nt lds
M v[76:79], a[56:59], a[160:163], v[76:79]
 s_add_u32 s21, s21, 524160
M v[80:83], a[64:67], a[160:163], v[80:83]
M v[80:83], a[68:71], a[164:167], v[80:83]
M v[84:87], a[76:79], a[164:167], v[84:87]
M v[84:87], a[72:75], a[160:163], v[84:87]
M v[88:91], a[80:83], a[160:163], v[88:91]
M v[88:91], a[84:87], a[164:167], v[88:91]
 s_waitcnt lgkmcnt(2)
M v[92:95], a[92:95], a[164:167], v[92:95]
 s_waitcnt vmcnt(17) lgkmcnt(0)
M v[92:95], a[88:91], a[160:163], v[92:95]
 s_barrier
M v[124:127], a[88:91], a[168:171], v[124:127]
 ds_read_b128 a[160:163], v5 offset:16384
 ds_read_b128 a[164:167], v6 offset:16384
M v[124:127], a[92:95], a[172:175], v[124:127]
M v[120:123], a[84:87], a[172:175], v[120:123]
 s_add_u32 m0, s24, 0
 ds_read_b64_tr_b16 a[128:129], v1 offset:49152
 ds_read_b64_tr_b16 a[130:131], v1 offset:50176
M v[120:123], a[80:83], a[168:171], v[120:123]
 buffer_load_dwordx4 v12, s[48:51], s22 offen offset:0   lds
M v[116:119], a[72:75], a[168:171], v[116:119]
M v[116:119], a[76:79], a[172:175], v[116:119]
M v[112:115], a[68:71], a[172:175], v[112:115]
M v[112:115], a[64:67], a[168:171], v[112:115]
M v[108:111], a[56:59], a[168:171], v[108:111]
M v[108:111], a[60:63], a[172:175], v[108:111]
 ds_read_b64_tr_b16 a[132:133], v1 offset:57344
 ds_read_b64_tr_b16 a[134:135], v1 offset:58368
M v[104:107], a[52:55], a[172:175], v[104:107]
 buffer_load_dwordx4 v13, s[48:51], s22 offen offset:1024   lds
M v[104:107], a[48:51], a[168:171], v[104:107]
M v[100:103], a[40:43], a[168:171], v[100:103]
M v[100:103], a[44:47], a[172:175], v[100:103]
 s_waitcnt lgkmcnt(4)
M v[96:99], a[36:39], a[172:175], v[96:99]
M v[96:99], a[32:35], a[168:171], v[96:99]
M v[128:131], a[32:35], a[160:163], v[128:131]
 ds_read_b128 a[168:171], v5 offset:18432
 ds_read_b128 a[172:175], v6 offset:18432
M v[128:131], a[36:39], a[164:167], v[128:131]
 ds_read_b64_tr_b16 a[136:137], v2 offset:49152
 ds_read_b64_tr_b16 a[138:139], v2 offset:50176
M v[132:135], a[44:47], a[164:167], v[132:135]
 buffer_load_dwordx4 v14, s[48:51], s22 offen offset:2048   lds
M v[132:135], a[40:43], a[160:163], v[132:135]
M v[136:139], a[48:51], a[160:163], v[136:139]
M v[136:139], a[52:55], a[164:167], v[136:139]
M v[140:143], a[60:63], a[164:167], v[140:143]
M v[140:143], a[56:59], a[160:163], v[140:143]
 ds_read_b64_tr_b16 a[140:141], v2 offset:57344
 ds_read_b64_tr_b16 a[142:143], v2 offset:58368
M v[144:147], a[64:67], a[160:163], v[144:147]
 buffer_load_dwordx4 v15, s[48:51], s22 offen offset:3072   lds
M v[144:147], a[68:71], a[164:167], v[144:147]
 s_add_u32 s22, s22, 2097152
M v[148:151], a[76:79], a[164:167], v[148:151]
M v[148:151], a[72:75], a[160:163], v[148:151]
M v[152:155], a[80:83], a[160:163], v[152:155]
M v[152:155], a[84:87], a[164:167], v[152:155]
 s_waitcnt lgkmcnt(4)
M v[156:159], a[92:95], a[164:167], v[156:159]
 s_add_u32 m0, s23, 32768
 ds_read_b64_tr_b16 a[144:145], v3 offset:49152
 ds_read_b64_tr_b16 a[146:147], v3 offset:50176
M v[156:159], a[88:91], a[160:163], v[156:159]
 buffer_load_dwordx4 v8, s[16:19], s21 offen offset:0  nt lds
M v[188:191], a[88:91], a[168:171], v[188:191]
 ds_read_b128 a[160:163], v5 offset:20480
 ds_read_b128 a[164:167], v6 offset:20480
M v[188:191], a[92:95], a[172:175], v[188:191]
M v[184:187], a[84:87], a[172:175], v[184:187]
M v[184:187], a[80:83], a[168:171], v[184:187]
M v[180:183], a[72:75], a[168:171], v[180:183]
M v[180:183], a[76:79], a[172:175], v[180:183]
 ds_read_b64_tr_b16 a[148:149], v3 offset:57344
 ds_read_b64_tr_b16 a[150:151], v3 offset:58368
M v[176:179], a[68:71], a[172:175], v[176:179]
 buffer_load_dwordx4 v9, s[16:19], s21 offen offset:1024  nt lds
M v[176:179], a[64:67], a[168:171], v[176:179]
M v[172:175], a[56:59], a[168:171], v[172:175]
M v[172:175], a[60:63], a[172:175], v[172:175]
M v[168:171], a[52:55], a[172:175], v[168:171]
M v[168:171], a[48:51], a[168:171], v[168:171]
M v[164:167], a[40:43], a[168:171], v[164:167]
 ds_read_b64_tr_b16 a[152:153], v4 offset:49152
 ds_read_b64_tr_b16 a[154:155], v4 offset:50176
M v[164:167], a[44:47], a[172:175], v[164:167]
 s_waitcnt lgkmcnt(4)
M v[160:163], a[36:39], a[172:175], v[160:163]
 buffer_load_dwordx4 v10, s[16:19], s21 offen offset:2048  nt lds
M v[160:163], a[32:35], a[168:171], v[160:163]
M v[192:195], a[32:35], a[160:163], v[192:195]
 ds_read_b128 a[168:171], v5 offset:22528
 ds_read_b128 a[172:175], v6 offset:22528
M v[192:195], a[36:39], a[164:167], v[192:195]
M v[196:199], a[44:47], a[164:167], v[196:199]
M v[196:199], a[40:43], a[160:163], v[196:199]
 ds_read_b64_tr_b16 a[156:157], v4 offset:57344
 ds_read_b64_tr_b16 a[158:159], v4 offset:58368
M v[200:203], a[48:51], a[160:163], v[200:203]
 buffer_load_dwordx4 v11, s[16:19], s21 offen offset:3072  nt lds
M v[200:203], a[52:55], a[164:167], v[200:203]
 s_add_u32 s21, s21, 128
M v[204:207], a[60:63], a[164:167], v[204:207]
M v[204:207], a[56:59], a[160:163], v[204:207]
M v[208:211], a[64:67], a[160:163], v[208:211]
M v[208:211], a[68:71], a[164:167], v[208:211]
M v[212:215], a[76:79], a[164:167], v[212:215]
M v[212:215], a[72:75], a[160:163], v[212:215]
M v[216:219], a[80:83], a[160:163], v[216:219]
M v[216:219], a[84:87], a[164:167], v[216:219]
 s_waitcnt lgkmcnt(2)
M v[220:223], a[92:95], a[164:167], v[220:223]
 s_waitcnt vmcnt(17) lgkmcnt(0)
M v[220:223], a[88:91], a[160:163], v[220:223]
 s_barrier
M v[252:255], a[88:91], a[168:171], v[252:255]
 ds_read_b128 a[160:163], v5 offset:32768
 ds_read_b128 a[164:167], v6 offset:32768
M v[252:255], a[92:95], a[172:175], v[252:255]
 buffer_load_dword a240, v23, s[52:55], 0 offen offset:0
M v[248:251], a[84:87], a[172:175], v[248:251]
 v_add_u32 v23, 32768, v23
M v[248:251], a[80:83], a[168:171], v[248:251]
M v[244:247], a[72:75], a[168:171], v[244:247]
M v[244:247], a[76:79], a[172:175], v[244:247]
M v[240:243], a[68:71], a[172:175], v[240:243]
M v[240:243], a[64:67], a[168:171], v[240:243]
M v[236:239], a[56:59], a[168:171], v[236:239]
M v[236:239], a[60:63], a[172:175], v[236:239]
M v[232:235], a[52:55], a[172:175], v[232:235]
M v[232:235], a[48:51], a[168:171], v[232:235]
M v[228:231], a[40:43], a[168:171], v[228:231]
M v[228:231], a[44:47], a[172:175], v[228:231]
 s_waitcnt lgkmcnt(0)
M v[224:227], a[36:39], a[172:175], v[224:227]
M v[224:227], a[32:35], a[168:171], v[224:227]
M a[0:3], a[96:99], a[160:163], a[0:3]
 ds_read_b128 a[168:171], v5 offset:34816
 ds_read_b128 a[172:175], v6 offset:34816
M a[0:3], a[100:103], a[164:167], a[0:3]
 ds_read_b64_tr_b16 a[32:33], v1 offset:0
 ds_read_b64_tr_b16 a[34:35], v1 offset:1024
M a[4:7], a[108:111], a[164:167], a[4:7]
 s_add_u32 m0, s24, 16384
M a[4:7], a[104:107], a[160:163], a[4:7]
 buffer_load_dwordx4 v12, s[48:51], s22 offen offset:0   lds
M a[8:11], a[112:115], a[160:163], a[8:11]
M a[8:11], a[116:119], a[164:167], a[8:11]
M a[12:15], a[124:127], a[164:167], a[12:15]
 ds_read_b64_tr_b16 a[36:37], v1 offset:8192
 ds_read_b64_tr_b16 a[38:39], v1 offset:9216
M a[12:15], a[120:123], a[160:163], a[12:15]
M a[16:19], a[128:131], a[160:163], a[16:19]
 buffer_load_dwordx4 v13, s[48:51], s22 offen offset:1024   lds
M a[16:19], a[132:135], a[164:167], a[16:19]
M a[20:23], a[140:143], a[164:167], a[20:23]
M a[20:23], a[136:139], a[160:163], a[20:23]
 ds_read_b64_tr_b16 a[40:41], v2 offset:0
 ds_read_b64_tr_b16 a[42:43], v2 offset:1024
M a[24:27], a[144:147], a[160:163], a[24:27]
M a[24:27], a[148:151], a[164:167], a[24:27]
 s_waitcnt lgkmcnt(6)
M a[28:31], a[156:159], a[164:167], a[28:31]
 buffer_load_dwordx4 v14, s[48:51], s22 offen offset:2048   lds
M a[28:31], a[152:155], a[160:163], a[28:31]
M v[60:63], a[152:155], a[168:171], v[60:63]
 ds_read_b128 a[160:163], v5 offset:36864
 ds_read_b128 a[164:167], v6 offset:36864
M v[60:63], a[156:159], a[172:175], v[60:63]
 ds_read_b64_tr_b16 a[44:45], v2 offset:8192
 ds_read_b64_tr_b16 a[46:47], v2 offset:9216
M v[56:59], a[148:151], a[172:175], v[56:59]
 buffer_load_dwordx4 v15, s[48:51], s22 offen offset:3072   lds
M v[56:59], a[144:147], a[168:171], v[56:59]
 s_sub_u32 s22, s22, 2097024
M v[52:55], a[136:139], a[168:171], v[52:55]
M v[52:55], a[140:143], a[172:175], v[52:55]
 ds_read_b64_tr_b16 a[48:49], v3 offset:0
 ds_read_b64_tr_b16 a[50:51], v3 offset:1024
M v[48:51], a[132:135], a[172:175], v[48:51]
 s_add_u32 m0, s23, 49152
M v[48:51], a[128:131], a[168:171], v[48:51]
 buffer_load_dwordx4 v8, s[16:19], s21 offen offset:0  nt lds
M v[44:47], a[120:123], a[168:171], v[44:47]
M v[44:47], a[124:127], a[172:175], v[44:47]
M v[40:43], a[116:119], a[172:175], v[40:43]
 ds_read_b64_tr_b16 a[52:53], v3 offset:8192
 ds_read_b64_tr_b16 a[54:55], v3 offset:9216
M v[40:43], a[112:115], a[168:171], v[40:43]
M v[36:39], a[104:107], a[168:171], v[36:39]
 buffer_load_dwordx4 v9, s[16:19], s21 offen offset:1024  nt lds
M v[36:39], a[108:111], a[172:175], v[36:39]
 s_waitcnt lgkmcnt(6)
M v[32:35], a[100:103], a[172:175], v[32:35]
M v[32:35], a[96:99], a[168:171], v[32:35]
 ds_read_b64_tr_b16 a[56:57], v4 offset:0
 ds_read_b64_tr_b16 a[58:59], v4 offset:1024
M v[64:67], a[96:99], a[160:163], v[64:67]
 ds_read_b128 a[168:171], v5 offset:38912
 ds_read_b128 a[172:175], v6 offset:38912
M v[64:67], a[100:103], a[164:167], v[64:67]
 buffer_load_dwordx4 v10, s[16:19], s21 offen offset:2048  nt lds
M v[68:71], a[108:111], a[164:167], v[68:71]
M v[68:71], a[104:107], a[160:163], v[68:71]
M v[72:75], a[112:115], a[160:163], v[72:75]
 ds_read_b64_tr_b16 a[60:61], v4 offset:8192
 ds_read_b64_tr_b16 a[62:63], v4 offset:9216
M v[72:75], a[116:119], a[164:167], v[72:75]
M v[76:79], a[124:127], a[164:167], v[76:79]
 buffer_load_dwordx4 v11, s[16:19], s21 offen offset:3072  nt lds
M v[76:79], a[120:123], a[160:163], v[76:79]
 s_add_u32 s21, s21, 524160
M v[80:83], a[128:131], a[160:163], v[80:83]
M v[80:83], a[132:135], a[164:167], v[80:83]
M v[84:87], a[140:143], a[164:167], v[84:87]
M v[84:87], a[136:139], a[160:163], v[84:87]
M v[88:91], a[144:147], a[160:163], v[88:91]
M v[88:91], a[148:151], a[164:167], v[88:91]
 s_waitcnt lgkmcnt(2)
M v[92:95], a[156:159], a[164:167], v[92:95]
 s_waitcnt vmcnt(17) lgkmcnt(0)
M v[92:95], a[152:155], a[160:163], v[92:95]
 s_barrier
M v[124:127], a[152:155], a[168:171], v[124:127]
 ds_read_b128 a[160:163], v5 offset:49152
 ds_read_b128 a[164:167], v6 offset:49152
M v[124:127], a[156:159], a[172:175], v[124:127]
M v[120:123], a[148:151], a[172:175], v[120:123]
 s_add_u32 m0, s24, 32768
 ds_read_b64_tr_b16 a[64:65], v1 offset:16384
 ds_read_b64_tr_b16 a[66:67], v1 offset:17408
M v[120:123], a[144:147], a[168:171], v[120:123]
 buffer_load_dwordx4 v12, s[48:51], s22 offen offset:0   lds
M v[116:119], a[136:139], a[168:171], v[116:119]
M v[116:119], a[140:143], a[172:175], v[116:119]
M v[112:115], a[132:135], a[172:175], v[112:115]
M v[112:115], a[128:131], a[168:171], v[112:115]
M v[108:111], a[120:123], a[168:171], v[108:111]
M v[108:111], a[124:127], a[172:175], v[108:111]
 ds_read_b64_tr_b16 a[68:69], v1 offset:24576
 ds_read_b64_tr_b16 a[70:71], v1 offset:25600
M v[104:107], a[116:119], a[172:175], v[104:107]
 buffer_load_dwordx4 v13, s[48:51], s22 offen offset:1024   lds
M v[104:107], a[112:115], a[168:171], v[104:107]
M v[100:103], a[104:107], a[168:171], v[100:103]
M v[100:103], a[108:111], a[172:175], v[100:103]
 s_waitcnt lgkmcnt(4)
M v[96:99], a[100:103], a[172:175], v[96:99]
M v[96:99], a[96:99], a[168:171], v[96:99]
M v[128:131], a[96:99], a[160:163], v[128:131]
 ds_read_b128 a[168:171], v5 offset:51200
 ds_read_b128 a[172:175], v6 offset:51200
M v[128:131], a[100:103], a[164:167], v[128:131]
 ds_read_b64_tr_b16 a[72:73], v2 offset:16384
 ds_read_b64_tr_b16 a[74:75], v2 offset:17408
M v[132:135], a[108:111], a[164:167], v[132:135]
 buffer_load_dwordx4 v14, s[48:51], s22 offen offset:2048   lds
M v[132:135], a[104:107], a[160:163], v[132:135]
M v[136:139], a[112:115], a[160:163], v[136:139]
M v[136:139], a[116:119], a[164:167], v[136:139]
M v[140:143], a[124:127], a[164:167], v[140:143]
M v[140:143], a[120:123], a[160:163], v[140:143]
 ds_read_b64_tr_b16 a[76:77], v2 offset:24576
 ds_read_b64_tr_b16 a[78:79], v2 offset:25600
M v[144:147], a[128:131], a[160:163], v[144:147]
 buffer_load_dwordx4 v15, s[48:51], s22 offen offset:3072   lds
M v[144:147], a[132:135], a[164:167], v[144:147]
 s_add_u32 s22, s22, 2097152
M v[148:151], a[140:143], a[164:167], v[148:151]
M v[148:151], a[136:139], a[160:163], v[148:151]
M v[152:155], a[144:147], a[160:163], v[152:155]
M v[152:155], a[148:151], a[164:167], v[152:155]
 s_waitcnt lgkmcnt(4)
M v[156:159], a[156:159], a[164:167], v[156:159]
 s_add_u32 m0, s23, 0
 ds_read_b64_tr_b16 a[80:81], v3 offset:16384
 ds_read_b64_tr_b16 a[82:83], v3 offset:17408
M v[156:159], a[152:155], a[160:163], v[156:159]
 buffer_load_dwordx4 v8, s[16:19], s21 offen offset:0  nt lds
M v[188:191], a[152:155], a[168:171], v[188:191]
 ds_read_b128 a[160:163], v5 offset:53248
 ds_read_b128 a[164:167], v6 offset:53248
M v[188:191], a[156:159], a[172:175], v[188:191]
M v[184:187], a[148:151], a[172:175], v[184:187]
M v[184:187], a[144:147], a[168:171], v[184:187]
M v[180:183], a[136:139], a[168:171], v[180:183]
M v[180:183], a[140:143], a[172:175], v[180:183]
 ds_read_b64_tr_b16 a[84:85], v3 offset:24576
 ds_read_b64_tr_b16 a[86:87], v3 offset:25600
M v[176:179], a[132:135], a[172:175], v[176:179]
 buffer_load_dwordx4 v9, s[16:19], s21 offen offset:1024  nt lds
M v[176:179], a[128:131], a[168:171], v[176:179]
M v[172:175], a[120:123], a[168:171], v[172:175]
M v[172:175], a[124:127], a[172:175], v[172:175]
M v[168:171], a[116:119], a[172:175], v[168:171]
M v[168:171], a[112:115], a[168:171], v[168:171]
M v[164:167], a[104:107], a[168:171], v[164:167]
 ds_read_b64_tr_b16 a[88:89], v4 offset:16384
 ds_read_b64_tr_b16 a[90:91], v4 offset:17408
M v[164:167], a[108:111], a[172:175], v[164:167]
 s_waitcnt lgkmcnt(4)
M v[160:163], a[100:103], a[172:175], v[160:163]
 buffer_load_dwordx4 v10, s[16:19], s21 offen offset:2048  nt lds
M v[160:163], a[96:99], a[168:171], v[160:163]
M v[192:195], a[96:99], a[160:163], v[192:195]
 ds_read_b128 a[168:171], v5 offset:55296
 ds_read_b128 a[172:175], v6 offset:55296
M v[192:195], a[100:103], a[164:167], v[192:195]
M v[196:199], a[108:111], a[164:167], v[196:199]
M v[196:199], a[104:107], a[160:163], v[196:199]
 ds_read_b64_tr_b16 a[92:93], v4 offset:24576
 ds_read_b64_tr_b16 a[94:95], v4 offset:25600
M v[200:203], a[112:115], a[160:163], v[200:203]
 buffer_load_dwordx4 v11, s[16:19], s21 offen offset:3072  nt lds
M v[200:203], a[116:119], a[164:167], v[200:203]
 s_add_u32 s21, s21, 128
M v[204:207], a[124:127], a[164:167], v[204:207]
M v[204:207], a[120:123], a[160:163], v[204:207]
M v[208:211], a[128:131], a[160:163], v[208:211]
M v[208:211], a[132:135], a[164:167], v[208:211]
M v[212:215], a[140:143], a[164:167], v[212:215]
M v[212:215], a[136:139], a[160:163], v[212:215]
M v[216:219], a[144:147], a[160:163], v[216:219]
M v[216:219], a[148:151], a[164:167], v[216:219]
 s_waitcnt lgkmcnt(2)
M v[220:223], a[156:159], a[164:167], v[220:223]
 s_waitcnt vmcnt(17) lgkmcnt(0)
M v[220:223], a[152:155], a[160:163], v[220:223]
 s_barrier
M v[252:255], a[152:155], a[168:171], v[252:255]
 ds_read_b128 a[160:163], v5 offset:0
 ds_read_b128 a[164:167], v6 offset:0
M v[252:255], a[156:159], a[172:175], v[252:255]
 buffer_load_dword a240, v23, s[52:55], 0 offen offset:0
M v[248:251], a[148:151], a[172:175], v[248:251]
 v_add_u32 v23, 16384, v23
M v[248:251], a[144:147], a[168:171], v[248:251]
M v[244:247], a[136:139], a[168:171], v[244:247]
M v[244:247], a[140:143], a[172:175], v[244:247]
M v[240:243], a[132:135], a[172:175], v[240:243]
M v[240:243], a[128:131], a[168:171], v[240:243]
M v[236:239], a[120:123], a[168:171], v[236:239]
M v[236:239], a[124:127], a[172:175], v[236:239]
M v[232:235], a[116:119], a[172:175], v[232:235]
M v[232:235], a[112:115], a[168:171], v[232:235]
M v[228:231], a[104:107], a[168:171], v[228:231]
M v[228:231], a[108:111], a[172:175], v[228:231]
 s_waitcnt lgkmcnt(0)
M v[224:227], a[100:103], a[172:175], v[224:227]
M v[224:227], a[96:99], a[168:171], v[224:227]
M a[0:3], a[32:35], a[160:163], a[0:3]
 ds_read_b128 a[168:171], v5 offset:2048
 ds_read_b128 a[172:175], v6 offset:2048
M a[0:3], a[36:39], a[164:167], a[0:3]
 ds_read_b64_tr_b16 a[96:97], v1 offset:32768
 ds_read_b64_tr_b16 a[98:99], v1 offset:33792
M a[4:7], a[44:47], a[164:167], a[4:7]
 s_add_u32 m0, s24, 49152
 v_accvgpr_read_b32 v27, a241
M a[4:7], a[40:43], a[160:163], a[4:7]
 buffer_load_dwordx4 v12, s[48:51], s22 offen offset:0   lds
M a[8:11], a[48:51], a[160:163], a[8:11]
M a[8:11], a[52:55], a[164:167], a[8:11]
M a[12:15], a[60:63], a[164:167], a[12:15]
 ds_read_b64_tr_b16 a[100:101], v1 offset:40960
 ds_read_b64_tr_b16 a[102:103], v1 offset:41984
M a[12:15], a[56:59], a[160:163], a[12:15]
M a[16:19], a[64:67], a[160:163], a[16:19]
 buffer_load_dwordx4 v13, s[48:51], s22 offen offset:1024   lds
M a[16:19], a[68:71], a[164:167], a[16:19]
M a[20:23], a[76:79], a[164:167], a[20:23]
M a[20:23], a[72:75], a[160:163], a[20:23]
 ds_read_b64_tr_b16 a[104:105], v2 offset:32768
 ds_read_b64_tr_b16 a[106:107], v2 offset:33792
M a[24:27], a[80:83], a[160:163], a[24:27]
M a[24:27], a[84:87], a[164:167], a[24:27]
 s_waitcnt lgkmcnt(6)
M a[28:31], a[92:95], a[164:167], a[28:31]
 buffer_load_dwordx4 v14, s[48:51], s22 offen offset:2048   lds
M a[28:31], a[88:91], a[160:163], a[28:31]
M v[60:63], a[88:91], a[168:171], v[60:63]
 ds_read_b128 a[160:163], v5 offset:4096
 ds_read_b128 a[164:167], v6 offset:4096
M v[60:63], a[92:95], a[172:175], v[60:63]
 ds_read_b64_tr_b16 a[108:109], v2 offset:40960
 ds_read_b64_tr_b16 a[110:111], v2 offset:41984
M v[56:59], a[84:87], a[172:175], v[56:59]
 buffer_load_dwordx4 v15, s[48:51], s22 offen offset:3072   lds
M v[56:59], a[80:83], a[168:171], v[56:59]
 s_sub_u32 s22, s22, 2097024
M v[52:55], a[72:75], a[168:171], v[52:55]
M v[52:55], a[76:79], a[172:175], v[52:55]
 ds_read_b64_tr_b16 a[112:113], v3 offset:32768
 ds_read_b64_tr_b16 a[114:115], v3 offset:33792
M v[48:51], a[68:71], a[172:175], v[48:51]
 s_add_u32 m0, s23, 16384
M v[48:51], a[64:67], a[168:171], v[48:51]
 buffer_load_dwordx4 v8, s[16:19], s21 offen offset:0  nt lds
M v[44:47], a[56:59], a[168:171], v[44:47]
M v[44:47], a[60:63], a[172:175], v[44:47]
M v[40:43], a[52:55], a[172:175], v[40:43]
 ds_read_b64_tr_b16 a[116:117], v3 offset:40960
 ds_read_b64_tr_b16 a[118:119], v3 offset:41984
M v[40:43], a[48:51], a[168:171], v[40:43]
M v[36:39], a[40:43], a[168:171], v[36:39]
 buffer_load_dwordx4 v9, s[16:19], s21 offen offset:1024  nt lds
M v[36:39], a[44:47], a[172:175], v[36:39]
 s_waitcnt lgkmcnt(6)
M v[32:35], a[36:39], a[172:175], v[32:35]
M v[32:35], a[32:35], a[168:171], v[32:35]
 ds_read_b64_tr_b16 a[120:121], v4 offset:32768
 ds_read_b64_tr_b16 a[122:123], v4 offset:33792
M v[64:67], a[32:35], a[160:163], v[64:67]
 ds_read_b128 a[168:171], v5 offset:6144
 ds_read_b128 a[172:175], v6 offset:6144
M v[64:67], a[36:39], a[164:167], v[64:67]
 buffer_load_dwordx4 v10, s[16:19], s21 offen offset:2048  nt lds
M v[68:71], a[44:47], a[164:167], v[68:71]
M v[68:71], a[40:43], a[160:163], v[68:71]
M v[72:75], a[48:51], a[160:163], v[72:75]
 ds_read_b64_tr_b16 a[124:125], v4 offset:40960
 ds_read_b64_tr_b16 a[126:127], v4 offset:41984
M v[72:75], a[52:55], a[164:167], v[72:75]
 v_sub_f32 v48, v48, v27
 v_sub_f32 v49, v49, v27
M v[76:79], a[60:63], a[164:167], v[76:79]
 buffer_load_dwordx4 v11, s[16:19], s21 offen offset:3072  nt lds
M v[76:79], a[56:59], a[160:163], v[76:79]
 s_add_u32 s21, s21, 524160
 v_sub_f32 v50, v50, v27
 v_sub_f32 v51, v51, v27
M v[80:83], a[64:67], a[160:163], v[80:83]
 v_sub_f32 v52, v52, v27
 v_sub_f32 v53, v53, v27
M v[80:83], a[68:71], a[164:167], v[80:83]
 v_sub_f32 v54, v54, v27
 v_sub_f32 v55, v55, v27
M v[84:87], a[76:79], a[164:167], v[84:87]
 v_sub_f32 v56, v56, v27
 v_sub_f32 v57, v57, v27
M v[84:87], a[72:75], a[160:163], v[84:87]
 v_sub_f32 v58, v58, v27
 v_sub_f32 v59, v59, v27
M v[88:91], a[80:83], a[160:163], v[88:91]
 v_sub_f32 v60, v60, v27
 v_sub_f32 v61, v61, v27
M v[88:91], a[84:87], a[164:167], v[88:91]
 s_waitcnt lgkmcnt(2)
 v_sub_f32 v62, v62, v27
 v_sub_f32 v63, v63, v27
M v[92:95], a[92:95], a[164:167], v[92:95]
 s_waitcnt vmcnt(17) lgkmcnt(0)
M v[92:95], a[88:91], a[160:163], v[92:95]
 s_barrier
M v[124:127], a[88:91], a[168:171], v[124:127]
 ds_read_b128 a[160:163], v5 offset:16384
 ds_read_b128 a[164:167], v6 offset:16384
M v[124:127], a[92:95], a[172:175], v[124:127]
M v[120:123], a[84:87], a[172:175], v[120:123]
 s_add_u32 m0, s24, 0
 ds_read_b64_tr_b16 a[128:129], v1 offset:49152
 ds_read_b64_tr_b16 a[130:131], v1 offset:50176
M v[120:123], a[80:83], a[168:171], v[120:123]
 buffer_load_dwordx4 v12, s[48:51], s22 offen offset:0   lds
M v[116:119], a[72:75], a[168:171], v[116:119]
 v_sub_f32 v80, v80, v27
 v_sub_f32 v81, v81, v27
M v[116:119], a[76:79], a[172:175], v[116:119]
 v_sub_f32 v82, v82, v27
 v_sub_f32 v83, v83, v27
M v[112:115], a[68:71], a[172:175], v[112:115]
 v_sub_f32 v84, v84, v27
 v_sub_f32 v85, v85, v27
M v[112:115], a[64:67], a[168:171], v[112:115]
 v_sub_f32 v86, v86, v27
 v_sub_f32 v87, v87, v27
M v[108:111], a[56:59], a[168:171], v[108:111]
 v_sub_f32 v88, v88, v27
 v_sub_f32 v89, v89, v27
M v[108:111], a[60:63], a[172:175], v[108:111]
 ds_read_b64_tr_b16 a[132:133], v1 offset:57344
 ds_read_b64_tr_b16 a[134:135], v1 offset:58368
M v[104:107], a[52:55], a[172:175], v[104:107]
 buffer_load_dwordx4 v13, s[48:51], s22 offen offset:1024   lds
M v[104:107], a[48:51], a[168:171], v[104:107]
 v_sub_f32 v90, v90, v27
 v_sub_f32 v91, v91, v27
M v[100:103], a[40:43], a[168:171], v[100:103]
 v_sub_f32 v92, v92, v27
 v_sub_f32 v93, v93, v27
M v[100:103], a[44:47], a[172:175], v[100:103]
 s_waitcnt lgkmcnt(4)
 v_sub_f32 v94, v94, v27
 v_sub_f32 v95, v95, v27
M v[96:99], a[36:39], a[172:175], v[96:99]
M v[96:99], a[32:35], a[168:171], v[96:99]
M v[128:131], a[32:35], a[160:163], v[128:131]
 ds_read_b128 a[168:171], v5 offset:18432
 ds_read_b128 a[172:175], v6 offset:18432
M v[128:131], a[36:39], a[164:167], v[128:131]
 ds_read_b64_tr_b16 a[136:137], v2 offset:49152
 ds_read_b64_tr_b16 a[138:139], v2 offset:50176
M v[132:135], a[44:47], a[164:167], v[132:135]
 buffer_load_dwordx4 v14, s[48:51], s22 offen offset:2048   lds
M v[132:135], a[40:43], a[160:163], v[132:135]
M v[136:139], a[48:51], a[160:163], v[136:139]
 v_sub_f32 v112, v112, v27
 v_sub_f32 v113, v113, v27
M v[136:139], a[52:55], a[164:167], v[136:139]
 v_sub_f32 v114, v114, v27
 v_sub_f32 v115, v115, v27
M v[140:143], a[60:63], a[164:167], v[140:143]
 v_sub_f32 v116, v116, v27
 v_sub_f32 v117, v117, v27
M v[140:143], a[56:59], a[160:163], v[140:143]
 ds_read_b64_tr_b16 a[140:141], v2 offset:57344
 ds_read_b64_tr_b16 a[142:143], v2 offset:58368
M v[144:147], a[64:67], a[160:163], v[144:147]
 buffer_load_dwordx4 v15, s[48:51], s22 offen offset:3072   lds
M v[144:147], a[68:71], a[164:167], v[144:147]
 s_add_u32 s22, s22, 2097152
 v_sub_f32 v118, v118, v27
 v_sub_f32 v119, v119, v27
M v[148:151], a[76:79], a[164:167], v[148:151]
 v_sub_f32 v120, v120, v27
 v_sub_f32 v121, v121, v27
M v[148:151], a[72:75], a[160:163], v[148:151]
 v_sub_f32 v122, v122, v27
 v_sub_f32 v123, v123, v27
M v[152:155], a[80:83], a[160:163], v[152:155]
 v_sub_f32 v124, v124, v27
 v_sub_f32 v125, v125, v27
M v[152:155], a[84:87], a[164:167], v[152:155]
 s_waitcnt lgkmcnt(4)
 v_sub_f32 v126, v126, v27
 v_sub_f32 v127, v127, v27
M v[156:159], a[92:95], a[164:167], v[156:159]
 s_add_u32 m0, s23, 32768
 ds_read_b64_tr_b16 a[144:145], v3 offset:49152
 ds_read_b64_tr_b16 a[146:147], v3 offset:50176
M v[156:159], a[88:91], a[160:163], v[156:159]
 buffer_load_dwordx4 v8, s[16:19], s21 offen offset:0  nt lds
M v[188:191], a[88:91], a[168:171], v[188:191]
 ds_read_b128 a[160:163], v5 offset:20480
 ds_read_b128 a[164:167], v6 offset:20480
M v[188:191], a[92:95], a[172:175], v[188:191]
M v[184:187], a[84:87], a[172:175], v[184:187]
M v[184:187], a[80:83], a[168:171], v[184:187]
M v[180:183], a[72:75], a[168:171], v[180:183]
 v_sub_f32 v128, v128, v27
 v_sub_f32 v129, v129, v27
M v[180:183], a[76:79], a[172:175], v[180:183]
 ds_read_b64_tr_b16 a[148:149], v3 offset:57344
 ds_read_b64_tr_b16 a[150:151], v3 offset:58368
M v[176:179], a[68:71], a[172:175], v[176:179]
 buffer_load_dwordx4 v9, s[16:19], s21 offen offset:1024  nt lds
M v[176:179], a[64:67], a[168:171], v[176:179]
 v_sub_f32 v130, v130, v27
 v_sub_f32 v131, v131, v27
M v[172:175], a[56:59], a[168:171], v[172:175]
 v_sub_f32 v132, v132, v27
 v_sub_f32 v133, v133, v27
M v[172:175], a[60:63], a[172:175], v[172:175]
 v_sub_f32 v134, v134, v27
 v_sub_f32 v135, v135, v27
M v[168:171], a[52:55], a[172:175], v[168:171]
 v_sub_f32 v136, v136, v27
 v_sub_f32 v137, v137, v27
M v[168:171], a[48:51], a[168:171], v[168:171]
 v_sub_f32 v138, v138, v27
 v_sub_f32 v139, v139, v27
M v[164:167], a[40:43], a[168:171], v[164:167]
 ds_read_b64_tr_b16 a[152:153], v4 offset:49152
 ds_read_b64_tr_b16 a[154:155], v4 offset:50176
M v[164:167], a[44:47], a[172:175], v[164:167]
 s_waitcnt lgkmcnt(4)
 v_sub_f32 v140, v140, v27
 v_sub_f32 v141, v141, v27
M v[160:163], a[36:39], a[172:175], v[160:163]
 buffer_load_dwordx4 v10, s[16:19], s21 offen offset:2048  nt lds
M v[160:163], a[32:35], a[168:171], v[160:163]
 v_sub_f32 v142, v142, v27
 v_sub_f32 v143, v143, v27
M v[192:195], a[32:35], a[160:163], v[192:195]
 ds_read_b128 a[168:171], v5 offset:22528
 ds_read_b128 a[172:175], v6 offset:22528
M v[192:195], a[36:39], a[164:167], v[192:195]
 v_sub_f32 v144, v144, v27
 v_sub_f32 v145, v145, v27
M v[196:199], a[44:47], a[164:167], v[196:199]
 v_sub_f32 v146, v146, v27
 v_sub_f32 v147, v147, v27
M v[196:199], a[40:43], a[160:163], v[196:199]
 ds_read_b64_tr_b16 a[156:157], v4 offset:57344
 ds_read_b64_tr_b16 a[158:159], v4 offset:58368
M v[200:203], a[48:51], a[160:163], v[200:203]
 buffer_load_dwordx4 v11, s[16:19], s21 offen offset:3072  nt lds
M v[200:203], a[52:55], a[164:167], v[200:203]
 s_add_u32 s21, s21, 128
 v_sub_f32 v148, v148, v27
 v_sub_f32 v149, v149, v27
M v[204:207], a[60:63], a[164:167], v[204:207]
 v_sub_f32 v150, v150, v27
 v_sub_f32 v151, v151, v27
M v[204:207], a[56:59], a[160:163], v[204:207]
 v_sub_f32 v152, v152, v27
 v_sub_f32 v153, v153, v27
M v[208:211], a[64:67], a[160:163], v[208:211]
 v_sub_f32 v154, v154, v27
 v_sub_f32 v155, v155, v27
M v[208:211], a[68:71], a[164:167], v[208:211]
 v_sub_f32 v156, v156, v27
 v_sub_f32 v157, v157, v27
M v[212:215], a[76:79], a[164:167], v[212:215]
 v_sub_f32 v158, v158, v27
 v_sub_f32 v159, v159, v27
M v[212:215], a[72:75], a[160:163], v[212:215]
M v[216:219], a[80:83], a[160:163], v[216:219]
M v[216:219], a[84:87], a[164:167], v[216:219]
 s_waitcnt lgkmcnt(2)
M v[220:223], a[92:95], a[164:167], v[220:223]
 s_waitcnt vmcnt(17) lgkmcnt(0)
M v[220:223], a[88:91], a[160:163], v[220:223]
 s_barrier
M v[252:255], a[88:91], a[168:171], v[252:255]
 ds_read_b128 a[160:163], v5 offset:32768
 ds_read_b128 a[164:167], v6 offset:32768
M v[252:255], a[92:95], a[172:175], v[252:255]
 buffer_load_dword a240, v23, s[52:55], 0 offen offset:0
M v[248:251], a[84:87], a[172:175], v[248:251]
 v_add_u32 v23, 16384, v23
M v[248:251], a[80:83], a[168:171], v[248:251]
M v[244:247], a[72:75], a[168:171], v[244:247]
M v[244:247], a[76:79], a[172:175], v[244:247]
M v[240:243], a[68:71], a[172:175], v[240:243]
M v[240:243], a[64:67], a[168:171], v[240:243]
M v[236:239], a[56:59], a[168:171], v[236:239]
M v[236:239], a[60:63], a[172:175], v[236:239]
M v[232:235], a[52:55], a[172:175], v[232:235]
M v[232:235], a[48:51], a[168:171], v[232:235]
M v[228:231], a[40:43], a[168:171], v[228:231]
M v[228:231], a[44:47], a[172:175], v[228:231]
 s_waitcnt lgkmcnt(0)
M v[224:227], a[36:39], a[172:175], v[224:227]
M v[224:227], a[32:35], a[168:171], v[224:227]
M a[0:3], a[96:99], a[160:163], a[0:3]
 ds_read_b128 a[168:171], v5 offset:34816
 ds_read_b128 a[172:175], v6 offset:34816
M a[0:3], a[100:103], a[164:167], a[0:3]
 ds_read_b64_tr_b16 a[32:33], v1 offset:0
 ds_read_b64_tr_b16 a[34:35], v1 offset:1024
M a[4:7], a[108:111], a[164:167], a[4:7]
 s_add_u32 m0, s24, 16384
M a[4:7], a[104:107], a[160:163], a[4:7]
 buffer_load_dwordx4 v12, s[48:51], s22 offen offset:0   lds
M a[8:11], a[112:115], a[160:163], a[8:11]
M a[8:11], a[116:119], a[164:167], a[8:11]
M a[12:15], a[124:127], a[164:167], a[12:15]
 ds_read_b64_tr_b16 a[36:37], v1 offset:8192
 ds_read_b64_tr_b16 a[38:39], v1 offset:9216
M a[12:15], a[120:123], a[160:163], a[12:15]
M a[16:19], a[128:131], a[160:163], a[16:19]
 buffer_load_dwordx4 v13, s[48:51], s22 offen offset:1024   lds
M a[16:19], a[132:135], a[164:167], a[16:19]
M a[20:23], a[140:143], a[164:167], a[20:23]
M a[20:23], a[136:139], a[160:163], a[20:23]
 ds_read_b64_tr_b16 a[40:41], v2 offset:0
 ds_read_b64_tr_b16 a[42:43], v2 offset:1024
M a[24:27], a[144:147], a[160:163], a[24:27]
M a[24:27], a[148:151], a[164:167], a[24:27]
 s_waitcnt lgkmcnt(6)
M a[28:31], a[156:159], a[164:167], a[28:31]
 buffer_load_dwordx4 v14, s[48:51], s22 offen offset:2048   lds
M a[28:31], a[152:155], a[160:163], a[28:31]
M v[60:63], a[152:155], a[168:171], v[60:63]
 ds_read_b128 a[160:163], v5 offset:36864
 ds_read_b128 a[164:167], v6 offset:36864
M v[60:63], a[156:159], a[172:175], v[60:63]
 ds_read_b64_tr_b16 a[44:45], v2 offset:8192
 ds_read_b64_tr_b16 a[46:47], v2 offset:9216
M v[56:59], a[148:151], a[172:175], v[56:59]
 buffer_load_dwordx4 v15, s[48:51], s22 offen offset:3072   lds
M v[56:59], a[144:147], a[168:171], v[56:59]
 s_sub_u32 s22, s22, 2097024
M v[52:55], a[136:139], a[168:171], v[52:55]
M v[52:55], a[140:143], a[172:175], v[52:55]
 ds_read_b64_tr_b16 a[48:49], v3 offset:0
 ds_read_b64_tr_b16 a[50:51], v3 offset:1024
M v[48:51], a[132:135], a[172:175], v[48:51]
 s_add_u32 m0, s23, 49152
M v[48:51], a[128:131], a[168:171], v[48:51]
 buffer_load_dwordx4 v8, s[16:19], s21 offen offset:0  nt lds
M v[44:47], a[120:123], a[168:171], v[44:47]
M v[44:47], a[124:127], a[172:175], v[44:47]
M v[40:43], a[116:119], a[172:175], v[40:43]
 ds_read_b64_tr_b16 a[52:53], v3 offset:8192
 ds_read_b64_tr_b16 a[54:55], v3 offset:9216
M v[40:43], a[112:115], a[168:171], v[40:43]
M v[36:39], a[104:107], a[168:171], v[36:39]
 buffer_load_dwordx4 v9, s[16:19], s21 offen offset:1024  nt lds
M v[36:39], a[108:111], a[172:175], v[36:39]
 s_waitcnt lgkmcnt(6)
M v[32:35], a[100:103], a[172:175], v[32:35]
M v[32:35], a[96:99], a[168:171], v[32:35]
 ds_read_b64_tr_b16 a[56:57], v4 offset:0
 ds_read_b64_tr_b16 a[58:59], v4 offset:1024
M v[64:67], a[96:99], a[160:163], v[64:67]
 ds_read_b128 a[168:171], v5 offset:38912
 ds_read_b128 a[172:175], v6 offset:38912
M v[64:67], a[100:103], a[164:167], v[64:67]
 buffer_load_dwordx4 v10, s[16:19], s21 offen offset:2048  nt lds
M v[68:71], a[108:111], a[164:167], v[68:71]
M v[68:71], a[104:107], a[160:163], v[68:71]
M v[72:75], a[112:115], a[160:163], v[72:75]
 ds_read_b64_tr_b16 a[60:61], v4 offset:8192
 ds_read_b64_tr_b16 a[62:63], v4 offset:9216
M v[72:75], a[116:119], a[164:167], v[72:75]
M v[76:79], a[124:127], a[164:167], v[76:79]
 buffer_load_dwordx4 v11, s[16:19], s21 offen offset:3072  nt lds
M v[76:79], a[120:123], a[160:163], v[76:79]
 s_add_u32 s21, s21, 524160
M v[80:83], a[128:131], a[160:163], v[80:83]
M v[80:83], a[132:135], a[164:167], v[80:83]
M v[84:87], a[140:143], a[164:167], v[84:87]
M v[84:87], a[136:139], a[160:163], v[84:87]
M v[88:91], a[144:147], a[160:163], v[88:91]
M v[88:91], a[148:151], a[164:167], v[88:91]
 s_waitcnt lgkmcnt(2)
M v[92:95], a[156:159], a[164:167], v[92:95]
 s_waitcnt vmcnt(17) lgkmcnt(0)
M v[92:95], a[152:155], a[160:163], v[92:95]
 s_barrier
M v[124:127], a[152:155], a[168:171], v[124:127]
 ds_read_b128 a[160:163], v5 offset:49152
 ds_read_b128 a[164:167], v6 offset:49152
M v[124:127], a[156:159], a[172:175], v[124:127]
M v[120:123], a[148:151], a[172:175], v[120:123]
 s_add_u32 m0, s24, 32768
 ds_read_b64_tr_b16 a[64:65], v1 offset:16384
 ds_read_b64_tr_b16 a[66:67], v1 offset:17408
M v[120:123], a[144:147], a[168:171], v[120:123]
 buffer_load_dwordx4 v12, s[48:51], s22 offen offset:0   lds
M v[116:119], a[136:139], a[168:171], v[116:119]
M v[116:119], a[140:143], a[172:175], v[116:119]
M v[112:115], a[132:135], a[172:175], v[112:115]
M v[112:115], a[128:131], a[168:171], v[112:115]
M v[108:111], a[120:123], a[168:171], v[108:111]
M v[108:111], a[124:127], a[172:175], v[108:111]
 ds_read_b64_tr_b16 a[68:69], v1 offset:24576
 ds_read_b64_tr_b16 a[70:71], v1 offset:25600
M v[104:107], a[116:119], a[172:175], v[104:107]
 buffer_load_dwordx4 v13, s[48:51], s22 offen offset:1024   lds
M v[104:107], a[112:115], a[168:171], v[104:107]
M v[100:103], a[104:107], a[168:171], v[100:103]
M v[100:103], a[108:111], a[172:175], v[100:103]
 s_waitcnt lgkmcnt(4)
M v[96:99], a[100:103], a[172:175], v[96:99]
M v[96:99], a[96:99], a[168:171], v[96:99]
M v[128:131], a[96:99], a[160:163], v[128:131]
 ds_read_b128 a[168:171], v5 offset:51200
 ds_read_b128 a[172:175], v6 offset:51200
M v[128:131], a[100:103], a[164:167], v[128:131]
 ds_read_b64_tr_b16 a[72:73], v2 offset:16384
 ds_read_b64_tr_b16 a[74:75], v2 offset:17408
M v[132:135], a[108:111], a[164:167], v[132:135]
 buffer_load_dwordx4 v14, s[48:51], s22 offen offset:2048   lds
M v[132:135], a[104:107], a[160:163], v[132:135]
M v[136:139], a[112:115], a[160:163], v[136:139]
M v[136:139], a[116:119], a[164:167], v[136:139]
M v[140:143], a[124:127], a[164:167], v[140:143]
M v[140:143], a[120:123], a[160:163], v[140:143]
 ds_read_b64_tr_b16 a[76:77], v2 offset:24576
 ds_read_b64_tr_b16 a[78:79], v2 offset:25600
M v[144:147], a[128:131], a[160:163], v[144:147]
 buffer_load_dwordx4 v15, s[48:51], s22 offen offset:3072   lds
M v[144:147], a[132:135], a[164:167], v[144:147]
 s_add_u32 s22, s22, 2097152
M v[148:151], a[140:143], a[164:167], v[148:151]
M v[148:151], a[136:139], a[160:163], v[148:151]
M v[152:155], a[144:147], a[160:163], v[152:155]
M v[152:155], a[148:151], a[164:167], v[152:155]
 s_waitcnt lgkmcnt(4)
M v[156:159], a[156:159], a[164:167], v[156:159]
 s_add_u32 m0, s23, 0
 ds_read_b64_tr_b16 a[80:81], v3 offset:16384
 ds_read_b64_tr_b16 a[82:83], v3 offset:17408
M v[156:159], a[152:155], a[160:163], v[156:159]
 buffer_load_dwordx4 v8, s[52:55], s28 offen offset:0   lds
M v[188:191], a[152:155], a[168:171], v[188:191]
 ds_read_b128 a[160:163], v5 offset:53248
 ds_read_b128 a[164:167], v6 offset:53248
M v[188:191], a[156:159], a[172:175], v[188:191]
M v[184:187], a[148:151], a[172:175], v[184:187]
M v[184:187], a[144:147], a[168:171], v[184:187]
M v[180:183], a[136:139], a[168:171], v[180:183]
M v[180:183], a[140:143], a[172:175], v[180:183]
 ds_read_b64_tr_b16 a[84:85], v3 offset:24576
 ds_read_b64_tr_b16 a[86:87], v3 offset:25600
M v[176:179], a[132:135], a[172:175], v[176:179]
 buffer_load_dwordx4 v9, s[52:55], s28 offen offset:1024   lds
M v[176:179], a[128:131], a[168:171], v[176:179]
M v[172:175], a[120:123], a[168:171], v[172:175]
M v[172:175], a[124:127], a[172:175], v[172:175]
M v[168:171], a[116:119], a[172:175], v[168:171]
M v[168:171], a[112:115], a[168:171], v[168:171]
M v[164:167], a[104:107], a[168:171], v[164:167]
 ds_read_b64_tr_b16 a[88:89], v4 offset:16384
 ds_read_b64_tr_b16 a[90:91], v4 offset:17408
M v[164:167], a[108:111], a[172:175], v[164:167]
 s_waitcnt lgkmcnt(4)
M v[160:163], a[100:103], a[172:175], v[160:163]
 buffer_load_dwordx4 v10, s[52:55], s28 offen offset:2048   lds
M v[160:163], a[96:99], a[168:171], v[160:163]
M v[192:195], a[96:99], a[160:163], v[192:195]
 ds_read_b128 a[168:171], v5 offset:55296
 ds_read_b128 a[172:175], v6 offset:55296
M v[192:195], a[100:103], a[164:167], v[192:195]
M v[196:199], a[108:111], a[164:167], v[196:199]
M v[196:199], a[104:107], a[160:163], v[196:199]
 ds_read_b64_tr_b16 a[92:93], v4 offset:24576
 ds_read_b64_tr_b16 a[94:95], v4 offset:25600
M v[200:203], a[112:115], a[160:163], v[200:203]
 buffer_load_dwordx4 v11, s[52:55], s28 offen offset:3072   lds
M v[200:203], a[116:119], a[164:167], v[200:203]
 s_add_u32 s28, s28, 128
 v_sub_f32 v160, v160, v27
 v_sub_f32 v161, v161, v27
M v[204:207], a[124:127], a[164:167], v[204:207]
 v_sub_f32 v162, v162, v27
 v_sub_f32 v163, v163, v27
M v[204:207], a[120:123], a[160:163], v[204:207]
 v_sub_f32 v164, v164, v27
 v_sub_f32 v165, v165, v27
M v[208:211], a[128:131], a[160:163], v[208:211]
 v_sub_f32 v166, v166, v27
 v_sub_f32 v167, v167, v27
M v[208:211], a[132:135], a[164:167], v[208:211]
 v_sub_f32 v168, v168, v27
 v_sub_f32 v169, v169, v27
M v[212:215], a[140:143], a[164:167], v[212:215]
 v_sub_f32 v170, v170, v27
 v_sub_f32 v171, v171, v27
M v[212:215], a[136:139], a[160:163], v[212:215]
 v_sub_f32 v172, v172, v27
 v_sub_f32 v173, v173, v27
M v[216:219], a[144:147], a[160:163], v[216:219]
 v_sub_f32 v174, v174, v27
 v_sub_f32 v175, v175, v27
M v[216:219], a[148:151], a[164:167], v[216:219]
 s_waitcnt lgkmcnt(2)
 v_sub_f32 v176, v176, v27
 v_sub_f32 v177, v177, v27
M v[220:223], a[156:159], a[164:167], v[220:223]
 s_waitcnt vmcnt(17) lgkmcnt(0)
 v_sub_f32 v178, v178, v27
 v_sub_f32 v179, v179, v27
M v[220:223], a[152:155], a[160:163], v[220:223]
 s_barrier
M v[252:255], a[152:155], a[168:171], v[252:255]
 ds_read_b128 a[160:163], v5 offset:0
 ds_read_b128 a[164:167], v6 offset:0
M v[252:255], a[156:159], a[172:175], v[252:255]
 v_and_b32 v26, 48, v0
 v_lshlrev_b32 v26, 17, v26
M v[248:251], a[148:151], a[172:175], v[248:251]
 v_or_b32 v26, v26, v0
 v_lshl_add_u32 v26, v26, 7, s95
M v[248:251], a[144:147], a[168:171], v[248:251]
 buffer_load_dword a240, v26, s[76:79], 0 offen offset:0
M v[244:247], a[136:139], a[168:171], v[244:247]
 v_sub_f32 v180, v180, v27
 v_sub_f32 v181, v181, v27
M v[244:247], a[140:143], a[172:175], v[244:247]
 v_sub_f32 v182, v182, v27
 v_sub_f32 v183, v183, v27
M v[240:243], a[132:135], a[172:175], v[240:243]
 v_sub_f32 v184, v184, v27
 v_sub_f32 v185, v185, v27
M v[240:243], a[128:131], a[168:171], v[240:243]
 v_sub_f32 v186, v186, v27
 v_sub_f32 v187, v187, v27
M v[236:239], a[120:123], a[168:171], v[236:239]
 v_sub_f32 v188, v188, v27
 v_sub_f32 v189, v189, v27
M v[236:239], a[124:127], a[172:175], v[236:239]
 v_sub_f32 v190, v190, v27
 v_sub_f32 v191, v191, v27
M v[232:235], a[116:119], a[172:175], v[232:235]
 v_sub_f32 v192, v192, v27
 v_sub_f32 v193, v193, v27
M v[232:235], a[112:115], a[168:171], v[232:235]
 v_sub_f32 v194, v194, v27
 v_sub_f32 v195, v195, v27
M v[228:231], a[104:107], a[168:171], v[228:231]
 v_sub_f32 v196, v196, v27
 v_sub_f32 v197, v197, v27
M v[228:231], a[108:111], a[172:175], v[228:231]
 s_waitcnt lgkmcnt(0)
 v_sub_f32 v198, v198, v27
 v_sub_f32 v199, v199, v27
M v[224:227], a[100:103], a[172:175], v[224:227]
 v_sub_f32 v200, v200, v27
 v_sub_f32 v201, v201, v27
M v[224:227], a[96:99], a[168:171], v[224:227]
 v_sub_f32 v202, v202, v27
 v_sub_f32 v203, v203, v27
M a[0:3], a[32:35], a[160:163], a[0:3]
 ds_read_b128 a[168:171], v5 offset:2048
 ds_read_b128 a[172:175], v6 offset:2048
M a[0:3], a[36:39], a[164:167], a[0:3]
 ds_read_b64_tr_b16 a[96:97], v1 offset:32768
 ds_read_b64_tr_b16 a[98:99], v1 offset:33792
M a[4:7], a[44:47], a[164:167], a[4:7]
 s_add_u32 m0, s24, 49152
 v_lshrrev_b32 v28, 4, v0
 v_add_u32 v28, 0, v28
M a[4:7], a[40:43], a[160:163], a[4:7]
 buffer_load_dwordx4 v12, s[48:51], s22 offen offset:0   lds
M a[8:11], a[48:51], a[160:163], a[8:11]
 v_and_b32 v29, 7, v0
 v_xor_b32 v28, v28, v29
M a[8:11], a[52:55], a[164:167], a[8:11]
 v_lshlrev_b32 v28, 4, v28
 v_lshrrev_b32 v29, 3, v0
M a[12:15], a[60:63], a[164:167], a[12:15]
 ds_read_b64_tr_b16 a[100:101], v1 offset:40960
 ds_read_b64_tr_b16 a[102:103], v1 offset:41984
M a[12:15], a[56:59], a[160:163], a[12:15]
 buffer_load_dwordx4 v13, s[48:51], s22 offen offset:1024   lds
M a[16:19], a[64:67], a[160:163], a[16:19]
 v_mul_u32_u24 v29, 896, v29
 s_mul_i32 s64, s20, 28672
M a[16:19], a[68:71], a[164:167], a[16:19]
 buffer_load_dwordx4 v14, s[48:51], s22 offen offset:2048   lds
M a[20:23], a[76:79], a[164:167], a[20:23]
 s_add_u32 s64, s64, 0
 v_add3_u32 v16, v29, v28, s64
M a[20:23], a[72:75], a[160:163], a[20:23]
 ds_read_b64_tr_b16 a[104:105], v2 offset:32768
 ds_read_b64_tr_b16 a[106:107], v2 offset:33792
M a[24:27], a[80:83], a[160:163], a[24:27]
 v_add_u32 v18, 12288, v16
 v_lshrrev_b32 v28, 4, v0
M a[24:27], a[84:87], a[164:167], a[24:27]
 s_waitcnt lgkmcnt(6)
 v_add_u32 v28, 4, v28
 v_and_b32 v29, 7, v0
M a[28:31], a[92:95], a[164:167], a[28:31]
 buffer_load_dwordx4 v15, s[48:51], s22 offen offset:3072   lds
M a[28:31], a[88:91], a[160:163], a[28:31]
 s_sub_u32 s22, s22, 2097024
 v_xor_b32 v28, v28, v29
 v_lshlrev_b32 v28, 4, v28
M v[60:63], a[88:91], a[168:171], v[60:63]
 s_add_u32 m0, s23, 16384
 ds_read_b128 a[160:163], v5 offset:4096
 ds_read_b128 a[164:167], v6 offset:4096
M v[60:63], a[92:95], a[172:175], v[60:63]
 ds_read_b64_tr_b16 a[108:109], v2 offset:40960
 ds_read_b64_tr_b16 a[110:111], v2 offset:41984
M v[56:59], a[84:87], a[172:175], v[56:59]
 buffer_load_dwordx4 v8, s[52:55], s28 offen offset:0   lds
M v[56:59], a[80:83], a[168:171], v[56:59]
 v_lshrrev_b32 v29, 3, v0
 v_mul_u32_u24 v29, 896, v29
M v[52:55], a[72:75], a[168:171], v[52:55]
 buffer_load_dwordx4 v9, s[52:55], s28 offen offset:1024   lds
M v[52:55], a[76:79], a[172:175], v[52:55]
 ds_read_b64_tr_b16 a[112:113], v3 offset:32768
 ds_read_b64_tr_b16 a[114:115], v3 offset:33792
M v[48:51], a[68:71], a[172:175], v[48:51]
 s_mul_i32 s64, s20, 28672
 s_add_u32 s64, s64, 6144
M v[48:51], a[64:67], a[168:171], v[48:51]
 buffer_load_dwordx4 v10, s[52:55], s28 offen offset:2048   lds
M v[44:47], a[56:59], a[168:171], v[44:47]
 v_add3_u32 v17, v29, v28, s64
 v_add_u32 v19, 12288, v17
M v[44:47], a[60:63], a[172:175], v[44:47]
 v_add_u32 v20, 0x20000, v1
 v_add_u32 v21, 0x20000, v2
M v[40:43], a[52:55], a[172:175], v[40:43]
 ds_read_b64_tr_b16 a[116:117], v3 offset:40960
 ds_read_b64_tr_b16 a[118:119], v3 offset:41984
M v[40:43], a[48:51], a[168:171], v[40:43]
 buffer_load_dwordx4 v11, s[52:55], s28 offen offset:3072   lds
M v[36:39], a[40:43], a[168:171], v[36:39]
 s_add_u32 s28, s28, 1048448
 v_add_u32 v22, 0x20000, v3
 v_add_u32 v23, 0x20000, v4
M v[36:39], a[44:47], a[172:175], v[36:39]
 s_waitcnt lgkmcnt(6)
 v_sub_f32 v204, v204, v27
 v_sub_f32 v205, v205, v27
M v[32:35], a[36:39], a[172:175], v[32:35]
 s_add_u32 m0, s23, 131072
 v_sub_f32 v206, v206, v27
 v_sub_f32 v207, v207, v27
M v[32:35], a[32:35], a[168:171], v[32:35]
 ds_read_b64_tr_b16 a[120:121], v4 offset:32768
 ds_read_b64_tr_b16 a[122:123], v4 offset:33792
M v[64:67], a[32:35], a[160:163], v[64:67]
 ds_read_b128 a[168:171], v5 offset:6144
 ds_read_b128 a[172:175], v6 offset:6144
M v[64:67], a[36:39], a[164:167], v[64:67]
 buffer_load_dwordx4 v8, s[52:55], s28 offen offset:0   lds
M v[68:71], a[44:47], a[164:167], v[68:71]
 buffer_load_dwordx4 v9, s[52:55], s28 offen offset:1024   lds
M v[68:71], a[40:43], a[160:163], v[68:71]
 v_sub_f32 v208, v208, v27
 v_sub_f32 v209, v209, v27
M v[72:75], a[48:51], a[160:163], v[72:75]
 ds_read_b64_tr_b16 a[124:125], v4 offset:40960
 ds_read_b64_tr_b16 a[126:127], v4 offset:41984
M v[72:75], a[52:55], a[164:167], v[72:75]
 buffer_load_dwordx4 v10, s[52:55], s28 offen offset:2048   lds
M v[76:79], a[60:63], a[164:167], v[76:79]
 v_sub_f32 v210, v210, v27
 v_sub_f32 v211, v211, v27
M v[76:79], a[56:59], a[160:163], v[76:79]
 v_sub_f32 v212, v212, v27
 v_sub_f32 v213, v213, v27
M v[80:83], a[64:67], a[160:163], v[80:83]
 buffer_load_dwordx4 v11, s[52:55], s28 offen offset:3072   lds
M v[80:83], a[68:71], a[164:167], v[80:83]
 s_sub_u32 s28, s28, 524288
 v_sub_f32 v214, v214, v27
 v_sub_f32 v215, v215, v27
M v[84:87], a[76:79], a[164:167], v[84:87]
 v_sub_f32 v216, v216, v27
 v_sub_f32 v217, v217, v27
M v[84:87], a[72:75], a[160:163], v[84:87]
 v_sub_f32 v218, v218, v27
 v_sub_f32 v219, v219, v27
M v[88:91], a[80:83], a[160:163], v[88:91]
 v_sub_f32 v220, v220, v27
 v_sub_f32 v221, v221, v27
M v[88:91], a[84:87], a[164:167], v[88:91]
 s_waitcnt lgkmcnt(2)
 v_sub_f32 v222, v222, v27
 v_sub_f32 v223, v223, v27
M v[92:95], a[92:95], a[164:167], v[92:95]
 s_waitcnt vmcnt(21) lgkmcnt(0)
 v_sub_f32 v224, v224, v27
 v_sub_f32 v225, v225, v27
M v[92:95], a[88:91], a[160:163], v[92:95]
 s_barrier
M v[124:127], a[88:91], a[168:171], v[124:127]
 ds_read_b128 a[160:163], v5 offset:16384
 ds_read_b128 a[164:167], v6 offset:16384
M v[124:127], a[92:95], a[172:175], v[124:127]
 v_sub_f32 v226, v226, v27
 v_sub_f32 v227, v227, v27
M v[120:123], a[84:87], a[172:175], v[120:123]
 s_add_u32 m0, s24, 0
 ds_read_b64_tr_b16 a[128:129], v1 offset:49152
 ds_read_b64_tr_b16 a[130:131], v1 offset:50176
M v[120:123], a[80:83], a[168:171], v[120:123]
 buffer_load_dwordx4 v16, s[56:59], s29 offen offset:0   lds
M v[116:119], a[72:75], a[168:171], v[116:119]
 s_mul_i32 s72, s41, 4352
 v_sub_f32 v228, v228, v27
M v[116:119], a[76:79], a[172:175], v[116:119]
 s_add_u32 s46, s72, 104923136
 v_sub_f32 v229, v229, v27
 v_sub_f32 v230, v230, v27
M v[112:115], a[68:71], a[172:175], v[112:115]
 s_lshl_b32 s45, s42, 7
 s_add_u32 s45, s45, s46
 s_sub_u32 s66, 15, s42
M v[112:115], a[64:67], a[168:171], v[112:115]
 buffer_load_dwordx4 v17, s[56:59], s29 offen offset:1024   lds
M v[108:111], a[56:59], a[168:171], v[108:111]
 s_min_u32 s66, s66, s42
 v_sub_f32 v231, v231, v27
M v[108:111], a[60:63], a[172:175], v[108:111]
 s_lshl_b32 s47, s66, 7
 ds_read_b64_tr_b16 a[132:133], v1 offset:57344
 ds_read_b64_tr_b16 a[134:135], v1 offset:58368
M v[104:107], a[52:55], a[172:175], v[104:107]
 s_add_u32 s47, s47, s46
 v_sub_f32 v232, v232, v27
 v_sub_f32 v233, v233, v27
M v[104:107], a[48:51], a[168:171], v[104:107]
 s_add_u32 s47, s47, 2048
 s_lshl2_add_u32 s47, s20, s47
 s_lshl_b32 s65, s41, 3
M v[100:103], a[40:43], a[168:171], v[100:103]
 buffer_load_dwordx4 v18, s[56:59], s29 offen offset:2048   lds
M v[100:103], a[44:47], a[172:175], v[100:103]
 s_waitcnt lgkmcnt(4)
 s_add_u32 s65, s65, s66
 v_sub_f32 v234, v234, v27
M v[96:99], a[36:39], a[172:175], v[96:99]
 s_mul_i32 s34, s65, 73728
 v_sub_f32 v235, v235, v27
 v_sub_f32 v236, v236, v27
M v[96:99], a[32:35], a[168:171], v[96:99]
 s_add_u32 s34, s34, 50331648
 v_sub_f32 v237, v237, v27
 v_sub_f32 v238, v238, v27
M v[128:131], a[32:35], a[160:163], v[128:131]
 s_lshl_b32 s65, s42, 4
 ds_read_b128 a[168:171], v5 offset:18432
 ds_read_b128 a[172:175], v6 offset:18432
M v[128:131], a[36:39], a[164:167], v[128:131]
 s_add_u32 s65, s65, s41
 ds_read_b64_tr_b16 a[136:137], v2 offset:49152
 ds_read_b64_tr_b16 a[138:139], v2 offset:50176
M v[132:135], a[44:47], a[164:167], v[132:135]
 buffer_load_dwordx4 v19, s[56:59], s29 offen offset:3072   lds
M v[132:135], a[40:43], a[160:163], v[132:135]
 s_add_u32 s29, s29, 128
 s_mul_i32 s33, s65, 114688
 v_sub_f32 v239, v239, v27
M v[136:139], a[48:51], a[160:163], v[136:139]
 s_mul_i32 s65, s20, 28672
 s_add_u32 s33, s33, s65
 s_add_u32 s33, s33, 67108864
M v[136:139], a[52:55], a[164:167], v[136:139]
 s_add_u32 m0, s23, 32768
 s_sub_u32 s65, 15, s66
 s_lshl_b32 s65, s65, 16
M v[140:143], a[60:63], a[164:167], v[140:143]
 buffer_load_dwordx4 v8, s[52:55], s28 offen offset:0   lds
M v[140:143], a[56:59], a[160:163], v[140:143]
 ds_read_b64_tr_b16 a[140:141], v2 offset:57344
 ds_read_b64_tr_b16 a[142:143], v2 offset:58368
M v[144:147], a[64:67], a[160:163], v[144:147]
 s_lshl_b32 s64, s41, 20
 v_sub_f32 v240, v240, v27
M v[144:147], a[68:71], a[164:167], v[144:147]
 s_add_u32 s32, s64, s65
 s_lshl_b32 s65, s20, 14
 s_add_u32 s32, s32, s65
M v[148:151], a[76:79], a[164:167], v[148:151]
 buffer_load_dwordx4 v9, s[52:55], s28 offen offset:1024   lds
M v[148:151], a[72:75], a[160:163], v[148:151]
 s_add_u32 s32, s32, 33554432
 v_sub_f32 v241, v241, v27
M v[152:155], a[80:83], a[160:163], v[152:155]
 s_mov_b32 s31, 0x53800000
 s_mov_b32 s40, 1
 s_sub_u32 s64, s42, 10
M v[152:155], a[84:87], a[164:167], v[152:155]
 s_waitcnt lgkmcnt(4)
 s_and_b32 s35, s64, 536870912
 v_sub_f32 v242, v242, v27
M v[156:159], a[92:95], a[164:167], v[156:159]
 ds_read_b64_tr_b16 a[144:145], v3 offset:49152
 ds_read_b64_tr_b16 a[146:147], v3 offset:50176
M v[156:159], a[88:91], a[160:163], v[156:159]
 buffer_load_dwordx4 v10, s[52:55], s28 offen offset:2048   lds
M v[188:191], a[88:91], a[168:171], v[188:191]
 ds_read_b128 a[160:163], v5 offset:20480
 ds_read_b128 a[164:167], v6 offset:20480
M v[188:191], a[92:95], a[172:175], v[188:191]
 v_sub_f32 v243, v243, v27
 v_sub_f32 v244, v244, v27
M v[184:187], a[84:87], a[172:175], v[184:187]
 v_sub_f32 v245, v245, v27
 v_sub_f32 v246, v246, v27
M v[184:187], a[80:83], a[168:171], v[184:187]
 v_sub_f32 v247, v247, v27
 v_sub_f32 v248, v248, v27
M v[180:183], a[72:75], a[168:171], v[180:183]
 buffer_load_dwordx4 v11, s[52:55], s28 offen offset:3072   lds
M v[180:183], a[76:79], a[172:175], v[180:183]
 s_add_u32 s28, s28, 524416
 ds_read_b64_tr_b16 a[148:149], v3 offset:57344
 ds_read_b64_tr_b16 a[150:151], v3 offset:58368
M v[176:179], a[68:71], a[172:175], v[176:179]
 v_sub_f32 v249, v249, v27
 v_sub_f32 v250, v250, v27
M v[176:179], a[64:67], a[168:171], v[176:179]
 v_sub_f32 v251, v251, v27
 v_sub_f32 v252, v252, v27
M v[172:175], a[56:59], a[168:171], v[172:175]
 s_add_u32 m0, s23, 147456
 v_sub_f32 v253, v253, v27
 v_sub_f32 v254, v254, v27
M v[172:175], a[60:63], a[172:175], v[172:175]
 buffer_load_dwordx4 v8, s[52:55], s28 offen offset:0   lds
M v[168:171], a[52:55], a[172:175], v[168:171]
 v_sub_f32 v255, v255, v27
M v[168:171], a[48:51], a[168:171], v[168:171]
M v[164:167], a[40:43], a[168:171], v[164:167]
 ds_read_b64_tr_b16 a[152:153], v4 offset:49152
 ds_read_b64_tr_b16 a[154:155], v4 offset:50176
M v[164:167], a[44:47], a[172:175], v[164:167]
 s_waitcnt lgkmcnt(4)
M v[160:163], a[36:39], a[172:175], v[160:163]
 buffer_load_dwordx4 v9, s[52:55], s28 offen offset:1024   lds
M v[160:163], a[32:35], a[168:171], v[160:163]
M v[192:195], a[32:35], a[160:163], v[192:195]
 ds_read_b128 a[168:171], v5 offset:22528
 ds_read_b128 a[172:175], v6 offset:22528
M v[192:195], a[36:39], a[164:167], v[192:195]
M v[196:199], a[44:47], a[164:167], v[196:199]
 buffer_load_dwordx4 v10, s[52:55], s28 offen offset:2048   lds
M v[196:199], a[40:43], a[160:163], v[196:199]
 ds_read_b64_tr_b16 a[156:157], v4 offset:57344
 ds_read_b64_tr_b16 a[158:159], v4 offset:58368
M v[200:203], a[48:51], a[160:163], v[200:203]
M v[200:203], a[52:55], a[164:167], v[200:203]
M v[204:207], a[60:63], a[164:167], v[204:207]
M v[204:207], a[56:59], a[160:163], v[204:207]
 buffer_load_dwordx4 v11, s[52:55], s28 offen offset:3072   lds
M v[208:211], a[64:67], a[160:163], v[208:211]
 s_sub_u32 s28, s28, 524288
M v[208:211], a[68:71], a[164:167], v[208:211]
M v[212:215], a[76:79], a[164:167], v[212:215]
M v[212:215], a[72:75], a[160:163], v[212:215]
M v[216:219], a[80:83], a[160:163], v[216:219]
M v[216:219], a[84:87], a[164:167], v[216:219]
 s_waitcnt lgkmcnt(2)
M v[220:223], a[92:95], a[164:167], v[220:223]
 s_waitcnt vmcnt(25) lgkmcnt(0)
M v[220:223], a[88:91], a[160:163], v[220:223]
 s_barrier
M v[252:255], a[88:91], a[168:171], v[252:255]
 ds_read_b128 a[160:163], v5 offset:32768
 ds_read_b128 a[164:167], v6 offset:32768
M v[252:255], a[92:95], a[172:175], v[252:255]
M v[248:251], a[84:87], a[172:175], v[248:251]
M v[248:251], a[80:83], a[168:171], v[248:251]
M v[244:247], a[72:75], a[168:171], v[244:247]
M v[244:247], a[76:79], a[172:175], v[244:247]
M v[240:243], a[68:71], a[172:175], v[240:243]
M v[240:243], a[64:67], a[168:171], v[240:243]
M v[236:239], a[56:59], a[168:171], v[236:239]
M v[236:239], a[60:63], a[172:175], v[236:239]
M v[232:235], a[52:55], a[172:175], v[232:235]
M v[232:235], a[48:51], a[168:171], v[232:235]
M v[228:231], a[40:43], a[168:171], v[228:231]
M v[228:231], a[44:47], a[172:175], v[228:231]
 s_waitcnt lgkmcnt(0)
M v[224:227], a[36:39], a[172:175], v[224:227]
M v[224:227], a[32:35], a[168:171], v[224:227]
M a[0:3], a[96:99], a[160:163], a[0:3]
 ds_read_b128 a[168:171], v5 offset:34816
 ds_read_b128 a[172:175], v6 offset:34816
M a[0:3], a[100:103], a[164:167], a[0:3]
 ds_read_b64_tr_b16 a[32:33], v1 offset:0
 ds_read_b64_tr_b16 a[34:35], v1 offset:1024
M a[4:7], a[108:111], a[164:167], a[4:7]
 s_add_u32 m0, s24, 16384
M a[4:7], a[104:107], a[160:163], a[4:7]
 buffer_load_dwordx4 v16, s[56:59], s29 offen offset:0   lds
M a[8:11], a[112:115], a[160:163], a[8:11]
M a[8:11], a[116:119], a[164:167], a[8:11]
M a[12:15], a[124:127], a[164:167], a[12:15]
 ds_read_b64_tr_b16 a[36:37], v1 offset:8192
 ds_read_b64_tr_b16 a[38:39], v1 offset:9216
M a[12:15], a[120:123], a[160:163], a[12:15]
M a[16:19], a[128:131], a[160:163], a[16:19]
 buffer_load_dwordx4 v17, s[56:59], s29 offen offset:1024   lds
M a[16:19], a[132:135], a[164:167], a[16:19]
 v_accvgpr_read_b32 v24, a0
 v_accvgpr_read_b32 v25, a1
M a[20:23], a[140:143], a[164:167], a[20:23]
 v_accvgpr_read_b32 v26, a2
 v_accvgpr_read_b32 v27, a3
M a[20:23], a[136:139], a[160:163], a[20:23]
 ds_read_b64_tr_b16 a[40:41], v2 offset:0
 ds_read_b64_tr_b16 a[42:43], v2 offset:1024
M a[24:27], a[144:147], a[160:163], a[24:27]
 v_accvgpr_read_b32 v28, a4
 v_accvgpr_read_b32 v29, a5
M a[24:27], a[148:151], a[164:167], a[24:27]
 s_waitcnt lgkmcnt(6)
 buffer_load_dwordx4 v18, s[56:59], s29 offen offset:2048   lds
M a[28:31], a[156:159], a[164:167], a[28:31]
 v_accvgpr_read_b32 v30, a6
 v_accvgpr_read_b32 v31, a7
M a[28:31], a[152:155], a[160:163], a[28:31]
 v_cvt_pk_bf16_f32 v24, v24, v25
 v_cvt_pk_bf16_f32 v25, v26, v27
M v[32:35], a[96:99], a[168:171], v[32:35]
 ds_read_b128 a[160:163], v5 offset:36864
 ds_read_b128 a[164:167], v6 offset:36864
M v[32:35], a[100:103], a[172:175], v[32:35]
 ds_read_b64_tr_b16 a[44:45], v2 offset:8192
 ds_read_b64_tr_b16 a[46:47], v2 offset:9216
M v[36:39], a[108:111], a[172:175], v[36:39]
 buffer_load_dwordx4 v19, s[56:59], s29 offen offset:3072   lds
M v[36:39], a[104:107], a[168:171], v[36:39]
 s_add_u32 s29, s29, 128
 v_cvt_pk_bf16_f32 v26, v28, v29
 v_cvt_pk_bf16_f32 v27, v30, v31
M v[40:43], a[112:115], a[168:171], v[40:43]
 s_add_u32 s3, s93, 0
 buffer_store_dwordx4 v[24:27], v7, s[8:11], s3 offen offset:0 sc1
M v[40:43], a[116:119], a[172:175], v[40:43]
 ds_read_b64_tr_b16 a[48:49], v3 offset:0
 ds_read_b64_tr_b16 a[50:51], v3 offset:1024
M v[44:47], a[124:127], a[172:175], v[44:47]
 s_add_u32 m0, s23, 49152
 v_accvgpr_read_b32 v24, a8
 v_accvgpr_read_b32 v25, a9
M v[44:47], a[120:123], a[168:171], v[44:47]
 buffer_load_dwordx4 v8, s[52:55], s28 offen offset:0   lds
M v[48:51], a[128:131], a[168:171], v[48:51]
 v_accvgpr_read_b32 v26, a10
 v_accvgpr_read_b32 v27, a11
M v[48:51], a[132:135], a[172:175], v[48:51]
 v_accvgpr_read_b32 v28, a12
 v_accvgpr_read_b32 v29, a13
M v[52:55], a[140:143], a[172:175], v[52:55]
 ds_read_b64_tr_b16 a[52:53], v3 offset:8192
 ds_read_b64_tr_b16 a[54:55], v3 offset:9216
M v[52:55], a[136:139], a[168:171], v[52:55]
 v_accvgpr_read_b32 v30, a14
 v_accvgpr_read_b32 v31, a15
M v[56:59], a[144:147], a[168:171], v[56:59]
 buffer_load_dwordx4 v9, s[52:55], s28 offen offset:1024   lds
M v[56:59], a[148:151], a[172:175], v[56:59]
 s_waitcnt lgkmcnt(6)
 v_cvt_pk_bf16_f32 v24, v24, v25
 v_cvt_pk_bf16_f32 v25, v26, v27
M v[60:63], a[156:159], a[172:175], v[60:63]
 v_cvt_pk_bf16_f32 v26, v28, v29
 v_cvt_pk_bf16_f32 v27, v30, v31
M v[60:63], a[152:155], a[168:171], v[60:63]
 ds_read_b64_tr_b16 a[56:57], v4 offset:0
 ds_read_b64_tr_b16 a[58:59], v4 offset:1024
M v[64:67], a[96:99], a[160:163], v[64:67]
 ds_read_b128 a[168:171], v5 offset:38912
 ds_read_b128 a[172:175], v6 offset:38912
M v[64:67], a[100:103], a[164:167], v[64:67]
 buffer_load_dwordx4 v10, s[52:55], s28 offen offset:2048   lds
M v[68:71], a[108:111], a[164:167], v[68:71]
M v[68:71], a[104:107], a[160:163], v[68:71]
 buffer_store_dwordx4 v[24:27], v7, s[8:11], s3 offen offset:1024 sc1
M v[72:75], a[112:115], a[160:163], v[72:75]
 ds_read_b64_tr_b16 a[60:61], v4 offset:8192
 ds_read_b64_tr_b16 a[62:63], v4 offset:9216
M v[72:75], a[116:119], a[164:167], v[72:75]
 v_accvgpr_read_b32 v24, a16
 v_accvgpr_read_b32 v25, a17
M v[76:79], a[124:127], a[164:167], v[76:79]
 buffer_load_dwordx4 v11, s[52:55], s28 offen offset:3072   lds
M v[76:79], a[120:123], a[160:163], v[76:79]
 s_add_u32 s28, s28, 1048448
 v_accvgpr_read_b32 v26, a18
 v_accvgpr_read_b32 v27, a19
M v[80:83], a[128:131], a[160:163], v[80:83]
 v_accvgpr_read_b32 v28, a20
 v_accvgpr_read_b32 v29, a21
M v[80:83], a[132:135], a[164:167], v[80:83]
 v_accvgpr_read_b32 v30, a22
 v_accvgpr_read_b32 v31, a23
M v[84:87], a[140:143], a[164:167], v[84:87]
 v_cvt_pk_bf16_f32 v24, v24, v25
 v_cvt_pk_bf16_f32 v25, v26, v27
M v[84:87], a[136:139], a[160:163], v[84:87]
 v_cvt_pk_bf16_f32 v26, v28, v29
 v_cvt_pk_bf16_f32 v27, v30, v31
M v[88:91], a[144:147], a[160:163], v[88:91]
 buffer_store_dwordx4 v[24:27], v7, s[8:11], s3 offen offset:2048 sc1
M v[88:91], a[148:151], a[164:167], v[88:91]
 s_waitcnt lgkmcnt(2)
 v_accvgpr_read_b32 v24, a24
 v_accvgpr_read_b32 v25, a25
M v[92:95], a[156:159], a[164:167], v[92:95]
 s_waitcnt vmcnt(27) lgkmcnt(0)
 v_accvgpr_read_b32 v26, a26
 v_accvgpr_read_b32 v27, a27
M v[92:95], a[152:155], a[160:163], v[92:95]
 s_barrier
M v[96:99], a[96:99], a[168:171], v[96:99]
 ds_read_b128 a[160:163], v5 offset:49152
 ds_read_b128 a[164:167], v6 offset:49152
M v[96:99], a[100:103], a[172:175], v[96:99]
 v_accvgpr_read_b32 v28, a28
 v_accvgpr_read_b32 v29, a29
M v[100:103], a[108:111], a[172:175], v[100:103]
 s_add_u32 m0, s24, 32768
 ds_read_b64_tr_b16 a[64:65], v1 offset:16384
 ds_read_b64_tr_b16 a[66:67], v1 offset:17408
M v[100:103], a[104:107], a[168:171], v[100:103]
 buffer_load_dwordx4 v16, s[56:59], s29 offen offset:0   lds
M v[104:107], a[112:115], a[168:171], v[104:107]
 v_accvgpr_read_b32 v30, a30
 v_accvgpr_read_b32 v31, a31
M v[104:107], a[116:119], a[172:175], v[104:107]
 v_cvt_pk_bf16_f32 v24, v24, v25
 v_cvt_pk_bf16_f32 v25, v26, v27
M v[108:111], a[124:127], a[172:175], v[108:111]
 v_cvt_pk_bf16_f32 v26, v28, v29
 v_cvt_pk_bf16_f32 v27, v30, v31
M v[108:111], a[120:123], a[168:171], v[108:111]
 buffer_store_dwordx4 v[24:27], v7, s[8:11], s3 offen offset:3072 sc1
M v[112:115], a[128:131], a[168:171], v[112:115]
 v_cvt_pk_bf16_f32 v32, v32, v33
 v_cvt_pk_bf16_f32 v33, v34, v35
M v[112:115], a[132:135], a[172:175], v[112:115]
 ds_read_b64_tr_b16 a[68:69], v1 offset:24576
 ds_read_b64_tr_b16 a[70:71], v1 offset:25600
M v[116:119], a[140:143], a[172:175], v[116:119]
 buffer_load_dwordx4 v17, s[56:59], s29 offen offset:1024   lds
M v[116:119], a[136:139], a[168:171], v[116:119]
 v_cvt_pk_bf16_f32 v34, v36, v37
 v_cvt_pk_bf16_f32 v35, v38, v39
M v[120:123], a[144:147], a[168:171], v[120:123]
 v_accvgpr_write_b32 a4, v32
 v_accvgpr_write_b32 a5, v33
M v[120:123], a[148:151], a[172:175], v[120:123]
 s_waitcnt lgkmcnt(4)
 v_accvgpr_write_b32 a6, v34
 v_accvgpr_write_b32 a7, v35
M v[124:127], a[156:159], a[172:175], v[124:127]
 v_cvt_pk_bf16_f32 v40, v40, v41
 v_cvt_pk_bf16_f32 v41, v42, v43
M v[124:127], a[152:155], a[168:171], v[124:127]
 v_cvt_pk_bf16_f32 v42, v44, v45
 v_cvt_pk_bf16_f32 v43, v46, v47
M v[128:131], a[96:99], a[160:163], v[128:131]
 ds_read_b128 a[168:171], v5 offset:51200
 ds_read_b128 a[172:175], v6 offset:51200
M v[128:131], a[100:103], a[164:167], v[128:131]
 ds_read_b64_tr_b16 a[72:73], v2 offset:16384
 ds_read_b64_tr_b16 a[74:75], v2 offset:17408
M v[132:135], a[108:111], a[164:167], v[132:135]
 buffer_load_dwordx4 v18, s[56:59], s29 offen offset:2048   lds
M v[132:135], a[104:107], a[160:163], v[132:135]
 v_accvgpr_write_b32 a12, v40
 v_accvgpr_write_b32 a13, v41
M v[136:139], a[112:115], a[160:163], v[136:139]
 v_accvgpr_write_b32 a14, v42
 v_accvgpr_write_b32 a15, v43
M v[136:139], a[116:119], a[164:167], v[136:139]
 v_cvt_pk_bf16_f32 v48, v48, v49
 v_cvt_pk_bf16_f32 v49, v50, v51
M v[140:143], a[124:127], a[164:167], v[140:143]
 v_cvt_pk_bf16_f32 v50, v52, v53
 v_cvt_pk_bf16_f32 v51, v54, v55
M v[140:143], a[120:123], a[160:163], v[140:143]
 ds_read_b64_tr_b16 a[76:77], v2 offset:24576
 ds_read_b64_tr_b16 a[78:79], v2 offset:25600
M v[144:147], a[128:131], a[160:163], v[144:147]
 buffer_load_dwordx4 v19, s[56:59], s29 offen offset:3072   lds
M v[144:147], a[132:135], a[164:167], v[144:147]
 s_add_u32 s29, s29, 128
 v_accvgpr_write_b32 a20, v48
 v_accvgpr_write_b32 a21, v49
M v[148:151], a[140:143], a[164:167], v[148:151]
 v_accvgpr_write_b32 a22, v50
 v_accvgpr_write_b32 a23, v51
M v[148:151], a[136:139], a[160:163], v[148:151]
 v_cvt_pk_bf16_f32 v56, v56, v57
 v_cvt_pk_bf16_f32 v57, v58, v59
M v[152:155], a[144:147], a[160:163], v[152:155]
 v_cvt_pk_bf16_f32 v58, v60, v61
 v_cvt_pk_bf16_f32 v59, v62, v63
M v[152:155], a[148:151], a[164:167], v[152:155]
 s_waitcnt lgkmcnt(4)
 v_accvgpr_write_b32 a28, v56
 v_accvgpr_write_b32 a29, v57
M v[156:159], a[156:159], a[164:167], v[156:159]
 s_add_u32 m0, s23, 0
 ds_read_b64_tr_b16 a[80:81], v3 offset:16384
 ds_read_b64_tr_b16 a[82:83], v3 offset:17408
M v[156:159], a[152:155], a[160:163], v[156:159]
 buffer_load_dwordx4 v8, s[52:55], s28 offen offset:0   lds
M v[160:163], a[96:99], a[168:171], v[160:163]
 ds_read_b128 a[160:163], v5 offset:53248
 ds_read_b128 a[164:167], v6 offset:53248
M v[160:163], a[100:103], a[172:175], v[160:163]
 v_accvgpr_write_b32 a30, v58
 v_accvgpr_write_b32 a31, v59
M v[164:167], a[108:111], a[172:175], v[164:167]
 v_cvt_pk_bf16_f32 v64, v64, v65
 v_cvt_pk_bf16_f32 v65, v66, v67
M v[164:167], a[104:107], a[168:171], v[164:167]
 v_cvt_pk_bf16_f32 v66, v68, v69
 v_cvt_pk_bf16_f32 v67, v70, v71
M v[168:171], a[112:115], a[168:171], v[168:171]
 v_cvt_pk_bf16_f32 v72, v72, v73
 v_cvt_pk_bf16_f32 v73, v74, v75
M v[168:171], a[116:119], a[172:175], v[168:171]
 ds_read_b64_tr_b16 a[84:85], v3 offset:24576
 ds_read_b64_tr_b16 a[86:87], v3 offset:25600
M v[172:175], a[124:127], a[172:175], v[172:175]
 buffer_load_dwordx4 v9, s[52:55], s28 offen offset:1024   lds
M v[172:175], a[120:123], a[168:171], v[172:175]
 v_cvt_pk_bf16_f32 v74, v76, v77
 v_cvt_pk_bf16_f32 v75, v78, v79
M v[176:179], a[128:131], a[168:171], v[176:179]
 v_cvt_pk_bf16_f32 v80, v80, v81
 v_cvt_pk_bf16_f32 v81, v82, v83
M v[176:179], a[132:135], a[172:175], v[176:179]
 v_cvt_pk_bf16_f32 v82, v84, v85
 v_cvt_pk_bf16_f32 v83, v86, v87
M v[180:183], a[140:143], a[172:175], v[180:183]
 v_cvt_pk_bf16_f32 v88, v88, v89
 v_cvt_pk_bf16_f32 v89, v90, v91
M v[180:183], a[136:139], a[168:171], v[180:183]
 v_cvt_pk_bf16_f32 v90, v92, v93
 v_cvt_pk_bf16_f32 v91, v94, v95
M v[184:187], a[144:147], a[168:171], v[184:187]
 ds_read_b64_tr_b16 a[88:89], v4 offset:16384
 ds_read_b64_tr_b16 a[90:91], v4 offset:17408
M v[184:187], a[148:151], a[172:175], v[184:187]
 s_waitcnt lgkmcnt(4)
 buffer_load_dwordx4 v10, s[52:55], s28 offen offset:2048   lds
M v[188:191], a[156:159], a[172:175], v[188:191]
 v_cvt_pk_bf16_f32 v96, v96, v97
 v_cvt_pk_bf16_f32 v97, v98, v99
M v[188:191], a[152:155], a[168:171], v[188:191]
 v_cvt_pk_bf16_f32 v98, v100, v101
 v_cvt_pk_bf16_f32 v99, v102, v103
M v[192:195], a[96:99], a[160:163], v[192:195]
 ds_read_b128 a[168:171], v5 offset:55296
 ds_read_b128 a[172:175], v6 offset:55296
M v[192:195], a[100:103], a[164:167], v[192:195]
 v_cvt_pk_bf16_f32 v104, v104, v105
 v_cvt_pk_bf16_f32 v105, v106, v107
M v[196:199], a[108:111], a[164:167], v[196:199]
 v_cvt_pk_bf16_f32 v106, v108, v109
 v_cvt_pk_bf16_f32 v107, v110, v111
M v[196:199], a[104:107], a[160:163], v[196:199]
 ds_read_b64_tr_b16 a[92:93], v4 offset:24576
 ds_read_b64_tr_b16 a[94:95], v4 offset:25600
M v[200:203], a[112:115], a[160:163], v[200:203]
 buffer_load_dwordx4 v11, s[52:55], s28 offen offset:3072   lds
M v[200:203], a[116:119], a[164:167], v[200:203]
 s_add_u32 s28, s28, 128
 v_cvt_pk_bf16_f32 v112, v112, v113
 v_cvt_pk_bf16_f32 v113, v114, v115
M v[204:207], a[124:127], a[164:167], v[204:207]
 v_cvt_pk_bf16_f32 v114, v116, v117
 v_cvt_pk_bf16_f32 v115, v118, v119
M v[204:207], a[120:123], a[160:163], v[204:207]
 v_cvt_pk_bf16_f32 v120, v120, v121
 v_cvt_pk_bf16_f32 v121, v122, v123
M v[208:211], a[128:131], a[160:163], v[208:211]
 v_cvt_pk_bf16_f32 v122, v124, v125
 v_cvt_pk_bf16_f32 v123, v126, v127
M v[208:211], a[132:135], a[164:167], v[208:211]
 v_cvt_pk_bf16_f32 v128, v128, v129
 v_cvt_pk_bf16_f32 v129, v130, v131
M v[212:215], a[140:143], a[164:167], v[212:215]
 v_cvt_pk_bf16_f32 v130, v132, v133
 v_cvt_pk_bf16_f32 v131, v134, v135
M v[212:215], a[136:139], a[160:163], v[212:215]
 v_cvt_pk_bf16_f32 v136, v136, v137
 v_cvt_pk_bf16_f32 v137, v138, v139
M v[216:219], a[144:147], a[160:163], v[216:219]
 v_cvt_pk_bf16_f32 v138, v140, v141
 v_cvt_pk_bf16_f32 v139, v142, v143
M v[216:219], a[148:151], a[164:167], v[216:219]
 s_waitcnt lgkmcnt(2)
 v_cvt_pk_bf16_f32 v144, v144, v145
 v_cvt_pk_bf16_f32 v145, v146, v147
M v[220:223], a[156:159], a[164:167], v[220:223]
 s_waitcnt vmcnt(24) lgkmcnt(0)
 v_cvt_pk_bf16_f32 v146, v148, v149
 v_cvt_pk_bf16_f32 v147, v150, v151
M v[220:223], a[152:155], a[160:163], v[220:223]
 s_barrier
M v[224:227], a[96:99], a[168:171], v[224:227]
 ds_read_b128 a[160:163], v5 offset:0
 ds_read_b128 a[164:167], v6 offset:0
M v[224:227], a[100:103], a[172:175], v[224:227]
 v_cvt_pk_bf16_f32 v152, v152, v153
 v_cvt_pk_bf16_f32 v153, v154, v155
M v[228:231], a[108:111], a[172:175], v[228:231]
 v_cvt_pk_bf16_f32 v154, v156, v157
 v_cvt_pk_bf16_f32 v155, v158, v159
M v[228:231], a[104:107], a[168:171], v[228:231]
 v_cvt_pk_bf16_f32 v160, v160, v161
 v_cvt_pk_bf16_f32 v161, v162, v163
M v[232:235], a[112:115], a[168:171], v[232:235]
 v_cvt_pk_bf16_f32 v162, v164, v165
 v_cvt_pk_bf16_f32 v163, v166, v167
M v[232:235], a[116:119], a[172:175], v[232:235]
 v_cvt_pk_bf16_f32 v168, v168, v169
 v_cvt_pk_bf16_f32 v169, v170, v171
M v[236:239], a[124:127], a[172:175], v[236:239]
 v_cvt_pk_bf16_f32 v170, v172, v173
 v_cvt_pk_bf16_f32 v171, v174, v175
M v[236:239], a[120:123], a[168:171], v[236:239]
 v_cvt_pk_bf16_f32 v176, v176, v177
 v_cvt_pk_bf16_f32 v177, v178, v179
M v[240:243], a[128:131], a[168:171], v[240:243]
 v_cvt_pk_bf16_f32 v178, v180, v181
 v_cvt_pk_bf16_f32 v179, v182, v183
M v[240:243], a[132:135], a[172:175], v[240:243]
 v_cvt_pk_bf16_f32 v184, v184, v185
 v_cvt_pk_bf16_f32 v185, v186, v187
M v[244:247], a[140:143], a[172:175], v[244:247]
 v_cvt_pk_bf16_f32 v186, v188, v189
 v_cvt_pk_bf16_f32 v187, v190, v191
M v[244:247], a[136:139], a[168:171], v[244:247]
 v_cvt_pk_bf16_f32 v192, v192, v193
 v_cvt_pk_bf16_f32 v193, v194, v195
M v[248:251], a[144:147], a[168:171], v[248:251]
 v_cvt_pk_bf16_f32 v194, v196, v197
 v_cvt_pk_bf16_f32 v195, v198, v199
M v[248:251], a[148:151], a[172:175], v[248:251]
 s_waitcnt lgkmcnt(0)
 v_cvt_pk_bf16_f32 v200, v200, v201
 v_cvt_pk_bf16_f32 v201, v202, v203
M v[252:255], a[156:159], a[172:175], v[252:255]
 v_cvt_pk_bf16_f32 v202, v204, v205
 v_cvt_pk_bf16_f32 v203, v206, v207
M v[252:255], a[152:155], a[168:171], v[252:255]
 v_cvt_pk_bf16_f32 v208, v208, v209
 v_cvt_pk_bf16_f32 v209, v210, v211
M v[32:35], a[32:35], a[160:163], 0
 s_add_u32 m0, s23, 16384
 ds_read_b128 a[168:171], v5 offset:2048
 ds_read_b128 a[172:175], v6 offset:2048
M v[32:35], a[36:39], a[164:167], v[32:35]
 ds_read_b64_tr_b16 a[96:97], v1 offset:32768
 ds_read_b64_tr_b16 a[98:99], v1 offset:33792
M v[36:39], a[44:47], a[164:167], 0
 buffer_load_dwordx4 v8, s[52:55], s28 offen offset:0   lds
M v[36:39], a[40:43], a[160:163], v[36:39]
 v_cvt_pk_bf16_f32 v210, v212, v213
 v_cvt_pk_bf16_f32 v211, v214, v215
M v[40:43], a[48:51], a[160:163], 0
 ds_read_b64_tr_b16 a[100:101], v1 offset:40960
 ds_read_b64_tr_b16 a[102:103], v1 offset:41984
M v[40:43], a[52:55], a[164:167], v[40:43]
 buffer_load_dwordx4 v9, s[52:55], s28 offen offset:1024   lds
M v[44:47], a[60:63], a[164:167], 0
 v_cvt_pk_bf16_f32 v216, v216, v217
 v_cvt_pk_bf16_f32 v217, v218, v219
M v[44:47], a[56:59], a[160:163], v[44:47]
 ds_read_b64_tr_b16 a[104:105], v2 offset:32768
 ds_read_b64_tr_b16 a[106:107], v2 offset:33792
M v[48:51], a[64:67], a[160:163], 0
 v_cvt_pk_bf16_f32 v218, v220, v221
 v_cvt_pk_bf16_f32 v219, v222, v223
M v[48:51], a[68:71], a[164:167], v[48:51]
 v_cvt_pk_bf16_f32 v224, v224, v225
 v_cvt_pk_bf16_f32 v225, v226, v227
M v[52:55], a[76:79], a[164:167], 0
 ds_read_b64_tr_b16 a[108:109], v2 offset:40960
 ds_read_b64_tr_b16 a[110:111], v2 offset:41984
M v[52:55], a[72:75], a[160:163], v[52:55]
 buffer_load_dwordx4 v10, s[52:55], s28 offen offset:2048   lds
M v[56:59], a[80:83], a[160:163], 0
 v_cvt_pk_bf16_f32 v226, v228, v229
 v_cvt_pk_bf16_f32 v227, v230, v231
M v[56:59], a[84:87], a[164:167], v[56:59]
 s_waitcnt lgkmcnt(8)
 ds_read_b64_tr_b16 a[112:113], v3 offset:32768
 ds_read_b64_tr_b16 a[114:115], v3 offset:33792
M v[60:63], a[92:95], a[164:167], 0
 v_cvt_pk_bf16_f32 v232, v232, v233
 v_cvt_pk_bf16_f32 v233, v234, v235
M v[60:63], a[88:91], a[160:163], v[60:63]
 buffer_load_dwordx4 v11, s[52:55], s28 offen offset:3072   lds
M v[68:71], a[32:35], a[168:171], 0
 s_add_u32 s28, s28, 524160
 ds_read_b128 a[160:163], v5 offset:4096
 ds_read_b128 a[164:167], v6 offset:4096
M v[68:71], a[36:39], a[172:175], v[68:71]
 ds_read_b64_tr_b16 a[116:117], v3 offset:40960
 ds_read_b64_tr_b16 a[118:119], v3 offset:41984
M v[76:79], a[44:47], a[172:175], 0
 v_cvt_pk_bf16_f32 v234, v236, v237
 v_cvt_pk_bf16_f32 v235, v238, v239
M v[76:79], a[40:43], a[168:171], v[76:79]
 s_add_u32 m0, s24, 49152
 ds_read_b64_tr_b16 a[120:121], v4 offset:32768
 ds_read_b64_tr_b16 a[122:123], v4 offset:33792
M v[84:87], a[48:51], a[168:171], 0
 buffer_load_dwordx4 v16, s[56:59], s29 offen offset:0   lds
M v[84:87], a[52:55], a[172:175], v[84:87]
 v_cvt_pk_bf16_f32 v240, v240, v241
 v_cvt_pk_bf16_f32 v241, v242, v243
M v[92:95], a[60:63], a[172:175], 0
 ds_read_b64_tr_b16 a[124:125], v4 offset:40960
 ds_read_b64_tr_b16 a[126:127], v4 offset:41984
M v[92:95], a[56:59], a[168:171], v[92:95]
 v_cvt_pk_bf16_f32 v242, v244, v245
 v_cvt_pk_bf16_f32 v243, v246, v247
M v[100:103], a[64:67], a[168:171], 0
 v_cvt_pk_bf16_f32 v248, v248, v249
 v_cvt_pk_bf16_f32 v249, v250, v251
M v[100:103], a[68:71], a[172:175], v[100:103]
 buffer_load_dwordx4 v17, s[56:59], s29 offen offset:1024   lds
M v[108:111], a[76:79], a[172:175], 0
 v_cvt_pk_bf16_f32 v250, v252, v253
 v_cvt_pk_bf16_f32 v251, v254, v255
M v[108:111], a[72:75], a[168:171], v[108:111]
 s_add_u32 s3, s93, 8192
 v_mov_b32 v12, 1
 v_or_b32 v15, s20, v0
M v[116:119], a[80:83], a[168:171], 0
 v_min_u32 v15, 1, v15
 v_lshlrev_b32 v15, 29, v15
M v[116:119], a[84:87], a[172:175], v[116:119]
 s_waitcnt lgkmcnt(6)
 buffer_store_dwordx4 a[4:7], v7, s[8:11], s3 offen offset:0 sc1
M v[124:127], a[92:95], a[172:175], 0
 s_waitcnt vmcnt(17) lgkmcnt(0)
 buffer_load_dwordx4 v18, s[56:59], s29 offen offset:2048   lds
M v[124:127], a[88:91], a[168:171], v[124:127]
 s_barrier
M v[132:135], a[32:35], a[160:163], 0
 ds_read_b128 a[168:171], v5 offset:6144
 ds_read_b128 a[172:175], v6 offset:6144
M v[132:135], a[36:39], a[164:167], v[132:135]
 ds_read_b64_tr_b16 a[128:129], v1 offset:49152
 ds_read_b64_tr_b16 a[130:131], v1 offset:50176
M v[140:143], a[44:47], a[164:167], 0
M v[140:143], a[40:43], a[160:163], v[140:143]
 buffer_load_dwordx4 v19, s[56:59], s29 offen offset:3072   lds
M v[148:151], a[48:51], a[160:163], 0
 s_add_u32 s29, s29, 128
 ds_read_b64_tr_b16 a[132:133], v1 offset:57344
 ds_read_b64_tr_b16 a[134:135], v1 offset:58368
M v[148:151], a[52:55], a[164:167], v[148:151]
 buffer_store_dwordx4 a[12:15], v7, s[8:11], s3 offen offset:1024 sc1
M v[156:159], a[60:63], a[164:167], 0
M v[156:159], a[56:59], a[160:163], v[156:159]
 s_add_u32 m0, s23, 32768
 ds_read_b64_tr_b16 a[136:137], v2 offset:49152
 ds_read_b64_tr_b16 a[138:139], v2 offset:50176
M v[164:167], a[64:67], a[160:163], 0
 buffer_load_dwordx4 v8, s[52:55], s28 offen offset:0   lds
M v[164:167], a[68:71], a[164:167], v[164:167]
M v[172:175], a[76:79], a[164:167], 0
 ds_read_b64_tr_b16 a[140:141], v2 offset:57344
 ds_read_b64_tr_b16 a[142:143], v2 offset:58368
M v[172:175], a[72:75], a[160:163], v[172:175]
M v[180:183], a[80:83], a[160:163], 0
M v[180:183], a[84:87], a[164:167], v[180:183]
 s_waitcnt lgkmcnt(8)
 ds_read_b64_tr_b16 a[144:145], v3 offset:49152
 ds_read_b64_tr_b16 a[146:147], v3 offset:50176
M v[188:191], a[92:95], a[164:167], 0
 buffer_load_dwordx4 v9, s[52:55], s28 offen offset:1024   lds
M v[188:191], a[88:91], a[160:163], v[188:191]
M v[196:199], a[32:35], a[168:171], 0
 ds_read_b128 a[160:163], v5 offset:16384
 ds_read_b128 a[164:167], v6 offset:16384
M v[196:199], a[36:39], a[172:175], v[196:199]
 ds_read_b64_tr_b16 a[148:149], v3 offset:57344
 ds_read_b64_tr_b16 a[150:151], v3 offset:58368
M v[204:207], a[44:47], a[172:175], 0
 buffer_load_dwordx4 v10, s[52:55], s28 offen offset:2048   lds
M v[204:207], a[40:43], a[168:171], v[204:207]
 ds_read_b64_tr_b16 a[152:153], v4 offset:49152
 ds_read_b64_tr_b16 a[154:155], v4 offset:50176
M v[212:215], a[48:51], a[168:171], 0
M v[212:215], a[52:55], a[172:175], v[212:215]
M v[220:223], a[60:63], a[172:175], 0
 ds_read_b64_tr_b16 a[156:157], v4 offset:57344
 ds_read_b64_tr_b16 a[158:159], v4 offset:58368
M v[220:223], a[56:59], a[168:171], v[220:223]
 buffer_load_dwordx4 v11, s[52:55], s28 offen offset:3072   lds
M v[228:231], a[64:67], a[168:171], 0
 s_add_u32 s28, s28, 128
M v[228:231], a[68:71], a[172:175], v[228:231]
M v[236:239], a[76:79], a[172:175], 0
M v[236:239], a[72:75], a[168:171], v[236:239]
M v[244:247], a[80:83], a[168:171], 0
M v[244:247], a[84:87], a[172:175], v[244:247]
 s_waitcnt lgkmcnt(6)
M v[252:255], a[92:95], a[172:175], 0
 s_waitcnt lgkmcnt(0)
M v[252:255], a[88:91], a[168:171], v[252:255]
 s_barrier
M v[32:35], a[96:99], a[160:163], v[32:35]
 s_add_u32 m0, s23, 49152
 ds_read_b128 a[168:171], v5 offset:18432
 ds_read_b128 a[172:175], v6 offset:18432
M v[32:35], a[100:103], a[164:167], v[32:35]
 ds_read_b64_tr_b16 a[32:33], v20 offset:0
 ds_read_b64_tr_b16 a[34:35], v20 offset:1024
M v[36:39], a[108:111], a[164:167], v[36:39]
 s_mov_b32 s39, 1280
 buffer_load_dwordx4 v8, s[52:55], s28 offen offset:0   lds
M v[36:39], a[104:107], a[160:163], v[36:39]
 s_cmp_ge_u32 s42, 10
M v[40:43], a[112:115], a[160:163], v[40:43]
 s_cselect_b32 s64, 0xf000000, 0
 ds_read_b64_tr_b16 a[36:37], v20 offset:8192
 ds_read_b64_tr_b16 a[38:39], v20 offset:9216
M v[40:43], a[116:119], a[164:167], v[40:43]
 s_or_b32 s39, s39, s64
 buffer_load_dwordx4 v9, s[52:55], s28 offen offset:1024   lds
M v[44:47], a[124:127], a[164:167], v[44:47]
 s_lshl_b32 s64, s20, 14
M v[44:47], a[120:123], a[160:163], v[44:47]
 s_add_u32 s12, s64, s34
 ds_read_b64_tr_b16 a[40:41], v21 offset:0
 ds_read_b64_tr_b16 a[42:43], v21 offset:1024
M v[48:51], a[128:131], a[160:163], v[48:51]
 s_add_u32 s13, s12, 4096
 buffer_store_dwordx4 a[20:23], v7, s[8:11], s3 offen offset:2048 sc1
M v[48:51], a[132:135], a[164:167], v[48:51]
 s_add_u32 s14, s12, 8192
M v[52:55], a[140:143], a[164:167], v[52:55]
 s_add_u32 s15, s12, 12288
 ds_read_b64_tr_b16 a[44:45], v21 offset:8192
 ds_read_b64_tr_b16 a[46:47], v21 offset:9216
M v[52:55], a[136:139], a[160:163], v[52:55]
 buffer_load_dwordx4 v10, s[52:55], s28 offen offset:2048   lds
M v[56:59], a[144:147], a[160:163], v[56:59]
M v[56:59], a[148:151], a[164:167], v[56:59]
 s_waitcnt lgkmcnt(8)
 ds_read_b64_tr_b16 a[48:49], v22 offset:0
 ds_read_b64_tr_b16 a[50:51], v22 offset:1024
M v[60:63], a[156:159], a[164:167], v[60:63]
M v[60:63], a[152:155], a[160:163], v[60:63]
 buffer_load_dwordx4 v11, s[52:55], s28 offen offset:3072   lds
M v[68:71], a[96:99], a[168:171], v[68:71]
 s_add_u32 s28, s28, 524160
 ds_read_b128 a[160:163], v5 offset:20480
 ds_read_b128 a[164:167], v6 offset:20480
M v[68:71], a[100:103], a[172:175], v[68:71]
 ds_read_b64_tr_b16 a[52:53], v22 offset:8192
 ds_read_b64_tr_b16 a[54:55], v22 offset:9216
M v[76:79], a[108:111], a[172:175], v[76:79]
M v[76:79], a[104:107], a[168:171], v[76:79]
 s_add_u32 m0, s24, 0
 ds_read_b64_tr_b16 a[56:57], v23 offset:0
 ds_read_b64_tr_b16 a[58:59], v23 offset:1024
M v[84:87], a[112:115], a[168:171], v[84:87]
 buffer_load_dwordx4 v16, s[56:59], s29 offen offset:0   lds
M v[84:87], a[116:119], a[172:175], v[84:87]
M v[92:95], a[124:127], a[172:175], v[92:95]
 ds_read_b64_tr_b16 a[60:61], v23 offset:8192
 ds_read_b64_tr_b16 a[62:63], v23 offset:9216
M v[92:95], a[120:123], a[168:171], v[92:95]
M v[100:103], a[128:131], a[168:171], v[100:103]
M v[100:103], a[132:135], a[172:175], v[100:103]
 buffer_load_dwordx4 v17, s[56:59], s29 offen offset:1024   lds
M v[108:111], a[140:143], a[172:175], v[108:111]
M v[108:111], a[136:139], a[168:171], v[108:111]
M v[116:119], a[144:147], a[168:171], v[116:119]
M v[116:119], a[148:151], a[172:175], v[116:119]
 s_waitcnt lgkmcnt(6)
M v[124:127], a[156:159], a[172:175], v[124:127]
 s_waitcnt vmcnt(25) lgkmcnt(0)
 buffer_load_dwordx4 v18, s[56:59], s29 offen offset:2048   lds
M v[124:127], a[152:155], a[168:171], v[124:127]
 s_barrier
M v[132:135], a[96:99], a[160:163], v[132:135]
 ds_read_b128 a[168:171], v5 offset:22528
 ds_read_b128 a[172:175], v6 offset:22528
M v[132:135], a[100:103], a[164:167], v[132:135]
 ds_read_b64_tr_b16 a[64:65], v20 offset:16384
 ds_read_b64_tr_b16 a[66:67], v20 offset:17408
M v[140:143], a[108:111], a[164:167], v[140:143]
M v[140:143], a[104:107], a[160:163], v[140:143]
 buffer_load_dwordx4 v19, s[56:59], s29 offen offset:3072   lds
M v[148:151], a[112:115], a[160:163], v[148:151]
 s_add_u32 s29, s29, 128
 ds_read_b64_tr_b16 a[68:69], v20 offset:24576
 ds_read_b64_tr_b16 a[70:71], v20 offset:25600
M v[148:151], a[116:119], a[164:167], v[148:151]
 buffer_store_dwordx4 a[28:31], v7, s[8:11], s3 offen offset:3072 sc1
M v[156:159], a[124:127], a[164:167], v[156:159]
M v[156:159], a[120:123], a[160:163], v[156:159]
 s_add_u32 m0, s23, 131072
 ds_read_b64_tr_b16 a[72:73], v21 offset:16384
 ds_read_b64_tr_b16 a[74:75], v21 offset:17408
M v[164:167], a[128:131], a[160:163], v[164:167]
 buffer_load_dwordx4 v8, s[52:55], s28 offen offset:0   lds
M v[164:167], a[132:135], a[164:167], v[164:167]
M v[172:175], a[140:143], a[164:167], v[172:175]
 ds_read_b64_tr_b16 a[76:77], v21 offset:24576
 ds_read_b64_tr_b16 a[78:79], v21 offset:25600
M v[172:175], a[136:139], a[160:163], v[172:175]
M v[180:183], a[144:147], a[160:163], v[180:183]
M v[180:183], a[148:151], a[164:167], v[180:183]
 s_waitcnt lgkmcnt(8)
 ds_read_b64_tr_b16 a[80:81], v22 offset:16384
 ds_read_b64_tr_b16 a[82:83], v22 offset:17408
M v[188:191], a[156:159], a[164:167], v[188:191]
 buffer_load_dwordx4 v9, s[52:55], s28 offen offset:1024   lds
M v[188:191], a[152:155], a[160:163], v[188:191]
M v[196:199], a[96:99], a[168:171], v[196:199]
 ds_read_b128 a[160:163], v5 offset:32768
 ds_read_b128 a[164:167], v6 offset:32768
M v[196:199], a[100:103], a[172:175], v[196:199]
 ds_read_b64_tr_b16 a[84:85], v22 offset:24576
 ds_read_b64_tr_b16 a[86:87], v22 offset:25600
M v[204:207], a[108:111], a[172:175], v[204:207]
 buffer_load_dwordx4 v10, s[52:55], s28 offen offset:2048   lds
M v[204:207], a[104:107], a[168:171], v[204:207]
 ds_read_b64_tr_b16 a[88:89], v23 offset:16384
 ds_read_b64_tr_b16 a[90:91], v23 offset:17408
M v[212:215], a[112:115], a[168:171], v[212:215]
M v[212:215], a[116:119], a[172:175], v[212:215]
M v[220:223], a[124:127], a[172:175], v[220:223]
 ds_read_b64_tr_b16 a[92:93], v23 offset:24576
 ds_read_b64_tr_b16 a[94:95], v23 offset:25600
M v[220:223], a[120:123], a[168:171], v[220:223]
 buffer_load_dwordx4 v11, s[52:55], s28 offen offset:3072   lds
M v[228:231], a[128:131], a[168:171], v[228:231]
 s_add_u32 s28, s28, 128
M v[228:231], a[132:135], a[172:175], v[228:231]
M v[236:239], a[140:143], a[172:175], v[236:239]
M v[236:239], a[136:139], a[168:171], v[236:239]
M v[244:247], a[144:147], a[168:171], v[244:247]
M v[244:247], a[148:151], a[172:175], v[244:247]
 s_waitcnt lgkmcnt(6)
M v[252:255], a[156:159], a[172:175], v[252:255]
 s_waitcnt vmcnt(28) lgkmcnt(0)
M v[252:255], a[152:155], a[168:171], v[252:255]
 s_barrier
M v[32:35], a[32:35], a[160:163], v[32:35]
 s_add_u32 m0, s23, 147456
 ds_read_b128 a[168:171], v5 offset:34816
 ds_read_b128 a[172:175], v6 offset:34816
M v[32:35], a[36:39], a[164:167], v[32:35]
 ds_read_b64_tr_b16 a[96:97], v1 offset:0
 ds_read_b64_tr_b16 a[98:99], v1 offset:1024
M v[36:39], a[44:47], a[164:167], v[36:39]
 buffer_load_dwordx4 v8, s[52:55], s28 offen offset:0   lds
M v[36:39], a[40:43], a[160:163], v[36:39]
M v[40:43], a[48:51], a[160:163], v[40:43]
 ds_read_b64_tr_b16 a[100:101], v1 offset:8192
 ds_read_b64_tr_b16 a[102:103], v1 offset:9216
M v[40:43], a[52:55], a[164:167], v[40:43]
 buffer_load_dwordx4 v9, s[52:55], s28 offen offset:1024   lds
M v[44:47], a[60:63], a[164:167], v[44:47]
M v[44:47], a[56:59], a[160:163], v[44:47]
 ds_read_b64_tr_b16 a[104:105], v2 offset:0
 ds_read_b64_tr_b16 a[106:107], v2 offset:1024
M v[48:51], a[64:67], a[160:163], v[48:51]
M v[48:51], a[68:71], a[164:167], v[48:51]
M v[52:55], a[76:79], a[164:167], v[52:55]
 ds_read_b64_tr_b16 a[108:109], v2 offset:8192
 ds_read_b64_tr_b16 a[110:111], v2 offset:9216
M v[52:55], a[72:75], a[160:163], v[52:55]
 buffer_load_dwordx4 v10, s[52:55], s28 offen offset:2048   lds
M v[56:59], a[80:83], a[160:163], v[56:59]
M v[56:59], a[84:87], a[164:167], v[56:59]
 s_waitcnt lgkmcnt(8)
 ds_read_b64_tr_b16 a[112:113], v3 offset:0
 ds_read_b64_tr_b16 a[114:115], v3 offset:1024
M v[60:63], a[92:95], a[164:167], v[60:63]
M v[60:63], a[88:91], a[160:163], v[60:63]
 buffer_load_dwordx4 v11, s[52:55], s28 offen offset:3072   lds
M v[68:71], a[32:35], a[168:171], v[68:71]
 s_add_u32 s28, s28, 524160
 ds_read_b128 a[160:163], v5 offset:36864
 ds_read_b128 a[164:167], v6 offset:36864
M v[68:71], a[36:39], a[172:175], v[68:71]
 ds_read_b64_tr_b16 a[116:117], v3 offset:8192
 ds_read_b64_tr_b16 a[118:119], v3 offset:9216
M v[76:79], a[44:47], a[172:175], v[76:79]
M v[76:79], a[40:43], a[168:171], v[76:79]
 s_add_u32 m0, s24, 16384
 ds_read_b64_tr_b16 a[120:121], v4 offset:0
 ds_read_b64_tr_b16 a[122:123], v4 offset:1024
M v[84:87], a[48:51], a[168:171], v[84:87]
 buffer_load_dwordx4 v16, s[56:59], s29 offen offset:0   lds
M v[84:87], a[52:55], a[172:175], v[84:87]
M v[92:95], a[60:63], a[172:175], v[92:95]
 ds_read_b64_tr_b16 a[124:125], v4 offset:8192
 ds_read_b64_tr_b16 a[126:127], v4 offset:9216
M v[92:95], a[56:59], a[168:171], v[92:95]
M v[100:103], a[64:67], a[168:171], v[100:103]
M v[100:103], a[68:71], a[172:175], v[100:103]
 buffer_load_dwordx4 v17, s[56:59], s29 offen offset:1024   lds
M v[108:111], a[76:79], a[172:175], v[108:111]
M v[108:111], a[72:75], a[168:171], v[108:111]
M v[116:119], a[80:83], a[168:171], v[116:119]
M v[116:119], a[84:87], a[172:175], v[116:119]
 s_waitcnt lgkmcnt(6)
M v[124:127], a[92:95], a[172:175], v[124:127]
 s_waitcnt vmcnt(25) lgkmcnt(0)
 buffer_load_dwordx4 v18, s[56:59], s29 offen offset:2048   lds
M v[124:127], a[88:91], a[168:171], v[124:127]
 s_barrier
M v[132:135], a[32:35], a[160:163], v[132:135]
 ds_read_b128 a[168:171], v5 offset:38912
 ds_read_b128 a[172:175], v6 offset:38912
M v[132:135], a[36:39], a[164:167], v[132:135]
 ds_read_b64_tr_b16 a[128:129], v1 offset:16384
 ds_read_b64_tr_b16 a[130:131], v1 offset:17408
M v[140:143], a[44:47], a[164:167], v[140:143]
M v[140:143], a[40:43], a[160:163], v[140:143]
 buffer_load_dwordx4 v19, s[56:59], s29 offen offset:3072   lds
M v[148:151], a[48:51], a[160:163], v[148:151]
 s_add_u32 s29, s29, 128
 ds_read_b64_tr_b16 a[132:133], v1 offset:24576
 ds_read_b64_tr_b16 a[134:135], v1 offset:25600
M v[148:151], a[52:55], a[164:167], v[148:151]
M v[156:159], a[60:63], a[164:167], v[156:159]
M v[156:159], a[56:59], a[160:163], v[156:159]
 s_add_u32 m0, s23, 0
 ds_read_b64_tr_b16 a[136:137], v2 offset:16384
 ds_read_b64_tr_b16 a[138:139], v2 offset:17408
M v[164:167], a[64:67], a[160:163], v[164:167]
 buffer_load_dwordx4 v8, s[52:55], s28 offen offset:0   lds
M v[164:167], a[68:71], a[164:167], v[164:167]
M v[172:175], a[76:79], a[164:167], v[172:175]
 ds_read_b64_tr_b16 a[140:141], v2 offset:24576
 ds_read_b64_tr_b16 a[142:143], v2 offset:25600
M v[172:175], a[72:75], a[160:163], v[172:175]
M v[180:183], a[80:83], a[160:163], v[180:183]
M v[180:183], a[84:87], a[164:167], v[180:183]
 s_waitcnt lgkmcnt(8)
 ds_read_b64_tr_b16 a[144:145], v3 offset:16384
 ds_read_b64_tr_b16 a[146:147], v3 offset:17408
M v[188:191], a[92:95], a[164:167], v[188:191]
 buffer_load_dwordx4 v9, s[52:55], s28 offen offset:1024   lds
M v[188:191], a[88:91], a[160:163], v[188:191]
M v[196:199], a[32:35], a[168:171], v[196:199]
 ds_read_b128 a[160:163], v5 offset:49152
 ds_read_b128 a[164:167], v6 offset:49152
M v[196:199], a[36:39], a[172:175], v[196:199]
 ds_read_b64_tr_b16 a[148:149], v3 offset:24576
 ds_read_b64_tr_b16 a[150:151], v3 offset:25600
M v[204:207], a[44:47], a[172:175], v[204:207]
 buffer_load_dwordx4 v10, s[52:55], s28 offen offset:2048   lds
M v[204:207], a[40:43], a[168:171], v[204:207]
 ds_read_b64_tr_b16 a[152:153], v4 offset:16384
 ds_read_b64_tr_b16 a[154:155], v4 offset:17408
M v[212:215], a[48:51], a[168:171], v[212:215]
M v[212:215], a[52:55], a[172:175], v[212:215]
M v[220:223], a[60:63], a[172:175], v[220:223]
 ds_read_b64_tr_b16 a[156:157], v4 offset:24576
 ds_read_b64_tr_b16 a[158:159], v4 offset:25600
M v[220:223], a[56:59], a[168:171], v[220:223]
 buffer_load_dwordx4 v11, s[52:55], s28 offen offset:3072   lds
M v[228:231], a[64:67], a[168:171], v[228:231]
 s_add_u32 s28, s28, 128
M v[228:231], a[68:71], a[172:175], v[228:231]
M v[236:239], a[76:79], a[172:175], v[236:239]
M v[236:239], a[72:75], a[168:171], v[236:239]
M v[244:247], a[80:83], a[168:171], v[244:247]
M v[244:247], a[84:87], a[172:175], v[244:247]
 s_waitcnt lgkmcnt(6)
M v[252:255], a[92:95], a[172:175], v[252:255]
 s_waitcnt vmcnt(16) lgkmcnt(0)
M v[252:255], a[88:91], a[168:171], v[252:255]
 s_barrier
M v[32:35], a[96:99], a[160:163], v[32:35]
 s_add_u32 m0, s23, 16384
 ds_read_b128 a[168:171], v5 offset:51200
 ds_read_b128 a[172:175], v6 offset:51200
M v[32:35], a[100:103], a[164:167], v[32:35]
 ds_read_b64_tr_b16 a[32:33], v1 offset:32768
 ds_read_b64_tr_b16 a[34:35], v1 offset:33792
M v[36:39], a[108:111], a[164:167], v[36:39]
 buffer_load_dwordx4 v8, s[52:55], s28 offen offset:0   lds
M v[36:39], a[104:107], a[160:163], v[36:39]
 buffer_store_dword v12, v15, s[8:11], s45 offen sc1
M v[40:43], a[112:115], a[160:163], v[40:43]
 s_add_u32 s3, s93, 262144
 ds_read_b64_tr_b16 a[36:37], v1 offset:40960
 ds_read_b64_tr_b16 a[38:39], v1 offset:41984
M v[40:43], a[116:119], a[164:167], v[40:43]
 v_min_u32 v25, 15, v0
 v_lshlrev_b32 v25, 7, v25
M v[44:47], a[124:127], a[164:167], v[44:47]
 v_max_u32 v13, 1024, v25
M v[44:47], a[120:123], a[160:163], v[44:47]
 ds_read_b64_tr_b16 a[40:41], v2 offset:32768
 ds_read_b64_tr_b16 a[42:43], v2 offset:33792
M v[48:51], a[128:131], a[160:163], v[48:51]
 buffer_load_dwordx4 v9, s[52:55], s28 offen offset:1024   lds
M v[48:51], a[132:135], a[164:167], v[48:51]
 buffer_store_dwordx4 v[64:67], v7, s[8:11], s3 offen offset:0 sc1
M v[52:55], a[140:143], a[164:167], v[52:55]
 ds_read_b64_tr_b16 a[44:45], v2 offset:40960
 ds_read_b64_tr_b16 a[46:47], v2 offset:41984
M v[52:55], a[136:139], a[160:163], v[52:55]
M v[56:59], a[144:147], a[160:163], v[56:59]
M v[56:59], a[148:151], a[164:167], v[56:59]
 s_waitcnt lgkmcnt(8)
 ds_read_b64_tr_b16 a[48:49], v3 offset:32768
 ds_read_b64_tr_b16 a[50:51], v3 offset:33792
M v[60:63], a[156:159], a[164:167], v[60:63]
 buffer_load_dwordx4 v10, s[52:55], s28 offen offset:2048   lds
M v[60:63], a[152:155], a[160:163], v[60:63]
M v[68:71], a[96:99], a[168:171], v[68:71]
 ds_read_b128 a[160:163], v5 offset:53248
 ds_read_b128 a[164:167], v6 offset:53248
M v[68:71], a[100:103], a[172:175], v[68:71]
 ds_read_b64_tr_b16 a[52:53], v3 offset:40960
 ds_read_b64_tr_b16 a[54:55], v3 offset:41984
M v[76:79], a[108:111], a[172:175], v[76:79]
 buffer_store_dwordx4 v[72:75], v7, s[8:11], s3 offen offset:1024 sc1
M v[76:79], a[104:107], a[168:171], v[76:79]
 ds_read_b64_tr_b16 a[56:57], v4 offset:32768
 ds_read_b64_tr_b16 a[58:59], v4 offset:33792
M v[84:87], a[112:115], a[168:171], v[84:87]
M v[84:87], a[116:119], a[172:175], v[84:87]
 buffer_load_dwordx4 v11, s[52:55], s28 offen offset:3072   lds
M v[92:95], a[124:127], a[172:175], v[92:95]
 s_add_u32 s28, s28, 524160
 ds_read_b64_tr_b16 a[60:61], v4 offset:40960
 ds_read_b64_tr_b16 a[62:63], v4 offset:41984
M v[92:95], a[120:123], a[168:171], v[92:95]
M v[100:103], a[128:131], a[168:171], v[100:103]
M v[100:103], a[132:135], a[172:175], v[100:103]
M v[108:111], a[140:143], a[172:175], v[108:111]
M v[108:111], a[136:139], a[168:171], v[108:111]
M v[116:119], a[144:147], a[168:171], v[116:119]
M v[116:119], a[148:151], a[172:175], v[116:119]
 s_waitcnt lgkmcnt(6)
M v[124:127], a[156:159], a[172:175], v[124:127]
 s_waitcnt lgkmcnt(0)
M v[124:127], a[152:155], a[168:171], v[124:127]
 s_barrier
M v[132:135], a[96:99], a[160:163], v[132:135]
 ds_read_b128 a[168:171], v5 offset:55296
 ds_read_b128 a[172:175], v6 offset:55296
M v[132:135], a[100:103], a[164:167], v[132:135]
 ds_read_b64_tr_b16 a[64:65], v1 offset:49152
 ds_read_b64_tr_b16 a[66:67], v1 offset:50176
M v[140:143], a[108:111], a[164:167], v[140:143]
 buffer_store_dwordx4 v[80:83], v7, s[8:11], s3 offen offset:2048 sc1
M v[140:143], a[104:107], a[160:163], v[140:143]
M v[148:151], a[112:115], a[160:163], v[148:151]
 ds_read_b64_tr_b16 a[68:69], v1 offset:57344
 ds_read_b64_tr_b16 a[70:71], v1 offset:58368
M v[148:151], a[116:119], a[164:167], v[148:151]
M v[156:159], a[124:127], a[164:167], v[156:159]
M v[156:159], a[120:123], a[160:163], v[156:159]
 ds_read_b64_tr_b16 a[72:73], v2 offset:49152
 ds_read_b64_tr_b16 a[74:75], v2 offset:50176
M v[164:167], a[128:131], a[160:163], v[164:167]
M v[164:167], a[132:135], a[164:167], v[164:167]
M v[172:175], a[140:143], a[164:167], v[172:175]
 ds_read_b64_tr_b16 a[76:77], v2 offset:57344
 ds_read_b64_tr_b16 a[78:79], v2 offset:58368
M v[172:175], a[136:139], a[160:163], v[172:175]
M v[180:183], a[144:147], a[160:163], v[180:183]
M v[180:183], a[148:151], a[164:167], v[180:183]
 s_waitcnt lgkmcnt(8)
 ds_read_b64_tr_b16 a[80:81], v3 offset:49152
 ds_read_b64_tr_b16 a[82:83], v3 offset:50176
M v[188:191], a[156:159], a[164:167], v[188:191]
 buffer_store_dwordx4 v[88:91], v7, s[8:11], s3 offen offset:3072 sc1
M v[188:191], a[152:155], a[160:163], v[188:191]
M v[196:199], a[96:99], a[168:171], v[196:199]
 ds_read_b128 a[160:163], v5 offset:0
 ds_read_b128 a[164:167], v6 offset:0
M v[196:199], a[100:103], a[172:175], v[196:199]
 ds_read_b64_tr_b16 a[84:85], v3 offset:57344
 ds_read_b64_tr_b16 a[86:87], v3 offset:58368
M v[204:207], a[108:111], a[172:175], v[204:207]
M v[204:207], a[104:107], a[168:171], v[204:207]
 ds_read_b64_tr_b16 a[88:89], v4 offset:49152
 ds_read_b64_tr_b16 a[90:91], v4 offset:50176
M v[212:215], a[112:115], a[168:171], v[212:215]
M v[212:215], a[116:119], a[172:175], v[212:215]
M v[220:223], a[124:127], a[172:175], v[220:223]
 ds_read_b64_tr_b16 a[92:93], v4 offset:57344
 ds_read_b64_tr_b16 a[94:95], v4 offset:58368
M v[220:223], a[120:123], a[168:171], v[220:223]
M v[228:231], a[128:131], a[168:171], v[228:231]
M v[228:231], a[132:135], a[172:175], v[228:231]
M v[236:239], a[140:143], a[172:175], v[236:239]
M v[236:239], a[136:139], a[168:171], v[236:239]
M v[244:247], a[144:147], a[168:171], v[244:247]
M v[244:247], a[148:151], a[172:175], v[244:247]
 s_waitcnt lgkmcnt(6)
M v[252:255], a[156:159], a[172:175], v[252:255]
 s_waitcnt vmcnt(21) lgkmcnt(0)
M v[252:255], a[152:155], a[168:171], v[252:255]
 s_barrier
M v[32:35], a[32:35], a[160:163], v[32:35]
 s_add_u32 m0, s23, 32768
 ds_read_b128 a[168:171], v5 offset:2048
 ds_read_b128 a[172:175], v6 offset:2048
M v[32:35], a[36:39], a[164:167], v[32:35]
 ds_read_b64_tr_b16 a[96:97], v20 offset:0
 ds_read_b64_tr_b16 a[98:99], v20 offset:1024
M v[36:39], a[44:47], a[164:167], v[36:39]
 buffer_load_dwordx4 v16, s[56:59], s29 offen offset:0   lds
M v[36:39], a[40:43], a[160:163], v[36:39]
M v[40:43], a[48:51], a[160:163], v[40:43]
 s_add_u32 s3, s93, 270336
 ds_read_b64_tr_b16 a[100:101], v20 offset:8192
 ds_read_b64_tr_b16 a[102:103], v20 offset:9216
M v[40:43], a[52:55], a[164:167], v[40:43]
 buffer_load_dwordx4 v17, s[56:59], s29 offen offset:1024   lds
M v[44:47], a[60:63], a[164:167], v[44:47]
 buffer_store_dwordx4 v[96:99], v7, s[8:11], s3 offen offset:0 sc1
M v[44:47], a[56:59], a[160:163], v[44:47]
 ds_read_b64_tr_b16 a[104:105], v21 offset:0
 ds_read_b64_tr_b16 a[106:107], v21 offset:1024
M v[48:51], a[64:67], a[160:163], v[48:51]
M v[48:51], a[68:71], a[164:167], v[48:51]
 buffer_load_dwordx4 v18, s[56:59], s29 offen offset:2048   lds
M v[52:55], a[76:79], a[164:167], v[52:55]
 ds_read_b64_tr_b16 a[108:109], v21 offset:8192
 ds_read_b64_tr_b16 a[110:111], v21 offset:9216
M v[52:55], a[72:75], a[160:163], v[52:55]
M v[56:59], a[80:83], a[160:163], v[56:59]
M v[56:59], a[84:87], a[164:167], v[56:59]
 s_waitcnt lgkmcnt(8)
 ds_read_b64_tr_b16 a[112:113], v22 offset:0
 ds_read_b64_tr_b16 a[114:115], v22 offset:1024
M v[60:63], a[92:95], a[164:167], v[60:63]
 buffer_load_dwordx4 v19, s[56:59], s29 offen offset:3072   lds
M v[60:63], a[88:91], a[160:163], v[60:63]
 s_add_u32 s29, s29, 128
M v[68:71], a[32:35], a[168:171], v[68:71]
 ds_read_b128 a[160:163], v5 offset:4096
 ds_read_b128 a[164:167], v6 offset:4096
M v[68:71], a[36:39], a[172:175], v[68:71]
 ds_read_b64_tr_b16 a[116:117], v22 offset:8192
 ds_read_b64_tr_b16 a[118:119], v22 offset:9216
M v[76:79], a[44:47], a[172:175], v[76:79]
 s_lshl_b32 s28, s20, 13
 buffer_store_dwordx4 v[104:107], v7, s[8:11], s3 offen offset:1024 sc1
M v[76:79], a[40:43], a[168:171], v[76:79]
 s_lshl_b32 s21, s41, 20
 ds_read_b64_tr_b16 a[120:121], v23 offset:0
 ds_read_b64_tr_b16 a[122:123], v23 offset:1024
M v[84:87], a[48:51], a[168:171], v[84:87]
 s_mov_b32 s22, 0
M v[84:87], a[52:55], a[172:175], v[84:87]
 s_lshl_b32 s7, s41, 18
M v[92:95], a[60:63], a[172:175], v[92:95]
 s_add_u32 s7, s7, 100663296
 ds_read_b64_tr_b16 a[124:125], v23 offset:8192
 ds_read_b64_tr_b16 a[126:127], v23 offset:9216
M v[92:95], a[56:59], a[168:171], v[92:95]
 s_add_u32 s38, s7, 65536
M v[100:103], a[64:67], a[168:171], v[100:103]
 s_add_u32 s64, s42, 1
M v[100:103], a[68:71], a[172:175], v[100:103]
 s_min_u32 s64, s64, 10
M v[108:111], a[76:79], a[172:175], v[108:111]
 s_sub_u32 s27, s64, 3
 buffer_load_dword v24, v13, s[8:11], s46 offen sc1
M v[108:111], a[72:75], a[168:171], v[108:111]
 s_lshl_b32 s6, s64, 1
M v[116:119], a[80:83], a[168:171], v[116:119]
 s_sub_u32 s43, s6, 2
 s_lshl_b32 s64, s42, 16
 s_add_u32 s4, s21, s64
M v[116:119], a[84:87], a[172:175], v[116:119]
 s_waitcnt lgkmcnt(6)
 s_sub_u32 s26, 1114112, s64
 s_add_u32 s26, s26, s21
M v[124:127], a[92:95], a[172:175], v[124:127]
 s_waitcnt vmcnt(20) lgkmcnt(0)
 s_lshl_b32 s64, s42, 1
 s_sub_u32 s64, 32, s64
M v[124:127], a[88:91], a[168:171], v[124:127]
 s_barrier
M v[132:135], a[32:35], a[160:163], v[132:135]
 s_cmp_ge_u32 s42, 10
 ds_read_b128 a[168:171], v5 offset:6144
 ds_read_b128 a[172:175], v6 offset:6144
M v[132:135], a[36:39], a[164:167], v[132:135]
 s_cselect_b32 s25, s64, 32767
 ds_read_b64_tr_b16 a[128:129], v20 offset:16384
 ds_read_b64_tr_b16 a[130:131], v20 offset:17408
M v[140:143], a[44:47], a[164:167], v[140:143]
 s_mov_b32 s23, 0
 buffer_store_dwordx4 v[112:115], v7, s[8:11], s3 offen offset:2048 sc1
M v[140:143], a[40:43], a[160:163], v[140:143]
M v[148:151], a[48:51], a[160:163], v[148:151]
 ds_read_b64_tr_b16 a[132:133], v20 offset:24576
 ds_read_b64_tr_b16 a[134:135], v20 offset:25600
M v[148:151], a[52:55], a[164:167], v[148:151]
M v[156:159], a[60:63], a[164:167], v[156:159]
M v[156:159], a[56:59], a[160:163], v[156:159]
 ds_read_b64_tr_b16 a[136:137], v21 offset:16384
 ds_read_b64_tr_b16 a[138:139], v21 offset:17408
M v[164:167], a[64:67], a[160:163], v[164:167]
M v[164:167], a[68:71], a[164:167], v[164:167]
M v[172:175], a[76:79], a[164:167], v[172:175]
 ds_read_b64_tr_b16 a[140:141], v21 offset:24576
 ds_read_b64_tr_b16 a[142:143], v21 offset:25600
M v[172:175], a[72:75], a[160:163], v[172:175]
M v[180:183], a[80:83], a[160:163], v[180:183]
M v[180:183], a[84:87], a[164:167], v[180:183]
 s_waitcnt lgkmcnt(8)
 ds_read_b64_tr_b16 a[144:145], v22 offset:16384
 ds_read_b64_tr_b16 a[146:147], v22 offset:17408
M v[188:191], a[92:95], a[164:167], v[188:191]
 buffer_store_dwordx4 v[120:123], v7, s[8:11], s3 offen offset:3072 sc1
M v[188:191], a[88:91], a[160:163], v[188:191]
M v[196:199], a[32:35], a[168:171], v[196:199]
 ds_read_b128 a[160:163], v5 offset:16384
 ds_read_b128 a[164:167], v6 offset:16384
M v[196:199], a[36:39], a[172:175], v[196:199]
 ds_read_b64_tr_b16 a[148:149], v22 offset:24576
 ds_read_b64_tr_b16 a[150:151], v22 offset:25600
M v[204:207], a[44:47], a[172:175], v[204:207]
M v[204:207], a[40:43], a[168:171], v[204:207]
 ds_read_b64_tr_b16 a[152:153], v23 offset:16384
 ds_read_b64_tr_b16 a[154:155], v23 offset:17408
M v[212:215], a[48:51], a[168:171], v[212:215]
M v[212:215], a[52:55], a[172:175], v[212:215]
M v[220:223], a[60:63], a[172:175], v[220:223]
 ds_read_b64_tr_b16 a[156:157], v23 offset:24576
 ds_read_b64_tr_b16 a[158:159], v23 offset:25600
M v[220:223], a[56:59], a[168:171], v[220:223]
M v[228:231], a[64:67], a[168:171], v[228:231]
M v[228:231], a[68:71], a[172:175], v[228:231]
M v[236:239], a[76:79], a[172:175], v[236:239]
M v[236:239], a[72:75], a[168:171], v[236:239]
M v[244:247], a[80:83], a[168:171], v[244:247]
M v[244:247], a[84:87], a[172:175], v[244:247]
 s_waitcnt lgkmcnt(6)
M v[252:255], a[92:95], a[172:175], v[252:255]
 s_waitcnt vmcnt(18) lgkmcnt(0)
M v[252:255], a[88:91], a[168:171], v[252:255]
 s_barrier
M v[32:35], a[96:99], a[160:163], v[32:35]
 ds_read_b128 a[168:171], v5 offset:18432
 ds_read_b128 a[172:175], v6 offset:18432
M v[32:35], a[100:103], a[164:167], v[32:35]
 ds_read_b64_tr_b16 a[32:33], v1 offset:0
 ds_read_b64_tr_b16 a[34:35], v1 offset:1024
M v[36:39], a[108:111], a[164:167], v[36:39]
 v_add_u32 v10, s28, v7
 v_add_u32 v11, 0x1000, v10
M v[36:39], a[104:107], a[160:163], v[36:39]
 s_waitcnt vmcnt(2)
 v_cmp_eq_u32 vcc, 0, v24
 s_add_u32 s3, s93, 524288
M v[40:43], a[112:115], a[160:163], v[40:43]
 s_lshl_b32 s64, s20, 10
 ds_read_b64_tr_b16 a[36:37], v1 offset:8192
 ds_read_b64_tr_b16 a[38:39], v1 offset:9216
M v[40:43], a[116:119], a[164:167], v[40:43]
 s_cbranch_vccnz L_f1s14
L_f1r14:
M v[44:47], a[124:127], a[164:167], v[44:47]
 s_add_u32 m0, s28, 98304
 s_nop 0
 buffer_load_dwordx4 v10, s[8:11], s21 offen offset:0 sc1 lds
M v[44:47], a[120:123], a[160:163], v[44:47]
 ds_read_b64_tr_b16 a[40:41], v2 offset:0
 ds_read_b64_tr_b16 a[42:43], v2 offset:1024
M v[48:51], a[128:131], a[160:163], v[48:51]
 buffer_store_dwordx4 v[128:131], v7, s[8:11], s3 offen offset:0 sc1
M v[48:51], a[132:135], a[164:167], v[48:51]
M v[52:55], a[140:143], a[164:167], v[52:55]
 ds_read_b64_tr_b16 a[44:45], v2 offset:8192
 ds_read_b64_tr_b16 a[46:47], v2 offset:9216
M v[52:55], a[136:139], a[160:163], v[52:55]
 buffer_load_dwordx4 v10, s[8:11], s21 offen offset:1024 sc1 lds
M v[56:59], a[144:147], a[160:163], v[56:59]
M v[56:59], a[148:151], a[164:167], v[56:59]
 s_waitcnt lgkmcnt(8)
 ds_read_b64_tr_b16 a[48:49], v3 offset:0
 ds_read_b64_tr_b16 a[50:51], v3 offset:1024
M v[60:63], a[156:159], a[164:167], v[60:63]
M v[60:63], a[152:155], a[160:163], v[60:63]
 buffer_load_dwordx4 v10, s[8:11], s21 offen offset:2048 sc1 lds
M v[68:71], a[96:99], a[168:171], v[68:71]
 ds_read_b128 a[160:163], v5 offset:20480
 ds_read_b128 a[164:167], v6 offset:20480
M v[68:71], a[100:103], a[172:175], v[68:71]
 ds_read_b64_tr_b16 a[52:53], v3 offset:8192
 ds_read_b64_tr_b16 a[54:55], v3 offset:9216
M v[76:79], a[108:111], a[172:175], v[76:79]
 buffer_store_dwordx4 v[136:139], v7, s[8:11], s3 offen offset:1024 sc1
M v[76:79], a[104:107], a[168:171], v[76:79]
 ds_read_b64_tr_b16 a[56:57], v4 offset:0
 ds_read_b64_tr_b16 a[58:59], v4 offset:1024
M v[84:87], a[112:115], a[168:171], v[84:87]
 buffer_load_dwordx4 v10, s[8:11], s21 offen offset:3072 sc1 lds
M v[84:87], a[116:119], a[172:175], v[84:87]
 s_add_u32 m0, s28, 102400
M v[92:95], a[124:127], a[172:175], v[92:95]
 ds_read_b64_tr_b16 a[60:61], v4 offset:8192
 ds_read_b64_tr_b16 a[62:63], v4 offset:9216
M v[92:95], a[120:123], a[168:171], v[92:95]
M v[100:103], a[128:131], a[168:171], v[100:103]
 buffer_load_dwordx4 v11, s[8:11], s21 offen offset:0 sc1 lds
M v[100:103], a[132:135], a[172:175], v[100:103]
M v[108:111], a[140:143], a[172:175], v[108:111]
M v[108:111], a[136:139], a[168:171], v[108:111]
M v[116:119], a[144:147], a[168:171], v[116:119]
 buffer_load_dwordx4 v11, s[8:11], s21 offen offset:1024 sc1 lds
M v[116:119], a[148:151], a[172:175], v[116:119]
 s_waitcnt lgkmcnt(6)
M v[124:127], a[156:159], a[172:175], v[124:127]
 s_waitcnt lgkmcnt(0)
 buffer_load_dwordx4 v11, s[8:11], s21 offen offset:2048 sc1 lds
M v[124:127], a[152:155], a[168:171], v[124:127]
 s_barrier
M v[132:135], a[96:99], a[160:163], v[132:135]
 ds_read_b128 a[168:171], v5 offset:22528
 ds_read_b128 a[172:175], v6 offset:22528
M v[132:135], a[100:103], a[164:167], v[132:135]
 ds_read_b64_tr_b16 a[64:65], v1 offset:16384
 ds_read_b64_tr_b16 a[66:67], v1 offset:17408
M v[140:143], a[108:111], a[164:167], v[140:143]
 buffer_load_dwordx4 v11, s[8:11], s21 offen offset:3072 sc1 lds
M v[140:143], a[104:107], a[160:163], v[140:143]
 s_add_u32 s24, s23, 16777216
 buffer_store_dwordx4 v[144:147], v7, s[8:11], s3 offen offset:2048 sc1
M v[148:151], a[112:115], a[160:163], v[148:151]
 s_mov_b32 s23, s21
 ds_read_b64_tr_b16 a[68:69], v1 offset:24576
 ds_read_b64_tr_b16 a[70:71], v1 offset:25600
M v[148:151], a[116:119], a[164:167], v[148:151]
 s_add_u32 s21, s21, 32768
M v[156:159], a[124:127], a[164:167], v[156:159]
 s_add_u32 s22, s22, 1
M v[156:159], a[120:123], a[160:163], v[156:159]
 s_cmp_eq_u32 s22, s25
 ds_read_b64_tr_b16 a[72:73], v2 offset:16384
 ds_read_b64_tr_b16 a[74:75], v2 offset:17408
M v[164:167], a[128:131], a[160:163], v[164:167]
 s_cselect_b32 s21, s26, s21
 v_subrev_u32 v5, 0x10000, v5
 v_subrev_u32 v6, 0x10000, v6
M v[164:167], a[132:135], a[164:167], v[164:167]
 s_cmp_eq_u32 s22, s43
M v[172:175], a[140:143], a[164:167], v[172:175]
 s_cselect_b32 s21, s4, s21
 ds_read_b64_tr_b16 a[76:77], v2 offset:24576
 ds_read_b64_tr_b16 a[78:79], v2 offset:25600
M v[172:175], a[136:139], a[160:163], v[172:175]
 s_cmp_eq_u32 s22, s6
M v[180:183], a[144:147], a[160:163], v[180:183]
 s_cselect_b32 s21, s7, s21
 v_mov_b32 v9, v25
 v_lshrrev_b32 v24, 4, v0
M v[180:183], a[148:151], a[164:167], v[180:183]
 s_waitcnt lgkmcnt(8)
 ds_read_b64_tr_b16 a[80:81], v3 offset:16384
 ds_read_b64_tr_b16 a[82:83], v3 offset:17408
M v[188:191], a[156:159], a[164:167], v[188:191]
 v_lshlrev_b32 v24, 2, v24
 v_and_b32 v25, 15, v0
M v[188:191], a[152:155], a[160:163], v[188:191]
 v_sub_u32 v24, v24, v25
M v[196:199], a[96:99], a[168:171], v[196:199]
 s_add_u32 s64, s64, s34
 ds_read_b128 a[160:163], v5 offset:32768
 ds_read_b128 a[164:167], v6 offset:32768
M v[196:199], a[100:103], a[172:175], v[196:199]
 s_add_u32 s52, s64, 65536
 ds_read_b64_tr_b16 a[84:85], v3 offset:24576
 ds_read_b64_tr_b16 a[86:87], v3 offset:25600
M v[204:207], a[108:111], a[172:175], v[204:207]
 s_mov_b32 s55, 0x21800000
 buffer_store_dwordx4 v[152:155], v7, s[8:11], s3 offen offset:3072 sc1
M v[204:207], a[104:107], a[168:171], v[204:207]
 s_and_b32 s65, s39, 0xf000000
 ds_read_b64_tr_b16 a[88:89], v4 offset:16384
 ds_read_b64_tr_b16 a[90:91], v4 offset:17408
M v[212:215], a[112:115], a[168:171], v[212:215]
 s_cmp_eq_u32 s20, 0
M v[212:215], a[116:119], a[172:175], v[212:215]
 s_cselect_b32 s54, s39, s65
M v[220:223], a[124:127], a[172:175], v[220:223]
 s_lshr_b32 s64, s20, 1
 ds_read_b64_tr_b16 a[92:93], v4 offset:24576
 ds_read_b64_tr_b16 a[94:95], v4 offset:25600
M v[220:223], a[120:123], a[168:171], v[220:223]
 s_lshl_b32 s64, s64, 17
M v[228:231], a[128:131], a[168:171], v[228:231]
 s_and_b32 s65, s20, 1
M v[228:231], a[132:135], a[172:175], v[228:231]
 s_lshl_b32 s65, s65, 12
M v[236:239], a[140:143], a[172:175], v[236:239]
 s_add_u32 s64, s64, s65
 v_add_u32 v14, s64, v7
 v_mov_b32 v8, 0xff800000
M v[236:239], a[136:139], a[168:171], v[236:239]
 v_cmp_lt_i32 s[16:17], 0, v24
 v_cmp_lt_i32 s[18:19], -1, v24
M v[244:247], a[144:147], a[168:171], v[244:247]
 v_cmp_lt_i32 s[48:49], -2, v24
 v_cmp_lt_i32 s[50:51], -3, v24
M v[244:247], a[148:151], a[172:175], v[244:247]
 s_waitcnt lgkmcnt(6)
M v[252:255], a[156:159], a[172:175], v[252:255]
 s_waitcnt lgkmcnt(0)
M v[252:255], a[152:155], a[168:171], v[252:255]
 s_barrier
M v[32:35], a[32:35], a[160:163], v[32:35]
 ds_read_b128 a[168:171], v5 offset:34816
 ds_read_b128 a[172:175], v6 offset:34816
M v[32:35], a[36:39], a[164:167], v[32:35]
 buffer_load_dword v24, v9, s[8:11], s46 offen sc1
M v[36:39], a[44:47], a[164:167], v[36:39]
 v_mov_b32 v1, v15
 v_add_u32 v2, 0x10000, v7
M v[36:39], a[40:43], a[160:163], v[36:39]
 v_mov_b32 v3, v10
 v_mov_b32 v4, v11
M v[40:43], a[48:51], a[160:163], v[40:43]
 s_mov_b64 s[60:61], s[76:77]
M v[40:43], a[52:55], a[164:167], v[40:43]
 s_mov_b32 s62, s78
M v[44:47], a[60:63], a[164:167], v[44:47]
 s_mov_b32 s63, 0x20000
 v_lshl_add_u32 v10, v0, 7, s95
 v_and_b32 v0, 48, v0
M v[44:47], a[56:59], a[160:163], v[44:47]
 v_lshl_add_u32 v0, v0, 24, v10
 v_mul_f32 v32, s5, v32
M v[48:51], a[64:67], a[160:163], v[48:51]
 v_mul_f32 v33, s5, v33
 v_mul_f32 v34, s5, v34
M v[48:51], a[68:71], a[164:167], v[48:51]
 v_mul_f32 v35, s5, v35
 v_mul_f32 v36, s5, v36
M v[52:55], a[76:79], a[164:167], v[52:55]
 v_mul_f32 v37, s5, v37
 v_mul_f32 v38, s5, v38
M v[52:55], a[72:75], a[160:163], v[52:55]
 v_mul_f32 v39, s5, v39
 v_cvt_pk_bf16_f32 v32, v32, v33
M v[56:59], a[80:83], a[160:163], v[56:59]
 v_cvt_pk_bf16_f32 v33, v34, v35
 v_cvt_pk_bf16_f32 v34, v36, v37
M v[56:59], a[84:87], a[164:167], v[56:59]
 s_waitcnt lgkmcnt(0)
 v_cvt_pk_bf16_f32 v35, v38, v39
 ds_write_b128 v14, v[32:35] offset:0
M v[60:63], a[92:95], a[164:167], v[60:63]
 s_add_u32 s3, s93, 532480
 buffer_store_dwordx4 v[160:163], v7, s[8:11], s3 offen offset:0 sc1
M v[60:63], a[88:91], a[160:163], v[60:63]
 v_mul_f32 v40, s5, v40
 v_mul_f32 v41, s5, v41
M v[68:71], a[32:35], a[168:171], v[68:71]
 ds_read_b128 a[160:163], v5 offset:36864
 ds_read_b128 a[164:167], v6 offset:36864
M v[68:71], a[36:39], a[172:175], v[68:71]
 v_mul_f32 v42, s5, v42
 v_mul_f32 v43, s5, v43
M v[76:79], a[44:47], a[172:175], v[76:79]
 v_mul_f32 v44, s5, v44
 v_mul_f32 v45, s5, v45
M v[76:79], a[40:43], a[168:171], v[76:79]
 v_mul_f32 v46, s5, v46
 v_mul_f32 v47, s5, v47
M v[84:87], a[48:51], a[168:171], v[84:87]
 v_cvt_pk_bf16_f32 v40, v40, v41
 v_cvt_pk_bf16_f32 v41, v42, v43
M v[84:87], a[52:55], a[172:175], v[84:87]
 v_cvt_pk_bf16_f32 v42, v44, v45
 v_cvt_pk_bf16_f32 v43, v46, v47
M v[92:95], a[60:63], a[172:175], v[92:95]
 ds_write_b128 v14, v[40:43] offset:1024
M v[92:95], a[56:59], a[168:171], v[92:95]
 buffer_store_dwordx4 v[168:171], v7, s[8:11], s3 offen offset:1024 sc1
M v[100:103], a[64:67], a[168:171], v[100:103]
 v_mul_f32 v48, s5, v48
 v_mul_f32 v49, s5, v49
M v[100:103], a[68:71], a[172:175], v[100:103]
 v_mul_f32 v50, s5, v50
 v_mul_f32 v51, s5, v51
M v[108:111], a[76:79], a[172:175], v[108:111]
 v_mul_f32 v52, s5, v52
 v_mul_f32 v53, s5, v53
M v[108:111], a[72:75], a[168:171], v[108:111]
 v_mul_f32 v54, s5, v54
 v_mul_f32 v55, s5, v55
M v[116:119], a[80:83], a[168:171], v[116:119]
 v_cvt_pk_bf16_f32 v48, v48, v49
 v_cvt_pk_bf16_f32 v49, v50, v51
M v[116:119], a[84:87], a[172:175], v[116:119]
 s_waitcnt lgkmcnt(1)
 v_cvt_pk_bf16_f32 v50, v52, v53
 v_cvt_pk_bf16_f32 v51, v54, v55
M v[124:127], a[92:95], a[172:175], v[124:127]
 ds_write_b128 v14, v[48:51] offset:2048
M v[124:127], a[88:91], a[168:171], v[124:127]
 buffer_store_dwordx4 v[176:179], v7, s[8:11], s3 offen offset:2048 sc1
M v[132:135], a[32:35], a[160:163], v[132:135]
 ds_read_b128 a[168:171], v5 offset:38912
 ds_read_b128 a[172:175], v6 offset:38912
M v[132:135], a[36:39], a[164:167], v[132:135]
 v_mul_f32 v56, s5, v56
 v_mul_f32 v57, s5, v57
M v[140:143], a[44:47], a[164:167], v[140:143]
 v_mul_f32 v58, s5, v58
 v_mul_f32 v59, s5, v59
M v[140:143], a[40:43], a[160:163], v[140:143]
 v_mul_f32 v60, s5, v60
 v_mul_f32 v61, s5, v61
M v[148:151], a[48:51], a[160:163], v[148:151]
 v_mul_f32 v62, s5, v62
 v_mul_f32 v63, s5, v63
M v[148:151], a[52:55], a[164:167], v[148:151]
 v_cvt_pk_bf16_f32 v56, v56, v57
 v_cvt_pk_bf16_f32 v57, v58, v59
M v[156:159], a[60:63], a[164:167], v[156:159]
 v_cvt_pk_bf16_f32 v58, v60, v61
 v_cvt_pk_bf16_f32 v59, v62, v63
M v[156:159], a[56:59], a[160:163], v[156:159]
 s_waitcnt lgkmcnt(0)
 ds_write_b128 v14, v[56:59] offset:3072
M v[164:167], a[64:67], a[160:163], v[164:167]
 s_barrier
M v[164:167], a[68:71], a[164:167], v[164:167]
M v[172:175], a[76:79], a[164:167], v[172:175]
 s_add_u32 m0, s28, 32768
 s_nop 0
 buffer_load_dwordx4 v3, s[8:11], s21 offen offset:0 sc1 lds
M v[172:175], a[72:75], a[160:163], v[172:175]
M v[180:183], a[80:83], a[160:163], v[180:183]
 buffer_store_dwordx4 v[184:187], v7, s[8:11], s3 offen offset:3072 sc1
M v[180:183], a[84:87], a[164:167], v[180:183]
 v_mul_f32 v68, s5, v68
 v_mul_f32 v69, s5, v69
M v[188:191], a[92:95], a[164:167], v[188:191]
 buffer_load_dwordx4 v3, s[8:11], s21 offen offset:1024 sc1 lds
M v[188:191], a[88:91], a[160:163], v[188:191]
 v_mul_f32 v70, s5, v70
 v_mul_f32 v71, s5, v71
M v[196:199], a[32:35], a[168:171], v[196:199]
 v_mul_f32 v76, s5, v76
 v_mul_f32 v77, s5, v77
M v[196:199], a[36:39], a[172:175], v[196:199]
 v_mul_f32 v78, s5, v78
 v_mul_f32 v79, s5, v79
M v[204:207], a[44:47], a[172:175], v[204:207]
 buffer_load_dwordx4 v3, s[8:11], s21 offen offset:2048 sc1 lds
M v[204:207], a[40:43], a[168:171], v[204:207]
 v_cvt_pk_bf16_f32 v68, v68, v69
 v_cvt_pk_bf16_f32 v69, v70, v71
M v[212:215], a[48:51], a[168:171], v[212:215]
 v_cvt_pk_bf16_f32 v70, v76, v77
 v_cvt_pk_bf16_f32 v71, v78, v79
M v[212:215], a[52:55], a[172:175], v[212:215]
 ds_write_b128 v14, v[68:71] offset:8192
 v_mul_f32 v84, s5, v84
M v[220:223], a[60:63], a[172:175], v[220:223]
 buffer_load_dwordx4 v3, s[8:11], s21 offen offset:3072 sc1 lds
M v[220:223], a[56:59], a[168:171], v[220:223]
 s_add_u32 m0, s28, 36864
 v_mul_f32 v85, s5, v85
 v_mul_f32 v86, s5, v86
M v[228:231], a[64:67], a[168:171], v[228:231]
 v_mul_f32 v87, s5, v87
 v_mul_f32 v92, s5, v92
M v[228:231], a[68:71], a[172:175], v[228:231]
 v_mul_f32 v93, s5, v93
 v_mul_f32 v94, s5, v94
M v[236:239], a[76:79], a[172:175], v[236:239]
 buffer_load_dwordx4 v4, s[8:11], s21 offen offset:0 sc1 lds
M v[236:239], a[72:75], a[168:171], v[236:239]
 v_mul_f32 v95, s5, v95
 v_cvt_pk_bf16_f32 v84, v84, v85
M v[244:247], a[80:83], a[168:171], v[244:247]
 v_cvt_pk_bf16_f32 v85, v86, v87
 v_cvt_pk_bf16_f32 v86, v92, v93
M v[244:247], a[84:87], a[172:175], v[244:247]
 v_cvt_pk_bf16_f32 v87, v94, v95
 ds_write_b128 v14, v[84:87] offset:9216
M v[252:255], a[92:95], a[172:175], v[252:255]
 buffer_load_dwordx4 v4, s[8:11], s21 offen offset:1024 sc1 lds
M v[252:255], a[88:91], a[168:171], v[252:255]
 buffer_load_dwordx4 v4, s[8:11], s21 offen offset:2048 sc1 lds
 buffer_load_dwordx4 v4, s[8:11], s21 offen offset:3072 sc1 lds
 s_add_u32 s24, s23, 16777216
 s_mov_b32 s23, s21
 s_add_u32 s21, s21, 32768
 s_add_u32 s22, s22, 1
 s_cmp_eq_u32 s22, s25
 s_cselect_b32 s21, s26, s21
 s_cmp_eq_u32 s22, s43
 s_cselect_b32 s21, s4, s21
 s_cmp_eq_u32 s22, s6
 s_cselect_b32 s21, s7, s21
 v_mul_f32 v100, s5, v100
 v_mul_f32 v101, s5, v101
 v_mul_f32 v102, s5, v102
 v_mul_f32 v103, s5, v103
 v_mul_f32 v108, s5, v108
 v_mul_f32 v109, s5, v109
 v_mul_f32 v110, s5, v110
 v_mul_f32 v111, s5, v111
 v_cvt_pk_bf16_f32 v100, v100, v101
 v_cvt_pk_bf16_f32 v101, v102, v103
 v_cvt_pk_bf16_f32 v102, v108, v109
 v_cvt_pk_bf16_f32 v103, v110, v111
 ds_write_b128 v14, v[100:103] offset:10240
 v_pk_mul_f32 v[116:117], v[116:117], s[4:5] op_sel:[0,1] op_sel_hi:[1,1]
 v_pk_mul_f32 v[118:119], v[118:119], s[4:5] op_sel:[0,1] op_sel_hi:[1,1]
 v_pk_mul_f32 v[124:125], v[124:125], s[4:5] op_sel:[0,1] op_sel_hi:[1,1]
 v_pk_mul_f32 v[126:127], v[126:127], s[4:5] op_sel:[0,1] op_sel_hi:[1,1]
 v_cvt_pk_bf16_f32 v116, v116, v117
 v_cvt_pk_bf16_f32 v117, v118, v119
 v_cvt_pk_bf16_f32 v118, v124, v125
 v_cvt_pk_bf16_f32 v119, v126, v127
 ds_write_b128 v14, v[116:119] offset:11264
 v_pk_mul_f32 v[132:133], v[132:133], s[4:5] op_sel:[0,1] op_sel_hi:[1,1]
 v_pk_mul_f32 v[134:135], v[134:135], s[4:5] op_sel:[0,1] op_sel_hi:[1,1]
 v_pk_mul_f32 v[140:141], v[140:141], s[4:5] op_sel:[0,1] op_sel_hi:[1,1]
 v_pk_mul_f32 v[142:143], v[142:143], s[4:5] op_sel:[0,1] op_sel_hi:[1,1]
 v_cvt_pk_bf16_f32 v132, v132, v133
 v_cvt_pk_bf16_f32 v133, v134, v135
 v_cvt_pk_bf16_f32 v134, v140, v141
 v_cvt_pk_bf16_f32 v135, v142, v143
 ds_write_b128 v14, v[132:135] offset:16384
 v_pk_mul_f32 v[148:149], v[148:149], s[4:5] op_sel:[0,1] op_sel_hi:[1,1]
 v_pk_mul_f32 v[150:151], v[150:151], s[4:5] op_sel:[0,1] op_sel_hi:[1,1]
 v_pk_mul_f32 v[156:157], v[156:157], s[4:5] op_sel:[0,1] op_sel_hi:[1,1]
 v_pk_mul_f32 v[158:159], v[158:159], s[4:5] op_sel:[0,1] op_sel_hi:[1,1]
 v_cvt_pk_bf16_f32 v148, v148, v149
 v_cvt_pk_bf16_f32 v149, v150, v151
 v_cvt_pk_bf16_f32 v150, v156, v157
 v_cvt_pk_bf16_f32 v151, v158, v159
 ds_write_b128 v14, v[148:151] offset:17408
 v_pk_mul_f32 v[164:165], v[164:165], s[4:5] op_sel:[0,1] op_sel_hi:[1,1]
 v_pk_mul_f32 v[166:167], v[166:167], s[4:5] op_sel:[0,1] op_sel_hi:[1,1]
 v_pk_mul_f32 v[172:173], v[172:173], s[4:5] op_sel:[0,1] op_sel_hi:[1,1]
 v_pk_mul_f32 v[174:175], v[174:175], s[4:5] op_sel:[0,1] op_sel_hi:[1,1]
 v_cvt_pk_bf16_f32 v164, v164, v165
 v_cvt_pk_bf16_f32 v165, v166, v167
 v_cvt_pk_bf16_f32 v166, v172, v173
 v_cvt_pk_bf16_f32 v167, v174, v175
 ds_write_b128 v14, v[164:167] offset:18432
 v_pk_mul_f32 v[180:181], v[180:181], s[4:5] op_sel:[0,1] op_sel_hi:[1,1]
 v_pk_mul_f32 v[182:183], v[182:183], s[4:5] op_sel:[0,1] op_sel_hi:[1,1]
 v_pk_mul_f32 v[188:189], v[188:189], s[4:5] op_sel:[0,1] op_sel_hi:[1,1]
 v_pk_mul_f32 v[190:191], v[190:191], s[4:5] op_sel:[0,1] op_sel_hi:[1,1]
 v_cvt_pk_bf16_f32 v180, v180, v181
 v_cvt_pk_bf16_f32 v181, v182, v183
 v_cvt_pk_bf16_f32 v182, v188, v189
 v_cvt_pk_bf16_f32 v183, v190, v191
 ds_write_b128 v14, v[180:183] offset:19456
 v_pk_mul_f32 v[196:197], v[196:197], s[4:5] op_sel:[0,1] op_sel_hi:[1,1]
 v_pk_mul_f32 v[198:199], v[198:199], s[4:5] op_sel:[0,1] op_sel_hi:[1,1]
 v_pk_mul_f32 v[204:205], v[204:205], s[4:5] op_sel:[0,1] op_sel_hi:[1,1]
 v_pk_mul_f32 v[206:207], v[206:207], s[4:5] op_sel:[0,1] op_sel_hi:[1,1]
 v_cvt_pk_bf16_f32 v196, v196, v197
 v_cvt_pk_bf16_f32 v197, v198, v199
 v_cvt_pk_bf16_f32 v198, v204, v205
 v_cvt_pk_bf16_f32 v199, v206, v207
 ds_write_b128 v14, v[196:199] offset:24576
 v_pk_mul_f32 v[212:213], v[212:213], s[4:5] op_sel:[0,1] op_sel_hi:[1,1]
 v_pk_mul_f32 v[214:215], v[214:215], s[4:5] op_sel:[0,1] op_sel_hi:[1,1]
 v_pk_mul_f32 v[220:221], v[220:221], s[4:5] op_sel:[0,1] op_sel_hi:[1,1]
 v_pk_mul_f32 v[222:223], v[222:223], s[4:5] op_sel:[0,1] op_sel_hi:[1,1]
 v_cvt_pk_bf16_f32 v212, v212, v213
 v_cvt_pk_bf16_f32 v213, v214, v215
 v_cvt_pk_bf16_f32 v214, v220, v221
 v_cvt_pk_bf16_f32 v215, v222, v223
 ds_write_b128 v14, v[212:215] offset:25600
 v_pk_mul_f32 v[228:229], v[228:229], s[4:5] op_sel:[0,1] op_sel_hi:[1,1]
 v_pk_mul_f32 v[230:231], v[230:231], s[4:5] op_sel:[0,1] op_sel_hi:[1,1]
 v_pk_mul_f32 v[236:237], v[236:237], s[4:5] op_sel:[0,1] op_sel_hi:[1,1]
 v_pk_mul_f32 v[238:239], v[238:239], s[4:5] op_sel:[0,1] op_sel_hi:[1,1]
 v_cvt_pk_bf16_f32 v228, v228, v229
 v_cvt_pk_bf16_f32 v229, v230, v231
 v_cvt_pk_bf16_f32 v230, v236, v237
 v_cvt_pk_bf16_f32 v231, v238, v239
 ds_write_b128 v14, v[228:231] offset:26624
 v_pk_mul_f32 v[244:245], v[244:245], s[4:5] op_sel:[0,1] op_sel_hi:[1,1]
 v_pk_mul_f32 v[246:247], v[246:247], s[4:5] op_sel:[0,1] op_sel_hi:[1,1]
 v_pk_mul_f32 v[252:253], v[252:253], s[4:5] op_sel:[0,1] op_sel_hi:[1,1]
 v_pk_mul_f32 v[254:255], v[254:255], s[4:5] op_sel:[0,1] op_sel_hi:[1,1]
 v_cvt_pk_bf16_f32 v244, v244, v245
 v_cvt_pk_bf16_f32 v245, v246, v247
 v_cvt_pk_bf16_f32 v246, v252, v253
 v_cvt_pk_bf16_f32 v247, v254, v255
 ds_write_b128 v14, v[244:247] offset:27648
 s_waitcnt vmcnt(15) lgkmcnt(0)
 s_barrier
 ds_read_b128 a[64:67], v2 offset:32768
 ds_read_b128 a[68:71], v2 offset:33792
 ds_read_b128 a[72:75], v2 offset:34816
 ds_read_b128 a[76:79], v2 offset:35840
 ds_read_b128 a[80:83], v2 offset:36864
 ds_read_b128 a[84:87], v2 offset:37888
 ds_read_b128 a[88:91], v2 offset:38912
 ds_read_b128 a[92:95], v2 offset:39936
 s_lshl_b32 s64, s20, 13
 s_sub_u32 s65, 155648, s64
 v_add_u32 v10, s64, v7
 v_add_u32 v11, s65, v7
 ds_read_b128 a[0:3], v10 offset:0
 ds_read_b128 a[4:7], v10 offset:1024
 ds_read_b128 a[8:11], v10 offset:2048
 ds_read_b128 a[12:15], v10 offset:3072
 ds_read_b128 a[16:19], v10 offset:4096
 ds_read_b128 a[20:23], v10 offset:5120
 ds_read_b128 a[24:27], v10 offset:6144
 ds_read_b128 a[28:31], v10 offset:7168
 ds_read_b128 a[32:35], v11 offset:0
 ds_read_b128 a[36:39], v11 offset:1024
 ds_read_b128 a[40:43], v11 offset:2048
 ds_read_b128 a[44:47], v11 offset:3072
 ds_read_b128 a[48:51], v11 offset:4096
 ds_read_b128 a[52:55], v11 offset:5120
 ds_read_b128 a[56:59], v11 offset:6144
 ds_read_b128 a[60:63], v11 offset:7168
 s_waitcnt vmcnt(12)
 v_cmp_eq_u32 vcc, 0, v24
 v_mov_b32 v17, 3
 v_or_b32 v6, s35, v7
 s_cbranch_vccnz L_f1s15
L_f1r15:
 s_mov_b32 s30, s93
 s_mov_b32 s29, s94
 s_cmp_eq_u32 s20, 0
 s_cselect_b32 s5, 5, 0
 v_mov_b32 v32, 0xc1800000
 v_mov_b32 v33, 0xc1800000
 v_mov_b32 v34, 0xc1800000
 v_mov_b32 v35, 0xc1800000
 v_mov_b32 v36, 0xc1800000
 v_mov_b32 v37, 0xc1800000
 v_mov_b32 v38, 0xc1800000
 v_mov_b32 v39, 0xc1800000
 s_waitcnt lgkmcnt(0)
M v[64:67], a[64:67], a[0:3], v[32:35]
 ds_read_b128 a[96:99], v2 offset:40960
 v_mov_b32 v30, 0
M v[64:67], a[68:71], a[4:7], v[64:67]
 s_add_u32 m0, s28, 65536
 ds_read_b128 a[100:103], v2 offset:41984
 v_mov_b32 v31, 0
M v[64:67], a[72:75], a[8:11], v[64:67]
 buffer_load_dwordx4 v3, s[8:11], s24 offen offset:0 sc1 lds
M v[64:67], a[76:79], a[12:15], v[64:67]
 ds_read_b128 a[104:107], v2 offset:43008
 v_accvgpr_write_b32 a128, v192
M v[64:67], a[80:83], a[16:19], v[64:67]
 ds_read_b128 a[108:111], v2 offset:44032
 v_accvgpr_write_b32 a129, v193
M v[64:67], a[84:87], a[20:23], v[64:67]
 buffer_load_dwordx4 v3, s[8:11], s24 offen offset:1024 sc1 lds
M v[64:67], a[88:91], a[24:27], v[64:67]
 ds_read_b128 a[112:115], v2 offset:45056
 v_accvgpr_write_b32 a130, v194
M v[64:67], a[92:95], a[28:31], v[64:67]
 ds_read_b128 a[116:119], v2 offset:46080
 v_accvgpr_write_b32 a131, v195
M v[68:71], a[92:95], a[60:63], v[36:39]
 v_accvgpr_write_b32 a132, v200
 v_accvgpr_write_b32 a133, v201
M v[68:71], a[88:91], a[56:59], v[68:71]
 ds_read_b128 a[120:123], v2 offset:47104
 v_accvgpr_write_b32 a134, v202
M v[68:71], a[84:87], a[52:55], v[68:71]
 ds_read_b128 a[124:127], v2 offset:48128
 v_accvgpr_write_b32 a135, v203
M v[68:71], a[80:83], a[48:51], v[68:71]
 buffer_load_dwordx4 v3, s[8:11], s24 offen offset:2048 sc1 lds
M v[68:71], a[76:79], a[44:47], v[68:71]
 v_accvgpr_write_b32 a136, v208
 v_accvgpr_write_b32 a137, v209
M v[68:71], a[72:75], a[40:43], v[68:71]
 v_accvgpr_write_b32 a138, v210
 v_accvgpr_write_b32 a139, v211
M v[68:71], a[68:71], a[36:39], v[68:71]
 v_exp_f32 v18, v64
M v[68:71], a[64:67], a[32:35], v[68:71]
 s_waitcnt lgkmcnt(0)
 v_exp_f32 v19, v65
M v[72:75], a[96:99], a[0:3], v[32:35]
 ds_read_b128 a[64:67], v2 offset:49152
 v_add_f32 v26, v18, v19
M v[72:75], a[100:103], a[4:7], v[72:75]
 ds_read_b128 a[68:71], v2 offset:50176
 v_cvt_pk_bf16_f32 v40, v18, v19
M v[72:75], a[104:107], a[8:11], v[72:75]
 buffer_load_dwordx4 v3, s[8:11], s24 offen offset:3072 sc1 lds
M v[72:75], a[108:111], a[12:15], v[72:75]
 ds_read_b128 a[72:75], v2 offset:51200
 v_accvgpr_write_b32 a140, v216
M v[72:75], a[112:115], a[16:19], v[72:75]
 s_add_u32 m0, s28, 69632
 ds_read_b128 a[76:79], v2 offset:52224
 v_accvgpr_write_b32 a141, v217
M v[72:75], a[116:119], a[20:23], v[72:75]
 buffer_load_dwordx4 v4, s[8:11], s24 offen offset:0 sc1 lds
M v[72:75], a[120:123], a[24:27], v[72:75]
 ds_read_b128 a[80:83], v2 offset:53248
 v_accvgpr_write_b32 a142, v218
M v[72:75], a[124:127], a[28:31], v[72:75]
 s_add_u32 s3, s32, 0
 ds_read_b128 a[84:87], v2 offset:54272
 v_accvgpr_write_b32 a143, v219
M v[76:79], a[124:127], a[60:63], v[36:39]
 buffer_store_dwordx4 a[0:3], v6, s[8:11], s3 offen offset:0 sc1
M v[76:79], a[120:123], a[56:59], v[76:79]
 ds_read_b128 a[88:91], v2 offset:55296
 v_accvgpr_write_b32 a144, v224
M v[76:79], a[116:119], a[52:55], v[76:79]
 ds_read_b128 a[92:95], v2 offset:56320
 v_accvgpr_write_b32 a145, v225
M v[76:79], a[112:115], a[48:51], v[76:79]
 buffer_load_dwordx4 v4, s[8:11], s24 offen offset:1024 sc1 lds
M v[76:79], a[108:111], a[44:47], v[76:79]
 v_exp_f32 v20, v66
M v[76:79], a[104:107], a[40:43], v[76:79]
 buffer_store_dwordx4 a[4:7], v6, s[8:11], s3 offen offset:1024 sc1
M v[76:79], a[100:103], a[36:39], v[76:79]
 v_exp_f32 v21, v67
M v[76:79], a[96:99], a[32:35], v[76:79]
 s_waitcnt lgkmcnt(0)
 v_exp_f32 v22, v68
M v[80:83], a[64:67], a[0:3], v[32:35]
 ds_read_b128 a[96:99], v2 offset:57344
 v_add_f32 v26, v20, v26
M v[80:83], a[68:71], a[4:7], v[80:83]
 ds_read_b128 a[100:103], v2 offset:58368
 v_cvt_pk_bf16_f32 v41, v20, v21
M v[80:83], a[72:75], a[8:11], v[80:83]
 buffer_load_dwordx4 v4, s[8:11], s24 offen offset:2048 sc1 lds
M v[80:83], a[76:79], a[12:15], v[80:83]
 ds_read_b128 a[104:107], v2 offset:59392
 v_add_f32 v26, v21, v26
M v[80:83], a[80:83], a[16:19], v[80:83]
 ds_read_b128 a[108:111], v2 offset:60416
 v_accvgpr_write_b32 a146, v226
M v[80:83], a[84:87], a[20:23], v[80:83]
 buffer_store_dwordx4 a[8:11], v6, s[8:11], s3 offen offset:2048 sc1
M v[80:83], a[88:91], a[24:27], v[80:83]
 ds_read_b128 a[112:115], v2 offset:61440
 v_accvgpr_write_b32 a147, v227
M v[80:83], a[92:95], a[28:31], v[80:83]
 ds_read_b128 a[116:119], v2 offset:62464
 v_accvgpr_write_b32 a148, v232
M v[84:87], a[92:95], a[60:63], v[36:39]
 buffer_load_dwordx4 v4, s[8:11], s24 offen offset:3072 sc1 lds
M v[84:87], a[88:91], a[56:59], v[84:87]
 ds_read_b128 a[120:123], v2 offset:63488
 v_accvgpr_write_b32 a149, v233
M v[84:87], a[84:87], a[52:55], v[84:87]
 ds_read_b128 a[124:127], v2 offset:64512
 v_accvgpr_write_b32 a150, v234
M v[84:87], a[80:83], a[48:51], v[84:87]
 buffer_store_dwordx4 a[12:15], v6, s[8:11], s3 offen offset:3072 sc1
M v[84:87], a[76:79], a[44:47], v[84:87]
 s_add_u32 s3, s32, 4096
 v_exp_f32 v23, v69
M v[84:87], a[72:75], a[40:43], v[84:87]
 buffer_store_dwordx4 a[16:19], v6, s[8:11], s3 offen offset:0 sc1
M v[84:87], a[68:71], a[36:39], v[84:87]
 s_waitcnt vmcnt(13) lgkmcnt(0)
 v_exp_f32 v24, v70
M v[84:87], a[64:67], a[32:35], v[84:87]
 s_barrier
M v[88:91], a[96:99], a[0:3], v[32:35]
 ds_read_b128 a[64:67], v7 offset:32768
 v_add_f32 v27, v22, v23
M v[88:91], a[100:103], a[4:7], v[88:91]
 ds_read_b128 a[68:71], v7 offset:33792
 v_cvt_pk_bf16_f32 v44, v22, v23
M v[88:91], a[104:107], a[8:11], v[88:91]
 buffer_store_dword v17, v1, s[8:11], s45 offen sc1
M v[88:91], a[108:111], a[12:15], v[88:91]
 ds_read_b128 a[72:75], v7 offset:34816
 v_accvgpr_write_b32 a151, v235
M v[88:91], a[112:115], a[16:19], v[88:91]
 ds_read_b128 a[76:79], v7 offset:35840
 v_accvgpr_write_b32 a152, v240
M v[88:91], a[116:119], a[20:23], v[88:91]
 buffer_store_dwordx4 a[20:23], v6, s[8:11], s3 offen offset:1024 sc1
M v[88:91], a[120:123], a[24:27], v[88:91]
 ds_read_b128 a[80:83], v7 offset:36864
 v_accvgpr_write_b32 a153, v241
M v[88:91], a[124:127], a[28:31], v[88:91]
 ds_read_b128 a[84:87], v7 offset:37888
 v_accvgpr_write_b32 a154, v242
M v[92:95], a[124:127], a[60:63], v[36:39]
 buffer_store_dwordx4 a[24:27], v6, s[8:11], s3 offen offset:2048 sc1
M v[92:95], a[120:123], a[56:59], v[92:95]
 ds_read_b128 a[88:91], v7 offset:38912
 v_accvgpr_write_b32 a155, v243
M v[92:95], a[116:119], a[52:55], v[92:95]
 ds_read_b128 a[92:95], v7 offset:39936
 v_accvgpr_write_b32 a156, v248
M v[92:95], a[112:115], a[48:51], v[92:95]
 buffer_store_dwordx4 a[28:31], v6, s[8:11], s3 offen offset:3072 sc1
M v[92:95], a[108:111], a[44:47], v[92:95]
 v_exp_f32 v25, v71
M v[92:95], a[104:107], a[40:43], v[92:95]
 v_exp_f32 v18, v72
M v[92:95], a[100:103], a[36:39], v[92:95]
 s_waitcnt lgkmcnt(0)
 v_exp_f32 v19, v73
M v[92:95], a[96:99], a[32:35], v[92:95]
 v_exp_f32 v20, v74
M v[96:99], a[64:67], a[0:3], v[32:35]
 s_add_u32 m0, s28, 98304
 ds_read_b128 a[96:99], v7 offset:40960
 ds_read_b128 a[100:103], v7 offset:41984
M v[96:99], a[68:71], a[4:7], v[96:99]
 buffer_load_dwordx4 v3, s[8:11], s21 offen offset:0 sc1 lds
M v[96:99], a[72:75], a[8:11], v[96:99]
 v_exp_f32 v21, v75
M v[96:99], a[76:79], a[12:15], v[96:99]
 s_add_u32 s3, s32, 8192
 ds_read_b128 a[104:107], v7 offset:43008
 ds_read_b128 a[108:111], v7 offset:44032
M v[96:99], a[80:83], a[16:19], v[96:99]
 buffer_store_dwordx4 a[32:35], v6, s[8:11], s3 offen offset:0 sc1
M v[96:99], a[84:87], a[20:23], v[96:99]
 v_exp_f32 v22, v76
M v[96:99], a[88:91], a[24:27], v[96:99]
 ds_read_b128 a[112:115], v7 offset:45056
 ds_read_b128 a[116:119], v7 offset:46080
M v[96:99], a[92:95], a[28:31], v[96:99]
 buffer_load_dwordx4 v3, s[8:11], s21 offen offset:1024 sc1 lds
M v[100:103], a[92:95], a[60:63], v[36:39]
 v_exp_f32 v23, v77
M v[100:103], a[88:91], a[56:59], v[100:103]
 ds_read_b128 a[120:123], v7 offset:47104
 ds_read_b128 a[124:127], v7 offset:48128
M v[100:103], a[84:87], a[52:55], v[100:103]
 buffer_store_dwordx4 a[36:39], v6, s[8:11], s3 offen offset:1024 sc1
M v[100:103], a[80:83], a[48:51], v[100:103]
 v_add_f32 v27, v24, v27
 v_cvt_pk_bf16_f32 v45, v24, v25
M v[100:103], a[76:79], a[44:47], v[100:103]
 buffer_load_dwordx4 v3, s[8:11], s21 offen offset:2048 sc1 lds
M v[100:103], a[72:75], a[40:43], v[100:103]
 v_add_f32 v27, v25, v27
 v_add_f32 v26, v18, v26
M v[100:103], a[68:71], a[36:39], v[100:103]
 v_exp_f32 v24, v78
M v[100:103], a[64:67], a[32:35], v[100:103]
 s_waitcnt lgkmcnt(0)
 v_exp_f32 v25, v79
M v[108:111], a[96:99], a[32:35], v[36:39]
 ds_read_b128 a[64:67], v7 offset:49152
 ds_read_b128 a[68:71], v7 offset:50176
M v[108:111], a[100:103], a[36:39], v[108:111]
 buffer_load_dwordx4 v3, s[8:11], s21 offen offset:3072 sc1 lds
M v[108:111], a[104:107], a[40:43], v[108:111]
 v_cvt_pk_bf16_f32 v42, v18, v19
 v_add_f32 v26, v19, v26
M v[108:111], a[108:111], a[44:47], v[108:111]
 ds_read_b128 a[72:75], v7 offset:51200
 ds_read_b128 a[76:79], v7 offset:52224
M v[108:111], a[112:115], a[48:51], v[108:111]
 buffer_store_dwordx4 a[40:43], v6, s[8:11], s3 offen offset:2048 sc1
M v[108:111], a[116:119], a[52:55], v[108:111]
 v_exp_f32 v18, v80
M v[108:111], a[120:123], a[56:59], v[108:111]
 s_add_u32 m0, s28, 102400
 ds_read_b128 a[80:83], v7 offset:53248
 ds_read_b128 a[84:87], v7 offset:54272
M v[108:111], a[124:127], a[60:63], v[108:111]
 buffer_load_dwordx4 v4, s[8:11], s21 offen offset:0 sc1 lds
M v[104:107], a[124:127], a[28:31], v[32:35]
 v_exp_f32 v19, v81
M v[104:107], a[120:123], a[24:27], v[104:107]
 ds_read_b128 a[88:91], v7 offset:55296
 ds_read_b128 a[92:95], v7 offset:56320
M v[104:107], a[116:119], a[20:23], v[104:107]
 buffer_store_dwordx4 a[44:47], v6, s[8:11], s3 offen offset:3072 sc1
M v[104:107], a[112:115], a[16:19], v[104:107]
 v_add_f32 v26, v20, v26
 v_cvt_pk_bf16_f32 v43, v20, v21
M v[104:107], a[108:111], a[12:15], v[104:107]
 buffer_load_dwordx4 v4, s[8:11], s21 offen offset:1024 sc1 lds
M v[104:107], a[104:107], a[8:11], v[104:107]
 s_add_u32 s3, s32, 12288
 v_add_f32 v26, v21, v26
 v_add_f32 v27, v22, v27
M v[104:107], a[100:103], a[4:7], v[104:107]
 buffer_store_dwordx4 a[48:51], v6, s[8:11], s3 offen offset:0 sc1
M v[104:107], a[96:99], a[0:3], v[104:107]
 s_waitcnt lgkmcnt(0)
 v_exp_f32 v20, v82
M v[112:115], a[64:67], a[0:3], v[32:35]
 ds_read_b128 a[96:99], v7 offset:57344
 ds_read_b128 a[100:103], v7 offset:58368
M v[112:115], a[68:71], a[4:7], v[112:115]
 buffer_load_dwordx4 v4, s[8:11], s21 offen offset:2048 sc1 lds
M v[112:115], a[72:75], a[8:11], v[112:115]
 v_exp_f32 v21, v83
M v[112:115], a[76:79], a[12:15], v[112:115]
 ds_read_b128 a[104:107], v7 offset:59392
 ds_read_b128 a[108:111], v7 offset:60416
M v[112:115], a[80:83], a[16:19], v[112:115]
 buffer_load_dwordx4 v4, s[8:11], s21 offen offset:3072 sc1 lds
M v[112:115], a[84:87], a[20:23], v[112:115]
 s_add_u32 s24, s23, 16777216
 v_cvt_pk_bf16_f32 v46, v22, v23
 v_add_f32 v27, v23, v27
M v[112:115], a[88:91], a[24:27], v[112:115]
 s_mov_b32 s23, s21
 ds_read_b128 a[112:115], v7 offset:61440
 ds_read_b128 a[116:119], v7 offset:62464
M v[112:115], a[92:95], a[28:31], v[112:115]
 buffer_store_dwordx4 a[52:55], v6, s[8:11], s3 offen offset:1024 sc1
M v[116:119], a[92:95], a[60:63], v[36:39]
 s_add_u32 s21, s21, 32768
 v_add_f32 v27, v24, v27
M v[116:119], a[88:91], a[56:59], v[116:119]
 s_add_u32 s22, s22, 1
 ds_read_b128 a[120:123], v7 offset:63488
 ds_read_b128 a[124:127], v7 offset:64512
M v[116:119], a[84:87], a[52:55], v[116:119]
 s_cmp_eq_u32 s22, s25
 v_exp_f32 v22, v88
M v[116:119], a[80:83], a[48:51], v[116:119]
 s_cselect_b32 s21, s26, s21
 v_exp_f32 v23, v89
M v[116:119], a[76:79], a[44:47], v[116:119]
 buffer_store_dwordx4 a[56:59], v6, s[8:11], s3 offen offset:2048 sc1
M v[116:119], a[72:75], a[40:43], v[116:119]
 s_cmp_eq_u32 s22, s43
 v_cvt_pk_bf16_f32 v47, v24, v25
 v_add_f32 v27, v25, v27
M v[116:119], a[68:71], a[36:39], v[116:119]
 s_waitcnt vmcnt(21) lgkmcnt(0)
 v_exp_f32 v24, v90
M v[116:119], a[64:67], a[32:35], v[116:119]
 s_barrier
M v[124:127], a[96:99], a[32:35], v[36:39]
 s_cselect_b32 s21, s4, s21
 ds_read_b128 a[64:67], v2 offset:0
 ds_read_b128 a[68:71], v2 offset:1024
M v[124:127], a[100:103], a[36:39], v[124:127]
 s_cmp_eq_u32 s22, s6
 v_exp_f32 v25, v91
M v[124:127], a[104:107], a[40:43], v[124:127]
 s_cselect_b32 s21, s7, s21
 v_add_f32 v26, v18, v26
 v_cvt_pk_bf16_f32 v56, v18, v19
M v[124:127], a[108:111], a[44:47], v[124:127]
 ds_read_b128 a[72:75], v2 offset:2048
 ds_read_b128 a[76:79], v2 offset:3072
M v[124:127], a[112:115], a[48:51], v[124:127]
 buffer_store_dwordx4 a[60:63], v6, s[8:11], s3 offen offset:3072 sc1
M v[124:127], a[116:119], a[52:55], v[124:127]
 v_add_f32 v26, v19, v26
 v_add_f32 v26, v20, v26
M v[124:127], a[120:123], a[56:59], v[124:127]
 ds_read_b128 a[80:83], v2 offset:4096
 ds_read_b128 a[84:87], v2 offset:5120
M v[124:127], a[124:127], a[60:63], v[124:127]
 v_exp_f32 v18, v84
M v[120:123], a[124:127], a[28:31], v[32:35]
 v_exp_f32 v19, v85
M v[120:123], a[120:123], a[24:27], v[120:123]
 ds_read_b128 a[88:91], v2 offset:6144
 ds_read_b128 a[92:95], v2 offset:7168
M v[120:123], a[116:119], a[20:23], v[120:123]
 v_cvt_pk_bf16_f32 v57, v20, v21
 v_add_f32 v26, v21, v26
M v[120:123], a[112:115], a[16:19], v[120:123]
 v_exp_f32 v20, v86
M v[120:123], a[108:111], a[12:15], v[120:123]
 v_exp_f32 v21, v87
M v[120:123], a[104:107], a[8:11], v[120:123]
 v_add_f32 v26, v22, v26
 v_cvt_pk_bf16_f32 v58, v22, v23
M v[120:123], a[100:103], a[4:7], v[120:123]
 s_waitcnt lgkmcnt(0)
 v_add_f32 v26, v23, v26
 v_add_f32 v26, v24, v26
M v[120:123], a[96:99], a[0:3], v[120:123]
 v_exp_f32 v22, v92
 v_cvt_pk_bf16_f32 v59, v24, v25
 v_add_f32 v26, v25, v26
 v_add_f32 v27, v18, v27
 v_cvt_pk_bf16_f32 v60, v18, v19
 v_add_f32 v27, v19, v27
 v_exp_f32 v23, v93
 v_add_f32 v27, v20, v27
 v_cvt_pk_bf16_f32 v61, v20, v21
 v_add_f32 v27, v21, v27
 v_exp_f32 v24, v94
 v_add_f32 v27, v22, v27
 v_cvt_pk_bf16_f32 v62, v22, v23
 v_exp_f32 v25, v95
 v_add_f32 v27, v23, v27
 v_add_f32 v27, v24, v27
 v_cvt_pk_bf16_f32 v63, v24, v25
 v_add_f32 v27, v25, v27
 v_max_f32 v10, v26, v27
 v_min_f32 v11, v26, v27
 v_cmp_lt_f32 s[36:37], s31, v10
 v_cmp_gt_f32 vcc, s55, v11
 s_nop 0
 s_or_b64 vcc, vcc, s[36:37]
 s_cbranch_vccnz L_st8
L_rt8:
M v[128:131], a[64:67], v[40:43], 0
 s_add_u32 m0, s28, 0
 ds_read_b128 a[96:99], v2 offset:8192
 ds_read_b128 a[100:103], v2 offset:9216
M v[128:131], a[68:71], v[56:59], v[128:131]
 buffer_load_dwordx4 v3, s[8:11], s24 offen offset:0 sc1 lds
M v[132:135], a[68:71], v[60:63], 0
 v_accvgpr_write_b32 a157, v249
 v_accvgpr_write_b32 a158, v250
M v[132:135], a[64:67], v[44:47], v[132:135]
 ds_read_b128 a[104:107], v2 offset:10240
 ds_read_b128 a[108:111], v2 offset:11264
M v[140:143], a[72:75], v[44:47], 0
 buffer_load_dwordx4 v3, s[8:11], s24 offen offset:1024 sc1 lds
M v[140:143], a[76:79], v[60:63], v[140:143]
 v_accvgpr_write_b32 a159, v251
 v_add_f32 v30, v26, v30
M v[136:139], a[76:79], v[56:59], 0
 ds_read_b128 a[112:115], v2 offset:12288
 ds_read_b128 a[116:119], v2 offset:13312
M v[136:139], a[72:75], v[40:43], v[136:139]
 buffer_load_dwordx4 v3, s[8:11], s24 offen offset:2048 sc1 lds
M v[144:147], a[80:83], v[40:43], 0
 v_exp_f32 v18, v96
M v[144:147], a[84:87], v[56:59], v[144:147]
 ds_read_b128 a[120:123], v2 offset:14336
 ds_read_b128 a[124:127], v2 offset:15360
M v[148:151], a[84:87], v[60:63], 0
 buffer_load_dwordx4 v3, s[8:11], s24 offen offset:3072 sc1 lds
M v[148:151], a[80:83], v[44:47], v[148:151]
 s_add_u32 m0, s28, 4096
 v_exp_f32 v19, v97
M v[156:159], a[88:91], v[44:47], 0
 buffer_load_dwordx4 v4, s[8:11], s24 offen offset:0 sc1 lds
M v[156:159], a[92:95], v[60:63], v[156:159]
 v_exp_f32 v20, v98
M v[152:155], a[92:95], v[56:59], 0
 v_exp_f32 v21, v99
M v[152:155], a[88:91], v[40:43], v[152:155]
 s_waitcnt lgkmcnt(0)
 v_exp_f32 v22, v104
M v[160:163], a[96:99], v[40:43], 0
 ds_read_b128 a[64:67], v2 offset:16384
 ds_read_b128 a[68:71], v2 offset:17408
M v[160:163], a[100:103], v[56:59], v[160:163]
 buffer_load_dwordx4 v4, s[8:11], s24 offen offset:1024 sc1 lds
M v[164:167], a[100:103], v[60:63], 0
 v_exp_f32 v23, v105
M v[164:167], a[96:99], v[44:47], v[164:167]
 ds_read_b128 a[72:75], v2 offset:18432
 ds_read_b128 a[76:79], v2 offset:19456
M v[172:175], a[104:107], v[44:47], 0
 buffer_load_dwordx4 v4, s[8:11], s24 offen offset:2048 sc1 lds
M v[172:175], a[108:111], v[60:63], v[172:175]
 v_add_f32 v31, v27, v31
 v_add_f32 v28, v18, v19
M v[168:171], a[108:111], v[56:59], 0
 ds_read_b128 a[80:83], v2 offset:20480
 ds_read_b128 a[84:87], v2 offset:21504
M v[168:171], a[104:107], v[40:43], v[168:171]
 buffer_load_dwordx4 v4, s[8:11], s24 offen offset:3072 sc1 lds
M v[176:179], a[112:115], v[40:43], 0
 v_exp_f32 v24, v106
M v[176:179], a[116:119], v[56:59], v[176:179]
 s_add_u32 m0, s28, 32768
 ds_read_b128 a[88:91], v2 offset:22528
 ds_read_b128 a[92:95], v2 offset:23552
M v[180:183], a[116:119], v[60:63], 0
 buffer_load_dwordx4 v3, s[8:11], s21 offen offset:0 sc1 lds
M v[180:183], a[112:115], v[44:47], v[180:183]
 v_exp_f32 v25, v107
M v[188:191], a[120:123], v[44:47], 0
 buffer_load_dwordx4 v3, s[8:11], s21 offen offset:1024 sc1 lds
M v[188:191], a[124:127], v[60:63], v[188:191]
 v_cvt_pk_bf16_f32 v48, v18, v19
 v_add_f32 v28, v20, v28
M v[184:187], a[124:127], v[56:59], 0
 buffer_load_dwordx4 v3, s[8:11], s21 offen offset:2048 sc1 lds
M v[184:187], a[120:123], v[40:43], v[184:187]
 s_waitcnt lgkmcnt(0)
 v_exp_f32 v18, v100
M v[192:195], a[64:67], v[40:43], 0
 ds_read_b128 a[96:99], v2 offset:24576
 ds_read_b128 a[100:103], v2 offset:25600
M v[192:195], a[68:71], v[56:59], v[192:195]
 buffer_load_dwordx4 v3, s[8:11], s21 offen offset:3072 sc1 lds
M v[196:199], a[68:71], v[60:63], 0
 v_exp_f32 v19, v101
M v[196:199], a[64:67], v[44:47], v[196:199]
 s_add_u32 m0, s28, 36864
 ds_read_b128 a[104:107], v2 offset:26624
 ds_read_b128 a[108:111], v2 offset:27648
M v[204:207], a[72:75], v[44:47], 0
 buffer_load_dwordx4 v4, s[8:11], s21 offen offset:0 sc1 lds
M v[204:207], a[76:79], v[60:63], v[204:207]
 v_cvt_pk_bf16_f32 v49, v20, v21
 v_add_f32 v28, v21, v28
M v[200:203], a[76:79], v[56:59], 0
 ds_read_b128 a[112:115], v2 offset:28672
 ds_read_b128 a[116:119], v2 offset:29696
M v[200:203], a[72:75], v[40:43], v[200:203]
 buffer_load_dwordx4 v4, s[8:11], s21 offen offset:1024 sc1 lds
M v[208:211], a[80:83], v[40:43], 0
 v_exp_f32 v20, v102
M v[208:211], a[84:87], v[56:59], v[208:211]
 ds_read_b128 a[120:123], v2 offset:30720
 ds_read_b128 a[124:127], v2 offset:31744
M v[212:215], a[84:87], v[60:63], 0
 buffer_load_dwordx4 v4, s[8:11], s21 offen offset:2048 sc1 lds
M v[212:215], a[80:83], v[44:47], v[212:215]
 v_exp_f32 v21, v103
M v[220:223], a[88:91], v[44:47], 0
 v_add_f32 v28, v22, v28
 v_cvt_pk_bf16_f32 v50, v22, v23
M v[220:223], a[92:95], v[60:63], v[220:223]
 buffer_load_dwordx4 v4, s[8:11], s21 offen offset:3072 sc1 lds
M v[216:219], a[92:95], v[56:59], 0
 s_waitcnt vmcnt(16) lgkmcnt(0)
 s_add_u32 s24, s23, 16777216
 s_mov_b32 s23, s21
M v[216:219], a[88:91], v[40:43], v[216:219]
 s_barrier
M v[224:227], a[96:99], v[40:43], 0
 ds_read_b128 a[64:67], v2 offset:32768
 ds_read_b128 a[68:71], v2 offset:33792
M v[224:227], a[100:103], v[56:59], v[224:227]
 s_xor_b32 s3, s47, 64
 v_mov_b32 v5, 1
M v[228:231], a[100:103], v[60:63], 0
 v_min_u32 v6, 1, v7
 v_lshlrev_b32 v6, 29, v6
M v[228:231], a[96:99], v[44:47], v[228:231]
 ds_read_b128 a[72:75], v2 offset:34816
 ds_read_b128 a[76:79], v2 offset:35840
M v[236:239], a[104:107], v[44:47], 0
 v_or_b32 v6, s35, v6
 s_add_u32 s21, s21, 32768
M v[236:239], a[108:111], v[60:63], v[236:239]
 buffer_store_dword v5, v6, s[8:11], s3 offen sc1
M v[232:235], a[108:111], v[56:59], 0
 ds_read_b128 a[80:83], v2 offset:36864
 ds_read_b128 a[84:87], v2 offset:37888
M v[232:235], a[104:107], v[40:43], v[232:235]
 s_add_u32 s22, s22, 1
 v_add_f32 v28, v23, v28
M v[240:243], a[112:115], v[40:43], 0
 s_cmp_eq_u32 s22, s25
 v_exp_f32 v22, v108
M v[240:243], a[116:119], v[56:59], v[240:243]
 s_cselect_b32 s21, s26, s21
 ds_read_b128 a[88:91], v2 offset:38912
 ds_read_b128 a[92:95], v2 offset:39936
M v[244:247], a[116:119], v[60:63], 0
 s_cmp_eq_u32 s22, s43
 v_exp_f32 v23, v109
M v[244:247], a[112:115], v[44:47], v[244:247]
 s_cselect_b32 s21, s4, s21
 v_add_f32 v28, v24, v28
 v_cvt_pk_bf16_f32 v51, v24, v25
M v[252:255], a[120:123], v[44:47], 0
 s_cmp_eq_u32 s22, s6
 v_add_f32 v28, v25, v28
 v_add_f32 v29, v18, v19
M v[252:255], a[124:127], v[60:63], v[252:255]
 s_cselect_b32 s21, s7, s21
 v_exp_f32 v24, v110
M v[248:251], a[124:127], v[56:59], 0
 s_waitcnt lgkmcnt(0)
 v_exp_f32 v25, v111
M v[248:251], a[120:123], v[40:43], v[248:251]
 v_cvt_pk_bf16_f32 v52, v18, v19
 v_add_f32 v29, v20, v29
 v_cvt_pk_bf16_f32 v53, v20, v21
 v_add_f32 v29, v21, v29
 v_add_f32 v29, v22, v29
 v_cvt_pk_bf16_f32 v54, v22, v23
 v_add_f32 v29, v23, v29
 v_add_f32 v29, v24, v29
 v_cvt_pk_bf16_f32 v55, v24, v25
 v_add_f32 v29, v25, v29
M v[64:67], a[64:67], a[0:3], v[32:35]
 s_add_u32 m0, s28, 65536
 ds_read_b128 a[96:99], v2 offset:40960
 ds_read_b128 a[100:103], v2 offset:41984
M v[64:67], a[68:71], a[4:7], v[64:67]
 buffer_load_dwordx4 v3, s[8:11], s24 offen offset:0 sc1 lds
M v[64:67], a[72:75], a[8:11], v[64:67]
 v_exp_f32 v18, v112
M v[64:67], a[76:79], a[12:15], v[64:67]
 s_add_u32 s3, s30, 786432
 ds_read_b128 a[104:107], v2 offset:43008
 ds_read_b128 a[108:111], v2 offset:44032
M v[64:67], a[80:83], a[16:19], v[64:67]
 buffer_store_dwordx4 a[128:131], v7, s[8:11], s3 offen offset:0 sc1
M v[64:67], a[84:87], a[20:23], v[64:67]
 v_exp_f32 v19, v113
M v[64:67], a[88:91], a[24:27], v[64:67]
 ds_read_b128 a[112:115], v2 offset:45056
 ds_read_b128 a[116:119], v2 offset:46080
M v[64:67], a[92:95], a[28:31], v[64:67]
 buffer_load_dwordx4 v3, s[8:11], s24 offen offset:1024 sc1 lds
M v[68:71], a[92:95], a[60:63], v[36:39]
 v_exp_f32 v20, v114
M v[68:71], a[88:91], a[56:59], v[68:71]
 ds_read_b128 a[120:123], v2 offset:47104
 ds_read_b128 a[124:127], v2 offset:48128
M v[68:71], a[84:87], a[52:55], v[68:71]
 v_exp_f32 v21, v115
M v[68:71], a[80:83], a[48:51], v[68:71]
 v_add_f32 v28, v18, v28
 v_cvt_pk_bf16_f32 v56, v18, v19
M v[68:71], a[76:79], a[44:47], v[68:71]
 v_add_f32 v28, v19, v28
 v_add_f32 v28, v20, v28
M v[68:71], a[72:75], a[40:43], v[68:71]
 buffer_load_dwordx4 v3, s[8:11], s24 offen offset:2048 sc1 lds
M v[68:71], a[68:71], a[36:39], v[68:71]
 v_exp_f32 v22, v120
M v[68:71], a[64:67], a[32:35], v[68:71]
 s_waitcnt lgkmcnt(0)
 v_cvt_pk_bf16_f32 v57, v20, v21
 v_add_f32 v28, v21, v28
M v[76:79], a[96:99], a[32:35], v[36:39]
 ds_read_b128 a[64:67], v2 offset:49152
 ds_read_b128 a[68:71], v2 offset:50176
M v[76:79], a[100:103], a[36:39], v[76:79]
 buffer_store_dwordx4 a[132:135], v7, s[8:11], s3 offen offset:1024 sc1
M v[76:79], a[104:107], a[40:43], v[76:79]
 v_exp_f32 v23, v121
M v[76:79], a[108:111], a[44:47], v[76:79]
 ds_read_b128 a[72:75], v2 offset:51200
 ds_read_b128 a[76:79], v2 offset:52224
M v[76:79], a[112:115], a[48:51], v[76:79]
 buffer_load_dwordx4 v3, s[8:11], s24 offen offset:3072 sc1 lds
M v[76:79], a[116:119], a[52:55], v[76:79]
 v_exp_f32 v24, v122
M v[76:79], a[120:123], a[56:59], v[76:79]
 ds_read_b128 a[80:83], v2 offset:53248
 ds_read_b128 a[84:87], v2 offset:54272
M v[76:79], a[124:127], a[60:63], v[76:79]
 v_add_f32 v28, v22, v28
 v_cvt_pk_bf16_f32 v58, v22, v23
M v[72:75], a[124:127], a[28:31], v[32:35]
 v_exp_f32 v25, v123
M v[72:75], a[120:123], a[24:27], v[72:75]
 s_add_u32 m0, s28, 69632
 ds_read_b128 a[88:91], v2 offset:55296
 ds_read_b128 a[92:95], v2 offset:56320
M v[72:75], a[116:119], a[20:23], v[72:75]
 buffer_load_dwordx4 v4, s[8:11], s24 offen offset:0 sc1 lds
M v[72:75], a[112:115], a[16:19], v[72:75]
 v_add_f32 v28, v23, v28
 v_add_f32 v28, v24, v28
M v[72:75], a[108:111], a[12:15], v[72:75]
 v_exp_f32 v18, v116
M v[72:75], a[104:107], a[8:11], v[72:75]
 v_cvt_pk_bf16_f32 v59, v24, v25
 v_add_f32 v28, v25, v28
M v[72:75], a[100:103], a[4:7], v[72:75]
M v[72:75], a[96:99], a[0:3], v[72:75]
 s_waitcnt lgkmcnt(0)
 v_exp_f32 v19, v117
M v[80:83], a[64:67], a[0:3], v[32:35]
 ds_read_b128 a[96:99], v2 offset:57344
 ds_read_b128 a[100:103], v2 offset:58368
M v[80:83], a[68:71], a[4:7], v[80:83]
 buffer_store_dwordx4 a[136:139], v7, s[8:11], s3 offen offset:2048 sc1
M v[80:83], a[72:75], a[8:11], v[80:83]
 v_add_f32 v29, v18, v29
 v_cvt_pk_bf16_f32 v60, v18, v19
M v[80:83], a[76:79], a[12:15], v[80:83]
 ds_read_b128 a[104:107], v2 offset:59392
 ds_read_b128 a[108:111], v2 offset:60416
M v[80:83], a[80:83], a[16:19], v[80:83]
 buffer_load_dwordx4 v4, s[8:11], s24 offen offset:1024 sc1 lds
M v[80:83], a[84:87], a[20:23], v[80:83]
 v_exp_f32 v20, v118
M v[80:83], a[88:91], a[24:27], v[80:83]
 ds_read_b128 a[112:115], v2 offset:61440
 ds_read_b128 a[116:119], v2 offset:62464
M v[80:83], a[92:95], a[28:31], v[80:83]
 buffer_load_dwordx4 v4, s[8:11], s24 offen offset:2048 sc1 lds
M v[84:87], a[92:95], a[60:63], v[36:39]
 v_exp_f32 v21, v119
M v[84:87], a[88:91], a[56:59], v[84:87]
 ds_read_b128 a[120:123], v2 offset:63488
 ds_read_b128 a[124:127], v2 offset:64512
M v[84:87], a[84:87], a[52:55], v[84:87]
 v_exp_f32 v22, v124
M v[84:87], a[80:83], a[48:51], v[84:87]
 buffer_load_dwordx4 v4, s[8:11], s24 offen offset:3072 sc1 lds
M v[84:87], a[76:79], a[44:47], v[84:87]
 v_add_f32 v29, v19, v29
 v_add_f32 v29, v20, v29
M v[84:87], a[72:75], a[40:43], v[84:87]
 buffer_store_dwordx4 a[140:143], v7, s[8:11], s3 offen offset:3072 sc1
M v[84:87], a[68:71], a[36:39], v[84:87]
 s_waitcnt vmcnt(21) lgkmcnt(0)
 v_exp_f32 v23, v125
M v[84:87], a[64:67], a[32:35], v[84:87]
 s_barrier
M v[92:95], a[96:99], a[32:35], v[36:39]
 ds_read_b128 a[64:67], v7 offset:0
 ds_read_b128 a[68:71], v7 offset:1024
M v[92:95], a[100:103], a[36:39], v[92:95]
 v_exp_f32 v24, v126
M v[92:95], a[104:107], a[40:43], v[92:95]
 v_cvt_pk_bf16_f32 v61, v20, v21
 v_add_f32 v29, v21, v29
M v[92:95], a[108:111], a[44:47], v[92:95]
 ds_read_b128 a[72:75], v7 offset:2048
 ds_read_b128 a[76:79], v7 offset:3072
M v[92:95], a[112:115], a[48:51], v[92:95]
 v_exp_f32 v25, v127
M v[92:95], a[116:119], a[52:55], v[92:95]
 v_add_f32 v29, v22, v29
 v_cvt_pk_bf16_f32 v62, v22, v23
M v[92:95], a[120:123], a[56:59], v[92:95]
 ds_read_b128 a[80:83], v7 offset:4096
 ds_read_b128 a[84:87], v7 offset:5120
M v[92:95], a[124:127], a[60:63], v[92:95]
 v_add_f32 v29, v23, v29
 v_add_f32 v29, v24, v29
M v[88:91], a[124:127], a[28:31], v[32:35]
 v_cvt_pk_bf16_f32 v63, v24, v25
 v_add_f32 v29, v25, v29
M v[88:91], a[120:123], a[24:27], v[88:91]
 ds_read_b128 a[88:91], v7 offset:6144
 ds_read_b128 a[92:95], v7 offset:7168
M v[88:91], a[116:119], a[20:23], v[88:91]
 v_max_f32 v10, v28, v29
M v[88:91], a[112:115], a[16:19], v[88:91]
 v_cmp_lt_f32 vcc, s31, v10
M v[88:91], a[108:111], a[12:15], v[88:91]
M v[88:91], a[104:107], a[8:11], v[88:91]
M v[88:91], a[100:103], a[4:7], v[88:91]
 s_waitcnt lgkmcnt(0)
M v[88:91], a[96:99], a[0:3], v[88:91]
 s_cbranch_vccnz L_st9
L_rt9:
M v[128:131], a[64:67], v[48:51], v[128:131]
 s_add_u32 m0, s28, 98304
 ds_read_b128 a[96:99], v7 offset:8192
 ds_read_b128 a[100:103], v7 offset:9216
M v[128:131], a[68:71], v[56:59], v[128:131]
 buffer_load_dwordx4 v3, s[8:11], s21 offen offset:0 sc1 lds
M v[132:135], a[68:71], v[60:63], v[132:135]
 v_exp_f32 v18, v64
M v[132:135], a[64:67], v[52:55], v[132:135]
 s_add_u32 s3, s30, 794624
 ds_read_b128 a[104:107], v7 offset:10240
 ds_read_b128 a[108:111], v7 offset:11264
M v[140:143], a[72:75], v[52:55], v[140:143]
 buffer_store_dwordx4 a[144:147], v7, s[8:11], s3 offen offset:0 sc1
M v[140:143], a[76:79], v[60:63], v[140:143]
 v_exp_f32 v19, v65
M v[136:139], a[76:79], v[56:59], v[136:139]
 ds_read_b128 a[112:115], v7 offset:12288
 ds_read_b128 a[116:119], v7 offset:13312
M v[136:139], a[72:75], v[48:51], v[136:139]
 buffer_load_dwordx4 v3, s[8:11], s21 offen offset:1024 sc1 lds
M v[144:147], a[80:83], v[48:51], v[144:147]
 v_exp_f32 v20, v66
M v[144:147], a[84:87], v[56:59], v[144:147]
 ds_read_b128 a[120:123], v7 offset:14336
 ds_read_b128 a[124:127], v7 offset:15360
M v[148:151], a[84:87], v[60:63], v[148:151]
 v_add_f32 v30, v28, v30
 v_add_f32 v31, v29, v31
M v[148:151], a[80:83], v[52:55], v[148:151]
 buffer_load_dwordx4 v3, s[8:11], s21 offen offset:2048 sc1 lds
M v[156:159], a[88:91], v[52:55], v[156:159]
 v_exp_f32 v21, v67
M v[156:159], a[92:95], v[60:63], v[156:159]
 v_add_f32 v26, v18, v19
 v_cvt_pk_bf16_f32 v40, v18, v19
M v[152:155], a[92:95], v[56:59], v[152:155]
 v_exp_f32 v22, v72
M v[152:155], a[88:91], v[48:51], v[152:155]
 s_waitcnt lgkmcnt(0)
 v_add_f32 v26, v20, v26
 v_cvt_pk_bf16_f32 v41, v20, v21
M v[160:163], a[96:99], v[48:51], v[160:163]
 ds_read_b128 a[64:67], v7 offset:16384
 ds_read_b128 a[68:71], v7 offset:17408
M v[160:163], a[100:103], v[56:59], v[160:163]
 buffer_store_dwordx4 a[148:151], v7, s[8:11], s3 offen offset:1024 sc1
M v[164:167], a[100:103], v[60:63], v[164:167]
 v_exp_f32 v23, v73
M v[164:167], a[96:99], v[52:55], v[164:167]
 ds_read_b128 a[72:75], v7 offset:18432
 ds_read_b128 a[76:79], v7 offset:19456
M v[172:175], a[104:107], v[52:55], v[172:175]
 buffer_load_dwordx4 v3, s[8:11], s21 offen offset:3072 sc1 lds
M v[172:175], a[108:111], v[60:63], v[172:175]
 v_add_f32 v26, v21, v26
 v_add_f32 v26, v22, v26
M v[168:171], a[108:111], v[56:59], v[168:171]
 s_add_u32 m0, s28, 102400
 ds_read_b128 a[80:83], v7 offset:20480
 ds_read_b128 a[84:87], v7 offset:21504
M v[168:171], a[104:107], v[48:51], v[168:171]
 buffer_load_dwordx4 v4, s[8:11], s21 offen offset:0 sc1 lds
M v[176:179], a[112:115], v[48:51], v[176:179]
 v_exp_f32 v24, v74
M v[176:179], a[116:119], v[56:59], v[176:179]
 ds_read_b128 a[88:91], v7 offset:22528
 ds_read_b128 a[92:95], v7 offset:23552
M v[180:183], a[116:119], v[60:63], v[180:183]
 v_exp_f32 v25, v75
M v[180:183], a[112:115], v[52:55], v[180:183]
 buffer_load_dwordx4 v4, s[8:11], s21 offen offset:1024 sc1 lds
M v[188:191], a[120:123], v[52:55], v[188:191]
 v_cvt_pk_bf16_f32 v42, v22, v23
 v_add_f32 v26, v23, v26
M v[188:191], a[124:127], v[60:63], v[188:191]
 v_exp_f32 v18, v68
M v[184:187], a[124:127], v[56:59], v[184:187]
 v_add_f32 v26, v24, v26
 v_cvt_pk_bf16_f32 v43, v24, v25
M v[184:187], a[120:123], v[48:51], v[184:187]
 s_waitcnt lgkmcnt(0)
 v_add_f32 v26, v25, v26
M v[192:195], a[64:67], v[48:51], v[192:195]
 ds_read_b128 a[96:99], v7 offset:24576
 ds_read_b128 a[100:103], v7 offset:25600
M v[192:195], a[68:71], v[56:59], v[192:195]
 buffer_store_dwordx4 a[152:155], v7, s[8:11], s3 offen offset:2048 sc1
M v[196:199], a[68:71], v[60:63], v[196:199]
 v_exp_f32 v19, v69
M v[196:199], a[64:67], v[52:55], v[196:199]
 ds_read_b128 a[104:107], v7 offset:26624
 ds_read_b128 a[108:111], v7 offset:27648
M v[204:207], a[72:75], v[52:55], v[204:207]
 buffer_load_dwordx4 v4, s[8:11], s21 offen offset:2048 sc1 lds
M v[204:207], a[76:79], v[60:63], v[204:207]
 v_exp_f32 v20, v70
M v[200:203], a[76:79], v[56:59], v[200:203]
 ds_read_b128 a[112:115], v7 offset:28672
 ds_read_b128 a[116:119], v7 offset:29696
M v[200:203], a[72:75], v[48:51], v[200:203]
 buffer_load_dwordx4 v4, s[8:11], s21 offen offset:3072 sc1 lds
M v[208:211], a[80:83], v[48:51], v[208:211]
 s_add_u32 s24, s23, 16777216
 v_exp_f32 v21, v71
M v[208:211], a[84:87], v[56:59], v[208:211]
 s_mov_b32 s23, s21
 ds_read_b128 a[120:123], v7 offset:30720
 ds_read_b128 a[124:127], v7 offset:31744
M v[212:215], a[84:87], v[60:63], v[212:215]
 s_add_u32 s21, s21, 32768
 v_add_f32 v27, v18, v19
 v_cvt_pk_bf16_f32 v44, v18, v19
M v[212:215], a[80:83], v[52:55], v[212:215]
 s_add_u32 s22, s22, 1
 v_add_f32 v27, v20, v27
 v_cvt_pk_bf16_f32 v45, v20, v21
M v[220:223], a[88:91], v[52:55], v[220:223]
 s_cmp_eq_u32 s22, s25
 v_exp_f32 v22, v76
M v[220:223], a[92:95], v[60:63], v[220:223]
 buffer_store_dwordx4 a[156:159], v7, s[8:11], s3 offen offset:3072 sc1
M v[216:219], a[92:95], v[56:59], v[216:219]
 s_waitcnt vmcnt(25) lgkmcnt(0)
 v_add_f32 v27, v21, v27
M v[216:219], a[88:91], v[48:51], v[216:219]
 s_barrier
M v[224:227], a[96:99], v[48:51], v[224:227]
 s_cselect_b32 s21, s26, s21
 ds_read_b128 a[64:67], v7 offset:32768
 ds_read_b128 a[68:71], v7 offset:33792
M v[224:227], a[100:103], v[56:59], v[224:227]
 s_cmp_eq_u32 s22, s43
 v_exp_f32 v23, v77
M v[228:231], a[100:103], v[60:63], v[228:231]
 s_cselect_b32 s21, s4, s21
 v_add_f32 v27, v22, v27
 v_cvt_pk_bf16_f32 v46, v22, v23
M v[228:231], a[96:99], v[52:55], v[228:231]
 s_cmp_eq_u32 s22, s6
 ds_read_b128 a[72:75], v7 offset:34816
 ds_read_b128 a[76:79], v7 offset:35840
M v[236:239], a[104:107], v[52:55], v[236:239]
 s_cselect_b32 s21, s7, s21
 v_exp_f32 v24, v78
M v[236:239], a[108:111], v[60:63], v[236:239]
 v_add_f32 v27, v23, v27
M v[232:235], a[108:111], v[56:59], v[232:235]
 ds_read_b128 a[80:83], v7 offset:36864
 ds_read_b128 a[84:87], v7 offset:37888
M v[232:235], a[104:107], v[48:51], v[232:235]
 v_exp_f32 v25, v79
M v[240:243], a[112:115], v[48:51], v[240:243]
 v_add_f32 v27, v24, v27
 v_cvt_pk_bf16_f32 v47, v24, v25
M v[240:243], a[116:119], v[56:59], v[240:243]
 ds_read_b128 a[88:91], v7 offset:38912
 ds_read_b128 a[92:95], v7 offset:39936
M v[244:247], a[116:119], v[60:63], v[244:247]
 v_add_f32 v27, v25, v27
M v[244:247], a[112:115], v[52:55], v[244:247]
M v[252:255], a[120:123], v[52:55], v[252:255]
M v[252:255], a[124:127], v[60:63], v[252:255]
M v[248:251], a[124:127], v[56:59], v[248:251]
 s_waitcnt lgkmcnt(0)
M v[248:251], a[120:123], v[48:51], v[248:251]
M v[96:99], a[64:67], a[0:3], v[32:35]
 s_add_u32 m0, s28, 0
 ds_read_b128 a[96:99], v7 offset:40960
M v[96:99], a[68:71], a[4:7], v[96:99]
 ds_read_b128 a[100:103], v7 offset:41984
M v[96:99], a[72:75], a[8:11], v[96:99]
 buffer_load_dword v6, v9, s[8:11], s46 offen sc1
M v[96:99], a[76:79], a[12:15], v[96:99]
 s_cmp_eq_u32 s20, 0
 ds_read_b128 a[104:107], v7 offset:43008
M v[96:99], a[80:83], a[16:19], v[96:99]
 s_cselect_b64 s[64:65], s[16:17], 0
 ds_read_b128 a[108:111], v7 offset:44032
M v[96:99], a[84:87], a[20:23], v[96:99]
 buffer_load_dwordx4 v3, s[8:11], s24 offen offset:0 sc1 lds
M v[96:99], a[88:91], a[24:27], v[96:99]
 s_cselect_b64 s[66:67], s[18:19], 0
 ds_read_b128 a[112:115], v7 offset:45056
M v[96:99], a[92:95], a[28:31], v[96:99]
 s_cselect_b64 s[68:69], s[48:49], 0
 ds_read_b128 a[116:119], v7 offset:46080
M v[100:103], a[92:95], a[60:63], v[36:39]
 buffer_load_dwordx4 v3, s[8:11], s24 offen offset:1024 sc1 lds
M v[100:103], a[88:91], a[56:59], v[100:103]
 s_cselect_b64 s[70:71], s[50:51], 0
 ds_read_b128 a[120:123], v7 offset:47104
M v[100:103], a[84:87], a[52:55], v[100:103]
 s_cmp_lt_u32 s20, 1
 ds_read_b128 a[124:127], v7 offset:48128
M v[100:103], a[80:83], a[48:51], v[100:103]
 s_cselect_b64 s[78:79], -1, 0
 v_exp_f32 v18, v80
M v[100:103], a[76:79], a[44:47], v[100:103]
 buffer_load_dwordx4 v3, s[8:11], s24 offen offset:2048 sc1 lds
M v[100:103], a[72:75], a[40:43], v[100:103]
 s_cmp_eq_u32 s20, 1
 v_exp_f32 v19, v81
M v[100:103], a[68:71], a[36:39], v[100:103]
 s_cselect_b64 s[72:73], s[16:17], s[78:79]
 v_exp_f32 v20, v82
M v[100:103], a[64:67], a[32:35], v[100:103]
 s_waitcnt lgkmcnt(0)
 v_exp_f32 v21, v83
M v[108:111], a[96:99], a[32:35], v[36:39]
 s_cselect_b64 s[74:75], s[18:19], s[78:79]
 ds_read_b128 a[64:67], v7 offset:49152
 v_add_f32 v26, v18, v26
M v[108:111], a[100:103], a[36:39], v[108:111]
 s_cselect_b64 s[76:77], s[48:49], s[78:79]
 ds_read_b128 a[68:71], v7 offset:50176
 v_cvt_pk_bf16_f32 v56, v18, v19
M v[108:111], a[104:107], a[40:43], v[108:111]
 buffer_load_dwordx4 v3, s[8:11], s24 offen offset:3072 sc1 lds
M v[108:111], a[108:111], a[44:47], v[108:111]
 s_cselect_b64 s[78:79], s[50:51], s[78:79]
 ds_read_b128 a[72:75], v7 offset:51200
 v_add_f32 v26, v19, v26
M v[108:111], a[112:115], a[48:51], v[108:111]
 s_add_u32 s3, s29, 0
 ds_read_b128 a[76:79], v7 offset:52224
 v_add_f32 v26, v20, v26
M v[108:111], a[116:119], a[52:55], v[108:111]
 buffer_store_dwordx4 a[192:195], v7, s[8:11], s3 offen sc1
M v[108:111], a[120:123], a[56:59], v[108:111]
 s_add_u32 m0, s28, 4096
 ds_read_b128 a[80:83], v7 offset:53248
 v_cvt_pk_bf16_f32 v57, v20, v21
M v[108:111], a[124:127], a[60:63], v[108:111]
 ds_read_b128 a[84:87], v7 offset:54272
 v_add_f32 v26, v21, v26
M v[104:107], a[124:127], a[28:31], v[32:35]
 buffer_load_dwordx4 v4, s[8:11], s24 offen offset:0 sc1 lds
M v[104:107], a[120:123], a[24:27], v[104:107]
 ds_read_b128 a[88:91], v7 offset:55296
M v[104:107], a[116:119], a[20:23], v[104:107]
 ds_read_b128 a[92:95], v7 offset:56320
M v[104:107], a[112:115], a[16:19], v[104:107]
 v_exp_f32 v22, v88
M v[104:107], a[108:111], a[12:15], v[104:107]
 buffer_load_dwordx4 v4, s[8:11], s24 offen offset:1024 sc1 lds
M v[104:107], a[104:107], a[8:11], v[104:107]
 v_exp_f32 v23, v89
M v[104:107], a[100:103], a[4:7], v[104:107]
 v_exp_f32 v24, v90
M v[104:107], a[96:99], a[0:3], v[104:107]
 s_waitcnt lgkmcnt(0)
 v_exp_f32 v25, v91
M v[112:115], a[64:67], a[0:3], v[32:35]
 s_add_u32 s3, s29, 32768
 ds_read_b128 a[96:99], v7 offset:57344
 v_add_f32 v26, v22, v26
M v[112:115], a[68:71], a[4:7], v[112:115]
 ds_read_b128 a[100:103], v7 offset:58368
 v_cvt_pk_bf16_f32 v58, v22, v23
M v[112:115], a[72:75], a[8:11], v[112:115]
 buffer_load_dwordx4 v4, s[8:11], s24 offen offset:2048 sc1 lds
M v[112:115], a[76:79], a[12:15], v[112:115]
 ds_read_b128 a[104:107], v7 offset:59392
 v_add_f32 v26, v23, v26
M v[112:115], a[80:83], a[16:19], v[112:115]
 ds_read_b128 a[108:111], v7 offset:60416
 v_add_f32 v26, v24, v26
M v[112:115], a[84:87], a[20:23], v[112:115]
 buffer_store_dwordx4 a[196:199], v7, s[8:11], s3 offen sc1
M v[112:115], a[88:91], a[24:27], v[112:115]
 ds_read_b128 a[112:115], v7 offset:61440
 v_cvt_pk_bf16_f32 v59, v24, v25
M v[112:115], a[92:95], a[28:31], v[112:115]
 ds_read_b128 a[116:119], v7 offset:62464
 v_add_f32 v26, v25, v26
M v[116:119], a[92:95], a[60:63], v[36:39]
 buffer_load_dwordx4 v4, s[8:11], s24 offen offset:3072 sc1 lds
M v[116:119], a[88:91], a[56:59], v[116:119]
 ds_read_b128 a[120:123], v7 offset:63488
M v[116:119], a[84:87], a[52:55], v[116:119]
 ds_read_b128 a[124:127], v7 offset:64512
M v[116:119], a[80:83], a[48:51], v[116:119]
 v_exp_f32 v18, v84
M v[116:119], a[76:79], a[44:47], v[116:119]
 v_exp_f32 v19, v85
M v[116:119], a[72:75], a[40:43], v[116:119]
 v_exp_f32 v20, v86
M v[116:119], a[68:71], a[36:39], v[116:119]
 s_waitcnt vmcnt(24) lgkmcnt(0)
 v_exp_f32 v21, v87
M v[116:119], a[64:67], a[32:35], v[116:119]
 s_barrier
M v[124:127], a[96:99], a[32:35], v[36:39]
 ds_read_b128 a[64:67], v2 offset:0
 v_add_f32 v27, v18, v27
M v[124:127], a[100:103], a[36:39], v[124:127]
 ds_read_b128 a[68:71], v2 offset:1024
 v_cvt_pk_bf16_f32 v60, v18, v19
M v[124:127], a[104:107], a[40:43], v[124:127]
 v_exp_f32 v22, v92
M v[124:127], a[108:111], a[44:47], v[124:127]
 ds_read_b128 a[72:75], v2 offset:2048
 v_add_f32 v27, v19, v27
M v[124:127], a[112:115], a[48:51], v[124:127]
 ds_read_b128 a[76:79], v2 offset:3072
 v_add_f32 v27, v20, v27
M v[124:127], a[116:119], a[52:55], v[124:127]
 v_exp_f32 v23, v93
M v[124:127], a[120:123], a[56:59], v[124:127]
 ds_read_b128 a[80:83], v2 offset:4096
 v_cvt_pk_bf16_f32 v61, v20, v21
M v[124:127], a[124:127], a[60:63], v[124:127]
 ds_read_b128 a[84:87], v2 offset:5120
 v_add_f32 v27, v21, v27
M v[120:123], a[124:127], a[28:31], v[32:35]
 v_exp_f32 v24, v94
M v[120:123], a[120:123], a[24:27], v[120:123]
 ds_read_b128 a[88:91], v2 offset:6144
 v_add_f32 v27, v22, v27
M v[120:123], a[116:119], a[20:23], v[120:123]
 ds_read_b128 a[92:95], v2 offset:7168
 v_cvt_pk_bf16_f32 v62, v22, v23
M v[120:123], a[112:115], a[16:19], v[120:123]
 v_exp_f32 v25, v95
M v[120:123], a[108:111], a[12:15], v[120:123]
 v_add_f32 v27, v23, v27
 v_add_f32 v27, v24, v27
M v[120:123], a[104:107], a[8:11], v[120:123]
 v_cvt_pk_bf16_f32 v63, v24, v25
 v_add_f32 v27, v25, v27
M v[120:123], a[100:103], a[4:7], v[120:123]
 s_waitcnt lgkmcnt(0)
M v[120:123], a[96:99], a[0:3], v[120:123]
 v_max_f32 v10, v26, v27
 v_cmp_lt_f32 vcc, s31, v10
 s_nop 0
 s_cbranch_vccnz L_st12
L_rt12:
M v[128:131], a[64:67], v[40:43], v[128:131]
 s_add_u32 m0, s28, 32768
 ds_read_b128 a[96:99], v2 offset:8192
 v_add_f32 v30, v26, v30
M v[128:131], a[68:71], v[56:59], v[128:131]
 ds_read_b128 a[100:103], v2 offset:9216
 v_add_f32 v31, v27, v31
M v[132:135], a[68:71], v[60:63], v[132:135]
 buffer_load_dwordx4 v3, s[8:11], s21 offen offset:0 sc1 lds
M v[132:135], a[64:67], v[44:47], v[132:135]
 s_add_u32 s3, s29, 65536
 ds_read_b128 a[104:107], v2 offset:10240
M v[140:143], a[72:75], v[44:47], v[140:143]
 ds_read_b128 a[108:111], v2 offset:11264
M v[140:143], a[76:79], v[60:63], v[140:143]
 buffer_load_dwordx4 v3, s[8:11], s21 offen offset:1024 sc1 lds
M v[136:139], a[76:79], v[56:59], v[136:139]
 ds_read_b128 a[112:115], v2 offset:12288
M v[136:139], a[72:75], v[40:43], v[136:139]
 ds_read_b128 a[116:119], v2 offset:13312
M v[144:147], a[80:83], v[40:43], v[144:147]
 buffer_store_dwordx4 a[200:203], v7, s[8:11], s3 offen sc1
M v[144:147], a[84:87], v[56:59], v[144:147]
 ds_read_b128 a[120:123], v2 offset:14336
M v[148:151], a[84:87], v[60:63], v[148:151]
 ds_read_b128 a[124:127], v2 offset:15360
M v[148:151], a[80:83], v[44:47], v[148:151]
 buffer_load_dwordx4 v3, s[8:11], s21 offen offset:2048 sc1 lds
M v[156:159], a[88:91], v[44:47], v[156:159]
 v_exp_f32 v18, v96
M v[156:159], a[92:95], v[60:63], v[156:159]
 v_exp_f32 v19, v97
M v[152:155], a[92:95], v[56:59], v[152:155]
 buffer_load_dwordx4 v3, s[8:11], s21 offen offset:3072 sc1 lds
M v[152:155], a[88:91], v[40:43], v[152:155]
 s_waitcnt lgkmcnt(0)
 v_exp_f32 v20, v98
M v[160:163], a[96:99], v[40:43], v[160:163]
 ds_read_b128 a[64:67], v2 offset:16384
 v_add_f32 v28, v18, v19
M v[160:163], a[100:103], v[56:59], v[160:163]
 s_add_u32 m0, s28, 36864
 ds_read_b128 a[68:71], v2 offset:17408
 v_cvt_pk_bf16_f32 v48, v18, v19
M v[164:167], a[100:103], v[60:63], v[164:167]
 buffer_load_dwordx4 v4, s[8:11], s21 offen offset:0 sc1 lds
M v[164:167], a[96:99], v[44:47], v[164:167]
 ds_read_b128 a[72:75], v2 offset:18432
M v[172:175], a[104:107], v[44:47], v[172:175]
 ds_read_b128 a[76:79], v2 offset:19456
M v[172:175], a[108:111], v[60:63], v[172:175]
 v_exp_f32 v21, v99
M v[168:171], a[108:111], v[56:59], v[168:171]
 ds_read_b128 a[80:83], v2 offset:20480
 v_add_f32 v28, v20, v28
M v[168:171], a[104:107], v[40:43], v[168:171]
 s_add_u32 s3, s29, 98304
 ds_read_b128 a[84:87], v2 offset:21504
 v_cvt_pk_bf16_f32 v49, v20, v21
M v[176:179], a[112:115], v[40:43], v[176:179]
 buffer_load_dwordx4 v4, s[8:11], s21 offen offset:1024 sc1 lds
M v[176:179], a[116:119], v[56:59], v[176:179]
 ds_read_b128 a[88:91], v2 offset:22528
 v_add_f32 v28, v21, v28
M v[180:183], a[116:119], v[60:63], v[180:183]
 ds_read_b128 a[92:95], v2 offset:23552
M v[180:183], a[112:115], v[44:47], v[180:183]
 buffer_load_dwordx4 v4, s[8:11], s21 offen offset:2048 sc1 lds
M v[188:191], a[120:123], v[44:47], v[188:191]
 buffer_store_dwordx4 a[204:207], v7, s[8:11], s3 offen sc1
M v[188:191], a[124:127], v[60:63], v[188:191]
 v_exp_f32 v22, v104
M v[184:187], a[124:127], v[56:59], v[184:187]
 v_exp_f32 v23, v105
M v[184:187], a[120:123], v[40:43], v[184:187]
 s_waitcnt lgkmcnt(0)
 v_exp_f32 v24, v106
M v[192:195], a[64:67], v[40:43], v[192:195]
 ds_read_b128 a[96:99], v2 offset:24576
 v_add_f32 v28, v22, v28
M v[192:195], a[68:71], v[56:59], v[192:195]
 ds_read_b128 a[100:103], v2 offset:25600
 v_cvt_pk_bf16_f32 v50, v22, v23
M v[196:199], a[68:71], v[60:63], v[196:199]
 buffer_load_dwordx4 v4, s[8:11], s21 offen offset:3072 sc1 lds
M v[196:199], a[64:67], v[44:47], v[196:199]
 s_add_u32 s24, s23, 16777216
 ds_read_b128 a[104:107], v2 offset:26624
 v_add_f32 v28, v23, v28
M v[204:207], a[72:75], v[44:47], v[204:207]
 s_mov_b32 s23, s21
 ds_read_b128 a[108:111], v2 offset:27648
M v[204:207], a[76:79], v[60:63], v[204:207]
 s_add_u32 s21, s21, 32768
 v_exp_f32 v25, v107
M v[200:203], a[76:79], v[56:59], v[200:203]
 s_add_u32 s22, s22, 1
 ds_read_b128 a[112:115], v2 offset:28672
 v_add_f32 v28, v24, v28
M v[200:203], a[72:75], v[40:43], v[200:203]
 s_cmp_eq_u32 s22, s25
 ds_read_b128 a[116:119], v2 offset:29696
 v_cvt_pk_bf16_f32 v51, v24, v25
M v[208:211], a[80:83], v[40:43], v[208:211]
 s_cselect_b32 s21, s26, s21
 v_exp_f32 v18, v100
M v[208:211], a[84:87], v[56:59], v[208:211]
 s_cmp_eq_u32 s22, s43
 ds_read_b128 a[120:123], v2 offset:30720
 v_add_f32 v28, v25, v28
M v[212:215], a[84:87], v[60:63], v[212:215]
 s_cselect_b32 s21, s4, s21
 ds_read_b128 a[124:127], v2 offset:31744
M v[212:215], a[80:83], v[44:47], v[212:215]
 s_cmp_eq_u32 s22, s6
 v_exp_f32 v19, v101
M v[220:223], a[88:91], v[44:47], v[220:223]
 s_cselect_b32 s21, s7, s21
 v_exp_f32 v20, v102
M v[220:223], a[92:95], v[60:63], v[220:223]
 v_exp_f32 v21, v103
M v[216:219], a[92:95], v[56:59], v[216:219]
 s_waitcnt vmcnt(21) lgkmcnt(0)
 v_exp_f32 v22, v108
M v[216:219], a[88:91], v[40:43], v[216:219]
 s_barrier
M v[224:227], a[96:99], v[40:43], v[224:227]
 ds_read_b128 a[64:67], v2 offset:32768
 v_add_f32 v29, v18, v19
M v[224:227], a[100:103], v[56:59], v[224:227]
 ds_read_b128 a[68:71], v2 offset:33792
 v_mov_b32 v17, 4
M v[228:231], a[100:103], v[60:63], v[228:231]
 s_waitcnt vmcnt(20)
 v_cmp_gt_u32 vcc, 3, v6
 v_cvt_pk_bf16_f32 v52, v18, v19
M v[228:231], a[96:99], v[44:47], v[228:231]
 ds_read_b128 a[72:75], v2 offset:34816
 v_add_f32 v29, v20, v29
M v[236:239], a[104:107], v[44:47], v[236:239]
 ds_read_b128 a[76:79], v2 offset:35840
 v_cvt_pk_bf16_f32 v53, v20, v21
M v[236:239], a[108:111], v[60:63], v[236:239]
 s_cbranch_vccnz L_f4s
L_f4r:
 v_exp_f32 v23, v109
M v[232:235], a[108:111], v[56:59], v[232:235]
 ds_read_b128 a[80:83], v2 offset:36864
 v_add_f32 v29, v21, v29
M v[232:235], a[104:107], v[40:43], v[232:235]
 ds_read_b128 a[84:87], v2 offset:37888
 v_add_f32 v29, v22, v29
M v[240:243], a[112:115], v[40:43], v[240:243]
 buffer_store_dword v17, v1, s[8:11], s45 offen sc1
M v[240:243], a[116:119], v[56:59], v[240:243]
 ds_read_b128 a[88:91], v2 offset:38912
 v_cvt_pk_bf16_f32 v54, v22, v23
M v[244:247], a[116:119], v[60:63], v[244:247]
 ds_read_b128 a[92:95], v2 offset:39936
 v_add_f32 v29, v23, v29
M v[244:247], a[112:115], v[44:47], v[244:247]
 v_exp_f32 v24, v110
M v[252:255], a[120:123], v[44:47], v[252:255]
 v_exp_f32 v25, v111
M v[252:255], a[124:127], v[60:63], v[252:255]
 v_add_f32 v29, v24, v29
 v_cvt_pk_bf16_f32 v55, v24, v25
M v[248:251], a[124:127], v[56:59], v[248:251]
 s_waitcnt lgkmcnt(0)
 v_add_f32 v29, v25, v29
M v[248:251], a[120:123], v[40:43], v[248:251]
M v[64:67], a[64:67], a[0:3], v[32:35]
 s_add_u32 m0, s28, 65536
 ds_read_b128 a[96:99], v2 offset:40960
M v[64:67], a[68:71], a[4:7], v[64:67]
 ds_read_b128 a[100:103], v2 offset:41984
M v[64:67], a[72:75], a[8:11], v[64:67]
 buffer_load_dwordx4 v3, s[8:11], s24 offen offset:0 sc1 lds
M v[64:67], a[76:79], a[12:15], v[64:67]
 s_cmp_lt_u32 s20, 2
 ds_read_b128 a[104:107], v2 offset:43008
M v[64:67], a[80:83], a[16:19], v[64:67]
 s_cselect_b64 s[86:87], -1, 0
 ds_read_b128 a[108:111], v2 offset:44032
M v[64:67], a[84:87], a[20:23], v[64:67]
 s_cmp_eq_u32 s20, 2
 v_exp_f32 v18, v112
M v[64:67], a[88:91], a[24:27], v[64:67]
 s_cselect_b64 s[80:81], s[16:17], s[86:87]
 ds_read_b128 a[112:115], v2 offset:45056
M v[64:67], a[92:95], a[28:31], v[64:67]
 s_cselect_b64 s[82:83], s[18:19], s[86:87]
 ds_read_b128 a[116:119], v2 offset:46080
M v[68:71], a[92:95], a[60:63], v[36:39]
 buffer_load_dwordx4 v3, s[8:11], s24 offen offset:1024 sc1 lds
M v[68:71], a[88:91], a[56:59], v[68:71]
 s_cselect_b64 s[84:85], s[48:49], s[86:87]
 ds_read_b128 a[120:123], v2 offset:47104
M v[68:71], a[84:87], a[52:55], v[68:71]
 s_cselect_b64 s[86:87], s[50:51], s[86:87]
 ds_read_b128 a[124:127], v2 offset:48128
M v[68:71], a[80:83], a[48:51], v[68:71]
 s_cmp_eq_u32 s20, 3
 v_exp_f32 v19, v113
M v[68:71], a[76:79], a[44:47], v[68:71]
 buffer_load_dwordx4 v3, s[8:11], s24 offen offset:2048 sc1 lds
M v[68:71], a[72:75], a[40:43], v[68:71]
 s_cselect_b64 s[88:89], s[16:17], -1
 v_exp_f32 v20, v114
M v[68:71], a[68:71], a[36:39], v[68:71]
 s_cselect_b64 s[90:91], s[18:19], -1
 v_exp_f32 v21, v115
M v[68:71], a[64:67], a[32:35], v[68:71]
 s_waitcnt lgkmcnt(0)
 v_exp_f32 v22, v120
M v[76:79], a[96:99], a[32:35], v[36:39]
 s_cselect_b64 s[92:93], s[48:49], -1
 ds_read_b128 a[64:67], v2 offset:49152
 v_add_f32 v28, v18, v28
M v[76:79], a[100:103], a[36:39], v[76:79]
 s_cselect_b64 s[94:95], s[50:51], -1
 ds_read_b128 a[68:71], v2 offset:50176
 v_cvt_pk_bf16_f32 v56, v18, v19
M v[76:79], a[104:107], a[40:43], v[76:79]
 buffer_load_dwordx4 v3, s[8:11], s24 offen offset:3072 sc1 lds
M v[76:79], a[108:111], a[44:47], v[76:79]
 s_add_u32 s3, s29, 131072
 ds_read_b128 a[72:75], v2 offset:51200
 v_add_f32 v28, v19, v28
M v[76:79], a[112:115], a[48:51], v[76:79]
 ds_read_b128 a[76:79], v2 offset:52224
 v_add_f32 v28, v20, v28
M v[76:79], a[116:119], a[52:55], v[76:79]
 buffer_store_dwordx4 a[208:211], v7, s[8:11], s3 offen sc1
M v[76:79], a[120:123], a[56:59], v[76:79]
 s_add_u32 m0, s28, 69632
 ds_read_b128 a[80:83], v2 offset:53248
 v_cvt_pk_bf16_f32 v57, v20, v21
M v[76:79], a[124:127], a[60:63], v[76:79]
 ds_read_b128 a[84:87], v2 offset:54272
 v_add_f32 v28, v21, v28
M v[72:75], a[124:127], a[28:31], v[32:35]
 buffer_load_dwordx4 v4, s[8:11], s24 offen offset:0 sc1 lds
M v[72:75], a[120:123], a[24:27], v[72:75]
 ds_read_b128 a[88:91], v2 offset:55296
M v[72:75], a[116:119], a[20:23], v[72:75]
 ds_read_b128 a[92:95], v2 offset:56320
M v[72:75], a[112:115], a[16:19], v[72:75]
 v_exp_f32 v23, v121
M v[72:75], a[108:111], a[12:15], v[72:75]
 buffer_load_dwordx4 v4, s[8:11], s24 offen offset:1024 sc1 lds
M v[72:75], a[104:107], a[8:11], v[72:75]
 v_exp_f32 v24, v122
M v[72:75], a[100:103], a[4:7], v[72:75]
 s_add_u32 s3, s29, 163840
 v_exp_f32 v25, v123
M v[72:75], a[96:99], a[0:3], v[72:75]
 s_waitcnt lgkmcnt(0)
 v_exp_f32 v18, v116
M v[80:83], a[64:67], a[0:3], v[32:35]
 ds_read_b128 a[96:99], v2 offset:57344
 v_add_f32 v28, v22, v28
M v[80:83], a[68:71], a[4:7], v[80:83]
 ds_read_b128 a[100:103], v2 offset:58368
 v_cvt_pk_bf16_f32 v58, v22, v23
M v[80:83], a[72:75], a[8:11], v[80:83]
 buffer_load_dwordx4 v4, s[8:11], s24 offen offset:2048 sc1 lds
M v[80:83], a[76:79], a[12:15], v[80:83]
 ds_read_b128 a[104:107], v2 offset:59392
 v_add_f32 v28, v23, v28
M v[80:83], a[80:83], a[16:19], v[80:83]
 ds_read_b128 a[108:111], v2 offset:60416
 v_add_f32 v28, v24, v28
M v[80:83], a[84:87], a[20:23], v[80:83]
 buffer_store_dwordx4 a[212:215], v7, s[8:11], s3 offen sc1
M v[80:83], a[88:91], a[24:27], v[80:83]
 ds_read_b128 a[112:115], v2 offset:61440
 v_cvt_pk_bf16_f32 v59, v24, v25
M v[80:83], a[92:95], a[28:31], v[80:83]
 ds_read_b128 a[116:119], v2 offset:62464
 v_add_f32 v28, v25, v28
M v[84:87], a[92:95], a[60:63], v[36:39]
 buffer_load_dwordx4 v4, s[8:11], s24 offen offset:3072 sc1 lds
M v[84:87], a[88:91], a[56:59], v[84:87]
 ds_read_b128 a[120:123], v2 offset:63488
M v[84:87], a[84:87], a[52:55], v[84:87]
 ds_read_b128 a[124:127], v2 offset:64512
M v[84:87], a[80:83], a[48:51], v[84:87]
 v_exp_f32 v19, v117
M v[84:87], a[76:79], a[44:47], v[84:87]
 v_exp_f32 v20, v118
M v[84:87], a[72:75], a[40:43], v[84:87]
 v_exp_f32 v21, v119
M v[84:87], a[68:71], a[36:39], v[84:87]
 s_waitcnt vmcnt(21) lgkmcnt(0)
 v_exp_f32 v22, v124
M v[84:87], a[64:67], a[32:35], v[84:87]
 s_barrier
M v[92:95], a[96:99], a[32:35], v[36:39]
 ds_read_b128 a[64:67], v7 offset:0
 v_add_f32 v29, v18, v29
M v[92:95], a[100:103], a[36:39], v[92:95]
 ds_read_b128 a[68:71], v7 offset:1024
 v_cvt_pk_bf16_f32 v60, v18, v19
M v[92:95], a[104:107], a[40:43], v[92:95]
 v_exp_f32 v23, v125
M v[92:95], a[108:111], a[44:47], v[92:95]
 ds_read_b128 a[72:75], v7 offset:2048
 v_add_f32 v29, v19, v29
M v[92:95], a[112:115], a[48:51], v[92:95]
 ds_read_b128 a[76:79], v7 offset:3072
 v_add_f32 v29, v20, v29
M v[92:95], a[116:119], a[52:55], v[92:95]
 v_exp_f32 v24, v126
M v[92:95], a[120:123], a[56:59], v[92:95]
 ds_read_b128 a[80:83], v7 offset:4096
 v_cvt_pk_bf16_f32 v61, v20, v21
M v[92:95], a[124:127], a[60:63], v[92:95]
 ds_read_b128 a[84:87], v7 offset:5120
 v_add_f32 v29, v21, v29
M v[88:91], a[124:127], a[28:31], v[32:35]
 v_exp_f32 v25, v127
M v[88:91], a[120:123], a[24:27], v[88:91]
 ds_read_b128 a[88:91], v7 offset:6144
 v_add_f32 v29, v22, v29
M v[88:91], a[116:119], a[20:23], v[88:91]
 ds_read_b128 a[92:95], v7 offset:7168
 v_cvt_pk_bf16_f32 v62, v22, v23
M v[88:91], a[112:115], a[16:19], v[88:91]
 v_add_f32 v29, v23, v29
 v_add_f32 v29, v24, v29
M v[88:91], a[108:111], a[12:15], v[88:91]
 v_cvt_pk_bf16_f32 v63, v24, v25
 v_add_f32 v29, v25, v29
M v[88:91], a[104:107], a[8:11], v[88:91]
M v[88:91], a[100:103], a[4:7], v[88:91]
 s_waitcnt lgkmcnt(0)
M v[88:91], a[96:99], a[0:3], v[88:91]
 v_max_f32 v10, v28, v29
 v_cmp_lt_f32 vcc, s31, v10
 s_nop 0
 s_cbranch_vccnz L_st13
L_rt13:
M v[128:131], a[64:67], v[48:51], v[128:131]
 s_add_u32 m0, s28, 98304
 ds_read_b128 a[96:99], v7 offset:8192
 v_add_f32 v30, v28, v30
M v[128:131], a[68:71], v[56:59], v[128:131]
 s_add_u32 s3, s29, 196608
 ds_read_b128 a[100:103], v7 offset:9216
 v_add_f32 v31, v29, v31
M v[132:135], a[68:71], v[60:63], v[132:135]
 buffer_load_dwordx4 v3, s[8:11], s21 offen offset:0 sc1 lds
M v[132:135], a[64:67], v[52:55], v[132:135]
 ds_read_b128 a[104:107], v7 offset:10240
M v[140:143], a[72:75], v[52:55], v[140:143]
 ds_read_b128 a[108:111], v7 offset:11264
M v[140:143], a[76:79], v[60:63], v[140:143]
 buffer_load_dwordx4 v3, s[8:11], s21 offen offset:1024 sc1 lds
M v[136:139], a[76:79], v[56:59], v[136:139]
 ds_read_b128 a[112:115], v7 offset:12288
M v[136:139], a[72:75], v[48:51], v[136:139]
 ds_read_b128 a[116:119], v7 offset:13312
M v[144:147], a[80:83], v[48:51], v[144:147]
 buffer_store_dwordx4 a[216:219], v7, s[8:11], s3 offen sc1
M v[144:147], a[84:87], v[56:59], v[144:147]
 ds_read_b128 a[120:123], v7 offset:14336
M v[148:151], a[84:87], v[60:63], v[148:151]
 ds_read_b128 a[124:127], v7 offset:15360
M v[148:151], a[80:83], v[52:55], v[148:151]
 buffer_load_dwordx4 v3, s[8:11], s21 offen offset:2048 sc1 lds
M v[156:159], a[88:91], v[52:55], v[156:159]
 v_exp_f32 v18, v64
M v[156:159], a[92:95], v[60:63], v[156:159]
 v_exp_f32 v19, v65
M v[152:155], a[92:95], v[56:59], v[152:155]
 buffer_load_dwordx4 v3, s[8:11], s21 offen offset:3072 sc1 lds
M v[152:155], a[88:91], v[48:51], v[152:155]
 s_waitcnt lgkmcnt(0)
 v_exp_f32 v20, v66
M v[160:163], a[96:99], v[48:51], v[160:163]
 ds_read_b128 a[64:67], v7 offset:16384
 v_add_f32 v26, v18, v19
M v[160:163], a[100:103], v[56:59], v[160:163]
 s_add_u32 m0, s28, 102400
 ds_read_b128 a[68:71], v7 offset:17408
 v_cvt_pk_bf16_f32 v40, v18, v19
M v[164:167], a[100:103], v[60:63], v[164:167]
 buffer_load_dwordx4 v4, s[8:11], s21 offen offset:0 sc1 lds
M v[164:167], a[96:99], v[52:55], v[164:167]
 ds_read_b128 a[72:75], v7 offset:18432
M v[172:175], a[104:107], v[52:55], v[172:175]
 ds_read_b128 a[76:79], v7 offset:19456
M v[172:175], a[108:111], v[60:63], v[172:175]
 v_exp_f32 v21, v67
M v[168:171], a[108:111], v[56:59], v[168:171]
 ds_read_b128 a[80:83], v7 offset:20480
 v_add_f32 v26, v20, v26
M v[168:171], a[104:107], v[48:51], v[168:171]
 ds_read_b128 a[84:87], v7 offset:21504
 v_cvt_pk_bf16_f32 v41, v20, v21
M v[176:179], a[112:115], v[48:51], v[176:179]
 buffer_load_dwordx4 v4, s[8:11], s21 offen offset:1024 sc1 lds
M v[176:179], a[116:119], v[56:59], v[176:179]
 ds_read_b128 a[88:91], v7 offset:22528
 v_add_f32 v26, v21, v26
M v[180:183], a[116:119], v[60:63], v[180:183]
 ds_read_b128 a[92:95], v7 offset:23552
M v[180:183], a[112:115], v[52:55], v[180:183]
 buffer_load_dwordx4 v4, s[8:11], s21 offen offset:2048 sc1 lds
M v[188:191], a[120:123], v[52:55], v[188:191]
 v_exp_f32 v22, v72
M v[188:191], a[124:127], v[60:63], v[188:191]
 v_exp_f32 v23, v73
M v[184:187], a[124:127], v[56:59], v[184:187]
 v_exp_f32 v24, v74
M v[184:187], a[120:123], v[48:51], v[184:187]
 s_waitcnt lgkmcnt(0)
 v_exp_f32 v25, v75
M v[192:195], a[64:67], v[48:51], v[192:195]
 ds_read_b128 a[96:99], v7 offset:24576
 v_add_f32 v26, v22, v26
M v[192:195], a[68:71], v[56:59], v[192:195]
 ds_read_b128 a[100:103], v7 offset:25600
 v_cvt_pk_bf16_f32 v42, v22, v23
M v[196:199], a[68:71], v[60:63], v[196:199]
 buffer_load_dwordx4 v4, s[8:11], s21 offen offset:3072 sc1 lds
M v[196:199], a[64:67], v[52:55], v[196:199]
 s_add_u32 s24, s23, 16777216
 ds_read_b128 a[104:107], v7 offset:26624
 v_add_f32 v26, v23, v26
M v[204:207], a[72:75], v[52:55], v[204:207]
 s_mov_b32 s23, s21
 ds_read_b128 a[108:111], v7 offset:27648
 v_add_f32 v26, v24, v26
M v[204:207], a[76:79], v[60:63], v[204:207]
 s_add_u32 s21, s21, 32768
 v_exp_f32 v18, v68
M v[200:203], a[76:79], v[56:59], v[200:203]
 s_add_u32 s22, s22, 1
 ds_read_b128 a[112:115], v7 offset:28672
 v_cvt_pk_bf16_f32 v43, v24, v25
M v[200:203], a[72:75], v[48:51], v[200:203]
 s_cmp_eq_u32 s22, s25
 ds_read_b128 a[116:119], v7 offset:29696
 v_add_f32 v26, v25, v26
M v[208:211], a[80:83], v[48:51], v[208:211]
 s_cselect_b32 s21, s26, s21
 v_exp_f32 v19, v69
M v[208:211], a[84:87], v[56:59], v[208:211]
 s_cmp_eq_u32 s22, s43
 ds_read_b128 a[120:123], v7 offset:30720
 v_add_f32 v27, v18, v19
M v[212:215], a[84:87], v[60:63], v[212:215]
 s_cselect_b32 s21, s4, s21
 ds_read_b128 a[124:127], v7 offset:31744
 v_cvt_pk_bf16_f32 v44, v18, v19
M v[212:215], a[80:83], v[52:55], v[212:215]
 s_cmp_eq_u32 s22, s6
 v_exp_f32 v20, v70
M v[220:223], a[88:91], v[52:55], v[220:223]
 s_cselect_b32 s21, s7, s21
 v_exp_f32 v21, v71
M v[220:223], a[92:95], v[60:63], v[220:223]
 v_exp_f32 v22, v76
M v[216:219], a[92:95], v[56:59], v[216:219]
 s_waitcnt vmcnt(20) lgkmcnt(0)
 v_add_f32 v27, v20, v27
 v_cvt_pk_bf16_f32 v45, v20, v21
M v[216:219], a[88:91], v[48:51], v[216:219]
 s_barrier
M v[224:227], a[96:99], v[48:51], v[224:227]
 ds_read_b128 a[64:67], v7 offset:32768
 v_add_f32 v27, v21, v27
M v[224:227], a[100:103], v[56:59], v[224:227]
 ds_read_b128 a[68:71], v7 offset:33792
M v[228:231], a[100:103], v[60:63], v[228:231]
 v_exp_f32 v23, v77
M v[228:231], a[96:99], v[52:55], v[228:231]
 ds_read_b128 a[72:75], v7 offset:34816
 v_add_f32 v27, v22, v27
M v[236:239], a[104:107], v[52:55], v[236:239]
 ds_read_b128 a[76:79], v7 offset:35840
 v_cvt_pk_bf16_f32 v46, v22, v23
M v[236:239], a[108:111], v[60:63], v[236:239]
 v_exp_f32 v24, v78
M v[232:235], a[108:111], v[56:59], v[232:235]
 ds_read_b128 a[80:83], v7 offset:36864
 v_add_f32 v27, v23, v27
M v[232:235], a[104:107], v[48:51], v[232:235]
 ds_read_b128 a[84:87], v7 offset:37888
M v[240:243], a[112:115], v[48:51], v[240:243]
 v_exp_f32 v25, v79
M v[240:243], a[116:119], v[56:59], v[240:243]
 ds_read_b128 a[88:91], v7 offset:38912
 v_add_f32 v27, v24, v27
M v[244:247], a[116:119], v[60:63], v[244:247]
 ds_read_b128 a[92:95], v7 offset:39936
 v_cvt_pk_bf16_f32 v47, v24, v25
M v[244:247], a[112:115], v[52:55], v[244:247]
 v_add_f32 v27, v25, v27
M v[252:255], a[120:123], v[52:55], v[252:255]
M v[252:255], a[124:127], v[60:63], v[252:255]
M v[248:251], a[124:127], v[56:59], v[248:251]
 s_waitcnt lgkmcnt(0)
M v[248:251], a[120:123], v[48:51], v[248:251]
 s_branch L_loop_mid
L_zs0:
 s_mov_b32 s64, 65536
L_zs0_l:
 s_sleep 2
 buffer_load_dword v17, v16, s[12:15], 0 offen offset:64 sc1
 s_sub_u32 s64, s64, 1
 s_cbranch_scc1 L_zs0_x
 s_waitcnt vmcnt(0)
 v_cmp_ne_u32 vcc, 1, v17
 s_nop 0
 s_cbranch_vccnz L_zs0_l
L_zs0_x:
 s_waitcnt vmcnt(0)
 s_branch L_zr0
L_zs1:
 s_mov_b32 s64, 65536
L_zs1_l:
 s_sleep 2
 buffer_load_dword v17, v16, s[12:15], 0 offen offset:64 sc1
 s_sub_u32 s64, s64, 1
 s_cbranch_scc1 L_zs1_x
 s_waitcnt vmcnt(0)
 v_cmp_ne_u32 vcc, 1, v17
 s_nop 0
 s_cbranch_vccnz L_zs1_l
L_zs1_x:
 s_waitcnt vmcnt(0)
 s_branch L_zr1
L_hs:
 s_mov_b32 s91, 65536
L_hs_l:
 buffer_load_dwordx4 v[16:19], v7, s[8:11], s67 offen offset:0 sc1
 buffer_load_dwordx4 v[20:23], v7, s[8:11], s67 offen offset:1024 sc1
 s_waitcnt vmcnt(0)
 s_sub_u32 s91, s91, 1
 s_cbranch_scc1 L_hr
 v_min3_u32 v28, v16, v17, v18
 v_min3_u32 v28, v28, v19, v20
 v_min3_u32 v28, v28, v21, v22
 v_min_u32 v28, v28, v23
 v_cmp_eq_u32 vcc, 0, v28
 s_nop 0
 s_cbranch_vccnz L_hs_l
 s_branch L_hr
L_f1s04:
 s_mov_b32 s91, 65536
L_f1s04_l:
 s_sleep 2
 buffer_load_dword v24, v13, s[8:11], s46 offen sc1
 s_sub_u32 s91, s91, 1
 s_cbranch_scc1 L_f1s04_x
 s_waitcnt vmcnt(0)
 v_cmp_eq_u32 vcc, 0, v24
 s_nop 0
 s_cbranch_vccnz L_f1s04_l
L_f1s04_x:
 s_waitcnt vmcnt(0)
 s_branch L_f1r04
L_f1s05:
 s_mov_b32 s91, 65536
L_f1s05_l:
 s_sleep 2
 buffer_load_dword v24, v9, s[8:11], s46 offen sc1
 s_sub_u32 s91, s91, 1
 s_cbranch_scc1 L_f1s05_x
 s_waitcnt vmcnt(0)
 v_cmp_eq_u32 vcc, 0, v24
 s_nop 0
 s_cbranch_vccnz L_f1s05_l
L_f1s05_x:
 s_waitcnt vmcnt(0)
 s_branch L_f1r05
L_f1s14:
 s_mov_b32 s91, 65536
L_f1s14_l:
 s_sleep 2
 buffer_load_dword v24, v13, s[8:11], s46 offen sc1
 s_sub_u32 s91, s91, 1
 s_cbranch_scc1 L_f1s14_x
 s_waitcnt vmcnt(0)
 v_cmp_eq_u32 vcc, 0, v24
 s_nop 0
 s_cbranch_vccnz L_f1s14_l
L_f1s14_x:
 s_waitcnt vmcnt(0)
 s_branch L_f1r14
L_f1s15:
 s_mov_b32 s91, 65536
L_f1s15_l:
 s_sleep 2
 buffer_load_dword v24, v9, s[8:11], s46 offen sc1
 s_sub_u32 s91, s91, 1
 s_cbranch_scc1 L_f1s15_x
 s_waitcnt vmcnt(0)
 v_cmp_eq_u32 vcc, 0, v24
 s_nop 0
 s_cbranch_vccnz L_f1s15_l
L_f1s15_x:
 s_waitcnt vmcnt(0)
 s_branch L_f1r15
.p2align 6
L_loop_top:
M v[64:67], a[64:67], a[0:3], v[32:35]
 s_add_u32 m0, s28, 65536
 ds_read_b128 a[96:99], v2 offset:40960
M v[64:67], a[68:71], a[4:7], v[64:67]
 ds_read_b128 a[100:103], v2 offset:41984
M v[64:67], a[72:75], a[8:11], v[64:67]
 buffer_load_dword a240, v0, s[60:63], 0 offen offset:0
M v[64:67], a[76:79], a[12:15], v[64:67]
 ds_read_b128 a[104:107], v2 offset:43008
M v[64:67], a[80:83], a[16:19], v[64:67]
 ds_read_b128 a[108:111], v2 offset:44032
M v[64:67], a[84:87], a[20:23], v[64:67]
 buffer_load_dwordx4 v3, s[8:11], s24 offen offset:0 sc1 lds
M v[64:67], a[88:91], a[24:27], v[64:67]
 ds_read_b128 a[112:115], v2 offset:45056
M v[64:67], a[92:95], a[28:31], v[64:67]
 ds_read_b128 a[116:119], v2 offset:46080
M v[68:71], a[92:95], a[60:63], v[36:39]
 buffer_load_dwordx4 v3, s[8:11], s24 offen offset:1024 sc1 lds
M v[68:71], a[88:91], a[56:59], v[68:71]
 ds_read_b128 a[120:123], v2 offset:47104
M v[68:71], a[84:87], a[52:55], v[68:71]
 ds_read_b128 a[124:127], v2 offset:48128
M v[68:71], a[80:83], a[48:51], v[68:71]
 v_exp_f32 v18, v112
M v[68:71], a[76:79], a[44:47], v[68:71]
 buffer_load_dwordx4 v3, s[8:11], s24 offen offset:2048 sc1 lds
M v[68:71], a[72:75], a[40:43], v[68:71]
 v_exp_f32 v19, v113
M v[68:71], a[68:71], a[36:39], v[68:71]
 v_exp_f32 v20, v114
M v[68:71], a[64:67], a[32:35], v[68:71]
 s_waitcnt lgkmcnt(0)
 v_exp_f32 v21, v115
M v[76:79], a[96:99], a[32:35], v[36:39]
 ds_read_b128 a[64:67], v2 offset:49152
 v_add_f32 v28, v18, v28
M v[76:79], a[100:103], a[36:39], v[76:79]
 ds_read_b128 a[68:71], v2 offset:50176
 v_cvt_pk_bf16_f32 v56, v18, v19
M v[76:79], a[104:107], a[40:43], v[76:79]
 buffer_load_dwordx4 v3, s[8:11], s24 offen offset:3072 sc1 lds
M v[76:79], a[108:111], a[44:47], v[76:79]
 ds_read_b128 a[72:75], v2 offset:51200
 v_add_f32 v28, v19, v28
M v[76:79], a[112:115], a[48:51], v[76:79]
 ds_read_b128 a[76:79], v2 offset:52224
 v_add_f32 v28, v20, v28
M v[76:79], a[116:119], a[52:55], v[76:79]
 v_exp_f32 v22, v120
M v[76:79], a[120:123], a[56:59], v[76:79]
 s_add_u32 m0, s28, 69632
 ds_read_b128 a[80:83], v2 offset:53248
 v_cvt_pk_bf16_f32 v57, v20, v21
M v[76:79], a[124:127], a[60:63], v[76:79]
 ds_read_b128 a[84:87], v2 offset:54272
 v_add_f32 v28, v21, v28
M v[72:75], a[124:127], a[28:31], v[32:35]
 buffer_load_dwordx4 v4, s[8:11], s24 offen offset:0 sc1 lds
M v[72:75], a[120:123], a[24:27], v[72:75]
 ds_read_b128 a[88:91], v2 offset:55296
M v[72:75], a[116:119], a[20:23], v[72:75]
 ds_read_b128 a[92:95], v2 offset:56320
M v[72:75], a[112:115], a[16:19], v[72:75]
 v_exp_f32 v23, v121
M v[72:75], a[108:111], a[12:15], v[72:75]
 buffer_load_dwordx4 v4, s[8:11], s24 offen offset:1024 sc1 lds
M v[72:75], a[104:107], a[8:11], v[72:75]
 v_exp_f32 v24, v122
M v[72:75], a[100:103], a[4:7], v[72:75]
 v_exp_f32 v25, v123
M v[72:75], a[96:99], a[0:3], v[72:75]
 s_waitcnt lgkmcnt(0)
 v_exp_f32 v18, v116
M v[80:83], a[64:67], a[0:3], v[32:35]
 ds_read_b128 a[96:99], v2 offset:57344
 v_add_f32 v28, v22, v28
M v[80:83], a[68:71], a[4:7], v[80:83]
 ds_read_b128 a[100:103], v2 offset:58368
 v_cvt_pk_bf16_f32 v58, v22, v23
M v[80:83], a[72:75], a[8:11], v[80:83]
 buffer_load_dwordx4 v4, s[8:11], s24 offen offset:2048 sc1 lds
M v[80:83], a[76:79], a[12:15], v[80:83]
 ds_read_b128 a[104:107], v2 offset:59392
 v_add_f32 v28, v23, v28
M v[80:83], a[80:83], a[16:19], v[80:83]
 ds_read_b128 a[108:111], v2 offset:60416
 v_add_f32 v28, v24, v28
M v[80:83], a[84:87], a[20:23], v[80:83]
 v_exp_f32 v19, v117
M v[80:83], a[88:91], a[24:27], v[80:83]
 ds_read_b128 a[112:115], v2 offset:61440
 v_cvt_pk_bf16_f32 v59, v24, v25
M v[80:83], a[92:95], a[28:31], v[80:83]
 ds_read_b128 a[116:119], v2 offset:62464
 v_add_f32 v28, v25, v28
M v[84:87], a[92:95], a[60:63], v[36:39]
 buffer_load_dwordx4 v4, s[8:11], s24 offen offset:3072 sc1 lds
M v[84:87], a[88:91], a[56:59], v[84:87]
 ds_read_b128 a[120:123], v2 offset:63488
 v_add_f32 v29, v18, v29
M v[84:87], a[84:87], a[52:55], v[84:87]
 ds_read_b128 a[124:127], v2 offset:64512
 v_cvt_pk_bf16_f32 v60, v18, v19
M v[84:87], a[80:83], a[48:51], v[84:87]
 v_exp_f32 v20, v118
M v[84:87], a[76:79], a[44:47], v[84:87]
 v_exp_f32 v21, v119
M v[84:87], a[72:75], a[40:43], v[84:87]
 v_exp_f32 v22, v124
M v[84:87], a[68:71], a[36:39], v[84:87]
 s_waitcnt vmcnt(17) lgkmcnt(0)
 v_exp_f32 v23, v125
M v[84:87], a[64:67], a[32:35], v[84:87]
 s_barrier
M v[92:95], a[96:99], a[32:35], v[36:39]
 ds_read_b128 a[64:67], v7 offset:0
 v_add_f32 v29, v19, v29
M v[92:95], a[100:103], a[36:39], v[92:95]
 ds_read_b128 a[68:71], v7 offset:1024
 v_add_f32 v29, v20, v29
M v[92:95], a[104:107], a[40:43], v[92:95]
 v_exp_f32 v24, v126
M v[92:95], a[108:111], a[44:47], v[92:95]
 ds_read_b128 a[72:75], v7 offset:2048
 v_cvt_pk_bf16_f32 v61, v20, v21
M v[92:95], a[112:115], a[48:51], v[92:95]
 ds_read_b128 a[76:79], v7 offset:3072
 v_add_f32 v29, v21, v29
M v[92:95], a[116:119], a[52:55], v[92:95]
 v_exp_f32 v25, v127
M v[92:95], a[120:123], a[56:59], v[92:95]
 ds_read_b128 a[80:83], v7 offset:4096
 v_add_f32 v29, v22, v29
M v[92:95], a[124:127], a[60:63], v[92:95]
 ds_read_b128 a[84:87], v7 offset:5120
 v_cvt_pk_bf16_f32 v62, v22, v23
M v[88:91], a[124:127], a[28:31], v[32:35]
 v_add_f32 v29, v23, v29
 v_add_f32 v29, v24, v29
M v[88:91], a[120:123], a[24:27], v[88:91]
 ds_read_b128 a[88:91], v7 offset:6144
 v_cvt_pk_bf16_f32 v63, v24, v25
M v[88:91], a[116:119], a[20:23], v[88:91]
 ds_read_b128 a[92:95], v7 offset:7168
 v_add_f32 v29, v25, v29
M v[88:91], a[112:115], a[16:19], v[88:91]
 v_max_f32 v10, v28, v29
M v[88:91], a[108:111], a[12:15], v[88:91]
 v_cmp_lt_f32 vcc, s31, v10
M v[88:91], a[104:107], a[8:11], v[88:91]
M v[88:91], a[100:103], a[4:7], v[88:91]
 s_waitcnt lgkmcnt(0)
M v[88:91], a[96:99], a[0:3], v[88:91]
 s_cbranch_vccnz L_st1
L_rt1:
M v[128:131], a[64:67], v[48:51], v[128:131]
 s_add_u32 m0, s28, 98304
 ds_read_b128 a[96:99], v7 offset:8192
 v_add_f32 v30, v28, v30
M v[128:131], a[68:71], v[56:59], v[128:131]
 ds_read_b128 a[100:103], v7 offset:9216
 v_add_f32 v31, v29, v31
M v[132:135], a[68:71], v[60:63], v[132:135]
 buffer_load_dwordx4 v3, s[8:11], s21 offen offset:0 sc1 lds
M v[132:135], a[64:67], v[52:55], v[132:135]
 ds_read_b128 a[104:107], v7 offset:10240
M v[140:143], a[72:75], v[52:55], v[140:143]
 ds_read_b128 a[108:111], v7 offset:11264
M v[140:143], a[76:79], v[60:63], v[140:143]
 buffer_load_dwordx4 v3, s[8:11], s21 offen offset:1024 sc1 lds
M v[136:139], a[76:79], v[56:59], v[136:139]
 ds_read_b128 a[112:115], v7 offset:12288
M v[136:139], a[72:75], v[48:51], v[136:139]
 ds_read_b128 a[116:119], v7 offset:13312
M v[144:147], a[80:83], v[48:51], v[144:147]
 v_exp_f32 v18, v64
M v[144:147], a[84:87], v[56:59], v[144:147]
 ds_read_b128 a[120:123], v7 offset:14336
M v[148:151], a[84:87], v[60:63], v[148:151]
 ds_read_b128 a[124:127], v7 offset:15360
M v[148:151], a[80:83], v[52:55], v[148:151]
 buffer_load_dwordx4 v3, s[8:11], s21 offen offset:2048 sc1 lds
M v[156:159], a[88:91], v[52:55], v[156:159]
 v_exp_f32 v19, v65
M v[156:159], a[92:95], v[60:63], v[156:159]
 v_exp_f32 v20, v66
M v[152:155], a[92:95], v[56:59], v[152:155]
 buffer_load_dwordx4 v3, s[8:11], s21 offen offset:3072 sc1 lds
M v[152:155], a[88:91], v[48:51], v[152:155]
 s_waitcnt lgkmcnt(0)
 v_exp_f32 v21, v67
M v[160:163], a[96:99], v[48:51], v[160:163]
 ds_read_b128 a[64:67], v7 offset:16384
 v_add_f32 v26, v18, v19
M v[160:163], a[100:103], v[56:59], v[160:163]
 s_add_u32 m0, s28, 102400
 ds_read_b128 a[68:71], v7 offset:17408
 v_cvt_pk_bf16_f32 v40, v18, v19
M v[164:167], a[100:103], v[60:63], v[164:167]
 buffer_load_dwordx4 v4, s[8:11], s21 offen offset:0 sc1 lds
M v[164:167], a[96:99], v[52:55], v[164:167]
 ds_read_b128 a[72:75], v7 offset:18432
 v_add_f32 v26, v20, v26
M v[172:175], a[104:107], v[52:55], v[172:175]
 ds_read_b128 a[76:79], v7 offset:19456
 v_cvt_pk_bf16_f32 v41, v20, v21
M v[172:175], a[108:111], v[60:63], v[172:175]
 v_exp_f32 v22, v72
M v[168:171], a[108:111], v[56:59], v[168:171]
 ds_read_b128 a[80:83], v7 offset:20480
 v_add_f32 v26, v21, v26
M v[168:171], a[104:107], v[48:51], v[168:171]
 ds_read_b128 a[84:87], v7 offset:21504
M v[176:179], a[112:115], v[48:51], v[176:179]
 buffer_load_dwordx4 v4, s[8:11], s21 offen offset:1024 sc1 lds
M v[176:179], a[116:119], v[56:59], v[176:179]
 ds_read_b128 a[88:91], v7 offset:22528
M v[180:183], a[116:119], v[60:63], v[180:183]
 ds_read_b128 a[92:95], v7 offset:23552
M v[180:183], a[112:115], v[52:55], v[180:183]
 buffer_load_dwordx4 v4, s[8:11], s21 offen offset:2048 sc1 lds
M v[188:191], a[120:123], v[52:55], v[188:191]
 v_exp_f32 v23, v73
M v[188:191], a[124:127], v[60:63], v[188:191]
 v_exp_f32 v24, v74
M v[184:187], a[124:127], v[56:59], v[184:187]
 v_exp_f32 v25, v75
M v[184:187], a[120:123], v[48:51], v[184:187]
 s_waitcnt lgkmcnt(0)
 v_exp_f32 v18, v68
M v[192:195], a[64:67], v[48:51], v[192:195]
 ds_read_b128 a[96:99], v7 offset:24576
 v_add_f32 v26, v22, v26
M v[192:195], a[68:71], v[56:59], v[192:195]
 ds_read_b128 a[100:103], v7 offset:25600
 v_cvt_pk_bf16_f32 v42, v22, v23
M v[196:199], a[68:71], v[60:63], v[196:199]
 buffer_load_dwordx4 v4, s[8:11], s21 offen offset:3072 sc1 lds
M v[196:199], a[64:67], v[52:55], v[196:199]
 s_add_u32 s24, s23, 16777216
 ds_read_b128 a[104:107], v7 offset:26624
 v_add_f32 v26, v23, v26
M v[204:207], a[72:75], v[52:55], v[204:207]
 s_mov_b32 s23, s21
 ds_read_b128 a[108:111], v7 offset:27648
 v_add_f32 v26, v24, v26
M v[204:207], a[76:79], v[60:63], v[204:207]
 s_add_u32 s21, s21, 32768
 v_exp_f32 v19, v69
M v[200:203], a[76:79], v[56:59], v[200:203]
 s_add_u32 s22, s22, 1
 ds_read_b128 a[112:115], v7 offset:28672
 v_cvt_pk_bf16_f32 v43, v24, v25
M v[200:203], a[72:75], v[48:51], v[200:203]
 s_cmp_eq_u32 s22, s25
 ds_read_b128 a[116:119], v7 offset:29696
 v_add_f32 v26, v25, v26
M v[208:211], a[80:83], v[48:51], v[208:211]
 s_cselect_b32 s21, s26, s21
 v_exp_f32 v20, v70
M v[208:211], a[84:87], v[56:59], v[208:211]
 s_cmp_eq_u32 s22, s43
 ds_read_b128 a[120:123], v7 offset:30720
 v_add_f32 v27, v18, v19
M v[212:215], a[84:87], v[60:63], v[212:215]
 s_cselect_b32 s21, s4, s21
 ds_read_b128 a[124:127], v7 offset:31744
 v_cvt_pk_bf16_f32 v44, v18, v19
M v[212:215], a[80:83], v[52:55], v[212:215]
 s_cmp_eq_u32 s22, s6
 v_exp_f32 v21, v71
M v[220:223], a[88:91], v[52:55], v[220:223]
 s_cselect_b32 s21, s7, s21
 v_exp_f32 v22, v76
M v[220:223], a[92:95], v[60:63], v[220:223]
 v_add_f32 v27, v20, v27
 v_cvt_pk_bf16_f32 v45, v20, v21
M v[216:219], a[92:95], v[56:59], v[216:219]
 s_waitcnt vmcnt(17) lgkmcnt(0)
 v_add_f32 v27, v21, v27
M v[216:219], a[88:91], v[48:51], v[216:219]
 s_barrier
M v[224:227], a[96:99], v[48:51], v[224:227]
 ds_read_b128 a[64:67], v7 offset:32768
M v[224:227], a[100:103], v[56:59], v[224:227]
 ds_read_b128 a[68:71], v7 offset:33792
M v[228:231], a[100:103], v[60:63], v[228:231]
 v_exp_f32 v23, v77
M v[228:231], a[96:99], v[52:55], v[228:231]
 ds_read_b128 a[72:75], v7 offset:34816
 v_add_f32 v27, v22, v27
M v[236:239], a[104:107], v[52:55], v[236:239]
 ds_read_b128 a[76:79], v7 offset:35840
 v_cvt_pk_bf16_f32 v46, v22, v23
M v[236:239], a[108:111], v[60:63], v[236:239]
 v_exp_f32 v24, v78
M v[232:235], a[108:111], v[56:59], v[232:235]
 ds_read_b128 a[80:83], v7 offset:36864
 v_add_f32 v27, v23, v27
M v[232:235], a[104:107], v[48:51], v[232:235]
 ds_read_b128 a[84:87], v7 offset:37888
M v[240:243], a[112:115], v[48:51], v[240:243]
 v_exp_f32 v25, v79
M v[240:243], a[116:119], v[56:59], v[240:243]
 ds_read_b128 a[88:91], v7 offset:38912
 v_add_f32 v27, v24, v27
M v[244:247], a[116:119], v[60:63], v[244:247]
 ds_read_b128 a[92:95], v7 offset:39936
 v_cvt_pk_bf16_f32 v47, v24, v25
M v[244:247], a[112:115], v[52:55], v[244:247]
 v_add_f32 v27, v25, v27
M v[252:255], a[120:123], v[52:55], v[252:255]
M v[252:255], a[124:127], v[60:63], v[252:255]
M v[248:251], a[124:127], v[56:59], v[248:251]
 s_waitcnt lgkmcnt(0)
M v[248:251], a[120:123], v[48:51], v[248:251]
L_loop_mid:
M v[96:99], a[64:67], a[0:3], v[32:35]
 s_and_b32 s39, s54, 15
 ds_read_b128 a[96:99], v7 offset:40960
M v[96:99], a[68:71], a[4:7], v[96:99]
 s_cbranch_scc1 L_fll
L_fllr:
 ds_read_b128 a[100:103], v7 offset:41984
M v[96:99], a[72:75], a[8:11], v[96:99]
 s_lshr_b32 s54, s54, 4
 v_exp_f32 v18, v80
M v[96:99], a[76:79], a[12:15], v[96:99]
 s_add_u32 m0, s28, 0
 ds_read_b128 a[104:107], v7 offset:43008
M v[96:99], a[80:83], a[16:19], v[96:99]
 ds_read_b128 a[108:111], v7 offset:44032
M v[96:99], a[84:87], a[20:23], v[96:99]
 buffer_load_dwordx4 v3, s[8:11], s24 offen offset:0 sc1 lds
M v[96:99], a[88:91], a[24:27], v[96:99]
 ds_read_b128 a[112:115], v7 offset:45056
M v[96:99], a[92:95], a[28:31], v[96:99]
 ds_read_b128 a[116:119], v7 offset:46080
M v[100:103], a[92:95], a[60:63], v[36:39]
 v_exp_f32 v19, v81
M v[100:103], a[88:91], a[56:59], v[100:103]
 ds_read_b128 a[120:123], v7 offset:47104
 v_add_f32 v26, v18, v26
M v[100:103], a[84:87], a[52:55], v[100:103]
 ds_read_b128 a[124:127], v7 offset:48128
 v_cvt_pk_bf16_f32 v56, v18, v19
M v[100:103], a[80:83], a[48:51], v[100:103]
 buffer_load_dwordx4 v3, s[8:11], s24 offen offset:1024 sc1 lds
M v[100:103], a[76:79], a[44:47], v[100:103]
 v_exp_f32 v20, v82
M v[100:103], a[72:75], a[40:43], v[100:103]
 v_exp_f32 v21, v83
M v[100:103], a[68:71], a[36:39], v[100:103]
 buffer_load_dwordx4 v3, s[8:11], s24 offen offset:2048 sc1 lds
M v[100:103], a[64:67], a[32:35], v[100:103]
 s_waitcnt lgkmcnt(0)
 v_exp_f32 v22, v88
M v[108:111], a[96:99], a[32:35], v[36:39]
 ds_read_b128 a[64:67], v7 offset:49152
 v_add_f32 v26, v19, v26
M v[108:111], a[100:103], a[36:39], v[108:111]
 ds_read_b128 a[68:71], v7 offset:50176
 v_add_f32 v26, v20, v26
M v[108:111], a[104:107], a[40:43], v[108:111]
 v_exp_f32 v23, v89
M v[108:111], a[108:111], a[44:47], v[108:111]
 ds_read_b128 a[72:75], v7 offset:51200
 v_cvt_pk_bf16_f32 v57, v20, v21
M v[108:111], a[112:115], a[48:51], v[108:111]
 ds_read_b128 a[76:79], v7 offset:52224
 v_add_f32 v26, v21, v26
M v[108:111], a[116:119], a[52:55], v[108:111]
 buffer_load_dwordx4 v3, s[8:11], s24 offen offset:3072 sc1 lds
M v[108:111], a[120:123], a[56:59], v[108:111]
 ds_read_b128 a[80:83], v7 offset:53248
 v_add_f32 v26, v22, v26
M v[108:111], a[124:127], a[60:63], v[108:111]
 s_add_u32 m0, s28, 4096
 ds_read_b128 a[84:87], v7 offset:54272
 v_cvt_pk_bf16_f32 v58, v22, v23
M v[104:107], a[124:127], a[28:31], v[32:35]
 buffer_load_dwordx4 v4, s[8:11], s24 offen offset:0 sc1 lds
M v[104:107], a[120:123], a[24:27], v[104:107]
 ds_read_b128 a[88:91], v7 offset:55296
 v_add_f32 v26, v23, v26
M v[104:107], a[116:119], a[20:23], v[104:107]
 ds_read_b128 a[92:95], v7 offset:56320
M v[104:107], a[112:115], a[16:19], v[104:107]
 v_exp_f32 v24, v90
M v[104:107], a[108:111], a[12:15], v[104:107]
 v_exp_f32 v25, v91
M v[104:107], a[104:107], a[8:11], v[104:107]
 buffer_load_dwordx4 v4, s[8:11], s24 offen offset:1024 sc1 lds
M v[104:107], a[100:103], a[4:7], v[104:107]
 v_exp_f32 v18, v84
M v[104:107], a[96:99], a[0:3], v[104:107]
 s_waitcnt lgkmcnt(0)
 v_exp_f32 v19, v85
M v[112:115], a[64:67], a[0:3], v[32:35]
 ds_read_b128 a[96:99], v7 offset:57344
 v_add_f32 v26, v24, v26
M v[112:115], a[68:71], a[4:7], v[112:115]
 ds_read_b128 a[100:103], v7 offset:58368
 v_cvt_pk_bf16_f32 v59, v24, v25
M v[112:115], a[72:75], a[8:11], v[112:115]
 buffer_load_dwordx4 v4, s[8:11], s24 offen offset:2048 sc1 lds
M v[112:115], a[76:79], a[12:15], v[112:115]
 ds_read_b128 a[104:107], v7 offset:59392
 v_add_f32 v26, v25, v26
M v[112:115], a[80:83], a[16:19], v[112:115]
 ds_read_b128 a[108:111], v7 offset:60416
 v_add_f32 v27, v18, v27
M v[112:115], a[84:87], a[20:23], v[112:115]
 v_exp_f32 v20, v86
M v[112:115], a[88:91], a[24:27], v[112:115]
 ds_read_b128 a[112:115], v7 offset:61440
 v_cvt_pk_bf16_f32 v60, v18, v19
M v[112:115], a[92:95], a[28:31], v[112:115]
 ds_read_b128 a[116:119], v7 offset:62464
 v_add_f32 v27, v19, v27
M v[116:119], a[92:95], a[60:63], v[36:39]
 buffer_load_dwordx4 v4, s[8:11], s24 offen offset:3072 sc1 lds
M v[116:119], a[88:91], a[56:59], v[116:119]
 ds_read_b128 a[120:123], v7 offset:63488
M v[116:119], a[84:87], a[52:55], v[116:119]
 ds_read_b128 a[124:127], v7 offset:64512
M v[116:119], a[80:83], a[48:51], v[116:119]
 v_exp_f32 v21, v87
M v[116:119], a[76:79], a[44:47], v[116:119]
 v_exp_f32 v22, v92
M v[116:119], a[72:75], a[40:43], v[116:119]
 v_exp_f32 v23, v93
M v[116:119], a[68:71], a[36:39], v[116:119]
 s_waitcnt vmcnt(16) lgkmcnt(0)
 v_add_f32 v27, v20, v27
 v_cvt_pk_bf16_f32 v61, v20, v21
M v[116:119], a[64:67], a[32:35], v[116:119]
 s_barrier
M v[124:127], a[96:99], a[32:35], v[36:39]
 ds_read_b128 a[64:67], v2 offset:0
 v_add_f32 v27, v21, v27
M v[124:127], a[100:103], a[36:39], v[124:127]
 ds_read_b128 a[68:71], v2 offset:1024
 v_add_f32 v27, v22, v27
M v[124:127], a[104:107], a[40:43], v[124:127]
 v_exp_f32 v24, v94
M v[124:127], a[108:111], a[44:47], v[124:127]
 ds_read_b128 a[72:75], v2 offset:2048
 v_cvt_pk_bf16_f32 v62, v22, v23
M v[124:127], a[112:115], a[48:51], v[124:127]
 ds_read_b128 a[76:79], v2 offset:3072
 v_add_f32 v27, v23, v27
M v[124:127], a[116:119], a[52:55], v[124:127]
 v_exp_f32 v25, v95
M v[124:127], a[120:123], a[56:59], v[124:127]
 ds_read_b128 a[80:83], v2 offset:4096
 v_add_f32 v27, v24, v27
M v[124:127], a[124:127], a[60:63], v[124:127]
 ds_read_b128 a[84:87], v2 offset:5120
 v_cvt_pk_bf16_f32 v63, v24, v25
M v[120:123], a[124:127], a[28:31], v[32:35]
 v_add_f32 v27, v25, v27
M v[120:123], a[120:123], a[24:27], v[120:123]
 ds_read_b128 a[88:91], v2 offset:6144
M v[120:123], a[116:119], a[20:23], v[120:123]
 ds_read_b128 a[92:95], v2 offset:7168
 v_max_f32 v10, v26, v27
M v[120:123], a[112:115], a[16:19], v[120:123]
 v_cmp_lt_f32 vcc, s31, v10
M v[120:123], a[108:111], a[12:15], v[120:123]
M v[120:123], a[104:107], a[8:11], v[120:123]
M v[120:123], a[100:103], a[4:7], v[120:123]
 s_waitcnt lgkmcnt(0)
M v[120:123], a[96:99], a[0:3], v[120:123]
 s_cbranch_vccnz L_st0
L_rt0:
M v[128:131], a[64:67], v[40:43], v[128:131]
 s_add_u32 m0, s28, 32768
 ds_read_b128 a[96:99], v2 offset:8192
 v_add_f32 v30, v26, v30
M v[128:131], a[68:71], v[56:59], v[128:131]
 ds_read_b128 a[100:103], v2 offset:9216
 v_add_f32 v31, v27, v31
M v[132:135], a[68:71], v[60:63], v[132:135]
 buffer_load_dwordx4 v3, s[8:11], s21 offen offset:0 sc1 lds
M v[132:135], a[64:67], v[44:47], v[132:135]
 ds_read_b128 a[104:107], v2 offset:10240
M v[140:143], a[72:75], v[44:47], v[140:143]
 ds_read_b128 a[108:111], v2 offset:11264
M v[140:143], a[76:79], v[60:63], v[140:143]
 buffer_load_dwordx4 v3, s[8:11], s21 offen offset:1024 sc1 lds
M v[136:139], a[76:79], v[56:59], v[136:139]
 ds_read_b128 a[112:115], v2 offset:12288
M v[136:139], a[72:75], v[40:43], v[136:139]
 ds_read_b128 a[116:119], v2 offset:13312
M v[144:147], a[80:83], v[40:43], v[144:147]
 v_exp_f32 v18, v96
M v[144:147], a[84:87], v[56:59], v[144:147]
 ds_read_b128 a[120:123], v2 offset:14336
M v[148:151], a[84:87], v[60:63], v[148:151]
 ds_read_b128 a[124:127], v2 offset:15360
M v[148:151], a[80:83], v[44:47], v[148:151]
 buffer_load_dwordx4 v3, s[8:11], s21 offen offset:2048 sc1 lds
M v[156:159], a[88:91], v[44:47], v[156:159]
 v_exp_f32 v19, v97
M v[156:159], a[92:95], v[60:63], v[156:159]
 v_exp_f32 v20, v98
M v[152:155], a[92:95], v[56:59], v[152:155]
 buffer_load_dwordx4 v3, s[8:11], s21 offen offset:3072 sc1 lds
M v[152:155], a[88:91], v[40:43], v[152:155]
 s_waitcnt lgkmcnt(0)
 v_exp_f32 v21, v99
M v[160:163], a[96:99], v[40:43], v[160:163]
 ds_read_b128 a[64:67], v2 offset:16384
 v_add_f32 v28, v18, v19
M v[160:163], a[100:103], v[56:59], v[160:163]
 s_add_u32 m0, s28, 36864
 ds_read_b128 a[68:71], v2 offset:17408
 v_cvt_pk_bf16_f32 v48, v18, v19
M v[164:167], a[100:103], v[60:63], v[164:167]
 buffer_load_dwordx4 v4, s[8:11], s21 offen offset:0 sc1 lds
M v[164:167], a[96:99], v[44:47], v[164:167]
 ds_read_b128 a[72:75], v2 offset:18432
 v_add_f32 v28, v20, v28
M v[172:175], a[104:107], v[44:47], v[172:175]
 ds_read_b128 a[76:79], v2 offset:19456
 v_cvt_pk_bf16_f32 v49, v20, v21
M v[172:175], a[108:111], v[60:63], v[172:175]
 v_exp_f32 v22, v104
M v[168:171], a[108:111], v[56:59], v[168:171]
 ds_read_b128 a[80:83], v2 offset:20480
 v_add_f32 v28, v21, v28
M v[168:171], a[104:107], v[40:43], v[168:171]
 ds_read_b128 a[84:87], v2 offset:21504
M v[176:179], a[112:115], v[40:43], v[176:179]
 buffer_load_dwordx4 v4, s[8:11], s21 offen offset:1024 sc1 lds
M v[176:179], a[116:119], v[56:59], v[176:179]
 ds_read_b128 a[88:91], v2 offset:22528
M v[180:183], a[116:119], v[60:63], v[180:183]
 ds_read_b128 a[92:95], v2 offset:23552
M v[180:183], a[112:115], v[44:47], v[180:183]
 buffer_load_dwordx4 v4, s[8:11], s21 offen offset:2048 sc1 lds
M v[188:191], a[120:123], v[44:47], v[188:191]
 v_exp_f32 v23, v105
M v[188:191], a[124:127], v[60:63], v[188:191]
 v_exp_f32 v24, v106
M v[184:187], a[124:127], v[56:59], v[184:187]
 v_exp_f32 v25, v107
M v[184:187], a[120:123], v[40:43], v[184:187]
 s_waitcnt lgkmcnt(0)
 v_exp_f32 v18, v100
M v[192:195], a[64:67], v[40:43], v[192:195]
 ds_read_b128 a[96:99], v2 offset:24576
 v_add_f32 v28, v22, v28
M v[192:195], a[68:71], v[56:59], v[192:195]
 ds_read_b128 a[100:103], v2 offset:25600
 v_cvt_pk_bf16_f32 v50, v22, v23
M v[196:199], a[68:71], v[60:63], v[196:199]
 buffer_load_dwordx4 v4, s[8:11], s21 offen offset:3072 sc1 lds
M v[196:199], a[64:67], v[44:47], v[196:199]
 s_add_u32 s24, s23, 16777216
 ds_read_b128 a[104:107], v2 offset:26624
 v_add_f32 v28, v23, v28
M v[204:207], a[72:75], v[44:47], v[204:207]
 s_mov_b32 s23, s21
 ds_read_b128 a[108:111], v2 offset:27648
 v_add_f32 v28, v24, v28
M v[204:207], a[76:79], v[60:63], v[204:207]
 s_add_u32 s21, s21, 32768
 v_exp_f32 v19, v101
M v[200:203], a[76:79], v[56:59], v[200:203]
 s_add_u32 s22, s22, 1
 ds_read_b128 a[112:115], v2 offset:28672
 v_cvt_pk_bf16_f32 v51, v24, v25
M v[200:203], a[72:75], v[40:43], v[200:203]
 s_cmp_eq_u32 s22, s25
 ds_read_b128 a[116:119], v2 offset:29696
 v_add_f32 v28, v25, v28
M v[208:211], a[80:83], v[40:43], v[208:211]
 s_cselect_b32 s21, s26, s21
 v_exp_f32 v20, v102
M v[208:211], a[84:87], v[56:59], v[208:211]
 s_cmp_eq_u32 s22, s43
 ds_read_b128 a[120:123], v2 offset:30720
 v_add_f32 v29, v18, v19
M v[212:215], a[84:87], v[60:63], v[212:215]
 s_cselect_b32 s21, s4, s21
 ds_read_b128 a[124:127], v2 offset:31744
 v_cvt_pk_bf16_f32 v52, v18, v19
M v[212:215], a[80:83], v[44:47], v[212:215]
 s_cmp_eq_u32 s22, s6
 v_exp_f32 v21, v103
M v[220:223], a[88:91], v[44:47], v[220:223]
 s_cselect_b32 s21, s7, s21
 v_exp_f32 v22, v108
M v[220:223], a[92:95], v[60:63], v[220:223]
 v_add_f32 v29, v20, v29
 v_cvt_pk_bf16_f32 v53, v20, v21
M v[216:219], a[92:95], v[56:59], v[216:219]
 s_waitcnt vmcnt(16) lgkmcnt(0)
 v_exp_f32 v23, v109
M v[216:219], a[88:91], v[40:43], v[216:219]
 s_barrier
M v[224:227], a[96:99], v[40:43], v[224:227]
 ds_read_b128 a[64:67], v2 offset:32768
 v_add_f32 v29, v21, v29
M v[224:227], a[100:103], v[56:59], v[224:227]
 ds_read_b128 a[68:71], v2 offset:33792
 v_add_f32 v29, v22, v29
M v[228:231], a[100:103], v[60:63], v[228:231]
 v_cmp_gt_u32 vcc, s39, v6
 v_cvt_pk_bf16_f32 v54, v22, v23
M v[228:231], a[96:99], v[44:47], v[228:231]
 ds_read_b128 a[72:75], v2 offset:34816
 v_add_f32 v29, v23, v29
M v[236:239], a[104:107], v[44:47], v[236:239]
 ds_read_b128 a[76:79], v2 offset:35840
M v[236:239], a[108:111], v[60:63], v[236:239]
 s_cbranch_vccnz L_fls0
L_flr0:
 v_exp_f32 v24, v110
M v[232:235], a[108:111], v[56:59], v[232:235]
 s_and_b32 s3, s5, 15
 ds_read_b128 a[80:83], v2 offset:36864
M v[232:235], a[104:107], v[40:43], v[232:235]
 s_cbranch_scc1 L_pub3
L_pub3r:
 ds_read_b128 a[84:87], v2 offset:37888
M v[240:243], a[112:115], v[40:43], v[240:243]
 s_lshr_b32 s5, s5, 4
 v_exp_f32 v25, v111
M v[240:243], a[116:119], v[56:59], v[240:243]
 ds_read_b128 a[88:91], v2 offset:38912
 v_add_f32 v29, v24, v29
M v[244:247], a[116:119], v[60:63], v[244:247]
 ds_read_b128 a[92:95], v2 offset:39936
 v_cvt_pk_bf16_f32 v55, v24, v25
M v[244:247], a[112:115], v[44:47], v[244:247]
 v_add_f32 v29, v25, v29
M v[252:255], a[120:123], v[44:47], v[252:255]
 s_sub_u32 s27, s27, 1
M v[252:255], a[124:127], v[60:63], v[252:255]
 s_cmp_lg_u32 s27, 0
M v[248:251], a[124:127], v[56:59], v[248:251]
 s_waitcnt lgkmcnt(0)
M v[248:251], a[120:123], v[40:43], v[248:251]
 s_cbranch_scc1 L_loop_top
L_p1:
 s_cmp_eq_u32 s40, 0
 s_cbranch_scc1 L_final_h
 s_cmp_lt_u32 s42, 10
 s_cbranch_scc1 L_p1n
L_p1c:
 v_cndmask_b32 v64, v32, v8, s[64:65]
 v_cndmask_b32 v65, v32, v8, s[66:67]
 v_cndmask_b32 v66, v32, v8, s[68:69]
 v_cndmask_b32 v67, v32, v8, s[70:71]
 s_nop 1
M v[64:67], a[64:67], a[0:3], v[64:67]
 s_add_u32 m0, s28, 65536
 ds_read_b128 a[96:99], v2 offset:40960
 ds_read_b128 a[100:103], v2 offset:41984
M v[64:67], a[68:71], a[4:7], v[64:67]
 buffer_load_dwordx4 v3, s[8:11], s24 offen offset:0 sc1 lds
M v[64:67], a[72:75], a[8:11], v[64:67]
 v_exp_f32 v18, v112
M v[64:67], a[76:79], a[12:15], v[64:67]
 ds_read_b128 a[104:107], v2 offset:43008
 ds_read_b128 a[108:111], v2 offset:44032
M v[64:67], a[80:83], a[16:19], v[64:67]
 buffer_load_dwordx4 v[14:17], v7, s[8:11], s52 offen sc1
M v[64:67], a[84:87], a[20:23], v[64:67]
 s_cmp_eq_u32 s20, 3
 v_exp_f32 v19, v113
M v[64:67], a[88:91], a[24:27], v[64:67]
 s_cselect_b64 s[64:65], s[16:17], 0
 ds_read_b128 a[112:115], v2 offset:45056
 ds_read_b128 a[116:119], v2 offset:46080
M v[64:67], a[92:95], a[28:31], v[64:67]
 s_cselect_b64 s[66:67], s[18:19], 0
 v_exp_f32 v20, v114
M v[68:71], a[92:95], a[60:63], v[36:39]
 s_cselect_b64 s[68:69], s[48:49], 0
 v_add_f32 v28, v18, v28
 v_cvt_pk_bf16_f32 v56, v18, v19
M v[68:71], a[88:91], a[56:59], v[68:71]
 s_cselect_b64 s[70:71], s[50:51], 0
 ds_read_b128 a[120:123], v2 offset:47104
 ds_read_b128 a[124:127], v2 offset:48128
M v[68:71], a[84:87], a[52:55], v[68:71]
 buffer_load_dwordx4 v3, s[8:11], s24 offen offset:1024 sc1 lds
M v[68:71], a[80:83], a[48:51], v[68:71]
 v_cndmask_b32 v72, v32, v8, s[72:73]
 v_cndmask_b32 v73, v32, v8, s[74:75]
M v[68:71], a[76:79], a[44:47], v[68:71]
 v_cndmask_b32 v74, v32, v8, s[76:77]
 v_cndmask_b32 v75, v32, v8, s[78:79]
M v[68:71], a[72:75], a[40:43], v[68:71]
 buffer_load_dwordx4 a[128:131], v7, s[8:11], s12 offen offset:0 sc1 nt
M v[68:71], a[68:71], a[36:39], v[68:71]
 buffer_load_dwordx4 a[132:135], v7, s[8:11], s12 offen offset:1024 sc1 nt
M v[68:71], a[64:67], a[32:35], v[68:71]
 s_waitcnt lgkmcnt(0)
 v_exp_f32 v21, v115
M v[72:75], a[96:99], a[0:3], v[72:75]
 ds_read_b128 a[64:67], v2 offset:49152
 ds_read_b128 a[68:71], v2 offset:50176
M v[72:75], a[100:103], a[4:7], v[72:75]
 buffer_load_dwordx4 v3, s[8:11], s24 offen offset:2048 sc1 lds
M v[72:75], a[104:107], a[8:11], v[72:75]
 v_exp_f32 v22, v120
M v[72:75], a[108:111], a[12:15], v[72:75]
 ds_read_b128 a[72:75], v2 offset:51200
 ds_read_b128 a[76:79], v2 offset:52224
M v[72:75], a[112:115], a[16:19], v[72:75]
 buffer_load_dwordx4 v3, s[8:11], s24 offen offset:3072 sc1 lds
M v[72:75], a[116:119], a[20:23], v[72:75]
 s_cmp_gt_u32 s20, 2
 v_exp_f32 v23, v121
M v[72:75], a[120:123], a[24:27], v[72:75]
 s_cselect_b64 s[78:79], -1, 0
 ds_read_b128 a[80:83], v2 offset:53248
 ds_read_b128 a[84:87], v2 offset:54272
M v[72:75], a[124:127], a[28:31], v[72:75]
 s_cmp_eq_u32 s20, 2
 v_exp_f32 v24, v122
M v[76:79], a[124:127], a[60:63], v[36:39]
 s_cselect_b64 s[72:73], s[16:17], s[78:79]
 v_exp_f32 v25, v123
M v[76:79], a[120:123], a[56:59], v[76:79]
 s_cselect_b64 s[74:75], s[18:19], s[78:79]
 ds_read_b128 a[88:91], v2 offset:55296
 ds_read_b128 a[92:95], v2 offset:56320
M v[76:79], a[116:119], a[52:55], v[76:79]
 s_cselect_b64 s[76:77], s[48:49], s[78:79]
 v_add_f32 v28, v19, v28
 v_add_f32 v28, v20, v28
M v[76:79], a[112:115], a[48:51], v[76:79]
 s_cselect_b64 s[78:79], s[50:51], s[78:79]
 v_cndmask_b32 v80, v32, v8, s[80:81]
 v_cndmask_b32 v81, v32, v8, s[82:83]
M v[76:79], a[108:111], a[44:47], v[76:79]
 s_add_u32 m0, s28, 69632
 v_cndmask_b32 v82, v32, v8, s[84:85]
 v_cndmask_b32 v83, v32, v8, s[86:87]
M v[76:79], a[104:107], a[40:43], v[76:79]
 buffer_load_dwordx4 a[136:139], v7, s[8:11], s12 offen offset:2048 sc1 nt
M v[76:79], a[100:103], a[36:39], v[76:79]
 buffer_load_dwordx4 v4, s[8:11], s24 offen offset:0 sc1 lds
M v[76:79], a[96:99], a[32:35], v[76:79]
 s_waitcnt lgkmcnt(0)
 v_exp_f32 v18, v116
M v[80:83], a[64:67], a[0:3], v[80:83]
 ds_read_b128 a[96:99], v2 offset:57344
 ds_read_b128 a[100:103], v2 offset:58368
M v[80:83], a[68:71], a[4:7], v[80:83]
 buffer_load_dwordx4 a[140:143], v7, s[8:11], s12 offen offset:3072 sc1 nt
M v[80:83], a[72:75], a[8:11], v[80:83]
 buffer_load_dwordx4 v4, s[8:11], s24 offen offset:1024 sc1 lds
M v[80:83], a[76:79], a[12:15], v[80:83]
 ds_read_b128 a[104:107], v2 offset:59392
 ds_read_b128 a[108:111], v2 offset:60416
M v[80:83], a[80:83], a[16:19], v[80:83]
 buffer_load_dwordx4 a[144:147], v7, s[8:11], s13 offen offset:0 sc1 nt
M v[80:83], a[84:87], a[20:23], v[80:83]
 s_cmp_gt_u32 s20, 1
 v_exp_f32 v19, v117
M v[80:83], a[88:91], a[24:27], v[80:83]
 s_cselect_b64 s[86:87], -1, 0
 ds_read_b128 a[112:115], v2 offset:61440
 ds_read_b128 a[116:119], v2 offset:62464
M v[80:83], a[92:95], a[28:31], v[80:83]
 s_cmp_eq_u32 s20, 1
 v_cvt_pk_bf16_f32 v57, v20, v21
 v_add_f32 v28, v21, v28
M v[84:87], a[92:95], a[60:63], v[36:39]
 s_cselect_b64 s[80:81], s[16:17], s[86:87]
 v_exp_f32 v20, v118
M v[84:87], a[88:91], a[56:59], v[84:87]
 s_cselect_b64 s[82:83], s[18:19], s[86:87]
 ds_read_b128 a[120:123], v2 offset:63488
 ds_read_b128 a[124:127], v2 offset:64512
M v[84:87], a[84:87], a[52:55], v[84:87]
 s_cselect_b64 s[84:85], s[48:49], s[86:87]
 v_exp_f32 v21, v119
M v[84:87], a[80:83], a[48:51], v[84:87]
 s_cselect_b64 s[86:87], s[50:51], s[86:87]
 v_cndmask_b32 v88, v32, v8, s[88:89]
 v_cndmask_b32 v89, v32, v8, s[90:91]
M v[84:87], a[76:79], a[44:47], v[84:87]
 v_cndmask_b32 v90, v32, v8, s[92:93]
 v_cndmask_b32 v91, v32, v8, s[94:95]
M v[84:87], a[72:75], a[40:43], v[84:87]
 buffer_load_dwordx4 v4, s[8:11], s24 offen offset:2048 sc1 lds
M v[84:87], a[68:71], a[36:39], v[84:87]
 s_waitcnt vmcnt(21) lgkmcnt(0)
 v_add_f32 v28, v22, v28
 v_cvt_pk_bf16_f32 v58, v22, v23
M v[84:87], a[64:67], a[32:35], v[84:87]
 s_barrier
M v[88:91], a[96:99], a[0:3], v[88:91]
 ds_read_b128 a[64:67], v7 offset:0
 ds_read_b128 a[68:71], v7 offset:1024
M v[88:91], a[100:103], a[4:7], v[88:91]
 s_cmp_eq_u32 s20, 0
 v_add_f32 v28, v23, v28
 v_add_f32 v28, v24, v28
M v[88:91], a[104:107], a[8:11], v[88:91]
 s_cselect_b64 s[88:89], s[16:17], -1
 v_exp_f32 v22, v124
M v[88:91], a[108:111], a[12:15], v[88:91]
 s_cselect_b64 s[90:91], s[18:19], -1
 ds_read_b128 a[72:75], v7 offset:2048
 ds_read_b128 a[76:79], v7 offset:3072
M v[88:91], a[112:115], a[16:19], v[88:91]
 s_cselect_b64 s[92:93], s[48:49], -1
 v_exp_f32 v23, v125
M v[88:91], a[116:119], a[20:23], v[88:91]
 s_cselect_b64 s[94:95], s[50:51], -1
 v_cvt_pk_bf16_f32 v59, v24, v25
 v_add_f32 v28, v25, v28
M v[88:91], a[120:123], a[24:27], v[88:91]
 ds_read_b128 a[80:83], v7 offset:4096
 ds_read_b128 a[84:87], v7 offset:5120
M v[88:91], a[124:127], a[28:31], v[88:91]
 buffer_load_dwordx4 a[148:151], v7, s[8:11], s13 offen offset:1024 sc1 nt
M v[92:95], a[124:127], a[60:63], v[36:39]
 buffer_load_dwordx4 v4, s[8:11], s24 offen offset:3072 sc1 lds
M v[92:95], a[120:123], a[56:59], v[92:95]
 ds_read_b128 a[88:91], v7 offset:6144
 ds_read_b128 a[92:95], v7 offset:7168
M v[92:95], a[116:119], a[52:55], v[92:95]
 buffer_load_dwordx4 a[152:155], v7, s[8:11], s13 offen offset:2048 sc1 nt
M v[92:95], a[112:115], a[48:51], v[92:95]
 v_exp_f32 v24, v126
M v[92:95], a[108:111], a[44:47], v[92:95]
 buffer_load_dwordx4 a[156:159], v7, s[8:11], s13 offen offset:3072 sc1 nt
M v[92:95], a[104:107], a[40:43], v[92:95]
 v_exp_f32 v25, v127
M v[92:95], a[100:103], a[36:39], v[92:95]
 s_waitcnt lgkmcnt(0)
 v_add_f32 v29, v18, v29
 v_cvt_pk_bf16_f32 v60, v18, v19
M v[92:95], a[96:99], a[32:35], v[92:95]
 v_add_f32 v29, v19, v29
 v_add_f32 v29, v20, v29
 v_cvt_pk_bf16_f32 v61, v20, v21
 v_add_f32 v29, v21, v29
 v_add_f32 v29, v22, v29
 v_cvt_pk_bf16_f32 v62, v22, v23
 v_add_f32 v29, v23, v29
 v_add_f32 v29, v24, v29
 v_cvt_pk_bf16_f32 v63, v24, v25
 v_add_f32 v29, v25, v29
 v_max_f32 v10, v28, v29
 v_cmp_lt_f32 vcc, s31, v10
 s_nop 0
 s_cbranch_vccnz L_st3
L_rt3:
M v[128:131], a[64:67], v[48:51], v[128:131]
 s_add_u32 m0, s28, 98304
 ds_read_b128 a[96:99], v7 offset:8192
 ds_read_b128 a[100:103], v7 offset:9216
M v[128:131], a[68:71], v[56:59], v[128:131]
 buffer_load_dwordx4 v3, s[8:11], s21 offen offset:0 sc1 lds
M v[132:135], a[68:71], v[60:63], v[132:135]
 v_exp_f32 v18, v64
M v[132:135], a[64:67], v[52:55], v[132:135]
 ds_read_b128 a[104:107], v7 offset:10240
 ds_read_b128 a[108:111], v7 offset:11264
M v[140:143], a[72:75], v[52:55], v[140:143]
 buffer_load_dwordx4 a[160:163], v7, s[8:11], s14 offen offset:0 sc1 nt
M v[140:143], a[76:79], v[60:63], v[140:143]
 v_cndmask_b32 v100, v36, v8, s[64:65]
 v_add_f32 v30, v28, v30
M v[136:139], a[76:79], v[56:59], v[136:139]
 ds_read_b128 a[112:115], v7 offset:12288
 ds_read_b128 a[116:119], v7 offset:13312
M v[136:139], a[72:75], v[48:51], v[136:139]
 buffer_load_dwordx4 v3, s[8:11], s21 offen offset:1024 sc1 lds
M v[144:147], a[80:83], v[48:51], v[144:147]
 v_cndmask_b32 v101, v36, v8, s[66:67]
 v_add_f32 v31, v29, v31
M v[144:147], a[84:87], v[56:59], v[144:147]
 ds_read_b128 a[120:123], v7 offset:14336
 ds_read_b128 a[124:127], v7 offset:15360
M v[148:151], a[84:87], v[60:63], v[148:151]
 buffer_load_dwordx4 a[164:167], v7, s[8:11], s14 offen offset:1024 sc1 nt
M v[148:151], a[80:83], v[52:55], v[148:151]
 v_cndmask_b32 v102, v36, v8, s[68:69]
M v[156:159], a[88:91], v[52:55], v[156:159]
 buffer_load_dwordx4 v3, s[8:11], s21 offen offset:2048 sc1 lds
M v[156:159], a[92:95], v[60:63], v[156:159]
 v_exp_f32 v19, v65
M v[152:155], a[92:95], v[56:59], v[152:155]
 buffer_load_dwordx4 a[168:171], v7, s[8:11], s14 offen offset:2048 sc1 nt
M v[152:155], a[88:91], v[48:51], v[152:155]
 s_waitcnt lgkmcnt(0)
 v_cndmask_b32 v103, v36, v8, s[70:71]
 v_add_f32 v26, v18, v19
M v[160:163], a[96:99], v[48:51], v[160:163]
 ds_read_b128 a[64:67], v7 offset:16384
 ds_read_b128 a[68:71], v7 offset:17408
M v[160:163], a[100:103], v[56:59], v[160:163]
 buffer_load_dwordx4 v3, s[8:11], s21 offen offset:3072 sc1 lds
M v[164:167], a[100:103], v[60:63], v[164:167]
 v_cndmask_b32 v108, v36, v8, s[72:73]
 v_cvt_pk_bf16_f32 v40, v18, v19
M v[164:167], a[96:99], v[52:55], v[164:167]
 ds_read_b128 a[72:75], v7 offset:18432
 ds_read_b128 a[76:79], v7 offset:19456
M v[172:175], a[104:107], v[52:55], v[172:175]
 buffer_load_dwordx4 a[172:175], v7, s[8:11], s14 offen offset:3072 sc1 nt
M v[172:175], a[108:111], v[60:63], v[172:175]
 v_exp_f32 v20, v66
M v[168:171], a[108:111], v[56:59], v[168:171]
 s_add_u32 m0, s28, 102400
 ds_read_b128 a[80:83], v7 offset:20480
 ds_read_b128 a[84:87], v7 offset:21504
M v[168:171], a[104:107], v[48:51], v[168:171]
 buffer_load_dwordx4 v4, s[8:11], s21 offen offset:0 sc1 lds
M v[176:179], a[112:115], v[48:51], v[176:179]
 v_cndmask_b32 v109, v36, v8, s[74:75]
M v[176:179], a[116:119], v[56:59], v[176:179]
 ds_read_b128 a[88:91], v7 offset:22528
 ds_read_b128 a[92:95], v7 offset:23552
M v[180:183], a[116:119], v[60:63], v[180:183]
 buffer_load_dwordx4 a[176:179], v7, s[8:11], s15 offen offset:0 sc1 nt
M v[180:183], a[112:115], v[52:55], v[180:183]
 v_cndmask_b32 v110, v36, v8, s[76:77]
M v[188:191], a[120:123], v[52:55], v[188:191]
 buffer_load_dwordx4 v4, s[8:11], s21 offen offset:1024 sc1 lds
M v[188:191], a[124:127], v[60:63], v[188:191]
 v_cndmask_b32 v111, v36, v8, s[78:79]
M v[184:187], a[124:127], v[56:59], v[184:187]
 buffer_load_dwordx4 a[180:183], v7, s[8:11], s15 offen offset:1024 sc1 nt
M v[184:187], a[120:123], v[48:51], v[184:187]
 s_waitcnt lgkmcnt(0)
 v_exp_f32 v21, v67
M v[192:195], a[64:67], v[48:51], v[192:195]
 ds_read_b128 a[96:99], v7 offset:24576
 ds_read_b128 a[100:103], v7 offset:25600
M v[192:195], a[68:71], v[56:59], v[192:195]
 buffer_load_dwordx4 v4, s[8:11], s21 offen offset:2048 sc1 lds
M v[196:199], a[68:71], v[60:63], v[196:199]
 v_cndmask_b32 v116, v36, v8, s[80:81]
 v_add_f32 v26, v20, v26
M v[196:199], a[64:67], v[52:55], v[196:199]
 ds_read_b128 a[104:107], v7 offset:26624
 ds_read_b128 a[108:111], v7 offset:27648
M v[204:207], a[72:75], v[52:55], v[204:207]
 buffer_load_dwordx4 a[184:187], v7, s[8:11], s15 offen offset:2048 sc1 nt
M v[204:207], a[76:79], v[60:63], v[204:207]
 v_cndmask_b32 v117, v36, v8, s[82:83]
 v_cvt_pk_bf16_f32 v41, v20, v21
M v[200:203], a[76:79], v[56:59], v[200:203]
 ds_read_b128 a[112:115], v7 offset:28672
 ds_read_b128 a[116:119], v7 offset:29696
M v[200:203], a[72:75], v[48:51], v[200:203]
 buffer_load_dwordx4 v4, s[8:11], s21 offen offset:3072 sc1 lds
M v[208:211], a[80:83], v[48:51], v[208:211]
 s_add_u32 s24, s23, 16777216
 v_cndmask_b32 v118, v36, v8, s[84:85]
 v_add_f32 v26, v21, v26
M v[208:211], a[84:87], v[56:59], v[208:211]
 s_mov_b32 s23, s21
 ds_read_b128 a[120:123], v7 offset:30720
 ds_read_b128 a[124:127], v7 offset:31744
M v[212:215], a[84:87], v[60:63], v[212:215]
 buffer_load_dwordx4 a[188:191], v7, s[8:11], s15 offen offset:3072 sc1 nt
M v[212:215], a[80:83], v[52:55], v[212:215]
 s_add_u32 s21, s21, 32768
 v_cndmask_b32 v119, v36, v8, s[86:87]
M v[220:223], a[88:91], v[52:55], v[220:223]
 s_add_u32 s22, s22, 1
 v_exp_f32 v22, v72
M v[220:223], a[92:95], v[60:63], v[220:223]
 s_cmp_eq_u32 s22, s25
 v_exp_f32 v23, v73
M v[216:219], a[92:95], v[56:59], v[216:219]
 s_waitcnt vmcnt(33) lgkmcnt(0)
 v_exp_f32 v24, v74
M v[216:219], a[88:91], v[48:51], v[216:219]
 s_barrier
M v[224:227], a[96:99], v[48:51], v[224:227]
 s_cselect_b32 s21, s26, s21
 ds_read_b128 a[64:67], v7 offset:32768
 ds_read_b128 a[68:71], v7 offset:33792
M v[224:227], a[100:103], v[56:59], v[224:227]
 s_cmp_eq_u32 s22, s43
 v_cndmask_b32 v124, v36, v8, s[88:89]
 v_add_f32 v26, v22, v26
M v[228:231], a[100:103], v[60:63], v[228:231]
 s_cselect_b32 s21, s4, s21
 v_exp_f32 v25, v75
M v[228:231], a[96:99], v[52:55], v[228:231]
 s_cmp_eq_u32 s22, s6
 ds_read_b128 a[72:75], v7 offset:34816
 ds_read_b128 a[76:79], v7 offset:35840
M v[236:239], a[104:107], v[52:55], v[236:239]
 s_cselect_b32 s21, s7, s21
 v_cndmask_b32 v125, v36, v8, s[90:91]
 v_cvt_pk_bf16_f32 v42, v22, v23
M v[236:239], a[108:111], v[60:63], v[236:239]
 v_exp_f32 v18, v68
M v[232:235], a[108:111], v[56:59], v[232:235]
 ds_read_b128 a[80:83], v7 offset:36864
 ds_read_b128 a[84:87], v7 offset:37888
M v[232:235], a[104:107], v[48:51], v[232:235]
 v_cndmask_b32 v126, v36, v8, s[92:93]
 v_add_f32 v26, v23, v26
M v[240:243], a[112:115], v[48:51], v[240:243]
 v_exp_f32 v19, v69
M v[240:243], a[116:119], v[56:59], v[240:243]
 ds_read_b128 a[88:91], v7 offset:38912
 ds_read_b128 a[92:95], v7 offset:39936
M v[244:247], a[116:119], v[60:63], v[244:247]
 v_cndmask_b32 v127, v36, v8, s[94:95]
 v_add_f32 v26, v24, v26
M v[244:247], a[112:115], v[52:55], v[244:247]
 v_exp_f32 v20, v70
M v[252:255], a[120:123], v[52:55], v[252:255]
 v_exp_f32 v21, v71
M v[252:255], a[124:127], v[60:63], v[252:255]
 v_exp_f32 v22, v76
M v[248:251], a[124:127], v[56:59], v[248:251]
 s_waitcnt lgkmcnt(0)
 v_exp_f32 v23, v77
M v[248:251], a[120:123], v[48:51], v[248:251]
 v_cvt_pk_bf16_f32 v43, v24, v25
 v_add_f32 v26, v25, v26
 v_add_f32 v27, v18, v19
 v_cvt_pk_bf16_f32 v44, v18, v19
 v_add_f32 v27, v20, v27
 v_cvt_pk_bf16_f32 v45, v20, v21
 v_add_f32 v27, v21, v27
 v_exp_f32 v24, v78
 v_add_f32 v27, v22, v27
 v_cvt_pk_bf16_f32 v46, v22, v23
 v_exp_f32 v25, v79
 v_add_f32 v27, v23, v27
 v_add_f32 v27, v24, v27
 v_cvt_pk_bf16_f32 v47, v24, v25
 v_add_f32 v27, v25, v27
 s_waitcnt vmcnt(31)
 v_cmp_neq_f32 vcc, v32, v14
 v_cmp_neq_f32 s[64:65], v36, v15
 s_nop 0
 s_or_b64 vcc, vcc, s[64:65]
 s_cbranch_vccnz L_comb
 v_add_f32 v30, v16, v30
 v_add_f32 v31, v17, v31
M v[100:103], a[64:67], a[32:35], v[100:103]
 ds_read_b128 a[96:99], v7 offset:40960
 ds_read_b128 a[100:103], v7 offset:41984
M v[100:103], a[68:71], a[36:39], v[100:103]
 ds_read_b128 a[104:107], v7 offset:43008
M v[100:103], a[72:75], a[40:43], v[100:103]
 ds_read_b128 a[108:111], v7 offset:44032
 ds_read_b128 a[112:115], v7 offset:45056
M v[100:103], a[76:79], a[44:47], v[100:103]
 ds_read_b128 a[116:119], v7 offset:46080
M v[100:103], a[80:83], a[48:51], v[100:103]
 s_add_u32 m0, s28, 0
 ds_read_b128 a[120:123], v7 offset:47104
 ds_read_b128 a[124:127], v7 offset:48128
M v[100:103], a[84:87], a[52:55], v[100:103]
 buffer_load_dwordx4 v3, s[8:11], s24 offen offset:0 sc1 lds
M v[100:103], a[88:91], a[56:59], v[100:103]
 ds_read_b128 a[0:3], v7 offset:49152
 ds_read_b128 a[4:7], v7 offset:50176
M v[100:103], a[92:95], a[60:63], v[100:103]
 s_waitcnt lgkmcnt(2)
 ds_read_b128 a[8:11], v7 offset:51200
M v[108:111], a[124:127], a[60:63], v[108:111]
 ds_read_b128 a[12:15], v7 offset:52224
 ds_read_b128 a[16:19], v7 offset:53248
M v[108:111], a[120:123], a[56:59], v[108:111]
 buffer_load_dwordx4 v3, s[8:11], s24 offen offset:1024 sc1 lds
M v[108:111], a[116:119], a[52:55], v[108:111]
 ds_read_b128 a[20:23], v7 offset:54272
 ds_read_b128 a[24:27], v7 offset:55296
M v[108:111], a[112:115], a[48:51], v[108:111]
 ds_read_b128 a[28:31], v7 offset:56320
M v[108:111], a[108:111], a[44:47], v[108:111]
 ds_read_b128 a[192:195], v7 offset:57344
 ds_read_b128 a[196:199], v7 offset:58368
M v[108:111], a[104:107], a[40:43], v[108:111]
 v_exp_f32 v18, v80
M v[108:111], a[100:103], a[36:39], v[108:111]
 ds_read_b128 a[200:203], v7 offset:59392
 ds_read_b128 a[204:207], v7 offset:60416
M v[108:111], a[96:99], a[32:35], v[108:111]
 s_waitcnt lgkmcnt(4)
 ds_read_b128 a[208:211], v7 offset:61440
M v[116:119], a[0:3], a[32:35], v[116:119]
 ds_read_b128 a[212:215], v7 offset:62464
 ds_read_b128 a[216:219], v7 offset:63488
M v[116:119], a[4:7], a[36:39], v[116:119]
 ds_read_b128 a[220:223], v7 offset:64512
M v[116:119], a[8:11], a[40:43], v[116:119]
 buffer_load_dwordx4 v3, s[8:11], s24 offen offset:2048 sc1 lds
M v[116:119], a[12:15], a[44:47], v[116:119]
 v_exp_f32 v19, v81
M v[116:119], a[16:19], a[48:51], v[116:119]
 buffer_load_dwordx4 v3, s[8:11], s24 offen offset:3072 sc1 lds
M v[116:119], a[20:23], a[52:55], v[116:119]
 v_exp_f32 v20, v82
M v[116:119], a[24:27], a[56:59], v[116:119]
 s_add_u32 m0, s28, 4096
 v_exp_f32 v21, v83
M v[116:119], a[28:31], a[60:63], v[116:119]
 s_waitcnt lgkmcnt(0)
 v_exp_f32 v22, v88
M v[124:127], a[220:223], a[60:63], v[124:127]
 buffer_load_dwordx4 v4, s[8:11], s24 offen offset:0 sc1 lds
M v[124:127], a[216:219], a[56:59], v[124:127]
 v_exp_f32 v23, v89
M v[124:127], a[212:215], a[52:55], v[124:127]
 v_exp_f32 v24, v90
M v[124:127], a[208:211], a[48:51], v[124:127]
 v_exp_f32 v25, v91
M v[124:127], a[204:207], a[44:47], v[124:127]
 v_add_f32 v26, v18, v26
 v_cvt_pk_bf16_f32 v56, v18, v19
M v[124:127], a[200:203], a[40:43], v[124:127]
 buffer_load_dwordx4 v4, s[8:11], s24 offen offset:1024 sc1 lds
M v[124:127], a[196:199], a[36:39], v[124:127]
 v_add_f32 v26, v19, v26
 v_add_f32 v26, v20, v26
M v[124:127], a[192:195], a[32:35], v[124:127]
 s_waitcnt vmcnt(22)
 v_exp_f32 v18, v84
M v[128:131], a[246:249], a[128:131], v[128:131]
 v_exp_f32 v19, v85
M v[136:139], a[244:247], a[128:131], v[136:139]
 v_cvt_pk_bf16_f32 v57, v20, v21
 v_add_f32 v26, v21, v26
M v[144:147], a[246:249], a[132:135], v[144:147]
 buffer_load_dwordx4 v4, s[8:11], s24 offen offset:2048 sc1 lds
M v[152:155], a[244:247], a[132:135], v[152:155]
 v_exp_f32 v20, v86
M v[160:163], a[246:249], a[136:139], v[160:163]
 v_add_f32 v26, v22, v26
 v_cvt_pk_bf16_f32 v58, v22, v23
M v[168:171], a[244:247], a[136:139], v[168:171]
 v_add_f32 v26, v23, v26
 v_add_f32 v26, v24, v26
M v[176:179], a[246:249], a[140:143], v[176:179]
 v_exp_f32 v21, v87
M v[184:187], a[244:247], a[140:143], v[184:187]
 buffer_load_dwordx4 v4, s[8:11], s24 offen offset:3072 sc1 lds
M v[192:195], a[246:249], a[144:147], v[192:195]
 v_cvt_pk_bf16_f32 v59, v24, v25
 v_add_f32 v26, v25, v26
M v[200:203], a[244:247], a[144:147], v[200:203]
 v_add_f32 v27, v18, v27
 v_cvt_pk_bf16_f32 v60, v18, v19
M v[208:211], a[246:249], a[148:151], v[208:211]
 v_exp_f32 v22, v92
M v[216:219], a[244:247], a[148:151], v[216:219]
 v_add_f32 v27, v19, v27
 v_add_f32 v27, v20, v27
M v[224:227], a[246:249], a[152:155], v[224:227]
 v_cvt_pk_bf16_f32 v61, v20, v21
 v_add_f32 v27, v21, v27
M v[232:235], a[244:247], a[152:155], v[232:235]
 s_waitcnt vmcnt(8)
 v_exp_f32 v23, v93
M v[240:243], a[246:249], a[156:159], v[240:243]
 v_add_f32 v27, v22, v27
 v_cvt_pk_bf16_f32 v62, v22, v23
M v[248:251], a[244:247], a[156:159], v[248:251]
 s_barrier
M v[132:135], a[246:249], a[160:163], v[132:135]
 ds_read_b128 a[64:67], v2 offset:0
 v_add_f32 v27, v23, v27
M v[140:143], a[244:247], a[160:163], v[140:143]
 ds_read_b128 a[68:71], v2 offset:1024
M v[148:151], a[246:249], a[164:167], v[148:151]
 v_exp_f32 v24, v94
M v[156:159], a[244:247], a[164:167], v[156:159]
 ds_read_b128 a[72:75], v2 offset:2048
M v[164:167], a[246:249], a[168:171], v[164:167]
 ds_read_b128 a[76:79], v2 offset:3072
M v[172:175], a[244:247], a[168:171], v[172:175]
 v_exp_f32 v25, v95
M v[180:183], a[246:249], a[172:175], v[180:183]
 ds_read_b128 a[80:83], v2 offset:4096
 v_add_f32 v27, v24, v27
M v[188:191], a[244:247], a[172:175], v[188:191]
 ds_read_b128 a[84:87], v2 offset:5120
 v_cvt_pk_bf16_f32 v63, v24, v25
M v[196:199], a[246:249], a[176:179], v[196:199]
 v_add_f32 v27, v25, v27
M v[204:207], a[244:247], a[176:179], v[204:207]
 ds_read_b128 a[88:91], v2 offset:6144
M v[212:215], a[246:249], a[180:183], v[212:215]
 ds_read_b128 a[92:95], v2 offset:7168
 v_max_f32 v10, v26, v27
M v[220:223], a[244:247], a[180:183], v[220:223]
 v_cmp_lt_f32 vcc, s31, v10
M v[228:231], a[246:249], a[184:187], v[228:231]
M v[236:239], a[244:247], a[184:187], v[236:239]
M v[244:247], a[246:249], a[188:191], v[244:247]
 s_waitcnt lgkmcnt(0)
M v[252:255], a[244:247], a[188:191], v[252:255]
 s_cbranch_vccnz L_st14
L_rt14:
L_p3o:
M v[128:131], a[64:67], v[40:43], v[128:131]
 s_add_u32 m0, s28, 32768
 ds_read_b128 a[96:99], v2 offset:8192
 v_add_f32 v30, v26, v30
M v[128:131], a[68:71], v[56:59], v[128:131]
 ds_read_b128 a[100:103], v2 offset:9216
 v_add_f32 v31, v27, v31
M v[132:135], a[68:71], v[60:63], v[132:135]
 buffer_load_dwordx4 v3, s[8:11], s21 offen offset:0 sc1 lds
M v[132:135], a[64:67], v[44:47], v[132:135]
 ds_read_b128 a[104:107], v2 offset:10240
M v[140:143], a[72:75], v[44:47], v[140:143]
 ds_read_b128 a[108:111], v2 offset:11264
M v[140:143], a[76:79], v[60:63], v[140:143]
 buffer_load_dwordx4 v3, s[8:11], s21 offen offset:1024 sc1 lds
M v[136:139], a[76:79], v[56:59], v[136:139]
 ds_read_b128 a[112:115], v2 offset:12288
M v[136:139], a[72:75], v[40:43], v[136:139]
 ds_read_b128 a[116:119], v2 offset:13312
M v[144:147], a[80:83], v[40:43], v[144:147]
 v_exp_f32 v18, v100
M v[144:147], a[84:87], v[56:59], v[144:147]
 ds_read_b128 a[120:123], v2 offset:14336
M v[148:151], a[84:87], v[60:63], v[148:151]
 ds_read_b128 a[124:127], v2 offset:15360
M v[148:151], a[80:83], v[44:47], v[148:151]
 buffer_load_dwordx4 v3, s[8:11], s21 offen offset:2048 sc1 lds
M v[156:159], a[88:91], v[44:47], v[156:159]
 v_exp_f32 v19, v101
M v[156:159], a[92:95], v[60:63], v[156:159]
 v_exp_f32 v20, v102
M v[152:155], a[92:95], v[56:59], v[152:155]
 buffer_load_dwordx4 v3, s[8:11], s21 offen offset:3072 sc1 lds
M v[152:155], a[88:91], v[40:43], v[152:155]
 s_waitcnt lgkmcnt(0)
 v_exp_f32 v21, v103
M v[160:163], a[96:99], v[40:43], v[160:163]
 ds_read_b128 a[64:67], v2 offset:16384
 v_add_f32 v29, v18, v19
M v[160:163], a[100:103], v[56:59], v[160:163]
 s_add_u32 m0, s28, 36864
 ds_read_b128 a[68:71], v2 offset:17408
 v_cvt_pk_bf16_f32 v52, v18, v19
M v[164:167], a[100:103], v[60:63], v[164:167]
 buffer_load_dwordx4 v4, s[8:11], s21 offen offset:0 sc1 lds
M v[164:167], a[96:99], v[44:47], v[164:167]
 ds_read_b128 a[72:75], v2 offset:18432
 v_add_f32 v29, v20, v29
M v[172:175], a[104:107], v[44:47], v[172:175]
 ds_read_b128 a[76:79], v2 offset:19456
 v_cvt_pk_bf16_f32 v53, v20, v21
M v[172:175], a[108:111], v[60:63], v[172:175]
 v_exp_f32 v22, v108
M v[168:171], a[108:111], v[56:59], v[168:171]
 ds_read_b128 a[80:83], v2 offset:20480
 v_add_f32 v29, v21, v29
M v[168:171], a[104:107], v[40:43], v[168:171]
 ds_read_b128 a[84:87], v2 offset:21504
M v[176:179], a[112:115], v[40:43], v[176:179]
 buffer_load_dwordx4 v4, s[8:11], s21 offen offset:1024 sc1 lds
M v[176:179], a[116:119], v[56:59], v[176:179]
 ds_read_b128 a[88:91], v2 offset:22528
M v[180:183], a[116:119], v[60:63], v[180:183]
 ds_read_b128 a[92:95], v2 offset:23552
M v[180:183], a[112:115], v[44:47], v[180:183]
 buffer_load_dwordx4 v4, s[8:11], s21 offen offset:2048 sc1 lds
M v[188:191], a[120:123], v[44:47], v[188:191]
 v_exp_f32 v23, v109
M v[188:191], a[124:127], v[60:63], v[188:191]
 v_exp_f32 v24, v110
M v[184:187], a[124:127], v[56:59], v[184:187]
 v_exp_f32 v25, v111
M v[184:187], a[120:123], v[40:43], v[184:187]
 s_waitcnt lgkmcnt(0)
 v_exp_f32 v18, v116
M v[192:195], a[64:67], v[40:43], v[192:195]
 ds_read_b128 a[96:99], v2 offset:24576
 v_add_f32 v29, v22, v29
M v[192:195], a[68:71], v[56:59], v[192:195]
 ds_read_b128 a[100:103], v2 offset:25600
 v_cvt_pk_bf16_f32 v54, v22, v23
M v[196:199], a[68:71], v[60:63], v[196:199]
 buffer_load_dwordx4 v4, s[8:11], s21 offen offset:3072 sc1 lds
M v[196:199], a[64:67], v[44:47], v[196:199]
 s_add_u32 s24, s23, 16777216
 ds_read_b128 a[104:107], v2 offset:26624
 v_add_f32 v29, v23, v29
M v[204:207], a[72:75], v[44:47], v[204:207]
 s_mov_b32 s23, s21
 ds_read_b128 a[108:111], v2 offset:27648
 v_add_f32 v29, v24, v29
M v[204:207], a[76:79], v[60:63], v[204:207]
 s_add_u32 s21, s21, 32768
 v_exp_f32 v19, v117
M v[200:203], a[76:79], v[56:59], v[200:203]
 s_add_u32 s22, s22, 1
 ds_read_b128 a[112:115], v2 offset:28672
 v_cvt_pk_bf16_f32 v55, v24, v25
M v[200:203], a[72:75], v[40:43], v[200:203]
 s_cmp_eq_u32 s22, s25
 ds_read_b128 a[116:119], v2 offset:29696
 v_add_f32 v29, v25, v29
M v[208:211], a[80:83], v[40:43], v[208:211]
 s_cselect_b32 s21, s26, s21
 v_exp_f32 v20, v118
M v[208:211], a[84:87], v[56:59], v[208:211]
 s_cmp_eq_u32 s22, s43
 ds_read_b128 a[120:123], v2 offset:30720
 v_add_f32 v29, v18, v29
M v[212:215], a[84:87], v[60:63], v[212:215]
 s_cselect_b32 s21, s4, s21
 ds_read_b128 a[124:127], v2 offset:31744
 v_cvt_pk_bf16_f32 v48, v18, v19
M v[212:215], a[80:83], v[44:47], v[212:215]
 s_cmp_eq_u32 s22, s6
 v_exp_f32 v21, v119
M v[220:223], a[88:91], v[44:47], v[220:223]
 s_cselect_b32 s21, s7, s21
 v_exp_f32 v22, v124
M v[220:223], a[92:95], v[60:63], v[220:223]
 v_exp_f32 v23, v125
M v[216:219], a[92:95], v[56:59], v[216:219]
 s_waitcnt vmcnt(8) lgkmcnt(0)
 v_add_f32 v29, v19, v29
 v_add_f32 v29, v20, v29
M v[216:219], a[88:91], v[40:43], v[216:219]
 s_barrier
M v[224:227], a[96:99], v[40:43], v[224:227]
 ds_read_b128 a[64:67], v7 offset:0
 v_cvt_pk_bf16_f32 v49, v20, v21
M v[224:227], a[100:103], v[56:59], v[224:227]
 ds_read_b128 a[68:71], v7 offset:1024
 v_add_f32 v29, v21, v29
M v[228:231], a[100:103], v[60:63], v[228:231]
 v_exp_f32 v24, v126
M v[228:231], a[96:99], v[44:47], v[228:231]
 ds_read_b128 a[72:75], v7 offset:2048
 v_add_f32 v29, v22, v29
M v[236:239], a[104:107], v[44:47], v[236:239]
 ds_read_b128 a[76:79], v7 offset:3072
 v_cvt_pk_bf16_f32 v50, v22, v23
M v[236:239], a[108:111], v[60:63], v[236:239]
 v_exp_f32 v25, v127
M v[232:235], a[108:111], v[56:59], v[232:235]
 ds_read_b128 a[80:83], v7 offset:4096
 v_add_f32 v29, v23, v29
M v[232:235], a[104:107], v[40:43], v[232:235]
 ds_read_b128 a[84:87], v7 offset:5120
 v_add_f32 v29, v24, v29
M v[240:243], a[112:115], v[40:43], v[240:243]
 v_cvt_pk_bf16_f32 v51, v24, v25
 v_add_f32 v29, v25, v29
M v[240:243], a[116:119], v[56:59], v[240:243]
 ds_read_b128 a[88:91], v7 offset:6144
M v[244:247], a[116:119], v[60:63], v[244:247]
 ds_read_b128 a[92:95], v7 offset:7168
M v[244:247], a[112:115], v[44:47], v[244:247]
 v_cmp_lt_f32 vcc, s31, v29
M v[252:255], a[120:123], v[44:47], v[252:255]
M v[252:255], a[124:127], v[60:63], v[252:255]
M v[248:251], a[124:127], v[56:59], v[248:251]
 s_waitcnt lgkmcnt(0)
M v[248:251], a[120:123], v[40:43], v[248:251]
 s_cbranch_vccnz L_st2
L_rt2:
L_pBo:
M v[132:135], a[64:67], v[52:55], v[132:135]
 ds_read_b128 a[96:99], v7 offset:8192
 ds_read_b128 a[100:103], v7 offset:9216
M v[132:135], a[68:71], v[48:51], v[132:135]
 ds_read_b128 a[104:107], v7 offset:10240
 v_cvt_pk_bf16_f32 v128, v128, v129
 v_cvt_pk_bf16_f32 v129, v130, v131
M v[140:143], a[76:79], v[48:51], v[140:143]
 ds_read_b128 a[108:111], v7 offset:11264
 ds_read_b128 a[112:115], v7 offset:12288
 v_cvt_pk_bf16_f32 v130, v136, v137
M v[140:143], a[72:75], v[52:55], v[140:143]
 ds_read_b128 a[116:119], v7 offset:13312
 v_cvt_pk_bf16_f32 v131, v138, v139
 v_cvt_pk_bf16_f32 v144, v144, v145
M v[148:151], a[80:83], v[52:55], v[148:151]
 s_add_u32 m0, s28, 65536
 ds_read_b128 a[120:123], v7 offset:14336
 ds_read_b128 a[124:127], v7 offset:15360
M v[148:151], a[84:87], v[48:51], v[148:151]
 buffer_load_dwordx4 v3, s[8:11], s38 offen offset:0 sc1 lds
M v[156:159], a[92:95], v[48:51], v[156:159]
 ds_read_b128 a[128:131], v7 offset:16384
 ds_read_b128 a[132:135], v7 offset:17408
 v_cvt_pk_bf16_f32 v145, v146, v147
M v[156:159], a[88:91], v[52:55], v[156:159]
 s_waitcnt lgkmcnt(2)
 ds_read_b128 a[136:139], v7 offset:18432
 v_cvt_pk_bf16_f32 v146, v152, v153
 v_cvt_pk_bf16_f32 v147, v154, v155
M v[164:167], a[96:99], v[52:55], v[164:167]
 ds_read_b128 a[140:143], v7 offset:19456
 ds_read_b128 a[144:147], v7 offset:20480
 v_cvt_pk_bf16_f32 v160, v160, v161
M v[164:167], a[100:103], v[48:51], v[164:167]
 buffer_load_dwordx4 v3, s[8:11], s38 offen offset:1024 sc1 lds
M v[172:175], a[108:111], v[48:51], v[172:175]
 ds_read_b128 a[148:151], v7 offset:21504
 ds_read_b128 a[152:155], v7 offset:22528
 v_cvt_pk_bf16_f32 v161, v162, v163
M v[172:175], a[104:107], v[52:55], v[172:175]
 ds_read_b128 a[156:159], v7 offset:23552
 v_cvt_pk_bf16_f32 v162, v168, v169
 v_cvt_pk_bf16_f32 v163, v170, v171
M v[180:183], a[112:115], v[52:55], v[180:183]
 ds_read_b128 a[160:163], v7 offset:24576
 ds_read_b128 a[164:167], v7 offset:25600
 v_cvt_pk_bf16_f32 v176, v176, v177
M v[180:183], a[116:119], v[48:51], v[180:183]
 buffer_load_dwordx4 v3, s[8:11], s38 offen offset:2048 sc1 lds
M v[188:191], a[124:127], v[48:51], v[188:191]
 ds_read_b128 a[168:171], v7 offset:26624
 ds_read_b128 a[172:175], v7 offset:27648
 v_cvt_pk_bf16_f32 v177, v178, v179
M v[188:191], a[120:123], v[52:55], v[188:191]
 s_waitcnt lgkmcnt(4)
 ds_read_b128 a[176:179], v7 offset:28672
 v_cvt_pk_bf16_f32 v178, v184, v185
M v[196:199], a[128:131], v[52:55], v[196:199]
 ds_read_b128 a[180:183], v7 offset:29696
 ds_read_b128 a[184:187], v7 offset:30720
 v_cvt_pk_bf16_f32 v179, v186, v187
M v[196:199], a[132:135], v[48:51], v[196:199]
 ds_read_b128 a[188:191], v7 offset:31744
 v_cvt_pk_bf16_f32 v192, v192, v193
 v_cvt_pk_bf16_f32 v193, v194, v195
M v[204:207], a[140:143], v[48:51], v[204:207]
 buffer_load_dwordx4 v3, s[8:11], s38 offen offset:3072 sc1 lds
M v[204:207], a[136:139], v[52:55], v[204:207]
 s_add_u32 m0, s28, 69632
 v_cvt_pk_bf16_f32 v194, v200, v201
 v_cvt_pk_bf16_f32 v195, v202, v203
 v_cvt_pk_bf16_f32 v208, v208, v209
M v[212:215], a[144:147], v[52:55], v[212:215]
 buffer_load_dwordx4 v4, s[8:11], s38 offen offset:0 sc1 lds
M v[212:215], a[148:151], v[48:51], v[212:215]
 s_waitcnt lgkmcnt(0)
 v_cvt_pk_bf16_f32 v209, v210, v211
 v_cvt_pk_bf16_f32 v210, v216, v217
 v_cvt_pk_bf16_f32 v211, v218, v219
M v[220:223], a[156:159], v[48:51], v[220:223]
 s_barrier
M v[220:223], a[152:155], v[52:55], v[220:223]
 ds_read_b128 a[64:67], v2 offset:32768
 ds_read_b128 a[68:71], v2 offset:33792
 v_cvt_pk_bf16_f32 v224, v224, v225
M v[228:231], a[160:163], v[52:55], v[228:231]
 ds_read_b128 a[72:75], v2 offset:34816
 v_cvt_pk_bf16_f32 v225, v226, v227
 v_cvt_pk_bf16_f32 v226, v232, v233
M v[228:231], a[164:167], v[48:51], v[228:231]
 ds_read_b128 a[76:79], v2 offset:35840
 ds_read_b128 a[80:83], v2 offset:36864
M v[236:239], a[172:175], v[48:51], v[236:239]
 ds_read_b128 a[84:87], v2 offset:37888
 v_cvt_pk_bf16_f32 v227, v234, v235
 v_cvt_pk_bf16_f32 v240, v240, v241
M v[236:239], a[168:171], v[52:55], v[236:239]
 ds_read_b128 a[88:91], v2 offset:38912
 ds_read_b128 a[92:95], v2 offset:39936
 v_cvt_pk_bf16_f32 v241, v242, v243
M v[244:247], a[176:179], v[52:55], v[244:247]
 buffer_load_dwordx4 v4, s[8:11], s38 offen offset:1024 sc1 lds
M v[244:247], a[180:183], v[48:51], v[244:247]
 buffer_load_dwordx4 v4, s[8:11], s38 offen offset:2048 sc1 lds
M v[252:255], a[188:191], v[48:51], v[252:255]
 buffer_load_dwordx4 v4, s[8:11], s38 offen offset:3072 sc1 lds
M v[252:255], a[184:187], v[52:55], v[252:255]
 s_waitcnt lgkmcnt(0)
 s_add_u32 s38, s38, 32768
 v_cvt_pk_bf16_f32 v242, v248, v249
 v_cvt_pk_bf16_f32 v243, v250, v251
L_op1:
M v[64:67], a[64:67], v[128:131], 0
 ds_read_b128 a[96:99], v2 offset:40960
 ds_read_b128 a[100:103], v2 offset:41984
M v[64:67], a[68:71], v[144:147], v[64:67]
 ds_read_b128 a[104:107], v2 offset:43008
 v_cvt_pk_bf16_f32 v132, v132, v133
 v_cvt_pk_bf16_f32 v133, v134, v135
M v[64:67], a[72:75], v[160:163], v[64:67]
 ds_read_b128 a[108:111], v2 offset:44032
 ds_read_b128 a[112:115], v2 offset:45056
M v[64:67], a[76:79], v[176:179], v[64:67]
 ds_read_b128 a[116:119], v2 offset:46080
 v_cvt_pk_bf16_f32 v134, v140, v141
 v_cvt_pk_bf16_f32 v135, v142, v143
M v[64:67], a[80:83], v[192:195], v[64:67]
 s_add_u32 m0, s28, 0
 ds_read_b128 a[120:123], v2 offset:47104
 ds_read_b128 a[124:127], v2 offset:48128
M v[64:67], a[84:87], v[208:211], v[64:67]
 buffer_load_dwordx4 v3, s[8:11], s38 offen offset:0 sc1 lds
M v[64:67], a[88:91], v[224:227], v[64:67]
 ds_read_b128 a[128:131], v2 offset:49152
 ds_read_b128 a[132:135], v2 offset:50176
 v_cvt_pk_bf16_f32 v148, v148, v149
M v[64:67], a[92:95], v[240:243], v[64:67]
 s_waitcnt lgkmcnt(2)
 ds_read_b128 a[136:139], v2 offset:51200
 v_cvt_pk_bf16_f32 v149, v150, v151
M v[72:75], a[96:99], v[128:131], 0
 ds_read_b128 a[140:143], v2 offset:52224
 ds_read_b128 a[144:147], v2 offset:53248
M v[72:75], a[100:103], v[144:147], v[72:75]
 buffer_load_dwordx4 v3, s[8:11], s38 offen offset:1024 sc1 lds
M v[72:75], a[104:107], v[160:163], v[72:75]
 ds_read_b128 a[148:151], v2 offset:54272
 ds_read_b128 a[152:155], v2 offset:55296
 v_cvt_pk_bf16_f32 v150, v156, v157
M v[72:75], a[108:111], v[176:179], v[72:75]
 ds_read_b128 a[156:159], v2 offset:56320
 v_cvt_pk_bf16_f32 v151, v158, v159
M v[72:75], a[112:115], v[192:195], v[72:75]
 ds_read_b128 a[160:163], v2 offset:57344
 ds_read_b128 a[164:167], v2 offset:58368
 v_cvt_pk_bf16_f32 v164, v164, v165
M v[72:75], a[116:119], v[208:211], v[72:75]
 buffer_load_dwordx4 v3, s[8:11], s38 offen offset:2048 sc1 lds
M v[72:75], a[120:123], v[224:227], v[72:75]
 ds_read_b128 a[168:171], v2 offset:59392
 ds_read_b128 a[172:175], v2 offset:60416
M v[72:75], a[124:127], v[240:243], v[72:75]
 s_waitcnt lgkmcnt(4)
 ds_read_b128 a[176:179], v2 offset:61440
 v_cvt_pk_bf16_f32 v165, v166, v167
 v_cvt_pk_bf16_f32 v166, v172, v173
M v[80:83], a[128:131], v[128:131], 0
 ds_read_b128 a[180:183], v2 offset:62464
 ds_read_b128 a[184:187], v2 offset:63488
M v[80:83], a[132:135], v[144:147], v[80:83]
 ds_read_b128 a[188:191], v2 offset:64512
 v_cvt_pk_bf16_f32 v167, v174, v175
 v_cvt_pk_bf16_f32 v180, v180, v181
M v[80:83], a[136:139], v[160:163], v[80:83]
 buffer_load_dwordx4 v3, s[8:11], s38 offen offset:3072 sc1 lds
M v[80:83], a[140:143], v[176:179], v[80:83]
 s_add_u32 m0, s28, 4096
 v_cvt_pk_bf16_f32 v181, v182, v183
 v_cvt_pk_bf16_f32 v182, v188, v189
M v[80:83], a[144:147], v[192:195], v[80:83]
 buffer_load_dwordx4 v4, s[8:11], s38 offen offset:0 sc1 lds
M v[80:83], a[148:151], v[208:211], v[80:83]
 v_cvt_pk_bf16_f32 v183, v190, v191
 v_cvt_pk_bf16_f32 v196, v196, v197
M v[80:83], a[152:155], v[224:227], v[80:83]
 buffer_load_dwordx4 v4, s[8:11], s38 offen offset:1024 sc1 lds
M v[80:83], a[156:159], v[240:243], v[80:83]
 s_waitcnt lgkmcnt(0)
 v_cvt_pk_bf16_f32 v197, v198, v199
 v_cvt_pk_bf16_f32 v198, v204, v205
 v_cvt_pk_bf16_f32 v199, v206, v207
M v[88:91], a[160:163], v[128:131], 0
 v_cvt_pk_bf16_f32 v212, v212, v213
 v_cvt_pk_bf16_f32 v213, v214, v215
M v[88:91], a[164:167], v[144:147], v[88:91]
 v_cvt_pk_bf16_f32 v214, v220, v221
 v_cvt_pk_bf16_f32 v215, v222, v223
 v_cvt_pk_bf16_f32 v228, v228, v229
M v[88:91], a[168:171], v[160:163], v[88:91]
 buffer_load_dwordx4 v4, s[8:11], s38 offen offset:2048 sc1 lds
M v[88:91], a[172:175], v[176:179], v[88:91]
 v_cvt_pk_bf16_f32 v229, v230, v231
 v_cvt_pk_bf16_f32 v230, v236, v237
M v[88:91], a[176:179], v[192:195], v[88:91]
 v_cvt_pk_bf16_f32 v231, v238, v239
 v_cvt_pk_bf16_f32 v244, v244, v245
 v_cvt_pk_bf16_f32 v245, v246, v247
M v[88:91], a[180:183], v[208:211], v[88:91]
 buffer_load_dwordx4 v4, s[8:11], s38 offen offset:3072 sc1 lds
M v[88:91], a[184:187], v[224:227], v[88:91]
 v_cvt_pk_bf16_f32 v246, v252, v253
 v_cvt_pk_bf16_f32 v247, v254, v255
M v[88:91], a[188:191], v[240:243], v[88:91]
 s_add_u32 s38, s38, 32768
 v_add_f32 v31, v29, v31
 v_mov_b32 v10, v30
M v[68:71], a[64:67], v[132:135], 0
 s_add_u32 m0, s28, 131072
 v_mov_b32 v11, v31
 v_permlane16_swap_b32 v10, v30
M v[68:71], a[68:71], v[148:151], v[68:71]
 buffer_load_dwordx4 v3, s[8:11], s38 offen offset:0 sc1 lds
M v[68:71], a[72:75], v[164:167], v[68:71]
 v_permlane16_swap_b32 v11, v31
 v_add_f32 v30, v10, v30
M v[68:71], a[76:79], v[180:183], v[68:71]
 v_add_f32 v31, v11, v31
 v_mov_b32 v10, v30
M v[68:71], a[80:83], v[196:199], v[68:71]
 buffer_load_dwordx4 v3, s[8:11], s38 offen offset:1024 sc1 lds
M v[68:71], a[84:87], v[212:215], v[68:71]
 v_mov_b32 v11, v31
 v_permlane32_swap_b32 v10, v30
M v[68:71], a[88:91], v[228:231], v[68:71]
 v_permlane32_swap_b32 v11, v31
 v_add_f32 v30, v10, v30
M v[68:71], a[92:95], v[244:247], v[68:71]
 v_add_f32 v31, v11, v31
M v[76:79], a[96:99], v[132:135], 0
 buffer_load_dwordx4 v3, s[8:11], s38 offen offset:2048 sc1 lds
M v[76:79], a[100:103], v[148:151], v[76:79]
 v_rcp_f32 v5, v30
M v[76:79], a[104:107], v[164:167], v[76:79]
 v_rcp_f32 v6, v31
M v[76:79], a[108:111], v[180:183], v[76:79]
 buffer_load_dwordx4 v3, s[8:11], s38 offen offset:3072 sc1 lds
M v[76:79], a[112:115], v[196:199], v[76:79]
 v_max3_f32 v32, |v64|, |v65|, |v66|
M v[76:79], a[116:119], v[212:215], v[76:79]
 v_max3_f32 v32, |v67|, |v72|, v32
 v_max3_f32 v32, |v73|, |v74|, v32
M v[76:79], a[120:123], v[228:231], v[76:79]
 s_waitcnt vmcnt(20)
 v_mul_f32 v32, 2.0, v32
 v_mov_b32 v33, v32
M v[76:79], a[124:127], v[244:247], v[76:79]
 s_barrier
M v[84:87], a[128:131], v[132:135], 0
 ds_read_b128 a[64:67], v7 offset:32768
 v_mov_b32 v34, v32
M v[84:87], a[132:135], v[148:151], v[84:87]
 s_add_u32 m0, s28, 135168
 ds_read_b128 a[68:71], v7 offset:33792
M v[84:87], a[136:139], v[164:167], v[84:87]
 buffer_load_dwordx4 v4, s[8:11], s38 offen offset:0 sc1 lds
M v[84:87], a[140:143], v[180:183], v[84:87]
 ds_read_b128 a[72:75], v7 offset:34816
 v_mov_b32 v35, v32
M v[84:87], a[144:147], v[196:199], v[84:87]
 ds_read_b128 a[76:79], v7 offset:35840
 v_max3_f32 v36, |v68|, |v69|, |v70|
M v[84:87], a[148:151], v[212:215], v[84:87]
 buffer_load_dwordx4 v4, s[8:11], s38 offen offset:1024 sc1 lds
M v[84:87], a[152:155], v[228:231], v[84:87]
 ds_read_b128 a[80:83], v7 offset:36864
M v[84:87], a[156:159], v[244:247], v[84:87]
 ds_read_b128 a[84:87], v7 offset:37888
 v_max3_f32 v36, |v71|, |v76|, v36
M v[92:95], a[160:163], v[132:135], 0
 buffer_load_dwordx4 v4, s[8:11], s38 offen offset:2048 sc1 lds
M v[92:95], a[164:167], v[148:151], v[92:95]
 ds_read_b128 a[88:91], v7 offset:38912
 v_max3_f32 v36, |v77|, |v78|, v36
M v[92:95], a[168:171], v[164:167], v[92:95]
 ds_read_b128 a[92:95], v7 offset:39936
 v_mul_f32 v36, 2.0, v36
M v[92:95], a[172:175], v[180:183], v[92:95]
 buffer_load_dwordx4 v4, s[8:11], s38 offen offset:3072 sc1 lds
M v[92:95], a[176:179], v[196:199], v[92:95]
 s_add_u32 s38, s38, 32768
 v_mov_b32 v37, v36
M v[92:95], a[180:183], v[212:215], v[92:95]
 v_mov_b32 v38, v36
 v_mov_b32 v39, v36
M v[92:95], a[184:187], v[228:231], v[92:95]
 s_waitcnt lgkmcnt(0)
 s_cmp_eq_u32 s42, 6
M v[92:95], a[188:191], v[244:247], v[92:95]
 s_cbranch_scc1 L_y1
L_y1r:
M v[96:99], a[64:67], v[128:131], v[32:35]
 s_add_u32 m0, s28, 98304
 ds_read_b128 a[96:99], v7 offset:40960
M v[96:99], a[68:71], v[144:147], v[96:99]
 ds_read_b128 a[100:103], v7 offset:41984
M v[96:99], a[72:75], v[160:163], v[96:99]
 buffer_load_dwordx4 v3, s[8:11], s38 offen offset:0 sc1 lds
M v[96:99], a[76:79], v[176:179], v[96:99]
 ds_read_b128 a[104:107], v7 offset:43008
 s_add_u32 s29, s33, 0
M v[96:99], a[80:83], v[192:195], v[96:99]
 ds_read_b128 a[108:111], v7 offset:44032
 s_add_u32 s30, s33, 14336
M v[96:99], a[84:87], v[208:211], v[96:99]
 buffer_load_dwordx4 v3, s[8:11], s38 offen offset:1024 sc1 lds
M v[96:99], a[88:91], v[224:227], v[96:99]
 ds_read_b128 a[112:115], v7 offset:45056
 v_mul_f32 v28, -v32, v5
M v[96:99], a[92:95], v[240:243], v[96:99]
 ds_read_b128 a[116:119], v7 offset:46080
 v_mul_f32 v64, v5, v64
M v[100:103], a[92:95], v[244:247], v[36:39]
 buffer_load_dwordx4 v3, s[8:11], s38 offen offset:2048 sc1 lds
M v[100:103], a[88:91], v[228:231], v[100:103]
 ds_read_b128 a[120:123], v7 offset:47104
 v_mul_f32 v65, v5, v65
M v[100:103], a[84:87], v[212:215], v[100:103]
 ds_read_b128 a[124:127], v7 offset:48128
 v_mul_f32 v66, v5, v66
M v[100:103], a[80:83], v[196:199], v[100:103]
 buffer_load_dwordx4 v3, s[8:11], s38 offen offset:3072 sc1 lds
M v[100:103], a[76:79], v[180:183], v[100:103]
 s_add_u32 m0, s28, 102400
 v_mul_f32 v67, v5, v67
 v_mul_f32 v72, v5, v72
M v[100:103], a[72:75], v[164:167], v[100:103]
 buffer_load_dwordx4 v4, s[8:11], s38 offen offset:0 sc1 lds
M v[100:103], a[68:71], v[148:151], v[100:103]
 v_mul_f32 v73, v5, v73
 v_mul_f32 v74, v5, v74
M v[100:103], a[64:67], v[132:135], v[100:103]
 s_waitcnt lgkmcnt(0)
 v_mul_f32 v75, v5, v75
 v_cvt_pk_bf16_f32 v64, v64, v65
M v[108:111], a[96:99], v[132:135], v[36:39]
 ds_read_b128 a[64:67], v7 offset:49152
 v_cvt_pk_bf16_f32 v65, v66, v67
M v[108:111], a[100:103], v[148:151], v[108:111]
 ds_read_b128 a[68:71], v7 offset:50176
 v_cvt_pk_bf16_f32 v66, v72, v73
M v[108:111], a[104:107], v[164:167], v[108:111]
 buffer_load_dwordx4 v4, s[8:11], s38 offen offset:1024 sc1 lds
M v[108:111], a[108:111], v[180:183], v[108:111]
 ds_read_b128 a[72:75], v7 offset:51200
 v_cvt_pk_bf16_f32 v67, v74, v75
M v[108:111], a[112:115], v[196:199], v[108:111]
 ds_read_b128 a[76:79], v7 offset:52224
M v[108:111], a[116:119], v[212:215], v[108:111]
 buffer_load_dwordx4 v4, s[8:11], s38 offen offset:2048 sc1 lds
M v[108:111], a[120:123], v[228:231], v[108:111]
 ds_read_b128 a[80:83], v7 offset:53248
M v[108:111], a[124:127], v[244:247], v[108:111]
 ds_read_b128 a[84:87], v7 offset:54272
M v[104:107], a[124:127], v[240:243], v[32:35]
 buffer_load_dwordx4 v4, s[8:11], s38 offen offset:3072 sc1 lds
M v[104:107], a[120:123], v[224:227], v[104:107]
 s_add_u32 s38, s38, 32768
 ds_read_b128 a[88:91], v7 offset:55296
M v[104:107], a[116:119], v[208:211], v[104:107]
 ds_read_b128 a[92:95], v7 offset:56320
M v[104:107], a[112:115], v[192:195], v[104:107]
 buffer_store_dwordx4 v[64:67], v7, s[8:11], s29 offen offset:0 sc1
M v[104:107], a[108:111], v[176:179], v[104:107]
 v_mul_f32 v29, -v36, v6
 v_mul_f32 v68, v6, v68
M v[104:107], a[104:107], v[160:163], v[104:107]
 v_mul_f32 v69, v6, v69
 v_mul_f32 v70, v6, v70
M v[104:107], a[100:103], v[144:147], v[104:107]
 v_mul_f32 v71, v6, v71
 v_mul_f32 v76, v6, v76
M v[104:107], a[96:99], v[128:131], v[104:107]
 s_waitcnt lgkmcnt(0)
 v_mul_f32 v77, v6, v77
 v_mul_f32 v78, v6, v78
M v[112:115], a[64:67], v[128:131], v[32:35]
 ds_read_b128 a[96:99], v7 offset:57344
 v_mul_f32 v79, v6, v79
M v[112:115], a[68:71], v[144:147], v[112:115]
 ds_read_b128 a[100:103], v7 offset:58368
 v_cvt_pk_bf16_f32 v68, v68, v69
M v[112:115], a[72:75], v[160:163], v[112:115]
 v_cvt_pk_bf16_f32 v69, v70, v71
 v_cvt_pk_bf16_f32 v70, v76, v77
M v[112:115], a[76:79], v[176:179], v[112:115]
 ds_read_b128 a[104:107], v7 offset:59392
 v_cvt_pk_bf16_f32 v71, v78, v79
M v[112:115], a[80:83], v[192:195], v[112:115]
 ds_read_b128 a[108:111], v7 offset:60416
M v[112:115], a[84:87], v[208:211], v[112:115]
 buffer_store_dwordx4 v[68:71], v7, s[8:11], s30 offen offset:0 sc1
M v[112:115], a[88:91], v[224:227], v[112:115]
 ds_read_b128 a[112:115], v7 offset:61440
 v_mul_f32 v80, v5, v80
M v[112:115], a[92:95], v[240:243], v[112:115]
 ds_read_b128 a[116:119], v7 offset:62464
 v_mul_f32 v81, v5, v81
M v[116:119], a[92:95], v[244:247], v[36:39]
 v_mul_f32 v82, v5, v82
 v_mul_f32 v83, v5, v83
M v[116:119], a[88:91], v[228:231], v[116:119]
 ds_read_b128 a[120:123], v7 offset:63488
 v_mul_f32 v88, v5, v88
M v[116:119], a[84:87], v[212:215], v[116:119]
 ds_read_b128 a[124:127], v7 offset:64512
 v_mul_f32 v89, v5, v89
M v[116:119], a[80:83], v[196:199], v[116:119]
 v_mul_f32 v90, v5, v90
 v_mul_f32 v91, v5, v91
M v[116:119], a[76:79], v[180:183], v[116:119]
 v_cvt_pk_bf16_f32 v80, v80, v81
 v_cvt_pk_bf16_f32 v81, v82, v83
M v[116:119], a[72:75], v[164:167], v[116:119]
 v_cvt_pk_bf16_f32 v82, v88, v89
 v_cvt_pk_bf16_f32 v83, v90, v91
M v[116:119], a[68:71], v[148:151], v[116:119]
 s_waitcnt vmcnt(26) lgkmcnt(0)
M v[116:119], a[64:67], v[132:135], v[116:119]
 s_barrier
M v[124:127], a[96:99], v[132:135], v[36:39]
 ds_read_b128 a[64:67], v2 offset:0
M v[124:127], a[100:103], v[148:151], v[124:127]
 ds_read_b128 a[68:71], v2 offset:1024
M v[124:127], a[104:107], v[164:167], v[124:127]
 buffer_store_dwordx4 v[80:83], v7, s[8:11], s29 offen offset:1024 sc1
M v[124:127], a[108:111], v[180:183], v[124:127]
 ds_read_b128 a[72:75], v2 offset:2048
 v_mul_f32 v84, v6, v84
M v[124:127], a[112:115], v[196:199], v[124:127]
 ds_read_b128 a[76:79], v2 offset:3072
 v_mul_f32 v85, v6, v85
M v[124:127], a[116:119], v[212:215], v[124:127]
 v_mul_f32 v86, v6, v86
 v_mul_f32 v87, v6, v87
M v[124:127], a[120:123], v[228:231], v[124:127]
 ds_read_b128 a[80:83], v2 offset:4096
 v_mul_f32 v92, v6, v92
M v[124:127], a[124:127], v[244:247], v[124:127]
 ds_read_b128 a[84:87], v2 offset:5120
 v_mul_f32 v93, v6, v93
M v[120:123], a[124:127], v[240:243], v[32:35]
 v_mul_f32 v94, v6, v94
 v_mul_f32 v95, v6, v95
M v[120:123], a[120:123], v[224:227], v[120:123]
 ds_read_b128 a[88:91], v2 offset:6144
 v_cvt_pk_bf16_f32 v84, v84, v85
M v[120:123], a[116:119], v[208:211], v[120:123]
 ds_read_b128 a[92:95], v2 offset:7168
 v_cvt_pk_bf16_f32 v85, v86, v87
M v[120:123], a[112:115], v[192:195], v[120:123]
 v_cvt_pk_bf16_f32 v86, v92, v93
 v_cvt_pk_bf16_f32 v87, v94, v95
M v[120:123], a[108:111], v[176:179], v[120:123]
 buffer_store_dwordx4 v[84:87], v7, s[8:11], s30 offen offset:1024 sc1
M v[120:123], a[104:107], v[160:163], v[120:123]
M v[120:123], a[100:103], v[144:147], v[120:123]
 s_waitcnt lgkmcnt(0)
M v[120:123], a[96:99], v[128:131], v[120:123]
M v[64:67], a[64:67], v[128:131], v[32:35]
 s_add_u32 m0, s28, 32768
 ds_read_b128 a[96:99], v2 offset:8192
M v[64:67], a[68:71], v[144:147], v[64:67]
 ds_read_b128 a[100:103], v2 offset:9216
 s_mov_b32 s79, 104923136
M v[64:67], a[72:75], v[160:163], v[64:67]
 buffer_load_dwordx4 v3, s[8:11], s38 offen offset:0 sc1 lds
M v[64:67], a[76:79], v[176:179], v[64:67]
 ds_read_b128 a[104:107], v2 offset:10240
 s_add_u32 s29, s33, 2048
M v[64:67], a[80:83], v[192:195], v[64:67]
 ds_read_b128 a[108:111], v2 offset:11264
 s_add_u32 s30, s33, 16384
M v[64:67], a[84:87], v[208:211], v[64:67]
 buffer_load_dwordx4 v3, s[8:11], s38 offen offset:1024 sc1 lds
M v[64:67], a[88:91], v[224:227], v[64:67]
 ds_read_b128 a[112:115], v2 offset:12288
 v_fma_f32 v96, v96, v5, v28
M v[64:67], a[92:95], v[240:243], v[64:67]
 ds_read_b128 a[116:119], v2 offset:13312
 v_fma_f32 v97, v97, v5, v28
M v[68:71], a[92:95], v[244:247], v[36:39]
 buffer_load_dwordx4 v3, s[8:11], s38 offen offset:2048 sc1 lds
M v[68:71], a[88:91], v[228:231], v[68:71]
 ds_read_b128 a[120:123], v2 offset:14336
 v_fma_f32 v98, v98, v5, v28
M v[68:71], a[84:87], v[212:215], v[68:71]
 ds_read_b128 a[124:127], v2 offset:15360
 v_fma_f32 v99, v99, v5, v28
M v[68:71], a[80:83], v[196:199], v[68:71]
 buffer_load_dwordx4 v3, s[8:11], s38 offen offset:3072 sc1 lds
M v[68:71], a[76:79], v[180:183], v[68:71]
 s_add_u32 m0, s28, 36864
 v_fma_f32 v104, v104, v5, v28
 v_fma_f32 v105, v105, v5, v28
M v[68:71], a[72:75], v[164:167], v[68:71]
 buffer_load_dwordx4 v4, s[8:11], s38 offen offset:0 sc1 lds
M v[68:71], a[68:71], v[148:151], v[68:71]
 buffer_load_dword v24, off, s[8:11], s79 sc1
M v[68:71], a[64:67], v[132:135], v[68:71]
 s_waitcnt lgkmcnt(0)
 v_lshrrev_b32 v0, 4, v7
 v_and_b32 v14, 15, v0
M v[76:79], a[96:99], v[132:135], v[36:39]
 ds_read_b128 a[64:67], v2 offset:16384
 v_lshlrev_b32 v14, 2, v14
M v[76:79], a[100:103], v[148:151], v[76:79]
 ds_read_b128 a[68:71], v2 offset:17408
 v_lshrrev_b32 v11, 4, v0
M v[76:79], a[104:107], v[164:167], v[76:79]
 buffer_load_dwordx4 v4, s[8:11], s38 offen offset:1024 sc1 lds
M v[76:79], a[108:111], v[180:183], v[76:79]
 ds_read_b128 a[72:75], v2 offset:18432
 s_mov_b32 s52, s96
M v[76:79], a[112:115], v[196:199], v[76:79]
 s_and_b32 s53, s97, 0xffff
 ds_read_b128 a[76:79], v2 offset:19456
 s_mov_b32 s54, 1835008
M v[76:79], a[116:119], v[212:215], v[76:79]
 buffer_load_dwordx4 v4, s[8:11], s38 offen offset:2048 sc1 lds
M v[76:79], a[120:123], v[228:231], v[76:79]
 ds_read_b128 a[80:83], v2 offset:20480
 s_mov_b32 s55, 0x20000
M v[76:79], a[124:127], v[244:247], v[76:79]
 s_lshr_b32 s74, s41, 3
 ds_read_b128 a[84:87], v2 offset:21504
 s_xor_b32 s74, s74, 0
M v[72:75], a[124:127], v[240:243], v[32:35]
 buffer_load_dwordx4 v4, s[8:11], s38 offen offset:3072 sc1 lds
M v[72:75], a[120:123], v[224:227], v[72:75]
 s_add_u32 s38, s38, 32768
 ds_read_b128 a[88:91], v2 offset:22528
 s_mul_i32 s67, s74, -2
M v[72:75], a[116:119], v[208:211], v[72:75]
 s_mul_i32 s74, s74, 8
 ds_read_b128 a[92:95], v2 offset:23552
 v_fma_f32 v106, v106, v5, v28
M v[72:75], a[112:115], v[192:195], v[72:75]
 s_add_u32 s74, s74, s20
 v_fma_f32 v107, v107, v5, v28
 v_cvt_pk_bf16_f32 v96, v96, v97
M v[72:75], a[108:111], v[176:179], v[72:75]
 s_lshl_b32 s75, s74, 6
 v_cvt_pk_bf16_f32 v97, v98, v99
 v_cvt_pk_bf16_f32 v98, v104, v105
M v[72:75], a[104:107], v[160:163], v[72:75]
 s_add_u32 s76, s75, 256
 v_cvt_pk_bf16_f32 v99, v106, v107
M v[72:75], a[100:103], v[144:147], v[72:75]
 s_add_u32 s67, s67, 3
 v_add_u32 v43, 0x20000, v7
 s_sub_u32 s67, s67, s20
M v[72:75], a[96:99], v[128:131], v[72:75]
 s_waitcnt lgkmcnt(0)
 s_and_b32 s67, s67, 536870912
M v[80:83], a[64:67], v[128:131], v[32:35]
 s_or_b32 s76, s76, s67
 ds_read_b128 a[96:99], v2 offset:24576
 v_or_b32 v27, s67, v7
M v[80:83], a[68:71], v[144:147], v[80:83]
 ds_read_b128 a[100:103], v2 offset:25600
 v_add_u32 v27, 4096, v27
M v[80:83], a[72:75], v[160:163], v[80:83]
 buffer_store_dwordx4 v[96:99], v7, s[8:11], s29 offen offset:0 sc1
M v[80:83], a[76:79], v[176:179], v[80:83]
 ds_read_b128 a[104:107], v2 offset:26624
 v_fma_f32 v100, v100, v6, v29
M v[80:83], a[80:83], v[192:195], v[80:83]
 ds_read_b128 a[108:111], v2 offset:27648
 v_fma_f32 v101, v101, v6, v29
M v[80:83], a[84:87], v[208:211], v[80:83]
 v_fma_f32 v102, v102, v6, v29
 v_fma_f32 v103, v103, v6, v29
M v[80:83], a[88:91], v[224:227], v[80:83]
 ds_read_b128 a[112:115], v2 offset:28672
 v_fma_f32 v108, v108, v6, v29
M v[80:83], a[92:95], v[240:243], v[80:83]
 ds_read_b128 a[116:119], v2 offset:29696
 v_fma_f32 v109, v109, v6, v29
M v[84:87], a[92:95], v[244:247], v[36:39]
 v_fma_f32 v110, v110, v6, v29
 v_fma_f32 v111, v111, v6, v29
M v[84:87], a[88:91], v[228:231], v[84:87]
 ds_read_b128 a[120:123], v2 offset:30720
 v_cvt_pk_bf16_f32 v100, v100, v101
M v[84:87], a[84:87], v[212:215], v[84:87]
 ds_read_b128 a[124:127], v2 offset:31744
 v_cvt_pk_bf16_f32 v101, v102, v103
M v[84:87], a[80:83], v[196:199], v[84:87]
 v_cvt_pk_bf16_f32 v102, v108, v109
 v_cvt_pk_bf16_f32 v103, v110, v111
M v[84:87], a[76:79], v[180:183], v[84:87]
 buffer_store_dwordx4 v[100:103], v7, s[8:11], s30 offen offset:0 sc1
M v[84:87], a[72:75], v[164:167], v[84:87]
 v_fma_f32 v112, v112, v5, v28
 v_fma_f32 v113, v113, v5, v28
M v[84:87], a[68:71], v[148:151], v[84:87]
 s_waitcnt vmcnt(31) lgkmcnt(0)
 v_fma_f32 v114, v114, v5, v28
 v_fma_f32 v115, v115, v5, v28
M v[84:87], a[64:67], v[132:135], v[84:87]
 s_barrier
M v[92:95], a[96:99], v[132:135], v[36:39]
 ds_read_b128 a[64:67], v7 offset:0
 v_fma_f32 v120, v120, v5, v28
M v[92:95], a[100:103], v[148:151], v[92:95]
 ds_read_b128 a[68:71], v7 offset:1024
 v_fma_f32 v121, v121, v5, v28
M v[92:95], a[104:107], v[164:167], v[92:95]
 v_fma_f32 v122, v122, v5, v28
 v_fma_f32 v123, v123, v5, v28
M v[92:95], a[108:111], v[180:183], v[92:95]
 ds_read_b128 a[72:75], v7 offset:2048
 v_cvt_pk_bf16_f32 v112, v112, v113
M v[92:95], a[112:115], v[196:199], v[92:95]
 ds_read_b128 a[76:79], v7 offset:3072
 v_cvt_pk_bf16_f32 v113, v114, v115
M v[92:95], a[116:119], v[212:215], v[92:95]
 v_cvt_pk_bf16_f32 v114, v120, v121
 v_cvt_pk_bf16_f32 v115, v122, v123
M v[92:95], a[120:123], v[228:231], v[92:95]
 ds_read_b128 a[80:83], v7 offset:4096
M v[92:95], a[124:127], v[244:247], v[92:95]
 ds_read_b128 a[84:87], v7 offset:5120
M v[88:91], a[124:127], v[240:243], v[32:35]
 buffer_store_dwordx4 v[112:115], v7, s[8:11], s29 offen offset:1024 sc1
M v[88:91], a[120:123], v[224:227], v[88:91]
 ds_read_b128 a[88:91], v7 offset:6144
 v_fma_f32 v116, v116, v6, v29
M v[88:91], a[116:119], v[208:211], v[88:91]
 ds_read_b128 a[92:95], v7 offset:7168
 v_fma_f32 v117, v117, v6, v29
M v[88:91], a[112:115], v[192:195], v[88:91]
 v_fma_f32 v118, v118, v6, v29
 v_fma_f32 v119, v119, v6, v29
M v[88:91], a[108:111], v[176:179], v[88:91]
 v_fma_f32 v124, v124, v6, v29
 v_fma_f32 v125, v125, v6, v29
M v[88:91], a[104:107], v[160:163], v[88:91]
 v_fma_f32 v126, v126, v6, v29
 v_fma_f32 v127, v127, v6, v29
M v[88:91], a[100:103], v[144:147], v[88:91]
 s_waitcnt lgkmcnt(0)
 v_cvt_pk_bf16_f32 v116, v116, v117
 v_cvt_pk_bf16_f32 v117, v118, v119
M v[88:91], a[96:99], v[128:131], v[88:91]
 v_cvt_pk_bf16_f32 v118, v124, v125
 v_cvt_pk_bf16_f32 v119, v126, v127
 buffer_store_dwordx4 v[116:119], v7, s[8:11], s30 offen offset:1024 sc1
M v[96:99], a[64:67], v[128:131], v[32:35]
 ds_read_b128 a[96:99], v7 offset:8192
M v[96:99], a[68:71], v[144:147], v[96:99]
 ds_read_b128 a[100:103], v7 offset:9216
M v[96:99], a[72:75], v[160:163], v[96:99]
 s_sub_u32 s64, 15, s42
M v[96:99], a[76:79], v[176:179], v[96:99]
 s_min_u32 s64, s64, s42
 ds_read_b128 a[104:107], v7 offset:10240
 s_add_u32 s29, s33, 4096
M v[96:99], a[80:83], v[192:195], v[96:99]
 s_mul_i32 s45, s64, 8704
 ds_read_b128 a[108:111], v7 offset:11264
 s_add_u32 s30, s33, 18432
M v[96:99], a[84:87], v[208:211], v[96:99]
 s_lshl_b32 s64, s20, 6
 v_fma_f32 v64, v64, v5, v28
 v_fma_f32 v65, v65, v5, v28
M v[96:99], a[88:91], v[224:227], v[96:99]
 s_add_u32 s64, s64, s41
 ds_read_b128 a[112:115], v7 offset:12288
 v_fma_f32 v66, v66, v5, v28
M v[96:99], a[92:95], v[240:243], v[96:99]
 s_lshl2_add_u32 s45, s64, s45
 ds_read_b128 a[116:119], v7 offset:13312
 v_fma_f32 v67, v67, v5, v28
M v[100:103], a[92:95], v[244:247], v[36:39]
 s_add_u32 s45, s45, 104992768
 v_fma_f32 v72, v72, v5, v28
M v[100:103], a[88:91], v[228:231], v[100:103]
 s_movk_i32 s65, 1024
 ds_read_b128 a[120:123], v7 offset:14336
 v_fma_f32 v73, v73, v5, v28
M v[100:103], a[84:87], v[212:215], v[100:103]
 s_cmp_lt_u32 s42, 8
 ds_read_b128 a[124:127], v7 offset:15360
 v_fma_f32 v74, v74, v5, v28
M v[100:103], a[80:83], v[196:199], v[100:103]
 s_cselect_b32 s64, 4352, s65
 v_fma_f32 v75, v75, v5, v28
M v[100:103], a[76:79], v[180:183], v[100:103]
 s_cselect_b32 s65, 0, 64
 v_cvt_pk_bf16_f32 v64, v64, v65
M v[100:103], a[72:75], v[164:167], v[100:103]
 s_cselect_b32 s66, 32, 64
 v_cvt_pk_bf16_f32 v65, v66, v67
M v[100:103], a[68:71], v[148:151], v[100:103]
 s_add_u32 s3, s45, s64
 s_add_u32 s45, s45, s65
 v_lshrrev_b32 v42, 5, v7
M v[100:103], a[64:67], v[132:135], v[100:103]
 s_waitcnt lgkmcnt(0)
 v_mul_u32_u24 v42, 4352, v42
 v_and_b32 v41, 16, v7
M v[108:111], a[96:99], v[132:135], v[36:39]
 ds_read_b128 a[64:67], v7 offset:16384
 v_lshl_add_u32 v41, v41, 3, v42
M v[108:111], a[100:103], v[148:151], v[108:111]
 ds_read_b128 a[68:71], v7 offset:17408
 v_mov_b32 v42, 536870912
M v[108:111], a[104:107], v[164:167], v[108:111]
 v_cmp_gt_u32 vcc, s66, v7
 v_mov_b32 v40, 1
M v[108:111], a[108:111], v[180:183], v[108:111]
 s_nop 0
 ds_read_b128 a[72:75], v7 offset:18432
 v_cndmask_b32 v41, v42, v41, vcc
M v[108:111], a[112:115], v[196:199], v[108:111]
 ds_read_b128 a[76:79], v7 offset:19456
 v_cvt_pk_bf16_f32 v66, v72, v73
M v[108:111], a[116:119], v[212:215], v[108:111]
 v_cvt_pk_bf16_f32 v67, v74, v75
M v[108:111], a[120:123], v[228:231], v[108:111]
 ds_read_b128 a[80:83], v7 offset:20480
M v[108:111], a[124:127], v[244:247], v[108:111]
 ds_read_b128 a[84:87], v7 offset:21504
M v[104:107], a[124:127], v[240:243], v[32:35]
 buffer_store_dwordx4 v[64:67], v7, s[8:11], s29 offen offset:0 sc1
M v[104:107], a[120:123], v[224:227], v[104:107]
 ds_read_b128 a[88:91], v7 offset:22528
 v_fma_f32 v68, v68, v6, v29
M v[104:107], a[116:119], v[208:211], v[104:107]
 ds_read_b128 a[92:95], v7 offset:23552
 v_fma_f32 v69, v69, v6, v29
M v[104:107], a[112:115], v[192:195], v[104:107]
 v_fma_f32 v70, v70, v6, v29
 v_fma_f32 v71, v71, v6, v29
M v[104:107], a[108:111], v[176:179], v[104:107]
 v_fma_f32 v76, v76, v6, v29
 v_fma_f32 v77, v77, v6, v29
M v[104:107], a[104:107], v[160:163], v[104:107]
 v_fma_f32 v78, v78, v6, v29
 v_fma_f32 v79, v79, v6, v29
M v[104:107], a[100:103], v[144:147], v[104:107]
 v_cvt_pk_bf16_f32 v68, v68, v69
 v_cvt_pk_bf16_f32 v69, v70, v71
M v[104:107], a[96:99], v[128:131], v[104:107]
 s_waitcnt lgkmcnt(0)
 v_cvt_pk_bf16_f32 v70, v76, v77
 v_cvt_pk_bf16_f32 v71, v78, v79
M v[112:115], a[64:67], v[128:131], v[32:35]
 ds_read_b128 a[96:99], v7 offset:24576
M v[112:115], a[68:71], v[144:147], v[112:115]
 ds_read_b128 a[100:103], v7 offset:25600
M v[112:115], a[72:75], v[160:163], v[112:115]
 buffer_store_dwordx4 v[68:71], v7, s[8:11], s30 offen offset:0 sc1
M v[112:115], a[76:79], v[176:179], v[112:115]
 ds_read_b128 a[104:107], v7 offset:26624
 v_fma_f32 v80, v80, v5, v28
M v[112:115], a[80:83], v[192:195], v[112:115]
 ds_read_b128 a[108:111], v7 offset:27648
 v_fma_f32 v81, v81, v5, v28
M v[112:115], a[84:87], v[208:211], v[112:115]
 v_fma_f32 v82, v82, v5, v28
 v_fma_f32 v83, v83, v5, v28
M v[112:115], a[88:91], v[224:227], v[112:115]
 ds_read_b128 a[112:115], v7 offset:28672
 v_fma_f32 v88, v88, v5, v28
M v[112:115], a[92:95], v[240:243], v[112:115]
 ds_read_b128 a[116:119], v7 offset:29696
 v_fma_f32 v89, v89, v5, v28
M v[116:119], a[92:95], v[244:247], v[36:39]
 v_fma_f32 v90, v90, v5, v28
 v_fma_f32 v91, v91, v5, v28
M v[116:119], a[88:91], v[228:231], v[116:119]
 ds_read_b128 a[120:123], v7 offset:30720
 v_cvt_pk_bf16_f32 v80, v80, v81
M v[116:119], a[84:87], v[212:215], v[116:119]
 ds_read_b128 a[124:127], v7 offset:31744
 v_cvt_pk_bf16_f32 v81, v82, v83
M v[116:119], a[80:83], v[196:199], v[116:119]
 v_cvt_pk_bf16_f32 v82, v88, v89
 v_cvt_pk_bf16_f32 v83, v90, v91
M v[116:119], a[76:79], v[180:183], v[116:119]
 buffer_store_dwordx4 v[80:83], v7, s[8:11], s29 offen offset:1024 sc1
M v[116:119], a[72:75], v[164:167], v[116:119]
 v_fma_f32 v84, v84, v6, v29
 v_fma_f32 v85, v85, v6, v29
M v[116:119], a[68:71], v[148:151], v[116:119]
 s_waitcnt vmcnt(28) lgkmcnt(0)
 v_fma_f32 v86, v86, v6, v29
M v[116:119], a[64:67], v[132:135], v[116:119]
 s_barrier
M v[124:127], a[96:99], v[132:135], v[36:39]
 ds_read_b128 a[64:67], v43 offset:0
 v_fma_f32 v87, v87, v6, v29
M v[124:127], a[100:103], v[148:151], v[124:127]
 ds_read_b128 a[68:71], v43 offset:1024
 v_fma_f32 v92, v92, v6, v29
M v[124:127], a[104:107], v[164:167], v[124:127]
 v_fma_f32 v93, v93, v6, v29
 v_fma_f32 v94, v94, v6, v29
M v[124:127], a[108:111], v[180:183], v[124:127]
 ds_read_b128 a[72:75], v43 offset:2048
 v_fma_f32 v95, v95, v6, v29
M v[124:127], a[112:115], v[196:199], v[124:127]
 ds_read_b128 a[76:79], v43 offset:3072
 v_cvt_pk_bf16_f32 v84, v84, v85
M v[124:127], a[116:119], v[212:215], v[124:127]
 v_cvt_pk_bf16_f32 v85, v86, v87
M v[124:127], a[120:123], v[228:231], v[124:127]
 ds_read_b128 a[80:83], v43 offset:4096
 v_cvt_pk_bf16_f32 v86, v92, v93
M v[124:127], a[124:127], v[244:247], v[124:127]
 ds_read_b128 a[84:87], v43 offset:5120
 v_cvt_pk_bf16_f32 v87, v94, v95
M v[120:123], a[124:127], v[240:243], v[32:35]
 buffer_store_dwordx4 v[84:87], v7, s[8:11], s30 offen offset:1024 sc1
M v[120:123], a[120:123], v[224:227], v[120:123]
 ds_read_b128 a[88:91], v43 offset:6144
M v[120:123], a[116:119], v[208:211], v[120:123]
 ds_read_b128 a[92:95], v43 offset:7168
M v[120:123], a[112:115], v[192:195], v[120:123]
M v[120:123], a[108:111], v[176:179], v[120:123]
M v[120:123], a[104:107], v[160:163], v[120:123]
M v[120:123], a[100:103], v[144:147], v[120:123]
 s_waitcnt lgkmcnt(0)
 s_cmp_eq_u32 s42, 6
M v[120:123], a[96:99], v[128:131], v[120:123]
 s_cbranch_scc1 L_y2
L_y2r:
M v[64:67], a[64:67], v[128:131], v[32:35]
 ds_read_b128 a[96:99], v43 offset:8192
M v[64:67], a[68:71], v[144:147], v[64:67]
 ds_read_b128 a[100:103], v43 offset:9216
M v[64:67], a[72:75], v[160:163], v[64:67]
 s_waitcnt vmcnt(11)
 v_cmp_gt_u32 vcc, 1, v24
M v[64:67], a[76:79], v[176:179], v[64:67]
 s_mov_b32 s65, 104890368
 ds_read_b128 a[104:107], v43 offset:10240
 s_add_u32 s29, s33, 6144
M v[64:67], a[80:83], v[192:195], v[64:67]
 s_cbranch_vccnz L_fhs1
L_fhr1:
 ds_read_b128 a[108:111], v43 offset:11264
 s_add_u32 s30, s33, 20480
M v[64:67], a[84:87], v[208:211], v[64:67]
 buffer_load_dword v25, v14, s[8:11], s65 offen sc1
M v[64:67], a[88:91], v[224:227], v[64:67]
 ds_read_b128 a[112:115], v43 offset:12288
 v_fma_f32 v96, v96, v5, v28
M v[64:67], a[92:95], v[240:243], v[64:67]
 ds_read_b128 a[116:119], v43 offset:13312
 v_fma_f32 v97, v97, v5, v28
M v[68:71], a[92:95], v[244:247], v[36:39]
 v_fma_f32 v98, v98, v5, v28
 v_fma_f32 v99, v99, v5, v28
M v[68:71], a[88:91], v[228:231], v[68:71]
 ds_read_b128 a[120:123], v43 offset:14336
 v_fma_f32 v104, v104, v5, v28
M v[68:71], a[84:87], v[212:215], v[68:71]
 ds_read_b128 a[124:127], v43 offset:15360
 v_fma_f32 v105, v105, v5, v28
M v[68:71], a[80:83], v[196:199], v[68:71]
 v_fma_f32 v106, v106, v5, v28
 v_fma_f32 v107, v107, v5, v28
M v[68:71], a[76:79], v[180:183], v[68:71]
 v_cvt_pk_bf16_f32 v96, v96, v97
M v[68:71], a[72:75], v[164:167], v[68:71]
 v_cvt_pk_bf16_f32 v97, v98, v99
M v[68:71], a[68:71], v[148:151], v[68:71]
 v_cvt_pk_bf16_f32 v98, v104, v105
M v[68:71], a[64:67], v[132:135], v[68:71]
 s_waitcnt lgkmcnt(0)
 v_cvt_pk_bf16_f32 v99, v106, v107
M v[76:79], a[96:99], v[132:135], v[36:39]
 ds_read_b128 a[64:67], v43 offset:16384
M v[76:79], a[100:103], v[148:151], v[76:79]
 ds_read_b128 a[68:71], v43 offset:17408
M v[76:79], a[104:107], v[164:167], v[76:79]
 buffer_store_dwordx4 v[96:99], v7, s[8:11], s29 offen offset:0 sc1
M v[76:79], a[108:111], v[180:183], v[76:79]
 ds_read_b128 a[72:75], v43 offset:18432
 v_fma_f32 v100, v100, v6, v29
M v[76:79], a[112:115], v[196:199], v[76:79]
 ds_read_b128 a[76:79], v43 offset:19456
 v_fma_f32 v101, v101, v6, v29
M v[76:79], a[116:119], v[212:215], v[76:79]
 v_fma_f32 v102, v102, v6, v29
 v_fma_f32 v103, v103, v6, v29
M v[76:79], a[120:123], v[228:231], v[76:79]
 ds_read_b128 a[80:83], v43 offset:20480
 v_fma_f32 v108, v108, v6, v29
M v[76:79], a[124:127], v[244:247], v[76:79]
 ds_read_b128 a[84:87], v43 offset:21504
 v_fma_f32 v109, v109, v6, v29
M v[72:75], a[124:127], v[240:243], v[32:35]
 v_fma_f32 v110, v110, v6, v29
 v_fma_f32 v111, v111, v6, v29
M v[72:75], a[120:123], v[224:227], v[72:75]
 ds_read_b128 a[88:91], v43 offset:22528
 v_cvt_pk_bf16_f32 v100, v100, v101
M v[72:75], a[116:119], v[208:211], v[72:75]
 ds_read_b128 a[92:95], v43 offset:23552
 v_cvt_pk_bf16_f32 v101, v102, v103
M v[72:75], a[112:115], v[192:195], v[72:75]
 v_cvt_pk_bf16_f32 v102, v108, v109
M v[72:75], a[108:111], v[176:179], v[72:75]
 v_cvt_pk_bf16_f32 v103, v110, v111
M v[72:75], a[104:107], v[160:163], v[72:75]
 buffer_store_dwordx4 v[100:103], v7, s[8:11], s30 offen offset:0 sc1
M v[72:75], a[100:103], v[144:147], v[72:75]
M v[72:75], a[96:99], v[128:131], v[72:75]
 s_waitcnt lgkmcnt(0)
 v_fma_f32 v112, v112, v5, v28
M v[80:83], a[64:67], v[128:131], v[32:35]
 ds_read_b128 a[96:99], v43 offset:24576
 v_fma_f32 v113, v113, v5, v28
M v[80:83], a[68:71], v[144:147], v[80:83]
 ds_read_b128 a[100:103], v43 offset:25600
 v_fma_f32 v114, v114, v5, v28
M v[80:83], a[72:75], v[160:163], v[80:83]
 v_fma_f32 v115, v115, v5, v28
M v[80:83], a[76:79], v[176:179], v[80:83]
 ds_read_b128 a[104:107], v43 offset:26624
 v_fma_f32 v120, v120, v5, v28
M v[80:83], a[80:83], v[192:195], v[80:83]
 ds_read_b128 a[108:111], v43 offset:27648
 v_fma_f32 v121, v121, v5, v28
M v[80:83], a[84:87], v[208:211], v[80:83]
 v_fma_f32 v122, v122, v5, v28
M v[80:83], a[88:91], v[224:227], v[80:83]
 ds_read_b128 a[112:115], v43 offset:28672
 v_fma_f32 v123, v123, v5, v28
M v[80:83], a[92:95], v[240:243], v[80:83]
 ds_read_b128 a[116:119], v43 offset:29696
 v_cvt_pk_bf16_f32 v112, v112, v113
M v[84:87], a[92:95], v[244:247], v[36:39]
 v_cvt_pk_bf16_f32 v113, v114, v115
 v_cvt_pk_bf16_f32 v114, v120, v121
M v[84:87], a[88:91], v[228:231], v[84:87]
 ds_read_b128 a[120:123], v43 offset:30720
 v_cvt_pk_bf16_f32 v115, v122, v123
M v[84:87], a[84:87], v[212:215], v[84:87]
 ds_read_b128 a[124:127], v43 offset:31744
M v[84:87], a[80:83], v[196:199], v[84:87]
 buffer_store_dwordx4 v[112:115], v7, s[8:11], s29 offen offset:1024 sc1
M v[84:87], a[76:79], v[180:183], v[84:87]
 v_fma_f32 v116, v116, v6, v29
M v[84:87], a[72:75], v[164:167], v[84:87]
 v_fma_f32 v117, v117, v6, v29
M v[84:87], a[68:71], v[148:151], v[84:87]
 s_waitcnt lgkmcnt(0)
 v_fma_f32 v118, v118, v6, v29
M v[84:87], a[64:67], v[132:135], v[84:87]
 s_barrier
M v[92:95], a[96:99], v[132:135], v[36:39]
 ds_read_b128 a[64:67], v2 offset:32768
 v_fma_f32 v119, v119, v6, v29
M v[92:95], a[100:103], v[148:151], v[92:95]
 ds_read_b128 a[68:71], v2 offset:33792
 v_fma_f32 v124, v124, v6, v29
M v[92:95], a[104:107], v[164:167], v[92:95]
 v_fma_f32 v125, v125, v6, v29
 v_fma_f32 v126, v126, v6, v29
M v[92:95], a[108:111], v[180:183], v[92:95]
 ds_read_b128 a[72:75], v2 offset:34816
 v_fma_f32 v127, v127, v6, v29
M v[92:95], a[112:115], v[196:199], v[92:95]
 ds_read_b128 a[76:79], v2 offset:35840
 v_cvt_pk_bf16_f32 v116, v116, v117
M v[92:95], a[116:119], v[212:215], v[92:95]
 v_cvt_pk_bf16_f32 v117, v118, v119
M v[92:95], a[120:123], v[228:231], v[92:95]
 ds_read_b128 a[80:83], v2 offset:36864
 v_cvt_pk_bf16_f32 v118, v124, v125
M v[92:95], a[124:127], v[244:247], v[92:95]
 ds_read_b128 a[84:87], v2 offset:37888
 v_cvt_pk_bf16_f32 v119, v126, v127
M v[88:91], a[124:127], v[240:243], v[32:35]
 buffer_store_dwordx4 v[116:119], v7, s[8:11], s30 offen offset:1024 sc1
M v[88:91], a[120:123], v[224:227], v[88:91]
 ds_read_b128 a[88:91], v2 offset:38912
M v[88:91], a[116:119], v[208:211], v[88:91]
 ds_read_b128 a[92:95], v2 offset:39936
M v[88:91], a[112:115], v[192:195], v[88:91]
M v[88:91], a[108:111], v[176:179], v[88:91]
M v[88:91], a[104:107], v[160:163], v[88:91]
M v[88:91], a[100:103], v[144:147], v[88:91]
 s_waitcnt lgkmcnt(0)
M v[88:91], a[96:99], v[128:131], v[88:91]
M v[96:99], a[64:67], v[128:131], v[32:35]
 ds_read_b128 a[96:99], v2 offset:40960
M v[96:99], a[68:71], v[144:147], v[96:99]
 ds_read_b128 a[100:103], v2 offset:41984
M v[96:99], a[72:75], v[160:163], v[96:99]
M v[96:99], a[76:79], v[176:179], v[96:99]
 ds_read_b128 a[104:107], v2 offset:43008
 s_add_u32 s29, s33, 8192
M v[96:99], a[80:83], v[192:195], v[96:99]
 ds_read_b128 a[108:111], v2 offset:44032
 s_add_u32 s30, s33, 22528
M v[96:99], a[84:87], v[208:211], v[96:99]
 v_fma_f32 v64, v64, v5, v28
 v_fma_f32 v65, v65, v5, v28
M v[96:99], a[88:91], v[224:227], v[96:99]
 ds_read_b128 a[112:115], v2 offset:45056
 v_fma_f32 v66, v66, v5, v28
M v[96:99], a[92:95], v[240:243], v[96:99]
 ds_read_b128 a[116:119], v2 offset:46080
 v_fma_f32 v67, v67, v5, v28
M v[100:103], a[92:95], v[244:247], v[36:39]
 v_fma_f32 v72, v72, v5, v28
M v[100:103], a[88:91], v[228:231], v[100:103]
 ds_read_b128 a[120:123], v2 offset:47104
 v_fma_f32 v73, v73, v5, v28
M v[100:103], a[84:87], v[212:215], v[100:103]
 ds_read_b128 a[124:127], v2 offset:48128
 v_fma_f32 v74, v74, v5, v28
M v[100:103], a[80:83], v[196:199], v[100:103]
 v_fma_f32 v75, v75, v5, v28
M v[100:103], a[76:79], v[180:183], v[100:103]
 v_cvt_pk_bf16_f32 v64, v64, v65
M v[100:103], a[72:75], v[164:167], v[100:103]
 v_cvt_pk_bf16_f32 v65, v66, v67
M v[100:103], a[68:71], v[148:151], v[100:103]
 v_cvt_pk_bf16_f32 v66, v72, v73
M v[100:103], a[64:67], v[132:135], v[100:103]
 s_waitcnt lgkmcnt(0)
 v_cvt_pk_bf16_f32 v67, v74, v75
M v[108:111], a[96:99], v[132:135], v[36:39]
 ds_read_b128 a[64:67], v2 offset:49152
M v[108:111], a[100:103], v[148:151], v[108:111]
 ds_read_b128 a[68:71], v2 offset:50176
M v[108:111], a[104:107], v[164:167], v[108:111]
 buffer_store_dwordx4 v[64:67], v7, s[8:11], s29 offen offset:0 sc1
M v[108:111], a[108:111], v[180:183], v[108:111]
 ds_read_b128 a[72:75], v2 offset:51200
 v_fma_f32 v68, v68, v6, v29
M v[108:111], a[112:115], v[196:199], v[108:111]
 ds_read_b128 a[76:79], v2 offset:52224
 v_fma_f32 v69, v69, v6, v29
M v[108:111], a[116:119], v[212:215], v[108:111]
 v_fma_f32 v70, v70, v6, v29
 v_fma_f32 v71, v71, v6, v29
M v[108:111], a[120:123], v[228:231], v[108:111]
 ds_read_b128 a[80:83], v2 offset:53248
 v_fma_f32 v76, v76, v6, v29
M v[108:111], a[124:127], v[244:247], v[108:111]
 ds_read_b128 a[84:87], v2 offset:54272
 v_fma_f32 v77, v77, v6, v29
M v[104:107], a[124:127], v[240:243], v[32:35]
 v_fma_f32 v78, v78, v6, v29
 v_fma_f32 v79, v79, v6, v29
M v[104:107], a[120:123], v[224:227], v[104:107]
 ds_read_b128 a[88:91], v2 offset:55296
 v_cvt_pk_bf16_f32 v68, v68, v69
M v[104:107], a[116:119], v[208:211], v[104:107]
 ds_read_b128 a[92:95], v2 offset:56320
 v_cvt_pk_bf16_f32 v69, v70, v71
M v[104:107], a[112:115], v[192:195], v[104:107]
 v_cvt_pk_bf16_f32 v70, v76, v77
M v[104:107], a[108:111], v[176:179], v[104:107]
 v_cvt_pk_bf16_f32 v71, v78, v79
M v[104:107], a[104:107], v[160:163], v[104:107]
 buffer_store_dwordx4 v[68:71], v7, s[8:11], s30 offen offset:0 sc1
M v[104:107], a[100:103], v[144:147], v[104:107]
M v[104:107], a[96:99], v[128:131], v[104:107]
 s_waitcnt lgkmcnt(0)
 v_fma_f32 v80, v80, v5, v28
M v[112:115], a[64:67], v[128:131], v[32:35]
 ds_read_b128 a[96:99], v2 offset:57344
 v_fma_f32 v81, v81, v5, v28
M v[112:115], a[68:71], v[144:147], v[112:115]
 ds_read_b128 a[100:103], v2 offset:58368
 v_fma_f32 v82, v82, v5, v28
M v[112:115], a[72:75], v[160:163], v[112:115]
 v_fma_f32 v83, v83, v5, v28
M v[112:115], a[76:79], v[176:179], v[112:115]
 ds_read_b128 a[104:107], v2 offset:59392
 v_fma_f32 v88, v88, v5, v28
M v[112:115], a[80:83], v[192:195], v[112:115]
 ds_read_b128 a[108:111], v2 offset:60416
 v_fma_f32 v89, v89, v5, v28
M v[112:115], a[84:87], v[208:211], v[112:115]
 v_fma_f32 v90, v90, v5, v28
M v[112:115], a[88:91], v[224:227], v[112:115]
 ds_read_b128 a[112:115], v2 offset:61440
 v_fma_f32 v91, v91, v5, v28
M v[112:115], a[92:95], v[240:243], v[112:115]
 ds_read_b128 a[116:119], v2 offset:62464
 v_cvt_pk_bf16_f32 v80, v80, v81
M v[116:119], a[92:95], v[244:247], v[36:39]
 s_waitcnt vmcnt(6)
 v_readlane_b32 s84, v25, 0
 v_readlane_b32 s85, v25, 1
M v[116:119], a[88:91], v[228:231], v[116:119]
 ds_read_b128 a[120:123], v2 offset:63488
 v_mov_b32 v24, 0x3f80
M v[116:119], a[84:87], v[212:215], v[116:119]
 ds_read_b128 a[124:127], v2 offset:64512
 v_mov_b32 v25, 0x3f800000
M v[116:119], a[80:83], v[196:199], v[116:119]
 v_cvt_pk_bf16_f32 v81, v82, v83
 v_cvt_pk_bf16_f32 v82, v88, v89
M v[116:119], a[76:79], v[180:183], v[116:119]
 v_cvt_pk_bf16_f32 v83, v90, v91
M v[116:119], a[72:75], v[164:167], v[116:119]
 buffer_store_dwordx4 v[80:83], v7, s[8:11], s29 offen offset:1024 sc1
M v[116:119], a[68:71], v[148:151], v[116:119]
 s_waitcnt lgkmcnt(0)
 v_fma_f32 v84, v84, v6, v29
 v_fma_f32 v85, v85, v6, v29
M v[116:119], a[64:67], v[132:135], v[116:119]
 s_barrier
M v[124:127], a[96:99], v[132:135], v[36:39]
 ds_read_b128 a[64:67], v7 offset:32768
 v_fma_f32 v86, v86, v6, v29
M v[124:127], a[100:103], v[148:151], v[124:127]
 ds_read_b128 a[68:71], v7 offset:33792
 v_fma_f32 v87, v87, v6, v29
M v[124:127], a[104:107], v[164:167], v[124:127]
 v_fma_f32 v92, v92, v6, v29
 v_fma_f32 v93, v93, v6, v29
M v[124:127], a[108:111], v[180:183], v[124:127]
 ds_read_b128 a[72:75], v7 offset:34816
 v_fma_f32 v94, v94, v6, v29
M v[124:127], a[112:115], v[196:199], v[124:127]
 ds_read_b128 a[76:79], v7 offset:35840
 v_fma_f32 v95, v95, v6, v29
M v[124:127], a[116:119], v[212:215], v[124:127]
 s_waitcnt vmcnt(3)
 v_cvt_pk_bf16_f32 v84, v84, v85
 v_cvt_pk_bf16_f32 v85, v86, v87
M v[124:127], a[120:123], v[228:231], v[124:127]
 ds_read_b128 a[80:83], v7 offset:36864
 v_cvt_pk_bf16_f32 v86, v92, v93
M v[124:127], a[124:127], v[244:247], v[124:127]
 ds_read_b128 a[84:87], v7 offset:37888
 v_cvt_pk_bf16_f32 v87, v94, v95
M v[120:123], a[124:127], v[240:243], v[32:35]
 buffer_store_dword v40, v41, s[8:11], s45 offen sc1
M v[120:123], a[120:123], v[224:227], v[120:123]
 ds_read_b128 a[88:91], v7 offset:38912
M v[120:123], a[116:119], v[208:211], v[120:123]
 ds_read_b128 a[92:95], v7 offset:39936
M v[120:123], a[112:115], v[192:195], v[120:123]
 buffer_store_dwordx4 v[84:87], v7, s[8:11], s30 offen offset:1024 sc1
M v[120:123], a[108:111], v[176:179], v[120:123]
M v[120:123], a[104:107], v[160:163], v[120:123]
M v[120:123], a[100:103], v[144:147], v[120:123]
 s_waitcnt lgkmcnt(0)
 s_cmp_eq_u32 s42, 6
M v[120:123], a[96:99], v[128:131], v[120:123]
 s_cbranch_scc1 L_y3
L_y3r:
M v[64:67], a[64:67], v[128:131], v[32:35]
 ds_read_b128 a[96:99], v7 offset:40960
M v[64:67], a[68:71], v[144:147], v[64:67]
 ds_read_b128 a[100:103], v7 offset:41984
M v[64:67], a[72:75], v[160:163], v[64:67]
M v[64:67], a[76:79], v[176:179], v[64:67]
 ds_read_b128 a[104:107], v7 offset:43008
 s_add_u32 s29, s33, 10240
M v[64:67], a[80:83], v[192:195], v[64:67]
 ds_read_b128 a[108:111], v7 offset:44032
 s_add_u32 s30, s33, 24576
M v[64:67], a[84:87], v[208:211], v[64:67]
 v_fma_f32 v96, v96, v5, v28
 v_fma_f32 v97, v97, v5, v28
M v[64:67], a[88:91], v[224:227], v[64:67]
 ds_read_b128 a[112:115], v7 offset:45056
 v_fma_f32 v98, v98, v5, v28
M v[64:67], a[92:95], v[240:243], v[64:67]
 ds_read_b128 a[116:119], v7 offset:46080
 v_fma_f32 v99, v99, v5, v28
M v[68:71], a[92:95], v[244:247], v[36:39]
 v_fma_f32 v104, v104, v5, v28
 v_fma_f32 v105, v105, v5, v28
M v[68:71], a[88:91], v[228:231], v[68:71]
 ds_read_b128 a[120:123], v7 offset:47104
 v_fma_f32 v106, v106, v5, v28
M v[68:71], a[84:87], v[212:215], v[68:71]
 ds_read_b128 a[124:127], v7 offset:48128
 v_fma_f32 v107, v107, v5, v28
M v[68:71], a[80:83], v[196:199], v[68:71]
 v_cvt_pk_bf16_f32 v96, v96, v97
 v_cvt_pk_bf16_f32 v97, v98, v99
M v[68:71], a[76:79], v[180:183], v[68:71]
 v_cvt_pk_bf16_f32 v98, v104, v105
 v_cvt_pk_bf16_f32 v99, v106, v107
M v[68:71], a[72:75], v[164:167], v[68:71]
 buffer_store_dwordx4 v[96:99], v7, s[8:11], s29 offen offset:0 sc1
M v[68:71], a[68:71], v[148:151], v[68:71]
 v_fma_f32 v100, v100, v6, v29
 v_fma_f32 v101, v101, v6, v29
M v[68:71], a[64:67], v[132:135], v[68:71]
 s_waitcnt lgkmcnt(0)
 v_fma_f32 v102, v102, v6, v29
 v_fma_f32 v103, v103, v6, v29
M v[72:75], a[96:99], v[128:131], v[32:35]
 ds_read_b128 a[64:67], v7 offset:49152
 v_fma_f32 v108, v108, v6, v29
M v[72:75], a[100:103], v[144:147], v[72:75]
 ds_read_b128 a[68:71], v7 offset:50176
 v_fma_f32 v109, v109, v6, v29
M v[72:75], a[104:107], v[160:163], v[72:75]
 v_fma_f32 v110, v110, v6, v29
 v_fma_f32 v111, v111, v6, v29
M v[72:75], a[108:111], v[176:179], v[72:75]
 ds_read_b128 a[72:75], v7 offset:51200
 v_cvt_pk_bf16_f32 v100, v100, v101
M v[72:75], a[112:115], v[192:195], v[72:75]
 ds_read_b128 a[76:79], v7 offset:52224
 v_cvt_pk_bf16_f32 v101, v102, v103
M v[72:75], a[116:119], v[208:211], v[72:75]
 v_cvt_pk_bf16_f32 v102, v108, v109
 v_cvt_pk_bf16_f32 v103, v110, v111
M v[72:75], a[120:123], v[224:227], v[72:75]
 ds_read_b128 a[80:83], v7 offset:53248
M v[72:75], a[124:127], v[240:243], v[72:75]
 ds_read_b128 a[84:87], v7 offset:54272
M v[76:79], a[124:127], v[244:247], v[36:39]
 buffer_store_dwordx4 v[100:103], v7, s[8:11], s30 offen offset:0 sc1
M v[76:79], a[120:123], v[228:231], v[76:79]
 ds_read_b128 a[88:91], v7 offset:55296
 v_fma_f32 v112, v112, v5, v28
M v[76:79], a[116:119], v[212:215], v[76:79]
 ds_read_b128 a[92:95], v7 offset:56320
 v_fma_f32 v113, v113, v5, v28
M v[76:79], a[112:115], v[196:199], v[76:79]
 v_fma_f32 v114, v114, v5, v28
 v_fma_f32 v115, v115, v5, v28
M v[76:79], a[108:111], v[180:183], v[76:79]
 v_fma_f32 v120, v120, v5, v28
 v_fma_f32 v121, v121, v5, v28
M v[76:79], a[104:107], v[164:167], v[76:79]
 v_fma_f32 v122, v122, v5, v28
 v_fma_f32 v123, v123, v5, v28
M v[76:79], a[100:103], v[148:151], v[76:79]
 v_cvt_pk_bf16_f32 v112, v112, v113
 v_cvt_pk_bf16_f32 v113, v114, v115
M v[76:79], a[96:99], v[132:135], v[76:79]
 s_waitcnt lgkmcnt(0)
 v_cvt_pk_bf16_f32 v114, v120, v121
 v_cvt_pk_bf16_f32 v115, v122, v123
M v[80:83], a[64:67], v[128:131], v[32:35]
 ds_read_b128 a[96:99], v7 offset:57344
M v[80:83], a[68:71], v[144:147], v[80:83]
 ds_read_b128 a[100:103], v7 offset:58368
M v[80:83], a[72:75], v[160:163], v[80:83]
 buffer_store_dwordx4 v[112:115], v7, s[8:11], s29 offen offset:1024 sc1
M v[80:83], a[76:79], v[176:179], v[80:83]
 ds_read_b128 a[104:107], v7 offset:59392
 v_fma_f32 v116, v116, v6, v29
M v[80:83], a[80:83], v[192:195], v[80:83]
 ds_read_b128 a[108:111], v7 offset:60416
 v_fma_f32 v117, v117, v6, v29
M v[80:83], a[84:87], v[208:211], v[80:83]
 v_fma_f32 v118, v118, v6, v29
 v_fma_f32 v119, v119, v6, v29
M v[80:83], a[88:91], v[224:227], v[80:83]
 ds_read_b128 a[112:115], v7 offset:61440
 v_fma_f32 v124, v124, v6, v29
M v[80:83], a[92:95], v[240:243], v[80:83]
 ds_read_b128 a[116:119], v7 offset:62464
 v_fma_f32 v125, v125, v6, v29
M v[84:87], a[92:95], v[244:247], v[36:39]
 v_fma_f32 v126, v126, v6, v29
 v_fma_f32 v127, v127, v6, v29
M v[84:87], a[88:91], v[228:231], v[84:87]
 ds_read_b128 a[120:123], v7 offset:63488
 v_cvt_pk_bf16_f32 v116, v116, v117
M v[84:87], a[84:87], v[212:215], v[84:87]
 ds_read_b128 a[124:127], v7 offset:64512
 v_cvt_pk_bf16_f32 v117, v118, v119
M v[84:87], a[80:83], v[196:199], v[84:87]
 v_cvt_pk_bf16_f32 v118, v124, v125
 v_cvt_pk_bf16_f32 v119, v126, v127
M v[84:87], a[76:79], v[180:183], v[84:87]
 buffer_store_dwordx4 v[116:119], v7, s[8:11], s30 offen offset:1024 sc1
M v[84:87], a[72:75], v[164:167], v[84:87]
 s_add_u32 s29, s33, 12288
M v[84:87], a[68:71], v[148:151], v[84:87]
 s_add_u32 s30, s33, 26624
 v_fma_f32 v64, v64, v5, v28
 v_fma_f32 v65, v65, v5, v28
M v[84:87], a[64:67], v[132:135], v[84:87]
 s_waitcnt lgkmcnt(0)
 v_fma_f32 v66, v66, v5, v28
 v_fma_f32 v67, v67, v5, v28
M v[88:91], a[96:99], v[128:131], v[32:35]
 v_fma_f32 v72, v72, v5, v28
 v_fma_f32 v73, v73, v5, v28
M v[88:91], a[100:103], v[144:147], v[88:91]
 v_fma_f32 v74, v74, v5, v28
 v_fma_f32 v75, v75, v5, v28
M v[88:91], a[104:107], v[160:163], v[88:91]
 v_cvt_pk_bf16_f32 v64, v64, v65
 v_cvt_pk_bf16_f32 v65, v66, v67
M v[88:91], a[108:111], v[176:179], v[88:91]
 v_cvt_pk_bf16_f32 v66, v72, v73
 v_cvt_pk_bf16_f32 v67, v74, v75
M v[88:91], a[112:115], v[192:195], v[88:91]
 buffer_store_dwordx4 v[64:67], v7, s[8:11], s29 offen offset:0 sc1
M v[88:91], a[116:119], v[208:211], v[88:91]
 v_fma_f32 v68, v68, v6, v29
 v_fma_f32 v69, v69, v6, v29
M v[88:91], a[120:123], v[224:227], v[88:91]
 v_fma_f32 v70, v70, v6, v29
 v_fma_f32 v71, v71, v6, v29
M v[88:91], a[124:127], v[240:243], v[88:91]
 v_fma_f32 v76, v76, v6, v29
 v_fma_f32 v77, v77, v6, v29
M v[92:95], a[124:127], v[244:247], v[36:39]
 v_fma_f32 v78, v78, v6, v29
 v_fma_f32 v79, v79, v6, v29
M v[92:95], a[120:123], v[228:231], v[92:95]
 v_cvt_pk_bf16_f32 v68, v68, v69
 v_cvt_pk_bf16_f32 v69, v70, v71
M v[92:95], a[116:119], v[212:215], v[92:95]
 v_cvt_pk_bf16_f32 v70, v76, v77
 v_cvt_pk_bf16_f32 v71, v78, v79
M v[92:95], a[112:115], v[196:199], v[92:95]
 buffer_store_dwordx4 v[68:71], v7, s[8:11], s30 offen offset:0 sc1
M v[92:95], a[108:111], v[180:183], v[92:95]
M v[92:95], a[104:107], v[164:167], v[92:95]
M v[92:95], a[100:103], v[148:151], v[92:95]
M v[92:95], a[96:99], v[132:135], v[92:95]
 v_fma_f32 v80, v80, v5, v28
 v_fma_f32 v81, v81, v5, v28
 v_fma_f32 v82, v82, v5, v28
 v_fma_f32 v83, v83, v5, v28
 v_fma_f32 v88, v88, v5, v28
 v_fma_f32 v89, v89, v5, v28
 v_fma_f32 v90, v90, v5, v28
 v_fma_f32 v91, v91, v5, v28
 v_cvt_pk_bf16_f32 v80, v80, v81
 v_cvt_pk_bf16_f32 v81, v82, v83
 v_cvt_pk_bf16_f32 v82, v88, v89
 v_cvt_pk_bf16_f32 v83, v90, v91
 buffer_store_dwordx4 v[80:83], v7, s[8:11], s29 offen offset:1024 sc1
 v_fma_f32 v84, v84, v6, v29
 v_fma_f32 v85, v85, v6, v29
 v_fma_f32 v86, v86, v6, v29
 v_fma_f32 v87, v87, v6, v29
 v_fma_f32 v92, v92, v6, v29
 v_fma_f32 v93, v93, v6, v29
 v_fma_f32 v94, v94, v6, v29
 v_fma_f32 v95, v95, v6, v29
 v_cvt_pk_bf16_f32 v84, v84, v85
 v_cvt_pk_bf16_f32 v85, v86, v87
 v_cvt_pk_bf16_f32 v86, v92, v93
 v_cvt_pk_bf16_f32 v87, v94, v95
 buffer_store_dwordx4 v[84:87], v7, s[8:11], s30 offen offset:1024 sc1
 s_cmp_lt_u32 s42, 8
 s_cbranch_scc1 L_red
 s_cmp_eq_u32 s20, 3
 s_cbranch_scc1 L_vend3
 s_sub_u32 s64, 15, s42
 s_lshl_b32 s64, s64, 1
 s_lshr_b32 s65, s41, 3
 s_add_u32 s46, s64, s65
 s_mul_i32 s46, s46, 4352
 s_and_b32 s72, s41, 7
 s_lshl_b32 s66, s72, 7
 s_add_u32 s46, s46, s66
 s_add_u32 s46, s46, 104993792
 v_and_b32 v14, 15, v0
 v_lshlrev_b32 v14, 2, v14
 buffer_load_dword v9, v14, s[8:11], s46 offen sc1
 s_mul_i32 s86, s65, 3
 s_add_u32 s86, s86, s20
 s_add_u32 s86, s86, 8
 s_mul_i32 s77, s42, 1835008
 s_mul_i32 s78, s72, 14336
 s_add_u32 s77, s77, s78
 s_add_u32 s77, s77, 67108864
 s_lshl_b32 s78, s86, 10
 s_add_u32 s77, s77, s78
 s_lshl_b32 s86, s86, 6
 s_lshr_b32 s73, s72, 1
 s_sub_u32 s65, 7, s73
 s_bitcmp1_b32 s72, 0
 s_cselect_b32 s73, s65, s73
 s_lshl_b32 s73, s73, 4
 s_lshl_b32 s65, s42, 7
 s_add_u32 s73, s73, s65
 v_and_b32 v10, 15, v0
 v_add_u32 v10, s73, v10
 s_mov_b32 s64, 104857664
 v_mul_u32_u24 v12, 896, v10
 v_lshl_add_u32 v12, v11, 4, v12
 v_lshrrev_b32 v13, 4, v10
 v_lshlrev_b32 v13, 5, v13
 v_and_b32 v104, 15, v10
 v_add_lshl_u32 v13, v13, v104, 2
 buffer_load_dword v15, v13, s[8:11], s64 offen sc1
 buffer_load_dwordx4 v[16:19], v12, s[56:59], s86 offen
 v_mov_b32 v48, 0
 v_mov_b32 v49, 0
 v_mov_b32 v50, 0
 v_mov_b32 v51, 0
 v_mov_b32 v52, 0
 v_mov_b32 v53, 0
 v_mov_b32 v54, 0
 v_mov_b32 v55, 0
 s_waitcnt vmcnt(3)
 buffer_store_dword v40, v41, s[8:11], s3 offen sc1
 s_waitcnt vmcnt(3)
 v_cmp_eq_u32 vcc, 1, v9
 s_mov_b32 s91, 65536
 s_mov_b32 s69, 0
 s_and_b32 s70, vcc_lo, 0xffff
 s_or_b32 s68, s70, 0xffff0000
 s_cmp_lg_u32 s70, 0
 s_cbranch_scc1 L_vk0
 s_call_b64 s[36:37], L_rpoll
L_vk0:
 s_ff1_i32_b32 s71, s70
 s_bitset0_b32 s70, s71
 s_mul_i32 s71, s71, 114688
 s_add_u32 s12, s71, s77
 buffer_load_dwordx4 v[128:131], v7, s[8:11], s12 offen sc1 nt
 s_cmp_lg_u32 s70, 0
 s_cbranch_scc1 L_vk1
 s_call_b64 s[36:37], L_rpoll
L_vk1:
 s_ff1_i32_b32 s71, s70
 s_bitset0_b32 s70, s71
 s_mul_i32 s71, s71, 114688
 s_add_u32 s13, s71, s77
 buffer_load_dwordx4 v[132:135], v7, s[8:11], s13 offen sc1 nt
 s_waitcnt vmcnt(3)
 v_lshlrev_b32 v32, 16, v16
 v_and_b32 v33, 0xffff0000, v16
 v_lshlrev_b32 v34, 16, v17
 v_and_b32 v35, 0xffff0000, v17
 v_lshlrev_b32 v36, 16, v18
 v_and_b32 v37, 0xffff0000, v18
 v_lshlrev_b32 v38, 16, v19
 v_and_b32 v39, 0xffff0000, v19
 v_sub_f32 v13, 1.0, v15
 v_cmp_eq_u32 s[80:81], s84, v10
 v_cmp_eq_u32 s[82:83], s85, v10
 s_nop 0
 s_or_b64 vcc, s[80:81], s[82:83]
 s_cbranch_vccnz L_moe2
L_moe_ret2:
 v_mul_f32 v32, v13, v32
 v_mul_f32 v33, v13, v33
 v_mul_f32 v34, v13, v34
 v_mul_f32 v35, v13, v35
 v_mul_f32 v36, v13, v36
 v_mul_f32 v37, v13, v37
 v_mul_f32 v38, v13, v38
 v_mul_f32 v39, v13, v39
 s_cmp_lg_u32 s70, 0
 s_cbranch_scc1 L_vk2
 s_call_b64 s[36:37], L_rpoll
L_vk2:
 s_ff1_i32_b32 s71, s70
 s_bitset0_b32 s70, s71
 s_mul_i32 s71, s71, 114688
 s_add_u32 s14, s71, s77
 buffer_load_dwordx4 v[136:139], v7, s[8:11], s14 offen sc1 nt
 s_cmp_lg_u32 s70, 0
 s_cbranch_scc1 L_vk3
 s_call_b64 s[36:37], L_rpoll
L_vk3:
 s_ff1_i32_b32 s71, s70
 s_bitset0_b32 s70, s71
 s_mul_i32 s71, s71, 114688
 s_add_u32 s15, s71, s77
 buffer_load_dwordx4 v[140:143], v7, s[8:11], s15 offen sc1 nt
 s_cmp_lg_u32 s70, 0
 s_cbranch_scc1 L_vk4
 s_call_b64 s[36:37], L_rpoll
L_vk4:
 s_ff1_i32_b32 s71, s70
 s_bitset0_b32 s70, s71
 s_mul_i32 s71, s71, 114688
 s_add_u32 s16, s71, s77
 buffer_load_dwordx4 v[144:147], v7, s[8:11], s16 offen sc1 nt
 s_cmp_lg_u32 s70, 0
 s_cbranch_scc1 L_vk5
 s_call_b64 s[36:37], L_rpoll
L_vk5:
 s_ff1_i32_b32 s71, s70
 s_bitset0_b32 s70, s71
 s_mul_i32 s71, s71, 114688
 s_add_u32 s17, s71, s77
 buffer_load_dwordx4 v[148:151], v7, s[8:11], s17 offen sc1 nt
 s_cmp_lg_u32 s70, 0
 s_cbranch_scc1 L_vk6
 s_call_b64 s[36:37], L_rpoll
L_vk6:
 s_ff1_i32_b32 s71, s70
 s_bitset0_b32 s70, s71
 s_mul_i32 s71, s71, 114688
 s_add_u32 s18, s71, s77
 buffer_load_dwordx4 v[152:155], v7, s[8:11], s18 offen sc1 nt
 s_cmp_lg_u32 s70, 0
 s_cbranch_scc1 L_vk7
 s_call_b64 s[36:37], L_rpoll
L_vk7:
 s_ff1_i32_b32 s71, s70
 s_bitset0_b32 s70, s71
 s_mul_i32 s71, s71, 114688
 s_add_u32 s19, s71, s77
 buffer_load_dwordx4 v[156:159], v7, s[8:11], s19 offen sc1 nt
 s_cmp_lg_u32 s70, 0
 s_cbranch_scc1 L_vk8
 s_call_b64 s[36:37], L_rpoll
L_vk8:
 s_ff1_i32_b32 s71, s70
 s_bitset0_b32 s70, s71
 s_mul_i32 s71, s71, 114688
 s_add_u32 s21, s71, s77
 buffer_load_dwordx4 v[160:163], v7, s[8:11], s21 offen sc1 nt
 s_cmp_lg_u32 s70, 0
 s_cbranch_scc1 L_vk9
 s_call_b64 s[36:37], L_rpoll
L_vk9:
 s_ff1_i32_b32 s71, s70
 s_bitset0_b32 s70, s71
 s_mul_i32 s71, s71, 114688
 s_add_u32 s22, s71, s77
 buffer_load_dwordx4 v[164:167], v7, s[8:11], s22 offen sc1 nt
 s_cmp_lg_u32 s70, 0
 s_cbranch_scc1 L_vk10
 s_call_b64 s[36:37], L_rpoll
L_vk10:
 s_ff1_i32_b32 s71, s70
 s_bitset0_b32 s70, s71
 s_mul_i32 s71, s71, 114688
 s_add_u32 s23, s71, s77
 buffer_load_dwordx4 v[168:171], v7, s[8:11], s23 offen sc1 nt
 s_cmp_lg_u32 s70, 0
 s_cbranch_scc1 L_vk11
 s_call_b64 s[36:37], L_rpoll
L_vk11:
 s_ff1_i32_b32 s71, s70
 s_bitset0_b32 s70, s71
 s_mul_i32 s71, s71, 114688
 s_add_u32 s24, s71, s77
 buffer_load_dwordx4 v[172:175], v7, s[8:11], s24 offen sc1 nt
 s_cmp_lg_u32 s70, 0
 s_cbranch_scc1 L_vk12
 s_call_b64 s[36:37], L_rpoll
L_vk12:
 s_ff1_i32_b32 s71, s70
 s_bitset0_b32 s70, s71
 s_mul_i32 s71, s71, 114688
 s_add_u32 s48, s71, s77
 buffer_load_dwordx4 v[176:179], v7, s[8:11], s48 offen sc1 nt
 s_cmp_lg_u32 s70, 0
 s_cbranch_scc1 L_vk13
 s_call_b64 s[36:37], L_rpoll
L_vk13:
 s_ff1_i32_b32 s71, s70
 s_bitset0_b32 s70, s71
 s_mul_i32 s71, s71, 114688
 s_add_u32 s49, s71, s77
 buffer_load_dwordx4 v[180:183], v7, s[8:11], s49 offen sc1 nt
 s_cmp_lg_u32 s70, 0
 s_cbranch_scc1 L_vk14
 s_call_b64 s[36:37], L_rpoll
L_vk14:
 s_ff1_i32_b32 s71, s70
 s_bitset0_b32 s70, s71
 s_mul_i32 s71, s71, 114688
 s_add_u32 s50, s71, s77
 buffer_load_dwordx4 v[184:187], v7, s[8:11], s50 offen sc1 nt
 s_cmp_lg_u32 s70, 0
 s_cbranch_scc1 L_vk15
 s_call_b64 s[36:37], L_rpoll
L_vk15:
 s_ff1_i32_b32 s71, s70
 s_bitset0_b32 s70, s71
 s_mul_i32 s71, s71, 114688
 s_add_u32 s51, s71, s77
 buffer_load_dwordx4 v[188:191], v7, s[8:11], s51 offen sc1 nt
 s_waitcnt vmcnt(15)
 v_dot2c_f32_bf16 v48, v128, v24
 v_dot2c_f32_bf16 v49, v128, v25
 v_dot2c_f32_bf16 v50, v129, v24
 v_dot2c_f32_bf16 v51, v129, v25
 v_dot2c_f32_bf16 v52, v130, v24
 v_dot2c_f32_bf16 v53, v130, v25
 v_dot2c_f32_bf16 v54, v131, v24
 v_dot2c_f32_bf16 v55, v131, v25
 s_waitcnt vmcnt(14)
 v_dot2c_f32_bf16 v48, v132, v24
 v_dot2c_f32_bf16 v49, v132, v25
 v_dot2c_f32_bf16 v50, v133, v24
 v_dot2c_f32_bf16 v51, v133, v25
 v_dot2c_f32_bf16 v52, v134, v24
 v_dot2c_f32_bf16 v53, v134, v25
 v_dot2c_f32_bf16 v54, v135, v24
 v_dot2c_f32_bf16 v55, v135, v25
 s_waitcnt vmcnt(13)
 v_dot2c_f32_bf16 v48, v136, v24
 v_dot2c_f32_bf16 v49, v136, v25
 v_dot2c_f32_bf16 v50, v137, v24
 v_dot2c_f32_bf16 v51, v137, v25
 v_dot2c_f32_bf16 v52, v138, v24
 v_dot2c_f32_bf16 v53, v138, v25
 v_dot2c_f32_bf16 v54, v139, v24
 v_dot2c_f32_bf16 v55, v139, v25
 s_waitcnt vmcnt(12)
 v_dot2c_f32_bf16 v48, v140, v24
 v_dot2c_f32_bf16 v49, v140, v25
 v_dot2c_f32_bf16 v50, v141, v24
 v_dot2c_f32_bf16 v51, v141, v25
 v_dot2c_f32_bf16 v52, v142, v24
 v_dot2c_f32_bf16 v53, v142, v25
 v_dot2c_f32_bf16 v54, v143, v24
 v_dot2c_f32_bf16 v55, v143, v25
 s_waitcnt vmcnt(11)
 v_dot2c_f32_bf16 v48, v144, v24
 v_dot2c_f32_bf16 v49, v144, v25
 v_dot2c_f32_bf16 v50, v145, v24
 v_dot2c_f32_bf16 v51, v145, v25
 v_dot2c_f32_bf16 v52, v146, v24
 v_dot2c_f32_bf16 v53, v146, v25
 v_dot2c_f32_bf16 v54, v147, v24
 v_dot2c_f32_bf16 v55, v147, v25
 s_waitcnt vmcnt(10)
 v_dot2c_f32_bf16 v48, v148, v24
 v_dot2c_f32_bf16 v49, v148, v25
 v_dot2c_f32_bf16 v50, v149, v24
 v_dot2c_f32_bf16 v51, v149, v25
 v_dot2c_f32_bf16 v52, v150, v24
 v_dot2c_f32_bf16 v53, v150, v25
 v_dot2c_f32_bf16 v54, v151, v24
 v_dot2c_f32_bf16 v55, v151, v25
 s_waitcnt vmcnt(9)
 v_dot2c_f32_bf16 v48, v152, v24
 v_dot2c_f32_bf16 v49, v152, v25
 v_dot2c_f32_bf16 v50, v153, v24
 v_dot2c_f32_bf16 v51, v153, v25
 v_dot2c_f32_bf16 v52, v154, v24
 v_dot2c_f32_bf16 v53, v154, v25
 v_dot2c_f32_bf16 v54, v155, v24
 v_dot2c_f32_bf16 v55, v155, v25
 s_waitcnt vmcnt(8)
 v_dot2c_f32_bf16 v48, v156, v24
 v_dot2c_f32_bf16 v49, v156, v25
 v_dot2c_f32_bf16 v50, v157, v24
 v_dot2c_f32_bf16 v51, v157, v25
 v_dot2c_f32_bf16 v52, v158, v24
 v_dot2c_f32_bf16 v53, v158, v25
 v_dot2c_f32_bf16 v54, v159, v24
 v_dot2c_f32_bf16 v55, v159, v25
 s_waitcnt vmcnt(7)
 v_dot2c_f32_bf16 v48, v160, v24
 v_dot2c_f32_bf16 v49, v160, v25
 v_dot2c_f32_bf16 v50, v161, v24
 v_dot2c_f32_bf16 v51, v161, v25
 v_dot2c_f32_bf16 v52, v162, v24
 v_dot2c_f32_bf16 v53, v162, v25
 v_dot2c_f32_bf16 v54, v163, v24
 v_dot2c_f32_bf16 v55, v163, v25
 s_waitcnt vmcnt(6)
 v_dot2c_f32_bf16 v48, v164, v24
 v_dot2c_f32_bf16 v49, v164, v25
 v_dot2c_f32_bf16 v50, v165, v24
 v_dot2c_f32_bf16 v51, v165, v25
 v_dot2c_f32_bf16 v52, v166, v24
 v_dot2c_f32_bf16 v53, v166, v25
 v_dot2c_f32_bf16 v54, v167, v24
 v_dot2c_f32_bf16 v55, v167, v25
 s_waitcnt vmcnt(5)
 v_dot2c_f32_bf16 v48, v168, v24
 v_dot2c_f32_bf16 v49, v168, v25
 v_dot2c_f32_bf16 v50, v169, v24
 v_dot2c_f32_bf16 v51, v169, v25
 v_dot2c_f32_bf16 v52, v170, v24
 v_dot2c_f32_bf16 v53, v170, v25
 v_dot2c_f32_bf16 v54, v171, v24
 v_dot2c_f32_bf16 v55, v171, v25
 s_waitcnt vmcnt(4)
 v_dot2c_f32_bf16 v48, v172, v24
 v_dot2c_f32_bf16 v49, v172, v25
 v_dot2c_f32_bf16 v50, v173, v24
 v_dot2c_f32_bf16 v51, v173, v25
 v_dot2c_f32_bf16 v52, v174, v24
 v_dot2c_f32_bf16 v53, v174, v25
 v_dot2c_f32_bf16 v54, v175, v24
 v_dot2c_f32_bf16 v55, v175, v25
 s_waitcnt vmcnt(3)
 v_dot2c_f32_bf16 v48, v176, v24
 v_dot2c_f32_bf16 v49, v176, v25
 v_dot2c_f32_bf16 v50, v177, v24
 v_dot2c_f32_bf16 v51, v177, v25
 v_dot2c_f32_bf16 v52, v178, v24
 v_dot2c_f32_bf16 v53, v178, v25
 v_dot2c_f32_bf16 v54, v179, v24
 v_dot2c_f32_bf16 v55, v179, v25
 s_waitcnt vmcnt(2)
 v_dot2c_f32_bf16 v48, v180, v24
 v_dot2c_f32_bf16 v49, v180, v25
 v_dot2c_f32_bf16 v50, v181, v24
 v_dot2c_f32_bf16 v51, v181, v25
 v_dot2c_f32_bf16 v52, v182, v24
 v_dot2c_f32_bf16 v53, v182, v25
 v_dot2c_f32_bf16 v54, v183, v24
 v_dot2c_f32_bf16 v55, v183, v25
 s_waitcnt vmcnt(1)
 v_dot2c_f32_bf16 v48, v184, v24
 v_dot2c_f32_bf16 v49, v184, v25
 v_dot2c_f32_bf16 v50, v185, v24
 v_dot2c_f32_bf16 v51, v185, v25
 v_dot2c_f32_bf16 v52, v186, v24
 v_dot2c_f32_bf16 v53, v186, v25
 v_dot2c_f32_bf16 v54, v187, v24
 v_dot2c_f32_bf16 v55, v187, v25
 s_waitcnt vmcnt(0)
 v_dot2c_f32_bf16 v48, v188, v24
 v_dot2c_f32_bf16 v49, v188, v25
 v_dot2c_f32_bf16 v50, v189, v24
 v_dot2c_f32_bf16 v51, v189, v25
 v_dot2c_f32_bf16 v52, v190, v24
 v_dot2c_f32_bf16 v53, v190, v25
 v_dot2c_f32_bf16 v54, v191, v24
 v_dot2c_f32_bf16 v55, v191, v25
 s_nop 1
 v_fmac_f32 v32, v15, v48
 v_fmac_f32 v33, v15, v49
 v_fmac_f32 v34, v15, v50
 v_fmac_f32 v35, v15, v51
 v_fmac_f32 v36, v15, v52
 v_fmac_f32 v37, v15, v53
 v_fmac_f32 v38, v15, v54
 v_fmac_f32 v39, v15, v55
 v_cvt_pk_bf16_f32 v16, v32, v33
 v_cvt_pk_bf16_f32 v17, v34, v35
 v_cvt_pk_bf16_f32 v18, v36, v37
 v_cvt_pk_bf16_f32 v19, v38, v39
 buffer_store_dwordx4 v[16:19], v12, s[52:55], s86 offen sc1
L_vend:
 s_endpgm
L_vend3:
 s_waitcnt vmcnt(0)
 buffer_store_dword v40, v41, s[8:11], s3 offen sc1
 s_branch L_vend
 s_waitcnt vmcnt(0)
L_p1n:
 v_cndmask_b32 v64, v32, v8, s[64:65]
 v_cndmask_b32 v65, v32, v8, s[66:67]
 v_cndmask_b32 v66, v32, v8, s[68:69]
 v_cndmask_b32 v67, v32, v8, s[70:71]
 s_nop 1
M v[64:67], a[64:67], a[0:3], v[64:67]
 s_add_u32 m0, s28, 65536
 ds_read_b128 a[96:99], v2 offset:40960
 v_cndmask_b32 v72, v32, v8, s[72:73]
M v[64:67], a[68:71], a[4:7], v[64:67]
 ds_read_b128 a[100:103], v2 offset:41984
 v_cndmask_b32 v73, v32, v8, s[74:75]
M v[64:67], a[72:75], a[8:11], v[64:67]
 buffer_load_dwordx4 v3, s[8:11], s24 offen offset:0 sc1 lds
M v[64:67], a[76:79], a[12:15], v[64:67]
 ds_read_b128 a[104:107], v2 offset:43008
 v_cndmask_b32 v74, v32, v8, s[76:77]
M v[64:67], a[80:83], a[16:19], v[64:67]
 ds_read_b128 a[108:111], v2 offset:44032
 v_cndmask_b32 v75, v32, v8, s[78:79]
M v[64:67], a[84:87], a[20:23], v[64:67]
 v_exp_f32 v18, v112
M v[64:67], a[88:91], a[24:27], v[64:67]
 ds_read_b128 a[112:115], v2 offset:45056
M v[64:67], a[92:95], a[28:31], v[64:67]
 ds_read_b128 a[116:119], v2 offset:46080
M v[68:71], a[92:95], a[60:63], v[36:39]
 buffer_load_dwordx4 v3, s[8:11], s24 offen offset:1024 sc1 lds
M v[68:71], a[88:91], a[56:59], v[68:71]
 ds_read_b128 a[120:123], v2 offset:47104
M v[68:71], a[84:87], a[52:55], v[68:71]
 ds_read_b128 a[124:127], v2 offset:48128
M v[68:71], a[80:83], a[48:51], v[68:71]
 v_exp_f32 v19, v113
M v[68:71], a[76:79], a[44:47], v[68:71]
 buffer_load_dwordx4 v3, s[8:11], s24 offen offset:2048 sc1 lds
M v[68:71], a[72:75], a[40:43], v[68:71]
 v_exp_f32 v20, v114
M v[68:71], a[68:71], a[36:39], v[68:71]
 v_exp_f32 v21, v115
M v[68:71], a[64:67], a[32:35], v[68:71]
 s_waitcnt lgkmcnt(0)
 v_exp_f32 v22, v120
M v[72:75], a[96:99], a[0:3], v[72:75]
 ds_read_b128 a[64:67], v2 offset:49152
 v_cndmask_b32 v80, v32, v8, s[80:81]
M v[72:75], a[100:103], a[4:7], v[72:75]
 ds_read_b128 a[68:71], v2 offset:50176
 v_cndmask_b32 v81, v32, v8, s[82:83]
M v[72:75], a[104:107], a[8:11], v[72:75]
 buffer_load_dwordx4 v3, s[8:11], s24 offen offset:3072 sc1 lds
M v[72:75], a[108:111], a[12:15], v[72:75]
 ds_read_b128 a[72:75], v2 offset:51200
 v_cndmask_b32 v82, v32, v8, s[84:85]
M v[72:75], a[112:115], a[16:19], v[72:75]
 ds_read_b128 a[76:79], v2 offset:52224
 v_cndmask_b32 v83, v32, v8, s[86:87]
M v[72:75], a[116:119], a[20:23], v[72:75]
 v_exp_f32 v23, v121
M v[72:75], a[120:123], a[24:27], v[72:75]
 s_add_u32 m0, s28, 69632
 ds_read_b128 a[80:83], v2 offset:53248
 v_add_f32 v28, v18, v28
M v[72:75], a[124:127], a[28:31], v[72:75]
 ds_read_b128 a[84:87], v2 offset:54272
 v_cvt_pk_bf16_f32 v56, v18, v19
M v[76:79], a[124:127], a[60:63], v[36:39]
 buffer_load_dwordx4 v4, s[8:11], s24 offen offset:0 sc1 lds
M v[76:79], a[120:123], a[56:59], v[76:79]
 ds_read_b128 a[88:91], v2 offset:55296
 v_add_f32 v28, v19, v28
M v[76:79], a[116:119], a[52:55], v[76:79]
 ds_read_b128 a[92:95], v2 offset:56320
 v_add_f32 v28, v20, v28
M v[76:79], a[112:115], a[48:51], v[76:79]
 v_exp_f32 v24, v122
M v[76:79], a[108:111], a[44:47], v[76:79]
 buffer_load_dwordx4 v4, s[8:11], s24 offen offset:1024 sc1 lds
M v[76:79], a[104:107], a[40:43], v[76:79]
 v_exp_f32 v25, v123
M v[76:79], a[100:103], a[36:39], v[76:79]
 v_exp_f32 v18, v116
M v[76:79], a[96:99], a[32:35], v[76:79]
 s_waitcnt lgkmcnt(0)
 v_exp_f32 v19, v117
M v[80:83], a[64:67], a[0:3], v[80:83]
 ds_read_b128 a[96:99], v2 offset:57344
 v_cndmask_b32 v88, v32, v8, s[88:89]
M v[80:83], a[68:71], a[4:7], v[80:83]
 ds_read_b128 a[100:103], v2 offset:58368
 v_cndmask_b32 v89, v32, v8, s[90:91]
M v[80:83], a[72:75], a[8:11], v[80:83]
 buffer_load_dwordx4 v4, s[8:11], s24 offen offset:2048 sc1 lds
M v[80:83], a[76:79], a[12:15], v[80:83]
 ds_read_b128 a[104:107], v2 offset:59392
 v_cndmask_b32 v90, v32, v8, s[92:93]
M v[80:83], a[80:83], a[16:19], v[80:83]
 ds_read_b128 a[108:111], v2 offset:60416
 v_cndmask_b32 v91, v32, v8, s[94:95]
M v[80:83], a[84:87], a[20:23], v[80:83]
 v_cvt_pk_bf16_f32 v57, v20, v21
 v_add_f32 v28, v21, v28
M v[80:83], a[88:91], a[24:27], v[80:83]
 ds_read_b128 a[112:115], v2 offset:61440
 v_add_f32 v28, v22, v28
M v[80:83], a[92:95], a[28:31], v[80:83]
 ds_read_b128 a[116:119], v2 offset:62464
 v_cvt_pk_bf16_f32 v58, v22, v23
M v[84:87], a[92:95], a[60:63], v[36:39]
 buffer_load_dwordx4 v4, s[8:11], s24 offen offset:3072 sc1 lds
M v[84:87], a[88:91], a[56:59], v[84:87]
 ds_read_b128 a[120:123], v2 offset:63488
 v_add_f32 v28, v23, v28
M v[84:87], a[84:87], a[52:55], v[84:87]
 ds_read_b128 a[124:127], v2 offset:64512
 v_add_f32 v28, v24, v28
M v[84:87], a[80:83], a[48:51], v[84:87]
 v_exp_f32 v20, v118
M v[84:87], a[76:79], a[44:47], v[84:87]
 v_exp_f32 v21, v119
M v[84:87], a[72:75], a[40:43], v[84:87]
 v_exp_f32 v22, v124
M v[84:87], a[68:71], a[36:39], v[84:87]
 s_waitcnt vmcnt(16) lgkmcnt(0)
 v_exp_f32 v23, v125
M v[84:87], a[64:67], a[32:35], v[84:87]
 s_barrier
M v[88:91], a[96:99], a[0:3], v[88:91]
 ds_read_b128 a[64:67], v7 offset:0
 v_cvt_pk_bf16_f32 v59, v24, v25
M v[88:91], a[100:103], a[4:7], v[88:91]
 ds_read_b128 a[68:71], v7 offset:1024
 v_add_f32 v28, v25, v28
M v[88:91], a[104:107], a[8:11], v[88:91]
 v_exp_f32 v24, v126
M v[88:91], a[108:111], a[12:15], v[88:91]
 ds_read_b128 a[72:75], v7 offset:2048
 v_add_f32 v29, v18, v29
M v[88:91], a[112:115], a[16:19], v[88:91]
 ds_read_b128 a[76:79], v7 offset:3072
 v_cvt_pk_bf16_f32 v60, v18, v19
M v[88:91], a[116:119], a[20:23], v[88:91]
 v_exp_f32 v25, v127
M v[88:91], a[120:123], a[24:27], v[88:91]
 ds_read_b128 a[80:83], v7 offset:4096
 v_add_f32 v29, v19, v29
M v[88:91], a[124:127], a[28:31], v[88:91]
 ds_read_b128 a[84:87], v7 offset:5120
 v_add_f32 v29, v20, v29
M v[92:95], a[124:127], a[60:63], v[36:39]
 v_cvt_pk_bf16_f32 v61, v20, v21
 v_add_f32 v29, v21, v29
M v[92:95], a[120:123], a[56:59], v[92:95]
 ds_read_b128 a[88:91], v7 offset:6144
 v_add_f32 v29, v22, v29
M v[92:95], a[116:119], a[52:55], v[92:95]
 ds_read_b128 a[92:95], v7 offset:7168
 v_cvt_pk_bf16_f32 v62, v22, v23
M v[92:95], a[112:115], a[48:51], v[92:95]
 v_add_f32 v29, v23, v29
 v_add_f32 v29, v24, v29
M v[92:95], a[108:111], a[44:47], v[92:95]
 v_cvt_pk_bf16_f32 v63, v24, v25
 v_add_f32 v29, v25, v29
M v[92:95], a[104:107], a[40:43], v[92:95]
M v[92:95], a[100:103], a[36:39], v[92:95]
 s_waitcnt lgkmcnt(0)
M v[92:95], a[96:99], a[32:35], v[92:95]
 v_max_f32 v10, v28, v29
 v_cmp_lt_f32 vcc, s31, v10
 s_nop 0
 s_cbranch_vccnz L_st5
L_rt5:
M v[128:131], a[64:67], v[48:51], v[128:131]
 s_add_u32 m0, s28, 98304
 ds_read_b128 a[96:99], v7 offset:8192
 v_add_f32 v30, v28, v30
M v[128:131], a[68:71], v[56:59], v[128:131]
 ds_read_b128 a[100:103], v7 offset:9216
 v_add_f32 v31, v29, v31
M v[132:135], a[68:71], v[60:63], v[132:135]
 buffer_load_dwordx4 v3, s[8:11], s21 offen offset:0 sc1 lds
M v[132:135], a[64:67], v[52:55], v[132:135]
 s_cmp_eq_u32 s20, 3
 ds_read_b128 a[104:107], v7 offset:10240
M v[140:143], a[72:75], v[52:55], v[140:143]
 s_cselect_b64 s[64:65], s[16:17], 0
 ds_read_b128 a[108:111], v7 offset:11264
M v[140:143], a[76:79], v[60:63], v[140:143]
 buffer_load_dwordx4 v3, s[8:11], s21 offen offset:1024 sc1 lds
M v[136:139], a[76:79], v[56:59], v[136:139]
 s_cselect_b64 s[66:67], s[18:19], 0
 ds_read_b128 a[112:115], v7 offset:12288
M v[136:139], a[72:75], v[48:51], v[136:139]
 s_cselect_b64 s[68:69], s[48:49], 0
 ds_read_b128 a[116:119], v7 offset:13312
M v[144:147], a[80:83], v[48:51], v[144:147]
 s_cselect_b64 s[70:71], s[50:51], 0
 v_exp_f32 v18, v64
M v[144:147], a[84:87], v[56:59], v[144:147]
 s_cmp_gt_u32 s20, 2
 ds_read_b128 a[120:123], v7 offset:14336
M v[148:151], a[84:87], v[60:63], v[148:151]
 s_cselect_b64 s[78:79], -1, 0
 ds_read_b128 a[124:127], v7 offset:15360
M v[148:151], a[80:83], v[52:55], v[148:151]
 buffer_load_dwordx4 v3, s[8:11], s21 offen offset:2048 sc1 lds
M v[156:159], a[88:91], v[52:55], v[156:159]
 v_exp_f32 v19, v65
M v[156:159], a[92:95], v[60:63], v[156:159]
 v_exp_f32 v20, v66
M v[152:155], a[92:95], v[56:59], v[152:155]
 buffer_load_dwordx4 v3, s[8:11], s21 offen offset:3072 sc1 lds
M v[152:155], a[88:91], v[48:51], v[152:155]
 s_waitcnt lgkmcnt(0)
 v_exp_f32 v21, v67
M v[160:163], a[96:99], v[48:51], v[160:163]
 ds_read_b128 a[64:67], v7 offset:16384
 v_add_f32 v26, v18, v19
M v[160:163], a[100:103], v[56:59], v[160:163]
 s_add_u32 m0, s28, 102400
 ds_read_b128 a[68:71], v7 offset:17408
 v_cvt_pk_bf16_f32 v40, v18, v19
M v[164:167], a[100:103], v[60:63], v[164:167]
 buffer_load_dwordx4 v4, s[8:11], s21 offen offset:0 sc1 lds
M v[164:167], a[96:99], v[52:55], v[164:167]
 s_cmp_eq_u32 s20, 2
 ds_read_b128 a[72:75], v7 offset:18432
 v_add_f32 v26, v20, v26
M v[172:175], a[104:107], v[52:55], v[172:175]
 s_cselect_b64 s[72:73], s[16:17], s[78:79]
 ds_read_b128 a[76:79], v7 offset:19456
 v_cvt_pk_bf16_f32 v41, v20, v21
M v[172:175], a[108:111], v[60:63], v[172:175]
 s_cselect_b64 s[74:75], s[18:19], s[78:79]
 v_exp_f32 v22, v72
M v[168:171], a[108:111], v[56:59], v[168:171]
 s_cselect_b64 s[76:77], s[48:49], s[78:79]
 ds_read_b128 a[80:83], v7 offset:20480
 v_add_f32 v26, v21, v26
M v[168:171], a[104:107], v[48:51], v[168:171]
 s_cselect_b64 s[78:79], s[50:51], s[78:79]
 ds_read_b128 a[84:87], v7 offset:21504
M v[176:179], a[112:115], v[48:51], v[176:179]
 buffer_load_dwordx4 v4, s[8:11], s21 offen offset:1024 sc1 lds
M v[176:179], a[116:119], v[56:59], v[176:179]
 s_cmp_gt_u32 s20, 1
 ds_read_b128 a[88:91], v7 offset:22528
M v[180:183], a[116:119], v[60:63], v[180:183]
 s_cselect_b64 s[86:87], -1, 0
 ds_read_b128 a[92:95], v7 offset:23552
M v[180:183], a[112:115], v[52:55], v[180:183]
 buffer_load_dwordx4 v4, s[8:11], s21 offen offset:2048 sc1 lds
M v[188:191], a[120:123], v[52:55], v[188:191]
 s_cmp_eq_u32 s20, 1
 v_exp_f32 v23, v73
M v[188:191], a[124:127], v[60:63], v[188:191]
 s_cselect_b64 s[80:81], s[16:17], s[86:87]
 v_exp_f32 v24, v74
M v[184:187], a[124:127], v[56:59], v[184:187]
 s_cselect_b64 s[82:83], s[18:19], s[86:87]
 v_exp_f32 v25, v75
M v[184:187], a[120:123], v[48:51], v[184:187]
 s_waitcnt lgkmcnt(0)
 v_exp_f32 v18, v68
M v[192:195], a[64:67], v[48:51], v[192:195]
 s_cselect_b64 s[84:85], s[48:49], s[86:87]
 ds_read_b128 a[96:99], v7 offset:24576
 v_add_f32 v26, v22, v26
M v[192:195], a[68:71], v[56:59], v[192:195]
 s_cselect_b64 s[86:87], s[50:51], s[86:87]
 ds_read_b128 a[100:103], v7 offset:25600
 v_cvt_pk_bf16_f32 v42, v22, v23
M v[196:199], a[68:71], v[60:63], v[196:199]
 buffer_load_dwordx4 v4, s[8:11], s21 offen offset:3072 sc1 lds
M v[196:199], a[64:67], v[52:55], v[196:199]
 s_add_u32 s24, s23, 16777216
 ds_read_b128 a[104:107], v7 offset:26624
 v_add_f32 v26, v23, v26
M v[204:207], a[72:75], v[52:55], v[204:207]
 s_mov_b32 s23, s21
 ds_read_b128 a[108:111], v7 offset:27648
 v_add_f32 v26, v24, v26
M v[204:207], a[76:79], v[60:63], v[204:207]
 s_add_u32 s21, s21, 32768
 v_exp_f32 v19, v69
M v[200:203], a[76:79], v[56:59], v[200:203]
 s_add_u32 s22, s22, 1
 ds_read_b128 a[112:115], v7 offset:28672
 v_cvt_pk_bf16_f32 v43, v24, v25
M v[200:203], a[72:75], v[48:51], v[200:203]
 s_cmp_eq_u32 s22, s25
 ds_read_b128 a[116:119], v7 offset:29696
 v_add_f32 v26, v25, v26
M v[208:211], a[80:83], v[48:51], v[208:211]
 s_cselect_b32 s21, s26, s21
 v_exp_f32 v20, v70
M v[208:211], a[84:87], v[56:59], v[208:211]
 s_cmp_eq_u32 s22, s43
 ds_read_b128 a[120:123], v7 offset:30720
 v_add_f32 v27, v18, v19
M v[212:215], a[84:87], v[60:63], v[212:215]
 s_cselect_b32 s21, s4, s21
 ds_read_b128 a[124:127], v7 offset:31744
 v_cvt_pk_bf16_f32 v44, v18, v19
M v[212:215], a[80:83], v[52:55], v[212:215]
 s_cmp_eq_u32 s22, s6
 v_exp_f32 v21, v71
M v[220:223], a[88:91], v[52:55], v[220:223]
 s_cselect_b32 s21, s7, s21
 v_exp_f32 v22, v76
M v[220:223], a[92:95], v[60:63], v[220:223]
 s_cmp_eq_u32 s20, 0
 v_exp_f32 v23, v77
M v[216:219], a[92:95], v[56:59], v[216:219]
 s_waitcnt vmcnt(16) lgkmcnt(0)
 v_exp_f32 v24, v78
M v[216:219], a[88:91], v[48:51], v[216:219]
 s_barrier
M v[224:227], a[96:99], v[48:51], v[224:227]
 s_cselect_b64 s[88:89], s[16:17], -1
 ds_read_b128 a[64:67], v7 offset:32768
 v_add_f32 v27, v20, v27
M v[224:227], a[100:103], v[56:59], v[224:227]
 s_cselect_b64 s[90:91], s[18:19], -1
 ds_read_b128 a[68:71], v7 offset:33792
 v_cvt_pk_bf16_f32 v45, v20, v21
M v[228:231], a[100:103], v[60:63], v[228:231]
 buffer_load_dword v5, off, s[8:11], s47 sc1
M v[228:231], a[96:99], v[52:55], v[228:231]
 s_cselect_b64 s[92:93], s[48:49], -1
 ds_read_b128 a[72:75], v7 offset:34816
 v_add_f32 v27, v21, v27
M v[236:239], a[104:107], v[52:55], v[236:239]
 s_cselect_b64 s[94:95], s[50:51], -1
 ds_read_b128 a[76:79], v7 offset:35840
 v_add_f32 v27, v22, v27
M v[236:239], a[108:111], v[60:63], v[236:239]
 v_cndmask_b32 v100, v36, v8, s[64:65]
 v_cndmask_b32 v101, v36, v8, s[66:67]
M v[232:235], a[108:111], v[56:59], v[232:235]
 ds_read_b128 a[80:83], v7 offset:36864
 v_cndmask_b32 v102, v36, v8, s[68:69]
M v[232:235], a[104:107], v[48:51], v[232:235]
 ds_read_b128 a[84:87], v7 offset:37888
 v_cndmask_b32 v103, v36, v8, s[70:71]
M v[240:243], a[112:115], v[48:51], v[240:243]
 v_cndmask_b32 v108, v36, v8, s[72:73]
 v_cndmask_b32 v109, v36, v8, s[74:75]
M v[240:243], a[116:119], v[56:59], v[240:243]
 ds_read_b128 a[88:91], v7 offset:38912
 v_cndmask_b32 v110, v36, v8, s[76:77]
M v[244:247], a[116:119], v[60:63], v[244:247]
 ds_read_b128 a[92:95], v7 offset:39936
 v_cndmask_b32 v111, v36, v8, s[78:79]
M v[244:247], a[112:115], v[52:55], v[244:247]
 v_cndmask_b32 v116, v36, v8, s[80:81]
 v_cndmask_b32 v117, v36, v8, s[82:83]
M v[252:255], a[120:123], v[52:55], v[252:255]
 v_cndmask_b32 v118, v36, v8, s[84:85]
 v_cndmask_b32 v119, v36, v8, s[86:87]
M v[252:255], a[124:127], v[60:63], v[252:255]
 v_cndmask_b32 v124, v36, v8, s[88:89]
 v_cndmask_b32 v125, v36, v8, s[90:91]
M v[248:251], a[124:127], v[56:59], v[248:251]
 s_waitcnt lgkmcnt(0)
 v_cndmask_b32 v126, v36, v8, s[92:93]
 v_cndmask_b32 v127, v36, v8, s[94:95]
M v[248:251], a[120:123], v[48:51], v[248:251]
 v_exp_f32 v25, v79
 v_cvt_pk_bf16_f32 v46, v22, v23
 v_add_f32 v27, v23, v27
 v_add_f32 v27, v24, v27
 v_cvt_pk_bf16_f32 v47, v24, v25
 v_add_f32 v27, v25, v27
L_p2:
M v[100:103], a[64:67], a[32:35], v[100:103]
 ds_read_b128 a[96:99], v7 offset:40960
 ds_read_b128 a[100:103], v7 offset:41984
 v_exp_f32 v18, v80
M v[100:103], a[68:71], a[36:39], v[100:103]
 ds_read_b128 a[104:107], v7 offset:43008
 v_exp_f32 v19, v81
M v[100:103], a[72:75], a[40:43], v[100:103]
 ds_read_b128 a[108:111], v7 offset:44032
 ds_read_b128 a[112:115], v7 offset:45056
 v_exp_f32 v20, v82
 v_add_f32 v26, v18, v26
M v[100:103], a[76:79], a[44:47], v[100:103]
 ds_read_b128 a[116:119], v7 offset:46080
 v_cvt_pk_bf16_f32 v56, v18, v19
 v_exp_f32 v21, v83
M v[100:103], a[80:83], a[48:51], v[100:103]
 s_add_u32 m0, s28, 0
 ds_read_b128 a[120:123], v7 offset:47104
 ds_read_b128 a[124:127], v7 offset:48128
 v_add_f32 v26, v19, v26
M v[100:103], a[84:87], a[52:55], v[100:103]
 buffer_load_dwordx4 v3, s[8:11], s24 offen offset:0 sc1 lds
M v[100:103], a[88:91], a[56:59], v[100:103]
 ds_read_b128 a[128:131], v7 offset:49152
 ds_read_b128 a[132:135], v7 offset:50176
 v_exp_f32 v22, v88
 v_add_f32 v26, v20, v26
 v_cvt_pk_bf16_f32 v57, v20, v21
M v[100:103], a[92:95], a[60:63], v[100:103]
 s_waitcnt lgkmcnt(2)
 ds_read_b128 a[136:139], v7 offset:51200
 v_exp_f32 v23, v89
 v_add_f32 v26, v21, v26
M v[108:111], a[124:127], a[60:63], v[108:111]
 ds_read_b128 a[140:143], v7 offset:52224
 ds_read_b128 a[144:147], v7 offset:53248
 v_exp_f32 v24, v90
M v[108:111], a[120:123], a[56:59], v[108:111]
 buffer_load_dwordx4 v3, s[8:11], s24 offen offset:1024 sc1 lds
M v[108:111], a[116:119], a[52:55], v[108:111]
 ds_read_b128 a[148:151], v7 offset:54272
 ds_read_b128 a[152:155], v7 offset:55296
 v_add_f32 v26, v22, v26
 v_cvt_pk_bf16_f32 v58, v22, v23
M v[108:111], a[112:115], a[48:51], v[108:111]
 ds_read_b128 a[156:159], v7 offset:56320
 v_exp_f32 v25, v91
 v_add_f32 v26, v23, v26
M v[108:111], a[108:111], a[44:47], v[108:111]
 ds_read_b128 a[160:163], v7 offset:57344
 ds_read_b128 a[164:167], v7 offset:58368
 v_exp_f32 v18, v84
M v[108:111], a[104:107], a[40:43], v[108:111]
 buffer_load_dwordx4 v3, s[8:11], s24 offen offset:2048 sc1 lds
M v[108:111], a[100:103], a[36:39], v[108:111]
 ds_read_b128 a[168:171], v7 offset:59392
 ds_read_b128 a[172:175], v7 offset:60416
 v_add_f32 v26, v24, v26
 v_cvt_pk_bf16_f32 v59, v24, v25
M v[108:111], a[96:99], a[32:35], v[108:111]
 s_waitcnt lgkmcnt(4)
 ds_read_b128 a[176:179], v7 offset:61440
 v_exp_f32 v19, v85
 v_add_f32 v26, v25, v26
M v[116:119], a[128:131], a[32:35], v[116:119]
 ds_read_b128 a[180:183], v7 offset:62464
 ds_read_b128 a[184:187], v7 offset:63488
 v_exp_f32 v20, v86
M v[116:119], a[132:135], a[36:39], v[116:119]
 ds_read_b128 a[188:191], v7 offset:64512
 v_add_f32 v27, v18, v27
 v_cvt_pk_bf16_f32 v60, v18, v19
M v[116:119], a[136:139], a[40:43], v[116:119]
 buffer_load_dwordx4 v3, s[8:11], s24 offen offset:3072 sc1 lds
M v[116:119], a[140:143], a[44:47], v[116:119]
 s_add_u32 m0, s28, 4096
 v_exp_f32 v21, v87
 v_add_f32 v27, v19, v27
 v_exp_f32 v22, v92
M v[116:119], a[144:147], a[48:51], v[116:119]
 buffer_load_dwordx4 v4, s[8:11], s24 offen offset:0 sc1 lds
M v[116:119], a[148:151], a[52:55], v[116:119]
 s_waitcnt vmcnt(14) lgkmcnt(0)
 v_add_f32 v27, v20, v27
 v_cvt_pk_bf16_f32 v61, v20, v21
 v_exp_f32 v23, v93
 v_add_f32 v27, v21, v27
M v[116:119], a[152:155], a[56:59], v[116:119]
 s_barrier
M v[116:119], a[156:159], a[60:63], v[116:119]
 ds_read_b128 a[64:67], v2 offset:0
 ds_read_b128 a[68:71], v2 offset:1024
 v_exp_f32 v24, v94
M v[124:127], a[188:191], a[60:63], v[124:127]
 ds_read_b128 a[72:75], v2 offset:2048
 v_add_f32 v27, v22, v27
 v_cvt_pk_bf16_f32 v62, v22, v23
M v[124:127], a[184:187], a[56:59], v[124:127]
 ds_read_b128 a[76:79], v2 offset:3072
 ds_read_b128 a[80:83], v2 offset:4096
 v_exp_f32 v25, v95
 v_add_f32 v27, v23, v27
M v[124:127], a[180:183], a[52:55], v[124:127]
 ds_read_b128 a[84:87], v2 offset:5120
 v_add_f32 v27, v24, v27
 v_cvt_pk_bf16_f32 v63, v24, v25
 v_add_f32 v27, v25, v27
M v[124:127], a[176:179], a[48:51], v[124:127]
 ds_read_b128 a[88:91], v2 offset:6144
 ds_read_b128 a[92:95], v2 offset:7168
 v_max_f32 v10, v26, v27
 v_cmp_lt_f32 vcc, s31, v10
M v[124:127], a[172:175], a[44:47], v[124:127]
 buffer_load_dwordx4 v4, s[8:11], s24 offen offset:1024 sc1 lds
M v[124:127], a[168:171], a[40:43], v[124:127]
 buffer_load_dwordx4 v4, s[8:11], s24 offen offset:2048 sc1 lds
M v[124:127], a[164:167], a[36:39], v[124:127]
 buffer_load_dwordx4 v4, s[8:11], s24 offen offset:3072 sc1 lds
M v[124:127], a[160:163], a[32:35], v[124:127]
 s_waitcnt lgkmcnt(0)
 s_cbranch_vccnz L_st6
L_rt6:
 s_cmp_gt_u32 s42, 5
 s_cbranch_scc1 L_p3o
L_p3k:
 s_mov_b32 s72, s32
 s_add_u32 s73, s72, 4096
 s_add_u32 s74, s72, 8192
 s_add_u32 s75, s72, 12288
 s_waitcnt vmcnt(8)
 v_cmp_ne_u32 vcc, 1, v5
 s_nop 0
 s_cbranch_vccnz L_fps1
L_fpr1:
M v[128:131], a[64:67], v[40:43], v[128:131]
 ds_read_b128 a[96:99], v2 offset:8192
 ds_read_b128 a[100:103], v2 offset:9216
M v[128:131], a[68:71], v[56:59], v[128:131]
 buffer_load_dwordx4 a[0:3], v7, s[8:11], s72 offen offset:0 sc1 nt
M v[132:135], a[68:71], v[60:63], v[132:135]
 v_exp_f32 v18, v100
M v[132:135], a[64:67], v[44:47], v[132:135]
 ds_read_b128 a[104:107], v2 offset:10240
 ds_read_b128 a[108:111], v2 offset:11264
M v[140:143], a[72:75], v[44:47], v[140:143]
 buffer_load_dwordx4 a[4:7], v7, s[8:11], s72 offen offset:1024 sc1 nt
M v[140:143], a[76:79], v[60:63], v[140:143]
 v_exp_f32 v19, v101
M v[136:139], a[76:79], v[56:59], v[136:139]
 ds_read_b128 a[112:115], v2 offset:12288
 ds_read_b128 a[116:119], v2 offset:13312
M v[136:139], a[72:75], v[40:43], v[136:139]
 buffer_load_dwordx4 a[8:11], v7, s[8:11], s72 offen offset:2048 sc1 nt
M v[144:147], a[80:83], v[40:43], v[144:147]
 v_exp_f32 v20, v102
M v[144:147], a[84:87], v[56:59], v[144:147]
 ds_read_b128 a[120:123], v2 offset:14336
 ds_read_b128 a[124:127], v2 offset:15360
M v[148:151], a[84:87], v[60:63], v[148:151]
 v_exp_f32 v21, v103
M v[148:151], a[80:83], v[44:47], v[148:151]
 buffer_load_dwordx4 a[12:15], v7, s[8:11], s72 offen offset:3072 sc1 nt
M v[156:159], a[88:91], v[44:47], v[156:159]
 v_add_f32 v30, v26, v30
 v_add_f32 v31, v27, v31
M v[156:159], a[92:95], v[60:63], v[156:159]
 v_add_f32 v29, v18, v19
 v_cvt_pk_bf16_f32 v52, v18, v19
M v[152:155], a[92:95], v[56:59], v[152:155]
 v_exp_f32 v22, v108
M v[152:155], a[88:91], v[40:43], v[152:155]
 s_waitcnt lgkmcnt(0)
 v_add_f32 v29, v20, v29
 v_cvt_pk_bf16_f32 v53, v20, v21
M v[160:163], a[96:99], v[40:43], v[160:163]
 ds_read_b128 a[64:67], v2 offset:16384
 ds_read_b128 a[68:71], v2 offset:17408
M v[160:163], a[100:103], v[56:59], v[160:163]
 buffer_load_dwordx4 a[16:19], v7, s[8:11], s73 offen offset:0 sc1 nt
M v[164:167], a[100:103], v[60:63], v[164:167]
 v_exp_f32 v23, v109
M v[164:167], a[96:99], v[44:47], v[164:167]
 ds_read_b128 a[72:75], v2 offset:18432
 ds_read_b128 a[76:79], v2 offset:19456
M v[172:175], a[104:107], v[44:47], v[172:175]
 buffer_load_dwordx4 a[20:23], v7, s[8:11], s73 offen offset:1024 sc1 nt
M v[172:175], a[108:111], v[60:63], v[172:175]
 v_exp_f32 v24, v110
M v[168:171], a[108:111], v[56:59], v[168:171]
 ds_read_b128 a[80:83], v2 offset:20480
 ds_read_b128 a[84:87], v2 offset:21504
M v[168:171], a[104:107], v[40:43], v[168:171]
 buffer_load_dwordx4 a[24:27], v7, s[8:11], s73 offen offset:2048 sc1 nt
M v[176:179], a[112:115], v[40:43], v[176:179]
 v_exp_f32 v25, v111
M v[176:179], a[116:119], v[56:59], v[176:179]
 ds_read_b128 a[88:91], v2 offset:22528
 ds_read_b128 a[92:95], v2 offset:23552
M v[180:183], a[116:119], v[60:63], v[180:183]
 buffer_load_dwordx4 a[28:31], v7, s[8:11], s73 offen offset:3072 sc1 nt
M v[180:183], a[112:115], v[44:47], v[180:183]
 v_add_f32 v29, v21, v29
 v_add_f32 v29, v22, v29
M v[188:191], a[120:123], v[44:47], v[188:191]
 v_exp_f32 v18, v116
M v[188:191], a[124:127], v[60:63], v[188:191]
 v_cvt_pk_bf16_f32 v54, v22, v23
 v_add_f32 v29, v23, v29
M v[184:187], a[124:127], v[56:59], v[184:187]
 buffer_load_dwordx4 a[32:35], v7, s[8:11], s74 offen offset:0 sc1 nt
M v[184:187], a[120:123], v[40:43], v[184:187]
 s_waitcnt lgkmcnt(0)
 v_exp_f32 v19, v117
M v[192:195], a[64:67], v[40:43], v[192:195]
 ds_read_b128 a[96:99], v2 offset:24576
 ds_read_b128 a[100:103], v2 offset:25600
M v[192:195], a[68:71], v[56:59], v[192:195]
 buffer_load_dwordx4 a[36:39], v7, s[8:11], s74 offen offset:1024 sc1 nt
M v[196:199], a[68:71], v[60:63], v[196:199]
 v_add_f32 v29, v24, v29
 v_cvt_pk_bf16_f32 v55, v24, v25
M v[196:199], a[64:67], v[44:47], v[196:199]
 ds_read_b128 a[104:107], v2 offset:26624
 ds_read_b128 a[108:111], v2 offset:27648
M v[204:207], a[72:75], v[44:47], v[204:207]
 v_exp_f32 v20, v118
M v[204:207], a[76:79], v[60:63], v[204:207]
 buffer_load_dwordx4 a[40:43], v7, s[8:11], s74 offen offset:2048 sc1 nt
M v[200:203], a[76:79], v[56:59], v[200:203]
 ds_read_b128 a[112:115], v2 offset:28672
 ds_read_b128 a[116:119], v2 offset:29696
M v[200:203], a[72:75], v[40:43], v[200:203]
 v_exp_f32 v21, v119
M v[208:211], a[80:83], v[40:43], v[208:211]
 v_add_f32 v29, v25, v29
 v_add_f32 v29, v18, v29
M v[208:211], a[84:87], v[56:59], v[208:211]
 ds_read_b128 a[120:123], v2 offset:30720
 ds_read_b128 a[124:127], v2 offset:31744
M v[212:215], a[84:87], v[60:63], v[212:215]
 buffer_load_dwordx4 a[44:47], v7, s[8:11], s74 offen offset:3072 sc1 nt
M v[212:215], a[80:83], v[44:47], v[212:215]
 v_exp_f32 v22, v124
M v[220:223], a[88:91], v[44:47], v[220:223]
 v_cvt_pk_bf16_f32 v48, v18, v19
 v_add_f32 v29, v19, v29
M v[220:223], a[92:95], v[60:63], v[220:223]
 buffer_load_dwordx4 a[48:51], v7, s[8:11], s75 offen offset:0 sc1 nt
M v[216:219], a[92:95], v[56:59], v[216:219]
 s_waitcnt vmcnt(13) lgkmcnt(0)
 v_exp_f32 v23, v125
M v[216:219], a[88:91], v[40:43], v[216:219]
 s_barrier
M v[224:227], a[96:99], v[40:43], v[224:227]
 ds_read_b128 a[64:67], v7 offset:0
 ds_read_b128 a[68:71], v7 offset:1024
M v[224:227], a[100:103], v[56:59], v[224:227]
 buffer_load_dwordx4 a[52:55], v7, s[8:11], s75 offen offset:1024 sc1 nt
M v[228:231], a[100:103], v[60:63], v[228:231]
 v_exp_f32 v24, v126
M v[228:231], a[96:99], v[44:47], v[228:231]
 ds_read_b128 a[72:75], v7 offset:2048
 ds_read_b128 a[76:79], v7 offset:3072
M v[236:239], a[104:107], v[44:47], v[236:239]
 buffer_load_dwordx4 a[56:59], v7, s[8:11], s75 offen offset:2048 sc1 nt
M v[236:239], a[108:111], v[60:63], v[236:239]
 v_exp_f32 v25, v127
M v[232:235], a[108:111], v[56:59], v[232:235]
 ds_read_b128 a[80:83], v7 offset:4096
 ds_read_b128 a[84:87], v7 offset:5120
M v[232:235], a[104:107], v[40:43], v[232:235]
 v_add_f32 v29, v20, v29
 v_cvt_pk_bf16_f32 v49, v20, v21
M v[240:243], a[112:115], v[40:43], v[240:243]
 buffer_load_dwordx4 a[60:63], v7, s[8:11], s75 offen offset:3072 sc1 nt
M v[240:243], a[116:119], v[56:59], v[240:243]
 ds_read_b128 a[88:91], v7 offset:6144
 ds_read_b128 a[92:95], v7 offset:7168
M v[244:247], a[116:119], v[60:63], v[244:247]
 v_add_f32 v29, v21, v29
 v_add_f32 v29, v22, v29
M v[244:247], a[112:115], v[44:47], v[244:247]
 v_cvt_pk_bf16_f32 v50, v22, v23
 v_add_f32 v29, v23, v29
M v[252:255], a[120:123], v[44:47], v[252:255]
 v_add_f32 v29, v24, v29
 v_cvt_pk_bf16_f32 v51, v24, v25
M v[252:255], a[124:127], v[60:63], v[252:255]
 v_add_f32 v29, v25, v29
M v[248:251], a[124:127], v[56:59], v[248:251]
 s_waitcnt lgkmcnt(0)
M v[248:251], a[120:123], v[40:43], v[248:251]
 v_cmp_lt_f32 vcc, s31, v29
 s_nop 0
 s_cbranch_vccnz L_st7
L_rt7:
M v[132:135], a[64:67], v[52:55], v[132:135]
 ds_read_b128 a[96:99], v7 offset:8192
 ds_read_b128 a[100:103], v7 offset:9216
M v[132:135], a[68:71], v[48:51], v[132:135]
 ds_read_b128 a[104:107], v7 offset:10240
 v_add_f32 v31, v29, v31
M v[140:143], a[76:79], v[48:51], v[140:143]
 s_sub_u32 s27, 5, s42
 ds_read_b128 a[108:111], v7 offset:11264
 ds_read_b128 a[112:115], v7 offset:12288
M v[140:143], a[72:75], v[52:55], v[140:143]
 s_mov_b32 s40, 0
 ds_read_b128 a[116:119], v7 offset:13312
 v_mov_b32 v10, v30
M v[148:151], a[80:83], v[52:55], v[148:151]
 s_add_u32 m0, s28, 32768
 ds_read_b128 a[120:123], v7 offset:14336
 ds_read_b128 a[124:127], v7 offset:15360
M v[148:151], a[84:87], v[48:51], v[148:151]
 buffer_load_dwordx4 v3, s[8:11], s21 offen offset:0 sc1 lds
M v[156:159], a[92:95], v[48:51], v[156:159]
 ds_read_b128 a[128:131], v7 offset:16384
 ds_read_b128 a[132:135], v7 offset:17408
M v[156:159], a[88:91], v[52:55], v[156:159]
 s_waitcnt lgkmcnt(2)
 ds_read_b128 a[136:139], v7 offset:18432
 v_mov_b32 v11, v31
M v[164:167], a[96:99], v[52:55], v[164:167]
 ds_read_b128 a[140:143], v7 offset:19456
 ds_read_b128 a[144:147], v7 offset:20480
M v[164:167], a[100:103], v[48:51], v[164:167]
 buffer_load_dwordx4 v3, s[8:11], s21 offen offset:1024 sc1 lds
M v[172:175], a[108:111], v[48:51], v[172:175]
 ds_read_b128 a[148:151], v7 offset:21504
 ds_read_b128 a[152:155], v7 offset:22528
M v[172:175], a[104:107], v[52:55], v[172:175]
 ds_read_b128 a[156:159], v7 offset:23552
 v_permlane16_swap_b32 v10, v30
M v[180:183], a[112:115], v[52:55], v[180:183]
 ds_read_b128 a[160:163], v7 offset:24576
 ds_read_b128 a[164:167], v7 offset:25600
M v[180:183], a[116:119], v[48:51], v[180:183]
 buffer_load_dwordx4 v3, s[8:11], s21 offen offset:2048 sc1 lds
M v[188:191], a[124:127], v[48:51], v[188:191]
 ds_read_b128 a[168:171], v7 offset:26624
 ds_read_b128 a[172:175], v7 offset:27648
M v[188:191], a[120:123], v[52:55], v[188:191]
 s_waitcnt lgkmcnt(4)
 ds_read_b128 a[176:179], v7 offset:28672
 v_permlane16_swap_b32 v11, v31
M v[196:199], a[128:131], v[52:55], v[196:199]
 ds_read_b128 a[180:183], v7 offset:29696
 ds_read_b128 a[184:187], v7 offset:30720
M v[196:199], a[132:135], v[48:51], v[196:199]
 ds_read_b128 a[188:191], v7 offset:31744
 v_add_f32 v30, v10, v30
M v[204:207], a[140:143], v[48:51], v[204:207]
 buffer_load_dwordx4 v3, s[8:11], s21 offen offset:3072 sc1 lds
M v[204:207], a[136:139], v[52:55], v[204:207]
 s_add_u32 m0, s28, 36864
 v_add_f32 v31, v11, v31
 v_mov_b32 v10, v30
M v[212:215], a[144:147], v[52:55], v[212:215]
 buffer_load_dwordx4 v4, s[8:11], s21 offen offset:0 sc1 lds
M v[212:215], a[148:151], v[48:51], v[212:215]
 s_waitcnt lgkmcnt(0)
 v_mov_b32 v11, v31
 v_permlane32_swap_b32 v10, v30
M v[220:223], a[156:159], v[48:51], v[220:223]
 s_barrier
M v[220:223], a[152:155], v[52:55], v[220:223]
 ds_read_b128 a[64:67], v2 offset:32768
 ds_read_b128 a[68:71], v2 offset:33792
M v[228:231], a[160:163], v[52:55], v[228:231]
 ds_read_b128 a[72:75], v2 offset:34816
 v_permlane32_swap_b32 v11, v31
M v[228:231], a[164:167], v[48:51], v[228:231]
 ds_read_b128 a[76:79], v2 offset:35840
 ds_read_b128 a[80:83], v2 offset:36864
M v[236:239], a[172:175], v[48:51], v[236:239]
 ds_read_b128 a[84:87], v2 offset:37888
 v_add_f32 v30, v10, v30
M v[236:239], a[168:171], v[52:55], v[236:239]
 ds_read_b128 a[88:91], v2 offset:38912
 ds_read_b128 a[92:95], v2 offset:39936
M v[244:247], a[176:179], v[52:55], v[244:247]
 buffer_load_dwordx4 v4, s[8:11], s21 offen offset:1024 sc1 lds
M v[244:247], a[180:183], v[48:51], v[244:247]
 buffer_load_dwordx4 v4, s[8:11], s21 offen offset:2048 sc1 lds
M v[252:255], a[188:191], v[48:51], v[252:255]
 buffer_load_dwordx4 v4, s[8:11], s21 offen offset:3072 sc1 lds
M v[252:255], a[184:187], v[52:55], v[252:255]
 s_waitcnt lgkmcnt(0)
 s_add_u32 s24, s23, 16777216
 s_mov_b32 s23, s21
 s_add_u32 s21, s21, 32768
 s_add_u32 s22, s22, 1
 s_cmp_eq_u32 s22, s25
 s_cselect_b32 s21, s26, s21
 s_cmp_eq_u32 s22, s43
 s_cselect_b32 s21, s4, s21
 s_cmp_eq_u32 s22, s6
 s_cselect_b32 s21, s7, s21
 v_add_f32 v31, v11, v31
 v_rcp_f32 v5, v30
 v_rcp_f32 v6, v31
 v_accvgpr_write_b32 a192, v5
 v_accvgpr_write_b32 a193, v6
 v_mov_b32 v30, 0
 v_mov_b32 v31, 0
 v_mov_b32 v32, 0xc1800000
 v_mov_b32 v33, 0xc1800000
 v_mov_b32 v34, 0xc1800000
 v_mov_b32 v35, 0xc1800000
 v_mov_b32 v36, 0xc1800000
 v_mov_b32 v37, 0xc1800000
 v_mov_b32 v38, 0xc1800000
 v_mov_b32 v39, 0xc1800000
 s_waitcnt vmcnt(8)
M v[64:67], a[64:67], a[0:3], v[32:35]
 ds_read_b128 a[96:99], v2 offset:40960
 v_cvt_pk_bf16_f32 v128, v128, v129
M v[64:67], a[68:71], a[4:7], v[64:67]
 ds_read_b128 a[100:103], v2 offset:41984
 v_cvt_pk_bf16_f32 v129, v130, v131
M v[64:67], a[72:75], a[8:11], v[64:67]
 buffer_load_dword v6, v9, s[8:11], s46 offen sc1
M v[64:67], a[76:79], a[12:15], v[64:67]
 ds_read_b128 a[104:107], v2 offset:43008
 v_cvt_pk_bf16_f32 v130, v136, v137
M v[64:67], a[80:83], a[16:19], v[64:67]
 s_add_u32 m0, s28, 65536
 ds_read_b128 a[108:111], v2 offset:44032
 v_cvt_pk_bf16_f32 v131, v138, v139
M v[64:67], a[84:87], a[20:23], v[64:67]
 buffer_load_dwordx4 v3, s[8:11], s24 offen offset:0 sc1 lds
M v[64:67], a[88:91], a[24:27], v[64:67]
 ds_read_b128 a[112:115], v2 offset:45056
 v_accvgpr_write_b32 a128, v128
M v[64:67], a[92:95], a[28:31], v[64:67]
 ds_read_b128 a[116:119], v2 offset:46080
 v_accvgpr_write_b32 a129, v129
M v[68:71], a[92:95], a[60:63], v[36:39]
 buffer_load_dwordx4 v3, s[8:11], s24 offen offset:1024 sc1 lds
M v[68:71], a[88:91], a[56:59], v[68:71]
 ds_read_b128 a[120:123], v2 offset:47104
 v_accvgpr_write_b32 a130, v130
M v[68:71], a[84:87], a[52:55], v[68:71]
 ds_read_b128 a[124:127], v2 offset:48128
 v_accvgpr_write_b32 a131, v131
M v[68:71], a[80:83], a[48:51], v[68:71]
 v_exp_f32 v18, v64
M v[68:71], a[76:79], a[44:47], v[68:71]
 v_exp_f32 v19, v65
M v[68:71], a[72:75], a[40:43], v[68:71]
 buffer_load_dwordx4 v3, s[8:11], s24 offen offset:2048 sc1 lds
M v[68:71], a[68:71], a[36:39], v[68:71]
 v_exp_f32 v20, v66
M v[68:71], a[64:67], a[32:35], v[68:71]
 s_waitcnt lgkmcnt(0)
 v_exp_f32 v21, v67
M v[72:75], a[96:99], a[0:3], v[32:35]
 ds_read_b128 a[64:67], v2 offset:49152
 v_add_f32 v26, v18, v19
M v[72:75], a[100:103], a[4:7], v[72:75]
 ds_read_b128 a[68:71], v2 offset:50176
 v_cvt_pk_bf16_f32 v40, v18, v19
M v[72:75], a[104:107], a[8:11], v[72:75]
 buffer_load_dwordx4 v3, s[8:11], s24 offen offset:3072 sc1 lds
M v[72:75], a[108:111], a[12:15], v[72:75]
 ds_read_b128 a[72:75], v2 offset:51200
 v_add_f32 v26, v20, v26
M v[72:75], a[112:115], a[16:19], v[72:75]
 ds_read_b128 a[76:79], v2 offset:52224
 v_cvt_pk_bf16_f32 v41, v20, v21
M v[72:75], a[116:119], a[20:23], v[72:75]
 v_exp_f32 v22, v68
M v[72:75], a[120:123], a[24:27], v[72:75]
 ds_read_b128 a[80:83], v2 offset:53248
 v_add_f32 v26, v21, v26
M v[72:75], a[124:127], a[28:31], v[72:75]
 s_add_u32 m0, s28, 69632
 ds_read_b128 a[84:87], v2 offset:54272
 v_cvt_pk_bf16_f32 v132, v132, v133
M v[76:79], a[124:127], a[60:63], v[36:39]
 buffer_load_dwordx4 v4, s[8:11], s24 offen offset:0 sc1 lds
M v[76:79], a[120:123], a[56:59], v[76:79]
 ds_read_b128 a[88:91], v2 offset:55296
 v_cvt_pk_bf16_f32 v133, v134, v135
M v[76:79], a[116:119], a[52:55], v[76:79]
 ds_read_b128 a[92:95], v2 offset:56320
 v_cvt_pk_bf16_f32 v134, v140, v141
M v[76:79], a[112:115], a[48:51], v[76:79]
 v_exp_f32 v23, v69
M v[76:79], a[108:111], a[44:47], v[76:79]
 buffer_load_dwordx4 v4, s[8:11], s24 offen offset:1024 sc1 lds
M v[76:79], a[104:107], a[40:43], v[76:79]
 v_exp_f32 v24, v70
M v[76:79], a[100:103], a[36:39], v[76:79]
 v_exp_f32 v25, v71
M v[76:79], a[96:99], a[32:35], v[76:79]
 s_waitcnt lgkmcnt(0)
 v_exp_f32 v18, v72
M v[80:83], a[64:67], a[0:3], v[32:35]
 ds_read_b128 a[96:99], v2 offset:57344
 v_add_f32 v27, v22, v23
M v[80:83], a[68:71], a[4:7], v[80:83]
 ds_read_b128 a[100:103], v2 offset:58368
 v_cvt_pk_bf16_f32 v44, v22, v23
M v[80:83], a[72:75], a[8:11], v[80:83]
 buffer_load_dwordx4 v4, s[8:11], s24 offen offset:2048 sc1 lds
M v[80:83], a[76:79], a[12:15], v[80:83]
 ds_read_b128 a[104:107], v2 offset:59392
 v_add_f32 v27, v24, v27
M v[80:83], a[80:83], a[16:19], v[80:83]
 ds_read_b128 a[108:111], v2 offset:60416
 v_cvt_pk_bf16_f32 v45, v24, v25
M v[80:83], a[84:87], a[20:23], v[80:83]
 v_exp_f32 v19, v73
M v[80:83], a[88:91], a[24:27], v[80:83]
 ds_read_b128 a[112:115], v2 offset:61440
 v_add_f32 v27, v25, v27
M v[80:83], a[92:95], a[28:31], v[80:83]
 ds_read_b128 a[116:119], v2 offset:62464
 v_add_f32 v26, v18, v26
M v[84:87], a[92:95], a[60:63], v[36:39]
 s_waitcnt vmcnt(7)
 v_cmp_gt_u32 vcc, 3, v6
 v_cvt_pk_bf16_f32 v42, v18, v19
M v[84:87], a[88:91], a[56:59], v[84:87]
 ds_read_b128 a[120:123], v2 offset:63488
 v_add_f32 v26, v19, v26
M v[84:87], a[84:87], a[52:55], v[84:87]
 ds_read_b128 a[124:127], v2 offset:64512
 v_cvt_pk_bf16_f32 v135, v142, v143
M v[84:87], a[80:83], a[48:51], v[84:87]
 s_cbranch_vccnz L_f2s
L_f2r:
 v_exp_f32 v20, v74
M v[84:87], a[76:79], a[44:47], v[84:87]
 buffer_load_dwordx4 v4, s[8:11], s24 offen offset:3072 sc1 lds
M v[84:87], a[72:75], a[40:43], v[84:87]
 v_exp_f32 v21, v75
M v[84:87], a[68:71], a[36:39], v[84:87]
 s_waitcnt lgkmcnt(0)
 v_exp_f32 v22, v76
M v[84:87], a[64:67], a[32:35], v[84:87]
 s_barrier
M v[88:91], a[96:99], a[0:3], v[32:35]
 ds_read_b128 a[64:67], v7 offset:32768
 v_add_f32 v26, v20, v26
M v[88:91], a[100:103], a[4:7], v[88:91]
 ds_read_b128 a[68:71], v7 offset:33792
 v_cvt_pk_bf16_f32 v43, v20, v21
M v[88:91], a[104:107], a[8:11], v[88:91]
 v_exp_f32 v23, v77
M v[88:91], a[108:111], a[12:15], v[88:91]
 ds_read_b128 a[72:75], v7 offset:34816
 v_add_f32 v26, v21, v26
M v[88:91], a[112:115], a[16:19], v[88:91]
 ds_read_b128 a[76:79], v7 offset:35840
 v_add_f32 v27, v22, v27
M v[88:91], a[116:119], a[20:23], v[88:91]
 v_exp_f32 v24, v78
M v[88:91], a[120:123], a[24:27], v[88:91]
 ds_read_b128 a[80:83], v7 offset:36864
 v_cvt_pk_bf16_f32 v46, v22, v23
M v[88:91], a[124:127], a[28:31], v[88:91]
 ds_read_b128 a[84:87], v7 offset:37888
 v_add_f32 v27, v23, v27
M v[92:95], a[124:127], a[60:63], v[36:39]
 v_exp_f32 v25, v79
M v[92:95], a[120:123], a[56:59], v[92:95]
 ds_read_b128 a[88:91], v7 offset:38912
 v_add_f32 v27, v24, v27
M v[92:95], a[116:119], a[52:55], v[92:95]
 ds_read_b128 a[92:95], v7 offset:39936
 v_cvt_pk_bf16_f32 v47, v24, v25
M v[92:95], a[112:115], a[48:51], v[92:95]
 v_add_f32 v27, v25, v27
 v_accvgpr_write_b32 a160, v132
M v[92:95], a[108:111], a[44:47], v[92:95]
 v_accvgpr_write_b32 a161, v133
 v_accvgpr_write_b32 a162, v134
M v[92:95], a[104:107], a[40:43], v[92:95]
 v_accvgpr_write_b32 a163, v135
 v_cvt_pk_bf16_f32 v144, v144, v145
M v[92:95], a[100:103], a[36:39], v[92:95]
 s_waitcnt lgkmcnt(0)
 v_cvt_pk_bf16_f32 v145, v146, v147
 v_cvt_pk_bf16_f32 v146, v152, v153
M v[92:95], a[96:99], a[32:35], v[92:95]
 v_cvt_pk_bf16_f32 v147, v154, v155
 v_accvgpr_write_b32 a132, v144
M v[96:99], a[64:67], a[0:3], v[32:35]
 s_add_u32 m0, s28, 98304
 ds_read_b128 a[96:99], v7 offset:40960
 v_accvgpr_write_b32 a133, v145
M v[96:99], a[68:71], a[4:7], v[96:99]
 ds_read_b128 a[100:103], v7 offset:41984
 v_accvgpr_write_b32 a134, v146
M v[96:99], a[72:75], a[8:11], v[96:99]
 buffer_load_dwordx4 v3, s[8:11], s21 offen offset:0 sc1 lds
M v[96:99], a[76:79], a[12:15], v[96:99]
 ds_read_b128 a[104:107], v7 offset:43008
 v_accvgpr_write_b32 a135, v147
M v[96:99], a[80:83], a[16:19], v[96:99]
 ds_read_b128 a[108:111], v7 offset:44032
 v_cvt_pk_bf16_f32 v148, v148, v149
M v[96:99], a[84:87], a[20:23], v[96:99]
 buffer_load_dwordx4 v3, s[8:11], s21 offen offset:1024 sc1 lds
M v[96:99], a[88:91], a[24:27], v[96:99]
 ds_read_b128 a[112:115], v7 offset:45056
 v_cvt_pk_bf16_f32 v149, v150, v151
M v[96:99], a[92:95], a[28:31], v[96:99]
 ds_read_b128 a[116:119], v7 offset:46080
 v_cvt_pk_bf16_f32 v150, v156, v157
M v[100:103], a[92:95], a[60:63], v[36:39]
 v_exp_f32 v18, v80
M v[100:103], a[88:91], a[56:59], v[100:103]
 ds_read_b128 a[120:123], v7 offset:47104
 v_cvt_pk_bf16_f32 v151, v158, v159
M v[100:103], a[84:87], a[52:55], v[100:103]
 ds_read_b128 a[124:127], v7 offset:48128
 v_accvgpr_write_b32 a164, v148
M v[100:103], a[80:83], a[48:51], v[100:103]
 buffer_load_dwordx4 v3, s[8:11], s21 offen offset:2048 sc1 lds
M v[100:103], a[76:79], a[44:47], v[100:103]
 v_exp_f32 v19, v81
M v[100:103], a[72:75], a[40:43], v[100:103]
 v_exp_f32 v20, v82
M v[100:103], a[68:71], a[36:39], v[100:103]
 v_exp_f32 v21, v83
M v[100:103], a[64:67], a[32:35], v[100:103]
 s_waitcnt lgkmcnt(0)
 v_exp_f32 v22, v88
M v[108:111], a[96:99], a[32:35], v[36:39]
 ds_read_b128 a[64:67], v7 offset:49152
 v_add_f32 v26, v18, v26
M v[108:111], a[100:103], a[36:39], v[108:111]
 ds_read_b128 a[68:71], v7 offset:50176
 v_cvt_pk_bf16_f32 v56, v18, v19
M v[108:111], a[104:107], a[40:43], v[108:111]
 buffer_load_dwordx4 v3, s[8:11], s21 offen offset:3072 sc1 lds
M v[108:111], a[108:111], a[44:47], v[108:111]
 s_add_u32 m0, s28, 102400
 ds_read_b128 a[72:75], v7 offset:51200
 v_add_f32 v26, v19, v26
M v[108:111], a[112:115], a[48:51], v[108:111]
 ds_read_b128 a[76:79], v7 offset:52224
 v_add_f32 v26, v20, v26
M v[108:111], a[116:119], a[52:55], v[108:111]
 buffer_load_dwordx4 v4, s[8:11], s21 offen offset:0 sc1 lds
M v[108:111], a[120:123], a[56:59], v[108:111]
 ds_read_b128 a[80:83], v7 offset:53248
 v_cvt_pk_bf16_f32 v57, v20, v21
M v[108:111], a[124:127], a[60:63], v[108:111]
 ds_read_b128 a[84:87], v7 offset:54272
 v_add_f32 v26, v21, v26
M v[104:107], a[124:127], a[28:31], v[32:35]
 v_exp_f32 v23, v89
M v[104:107], a[120:123], a[24:27], v[104:107]
 ds_read_b128 a[88:91], v7 offset:55296
 v_add_f32 v26, v22, v26
M v[104:107], a[116:119], a[20:23], v[104:107]
 ds_read_b128 a[92:95], v7 offset:56320
 v_cvt_pk_bf16_f32 v58, v22, v23
M v[104:107], a[112:115], a[16:19], v[104:107]
 buffer_load_dwordx4 v4, s[8:11], s21 offen offset:1024 sc1 lds
M v[104:107], a[108:111], a[12:15], v[104:107]
 v_exp_f32 v24, v90
M v[104:107], a[104:107], a[8:11], v[104:107]
 v_exp_f32 v25, v91
M v[104:107], a[100:103], a[4:7], v[104:107]
 buffer_load_dwordx4 v4, s[8:11], s21 offen offset:2048 sc1 lds
M v[104:107], a[96:99], a[0:3], v[104:107]
 s_waitcnt lgkmcnt(0)
 v_exp_f32 v18, v84
M v[112:115], a[64:67], a[0:3], v[32:35]
 ds_read_b128 a[96:99], v7 offset:57344
 v_add_f32 v26, v23, v26
M v[112:115], a[68:71], a[4:7], v[112:115]
 ds_read_b128 a[100:103], v7 offset:58368
 v_add_f32 v26, v24, v26
M v[112:115], a[72:75], a[8:11], v[112:115]
 v_exp_f32 v19, v85
M v[112:115], a[76:79], a[12:15], v[112:115]
 ds_read_b128 a[104:107], v7 offset:59392
 v_cvt_pk_bf16_f32 v59, v24, v25
M v[112:115], a[80:83], a[16:19], v[112:115]
 ds_read_b128 a[108:111], v7 offset:60416
 v_add_f32 v26, v25, v26
M v[112:115], a[84:87], a[20:23], v[112:115]
 buffer_load_dwordx4 v4, s[8:11], s21 offen offset:3072 sc1 lds
M v[112:115], a[88:91], a[24:27], v[112:115]
 s_add_u32 s24, s23, 16777216
 ds_read_b128 a[112:115], v7 offset:61440
 v_add_f32 v27, v18, v27
M v[112:115], a[92:95], a[28:31], v[112:115]
 s_mov_b32 s23, s21
 ds_read_b128 a[116:119], v7 offset:62464
 v_cvt_pk_bf16_f32 v60, v18, v19
M v[116:119], a[92:95], a[60:63], v[36:39]
 s_add_u32 s21, s21, 32768
 v_exp_f32 v20, v86
M v[116:119], a[88:91], a[56:59], v[116:119]
 s_add_u32 s22, s22, 1
 ds_read_b128 a[120:123], v7 offset:63488
 v_add_f32 v27, v19, v27
M v[116:119], a[84:87], a[52:55], v[116:119]
 s_cmp_eq_u32 s22, s25
 ds_read_b128 a[124:127], v7 offset:64512
 v_accvgpr_write_b32 a165, v149
M v[116:119], a[80:83], a[48:51], v[116:119]
 s_cselect_b32 s21, s26, s21
 v_exp_f32 v21, v87
M v[116:119], a[76:79], a[44:47], v[116:119]
 s_cmp_eq_u32 s22, s43
 v_exp_f32 v22, v92
M v[116:119], a[72:75], a[40:43], v[116:119]
 s_cselect_b32 s21, s4, s21
 v_exp_f32 v23, v93
M v[116:119], a[68:71], a[36:39], v[116:119]
 s_waitcnt vmcnt(8) lgkmcnt(0)
 v_add_f32 v27, v20, v27
 v_cvt_pk_bf16_f32 v61, v20, v21
M v[116:119], a[64:67], a[32:35], v[116:119]
 s_barrier
M v[124:127], a[96:99], a[32:35], v[36:39]
 s_cmp_eq_u32 s22, s6
 ds_read_b128 a[64:67], v2 offset:0
 v_add_f32 v27, v21, v27
M v[124:127], a[100:103], a[36:39], v[124:127]
 s_cselect_b32 s21, s7, s21
 ds_read_b128 a[68:71], v2 offset:1024
 v_add_f32 v27, v22, v27
M v[124:127], a[104:107], a[40:43], v[124:127]
 v_exp_f32 v24, v94
M v[124:127], a[108:111], a[44:47], v[124:127]
 ds_read_b128 a[72:75], v2 offset:2048
 v_cvt_pk_bf16_f32 v62, v22, v23
M v[124:127], a[112:115], a[48:51], v[124:127]
 ds_read_b128 a[76:79], v2 offset:3072
 v_add_f32 v27, v23, v27
M v[124:127], a[116:119], a[52:55], v[124:127]
 v_exp_f32 v25, v95
M v[124:127], a[120:123], a[56:59], v[124:127]
 ds_read_b128 a[80:83], v2 offset:4096
 v_add_f32 v27, v24, v27
M v[124:127], a[124:127], a[60:63], v[124:127]
 ds_read_b128 a[84:87], v2 offset:5120
 v_cvt_pk_bf16_f32 v63, v24, v25
M v[120:123], a[124:127], a[28:31], v[32:35]
 v_add_f32 v27, v25, v27
 v_accvgpr_write_b32 a166, v150
M v[120:123], a[120:123], a[24:27], v[120:123]
 ds_read_b128 a[88:91], v2 offset:6144
 v_max_f32 v10, v26, v27
M v[120:123], a[116:119], a[20:23], v[120:123]
 ds_read_b128 a[92:95], v2 offset:7168
 v_min_f32 v11, v26, v27
M v[120:123], a[112:115], a[16:19], v[120:123]
 v_cmp_lt_f32 s[36:37], s31, v10
 v_accvgpr_write_b32 a167, v151
M v[120:123], a[108:111], a[12:15], v[120:123]
 v_cmp_gt_f32 vcc, s55, v11
 v_cvt_pk_bf16_f32 v160, v160, v161
M v[120:123], a[104:107], a[8:11], v[120:123]
 v_cvt_pk_bf16_f32 v161, v162, v163
 v_cvt_pk_bf16_f32 v162, v168, v169
M v[120:123], a[100:103], a[4:7], v[120:123]
 s_waitcnt lgkmcnt(0)
 s_or_b64 vcc, vcc, s[36:37]
M v[120:123], a[96:99], a[0:3], v[120:123]
 s_cbranch_vccnz L_st11
L_rt11:
 v_cvt_pk_bf16_f32 v163, v170, v171
 v_accvgpr_write_b32 a136, v160
 v_accvgpr_write_b32 a137, v161
 v_accvgpr_write_b32 a138, v162
 v_accvgpr_write_b32 a139, v163
 v_cvt_pk_bf16_f32 v164, v164, v165
 v_cvt_pk_bf16_f32 v165, v166, v167
 v_cvt_pk_bf16_f32 v166, v172, v173
 v_cvt_pk_bf16_f32 v167, v174, v175
 v_accvgpr_write_b32 a168, v164
 v_accvgpr_write_b32 a169, v165
 v_accvgpr_write_b32 a170, v166
 v_accvgpr_write_b32 a171, v167
 v_cvt_pk_bf16_f32 v176, v176, v177
 v_cvt_pk_bf16_f32 v177, v178, v179
 v_cvt_pk_bf16_f32 v178, v184, v185
 v_cvt_pk_bf16_f32 v179, v186, v187
 v_accvgpr_write_b32 a140, v176
 v_accvgpr_write_b32 a141, v177
 v_accvgpr_write_b32 a142, v178
 v_accvgpr_write_b32 a143, v179
 v_cvt_pk_bf16_f32 v180, v180, v181
 v_cvt_pk_bf16_f32 v181, v182, v183
 v_cvt_pk_bf16_f32 v182, v188, v189
 v_cvt_pk_bf16_f32 v183, v190, v191
 v_accvgpr_write_b32 a172, v180
 v_accvgpr_write_b32 a173, v181
 v_accvgpr_write_b32 a174, v182
 v_accvgpr_write_b32 a175, v183
 v_cvt_pk_bf16_f32 v192, v192, v193
 v_cvt_pk_bf16_f32 v193, v194, v195
 v_cvt_pk_bf16_f32 v194, v200, v201
 v_cvt_pk_bf16_f32 v195, v202, v203
 v_accvgpr_write_b32 a144, v192
 v_accvgpr_write_b32 a145, v193
 v_accvgpr_write_b32 a146, v194
 v_accvgpr_write_b32 a147, v195
 v_cvt_pk_bf16_f32 v196, v196, v197
 v_cvt_pk_bf16_f32 v197, v198, v199
 v_cvt_pk_bf16_f32 v198, v204, v205
 v_cvt_pk_bf16_f32 v199, v206, v207
 v_accvgpr_write_b32 a176, v196
 v_accvgpr_write_b32 a177, v197
 v_accvgpr_write_b32 a178, v198
 v_accvgpr_write_b32 a179, v199
 v_cvt_pk_bf16_f32 v208, v208, v209
 v_cvt_pk_bf16_f32 v209, v210, v211
 v_cvt_pk_bf16_f32 v210, v216, v217
 v_cvt_pk_bf16_f32 v211, v218, v219
 v_accvgpr_write_b32 a148, v208
 v_accvgpr_write_b32 a149, v209
 v_accvgpr_write_b32 a150, v210
 v_accvgpr_write_b32 a151, v211
 v_cvt_pk_bf16_f32 v212, v212, v213
 v_cvt_pk_bf16_f32 v213, v214, v215
 v_cvt_pk_bf16_f32 v214, v220, v221
 v_cvt_pk_bf16_f32 v215, v222, v223
 v_accvgpr_write_b32 a180, v212
 v_accvgpr_write_b32 a181, v213
 v_accvgpr_write_b32 a182, v214
 v_accvgpr_write_b32 a183, v215
 v_cvt_pk_bf16_f32 v224, v224, v225
 v_cvt_pk_bf16_f32 v225, v226, v227
 v_cvt_pk_bf16_f32 v226, v232, v233
 v_cvt_pk_bf16_f32 v227, v234, v235
 v_accvgpr_write_b32 a152, v224
 v_accvgpr_write_b32 a153, v225
 v_accvgpr_write_b32 a154, v226
 v_accvgpr_write_b32 a155, v227
 v_cvt_pk_bf16_f32 v228, v228, v229
 v_cvt_pk_bf16_f32 v229, v230, v231
 v_cvt_pk_bf16_f32 v230, v236, v237
 v_cvt_pk_bf16_f32 v231, v238, v239
 v_accvgpr_write_b32 a184, v228
 v_accvgpr_write_b32 a185, v229
 v_accvgpr_write_b32 a186, v230
 v_accvgpr_write_b32 a187, v231
M v[128:131], a[64:67], v[40:43], 0
 s_add_u32 m0, s28, 0
 ds_read_b128 a[96:99], v2 offset:8192
 ds_read_b128 a[100:103], v2 offset:9216
M v[128:131], a[68:71], v[56:59], v[128:131]
 buffer_load_dwordx4 v3, s[8:11], s24 offen offset:0 sc1 lds
M v[132:135], a[68:71], v[60:63], 0
 v_cvt_pk_bf16_f32 v240, v240, v241
 v_cvt_pk_bf16_f32 v241, v242, v243
M v[132:135], a[64:67], v[44:47], v[132:135]
 ds_read_b128 a[104:107], v2 offset:10240
 ds_read_b128 a[108:111], v2 offset:11264
M v[140:143], a[72:75], v[44:47], 0
 buffer_load_dwordx4 v3, s[8:11], s24 offen offset:1024 sc1 lds
M v[140:143], a[76:79], v[60:63], v[140:143]
 v_cvt_pk_bf16_f32 v242, v248, v249
 v_cvt_pk_bf16_f32 v243, v250, v251
M v[136:139], a[76:79], v[56:59], 0
 ds_read_b128 a[112:115], v2 offset:12288
 ds_read_b128 a[116:119], v2 offset:13312
M v[136:139], a[72:75], v[40:43], v[136:139]
 buffer_load_dwordx4 v3, s[8:11], s24 offen offset:2048 sc1 lds
M v[144:147], a[80:83], v[40:43], 0
 v_accvgpr_write_b32 a156, v240
 v_accvgpr_write_b32 a157, v241
M v[144:147], a[84:87], v[56:59], v[144:147]
 ds_read_b128 a[120:123], v2 offset:14336
 ds_read_b128 a[124:127], v2 offset:15360
M v[148:151], a[84:87], v[60:63], 0
 buffer_load_dwordx4 v3, s[8:11], s24 offen offset:3072 sc1 lds
M v[148:151], a[80:83], v[44:47], v[148:151]
 s_add_u32 m0, s28, 4096
 v_accvgpr_write_b32 a158, v242
 v_accvgpr_write_b32 a159, v243
M v[156:159], a[88:91], v[44:47], 0
 buffer_load_dwordx4 v4, s[8:11], s24 offen offset:0 sc1 lds
M v[156:159], a[92:95], v[60:63], v[156:159]
 v_cvt_pk_bf16_f32 v244, v244, v245
 v_cvt_pk_bf16_f32 v245, v246, v247
M v[152:155], a[92:95], v[56:59], 0
 v_cvt_pk_bf16_f32 v246, v252, v253
 v_cvt_pk_bf16_f32 v247, v254, v255
M v[152:155], a[88:91], v[40:43], v[152:155]
 s_waitcnt lgkmcnt(0)
 v_accvgpr_write_b32 a188, v244
 v_accvgpr_write_b32 a189, v245
M v[160:163], a[96:99], v[40:43], 0
 ds_read_b128 a[64:67], v2 offset:16384
 ds_read_b128 a[68:71], v2 offset:17408
M v[160:163], a[100:103], v[56:59], v[160:163]
 buffer_load_dwordx4 v4, s[8:11], s24 offen offset:1024 sc1 lds
M v[164:167], a[100:103], v[60:63], 0
 v_accvgpr_write_b32 a190, v246
 v_accvgpr_write_b32 a191, v247
M v[164:167], a[96:99], v[44:47], v[164:167]
 ds_read_b128 a[72:75], v2 offset:18432
 ds_read_b128 a[76:79], v2 offset:19456
M v[172:175], a[104:107], v[44:47], 0
 buffer_load_dwordx4 v4, s[8:11], s24 offen offset:2048 sc1 lds
M v[172:175], a[108:111], v[60:63], v[172:175]
 v_exp_f32 v18, v96
M v[168:171], a[108:111], v[56:59], 0
 ds_read_b128 a[80:83], v2 offset:20480
 ds_read_b128 a[84:87], v2 offset:21504
M v[168:171], a[104:107], v[40:43], v[168:171]
 buffer_load_dwordx4 v4, s[8:11], s24 offen offset:3072 sc1 lds
M v[176:179], a[112:115], v[40:43], 0
 v_exp_f32 v19, v97
M v[176:179], a[116:119], v[56:59], v[176:179]
 s_add_u32 m0, s28, 32768
 ds_read_b128 a[88:91], v2 offset:22528
 ds_read_b128 a[92:95], v2 offset:23552
M v[180:183], a[116:119], v[60:63], 0
 buffer_load_dwordx4 v3, s[8:11], s21 offen offset:0 sc1 lds
M v[180:183], a[112:115], v[44:47], v[180:183]
 v_exp_f32 v20, v98
M v[188:191], a[120:123], v[44:47], 0
 buffer_load_dwordx4 v3, s[8:11], s21 offen offset:1024 sc1 lds
M v[188:191], a[124:127], v[60:63], v[188:191]
 v_exp_f32 v21, v99
M v[184:187], a[124:127], v[56:59], 0
 buffer_load_dwordx4 v3, s[8:11], s21 offen offset:2048 sc1 lds
M v[184:187], a[120:123], v[40:43], v[184:187]
 s_waitcnt lgkmcnt(0)
 v_exp_f32 v22, v104
M v[192:195], a[64:67], v[40:43], 0
 ds_read_b128 a[96:99], v2 offset:24576
 ds_read_b128 a[100:103], v2 offset:25600
M v[192:195], a[68:71], v[56:59], v[192:195]
 buffer_load_dwordx4 v3, s[8:11], s21 offen offset:3072 sc1 lds
M v[196:199], a[68:71], v[60:63], 0
 v_exp_f32 v23, v105
M v[196:199], a[64:67], v[44:47], v[196:199]
 s_add_u32 m0, s28, 36864
 ds_read_b128 a[104:107], v2 offset:26624
 ds_read_b128 a[108:111], v2 offset:27648
M v[204:207], a[72:75], v[44:47], 0
 buffer_load_dwordx4 v4, s[8:11], s21 offen offset:0 sc1 lds
M v[204:207], a[76:79], v[60:63], v[204:207]
 v_add_f32 v30, v26, v30
 v_add_f32 v31, v27, v31
M v[200:203], a[76:79], v[56:59], 0
 ds_read_b128 a[112:115], v2 offset:28672
 ds_read_b128 a[116:119], v2 offset:29696
M v[200:203], a[72:75], v[40:43], v[200:203]
 buffer_load_dwordx4 v4, s[8:11], s21 offen offset:1024 sc1 lds
M v[208:211], a[80:83], v[40:43], 0
 v_exp_f32 v24, v106
M v[208:211], a[84:87], v[56:59], v[208:211]
 ds_read_b128 a[120:123], v2 offset:30720
 ds_read_b128 a[124:127], v2 offset:31744
M v[212:215], a[84:87], v[60:63], 0
 buffer_load_dwordx4 v4, s[8:11], s21 offen offset:2048 sc1 lds
M v[212:215], a[80:83], v[44:47], v[212:215]
 v_exp_f32 v25, v107
M v[220:223], a[88:91], v[44:47], 0
 v_add_f32 v28, v18, v19
 v_cvt_pk_bf16_f32 v48, v18, v19
M v[220:223], a[92:95], v[60:63], v[220:223]
 buffer_load_dwordx4 v4, s[8:11], s21 offen offset:3072 sc1 lds
M v[216:219], a[92:95], v[56:59], 0
 s_waitcnt vmcnt(16) lgkmcnt(0)
 s_add_u32 s24, s23, 16777216
 s_mov_b32 s23, s21
M v[216:219], a[88:91], v[40:43], v[216:219]
 s_barrier
M v[224:227], a[96:99], v[40:43], 0
 ds_read_b128 a[64:67], v2 offset:32768
 ds_read_b128 a[68:71], v2 offset:33792
M v[224:227], a[100:103], v[56:59], v[224:227]
 s_add_u32 s21, s21, 32768
 v_add_f32 v28, v20, v28
M v[228:231], a[100:103], v[60:63], 0
 s_add_u32 s22, s22, 1
 v_exp_f32 v18, v100
M v[228:231], a[96:99], v[44:47], v[228:231]
 s_cmp_eq_u32 s22, s25
 ds_read_b128 a[72:75], v2 offset:34816
 ds_read_b128 a[76:79], v2 offset:35840
M v[236:239], a[104:107], v[44:47], 0
 s_cselect_b32 s21, s26, s21
 v_exp_f32 v19, v101
M v[236:239], a[108:111], v[60:63], v[236:239]
 s_cmp_eq_u32 s22, s43
 v_cvt_pk_bf16_f32 v49, v20, v21
 v_add_f32 v28, v21, v28
M v[232:235], a[108:111], v[56:59], 0
 s_cselect_b32 s21, s4, s21
 ds_read_b128 a[80:83], v2 offset:36864
 ds_read_b128 a[84:87], v2 offset:37888
M v[232:235], a[104:107], v[40:43], v[232:235]
 s_cmp_eq_u32 s22, s6
 v_exp_f32 v20, v102
M v[240:243], a[112:115], v[40:43], 0
 s_cselect_b32 s21, s7, s21
 v_exp_f32 v21, v103
M v[240:243], a[116:119], v[56:59], v[240:243]
 ds_read_b128 a[88:91], v2 offset:38912
 ds_read_b128 a[92:95], v2 offset:39936
M v[244:247], a[116:119], v[60:63], 0
 v_add_f32 v28, v22, v28
 v_cvt_pk_bf16_f32 v50, v22, v23
M v[244:247], a[112:115], v[44:47], v[244:247]
 v_add_f32 v28, v23, v28
 v_add_f32 v28, v24, v28
M v[252:255], a[120:123], v[44:47], 0
 v_exp_f32 v22, v108
M v[252:255], a[124:127], v[60:63], v[252:255]
 s_cmp_lg_u32 s27, 0
 v_exp_f32 v23, v109
M v[248:251], a[124:127], v[56:59], 0
 s_waitcnt lgkmcnt(0)
 v_cvt_pk_bf16_f32 v51, v24, v25
 v_add_f32 v28, v25, v28
M v[248:251], a[120:123], v[40:43], v[248:251]
 v_exp_f32 v24, v110
 v_add_f32 v29, v18, v19
 v_cvt_pk_bf16_f32 v52, v18, v19
 v_add_f32 v29, v20, v29
 v_cvt_pk_bf16_f32 v53, v20, v21
 v_add_f32 v29, v21, v29
 v_exp_f32 v25, v111
 v_add_f32 v29, v22, v29
 v_cvt_pk_bf16_f32 v54, v22, v23
 v_add_f32 v29, v23, v29
 v_add_f32 v29, v24, v29
 v_cvt_pk_bf16_f32 v55, v24, v25
 v_add_f32 v29, v25, v29
 s_cbranch_scc1 L_loop_top
L_final_h:
 s_waitcnt vmcnt(8)
 s_barrier
 ds_read_b128 a[64:67], v7 offset:0
 ds_read_b128 a[68:71], v7 offset:1024
 ds_read_b128 a[72:75], v7 offset:2048
 ds_read_b128 a[76:79], v7 offset:3072
 ds_read_b128 a[80:83], v7 offset:4096
 ds_read_b128 a[84:87], v7 offset:5120
 ds_read_b128 a[88:91], v7 offset:6144
 ds_read_b128 a[92:95], v7 offset:7168
 s_add_u32 m0, s28, 65536
 v_exp_f32 v18, v112
 buffer_load_dwordx4 v3, s[8:11], s38 offen offset:0 sc1 lds
 v_exp_f32 v19, v113
 v_exp_f32 v20, v114
 v_add_f32 v28, v18, v28
 v_cvt_pk_bf16_f32 v56, v18, v19
 buffer_load_dwordx4 v3, s[8:11], s38 offen offset:1024 sc1 lds
 v_exp_f32 v21, v115
 v_add_f32 v28, v19, v28
 v_exp_f32 v22, v120
 v_add_f32 v28, v20, v28
 v_cvt_pk_bf16_f32 v57, v20, v21
 buffer_load_dwordx4 v3, s[8:11], s38 offen offset:2048 sc1 lds
 v_exp_f32 v23, v121
 v_add_f32 v28, v21, v28
 v_exp_f32 v24, v122
 v_add_f32 v28, v22, v28
 v_cvt_pk_bf16_f32 v58, v22, v23
 buffer_load_dwordx4 v3, s[8:11], s38 offen offset:3072 sc1 lds
 v_exp_f32 v25, v123
 v_add_f32 v28, v23, v28
 v_exp_f32 v18, v116
 v_add_f32 v28, v24, v28
 s_add_u32 m0, s28, 69632
 v_cvt_pk_bf16_f32 v59, v24, v25
 buffer_load_dwordx4 v4, s[8:11], s38 offen offset:0 sc1 lds
 v_exp_f32 v19, v117
 v_add_f32 v28, v25, v28
 v_exp_f32 v20, v118
 v_add_f32 v29, v18, v29
 v_cvt_pk_bf16_f32 v60, v18, v19
 buffer_load_dwordx4 v4, s[8:11], s38 offen offset:1024 sc1 lds
 v_exp_f32 v21, v119
 v_add_f32 v29, v19, v29
 v_exp_f32 v22, v124
 v_add_f32 v29, v20, v29
 v_cvt_pk_bf16_f32 v61, v20, v21
 buffer_load_dwordx4 v4, s[8:11], s38 offen offset:2048 sc1 lds
 v_exp_f32 v23, v125
 v_add_f32 v29, v21, v29
 v_exp_f32 v24, v126
 v_add_f32 v29, v22, v29
 v_cvt_pk_bf16_f32 v62, v22, v23
 buffer_load_dwordx4 v4, s[8:11], s38 offen offset:3072 sc1 lds
 s_add_u32 s38, s38, 32768
 v_exp_f32 v25, v127
 v_add_f32 v29, v23, v29
 v_add_f32 v29, v24, v29
 v_cvt_pk_bf16_f32 v63, v24, v25
 v_add_f32 v29, v25, v29
 v_max_f32 v10, v28, v29
 v_cmp_lt_f32 vcc, s31, v10
 s_nop 0
 s_cbranch_vccnz L_st4
L_rt4:
 v_add_f32 v30, v28, v30
 v_add_f32 v31, v29, v31
 v_mov_b32 v12, v32
 v_mov_b32 v13, v36
 v_mov_b32 v14, v30
 v_mov_b32 v15, v31
 buffer_store_dwordx4 v[12:15], v7, s[8:11], s52 offen sc1
 s_waitcnt lgkmcnt(0)
M v[128:131], a[64:67], v[48:51], v[128:131]
 ds_read_b128 a[96:99], v7 offset:8192
M v[128:131], a[68:71], v[56:59], v[128:131]
 ds_read_b128 a[100:103], v7 offset:9216
M v[132:135], a[68:71], v[60:63], v[132:135]
M v[132:135], a[64:67], v[52:55], v[132:135]
 ds_read_b128 a[104:107], v7 offset:10240
M v[140:143], a[72:75], v[52:55], v[140:143]
 ds_read_b128 a[108:111], v7 offset:11264
M v[140:143], a[76:79], v[60:63], v[140:143]
M v[136:139], a[76:79], v[56:59], v[136:139]
 ds_read_b128 a[112:115], v7 offset:12288
M v[136:139], a[72:75], v[48:51], v[136:139]
 ds_read_b128 a[116:119], v7 offset:13312
M v[144:147], a[80:83], v[48:51], v[144:147]
M v[144:147], a[84:87], v[56:59], v[144:147]
 ds_read_b128 a[120:123], v7 offset:14336
M v[148:151], a[84:87], v[60:63], v[148:151]
 ds_read_b128 a[124:127], v7 offset:15360
M v[148:151], a[80:83], v[52:55], v[148:151]
 v_cvt_pk_bf16_f32 v128, v128, v129
 v_cvt_pk_bf16_f32 v129, v130, v131
M v[156:159], a[88:91], v[52:55], v[156:159]
 v_cvt_pk_bf16_f32 v130, v136, v137
 v_cvt_pk_bf16_f32 v131, v138, v139
M v[156:159], a[92:95], v[60:63], v[156:159]
 buffer_store_dwordx4 v[128:131], v7, s[8:11], s12 offen offset:0 sc1
M v[152:155], a[92:95], v[56:59], v[152:155]
 v_cvt_pk_bf16_f32 v132, v132, v133
 v_cvt_pk_bf16_f32 v133, v134, v135
M v[152:155], a[88:91], v[48:51], v[152:155]
 s_waitcnt lgkmcnt(0)
 v_cvt_pk_bf16_f32 v134, v140, v141
 v_cvt_pk_bf16_f32 v135, v142, v143
M v[160:163], a[96:99], v[48:51], v[160:163]
 ds_read_b128 a[64:67], v7 offset:16384
M v[160:163], a[100:103], v[56:59], v[160:163]
 ds_read_b128 a[68:71], v7 offset:17408
M v[164:167], a[100:103], v[60:63], v[164:167]
 buffer_store_dwordx4 v[132:135], v7, s[8:11], s14 offen offset:0 sc1
M v[164:167], a[96:99], v[52:55], v[164:167]
 ds_read_b128 a[72:75], v7 offset:18432
 v_cvt_pk_bf16_f32 v144, v144, v145
M v[172:175], a[104:107], v[52:55], v[172:175]
 ds_read_b128 a[76:79], v7 offset:19456
 v_cvt_pk_bf16_f32 v145, v146, v147
M v[172:175], a[108:111], v[60:63], v[172:175]
 v_cvt_pk_bf16_f32 v146, v152, v153
 v_cvt_pk_bf16_f32 v147, v154, v155
M v[168:171], a[108:111], v[56:59], v[168:171]
 ds_read_b128 a[80:83], v7 offset:20480
M v[168:171], a[104:107], v[48:51], v[168:171]
 ds_read_b128 a[84:87], v7 offset:21504
M v[176:179], a[112:115], v[48:51], v[176:179]
 buffer_store_dwordx4 v[144:147], v7, s[8:11], s12 offen offset:1024 sc1
M v[176:179], a[116:119], v[56:59], v[176:179]
 ds_read_b128 a[88:91], v7 offset:22528
 v_cvt_pk_bf16_f32 v148, v148, v149
M v[180:183], a[116:119], v[60:63], v[180:183]
 ds_read_b128 a[92:95], v7 offset:23552
 v_cvt_pk_bf16_f32 v149, v150, v151
M v[180:183], a[112:115], v[52:55], v[180:183]
 v_cvt_pk_bf16_f32 v150, v156, v157
 v_cvt_pk_bf16_f32 v151, v158, v159
M v[188:191], a[120:123], v[52:55], v[188:191]
 buffer_store_dwordx4 v[148:151], v7, s[8:11], s14 offen offset:1024 sc1
M v[188:191], a[124:127], v[60:63], v[188:191]
 v_cvt_pk_bf16_f32 v160, v160, v161
 v_cvt_pk_bf16_f32 v161, v162, v163
M v[184:187], a[124:127], v[56:59], v[184:187]
 v_cvt_pk_bf16_f32 v162, v168, v169
 v_cvt_pk_bf16_f32 v163, v170, v171
M v[184:187], a[120:123], v[48:51], v[184:187]
 s_waitcnt lgkmcnt(0)
M v[192:195], a[64:67], v[48:51], v[192:195]
 ds_read_b128 a[96:99], v7 offset:24576
M v[192:195], a[68:71], v[56:59], v[192:195]
 ds_read_b128 a[100:103], v7 offset:25600
M v[196:199], a[68:71], v[60:63], v[196:199]
 buffer_store_dwordx4 v[160:163], v7, s[8:11], s12 offen offset:2048 sc1
M v[196:199], a[64:67], v[52:55], v[196:199]
 ds_read_b128 a[104:107], v7 offset:26624
 v_cvt_pk_bf16_f32 v164, v164, v165
M v[204:207], a[72:75], v[52:55], v[204:207]
 ds_read_b128 a[108:111], v7 offset:27648
 v_cvt_pk_bf16_f32 v165, v166, v167
M v[204:207], a[76:79], v[60:63], v[204:207]
 v_cvt_pk_bf16_f32 v166, v172, v173
 v_cvt_pk_bf16_f32 v167, v174, v175
M v[200:203], a[76:79], v[56:59], v[200:203]
 ds_read_b128 a[112:115], v7 offset:28672
M v[200:203], a[72:75], v[48:51], v[200:203]
 ds_read_b128 a[116:119], v7 offset:29696
M v[208:211], a[80:83], v[48:51], v[208:211]
 buffer_store_dwordx4 v[164:167], v7, s[8:11], s14 offen offset:2048 sc1
M v[208:211], a[84:87], v[56:59], v[208:211]
 ds_read_b128 a[120:123], v7 offset:30720
 v_cvt_pk_bf16_f32 v176, v176, v177
M v[212:215], a[84:87], v[60:63], v[212:215]
 ds_read_b128 a[124:127], v7 offset:31744
 v_cvt_pk_bf16_f32 v177, v178, v179
M v[212:215], a[80:83], v[52:55], v[212:215]
 v_cvt_pk_bf16_f32 v178, v184, v185
 v_cvt_pk_bf16_f32 v179, v186, v187
M v[220:223], a[88:91], v[52:55], v[220:223]
 buffer_store_dwordx4 v[176:179], v7, s[8:11], s12 offen offset:3072 sc1
M v[220:223], a[92:95], v[60:63], v[220:223]
 v_cvt_pk_bf16_f32 v180, v180, v181
 v_cvt_pk_bf16_f32 v181, v182, v183
M v[216:219], a[92:95], v[56:59], v[216:219]
 s_waitcnt lgkmcnt(0)
 v_cvt_pk_bf16_f32 v182, v188, v189
 v_cvt_pk_bf16_f32 v183, v190, v191
M v[216:219], a[88:91], v[48:51], v[216:219]
 s_barrier
M v[224:227], a[96:99], v[48:51], v[224:227]
 ds_read_b128 a[64:67], v2 offset:32768
M v[224:227], a[100:103], v[56:59], v[224:227]
 ds_read_b128 a[68:71], v2 offset:33792
M v[228:231], a[100:103], v[60:63], v[228:231]
 buffer_store_dwordx4 v[180:183], v7, s[8:11], s14 offen offset:3072 sc1
M v[228:231], a[96:99], v[52:55], v[228:231]
 ds_read_b128 a[72:75], v2 offset:34816
 v_cvt_pk_bf16_f32 v192, v192, v193
M v[236:239], a[104:107], v[52:55], v[236:239]
 ds_read_b128 a[76:79], v2 offset:35840
 v_cvt_pk_bf16_f32 v193, v194, v195
M v[236:239], a[108:111], v[60:63], v[236:239]
 v_cvt_pk_bf16_f32 v194, v200, v201
 v_cvt_pk_bf16_f32 v195, v202, v203
M v[232:235], a[108:111], v[56:59], v[232:235]
 ds_read_b128 a[80:83], v2 offset:36864
M v[232:235], a[104:107], v[48:51], v[232:235]
 ds_read_b128 a[84:87], v2 offset:37888
M v[240:243], a[112:115], v[48:51], v[240:243]
 buffer_store_dwordx4 v[192:195], v7, s[8:11], s13 offen offset:0 sc1
M v[240:243], a[116:119], v[56:59], v[240:243]
 ds_read_b128 a[88:91], v2 offset:38912
 v_cvt_pk_bf16_f32 v196, v196, v197
M v[244:247], a[116:119], v[60:63], v[244:247]
 ds_read_b128 a[92:95], v2 offset:39936
 v_cvt_pk_bf16_f32 v197, v198, v199
M v[244:247], a[112:115], v[52:55], v[244:247]
 v_cvt_pk_bf16_f32 v198, v204, v205
 v_cvt_pk_bf16_f32 v199, v206, v207
M v[252:255], a[120:123], v[52:55], v[252:255]
 buffer_store_dwordx4 v[196:199], v7, s[8:11], s15 offen offset:0 sc1
M v[252:255], a[124:127], v[60:63], v[252:255]
 v_cvt_pk_bf16_f32 v208, v208, v209
 v_cvt_pk_bf16_f32 v209, v210, v211
M v[248:251], a[124:127], v[56:59], v[248:251]
 s_waitcnt lgkmcnt(0)
 v_cvt_pk_bf16_f32 v210, v216, v217
 v_cvt_pk_bf16_f32 v211, v218, v219
M v[248:251], a[120:123], v[48:51], v[248:251]
 buffer_store_dwordx4 v[208:211], v7, s[8:11], s13 offen offset:1024 sc1
 v_cvt_pk_bf16_f32 v212, v212, v213
 v_cvt_pk_bf16_f32 v213, v214, v215
 v_cvt_pk_bf16_f32 v214, v220, v221
 v_cvt_pk_bf16_f32 v215, v222, v223
 buffer_store_dwordx4 v[212:215], v7, s[8:11], s15 offen offset:1024 sc1
 v_cvt_pk_bf16_f32 v224, v224, v225
 v_cvt_pk_bf16_f32 v225, v226, v227
 v_cvt_pk_bf16_f32 v226, v232, v233
 v_cvt_pk_bf16_f32 v227, v234, v235
 buffer_store_dwordx4 v[224:227], v7, s[8:11], s13 offen offset:2048 sc1
 v_cvt_pk_bf16_f32 v228, v228, v229
 v_cvt_pk_bf16_f32 v229, v230, v231
 v_cvt_pk_bf16_f32 v230, v236, v237
 v_cvt_pk_bf16_f32 v231, v238, v239
 buffer_store_dwordx4 v[228:231], v7, s[8:11], s15 offen offset:2048 sc1
 v_cvt_pk_bf16_f32 v240, v240, v241
 v_cvt_pk_bf16_f32 v241, v242, v243
 v_cvt_pk_bf16_f32 v242, v248, v249
 v_cvt_pk_bf16_f32 v243, v250, v251
 buffer_store_dwordx4 v[240:243], v7, s[8:11], s13 offen offset:3072 sc1
 v_cvt_pk_bf16_f32 v244, v244, v245
 v_cvt_pk_bf16_f32 v245, v246, v247
 v_cvt_pk_bf16_f32 v246, v252, v253
 v_cvt_pk_bf16_f32 v247, v254, v255
 buffer_store_dwordx4 v[244:247], v7, s[8:11], s15 offen offset:3072 sc1
M v[64:67], a[64:67], a[128:131], 0
 ds_read_b128 a[96:99], v2 offset:40960
M v[64:67], a[68:71], a[132:135], v[64:67]
 s_add_u32 m0, s28, 0
 ds_read_b128 a[100:103], v2 offset:41984
M v[64:67], a[72:75], a[136:139], v[64:67]
 buffer_load_dwordx4 v3, s[8:11], s38 offen offset:0 sc1 lds
M v[64:67], a[76:79], a[140:143], v[64:67]
 ds_read_b128 a[104:107], v2 offset:43008
 v_accvgpr_read_b32 v5, a192
M v[64:67], a[80:83], a[144:147], v[64:67]
 ds_read_b128 a[108:111], v2 offset:44032
 v_accvgpr_read_b32 v6, a193
M v[64:67], a[84:87], a[148:151], v[64:67]
 buffer_load_dwordx4 v3, s[8:11], s38 offen offset:1024 sc1 lds
M v[64:67], a[88:91], a[152:155], v[64:67]
 ds_read_b128 a[112:115], v2 offset:45056
M v[64:67], a[92:95], a[156:159], v[64:67]
 ds_read_b128 a[116:119], v2 offset:46080
M v[68:71], a[92:95], a[188:191], 0
 buffer_load_dwordx4 v3, s[8:11], s38 offen offset:2048 sc1 lds
M v[68:71], a[88:91], a[184:187], v[68:71]
 ds_read_b128 a[120:123], v2 offset:47104
M v[68:71], a[84:87], a[180:183], v[68:71]
 ds_read_b128 a[124:127], v2 offset:48128
M v[68:71], a[80:83], a[176:179], v[68:71]
M v[68:71], a[76:79], a[172:175], v[68:71]
 buffer_load_dwordx4 v3, s[8:11], s38 offen offset:3072 sc1 lds
M v[68:71], a[72:75], a[168:171], v[68:71]
M v[68:71], a[68:71], a[164:167], v[68:71]
M v[68:71], a[64:67], a[160:163], v[68:71]
 s_waitcnt lgkmcnt(0)
M v[76:79], a[96:99], a[160:163], 0
 ds_read_b128 a[64:67], v2 offset:49152
M v[76:79], a[100:103], a[164:167], v[76:79]
 s_add_u32 m0, s28, 4096
 ds_read_b128 a[68:71], v2 offset:50176
M v[76:79], a[104:107], a[168:171], v[76:79]
 buffer_load_dwordx4 v4, s[8:11], s38 offen offset:0 sc1 lds
M v[76:79], a[108:111], a[172:175], v[76:79]
 ds_read_b128 a[72:75], v2 offset:51200
M v[76:79], a[112:115], a[176:179], v[76:79]
 s_xor_b32 s47, s47, 64
 ds_read_b128 a[76:79], v2 offset:52224
M v[76:79], a[116:119], a[180:183], v[76:79]
 v_mov_b32 v18, 1
 v_min_u32 v19, 1, v7
M v[76:79], a[120:123], a[184:187], v[76:79]
 ds_read_b128 a[80:83], v2 offset:53248
 v_lshlrev_b32 v19, 29, v19
M v[76:79], a[124:127], a[188:191], v[76:79]
 s_waitcnt vmcnt(5)
 ds_read_b128 a[84:87], v2 offset:54272
M v[72:75], a[124:127], a[156:159], 0
 buffer_store_dword v18, v19, s[8:11], s47 offen sc1
M v[72:75], a[120:123], a[152:155], v[72:75]
 ds_read_b128 a[88:91], v2 offset:55296
M v[72:75], a[116:119], a[148:151], v[72:75]
 ds_read_b128 a[92:95], v2 offset:56320
M v[72:75], a[112:115], a[144:147], v[72:75]
 buffer_load_dwordx4 v4, s[8:11], s38 offen offset:1024 sc1 lds
M v[72:75], a[108:111], a[140:143], v[72:75]
M v[72:75], a[104:107], a[136:139], v[72:75]
 buffer_load_dwordx4 v4, s[8:11], s38 offen offset:2048 sc1 lds
M v[72:75], a[100:103], a[132:135], v[72:75]
M v[72:75], a[96:99], a[128:131], v[72:75]
 s_waitcnt lgkmcnt(0)
M v[80:83], a[64:67], a[128:131], 0
 ds_read_b128 a[96:99], v2 offset:57344
M v[80:83], a[68:71], a[132:135], v[80:83]
 ds_read_b128 a[100:103], v2 offset:58368
M v[80:83], a[72:75], a[136:139], v[80:83]
 buffer_load_dwordx4 v4, s[8:11], s38 offen offset:3072 sc1 lds
M v[80:83], a[76:79], a[140:143], v[80:83]
 s_add_u32 s38, s38, 32768
 ds_read_b128 a[104:107], v2 offset:59392
M v[80:83], a[80:83], a[144:147], v[80:83]
 s_add_u32 m0, s28, 131072
 ds_read_b128 a[108:111], v2 offset:60416
 v_max3_f32 v32, |v64|, |v65|, |v66|
M v[80:83], a[84:87], a[148:151], v[80:83]
 buffer_load_dwordx4 v3, s[8:11], s38 offen offset:0 sc1 lds
M v[80:83], a[88:91], a[152:155], v[80:83]
 ds_read_b128 a[112:115], v2 offset:61440
M v[80:83], a[92:95], a[156:159], v[80:83]
 ds_read_b128 a[116:119], v2 offset:62464
 v_max3_f32 v32, |v67|, |v72|, v32
M v[84:87], a[92:95], a[188:191], 0
 buffer_load_dwordx4 v3, s[8:11], s38 offen offset:1024 sc1 lds
M v[84:87], a[88:91], a[184:187], v[84:87]
 ds_read_b128 a[120:123], v2 offset:63488
M v[84:87], a[84:87], a[180:183], v[84:87]
 ds_read_b128 a[124:127], v2 offset:64512
 v_max3_f32 v32, |v73|, |v74|, v32
M v[84:87], a[80:83], a[176:179], v[84:87]
 buffer_load_dwordx4 v3, s[8:11], s38 offen offset:2048 sc1 lds
M v[84:87], a[76:79], a[172:175], v[84:87]
 v_mul_f32 v32, 2.0, v32
 v_mov_b32 v33, v32
M v[84:87], a[72:75], a[168:171], v[84:87]
 buffer_load_dwordx4 v3, s[8:11], s38 offen offset:3072 sc1 lds
M v[84:87], a[68:71], a[164:167], v[84:87]
 s_waitcnt lgkmcnt(0)
 v_mov_b32 v34, v32
M v[84:87], a[64:67], a[160:163], v[84:87]
 s_barrier
M v[92:95], a[96:99], a[160:163], 0
 ds_read_b128 a[64:67], v7 offset:32768
 v_mov_b32 v35, v32
M v[92:95], a[100:103], a[164:167], v[92:95]
 s_add_u32 m0, s28, 135168
 ds_read_b128 a[68:71], v7 offset:33792
M v[92:95], a[104:107], a[168:171], v[92:95]
 buffer_load_dwordx4 v4, s[8:11], s38 offen offset:0 sc1 lds
M v[92:95], a[108:111], a[172:175], v[92:95]
 ds_read_b128 a[72:75], v7 offset:34816
 v_max3_f32 v36, |v68|, |v69|, |v70|
M v[92:95], a[112:115], a[176:179], v[92:95]
 ds_read_b128 a[76:79], v7 offset:35840
M v[92:95], a[116:119], a[180:183], v[92:95]
 buffer_load_dwordx4 v4, s[8:11], s38 offen offset:1024 sc1 lds
M v[92:95], a[120:123], a[184:187], v[92:95]
 ds_read_b128 a[80:83], v7 offset:36864
 v_max3_f32 v36, |v71|, |v76|, v36
M v[92:95], a[124:127], a[188:191], v[92:95]
 ds_read_b128 a[84:87], v7 offset:37888
 v_max3_f32 v36, |v77|, |v78|, v36
M v[88:91], a[124:127], a[156:159], 0
 buffer_load_dwordx4 v4, s[8:11], s38 offen offset:2048 sc1 lds
M v[88:91], a[120:123], a[152:155], v[88:91]
 ds_read_b128 a[88:91], v7 offset:38912
M v[88:91], a[116:119], a[148:151], v[88:91]
 ds_read_b128 a[92:95], v7 offset:39936
 v_mul_f32 v36, 2.0, v36
M v[88:91], a[112:115], a[144:147], v[88:91]
 buffer_load_dwordx4 v4, s[8:11], s38 offen offset:3072 sc1 lds
M v[88:91], a[108:111], a[140:143], v[88:91]
 s_add_u32 s38, s38, 32768
 v_mov_b32 v37, v36
M v[88:91], a[104:107], a[136:139], v[88:91]
 v_mov_b32 v38, v36
 v_mov_b32 v39, v36
M v[88:91], a[100:103], a[132:135], v[88:91]
 s_waitcnt lgkmcnt(0)
M v[88:91], a[96:99], a[128:131], v[88:91]
M v[96:99], a[64:67], a[128:131], v[32:35]
 s_add_u32 m0, s28, 98304
 ds_read_b128 a[96:99], v7 offset:40960
M v[96:99], a[68:71], a[132:135], v[96:99]
 ds_read_b128 a[100:103], v7 offset:41984
M v[96:99], a[72:75], a[136:139], v[96:99]
 buffer_load_dwordx4 v3, s[8:11], s38 offen offset:0 sc1 lds
M v[96:99], a[76:79], a[140:143], v[96:99]
 ds_read_b128 a[104:107], v7 offset:43008
 s_add_u32 s29, s33, 0
M v[96:99], a[80:83], a[144:147], v[96:99]
 ds_read_b128 a[108:111], v7 offset:44032
 s_add_u32 s30, s33, 14336
M v[96:99], a[84:87], a[148:151], v[96:99]
 buffer_load_dwordx4 v3, s[8:11], s38 offen offset:1024 sc1 lds
M v[96:99], a[88:91], a[152:155], v[96:99]
 ds_read_b128 a[112:115], v7 offset:45056
 v_mul_f32 v28, -v32, v5
M v[96:99], a[92:95], a[156:159], v[96:99]
 ds_read_b128 a[116:119], v7 offset:46080
 v_mul_f32 v64, v5, v64
M v[100:103], a[92:95], a[188:191], v[36:39]
 buffer_load_dwordx4 v3, s[8:11], s38 offen offset:2048 sc1 lds
M v[100:103], a[88:91], a[184:187], v[100:103]
 ds_read_b128 a[120:123], v7 offset:47104
 v_mul_f32 v65, v5, v65
M v[100:103], a[84:87], a[180:183], v[100:103]
 ds_read_b128 a[124:127], v7 offset:48128
 v_mul_f32 v66, v5, v66
M v[100:103], a[80:83], a[176:179], v[100:103]
 buffer_load_dwordx4 v3, s[8:11], s38 offen offset:3072 sc1 lds
M v[100:103], a[76:79], a[172:175], v[100:103]
 s_add_u32 m0, s28, 102400
 v_mul_f32 v67, v5, v67
 v_mul_f32 v72, v5, v72
M v[100:103], a[72:75], a[168:171], v[100:103]
 buffer_load_dwordx4 v4, s[8:11], s38 offen offset:0 sc1 lds
M v[100:103], a[68:71], a[164:167], v[100:103]
 v_mul_f32 v73, v5, v73
 v_mul_f32 v74, v5, v74
M v[100:103], a[64:67], a[160:163], v[100:103]
 s_waitcnt lgkmcnt(0)
 v_mul_f32 v75, v5, v75
 v_cvt_pk_bf16_f32 v64, v64, v65
M v[108:111], a[96:99], a[160:163], v[36:39]
 ds_read_b128 a[64:67], v7 offset:49152
 v_cvt_pk_bf16_f32 v65, v66, v67
M v[108:111], a[100:103], a[164:167], v[108:111]
 ds_read_b128 a[68:71], v7 offset:50176
 v_cvt_pk_bf16_f32 v66, v72, v73
M v[108:111], a[104:107], a[168:171], v[108:111]
 buffer_load_dwordx4 v4, s[8:11], s38 offen offset:1024 sc1 lds
M v[108:111], a[108:111], a[172:175], v[108:111]
 ds_read_b128 a[72:75], v7 offset:51200
 v_cvt_pk_bf16_f32 v67, v74, v75
M v[108:111], a[112:115], a[176:179], v[108:111]
 ds_read_b128 a[76:79], v7 offset:52224
M v[108:111], a[116:119], a[180:183], v[108:111]
 buffer_load_dwordx4 v4, s[8:11], s38 offen offset:2048 sc1 lds
M v[108:111], a[120:123], a[184:187], v[108:111]
 ds_read_b128 a[80:83], v7 offset:53248
M v[108:111], a[124:127], a[188:191], v[108:111]
 ds_read_b128 a[84:87], v7 offset:54272
M v[104:107], a[124:127], a[156:159], v[32:35]
 buffer_load_dwordx4 v4, s[8:11], s38 offen offset:3072 sc1 lds
M v[104:107], a[120:123], a[152:155], v[104:107]
 s_add_u32 s38, s38, 32768
 ds_read_b128 a[88:91], v7 offset:55296
M v[104:107], a[116:119], a[148:151], v[104:107]
 ds_read_b128 a[92:95], v7 offset:56320
M v[104:107], a[112:115], a[144:147], v[104:107]
 buffer_store_dwordx4 v[64:67], v7, s[8:11], s29 offen offset:0 sc1
M v[104:107], a[108:111], a[140:143], v[104:107]
 v_mul_f32 v29, -v36, v6
 v_mul_f32 v68, v6, v68
M v[104:107], a[104:107], a[136:139], v[104:107]
 v_mul_f32 v69, v6, v69
 v_mul_f32 v70, v6, v70
M v[104:107], a[100:103], a[132:135], v[104:107]
 v_mul_f32 v71, v6, v71
 v_mul_f32 v76, v6, v76
M v[104:107], a[96:99], a[128:131], v[104:107]
 s_waitcnt lgkmcnt(0)
 v_mul_f32 v77, v6, v77
 v_mul_f32 v78, v6, v78
M v[112:115], a[64:67], a[128:131], v[32:35]
 ds_read_b128 a[96:99], v7 offset:57344
 v_mul_f32 v79, v6, v79
M v[112:115], a[68:71], a[132:135], v[112:115]
 ds_read_b128 a[100:103], v7 offset:58368
 v_cvt_pk_bf16_f32 v68, v68, v69
M v[112:115], a[72:75], a[136:139], v[112:115]
 v_cvt_pk_bf16_f32 v69, v70, v71
 v_cvt_pk_bf16_f32 v70, v76, v77
M v[112:115], a[76:79], a[140:143], v[112:115]
 ds_read_b128 a[104:107], v7 offset:59392
 v_cvt_pk_bf16_f32 v71, v78, v79
M v[112:115], a[80:83], a[144:147], v[112:115]
 ds_read_b128 a[108:111], v7 offset:60416
M v[112:115], a[84:87], a[148:151], v[112:115]
 buffer_store_dwordx4 v[68:71], v7, s[8:11], s30 offen offset:0 sc1
M v[112:115], a[88:91], a[152:155], v[112:115]
 ds_read_b128 a[112:115], v7 offset:61440
 v_mul_f32 v80, v5, v80
M v[112:115], a[92:95], a[156:159], v[112:115]
 ds_read_b128 a[116:119], v7 offset:62464
 v_mul_f32 v81, v5, v81
M v[116:119], a[92:95], a[188:191], v[36:39]
 v_mul_f32 v82, v5, v82
 v_mul_f32 v83, v5, v83
M v[116:119], a[88:91], a[184:187], v[116:119]
 ds_read_b128 a[120:123], v7 offset:63488
 v_mul_f32 v88, v5, v88
M v[116:119], a[84:87], a[180:183], v[116:119]
 ds_read_b128 a[124:127], v7 offset:64512
 v_mul_f32 v89, v5, v89
M v[116:119], a[80:83], a[176:179], v[116:119]
 v_mul_f32 v90, v5, v90
 v_mul_f32 v91, v5, v91
M v[116:119], a[76:79], a[172:175], v[116:119]
 v_cvt_pk_bf16_f32 v80, v80, v81
 v_cvt_pk_bf16_f32 v81, v82, v83
M v[116:119], a[72:75], a[168:171], v[116:119]
 v_cvt_pk_bf16_f32 v82, v88, v89
 v_cvt_pk_bf16_f32 v83, v90, v91
M v[116:119], a[68:71], a[164:167], v[116:119]
 s_waitcnt lgkmcnt(0)
M v[116:119], a[64:67], a[160:163], v[116:119]
 s_barrier
M v[124:127], a[96:99], a[160:163], v[36:39]
 ds_read_b128 a[64:67], v2 offset:0
M v[124:127], a[100:103], a[164:167], v[124:127]
 ds_read_b128 a[68:71], v2 offset:1024
M v[124:127], a[104:107], a[168:171], v[124:127]
 buffer_store_dwordx4 v[80:83], v7, s[8:11], s29 offen offset:1024 sc1
M v[124:127], a[108:111], a[172:175], v[124:127]
 ds_read_b128 a[72:75], v2 offset:2048
 v_mul_f32 v84, v6, v84
M v[124:127], a[112:115], a[176:179], v[124:127]
 ds_read_b128 a[76:79], v2 offset:3072
 v_mul_f32 v85, v6, v85
M v[124:127], a[116:119], a[180:183], v[124:127]
 v_mul_f32 v86, v6, v86
 v_mul_f32 v87, v6, v87
M v[124:127], a[120:123], a[184:187], v[124:127]
 ds_read_b128 a[80:83], v2 offset:4096
 v_mul_f32 v92, v6, v92
M v[124:127], a[124:127], a[188:191], v[124:127]
 ds_read_b128 a[84:87], v2 offset:5120
 v_mul_f32 v93, v6, v93
M v[120:123], a[124:127], a[156:159], v[32:35]
 v_mul_f32 v94, v6, v94
 v_mul_f32 v95, v6, v95
M v[120:123], a[120:123], a[152:155], v[120:123]
 ds_read_b128 a[88:91], v2 offset:6144
 v_cvt_pk_bf16_f32 v84, v84, v85
M v[120:123], a[116:119], a[148:151], v[120:123]
 ds_read_b128 a[92:95], v2 offset:7168
 v_cvt_pk_bf16_f32 v85, v86, v87
M v[120:123], a[112:115], a[144:147], v[120:123]
 v_cvt_pk_bf16_f32 v86, v92, v93
 v_cvt_pk_bf16_f32 v87, v94, v95
M v[120:123], a[108:111], a[140:143], v[120:123]
 buffer_store_dwordx4 v[84:87], v7, s[8:11], s30 offen offset:1024 sc1
M v[120:123], a[104:107], a[136:139], v[120:123]
M v[120:123], a[100:103], a[132:135], v[120:123]
 s_waitcnt lgkmcnt(0)
M v[120:123], a[96:99], a[128:131], v[120:123]
M v[64:67], a[64:67], a[128:131], v[32:35]
 s_add_u32 m0, s28, 32768
 ds_read_b128 a[96:99], v2 offset:8192
M v[64:67], a[68:71], a[132:135], v[64:67]
 ds_read_b128 a[100:103], v2 offset:9216
 s_mov_b32 s79, 104923136
M v[64:67], a[72:75], a[136:139], v[64:67]
 buffer_load_dwordx4 v3, s[8:11], s38 offen offset:0 sc1 lds
M v[64:67], a[76:79], a[140:143], v[64:67]
 ds_read_b128 a[104:107], v2 offset:10240
 s_add_u32 s29, s33, 2048
M v[64:67], a[80:83], a[144:147], v[64:67]
 ds_read_b128 a[108:111], v2 offset:11264
 s_add_u32 s30, s33, 16384
M v[64:67], a[84:87], a[148:151], v[64:67]
 buffer_load_dwordx4 v3, s[8:11], s38 offen offset:1024 sc1 lds
M v[64:67], a[88:91], a[152:155], v[64:67]
 ds_read_b128 a[112:115], v2 offset:12288
 v_fma_f32 v96, v96, v5, v28
M v[64:67], a[92:95], a[156:159], v[64:67]
 ds_read_b128 a[116:119], v2 offset:13312
 v_fma_f32 v97, v97, v5, v28
M v[68:71], a[92:95], a[188:191], v[36:39]
 buffer_load_dwordx4 v3, s[8:11], s38 offen offset:2048 sc1 lds
M v[68:71], a[88:91], a[184:187], v[68:71]
 ds_read_b128 a[120:123], v2 offset:14336
 v_fma_f32 v98, v98, v5, v28
M v[68:71], a[84:87], a[180:183], v[68:71]
 ds_read_b128 a[124:127], v2 offset:15360
 v_fma_f32 v99, v99, v5, v28
M v[68:71], a[80:83], a[176:179], v[68:71]
 buffer_load_dwordx4 v3, s[8:11], s38 offen offset:3072 sc1 lds
M v[68:71], a[76:79], a[172:175], v[68:71]
 s_add_u32 m0, s28, 36864
 v_fma_f32 v104, v104, v5, v28
 v_fma_f32 v105, v105, v5, v28
M v[68:71], a[72:75], a[168:171], v[68:71]
 buffer_load_dwordx4 v4, s[8:11], s38 offen offset:0 sc1 lds
M v[68:71], a[68:71], a[164:167], v[68:71]
 buffer_load_dword v24, off, s[8:11], s79 sc1
M v[68:71], a[64:67], a[160:163], v[68:71]
 s_waitcnt lgkmcnt(0)
 v_lshrrev_b32 v0, 4, v7
 v_and_b32 v14, 15, v0
M v[76:79], a[96:99], a[160:163], v[36:39]
 ds_read_b128 a[64:67], v2 offset:16384
 v_lshlrev_b32 v14, 2, v14
M v[76:79], a[100:103], a[164:167], v[76:79]
 ds_read_b128 a[68:71], v2 offset:17408
 v_lshrrev_b32 v11, 4, v0
M v[76:79], a[104:107], a[168:171], v[76:79]
 buffer_load_dwordx4 v4, s[8:11], s38 offen offset:1024 sc1 lds
M v[76:79], a[108:111], a[172:175], v[76:79]
 ds_read_b128 a[72:75], v2 offset:18432
 s_mov_b32 s52, s96
M v[76:79], a[112:115], a[176:179], v[76:79]
 s_and_b32 s53, s97, 0xffff
 ds_read_b128 a[76:79], v2 offset:19456
 s_mov_b32 s54, 1835008
M v[76:79], a[116:119], a[180:183], v[76:79]
 buffer_load_dwordx4 v4, s[8:11], s38 offen offset:2048 sc1 lds
M v[76:79], a[120:123], a[184:187], v[76:79]
 ds_read_b128 a[80:83], v2 offset:20480
 s_mov_b32 s55, 0x20000
M v[76:79], a[124:127], a[188:191], v[76:79]
 s_lshr_b32 s74, s41, 3
 ds_read_b128 a[84:87], v2 offset:21504
 s_xor_b32 s74, s74, 0
M v[72:75], a[124:127], a[156:159], v[32:35]
 buffer_load_dwordx4 v4, s[8:11], s38 offen offset:3072 sc1 lds
M v[72:75], a[120:123], a[152:155], v[72:75]
 s_add_u32 s38, s38, 32768
 ds_read_b128 a[88:91], v2 offset:22528
 s_mul_i32 s67, s74, -2
M v[72:75], a[116:119], a[148:151], v[72:75]
 s_mul_i32 s74, s74, 8
 ds_read_b128 a[92:95], v2 offset:23552
 v_fma_f32 v106, v106, v5, v28
M v[72:75], a[112:115], a[144:147], v[72:75]
 s_add_u32 s74, s74, s20
 v_fma_f32 v107, v107, v5, v28
 v_cvt_pk_bf16_f32 v96, v96, v97
M v[72:75], a[108:111], a[140:143], v[72:75]
 s_lshl_b32 s75, s74, 6
 v_cvt_pk_bf16_f32 v97, v98, v99
 v_cvt_pk_bf16_f32 v98, v104, v105
M v[72:75], a[104:107], a[136:139], v[72:75]
 s_add_u32 s76, s75, 256
 v_cvt_pk_bf16_f32 v99, v106, v107
M v[72:75], a[100:103], a[132:135], v[72:75]
 s_add_u32 s67, s67, 3
 v_add_u32 v43, 0x20000, v7
 s_sub_u32 s67, s67, s20
M v[72:75], a[96:99], a[128:131], v[72:75]
 s_waitcnt lgkmcnt(0)
 s_and_b32 s67, s67, 536870912
M v[80:83], a[64:67], a[128:131], v[32:35]
 s_or_b32 s76, s76, s67
 ds_read_b128 a[96:99], v2 offset:24576
 v_or_b32 v27, s67, v7
M v[80:83], a[68:71], a[132:135], v[80:83]
 ds_read_b128 a[100:103], v2 offset:25600
 v_add_u32 v27, 4096, v27
M v[80:83], a[72:75], a[136:139], v[80:83]
 buffer_store_dwordx4 v[96:99], v7, s[8:11], s29 offen offset:0 sc1
M v[80:83], a[76:79], a[140:143], v[80:83]
 ds_read_b128 a[104:107], v2 offset:26624
 v_fma_f32 v100, v100, v6, v29
M v[80:83], a[80:83], a[144:147], v[80:83]
 ds_read_b128 a[108:111], v2 offset:27648
 v_fma_f32 v101, v101, v6, v29
M v[80:83], a[84:87], a[148:151], v[80:83]
 v_fma_f32 v102, v102, v6, v29
 v_fma_f32 v103, v103, v6, v29
M v[80:83], a[88:91], a[152:155], v[80:83]
 ds_read_b128 a[112:115], v2 offset:28672
 v_fma_f32 v108, v108, v6, v29
M v[80:83], a[92:95], a[156:159], v[80:83]
 ds_read_b128 a[116:119], v2 offset:29696
 v_fma_f32 v109, v109, v6, v29
M v[84:87], a[92:95], a[188:191], v[36:39]
 v_fma_f32 v110, v110, v6, v29
 v_fma_f32 v111, v111, v6, v29
M v[84:87], a[88:91], a[184:187], v[84:87]
 ds_read_b128 a[120:123], v2 offset:30720
 v_cvt_pk_bf16_f32 v100, v100, v101
M v[84:87], a[84:87], a[180:183], v[84:87]
 ds_read_b128 a[124:127], v2 offset:31744
 v_cvt_pk_bf16_f32 v101, v102, v103
M v[84:87], a[80:83], a[176:179], v[84:87]
 v_cvt_pk_bf16_f32 v102, v108, v109
 v_cvt_pk_bf16_f32 v103, v110, v111
M v[84:87], a[76:79], a[172:175], v[84:87]
 buffer_store_dwordx4 v[100:103], v7, s[8:11], s30 offen offset:0 sc1
M v[84:87], a[72:75], a[168:171], v[84:87]
 v_fma_f32 v112, v112, v5, v28
 v_fma_f32 v113, v113, v5, v28
M v[84:87], a[68:71], a[164:167], v[84:87]
 s_waitcnt vmcnt(31) lgkmcnt(0)
 v_fma_f32 v114, v114, v5, v28
 v_fma_f32 v115, v115, v5, v28
M v[84:87], a[64:67], a[160:163], v[84:87]
 s_barrier
M v[92:95], a[96:99], a[160:163], v[36:39]
 ds_read_b128 a[64:67], v7 offset:0
 v_fma_f32 v120, v120, v5, v28
M v[92:95], a[100:103], a[164:167], v[92:95]
 ds_read_b128 a[68:71], v7 offset:1024
 v_fma_f32 v121, v121, v5, v28
M v[92:95], a[104:107], a[168:171], v[92:95]
 v_fma_f32 v122, v122, v5, v28
 v_fma_f32 v123, v123, v5, v28
M v[92:95], a[108:111], a[172:175], v[92:95]
 ds_read_b128 a[72:75], v7 offset:2048
 v_cvt_pk_bf16_f32 v112, v112, v113
M v[92:95], a[112:115], a[176:179], v[92:95]
 ds_read_b128 a[76:79], v7 offset:3072
 v_cvt_pk_bf16_f32 v113, v114, v115
M v[92:95], a[116:119], a[180:183], v[92:95]
 v_cvt_pk_bf16_f32 v114, v120, v121
 v_cvt_pk_bf16_f32 v115, v122, v123
M v[92:95], a[120:123], a[184:187], v[92:95]
 ds_read_b128 a[80:83], v7 offset:4096
M v[92:95], a[124:127], a[188:191], v[92:95]
 ds_read_b128 a[84:87], v7 offset:5120
M v[88:91], a[124:127], a[156:159], v[32:35]
 buffer_store_dwordx4 v[112:115], v7, s[8:11], s29 offen offset:1024 sc1
M v[88:91], a[120:123], a[152:155], v[88:91]
 ds_read_b128 a[88:91], v7 offset:6144
 v_fma_f32 v116, v116, v6, v29
M v[88:91], a[116:119], a[148:151], v[88:91]
 ds_read_b128 a[92:95], v7 offset:7168
 v_fma_f32 v117, v117, v6, v29
M v[88:91], a[112:115], a[144:147], v[88:91]
 v_fma_f32 v118, v118, v6, v29
 v_fma_f32 v119, v119, v6, v29
M v[88:91], a[108:111], a[140:143], v[88:91]
 v_fma_f32 v124, v124, v6, v29
 v_fma_f32 v125, v125, v6, v29
M v[88:91], a[104:107], a[136:139], v[88:91]
 v_fma_f32 v126, v126, v6, v29
 v_fma_f32 v127, v127, v6, v29
M v[88:91], a[100:103], a[132:135], v[88:91]
 s_waitcnt lgkmcnt(0)
 v_cvt_pk_bf16_f32 v116, v116, v117
 v_cvt_pk_bf16_f32 v117, v118, v119
M v[88:91], a[96:99], a[128:131], v[88:91]
 v_cvt_pk_bf16_f32 v118, v124, v125
 v_cvt_pk_bf16_f32 v119, v126, v127
 buffer_store_dwordx4 v[116:119], v7, s[8:11], s30 offen offset:1024 sc1
M v[96:99], a[64:67], a[128:131], v[32:35]
 ds_read_b128 a[96:99], v7 offset:8192
M v[96:99], a[68:71], a[132:135], v[96:99]
 ds_read_b128 a[100:103], v7 offset:9216
M v[96:99], a[72:75], a[136:139], v[96:99]
 s_sub_u32 s64, 15, s42
M v[96:99], a[76:79], a[140:143], v[96:99]
 s_min_u32 s64, s64, s42
 ds_read_b128 a[104:107], v7 offset:10240
 s_add_u32 s29, s33, 4096
M v[96:99], a[80:83], a[144:147], v[96:99]
 s_mul_i32 s45, s64, 8704
 ds_read_b128 a[108:111], v7 offset:11264
 s_add_u32 s30, s33, 18432
M v[96:99], a[84:87], a[148:151], v[96:99]
 s_lshl_b32 s64, s20, 6
 v_fma_f32 v64, v64, v5, v28
 v_fma_f32 v65, v65, v5, v28
M v[96:99], a[88:91], a[152:155], v[96:99]
 s_add_u32 s64, s64, s41
 ds_read_b128 a[112:115], v7 offset:12288
 v_fma_f32 v66, v66, v5, v28
M v[96:99], a[92:95], a[156:159], v[96:99]
 s_lshl2_add_u32 s45, s64, s45
 ds_read_b128 a[116:119], v7 offset:13312
 v_fma_f32 v67, v67, v5, v28
M v[100:103], a[92:95], a[188:191], v[36:39]
 s_add_u32 s45, s45, 104992768
 v_fma_f32 v72, v72, v5, v28
M v[100:103], a[88:91], a[184:187], v[100:103]
 s_movk_i32 s65, 1024
 ds_read_b128 a[120:123], v7 offset:14336
 v_fma_f32 v73, v73, v5, v28
M v[100:103], a[84:87], a[180:183], v[100:103]
 s_cmp_lt_u32 s42, 8
 ds_read_b128 a[124:127], v7 offset:15360
 v_fma_f32 v74, v74, v5, v28
M v[100:103], a[80:83], a[176:179], v[100:103]
 s_cselect_b32 s64, 4352, s65
 v_fma_f32 v75, v75, v5, v28
M v[100:103], a[76:79], a[172:175], v[100:103]
 s_cselect_b32 s65, 0, 64
 v_cvt_pk_bf16_f32 v64, v64, v65
M v[100:103], a[72:75], a[168:171], v[100:103]
 s_cselect_b32 s66, 32, 64
 v_cvt_pk_bf16_f32 v65, v66, v67
M v[100:103], a[68:71], a[164:167], v[100:103]
 s_add_u32 s3, s45, s64
 s_add_u32 s45, s45, s65
 v_lshrrev_b32 v42, 5, v7
M v[100:103], a[64:67], a[160:163], v[100:103]
 s_waitcnt lgkmcnt(0)
 v_mul_u32_u24 v42, 4352, v42
 v_and_b32 v41, 16, v7
M v[108:111], a[96:99], a[160:163], v[36:39]
 ds_read_b128 a[64:67], v7 offset:16384
 v_lshl_add_u32 v41, v41, 3, v42
M v[108:111], a[100:103], a[164:167], v[108:111]
 ds_read_b128 a[68:71], v7 offset:17408
 v_mov_b32 v42, 536870912
M v[108:111], a[104:107], a[168:171], v[108:111]
 v_cmp_gt_u32 vcc, s66, v7
 v_mov_b32 v40, 1
M v[108:111], a[108:111], a[172:175], v[108:111]
 s_nop 0
 ds_read_b128 a[72:75], v7 offset:18432
 v_cndmask_b32 v41, v42, v41, vcc
M v[108:111], a[112:115], a[176:179], v[108:111]
 ds_read_b128 a[76:79], v7 offset:19456
 v_cvt_pk_bf16_f32 v66, v72, v73
M v[108:111], a[116:119], a[180:183], v[108:111]
 v_cvt_pk_bf16_f32 v67, v74, v75
M v[108:111], a[120:123], a[184:187], v[108:111]
 ds_read_b128 a[80:83], v7 offset:20480
M v[108:111], a[124:127], a[188:191], v[108:111]
 ds_read_b128 a[84:87], v7 offset:21504
M v[104:107], a[124:127], a[156:159], v[32:35]
 buffer_store_dwordx4 v[64:67], v7, s[8:11], s29 offen offset:0 sc1
M v[104:107], a[120:123], a[152:155], v[104:107]
 ds_read_b128 a[88:91], v7 offset:22528
 v_fma_f32 v68, v68, v6, v29
M v[104:107], a[116:119], a[148:151], v[104:107]
 ds_read_b128 a[92:95], v7 offset:23552
 v_fma_f32 v69, v69, v6, v29
M v[104:107], a[112:115], a[144:147], v[104:107]
 v_fma_f32 v70, v70, v6, v29
 v_fma_f32 v71, v71, v6, v29
M v[104:107], a[108:111], a[140:143], v[104:107]
 v_fma_f32 v76, v76, v6, v29
 v_fma_f32 v77, v77, v6, v29
M v[104:107], a[104:107], a[136:139], v[104:107]
 v_fma_f32 v78, v78, v6, v29
 v_fma_f32 v79, v79, v6, v29
M v[104:107], a[100:103], a[132:135], v[104:107]
 v_cvt_pk_bf16_f32 v68, v68, v69
 v_cvt_pk_bf16_f32 v69, v70, v71
M v[104:107], a[96:99], a[128:131], v[104:107]
 s_waitcnt lgkmcnt(0)
 v_cvt_pk_bf16_f32 v70, v76, v77
 v_cvt_pk_bf16_f32 v71, v78, v79
M v[112:115], a[64:67], a[128:131], v[32:35]
 ds_read_b128 a[96:99], v7 offset:24576
M v[112:115], a[68:71], a[132:135], v[112:115]
 ds_read_b128 a[100:103], v7 offset:25600
M v[112:115], a[72:75], a[136:139], v[112:115]
 buffer_store_dwordx4 v[68:71], v7, s[8:11], s30 offen offset:0 sc1
M v[112:115], a[76:79], a[140:143], v[112:115]
 ds_read_b128 a[104:107], v7 offset:26624
 v_fma_f32 v80, v80, v5, v28
M v[112:115], a[80:83], a[144:147], v[112:115]
 ds_read_b128 a[108:111], v7 offset:27648
 v_fma_f32 v81, v81, v5, v28
M v[112:115], a[84:87], a[148:151], v[112:115]
 v_fma_f32 v82, v82, v5, v28
 v_fma_f32 v83, v83, v5, v28
M v[112:115], a[88:91], a[152:155], v[112:115]
 ds_read_b128 a[112:115], v7 offset:28672
 v_fma_f32 v88, v88, v5, v28
M v[112:115], a[92:95], a[156:159], v[112:115]
 ds_read_b128 a[116:119], v7 offset:29696
 v_fma_f32 v89, v89, v5, v28
M v[116:119], a[92:95], a[188:191], v[36:39]
 v_fma_f32 v90, v90, v5, v28
 v_fma_f32 v91, v91, v5, v28
M v[116:119], a[88:91], a[184:187], v[116:119]
 ds_read_b128 a[120:123], v7 offset:30720
 v_cvt_pk_bf16_f32 v80, v80, v81
M v[116:119], a[84:87], a[180:183], v[116:119]
 ds_read_b128 a[124:127], v7 offset:31744
 v_cvt_pk_bf16_f32 v81, v82, v83
M v[116:119], a[80:83], a[176:179], v[116:119]
 v_cvt_pk_bf16_f32 v82, v88, v89
 v_cvt_pk_bf16_f32 v83, v90, v91
M v[116:119], a[76:79], a[172:175], v[116:119]
 buffer_store_dwordx4 v[80:83], v7, s[8:11], s29 offen offset:1024 sc1
M v[116:119], a[72:75], a[168:171], v[116:119]
 v_fma_f32 v84, v84, v6, v29
 v_fma_f32 v85, v85, v6, v29
M v[116:119], a[68:71], a[164:167], v[116:119]
 s_waitcnt vmcnt(28) lgkmcnt(0)
 v_fma_f32 v86, v86, v6, v29
M v[116:119], a[64:67], a[160:163], v[116:119]
 s_barrier
M v[124:127], a[96:99], a[160:163], v[36:39]
 ds_read_b128 a[64:67], v43 offset:0
 v_fma_f32 v87, v87, v6, v29
M v[124:127], a[100:103], a[164:167], v[124:127]
 ds_read_b128 a[68:71], v43 offset:1024
 v_fma_f32 v92, v92, v6, v29
M v[124:127], a[104:107], a[168:171], v[124:127]
 v_fma_f32 v93, v93, v6, v29
 v_fma_f32 v94, v94, v6, v29
M v[124:127], a[108:111], a[172:175], v[124:127]
 ds_read_b128 a[72:75], v43 offset:2048
 v_fma_f32 v95, v95, v6, v29
M v[124:127], a[112:115], a[176:179], v[124:127]
 ds_read_b128 a[76:79], v43 offset:3072
 v_cvt_pk_bf16_f32 v84, v84, v85
M v[124:127], a[116:119], a[180:183], v[124:127]
 v_cvt_pk_bf16_f32 v85, v86, v87
M v[124:127], a[120:123], a[184:187], v[124:127]
 ds_read_b128 a[80:83], v43 offset:4096
 v_cvt_pk_bf16_f32 v86, v92, v93
M v[124:127], a[124:127], a[188:191], v[124:127]
 ds_read_b128 a[84:87], v43 offset:5120
 v_cvt_pk_bf16_f32 v87, v94, v95
M v[120:123], a[124:127], a[156:159], v[32:35]
 buffer_store_dwordx4 v[84:87], v7, s[8:11], s30 offen offset:1024 sc1
M v[120:123], a[120:123], a[152:155], v[120:123]
 ds_read_b128 a[88:91], v43 offset:6144
M v[120:123], a[116:119], a[148:151], v[120:123]
 ds_read_b128 a[92:95], v43 offset:7168
M v[120:123], a[112:115], a[144:147], v[120:123]
M v[120:123], a[108:111], a[140:143], v[120:123]
M v[120:123], a[104:107], a[136:139], v[120:123]
M v[120:123], a[100:103], a[132:135], v[120:123]
 s_waitcnt lgkmcnt(0)
M v[120:123], a[96:99], a[128:131], v[120:123]
M v[64:67], a[64:67], a[128:131], v[32:35]
 ds_read_b128 a[96:99], v43 offset:8192
M v[64:67], a[68:71], a[132:135], v[64:67]
 ds_read_b128 a[100:103], v43 offset:9216
M v[64:67], a[72:75], a[136:139], v[64:67]
 s_waitcnt vmcnt(11)
 v_cmp_gt_u32 vcc, 1, v24
M v[64:67], a[76:79], a[140:143], v[64:67]
 s_mov_b32 s65, 104890368
 ds_read_b128 a[104:107], v43 offset:10240
 s_add_u32 s29, s33, 6144
M v[64:67], a[80:83], a[144:147], v[64:67]
 s_cbranch_vccnz L_fhs0
L_fhr0:
 ds_read_b128 a[108:111], v43 offset:11264
 s_add_u32 s30, s33, 20480
M v[64:67], a[84:87], a[148:151], v[64:67]
 buffer_load_dword v25, v14, s[8:11], s65 offen sc1
M v[64:67], a[88:91], a[152:155], v[64:67]
 ds_read_b128 a[112:115], v43 offset:12288
 v_fma_f32 v96, v96, v5, v28
M v[64:67], a[92:95], a[156:159], v[64:67]
 ds_read_b128 a[116:119], v43 offset:13312
 v_fma_f32 v97, v97, v5, v28
M v[68:71], a[92:95], a[188:191], v[36:39]
 v_fma_f32 v98, v98, v5, v28
 v_fma_f32 v99, v99, v5, v28
M v[68:71], a[88:91], a[184:187], v[68:71]
 ds_read_b128 a[120:123], v43 offset:14336
 v_fma_f32 v104, v104, v5, v28
M v[68:71], a[84:87], a[180:183], v[68:71]
 ds_read_b128 a[124:127], v43 offset:15360
 v_fma_f32 v105, v105, v5, v28
M v[68:71], a[80:83], a[176:179], v[68:71]
 v_fma_f32 v106, v106, v5, v28
 v_fma_f32 v107, v107, v5, v28
M v[68:71], a[76:79], a[172:175], v[68:71]
 v_cvt_pk_bf16_f32 v96, v96, v97
M v[68:71], a[72:75], a[168:171], v[68:71]
 v_cvt_pk_bf16_f32 v97, v98, v99
M v[68:71], a[68:71], a[164:167], v[68:71]
 v_cvt_pk_bf16_f32 v98, v104, v105
M v[68:71], a[64:67], a[160:163], v[68:71]
 s_waitcnt lgkmcnt(0)
 v_cvt_pk_bf16_f32 v99, v106, v107
M v[76:79], a[96:99], a[160:163], v[36:39]
 ds_read_b128 a[64:67], v43 offset:16384
M v[76:79], a[100:103], a[164:167], v[76:79]
 ds_read_b128 a[68:71], v43 offset:17408
M v[76:79], a[104:107], a[168:171], v[76:79]
 buffer_store_dwordx4 v[96:99], v7, s[8:11], s29 offen offset:0 sc1
M v[76:79], a[108:111], a[172:175], v[76:79]
 ds_read_b128 a[72:75], v43 offset:18432
 v_fma_f32 v100, v100, v6, v29
M v[76:79], a[112:115], a[176:179], v[76:79]
 ds_read_b128 a[76:79], v43 offset:19456
 v_fma_f32 v101, v101, v6, v29
M v[76:79], a[116:119], a[180:183], v[76:79]
 v_fma_f32 v102, v102, v6, v29
 v_fma_f32 v103, v103, v6, v29
M v[76:79], a[120:123], a[184:187], v[76:79]
 ds_read_b128 a[80:83], v43 offset:20480
 v_fma_f32 v108, v108, v6, v29
M v[76:79], a[124:127], a[188:191], v[76:79]
 ds_read_b128 a[84:87], v43 offset:21504
 v_fma_f32 v109, v109, v6, v29
M v[72:75], a[124:127], a[156:159], v[32:35]
 v_fma_f32 v110, v110, v6, v29
 v_fma_f32 v111, v111, v6, v29
M v[72:75], a[120:123], a[152:155], v[72:75]
 ds_read_b128 a[88:91], v43 offset:22528
 v_cvt_pk_bf16_f32 v100, v100, v101
M v[72:75], a[116:119], a[148:151], v[72:75]
 ds_read_b128 a[92:95], v43 offset:23552
 v_cvt_pk_bf16_f32 v101, v102, v103
M v[72:75], a[112:115], a[144:147], v[72:75]
 v_cvt_pk_bf16_f32 v102, v108, v109
M v[72:75], a[108:111], a[140:143], v[72:75]
 v_cvt_pk_bf16_f32 v103, v110, v111
M v[72:75], a[104:107], a[136:139], v[72:75]
 buffer_store_dwordx4 v[100:103], v7, s[8:11], s30 offen offset:0 sc1
M v[72:75], a[100:103], a[132:135], v[72:75]
M v[72:75], a[96:99], a[128:131], v[72:75]
 s_waitcnt lgkmcnt(0)
 v_fma_f32 v112, v112, v5, v28
M v[80:83], a[64:67], a[128:131], v[32:35]
 ds_read_b128 a[96:99], v43 offset:24576
 v_fma_f32 v113, v113, v5, v28
M v[80:83], a[68:71], a[132:135], v[80:83]
 ds_read_b128 a[100:103], v43 offset:25600
 v_fma_f32 v114, v114, v5, v28
M v[80:83], a[72:75], a[136:139], v[80:83]
 v_fma_f32 v115, v115, v5, v28
M v[80:83], a[76:79], a[140:143], v[80:83]
 ds_read_b128 a[104:107], v43 offset:26624
 v_fma_f32 v120, v120, v5, v28
M v[80:83], a[80:83], a[144:147], v[80:83]
 ds_read_b128 a[108:111], v43 offset:27648
 v_fma_f32 v121, v121, v5, v28
M v[80:83], a[84:87], a[148:151], v[80:83]
 v_fma_f32 v122, v122, v5, v28
M v[80:83], a[88:91], a[152:155], v[80:83]
 ds_read_b128 a[112:115], v43 offset:28672
 v_fma_f32 v123, v123, v5, v28
M v[80:83], a[92:95], a[156:159], v[80:83]
 ds_read_b128 a[116:119], v43 offset:29696
 v_cvt_pk_bf16_f32 v112, v112, v113
M v[84:87], a[92:95], a[188:191], v[36:39]
 v_cvt_pk_bf16_f32 v113, v114, v115
 v_cvt_pk_bf16_f32 v114, v120, v121
M v[84:87], a[88:91], a[184:187], v[84:87]
 ds_read_b128 a[120:123], v43 offset:30720
 v_cvt_pk_bf16_f32 v115, v122, v123
M v[84:87], a[84:87], a[180:183], v[84:87]
 ds_read_b128 a[124:127], v43 offset:31744
M v[84:87], a[80:83], a[176:179], v[84:87]
 buffer_store_dwordx4 v[112:115], v7, s[8:11], s29 offen offset:1024 sc1
M v[84:87], a[76:79], a[172:175], v[84:87]
 v_fma_f32 v116, v116, v6, v29
M v[84:87], a[72:75], a[168:171], v[84:87]
 v_fma_f32 v117, v117, v6, v29
M v[84:87], a[68:71], a[164:167], v[84:87]
 s_waitcnt lgkmcnt(0)
 v_fma_f32 v118, v118, v6, v29
M v[84:87], a[64:67], a[160:163], v[84:87]
 s_barrier
M v[92:95], a[96:99], a[160:163], v[36:39]
 ds_read_b128 a[64:67], v2 offset:32768
 v_fma_f32 v119, v119, v6, v29
M v[92:95], a[100:103], a[164:167], v[92:95]
 ds_read_b128 a[68:71], v2 offset:33792
 v_fma_f32 v124, v124, v6, v29
M v[92:95], a[104:107], a[168:171], v[92:95]
 v_fma_f32 v125, v125, v6, v29
 v_fma_f32 v126, v126, v6, v29
M v[92:95], a[108:111], a[172:175], v[92:95]
 ds_read_b128 a[72:75], v2 offset:34816
 v_fma_f32 v127, v127, v6, v29
M v[92:95], a[112:115], a[176:179], v[92:95]
 ds_read_b128 a[76:79], v2 offset:35840
 v_cvt_pk_bf16_f32 v116, v116, v117
M v[92:95], a[116:119], a[180:183], v[92:95]
 v_cvt_pk_bf16_f32 v117, v118, v119
M v[92:95], a[120:123], a[184:187], v[92:95]
 ds_read_b128 a[80:83], v2 offset:36864
 v_cvt_pk_bf16_f32 v118, v124, v125
M v[92:95], a[124:127], a[188:191], v[92:95]
 ds_read_b128 a[84:87], v2 offset:37888
 v_cvt_pk_bf16_f32 v119, v126, v127
M v[88:91], a[124:127], a[156:159], v[32:35]
 buffer_store_dwordx4 v[116:119], v7, s[8:11], s30 offen offset:1024 sc1
M v[88:91], a[120:123], a[152:155], v[88:91]
 ds_read_b128 a[88:91], v2 offset:38912
M v[88:91], a[116:119], a[148:151], v[88:91]
 ds_read_b128 a[92:95], v2 offset:39936
M v[88:91], a[112:115], a[144:147], v[88:91]
M v[88:91], a[108:111], a[140:143], v[88:91]
M v[88:91], a[104:107], a[136:139], v[88:91]
M v[88:91], a[100:103], a[132:135], v[88:91]
 s_waitcnt lgkmcnt(0)
M v[88:91], a[96:99], a[128:131], v[88:91]
M v[96:99], a[64:67], a[128:131], v[32:35]
 ds_read_b128 a[96:99], v2 offset:40960
M v[96:99], a[68:71], a[132:135], v[96:99]
 ds_read_b128 a[100:103], v2 offset:41984
M v[96:99], a[72:75], a[136:139], v[96:99]
M v[96:99], a[76:79], a[140:143], v[96:99]
 ds_read_b128 a[104:107], v2 offset:43008
 s_add_u32 s29, s33, 8192
M v[96:99], a[80:83], a[144:147], v[96:99]
 ds_read_b128 a[108:111], v2 offset:44032
 s_add_u32 s30, s33, 22528
M v[96:99], a[84:87], a[148:151], v[96:99]
 v_fma_f32 v64, v64, v5, v28
 v_fma_f32 v65, v65, v5, v28
M v[96:99], a[88:91], a[152:155], v[96:99]
 ds_read_b128 a[112:115], v2 offset:45056
 v_fma_f32 v66, v66, v5, v28
M v[96:99], a[92:95], a[156:159], v[96:99]
 ds_read_b128 a[116:119], v2 offset:46080
 v_fma_f32 v67, v67, v5, v28
M v[100:103], a[92:95], a[188:191], v[36:39]
 v_fma_f32 v72, v72, v5, v28
M v[100:103], a[88:91], a[184:187], v[100:103]
 ds_read_b128 a[120:123], v2 offset:47104
 v_fma_f32 v73, v73, v5, v28
M v[100:103], a[84:87], a[180:183], v[100:103]
 ds_read_b128 a[124:127], v2 offset:48128
 v_fma_f32 v74, v74, v5, v28
M v[100:103], a[80:83], a[176:179], v[100:103]
 v_fma_f32 v75, v75, v5, v28
M v[100:103], a[76:79], a[172:175], v[100:103]
 v_cvt_pk_bf16_f32 v64, v64, v65
M v[100:103], a[72:75], a[168:171], v[100:103]
 v_cvt_pk_bf16_f32 v65, v66, v67
M v[100:103], a[68:71], a[164:167], v[100:103]
 v_cvt_pk_bf16_f32 v66, v72, v73
M v[100:103], a[64:67], a[160:163], v[100:103]
 s_waitcnt lgkmcnt(0)
 v_cvt_pk_bf16_f32 v67, v74, v75
M v[108:111], a[96:99], a[160:163], v[36:39]
 ds_read_b128 a[64:67], v2 offset:49152
M v[108:111], a[100:103], a[164:167], v[108:111]
 ds_read_b128 a[68:71], v2 offset:50176
M v[108:111], a[104:107], a[168:171], v[108:111]
 buffer_store_dwordx4 v[64:67], v7, s[8:11], s29 offen offset:0 sc1
M v[108:111], a[108:111], a[172:175], v[108:111]
 ds_read_b128 a[72:75], v2 offset:51200
 v_fma_f32 v68, v68, v6, v29
M v[108:111], a[112:115], a[176:179], v[108:111]
 ds_read_b128 a[76:79], v2 offset:52224
 v_fma_f32 v69, v69, v6, v29
M v[108:111], a[116:119], a[180:183], v[108:111]
 v_fma_f32 v70, v70, v6, v29
 v_fma_f32 v71, v71, v6, v29
M v[108:111], a[120:123], a[184:187], v[108:111]
 ds_read_b128 a[80:83], v2 offset:53248
 v_fma_f32 v76, v76, v6, v29
M v[108:111], a[124:127], a[188:191], v[108:111]
 ds_read_b128 a[84:87], v2 offset:54272
 v_fma_f32 v77, v77, v6, v29
M v[104:107], a[124:127], a[156:159], v[32:35]
 v_fma_f32 v78, v78, v6, v29
 v_fma_f32 v79, v79, v6, v29
M v[104:107], a[120:123], a[152:155], v[104:107]
 ds_read_b128 a[88:91], v2 offset:55296
 v_cvt_pk_bf16_f32 v68, v68, v69
M v[104:107], a[116:119], a[148:151], v[104:107]
 ds_read_b128 a[92:95], v2 offset:56320
 v_cvt_pk_bf16_f32 v69, v70, v71
M v[104:107], a[112:115], a[144:147], v[104:107]
 v_cvt_pk_bf16_f32 v70, v76, v77
M v[104:107], a[108:111], a[140:143], v[104:107]
 v_cvt_pk_bf16_f32 v71, v78, v79
M v[104:107], a[104:107], a[136:139], v[104:107]
 buffer_store_dwordx4 v[68:71], v7, s[8:11], s30 offen offset:0 sc1
M v[104:107], a[100:103], a[132:135], v[104:107]
M v[104:107], a[96:99], a[128:131], v[104:107]
 s_waitcnt lgkmcnt(0)
 v_fma_f32 v80, v80, v5, v28
M v[112:115], a[64:67], a[128:131], v[32:35]
 ds_read_b128 a[96:99], v2 offset:57344
 v_fma_f32 v81, v81, v5, v28
M v[112:115], a[68:71], a[132:135], v[112:115]
 ds_read_b128 a[100:103], v2 offset:58368
 v_fma_f32 v82, v82, v5, v28
M v[112:115], a[72:75], a[136:139], v[112:115]
 v_fma_f32 v83, v83, v5, v28
M v[112:115], a[76:79], a[140:143], v[112:115]
 ds_read_b128 a[104:107], v2 offset:59392
 v_fma_f32 v88, v88, v5, v28
M v[112:115], a[80:83], a[144:147], v[112:115]
 ds_read_b128 a[108:111], v2 offset:60416
 v_fma_f32 v89, v89, v5, v28
M v[112:115], a[84:87], a[148:151], v[112:115]
 v_fma_f32 v90, v90, v5, v28
M v[112:115], a[88:91], a[152:155], v[112:115]
 ds_read_b128 a[112:115], v2 offset:61440
 v_fma_f32 v91, v91, v5, v28
M v[112:115], a[92:95], a[156:159], v[112:115]
 ds_read_b128 a[116:119], v2 offset:62464
 v_cvt_pk_bf16_f32 v80, v80, v81
M v[116:119], a[92:95], a[188:191], v[36:39]
 s_waitcnt vmcnt(6)
 v_readlane_b32 s84, v25, 0
 v_readlane_b32 s85, v25, 1
M v[116:119], a[88:91], a[184:187], v[116:119]
 ds_read_b128 a[120:123], v2 offset:63488
 v_mov_b32 v24, 0x3f80
M v[116:119], a[84:87], a[180:183], v[116:119]
 ds_read_b128 a[124:127], v2 offset:64512
 v_mov_b32 v25, 0x3f800000
M v[116:119], a[80:83], a[176:179], v[116:119]
 v_cvt_pk_bf16_f32 v81, v82, v83
 v_cvt_pk_bf16_f32 v82, v88, v89
M v[116:119], a[76:79], a[172:175], v[116:119]
 v_cvt_pk_bf16_f32 v83, v90, v91
M v[116:119], a[72:75], a[168:171], v[116:119]
 buffer_store_dwordx4 v[80:83], v7, s[8:11], s29 offen offset:1024 sc1
M v[116:119], a[68:71], a[164:167], v[116:119]
 s_waitcnt lgkmcnt(0)
 v_fma_f32 v84, v84, v6, v29
 v_fma_f32 v85, v85, v6, v29
M v[116:119], a[64:67], a[160:163], v[116:119]
 s_barrier
M v[124:127], a[96:99], a[160:163], v[36:39]
 ds_read_b128 a[64:67], v7 offset:32768
 v_fma_f32 v86, v86, v6, v29
M v[124:127], a[100:103], a[164:167], v[124:127]
 ds_read_b128 a[68:71], v7 offset:33792
 v_fma_f32 v87, v87, v6, v29
M v[124:127], a[104:107], a[168:171], v[124:127]
 v_fma_f32 v92, v92, v6, v29
 v_fma_f32 v93, v93, v6, v29
M v[124:127], a[108:111], a[172:175], v[124:127]
 ds_read_b128 a[72:75], v7 offset:34816
 v_fma_f32 v94, v94, v6, v29
M v[124:127], a[112:115], a[176:179], v[124:127]
 ds_read_b128 a[76:79], v7 offset:35840
 v_fma_f32 v95, v95, v6, v29
M v[124:127], a[116:119], a[180:183], v[124:127]
 s_waitcnt vmcnt(3)
 v_cvt_pk_bf16_f32 v84, v84, v85
 v_cvt_pk_bf16_f32 v85, v86, v87
M v[124:127], a[120:123], a[184:187], v[124:127]
 ds_read_b128 a[80:83], v7 offset:36864
 v_cvt_pk_bf16_f32 v86, v92, v93
M v[124:127], a[124:127], a[188:191], v[124:127]
 ds_read_b128 a[84:87], v7 offset:37888
 v_cvt_pk_bf16_f32 v87, v94, v95
M v[120:123], a[124:127], a[156:159], v[32:35]
 buffer_store_dword v40, v41, s[8:11], s45 offen sc1
M v[120:123], a[120:123], a[152:155], v[120:123]
 ds_read_b128 a[88:91], v7 offset:38912
M v[120:123], a[116:119], a[148:151], v[120:123]
 ds_read_b128 a[92:95], v7 offset:39936
M v[120:123], a[112:115], a[144:147], v[120:123]
 buffer_store_dwordx4 v[84:87], v7, s[8:11], s30 offen offset:1024 sc1
M v[120:123], a[108:111], a[140:143], v[120:123]
M v[120:123], a[104:107], a[136:139], v[120:123]
M v[120:123], a[100:103], a[132:135], v[120:123]
 s_waitcnt lgkmcnt(0)
M v[120:123], a[96:99], a[128:131], v[120:123]
M v[64:67], a[64:67], a[128:131], v[32:35]
 ds_read_b128 a[96:99], v7 offset:40960
M v[64:67], a[68:71], a[132:135], v[64:67]
 ds_read_b128 a[100:103], v7 offset:41984
M v[64:67], a[72:75], a[136:139], v[64:67]
M v[64:67], a[76:79], a[140:143], v[64:67]
 ds_read_b128 a[104:107], v7 offset:43008
 s_add_u32 s29, s33, 10240
M v[64:67], a[80:83], a[144:147], v[64:67]
 ds_read_b128 a[108:111], v7 offset:44032
 s_add_u32 s30, s33, 24576
M v[64:67], a[84:87], a[148:151], v[64:67]
 v_fma_f32 v96, v96, v5, v28
 v_fma_f32 v97, v97, v5, v28
M v[64:67], a[88:91], a[152:155], v[64:67]
 ds_read_b128 a[112:115], v7 offset:45056
 v_fma_f32 v98, v98, v5, v28
M v[64:67], a[92:95], a[156:159], v[64:67]
 ds_read_b128 a[116:119], v7 offset:46080
 v_fma_f32 v99, v99, v5, v28
M v[68:71], a[92:95], a[188:191], v[36:39]
 v_fma_f32 v104, v104, v5, v28
 v_fma_f32 v105, v105, v5, v28
M v[68:71], a[88:91], a[184:187], v[68:71]
 ds_read_b128 a[120:123], v7 offset:47104
 v_fma_f32 v106, v106, v5, v28
M v[68:71], a[84:87], a[180:183], v[68:71]
 ds_read_b128 a[124:127], v7 offset:48128
 v_fma_f32 v107, v107, v5, v28
M v[68:71], a[80:83], a[176:179], v[68:71]
 v_cvt_pk_bf16_f32 v96, v96, v97
 v_cvt_pk_bf16_f32 v97, v98, v99
M v[68:71], a[76:79], a[172:175], v[68:71]
 v_cvt_pk_bf16_f32 v98, v104, v105
 v_cvt_pk_bf16_f32 v99, v106, v107
M v[68:71], a[72:75], a[168:171], v[68:71]
 buffer_store_dwordx4 v[96:99], v7, s[8:11], s29 offen offset:0 sc1
M v[68:71], a[68:71], a[164:167], v[68:71]
 v_fma_f32 v100, v100, v6, v29
 v_fma_f32 v101, v101, v6, v29
M v[68:71], a[64:67], a[160:163], v[68:71]
 s_waitcnt lgkmcnt(0)
 v_fma_f32 v102, v102, v6, v29
 v_fma_f32 v103, v103, v6, v29
M v[72:75], a[96:99], a[128:131], v[32:35]
 ds_read_b128 a[64:67], v7 offset:49152
 v_fma_f32 v108, v108, v6, v29
M v[72:75], a[100:103], a[132:135], v[72:75]
 ds_read_b128 a[68:71], v7 offset:50176
 v_fma_f32 v109, v109, v6, v29
M v[72:75], a[104:107], a[136:139], v[72:75]
 v_fma_f32 v110, v110, v6, v29
 v_fma_f32 v111, v111, v6, v29
M v[72:75], a[108:111], a[140:143], v[72:75]
 ds_read_b128 a[72:75], v7 offset:51200
 v_cvt_pk_bf16_f32 v100, v100, v101
M v[72:75], a[112:115], a[144:147], v[72:75]
 ds_read_b128 a[76:79], v7 offset:52224
 v_cvt_pk_bf16_f32 v101, v102, v103
M v[72:75], a[116:119], a[148:151], v[72:75]
 v_cvt_pk_bf16_f32 v102, v108, v109
 v_cvt_pk_bf16_f32 v103, v110, v111
M v[72:75], a[120:123], a[152:155], v[72:75]
 ds_read_b128 a[80:83], v7 offset:53248
M v[72:75], a[124:127], a[156:159], v[72:75]
 ds_read_b128 a[84:87], v7 offset:54272
M v[76:79], a[124:127], a[188:191], v[36:39]
 buffer_store_dwordx4 v[100:103], v7, s[8:11], s30 offen offset:0 sc1
M v[76:79], a[120:123], a[184:187], v[76:79]
 ds_read_b128 a[88:91], v7 offset:55296
 v_fma_f32 v112, v112, v5, v28
M v[76:79], a[116:119], a[180:183], v[76:79]
 ds_read_b128 a[92:95], v7 offset:56320
 v_fma_f32 v113, v113, v5, v28
M v[76:79], a[112:115], a[176:179], v[76:79]
 v_fma_f32 v114, v114, v5, v28
 v_fma_f32 v115, v115, v5, v28
M v[76:79], a[108:111], a[172:175], v[76:79]
 v_fma_f32 v120, v120, v5, v28
 v_fma_f32 v121, v121, v5, v28
M v[76:79], a[104:107], a[168:171], v[76:79]
 v_fma_f32 v122, v122, v5, v28
 v_fma_f32 v123, v123, v5, v28
M v[76:79], a[100:103], a[164:167], v[76:79]
 v_cvt_pk_bf16_f32 v112, v112, v113
 v_cvt_pk_bf16_f32 v113, v114, v115
M v[76:79], a[96:99], a[160:163], v[76:79]
 s_waitcnt lgkmcnt(0)
 v_cvt_pk_bf16_f32 v114, v120, v121
 v_cvt_pk_bf16_f32 v115, v122, v123
M v[80:83], a[64:67], a[128:131], v[32:35]
 ds_read_b128 a[96:99], v7 offset:57344
M v[80:83], a[68:71], a[132:135], v[80:83]
 ds_read_b128 a[100:103], v7 offset:58368
M v[80:83], a[72:75], a[136:139], v[80:83]
 buffer_store_dwordx4 v[112:115], v7, s[8:11], s29 offen offset:1024 sc1
M v[80:83], a[76:79], a[140:143], v[80:83]
 ds_read_b128 a[104:107], v7 offset:59392
 v_fma_f32 v116, v116, v6, v29
M v[80:83], a[80:83], a[144:147], v[80:83]
 ds_read_b128 a[108:111], v7 offset:60416
 v_fma_f32 v117, v117, v6, v29
M v[80:83], a[84:87], a[148:151], v[80:83]
 v_fma_f32 v118, v118, v6, v29
 v_fma_f32 v119, v119, v6, v29
M v[80:83], a[88:91], a[152:155], v[80:83]
 ds_read_b128 a[112:115], v7 offset:61440
 v_fma_f32 v124, v124, v6, v29
M v[80:83], a[92:95], a[156:159], v[80:83]
 ds_read_b128 a[116:119], v7 offset:62464
 v_fma_f32 v125, v125, v6, v29
M v[84:87], a[92:95], a[188:191], v[36:39]
 v_fma_f32 v126, v126, v6, v29
 v_fma_f32 v127, v127, v6, v29
M v[84:87], a[88:91], a[184:187], v[84:87]
 ds_read_b128 a[120:123], v7 offset:63488
 v_cvt_pk_bf16_f32 v116, v116, v117
M v[84:87], a[84:87], a[180:183], v[84:87]
 ds_read_b128 a[124:127], v7 offset:64512
 v_cvt_pk_bf16_f32 v117, v118, v119
M v[84:87], a[80:83], a[176:179], v[84:87]
 v_cvt_pk_bf16_f32 v118, v124, v125
 v_cvt_pk_bf16_f32 v119, v126, v127
M v[84:87], a[76:79], a[172:175], v[84:87]
 buffer_store_dwordx4 v[116:119], v7, s[8:11], s30 offen offset:1024 sc1
M v[84:87], a[72:75], a[168:171], v[84:87]
 s_add_u32 s29, s33, 12288
M v[84:87], a[68:71], a[164:167], v[84:87]
 s_add_u32 s30, s33, 26624
 v_fma_f32 v64, v64, v5, v28
 v_fma_f32 v65, v65, v5, v28
M v[84:87], a[64:67], a[160:163], v[84:87]
 s_waitcnt lgkmcnt(0)
 v_fma_f32 v66, v66, v5, v28
 v_fma_f32 v67, v67, v5, v28
M v[88:91], a[96:99], a[128:131], v[32:35]
 v_fma_f32 v72, v72, v5, v28
 v_fma_f32 v73, v73, v5, v28
M v[88:91], a[100:103], a[132:135], v[88:91]
 v_fma_f32 v74, v74, v5, v28
 v_fma_f32 v75, v75, v5, v28
M v[88:91], a[104:107], a[136:139], v[88:91]
 v_cvt_pk_bf16_f32 v64, v64, v65
 v_cvt_pk_bf16_f32 v65, v66, v67
M v[88:91], a[108:111], a[140:143], v[88:91]
 v_cvt_pk_bf16_f32 v66, v72, v73
 v_cvt_pk_bf16_f32 v67, v74, v75
M v[88:91], a[112:115], a[144:147], v[88:91]
 buffer_store_dwordx4 v[64:67], v7, s[8:11], s29 offen offset:0 sc1
M v[88:91], a[116:119], a[148:151], v[88:91]
 v_fma_f32 v68, v68, v6, v29
 v_fma_f32 v69, v69, v6, v29
M v[88:91], a[120:123], a[152:155], v[88:91]
 v_fma_f32 v70, v70, v6, v29
 v_fma_f32 v71, v71, v6, v29
M v[88:91], a[124:127], a[156:159], v[88:91]
 v_fma_f32 v76, v76, v6, v29
 v_fma_f32 v77, v77, v6, v29
M v[92:95], a[124:127], a[188:191], v[36:39]
 v_fma_f32 v78, v78, v6, v29
 v_fma_f32 v79, v79, v6, v29
M v[92:95], a[120:123], a[184:187], v[92:95]
 v_cvt_pk_bf16_f32 v68, v68, v69
 v_cvt_pk_bf16_f32 v69, v70, v71
M v[92:95], a[116:119], a[180:183], v[92:95]
 v_cvt_pk_bf16_f32 v70, v76, v77
 v_cvt_pk_bf16_f32 v71, v78, v79
M v[92:95], a[112:115], a[176:179], v[92:95]
 buffer_store_dwordx4 v[68:71], v7, s[8:11], s30 offen offset:0 sc1
M v[92:95], a[108:111], a[172:175], v[92:95]
M v[92:95], a[104:107], a[168:171], v[92:95]
M v[92:95], a[100:103], a[164:167], v[92:95]
M v[92:95], a[96:99], a[160:163], v[92:95]
 v_fma_f32 v80, v80, v5, v28
 v_fma_f32 v81, v81, v5, v28
 v_fma_f32 v82, v82, v5, v28
 v_fma_f32 v83, v83, v5, v28
 v_fma_f32 v88, v88, v5, v28
 v_fma_f32 v89, v89, v5, v28
 v_fma_f32 v90, v90, v5, v28
 v_fma_f32 v91, v91, v5, v28
 v_cvt_pk_bf16_f32 v80, v80, v81
 v_cvt_pk_bf16_f32 v81, v82, v83
 v_cvt_pk_bf16_f32 v82, v88, v89
 v_cvt_pk_bf16_f32 v83, v90, v91
 buffer_store_dwordx4 v[80:83], v7, s[8:11], s29 offen offset:1024 sc1
 v_fma_f32 v84, v84, v6, v29
 v_fma_f32 v85, v85, v6, v29
 v_fma_f32 v86, v86, v6, v29
 v_fma_f32 v87, v87, v6, v29
 v_fma_f32 v92, v92, v6, v29
 v_fma_f32 v93, v93, v6, v29
 v_fma_f32 v94, v94, v6, v29
 v_fma_f32 v95, v95, v6, v29
 v_cvt_pk_bf16_f32 v84, v84, v85
 v_cvt_pk_bf16_f32 v85, v86, v87
 v_cvt_pk_bf16_f32 v86, v92, v93
 v_cvt_pk_bf16_f32 v87, v94, v95
 buffer_store_dwordx4 v[84:87], v7, s[8:11], s30 offen offset:1024 sc1
L_red:
 s_lshl_b32 s64, s42, 1
 s_lshr_b32 s65, s41, 3
 s_add_u32 s46, s64, s65
 s_mul_i32 s46, s46, 4352
 s_and_b32 s72, s41, 7
 s_lshl_b32 s66, s72, 7
 s_add_u32 s46, s46, s66
 s_add_u32 s46, s46, 104992768
 v_and_b32 v14, 31, v0
 v_lshlrev_b32 v14, 2, v14
 buffer_load_dword v9, v14, s[8:11], s46 offen sc1
 s_mul_i32 s86, s65, 4
 s_add_u32 s86, s86, s20
 s_mul_i32 s77, s42, 1835008
 s_mul_i32 s78, s72, 14336
 s_add_u32 s77, s77, s78
 s_add_u32 s77, s77, 67108864
 s_sub_u32 s64, 15, s64
 s_sub_u32 s78, s64, 1
 s_mul_i32 s78, s78, 1835008
 s_add_u32 s78, s78, s77
 s_lshl_b32 s66, s86, 10
 s_add_u32 s78, s78, s66
 s_lshl_b32 s66, s74, 10
 s_add_u32 s77, s77, s66
 s_lshl_b32 s66, s64, 7
 s_lshl_b32 s86, s86, 6
 s_lshr_b32 s73, s72, 1
 s_sub_u32 s65, 7, s73
 s_bitcmp1_b32 s72, 0
 s_cselect_b32 s73, s65, s73
 s_lshl_b32 s73, s73, 4
 s_lshl_b32 s65, s42, 7
 s_add_u32 s73, s73, s65
 v_and_b32 v10, 15, v0
 v_add_u32 v10, s73, v10
 v_add_u32 v29, s66, v10
 s_mov_b32 s64, 104857664
 v_mul_u32_u24 v12, 896, v10
 v_lshl_add_u32 v12, v11, 4, v12
 v_lshrrev_b32 v13, 4, v10
 v_lshlrev_b32 v13, 5, v13
 v_and_b32 v104, 15, v10
 v_add_lshl_u32 v13, v13, v104, 2
 buffer_load_dword v15, v13, s[8:11], s64 offen sc1
 buffer_load_dwordx4 v[16:19], v12, s[56:59], s75 offen
 buffer_load_dwordx4 v[20:23], v12, s[56:59], s76 offen
 v_mov_b32 v48, 0
 v_mov_b32 v49, 0
 v_mov_b32 v50, 0
 v_mov_b32 v51, 0
 v_mov_b32 v52, 0
 v_mov_b32 v53, 0
 v_mov_b32 v54, 0
 v_mov_b32 v55, 0
 v_mov_b32 v56, 0
 v_mov_b32 v57, 0
 v_mov_b32 v58, 0
 v_mov_b32 v59, 0
 v_mov_b32 v60, 0
 v_mov_b32 v61, 0
 v_mov_b32 v62, 0
 v_mov_b32 v63, 0
 v_mul_u32_u24 v28, 896, v29
 v_lshl_add_u32 v28, v11, 4, v28
 v_lshrrev_b32 v13, 4, v29
 v_lshlrev_b32 v13, 5, v13
 v_and_b32 v104, 15, v29
 v_add_lshl_u32 v13, v13, v104, 2
 buffer_load_dword v26, v13, s[8:11], s64 offen sc1
 buffer_load_dwordx4 v[96:99], v28, s[56:59], s86 offen
 v_mov_b32 v64, 0
 v_mov_b32 v65, 0
 v_mov_b32 v66, 0
 v_mov_b32 v67, 0
 v_mov_b32 v68, 0
 v_mov_b32 v69, 0
 v_mov_b32 v70, 0
 v_mov_b32 v71, 0
 s_waitcnt vmcnt(6)
 buffer_store_dword v40, v41, s[8:11], s3 offen sc1
 s_waitcnt vmcnt(6)
 v_cmp_eq_u32 vcc, 1, v9
 s_mov_b32 s91, 65536
 s_mov_b32 s69, 0
 s_mov_b32 s70, vcc_lo
 s_mov_b32 s68, vcc_lo
 s_cmp_lg_u32 s70, 0
 s_cbranch_scc1 L_rk0
 s_call_b64 s[36:37], L_rpoll
L_rk0:
 s_ff1_i32_b32 s71, s70
 s_bitset0_b32 s70, s71
 s_cmp_ge_u32 s71, 16
 s_cselect_b32 s72, s78, s77
 s_cselect_b32 s73, 0x1, 0
 s_cselect_b32 s87, 536870912, 0
 s_mul_i32 s71, s71, 114688
 s_add_u32 s71, s71, s72
 buffer_load_dwordx4 v[128:131], v7, s[8:11], s71 offen sc1 nt
 s_or_b32 s69, s69, s73
 s_or_b32 s71, s71, s87
 buffer_load_dwordx4 v[132:135], v27, s[8:11], s71 offen sc1 nt
 s_cmp_lg_u32 s70, 0
 s_cbranch_scc1 L_rk1
 s_call_b64 s[36:37], L_rpoll
L_rk1:
 s_ff1_i32_b32 s71, s70
 s_bitset0_b32 s70, s71
 s_cmp_ge_u32 s71, 16
 s_cselect_b32 s72, s78, s77
 s_cselect_b32 s73, 0x2, 0
 s_cselect_b32 s87, 536870912, 0
 s_mul_i32 s71, s71, 114688
 s_add_u32 s71, s71, s72
 buffer_load_dwordx4 v[136:139], v7, s[8:11], s71 offen sc1 nt
 s_or_b32 s69, s69, s73
 s_or_b32 s71, s71, s87
 buffer_load_dwordx4 v[140:143], v27, s[8:11], s71 offen sc1 nt
 s_waitcnt vmcnt(8)
 v_lshlrev_b32 v32, 16, v16
 v_and_b32 v33, 0xffff0000, v16
 v_lshlrev_b32 v34, 16, v17
 v_and_b32 v35, 0xffff0000, v17
 v_lshlrev_b32 v36, 16, v18
 v_and_b32 v37, 0xffff0000, v18
 v_lshlrev_b32 v38, 16, v19
 v_and_b32 v39, 0xffff0000, v19
 s_waitcnt vmcnt(7)
 v_lshlrev_b32 v40, 16, v20
 v_and_b32 v41, 0xffff0000, v20
 v_lshlrev_b32 v42, 16, v21
 v_and_b32 v43, 0xffff0000, v21
 v_lshlrev_b32 v44, 16, v22
 v_and_b32 v45, 0xffff0000, v22
 v_lshlrev_b32 v46, 16, v23
 v_and_b32 v47, 0xffff0000, v23
 v_sub_f32 v13, 1.0, v15
 v_cmp_eq_u32 s[80:81], s84, v10
 v_cmp_eq_u32 s[82:83], s85, v10
 s_nop 0
 s_or_b64 vcc, s[80:81], s[82:83]
 s_cbranch_vccnz L_moe0
L_moe_ret0:
 v_mul_f32 v32, v13, v32
 v_mul_f32 v33, v13, v33
 v_mul_f32 v34, v13, v34
 v_mul_f32 v35, v13, v35
 v_mul_f32 v36, v13, v36
 v_mul_f32 v37, v13, v37
 v_mul_f32 v38, v13, v38
 v_mul_f32 v39, v13, v39
 v_mul_f32 v40, v13, v40
 v_mul_f32 v41, v13, v41
 v_mul_f32 v42, v13, v42
 v_mul_f32 v43, v13, v43
 v_mul_f32 v44, v13, v44
 v_mul_f32 v45, v13, v45
 v_mul_f32 v46, v13, v46
 v_mul_f32 v47, v13, v47
 s_cmp_lg_u32 s70, 0
 s_cbranch_scc1 L_rk2
 s_call_b64 s[36:37], L_rpoll
L_rk2:
 s_ff1_i32_b32 s71, s70
 s_bitset0_b32 s70, s71
 s_cmp_ge_u32 s71, 16
 s_cselect_b32 s72, s78, s77
 s_cselect_b32 s73, 0x4, 0
 s_cselect_b32 s87, 536870912, 0
 s_mul_i32 s71, s71, 114688
 s_add_u32 s71, s71, s72
 buffer_load_dwordx4 v[144:147], v7, s[8:11], s71 offen sc1 nt
 s_or_b32 s69, s69, s73
 s_or_b32 s71, s71, s87
 buffer_load_dwordx4 v[148:151], v27, s[8:11], s71 offen sc1 nt
 s_waitcnt vmcnt(7)
 v_lshlrev_b32 v80, 16, v96
 v_and_b32 v81, 0xffff0000, v96
 v_lshlrev_b32 v82, 16, v97
 v_and_b32 v83, 0xffff0000, v97
 v_lshlrev_b32 v84, 16, v98
 v_and_b32 v85, 0xffff0000, v98
 v_lshlrev_b32 v86, 16, v99
 v_and_b32 v87, 0xffff0000, v99
 v_sub_f32 v13, 1.0, v26
 v_cmp_eq_u32 s[80:81], s84, v29
 v_cmp_eq_u32 s[82:83], s85, v29
 s_nop 0
 s_or_b64 vcc, s[80:81], s[82:83]
 s_cbranch_vccnz L_moe1
L_moe_ret1:
 v_mul_f32 v80, v13, v80
 v_mul_f32 v81, v13, v81
 v_mul_f32 v82, v13, v82
 v_mul_f32 v83, v13, v83
 v_mul_f32 v84, v13, v84
 v_mul_f32 v85, v13, v85
 v_mul_f32 v86, v13, v86
 v_mul_f32 v87, v13, v87
 s_cmp_lg_u32 s70, 0
 s_cbranch_scc1 L_rk3
 s_call_b64 s[36:37], L_rpoll
L_rk3:
 s_ff1_i32_b32 s71, s70
 s_bitset0_b32 s70, s71
 s_cmp_ge_u32 s71, 16
 s_cselect_b32 s72, s78, s77
 s_cselect_b32 s73, 0x8, 0
 s_cselect_b32 s87, 536870912, 0
 s_mul_i32 s71, s71, 114688
 s_add_u32 s71, s71, s72
 buffer_load_dwordx4 v[152:155], v7, s[8:11], s71 offen sc1 nt
 s_or_b32 s69, s69, s73
 s_or_b32 s71, s71, s87
 buffer_load_dwordx4 v[156:159], v27, s[8:11], s71 offen sc1 nt
 s_cmp_lg_u32 s70, 0
 s_cbranch_scc1 L_rk4
 s_call_b64 s[36:37], L_rpoll
L_rk4:
 s_ff1_i32_b32 s71, s70
 s_bitset0_b32 s70, s71
 s_cmp_ge_u32 s71, 16
 s_cselect_b32 s72, s78, s77
 s_cselect_b32 s73, 0x10, 0
 s_cselect_b32 s87, 536870912, 0
 s_mul_i32 s71, s71, 114688
 s_add_u32 s71, s71, s72
 buffer_load_dwordx4 v[160:163], v7, s[8:11], s71 offen sc1 nt
 s_or_b32 s69, s69, s73
 s_or_b32 s71, s71, s87
 buffer_load_dwordx4 v[164:167], v27, s[8:11], s71 offen sc1 nt
 s_cmp_lg_u32 s70, 0
 s_cbranch_scc1 L_rk5
 s_call_b64 s[36:37], L_rpoll
L_rk5:
 s_ff1_i32_b32 s71, s70
 s_bitset0_b32 s70, s71
 s_cmp_ge_u32 s71, 16
 s_cselect_b32 s72, s78, s77
 s_cselect_b32 s73, 0x20, 0
 s_cselect_b32 s87, 536870912, 0
 s_mul_i32 s71, s71, 114688
 s_add_u32 s71, s71, s72
 buffer_load_dwordx4 v[168:171], v7, s[8:11], s71 offen sc1 nt
 s_or_b32 s69, s69, s73
 s_or_b32 s71, s71, s87
 buffer_load_dwordx4 v[172:175], v27, s[8:11], s71 offen sc1 nt
 s_cmp_lg_u32 s70, 0
 s_cbranch_scc1 L_rk6
 s_call_b64 s[36:37], L_rpoll
L_rk6:
 s_ff1_i32_b32 s71, s70
 s_bitset0_b32 s70, s71
 s_cmp_ge_u32 s71, 16
 s_cselect_b32 s72, s78, s77
 s_cselect_b32 s73, 0x40, 0
 s_cselect_b32 s87, 536870912, 0
 s_mul_i32 s71, s71, 114688
 s_add_u32 s71, s71, s72
 buffer_load_dwordx4 v[176:179], v7, s[8:11], s71 offen sc1 nt
 s_or_b32 s69, s69, s73
 s_or_b32 s71, s71, s87
 buffer_load_dwordx4 v[180:183], v27, s[8:11], s71 offen sc1 nt
 s_cmp_lg_u32 s70, 0
 s_cbranch_scc1 L_rk7
 s_call_b64 s[36:37], L_rpoll
L_rk7:
 s_ff1_i32_b32 s71, s70
 s_bitset0_b32 s70, s71
 s_cmp_ge_u32 s71, 16
 s_cselect_b32 s72, s78, s77
 s_cselect_b32 s73, 0x80, 0
 s_cselect_b32 s87, 536870912, 0
 s_mul_i32 s71, s71, 114688
 s_add_u32 s71, s71, s72
 buffer_load_dwordx4 v[184:187], v7, s[8:11], s71 offen sc1 nt
 s_or_b32 s69, s69, s73
 s_or_b32 s71, s71, s87
 buffer_load_dwordx4 v[188:191], v27, s[8:11], s71 offen sc1 nt
 s_cmp_lg_u32 s70, 0
 s_cbranch_scc1 L_rk8
 s_call_b64 s[36:37], L_rpoll
L_rk8:
 s_ff1_i32_b32 s71, s70
 s_bitset0_b32 s70, s71
 s_cmp_ge_u32 s71, 16
 s_cselect_b32 s72, s78, s77
 s_cselect_b32 s73, 0x100, 0
 s_cselect_b32 s87, 536870912, 0
 s_mul_i32 s71, s71, 114688
 s_add_u32 s71, s71, s72
 buffer_load_dwordx4 v[192:195], v7, s[8:11], s71 offen sc1 nt
 s_or_b32 s69, s69, s73
 s_or_b32 s71, s71, s87
 buffer_load_dwordx4 v[196:199], v27, s[8:11], s71 offen sc1 nt
 s_waitcnt vmcnt(16)
 s_bitcmp1_b32 s69, 0
 s_cbranch_scc1 L_rx0
 v_dot2c_f32_bf16 v48, v128, v24
 v_dot2c_f32_bf16 v49, v128, v25
 v_dot2c_f32_bf16 v50, v129, v24
 v_dot2c_f32_bf16 v51, v129, v25
 v_dot2c_f32_bf16 v52, v130, v24
 v_dot2c_f32_bf16 v53, v130, v25
 v_dot2c_f32_bf16 v54, v131, v24
 v_dot2c_f32_bf16 v55, v131, v25
 v_dot2c_f32_bf16 v56, v132, v24
 v_dot2c_f32_bf16 v57, v132, v25
 v_dot2c_f32_bf16 v58, v133, v24
 v_dot2c_f32_bf16 v59, v133, v25
 v_dot2c_f32_bf16 v60, v134, v24
 v_dot2c_f32_bf16 v61, v134, v25
 v_dot2c_f32_bf16 v62, v135, v24
 v_dot2c_f32_bf16 v63, v135, v25
L_ry0:
 s_cmp_lg_u32 s70, 0
 s_cbranch_scc1 L_rk9
 s_call_b64 s[36:37], L_rpoll
L_rk9:
 s_ff1_i32_b32 s71, s70
 s_bitset0_b32 s70, s71
 s_cmp_ge_u32 s71, 16
 s_cselect_b32 s72, s78, s77
 s_cselect_b32 s73, 0x200, 0
 s_cselect_b32 s87, 536870912, 0
 s_mul_i32 s71, s71, 114688
 s_add_u32 s71, s71, s72
 buffer_load_dwordx4 v[200:203], v7, s[8:11], s71 offen sc1 nt
 s_or_b32 s69, s69, s73
 s_or_b32 s71, s71, s87
 buffer_load_dwordx4 v[204:207], v27, s[8:11], s71 offen sc1 nt
 s_waitcnt vmcnt(16)
 s_bitcmp1_b32 s69, 1
 s_cbranch_scc1 L_rx1
 v_dot2c_f32_bf16 v48, v136, v24
 v_dot2c_f32_bf16 v49, v136, v25
 v_dot2c_f32_bf16 v50, v137, v24
 v_dot2c_f32_bf16 v51, v137, v25
 v_dot2c_f32_bf16 v52, v138, v24
 v_dot2c_f32_bf16 v53, v138, v25
 v_dot2c_f32_bf16 v54, v139, v24
 v_dot2c_f32_bf16 v55, v139, v25
 v_dot2c_f32_bf16 v56, v140, v24
 v_dot2c_f32_bf16 v57, v140, v25
 v_dot2c_f32_bf16 v58, v141, v24
 v_dot2c_f32_bf16 v59, v141, v25
 v_dot2c_f32_bf16 v60, v142, v24
 v_dot2c_f32_bf16 v61, v142, v25
 v_dot2c_f32_bf16 v62, v143, v24
 v_dot2c_f32_bf16 v63, v143, v25
L_ry1:
 s_cmp_lg_u32 s70, 0
 s_cbranch_scc1 L_rk10
 s_call_b64 s[36:37], L_rpoll
L_rk10:
 s_ff1_i32_b32 s71, s70
 s_bitset0_b32 s70, s71
 s_cmp_ge_u32 s71, 16
 s_cselect_b32 s72, s78, s77
 s_cselect_b32 s73, 0x400, 0
 s_cselect_b32 s87, 536870912, 0
 s_mul_i32 s71, s71, 114688
 s_add_u32 s71, s71, s72
 buffer_load_dwordx4 v[208:211], v7, s[8:11], s71 offen sc1 nt
 s_or_b32 s69, s69, s73
 s_or_b32 s71, s71, s87
 buffer_load_dwordx4 v[212:215], v27, s[8:11], s71 offen sc1 nt
 s_waitcnt vmcnt(16)
 s_bitcmp1_b32 s69, 2
 s_cbranch_scc1 L_rx2
 v_dot2c_f32_bf16 v48, v144, v24
 v_dot2c_f32_bf16 v49, v144, v25
 v_dot2c_f32_bf16 v50, v145, v24
 v_dot2c_f32_bf16 v51, v145, v25
 v_dot2c_f32_bf16 v52, v146, v24
 v_dot2c_f32_bf16 v53, v146, v25
 v_dot2c_f32_bf16 v54, v147, v24
 v_dot2c_f32_bf16 v55, v147, v25
 v_dot2c_f32_bf16 v56, v148, v24
 v_dot2c_f32_bf16 v57, v148, v25
 v_dot2c_f32_bf16 v58, v149, v24
 v_dot2c_f32_bf16 v59, v149, v25
 v_dot2c_f32_bf16 v60, v150, v24
 v_dot2c_f32_bf16 v61, v150, v25
 v_dot2c_f32_bf16 v62, v151, v24
 v_dot2c_f32_bf16 v63, v151, v25
L_ry2:
 s_cmp_lg_u32 s70, 0
 s_cbranch_scc1 L_rk11
 s_call_b64 s[36:37], L_rpoll
L_rk11:
 s_ff1_i32_b32 s71, s70
 s_bitset0_b32 s70, s71
 s_cmp_ge_u32 s71, 16
 s_cselect_b32 s72, s78, s77
 s_cselect_b32 s73, 0x800, 0
 s_cselect_b32 s87, 536870912, 0
 s_mul_i32 s71, s71, 114688
 s_add_u32 s71, s71, s72
 buffer_load_dwordx4 v[216:219], v7, s[8:11], s71 offen sc1 nt
 s_or_b32 s69, s69, s73
 s_or_b32 s71, s71, s87
 buffer_load_dwordx4 v[220:223], v27, s[8:11], s71 offen sc1 nt
 s_waitcnt vmcnt(16)
 s_bitcmp1_b32 s69, 3
 s_cbranch_scc1 L_rx3
 v_dot2c_f32_bf16 v48, v152, v24
 v_dot2c_f32_bf16 v49, v152, v25
 v_dot2c_f32_bf16 v50, v153, v24
 v_dot2c_f32_bf16 v51, v153, v25
 v_dot2c_f32_bf16 v52, v154, v24
 v_dot2c_f32_bf16 v53, v154, v25
 v_dot2c_f32_bf16 v54, v155, v24
 v_dot2c_f32_bf16 v55, v155, v25
 v_dot2c_f32_bf16 v56, v156, v24
 v_dot2c_f32_bf16 v57, v156, v25
 v_dot2c_f32_bf16 v58, v157, v24
 v_dot2c_f32_bf16 v59, v157, v25
 v_dot2c_f32_bf16 v60, v158, v24
 v_dot2c_f32_bf16 v61, v158, v25
 v_dot2c_f32_bf16 v62, v159, v24
 v_dot2c_f32_bf16 v63, v159, v25
L_ry3:
 s_cmp_lg_u32 s70, 0
 s_cbranch_scc1 L_rk12
 s_call_b64 s[36:37], L_rpoll
L_rk12:
 s_ff1_i32_b32 s71, s70
 s_bitset0_b32 s70, s71
 s_cmp_ge_u32 s71, 16
 s_cselect_b32 s72, s78, s77
 s_cselect_b32 s73, 0x1000, 0
 s_cselect_b32 s87, 536870912, 0
 s_mul_i32 s71, s71, 114688
 s_add_u32 s71, s71, s72
 buffer_load_dwordx4 v[224:227], v7, s[8:11], s71 offen sc1 nt
 s_or_b32 s69, s69, s73
 s_or_b32 s71, s71, s87
 buffer_load_dwordx4 v[228:231], v27, s[8:11], s71 offen sc1 nt
 s_waitcnt vmcnt(16)
 s_bitcmp1_b32 s69, 4
 s_cbranch_scc1 L_rx4
 v_dot2c_f32_bf16 v48, v160, v24
 v_dot2c_f32_bf16 v49, v160, v25
 v_dot2c_f32_bf16 v50, v161, v24
 v_dot2c_f32_bf16 v51, v161, v25
 v_dot2c_f32_bf16 v52, v162, v24
 v_dot2c_f32_bf16 v53, v162, v25
 v_dot2c_f32_bf16 v54, v163, v24
 v_dot2c_f32_bf16 v55, v163, v25
 v_dot2c_f32_bf16 v56, v164, v24
 v_dot2c_f32_bf16 v57, v164, v25
 v_dot2c_f32_bf16 v58, v165, v24
 v_dot2c_f32_bf16 v59, v165, v25
 v_dot2c_f32_bf16 v60, v166, v24
 v_dot2c_f32_bf16 v61, v166, v25
 v_dot2c_f32_bf16 v62, v167, v24
 v_dot2c_f32_bf16 v63, v167, v25
L_ry4:
 s_cmp_lg_u32 s70, 0
 s_cbranch_scc1 L_rk13
 s_call_b64 s[36:37], L_rpoll
L_rk13:
 s_ff1_i32_b32 s71, s70
 s_bitset0_b32 s70, s71
 s_cmp_ge_u32 s71, 16
 s_cselect_b32 s72, s78, s77
 s_cselect_b32 s73, 0x2000, 0
 s_cselect_b32 s87, 536870912, 0
 s_mul_i32 s71, s71, 114688
 s_add_u32 s71, s71, s72
 buffer_load_dwordx4 v[232:235], v7, s[8:11], s71 offen sc1 nt
 s_or_b32 s69, s69, s73
 s_or_b32 s71, s71, s87
 buffer_load_dwordx4 v[236:239], v27, s[8:11], s71 offen sc1 nt
 s_waitcnt vmcnt(16)
 s_bitcmp1_b32 s69, 5
 s_cbranch_scc1 L_rx5
 v_dot2c_f32_bf16 v48, v168, v24
 v_dot2c_f32_bf16 v49, v168, v25
 v_dot2c_f32_bf16 v50, v169, v24
 v_dot2c_f32_bf16 v51, v169, v25
 v_dot2c_f32_bf16 v52, v170, v24
 v_dot2c_f32_bf16 v53, v170, v25
 v_dot2c_f32_bf16 v54, v171, v24
 v_dot2c_f32_bf16 v55, v171, v25
 v_dot2c_f32_bf16 v56, v172, v24
 v_dot2c_f32_bf16 v57, v172, v25
 v_dot2c_f32_bf16 v58, v173, v24
 v_dot2c_f32_bf16 v59, v173, v25
 v_dot2c_f32_bf16 v60, v174, v24
 v_dot2c_f32_bf16 v61, v174, v25
 v_dot2c_f32_bf16 v62, v175, v24
 v_dot2c_f32_bf16 v63, v175, v25
L_ry5:
 s_cmp_lg_u32 s70, 0
 s_cbranch_scc1 L_rk14
 s_call_b64 s[36:37], L_rpoll
L_rk14:
 s_ff1_i32_b32 s71, s70
 s_bitset0_b32 s70, s71
 s_cmp_ge_u32 s71, 16
 s_cselect_b32 s72, s78, s77
 s_cselect_b32 s73, 0x4000, 0
 s_cselect_b32 s87, 536870912, 0
 s_mul_i32 s71, s71, 114688
 s_add_u32 s71, s71, s72
 buffer_load_dwordx4 v[240:243], v7, s[8:11], s71 offen sc1 nt
 s_or_b32 s69, s69, s73
 s_or_b32 s71, s71, s87
 buffer_load_dwordx4 v[244:247], v27, s[8:11], s71 offen sc1 nt
 s_waitcnt vmcnt(16)
 s_bitcmp1_b32 s69, 6
 s_cbranch_scc1 L_rx6
 v_dot2c_f32_bf16 v48, v176, v24
 v_dot2c_f32_bf16 v49, v176, v25
 v_dot2c_f32_bf16 v50, v177, v24
 v_dot2c_f32_bf16 v51, v177, v25
 v_dot2c_f32_bf16 v52, v178, v24
 v_dot2c_f32_bf16 v53, v178, v25
 v_dot2c_f32_bf16 v54, v179, v24
 v_dot2c_f32_bf16 v55, v179, v25
 v_dot2c_f32_bf16 v56, v180, v24
 v_dot2c_f32_bf16 v57, v180, v25
 v_dot2c_f32_bf16 v58, v181, v24
 v_dot2c_f32_bf16 v59, v181, v25
 v_dot2c_f32_bf16 v60, v182, v24
 v_dot2c_f32_bf16 v61, v182, v25
 v_dot2c_f32_bf16 v62, v183, v24
 v_dot2c_f32_bf16 v63, v183, v25
L_ry6:
 s_cmp_lg_u32 s70, 0
 s_cbranch_scc1 L_rk15
 s_call_b64 s[36:37], L_rpoll
L_rk15:
 s_ff1_i32_b32 s71, s70
 s_bitset0_b32 s70, s71
 s_cmp_ge_u32 s71, 16
 s_cselect_b32 s72, s78, s77
 s_cselect_b32 s73, 0x8000, 0
 s_cselect_b32 s87, 536870912, 0
 s_mul_i32 s71, s71, 114688
 s_add_u32 s71, s71, s72
 buffer_load_dwordx4 v[248:251], v7, s[8:11], s71 offen sc1 nt
 s_or_b32 s69, s69, s73
 s_or_b32 s71, s71, s87
 buffer_load_dwordx4 v[252:255], v27, s[8:11], s71 offen sc1 nt
 s_waitcnt vmcnt(16)
 s_bitcmp1_b32 s69, 7
 s_cbranch_scc1 L_rx7
 v_dot2c_f32_bf16 v48, v184, v24
 v_dot2c_f32_bf16 v49, v184, v25
 v_dot2c_f32_bf16 v50, v185, v24
 v_dot2c_f32_bf16 v51, v185, v25
 v_dot2c_f32_bf16 v52, v186, v24
 v_dot2c_f32_bf16 v53, v186, v25
 v_dot2c_f32_bf16 v54, v187, v24
 v_dot2c_f32_bf16 v55, v187, v25
 v_dot2c_f32_bf16 v56, v188, v24
 v_dot2c_f32_bf16 v57, v188, v25
 v_dot2c_f32_bf16 v58, v189, v24
 v_dot2c_f32_bf16 v59, v189, v25
 v_dot2c_f32_bf16 v60, v190, v24
 v_dot2c_f32_bf16 v61, v190, v25
 v_dot2c_f32_bf16 v62, v191, v24
 v_dot2c_f32_bf16 v63, v191, v25
L_ry7:
 s_cmp_lg_u32 s70, 0
 s_cbranch_scc1 L_rk16
 s_call_b64 s[36:37], L_rpoll
L_rk16:
 s_ff1_i32_b32 s71, s70
 s_bitset0_b32 s70, s71
 s_cmp_ge_u32 s71, 16
 s_cselect_b32 s72, s78, s77
 s_cselect_b32 s73, 0x10000, 0
 s_cselect_b32 s87, 536870912, 0
 s_mul_i32 s71, s71, 114688
 s_add_u32 s71, s71, s72
 buffer_load_dwordx4 v[128:131], v7, s[8:11], s71 offen sc1 nt
 s_or_b32 s69, s69, s73
 s_or_b32 s71, s71, s87
 buffer_load_dwordx4 v[132:135], v27, s[8:11], s71 offen sc1 nt
 s_waitcnt vmcnt(16)
 s_bitcmp1_b32 s69, 8
 s_cbranch_scc1 L_rx8
 v_dot2c_f32_bf16 v48, v192, v24
 v_dot2c_f32_bf16 v49, v192, v25
 v_dot2c_f32_bf16 v50, v193, v24
 v_dot2c_f32_bf16 v51, v193, v25
 v_dot2c_f32_bf16 v52, v194, v24
 v_dot2c_f32_bf16 v53, v194, v25
 v_dot2c_f32_bf16 v54, v195, v24
 v_dot2c_f32_bf16 v55, v195, v25
 v_dot2c_f32_bf16 v56, v196, v24
 v_dot2c_f32_bf16 v57, v196, v25
 v_dot2c_f32_bf16 v58, v197, v24
 v_dot2c_f32_bf16 v59, v197, v25
 v_dot2c_f32_bf16 v60, v198, v24
 v_dot2c_f32_bf16 v61, v198, v25
 v_dot2c_f32_bf16 v62, v199, v24
 v_dot2c_f32_bf16 v63, v199, v25
L_ry8:
 s_cmp_lg_u32 s70, 0
 s_cbranch_scc1 L_rk17
 s_call_b64 s[36:37], L_rpoll
L_rk17:
 s_ff1_i32_b32 s71, s70
 s_bitset0_b32 s70, s71
 s_cmp_ge_u32 s71, 16
 s_cselect_b32 s72, s78, s77
 s_cselect_b32 s73, 0x20000, 0
 s_cselect_b32 s87, 536870912, 0
 s_mul_i32 s71, s71, 114688
 s_add_u32 s71, s71, s72
 buffer_load_dwordx4 v[136:139], v7, s[8:11], s71 offen sc1 nt
 s_or_b32 s69, s69, s73
 s_or_b32 s71, s71, s87
 buffer_load_dwordx4 v[140:143], v27, s[8:11], s71 offen sc1 nt
 s_waitcnt vmcnt(16)
 s_bitcmp1_b32 s69, 9
 s_cbranch_scc1 L_rx9
 v_dot2c_f32_bf16 v48, v200, v24
 v_dot2c_f32_bf16 v49, v200, v25
 v_dot2c_f32_bf16 v50, v201, v24
 v_dot2c_f32_bf16 v51, v201, v25
 v_dot2c_f32_bf16 v52, v202, v24
 v_dot2c_f32_bf16 v53, v202, v25
 v_dot2c_f32_bf16 v54, v203, v24
 v_dot2c_f32_bf16 v55, v203, v25
 v_dot2c_f32_bf16 v56, v204, v24
 v_dot2c_f32_bf16 v57, v204, v25
 v_dot2c_f32_bf16 v58, v205, v24
 v_dot2c_f32_bf16 v59, v205, v25
 v_dot2c_f32_bf16 v60, v206, v24
 v_dot2c_f32_bf16 v61, v206, v25
 v_dot2c_f32_bf16 v62, v207, v24
 v_dot2c_f32_bf16 v63, v207, v25
L_ry9:
 s_cmp_lg_u32 s70, 0
 s_cbranch_scc1 L_rk18
 s_call_b64 s[36:37], L_rpoll
L_rk18:
 s_ff1_i32_b32 s71, s70
 s_bitset0_b32 s70, s71
 s_cmp_ge_u32 s71, 16
 s_cselect_b32 s72, s78, s77
 s_cselect_b32 s73, 0x40000, 0
 s_cselect_b32 s87, 536870912, 0
 s_mul_i32 s71, s71, 114688
 s_add_u32 s71, s71, s72
 buffer_load_dwordx4 v[144:147], v7, s[8:11], s71 offen sc1 nt
 s_or_b32 s69, s69, s73
 s_or_b32 s71, s71, s87
 buffer_load_dwordx4 v[148:151], v27, s[8:11], s71 offen sc1 nt
 s_waitcnt vmcnt(16)
 s_bitcmp1_b32 s69, 10
 s_cbranch_scc1 L_rx10
 v_dot2c_f32_bf16 v48, v208, v24
 v_dot2c_f32_bf16 v49, v208, v25
 v_dot2c_f32_bf16 v50, v209, v24
 v_dot2c_f32_bf16 v51, v209, v25
 v_dot2c_f32_bf16 v52, v210, v24
 v_dot2c_f32_bf16 v53, v210, v25
 v_dot2c_f32_bf16 v54, v211, v24
 v_dot2c_f32_bf16 v55, v211, v25
 v_dot2c_f32_bf16 v56, v212, v24
 v_dot2c_f32_bf16 v57, v212, v25
 v_dot2c_f32_bf16 v58, v213, v24
 v_dot2c_f32_bf16 v59, v213, v25
 v_dot2c_f32_bf16 v60, v214, v24
 v_dot2c_f32_bf16 v61, v214, v25
 v_dot2c_f32_bf16 v62, v215, v24
 v_dot2c_f32_bf16 v63, v215, v25
L_ry10:
 s_cmp_lg_u32 s70, 0
 s_cbranch_scc1 L_rk19
 s_call_b64 s[36:37], L_rpoll
L_rk19:
 s_ff1_i32_b32 s71, s70
 s_bitset0_b32 s70, s71
 s_cmp_ge_u32 s71, 16
 s_cselect_b32 s72, s78, s77
 s_cselect_b32 s73, 0x80000, 0
 s_cselect_b32 s87, 536870912, 0
 s_mul_i32 s71, s71, 114688
 s_add_u32 s71, s71, s72
 buffer_load_dwordx4 v[152:155], v7, s[8:11], s71 offen sc1 nt
 s_or_b32 s69, s69, s73
 s_or_b32 s71, s71, s87
 buffer_load_dwordx4 v[156:159], v27, s[8:11], s71 offen sc1 nt
 s_waitcnt vmcnt(16)
 s_bitcmp1_b32 s69, 11
 s_cbranch_scc1 L_rx11
 v_dot2c_f32_bf16 v48, v216, v24
 v_dot2c_f32_bf16 v49, v216, v25
 v_dot2c_f32_bf16 v50, v217, v24
 v_dot2c_f32_bf16 v51, v217, v25
 v_dot2c_f32_bf16 v52, v218, v24
 v_dot2c_f32_bf16 v53, v218, v25
 v_dot2c_f32_bf16 v54, v219, v24
 v_dot2c_f32_bf16 v55, v219, v25
 v_dot2c_f32_bf16 v56, v220, v24
 v_dot2c_f32_bf16 v57, v220, v25
 v_dot2c_f32_bf16 v58, v221, v24
 v_dot2c_f32_bf16 v59, v221, v25
 v_dot2c_f32_bf16 v60, v222, v24
 v_dot2c_f32_bf16 v61, v222, v25
 v_dot2c_f32_bf16 v62, v223, v24
 v_dot2c_f32_bf16 v63, v223, v25
L_ry11:
 s_cmp_lg_u32 s70, 0
 s_cbranch_scc1 L_rk20
 s_call_b64 s[36:37], L_rpoll
L_rk20:
 s_ff1_i32_b32 s71, s70
 s_bitset0_b32 s70, s71
 s_cmp_ge_u32 s71, 16
 s_cselect_b32 s72, s78, s77
 s_cselect_b32 s73, 0x100000, 0
 s_cselect_b32 s87, 536870912, 0
 s_mul_i32 s71, s71, 114688
 s_add_u32 s71, s71, s72
 buffer_load_dwordx4 v[160:163], v7, s[8:11], s71 offen sc1 nt
 s_or_b32 s69, s69, s73
 s_or_b32 s71, s71, s87
 buffer_load_dwordx4 v[164:167], v27, s[8:11], s71 offen sc1 nt
 s_waitcnt vmcnt(16)
 s_bitcmp1_b32 s69, 12
 s_cbranch_scc1 L_rx12
 v_dot2c_f32_bf16 v48, v224, v24
 v_dot2c_f32_bf16 v49, v224, v25
 v_dot2c_f32_bf16 v50, v225, v24
 v_dot2c_f32_bf16 v51, v225, v25
 v_dot2c_f32_bf16 v52, v226, v24
 v_dot2c_f32_bf16 v53, v226, v25
 v_dot2c_f32_bf16 v54, v227, v24
 v_dot2c_f32_bf16 v55, v227, v25
 v_dot2c_f32_bf16 v56, v228, v24
 v_dot2c_f32_bf16 v57, v228, v25
 v_dot2c_f32_bf16 v58, v229, v24
 v_dot2c_f32_bf16 v59, v229, v25
 v_dot2c_f32_bf16 v60, v230, v24
 v_dot2c_f32_bf16 v61, v230, v25
 v_dot2c_f32_bf16 v62, v231, v24
 v_dot2c_f32_bf16 v63, v231, v25
L_ry12:
 s_cmp_lg_u32 s70, 0
 s_cbranch_scc1 L_rk21
 s_call_b64 s[36:37], L_rpoll
L_rk21:
 s_ff1_i32_b32 s71, s70
 s_bitset0_b32 s70, s71
 s_cmp_ge_u32 s71, 16
 s_cselect_b32 s72, s78, s77
 s_cselect_b32 s73, 0x200000, 0
 s_cselect_b32 s87, 536870912, 0
 s_mul_i32 s71, s71, 114688
 s_add_u32 s71, s71, s72
 buffer_load_dwordx4 v[168:171], v7, s[8:11], s71 offen sc1 nt
 s_or_b32 s69, s69, s73
 s_or_b32 s71, s71, s87
 buffer_load_dwordx4 v[172:175], v27, s[8:11], s71 offen sc1 nt
 s_waitcnt vmcnt(16)
 s_bitcmp1_b32 s69, 13
 s_cbranch_scc1 L_rx13
 v_dot2c_f32_bf16 v48, v232, v24
 v_dot2c_f32_bf16 v49, v232, v25
 v_dot2c_f32_bf16 v50, v233, v24
 v_dot2c_f32_bf16 v51, v233, v25
 v_dot2c_f32_bf16 v52, v234, v24
 v_dot2c_f32_bf16 v53, v234, v25
 v_dot2c_f32_bf16 v54, v235, v24
 v_dot2c_f32_bf16 v55, v235, v25
 v_dot2c_f32_bf16 v56, v236, v24
 v_dot2c_f32_bf16 v57, v236, v25
 v_dot2c_f32_bf16 v58, v237, v24
 v_dot2c_f32_bf16 v59, v237, v25
 v_dot2c_f32_bf16 v60, v238, v24
 v_dot2c_f32_bf16 v61, v238, v25
 v_dot2c_f32_bf16 v62, v239, v24
 v_dot2c_f32_bf16 v63, v239, v25
L_ry13:
 s_cmp_lg_u32 s70, 0
 s_cbranch_scc1 L_rk22
 s_call_b64 s[36:37], L_rpoll
L_rk22:
 s_ff1_i32_b32 s71, s70
 s_bitset0_b32 s70, s71
 s_cmp_ge_u32 s71, 16
 s_cselect_b32 s72, s78, s77
 s_cselect_b32 s73, 0x400000, 0
 s_cselect_b32 s87, 536870912, 0
 s_mul_i32 s71, s71, 114688
 s_add_u32 s71, s71, s72
 buffer_load_dwordx4 v[176:179], v7, s[8:11], s71 offen sc1 nt
 s_or_b32 s69, s69, s73
 s_or_b32 s71, s71, s87
 buffer_load_dwordx4 v[180:183], v27, s[8:11], s71 offen sc1 nt
 s_waitcnt vmcnt(16)
 s_bitcmp1_b32 s69, 14
 s_cbranch_scc1 L_rx14
 v_dot2c_f32_bf16 v48, v240, v24
 v_dot2c_f32_bf16 v49, v240, v25
 v_dot2c_f32_bf16 v50, v241, v24
 v_dot2c_f32_bf16 v51, v241, v25
 v_dot2c_f32_bf16 v52, v242, v24
 v_dot2c_f32_bf16 v53, v242, v25
 v_dot2c_f32_bf16 v54, v243, v24
 v_dot2c_f32_bf16 v55, v243, v25
 v_dot2c_f32_bf16 v56, v244, v24
 v_dot2c_f32_bf16 v57, v244, v25
 v_dot2c_f32_bf16 v58, v245, v24
 v_dot2c_f32_bf16 v59, v245, v25
 v_dot2c_f32_bf16 v60, v246, v24
 v_dot2c_f32_bf16 v61, v246, v25
 v_dot2c_f32_bf16 v62, v247, v24
 v_dot2c_f32_bf16 v63, v247, v25
L_ry14:
 s_cmp_lg_u32 s70, 0
 s_cbranch_scc1 L_rk23
 s_call_b64 s[36:37], L_rpoll
L_rk23:
 s_ff1_i32_b32 s71, s70
 s_bitset0_b32 s70, s71
 s_cmp_ge_u32 s71, 16
 s_cselect_b32 s72, s78, s77
 s_cselect_b32 s73, 0x800000, 0
 s_cselect_b32 s87, 536870912, 0
 s_mul_i32 s71, s71, 114688
 s_add_u32 s71, s71, s72
 buffer_load_dwordx4 v[184:187], v7, s[8:11], s71 offen sc1 nt
 s_or_b32 s69, s69, s73
 s_or_b32 s71, s71, s87
 buffer_load_dwordx4 v[188:191], v27, s[8:11], s71 offen sc1 nt
 s_waitcnt vmcnt(16)
 s_bitcmp1_b32 s69, 15
 s_cbranch_scc1 L_rx15
 v_dot2c_f32_bf16 v48, v248, v24
 v_dot2c_f32_bf16 v49, v248, v25
 v_dot2c_f32_bf16 v50, v249, v24
 v_dot2c_f32_bf16 v51, v249, v25
 v_dot2c_f32_bf16 v52, v250, v24
 v_dot2c_f32_bf16 v53, v250, v25
 v_dot2c_f32_bf16 v54, v251, v24
 v_dot2c_f32_bf16 v55, v251, v25
 v_dot2c_f32_bf16 v56, v252, v24
 v_dot2c_f32_bf16 v57, v252, v25
 v_dot2c_f32_bf16 v58, v253, v24
 v_dot2c_f32_bf16 v59, v253, v25
 v_dot2c_f32_bf16 v60, v254, v24
 v_dot2c_f32_bf16 v61, v254, v25
 v_dot2c_f32_bf16 v62, v255, v24
 v_dot2c_f32_bf16 v63, v255, v25
L_ry15:
 s_cmp_lg_u32 s70, 0
 s_cbranch_scc1 L_rk24
 s_call_b64 s[36:37], L_rpoll
L_rk24:
 s_ff1_i32_b32 s71, s70
 s_bitset0_b32 s70, s71
 s_cmp_ge_u32 s71, 16
 s_cselect_b32 s72, s78, s77
 s_cselect_b32 s73, 0x1000000, 0
 s_cselect_b32 s87, 536870912, 0
 s_mul_i32 s71, s71, 114688
 s_add_u32 s71, s71, s72
 buffer_load_dwordx4 v[192:195], v7, s[8:11], s71 offen sc1 nt
 s_or_b32 s69, s69, s73
 s_or_b32 s71, s71, s87
 buffer_load_dwordx4 v[196:199], v27, s[8:11], s71 offen sc1 nt
 s_waitcnt vmcnt(16)
 s_bitcmp0_b32 s69, 16
 s_cbranch_scc1 L_rx16
 v_dot2c_f32_bf16 v64, v128, v24
 v_dot2c_f32_bf16 v65, v128, v25
 v_dot2c_f32_bf16 v66, v129, v24
 v_dot2c_f32_bf16 v67, v129, v25
 v_dot2c_f32_bf16 v68, v130, v24
 v_dot2c_f32_bf16 v69, v130, v25
 v_dot2c_f32_bf16 v70, v131, v24
 v_dot2c_f32_bf16 v71, v131, v25
L_ry16:
 s_cmp_lg_u32 s70, 0
 s_cbranch_scc1 L_rk25
 s_call_b64 s[36:37], L_rpoll
L_rk25:
 s_ff1_i32_b32 s71, s70
 s_bitset0_b32 s70, s71
 s_cmp_ge_u32 s71, 16
 s_cselect_b32 s72, s78, s77
 s_cselect_b32 s73, 0x2000000, 0
 s_cselect_b32 s87, 536870912, 0
 s_mul_i32 s71, s71, 114688
 s_add_u32 s71, s71, s72
 buffer_load_dwordx4 v[200:203], v7, s[8:11], s71 offen sc1 nt
 s_or_b32 s69, s69, s73
 s_or_b32 s71, s71, s87
 buffer_load_dwordx4 v[204:207], v27, s[8:11], s71 offen sc1 nt
 s_waitcnt vmcnt(16)
 s_bitcmp0_b32 s69, 17
 s_cbranch_scc1 L_rx17
 v_dot2c_f32_bf16 v64, v136, v24
 v_dot2c_f32_bf16 v65, v136, v25
 v_dot2c_f32_bf16 v66, v137, v24
 v_dot2c_f32_bf16 v67, v137, v25
 v_dot2c_f32_bf16 v68, v138, v24
 v_dot2c_f32_bf16 v69, v138, v25
 v_dot2c_f32_bf16 v70, v139, v24
 v_dot2c_f32_bf16 v71, v139, v25
L_ry17:
 s_cmp_lg_u32 s70, 0
 s_cbranch_scc1 L_rk26
 s_call_b64 s[36:37], L_rpoll
L_rk26:
 s_ff1_i32_b32 s71, s70
 s_bitset0_b32 s70, s71
 s_cmp_ge_u32 s71, 16
 s_cselect_b32 s72, s78, s77
 s_cselect_b32 s73, 0x4000000, 0
 s_cselect_b32 s87, 536870912, 0
 s_mul_i32 s71, s71, 114688
 s_add_u32 s71, s71, s72
 buffer_load_dwordx4 v[208:211], v7, s[8:11], s71 offen sc1 nt
 s_or_b32 s69, s69, s73
 s_or_b32 s71, s71, s87
 buffer_load_dwordx4 v[212:215], v27, s[8:11], s71 offen sc1 nt
 s_waitcnt vmcnt(16)
 s_bitcmp0_b32 s69, 18
 s_cbranch_scc1 L_rx18
 v_dot2c_f32_bf16 v64, v144, v24
 v_dot2c_f32_bf16 v65, v144, v25
 v_dot2c_f32_bf16 v66, v145, v24
 v_dot2c_f32_bf16 v67, v145, v25
 v_dot2c_f32_bf16 v68, v146, v24
 v_dot2c_f32_bf16 v69, v146, v25
 v_dot2c_f32_bf16 v70, v147, v24
 v_dot2c_f32_bf16 v71, v147, v25
L_ry18:
 s_cmp_lg_u32 s70, 0
 s_cbranch_scc1 L_rk27
 s_call_b64 s[36:37], L_rpoll
L_rk27:
 s_ff1_i32_b32 s71, s70
 s_bitset0_b32 s70, s71
 s_cmp_ge_u32 s71, 16
 s_cselect_b32 s72, s78, s77
 s_cselect_b32 s73, 0x8000000, 0
 s_cselect_b32 s87, 536870912, 0
 s_mul_i32 s71, s71, 114688
 s_add_u32 s71, s71, s72
 buffer_load_dwordx4 v[216:219], v7, s[8:11], s71 offen sc1 nt
 s_or_b32 s69, s69, s73
 s_or_b32 s71, s71, s87
 buffer_load_dwordx4 v[220:223], v27, s[8:11], s71 offen sc1 nt
 s_waitcnt vmcnt(16)
 s_bitcmp0_b32 s69, 19
 s_cbranch_scc1 L_rx19
 v_dot2c_f32_bf16 v64, v152, v24
 v_dot2c_f32_bf16 v65, v152, v25
 v_dot2c_f32_bf16 v66, v153, v24
 v_dot2c_f32_bf16 v67, v153, v25
 v_dot2c_f32_bf16 v68, v154, v24
 v_dot2c_f32_bf16 v69, v154, v25
 v_dot2c_f32_bf16 v70, v155, v24
 v_dot2c_f32_bf16 v71, v155, v25
L_ry19:
 s_and_b32 s71, s69, 0xfffff
 s_bcnt1_i32_b32 s71, s71
 s_cmp_eq_u32 s71, 4
 s_cselect_b32 s66, 1, 0
 s_cbranch_scc0 L_rne
 v_fmac_f32 v32, v15, v48
 v_fmac_f32 v33, v15, v49
 v_fmac_f32 v34, v15, v50
 v_fmac_f32 v35, v15, v51
 v_fmac_f32 v36, v15, v52
 v_fmac_f32 v37, v15, v53
 v_fmac_f32 v38, v15, v54
 v_fmac_f32 v39, v15, v55
 v_cvt_pk_bf16_f32 v16, v32, v33
 v_cvt_pk_bf16_f32 v17, v34, v35
 v_cvt_pk_bf16_f32 v18, v36, v37
 v_cvt_pk_bf16_f32 v19, v38, v39
 buffer_store_dwordx4 v[16:19], v12, s[52:55], s75 offen sc1
 v_fmac_f32 v40, v15, v56
 v_fmac_f32 v41, v15, v57
 v_fmac_f32 v42, v15, v58
 v_fmac_f32 v43, v15, v59
 v_fmac_f32 v44, v15, v60
 v_fmac_f32 v45, v15, v61
 v_fmac_f32 v46, v15, v62
 v_fmac_f32 v47, v15, v63
 v_cvt_pk_bf16_f32 v20, v40, v41
 v_cvt_pk_bf16_f32 v21, v42, v43
 v_cvt_pk_bf16_f32 v22, v44, v45
 v_cvt_pk_bf16_f32 v23, v46, v47
 buffer_store_dwordx4 v[20:23], v12, s[52:55], s76 offen sc1
L_rne:
 s_cmp_lg_u32 s70, 0
 s_cbranch_scc1 L_rk28
 s_call_b64 s[36:37], L_rpoll
L_rk28:
 s_ff1_i32_b32 s71, s70
 s_bitset0_b32 s70, s71
 s_cmp_ge_u32 s71, 16
 s_cselect_b32 s72, s78, s77
 s_cselect_b32 s73, 0x10000000, 0
 s_cselect_b32 s87, 536870912, 0
 s_mul_i32 s71, s71, 114688
 s_add_u32 s71, s71, s72
 buffer_load_dwordx4 v[224:227], v7, s[8:11], s71 offen sc1 nt
 s_or_b32 s69, s69, s73
 s_or_b32 s71, s71, s87
 buffer_load_dwordx4 v[228:231], v27, s[8:11], s71 offen sc1 nt
 s_waitcnt vmcnt(16)
 s_bitcmp0_b32 s69, 20
 s_cbranch_scc1 L_rx20
 v_dot2c_f32_bf16 v64, v160, v24
 v_dot2c_f32_bf16 v65, v160, v25
 v_dot2c_f32_bf16 v66, v161, v24
 v_dot2c_f32_bf16 v67, v161, v25
 v_dot2c_f32_bf16 v68, v162, v24
 v_dot2c_f32_bf16 v69, v162, v25
 v_dot2c_f32_bf16 v70, v163, v24
 v_dot2c_f32_bf16 v71, v163, v25
L_ry20:
 s_cmp_lg_u32 s70, 0
 s_cbranch_scc1 L_rk29
 s_call_b64 s[36:37], L_rpoll
L_rk29:
 s_ff1_i32_b32 s71, s70
 s_bitset0_b32 s70, s71
 s_cmp_ge_u32 s71, 16
 s_cselect_b32 s72, s78, s77
 s_cselect_b32 s73, 0x20000000, 0
 s_cselect_b32 s87, 536870912, 0
 s_mul_i32 s71, s71, 114688
 s_add_u32 s71, s71, s72
 buffer_load_dwordx4 v[232:235], v7, s[8:11], s71 offen sc1 nt
 s_or_b32 s69, s69, s73
 s_or_b32 s71, s71, s87
 buffer_load_dwordx4 v[236:239], v27, s[8:11], s71 offen sc1 nt
 s_waitcnt vmcnt(16)
 s_bitcmp0_b32 s69, 21
 s_cbranch_scc1 L_rx21
 v_dot2c_f32_bf16 v64, v168, v24
 v_dot2c_f32_bf16 v65, v168, v25
 v_dot2c_f32_bf16 v66, v169, v24
 v_dot2c_f32_bf16 v67, v169, v25
 v_dot2c_f32_bf16 v68, v170, v24
 v_dot2c_f32_bf16 v69, v170, v25
 v_dot2c_f32_bf16 v70, v171, v24
 v_dot2c_f32_bf16 v71, v171, v25
L_ry21:
 s_cmp_lg_u32 s70, 0
 s_cbranch_scc1 L_rk30
 s_call_b64 s[36:37], L_rpoll
L_rk30:
 s_ff1_i32_b32 s71, s70
 s_bitset0_b32 s70, s71
 s_cmp_ge_u32 s71, 16
 s_cselect_b32 s72, s78, s77
 s_cselect_b32 s73, 0x40000000, 0
 s_cselect_b32 s87, 536870912, 0
 s_mul_i32 s71, s71, 114688
 s_add_u32 s71, s71, s72
 buffer_load_dwordx4 v[240:243], v7, s[8:11], s71 offen sc1 nt
 s_or_b32 s69, s69, s73
 s_or_b32 s71, s71, s87
 buffer_load_dwordx4 v[244:247], v27, s[8:11], s71 offen sc1 nt
 s_waitcnt vmcnt(16)
 s_bitcmp0_b32 s69, 22
 s_cbranch_scc1 L_rx22
 v_dot2c_f32_bf16 v64, v176, v24
 v_dot2c_f32_bf16 v65, v176, v25
 v_dot2c_f32_bf16 v66, v177, v24
 v_dot2c_f32_bf16 v67, v177, v25
 v_dot2c_f32_bf16 v68, v178, v24
 v_dot2c_f32_bf16 v69, v178, v25
 v_dot2c_f32_bf16 v70, v179, v24
 v_dot2c_f32_bf16 v71, v179, v25
L_ry22:
 s_cmp_lg_u32 s70, 0
 s_cbranch_scc1 L_rk31
 s_call_b64 s[36:37], L_rpoll
L_rk31:
 s_ff1_i32_b32 s71, s70
 s_bitset0_b32 s70, s71
 s_cmp_ge_u32 s71, 16
 s_cselect_b32 s72, s78, s77
 s_cselect_b32 s73, 0x80000000, 0
 s_cselect_b32 s87, 536870912, 0
 s_mul_i32 s71, s71, 114688
 s_add_u32 s71, s71, s72
 buffer_load_dwordx4 v[248:251], v7, s[8:11], s71 offen sc1 nt
 s_or_b32 s69, s69, s73
 s_or_b32 s71, s71, s87
 buffer_load_dwordx4 v[252:255], v27, s[8:11], s71 offen sc1 nt
 s_waitcnt vmcnt(16)
 s_bitcmp0_b32 s69, 23
 s_cbranch_scc1 L_rx23
 v_dot2c_f32_bf16 v64, v184, v24
 v_dot2c_f32_bf16 v65, v184, v25
 v_dot2c_f32_bf16 v66, v185, v24
 v_dot2c_f32_bf16 v67, v185, v25
 v_dot2c_f32_bf16 v68, v186, v24
 v_dot2c_f32_bf16 v69, v186, v25
 v_dot2c_f32_bf16 v70, v187, v24
 v_dot2c_f32_bf16 v71, v187, v25
L_ry23:
 s_waitcnt vmcnt(14)
 s_bitcmp0_b32 s69, 24
 s_cbranch_scc1 L_rx24
 v_dot2c_f32_bf16 v64, v192, v24
 v_dot2c_f32_bf16 v65, v192, v25
 v_dot2c_f32_bf16 v66, v193, v24
 v_dot2c_f32_bf16 v67, v193, v25
 v_dot2c_f32_bf16 v68, v194, v24
 v_dot2c_f32_bf16 v69, v194, v25
 v_dot2c_f32_bf16 v70, v195, v24
 v_dot2c_f32_bf16 v71, v195, v25
L_ry24:
 s_waitcnt vmcnt(12)
 s_bitcmp0_b32 s69, 25
 s_cbranch_scc1 L_rx25
 v_dot2c_f32_bf16 v64, v200, v24
 v_dot2c_f32_bf16 v65, v200, v25
 v_dot2c_f32_bf16 v66, v201, v24
 v_dot2c_f32_bf16 v67, v201, v25
 v_dot2c_f32_bf16 v68, v202, v24
 v_dot2c_f32_bf16 v69, v202, v25
 v_dot2c_f32_bf16 v70, v203, v24
 v_dot2c_f32_bf16 v71, v203, v25
L_ry25:
 s_waitcnt vmcnt(10)
 s_bitcmp0_b32 s69, 26
 s_cbranch_scc1 L_rx26
 v_dot2c_f32_bf16 v64, v208, v24
 v_dot2c_f32_bf16 v65, v208, v25
 v_dot2c_f32_bf16 v66, v209, v24
 v_dot2c_f32_bf16 v67, v209, v25
 v_dot2c_f32_bf16 v68, v210, v24
 v_dot2c_f32_bf16 v69, v210, v25
 v_dot2c_f32_bf16 v70, v211, v24
 v_dot2c_f32_bf16 v71, v211, v25
L_ry26:
 s_waitcnt vmcnt(8)
 s_bitcmp0_b32 s69, 27
 s_cbranch_scc1 L_rx27
 v_dot2c_f32_bf16 v64, v216, v24
 v_dot2c_f32_bf16 v65, v216, v25
 v_dot2c_f32_bf16 v66, v217, v24
 v_dot2c_f32_bf16 v67, v217, v25
 v_dot2c_f32_bf16 v68, v218, v24
 v_dot2c_f32_bf16 v69, v218, v25
 v_dot2c_f32_bf16 v70, v219, v24
 v_dot2c_f32_bf16 v71, v219, v25
L_ry27:
 s_waitcnt vmcnt(6)
 s_bitcmp0_b32 s69, 28
 s_cbranch_scc1 L_rx28
 v_dot2c_f32_bf16 v64, v224, v24
 v_dot2c_f32_bf16 v65, v224, v25
 v_dot2c_f32_bf16 v66, v225, v24
 v_dot2c_f32_bf16 v67, v225, v25
 v_dot2c_f32_bf16 v68, v226, v24
 v_dot2c_f32_bf16 v69, v226, v25
 v_dot2c_f32_bf16 v70, v227, v24
 v_dot2c_f32_bf16 v71, v227, v25
L_ry28:
 s_waitcnt vmcnt(4)
 s_bitcmp0_b32 s69, 29
 s_cbranch_scc1 L_rx29
 v_dot2c_f32_bf16 v64, v232, v24
 v_dot2c_f32_bf16 v65, v232, v25
 v_dot2c_f32_bf16 v66, v233, v24
 v_dot2c_f32_bf16 v67, v233, v25
 v_dot2c_f32_bf16 v68, v234, v24
 v_dot2c_f32_bf16 v69, v234, v25
 v_dot2c_f32_bf16 v70, v235, v24
 v_dot2c_f32_bf16 v71, v235, v25
L_ry29:
 s_waitcnt vmcnt(2)
 s_bitcmp0_b32 s69, 30
 s_cbranch_scc1 L_rx30
 v_dot2c_f32_bf16 v64, v240, v24
 v_dot2c_f32_bf16 v65, v240, v25
 v_dot2c_f32_bf16 v66, v241, v24
 v_dot2c_f32_bf16 v67, v241, v25
 v_dot2c_f32_bf16 v68, v242, v24
 v_dot2c_f32_bf16 v69, v242, v25
 v_dot2c_f32_bf16 v70, v243, v24
 v_dot2c_f32_bf16 v71, v243, v25
L_ry30:
 s_waitcnt vmcnt(0)
 s_bitcmp0_b32 s69, 31
 s_cbranch_scc1 L_rx31
 v_dot2c_f32_bf16 v64, v248, v24
 v_dot2c_f32_bf16 v65, v248, v25
 v_dot2c_f32_bf16 v66, v249, v24
 v_dot2c_f32_bf16 v67, v249, v25
 v_dot2c_f32_bf16 v68, v250, v24
 v_dot2c_f32_bf16 v69, v250, v25
 v_dot2c_f32_bf16 v70, v251, v24
 v_dot2c_f32_bf16 v71, v251, v25
L_ry31:
 s_nop 1
 v_fmac_f32 v80, v26, v64
 v_fmac_f32 v81, v26, v65
 v_fmac_f32 v82, v26, v66
 v_fmac_f32 v83, v26, v67
 v_fmac_f32 v84, v26, v68
 v_fmac_f32 v85, v26, v69
 v_fmac_f32 v86, v26, v70
 v_fmac_f32 v87, v26, v71
 v_cvt_pk_bf16_f32 v96, v80, v81
 v_cvt_pk_bf16_f32 v97, v82, v83
 v_cvt_pk_bf16_f32 v98, v84, v85
 v_cvt_pk_bf16_f32 v99, v86, v87
 buffer_store_dwordx4 v[96:99], v28, s[52:55], s86 offen sc1
 s_cmp_eq_u32 s66, 1
 s_cbranch_scc1 L_rdone
 v_fmac_f32 v32, v15, v48
 v_fmac_f32 v33, v15, v49
 v_fmac_f32 v34, v15, v50
 v_fmac_f32 v35, v15, v51
 v_fmac_f32 v36, v15, v52
 v_fmac_f32 v37, v15, v53
 v_fmac_f32 v38, v15, v54
 v_fmac_f32 v39, v15, v55
 v_cvt_pk_bf16_f32 v16, v32, v33
 v_cvt_pk_bf16_f32 v17, v34, v35
 v_cvt_pk_bf16_f32 v18, v36, v37
 v_cvt_pk_bf16_f32 v19, v38, v39
 buffer_store_dwordx4 v[16:19], v12, s[52:55], s75 offen sc1
 v_fmac_f32 v40, v15, v56
 v_fmac_f32 v41, v15, v57
 v_fmac_f32 v42, v15, v58
 v_fmac_f32 v43, v15, v59
 v_fmac_f32 v44, v15, v60
 v_fmac_f32 v45, v15, v61
 v_fmac_f32 v46, v15, v62
 v_fmac_f32 v47, v15, v63
 v_cvt_pk_bf16_f32 v20, v40, v41
 v_cvt_pk_bf16_f32 v21, v42, v43
 v_cvt_pk_bf16_f32 v22, v44, v45
 v_cvt_pk_bf16_f32 v23, v46, v47
 buffer_store_dwordx4 v[20:23], v12, s[52:55], s76 offen sc1
L_rdone:
 s_endpgm
L_rx0:
 v_dot2c_f32_bf16 v64, v128, v24
 v_dot2c_f32_bf16 v65, v128, v25
 v_dot2c_f32_bf16 v66, v129, v24
 v_dot2c_f32_bf16 v67, v129, v25
 v_dot2c_f32_bf16 v68, v130, v24
 v_dot2c_f32_bf16 v69, v130, v25
 v_dot2c_f32_bf16 v70, v131, v24
 v_dot2c_f32_bf16 v71, v131, v25
 s_branch L_ry0
L_rx1:
 v_dot2c_f32_bf16 v64, v136, v24
 v_dot2c_f32_bf16 v65, v136, v25
 v_dot2c_f32_bf16 v66, v137, v24
 v_dot2c_f32_bf16 v67, v137, v25
 v_dot2c_f32_bf16 v68, v138, v24
 v_dot2c_f32_bf16 v69, v138, v25
 v_dot2c_f32_bf16 v70, v139, v24
 v_dot2c_f32_bf16 v71, v139, v25
 s_branch L_ry1
L_rx2:
 v_dot2c_f32_bf16 v64, v144, v24
 v_dot2c_f32_bf16 v65, v144, v25
 v_dot2c_f32_bf16 v66, v145, v24
 v_dot2c_f32_bf16 v67, v145, v25
 v_dot2c_f32_bf16 v68, v146, v24
 v_dot2c_f32_bf16 v69, v146, v25
 v_dot2c_f32_bf16 v70, v147, v24
 v_dot2c_f32_bf16 v71, v147, v25
 s_branch L_ry2
L_rx3:
 v_dot2c_f32_bf16 v64, v152, v24
 v_dot2c_f32_bf16 v65, v152, v25
 v_dot2c_f32_bf16 v66, v153, v24
 v_dot2c_f32_bf16 v67, v153, v25
 v_dot2c_f32_bf16 v68, v154, v24
 v_dot2c_f32_bf16 v69, v154, v25
 v_dot2c_f32_bf16 v70, v155, v24
 v_dot2c_f32_bf16 v71, v155, v25
 s_branch L_ry3
L_rx4:
 v_dot2c_f32_bf16 v64, v160, v24
 v_dot2c_f32_bf16 v65, v160, v25
 v_dot2c_f32_bf16 v66, v161, v24
 v_dot2c_f32_bf16 v67, v161, v25
 v_dot2c_f32_bf16 v68, v162, v24
 v_dot2c_f32_bf16 v69, v162, v25
 v_dot2c_f32_bf16 v70, v163, v24
 v_dot2c_f32_bf16 v71, v163, v25
 s_branch L_ry4
L_rx5:
 v_dot2c_f32_bf16 v64, v168, v24
 v_dot2c_f32_bf16 v65, v168, v25
 v_dot2c_f32_bf16 v66, v169, v24
 v_dot2c_f32_bf16 v67, v169, v25
 v_dot2c_f32_bf16 v68, v170, v24
 v_dot2c_f32_bf16 v69, v170, v25
 v_dot2c_f32_bf16 v70, v171, v24
 v_dot2c_f32_bf16 v71, v171, v25
 s_branch L_ry5
L_rx6:
 v_dot2c_f32_bf16 v64, v176, v24
 v_dot2c_f32_bf16 v65, v176, v25
 v_dot2c_f32_bf16 v66, v177, v24
 v_dot2c_f32_bf16 v67, v177, v25
 v_dot2c_f32_bf16 v68, v178, v24
 v_dot2c_f32_bf16 v69, v178, v25
 v_dot2c_f32_bf16 v70, v179, v24
 v_dot2c_f32_bf16 v71, v179, v25
 s_branch L_ry6
L_rx7:
 v_dot2c_f32_bf16 v64, v184, v24
 v_dot2c_f32_bf16 v65, v184, v25
 v_dot2c_f32_bf16 v66, v185, v24
 v_dot2c_f32_bf16 v67, v185, v25
 v_dot2c_f32_bf16 v68, v186, v24
 v_dot2c_f32_bf16 v69, v186, v25
 v_dot2c_f32_bf16 v70, v187, v24
 v_dot2c_f32_bf16 v71, v187, v25
 s_branch L_ry7
L_rx8:
 v_dot2c_f32_bf16 v64, v192, v24
 v_dot2c_f32_bf16 v65, v192, v25
 v_dot2c_f32_bf16 v66, v193, v24
 v_dot2c_f32_bf16 v67, v193, v25
 v_dot2c_f32_bf16 v68, v194, v24
 v_dot2c_f32_bf16 v69, v194, v25
 v_dot2c_f32_bf16 v70, v195, v24
 v_dot2c_f32_bf16 v71, v195, v25
 s_branch L_ry8
L_rx9:
 v_dot2c_f32_bf16 v64, v200, v24
 v_dot2c_f32_bf16 v65, v200, v25
 v_dot2c_f32_bf16 v66, v201, v24
 v_dot2c_f32_bf16 v67, v201, v25
 v_dot2c_f32_bf16 v68, v202, v24
 v_dot2c_f32_bf16 v69, v202, v25
 v_dot2c_f32_bf16 v70, v203, v24
 v_dot2c_f32_bf16 v71, v203, v25
 s_branch L_ry9
L_rx10:
 v_dot2c_f32_bf16 v64, v208, v24
 v_dot2c_f32_bf16 v65, v208, v25
 v_dot2c_f32_bf16 v66, v209, v24
 v_dot2c_f32_bf16 v67, v209, v25
 v_dot2c_f32_bf16 v68, v210, v24
 v_dot2c_f32_bf16 v69, v210, v25
 v_dot2c_f32_bf16 v70, v211, v24
 v_dot2c_f32_bf16 v71, v211, v25
 s_branch L_ry10
L_rx11:
 v_dot2c_f32_bf16 v64, v216, v24
 v_dot2c_f32_bf16 v65, v216, v25
 v_dot2c_f32_bf16 v66, v217, v24
 v_dot2c_f32_bf16 v67, v217, v25
 v_dot2c_f32_bf16 v68, v218, v24
 v_dot2c_f32_bf16 v69, v218, v25
 v_dot2c_f32_bf16 v70, v219, v24
 v_dot2c_f32_bf16 v71, v219, v25
 s_branch L_ry11
L_rx12:
 v_dot2c_f32_bf16 v64, v224, v24
 v_dot2c_f32_bf16 v65, v224, v25
 v_dot2c_f32_bf16 v66, v225, v24
 v_dot2c_f32_bf16 v67, v225, v25
 v_dot2c_f32_bf16 v68, v226, v24
 v_dot2c_f32_bf16 v69, v226, v25
 v_dot2c_f32_bf16 v70, v227, v24
 v_dot2c_f32_bf16 v71, v227, v25
 s_branch L_ry12
L_rx13:
 v_dot2c_f32_bf16 v64, v232, v24
 v_dot2c_f32_bf16 v65, v232, v25
 v_dot2c_f32_bf16 v66, v233, v24
 v_dot2c_f32_bf16 v67, v233, v25
 v_dot2c_f32_bf16 v68, v234, v24
 v_dot2c_f32_bf16 v69, v234, v25
 v_dot2c_f32_bf16 v70, v235, v24
 v_dot2c_f32_bf16 v71, v235, v25
 s_branch L_ry13
L_rx14:
 v_dot2c_f32_bf16 v64, v240, v24
 v_dot2c_f32_bf16 v65, v240, v25
 v_dot2c_f32_bf16 v66, v241, v24
 v_dot2c_f32_bf16 v67, v241, v25
 v_dot2c_f32_bf16 v68, v242, v24
 v_dot2c_f32_bf16 v69, v242, v25
 v_dot2c_f32_bf16 v70, v243, v24
 v_dot2c_f32_bf16 v71, v243, v25
 s_branch L_ry14
L_rx15:
 v_dot2c_f32_bf16 v64, v248, v24
 v_dot2c_f32_bf16 v65, v248, v25
 v_dot2c_f32_bf16 v66, v249, v24
 v_dot2c_f32_bf16 v67, v249, v25
 v_dot2c_f32_bf16 v68, v250, v24
 v_dot2c_f32_bf16 v69, v250, v25
 v_dot2c_f32_bf16 v70, v251, v24
 v_dot2c_f32_bf16 v71, v251, v25
 s_branch L_ry15
L_rx16:
 v_dot2c_f32_bf16 v48, v128, v24
 v_dot2c_f32_bf16 v49, v128, v25
 v_dot2c_f32_bf16 v50, v129, v24
 v_dot2c_f32_bf16 v51, v129, v25
 v_dot2c_f32_bf16 v52, v130, v24
 v_dot2c_f32_bf16 v53, v130, v25
 v_dot2c_f32_bf16 v54, v131, v24
 v_dot2c_f32_bf16 v55, v131, v25
 v_dot2c_f32_bf16 v56, v132, v24
 v_dot2c_f32_bf16 v57, v132, v25
 v_dot2c_f32_bf16 v58, v133, v24
 v_dot2c_f32_bf16 v59, v133, v25
 v_dot2c_f32_bf16 v60, v134, v24
 v_dot2c_f32_bf16 v61, v134, v25
 v_dot2c_f32_bf16 v62, v135, v24
 v_dot2c_f32_bf16 v63, v135, v25
 s_branch L_ry16
L_rx17:
 v_dot2c_f32_bf16 v48, v136, v24
 v_dot2c_f32_bf16 v49, v136, v25
 v_dot2c_f32_bf16 v50, v137, v24
 v_dot2c_f32_bf16 v51, v137, v25
 v_dot2c_f32_bf16 v52, v138, v24
 v_dot2c_f32_bf16 v53, v138, v25
 v_dot2c_f32_bf16 v54, v139, v24
 v_dot2c_f32_bf16 v55, v139, v25
 v_dot2c_f32_bf16 v56, v140, v24
 v_dot2c_f32_bf16 v57, v140, v25
 v_dot2c_f32_bf16 v58, v141, v24
 v_dot2c_f32_bf16 v59, v141, v25
 v_dot2c_f32_bf16 v60, v142, v24
 v_dot2c_f32_bf16 v61, v142, v25
 v_dot2c_f32_bf16 v62, v143, v24
 v_dot2c_f32_bf16 v63, v143, v25
 s_branch L_ry17
L_rx18:
 v_dot2c_f32_bf16 v48, v144, v24
 v_dot2c_f32_bf16 v49, v144, v25
 v_dot2c_f32_bf16 v50, v145, v24
 v_dot2c_f32_bf16 v51, v145, v25
 v_dot2c_f32_bf16 v52, v146, v24
 v_dot2c_f32_bf16 v53, v146, v25
 v_dot2c_f32_bf16 v54, v147, v24
 v_dot2c_f32_bf16 v55, v147, v25
 v_dot2c_f32_bf16 v56, v148, v24
 v_dot2c_f32_bf16 v57, v148, v25
 v_dot2c_f32_bf16 v58, v149, v24
 v_dot2c_f32_bf16 v59, v149, v25
 v_dot2c_f32_bf16 v60, v150, v24
 v_dot2c_f32_bf16 v61, v150, v25
 v_dot2c_f32_bf16 v62, v151, v24
 v_dot2c_f32_bf16 v63, v151, v25
 s_branch L_ry18
L_rx19:
 v_dot2c_f32_bf16 v48, v152, v24
 v_dot2c_f32_bf16 v49, v152, v25
 v_dot2c_f32_bf16 v50, v153, v24
 v_dot2c_f32_bf16 v51, v153, v25
 v_dot2c_f32_bf16 v52, v154, v24
 v_dot2c_f32_bf16 v53, v154, v25
 v_dot2c_f32_bf16 v54, v155, v24
 v_dot2c_f32_bf16 v55, v155, v25
 v_dot2c_f32_bf16 v56, v156, v24
 v_dot2c_f32_bf16 v57, v156, v25
 v_dot2c_f32_bf16 v58, v157, v24
 v_dot2c_f32_bf16 v59, v157, v25
 v_dot2c_f32_bf16 v60, v158, v24
 v_dot2c_f32_bf16 v61, v158, v25
 v_dot2c_f32_bf16 v62, v159, v24
 v_dot2c_f32_bf16 v63, v159, v25
 s_branch L_ry19
L_rx20:
 v_dot2c_f32_bf16 v48, v160, v24
 v_dot2c_f32_bf16 v49, v160, v25
 v_dot2c_f32_bf16 v50, v161, v24
 v_dot2c_f32_bf16 v51, v161, v25
 v_dot2c_f32_bf16 v52, v162, v24
 v_dot2c_f32_bf16 v53, v162, v25
 v_dot2c_f32_bf16 v54, v163, v24
 v_dot2c_f32_bf16 v55, v163, v25
 v_dot2c_f32_bf16 v56, v164, v24
 v_dot2c_f32_bf16 v57, v164, v25
 v_dot2c_f32_bf16 v58, v165, v24
 v_dot2c_f32_bf16 v59, v165, v25
 v_dot2c_f32_bf16 v60, v166, v24
 v_dot2c_f32_bf16 v61, v166, v25
 v_dot2c_f32_bf16 v62, v167, v24
 v_dot2c_f32_bf16 v63, v167, v25
 s_branch L_ry20
L_rx21:
 v_dot2c_f32_bf16 v48, v168, v24
 v_dot2c_f32_bf16 v49, v168, v25
 v_dot2c_f32_bf16 v50, v169, v24
 v_dot2c_f32_bf16 v51, v169, v25
 v_dot2c_f32_bf16 v52, v170, v24
 v_dot2c_f32_bf16 v53, v170, v25
 v_dot2c_f32_bf16 v54, v171, v24
 v_dot2c_f32_bf16 v55, v171, v25
 v_dot2c_f32_bf16 v56, v172, v24
 v_dot2c_f32_bf16 v57, v172, v25
 v_dot2c_f32_bf16 v58, v173, v24
 v_dot2c_f32_bf16 v59, v173, v25
 v_dot2c_f32_bf16 v60, v174, v24
 v_dot2c_f32_bf16 v61, v174, v25
 v_dot2c_f32_bf16 v62, v175, v24
 v_dot2c_f32_bf16 v63, v175, v25
 s_branch L_ry21
L_rx22:
 v_dot2c_f32_bf16 v48, v176, v24
 v_dot2c_f32_bf16 v49, v176, v25
 v_dot2c_f32_bf16 v50, v177, v24
 v_dot2c_f32_bf16 v51, v177, v25
 v_dot2c_f32_bf16 v52, v178, v24
 v_dot2c_f32_bf16 v53, v178, v25
 v_dot2c_f32_bf16 v54, v179, v24
 v_dot2c_f32_bf16 v55, v179, v25
 v_dot2c_f32_bf16 v56, v180, v24
 v_dot2c_f32_bf16 v57, v180, v25
 v_dot2c_f32_bf16 v58, v181, v24
 v_dot2c_f32_bf16 v59, v181, v25
 v_dot2c_f32_bf16 v60, v182, v24
 v_dot2c_f32_bf16 v61, v182, v25
 v_dot2c_f32_bf16 v62, v183, v24
 v_dot2c_f32_bf16 v63, v183, v25
 s_branch L_ry22
L_rx23:
 v_dot2c_f32_bf16 v48, v184, v24
 v_dot2c_f32_bf16 v49, v184, v25
 v_dot2c_f32_bf16 v50, v185, v24
 v_dot2c_f32_bf16 v51, v185, v25
 v_dot2c_f32_bf16 v52, v186, v24
 v_dot2c_f32_bf16 v53, v186, v25
 v_dot2c_f32_bf16 v54, v187, v24
 v_dot2c_f32_bf16 v55, v187, v25
 v_dot2c_f32_bf16 v56, v188, v24
 v_dot2c_f32_bf16 v57, v188, v25
 v_dot2c_f32_bf16 v58, v189, v24
 v_dot2c_f32_bf16 v59, v189, v25
 v_dot2c_f32_bf16 v60, v190, v24
 v_dot2c_f32_bf16 v61, v190, v25
 v_dot2c_f32_bf16 v62, v191, v24
 v_dot2c_f32_bf16 v63, v191, v25
 s_branch L_ry23
L_rx24:
 v_dot2c_f32_bf16 v48, v192, v24
 v_dot2c_f32_bf16 v49, v192, v25
 v_dot2c_f32_bf16 v50, v193, v24
 v_dot2c_f32_bf16 v51, v193, v25
 v_dot2c_f32_bf16 v52, v194, v24
 v_dot2c_f32_bf16 v53, v194, v25
 v_dot2c_f32_bf16 v54, v195, v24
 v_dot2c_f32_bf16 v55, v195, v25
 v_dot2c_f32_bf16 v56, v196, v24
 v_dot2c_f32_bf16 v57, v196, v25
 v_dot2c_f32_bf16 v58, v197, v24
 v_dot2c_f32_bf16 v59, v197, v25
 v_dot2c_f32_bf16 v60, v198, v24
 v_dot2c_f32_bf16 v61, v198, v25
 v_dot2c_f32_bf16 v62, v199, v24
 v_dot2c_f32_bf16 v63, v199, v25
 s_branch L_ry24
L_rx25:
 v_dot2c_f32_bf16 v48, v200, v24
 v_dot2c_f32_bf16 v49, v200, v25
 v_dot2c_f32_bf16 v50, v201, v24
 v_dot2c_f32_bf16 v51, v201, v25
 v_dot2c_f32_bf16 v52, v202, v24
 v_dot2c_f32_bf16 v53, v202, v25
 v_dot2c_f32_bf16 v54, v203, v24
 v_dot2c_f32_bf16 v55, v203, v25
 v_dot2c_f32_bf16 v56, v204, v24
 v_dot2c_f32_bf16 v57, v204, v25
 v_dot2c_f32_bf16 v58, v205, v24
 v_dot2c_f32_bf16 v59, v205, v25
 v_dot2c_f32_bf16 v60, v206, v24
 v_dot2c_f32_bf16 v61, v206, v25
 v_dot2c_f32_bf16 v62, v207, v24
 v_dot2c_f32_bf16 v63, v207, v25
 s_branch L_ry25
L_rx26:
 v_dot2c_f32_bf16 v48, v208, v24
 v_dot2c_f32_bf16 v49, v208, v25
 v_dot2c_f32_bf16 v50, v209, v24
 v_dot2c_f32_bf16 v51, v209, v25
 v_dot2c_f32_bf16 v52, v210, v24
 v_dot2c_f32_bf16 v53, v210, v25
 v_dot2c_f32_bf16 v54, v211, v24
 v_dot2c_f32_bf16 v55, v211, v25
 v_dot2c_f32_bf16 v56, v212, v24
 v_dot2c_f32_bf16 v57, v212, v25
 v_dot2c_f32_bf16 v58, v213, v24
 v_dot2c_f32_bf16 v59, v213, v25
 v_dot2c_f32_bf16 v60, v214, v24
 v_dot2c_f32_bf16 v61, v214, v25
 v_dot2c_f32_bf16 v62, v215, v24
 v_dot2c_f32_bf16 v63, v215, v25
 s_branch L_ry26
L_rx27:
 v_dot2c_f32_bf16 v48, v216, v24
 v_dot2c_f32_bf16 v49, v216, v25
 v_dot2c_f32_bf16 v50, v217, v24
 v_dot2c_f32_bf16 v51, v217, v25
 v_dot2c_f32_bf16 v52, v218, v24
 v_dot2c_f32_bf16 v53, v218, v25
 v_dot2c_f32_bf16 v54, v219, v24
 v_dot2c_f32_bf16 v55, v219, v25
 v_dot2c_f32_bf16 v56, v220, v24
 v_dot2c_f32_bf16 v57, v220, v25
 v_dot2c_f32_bf16 v58, v221, v24
 v_dot2c_f32_bf16 v59, v221, v25
 v_dot2c_f32_bf16 v60, v222, v24
 v_dot2c_f32_bf16 v61, v222, v25
 v_dot2c_f32_bf16 v62, v223, v24
 v_dot2c_f32_bf16 v63, v223, v25
 s_branch L_ry27
L_rx28:
 v_dot2c_f32_bf16 v48, v224, v24
 v_dot2c_f32_bf16 v49, v224, v25
 v_dot2c_f32_bf16 v50, v225, v24
 v_dot2c_f32_bf16 v51, v225, v25
 v_dot2c_f32_bf16 v52, v226, v24
 v_dot2c_f32_bf16 v53, v226, v25
 v_dot2c_f32_bf16 v54, v227, v24
 v_dot2c_f32_bf16 v55, v227, v25
 v_dot2c_f32_bf16 v56, v228, v24
 v_dot2c_f32_bf16 v57, v228, v25
 v_dot2c_f32_bf16 v58, v229, v24
 v_dot2c_f32_bf16 v59, v229, v25
 v_dot2c_f32_bf16 v60, v230, v24
 v_dot2c_f32_bf16 v61, v230, v25
 v_dot2c_f32_bf16 v62, v231, v24
 v_dot2c_f32_bf16 v63, v231, v25
 s_branch L_ry28
L_rx29:
 v_dot2c_f32_bf16 v48, v232, v24
 v_dot2c_f32_bf16 v49, v232, v25
 v_dot2c_f32_bf16 v50, v233, v24
 v_dot2c_f32_bf16 v51, v233, v25
 v_dot2c_f32_bf16 v52, v234, v24
 v_dot2c_f32_bf16 v53, v234, v25
 v_dot2c_f32_bf16 v54, v235, v24
 v_dot2c_f32_bf16 v55, v235, v25
 v_dot2c_f32_bf16 v56, v236, v24
 v_dot2c_f32_bf16 v57, v236, v25
 v_dot2c_f32_bf16 v58, v237, v24
 v_dot2c_f32_bf16 v59, v237, v25
 v_dot2c_f32_bf16 v60, v238, v24
 v_dot2c_f32_bf16 v61, v238, v25
 v_dot2c_f32_bf16 v62, v239, v24
 v_dot2c_f32_bf16 v63, v239, v25
 s_branch L_ry29
L_rx30:
 v_dot2c_f32_bf16 v48, v240, v24
 v_dot2c_f32_bf16 v49, v240, v25
 v_dot2c_f32_bf16 v50, v241, v24
 v_dot2c_f32_bf16 v51, v241, v25
 v_dot2c_f32_bf16 v52, v242, v24
 v_dot2c_f32_bf16 v53, v242, v25
 v_dot2c_f32_bf16 v54, v243, v24
 v_dot2c_f32_bf16 v55, v243, v25
 v_dot2c_f32_bf16 v56, v244, v24
 v_dot2c_f32_bf16 v57, v244, v25
 v_dot2c_f32_bf16 v58, v245, v24
 v_dot2c_f32_bf16 v59, v245, v25
 v_dot2c_f32_bf16 v60, v246, v24
 v_dot2c_f32_bf16 v61, v246, v25
 v_dot2c_f32_bf16 v62, v247, v24
 v_dot2c_f32_bf16 v63, v247, v25
 s_branch L_ry30
L_rx31:
 v_dot2c_f32_bf16 v48, v248, v24
 v_dot2c_f32_bf16 v49, v248, v25
 v_dot2c_f32_bf16 v50, v249, v24
 v_dot2c_f32_bf16 v51, v249, v25
 v_dot2c_f32_bf16 v52, v250, v24
 v_dot2c_f32_bf16 v53, v250, v25
 v_dot2c_f32_bf16 v54, v251, v24
 v_dot2c_f32_bf16 v55, v251, v25
 v_dot2c_f32_bf16 v56, v252, v24
 v_dot2c_f32_bf16 v57, v252, v25
 v_dot2c_f32_bf16 v58, v253, v24
 v_dot2c_f32_bf16 v59, v253, v25
 v_dot2c_f32_bf16 v60, v254, v24
 v_dot2c_f32_bf16 v61, v254, v25
 v_dot2c_f32_bf16 v62, v255, v24
 v_dot2c_f32_bf16 v63, v255, v25
 s_branch L_ry31
L_rpoll0:
 s_sleep 1
L_rpoll:
 buffer_load_dword v9, v14, s[8:11], s46 offen sc1
 s_waitcnt vmcnt(0)
 v_cmp_eq_u32 vcc, 1, v9
 s_sub_u32 s91, s91, 1
 s_cselect_b32 s70, -1, 0
 s_or_b32 s70, s70, vcc_lo
 s_andn2_b32 s70, s70, s68
 s_cbranch_scc0 L_rpoll0
 s_or_b32 s68, s68, s70
 s_setpc_b64 s[36:37]
L_comb:
 buffer_load_dwordx4 v[14:17], v7, s[8:11], s52 offen sc1
 s_waitcnt vmcnt(0)
 s_nop 7
 v_sub_f32 v10, v32, v14
 v_sub_f32 v11, v36, v15
 v_max_f32 v10, 0, v10
 v_max_f32 v11, 0, v11
 v_sub_f32 v100, v100, v11
 v_sub_f32 v101, v101, v11
 v_sub_f32 v102, v102, v11
 v_sub_f32 v103, v103, v11
 v_sub_f32 v108, v108, v11
 v_sub_f32 v109, v109, v11
 v_sub_f32 v110, v110, v11
 v_sub_f32 v111, v111, v11
 v_sub_f32 v116, v116, v11
 v_sub_f32 v117, v117, v11
 v_sub_f32 v118, v118, v11
 v_sub_f32 v119, v119, v11
 v_sub_f32 v124, v124, v11
 v_sub_f32 v125, v125, v11
 v_sub_f32 v126, v126, v11
 v_sub_f32 v127, v127, v11
 v_sub_f32 v64, v64, v10
 v_sub_f32 v65, v65, v10
 v_sub_f32 v66, v66, v10
 v_sub_f32 v67, v67, v10
 v_sub_f32 v68, v68, v11
 v_sub_f32 v69, v69, v11
 v_sub_f32 v70, v70, v11
 v_sub_f32 v71, v71, v11
 v_sub_f32 v72, v72, v10
 v_sub_f32 v73, v73, v10
 v_sub_f32 v74, v74, v10
 v_sub_f32 v75, v75, v10
 v_sub_f32 v76, v76, v11
 v_sub_f32 v77, v77, v11
 v_sub_f32 v78, v78, v11
 v_sub_f32 v79, v79, v11
 v_sub_f32 v80, v80, v10
 v_sub_f32 v81, v81, v10
 v_sub_f32 v82, v82, v10
 v_sub_f32 v83, v83, v10
 v_sub_f32 v84, v84, v11
 v_sub_f32 v85, v85, v11
 v_sub_f32 v86, v86, v11
 v_sub_f32 v87, v87, v11
 v_sub_f32 v88, v88, v10
 v_sub_f32 v89, v89, v10
 v_sub_f32 v90, v90, v10
 v_sub_f32 v91, v91, v10
 v_sub_f32 v92, v92, v11
 v_sub_f32 v93, v93, v11
 v_sub_f32 v94, v94, v11
 v_sub_f32 v95, v95, v11
 v_sub_f32 v32, v32, v10
 v_sub_f32 v33, v33, v10
 v_sub_f32 v34, v34, v10
 v_sub_f32 v35, v35, v10
 v_sub_f32 v36, v36, v11
 v_sub_f32 v37, v37, v11
 v_sub_f32 v38, v38, v11
 v_sub_f32 v39, v39, v11
 v_exp_f32 v12, -v10
 v_exp_f32 v13, -v11
 v_mul_f32 v30, v12, v30
 v_mul_f32 v31, v13, v31
 v_mul_f32 v128, v12, v128
 v_mul_f32 v129, v12, v129
 v_mul_f32 v130, v12, v130
 v_mul_f32 v131, v12, v131
 v_mul_f32 v132, v13, v132
 v_mul_f32 v133, v13, v133
 v_mul_f32 v134, v13, v134
 v_mul_f32 v135, v13, v135
 v_mul_f32 v136, v12, v136
 v_mul_f32 v137, v12, v137
 v_mul_f32 v138, v12, v138
 v_mul_f32 v139, v12, v139
 v_mul_f32 v140, v13, v140
 v_mul_f32 v141, v13, v141
 v_mul_f32 v142, v13, v142
 v_mul_f32 v143, v13, v143
 v_mul_f32 v144, v12, v144
 v_mul_f32 v145, v12, v145
 v_mul_f32 v146, v12, v146
 v_mul_f32 v147, v12, v147
 v_mul_f32 v148, v13, v148
 v_mul_f32 v149, v13, v149
 v_mul_f32 v150, v13, v150
 v_mul_f32 v151, v13, v151
 v_mul_f32 v152, v12, v152
 v_mul_f32 v153, v12, v153
 v_mul_f32 v154, v12, v154
 v_mul_f32 v155, v12, v155
 v_mul_f32 v156, v13, v156
 v_mul_f32 v157, v13, v157
 v_mul_f32 v158, v13, v158
 v_mul_f32 v159, v13, v159
 v_mul_f32 v160, v12, v160
 v_mul_f32 v161, v12, v161
 v_mul_f32 v162, v12, v162
 v_mul_f32 v163, v12, v163
 v_mul_f32 v164, v13, v164
 v_mul_f32 v165, v13, v165
 v_mul_f32 v166, v13, v166
 v_mul_f32 v167, v13, v167
 v_mul_f32 v168, v12, v168
 v_mul_f32 v169, v12, v169
 v_mul_f32 v170, v12, v170
 v_mul_f32 v171, v12, v171
 v_mul_f32 v172, v13, v172
 v_mul_f32 v173, v13, v173
 v_mul_f32 v174, v13, v174
 v_mul_f32 v175, v13, v175
 v_mul_f32 v176, v12, v176
 v_mul_f32 v177, v12, v177
 v_mul_f32 v178, v12, v178
 v_mul_f32 v179, v12, v179
 v_mul_f32 v180, v13, v180
 v_mul_f32 v181, v13, v181
 v_mul_f32 v182, v13, v182
 v_mul_f32 v183, v13, v183
 v_mul_f32 v184, v12, v184
 v_mul_f32 v185, v12, v185
 v_mul_f32 v186, v12, v186
 v_mul_f32 v187, v12, v187
 v_mul_f32 v188, v13, v188
 v_mul_f32 v189, v13, v189
 v_mul_f32 v190, v13, v190
 v_mul_f32 v191, v13, v191
 v_mul_f32 v192, v12, v192
 v_mul_f32 v193, v12, v193
 v_mul_f32 v194, v12, v194
 v_mul_f32 v195, v12, v195
 v_mul_f32 v196, v13, v196
 v_mul_f32 v197, v13, v197
 v_mul_f32 v198, v13, v198
 v_mul_f32 v199, v13, v199
 v_mul_f32 v200, v12, v200
 v_mul_f32 v201, v12, v201
 v_mul_f32 v202, v12, v202
 v_mul_f32 v203, v12, v203
 v_mul_f32 v204, v13, v204
 v_mul_f32 v205, v13, v205
 v_mul_f32 v206, v13, v206
 v_mul_f32 v207, v13, v207
 v_mul_f32 v208, v12, v208
 v_mul_f32 v209, v12, v209
 v_mul_f32 v210, v12, v210
 v_mul_f32 v211, v12, v211
 v_mul_f32 v212, v13, v212
 v_mul_f32 v213, v13, v213
 v_mul_f32 v214, v13, v214
 v_mul_f32 v215, v13, v215
 v_mul_f32 v216, v12, v216
 v_mul_f32 v217, v12, v217
 v_mul_f32 v218, v12, v218
 v_mul_f32 v219, v12, v219
 v_mul_f32 v220, v13, v220
 v_mul_f32 v221, v13, v221
 v_mul_f32 v222, v13, v222
 v_mul_f32 v223, v13, v223
 v_mul_f32 v224, v12, v224
 v_mul_f32 v225, v12, v225
 v_mul_f32 v226, v12, v226
 v_mul_f32 v227, v12, v227
 v_mul_f32 v228, v13, v228
 v_mul_f32 v229, v13, v229
 v_mul_f32 v230, v13, v230
 v_mul_f32 v231, v13, v231
 v_mul_f32 v232, v12, v232
 v_mul_f32 v233, v12, v233
 v_mul_f32 v234, v12, v234
 v_mul_f32 v235, v12, v235
 v_mul_f32 v236, v13, v236
 v_mul_f32 v237, v13, v237
 v_mul_f32 v238, v13, v238
 v_mul_f32 v239, v13, v239
 v_mul_f32 v240, v12, v240
 v_mul_f32 v241, v12, v241
 v_mul_f32 v242, v12, v242
 v_mul_f32 v243, v12, v243
 v_mul_f32 v244, v13, v244
 v_mul_f32 v245, v13, v245
 v_mul_f32 v246, v13, v246
 v_mul_f32 v247, v13, v247
 v_mul_f32 v248, v12, v248
 v_mul_f32 v249, v12, v249
 v_mul_f32 v250, v12, v250
 v_mul_f32 v251, v12, v251
 v_mul_f32 v252, v13, v252
 v_mul_f32 v253, v13, v253
 v_mul_f32 v254, v13, v254
 v_mul_f32 v255, v13, v255
 v_exp_f32 v18, v64
 v_exp_f32 v19, v65
 v_exp_f32 v20, v66
 v_add_f32 v26, v18, v19
 v_cvt_pk_bf16_f32 v40, v18, v19
 v_exp_f32 v21, v67
 v_exp_f32 v22, v72
 v_add_f32 v26, v20, v26
 v_cvt_pk_bf16_f32 v41, v20, v21
 v_exp_f32 v23, v73
 v_add_f32 v26, v21, v26
 v_exp_f32 v24, v74
 v_add_f32 v26, v22, v26
 v_cvt_pk_bf16_f32 v42, v22, v23
 v_exp_f32 v25, v75
 v_add_f32 v26, v23, v26
 v_exp_f32 v18, v68
 v_add_f32 v26, v24, v26
 v_cvt_pk_bf16_f32 v43, v24, v25
 v_exp_f32 v19, v69
 v_add_f32 v26, v25, v26
 v_exp_f32 v20, v70
 v_add_f32 v27, v18, v19
 v_cvt_pk_bf16_f32 v44, v18, v19
 v_exp_f32 v21, v71
 v_exp_f32 v22, v76
 v_add_f32 v27, v20, v27
 v_cvt_pk_bf16_f32 v45, v20, v21
 v_exp_f32 v23, v77
 v_add_f32 v27, v21, v27
 v_exp_f32 v24, v78
 v_add_f32 v27, v22, v27
 v_cvt_pk_bf16_f32 v46, v22, v23
 v_exp_f32 v25, v79
 v_add_f32 v27, v23, v27
 v_add_f32 v27, v24, v27
 v_cvt_pk_bf16_f32 v47, v24, v25
 v_add_f32 v27, v25, v27
 v_sub_f32 v10, v32, v14
 v_sub_f32 v11, v36, v15
 v_cvt_i32_f32 v10, v10
 v_cvt_i32_f32 v11, v11
 v_ldexp_f32 v10, 1.0, v10
 v_ldexp_f32 v11, 1.0, v11
 v_and_b32 v10, 0xffff0000, v10
 v_and_b32 v11, 0xffff0000, v11
 v_fmac_f32 v30, v10, v16
 v_fmac_f32 v31, v11, v17
 v_lshrrev_b32 v12, 16, v10
 v_lshrrev_b32 v13, 16, v11
 v_accvgpr_read_b32 v18, a128
 v_dot2c_f32_bf16 v128, v18, v12
 v_dot2c_f32_bf16 v129, v18, v10
 v_accvgpr_read_b32 v19, a129
 v_dot2c_f32_bf16 v130, v19, v12
 v_dot2c_f32_bf16 v131, v19, v10
 v_accvgpr_read_b32 v20, a130
 v_dot2c_f32_bf16 v136, v20, v12
 v_dot2c_f32_bf16 v137, v20, v10
 v_accvgpr_read_b32 v21, a131
 v_dot2c_f32_bf16 v138, v21, v12
 v_dot2c_f32_bf16 v139, v21, v10
 v_accvgpr_read_b32 v22, a132
 v_dot2c_f32_bf16 v144, v22, v12
 v_dot2c_f32_bf16 v145, v22, v10
 v_accvgpr_read_b32 v23, a133
 v_dot2c_f32_bf16 v146, v23, v12
 v_dot2c_f32_bf16 v147, v23, v10
 v_accvgpr_read_b32 v24, a134
 v_dot2c_f32_bf16 v152, v24, v12
 v_dot2c_f32_bf16 v153, v24, v10
 v_accvgpr_read_b32 v25, a135
 v_dot2c_f32_bf16 v154, v25, v12
 v_dot2c_f32_bf16 v155, v25, v10
 v_accvgpr_read_b32 v18, a136
 v_dot2c_f32_bf16 v160, v18, v12
 v_dot2c_f32_bf16 v161, v18, v10
 v_accvgpr_read_b32 v19, a137
 v_dot2c_f32_bf16 v162, v19, v12
 v_dot2c_f32_bf16 v163, v19, v10
 v_accvgpr_read_b32 v20, a138
 v_dot2c_f32_bf16 v168, v20, v12
 v_dot2c_f32_bf16 v169, v20, v10
 v_accvgpr_read_b32 v21, a139
 v_dot2c_f32_bf16 v170, v21, v12
 v_dot2c_f32_bf16 v171, v21, v10
 v_accvgpr_read_b32 v22, a140
 v_dot2c_f32_bf16 v176, v22, v12
 v_dot2c_f32_bf16 v177, v22, v10
 v_accvgpr_read_b32 v23, a141
 v_dot2c_f32_bf16 v178, v23, v12
 v_dot2c_f32_bf16 v179, v23, v10
 v_accvgpr_read_b32 v24, a142
 v_dot2c_f32_bf16 v184, v24, v12
 v_dot2c_f32_bf16 v185, v24, v10
 v_accvgpr_read_b32 v25, a143
 v_dot2c_f32_bf16 v186, v25, v12
 v_dot2c_f32_bf16 v187, v25, v10
 v_accvgpr_read_b32 v18, a144
 v_dot2c_f32_bf16 v192, v18, v12
 v_dot2c_f32_bf16 v193, v18, v10
 v_accvgpr_read_b32 v19, a145
 v_dot2c_f32_bf16 v194, v19, v12
 v_dot2c_f32_bf16 v195, v19, v10
 v_accvgpr_read_b32 v20, a146
 v_dot2c_f32_bf16 v200, v20, v12
 v_dot2c_f32_bf16 v201, v20, v10
 v_accvgpr_read_b32 v21, a147
 v_dot2c_f32_bf16 v202, v21, v12
 v_dot2c_f32_bf16 v203, v21, v10
 v_accvgpr_read_b32 v22, a148
 v_dot2c_f32_bf16 v208, v22, v12
 v_dot2c_f32_bf16 v209, v22, v10
 v_accvgpr_read_b32 v23, a149
 v_dot2c_f32_bf16 v210, v23, v12
 v_dot2c_f32_bf16 v211, v23, v10
 v_accvgpr_read_b32 v24, a150
 v_dot2c_f32_bf16 v216, v24, v12
 v_dot2c_f32_bf16 v217, v24, v10
 v_accvgpr_read_b32 v25, a151
 v_dot2c_f32_bf16 v218, v25, v12
 v_dot2c_f32_bf16 v219, v25, v10
 v_accvgpr_read_b32 v18, a152
 v_dot2c_f32_bf16 v224, v18, v12
 v_dot2c_f32_bf16 v225, v18, v10
 v_accvgpr_read_b32 v19, a153
 v_dot2c_f32_bf16 v226, v19, v12
 v_dot2c_f32_bf16 v227, v19, v10
 v_accvgpr_read_b32 v20, a154
 v_dot2c_f32_bf16 v232, v20, v12
 v_dot2c_f32_bf16 v233, v20, v10
 v_accvgpr_read_b32 v21, a155
 v_dot2c_f32_bf16 v234, v21, v12
 v_dot2c_f32_bf16 v235, v21, v10
 v_accvgpr_read_b32 v22, a156
 v_dot2c_f32_bf16 v240, v22, v12
 v_dot2c_f32_bf16 v241, v22, v10
 v_accvgpr_read_b32 v23, a157
 v_dot2c_f32_bf16 v242, v23, v12
 v_dot2c_f32_bf16 v243, v23, v10
 v_accvgpr_read_b32 v24, a158
 v_dot2c_f32_bf16 v248, v24, v12
 v_dot2c_f32_bf16 v249, v24, v10
 v_accvgpr_read_b32 v25, a159
 v_dot2c_f32_bf16 v250, v25, v12
 v_dot2c_f32_bf16 v251, v25, v10
 v_accvgpr_read_b32 v18, a160
 v_dot2c_f32_bf16 v132, v18, v13
 v_dot2c_f32_bf16 v133, v18, v11
 v_accvgpr_read_b32 v19, a161
 v_dot2c_f32_bf16 v134, v19, v13
 v_dot2c_f32_bf16 v135, v19, v11
 v_accvgpr_read_b32 v20, a162
 v_dot2c_f32_bf16 v140, v20, v13
 v_dot2c_f32_bf16 v141, v20, v11
 v_accvgpr_read_b32 v21, a163
 v_dot2c_f32_bf16 v142, v21, v13
 v_dot2c_f32_bf16 v143, v21, v11
 v_accvgpr_read_b32 v22, a164
 v_dot2c_f32_bf16 v148, v22, v13
 v_dot2c_f32_bf16 v149, v22, v11
 v_accvgpr_read_b32 v23, a165
 v_dot2c_f32_bf16 v150, v23, v13
 v_dot2c_f32_bf16 v151, v23, v11
 v_accvgpr_read_b32 v24, a166
 v_dot2c_f32_bf16 v156, v24, v13
 v_dot2c_f32_bf16 v157, v24, v11
 v_accvgpr_read_b32 v25, a167
 v_dot2c_f32_bf16 v158, v25, v13
 v_dot2c_f32_bf16 v159, v25, v11
 v_accvgpr_read_b32 v18, a168
 v_dot2c_f32_bf16 v164, v18, v13
 v_dot2c_f32_bf16 v165, v18, v11
 v_accvgpr_read_b32 v19, a169
 v_dot2c_f32_bf16 v166, v19, v13
 v_dot2c_f32_bf16 v167, v19, v11
 v_accvgpr_read_b32 v20, a170
 v_dot2c_f32_bf16 v172, v20, v13
 v_dot2c_f32_bf16 v173, v20, v11
 v_accvgpr_read_b32 v21, a171
 v_dot2c_f32_bf16 v174, v21, v13
 v_dot2c_f32_bf16 v175, v21, v11
 v_accvgpr_read_b32 v22, a172
 v_dot2c_f32_bf16 v180, v22, v13
 v_dot2c_f32_bf16 v181, v22, v11
 v_accvgpr_read_b32 v23, a173
 v_dot2c_f32_bf16 v182, v23, v13
 v_dot2c_f32_bf16 v183, v23, v11
 v_accvgpr_read_b32 v24, a174
 v_dot2c_f32_bf16 v188, v24, v13
 v_dot2c_f32_bf16 v189, v24, v11
 v_accvgpr_read_b32 v25, a175
 v_dot2c_f32_bf16 v190, v25, v13
 v_dot2c_f32_bf16 v191, v25, v11
 v_accvgpr_read_b32 v18, a176
 v_dot2c_f32_bf16 v196, v18, v13
 v_dot2c_f32_bf16 v197, v18, v11
 v_accvgpr_read_b32 v19, a177
 v_dot2c_f32_bf16 v198, v19, v13
 v_dot2c_f32_bf16 v199, v19, v11
 v_accvgpr_read_b32 v20, a178
 v_dot2c_f32_bf16 v204, v20, v13
 v_dot2c_f32_bf16 v205, v20, v11
 v_accvgpr_read_b32 v21, a179
 v_dot2c_f32_bf16 v206, v21, v13
 v_dot2c_f32_bf16 v207, v21, v11
 v_accvgpr_read_b32 v22, a180
 v_dot2c_f32_bf16 v212, v22, v13
 v_dot2c_f32_bf16 v213, v22, v11
 v_accvgpr_read_b32 v23, a181
 v_dot2c_f32_bf16 v214, v23, v13
 v_dot2c_f32_bf16 v215, v23, v11
 v_accvgpr_read_b32 v24, a182
 v_dot2c_f32_bf16 v220, v24, v13
 v_dot2c_f32_bf16 v221, v24, v11
 v_accvgpr_read_b32 v25, a183
 v_dot2c_f32_bf16 v222, v25, v13
 v_dot2c_f32_bf16 v223, v25, v11
 v_accvgpr_read_b32 v18, a184
 v_dot2c_f32_bf16 v228, v18, v13
 v_dot2c_f32_bf16 v229, v18, v11
 v_accvgpr_read_b32 v19, a185
 v_dot2c_f32_bf16 v230, v19, v13
 v_dot2c_f32_bf16 v231, v19, v11
 v_accvgpr_read_b32 v20, a186
 v_dot2c_f32_bf16 v236, v20, v13
 v_dot2c_f32_bf16 v237, v20, v11
 v_accvgpr_read_b32 v21, a187
 v_dot2c_f32_bf16 v238, v21, v13
 v_dot2c_f32_bf16 v239, v21, v11
 v_accvgpr_read_b32 v22, a188
 v_dot2c_f32_bf16 v244, v22, v13
 v_dot2c_f32_bf16 v245, v22, v11
 v_accvgpr_read_b32 v23, a189
 v_dot2c_f32_bf16 v246, v23, v13
 v_dot2c_f32_bf16 v247, v23, v11
 v_accvgpr_read_b32 v24, a190
 v_dot2c_f32_bf16 v252, v24, v13
 v_dot2c_f32_bf16 v253, v24, v11
 v_accvgpr_read_b32 v25, a191
 v_dot2c_f32_bf16 v254, v25, v13
 v_dot2c_f32_bf16 v255, v25, v11
 s_nop 3
 s_branch L_p2
L_st0:
 s_call_b64 s[36:37], L_slow0
 s_branch L_rt0
L_st1:
 s_call_b64 s[36:37], L_slow1
 s_branch L_rt1
L_st2:
 s_call_b64 s[36:37], L_slowB
 s_branch L_rt2
L_st3:
 s_call_b64 s[36:37], L_slow1
 s_branch L_rt3
L_st4:
 s_call_b64 s[36:37], L_slow1n
 s_branch L_rt4
L_st5:
 s_call_b64 s[36:37], L_slow1
 s_branch L_rt5
L_st6:
 s_call_b64 s[36:37], L_slow0B
 s_branch L_rt6
L_st7:
 s_call_b64 s[36:37], L_slowB
 s_branch L_rt7
L_st8:
 s_call_b64 s[36:37], L_slowf
 s_branch L_rt8
L_st9:
 s_call_b64 s[36:37], L_slow1
 s_branch L_rt9
L_st10:
 s_call_b64 s[36:37], L_slowf
 s_branch L_rt10
L_st11:
 s_call_b64 s[36:37], L_slowf
 s_branch L_rt11
L_st14:
 s_call_b64 s[36:37], L_slow0B
 s_branch L_rt14
L_st12:
 s_call_b64 s[36:37], L_slow0
 s_branch L_rt12
L_st13:
 s_call_b64 s[36:37], L_slow1
 s_branch L_rt13
L_slow0:
 s_nop 7
 s_nop 3
 v_max3_f32 v10, v64, v65, v66
 v_max3_f32 v10, v67, v72, v10
 v_max3_f32 v10, v73, v74, v10
 v_max3_f32 v10, v75, v80, v10
 v_max3_f32 v10, v81, v82, v10
 v_max3_f32 v10, v83, v88, v10
 v_max3_f32 v10, v89, v90, v10
 v_max_f32 v10, v91, v10
 v_max3_f32 v11, v68, v69, v70
 v_max3_f32 v11, v71, v76, v11
 v_max3_f32 v11, v77, v78, v11
 v_max3_f32 v11, v79, v84, v11
 v_max3_f32 v11, v85, v86, v11
 v_max3_f32 v11, v87, v92, v11
 v_max3_f32 v11, v93, v94, v11
 v_max_f32 v11, v95, v11
 v_mov_b32 v12, v10
 v_mov_b32 v13, v11
 s_nop 0
 v_permlane16_swap_b32 v12, v10
 v_permlane16_swap_b32 v13, v11
 v_max_f32 v10, v12, v10
 v_max_f32 v11, v13, v11
 v_mov_b32 v12, v10
 v_mov_b32 v13, v11
 s_nop 0
 v_permlane32_swap_b32 v12, v10
 v_permlane32_swap_b32 v13, v11
 v_max_f32 v10, v12, v10
 v_max_f32 v11, v13, v11
 v_ceil_f32 v10, v10
 v_ceil_f32 v11, v11
 v_max_f32 v10, 0, v10
 v_max_f32 v11, 0, v11
 v_sub_f32 v64, v64, v10
 v_sub_f32 v65, v65, v10
 v_sub_f32 v66, v66, v10
 v_sub_f32 v67, v67, v10
 v_sub_f32 v68, v68, v11
 v_sub_f32 v69, v69, v11
 v_sub_f32 v70, v70, v11
 v_sub_f32 v71, v71, v11
 v_sub_f32 v72, v72, v10
 v_sub_f32 v73, v73, v10
 v_sub_f32 v74, v74, v10
 v_sub_f32 v75, v75, v10
 v_sub_f32 v76, v76, v11
 v_sub_f32 v77, v77, v11
 v_sub_f32 v78, v78, v11
 v_sub_f32 v79, v79, v11
 v_sub_f32 v80, v80, v10
 v_sub_f32 v81, v81, v10
 v_sub_f32 v82, v82, v10
 v_sub_f32 v83, v83, v10
 v_sub_f32 v84, v84, v11
 v_sub_f32 v85, v85, v11
 v_sub_f32 v86, v86, v11
 v_sub_f32 v87, v87, v11
 v_sub_f32 v88, v88, v10
 v_sub_f32 v89, v89, v10
 v_sub_f32 v90, v90, v10
 v_sub_f32 v91, v91, v10
 v_sub_f32 v92, v92, v11
 v_sub_f32 v93, v93, v11
 v_sub_f32 v94, v94, v11
 v_sub_f32 v95, v95, v11
 v_sub_f32 v96, v96, v10
 v_sub_f32 v97, v97, v10
 v_sub_f32 v98, v98, v10
 v_sub_f32 v99, v99, v10
 v_sub_f32 v100, v100, v11
 v_sub_f32 v101, v101, v11
 v_sub_f32 v102, v102, v11
 v_sub_f32 v103, v103, v11
 v_sub_f32 v104, v104, v10
 v_sub_f32 v105, v105, v10
 v_sub_f32 v106, v106, v10
 v_sub_f32 v107, v107, v10
 v_sub_f32 v108, v108, v11
 v_sub_f32 v109, v109, v11
 v_sub_f32 v110, v110, v11
 v_sub_f32 v111, v111, v11
 v_sub_f32 v112, v112, v10
 v_sub_f32 v113, v113, v10
 v_sub_f32 v114, v114, v10
 v_sub_f32 v115, v115, v10
 v_sub_f32 v116, v116, v11
 v_sub_f32 v117, v117, v11
 v_sub_f32 v118, v118, v11
 v_sub_f32 v119, v119, v11
 v_sub_f32 v120, v120, v10
 v_sub_f32 v121, v121, v10
 v_sub_f32 v122, v122, v10
 v_sub_f32 v123, v123, v10
 v_sub_f32 v124, v124, v11
 v_sub_f32 v125, v125, v11
 v_sub_f32 v126, v126, v11
 v_sub_f32 v127, v127, v11
 v_sub_f32 v32, v32, v10
 v_sub_f32 v33, v33, v10
 v_sub_f32 v34, v34, v10
 v_sub_f32 v35, v35, v10
 v_sub_f32 v36, v36, v11
 v_sub_f32 v37, v37, v11
 v_sub_f32 v38, v38, v11
 v_sub_f32 v39, v39, v11
 v_exp_f32 v12, -v10
 v_exp_f32 v13, -v11
 v_mul_f32 v30, v12, v30
 v_mul_f32 v31, v13, v31
 v_mul_f32 v128, v12, v128
 v_mul_f32 v129, v12, v129
 v_mul_f32 v130, v12, v130
 v_mul_f32 v131, v12, v131
 v_mul_f32 v132, v13, v132
 v_mul_f32 v133, v13, v133
 v_mul_f32 v134, v13, v134
 v_mul_f32 v135, v13, v135
 v_mul_f32 v136, v12, v136
 v_mul_f32 v137, v12, v137
 v_mul_f32 v138, v12, v138
 v_mul_f32 v139, v12, v139
 v_mul_f32 v140, v13, v140
 v_mul_f32 v141, v13, v141
 v_mul_f32 v142, v13, v142
 v_mul_f32 v143, v13, v143
 v_mul_f32 v144, v12, v144
 v_mul_f32 v145, v12, v145
 v_mul_f32 v146, v12, v146
 v_mul_f32 v147, v12, v147
 v_mul_f32 v148, v13, v148
 v_mul_f32 v149, v13, v149
 v_mul_f32 v150, v13, v150
 v_mul_f32 v151, v13, v151
 v_mul_f32 v152, v12, v152
 v_mul_f32 v153, v12, v153
 v_mul_f32 v154, v12, v154
 v_mul_f32 v155, v12, v155
 v_mul_f32 v156, v13, v156
 v_mul_f32 v157, v13, v157
 v_mul_f32 v158, v13, v158
 v_mul_f32 v159, v13, v159
 v_mul_f32 v160, v12, v160
 v_mul_f32 v161, v12, v161
 v_mul_f32 v162, v12, v162
 v_mul_f32 v163, v12, v163
 v_mul_f32 v164, v13, v164
 v_mul_f32 v165, v13, v165
 v_mul_f32 v166, v13, v166
 v_mul_f32 v167, v13, v167
 v_mul_f32 v168, v12, v168
 v_mul_f32 v169, v12, v169
 v_mul_f32 v170, v12, v170
 v_mul_f32 v171, v12, v171
 v_mul_f32 v172, v13, v172
 v_mul_f32 v173, v13, v173
 v_mul_f32 v174, v13, v174
 v_mul_f32 v175, v13, v175
 v_mul_f32 v176, v12, v176
 v_mul_f32 v177, v12, v177
 v_mul_f32 v178, v12, v178
 v_mul_f32 v179, v12, v179
 v_mul_f32 v180, v13, v180
 v_mul_f32 v181, v13, v181
 v_mul_f32 v182, v13, v182
 v_mul_f32 v183, v13, v183
 v_mul_f32 v184, v12, v184
 v_mul_f32 v185, v12, v185
 v_mul_f32 v186, v12, v186
 v_mul_f32 v187, v12, v187
 v_mul_f32 v188, v13, v188
 v_mul_f32 v189, v13, v189
 v_mul_f32 v190, v13, v190
 v_mul_f32 v191, v13, v191
 v_mul_f32 v192, v12, v192
 v_mul_f32 v193, v12, v193
 v_mul_f32 v194, v12, v194
 v_mul_f32 v195, v12, v195
 v_mul_f32 v196, v13, v196
 v_mul_f32 v197, v13, v197
 v_mul_f32 v198, v13, v198
 v_mul_f32 v199, v13, v199
 v_mul_f32 v200, v12, v200
 v_mul_f32 v201, v12, v201
 v_mul_f32 v202, v12, v202
 v_mul_f32 v203, v12, v203
 v_mul_f32 v204, v13, v204
 v_mul_f32 v205, v13, v205
 v_mul_f32 v206, v13, v206
 v_mul_f32 v207, v13, v207
 v_mul_f32 v208, v12, v208
 v_mul_f32 v209, v12, v209
 v_mul_f32 v210, v12, v210
 v_mul_f32 v211, v12, v211
 v_mul_f32 v212, v13, v212
 v_mul_f32 v213, v13, v213
 v_mul_f32 v214, v13, v214
 v_mul_f32 v215, v13, v215
 v_mul_f32 v216, v12, v216
 v_mul_f32 v217, v12, v217
 v_mul_f32 v218, v12, v218
 v_mul_f32 v219, v12, v219
 v_mul_f32 v220, v13, v220
 v_mul_f32 v221, v13, v221
 v_mul_f32 v222, v13, v222
 v_mul_f32 v223, v13, v223
 v_mul_f32 v224, v12, v224
 v_mul_f32 v225, v12, v225
 v_mul_f32 v226, v12, v226
 v_mul_f32 v227, v12, v227
 v_mul_f32 v228, v13, v228
 v_mul_f32 v229, v13, v229
 v_mul_f32 v230, v13, v230
 v_mul_f32 v231, v13, v231
 v_mul_f32 v232, v12, v232
 v_mul_f32 v233, v12, v233
 v_mul_f32 v234, v12, v234
 v_mul_f32 v235, v12, v235
 v_mul_f32 v236, v13, v236
 v_mul_f32 v237, v13, v237
 v_mul_f32 v238, v13, v238
 v_mul_f32 v239, v13, v239
 v_mul_f32 v240, v12, v240
 v_mul_f32 v241, v12, v241
 v_mul_f32 v242, v12, v242
 v_mul_f32 v243, v12, v243
 v_mul_f32 v244, v13, v244
 v_mul_f32 v245, v13, v245
 v_mul_f32 v246, v13, v246
 v_mul_f32 v247, v13, v247
 v_mul_f32 v248, v12, v248
 v_mul_f32 v249, v12, v249
 v_mul_f32 v250, v12, v250
 v_mul_f32 v251, v12, v251
 v_mul_f32 v252, v13, v252
 v_mul_f32 v253, v13, v253
 v_mul_f32 v254, v13, v254
 v_mul_f32 v255, v13, v255
 v_exp_f32 v18, v64
 v_exp_f32 v19, v65
 v_exp_f32 v20, v66
 v_add_f32 v26, v18, v19
 v_cvt_pk_bf16_f32 v40, v18, v19
 v_exp_f32 v21, v67
 v_exp_f32 v22, v72
 v_add_f32 v26, v20, v26
 v_cvt_pk_bf16_f32 v41, v20, v21
 v_exp_f32 v23, v73
 v_add_f32 v26, v21, v26
 v_exp_f32 v24, v74
 v_add_f32 v26, v22, v26
 v_cvt_pk_bf16_f32 v42, v22, v23
 v_exp_f32 v25, v75
 v_add_f32 v26, v23, v26
 v_exp_f32 v18, v68
 v_add_f32 v26, v24, v26
 v_cvt_pk_bf16_f32 v43, v24, v25
 v_exp_f32 v19, v69
 v_add_f32 v26, v25, v26
 v_exp_f32 v20, v70
 v_add_f32 v27, v18, v19
 v_cvt_pk_bf16_f32 v44, v18, v19
 v_exp_f32 v21, v71
 v_exp_f32 v22, v76
 v_add_f32 v27, v20, v27
 v_cvt_pk_bf16_f32 v45, v20, v21
 v_exp_f32 v23, v77
 v_add_f32 v27, v21, v27
 v_exp_f32 v24, v78
 v_add_f32 v27, v22, v27
 v_cvt_pk_bf16_f32 v46, v22, v23
 v_exp_f32 v25, v79
 v_add_f32 v27, v23, v27
 v_add_f32 v27, v24, v27
 v_cvt_pk_bf16_f32 v47, v24, v25
 v_add_f32 v27, v25, v27
 v_exp_f32 v18, v80
 v_exp_f32 v19, v81
 v_exp_f32 v20, v82
 v_add_f32 v26, v18, v26
 v_cvt_pk_bf16_f32 v56, v18, v19
 v_exp_f32 v21, v83
 v_add_f32 v26, v19, v26
 v_exp_f32 v22, v88
 v_add_f32 v26, v20, v26
 v_cvt_pk_bf16_f32 v57, v20, v21
 v_exp_f32 v23, v89
 v_add_f32 v26, v21, v26
 v_exp_f32 v24, v90
 v_add_f32 v26, v22, v26
 v_cvt_pk_bf16_f32 v58, v22, v23
 v_exp_f32 v25, v91
 v_add_f32 v26, v23, v26
 v_exp_f32 v18, v84
 v_add_f32 v26, v24, v26
 v_cvt_pk_bf16_f32 v59, v24, v25
 v_exp_f32 v19, v85
 v_add_f32 v26, v25, v26
 v_exp_f32 v20, v86
 v_add_f32 v27, v18, v27
 v_cvt_pk_bf16_f32 v60, v18, v19
 v_exp_f32 v21, v87
 v_add_f32 v27, v19, v27
 v_exp_f32 v22, v92
 v_add_f32 v27, v20, v27
 v_cvt_pk_bf16_f32 v61, v20, v21
 v_exp_f32 v23, v93
 v_add_f32 v27, v21, v27
 v_exp_f32 v24, v94
 v_add_f32 v27, v22, v27
 v_cvt_pk_bf16_f32 v62, v22, v23
 v_exp_f32 v25, v95
 v_add_f32 v27, v23, v27
 v_add_f32 v27, v24, v27
 v_cvt_pk_bf16_f32 v63, v24, v25
 v_add_f32 v27, v25, v27
 s_nop 3
 s_setpc_b64 s[36:37]
L_slow1:
 s_nop 7
 s_nop 3
 v_max3_f32 v10, v96, v97, v98
 v_max3_f32 v10, v99, v104, v10
 v_max3_f32 v10, v105, v106, v10
 v_max3_f32 v10, v107, v112, v10
 v_max3_f32 v10, v113, v114, v10
 v_max3_f32 v10, v115, v120, v10
 v_max3_f32 v10, v121, v122, v10
 v_max_f32 v10, v123, v10
 v_max3_f32 v11, v100, v101, v102
 v_max3_f32 v11, v103, v108, v11
 v_max3_f32 v11, v109, v110, v11
 v_max3_f32 v11, v111, v116, v11
 v_max3_f32 v11, v117, v118, v11
 v_max3_f32 v11, v119, v124, v11
 v_max3_f32 v11, v125, v126, v11
 v_max_f32 v11, v127, v11
 v_mov_b32 v12, v10
 v_mov_b32 v13, v11
 s_nop 0
 v_permlane16_swap_b32 v12, v10
 v_permlane16_swap_b32 v13, v11
 v_max_f32 v10, v12, v10
 v_max_f32 v11, v13, v11
 v_mov_b32 v12, v10
 v_mov_b32 v13, v11
 s_nop 0
 v_permlane32_swap_b32 v12, v10
 v_permlane32_swap_b32 v13, v11
 v_max_f32 v10, v12, v10
 v_max_f32 v11, v13, v11
 v_ceil_f32 v10, v10
 v_ceil_f32 v11, v11
 v_max_f32 v10, 0, v10
 v_max_f32 v11, 0, v11
 v_sub_f32 v96, v96, v10
 v_sub_f32 v97, v97, v10
 v_sub_f32 v98, v98, v10
 v_sub_f32 v99, v99, v10
 v_sub_f32 v100, v100, v11
 v_sub_f32 v101, v101, v11
 v_sub_f32 v102, v102, v11
 v_sub_f32 v103, v103, v11
 v_sub_f32 v104, v104, v10
 v_sub_f32 v105, v105, v10
 v_sub_f32 v106, v106, v10
 v_sub_f32 v107, v107, v10
 v_sub_f32 v108, v108, v11
 v_sub_f32 v109, v109, v11
 v_sub_f32 v110, v110, v11
 v_sub_f32 v111, v111, v11
 v_sub_f32 v112, v112, v10
 v_sub_f32 v113, v113, v10
 v_sub_f32 v114, v114, v10
 v_sub_f32 v115, v115, v10
 v_sub_f32 v116, v116, v11
 v_sub_f32 v117, v117, v11
 v_sub_f32 v118, v118, v11
 v_sub_f32 v119, v119, v11
 v_sub_f32 v120, v120, v10
 v_sub_f32 v121, v121, v10
 v_sub_f32 v122, v122, v10
 v_sub_f32 v123, v123, v10
 v_sub_f32 v124, v124, v11
 v_sub_f32 v125, v125, v11
 v_sub_f32 v126, v126, v11
 v_sub_f32 v127, v127, v11
 v_sub_f32 v64, v64, v10
 v_sub_f32 v65, v65, v10
 v_sub_f32 v66, v66, v10
 v_sub_f32 v67, v67, v10
 v_sub_f32 v68, v68, v11
 v_sub_f32 v69, v69, v11
 v_sub_f32 v70, v70, v11
 v_sub_f32 v71, v71, v11
 v_sub_f32 v72, v72, v10
 v_sub_f32 v73, v73, v10
 v_sub_f32 v74, v74, v10
 v_sub_f32 v75, v75, v10
 v_sub_f32 v76, v76, v11
 v_sub_f32 v77, v77, v11
 v_sub_f32 v78, v78, v11
 v_sub_f32 v79, v79, v11
 v_sub_f32 v80, v80, v10
 v_sub_f32 v81, v81, v10
 v_sub_f32 v82, v82, v10
 v_sub_f32 v83, v83, v10
 v_sub_f32 v84, v84, v11
 v_sub_f32 v85, v85, v11
 v_sub_f32 v86, v86, v11
 v_sub_f32 v87, v87, v11
 v_sub_f32 v88, v88, v10
 v_sub_f32 v89, v89, v10
 v_sub_f32 v90, v90, v10
 v_sub_f32 v91, v91, v10
 v_sub_f32 v92, v92, v11
 v_sub_f32 v93, v93, v11
 v_sub_f32 v94, v94, v11
 v_sub_f32 v95, v95, v11
 v_sub_f32 v32, v32, v10
 v_sub_f32 v33, v33, v10
 v_sub_f32 v34, v34, v10
 v_sub_f32 v35, v35, v10
 v_sub_f32 v36, v36, v11
 v_sub_f32 v37, v37, v11
 v_sub_f32 v38, v38, v11
 v_sub_f32 v39, v39, v11
 v_exp_f32 v12, -v10
 v_exp_f32 v13, -v11
 v_mul_f32 v30, v12, v30
 v_mul_f32 v31, v13, v31
 v_mul_f32 v128, v12, v128
 v_mul_f32 v129, v12, v129
 v_mul_f32 v130, v12, v130
 v_mul_f32 v131, v12, v131
 v_mul_f32 v132, v13, v132
 v_mul_f32 v133, v13, v133
 v_mul_f32 v134, v13, v134
 v_mul_f32 v135, v13, v135
 v_mul_f32 v136, v12, v136
 v_mul_f32 v137, v12, v137
 v_mul_f32 v138, v12, v138
 v_mul_f32 v139, v12, v139
 v_mul_f32 v140, v13, v140
 v_mul_f32 v141, v13, v141
 v_mul_f32 v142, v13, v142
 v_mul_f32 v143, v13, v143
 v_mul_f32 v144, v12, v144
 v_mul_f32 v145, v12, v145
 v_mul_f32 v146, v12, v146
 v_mul_f32 v147, v12, v147
 v_mul_f32 v148, v13, v148
 v_mul_f32 v149, v13, v149
 v_mul_f32 v150, v13, v150
 v_mul_f32 v151, v13, v151
 v_mul_f32 v152, v12, v152
 v_mul_f32 v153, v12, v153
 v_mul_f32 v154, v12, v154
 v_mul_f32 v155, v12, v155
 v_mul_f32 v156, v13, v156
 v_mul_f32 v157, v13, v157
 v_mul_f32 v158, v13, v158
 v_mul_f32 v159, v13, v159
 v_mul_f32 v160, v12, v160
 v_mul_f32 v161, v12, v161
 v_mul_f32 v162, v12, v162
 v_mul_f32 v163, v12, v163
 v_mul_f32 v164, v13, v164
 v_mul_f32 v165, v13, v165
 v_mul_f32 v166, v13, v166
 v_mul_f32 v167, v13, v167
 v_mul_f32 v168, v12, v168
 v_mul_f32 v169, v12, v169
 v_mul_f32 v170, v12, v170
 v_mul_f32 v171, v12, v171
 v_mul_f32 v172, v13, v172
 v_mul_f32 v173, v13, v173
 v_mul_f32 v174, v13, v174
 v_mul_f32 v175, v13, v175
 v_mul_f32 v176, v12, v176
 v_mul_f32 v177, v12, v177
 v_mul_f32 v178, v12, v178
 v_mul_f32 v179, v12, v179
 v_mul_f32 v180, v13, v180
 v_mul_f32 v181, v13, v181
 v_mul_f32 v182, v13, v182
 v_mul_f32 v183, v13, v183
 v_mul_f32 v184, v12, v184
 v_mul_f32 v185, v12, v185
 v_mul_f32 v186, v12, v186
 v_mul_f32 v187, v12, v187
 v_mul_f32 v188, v13, v188
 v_mul_f32 v189, v13, v189
 v_mul_f32 v190, v13, v190
 v_mul_f32 v191, v13, v191
 v_mul_f32 v192, v12, v192
 v_mul_f32 v193, v12, v193
 v_mul_f32 v194, v12, v194
 v_mul_f32 v195, v12, v195
 v_mul_f32 v196, v13, v196
 v_mul_f32 v197, v13, v197
 v_mul_f32 v198, v13, v198
 v_mul_f32 v199, v13, v199
 v_mul_f32 v200, v12, v200
 v_mul_f32 v201, v12, v201
 v_mul_f32 v202, v12, v202
 v_mul_f32 v203, v12, v203
 v_mul_f32 v204, v13, v204
 v_mul_f32 v205, v13, v205
 v_mul_f32 v206, v13, v206
 v_mul_f32 v207, v13, v207
 v_mul_f32 v208, v12, v208
 v_mul_f32 v209, v12, v209
 v_mul_f32 v210, v12, v210
 v_mul_f32 v211, v12, v211
 v_mul_f32 v212, v13, v212
 v_mul_f32 v213, v13, v213
 v_mul_f32 v214, v13, v214
 v_mul_f32 v215, v13, v215
 v_mul_f32 v216, v12, v216
 v_mul_f32 v217, v12, v217
 v_mul_f32 v218, v12, v218
 v_mul_f32 v219, v12, v219
 v_mul_f32 v220, v13, v220
 v_mul_f32 v221, v13, v221
 v_mul_f32 v222, v13, v222
 v_mul_f32 v223, v13, v223
 v_mul_f32 v224, v12, v224
 v_mul_f32 v225, v12, v225
 v_mul_f32 v226, v12, v226
 v_mul_f32 v227, v12, v227
 v_mul_f32 v228, v13, v228
 v_mul_f32 v229, v13, v229
 v_mul_f32 v230, v13, v230
 v_mul_f32 v231, v13, v231
 v_mul_f32 v232, v12, v232
 v_mul_f32 v233, v12, v233
 v_mul_f32 v234, v12, v234
 v_mul_f32 v235, v12, v235
 v_mul_f32 v236, v13, v236
 v_mul_f32 v237, v13, v237
 v_mul_f32 v238, v13, v238
 v_mul_f32 v239, v13, v239
 v_mul_f32 v240, v12, v240
 v_mul_f32 v241, v12, v241
 v_mul_f32 v242, v12, v242
 v_mul_f32 v243, v12, v243
 v_mul_f32 v244, v13, v244
 v_mul_f32 v245, v13, v245
 v_mul_f32 v246, v13, v246
 v_mul_f32 v247, v13, v247
 v_mul_f32 v248, v12, v248
 v_mul_f32 v249, v12, v249
 v_mul_f32 v250, v12, v250
 v_mul_f32 v251, v12, v251
 v_mul_f32 v252, v13, v252
 v_mul_f32 v253, v13, v253
 v_mul_f32 v254, v13, v254
 v_mul_f32 v255, v13, v255
 v_exp_f32 v18, v96
 v_exp_f32 v19, v97
 v_exp_f32 v20, v98
 v_add_f32 v28, v18, v19
 v_cvt_pk_bf16_f32 v48, v18, v19
 v_exp_f32 v21, v99
 v_exp_f32 v22, v104
 v_add_f32 v28, v20, v28
 v_cvt_pk_bf16_f32 v49, v20, v21
 v_exp_f32 v23, v105
 v_add_f32 v28, v21, v28
 v_exp_f32 v24, v106
 v_add_f32 v28, v22, v28
 v_cvt_pk_bf16_f32 v50, v22, v23
 v_exp_f32 v25, v107
 v_add_f32 v28, v23, v28
 v_exp_f32 v18, v100
 v_add_f32 v28, v24, v28
 v_cvt_pk_bf16_f32 v51, v24, v25
 v_exp_f32 v19, v101
 v_add_f32 v28, v25, v28
 v_exp_f32 v20, v102
 v_add_f32 v29, v18, v19
 v_cvt_pk_bf16_f32 v52, v18, v19
 v_exp_f32 v21, v103
 v_exp_f32 v22, v108
 v_add_f32 v29, v20, v29
 v_cvt_pk_bf16_f32 v53, v20, v21
 v_exp_f32 v23, v109
 v_add_f32 v29, v21, v29
 v_exp_f32 v24, v110
 v_add_f32 v29, v22, v29
 v_cvt_pk_bf16_f32 v54, v22, v23
 v_exp_f32 v25, v111
 v_add_f32 v29, v23, v29
 v_add_f32 v29, v24, v29
 v_cvt_pk_bf16_f32 v55, v24, v25
 v_add_f32 v29, v25, v29
 v_exp_f32 v18, v112
 v_exp_f32 v19, v113
 v_exp_f32 v20, v114
 v_add_f32 v28, v18, v28
 v_cvt_pk_bf16_f32 v56, v18, v19
 v_exp_f32 v21, v115
 v_add_f32 v28, v19, v28
 v_exp_f32 v22, v120
 v_add_f32 v28, v20, v28
 v_cvt_pk_bf16_f32 v57, v20, v21
 v_exp_f32 v23, v121
 v_add_f32 v28, v21, v28
 v_exp_f32 v24, v122
 v_add_f32 v28, v22, v28
 v_cvt_pk_bf16_f32 v58, v22, v23
 v_exp_f32 v25, v123
 v_add_f32 v28, v23, v28
 v_exp_f32 v18, v116
 v_add_f32 v28, v24, v28
 v_cvt_pk_bf16_f32 v59, v24, v25
 v_exp_f32 v19, v117
 v_add_f32 v28, v25, v28
 v_exp_f32 v20, v118
 v_add_f32 v29, v18, v29
 v_cvt_pk_bf16_f32 v60, v18, v19
 v_exp_f32 v21, v119
 v_add_f32 v29, v19, v29
 v_exp_f32 v22, v124
 v_add_f32 v29, v20, v29
 v_cvt_pk_bf16_f32 v61, v20, v21
 v_exp_f32 v23, v125
 v_add_f32 v29, v21, v29
 v_exp_f32 v24, v126
 v_add_f32 v29, v22, v29
 v_cvt_pk_bf16_f32 v62, v22, v23
 v_exp_f32 v25, v127
 v_add_f32 v29, v23, v29
 v_add_f32 v29, v24, v29
 v_cvt_pk_bf16_f32 v63, v24, v25
 v_add_f32 v29, v25, v29
 s_nop 3
 s_setpc_b64 s[36:37]
L_slow1n:
 s_nop 7
 s_nop 3
 v_max3_f32 v10, v96, v97, v98
 v_max3_f32 v10, v99, v104, v10
 v_max3_f32 v10, v105, v106, v10
 v_max3_f32 v10, v107, v112, v10
 v_max3_f32 v10, v113, v114, v10
 v_max3_f32 v10, v115, v120, v10
 v_max3_f32 v10, v121, v122, v10
 v_max_f32 v10, v123, v10
 v_max3_f32 v11, v100, v101, v102
 v_max3_f32 v11, v103, v108, v11
 v_max3_f32 v11, v109, v110, v11
 v_max3_f32 v11, v111, v116, v11
 v_max3_f32 v11, v117, v118, v11
 v_max3_f32 v11, v119, v124, v11
 v_max3_f32 v11, v125, v126, v11
 v_max_f32 v11, v127, v11
 v_mov_b32 v12, v10
 v_mov_b32 v13, v11
 s_nop 0
 v_permlane16_swap_b32 v12, v10
 v_permlane16_swap_b32 v13, v11
 v_max_f32 v10, v12, v10
 v_max_f32 v11, v13, v11
 v_mov_b32 v12, v10
 v_mov_b32 v13, v11
 s_nop 0
 v_permlane32_swap_b32 v12, v10
 v_permlane32_swap_b32 v13, v11
 v_max_f32 v10, v12, v10
 v_max_f32 v11, v13, v11
 v_ceil_f32 v10, v10
 v_ceil_f32 v11, v11
 v_max_f32 v10, 0, v10
 v_max_f32 v11, 0, v11
 v_sub_f32 v96, v96, v10
 v_sub_f32 v97, v97, v10
 v_sub_f32 v98, v98, v10
 v_sub_f32 v99, v99, v10
 v_sub_f32 v100, v100, v11
 v_sub_f32 v101, v101, v11
 v_sub_f32 v102, v102, v11
 v_sub_f32 v103, v103, v11
 v_sub_f32 v104, v104, v10
 v_sub_f32 v105, v105, v10
 v_sub_f32 v106, v106, v10
 v_sub_f32 v107, v107, v10
 v_sub_f32 v108, v108, v11
 v_sub_f32 v109, v109, v11
 v_sub_f32 v110, v110, v11
 v_sub_f32 v111, v111, v11
 v_sub_f32 v112, v112, v10
 v_sub_f32 v113, v113, v10
 v_sub_f32 v114, v114, v10
 v_sub_f32 v115, v115, v10
 v_sub_f32 v116, v116, v11
 v_sub_f32 v117, v117, v11
 v_sub_f32 v118, v118, v11
 v_sub_f32 v119, v119, v11
 v_sub_f32 v120, v120, v10
 v_sub_f32 v121, v121, v10
 v_sub_f32 v122, v122, v10
 v_sub_f32 v123, v123, v10
 v_sub_f32 v124, v124, v11
 v_sub_f32 v125, v125, v11
 v_sub_f32 v126, v126, v11
 v_sub_f32 v127, v127, v11
 v_sub_f32 v32, v32, v10
 v_sub_f32 v33, v33, v10
 v_sub_f32 v34, v34, v10
 v_sub_f32 v35, v35, v10
 v_sub_f32 v36, v36, v11
 v_sub_f32 v37, v37, v11
 v_sub_f32 v38, v38, v11
 v_sub_f32 v39, v39, v11
 v_exp_f32 v12, -v10
 v_exp_f32 v13, -v11
 v_mul_f32 v30, v12, v30
 v_mul_f32 v31, v13, v31
 v_mul_f32 v128, v12, v128
 v_mul_f32 v129, v12, v129
 v_mul_f32 v130, v12, v130
 v_mul_f32 v131, v12, v131
 v_mul_f32 v132, v13, v132
 v_mul_f32 v133, v13, v133
 v_mul_f32 v134, v13, v134
 v_mul_f32 v135, v13, v135
 v_mul_f32 v136, v12, v136
 v_mul_f32 v137, v12, v137
 v_mul_f32 v138, v12, v138
 v_mul_f32 v139, v12, v139
 v_mul_f32 v140, v13, v140
 v_mul_f32 v141, v13, v141
 v_mul_f32 v142, v13, v142
 v_mul_f32 v143, v13, v143
 v_mul_f32 v144, v12, v144
 v_mul_f32 v145, v12, v145
 v_mul_f32 v146, v12, v146
 v_mul_f32 v147, v12, v147
 v_mul_f32 v148, v13, v148
 v_mul_f32 v149, v13, v149
 v_mul_f32 v150, v13, v150
 v_mul_f32 v151, v13, v151
 v_mul_f32 v152, v12, v152
 v_mul_f32 v153, v12, v153
 v_mul_f32 v154, v12, v154
 v_mul_f32 v155, v12, v155
 v_mul_f32 v156, v13, v156
 v_mul_f32 v157, v13, v157
 v_mul_f32 v158, v13, v158
 v_mul_f32 v159, v13, v159
 v_mul_f32 v160, v12, v160
 v_mul_f32 v161, v12, v161
 v_mul_f32 v162, v12, v162
 v_mul_f32 v163, v12, v163
 v_mul_f32 v164, v13, v164
 v_mul_f32 v165, v13, v165
 v_mul_f32 v166, v13, v166
 v_mul_f32 v167, v13, v167
 v_mul_f32 v168, v12, v168
 v_mul_f32 v169, v12, v169
 v_mul_f32 v170, v12, v170
 v_mul_f32 v171, v12, v171
 v_mul_f32 v172, v13, v172
 v_mul_f32 v173, v13, v173
 v_mul_f32 v174, v13, v174
 v_mul_f32 v175, v13, v175
 v_mul_f32 v176, v12, v176
 v_mul_f32 v177, v12, v177
 v_mul_f32 v178, v12, v178
 v_mul_f32 v179, v12, v179
 v_mul_f32 v180, v13, v180
 v_mul_f32 v181, v13, v181
 v_mul_f32 v182, v13, v182
 v_mul_f32 v183, v13, v183
 v_mul_f32 v184, v12, v184
 v_mul_f32 v185, v12, v185
 v_mul_f32 v186, v12, v186
 v_mul_f32 v187, v12, v187
 v_mul_f32 v188, v13, v188
 v_mul_f32 v189, v13, v189
 v_mul_f32 v190, v13, v190
 v_mul_f32 v191, v13, v191
 v_mul_f32 v192, v12, v192
 v_mul_f32 v193, v12, v193
 v_mul_f32 v194, v12, v194
 v_mul_f32 v195, v12, v195
 v_mul_f32 v196, v13, v196
 v_mul_f32 v197, v13, v197
 v_mul_f32 v198, v13, v198
 v_mul_f32 v199, v13, v199
 v_mul_f32 v200, v12, v200
 v_mul_f32 v201, v12, v201
 v_mul_f32 v202, v12, v202
 v_mul_f32 v203, v12, v203
 v_mul_f32 v204, v13, v204
 v_mul_f32 v205, v13, v205
 v_mul_f32 v206, v13, v206
 v_mul_f32 v207, v13, v207
 v_mul_f32 v208, v12, v208
 v_mul_f32 v209, v12, v209
 v_mul_f32 v210, v12, v210
 v_mul_f32 v211, v12, v211
 v_mul_f32 v212, v13, v212
 v_mul_f32 v213, v13, v213
 v_mul_f32 v214, v13, v214
 v_mul_f32 v215, v13, v215
 v_mul_f32 v216, v12, v216
 v_mul_f32 v217, v12, v217
 v_mul_f32 v218, v12, v218
 v_mul_f32 v219, v12, v219
 v_mul_f32 v220, v13, v220
 v_mul_f32 v221, v13, v221
 v_mul_f32 v222, v13, v222
 v_mul_f32 v223, v13, v223
 v_mul_f32 v224, v12, v224
 v_mul_f32 v225, v12, v225
 v_mul_f32 v226, v12, v226
 v_mul_f32 v227, v12, v227
 v_mul_f32 v228, v13, v228
 v_mul_f32 v229, v13, v229
 v_mul_f32 v230, v13, v230
 v_mul_f32 v231, v13, v231
 v_mul_f32 v232, v12, v232
 v_mul_f32 v233, v12, v233
 v_mul_f32 v234, v12, v234
 v_mul_f32 v235, v12, v235
 v_mul_f32 v236, v13, v236
 v_mul_f32 v237, v13, v237
 v_mul_f32 v238, v13, v238
 v_mul_f32 v239, v13, v239
 v_mul_f32 v240, v12, v240
 v_mul_f32 v241, v12, v241
 v_mul_f32 v242, v12, v242
 v_mul_f32 v243, v12, v243
 v_mul_f32 v244, v13, v244
 v_mul_f32 v245, v13, v245
 v_mul_f32 v246, v13, v246
 v_mul_f32 v247, v13, v247
 v_mul_f32 v248, v12, v248
 v_mul_f32 v249, v12, v249
 v_mul_f32 v250, v12, v250
 v_mul_f32 v251, v12, v251
 v_mul_f32 v252, v13, v252
 v_mul_f32 v253, v13, v253
 v_mul_f32 v254, v13, v254
 v_mul_f32 v255, v13, v255
 v_exp_f32 v18, v96
 v_exp_f32 v19, v97
 v_exp_f32 v20, v98
 v_add_f32 v28, v18, v19
 v_cvt_pk_bf16_f32 v48, v18, v19
 v_exp_f32 v21, v99
 v_exp_f32 v22, v104
 v_add_f32 v28, v20, v28
 v_cvt_pk_bf16_f32 v49, v20, v21
 v_exp_f32 v23, v105
 v_add_f32 v28, v21, v28
 v_exp_f32 v24, v106
 v_add_f32 v28, v22, v28
 v_cvt_pk_bf16_f32 v50, v22, v23
 v_exp_f32 v25, v107
 v_add_f32 v28, v23, v28
 v_exp_f32 v18, v100
 v_add_f32 v28, v24, v28
 v_cvt_pk_bf16_f32 v51, v24, v25
 v_exp_f32 v19, v101
 v_add_f32 v28, v25, v28
 v_exp_f32 v20, v102
 v_add_f32 v29, v18, v19
 v_cvt_pk_bf16_f32 v52, v18, v19
 v_exp_f32 v21, v103
 v_exp_f32 v22, v108
 v_add_f32 v29, v20, v29
 v_cvt_pk_bf16_f32 v53, v20, v21
 v_exp_f32 v23, v109
 v_add_f32 v29, v21, v29
 v_exp_f32 v24, v110
 v_add_f32 v29, v22, v29
 v_cvt_pk_bf16_f32 v54, v22, v23
 v_exp_f32 v25, v111
 v_add_f32 v29, v23, v29
 v_add_f32 v29, v24, v29
 v_cvt_pk_bf16_f32 v55, v24, v25
 v_add_f32 v29, v25, v29
 v_exp_f32 v18, v112
 v_exp_f32 v19, v113
 v_exp_f32 v20, v114
 v_add_f32 v28, v18, v28
 v_cvt_pk_bf16_f32 v56, v18, v19
 v_exp_f32 v21, v115
 v_add_f32 v28, v19, v28
 v_exp_f32 v22, v120
 v_add_f32 v28, v20, v28
 v_cvt_pk_bf16_f32 v57, v20, v21
 v_exp_f32 v23, v121
 v_add_f32 v28, v21, v28
 v_exp_f32 v24, v122
 v_add_f32 v28, v22, v28
 v_cvt_pk_bf16_f32 v58, v22, v23
 v_exp_f32 v25, v123
 v_add_f32 v28, v23, v28
 v_exp_f32 v18, v116
 v_add_f32 v28, v24, v28
 v_cvt_pk_bf16_f32 v59, v24, v25
 v_exp_f32 v19, v117
 v_add_f32 v28, v25, v28
 v_exp_f32 v20, v118
 v_add_f32 v29, v18, v29
 v_cvt_pk_bf16_f32 v60, v18, v19
 v_exp_f32 v21, v119
 v_add_f32 v29, v19, v29
 v_exp_f32 v22, v124
 v_add_f32 v29, v20, v29
 v_cvt_pk_bf16_f32 v61, v20, v21
 v_exp_f32 v23, v125
 v_add_f32 v29, v21, v29
 v_exp_f32 v24, v126
 v_add_f32 v29, v22, v29
 v_cvt_pk_bf16_f32 v62, v22, v23
 v_exp_f32 v25, v127
 v_add_f32 v29, v23, v29
 v_add_f32 v29, v24, v29
 v_cvt_pk_bf16_f32 v63, v24, v25
 v_add_f32 v29, v25, v29
 s_nop 3
 s_setpc_b64 s[36:37]
L_slow0B:
 s_nop 7
 s_nop 3
 v_max3_f32 v10, v64, v65, v66
 v_max3_f32 v10, v67, v72, v10
 v_max3_f32 v10, v73, v74, v10
 v_max3_f32 v10, v75, v80, v10
 v_max3_f32 v10, v81, v82, v10
 v_max3_f32 v10, v83, v88, v10
 v_max3_f32 v10, v89, v90, v10
 v_max_f32 v10, v91, v10
 v_max3_f32 v11, v68, v69, v70
 v_max3_f32 v11, v71, v76, v11
 v_max3_f32 v11, v77, v78, v11
 v_max3_f32 v11, v79, v84, v11
 v_max3_f32 v11, v85, v86, v11
 v_max3_f32 v11, v87, v92, v11
 v_max3_f32 v11, v93, v94, v11
 v_max_f32 v11, v95, v11
 v_mov_b32 v12, v10
 v_mov_b32 v13, v11
 s_nop 0
 v_permlane16_swap_b32 v12, v10
 v_permlane16_swap_b32 v13, v11
 v_max_f32 v10, v12, v10
 v_max_f32 v11, v13, v11
 v_mov_b32 v12, v10
 v_mov_b32 v13, v11
 s_nop 0
 v_permlane32_swap_b32 v12, v10
 v_permlane32_swap_b32 v13, v11
 v_max_f32 v10, v12, v10
 v_max_f32 v11, v13, v11
 v_ceil_f32 v10, v10
 v_ceil_f32 v11, v11
 v_max_f32 v10, 0, v10
 v_max_f32 v11, 0, v11
 v_sub_f32 v64, v64, v10
 v_sub_f32 v65, v65, v10
 v_sub_f32 v66, v66, v10
 v_sub_f32 v67, v67, v10
 v_sub_f32 v68, v68, v11
 v_sub_f32 v69, v69, v11
 v_sub_f32 v70, v70, v11
 v_sub_f32 v71, v71, v11
 v_sub_f32 v72, v72, v10
 v_sub_f32 v73, v73, v10
 v_sub_f32 v74, v74, v10
 v_sub_f32 v75, v75, v10
 v_sub_f32 v76, v76, v11
 v_sub_f32 v77, v77, v11
 v_sub_f32 v78, v78, v11
 v_sub_f32 v79, v79, v11
 v_sub_f32 v80, v80, v10
 v_sub_f32 v81, v81, v10
 v_sub_f32 v82, v82, v10
 v_sub_f32 v83, v83, v10
 v_sub_f32 v84, v84, v11
 v_sub_f32 v85, v85, v11
 v_sub_f32 v86, v86, v11
 v_sub_f32 v87, v87, v11
 v_sub_f32 v88, v88, v10
 v_sub_f32 v89, v89, v10
 v_sub_f32 v90, v90, v10
 v_sub_f32 v91, v91, v10
 v_sub_f32 v92, v92, v11
 v_sub_f32 v93, v93, v11
 v_sub_f32 v94, v94, v11
 v_sub_f32 v95, v95, v11
 v_sub_f32 v100, v100, v11
 v_sub_f32 v101, v101, v11
 v_sub_f32 v102, v102, v11
 v_sub_f32 v103, v103, v11
 v_sub_f32 v108, v108, v11
 v_sub_f32 v109, v109, v11
 v_sub_f32 v110, v110, v11
 v_sub_f32 v111, v111, v11
 v_sub_f32 v116, v116, v11
 v_sub_f32 v117, v117, v11
 v_sub_f32 v118, v118, v11
 v_sub_f32 v119, v119, v11
 v_sub_f32 v124, v124, v11
 v_sub_f32 v125, v125, v11
 v_sub_f32 v126, v126, v11
 v_sub_f32 v127, v127, v11
 v_sub_f32 v32, v32, v10
 v_sub_f32 v33, v33, v10
 v_sub_f32 v34, v34, v10
 v_sub_f32 v35, v35, v10
 v_sub_f32 v36, v36, v11
 v_sub_f32 v37, v37, v11
 v_sub_f32 v38, v38, v11
 v_sub_f32 v39, v39, v11
 v_exp_f32 v12, -v10
 v_exp_f32 v13, -v11
 v_mul_f32 v30, v12, v30
 v_mul_f32 v31, v13, v31
 v_mul_f32 v128, v12, v128
 v_mul_f32 v129, v12, v129
 v_mul_f32 v130, v12, v130
 v_mul_f32 v131, v12, v131
 v_mul_f32 v132, v13, v132
 v_mul_f32 v133, v13, v133
 v_mul_f32 v134, v13, v134
 v_mul_f32 v135, v13, v135
 v_mul_f32 v136, v12, v136
 v_mul_f32 v137, v12, v137
 v_mul_f32 v138, v12, v138
 v_mul_f32 v139, v12, v139
 v_mul_f32 v140, v13, v140
 v_mul_f32 v141, v13, v141
 v_mul_f32 v142, v13, v142
 v_mul_f32 v143, v13, v143
 v_mul_f32 v144, v12, v144
 v_mul_f32 v145, v12, v145
 v_mul_f32 v146, v12, v146
 v_mul_f32 v147, v12, v147
 v_mul_f32 v148, v13, v148
 v_mul_f32 v149, v13, v149
 v_mul_f32 v150, v13, v150
 v_mul_f32 v151, v13, v151
 v_mul_f32 v152, v12, v152
 v_mul_f32 v153, v12, v153
 v_mul_f32 v154, v12, v154
 v_mul_f32 v155, v12, v155
 v_mul_f32 v156, v13, v156
 v_mul_f32 v157, v13, v157
 v_mul_f32 v158, v13, v158
 v_mul_f32 v159, v13, v159
 v_mul_f32 v160, v12, v160
 v_mul_f32 v161, v12, v161
 v_mul_f32 v162, v12, v162
 v_mul_f32 v163, v12, v163
 v_mul_f32 v164, v13, v164
 v_mul_f32 v165, v13, v165
 v_mul_f32 v166, v13, v166
 v_mul_f32 v167, v13, v167
 v_mul_f32 v168, v12, v168
 v_mul_f32 v169, v12, v169
 v_mul_f32 v170, v12, v170
 v_mul_f32 v171, v12, v171
 v_mul_f32 v172, v13, v172
 v_mul_f32 v173, v13, v173
 v_mul_f32 v174, v13, v174
 v_mul_f32 v175, v13, v175
 v_mul_f32 v176, v12, v176
 v_mul_f32 v177, v12, v177
 v_mul_f32 v178, v12, v178
 v_mul_f32 v179, v12, v179
 v_mul_f32 v180, v13, v180
 v_mul_f32 v181, v13, v181
 v_mul_f32 v182, v13, v182
 v_mul_f32 v183, v13, v183
 v_mul_f32 v184, v12, v184
 v_mul_f32 v185, v12, v185
 v_mul_f32 v186, v12, v186
 v_mul_f32 v187, v12, v187
 v_mul_f32 v188, v13, v188
 v_mul_f32 v189, v13, v189
 v_mul_f32 v190, v13, v190
 v_mul_f32 v191, v13, v191
 v_mul_f32 v192, v12, v192
 v_mul_f32 v193, v12, v193
 v_mul_f32 v194, v12, v194
 v_mul_f32 v195, v12, v195
 v_mul_f32 v196, v13, v196
 v_mul_f32 v197, v13, v197
 v_mul_f32 v198, v13, v198
 v_mul_f32 v199, v13, v199
 v_mul_f32 v200, v12, v200
 v_mul_f32 v201, v12, v201
 v_mul_f32 v202, v12, v202
 v_mul_f32 v203, v12, v203
 v_mul_f32 v204, v13, v204
 v_mul_f32 v205, v13, v205
 v_mul_f32 v206, v13, v206
 v_mul_f32 v207, v13, v207
 v_mul_f32 v208, v12, v208
 v_mul_f32 v209, v12, v209
 v_mul_f32 v210, v12, v210
 v_mul_f32 v211, v12, v211
 v_mul_f32 v212, v13, v212
 v_mul_f32 v213, v13, v213
 v_mul_f32 v214, v13, v214
 v_mul_f32 v215, v13, v215
 v_mul_f32 v216, v12, v216
 v_mul_f32 v217, v12, v217
 v_mul_f32 v218, v12, v218
 v_mul_f32 v219, v12, v219
 v_mul_f32 v220, v13, v220
 v_mul_f32 v221, v13, v221
 v_mul_f32 v222, v13, v222
 v_mul_f32 v223, v13, v223
 v_mul_f32 v224, v12, v224
 v_mul_f32 v225, v12, v225
 v_mul_f32 v226, v12, v226
 v_mul_f32 v227, v12, v227
 v_mul_f32 v228, v13, v228
 v_mul_f32 v229, v13, v229
 v_mul_f32 v230, v13, v230
 v_mul_f32 v231, v13, v231
 v_mul_f32 v232, v12, v232
 v_mul_f32 v233, v12, v233
 v_mul_f32 v234, v12, v234
 v_mul_f32 v235, v12, v235
 v_mul_f32 v236, v13, v236
 v_mul_f32 v237, v13, v237
 v_mul_f32 v238, v13, v238
 v_mul_f32 v239, v13, v239
 v_mul_f32 v240, v12, v240
 v_mul_f32 v241, v12, v241
 v_mul_f32 v242, v12, v242
 v_mul_f32 v243, v12, v243
 v_mul_f32 v244, v13, v244
 v_mul_f32 v245, v13, v245
 v_mul_f32 v246, v13, v246
 v_mul_f32 v247, v13, v247
 v_mul_f32 v248, v12, v248
 v_mul_f32 v249, v12, v249
 v_mul_f32 v250, v12, v250
 v_mul_f32 v251, v12, v251
 v_mul_f32 v252, v13, v252
 v_mul_f32 v253, v13, v253
 v_mul_f32 v254, v13, v254
 v_mul_f32 v255, v13, v255
 v_exp_f32 v18, v64
 v_exp_f32 v19, v65
 v_exp_f32 v20, v66
 v_add_f32 v26, v18, v19
 v_cvt_pk_bf16_f32 v40, v18, v19
 v_exp_f32 v21, v67
 v_exp_f32 v22, v72
 v_add_f32 v26, v20, v26
 v_cvt_pk_bf16_f32 v41, v20, v21
 v_exp_f32 v23, v73
 v_add_f32 v26, v21, v26
 v_exp_f32 v24, v74
 v_add_f32 v26, v22, v26
 v_cvt_pk_bf16_f32 v42, v22, v23
 v_exp_f32 v25, v75
 v_add_f32 v26, v23, v26
 v_exp_f32 v18, v68
 v_add_f32 v26, v24, v26
 v_cvt_pk_bf16_f32 v43, v24, v25
 v_exp_f32 v19, v69
 v_add_f32 v26, v25, v26
 v_exp_f32 v20, v70
 v_add_f32 v27, v18, v19
 v_cvt_pk_bf16_f32 v44, v18, v19
 v_exp_f32 v21, v71
 v_exp_f32 v22, v76
 v_add_f32 v27, v20, v27
 v_cvt_pk_bf16_f32 v45, v20, v21
 v_exp_f32 v23, v77
 v_add_f32 v27, v21, v27
 v_exp_f32 v24, v78
 v_add_f32 v27, v22, v27
 v_cvt_pk_bf16_f32 v46, v22, v23
 v_exp_f32 v25, v79
 v_add_f32 v27, v23, v27
 v_add_f32 v27, v24, v27
 v_cvt_pk_bf16_f32 v47, v24, v25
 v_add_f32 v27, v25, v27
 v_exp_f32 v18, v80
 v_exp_f32 v19, v81
 v_exp_f32 v20, v82
 v_add_f32 v26, v18, v26
 v_cvt_pk_bf16_f32 v56, v18, v19
 v_exp_f32 v21, v83
 v_add_f32 v26, v19, v26
 v_exp_f32 v22, v88
 v_add_f32 v26, v20, v26
 v_cvt_pk_bf16_f32 v57, v20, v21
 v_exp_f32 v23, v89
 v_add_f32 v26, v21, v26
 v_exp_f32 v24, v90
 v_add_f32 v26, v22, v26
 v_cvt_pk_bf16_f32 v58, v22, v23
 v_exp_f32 v25, v91
 v_add_f32 v26, v23, v26
 v_exp_f32 v18, v84
 v_add_f32 v26, v24, v26
 v_cvt_pk_bf16_f32 v59, v24, v25
 v_exp_f32 v19, v85
 v_add_f32 v26, v25, v26
 v_exp_f32 v20, v86
 v_add_f32 v27, v18, v27
 v_cvt_pk_bf16_f32 v60, v18, v19
 v_exp_f32 v21, v87
 v_add_f32 v27, v19, v27
 v_exp_f32 v22, v92
 v_add_f32 v27, v20, v27
 v_cvt_pk_bf16_f32 v61, v20, v21
 v_exp_f32 v23, v93
 v_add_f32 v27, v21, v27
 v_exp_f32 v24, v94
 v_add_f32 v27, v22, v27
 v_cvt_pk_bf16_f32 v62, v22, v23
 v_exp_f32 v25, v95
 v_add_f32 v27, v23, v27
 v_add_f32 v27, v24, v27
 v_cvt_pk_bf16_f32 v63, v24, v25
 v_add_f32 v27, v25, v27
 s_nop 3
 s_setpc_b64 s[36:37]
L_slowB:
 s_nop 7
 s_nop 3
 v_max3_f32 v11, v100, v101, v102
 v_max3_f32 v11, v103, v108, v11
 v_max3_f32 v11, v109, v110, v11
 v_max3_f32 v11, v111, v116, v11
 v_max3_f32 v11, v117, v118, v11
 v_max3_f32 v11, v119, v124, v11
 v_max3_f32 v11, v125, v126, v11
 v_max_f32 v11, v127, v11
 v_mov_b32 v13, v11
 s_nop 1
 v_permlane16_swap_b32 v13, v11
 v_max_f32 v11, v13, v11
 v_mov_b32 v13, v11
 s_nop 1
 v_permlane32_swap_b32 v13, v11
 v_max_f32 v11, v13, v11
 v_ceil_f32 v11, v11
 v_max_f32 v11, 0, v11
 v_sub_f32 v100, v100, v11
 v_sub_f32 v101, v101, v11
 v_sub_f32 v102, v102, v11
 v_sub_f32 v103, v103, v11
 v_sub_f32 v108, v108, v11
 v_sub_f32 v109, v109, v11
 v_sub_f32 v110, v110, v11
 v_sub_f32 v111, v111, v11
 v_sub_f32 v116, v116, v11
 v_sub_f32 v117, v117, v11
 v_sub_f32 v118, v118, v11
 v_sub_f32 v119, v119, v11
 v_sub_f32 v124, v124, v11
 v_sub_f32 v125, v125, v11
 v_sub_f32 v126, v126, v11
 v_sub_f32 v127, v127, v11
 v_sub_f32 v36, v36, v11
 v_sub_f32 v37, v37, v11
 v_sub_f32 v38, v38, v11
 v_sub_f32 v39, v39, v11
 v_exp_f32 v13, -v11
 s_nop 0
 v_mul_f32 v31, v13, v31
 v_mul_f32 v132, v13, v132
 v_mul_f32 v133, v13, v133
 v_mul_f32 v134, v13, v134
 v_mul_f32 v135, v13, v135
 v_mul_f32 v140, v13, v140
 v_mul_f32 v141, v13, v141
 v_mul_f32 v142, v13, v142
 v_mul_f32 v143, v13, v143
 v_mul_f32 v148, v13, v148
 v_mul_f32 v149, v13, v149
 v_mul_f32 v150, v13, v150
 v_mul_f32 v151, v13, v151
 v_mul_f32 v156, v13, v156
 v_mul_f32 v157, v13, v157
 v_mul_f32 v158, v13, v158
 v_mul_f32 v159, v13, v159
 v_mul_f32 v164, v13, v164
 v_mul_f32 v165, v13, v165
 v_mul_f32 v166, v13, v166
 v_mul_f32 v167, v13, v167
 v_mul_f32 v172, v13, v172
 v_mul_f32 v173, v13, v173
 v_mul_f32 v174, v13, v174
 v_mul_f32 v175, v13, v175
 v_mul_f32 v180, v13, v180
 v_mul_f32 v181, v13, v181
 v_mul_f32 v182, v13, v182
 v_mul_f32 v183, v13, v183
 v_mul_f32 v188, v13, v188
 v_mul_f32 v189, v13, v189
 v_mul_f32 v190, v13, v190
 v_mul_f32 v191, v13, v191
 v_mul_f32 v196, v13, v196
 v_mul_f32 v197, v13, v197
 v_mul_f32 v198, v13, v198
 v_mul_f32 v199, v13, v199
 v_mul_f32 v204, v13, v204
 v_mul_f32 v205, v13, v205
 v_mul_f32 v206, v13, v206
 v_mul_f32 v207, v13, v207
 v_mul_f32 v212, v13, v212
 v_mul_f32 v213, v13, v213
 v_mul_f32 v214, v13, v214
 v_mul_f32 v215, v13, v215
 v_mul_f32 v220, v13, v220
 v_mul_f32 v221, v13, v221
 v_mul_f32 v222, v13, v222
 v_mul_f32 v223, v13, v223
 v_mul_f32 v228, v13, v228
 v_mul_f32 v229, v13, v229
 v_mul_f32 v230, v13, v230
 v_mul_f32 v231, v13, v231
 v_mul_f32 v236, v13, v236
 v_mul_f32 v237, v13, v237
 v_mul_f32 v238, v13, v238
 v_mul_f32 v239, v13, v239
 v_mul_f32 v244, v13, v244
 v_mul_f32 v245, v13, v245
 v_mul_f32 v246, v13, v246
 v_mul_f32 v247, v13, v247
 v_mul_f32 v252, v13, v252
 v_mul_f32 v253, v13, v253
 v_mul_f32 v254, v13, v254
 v_mul_f32 v255, v13, v255
 v_exp_f32 v18, v100
 v_exp_f32 v19, v101
 v_exp_f32 v20, v102
 v_add_f32 v29, v18, v19
 v_cvt_pk_bf16_f32 v52, v18, v19
 v_exp_f32 v21, v103
 v_exp_f32 v22, v108
 v_add_f32 v29, v20, v29
 v_cvt_pk_bf16_f32 v53, v20, v21
 v_exp_f32 v23, v109
 v_add_f32 v29, v21, v29
 v_exp_f32 v24, v110
 v_add_f32 v29, v22, v29
 v_cvt_pk_bf16_f32 v54, v22, v23
 v_exp_f32 v25, v111
 v_add_f32 v29, v23, v29
 v_exp_f32 v18, v116
 v_add_f32 v29, v24, v29
 v_cvt_pk_bf16_f32 v55, v24, v25
 v_exp_f32 v19, v117
 v_add_f32 v29, v25, v29
 v_exp_f32 v20, v118
 v_add_f32 v29, v18, v29
 v_cvt_pk_bf16_f32 v48, v18, v19
 v_exp_f32 v21, v119
 v_add_f32 v29, v19, v29
 v_exp_f32 v22, v124
 v_add_f32 v29, v20, v29
 v_cvt_pk_bf16_f32 v49, v20, v21
 v_exp_f32 v23, v125
 v_add_f32 v29, v21, v29
 v_exp_f32 v24, v126
 v_add_f32 v29, v22, v29
 v_cvt_pk_bf16_f32 v50, v22, v23
 v_exp_f32 v25, v127
 v_add_f32 v29, v23, v29
 v_add_f32 v29, v24, v29
 v_cvt_pk_bf16_f32 v51, v24, v25
 v_add_f32 v29, v25, v29
 s_nop 3
 s_setpc_b64 s[36:37]
L_slowf:
 s_nop 7
 s_nop 3
 v_max3_f32 v10, v64, v65, v66
 v_max3_f32 v10, v67, v72, v10
 v_max3_f32 v10, v73, v74, v10
 v_max3_f32 v10, v75, v80, v10
 v_max3_f32 v10, v81, v82, v10
 v_max3_f32 v10, v83, v88, v10
 v_max3_f32 v10, v89, v90, v10
 v_max_f32 v10, v91, v10
 v_max3_f32 v11, v68, v69, v70
 v_max3_f32 v11, v71, v76, v11
 v_max3_f32 v11, v77, v78, v11
 v_max3_f32 v11, v79, v84, v11
 v_max3_f32 v11, v85, v86, v11
 v_max3_f32 v11, v87, v92, v11
 v_max3_f32 v11, v93, v94, v11
 v_max_f32 v11, v95, v11
 v_mov_b32 v12, v10
 v_mov_b32 v13, v11
 s_nop 0
 v_permlane16_swap_b32 v12, v10
 v_permlane16_swap_b32 v13, v11
 v_max_f32 v10, v12, v10
 v_max_f32 v11, v13, v11
 v_mov_b32 v12, v10
 v_mov_b32 v13, v11
 s_nop 0
 v_permlane32_swap_b32 v12, v10
 v_permlane32_swap_b32 v13, v11
 v_max_f32 v10, v12, v10
 v_max_f32 v11, v13, v11
 v_ceil_f32 v10, v10
 v_ceil_f32 v11, v11
 v_sub_f32 v64, v64, v10
 v_sub_f32 v65, v65, v10
 v_sub_f32 v66, v66, v10
 v_sub_f32 v67, v67, v10
 v_sub_f32 v68, v68, v11
 v_sub_f32 v69, v69, v11
 v_sub_f32 v70, v70, v11
 v_sub_f32 v71, v71, v11
 v_sub_f32 v72, v72, v10
 v_sub_f32 v73, v73, v10
 v_sub_f32 v74, v74, v10
 v_sub_f32 v75, v75, v10
 v_sub_f32 v76, v76, v11
 v_sub_f32 v77, v77, v11
 v_sub_f32 v78, v78, v11
 v_sub_f32 v79, v79, v11
 v_sub_f32 v80, v80, v10
 v_sub_f32 v81, v81, v10
 v_sub_f32 v82, v82, v10
 v_sub_f32 v83, v83, v10
 v_sub_f32 v84, v84, v11
 v_sub_f32 v85, v85, v11
 v_sub_f32 v86, v86, v11
 v_sub_f32 v87, v87, v11
 v_sub_f32 v88, v88, v10
 v_sub_f32 v89, v89, v10
 v_sub_f32 v90, v90, v10
 v_sub_f32 v91, v91, v10
 v_sub_f32 v92, v92, v11
 v_sub_f32 v93, v93, v11
 v_sub_f32 v94, v94, v11
 v_sub_f32 v95, v95, v11
 v_sub_f32 v96, v96, v10
 v_sub_f32 v97, v97, v10
 v_sub_f32 v98, v98, v10
 v_sub_f32 v99, v99, v10
 v_sub_f32 v100, v100, v11
 v_sub_f32 v101, v101, v11
 v_sub_f32 v102, v102, v11
 v_sub_f32 v103, v103, v11
 v_sub_f32 v104, v104, v10
 v_sub_f32 v105, v105, v10
 v_sub_f32 v106, v106, v10
 v_sub_f32 v107, v107, v10
 v_sub_f32 v108, v108, v11
 v_sub_f32 v109, v109, v11
 v_sub_f32 v110, v110, v11
 v_sub_f32 v111, v111, v11
 v_sub_f32 v112, v112, v10
 v_sub_f32 v113, v113, v10
 v_sub_f32 v114, v114, v10
 v_sub_f32 v115, v115, v10
 v_sub_f32 v116, v116, v11
 v_sub_f32 v117, v117, v11
 v_sub_f32 v118, v118, v11
 v_sub_f32 v119, v119, v11
 v_sub_f32 v120, v120, v10
 v_sub_f32 v121, v121, v10
 v_sub_f32 v122, v122, v10
 v_sub_f32 v123, v123, v10
 v_sub_f32 v124, v124, v11
 v_sub_f32 v125, v125, v11
 v_sub_f32 v126, v126, v11
 v_sub_f32 v127, v127, v11
 v_sub_f32 v32, v32, v10
 v_sub_f32 v33, v33, v10
 v_sub_f32 v34, v34, v10
 v_sub_f32 v35, v35, v10
 v_sub_f32 v36, v36, v11
 v_sub_f32 v37, v37, v11
 v_sub_f32 v38, v38, v11
 v_sub_f32 v39, v39, v11
 v_exp_f32 v18, v64
 v_exp_f32 v19, v65
 v_exp_f32 v20, v66
 v_add_f32 v26, v18, v19
 v_cvt_pk_bf16_f32 v40, v18, v19
 v_exp_f32 v21, v67
 v_exp_f32 v22, v72
 v_add_f32 v26, v20, v26
 v_cvt_pk_bf16_f32 v41, v20, v21
 v_exp_f32 v23, v73
 v_add_f32 v26, v21, v26
 v_exp_f32 v24, v74
 v_add_f32 v26, v22, v26
 v_cvt_pk_bf16_f32 v42, v22, v23
 v_exp_f32 v25, v75
 v_add_f32 v26, v23, v26
 v_exp_f32 v18, v68
 v_add_f32 v26, v24, v26
 v_cvt_pk_bf16_f32 v43, v24, v25
 v_exp_f32 v19, v69
 v_add_f32 v26, v25, v26
 v_exp_f32 v20, v70
 v_add_f32 v27, v18, v19
 v_cvt_pk_bf16_f32 v44, v18, v19
 v_exp_f32 v21, v71
 v_exp_f32 v22, v76
 v_add_f32 v27, v20, v27
 v_cvt_pk_bf16_f32 v45, v20, v21
 v_exp_f32 v23, v77
 v_add_f32 v27, v21, v27
 v_exp_f32 v24, v78
 v_add_f32 v27, v22, v27
 v_cvt_pk_bf16_f32 v46, v22, v23
 v_exp_f32 v25, v79
 v_add_f32 v27, v23, v27
 v_add_f32 v27, v24, v27
 v_cvt_pk_bf16_f32 v47, v24, v25
 v_add_f32 v27, v25, v27
 v_exp_f32 v18, v80
 v_exp_f32 v19, v81
 v_exp_f32 v20, v82
 v_add_f32 v26, v18, v26
 v_cvt_pk_bf16_f32 v56, v18, v19
 v_exp_f32 v21, v83
 v_add_f32 v26, v19, v26
 v_exp_f32 v22, v88
 v_add_f32 v26, v20, v26
 v_cvt_pk_bf16_f32 v57, v20, v21
 v_exp_f32 v23, v89
 v_add_f32 v26, v21, v26
 v_exp_f32 v24, v90
 v_add_f32 v26, v22, v26
 v_cvt_pk_bf16_f32 v58, v22, v23
 v_exp_f32 v25, v91
 v_add_f32 v26, v23, v26
 v_exp_f32 v18, v84
 v_add_f32 v26, v24, v26
 v_cvt_pk_bf16_f32 v59, v24, v25
 v_exp_f32 v19, v85
 v_add_f32 v26, v25, v26
 v_exp_f32 v20, v86
 v_add_f32 v27, v18, v27
 v_cvt_pk_bf16_f32 v60, v18, v19
 v_exp_f32 v21, v87
 v_add_f32 v27, v19, v27
 v_exp_f32 v22, v92
 v_add_f32 v27, v20, v27
 v_cvt_pk_bf16_f32 v61, v20, v21
 v_exp_f32 v23, v93
 v_add_f32 v27, v21, v27
 v_exp_f32 v24, v94
 v_add_f32 v27, v22, v27
 v_cvt_pk_bf16_f32 v62, v22, v23
 v_exp_f32 v25, v95
 v_add_f32 v27, v23, v27
 v_add_f32 v27, v24, v27
 v_cvt_pk_bf16_f32 v63, v24, v25
 v_add_f32 v27, v25, v27
 s_nop 3
 s_setpc_b64 s[36:37]
L_moe0:
 s_lshl_b32 s88, s75, 1
 s_call_b64 s[36:37], L_moe
 v_add_f32 v32, v108, v32
 v_add_f32 v33, v109, v33
 v_add_f32 v34, v110, v34
 v_add_f32 v35, v111, v35
 v_add_f32 v36, v112, v36
 v_add_f32 v37, v113, v37
 v_add_f32 v38, v114, v38
 v_add_f32 v39, v115, v39
 v_add_f32 v40, v116, v40
 v_add_f32 v41, v117, v41
 v_add_f32 v42, v118, v42
 v_add_f32 v43, v119, v43
 v_add_f32 v44, v120, v44
 v_add_f32 v45, v121, v45
 v_add_f32 v46, v122, v46
 v_add_f32 v47, v123, v47
 s_mov_b64 exec, -1
 s_branch L_moe_ret0
L_moe1:
 s_lshl_b32 s88, s86, 1
 s_call_b64 s[36:37], L_moe
 v_add_f32 v80, v108, v80
 v_add_f32 v81, v109, v81
 v_add_f32 v82, v110, v82
 v_add_f32 v83, v111, v83
 v_add_f32 v84, v112, v84
 v_add_f32 v85, v113, v85
 v_add_f32 v86, v114, v86
 v_add_f32 v87, v115, v87
 s_mov_b64 exec, -1
 s_branch L_moe_ret1
L_moe2:
 s_lshl_b32 s88, s86, 1
 s_call_b64 s[36:37], L_moe
 v_add_f32 v32, v108, v32
 v_add_f32 v33, v109, v33
 v_add_f32 v34, v110, v34
 v_add_f32 v35, v111, v35
 v_add_f32 v36, v112, v36
 v_add_f32 v37, v113, v37
 v_add_f32 v38, v114, v38
 v_add_f32 v39, v115, v39
 s_mov_b64 exec, -1
 s_branch L_moe_ret2
L_moe:
 v_min_u32 v104, 27, v0
 v_lshlrev_b32 v104, 2, v104
 s_mov_b32 s64, 105062912
 s_mov_b32 s65, 65536
 s_mov_b32 exec_lo, 0xffffffff
 s_mov_b32 exec_hi, 0xffffffff
L_pfy:
 buffer_load_dword v105, v104, s[8:11], s64 offen sc1
 s_sub_u32 s65, s65, 1
 s_cbranch_scc1 L_pfy_x
 s_waitcnt vmcnt(0)
 v_cmp_ne_u32 vcc, 1, v105
 s_nop 0
 s_cbranch_vccz L_pfy_x
 s_sleep 2
 s_branch L_pfy
L_pfy_x:
 s_waitcnt vmcnt(0)
 s_mov_b64 exec, -1
 s_or_b64 exec, s[80:81], s[82:83]
 v_mov_b32 v104, 1792
 v_cndmask_b32 v104, v104, 0, s[80:81]
 v_lshl_add_u32 v104, v11, 5, v104
 s_add_u32 s88, s88, 104898560
 buffer_load_dwordx4 v[108:111], v104, s[8:11], s88 offen sc1
 buffer_load_dwordx4 v[112:115], v104, s[8:11], s88 offen offset:16 sc1
 buffer_load_dwordx4 v[116:119], v104, s[8:11], s88 offen offset:512 sc1
 buffer_load_dwordx4 v[120:123], v104, s[8:11], s88 offen offset:528 sc1
 s_waitcnt vmcnt(0)
 s_setpc_b64 s[36:37]
L_y1:
 s_lshl_b32 s89, s41, 1
 s_add_u32 s89, s89, s20
 s_cmp_ge_u32 s20, 2
 s_cselect_b32 s89, 28, s89
 s_cmp_ge_u32 s89, 28
 s_cbranch_scc1 L_y1r
 v_lshrrev_b32 v50, 4, v7
 v_lshrrev_b32 v51, 3, v50
 v_mul_u32_u24 v51, 4352, v51
 v_and_b32 v52, 7, v50
 v_lshl_add_u32 v51, v52, 7, v51
 s_mov_b32 s90, 104923136
 s_mov_b32 s88, 104957952
 s_mov_b32 s91, 65536
L_yp:
 buffer_load_dword v52, v51, s[8:11], s90 offen sc1
 buffer_load_dword v53, v51, s[8:11], s88 offen sc1
 s_waitcnt vmcnt(0)
 v_min_u32 v52, v52, v53
 v_cmp_gt_u32 vcc, 4, v52
 s_sub_u32 s91, s91, 1
 s_cbranch_scc1 L_ypx
 s_cbranch_vccnz L_yp
L_ypx:
 s_cmp_lt_u32 s89, 14
 s_cselect_b32 s90, 8, 12
 s_add_u32 s90, s90, 104890368
 buffer_load_dword v53, off, s[8:11], s90 sc1
 v_lshrrev_b32 v51, 3, v50
 v_mul_u32_u24 v51, 3584, v51
 v_and_b32 v52, 7, v50
 v_lshl_add_u32 v51, v52, 4, v51
 s_lshl_b32 s88, s89, 7
 s_add_u32 s90, s88, 104898560
 s_add_u32 s88, s88, 105906176
 buffer_load_dwordx4 v[136:139], v51, s[8:11], s88 offen sc1
 s_add_u32 s88, s88, 28672
 buffer_load_dwordx4 v[140:143], v51, s[8:11], s88 offen sc1
 s_add_u32 s88, s88, 28672
 buffer_load_dwordx4 v[152:155], v51, s[8:11], s88 offen sc1
 s_add_u32 s88, s88, 28672
 buffer_load_dwordx4 v[156:159], v51, s[8:11], s88 offen sc1
 s_add_u32 s88, s88, 28672
 buffer_load_dwordx4 v[168:171], v51, s[8:11], s88 offen sc1
 s_add_u32 s88, s88, 28672
 buffer_load_dwordx4 v[172:175], v51, s[8:11], s88 offen sc1
 s_add_u32 s88, s88, 28672
 buffer_load_dwordx4 v[184:187], v51, s[8:11], s88 offen sc1
 s_add_u32 s88, s88, 28672
 buffer_load_dwordx4 v[188:191], v51, s[8:11], s88 offen sc1
 s_add_u32 s88, s88, 28672
 buffer_load_dwordx4 v[200:203], v51, s[8:11], s88 offen sc1
 s_add_u32 s88, s88, 28672
 buffer_load_dwordx4 v[204:207], v51, s[8:11], s88 offen sc1
 s_add_u32 s88, s88, 28672
 buffer_load_dwordx4 v[216:219], v51, s[8:11], s88 offen sc1
 s_add_u32 s88, s88, 28672
 buffer_load_dwordx4 v[220:223], v51, s[8:11], s88 offen sc1
 s_add_u32 s88, s88, 28672
 buffer_load_dwordx4 v[232:235], v51, s[8:11], s88 offen sc1
 s_add_u32 s88, s88, 28672
 buffer_load_dwordx4 v[236:239], v51, s[8:11], s88 offen sc1
 s_add_u32 s88, s88, 28672
 s_branch L_y1r
L_y2:
 s_cmp_ge_u32 s89, 28
 s_cbranch_scc1 L_y2r
 s_waitcnt vmcnt(24)
 s_waitcnt vmcnt(12)
 v_add_f32 v136, v140, v136
 v_add_f32 v137, v141, v137
 v_add_f32 v138, v142, v138
 v_add_f32 v139, v143, v139
 s_waitcnt vmcnt(11)
 v_add_f32 v136, v152, v136
 v_add_f32 v137, v153, v137
 v_add_f32 v138, v154, v138
 v_add_f32 v139, v155, v139
 s_waitcnt vmcnt(10)
 v_add_f32 v136, v156, v136
 v_add_f32 v137, v157, v137
 v_add_f32 v138, v158, v138
 v_add_f32 v139, v159, v139
 s_waitcnt vmcnt(9)
 v_add_f32 v136, v168, v136
 v_add_f32 v137, v169, v137
 v_add_f32 v138, v170, v138
 v_add_f32 v139, v171, v139
 s_waitcnt vmcnt(8)
 v_add_f32 v136, v172, v136
 v_add_f32 v137, v173, v137
 v_add_f32 v138, v174, v138
 v_add_f32 v139, v175, v139
 s_waitcnt vmcnt(7)
 v_add_f32 v136, v184, v136
 v_add_f32 v137, v185, v137
 v_add_f32 v138, v186, v138
 v_add_f32 v139, v187, v139
 s_waitcnt vmcnt(6)
 v_add_f32 v136, v188, v136
 v_add_f32 v137, v189, v137
 v_add_f32 v138, v190, v138
 v_add_f32 v139, v191, v139
 s_waitcnt vmcnt(5)
 v_add_f32 v136, v200, v136
 v_add_f32 v137, v201, v137
 v_add_f32 v138, v202, v138
 v_add_f32 v139, v203, v139
 s_waitcnt vmcnt(4)
 v_add_f32 v136, v204, v136
 v_add_f32 v137, v205, v137
 v_add_f32 v138, v206, v138
 v_add_f32 v139, v207, v139
 s_waitcnt vmcnt(3)
 v_add_f32 v136, v216, v136
 v_add_f32 v137, v217, v137
 v_add_f32 v138, v218, v138
 v_add_f32 v139, v219, v139
 s_waitcnt vmcnt(2)
 v_add_f32 v136, v220, v136
 v_add_f32 v137, v221, v137
 v_add_f32 v138, v222, v138
 v_add_f32 v139, v223, v139
 s_waitcnt vmcnt(1)
 v_add_f32 v136, v232, v136
 v_add_f32 v137, v233, v137
 v_add_f32 v138, v234, v138
 v_add_f32 v139, v235, v139
 s_waitcnt vmcnt(0)
 v_add_f32 v136, v236, v136
 v_add_f32 v137, v237, v137
 v_add_f32 v138, v238, v138
 v_add_f32 v139, v239, v139
 v_add_f32 v136, v136, v136 row_ror:8 row_mask:0xf bank_mask:0xf
 v_add_f32 v137, v137, v137 row_ror:8 row_mask:0xf bank_mask:0xf
 v_add_f32 v138, v138, v138 row_ror:8 row_mask:0xf bank_mask:0xf
 v_add_f32 v139, v139, v139 row_ror:8 row_mask:0xf bank_mask:0xf
 v_mov_b32 v140, v136
 v_mov_b32 v141, v137
 v_mov_b32 v142, v138
 v_mov_b32 v143, v139
 v_permlane16_swap_b32 v140, v136
 v_permlane16_swap_b32 v141, v137
 v_permlane16_swap_b32 v142, v138
 v_permlane16_swap_b32 v143, v139
 v_add_f32 v136, v140, v136
 v_add_f32 v137, v141, v137
 v_add_f32 v138, v142, v138
 v_add_f32 v139, v143, v139
 v_mov_b32 v140, v136
 v_mov_b32 v141, v137
 v_mov_b32 v142, v138
 v_mov_b32 v143, v139
 v_permlane32_swap_b32 v140, v136
 v_permlane32_swap_b32 v141, v137
 v_permlane32_swap_b32 v142, v138
 v_permlane32_swap_b32 v143, v139
 v_add_f32 v136, v140, v136
 v_add_f32 v137, v141, v137
 v_add_f32 v138, v142, v138
 v_add_f32 v139, v143, v139
 v_cvt_pk_bf16_f32 v51, v136, v137
 v_lshlrev_b32 v136, 16, v51
 v_and_b32 v137, 0xffff0000, v51
 v_cvt_pk_bf16_f32 v51, v138, v139
 v_lshlrev_b32 v138, 16, v51
 v_and_b32 v139, 0xffff0000, v51
 v_mul_f32 v136, v53, v136
 v_mul_f32 v137, v53, v137
 v_mul_f32 v138, v53, v138
 v_mul_f32 v139, v53, v139
 v_cvt_pk_bf16_f32 v51, v136, v137
 v_lshlrev_b32 v136, 16, v51
 v_and_b32 v137, 0xffff0000, v51
 v_cvt_pk_bf16_f32 v51, v138, v139
 v_lshlrev_b32 v138, 16, v51
 v_and_b32 v139, 0xffff0000, v51
 s_mov_b64 exec, 0xff
 buffer_store_dwordx4 v[136:139], v7, s[8:11], s90 offen sc1
 s_mov_b64 exec, -1
 s_branch L_y2r
L_y3:
 s_cmp_ge_u32 s89, 28
 s_cbranch_scc1 L_y3r
 v_mov_b32 v52, 1
 s_lshl_b32 s89, s89, 2
 s_add_u32 s89, s89, 105062912
 s_mov_b64 exec, 1
 s_waitcnt vmcnt(5)
 buffer_store_dword v52, off, s[8:11], s89 sc1
 s_mov_b64 exec, -1
 s_branch L_y3r
L_fll:
 s_cmp_lg_u32 s39, 15
 s_cbranch_scc1 L_fll1
 v_mov_b32 v9, 0
 s_mov_b32 s46, s47
 s_mov_b32 s39, 1
L_fll1:
 buffer_load_dword v6, v9, s[8:11], s46 offen sc1
 s_branch L_fllr
L_pub3:
 v_mov_b32 v17, s3
 buffer_store_dword v17, v1, s[8:11], s45 offen sc1
 s_branch L_pub3r
L_fhs0:
 s_mov_b32 s91, 65536
L_fhs0_l:
 s_sleep 2
 buffer_load_dword v24, off, s[8:11], s79 sc1
 s_sub_u32 s91, s91, 1
 s_cbranch_scc1 L_fhs0_x
 s_waitcnt vmcnt(0)
 v_cmp_gt_u32 vcc, 1, v24
 s_nop 0
 s_cbranch_vccnz L_fhs0_l
L_fhs0_x:
 s_waitcnt vmcnt(0)
 s_branch L_fhr0
L_fhs1:
 s_mov_b32 s91, 65536
L_fhs1_l:
 s_sleep 2
 buffer_load_dword v24, off, s[8:11], s79 sc1
 s_sub_u32 s91, s91, 1
 s_cbranch_scc1 L_fhs1_x
 s_waitcnt vmcnt(0)
 v_cmp_gt_u32 vcc, 1, v24
 s_nop 0
 s_cbranch_vccnz L_fhs1_l
L_fhs1_x:
 s_waitcnt vmcnt(0)
 s_branch L_fhr1
L_fps1:
 s_mov_b32 s53, 65536
L_fps1_l:
 s_sleep 2
 buffer_load_dword v5, off, s[8:11], s47 sc1
 s_sub_u32 s53, s53, 1
 s_cbranch_scc1 L_fps1_x
 s_waitcnt vmcnt(0)
 v_cmp_ne_u32 vcc, 1, v5
 s_nop 0
 s_cbranch_vccnz L_fps1_l
L_fps1_x:
 s_waitcnt vmcnt(0)
 s_branch L_fpr1
L_f4s:
 s_mov_b32 s53, 65536
L_f4s_l:
 s_sleep 2
 buffer_load_dword v6, v9, s[8:11], s46 offen sc1
 s_sub_u32 s53, s53, 1
 s_cbranch_scc1 L_f4s_x
 s_waitcnt vmcnt(0)
 v_cmp_gt_u32 vcc, 3, v6
 s_nop 0
 s_cbranch_vccnz L_f4s_l
L_f4s_x:
 s_waitcnt vmcnt(0)
 s_branch L_f4r
L_f2s:
 s_mov_b32 s53, 65536
L_f2s_l:
 s_sleep 2
 buffer_load_dword v6, v9, s[8:11], s46 offen sc1
 s_sub_u32 s53, s53, 1
 s_cbranch_scc1 L_f2s_x
 s_waitcnt vmcnt(0)
 v_cmp_gt_u32 vcc, 3, v6
 s_nop 0
 s_cbranch_vccnz L_f2s_l
L_f2s_x:
 s_waitcnt vmcnt(0)
 s_branch L_f2r
L_fls0:
 s_mov_b32 s53, 65536
L_fls0_l:
 s_sleep 2
 buffer_load_dword v6, v9, s[8:11], s46 offen sc1
 s_sub_u32 s53, s53, 1
 s_cbranch_scc1 L_fls0_x
 s_waitcnt vmcnt(0)
 v_cmp_gt_u32 vcc, s39, v6
 s_nop 0
 s_cbranch_vccnz L_fls0_l
L_fls0_x:
 s_waitcnt vmcnt(0)
 s_branch L_flr0
L_code_end:
.section .rodata,"a"
.p2align 6
.amdhsa_kernel gated_mix__compressed_kv_cla__moe_arch_mod__prompt_kernel
  .amdhsa_next_free_vgpr 512
  .amdhsa_next_free_sgpr 102
  .amdhsa_accum_offset 256
  .amdhsa_group_segment_fixed_size 0
  .amdhsa_kernarg_size 120
  .amdhsa_user_sgpr_count 2
  .amdhsa_user_sgpr_kernarg_segment_ptr 1
  .amdhsa_system_sgpr_workgroup_id_x 1
  .amdhsa_float_denorm_mode_32 3
.end_amdhsa_kernel
```

```asm
; @launch grid=(256,1,1) block=(256,1,1) lds=163840
.amdgcn_target "amdgcn-amd-amdhsa--gfx950"
.text
.macro M d, a, b, c
v_mfma_f32_16x16x32_bf16 \d, \a, \b, \c
.endm
.globl gated_mix__compressed_kv_cla__moe_arch_mod__prompt_kernel
.p2align 8
.type gated_mix__compressed_kv_cla__moe_arch_mod__prompt_kernel,@function
gated_mix__compressed_kv_cla__moe_arch_mod__prompt_kernel:
 s_cmp_lt_u32 s2, 256
 s_cbranch_scc1 L_go
 s_endpgm
L_go:
 s_load_dwordx8 s[80:87], s[0:1], 0
 s_load_dwordx4 s[88:91], s[0:1], 32
 s_load_dwordx2 s[92:93], s[0:1], 56
 s_load_dwordx2 s[30:31], s[0:1], 88
 s_load_dwordx4 s[4:7], s[0:1], 104
 v_lshrrev_b32 v24, 6, v0
 v_and_b32 v0, 63, v0
 v_readfirstlane_b32 s20, v24
 s_getpc_b64 s[76:77]
L_pc0:
 s_and_b32 s77, s77, 0xffff
 s_mov_b32 s78, L_code_end-L_pc0
 s_mov_b32 s79, 0x20000
 s_lshr_b32 s64, s2, 3
 s_lshl_b32 s64, s64, 2
 s_add_u32 s64, s64, s20
 s_lshl_b32 s95, s64, 11
 v_lshl_add_u32 v29, v0, 7, s95
 v_and_b32 v28, 48, v0
 v_lshl_add_u32 v28, v28, 24, v29
 buffer_load_dword a240, v28, s[76:79], 0 offen offset:0
 s_and_b32 s41, s2, 7
 s_lshr_b32 s42, s2, 3
 s_lshr_b32 s64, s42, 4
 s_lshl_b32 s64, s64, 3
 s_add_u32 s41, s41, s64
 s_and_b32 s42, s42, 15
 s_lshr_b32 s45, s42, 3
 s_xor_b32 s45, s45, 1
 s_mov_b32 s44, 0
 v_accvgpr_write_b32 a250, 0
 v_accvgpr_write_b32 a251, 0
 v_and_b32 v24, 15, v0
 v_lshrrev_b32 v25, 4, v0
 v_lshlrev_b32 v7, 4, v0
 s_and_b32 s65, s20, 1
 s_lshr_b32 s66, s20, 1
 v_or_b32 v28, 0, v25
 v_lshlrev_b32 v28, 1, v28
 v_xor_b32 v28, v28, v24
 v_lshrrev_b32 v29, 3, v28
 v_lshlrev_b32 v29, 8, v29
 v_and_b32 v28, 7, v28
 v_lshl_add_u32 v28, v28, 4, v29
 v_lshl_add_u32 v28, v25, 13, v28
 s_lshl_b32 s64, s20, 17
 s_add_u32 s64, s64, 0
 v_add_u32 v8, s64, v28
 v_add_u32 v9, 31744, v8
 v_or_b32 v28, 4, v25
 v_lshlrev_b32 v28, 1, v28
 v_xor_b32 v28, v28, v24
 v_lshrrev_b32 v29, 3, v28
 v_lshlrev_b32 v29, 8, v29
 v_and_b32 v28, 7, v28
 v_lshl_add_u32 v28, v28, 4, v29
 v_lshl_add_u32 v28, v25, 13, v28
 s_lshl_b32 s64, s20, 17
 s_add_u32 s64, s64, 63488
 v_add_u32 v10, s64, v28
 v_add_u32 v11, 31744, v10
 v_add_u32 v28, 0, v25
 v_and_b32 v29, 7, v0
 v_xor_b32 v28, v28, v29
 v_lshlrev_b32 v28, 4, v28
 v_lshrrev_b32 v29, 3, v0
 v_lshl_add_u32 v30, v29, 11, v28
 s_lshl_b32 s64, s66, 19
 s_lshl_b32 s67, s65, 20
 s_add_u32 s64, s64, s67
 s_add_u32 s64, s64, 0
 v_add_u32 v12, s64, v30
 v_add_u32 v14, 30720, v12
 v_add_u32 v28, 4, v25
 v_and_b32 v29, 7, v0
 v_xor_b32 v28, v28, v29
 v_lshlrev_b32 v28, 4, v28
 v_lshrrev_b32 v29, 3, v0
 v_lshl_add_u32 v30, v29, 11, v28
 s_lshl_b32 s64, s66, 19
 s_lshl_b32 s67, s65, 20
 s_add_u32 s64, s64, s67
 s_add_u32 s64, s64, 15360
 v_add_u32 v13, s64, v30
 v_add_u32 v15, 30720, v13
 s_mov_b32 s21, 0
 s_mov_b32 s22, 0
 s_lshl_b32 s23, s20, 12
 s_add_u32 s24, s23, 65536
 s_lshl_b32 s74, s41, 9
 s_sub_u32 s18, 8388608, s74
 s_mov_b32 s19, 0x20000
 s_and_b32 s75, s42, 7
 s_lshl_b32 s75, s75, 16
 s_sub_u32 s50, 4194304, s75
 s_mov_b32 s51, 0x20000
 s_mov_b32 m0, s23
 s_cmp_eq_u32 s45, 0
 s_waitcnt lgkmcnt(0)
 s_cselect_b64 s[72:73], s[86:87], s[88:89]
 s_add_u32 s16, s72, s74
 s_addc_u32 s17, s73, 0
 s_and_b32 s17, s17, 0xffff
 buffer_load_dwordx4 v8, s[16:19], s21 offen offset:0  nt lds
 buffer_load_dwordx4 v9, s[16:19], s21 offen offset:1024  nt lds
 buffer_load_dwordx4 v10, s[16:19], s21 offen offset:2048  nt lds
 buffer_load_dwordx4 v11, s[16:19], s21 offen offset:3072  nt lds
 s_add_u32 s21, s21, 128
 s_add_u32 s48, s82, s75
 s_addc_u32 s49, s83, 0
 s_and_b32 s49, s49, 0xffff
 s_add_u32 m0, s24, 0
 s_nop 0
 buffer_load_dwordx4 v12, s[48:51], s22 offen offset:0   lds
 buffer_load_dwordx4 v13, s[48:51], s22 offen offset:1024   lds
 buffer_load_dwordx4 v14, s[48:51], s22 offen offset:2048   lds
 buffer_load_dwordx4 v15, s[48:51], s22 offen offset:3072   lds
 s_add_u32 s22, s22, 2097152
 s_add_u32 m0, s23, 16384
 s_nop 0
 buffer_load_dwordx4 v8, s[16:19], s21 offen offset:0  nt lds
 buffer_load_dwordx4 v9, s[16:19], s21 offen offset:1024  nt lds
 buffer_load_dwordx4 v10, s[16:19], s21 offen offset:2048  nt lds
 buffer_load_dwordx4 v11, s[16:19], s21 offen offset:3072  nt lds
 s_add_u32 s21, s21, 524160
 s_lshl2_add_u32 s40, s2, s20
 s_lshr_b32 s46, s40, 7
 s_lshl_b32 s46, s46, 1
 s_and_b32 s47, s40, 1
 s_add_u32 s46, s46, s47
 s_lshl_b32 s46, s46, 6
 s_bfe_u32 s47, s40, 0x60001
 s_add_u32 s46, s46, s47
 s_lshl_b32 s46, s46, 7
 s_add_u32 s46, s46, 239075328
 s_add_u32 s46, s46, s6
 s_addc_u32 s47, s7, 0
 s_load_dword s43, s[46:47], 0
 v_lshrrev_b32 v26, 2, v24
 v_and_b32 v28, 1, v25
 v_lshl_or_b32 v28, v28, 2, v26
 v_lshl_add_u32 v29, v25, 3, v26
 v_lshlrev_b32 v29, 8, v29
 v_and_b32 v30, 3, v0
 v_lshl_add_u32 v29, v30, 3, v29
 s_lshl_b32 s64, s65, 2
 s_add_u32 s64, s64, 0
 v_xor_b32 v30, s64, v28
 v_lshl_add_u32 v1, v30, 5, v29
 s_lshl_b32 s64, s65, 2
 s_add_u32 s64, s64, 1
 v_xor_b32 v30, s64, v28
 v_lshl_add_u32 v2, v30, 5, v29
 s_lshl_b32 s64, s65, 2
 s_add_u32 s64, s64, 2
 v_xor_b32 v30, s64, v28
 v_lshl_add_u32 v3, v30, 5, v29
 s_lshl_b32 s64, s65, 2
 s_add_u32 s64, s64, 3
 v_xor_b32 v30, s64, v28
 v_lshl_add_u32 v4, v30, 5, v29
 v_add_u32 v28, 0, v25
 v_lshrrev_b32 v29, 1, v24
 v_xor_b32 v28, v28, v29
 v_lshlrev_b32 v28, 4, v28
 v_lshl_add_u32 v28, v24, 7, v28
 s_lshl_b32 s64, s66, 13
 s_add_u32 s64, s64, 65536
 v_add_u32 v5, s64, v28
 v_add_u32 v28, 4, v25
 v_lshrrev_b32 v29, 1, v24
 v_xor_b32 v28, v28, v29
 v_lshlrev_b32 v28, 4, v28
 v_lshl_add_u32 v28, v24, 7, v28
 s_lshl_b32 s64, s66, 13
 s_add_u32 s64, s64, 65536
 v_add_u32 v6, s64, v28
 s_lshl_b32 s64, s2, 2
 s_add_u32 s64, s64, s20
 s_lshl_b32 s64, s64, 12
 v_lshrrev_b32 v28, 2, v0
 v_and_b32 v29, 3, v0
 v_lshlrev_b32 v29, 7, v29
 v_lshl_add_u32 v28, v28, 11, v29
 v_add_u32 v24, s64, v28
 v_and_b32 v28, 56, v0
 v_lshl_add_u32 v24, v28, 24, v24
 s_mov_b32 s32, s82
 s_and_b32 s33, s83, 0xffff
 s_mov_b32 s34, 4194304
 s_mov_b32 s35, 0x20000
 s_mov_b32 s56, s80
 s_and_b32 s57, s81, 0xffff
 s_mov_b32 s58, 1835008
 s_mov_b32 s59, 0x20000
 s_mov_b32 s60, s92
 s_and_b32 s61, s93, 0xffff
 s_mov_b32 s62, 896
 s_mov_b32 s63, 0x20000
 s_mov_b32 s68, s30
 s_and_b32 s69, s31, 0xffff
 s_mov_b32 s70, 896
 s_mov_b32 s71, 0x20000
 s_mov_b32 s8, s6
 s_and_b32 s9, s7, 0xffff
 s_mov_b32 s10, 268435456
 s_mov_b32 s11, 0x20000
 s_mov_b32 s12, s4
 s_and_b32 s13, s5, 0xffff
 s_mov_b32 s14, 256
 s_mov_b32 s15, 0x20000
 s_add_u32 s72, s84, s74
 s_addc_u32 s73, s85, 0
 s_sub_u32 s75, 3670016, s74
 s_mov_b32 s52, s72
 s_and_b32 s53, s73, 0xffff
 s_mov_b32 s54, s75
 s_mov_b32 s55, 0x20000
 s_mov_b32 s5, 0x3db8aa3b
 s_mov_b32 s28, 0
 s_mul_i32 s29, s42, 114688
 s_lshl_b32 s72, s45, 25
 s_and_b32 s27, s41, 7
 s_lshr_b32 s73, s41, 3
 s_lshl1_add_u32 s27, s27, s73
 s_lshl_b32 s73, s27, 21
 s_add_u32 s72, s72, s73
 s_bfe_u32 s64, s42, 0x20001
 s_lshl_b32 s64, s64, 16
 s_add_u32 s72, s72, s64
 s_lshl_b32 s64, s66, 18
 s_add_u32 s72, s72, s64
 s_and_b32 s67, s42, 1
 s_cmp_eq_u32 s45, 0
 s_cselect_b32 s64, 12, 15
 s_cselect_b32 s75, 15, 10
 s_lshl_b32 s67, s67, s75
 s_add_u32 s72, s72, s67
 s_lshl_b32 s64, s65, s64
 s_add_u32 s93, s72, s64
 s_load_dwordx4 s[80:83], s[0:1], 64
 s_load_dwordx2 s[84:85], s[0:1], 80
 s_load_dwordx2 s[96:97], s[0:1], 96
 s_cmp_lt_u32 s42, 8
 s_cbranch_scc0 L_kv1
L_kv0:
 s_lshl_b32 s64, s42, 4
 s_add_u32 s64, s64, s41
 s_lshl_b32 s64, s64, 2
 s_add_u32 s64, s64, s20
 s_cmp_lt_u32 s64, 41
 s_cselect_b32 s39, 0, 536870912
 s_min_u32 s64, s64, 41
 s_lshl_b32 s38, s64, 2
 s_max_u32 s67, s64, 8
 s_sub_u32 s67, s67, 8
 s_mul_i32 s67, s67, 15488
 s_lshl_b32 s64, s64, 10
 s_add_u32 s64, s64, s67
 s_add_u32 s73, s64, 234938368
 v_or_b32 v64, s39, v7
 v_mov_b32 v68, 0
 v_mov_b32 v69, 0
 v_mov_b32 v70, 0
 v_mov_b32 v71, 0
 s_lshl_b32 s30, s41, 3
 s_add_u32 s30, s30, s42
 s_lshl_b32 s64, s30, 2
 s_add_u32 s64, s64, s20
 s_mul_i32 s72, s64, 3584
 v_mov_b32 v32, 536870912
 v_cmp_gt_u32 vcc, 56, v0
 s_lshl_b32 s67, s64, 2
 s_nop 0
 v_cndmask_b32 v32, v32, v7, vcc
 buffer_load_dwordx4 v[40:43], v32, s[56:59], s72 offen offset:0
 buffer_load_dwordx4 v[44:47], v32, s[56:59], s72 offen offset:896
 buffer_load_dwordx4 v[48:51], v32, s[56:59], s72 offen offset:1792
 buffer_load_dwordx4 v[52:55], v32, s[56:59], s72 offen offset:2688
 buffer_load_dwordx4 v[56:59], v32, s[60:63], 0 offen
 buffer_load_dwordx4 v[60:63], v32, s[68:71], 0 offen
 buffer_store_dwordx4 v[68:71], v64, s[8:11], s73 offen offset:0 sc1
 buffer_store_dwordx4 v[68:71], v64, s[8:11], s73 offen offset:1024 sc1
 buffer_store_dwordx4 v[68:71], v64, s[8:11], s73 offen offset:2048 sc1
 s_add_u32 s73, s73, 8192
 buffer_store_dwordx4 v[68:71], v64, s[8:11], s73 offen offset:0 sc1
 buffer_store_dwordx4 v[68:71], v64, s[8:11], s73 offen offset:1024 sc1
 buffer_store_dwordx4 v[68:71], v64, s[8:11], s73 offen offset:2048 sc1
 s_waitcnt vmcnt(16) lgkmcnt(0)
 s_barrier
 ds_read_b128 a[160:163], v5 offset:0
 ds_read_b128 a[164:167], v6 offset:0
 ds_read_b64_tr_b16 a[32:33], v1 offset:0
 ds_read_b64_tr_b16 a[34:35], v1 offset:1024
 ds_read_b64_tr_b16 a[36:37], v1 offset:8192
 ds_read_b64_tr_b16 a[38:39], v1 offset:9216
 ds_read_b64_tr_b16 a[40:41], v2 offset:0
 ds_read_b64_tr_b16 a[42:43], v2 offset:1024
 ds_read_b64_tr_b16 a[44:45], v2 offset:8192
 ds_read_b64_tr_b16 a[46:47], v2 offset:9216
 ds_read_b128 a[168:171], v5 offset:2048
 ds_read_b128 a[172:175], v6 offset:2048
 ds_read_b64_tr_b16 a[48:49], v3 offset:0
 ds_read_b64_tr_b16 a[50:51], v3 offset:1024
 ds_read_b64_tr_b16 a[52:53], v3 offset:8192
 ds_read_b64_tr_b16 a[54:55], v3 offset:9216
 ds_read_b64_tr_b16 a[56:57], v4 offset:0
 ds_read_b64_tr_b16 a[58:59], v4 offset:1024
 ds_read_b64_tr_b16 a[60:61], v4 offset:8192
 ds_read_b64_tr_b16 a[62:63], v4 offset:9216
 ds_read_b128 a[176:179], v5 offset:4096
 ds_read_b128 a[180:183], v6 offset:4096
 ds_read_b128 a[184:187], v5 offset:6144
 ds_read_b128 a[188:191], v6 offset:6144
 s_add_u32 m0, s24, 16384
 s_nop 0
 buffer_load_dwordx4 v12, s[48:51], s22 offen offset:0   lds
 buffer_load_dwordx4 v13, s[48:51], s22 offen offset:1024   lds
 buffer_load_dwordx4 v14, s[48:51], s22 offen offset:2048   lds
 buffer_load_dwordx4 v15, s[48:51], s22 offen offset:3072   lds
 s_sub_u32 s22, s22, 2097024
 s_add_u32 m0, s23, 32768
 s_nop 0
 buffer_load_dwordx4 v8, s[16:19], s21 offen offset:0  nt lds
 buffer_load_dwordx4 v9, s[16:19], s21 offen offset:1024  nt lds
 buffer_load_dwordx4 v10, s[16:19], s21 offen offset:2048  nt lds
 buffer_load_dwordx4 v11, s[16:19], s21 offen offset:3072  nt lds
 s_add_u32 s21, s21, 128
 v_mov_b32 v72, 0
 v_mov_b32 v73, 0
 v_mov_b32 v74, 0
 v_mov_b32 v75, 0
 v_mov_b32 v76, 0
 v_mov_b32 v77, 0
 v_mov_b32 v78, 0
 v_mov_b32 v79, 0
 s_waitcnt vmcnt(15)
 v_dot2c_f32_bf16 v72, v40, v56
 v_dot2c_f32_bf16 v73, v44, v56
 v_dot2c_f32_bf16 v74, v48, v56
 v_dot2c_f32_bf16 v75, v52, v56
 s_waitcnt vmcnt(14)
 v_dot2c_f32_bf16 v76, v40, v60
 v_dot2c_f32_bf16 v77, v44, v60
 v_dot2c_f32_bf16 v78, v48, v60
 v_dot2c_f32_bf16 v79, v52, v60
 v_dot2c_f32_bf16 v72, v41, v57
 v_dot2c_f32_bf16 v73, v45, v57
 v_dot2c_f32_bf16 v74, v49, v57
 v_dot2c_f32_bf16 v75, v53, v57
 v_dot2c_f32_bf16 v76, v41, v61
 v_dot2c_f32_bf16 v77, v45, v61
 v_dot2c_f32_bf16 v78, v49, v61
 v_dot2c_f32_bf16 v79, v53, v61
 v_dot2c_f32_bf16 v72, v42, v58
 v_dot2c_f32_bf16 v73, v46, v58
 v_dot2c_f32_bf16 v74, v50, v58
 v_dot2c_f32_bf16 v75, v54, v58
 v_dot2c_f32_bf16 v76, v42, v62
 v_dot2c_f32_bf16 v77, v46, v62
 v_dot2c_f32_bf16 v78, v50, v62
 v_dot2c_f32_bf16 v79, v54, v62
 v_dot2c_f32_bf16 v72, v43, v59
 v_dot2c_f32_bf16 v73, v47, v59
 v_dot2c_f32_bf16 v74, v51, v59
 v_dot2c_f32_bf16 v75, v55, v59
 v_dot2c_f32_bf16 v76, v43, v63
 v_dot2c_f32_bf16 v77, v47, v63
 v_dot2c_f32_bf16 v78, v51, v63
 v_dot2c_f32_bf16 v79, v55, v63
 v_permlane32_swap_b32 v72, v74
 v_permlane32_swap_b32 v73, v75
 v_permlane32_swap_b32 v76, v78
 v_permlane32_swap_b32 v77, v79
 v_add_f32 v72, v72, v74
 v_add_f32 v73, v73, v75
 v_add_f32 v76, v76, v78
 v_add_f32 v77, v77, v79
 v_lshrrev_b32 v80, 4, v0
 v_permlane16_swap_b32 v72, v73
 v_permlane16_swap_b32 v76, v77
 v_add_f32 v72, v72, v73
 v_add_f32 v76, v76, v77
 v_add_u32 v81, s67, v80
 v_add_f32 v72, v72, v72 row_ror:8 row_mask:0xf bank_mask:0xf
 v_add_f32 v76, v76, v76 row_ror:8 row_mask:0xf bank_mask:0xf
 s_nop 0
 v_add_f32 v72, v72, v72 row_ror:4 row_mask:0xf bank_mask:0xf
 v_add_f32 v76, v76, v76 row_ror:4 row_mask:0xf bank_mask:0xf
 s_nop 0
 v_add_f32 v72, v72, v72 row_ror:2 row_mask:0xf bank_mask:0xf
 v_add_f32 v76, v76, v76 row_ror:2 row_mask:0xf bank_mask:0xf
 s_nop 0
 v_add_f32 v72, v72, v72 row_ror:1 row_mask:0xf bank_mask:0xf
 v_add_f32 v76, v76, v76 row_ror:1 row_mask:0xf bank_mask:0xf
 v_ashrrev_i32 v82, 31, v72
 v_or_b32 v82, 0x80000000, v82
 v_xor_b32 v82, v82, v72
 v_and_b32 v82, 0xfffff800, v82
 v_sub_u32 v81, 2047, v81
 v_or_b32 v82, v82, v81
 v_max_u32 v82, 1, v82
 v_mul_f32 v77, 0xbfb8aa3b, v76
 v_exp_f32 v77, v77
 s_nop 0
 v_add_f32 v77, 1.0, v77
 v_rcp_f32 v76, v77
 s_lshl_b32 s72, s20, 4
 s_add_u32 s72, s72, 163584
 v_lshl_add_u32 v80, v80, 2, s72
 ds_write_b32 v80, v82
 ds_write_b32 v80, v72 offset:64
 ds_write_b32 v80, v76 offset:128
 s_waitcnt lgkmcnt(15)
M a[0:3], a[160:163], a[32:35], 0
M a[0:3], a[164:167], a[36:39], a[0:3]
M a[4:7], a[164:167], a[44:47], 0
M a[4:7], a[160:163], a[40:43], a[4:7]
 s_waitcnt lgkmcnt(11)
M a[8:11], a[160:163], a[48:51], 0
M a[8:11], a[164:167], a[52:55], a[8:11]
 s_waitcnt lgkmcnt(7)
M a[12:15], a[164:167], a[60:63], 0
 s_add_u32 m0, s23, 49152
M a[12:15], a[160:163], a[56:59], a[12:15]
 buffer_load_dwordx4 v8, s[16:19], s21 offen offset:0  nt lds
M v[32:35], a[168:171], a[32:35], 0
 buffer_load_dwordx4 v9, s[16:19], s21 offen offset:1024  nt lds
M v[32:35], a[172:175], a[36:39], v[32:35]
M v[36:39], a[172:175], a[44:47], 0
 buffer_load_dwordx4 v10, s[16:19], s21 offen offset:2048  nt lds
M v[36:39], a[168:171], a[40:43], v[36:39]
M v[40:43], a[168:171], a[48:51], 0
 buffer_load_dwordx4 v11, s[16:19], s21 offen offset:3072  nt lds
M v[40:43], a[172:175], a[52:55], v[40:43]
 s_add_u32 s21, s21, 524160
M v[44:47], a[172:175], a[60:63], 0
 s_waitcnt lgkmcnt(0)
M v[44:47], a[168:171], a[56:59], v[44:47]
 s_barrier
M v[64:67], a[176:179], a[32:35], 0
 s_add_u32 m0, s24, 32768
 ds_read_b64_tr_b16 a[64:65], v1 offset:16384
 ds_read_b64_tr_b16 a[66:67], v1 offset:17408
M v[64:67], a[180:183], a[36:39], v[64:67]
 ds_read_b64_tr_b16 a[68:69], v1 offset:24576
 ds_read_b64_tr_b16 a[70:71], v1 offset:25600
M v[68:71], a[180:183], a[44:47], 0
 buffer_load_dwordx4 v12, s[48:51], s22 offen offset:0   lds
M v[68:71], a[176:179], a[40:43], v[68:71]
 ds_read_b64_tr_b16 a[72:73], v2 offset:16384
 ds_read_b64_tr_b16 a[74:75], v2 offset:17408
M v[72:75], a[176:179], a[48:51], 0
 ds_read_b64_tr_b16 a[76:77], v2 offset:24576
 ds_read_b64_tr_b16 a[78:79], v2 offset:25600
M v[72:75], a[180:183], a[52:55], v[72:75]
 buffer_load_dwordx4 v13, s[48:51], s22 offen offset:1024   lds
M v[76:79], a[180:183], a[60:63], 0
 ds_read_b64_tr_b16 a[80:81], v3 offset:16384
 ds_read_b64_tr_b16 a[82:83], v3 offset:17408
M v[76:79], a[176:179], a[56:59], v[76:79]
 ds_read_b64_tr_b16 a[84:85], v3 offset:24576
 ds_read_b64_tr_b16 a[86:87], v3 offset:25600
M v[96:99], a[184:187], a[32:35], 0
 buffer_load_dwordx4 v14, s[48:51], s22 offen offset:2048   lds
M v[96:99], a[188:191], a[36:39], v[96:99]
 ds_read_b64_tr_b16 a[88:89], v4 offset:16384
 ds_read_b64_tr_b16 a[90:91], v4 offset:17408
M v[100:103], a[188:191], a[44:47], 0
 ds_read_b64_tr_b16 a[92:93], v4 offset:24576
 ds_read_b64_tr_b16 a[94:95], v4 offset:25600
M v[100:103], a[184:187], a[40:43], v[100:103]
 buffer_load_dwordx4 v15, s[48:51], s22 offen offset:3072   lds
M v[104:107], a[184:187], a[48:51], 0
 s_add_u32 s22, s22, 2097152
 v_max3_f32 v20, |v32|, |v33|, |v34|
 v_max3_f32 v20, |v35|, |v36|, v20
M v[104:107], a[188:191], a[52:55], v[104:107]
 v_max3_f32 v20, |v37|, |v38|, v20
 v_max3_f32 v21, |v64|, |v65|, |v66|
M v[108:111], a[188:191], a[60:63], 0
 s_add_u32 m0, s23, 0
 v_max3_f32 v21, |v67|, |v68|, v21
 v_max3_f32 v21, |v69|, |v70|, v21
M v[108:111], a[184:187], a[56:59], v[108:111]
 s_waitcnt lgkmcnt(0)
 v_min_f32 v20, v20, v21
 v_mul_f32 v20, 0x41000000, v20
M a[16:19], a[160:163], a[64:67], 0
 buffer_load_dwordx4 v8, s[16:19], s21 offen offset:0  nt lds
M a[16:19], a[164:167], a[68:71], a[16:19]
 v_mov_b32 v21, v20
 v_mov_b32 v22, v20
M a[20:23], a[164:167], a[76:79], 0
 buffer_load_dwordx4 v9, s[16:19], s21 offen offset:1024  nt lds
M a[20:23], a[160:163], a[72:75], a[20:23]
 v_mov_b32 v23, v20
 v_accvgpr_write_b32 a241, v20
M a[24:27], a[160:163], a[80:83], 0
M a[24:27], a[164:167], a[84:87], a[24:27]
M a[28:31], a[164:167], a[92:95], 0
 buffer_load_dwordx4 v10, s[16:19], s21 offen offset:2048  nt lds
M a[28:31], a[160:163], a[88:91], a[28:31]
M v[48:51], a[168:171], a[64:67], v[20:23]
M v[48:51], a[172:175], a[68:71], v[48:51]
 buffer_load_dwordx4 v11, s[16:19], s21 offen offset:3072  nt lds
M v[52:55], a[172:175], a[76:79], v[20:23]
 s_add_u32 s21, s21, 128
M v[52:55], a[168:171], a[72:75], v[52:55]
M v[56:59], a[168:171], a[80:83], v[20:23]
M v[56:59], a[172:175], a[84:87], v[56:59]
M v[60:63], a[172:175], a[92:95], v[20:23]
 s_waitcnt vmcnt(12)
M v[60:63], a[168:171], a[88:91], v[60:63]
 s_barrier
M v[80:83], a[176:179], a[64:67], v[20:23]
 s_add_u32 m0, s24, 49152
 ds_read_b128 a[160:163], v5 offset:16384
 ds_read_b128 a[164:167], v6 offset:16384
M v[80:83], a[180:183], a[68:71], v[80:83]
 buffer_load_dwordx4 v12, s[48:51], s22 offen offset:0   lds
M v[84:87], a[180:183], a[76:79], v[20:23]
 ds_read_b64_tr_b16 a[96:97], v1 offset:32768
 ds_read_b64_tr_b16 a[98:99], v1 offset:33792
M v[84:87], a[176:179], a[72:75], v[84:87]
M v[88:91], a[176:179], a[80:83], v[20:23]
 buffer_load_dwordx4 v13, s[48:51], s22 offen offset:1024   lds
M v[88:91], a[180:183], a[84:87], v[88:91]
 ds_read_b64_tr_b16 a[100:101], v1 offset:40960
 ds_read_b64_tr_b16 a[102:103], v1 offset:41984
M v[92:95], a[180:183], a[92:95], v[20:23]
M v[92:95], a[176:179], a[88:91], v[92:95]
M v[112:115], a[184:187], a[64:67], v[20:23]
 ds_read_b64_tr_b16 a[104:105], v2 offset:32768
 ds_read_b64_tr_b16 a[106:107], v2 offset:33792
M v[112:115], a[188:191], a[68:71], v[112:115]
 buffer_load_dwordx4 v14, s[48:51], s22 offen offset:2048   lds
M v[116:119], a[188:191], a[76:79], v[20:23]
M v[116:119], a[184:187], a[72:75], v[116:119]
 ds_read_b64_tr_b16 a[108:109], v2 offset:40960
 ds_read_b64_tr_b16 a[110:111], v2 offset:41984
M v[120:123], a[184:187], a[80:83], v[20:23]
 buffer_load_dwordx4 v15, s[48:51], s22 offen offset:3072   lds
M v[120:123], a[188:191], a[84:87], v[120:123]
 s_waitcnt lgkmcnt(8)
M v[124:127], a[188:191], a[92:95], v[20:23]
 s_sub_u32 s22, s22, 2097024
M v[124:127], a[184:187], a[88:91], v[124:127]
 s_add_u32 m0, s23, 16384
 ds_read_b64_tr_b16 a[112:113], v3 offset:32768
 ds_read_b64_tr_b16 a[114:115], v3 offset:33792
M v[128:131], a[160:163], a[32:35], v[20:23]
 ds_read_b128 a[168:171], v5 offset:18432
 ds_read_b128 a[172:175], v6 offset:18432
M v[128:131], a[164:167], a[36:39], v[128:131]
 buffer_load_dwordx4 v8, s[16:19], s21 offen offset:0  nt lds
M v[132:135], a[164:167], a[44:47], v[20:23]
 ds_read_b64_tr_b16 a[116:117], v3 offset:40960
 ds_read_b64_tr_b16 a[118:119], v3 offset:41984
M v[132:135], a[160:163], a[40:43], v[132:135]
 buffer_load_dwordx4 v9, s[16:19], s21 offen offset:1024  nt lds
M v[136:139], a[160:163], a[48:51], v[20:23]
M v[136:139], a[164:167], a[52:55], v[136:139]
 ds_read_b64_tr_b16 a[120:121], v4 offset:32768
 ds_read_b64_tr_b16 a[122:123], v4 offset:33792
M v[140:143], a[164:167], a[60:63], v[20:23]
 buffer_load_dwordx4 v10, s[16:19], s21 offen offset:2048  nt lds
M v[140:143], a[160:163], a[56:59], v[140:143]
M v[144:147], a[160:163], a[64:67], v[20:23]
 ds_read_b64_tr_b16 a[124:125], v4 offset:40960
 ds_read_b64_tr_b16 a[126:127], v4 offset:41984
M v[144:147], a[164:167], a[68:71], v[144:147]
 buffer_load_dwordx4 v11, s[16:19], s21 offen offset:3072  nt lds
M v[148:151], a[164:167], a[76:79], v[20:23]
 s_add_u32 s21, s21, 524160
M v[148:151], a[160:163], a[72:75], v[148:151]
M v[152:155], a[160:163], a[80:83], v[20:23]
M v[152:155], a[164:167], a[84:87], v[152:155]
 s_waitcnt lgkmcnt(6)
M v[156:159], a[164:167], a[92:95], v[20:23]
 s_waitcnt vmcnt(16) lgkmcnt(0)
M v[156:159], a[160:163], a[88:91], v[156:159]
 s_barrier
M v[160:163], a[168:171], a[32:35], v[20:23]
 s_add_u32 m0, s24, 0
 ds_read_b128 a[160:163], v5 offset:20480
 ds_read_b128 a[164:167], v6 offset:20480
M v[160:163], a[172:175], a[36:39], v[160:163]
 buffer_load_dwordx4 v12, s[48:51], s22 offen offset:0   lds
M v[164:167], a[172:175], a[44:47], v[20:23]
 ds_read_b64_tr_b16 a[128:129], v1 offset:49152
 ds_read_b64_tr_b16 a[130:131], v1 offset:50176
M v[164:167], a[168:171], a[40:43], v[164:167]
M v[168:171], a[168:171], a[48:51], v[20:23]
 buffer_load_dwordx4 v13, s[48:51], s22 offen offset:1024   lds
M v[168:171], a[172:175], a[52:55], v[168:171]
 ds_read_b64_tr_b16 a[132:133], v1 offset:57344
 ds_read_b64_tr_b16 a[134:135], v1 offset:58368
M v[172:175], a[172:175], a[60:63], v[20:23]
M v[172:175], a[168:171], a[56:59], v[172:175]
M v[176:179], a[168:171], a[64:67], v[20:23]
 ds_read_b64_tr_b16 a[136:137], v2 offset:49152
 ds_read_b64_tr_b16 a[138:139], v2 offset:50176
M v[176:179], a[172:175], a[68:71], v[176:179]
 buffer_load_dwordx4 v14, s[48:51], s22 offen offset:2048   lds
M v[180:183], a[172:175], a[76:79], v[20:23]
M v[180:183], a[168:171], a[72:75], v[180:183]
 ds_read_b64_tr_b16 a[140:141], v2 offset:57344
 ds_read_b64_tr_b16 a[142:143], v2 offset:58368
M v[184:187], a[168:171], a[80:83], v[20:23]
 buffer_load_dwordx4 v15, s[48:51], s22 offen offset:3072   lds
M v[184:187], a[172:175], a[84:87], v[184:187]
 s_waitcnt lgkmcnt(8)
M v[188:191], a[172:175], a[92:95], v[20:23]
 s_add_u32 s22, s22, 2097152
M v[188:191], a[168:171], a[88:91], v[188:191]
 s_add_u32 m0, s23, 32768
 ds_read_b64_tr_b16 a[144:145], v3 offset:49152
 ds_read_b64_tr_b16 a[146:147], v3 offset:50176
M v[192:195], a[160:163], a[32:35], v[20:23]
 ds_read_b128 a[168:171], v5 offset:22528
 ds_read_b128 a[172:175], v6 offset:22528
M v[192:195], a[164:167], a[36:39], v[192:195]
 buffer_load_dwordx4 v8, s[16:19], s21 offen offset:0  nt lds
M v[196:199], a[164:167], a[44:47], v[20:23]
 ds_read_b64_tr_b16 a[148:149], v3 offset:57344
 ds_read_b64_tr_b16 a[150:151], v3 offset:58368
M v[196:199], a[160:163], a[40:43], v[196:199]
 buffer_load_dwordx4 v9, s[16:19], s21 offen offset:1024  nt lds
M v[200:203], a[160:163], a[48:51], v[20:23]
M v[200:203], a[164:167], a[52:55], v[200:203]
 ds_read_b64_tr_b16 a[152:153], v4 offset:49152
 ds_read_b64_tr_b16 a[154:155], v4 offset:50176
M v[204:207], a[164:167], a[60:63], v[20:23]
 buffer_load_dwordx4 v10, s[16:19], s21 offen offset:2048  nt lds
M v[204:207], a[160:163], a[56:59], v[204:207]
M v[208:211], a[160:163], a[64:67], v[20:23]
 ds_read_b64_tr_b16 a[156:157], v4 offset:57344
 ds_read_b64_tr_b16 a[158:159], v4 offset:58368
M v[208:211], a[164:167], a[68:71], v[208:211]
 buffer_load_dwordx4 v11, s[16:19], s21 offen offset:3072  nt lds
M v[212:215], a[164:167], a[76:79], v[20:23]
 s_add_u32 s21, s21, 128
M v[212:215], a[160:163], a[72:75], v[212:215]
M v[216:219], a[160:163], a[80:83], v[20:23]
M v[216:219], a[164:167], a[84:87], v[216:219]
 s_waitcnt lgkmcnt(6)
M v[220:223], a[164:167], a[92:95], v[20:23]
 s_waitcnt vmcnt(16) lgkmcnt(0)
M v[220:223], a[160:163], a[88:91], v[220:223]
 s_barrier
M v[224:227], a[168:171], a[32:35], v[20:23]
 ds_read_b128 a[160:163], v5 offset:32768
 ds_read_b128 a[164:167], v6 offset:32768
M v[224:227], a[172:175], a[36:39], v[224:227]
 buffer_load_dword a240, v24, s[32:35], 0 offen offset:512
M v[228:231], a[172:175], a[44:47], v[20:23]
M v[228:231], a[168:171], a[40:43], v[228:231]
M v[232:235], a[168:171], a[48:51], v[20:23]
M v[232:235], a[172:175], a[52:55], v[232:235]
M v[236:239], a[172:175], a[60:63], v[20:23]
M v[236:239], a[168:171], a[56:59], v[236:239]
M v[240:243], a[168:171], a[64:67], v[20:23]
M v[240:243], a[172:175], a[68:71], v[240:243]
M v[244:247], a[172:175], a[76:79], v[20:23]
M v[244:247], a[168:171], a[72:75], v[244:247]
M v[248:251], a[168:171], a[80:83], v[20:23]
M v[248:251], a[172:175], a[84:87], v[248:251]
 s_waitcnt lgkmcnt(0)
M v[252:255], a[172:175], a[92:95], v[20:23]
M v[252:255], a[168:171], a[88:91], v[252:255]
M a[0:3], a[160:163], a[96:99], a[0:3]
 ds_read_b128 a[168:171], v5 offset:34816
 ds_read_b128 a[172:175], v6 offset:34816
M a[0:3], a[164:167], a[100:103], a[0:3]
 ds_read_b64_tr_b16 a[32:33], v1 offset:0
 ds_read_b64_tr_b16 a[34:35], v1 offset:1024
M a[4:7], a[164:167], a[108:111], a[4:7]
 s_add_u32 m0, s24, 16384
M a[4:7], a[160:163], a[104:107], a[4:7]
 buffer_load_dwordx4 v12, s[48:51], s22 offen offset:0   lds
M a[8:11], a[160:163], a[112:115], a[8:11]
M a[8:11], a[164:167], a[116:119], a[8:11]
M a[12:15], a[164:167], a[124:127], a[12:15]
 ds_read_b64_tr_b16 a[36:37], v1 offset:8192
 ds_read_b64_tr_b16 a[38:39], v1 offset:9216
M a[12:15], a[160:163], a[120:123], a[12:15]
M a[16:19], a[160:163], a[128:131], a[16:19]
 buffer_load_dwordx4 v13, s[48:51], s22 offen offset:1024   lds
M a[16:19], a[164:167], a[132:135], a[16:19]
M a[20:23], a[164:167], a[140:143], a[20:23]
M a[20:23], a[160:163], a[136:139], a[20:23]
 ds_read_b64_tr_b16 a[40:41], v2 offset:0
 ds_read_b64_tr_b16 a[42:43], v2 offset:1024
M a[24:27], a[160:163], a[144:147], a[24:27]
M a[24:27], a[164:167], a[148:151], a[24:27]
 s_waitcnt lgkmcnt(6)
M a[28:31], a[164:167], a[156:159], a[28:31]
 buffer_load_dwordx4 v14, s[48:51], s22 offen offset:2048   lds
M a[28:31], a[160:163], a[152:155], a[28:31]
M v[60:63], a[168:171], a[152:155], v[60:63]
 ds_read_b128 a[160:163], v5 offset:36864
 ds_read_b128 a[164:167], v6 offset:36864
M v[60:63], a[172:175], a[156:159], v[60:63]
 ds_read_b64_tr_b16 a[44:45], v2 offset:8192
 ds_read_b64_tr_b16 a[46:47], v2 offset:9216
M v[56:59], a[172:175], a[148:151], v[56:59]
 buffer_load_dwordx4 v15, s[48:51], s22 offen offset:3072   lds
M v[56:59], a[168:171], a[144:147], v[56:59]
 s_sub_u32 s22, s22, 2097024
M v[52:55], a[168:171], a[136:139], v[52:55]
M v[52:55], a[172:175], a[140:143], v[52:55]
 ds_read_b64_tr_b16 a[48:49], v3 offset:0
 ds_read_b64_tr_b16 a[50:51], v3 offset:1024
M v[48:51], a[172:175], a[132:135], v[48:51]
 s_add_u32 m0, s23, 49152
M v[48:51], a[168:171], a[128:131], v[48:51]
 buffer_load_dwordx4 v8, s[16:19], s21 offen offset:0  nt lds
M v[44:47], a[168:171], a[120:123], v[44:47]
M v[44:47], a[172:175], a[124:127], v[44:47]
M v[40:43], a[172:175], a[116:119], v[40:43]
 ds_read_b64_tr_b16 a[52:53], v3 offset:8192
 ds_read_b64_tr_b16 a[54:55], v3 offset:9216
M v[40:43], a[168:171], a[112:115], v[40:43]
M v[36:39], a[168:171], a[104:107], v[36:39]
 buffer_load_dwordx4 v9, s[16:19], s21 offen offset:1024  nt lds
M v[36:39], a[172:175], a[108:111], v[36:39]
 s_waitcnt lgkmcnt(6)
M v[32:35], a[172:175], a[100:103], v[32:35]
M v[32:35], a[168:171], a[96:99], v[32:35]
 ds_read_b64_tr_b16 a[56:57], v4 offset:0
 ds_read_b64_tr_b16 a[58:59], v4 offset:1024
M v[64:67], a[160:163], a[96:99], v[64:67]
 ds_read_b128 a[168:171], v5 offset:38912
 ds_read_b128 a[172:175], v6 offset:38912
M v[64:67], a[164:167], a[100:103], v[64:67]
 buffer_load_dwordx4 v10, s[16:19], s21 offen offset:2048  nt lds
M v[68:71], a[164:167], a[108:111], v[68:71]
M v[68:71], a[160:163], a[104:107], v[68:71]
M v[72:75], a[160:163], a[112:115], v[72:75]
 ds_read_b64_tr_b16 a[60:61], v4 offset:8192
 ds_read_b64_tr_b16 a[62:63], v4 offset:9216
M v[72:75], a[164:167], a[116:119], v[72:75]
M v[76:79], a[164:167], a[124:127], v[76:79]
 buffer_load_dwordx4 v11, s[16:19], s21 offen offset:3072  nt lds
M v[76:79], a[160:163], a[120:123], v[76:79]
 s_add_u32 s21, s21, 524160
M v[80:83], a[160:163], a[128:131], v[80:83]
M v[80:83], a[164:167], a[132:135], v[80:83]
M v[84:87], a[164:167], a[140:143], v[84:87]
M v[84:87], a[160:163], a[136:139], v[84:87]
M v[88:91], a[160:163], a[144:147], v[88:91]
M v[88:91], a[164:167], a[148:151], v[88:91]
 s_waitcnt lgkmcnt(2)
M v[92:95], a[164:167], a[156:159], v[92:95]
 s_waitcnt vmcnt(17) lgkmcnt(0)
M v[92:95], a[160:163], a[152:155], v[92:95]
 s_barrier
M v[124:127], a[168:171], a[152:155], v[124:127]
 ds_read_b128 a[160:163], v5 offset:49152
 ds_read_b128 a[164:167], v6 offset:49152
M v[124:127], a[172:175], a[156:159], v[124:127]
M v[120:123], a[172:175], a[148:151], v[120:123]
 s_add_u32 m0, s24, 32768
 ds_read_b64_tr_b16 a[64:65], v1 offset:16384
 ds_read_b64_tr_b16 a[66:67], v1 offset:17408
M v[120:123], a[168:171], a[144:147], v[120:123]
 buffer_load_dwordx4 v12, s[48:51], s22 offen offset:0   lds
M v[116:119], a[168:171], a[136:139], v[116:119]
M v[116:119], a[172:175], a[140:143], v[116:119]
M v[112:115], a[172:175], a[132:135], v[112:115]
M v[112:115], a[168:171], a[128:131], v[112:115]
M v[108:111], a[168:171], a[120:123], v[108:111]
M v[108:111], a[172:175], a[124:127], v[108:111]
 ds_read_b64_tr_b16 a[68:69], v1 offset:24576
 ds_read_b64_tr_b16 a[70:71], v1 offset:25600
M v[104:107], a[172:175], a[116:119], v[104:107]
 buffer_load_dwordx4 v13, s[48:51], s22 offen offset:1024   lds
M v[104:107], a[168:171], a[112:115], v[104:107]
M v[100:103], a[168:171], a[104:107], v[100:103]
M v[100:103], a[172:175], a[108:111], v[100:103]
 s_waitcnt lgkmcnt(4)
M v[96:99], a[172:175], a[100:103], v[96:99]
M v[96:99], a[168:171], a[96:99], v[96:99]
M v[128:131], a[160:163], a[96:99], v[128:131]
 ds_read_b128 a[168:171], v5 offset:51200
 ds_read_b128 a[172:175], v6 offset:51200
M v[128:131], a[164:167], a[100:103], v[128:131]
 ds_read_b64_tr_b16 a[72:73], v2 offset:16384
 ds_read_b64_tr_b16 a[74:75], v2 offset:17408
M v[132:135], a[164:167], a[108:111], v[132:135]
 buffer_load_dwordx4 v14, s[48:51], s22 offen offset:2048   lds
M v[132:135], a[160:163], a[104:107], v[132:135]
M v[136:139], a[160:163], a[112:115], v[136:139]
M v[136:139], a[164:167], a[116:119], v[136:139]
M v[140:143], a[164:167], a[124:127], v[140:143]
M v[140:143], a[160:163], a[120:123], v[140:143]
 ds_read_b64_tr_b16 a[76:77], v2 offset:24576
 ds_read_b64_tr_b16 a[78:79], v2 offset:25600
M v[144:147], a[160:163], a[128:131], v[144:147]
 buffer_load_dwordx4 v15, s[48:51], s22 offen offset:3072   lds
M v[144:147], a[164:167], a[132:135], v[144:147]
 s_add_u32 s22, s22, 2097152
M v[148:151], a[164:167], a[140:143], v[148:151]
M v[148:151], a[160:163], a[136:139], v[148:151]
M v[152:155], a[160:163], a[144:147], v[152:155]
M v[152:155], a[164:167], a[148:151], v[152:155]
 s_waitcnt lgkmcnt(4)
M v[156:159], a[164:167], a[156:159], v[156:159]
 s_add_u32 m0, s23, 0
 ds_read_b64_tr_b16 a[80:81], v3 offset:16384
 ds_read_b64_tr_b16 a[82:83], v3 offset:17408
M v[156:159], a[160:163], a[152:155], v[156:159]
 buffer_load_dwordx4 v8, s[16:19], s21 offen offset:0  nt lds
M v[188:191], a[168:171], a[152:155], v[188:191]
 ds_read_b128 a[160:163], v5 offset:53248
 ds_read_b128 a[164:167], v6 offset:53248
M v[188:191], a[172:175], a[156:159], v[188:191]
M v[184:187], a[172:175], a[148:151], v[184:187]
M v[184:187], a[168:171], a[144:147], v[184:187]
M v[180:183], a[168:171], a[136:139], v[180:183]
M v[180:183], a[172:175], a[140:143], v[180:183]
 ds_read_b64_tr_b16 a[84:85], v3 offset:24576
 ds_read_b64_tr_b16 a[86:87], v3 offset:25600
M v[176:179], a[172:175], a[132:135], v[176:179]
 buffer_load_dwordx4 v9, s[16:19], s21 offen offset:1024  nt lds
M v[176:179], a[168:171], a[128:131], v[176:179]
M v[172:175], a[168:171], a[120:123], v[172:175]
M v[172:175], a[172:175], a[124:127], v[172:175]
M v[168:171], a[172:175], a[116:119], v[168:171]
M v[168:171], a[168:171], a[112:115], v[168:171]
M v[164:167], a[168:171], a[104:107], v[164:167]
 ds_read_b64_tr_b16 a[88:89], v4 offset:16384
 ds_read_b64_tr_b16 a[90:91], v4 offset:17408
M v[164:167], a[172:175], a[108:111], v[164:167]
 s_waitcnt lgkmcnt(4)
M v[160:163], a[172:175], a[100:103], v[160:163]
 buffer_load_dwordx4 v10, s[16:19], s21 offen offset:2048  nt lds
M v[160:163], a[168:171], a[96:99], v[160:163]
M v[192:195], a[160:163], a[96:99], v[192:195]
 ds_read_b128 a[168:171], v5 offset:55296
 ds_read_b128 a[172:175], v6 offset:55296
M v[192:195], a[164:167], a[100:103], v[192:195]
M v[196:199], a[164:167], a[108:111], v[196:199]
M v[196:199], a[160:163], a[104:107], v[196:199]
 ds_read_b64_tr_b16 a[92:93], v4 offset:24576
 ds_read_b64_tr_b16 a[94:95], v4 offset:25600
M v[200:203], a[160:163], a[112:115], v[200:203]
 buffer_load_dwordx4 v11, s[16:19], s21 offen offset:3072  nt lds
M v[200:203], a[164:167], a[116:119], v[200:203]
 s_add_u32 s21, s21, 128
M v[204:207], a[164:167], a[124:127], v[204:207]
M v[204:207], a[160:163], a[120:123], v[204:207]
M v[208:211], a[160:163], a[128:131], v[208:211]
M v[208:211], a[164:167], a[132:135], v[208:211]
M v[212:215], a[164:167], a[140:143], v[212:215]
M v[212:215], a[160:163], a[136:139], v[212:215]
M v[216:219], a[160:163], a[144:147], v[216:219]
M v[216:219], a[164:167], a[148:151], v[216:219]
 s_waitcnt lgkmcnt(2)
M v[220:223], a[164:167], a[156:159], v[220:223]
 s_waitcnt vmcnt(17) lgkmcnt(0)
M v[220:223], a[160:163], a[152:155], v[220:223]
 s_barrier
M v[252:255], a[168:171], a[152:155], v[252:255]
 ds_read_b128 a[160:163], v5 offset:0
 ds_read_b128 a[164:167], v6 offset:0
M v[252:255], a[172:175], a[156:159], v[252:255]
 v_min_u32 v16, 1, v0
 v_lshlrev_b32 v16, 29, v16
M v[248:251], a[172:175], a[148:151], v[248:251]
 v_or_b32 v16, s39, v16
 v_mov_b32 v17, 1
M v[248:251], a[168:171], a[144:147], v[248:251]
M v[244:247], a[168:171], a[136:139], v[244:247]
 buffer_store_dword v17, v16, s[12:15], s38 offen offset:64 sc1
M v[244:247], a[172:175], a[140:143], v[244:247]
M v[240:243], a[172:175], a[132:135], v[240:243]
M v[240:243], a[168:171], a[128:131], v[240:243]
M v[236:239], a[168:171], a[120:123], v[236:239]
M v[236:239], a[172:175], a[124:127], v[236:239]
M v[232:235], a[172:175], a[116:119], v[232:235]
M v[232:235], a[168:171], a[112:115], v[232:235]
M v[228:231], a[168:171], a[104:107], v[228:231]
M v[228:231], a[172:175], a[108:111], v[228:231]
 s_waitcnt lgkmcnt(0)
M v[224:227], a[172:175], a[100:103], v[224:227]
M v[224:227], a[168:171], a[96:99], v[224:227]
M a[0:3], a[160:163], a[32:35], a[0:3]
 ds_read_b128 a[168:171], v5 offset:2048
 ds_read_b128 a[172:175], v6 offset:2048
M a[0:3], a[164:167], a[36:39], a[0:3]
 ds_read_b64_tr_b16 a[96:97], v1 offset:32768
 ds_read_b64_tr_b16 a[98:99], v1 offset:33792
M a[4:7], a[164:167], a[44:47], a[4:7]
 s_add_u32 m0, s24, 49152
M a[4:7], a[160:163], a[40:43], a[4:7]
 buffer_load_dwordx4 v12, s[48:51], s22 offen offset:0   lds
M a[8:11], a[160:163], a[48:51], a[8:11]
 v_and_b32 v20, 31, v0
M a[8:11], a[164:167], a[52:55], a[8:11]
 v_lshlrev_b32 v20, 2, v20
M a[12:15], a[164:167], a[60:63], a[12:15]
 ds_read_b64_tr_b16 a[100:101], v1 offset:40960
 ds_read_b64_tr_b16 a[102:103], v1 offset:41984
M a[12:15], a[160:163], a[56:59], a[12:15]
 v_add_u32 v21, 163584, v20
M a[16:19], a[160:163], a[64:67], a[16:19]
 buffer_load_dwordx4 v13, s[48:51], s22 offen offset:1024   lds
M a[16:19], a[164:167], a[68:71], a[16:19]
 ds_read_b32 v19, v21
M a[20:23], a[164:167], a[76:79], a[20:23]
 ds_read_b32 v21, v21 offset:64
M a[20:23], a[160:163], a[72:75], a[20:23]
 s_min_u32 s64, s20, 1
 ds_read_b64_tr_b16 a[104:105], v2 offset:32768
 ds_read_b64_tr_b16 a[106:107], v2 offset:33792
M a[24:27], a[160:163], a[80:83], a[24:27]
 s_lshl_b32 s64, s64, 29
 v_and_b32 v22, 32, v0
M a[24:27], a[164:167], a[84:87], a[24:27]
 s_waitcnt lgkmcnt(8)
 v_lshl_or_b32 v20, v22, 24, v20
M a[28:31], a[164:167], a[92:95], a[28:31]
 buffer_load_dwordx4 v14, s[48:51], s22 offen offset:2048   lds
M a[28:31], a[160:163], a[88:91], a[28:31]
 v_or_b32 v20, s64, v20
M v[60:63], a[168:171], a[88:91], v[60:63]
 ds_read_b128 a[160:163], v5 offset:4096
 ds_read_b128 a[164:167], v6 offset:4096
M v[60:63], a[172:175], a[92:95], v[60:63]
 ds_read_b64_tr_b16 a[108:109], v2 offset:40960
 ds_read_b64_tr_b16 a[110:111], v2 offset:41984
M v[56:59], a[172:175], a[84:87], v[56:59]
 buffer_load_dwordx4 v15, s[48:51], s22 offen offset:3072   lds
M v[56:59], a[168:171], a[80:83], v[56:59]
 s_sub_u32 s22, s22, 2097024
 v_and_b32 v22, 16, v0
M v[52:55], a[168:171], a[72:75], v[52:55]
 v_lshl_or_b32 v18, v22, 25, v20
M v[52:55], a[172:175], a[76:79], v[52:55]
 s_lshl_b32 s72, s30, 7
 ds_read_b64_tr_b16 a[112:113], v3 offset:32768
 ds_read_b64_tr_b16 a[114:115], v3 offset:33792
M v[48:51], a[172:175], a[68:71], v[48:51]
 s_add_u32 m0, s23, 16384
 s_add_u32 s72, s72, 234881024
M v[48:51], a[168:171], a[64:67], v[48:51]
 buffer_load_dwordx4 v8, s[16:19], s21 offen offset:0  nt lds
M v[44:47], a[168:171], a[56:59], v[44:47]
M v[44:47], a[172:175], a[60:63], v[44:47]
M v[40:43], a[172:175], a[52:55], v[40:43]
 ds_read_b64_tr_b16 a[116:117], v3 offset:40960
 ds_read_b64_tr_b16 a[118:119], v3 offset:41984
M v[40:43], a[168:171], a[48:51], v[40:43]
M v[36:39], a[168:171], a[40:43], v[36:39]
 buffer_load_dwordx4 v9, s[16:19], s21 offen offset:1024  nt lds
M v[36:39], a[172:175], a[44:47], v[36:39]
 s_waitcnt lgkmcnt(6)
M v[32:35], a[172:175], a[36:39], v[32:35]
 buffer_store_dword v21, v20, s[8:11], s72 offen sc1
M v[32:35], a[168:171], a[32:35], v[32:35]
 ds_read_b64_tr_b16 a[120:121], v4 offset:32768
 ds_read_b64_tr_b16 a[122:123], v4 offset:33792
M v[64:67], a[160:163], a[32:35], v[64:67]
 ds_read_b128 a[168:171], v5 offset:6144
 ds_read_b128 a[172:175], v6 offset:6144
M v[64:67], a[164:167], a[36:39], v[64:67]
 buffer_load_dwordx4 v10, s[16:19], s21 offen offset:2048  nt lds
M v[68:71], a[164:167], a[44:47], v[68:71]
M v[68:71], a[160:163], a[40:43], v[68:71]
M v[72:75], a[160:163], a[48:51], v[72:75]
 ds_read_b64_tr_b16 a[124:125], v4 offset:40960
 ds_read_b64_tr_b16 a[126:127], v4 offset:41984
M v[72:75], a[164:167], a[52:55], v[72:75]
M v[76:79], a[164:167], a[60:63], v[76:79]
 buffer_load_dwordx4 v11, s[16:19], s21 offen offset:3072  nt lds
M v[76:79], a[160:163], a[56:59], v[76:79]
 s_add_u32 s21, s21, 524160
M v[80:83], a[160:163], a[64:67], v[80:83]
M v[80:83], a[164:167], a[68:71], v[80:83]
M v[84:87], a[164:167], a[76:79], v[84:87]
M v[84:87], a[160:163], a[72:75], v[84:87]
 s_and_b32 s86, s41, 7
M v[88:91], a[160:163], a[80:83], v[88:91]
 s_mul_i32 s86, s86, 14
 s_lshr_b32 s64, s41, 3
 s_mul_i32 s64, s64, 7
M v[88:91], a[164:167], a[84:87], v[88:91]
 s_waitcnt lgkmcnt(2)
 s_add_u32 s86, s86, s64
 s_min_u32 s64, s42, 6
M v[92:95], a[164:167], a[92:95], v[92:95]
 s_waitcnt vmcnt(18) lgkmcnt(0)
 s_add_u32 s86, s86, s64
 s_sub_u32 s64, 6, s42
M v[92:95], a[160:163], a[88:91], v[92:95]
 s_barrier
M v[124:127], a[168:171], a[88:91], v[124:127]
 ds_read_b128 a[160:163], v5 offset:16384
 ds_read_b128 a[164:167], v6 offset:16384
M v[124:127], a[172:175], a[92:95], v[124:127]
 s_and_b32 s88, s64, 536870912
 s_mul_i32 s87, s20, 7168
M v[120:123], a[172:175], a[84:87], v[120:123]
 s_add_u32 m0, s24, 0
 ds_read_b64_tr_b16 a[128:129], v1 offset:49152
 ds_read_b64_tr_b16 a[130:131], v1 offset:50176
M v[120:123], a[168:171], a[80:83], v[120:123]
 buffer_load_dwordx4 v12, s[48:51], s22 offen offset:0   lds
M v[116:119], a[168:171], a[72:75], v[116:119]
 s_add_u32 s87, s87, 131072
M v[116:119], a[172:175], a[76:79], v[116:119]
 s_cmp_lt_u32 s20, 2
M v[112:115], a[172:175], a[68:71], v[112:115]
 s_cselect_b64 s[72:73], s[80:81], s[82:83]
M v[112:115], a[168:171], a[64:67], v[112:115]
 s_mov_b32 s60, s72
M v[108:111], a[168:171], a[56:59], v[108:111]
 s_and_b32 s61, s73, 0xffff
M v[108:111], a[172:175], a[60:63], v[108:111]
 s_mov_b32 s62, 1605632
 ds_read_b64_tr_b16 a[132:133], v1 offset:57344
 ds_read_b64_tr_b16 a[134:135], v1 offset:58368
M v[104:107], a[172:175], a[52:55], v[104:107]
 buffer_load_dwordx4 v13, s[48:51], s22 offen offset:1024   lds
M v[104:107], a[168:171], a[48:51], v[104:107]
 s_mov_b32 s63, 0x20000
M v[100:103], a[168:171], a[40:43], v[100:103]
 s_mov_b32 s68, s84
 s_and_b32 s69, s85, 0xffff
 s_mov_b32 s70, 1605632
M v[100:103], a[172:175], a[44:47], v[100:103]
 s_waitcnt lgkmcnt(4)
 s_mov_b32 s71, 0x20000
M v[96:99], a[172:175], a[36:39], v[96:99]
 s_lshl_b32 s89, s86, 5
 s_and_b32 s64, s20, 1
 s_mul_i32 s64, s64, 802816
M v[96:99], a[168:171], a[32:35], v[96:99]
 buffer_load_dwordx4 v14, s[48:51], s22 offen offset:2048   lds
M v[128:131], a[160:163], a[32:35], v[128:131]
 ds_read_b128 a[168:171], v5 offset:18432
 ds_read_b128 a[172:175], v6 offset:18432
M v[128:131], a[164:167], a[36:39], v[128:131]
 ds_read_b64_tr_b16 a[136:137], v2 offset:49152
 ds_read_b64_tr_b16 a[138:139], v2 offset:50176
M v[132:135], a[164:167], a[44:47], v[132:135]
 s_add_u32 s89, s89, s64
 v_lshrrev_b32 v28, 1, v0
M v[132:135], a[160:163], a[40:43], v[132:135]
 v_mul_u32_u24 v28, 3584, v28
 v_and_b32 v29, 1, v0
M v[136:139], a[160:163], a[48:51], v[136:139]
 v_lshl_add_u32 v25, v29, 4, v28
 v_or_b32 v25, s88, v25
M v[136:139], a[164:167], a[52:55], v[136:139]
M v[140:143], a[164:167], a[60:63], v[140:143]
 buffer_load_dwordx4 v15, s[48:51], s22 offen offset:3072   lds
M v[140:143], a[160:163], a[56:59], v[140:143]
 s_add_u32 s22, s22, 2097152
 ds_read_b64_tr_b16 a[140:141], v2 offset:57344
 ds_read_b64_tr_b16 a[142:143], v2 offset:58368
M v[144:147], a[160:163], a[64:67], v[144:147]
M v[144:147], a[164:167], a[68:71], v[144:147]
M v[148:151], a[164:167], a[76:79], v[148:151]
M v[148:151], a[160:163], a[72:75], v[148:151]
 s_add_u32 m0, s23, 32768
M v[152:155], a[160:163], a[80:83], v[152:155]
 buffer_load_dwordx4 v8, s[16:19], s21 offen offset:0  nt lds
M v[152:155], a[164:167], a[84:87], v[152:155]
 s_waitcnt lgkmcnt(4)
M v[156:159], a[164:167], a[92:95], v[156:159]
 ds_read_b64_tr_b16 a[144:145], v3 offset:49152
 ds_read_b64_tr_b16 a[146:147], v3 offset:50176
M v[156:159], a[160:163], a[88:91], v[156:159]
M v[188:191], a[168:171], a[88:91], v[188:191]
 ds_read_b128 a[160:163], v5 offset:20480
 ds_read_b128 a[164:167], v6 offset:20480
M v[188:191], a[172:175], a[92:95], v[188:191]
M v[184:187], a[172:175], a[84:87], v[184:187]
 buffer_load_dwordx4 v9, s[16:19], s21 offen offset:1024  nt lds
M v[184:187], a[168:171], a[80:83], v[184:187]
M v[180:183], a[168:171], a[72:75], v[180:183]
M v[180:183], a[172:175], a[76:79], v[180:183]
 ds_read_b64_tr_b16 a[148:149], v3 offset:57344
 ds_read_b64_tr_b16 a[150:151], v3 offset:58368
M v[176:179], a[172:175], a[68:71], v[176:179]
M v[176:179], a[168:171], a[64:67], v[176:179]
M v[172:175], a[168:171], a[56:59], v[172:175]
M v[172:175], a[172:175], a[60:63], v[172:175]
 buffer_load_dwordx4 v10, s[16:19], s21 offen offset:2048  nt lds
M v[168:171], a[172:175], a[52:55], v[168:171]
M v[168:171], a[168:171], a[48:51], v[168:171]
M v[164:167], a[168:171], a[40:43], v[164:167]
 ds_read_b64_tr_b16 a[152:153], v4 offset:49152
 ds_read_b64_tr_b16 a[154:155], v4 offset:50176
M v[164:167], a[172:175], a[44:47], v[164:167]
 s_waitcnt lgkmcnt(4)
M v[160:163], a[172:175], a[36:39], v[160:163]
M v[160:163], a[168:171], a[32:35], v[160:163]
 buffer_load_dwordx4 v11, s[16:19], s21 offen offset:3072  nt lds
M v[192:195], a[160:163], a[32:35], v[192:195]
 s_add_u32 s21, s21, 128
 ds_read_b128 a[168:171], v5 offset:22528
 ds_read_b128 a[172:175], v6 offset:22528
M v[192:195], a[164:167], a[36:39], v[192:195]
M v[196:199], a[164:167], a[44:47], v[196:199]
M v[196:199], a[160:163], a[40:43], v[196:199]
 ds_read_b64_tr_b16 a[156:157], v4 offset:57344
 ds_read_b64_tr_b16 a[158:159], v4 offset:58368
M v[200:203], a[160:163], a[48:51], v[200:203]
 s_add_u32 m0, s87, 0
M v[200:203], a[164:167], a[52:55], v[200:203]
 buffer_load_dwordx4 v25, s[60:63], s89 offen offset:0 nt lds
M v[204:207], a[164:167], a[60:63], v[204:207]
 s_add_u32 s89, s89, 114688
M v[204:207], a[160:163], a[56:59], v[204:207]
M v[208:211], a[160:163], a[64:67], v[208:211]
M v[208:211], a[164:167], a[68:71], v[208:211]
M v[212:215], a[164:167], a[76:79], v[212:215]
M v[212:215], a[160:163], a[72:75], v[212:215]
M v[216:219], a[160:163], a[80:83], v[216:219]
M v[216:219], a[164:167], a[84:87], v[216:219]
 s_waitcnt lgkmcnt(2)
M v[220:223], a[164:167], a[92:95], v[220:223]
 s_waitcnt vmcnt(19) lgkmcnt(0)
M v[220:223], a[160:163], a[88:91], v[220:223]
 s_barrier
M v[252:255], a[168:171], a[88:91], v[252:255]
 ds_read_b128 a[160:163], v5 offset:32768
 ds_read_b128 a[164:167], v6 offset:32768
M v[252:255], a[172:175], a[92:95], v[252:255]
M v[248:251], a[172:175], a[84:87], v[248:251]
M v[248:251], a[168:171], a[80:83], v[248:251]
M v[244:247], a[168:171], a[72:75], v[244:247]
M v[244:247], a[172:175], a[76:79], v[244:247]
M v[240:243], a[172:175], a[68:71], v[240:243]
M v[240:243], a[168:171], a[64:67], v[240:243]
M v[236:239], a[168:171], a[56:59], v[236:239]
M v[236:239], a[172:175], a[60:63], v[236:239]
M v[232:235], a[172:175], a[52:55], v[232:235]
M v[232:235], a[168:171], a[48:51], v[232:235]
M v[228:231], a[168:171], a[40:43], v[228:231]
M v[228:231], a[172:175], a[44:47], v[228:231]
 s_waitcnt lgkmcnt(0)
M v[224:227], a[172:175], a[36:39], v[224:227]
M v[224:227], a[168:171], a[32:35], v[224:227]
M a[0:3], a[160:163], a[96:99], a[0:3]
 ds_read_b128 a[168:171], v5 offset:34816
 ds_read_b128 a[172:175], v6 offset:34816
M a[0:3], a[164:167], a[100:103], a[0:3]
 ds_read_b64_tr_b16 a[32:33], v1 offset:0
 ds_read_b64_tr_b16 a[34:35], v1 offset:1024
M a[4:7], a[164:167], a[108:111], a[4:7]
 s_add_u32 m0, s24, 16384
M a[4:7], a[160:163], a[104:107], a[4:7]
 buffer_load_dwordx4 v12, s[48:51], s22 offen offset:0   lds
M a[8:11], a[160:163], a[112:115], a[8:11]
M a[8:11], a[164:167], a[116:119], a[8:11]
M a[12:15], a[164:167], a[124:127], a[12:15]
 ds_read_b64_tr_b16 a[36:37], v1 offset:8192
 ds_read_b64_tr_b16 a[38:39], v1 offset:9216
M a[12:15], a[160:163], a[120:123], a[12:15]
M a[16:19], a[160:163], a[128:131], a[16:19]
 buffer_load_dwordx4 v13, s[48:51], s22 offen offset:1024   lds
M a[16:19], a[164:167], a[132:135], a[16:19]
M a[20:23], a[164:167], a[140:143], a[20:23]
M a[20:23], a[160:163], a[136:139], a[20:23]
 ds_read_b64_tr_b16 a[40:41], v2 offset:0
 ds_read_b64_tr_b16 a[42:43], v2 offset:1024
M a[24:27], a[160:163], a[144:147], a[24:27]
M a[24:27], a[164:167], a[148:151], a[24:27]
 s_waitcnt lgkmcnt(6)
M a[28:31], a[164:167], a[156:159], a[28:31]
 buffer_load_dwordx4 v14, s[48:51], s22 offen offset:2048   lds
M a[28:31], a[160:163], a[152:155], a[28:31]
M v[60:63], a[168:171], a[152:155], v[60:63]
 ds_read_b128 a[160:163], v5 offset:36864
 ds_read_b128 a[164:167], v6 offset:36864
M v[60:63], a[172:175], a[156:159], v[60:63]
 ds_read_b64_tr_b16 a[44:45], v2 offset:8192
 ds_read_b64_tr_b16 a[46:47], v2 offset:9216
M v[56:59], a[172:175], a[148:151], v[56:59]
 buffer_load_dwordx4 v15, s[48:51], s22 offen offset:3072   lds
M v[56:59], a[168:171], a[144:147], v[56:59]
 s_sub_u32 s22, s22, 2097024
M v[52:55], a[168:171], a[136:139], v[52:55]
M v[52:55], a[172:175], a[140:143], v[52:55]
 ds_read_b64_tr_b16 a[48:49], v3 offset:0
 ds_read_b64_tr_b16 a[50:51], v3 offset:1024
M v[48:51], a[172:175], a[132:135], v[48:51]
 s_add_u32 m0, s23, 49152
M v[48:51], a[168:171], a[128:131], v[48:51]
 buffer_load_dwordx4 v8, s[16:19], s21 offen offset:0  nt lds
M v[44:47], a[168:171], a[120:123], v[44:47]
M v[44:47], a[172:175], a[124:127], v[44:47]
M v[40:43], a[172:175], a[116:119], v[40:43]
 ds_read_b64_tr_b16 a[52:53], v3 offset:8192
 ds_read_b64_tr_b16 a[54:55], v3 offset:9216
M v[40:43], a[168:171], a[112:115], v[40:43]
M v[36:39], a[168:171], a[104:107], v[36:39]
 buffer_load_dwordx4 v9, s[16:19], s21 offen offset:1024  nt lds
M v[36:39], a[172:175], a[108:111], v[36:39]
 s_waitcnt lgkmcnt(6)
M v[32:35], a[172:175], a[100:103], v[32:35]
M v[32:35], a[168:171], a[96:99], v[32:35]
 ds_read_b64_tr_b16 a[56:57], v4 offset:0
 ds_read_b64_tr_b16 a[58:59], v4 offset:1024
M v[64:67], a[160:163], a[96:99], v[64:67]
 ds_read_b128 a[168:171], v5 offset:38912
 ds_read_b128 a[172:175], v6 offset:38912
M v[64:67], a[164:167], a[100:103], v[64:67]
 buffer_load_dwordx4 v10, s[16:19], s21 offen offset:2048  nt lds
M v[68:71], a[164:167], a[108:111], v[68:71]
M v[68:71], a[160:163], a[104:107], v[68:71]
M v[72:75], a[160:163], a[112:115], v[72:75]
 ds_read_b64_tr_b16 a[60:61], v4 offset:8192
 ds_read_b64_tr_b16 a[62:63], v4 offset:9216
M v[72:75], a[164:167], a[116:119], v[72:75]
M v[76:79], a[164:167], a[124:127], v[76:79]
 buffer_load_dwordx4 v11, s[16:19], s21 offen offset:3072  nt lds
M v[76:79], a[160:163], a[120:123], v[76:79]
 s_add_u32 s21, s21, 524160
M v[80:83], a[160:163], a[128:131], v[80:83]
M v[80:83], a[164:167], a[132:135], v[80:83]
M v[84:87], a[164:167], a[140:143], v[84:87]
M v[84:87], a[160:163], a[136:139], v[84:87]
M v[88:91], a[160:163], a[144:147], v[88:91]
M v[88:91], a[164:167], a[148:151], v[88:91]
 s_waitcnt lgkmcnt(2)
M v[92:95], a[164:167], a[156:159], v[92:95]
 s_waitcnt vmcnt(17) lgkmcnt(0)
M v[92:95], a[160:163], a[152:155], v[92:95]
 s_barrier
M v[124:127], a[168:171], a[152:155], v[124:127]
 ds_read_b128 a[160:163], v5 offset:49152
 ds_read_b128 a[164:167], v6 offset:49152
M v[124:127], a[172:175], a[156:159], v[124:127]
M v[120:123], a[172:175], a[148:151], v[120:123]
 s_add_u32 m0, s24, 32768
 ds_read_b64_tr_b16 a[64:65], v1 offset:16384
 ds_read_b64_tr_b16 a[66:67], v1 offset:17408
M v[120:123], a[168:171], a[144:147], v[120:123]
 buffer_load_dwordx4 v12, s[48:51], s22 offen offset:0   lds
M v[116:119], a[168:171], a[136:139], v[116:119]
 v_min_u32 v16, 56, v0
 v_lshlrev_b32 v16, 2, v16
M v[116:119], a[172:175], a[140:143], v[116:119]
 buffer_load_dword v17, v16, s[12:15], 0 offen offset:0 sc1
M v[112:115], a[172:175], a[132:135], v[112:115]
M v[112:115], a[168:171], a[128:131], v[112:115]
M v[108:111], a[168:171], a[120:123], v[108:111]
M v[108:111], a[172:175], a[124:127], v[108:111]
 ds_read_b64_tr_b16 a[68:69], v1 offset:24576
 ds_read_b64_tr_b16 a[70:71], v1 offset:25600
M v[104:107], a[172:175], a[116:119], v[104:107]
 buffer_load_dwordx4 v13, s[48:51], s22 offen offset:1024   lds
M v[104:107], a[168:171], a[112:115], v[104:107]
M v[100:103], a[168:171], a[104:107], v[100:103]
M v[100:103], a[172:175], a[108:111], v[100:103]
 s_waitcnt lgkmcnt(4)
M v[96:99], a[172:175], a[100:103], v[96:99]
M v[96:99], a[168:171], a[96:99], v[96:99]
 buffer_load_dwordx4 v14, s[48:51], s22 offen offset:2048   lds
M v[128:131], a[160:163], a[96:99], v[128:131]
 ds_read_b128 a[168:171], v5 offset:51200
 ds_read_b128 a[172:175], v6 offset:51200
M v[128:131], a[164:167], a[100:103], v[128:131]
 ds_read_b64_tr_b16 a[72:73], v2 offset:16384
 ds_read_b64_tr_b16 a[74:75], v2 offset:17408
M v[132:135], a[164:167], a[108:111], v[132:135]
M v[132:135], a[160:163], a[104:107], v[132:135]
M v[136:139], a[160:163], a[112:115], v[136:139]
M v[136:139], a[164:167], a[116:119], v[136:139]
M v[140:143], a[164:167], a[124:127], v[140:143]
 buffer_load_dwordx4 v15, s[48:51], s22 offen offset:3072   lds
M v[140:143], a[160:163], a[120:123], v[140:143]
 s_add_u32 s22, s22, 2097152
 ds_read_b64_tr_b16 a[76:77], v2 offset:24576
 ds_read_b64_tr_b16 a[78:79], v2 offset:25600
M v[144:147], a[160:163], a[128:131], v[144:147]
M v[144:147], a[164:167], a[132:135], v[144:147]
M v[148:151], a[164:167], a[140:143], v[148:151]
M v[148:151], a[160:163], a[136:139], v[148:151]
 s_add_u32 m0, s23, 0
M v[152:155], a[160:163], a[144:147], v[152:155]
 buffer_load_dwordx4 v8, s[16:19], s21 offen offset:0  nt lds
M v[152:155], a[164:167], a[148:151], v[152:155]
 s_waitcnt lgkmcnt(4)
M v[156:159], a[164:167], a[156:159], v[156:159]
 ds_read_b64_tr_b16 a[80:81], v3 offset:16384
 ds_read_b64_tr_b16 a[82:83], v3 offset:17408
M v[156:159], a[160:163], a[152:155], v[156:159]
M v[188:191], a[168:171], a[152:155], v[188:191]
 ds_read_b128 a[160:163], v5 offset:53248
 ds_read_b128 a[164:167], v6 offset:53248
M v[188:191], a[172:175], a[156:159], v[188:191]
M v[184:187], a[172:175], a[148:151], v[184:187]
 buffer_load_dwordx4 v9, s[16:19], s21 offen offset:1024  nt lds
M v[184:187], a[168:171], a[144:147], v[184:187]
M v[180:183], a[168:171], a[136:139], v[180:183]
M v[180:183], a[172:175], a[140:143], v[180:183]
 ds_read_b64_tr_b16 a[84:85], v3 offset:24576
 ds_read_b64_tr_b16 a[86:87], v3 offset:25600
M v[176:179], a[172:175], a[132:135], v[176:179]
M v[176:179], a[168:171], a[128:131], v[176:179]
M v[172:175], a[168:171], a[120:123], v[172:175]
M v[172:175], a[172:175], a[124:127], v[172:175]
 buffer_load_dwordx4 v10, s[16:19], s21 offen offset:2048  nt lds
M v[168:171], a[172:175], a[116:119], v[168:171]
M v[168:171], a[168:171], a[112:115], v[168:171]
M v[164:167], a[168:171], a[104:107], v[164:167]
 ds_read_b64_tr_b16 a[88:89], v4 offset:16384
 ds_read_b64_tr_b16 a[90:91], v4 offset:17408
M v[164:167], a[172:175], a[108:111], v[164:167]
 s_waitcnt lgkmcnt(4)
M v[160:163], a[172:175], a[100:103], v[160:163]
M v[160:163], a[168:171], a[96:99], v[160:163]
 buffer_load_dwordx4 v11, s[16:19], s21 offen offset:3072  nt lds
M v[192:195], a[160:163], a[96:99], v[192:195]
 s_add_u32 s21, s21, 128
 ds_read_b128 a[168:171], v5 offset:55296
 ds_read_b128 a[172:175], v6 offset:55296
M v[192:195], a[164:167], a[100:103], v[192:195]
M v[196:199], a[164:167], a[108:111], v[196:199]
M v[196:199], a[160:163], a[104:107], v[196:199]
 ds_read_b64_tr_b16 a[92:93], v4 offset:24576
 ds_read_b64_tr_b16 a[94:95], v4 offset:25600
M v[200:203], a[160:163], a[112:115], v[200:203]
 s_add_u32 m0, s87, 1024
M v[200:203], a[164:167], a[116:119], v[200:203]
 buffer_load_dwordx4 v25, s[60:63], s89 offen offset:0 nt lds
M v[204:207], a[164:167], a[124:127], v[204:207]
 s_add_u32 s89, s89, 114688
M v[204:207], a[160:163], a[120:123], v[204:207]
M v[208:211], a[160:163], a[128:131], v[208:211]
M v[208:211], a[164:167], a[132:135], v[208:211]
M v[212:215], a[164:167], a[140:143], v[212:215]
M v[212:215], a[160:163], a[136:139], v[212:215]
M v[216:219], a[160:163], a[144:147], v[216:219]
M v[216:219], a[164:167], a[148:151], v[216:219]
 s_waitcnt lgkmcnt(2)
M v[220:223], a[164:167], a[156:159], v[220:223]
 s_waitcnt vmcnt(19) lgkmcnt(0)
M v[220:223], a[160:163], a[152:155], v[220:223]
 s_barrier
M v[252:255], a[168:171], a[152:155], v[252:255]
 ds_read_b128 a[160:163], v5 offset:0
 ds_read_b128 a[164:167], v6 offset:0
M v[252:255], a[172:175], a[156:159], v[252:255]
M v[248:251], a[172:175], a[148:151], v[248:251]
M v[248:251], a[168:171], a[144:147], v[248:251]
M v[244:247], a[168:171], a[136:139], v[244:247]
M v[244:247], a[172:175], a[140:143], v[244:247]
M v[240:243], a[172:175], a[132:135], v[240:243]
M v[240:243], a[168:171], a[128:131], v[240:243]
M v[236:239], a[168:171], a[120:123], v[236:239]
M v[236:239], a[172:175], a[124:127], v[236:239]
M v[232:235], a[172:175], a[116:119], v[232:235]
M v[232:235], a[168:171], a[112:115], v[232:235]
M v[228:231], a[168:171], a[104:107], v[228:231]
M v[228:231], a[172:175], a[108:111], v[228:231]
 s_waitcnt lgkmcnt(0)
M v[224:227], a[172:175], a[100:103], v[224:227]
M v[224:227], a[168:171], a[96:99], v[224:227]
M a[0:3], a[160:163], a[32:35], a[0:3]
 ds_read_b128 a[168:171], v5 offset:2048
 ds_read_b128 a[172:175], v6 offset:2048
M a[0:3], a[164:167], a[36:39], a[0:3]
 ds_read_b64_tr_b16 a[96:97], v1 offset:32768
 ds_read_b64_tr_b16 a[98:99], v1 offset:33792
M a[4:7], a[164:167], a[44:47], a[4:7]
 s_add_u32 m0, s24, 49152
M a[4:7], a[160:163], a[40:43], a[4:7]
 buffer_load_dwordx4 v12, s[48:51], s22 offen offset:0   lds
M a[8:11], a[160:163], a[48:51], a[8:11]
M a[8:11], a[164:167], a[52:55], a[8:11]
M a[12:15], a[164:167], a[60:63], a[12:15]
 ds_read_b64_tr_b16 a[100:101], v1 offset:40960
 ds_read_b64_tr_b16 a[102:103], v1 offset:41984
M a[12:15], a[160:163], a[56:59], a[12:15]
M a[16:19], a[160:163], a[64:67], a[16:19]
 buffer_load_dwordx4 v13, s[48:51], s22 offen offset:1024   lds
M a[16:19], a[164:167], a[68:71], a[16:19]
M a[20:23], a[164:167], a[76:79], a[20:23]
M a[20:23], a[160:163], a[72:75], a[20:23]
 ds_read_b64_tr_b16 a[104:105], v2 offset:32768
 ds_read_b64_tr_b16 a[106:107], v2 offset:33792
M a[24:27], a[160:163], a[80:83], a[24:27]
M a[24:27], a[164:167], a[84:87], a[24:27]
 s_waitcnt lgkmcnt(6)
M a[28:31], a[164:167], a[92:95], a[28:31]
 buffer_load_dwordx4 v14, s[48:51], s22 offen offset:2048   lds
M a[28:31], a[160:163], a[88:91], a[28:31]
M v[60:63], a[168:171], a[88:91], v[60:63]
 ds_read_b128 a[160:163], v5 offset:4096
 ds_read_b128 a[164:167], v6 offset:4096
M v[60:63], a[172:175], a[92:95], v[60:63]
 ds_read_b64_tr_b16 a[108:109], v2 offset:40960
 ds_read_b64_tr_b16 a[110:111], v2 offset:41984
M v[56:59], a[172:175], a[84:87], v[56:59]
 buffer_load_dwordx4 v15, s[48:51], s22 offen offset:3072   lds
M v[56:59], a[168:171], a[80:83], v[56:59]
 s_sub_u32 s22, s22, 2097024
M v[52:55], a[168:171], a[72:75], v[52:55]
M v[52:55], a[172:175], a[76:79], v[52:55]
 ds_read_b64_tr_b16 a[112:113], v3 offset:32768
 ds_read_b64_tr_b16 a[114:115], v3 offset:33792
M v[48:51], a[172:175], a[68:71], v[48:51]
 s_add_u32 m0, s23, 16384
M v[48:51], a[168:171], a[64:67], v[48:51]
 buffer_load_dwordx4 v8, s[16:19], s21 offen offset:0  nt lds
M v[44:47], a[168:171], a[56:59], v[44:47]
M v[44:47], a[172:175], a[60:63], v[44:47]
M v[40:43], a[172:175], a[52:55], v[40:43]
 ds_read_b64_tr_b16 a[116:117], v3 offset:40960
 ds_read_b64_tr_b16 a[118:119], v3 offset:41984
M v[40:43], a[168:171], a[48:51], v[40:43]
M v[36:39], a[168:171], a[40:43], v[36:39]
 buffer_load_dwordx4 v9, s[16:19], s21 offen offset:1024  nt lds
M v[36:39], a[172:175], a[44:47], v[36:39]
 s_waitcnt lgkmcnt(6)
M v[32:35], a[172:175], a[36:39], v[32:35]
M v[32:35], a[168:171], a[32:35], v[32:35]
 ds_read_b64_tr_b16 a[120:121], v4 offset:32768
 ds_read_b64_tr_b16 a[122:123], v4 offset:33792
M v[64:67], a[160:163], a[32:35], v[64:67]
 ds_read_b128 a[168:171], v5 offset:6144
 ds_read_b128 a[172:175], v6 offset:6144
M v[64:67], a[164:167], a[36:39], v[64:67]
 buffer_load_dwordx4 v10, s[16:19], s21 offen offset:2048  nt lds
M v[68:71], a[164:167], a[44:47], v[68:71]
M v[68:71], a[160:163], a[40:43], v[68:71]
M v[72:75], a[160:163], a[48:51], v[72:75]
 ds_read_b64_tr_b16 a[124:125], v4 offset:40960
 ds_read_b64_tr_b16 a[126:127], v4 offset:41984
M v[72:75], a[164:167], a[52:55], v[72:75]
M v[76:79], a[164:167], a[60:63], v[76:79]
 buffer_load_dwordx4 v11, s[16:19], s21 offen offset:3072  nt lds
M v[76:79], a[160:163], a[56:59], v[76:79]
 s_add_u32 s21, s21, 524160
M v[80:83], a[160:163], a[64:67], v[80:83]
M v[80:83], a[164:167], a[68:71], v[80:83]
M v[84:87], a[164:167], a[76:79], v[84:87]
M v[84:87], a[160:163], a[72:75], v[84:87]
M v[88:91], a[160:163], a[80:83], v[88:91]
M v[88:91], a[164:167], a[84:87], v[88:91]
 s_waitcnt lgkmcnt(2)
M v[92:95], a[164:167], a[92:95], v[92:95]
 s_waitcnt vmcnt(18) lgkmcnt(0)
M v[92:95], a[160:163], a[88:91], v[92:95]
 s_barrier
M v[124:127], a[168:171], a[88:91], v[124:127]
 ds_read_b128 a[160:163], v5 offset:16384
 ds_read_b128 a[164:167], v6 offset:16384
M v[124:127], a[172:175], a[92:95], v[124:127]
M v[120:123], a[172:175], a[84:87], v[120:123]
 s_add_u32 m0, s24, 0
 ds_read_b64_tr_b16 a[128:129], v1 offset:49152
 ds_read_b64_tr_b16 a[130:131], v1 offset:50176
M v[120:123], a[168:171], a[80:83], v[120:123]
 buffer_load_dwordx4 v12, s[48:51], s22 offen offset:0   lds
M v[116:119], a[168:171], a[72:75], v[116:119]
M v[116:119], a[172:175], a[76:79], v[116:119]
M v[112:115], a[172:175], a[68:71], v[112:115]
M v[112:115], a[168:171], a[64:67], v[112:115]
M v[108:111], a[168:171], a[56:59], v[108:111]
M v[108:111], a[172:175], a[60:63], v[108:111]
 ds_read_b64_tr_b16 a[132:133], v1 offset:57344
 ds_read_b64_tr_b16 a[134:135], v1 offset:58368
M v[104:107], a[172:175], a[52:55], v[104:107]
 buffer_load_dwordx4 v13, s[48:51], s22 offen offset:1024   lds
M v[104:107], a[168:171], a[48:51], v[104:107]
M v[100:103], a[168:171], a[40:43], v[100:103]
M v[100:103], a[172:175], a[44:47], v[100:103]
 s_waitcnt lgkmcnt(4)
M v[96:99], a[172:175], a[36:39], v[96:99]
M v[96:99], a[168:171], a[32:35], v[96:99]
 buffer_load_dwordx4 v14, s[48:51], s22 offen offset:2048   lds
M v[128:131], a[160:163], a[32:35], v[128:131]
 ds_read_b128 a[168:171], v5 offset:18432
 ds_read_b128 a[172:175], v6 offset:18432
M v[128:131], a[164:167], a[36:39], v[128:131]
 ds_read_b64_tr_b16 a[136:137], v2 offset:49152
 ds_read_b64_tr_b16 a[138:139], v2 offset:50176
M v[132:135], a[164:167], a[44:47], v[132:135]
M v[132:135], a[160:163], a[40:43], v[132:135]
M v[136:139], a[160:163], a[48:51], v[136:139]
M v[136:139], a[164:167], a[52:55], v[136:139]
M v[140:143], a[164:167], a[60:63], v[140:143]
 buffer_load_dwordx4 v15, s[48:51], s22 offen offset:3072   lds
M v[140:143], a[160:163], a[56:59], v[140:143]
 s_add_u32 s22, s22, 2097152
 ds_read_b64_tr_b16 a[140:141], v2 offset:57344
 ds_read_b64_tr_b16 a[142:143], v2 offset:58368
M v[144:147], a[160:163], a[64:67], v[144:147]
M v[144:147], a[164:167], a[68:71], v[144:147]
M v[148:151], a[164:167], a[76:79], v[148:151]
M v[148:151], a[160:163], a[72:75], v[148:151]
 s_add_u32 m0, s23, 32768
M v[152:155], a[160:163], a[80:83], v[152:155]
 buffer_load_dwordx4 v8, s[16:19], s21 offen offset:0  nt lds
M v[152:155], a[164:167], a[84:87], v[152:155]
 s_waitcnt lgkmcnt(4)
M v[156:159], a[164:167], a[92:95], v[156:159]
 ds_read_b64_tr_b16 a[144:145], v3 offset:49152
 ds_read_b64_tr_b16 a[146:147], v3 offset:50176
M v[156:159], a[160:163], a[88:91], v[156:159]
M v[188:191], a[168:171], a[88:91], v[188:191]
 ds_read_b128 a[160:163], v5 offset:20480
 ds_read_b128 a[164:167], v6 offset:20480
M v[188:191], a[172:175], a[92:95], v[188:191]
M v[184:187], a[172:175], a[84:87], v[184:187]
 buffer_load_dwordx4 v9, s[16:19], s21 offen offset:1024  nt lds
M v[184:187], a[168:171], a[80:83], v[184:187]
M v[180:183], a[168:171], a[72:75], v[180:183]
M v[180:183], a[172:175], a[76:79], v[180:183]
 ds_read_b64_tr_b16 a[148:149], v3 offset:57344
 ds_read_b64_tr_b16 a[150:151], v3 offset:58368
M v[176:179], a[172:175], a[68:71], v[176:179]
M v[176:179], a[168:171], a[64:67], v[176:179]
M v[172:175], a[168:171], a[56:59], v[172:175]
M v[172:175], a[172:175], a[60:63], v[172:175]
 buffer_load_dwordx4 v10, s[16:19], s21 offen offset:2048  nt lds
M v[168:171], a[172:175], a[52:55], v[168:171]
M v[168:171], a[168:171], a[48:51], v[168:171]
M v[164:167], a[168:171], a[40:43], v[164:167]
 ds_read_b64_tr_b16 a[152:153], v4 offset:49152
 ds_read_b64_tr_b16 a[154:155], v4 offset:50176
M v[164:167], a[172:175], a[44:47], v[164:167]
 s_waitcnt lgkmcnt(4)
M v[160:163], a[172:175], a[36:39], v[160:163]
M v[160:163], a[168:171], a[32:35], v[160:163]
 buffer_load_dwordx4 v11, s[16:19], s21 offen offset:3072  nt lds
M v[192:195], a[160:163], a[32:35], v[192:195]
 s_add_u32 s21, s21, 128
 ds_read_b128 a[168:171], v5 offset:22528
 ds_read_b128 a[172:175], v6 offset:22528
M v[192:195], a[164:167], a[36:39], v[192:195]
M v[196:199], a[164:167], a[44:47], v[196:199]
M v[196:199], a[160:163], a[40:43], v[196:199]
 ds_read_b64_tr_b16 a[156:157], v4 offset:57344
 ds_read_b64_tr_b16 a[158:159], v4 offset:58368
M v[200:203], a[160:163], a[48:51], v[200:203]
 s_add_u32 m0, s87, 2048
M v[200:203], a[164:167], a[52:55], v[200:203]
 buffer_load_dwordx4 v25, s[60:63], s89 offen offset:0 nt lds
M v[204:207], a[164:167], a[60:63], v[204:207]
 s_add_u32 s89, s89, 114688
M v[204:207], a[160:163], a[56:59], v[204:207]
M v[208:211], a[160:163], a[64:67], v[208:211]
M v[208:211], a[164:167], a[68:71], v[208:211]
M v[212:215], a[164:167], a[76:79], v[212:215]
M v[212:215], a[160:163], a[72:75], v[212:215]
M v[216:219], a[160:163], a[80:83], v[216:219]
M v[216:219], a[164:167], a[84:87], v[216:219]
 s_waitcnt lgkmcnt(2)
M v[220:223], a[164:167], a[92:95], v[220:223]
 s_waitcnt vmcnt(18) lgkmcnt(0)
M v[220:223], a[160:163], a[88:91], v[220:223]
 s_barrier
M v[252:255], a[168:171], a[88:91], v[252:255]
 ds_read_b128 a[160:163], v5 offset:32768
 ds_read_b128 a[164:167], v6 offset:32768
M v[252:255], a[172:175], a[92:95], v[252:255]
 v_cmp_eq_u32 vcc, 0, v17
M v[248:251], a[172:175], a[84:87], v[248:251]
 s_nop 0
M v[248:251], a[168:171], a[80:83], v[248:251]
 s_cbranch_vccnz L_zs0
L_zr0:
M v[244:247], a[168:171], a[72:75], v[244:247]
 buffer_load_dword a240, v24, s[32:35], 0 offen offset:1024
M v[244:247], a[172:175], a[76:79], v[244:247]
 s_lshl_b32 s72, s30, 6
M v[240:243], a[172:175], a[68:71], v[240:243]
 s_add_u32 s72, s72, 234938368
M v[240:243], a[168:171], a[64:67], v[240:243]
M v[236:239], a[168:171], a[56:59], v[236:239]
 buffer_store_dword v19, v18, s[8:11], s72 offen sc1
M v[236:239], a[172:175], a[60:63], v[236:239]
M v[232:235], a[172:175], a[52:55], v[232:235]
M v[232:235], a[168:171], a[48:51], v[232:235]
M v[228:231], a[168:171], a[40:43], v[228:231]
M v[228:231], a[172:175], a[44:47], v[228:231]
 s_waitcnt lgkmcnt(0)
M v[224:227], a[172:175], a[36:39], v[224:227]
M v[224:227], a[168:171], a[32:35], v[224:227]
M a[0:3], a[160:163], a[96:99], a[0:3]
 ds_read_b128 a[168:171], v5 offset:34816
 ds_read_b128 a[172:175], v6 offset:34816
M a[0:3], a[164:167], a[100:103], a[0:3]
 ds_read_b64_tr_b16 a[32:33], v1 offset:0
 ds_read_b64_tr_b16 a[34:35], v1 offset:1024
M a[4:7], a[164:167], a[108:111], a[4:7]
 s_add_u32 m0, s24, 16384
 v_cmp_le_u32 vcc, 0x40000000, v17
 v_and_b32 v17, 0xffff, v17
M a[4:7], a[160:163], a[104:107], a[4:7]
 buffer_load_dwordx4 v12, s[48:51], s22 offen offset:0   lds
M a[8:11], a[160:163], a[112:115], a[8:11]
 s_nop 0
M a[8:11], a[164:167], a[116:119], a[8:11]
 s_and_b32 s101, vcc_lo, 0xff
 v_add_u32 v17, v17, v17 row_ror:8 row_mask:0xf bank_mask:0xf
 s_nop 1
 v_add_u32 v17, v17, v17 row_ror:4 row_mask:0xf bank_mask:0xf
M a[12:15], a[164:167], a[124:127], a[12:15]
 ds_read_b64_tr_b16 a[36:37], v1 offset:8192
 ds_read_b64_tr_b16 a[38:39], v1 offset:9216
M a[12:15], a[160:163], a[120:123], a[12:15]
 v_add_u32 v17, v17, v17 row_ror:2 row_mask:0xf bank_mask:0xf
 s_nop 1
 v_add_u32 v17, v17, v17 row_ror:1 row_mask:0xf bank_mask:0xf
M a[16:19], a[160:163], a[128:131], a[16:19]
 buffer_load_dwordx4 v13, s[48:51], s22 offen offset:1024   lds
M a[16:19], a[164:167], a[132:135], a[16:19]
 v_cmp_lt_u32 vcc, 262144, v17
M a[20:23], a[164:167], a[140:143], a[20:23]
 s_nop 0
M a[20:23], a[160:163], a[136:139], a[20:23]
 s_nop 0
 ds_read_b64_tr_b16 a[40:41], v2 offset:0
 ds_read_b64_tr_b16 a[42:43], v2 offset:1024
M a[24:27], a[160:163], a[144:147], a[24:27]
 s_and_b32 s92, vcc_lo, 1
 s_mul_i32 s92, s92, 0xff
 s_xor_b32 s101, s101, s92
M a[24:27], a[164:167], a[148:151], a[24:27]
 s_waitcnt lgkmcnt(6)
M a[28:31], a[164:167], a[156:159], a[28:31]
 buffer_load_dwordx4 v14, s[48:51], s22 offen offset:2048   lds
M a[28:31], a[160:163], a[152:155], a[28:31]
M v[60:63], a[168:171], a[152:155], v[60:63]
 ds_read_b128 a[160:163], v5 offset:36864
 ds_read_b128 a[164:167], v6 offset:36864
M v[60:63], a[172:175], a[156:159], v[60:63]
 ds_read_b64_tr_b16 a[44:45], v2 offset:8192
 ds_read_b64_tr_b16 a[46:47], v2 offset:9216
M v[56:59], a[172:175], a[148:151], v[56:59]
 buffer_load_dwordx4 v15, s[48:51], s22 offen offset:3072   lds
M v[56:59], a[168:171], a[144:147], v[56:59]
 s_sub_u32 s22, s22, 2097024
M v[52:55], a[168:171], a[136:139], v[52:55]
M v[52:55], a[172:175], a[140:143], v[52:55]
 ds_read_b64_tr_b16 a[48:49], v3 offset:0
 ds_read_b64_tr_b16 a[50:51], v3 offset:1024
M v[48:51], a[172:175], a[132:135], v[48:51]
 s_add_u32 m0, s23, 49152
M v[48:51], a[168:171], a[128:131], v[48:51]
 buffer_load_dwordx4 v8, s[16:19], s21 offen offset:0  nt lds
M v[44:47], a[168:171], a[120:123], v[44:47]
M v[44:47], a[172:175], a[124:127], v[44:47]
M v[40:43], a[172:175], a[116:119], v[40:43]
 ds_read_b64_tr_b16 a[52:53], v3 offset:8192
 ds_read_b64_tr_b16 a[54:55], v3 offset:9216
M v[40:43], a[168:171], a[112:115], v[40:43]
M v[36:39], a[168:171], a[104:107], v[36:39]
 buffer_load_dwordx4 v9, s[16:19], s21 offen offset:1024  nt lds
M v[36:39], a[172:175], a[108:111], v[36:39]
 s_waitcnt lgkmcnt(6)
M v[32:35], a[172:175], a[100:103], v[32:35]
M v[32:35], a[168:171], a[96:99], v[32:35]
 ds_read_b64_tr_b16 a[56:57], v4 offset:0
 ds_read_b64_tr_b16 a[58:59], v4 offset:1024
M v[64:67], a[160:163], a[96:99], v[64:67]
 ds_read_b128 a[168:171], v5 offset:38912
 ds_read_b128 a[172:175], v6 offset:38912
M v[64:67], a[164:167], a[100:103], v[64:67]
 buffer_load_dwordx4 v10, s[16:19], s21 offen offset:2048  nt lds
M v[68:71], a[164:167], a[108:111], v[68:71]
M v[68:71], a[160:163], a[104:107], v[68:71]
M v[72:75], a[160:163], a[112:115], v[72:75]
 ds_read_b64_tr_b16 a[60:61], v4 offset:8192
 ds_read_b64_tr_b16 a[62:63], v4 offset:9216
M v[72:75], a[164:167], a[116:119], v[72:75]
M v[76:79], a[164:167], a[124:127], v[76:79]
 buffer_load_dwordx4 v11, s[16:19], s21 offen offset:3072  nt lds
M v[76:79], a[160:163], a[120:123], v[76:79]
 s_add_u32 s21, s21, 524160
M v[80:83], a[160:163], a[128:131], v[80:83]
M v[80:83], a[164:167], a[132:135], v[80:83]
M v[84:87], a[164:167], a[140:143], v[84:87]
M v[84:87], a[160:163], a[136:139], v[84:87]
M v[88:91], a[160:163], a[144:147], v[88:91]
M v[88:91], a[164:167], a[148:151], v[88:91]
 s_waitcnt lgkmcnt(2)
M v[92:95], a[164:167], a[156:159], v[92:95]
 s_waitcnt vmcnt(19) lgkmcnt(0)
M v[92:95], a[160:163], a[152:155], v[92:95]
 s_barrier
M v[124:127], a[168:171], a[152:155], v[124:127]
 ds_read_b128 a[160:163], v5 offset:49152
 ds_read_b128 a[164:167], v6 offset:49152
M v[124:127], a[172:175], a[156:159], v[124:127]
M v[120:123], a[172:175], a[148:151], v[120:123]
 s_add_u32 m0, s24, 32768
 ds_read_b64_tr_b16 a[64:65], v1 offset:16384
 ds_read_b64_tr_b16 a[66:67], v1 offset:17408
M v[120:123], a[168:171], a[144:147], v[120:123]
 buffer_load_dwordx4 v12, s[48:51], s22 offen offset:0   lds
M v[116:119], a[168:171], a[136:139], v[116:119]
M v[116:119], a[172:175], a[140:143], v[116:119]
M v[112:115], a[172:175], a[132:135], v[112:115]
M v[112:115], a[168:171], a[128:131], v[112:115]
M v[108:111], a[168:171], a[120:123], v[108:111]
M v[108:111], a[172:175], a[124:127], v[108:111]
 ds_read_b64_tr_b16 a[68:69], v1 offset:24576
 ds_read_b64_tr_b16 a[70:71], v1 offset:25600
M v[104:107], a[172:175], a[116:119], v[104:107]
 buffer_load_dwordx4 v13, s[48:51], s22 offen offset:1024   lds
M v[104:107], a[168:171], a[112:115], v[104:107]
M v[100:103], a[168:171], a[104:107], v[100:103]
M v[100:103], a[172:175], a[108:111], v[100:103]
 s_waitcnt lgkmcnt(4)
M v[96:99], a[172:175], a[100:103], v[96:99]
M v[96:99], a[168:171], a[96:99], v[96:99]
 buffer_load_dwordx4 v14, s[48:51], s22 offen offset:2048   lds
M v[128:131], a[160:163], a[96:99], v[128:131]
 ds_read_b128 a[168:171], v5 offset:51200
 ds_read_b128 a[172:175], v6 offset:51200
M v[128:131], a[164:167], a[100:103], v[128:131]
 ds_read_b64_tr_b16 a[72:73], v2 offset:16384
 ds_read_b64_tr_b16 a[74:75], v2 offset:17408
M v[132:135], a[164:167], a[108:111], v[132:135]
M v[132:135], a[160:163], a[104:107], v[132:135]
M v[136:139], a[160:163], a[112:115], v[136:139]
M v[136:139], a[164:167], a[116:119], v[136:139]
M v[140:143], a[164:167], a[124:127], v[140:143]
 buffer_load_dwordx4 v15, s[48:51], s22 offen offset:3072   lds
M v[140:143], a[160:163], a[120:123], v[140:143]
 s_add_u32 s22, s22, 2097152
 ds_read_b64_tr_b16 a[76:77], v2 offset:24576
 ds_read_b64_tr_b16 a[78:79], v2 offset:25600
M v[144:147], a[160:163], a[128:131], v[144:147]
M v[144:147], a[164:167], a[132:135], v[144:147]
M v[148:151], a[164:167], a[140:143], v[148:151]
M v[148:151], a[160:163], a[136:139], v[148:151]
 s_add_u32 m0, s23, 0
M v[152:155], a[160:163], a[144:147], v[152:155]
 buffer_load_dwordx4 v8, s[16:19], s21 offen offset:0  nt lds
M v[152:155], a[164:167], a[148:151], v[152:155]
 s_waitcnt lgkmcnt(4)
M v[156:159], a[164:167], a[156:159], v[156:159]
 ds_read_b64_tr_b16 a[80:81], v3 offset:16384
 ds_read_b64_tr_b16 a[82:83], v3 offset:17408
M v[156:159], a[160:163], a[152:155], v[156:159]
M v[188:191], a[168:171], a[152:155], v[188:191]
 ds_read_b128 a[160:163], v5 offset:53248
 ds_read_b128 a[164:167], v6 offset:53248
M v[188:191], a[172:175], a[156:159], v[188:191]
M v[184:187], a[172:175], a[148:151], v[184:187]
 buffer_load_dwordx4 v9, s[16:19], s21 offen offset:1024  nt lds
M v[184:187], a[168:171], a[144:147], v[184:187]
M v[180:183], a[168:171], a[136:139], v[180:183]
M v[180:183], a[172:175], a[140:143], v[180:183]
 ds_read_b64_tr_b16 a[84:85], v3 offset:24576
 ds_read_b64_tr_b16 a[86:87], v3 offset:25600
M v[176:179], a[172:175], a[132:135], v[176:179]
M v[176:179], a[168:171], a[128:131], v[176:179]
M v[172:175], a[168:171], a[120:123], v[172:175]
M v[172:175], a[172:175], a[124:127], v[172:175]
 buffer_load_dwordx4 v10, s[16:19], s21 offen offset:2048  nt lds
M v[168:171], a[172:175], a[116:119], v[168:171]
M v[168:171], a[168:171], a[112:115], v[168:171]
M v[164:167], a[168:171], a[104:107], v[164:167]
 ds_read_b64_tr_b16 a[88:89], v4 offset:16384
 ds_read_b64_tr_b16 a[90:91], v4 offset:17408
M v[164:167], a[172:175], a[108:111], v[164:167]
 s_waitcnt lgkmcnt(4)
M v[160:163], a[172:175], a[100:103], v[160:163]
M v[160:163], a[168:171], a[96:99], v[160:163]
 buffer_load_dwordx4 v11, s[16:19], s21 offen offset:3072  nt lds
M v[192:195], a[160:163], a[96:99], v[192:195]
 s_add_u32 s21, s21, 128
 ds_read_b128 a[168:171], v5 offset:55296
 ds_read_b128 a[172:175], v6 offset:55296
M v[192:195], a[164:167], a[100:103], v[192:195]
M v[196:199], a[164:167], a[108:111], v[196:199]
M v[196:199], a[160:163], a[104:107], v[196:199]
 ds_read_b64_tr_b16 a[92:93], v4 offset:24576
 ds_read_b64_tr_b16 a[94:95], v4 offset:25600
M v[200:203], a[160:163], a[112:115], v[200:203]
 s_add_u32 m0, s87, 3072
M v[200:203], a[164:167], a[116:119], v[200:203]
 buffer_load_dwordx4 v25, s[60:63], s89 offen offset:0 nt lds
M v[204:207], a[164:167], a[124:127], v[204:207]
 s_add_u32 s89, s89, 114688
M v[204:207], a[160:163], a[120:123], v[204:207]
M v[208:211], a[160:163], a[128:131], v[208:211]
M v[208:211], a[164:167], a[132:135], v[208:211]
M v[212:215], a[164:167], a[140:143], v[212:215]
M v[212:215], a[160:163], a[136:139], v[212:215]
M v[216:219], a[160:163], a[144:147], v[216:219]
M v[216:219], a[164:167], a[148:151], v[216:219]
 s_waitcnt lgkmcnt(2)
M v[220:223], a[164:167], a[156:159], v[220:223]
 s_waitcnt vmcnt(20) lgkmcnt(0)
M v[220:223], a[160:163], a[152:155], v[220:223]
 s_barrier
M v[252:255], a[168:171], a[152:155], v[252:255]
 ds_read_b128 a[160:163], v5 offset:0
 ds_read_b128 a[164:167], v6 offset:0
M v[252:255], a[172:175], a[156:159], v[252:255]
M v[248:251], a[172:175], a[148:151], v[248:251]
M v[248:251], a[168:171], a[144:147], v[248:251]
M v[244:247], a[168:171], a[136:139], v[244:247]
M v[244:247], a[172:175], a[140:143], v[244:247]
M v[240:243], a[172:175], a[132:135], v[240:243]
M v[240:243], a[168:171], a[128:131], v[240:243]
M v[236:239], a[168:171], a[120:123], v[236:239]
M v[236:239], a[172:175], a[124:127], v[236:239]
M v[232:235], a[172:175], a[116:119], v[232:235]
M v[232:235], a[168:171], a[112:115], v[232:235]
M v[228:231], a[168:171], a[104:107], v[228:231]
M v[228:231], a[172:175], a[108:111], v[228:231]
 s_waitcnt lgkmcnt(0)
M v[224:227], a[172:175], a[100:103], v[224:227]
M v[224:227], a[168:171], a[96:99], v[224:227]
M a[0:3], a[160:163], a[32:35], a[0:3]
 ds_read_b128 a[168:171], v5 offset:2048
 ds_read_b128 a[172:175], v6 offset:2048
M a[0:3], a[164:167], a[36:39], a[0:3]
 ds_read_b64_tr_b16 a[96:97], v1 offset:32768
 ds_read_b64_tr_b16 a[98:99], v1 offset:33792
M a[4:7], a[164:167], a[44:47], a[4:7]
 s_add_u32 m0, s24, 49152
M a[4:7], a[160:163], a[40:43], a[4:7]
 buffer_load_dwordx4 v12, s[48:51], s22 offen offset:0   lds
M a[8:11], a[160:163], a[48:51], a[8:11]
M a[8:11], a[164:167], a[52:55], a[8:11]
M a[12:15], a[164:167], a[60:63], a[12:15]
 ds_read_b64_tr_b16 a[100:101], v1 offset:40960
 ds_read_b64_tr_b16 a[102:103], v1 offset:41984
M a[12:15], a[160:163], a[56:59], a[12:15]
M a[16:19], a[160:163], a[64:67], a[16:19]
 buffer_load_dwordx4 v13, s[48:51], s22 offen offset:1024   lds
M a[16:19], a[164:167], a[68:71], a[16:19]
M a[20:23], a[164:167], a[76:79], a[20:23]
M a[20:23], a[160:163], a[72:75], a[20:23]
 ds_read_b64_tr_b16 a[104:105], v2 offset:32768
 ds_read_b64_tr_b16 a[106:107], v2 offset:33792
M a[24:27], a[160:163], a[80:83], a[24:27]
M a[24:27], a[164:167], a[84:87], a[24:27]
 s_waitcnt lgkmcnt(6)
M a[28:31], a[164:167], a[92:95], a[28:31]
 buffer_load_dwordx4 v14, s[48:51], s22 offen offset:2048   lds
M a[28:31], a[160:163], a[88:91], a[28:31]
M v[60:63], a[168:171], a[88:91], v[60:63]
 ds_read_b128 a[160:163], v5 offset:4096
 ds_read_b128 a[164:167], v6 offset:4096
M v[60:63], a[172:175], a[92:95], v[60:63]
 ds_read_b64_tr_b16 a[108:109], v2 offset:40960
 ds_read_b64_tr_b16 a[110:111], v2 offset:41984
M v[56:59], a[172:175], a[84:87], v[56:59]
 buffer_load_dwordx4 v15, s[48:51], s22 offen offset:3072   lds
M v[56:59], a[168:171], a[80:83], v[56:59]
 s_sub_u32 s22, s22, 2097024
M v[52:55], a[168:171], a[72:75], v[52:55]
M v[52:55], a[172:175], a[76:79], v[52:55]
 ds_read_b64_tr_b16 a[112:113], v3 offset:32768
 ds_read_b64_tr_b16 a[114:115], v3 offset:33792
M v[48:51], a[172:175], a[68:71], v[48:51]
 s_add_u32 m0, s23, 16384
M v[48:51], a[168:171], a[64:67], v[48:51]
 buffer_load_dwordx4 v8, s[16:19], s21 offen offset:0  nt lds
M v[44:47], a[168:171], a[56:59], v[44:47]
M v[44:47], a[172:175], a[60:63], v[44:47]
M v[40:43], a[172:175], a[52:55], v[40:43]
 ds_read_b64_tr_b16 a[116:117], v3 offset:40960
 ds_read_b64_tr_b16 a[118:119], v3 offset:41984
M v[40:43], a[168:171], a[48:51], v[40:43]
M v[36:39], a[168:171], a[40:43], v[36:39]
 buffer_load_dwordx4 v9, s[16:19], s21 offen offset:1024  nt lds
M v[36:39], a[172:175], a[44:47], v[36:39]
 s_waitcnt lgkmcnt(6)
M v[32:35], a[172:175], a[36:39], v[32:35]
M v[32:35], a[168:171], a[32:35], v[32:35]
 ds_read_b64_tr_b16 a[120:121], v4 offset:32768
 ds_read_b64_tr_b16 a[122:123], v4 offset:33792
M v[64:67], a[160:163], a[32:35], v[64:67]
 ds_read_b128 a[168:171], v5 offset:6144
 ds_read_b128 a[172:175], v6 offset:6144
M v[64:67], a[164:167], a[36:39], v[64:67]
 buffer_load_dwordx4 v10, s[16:19], s21 offen offset:2048  nt lds
M v[68:71], a[164:167], a[44:47], v[68:71]
M v[68:71], a[160:163], a[40:43], v[68:71]
M v[72:75], a[160:163], a[48:51], v[72:75]
 ds_read_b64_tr_b16 a[124:125], v4 offset:40960
 ds_read_b64_tr_b16 a[126:127], v4 offset:41984
M v[72:75], a[164:167], a[52:55], v[72:75]
M v[76:79], a[164:167], a[60:63], v[76:79]
 buffer_load_dwordx4 v11, s[16:19], s21 offen offset:3072  nt lds
M v[76:79], a[160:163], a[56:59], v[76:79]
 s_add_u32 s21, s21, 524160
M v[80:83], a[160:163], a[64:67], v[80:83]
M v[80:83], a[164:167], a[68:71], v[80:83]
M v[84:87], a[164:167], a[76:79], v[84:87]
M v[84:87], a[160:163], a[72:75], v[84:87]
M v[88:91], a[160:163], a[80:83], v[88:91]
M v[88:91], a[164:167], a[84:87], v[88:91]
 s_waitcnt lgkmcnt(2)
M v[92:95], a[164:167], a[92:95], v[92:95]
 s_waitcnt vmcnt(17) lgkmcnt(0)
M v[92:95], a[160:163], a[88:91], v[92:95]
 s_barrier
M v[124:127], a[168:171], a[88:91], v[124:127]
 ds_read_b128 a[160:163], v5 offset:16384
 ds_read_b128 a[164:167], v6 offset:16384
M v[124:127], a[172:175], a[92:95], v[124:127]
M v[120:123], a[172:175], a[84:87], v[120:123]
 s_add_u32 m0, s24, 0
 ds_read_b64_tr_b16 a[128:129], v1 offset:49152
 ds_read_b64_tr_b16 a[130:131], v1 offset:50176
M v[120:123], a[168:171], a[80:83], v[120:123]
 buffer_load_dwordx4 v12, s[48:51], s22 offen offset:0   lds
M v[116:119], a[168:171], a[72:75], v[116:119]
M v[116:119], a[172:175], a[76:79], v[116:119]
M v[112:115], a[172:175], a[68:71], v[112:115]
M v[112:115], a[168:171], a[64:67], v[112:115]
M v[108:111], a[168:171], a[56:59], v[108:111]
M v[108:111], a[172:175], a[60:63], v[108:111]
 ds_read_b64_tr_b16 a[132:133], v1 offset:57344
 ds_read_b64_tr_b16 a[134:135], v1 offset:58368
M v[104:107], a[172:175], a[52:55], v[104:107]
 buffer_load_dwordx4 v13, s[48:51], s22 offen offset:1024   lds
M v[104:107], a[168:171], a[48:51], v[104:107]
M v[100:103], a[168:171], a[40:43], v[100:103]
M v[100:103], a[172:175], a[44:47], v[100:103]
 s_waitcnt lgkmcnt(4)
M v[96:99], a[172:175], a[36:39], v[96:99]
M v[96:99], a[168:171], a[32:35], v[96:99]
 buffer_load_dwordx4 v14, s[48:51], s22 offen offset:2048   lds
M v[128:131], a[160:163], a[32:35], v[128:131]
 ds_read_b128 a[168:171], v5 offset:18432
 ds_read_b128 a[172:175], v6 offset:18432
M v[128:131], a[164:167], a[36:39], v[128:131]
 ds_read_b64_tr_b16 a[136:137], v2 offset:49152
 ds_read_b64_tr_b16 a[138:139], v2 offset:50176
M v[132:135], a[164:167], a[44:47], v[132:135]
M v[132:135], a[160:163], a[40:43], v[132:135]
M v[136:139], a[160:163], a[48:51], v[136:139]
M v[136:139], a[164:167], a[52:55], v[136:139]
M v[140:143], a[164:167], a[60:63], v[140:143]
 buffer_load_dwordx4 v15, s[48:51], s22 offen offset:3072   lds
M v[140:143], a[160:163], a[56:59], v[140:143]
 s_add_u32 s22, s22, 2097152
 ds_read_b64_tr_b16 a[140:141], v2 offset:57344
 ds_read_b64_tr_b16 a[142:143], v2 offset:58368
M v[144:147], a[160:163], a[64:67], v[144:147]
M v[144:147], a[164:167], a[68:71], v[144:147]
M v[148:151], a[164:167], a[76:79], v[148:151]
M v[148:151], a[160:163], a[72:75], v[148:151]
 s_add_u32 m0, s23, 32768
M v[152:155], a[160:163], a[80:83], v[152:155]
 buffer_load_dwordx4 v8, s[16:19], s21 offen offset:0  nt lds
M v[152:155], a[164:167], a[84:87], v[152:155]
 s_waitcnt lgkmcnt(4)
M v[156:159], a[164:167], a[92:95], v[156:159]
 ds_read_b64_tr_b16 a[144:145], v3 offset:49152
 ds_read_b64_tr_b16 a[146:147], v3 offset:50176
M v[156:159], a[160:163], a[88:91], v[156:159]
M v[188:191], a[168:171], a[88:91], v[188:191]
 ds_read_b128 a[160:163], v5 offset:20480
 ds_read_b128 a[164:167], v6 offset:20480
M v[188:191], a[172:175], a[92:95], v[188:191]
M v[184:187], a[172:175], a[84:87], v[184:187]
 buffer_load_dwordx4 v9, s[16:19], s21 offen offset:1024  nt lds
M v[184:187], a[168:171], a[80:83], v[184:187]
M v[180:183], a[168:171], a[72:75], v[180:183]
M v[180:183], a[172:175], a[76:79], v[180:183]
 ds_read_b64_tr_b16 a[148:149], v3 offset:57344
 ds_read_b64_tr_b16 a[150:151], v3 offset:58368
M v[176:179], a[172:175], a[68:71], v[176:179]
M v[176:179], a[168:171], a[64:67], v[176:179]
M v[172:175], a[168:171], a[56:59], v[172:175]
M v[172:175], a[172:175], a[60:63], v[172:175]
 buffer_load_dwordx4 v10, s[16:19], s21 offen offset:2048  nt lds
M v[168:171], a[172:175], a[52:55], v[168:171]
M v[168:171], a[168:171], a[48:51], v[168:171]
M v[164:167], a[168:171], a[40:43], v[164:167]
 ds_read_b64_tr_b16 a[152:153], v4 offset:49152
 ds_read_b64_tr_b16 a[154:155], v4 offset:50176
M v[164:167], a[172:175], a[44:47], v[164:167]
 s_waitcnt lgkmcnt(4)
M v[160:163], a[172:175], a[36:39], v[160:163]
M v[160:163], a[168:171], a[32:35], v[160:163]
 buffer_load_dwordx4 v11, s[16:19], s21 offen offset:3072  nt lds
M v[192:195], a[160:163], a[32:35], v[192:195]
 s_add_u32 s21, s21, 128
 ds_read_b128 a[168:171], v5 offset:22528
 ds_read_b128 a[172:175], v6 offset:22528
M v[192:195], a[164:167], a[36:39], v[192:195]
M v[196:199], a[164:167], a[44:47], v[196:199]
M v[196:199], a[160:163], a[40:43], v[196:199]
 ds_read_b64_tr_b16 a[156:157], v4 offset:57344
 ds_read_b64_tr_b16 a[158:159], v4 offset:58368
M v[200:203], a[160:163], a[48:51], v[200:203]
 s_add_u32 m0, s87, 4096
M v[200:203], a[164:167], a[52:55], v[200:203]
 buffer_load_dwordx4 v25, s[60:63], s89 offen offset:0 nt lds
M v[204:207], a[164:167], a[60:63], v[204:207]
 s_add_u32 s89, s89, 114688
M v[204:207], a[160:163], a[56:59], v[204:207]
M v[208:211], a[160:163], a[64:67], v[208:211]
M v[208:211], a[164:167], a[68:71], v[208:211]
M v[212:215], a[164:167], a[76:79], v[212:215]
M v[212:215], a[160:163], a[72:75], v[212:215]
M v[216:219], a[160:163], a[80:83], v[216:219]
M v[216:219], a[164:167], a[84:87], v[216:219]
 s_waitcnt lgkmcnt(2)
M v[220:223], a[164:167], a[92:95], v[220:223]
 s_waitcnt vmcnt(18) lgkmcnt(0)
M v[220:223], a[160:163], a[88:91], v[220:223]
 s_barrier
M v[252:255], a[168:171], a[88:91], v[252:255]
 ds_read_b128 a[160:163], v5 offset:32768
 ds_read_b128 a[164:167], v6 offset:32768
M v[252:255], a[172:175], a[92:95], v[252:255]
 v_and_b32 v26, 48, v0
 v_lshlrev_b32 v26, 17, v26
M v[248:251], a[172:175], a[84:87], v[248:251]
 v_or_b32 v26, v26, v0
 v_lshl_add_u32 v26, v26, 7, s95
M v[248:251], a[168:171], a[80:83], v[248:251]
 buffer_load_dword a240, v26, s[76:79], 0 offen offset:0
M v[244:247], a[168:171], a[72:75], v[244:247]
M v[244:247], a[172:175], a[76:79], v[244:247]
M v[240:243], a[172:175], a[68:71], v[240:243]
M v[240:243], a[168:171], a[64:67], v[240:243]
M v[236:239], a[168:171], a[56:59], v[236:239]
M v[236:239], a[172:175], a[60:63], v[236:239]
M v[232:235], a[172:175], a[52:55], v[232:235]
M v[232:235], a[168:171], a[48:51], v[232:235]
M v[228:231], a[168:171], a[40:43], v[228:231]
M v[228:231], a[172:175], a[44:47], v[228:231]
 s_waitcnt lgkmcnt(0)
M v[224:227], a[172:175], a[36:39], v[224:227]
M v[224:227], a[168:171], a[32:35], v[224:227]
M a[0:3], a[160:163], a[96:99], a[0:3]
 ds_read_b128 a[168:171], v5 offset:34816
 ds_read_b128 a[172:175], v6 offset:34816
M a[0:3], a[164:167], a[100:103], a[0:3]
 ds_read_b64_tr_b16 a[32:33], v1 offset:0
 ds_read_b64_tr_b16 a[34:35], v1 offset:1024
M a[4:7], a[164:167], a[108:111], a[4:7]
 s_add_u32 m0, s24, 16384
M a[4:7], a[160:163], a[104:107], a[4:7]
 buffer_load_dwordx4 v12, s[48:51], s22 offen offset:0   lds
M a[8:11], a[160:163], a[112:115], a[8:11]
M a[8:11], a[164:167], a[116:119], a[8:11]
 s_lshl_b32 s67, s20, 11
M a[12:15], a[164:167], a[124:127], a[12:15]
 s_add_u32 s67, s67, 234938368
 ds_read_b64_tr_b16 a[36:37], v1 offset:8192
 ds_read_b64_tr_b16 a[38:39], v1 offset:9216
M a[12:15], a[160:163], a[120:123], a[12:15]
M a[16:19], a[160:163], a[128:131], a[16:19]
 buffer_load_dwordx4 v13, s[48:51], s22 offen offset:1024   lds
M a[16:19], a[164:167], a[132:135], a[16:19]
M a[20:23], a[164:167], a[140:143], a[20:23]
 buffer_load_dwordx4 v[16:19], v7, s[8:11], s67 offen offset:0 sc1
M a[20:23], a[160:163], a[136:139], a[20:23]
 ds_read_b64_tr_b16 a[40:41], v2 offset:0
 ds_read_b64_tr_b16 a[42:43], v2 offset:1024
M a[24:27], a[160:163], a[144:147], a[24:27]
 buffer_load_dwordx4 v[20:23], v7, s[8:11], s67 offen offset:1024 sc1
M a[24:27], a[164:167], a[148:151], a[24:27]
 s_waitcnt lgkmcnt(6)
M a[28:31], a[164:167], a[156:159], a[28:31]
 buffer_load_dwordx4 v14, s[48:51], s22 offen offset:2048   lds
M a[28:31], a[160:163], a[152:155], a[28:31]
M v[60:63], a[168:171], a[152:155], v[60:63]
 ds_read_b128 a[160:163], v5 offset:36864
 ds_read_b128 a[164:167], v6 offset:36864
M v[60:63], a[172:175], a[156:159], v[60:63]
 ds_read_b64_tr_b16 a[44:45], v2 offset:8192
 ds_read_b64_tr_b16 a[46:47], v2 offset:9216
M v[56:59], a[172:175], a[148:151], v[56:59]
 buffer_load_dwordx4 v15, s[48:51], s22 offen offset:3072   lds
M v[56:59], a[168:171], a[144:147], v[56:59]
 s_sub_u32 s22, s22, 2097024
M v[52:55], a[168:171], a[136:139], v[52:55]
M v[52:55], a[172:175], a[140:143], v[52:55]
 ds_read_b64_tr_b16 a[48:49], v3 offset:0
 ds_read_b64_tr_b16 a[50:51], v3 offset:1024
M v[48:51], a[172:175], a[132:135], v[48:51]
 s_add_u32 m0, s23, 49152
M v[48:51], a[168:171], a[128:131], v[48:51]
 buffer_load_dwordx4 v8, s[16:19], s21 offen offset:0  nt lds
M v[44:47], a[168:171], a[120:123], v[44:47]
M v[44:47], a[172:175], a[124:127], v[44:47]
M v[40:43], a[172:175], a[116:119], v[40:43]
 ds_read_b64_tr_b16 a[52:53], v3 offset:8192
 ds_read_b64_tr_b16 a[54:55], v3 offset:9216
M v[40:43], a[168:171], a[112:115], v[40:43]
M v[36:39], a[168:171], a[104:107], v[36:39]
 buffer_load_dwordx4 v9, s[16:19], s21 offen offset:1024  nt lds
M v[36:39], a[172:175], a[108:111], v[36:39]
 s_waitcnt lgkmcnt(6)
M v[32:35], a[172:175], a[100:103], v[32:35]
M v[32:35], a[168:171], a[96:99], v[32:35]
 ds_read_b64_tr_b16 a[56:57], v4 offset:0
 ds_read_b64_tr_b16 a[58:59], v4 offset:1024
M v[64:67], a[160:163], a[96:99], v[64:67]
 ds_read_b128 a[168:171], v5 offset:38912
 ds_read_b128 a[172:175], v6 offset:38912
M v[64:67], a[164:167], a[100:103], v[64:67]
 buffer_load_dwordx4 v10, s[16:19], s21 offen offset:2048  nt lds
M v[68:71], a[164:167], a[108:111], v[68:71]
M v[68:71], a[160:163], a[104:107], v[68:71]
M v[72:75], a[160:163], a[112:115], v[72:75]
 ds_read_b64_tr_b16 a[60:61], v4 offset:8192
 ds_read_b64_tr_b16 a[62:63], v4 offset:9216
M v[72:75], a[164:167], a[116:119], v[72:75]
M v[76:79], a[164:167], a[124:127], v[76:79]
 buffer_load_dwordx4 v11, s[16:19], s21 offen offset:3072  nt lds
M v[76:79], a[160:163], a[120:123], v[76:79]
 s_add_u32 s21, s21, 524160
M v[80:83], a[160:163], a[128:131], v[80:83]
M v[80:83], a[164:167], a[132:135], v[80:83]
M v[84:87], a[164:167], a[140:143], v[84:87]
M v[84:87], a[160:163], a[136:139], v[84:87]
M v[88:91], a[160:163], a[144:147], v[88:91]
M v[88:91], a[164:167], a[148:151], v[88:91]
 s_waitcnt lgkmcnt(2)
M v[92:95], a[164:167], a[156:159], v[92:95]
 s_waitcnt vmcnt(20) lgkmcnt(0)
M v[92:95], a[160:163], a[152:155], v[92:95]
 s_barrier
M v[124:127], a[168:171], a[152:155], v[124:127]
 ds_read_b128 a[160:163], v5 offset:49152
 ds_read_b128 a[164:167], v6 offset:49152
M v[124:127], a[172:175], a[156:159], v[124:127]
M v[120:123], a[172:175], a[148:151], v[120:123]
 s_add_u32 m0, s24, 32768
 ds_read_b64_tr_b16 a[64:65], v1 offset:16384
 ds_read_b64_tr_b16 a[66:67], v1 offset:17408
M v[120:123], a[168:171], a[144:147], v[120:123]
 buffer_load_dwordx4 v12, s[48:51], s22 offen offset:0   lds
M v[116:119], a[168:171], a[136:139], v[116:119]
M v[116:119], a[172:175], a[140:143], v[116:119]
M v[112:115], a[172:175], a[132:135], v[112:115]
M v[112:115], a[168:171], a[128:131], v[112:115]
M v[108:111], a[168:171], a[120:123], v[108:111]
M v[108:111], a[172:175], a[124:127], v[108:111]
 ds_read_b64_tr_b16 a[68:69], v1 offset:24576
 ds_read_b64_tr_b16 a[70:71], v1 offset:25600
M v[104:107], a[172:175], a[116:119], v[104:107]
 buffer_load_dwordx4 v13, s[48:51], s22 offen offset:1024   lds
M v[104:107], a[168:171], a[112:115], v[104:107]
M v[100:103], a[168:171], a[104:107], v[100:103]
M v[100:103], a[172:175], a[108:111], v[100:103]
 s_waitcnt lgkmcnt(4)
M v[96:99], a[172:175], a[100:103], v[96:99]
M v[96:99], a[168:171], a[96:99], v[96:99]
 buffer_load_dwordx4 v14, s[48:51], s22 offen offset:2048   lds
M v[128:131], a[160:163], a[96:99], v[128:131]
 ds_read_b128 a[168:171], v5 offset:51200
 ds_read_b128 a[172:175], v6 offset:51200
M v[128:131], a[164:167], a[100:103], v[128:131]
 ds_read_b64_tr_b16 a[72:73], v2 offset:16384
 ds_read_b64_tr_b16 a[74:75], v2 offset:17408
M v[132:135], a[164:167], a[108:111], v[132:135]
M v[132:135], a[160:163], a[104:107], v[132:135]
M v[136:139], a[160:163], a[112:115], v[136:139]
M v[136:139], a[164:167], a[116:119], v[136:139]
M v[140:143], a[164:167], a[124:127], v[140:143]
 buffer_load_dwordx4 v15, s[48:51], s22 offen offset:3072   lds
M v[140:143], a[160:163], a[120:123], v[140:143]
 s_add_u32 s22, s22, 2097152
 ds_read_b64_tr_b16 a[76:77], v2 offset:24576
 ds_read_b64_tr_b16 a[78:79], v2 offset:25600
M v[144:147], a[160:163], a[128:131], v[144:147]
M v[144:147], a[164:167], a[132:135], v[144:147]
M v[148:151], a[164:167], a[140:143], v[148:151]
M v[148:151], a[160:163], a[136:139], v[148:151]
 s_add_u32 m0, s23, 0
M v[152:155], a[160:163], a[144:147], v[152:155]
 buffer_load_dwordx4 v8, s[16:19], s21 offen offset:0  nt lds
M v[152:155], a[164:167], a[148:151], v[152:155]
 s_waitcnt lgkmcnt(4)
M v[156:159], a[164:167], a[156:159], v[156:159]
 ds_read_b64_tr_b16 a[80:81], v3 offset:16384
 ds_read_b64_tr_b16 a[82:83], v3 offset:17408
M v[156:159], a[160:163], a[152:155], v[156:159]
M v[188:191], a[168:171], a[152:155], v[188:191]
 ds_read_b128 a[160:163], v5 offset:53248
 ds_read_b128 a[164:167], v6 offset:53248
M v[188:191], a[172:175], a[156:159], v[188:191]
M v[184:187], a[172:175], a[148:151], v[184:187]
 buffer_load_dwordx4 v9, s[16:19], s21 offen offset:1024  nt lds
M v[184:187], a[168:171], a[144:147], v[184:187]
M v[180:183], a[168:171], a[136:139], v[180:183]
M v[180:183], a[172:175], a[140:143], v[180:183]
 ds_read_b64_tr_b16 a[84:85], v3 offset:24576
 ds_read_b64_tr_b16 a[86:87], v3 offset:25600
M v[176:179], a[172:175], a[132:135], v[176:179]
M v[176:179], a[168:171], a[128:131], v[176:179]
M v[172:175], a[168:171], a[120:123], v[172:175]
M v[172:175], a[172:175], a[124:127], v[172:175]
 buffer_load_dwordx4 v10, s[16:19], s21 offen offset:2048  nt lds
M v[168:171], a[172:175], a[116:119], v[168:171]
M v[168:171], a[168:171], a[112:115], v[168:171]
M v[164:167], a[168:171], a[104:107], v[164:167]
 ds_read_b64_tr_b16 a[88:89], v4 offset:16384
 ds_read_b64_tr_b16 a[90:91], v4 offset:17408
M v[164:167], a[172:175], a[108:111], v[164:167]
 s_waitcnt lgkmcnt(4)
M v[160:163], a[172:175], a[100:103], v[160:163]
M v[160:163], a[168:171], a[96:99], v[160:163]
 buffer_load_dwordx4 v11, s[16:19], s21 offen offset:3072  nt lds
M v[192:195], a[160:163], a[96:99], v[192:195]
 s_add_u32 s21, s21, 128
 ds_read_b128 a[168:171], v5 offset:55296
 ds_read_b128 a[172:175], v6 offset:55296
M v[192:195], a[164:167], a[100:103], v[192:195]
M v[196:199], a[164:167], a[108:111], v[196:199]
M v[196:199], a[160:163], a[104:107], v[196:199]
 ds_read_b64_tr_b16 a[92:93], v4 offset:24576
 ds_read_b64_tr_b16 a[94:95], v4 offset:25600
M v[200:203], a[160:163], a[112:115], v[200:203]
 s_add_u32 m0, s87, 5120
M v[200:203], a[164:167], a[116:119], v[200:203]
 buffer_load_dwordx4 v25, s[60:63], s89 offen offset:0 nt lds
M v[204:207], a[164:167], a[124:127], v[204:207]
 s_add_u32 s89, s89, 114688
M v[204:207], a[160:163], a[120:123], v[204:207]
M v[208:211], a[160:163], a[128:131], v[208:211]
M v[208:211], a[164:167], a[132:135], v[208:211]
M v[212:215], a[164:167], a[140:143], v[212:215]
M v[212:215], a[160:163], a[136:139], v[212:215]
M v[216:219], a[160:163], a[144:147], v[216:219]
M v[216:219], a[164:167], a[148:151], v[216:219]
 s_waitcnt lgkmcnt(2)
M v[220:223], a[164:167], a[156:159], v[220:223]
 s_waitcnt vmcnt(21) lgkmcnt(0)
M v[220:223], a[160:163], a[152:155], v[220:223]
 s_barrier
M v[252:255], a[168:171], a[152:155], v[252:255]
 ds_read_b128 a[160:163], v5 offset:0
 ds_read_b128 a[164:167], v6 offset:0
M v[252:255], a[172:175], a[156:159], v[252:255]
M v[248:251], a[172:175], a[148:151], v[248:251]
M v[248:251], a[168:171], a[144:147], v[248:251]
M v[244:247], a[168:171], a[136:139], v[244:247]
M v[244:247], a[172:175], a[140:143], v[244:247]
M v[240:243], a[172:175], a[132:135], v[240:243]
M v[240:243], a[168:171], a[128:131], v[240:243]
M v[236:239], a[168:171], a[120:123], v[236:239]
M v[236:239], a[172:175], a[124:127], v[236:239]
M v[232:235], a[172:175], a[116:119], v[232:235]
M v[232:235], a[168:171], a[112:115], v[232:235]
M v[228:231], a[168:171], a[104:107], v[228:231]
M v[228:231], a[172:175], a[108:111], v[228:231]
 s_waitcnt lgkmcnt(0)
M v[224:227], a[172:175], a[100:103], v[224:227]
M v[224:227], a[168:171], a[96:99], v[224:227]
M a[0:3], a[160:163], a[32:35], a[0:3]
 ds_read_b128 a[168:171], v5 offset:2048
 ds_read_b128 a[172:175], v6 offset:2048
M a[0:3], a[164:167], a[36:39], a[0:3]
 ds_read_b64_tr_b16 a[96:97], v1 offset:32768
 ds_read_b64_tr_b16 a[98:99], v1 offset:33792
M a[4:7], a[164:167], a[44:47], a[4:7]
 s_add_u32 m0, s24, 49152
M a[4:7], a[160:163], a[40:43], a[4:7]
 buffer_load_dwordx4 v12, s[48:51], s22 offen offset:0   lds
M a[8:11], a[160:163], a[48:51], a[8:11]
M a[8:11], a[164:167], a[52:55], a[8:11]
M a[12:15], a[164:167], a[60:63], a[12:15]
 ds_read_b64_tr_b16 a[100:101], v1 offset:40960
 ds_read_b64_tr_b16 a[102:103], v1 offset:41984
M a[12:15], a[160:163], a[56:59], a[12:15]
M a[16:19], a[160:163], a[64:67], a[16:19]
 buffer_load_dwordx4 v13, s[48:51], s22 offen offset:1024   lds
M a[16:19], a[164:167], a[68:71], a[16:19]
M a[20:23], a[164:167], a[76:79], a[20:23]
 s_waitcnt vmcnt(18)
 v_min3_u32 v28, v16, v17, v18
M a[20:23], a[160:163], a[72:75], a[20:23]
 ds_read_b64_tr_b16 a[104:105], v2 offset:32768
 ds_read_b64_tr_b16 a[106:107], v2 offset:33792
M a[24:27], a[160:163], a[80:83], a[24:27]
 s_waitcnt vmcnt(17)
 v_min3_u32 v28, v28, v19, v20
M a[24:27], a[164:167], a[84:87], a[24:27]
 s_waitcnt lgkmcnt(6)
 v_min3_u32 v28, v28, v21, v22
M a[28:31], a[164:167], a[92:95], a[28:31]
 buffer_load_dwordx4 v14, s[48:51], s22 offen offset:2048   lds
M a[28:31], a[160:163], a[88:91], a[28:31]
 v_min_u32 v28, v28, v23
M v[60:63], a[168:171], a[88:91], v[60:63]
 ds_read_b128 a[160:163], v5 offset:4096
 ds_read_b128 a[164:167], v6 offset:4096
M v[60:63], a[172:175], a[92:95], v[60:63]
 ds_read_b64_tr_b16 a[108:109], v2 offset:40960
 ds_read_b64_tr_b16 a[110:111], v2 offset:41984
M v[56:59], a[172:175], a[84:87], v[56:59]
 buffer_load_dwordx4 v15, s[48:51], s22 offen offset:3072   lds
M v[56:59], a[168:171], a[80:83], v[56:59]
 s_sub_u32 s22, s22, 2097024
 v_cmp_eq_u32 vcc, 0, v28
M v[52:55], a[168:171], a[72:75], v[52:55]
 s_nop 0
M v[52:55], a[172:175], a[76:79], v[52:55]
 s_cbranch_vccnz L_hs
L_hr:
 ds_read_b64_tr_b16 a[112:113], v3 offset:32768
 ds_read_b64_tr_b16 a[114:115], v3 offset:33792
M v[48:51], a[172:175], a[68:71], v[48:51]
 s_add_u32 m0, s23, 16384
 v_max_u32 v28, v16, v17
M v[48:51], a[168:171], a[64:67], v[48:51]
 buffer_load_dwordx4 v8, s[16:19], s21 offen offset:0  nt lds
M v[44:47], a[168:171], a[56:59], v[44:47]
 v_min_u32 v29, v16, v17
M v[44:47], a[172:175], a[60:63], v[44:47]
 v_med3_u32 v29, v28, v29, v18
M v[40:43], a[172:175], a[52:55], v[40:43]
 ds_read_b64_tr_b16 a[116:117], v3 offset:40960
 ds_read_b64_tr_b16 a[118:119], v3 offset:41984
M v[40:43], a[168:171], a[48:51], v[40:43]
 v_max_u32 v28, v28, v18
M v[36:39], a[168:171], a[40:43], v[36:39]
 buffer_load_dwordx4 v9, s[16:19], s21 offen offset:1024  nt lds
M v[36:39], a[172:175], a[44:47], v[36:39]
 s_waitcnt lgkmcnt(6)
 v_med3_u32 v29, v28, v29, v19
M v[32:35], a[172:175], a[36:39], v[32:35]
 v_max_u32 v28, v28, v19
M v[32:35], a[168:171], a[32:35], v[32:35]
 ds_read_b64_tr_b16 a[120:121], v4 offset:32768
 ds_read_b64_tr_b16 a[122:123], v4 offset:33792
M v[64:67], a[160:163], a[32:35], v[64:67]
 ds_read_b128 a[168:171], v5 offset:6144
 ds_read_b128 a[172:175], v6 offset:6144
M v[64:67], a[164:167], a[36:39], v[64:67]
 buffer_load_dwordx4 v10, s[16:19], s21 offen offset:2048  nt lds
M v[68:71], a[164:167], a[44:47], v[68:71]
 v_med3_u32 v29, v28, v29, v20
M v[68:71], a[160:163], a[40:43], v[68:71]
 v_max_u32 v28, v28, v20
M v[72:75], a[160:163], a[48:51], v[72:75]
 ds_read_b64_tr_b16 a[124:125], v4 offset:40960
 ds_read_b64_tr_b16 a[126:127], v4 offset:41984
M v[72:75], a[164:167], a[52:55], v[72:75]
 v_med3_u32 v29, v28, v29, v21
M v[76:79], a[164:167], a[60:63], v[76:79]
 buffer_load_dwordx4 v11, s[16:19], s21 offen offset:3072  nt lds
M v[76:79], a[160:163], a[56:59], v[76:79]
 s_add_u32 s21, s21, 524160
 v_max_u32 v28, v28, v21
M v[80:83], a[160:163], a[64:67], v[80:83]
 v_med3_u32 v29, v28, v29, v22
M v[80:83], a[164:167], a[68:71], v[80:83]
 v_max_u32 v28, v28, v22
M v[84:87], a[164:167], a[76:79], v[84:87]
 v_med3_u32 v29, v28, v29, v23
M v[84:87], a[160:163], a[72:75], v[84:87]
 v_max_u32 v28, v28, v23
M v[88:91], a[160:163], a[80:83], v[88:91]
 s_nop 0
 v_mov_b32 v30, v28 row_ror:8 row_mask:0xf bank_mask:0xf
M v[88:91], a[164:167], a[84:87], v[88:91]
 s_waitcnt lgkmcnt(2)
 v_mov_b32 v31, v29 row_ror:8 row_mask:0xf bank_mask:0xf
M v[92:95], a[164:167], a[92:95], v[92:95]
 s_waitcnt vmcnt(17) lgkmcnt(0)
 v_min_u32 v16, v28, v30
M v[92:95], a[160:163], a[88:91], v[92:95]
 s_barrier
M v[124:127], a[168:171], a[88:91], v[124:127]
 ds_read_b128 a[160:163], v5 offset:16384
 ds_read_b128 a[164:167], v6 offset:16384
M v[124:127], a[172:175], a[92:95], v[124:127]
 v_max_u32 v28, v28, v30
M v[120:123], a[172:175], a[84:87], v[120:123]
 s_add_u32 m0, s24, 0
 ds_read_b64_tr_b16 a[128:129], v1 offset:49152
 ds_read_b64_tr_b16 a[130:131], v1 offset:50176
M v[120:123], a[168:171], a[80:83], v[120:123]
 buffer_load_dwordx4 v12, s[48:51], s22 offen offset:0   lds
M v[116:119], a[168:171], a[72:75], v[116:119]
 v_max3_u32 v29, v29, v31, v16
M v[116:119], a[172:175], a[76:79], v[116:119]
 v_mov_b32 v30, v28 row_ror:4 row_mask:0xf bank_mask:0xf
M v[112:115], a[172:175], a[68:71], v[112:115]
 v_mov_b32 v31, v29 row_ror:4 row_mask:0xf bank_mask:0xf
M v[112:115], a[168:171], a[64:67], v[112:115]
 v_min_u32 v16, v28, v30
M v[108:111], a[168:171], a[56:59], v[108:111]
 v_max_u32 v28, v28, v30
M v[108:111], a[172:175], a[60:63], v[108:111]
 ds_read_b64_tr_b16 a[132:133], v1 offset:57344
 ds_read_b64_tr_b16 a[134:135], v1 offset:58368
M v[104:107], a[172:175], a[52:55], v[104:107]
 buffer_load_dwordx4 v13, s[48:51], s22 offen offset:1024   lds
M v[104:107], a[168:171], a[48:51], v[104:107]
 v_max3_u32 v29, v29, v31, v16
M v[100:103], a[168:171], a[40:43], v[100:103]
 v_mov_b32 v30, v28 row_ror:2 row_mask:0xf bank_mask:0xf
M v[100:103], a[172:175], a[44:47], v[100:103]
 s_waitcnt lgkmcnt(4)
 v_mov_b32 v31, v29 row_ror:2 row_mask:0xf bank_mask:0xf
M v[96:99], a[172:175], a[36:39], v[96:99]
 v_min_u32 v16, v28, v30
M v[96:99], a[168:171], a[32:35], v[96:99]
 buffer_load_dwordx4 v14, s[48:51], s22 offen offset:2048   lds
M v[128:131], a[160:163], a[32:35], v[128:131]
 ds_read_b128 a[168:171], v5 offset:18432
 ds_read_b128 a[172:175], v6 offset:18432
M v[128:131], a[164:167], a[36:39], v[128:131]
 ds_read_b64_tr_b16 a[136:137], v2 offset:49152
 ds_read_b64_tr_b16 a[138:139], v2 offset:50176
M v[132:135], a[164:167], a[44:47], v[132:135]
 v_max_u32 v28, v28, v30
M v[132:135], a[160:163], a[40:43], v[132:135]
 v_max3_u32 v29, v29, v31, v16
M v[136:139], a[160:163], a[48:51], v[136:139]
 v_mov_b32 v30, v28 row_ror:1 row_mask:0xf bank_mask:0xf
M v[136:139], a[164:167], a[52:55], v[136:139]
 v_mov_b32 v31, v29 row_ror:1 row_mask:0xf bank_mask:0xf
M v[140:143], a[164:167], a[60:63], v[140:143]
 buffer_load_dwordx4 v15, s[48:51], s22 offen offset:3072   lds
M v[140:143], a[160:163], a[56:59], v[140:143]
 s_add_u32 s22, s22, 2097152
 ds_read_b64_tr_b16 a[140:141], v2 offset:57344
 ds_read_b64_tr_b16 a[142:143], v2 offset:58368
M v[144:147], a[160:163], a[64:67], v[144:147]
 v_min_u32 v16, v28, v30
M v[144:147], a[164:167], a[68:71], v[144:147]
 v_max_u32 v28, v28, v30
M v[148:151], a[164:167], a[76:79], v[148:151]
 v_max3_u32 v29, v29, v31, v16
M v[148:151], a[160:163], a[72:75], v[148:151]
 s_add_u32 m0, s23, 32768
 v_mov_b32 v30, v28
M v[152:155], a[160:163], a[80:83], v[152:155]
 buffer_load_dwordx4 v8, s[16:19], s21 offen offset:0  nt lds
M v[152:155], a[164:167], a[84:87], v[152:155]
 s_waitcnt lgkmcnt(4)
 v_mov_b32 v31, v29
M v[156:159], a[164:167], a[92:95], v[156:159]
 ds_read_b64_tr_b16 a[144:145], v3 offset:49152
 ds_read_b64_tr_b16 a[146:147], v3 offset:50176
M v[156:159], a[160:163], a[88:91], v[156:159]
 v_permlane16_swap_b32 v30, v28
M v[188:191], a[168:171], a[88:91], v[188:191]
 ds_read_b128 a[160:163], v5 offset:20480
 ds_read_b128 a[164:167], v6 offset:20480
M v[188:191], a[172:175], a[92:95], v[188:191]
 v_permlane16_swap_b32 v31, v29
M v[184:187], a[172:175], a[84:87], v[184:187]
 buffer_load_dwordx4 v9, s[16:19], s21 offen offset:1024  nt lds
M v[184:187], a[168:171], a[80:83], v[184:187]
 v_min_u32 v16, v28, v30
M v[180:183], a[168:171], a[72:75], v[180:183]
 v_max_u32 v28, v28, v30
M v[180:183], a[172:175], a[76:79], v[180:183]
 ds_read_b64_tr_b16 a[148:149], v3 offset:57344
 ds_read_b64_tr_b16 a[150:151], v3 offset:58368
M v[176:179], a[172:175], a[68:71], v[176:179]
 v_max3_u32 v29, v29, v31, v16
M v[176:179], a[168:171], a[64:67], v[176:179]
 v_mov_b32 v30, v28
M v[172:175], a[168:171], a[56:59], v[172:175]
 v_mov_b32 v31, v29
M v[172:175], a[172:175], a[60:63], v[172:175]
 buffer_load_dwordx4 v10, s[16:19], s21 offen offset:2048  nt lds
M v[168:171], a[172:175], a[52:55], v[168:171]
 v_permlane32_swap_b32 v30, v28
M v[168:171], a[168:171], a[48:51], v[168:171]
 v_permlane32_swap_b32 v31, v29
M v[164:167], a[168:171], a[40:43], v[164:167]
 ds_read_b64_tr_b16 a[152:153], v4 offset:49152
 ds_read_b64_tr_b16 a[154:155], v4 offset:50176
M v[164:167], a[172:175], a[44:47], v[164:167]
 s_waitcnt lgkmcnt(4)
 v_min_u32 v16, v28, v30
M v[160:163], a[172:175], a[36:39], v[160:163]
 v_max_u32 v28, v28, v30
M v[160:163], a[168:171], a[32:35], v[160:163]
 buffer_load_dwordx4 v11, s[16:19], s21 offen offset:3072  nt lds
M v[192:195], a[160:163], a[32:35], v[192:195]
 s_add_u32 s21, s21, 128
 ds_read_b128 a[168:171], v5 offset:22528
 ds_read_b128 a[172:175], v6 offset:22528
M v[192:195], a[164:167], a[36:39], v[192:195]
 v_max3_u32 v29, v29, v31, v16
M v[196:199], a[164:167], a[44:47], v[196:199]
 s_lshl_b32 s64, s20, 3
M v[196:199], a[160:163], a[40:43], v[196:199]
 s_add_u32 s64, s64, 159744
 ds_read_b64_tr_b16 a[156:157], v4 offset:57344
 ds_read_b64_tr_b16 a[158:159], v4 offset:58368
M v[200:203], a[160:163], a[48:51], v[200:203]
 s_add_u32 m0, s87, 6144
 v_mov_b32 v16, s64
M v[200:203], a[164:167], a[52:55], v[200:203]
 buffer_load_dwordx4 v25, s[60:63], s89 offen offset:0 nt lds
M v[204:207], a[164:167], a[60:63], v[204:207]
 s_add_u32 s89, s89, 114688
 ds_write_b64 v16, v[28:29]
M v[204:207], a[160:163], a[56:59], v[204:207]
M v[208:211], a[160:163], a[64:67], v[208:211]
M v[208:211], a[164:167], a[68:71], v[208:211]
M v[212:215], a[164:167], a[76:79], v[212:215]
M v[212:215], a[160:163], a[72:75], v[212:215]
M v[216:219], a[160:163], a[80:83], v[216:219]
M v[216:219], a[164:167], a[84:87], v[216:219]
 s_waitcnt lgkmcnt(3)
M v[220:223], a[164:167], a[92:95], v[220:223]
 s_waitcnt vmcnt(18) lgkmcnt(0)
M v[220:223], a[160:163], a[88:91], v[220:223]
 s_barrier
M v[252:255], a[168:171], a[88:91], v[252:255]
 ds_read_b128 a[160:163], v5 offset:32768
 ds_read_b128 a[164:167], v6 offset:32768
M v[252:255], a[172:175], a[92:95], v[252:255]
 buffer_load_dword a240, v24, s[32:35], 0 offen offset:1536
M v[248:251], a[172:175], a[84:87], v[248:251]
M v[248:251], a[168:171], a[80:83], v[248:251]
M v[244:247], a[168:171], a[72:75], v[244:247]
M v[244:247], a[172:175], a[76:79], v[244:247]
M v[240:243], a[172:175], a[68:71], v[240:243]
M v[240:243], a[168:171], a[64:67], v[240:243]
M v[236:239], a[168:171], a[56:59], v[236:239]
M v[236:239], a[172:175], a[60:63], v[236:239]
M v[232:235], a[172:175], a[52:55], v[232:235]
M v[232:235], a[168:171], a[48:51], v[232:235]
M v[228:231], a[168:171], a[40:43], v[228:231]
M v[228:231], a[172:175], a[44:47], v[228:231]
 s_waitcnt lgkmcnt(0)
M v[224:227], a[172:175], a[36:39], v[224:227]
M v[224:227], a[168:171], a[32:35], v[224:227]
M a[0:3], a[160:163], a[96:99], a[0:3]
 ds_read_b128 a[168:171], v5 offset:34816
 ds_read_b128 a[172:175], v6 offset:34816
M a[0:3], a[164:167], a[100:103], a[0:3]
 ds_read_b64_tr_b16 a[32:33], v1 offset:0
 ds_read_b64_tr_b16 a[34:35], v1 offset:1024
M a[4:7], a[164:167], a[108:111], a[4:7]
 s_add_u32 m0, s24, 16384
M a[4:7], a[160:163], a[104:107], a[4:7]
 buffer_load_dwordx4 v12, s[48:51], s22 offen offset:0   lds
M a[8:11], a[160:163], a[112:115], a[8:11]
 v_mov_b32 v28, 159744
M a[8:11], a[164:167], a[116:119], a[8:11]
 ds_read_b128 v[16:19], v28
M a[12:15], a[164:167], a[124:127], a[12:15]
 ds_read_b64_tr_b16 a[36:37], v1 offset:8192
 ds_read_b64_tr_b16 a[38:39], v1 offset:9216
M a[12:15], a[160:163], a[120:123], a[12:15]
 ds_read_b128 v[20:23], v28 offset:16
M a[16:19], a[160:163], a[128:131], a[16:19]
 buffer_load_dwordx4 v13, s[48:51], s22 offen offset:1024   lds
M a[16:19], a[164:167], a[132:135], a[16:19]
M a[20:23], a[164:167], a[140:143], a[20:23]
M a[20:23], a[160:163], a[136:139], a[20:23]
 ds_read_b64_tr_b16 a[40:41], v2 offset:0
 ds_read_b64_tr_b16 a[42:43], v2 offset:1024
M a[24:27], a[160:163], a[144:147], a[24:27]
M a[24:27], a[164:167], a[148:151], a[24:27]
 s_waitcnt lgkmcnt(8)
M a[28:31], a[164:167], a[156:159], a[28:31]
 buffer_load_dwordx4 v14, s[48:51], s22 offen offset:2048   lds
M a[28:31], a[160:163], a[152:155], a[28:31]
M v[60:63], a[168:171], a[152:155], v[60:63]
 ds_read_b128 a[160:163], v5 offset:36864
 ds_read_b128 a[164:167], v6 offset:36864
M v[60:63], a[172:175], a[156:159], v[60:63]
 ds_read_b64_tr_b16 a[44:45], v2 offset:8192
 ds_read_b64_tr_b16 a[46:47], v2 offset:9216
M v[56:59], a[172:175], a[148:151], v[56:59]
 buffer_load_dwordx4 v15, s[48:51], s22 offen offset:3072   lds
M v[56:59], a[168:171], a[144:147], v[56:59]
 s_sub_u32 s22, s22, 2097024
 s_waitcnt lgkmcnt(9)
 v_min_u32 v28, v16, v18
M v[52:55], a[168:171], a[136:139], v[52:55]
 v_max_u32 v16, v16, v18
M v[52:55], a[172:175], a[140:143], v[52:55]
 ds_read_b64_tr_b16 a[48:49], v3 offset:0
 ds_read_b64_tr_b16 a[50:51], v3 offset:1024
M v[48:51], a[172:175], a[132:135], v[48:51]
 s_add_u32 m0, s23, 49152
 v_max3_u32 v17, v17, v19, v28
M v[48:51], a[168:171], a[128:131], v[48:51]
 buffer_load_dwordx4 v8, s[16:19], s21 offen offset:0  nt lds
M v[44:47], a[168:171], a[120:123], v[44:47]
 s_waitcnt lgkmcnt(8)
 v_min_u32 v29, v20, v22
M v[44:47], a[172:175], a[124:127], v[44:47]
 v_max_u32 v20, v20, v22
M v[40:43], a[172:175], a[116:119], v[40:43]
 ds_read_b64_tr_b16 a[52:53], v3 offset:8192
 ds_read_b64_tr_b16 a[54:55], v3 offset:9216
M v[40:43], a[168:171], a[112:115], v[40:43]
 v_max3_u32 v21, v21, v23, v29
M v[36:39], a[168:171], a[104:107], v[36:39]
 buffer_load_dwordx4 v9, s[16:19], s21 offen offset:1024  nt lds
M v[36:39], a[172:175], a[108:111], v[36:39]
 s_waitcnt lgkmcnt(6)
 v_min_u32 v28, v16, v20
M v[32:35], a[172:175], a[100:103], v[32:35]
 v_max_u32 v16, v16, v20
M v[32:35], a[168:171], a[96:99], v[32:35]
 ds_read_b64_tr_b16 a[56:57], v4 offset:0
 ds_read_b64_tr_b16 a[58:59], v4 offset:1024
M v[64:67], a[160:163], a[96:99], v[64:67]
 ds_read_b128 a[168:171], v5 offset:38912
 ds_read_b128 a[172:175], v6 offset:38912
M v[64:67], a[164:167], a[100:103], v[64:67]
 buffer_load_dwordx4 v10, s[16:19], s21 offen offset:2048  nt lds
M v[68:71], a[164:167], a[108:111], v[68:71]
 v_max3_u32 v17, v17, v21, v28
M v[68:71], a[160:163], a[104:107], v[68:71]
 v_and_b32 v28, 1, v0
M v[72:75], a[160:163], a[112:115], v[72:75]
 ds_read_b64_tr_b16 a[60:61], v4 offset:8192
 ds_read_b64_tr_b16 a[62:63], v4 offset:9216
M v[72:75], a[164:167], a[116:119], v[72:75]
 v_cmp_eq_u32 vcc, 0, v28
M v[76:79], a[164:167], a[124:127], v[76:79]
 buffer_load_dwordx4 v11, s[16:19], s21 offen offset:3072  nt lds
M v[76:79], a[160:163], a[120:123], v[76:79]
 s_add_u32 s21, s21, 524160
 s_and_b32 s64, s20, 1
M v[80:83], a[160:163], a[128:131], v[80:83]
 s_mul_i32 s64, s64, 448
 v_cndmask_b32 v24, v17, v16, vcc
M v[80:83], a[164:167], a[132:135], v[80:83]
 v_and_b32 v24, 0x7ff, v24
M v[84:87], a[164:167], a[140:143], v[84:87]
 v_sub_u32 v24, 2047, v24
M v[84:87], a[160:163], a[136:139], v[84:87]
 v_mul_u32_u24 v28, 896, v24
M v[88:91], a[160:163], a[144:147], v[88:91]
 v_lshrrev_b32 v29, 4, v0
M v[88:91], a[164:167], a[148:151], v[88:91]
 s_waitcnt lgkmcnt(2)
 v_lshl_add_u32 v28, v29, 4, v28
M v[92:95], a[164:167], a[156:159], v[92:95]
 s_waitcnt vmcnt(18) lgkmcnt(0)
 v_bfe_u32 v30, v0, 1, 3
M v[92:95], a[160:163], a[152:155], v[92:95]
 s_barrier
M v[124:127], a[168:171], a[152:155], v[124:127]
 ds_read_b128 a[160:163], v5 offset:49152
 ds_read_b128 a[164:167], v6 offset:49152
M v[124:127], a[172:175], a[156:159], v[124:127]
 v_lshl_or_b32 v28, v30, 26, v28
M v[120:123], a[172:175], a[148:151], v[120:123]
 s_add_u32 m0, s24, 32768
 ds_read_b64_tr_b16 a[64:65], v1 offset:16384
 ds_read_b64_tr_b16 a[66:67], v1 offset:17408
M v[120:123], a[168:171], a[144:147], v[120:123]
 buffer_load_dwordx4 v12, s[48:51], s22 offen offset:0   lds
M v[116:119], a[168:171], a[136:139], v[116:119]
M v[116:119], a[172:175], a[140:143], v[116:119]
M v[112:115], a[172:175], a[132:135], v[112:115]
 buffer_load_dwordx4 a[208:211], v28, s[56:59], s64 offen offset:0
M v[112:115], a[168:171], a[128:131], v[112:115]
M v[108:111], a[168:171], a[120:123], v[108:111]
 buffer_load_dwordx4 a[212:215], v28, s[56:59], s64 offen offset:64
M v[108:111], a[172:175], a[124:127], v[108:111]
 ds_read_b64_tr_b16 a[68:69], v1 offset:24576
 ds_read_b64_tr_b16 a[70:71], v1 offset:25600
M v[104:107], a[172:175], a[116:119], v[104:107]
 buffer_load_dwordx4 v13, s[48:51], s22 offen offset:1024   lds
M v[104:107], a[168:171], a[112:115], v[104:107]
M v[100:103], a[168:171], a[104:107], v[100:103]
M v[100:103], a[172:175], a[108:111], v[100:103]
 s_waitcnt lgkmcnt(4)
M v[96:99], a[172:175], a[100:103], v[96:99]
 buffer_load_dwordx4 a[216:219], v28, s[56:59], s64 offen offset:128
M v[96:99], a[168:171], a[96:99], v[96:99]
M v[128:131], a[160:163], a[96:99], v[128:131]
 ds_read_b128 a[168:171], v5 offset:51200
 ds_read_b128 a[172:175], v6 offset:51200
M v[128:131], a[164:167], a[100:103], v[128:131]
 ds_read_b64_tr_b16 a[72:73], v2 offset:16384
 ds_read_b64_tr_b16 a[74:75], v2 offset:17408
M v[132:135], a[164:167], a[108:111], v[132:135]
 buffer_load_dwordx4 v14, s[48:51], s22 offen offset:2048   lds
M v[132:135], a[160:163], a[104:107], v[132:135]
M v[136:139], a[160:163], a[112:115], v[136:139]
 buffer_load_dwordx4 a[220:223], v28, s[56:59], s64 offen offset:192
M v[136:139], a[164:167], a[116:119], v[136:139]
M v[140:143], a[164:167], a[124:127], v[140:143]
 buffer_load_dwordx4 a[224:227], v28, s[56:59], s64 offen offset:256
M v[140:143], a[160:163], a[120:123], v[140:143]
 ds_read_b64_tr_b16 a[76:77], v2 offset:24576
 ds_read_b64_tr_b16 a[78:79], v2 offset:25600
M v[144:147], a[160:163], a[128:131], v[144:147]
 buffer_load_dwordx4 v15, s[48:51], s22 offen offset:3072   lds
M v[144:147], a[164:167], a[132:135], v[144:147]
 s_add_u32 s22, s22, 2097152
M v[148:151], a[164:167], a[140:143], v[148:151]
M v[148:151], a[160:163], a[136:139], v[148:151]
 buffer_load_dwordx4 a[228:231], v28, s[56:59], s64 offen offset:320
M v[152:155], a[160:163], a[144:147], v[152:155]
M v[152:155], a[164:167], a[148:151], v[152:155]
 s_waitcnt lgkmcnt(4)
M v[156:159], a[164:167], a[156:159], v[156:159]
 s_add_u32 m0, s23, 0
 ds_read_b64_tr_b16 a[80:81], v3 offset:16384
 ds_read_b64_tr_b16 a[82:83], v3 offset:17408
M v[156:159], a[160:163], a[152:155], v[156:159]
 buffer_load_dwordx4 v8, s[16:19], s21 offen offset:0  nt lds
M v[188:191], a[168:171], a[152:155], v[188:191]
 ds_read_b128 a[160:163], v5 offset:53248
 ds_read_b128 a[164:167], v6 offset:53248
M v[188:191], a[172:175], a[156:159], v[188:191]
 buffer_load_dwordx4 a[232:235], v28, s[56:59], s64 offen offset:384
M v[184:187], a[172:175], a[148:151], v[184:187]
 v_lshrrev_b32 v28, 4, v24
M v[184:187], a[168:171], a[144:147], v[184:187]
 v_lshlrev_b32 v28, 5, v28
M v[180:183], a[168:171], a[136:139], v[180:183]
 v_and_b32 v30, 15, v24
M v[180:183], a[172:175], a[140:143], v[180:183]
 ds_read_b64_tr_b16 a[84:85], v3 offset:24576
 ds_read_b64_tr_b16 a[86:87], v3 offset:25600
M v[176:179], a[172:175], a[132:135], v[176:179]
 buffer_load_dwordx4 v9, s[16:19], s21 offen offset:1024  nt lds
M v[176:179], a[168:171], a[128:131], v[176:179]
 v_add_lshl_u32 v28, v28, v30, 2
M v[172:175], a[168:171], a[120:123], v[172:175]
 v_lshrrev_b32 v30, 1, v0
M v[172:175], a[172:175], a[124:127], v[172:175]
 v_min_u32 v30, 1, v30
M v[168:171], a[172:175], a[116:119], v[168:171]
 v_lshl_or_b32 v28, v30, 29, v28
M v[168:171], a[168:171], a[112:115], v[168:171]
 s_mov_b32 s64, 234881024
M v[164:167], a[168:171], a[104:107], v[164:167]
 ds_read_b64_tr_b16 a[88:89], v4 offset:16384
 ds_read_b64_tr_b16 a[90:91], v4 offset:17408
M v[164:167], a[172:175], a[108:111], v[164:167]
 s_waitcnt lgkmcnt(4)
M v[160:163], a[172:175], a[100:103], v[160:163]
 buffer_load_dwordx4 v10, s[16:19], s21 offen offset:2048  nt lds
M v[160:163], a[168:171], a[96:99], v[160:163]
 buffer_load_dword v23, v28, s[8:11], s64 offen sc1
M v[192:195], a[160:163], a[96:99], v[192:195]
 ds_read_b128 a[168:171], v5 offset:55296
 ds_read_b128 a[172:175], v6 offset:55296
M v[192:195], a[164:167], a[100:103], v[192:195]
 v_bfe_u32 v28, v0, 2, 2
M v[196:199], a[164:167], a[108:111], v[196:199]
 v_lshl_add_u32 v28, v29, 3, v28
M v[196:199], a[160:163], a[104:107], v[196:199]
 ds_read_b64_tr_b16 a[92:93], v4 offset:24576
 ds_read_b64_tr_b16 a[94:95], v4 offset:25600
M v[200:203], a[160:163], a[112:115], v[200:203]
 buffer_load_dwordx4 v11, s[16:19], s21 offen offset:3072  nt lds
M v[200:203], a[164:167], a[116:119], v[200:203]
 s_add_u32 s21, s21, 128
 v_lshlrev_b32 v28, 5, v28
M v[204:207], a[164:167], a[124:127], v[204:207]
 v_and_b32 v30, 3, v0
M v[204:207], a[160:163], a[120:123], v[204:207]
 v_lshl_add_u32 v28, v30, 3, v28
M v[208:211], a[160:163], a[128:131], v[208:211]
 v_add_u32 v22, s87, v28
M v[208:211], a[164:167], a[132:135], v[208:211]
M v[212:215], a[164:167], a[140:143], v[212:215]
M v[212:215], a[160:163], a[136:139], v[212:215]
M v[216:219], a[160:163], a[144:147], v[216:219]
M v[216:219], a[164:167], a[148:151], v[216:219]
 s_waitcnt lgkmcnt(2)
M v[220:223], a[164:167], a[156:159], v[220:223]
 s_waitcnt vmcnt(26) lgkmcnt(0)
M v[220:223], a[160:163], a[152:155], v[220:223]
 s_barrier
M v[252:255], a[168:171], a[152:155], v[252:255]
 ds_read_b128 a[160:163], v5 offset:0
 ds_read_b128 a[164:167], v6 offset:0
M v[252:255], a[172:175], a[156:159], v[252:255]
M v[248:251], a[172:175], a[148:151], v[248:251]
M v[248:251], a[168:171], a[144:147], v[248:251]
M v[244:247], a[168:171], a[136:139], v[244:247]
M v[244:247], a[172:175], a[140:143], v[244:247]
M v[240:243], a[172:175], a[132:135], v[240:243]
M v[240:243], a[168:171], a[128:131], v[240:243]
M v[236:239], a[168:171], a[120:123], v[236:239]
M v[236:239], a[172:175], a[124:127], v[236:239]
M v[232:235], a[172:175], a[116:119], v[232:235]
M v[232:235], a[168:171], a[112:115], v[232:235]
M v[228:231], a[168:171], a[104:107], v[228:231]
M v[228:231], a[172:175], a[108:111], v[228:231]
 s_waitcnt lgkmcnt(0)
M v[224:227], a[172:175], a[100:103], v[224:227]
M v[224:227], a[168:171], a[96:99], v[224:227]
M a[0:3], a[160:163], a[32:35], a[0:3]
 ds_read_b128 a[168:171], v5 offset:2048
 ds_read_b128 a[172:175], v6 offset:2048
M a[0:3], a[164:167], a[36:39], a[0:3]
 ds_read_b64_tr_b16 a[96:97], v1 offset:32768
 ds_read_b64_tr_b16 a[98:99], v1 offset:33792
M a[4:7], a[164:167], a[44:47], a[4:7]
 s_add_u32 m0, s24, 49152
M a[4:7], a[160:163], a[40:43], a[4:7]
 buffer_load_dwordx4 v12, s[48:51], s22 offen offset:0   lds
M a[8:11], a[160:163], a[48:51], a[8:11]
M a[8:11], a[164:167], a[52:55], a[8:11]
M a[12:15], a[164:167], a[60:63], a[12:15]
 ds_read_b64_tr_b16 a[100:101], v1 offset:40960
 ds_read_b64_tr_b16 a[102:103], v1 offset:41984
M a[12:15], a[160:163], a[56:59], a[12:15]
M a[16:19], a[160:163], a[64:67], a[16:19]
 buffer_load_dwordx4 v13, s[48:51], s22 offen offset:1024   lds
M a[16:19], a[164:167], a[68:71], a[16:19]
M a[20:23], a[164:167], a[76:79], a[20:23]
M a[20:23], a[160:163], a[72:75], a[20:23]
 ds_read_b64_tr_b16 a[104:105], v2 offset:32768
 ds_read_b64_tr_b16 a[106:107], v2 offset:33792
M a[24:27], a[160:163], a[80:83], a[24:27]
M a[24:27], a[164:167], a[84:87], a[24:27]
 s_waitcnt lgkmcnt(6)
M a[28:31], a[164:167], a[92:95], a[28:31]
 buffer_load_dwordx4 v14, s[48:51], s22 offen offset:2048   lds
M a[28:31], a[160:163], a[88:91], a[28:31]
M v[60:63], a[168:171], a[88:91], v[60:63]
 ds_read_b128 a[160:163], v5 offset:4096
 ds_read_b128 a[164:167], v6 offset:4096
M v[60:63], a[172:175], a[92:95], v[60:63]
 ds_read_b64_tr_b16 a[108:109], v2 offset:40960
 ds_read_b64_tr_b16 a[110:111], v2 offset:41984
M v[56:59], a[172:175], a[84:87], v[56:59]
 buffer_load_dwordx4 v15, s[48:51], s22 offen offset:3072   lds
M v[56:59], a[168:171], a[80:83], v[56:59]
 s_sub_u32 s22, s22, 2097024
M v[52:55], a[168:171], a[72:75], v[52:55]
M v[52:55], a[172:175], a[76:79], v[52:55]
 ds_read_b64_tr_b16 a[112:113], v3 offset:32768
 ds_read_b64_tr_b16 a[114:115], v3 offset:33792
M v[48:51], a[172:175], a[68:71], v[48:51]
 s_add_u32 m0, s23, 16384
M v[48:51], a[168:171], a[64:67], v[48:51]
 buffer_load_dwordx4 v8, s[16:19], s21 offen offset:0  nt lds
M v[44:47], a[168:171], a[56:59], v[44:47]
M v[44:47], a[172:175], a[60:63], v[44:47]
M v[40:43], a[172:175], a[52:55], v[40:43]
 ds_read_b64_tr_b16 a[116:117], v3 offset:40960
 ds_read_b64_tr_b16 a[118:119], v3 offset:41984
M v[40:43], a[168:171], a[48:51], v[40:43]
M v[36:39], a[168:171], a[40:43], v[36:39]
 buffer_load_dwordx4 v9, s[16:19], s21 offen offset:1024  nt lds
M v[36:39], a[172:175], a[44:47], v[36:39]
 s_waitcnt lgkmcnt(6)
M v[32:35], a[172:175], a[36:39], v[32:35]
M v[32:35], a[168:171], a[32:35], v[32:35]
 ds_read_b64_tr_b16 a[120:121], v4 offset:32768
 ds_read_b64_tr_b16 a[122:123], v4 offset:33792
M v[64:67], a[160:163], a[32:35], v[64:67]
 ds_read_b128 a[168:171], v5 offset:6144
 ds_read_b128 a[172:175], v6 offset:6144
M v[64:67], a[164:167], a[36:39], v[64:67]
 buffer_load_dwordx4 v10, s[16:19], s21 offen offset:2048  nt lds
M v[68:71], a[164:167], a[44:47], v[68:71]
M v[68:71], a[160:163], a[40:43], v[68:71]
M v[72:75], a[160:163], a[48:51], v[72:75]
 ds_read_b64_tr_b16 a[124:125], v4 offset:40960
 ds_read_b64_tr_b16 a[126:127], v4 offset:41984
M v[72:75], a[164:167], a[52:55], v[72:75]
M v[76:79], a[164:167], a[60:63], v[76:79]
 buffer_load_dwordx4 v11, s[16:19], s21 offen offset:3072  nt lds
M v[76:79], a[160:163], a[56:59], v[76:79]
 s_add_u32 s21, s21, 524160
M v[80:83], a[160:163], a[64:67], v[80:83]
M v[80:83], a[164:167], a[68:71], v[80:83]
M v[84:87], a[164:167], a[76:79], v[84:87]
M v[84:87], a[160:163], a[72:75], v[84:87]
M v[88:91], a[160:163], a[80:83], v[88:91]
M v[88:91], a[164:167], a[84:87], v[88:91]
 s_waitcnt lgkmcnt(2)
M v[92:95], a[164:167], a[92:95], v[92:95]
 s_waitcnt vmcnt(24) lgkmcnt(0)
M v[92:95], a[160:163], a[88:91], v[92:95]
 s_barrier
M v[124:127], a[168:171], a[88:91], v[124:127]
 ds_read_b128 a[160:163], v5 offset:16384
 ds_read_b128 a[164:167], v6 offset:16384
M v[124:127], a[172:175], a[92:95], v[124:127]
M v[120:123], a[172:175], a[84:87], v[120:123]
 s_add_u32 m0, s24, 0
 ds_read_b64_tr_b16 a[128:129], v1 offset:49152
 ds_read_b64_tr_b16 a[130:131], v1 offset:50176
M v[120:123], a[168:171], a[80:83], v[120:123]
 buffer_load_dwordx4 v12, s[48:51], s22 offen offset:0   lds
M v[116:119], a[168:171], a[72:75], v[116:119]
 ds_read_b64_tr_b16 a[176:177], v22 offset:0
M v[116:119], a[172:175], a[76:79], v[116:119]
 ds_read_b64_tr_b16 a[178:179], v22 offset:128
 ds_read_b64_tr_b16 a[180:181], v22 offset:1024
M v[112:115], a[172:175], a[68:71], v[112:115]
 ds_read_b64_tr_b16 a[182:183], v22 offset:1152
M v[112:115], a[168:171], a[64:67], v[112:115]
 ds_read_b64_tr_b16 a[184:185], v22 offset:2048
 ds_read_b64_tr_b16 a[186:187], v22 offset:2176
M v[108:111], a[168:171], a[56:59], v[108:111]
 ds_read_b64_tr_b16 a[188:189], v22 offset:3072
M v[108:111], a[172:175], a[60:63], v[108:111]
 ds_read_b64_tr_b16 a[132:133], v1 offset:57344
 ds_read_b64_tr_b16 a[134:135], v1 offset:58368
M v[104:107], a[172:175], a[52:55], v[104:107]
 buffer_load_dwordx4 v13, s[48:51], s22 offen offset:1024   lds
M v[104:107], a[168:171], a[48:51], v[104:107]
 ds_read_b64_tr_b16 a[190:191], v22 offset:3200
M v[100:103], a[168:171], a[40:43], v[100:103]
M v[100:103], a[172:175], a[44:47], v[100:103]
 s_waitcnt lgkmcnt(12)
M v[96:99], a[172:175], a[36:39], v[96:99]
M v[96:99], a[168:171], a[32:35], v[96:99]
M v[128:131], a[160:163], a[32:35], v[128:131]
 ds_read_b128 a[168:171], v5 offset:18432
 ds_read_b128 a[172:175], v6 offset:18432
M v[128:131], a[164:167], a[36:39], v[128:131]
 ds_read_b64_tr_b16 a[136:137], v2 offset:49152
 ds_read_b64_tr_b16 a[138:139], v2 offset:50176
M v[132:135], a[164:167], a[44:47], v[132:135]
 buffer_load_dwordx4 v14, s[48:51], s22 offen offset:2048   lds
M v[132:135], a[160:163], a[40:43], v[132:135]
M v[136:139], a[160:163], a[48:51], v[136:139]
M v[136:139], a[164:167], a[52:55], v[136:139]
M v[140:143], a[164:167], a[60:63], v[140:143]
M v[140:143], a[160:163], a[56:59], v[140:143]
 ds_read_b64_tr_b16 a[140:141], v2 offset:57344
 ds_read_b64_tr_b16 a[142:143], v2 offset:58368
M v[144:147], a[160:163], a[64:67], v[144:147]
 buffer_load_dwordx4 v15, s[48:51], s22 offen offset:3072   lds
M v[144:147], a[164:167], a[68:71], v[144:147]
 s_add_u32 s22, s22, 2097152
M v[148:151], a[164:167], a[76:79], v[148:151]
M v[148:151], a[160:163], a[72:75], v[148:151]
M v[152:155], a[160:163], a[80:83], v[152:155]
M v[152:155], a[164:167], a[84:87], v[152:155]
 s_waitcnt lgkmcnt(4)
M v[156:159], a[164:167], a[92:95], v[156:159]
 s_add_u32 m0, s23, 32768
 ds_read_b64_tr_b16 a[144:145], v3 offset:49152
 ds_read_b64_tr_b16 a[146:147], v3 offset:50176
M v[156:159], a[160:163], a[88:91], v[156:159]
 buffer_load_dwordx4 v8, s[16:19], s21 offen offset:0  nt lds
 s_waitcnt vmcnt(27)
M v[16:19], a[176:179], a[208:211], 0
 s_waitcnt vmcnt(26)
M v[16:19], a[180:183], a[212:215], v[16:19]
 s_waitcnt vmcnt(24)
M v[16:19], a[184:187], a[216:219], v[16:19]
 s_waitcnt vmcnt(22)
M v[16:19], a[188:191], a[220:223], v[16:19]
M v[188:191], a[168:171], a[88:91], v[188:191]
 ds_read_b128 a[160:163], v5 offset:20480
 ds_read_b128 a[164:167], v6 offset:20480
M v[188:191], a[172:175], a[92:95], v[188:191]
 ds_read_b64_tr_b16 a[176:177], v22 offset:4096
M v[184:187], a[172:175], a[84:87], v[184:187]
 ds_read_b64_tr_b16 a[178:179], v22 offset:4224
 ds_read_b64_tr_b16 a[180:181], v22 offset:5120
M v[184:187], a[168:171], a[80:83], v[184:187]
 ds_read_b64_tr_b16 a[182:183], v22 offset:5248
M v[180:183], a[168:171], a[72:75], v[180:183]
 ds_read_b64_tr_b16 a[184:185], v22 offset:6144
M v[180:183], a[172:175], a[76:79], v[180:183]
 ds_read_b64_tr_b16 a[148:149], v3 offset:57344
 ds_read_b64_tr_b16 a[150:151], v3 offset:58368
M v[176:179], a[172:175], a[68:71], v[176:179]
 buffer_load_dwordx4 v9, s[16:19], s21 offen offset:1024  nt lds
M v[176:179], a[168:171], a[64:67], v[176:179]
 ds_read_b64_tr_b16 a[186:187], v22 offset:6272
M v[172:175], a[168:171], a[56:59], v[172:175]
M v[172:175], a[172:175], a[60:63], v[172:175]
M v[168:171], a[172:175], a[52:55], v[168:171]
M v[168:171], a[168:171], a[48:51], v[168:171]
M v[164:167], a[168:171], a[40:43], v[164:167]
 ds_read_b64_tr_b16 a[152:153], v4 offset:49152
 ds_read_b64_tr_b16 a[154:155], v4 offset:50176
M v[164:167], a[172:175], a[44:47], v[164:167]
 s_waitcnt lgkmcnt(10)
M v[160:163], a[172:175], a[36:39], v[160:163]
 buffer_load_dwordx4 v10, s[16:19], s21 offen offset:2048  nt lds
M v[160:163], a[168:171], a[32:35], v[160:163]
M v[192:195], a[160:163], a[32:35], v[192:195]
 ds_read_b128 a[168:171], v5 offset:22528
 ds_read_b128 a[172:175], v6 offset:22528
M v[192:195], a[164:167], a[36:39], v[192:195]
M v[196:199], a[164:167], a[44:47], v[196:199]
M v[196:199], a[160:163], a[40:43], v[196:199]
 ds_read_b64_tr_b16 a[156:157], v4 offset:57344
 ds_read_b64_tr_b16 a[158:159], v4 offset:58368
M v[200:203], a[160:163], a[48:51], v[200:203]
 buffer_load_dwordx4 v11, s[16:19], s21 offen offset:3072  nt lds
M v[200:203], a[164:167], a[52:55], v[200:203]
 s_add_u32 s21, s21, 128
M v[204:207], a[164:167], a[60:63], v[204:207]
M v[204:207], a[160:163], a[56:59], v[204:207]
M v[208:211], a[160:163], a[64:67], v[208:211]
M v[208:211], a[164:167], a[68:71], v[208:211]
M v[212:215], a[164:167], a[76:79], v[212:215]
M v[212:215], a[160:163], a[72:75], v[212:215]
M v[216:219], a[160:163], a[80:83], v[216:219]
M v[216:219], a[164:167], a[84:87], v[216:219]
 s_waitcnt lgkmcnt(2)
M v[220:223], a[164:167], a[92:95], v[220:223]
 s_waitcnt vmcnt(16) lgkmcnt(0)
M v[220:223], a[160:163], a[88:91], v[220:223]
 s_barrier
M v[16:19], a[176:179], a[224:227], v[16:19]
M v[16:19], a[180:183], a[228:231], v[16:19]
M v[16:19], a[184:187], a[232:235], v[16:19]
M v[252:255], a[168:171], a[88:91], v[252:255]
 ds_read_b128 a[160:163], v5 offset:32768
 ds_read_b128 a[164:167], v6 offset:32768
M v[252:255], a[172:175], a[92:95], v[252:255]
M v[248:251], a[172:175], a[84:87], v[248:251]
M v[248:251], a[168:171], a[80:83], v[248:251]
M v[244:247], a[168:171], a[72:75], v[244:247]
M v[244:247], a[172:175], a[76:79], v[244:247]
M v[240:243], a[172:175], a[68:71], v[240:243]
M v[240:243], a[168:171], a[64:67], v[240:243]
M v[236:239], a[168:171], a[56:59], v[236:239]
M v[236:239], a[172:175], a[60:63], v[236:239]
M v[232:235], a[172:175], a[52:55], v[232:235]
M v[232:235], a[168:171], a[48:51], v[232:235]
M v[228:231], a[168:171], a[40:43], v[228:231]
M v[228:231], a[172:175], a[44:47], v[228:231]
 s_waitcnt lgkmcnt(0)
M v[224:227], a[172:175], a[36:39], v[224:227]
M v[224:227], a[168:171], a[32:35], v[224:227]
M a[0:3], a[160:163], a[96:99], a[0:3]
 ds_read_b128 a[168:171], v5 offset:34816
 ds_read_b128 a[172:175], v6 offset:34816
M a[0:3], a[164:167], a[100:103], a[0:3]
 ds_read_b64_tr_b16 a[32:33], v1 offset:0
 ds_read_b64_tr_b16 a[34:35], v1 offset:1024
M a[4:7], a[164:167], a[108:111], a[4:7]
 s_add_u32 m0, s24, 16384
M a[4:7], a[160:163], a[104:107], a[4:7]
 buffer_load_dwordx4 v12, s[48:51], s22 offen offset:0   lds
M a[8:11], a[160:163], a[112:115], a[8:11]
M a[8:11], a[164:167], a[116:119], a[8:11]
 s_lshl_b32 s64, s20, 10
M a[12:15], a[164:167], a[124:127], a[12:15]
 s_add_u32 s64, s64, 159744
 ds_read_b64_tr_b16 a[36:37], v1 offset:8192
 ds_read_b64_tr_b16 a[38:39], v1 offset:9216
M a[12:15], a[160:163], a[120:123], a[12:15]
 v_add_u32 v21, s64, v7
 ds_write_b128 v21, v[16:19]
M a[16:19], a[160:163], a[128:131], a[16:19]
 buffer_load_dwordx4 v13, s[48:51], s22 offen offset:1024   lds
M a[16:19], a[164:167], a[132:135], a[16:19]
 s_mul_i32 s67, s86, 14336
M a[20:23], a[164:167], a[140:143], a[20:23]
 s_mul_i32 s64, s20, 224
M a[20:23], a[160:163], a[136:139], a[20:23]
 s_add_u32 s67, s67, s64
 ds_read_b64_tr_b16 a[40:41], v2 offset:0
 ds_read_b64_tr_b16 a[42:43], v2 offset:1024
M a[24:27], a[160:163], a[144:147], a[24:27]
 v_lshrrev_b32 v28, 4, v0
 v_mul_u32_u24 v28, 896, v28
M a[24:27], a[164:167], a[148:151], a[24:27]
 s_waitcnt lgkmcnt(7)
 v_and_b32 v29, 15, v0
 v_lshl_add_u32 v28, v29, 4, v28
M a[28:31], a[164:167], a[156:159], a[28:31]
 buffer_load_dwordx4 v14, s[48:51], s22 offen offset:2048   lds
M a[28:31], a[160:163], a[152:155], a[28:31]
 v_mov_b32 v30, 536870912
 v_cmp_gt_u32 vcc, 14, v29
M v[60:63], a[168:171], a[152:155], v[60:63]
 s_nop 0
 ds_read_b128 a[160:163], v5 offset:36864
 ds_read_b128 a[164:167], v6 offset:36864
M v[60:63], a[172:175], a[156:159], v[60:63]
 s_nop 0
 ds_read_b64_tr_b16 a[44:45], v2 offset:8192
 ds_read_b64_tr_b16 a[46:47], v2 offset:9216
M v[56:59], a[172:175], a[148:151], v[56:59]
 buffer_load_dwordx4 v15, s[48:51], s22 offen offset:3072   lds
M v[56:59], a[168:171], a[144:147], v[56:59]
 s_sub_u32 s22, s22, 2097024
 v_cndmask_b32 v28, v30, v28, vcc
 v_add_u32 v29, 2560, v28
M v[52:55], a[168:171], a[136:139], v[52:55]
 v_add_u32 v30, 5120, v28
 v_add_u32 v31, 7680, v28
M v[52:55], a[172:175], a[140:143], v[52:55]
 ds_read_b64_tr_b16 a[48:49], v3 offset:0
 ds_read_b64_tr_b16 a[50:51], v3 offset:1024
M v[48:51], a[172:175], a[132:135], v[48:51]
 s_add_u32 m0, s23, 49152
M v[48:51], a[168:171], a[128:131], v[48:51]
 buffer_load_dwordx4 v8, s[16:19], s21 offen offset:0  nt lds
M v[44:47], a[168:171], a[120:123], v[44:47]
M v[44:47], a[172:175], a[124:127], v[44:47]
M v[40:43], a[172:175], a[116:119], v[40:43]
 ds_read_b64_tr_b16 a[52:53], v3 offset:8192
 ds_read_b64_tr_b16 a[54:55], v3 offset:9216
M v[40:43], a[168:171], a[112:115], v[40:43]
M v[36:39], a[168:171], a[104:107], v[36:39]
 buffer_load_dwordx4 v9, s[16:19], s21 offen offset:1024  nt lds
M v[36:39], a[172:175], a[108:111], v[36:39]
 s_waitcnt lgkmcnt(6)
M v[32:35], a[172:175], a[100:103], v[32:35]
M v[32:35], a[168:171], a[96:99], v[32:35]
 ds_read_b64_tr_b16 a[56:57], v4 offset:0
 ds_read_b64_tr_b16 a[58:59], v4 offset:1024
M v[64:67], a[160:163], a[96:99], v[64:67]
 ds_read_b128 a[168:171], v5 offset:38912
 ds_read_b128 a[172:175], v6 offset:38912
M v[64:67], a[164:167], a[100:103], v[64:67]
 buffer_load_dwordx4 v10, s[16:19], s21 offen offset:2048  nt lds
M v[68:71], a[164:167], a[108:111], v[68:71]
M v[68:71], a[160:163], a[104:107], v[68:71]
M v[72:75], a[160:163], a[112:115], v[72:75]
 ds_read_b64_tr_b16 a[60:61], v4 offset:8192
 ds_read_b64_tr_b16 a[62:63], v4 offset:9216
M v[72:75], a[164:167], a[116:119], v[72:75]
M v[76:79], a[164:167], a[124:127], v[76:79]
 buffer_load_dwordx4 v11, s[16:19], s21 offen offset:3072  nt lds
M v[76:79], a[160:163], a[120:123], v[76:79]
 s_add_u32 s21, s21, 524160
M v[80:83], a[160:163], a[128:131], v[80:83]
M v[80:83], a[164:167], a[132:135], v[80:83]
M v[84:87], a[164:167], a[140:143], v[84:87]
M v[84:87], a[160:163], a[136:139], v[84:87]
M v[88:91], a[160:163], a[144:147], v[88:91]
M v[88:91], a[164:167], a[148:151], v[88:91]
 s_waitcnt lgkmcnt(2)
M v[92:95], a[164:167], a[156:159], v[92:95]
 s_waitcnt vmcnt(16) lgkmcnt(0)
M v[92:95], a[160:163], a[152:155], v[92:95]
 s_barrier
M v[124:127], a[168:171], a[152:155], v[124:127]
 ds_read_b128 a[160:163], v5 offset:49152
 ds_read_b128 a[164:167], v6 offset:49152
M v[124:127], a[172:175], a[156:159], v[124:127]
M v[120:123], a[172:175], a[148:151], v[120:123]
 s_add_u32 m0, s24, 32768
 ds_read_b64_tr_b16 a[64:65], v1 offset:16384
 ds_read_b64_tr_b16 a[66:67], v1 offset:17408
M v[120:123], a[168:171], a[144:147], v[120:123]
 buffer_load_dwordx4 v12, s[48:51], s22 offen offset:0   lds
M v[116:119], a[168:171], a[136:139], v[116:119]
M v[116:119], a[172:175], a[140:143], v[116:119]
M v[112:115], a[172:175], a[132:135], v[112:115]
M v[112:115], a[168:171], a[128:131], v[112:115]
 buffer_load_dwordx4 v13, s[48:51], s22 offen offset:1024   lds
M v[108:111], a[168:171], a[120:123], v[108:111]
M v[108:111], a[172:175], a[124:127], v[108:111]
 ds_read_b64_tr_b16 a[68:69], v1 offset:24576
 ds_read_b64_tr_b16 a[70:71], v1 offset:25600
M v[104:107], a[172:175], a[116:119], v[104:107]
M v[104:107], a[168:171], a[112:115], v[104:107]
M v[100:103], a[168:171], a[104:107], v[100:103]
 buffer_load_dwordx4 v14, s[48:51], s22 offen offset:2048   lds
M v[100:103], a[172:175], a[108:111], v[100:103]
 s_waitcnt lgkmcnt(4)
M v[96:99], a[172:175], a[100:103], v[96:99]
M v[96:99], a[168:171], a[96:99], v[96:99]
M v[128:131], a[160:163], a[96:99], v[128:131]
 ds_read_b128 a[168:171], v5 offset:51200
 ds_read_b128 a[172:175], v6 offset:51200
M v[128:131], a[164:167], a[100:103], v[128:131]
 ds_read_b64_tr_b16 a[72:73], v2 offset:16384
 ds_read_b64_tr_b16 a[74:75], v2 offset:17408
M v[132:135], a[164:167], a[108:111], v[132:135]
 buffer_load_dwordx4 v15, s[48:51], s22 offen offset:3072   lds
M v[132:135], a[160:163], a[104:107], v[132:135]
 s_add_u32 s22, s22, 2097152
M v[136:139], a[160:163], a[112:115], v[136:139]
M v[136:139], a[164:167], a[116:119], v[136:139]
 s_add_u32 m0, s23, 0
M v[140:143], a[164:167], a[124:127], v[140:143]
 buffer_load_dwordx4 v8, s[16:19], s21 offen offset:0  nt lds
M v[140:143], a[160:163], a[120:123], v[140:143]
 ds_read_b64_tr_b16 a[76:77], v2 offset:24576
 ds_read_b64_tr_b16 a[78:79], v2 offset:25600
M v[144:147], a[160:163], a[128:131], v[144:147]
M v[144:147], a[164:167], a[132:135], v[144:147]
M v[148:151], a[164:167], a[140:143], v[148:151]
 buffer_load_dwordx4 v9, s[16:19], s21 offen offset:1024  nt lds
M v[148:151], a[160:163], a[136:139], v[148:151]
M v[152:155], a[160:163], a[144:147], v[152:155]
M v[152:155], a[164:167], a[148:151], v[152:155]
 s_waitcnt lgkmcnt(4)
M v[156:159], a[164:167], a[156:159], v[156:159]
 ds_read_b64_tr_b16 a[80:81], v3 offset:16384
 ds_read_b64_tr_b16 a[82:83], v3 offset:17408
M v[156:159], a[160:163], a[152:155], v[156:159]
 buffer_load_dwordx4 v10, s[16:19], s21 offen offset:2048  nt lds
M v[188:191], a[168:171], a[152:155], v[188:191]
 ds_read_b128 a[160:163], v5 offset:53248
 ds_read_b128 a[164:167], v6 offset:53248
M v[188:191], a[172:175], a[156:159], v[188:191]
M v[184:187], a[172:175], a[148:151], v[184:187]
M v[184:187], a[168:171], a[144:147], v[184:187]
M v[180:183], a[168:171], a[136:139], v[180:183]
 buffer_load_dwordx4 v11, s[16:19], s21 offen offset:3072  nt lds
M v[180:183], a[172:175], a[140:143], v[180:183]
 s_add_u32 s21, s21, 128
 ds_read_b64_tr_b16 a[84:85], v3 offset:24576
 ds_read_b64_tr_b16 a[86:87], v3 offset:25600
M v[176:179], a[172:175], a[132:135], v[176:179]
M v[176:179], a[168:171], a[128:131], v[176:179]
M v[172:175], a[168:171], a[120:123], v[172:175]
 s_add_u32 m0, s87, 0
M v[172:175], a[172:175], a[124:127], v[172:175]
 buffer_load_dwordx4 v28, s[68:71], s67 offen offset:0 nt lds
M v[168:171], a[172:175], a[116:119], v[168:171]
M v[168:171], a[168:171], a[112:115], v[168:171]
M v[164:167], a[168:171], a[104:107], v[164:167]
 ds_read_b64_tr_b16 a[88:89], v4 offset:16384
 ds_read_b64_tr_b16 a[90:91], v4 offset:17408
M v[164:167], a[172:175], a[108:111], v[164:167]
 s_waitcnt lgkmcnt(4)
M v[160:163], a[172:175], a[100:103], v[160:163]
 buffer_load_dwordx4 v29, s[68:71], s67 offen offset:1024 nt lds
M v[160:163], a[168:171], a[96:99], v[160:163]
M v[192:195], a[160:163], a[96:99], v[192:195]
 ds_read_b128 a[168:171], v5 offset:55296
 ds_read_b128 a[172:175], v6 offset:55296
M v[192:195], a[164:167], a[100:103], v[192:195]
M v[196:199], a[164:167], a[108:111], v[196:199]
 buffer_load_dwordx4 v30, s[68:71], s67 offen offset:2048 nt lds
M v[196:199], a[160:163], a[104:107], v[196:199]
 ds_read_b64_tr_b16 a[92:93], v4 offset:24576
 ds_read_b64_tr_b16 a[94:95], v4 offset:25600
M v[200:203], a[160:163], a[112:115], v[200:203]
M v[200:203], a[164:167], a[116:119], v[200:203]
M v[204:207], a[164:167], a[124:127], v[204:207]
M v[204:207], a[160:163], a[120:123], v[204:207]
 buffer_load_dwordx4 v31, s[68:71], s67 offen offset:3072 nt lds
M v[208:211], a[160:163], a[128:131], v[208:211]
 s_add_u32 s67, s67, 0
M v[208:211], a[164:167], a[132:135], v[208:211]
M v[212:215], a[164:167], a[140:143], v[212:215]
M v[212:215], a[160:163], a[136:139], v[212:215]
M v[216:219], a[160:163], a[144:147], v[216:219]
M v[216:219], a[164:167], a[148:151], v[216:219]
 s_waitcnt lgkmcnt(2)
M v[220:223], a[164:167], a[156:159], v[220:223]
 s_waitcnt vmcnt(20) lgkmcnt(0)
M v[220:223], a[160:163], a[152:155], v[220:223]
 s_barrier
M v[252:255], a[168:171], a[152:155], v[252:255]
 ds_read_b128 a[160:163], v5 offset:0
 ds_read_b128 a[164:167], v6 offset:0
M v[252:255], a[172:175], a[156:159], v[252:255]
M v[248:251], a[172:175], a[148:151], v[248:251]
M v[248:251], a[168:171], a[144:147], v[248:251]
M v[244:247], a[168:171], a[136:139], v[244:247]
M v[244:247], a[172:175], a[140:143], v[244:247]
M v[240:243], a[172:175], a[132:135], v[240:243]
M v[240:243], a[168:171], a[128:131], v[240:243]
M v[236:239], a[168:171], a[120:123], v[236:239]
M v[236:239], a[172:175], a[124:127], v[236:239]
M v[232:235], a[172:175], a[116:119], v[232:235]
M v[232:235], a[168:171], a[112:115], v[232:235]
M v[228:231], a[168:171], a[104:107], v[228:231]
M v[228:231], a[172:175], a[108:111], v[228:231]
 s_waitcnt lgkmcnt(0)
M v[224:227], a[172:175], a[100:103], v[224:227]
M v[224:227], a[168:171], a[96:99], v[224:227]
M a[0:3], a[160:163], a[32:35], a[0:3]
 ds_read_b128 a[168:171], v5 offset:2048
 ds_read_b128 a[172:175], v6 offset:2048
M a[0:3], a[164:167], a[36:39], a[0:3]
 ds_read_b64_tr_b16 a[96:97], v1 offset:32768
 ds_read_b64_tr_b16 a[98:99], v1 offset:33792
M a[4:7], a[164:167], a[44:47], a[4:7]
 s_add_u32 m0, s24, 49152
 v_cvt_pk_bf16_f32 v23, v23, v23
 v_accvgpr_read_b32 v27, a241
M a[4:7], a[160:163], a[40:43], a[4:7]
 buffer_load_dwordx4 v12, s[48:51], s22 offen offset:0   lds
M a[8:11], a[160:163], a[48:51], a[8:11]
 v_and_b32 v23, 0xffff0000, v23
M a[8:11], a[164:167], a[52:55], a[8:11]
 v_mul_f32 v22, 0xbfb8aa3b, v23
M a[12:15], a[164:167], a[60:63], a[12:15]
 ds_read_b64_tr_b16 a[100:101], v1 offset:40960
 ds_read_b64_tr_b16 a[102:103], v1 offset:41984
M a[12:15], a[160:163], a[56:59], a[12:15]
 v_exp_f32 v22, v22
M a[16:19], a[160:163], a[64:67], a[16:19]
 buffer_load_dwordx4 v13, s[48:51], s22 offen offset:1024   lds
M a[16:19], a[164:167], a[68:71], a[16:19]
 v_add_f32 v22, 1.0, v22
M a[20:23], a[164:167], a[76:79], a[20:23]
 v_rcp_f32 v23, v22
M a[20:23], a[160:163], a[72:75], a[20:23]
 s_or_b32 s64, s86, s20
 ds_read_b64_tr_b16 a[104:105], v2 offset:32768
 ds_read_b64_tr_b16 a[106:107], v2 offset:33792
M a[24:27], a[160:163], a[80:83], a[24:27]
 s_min_u32 s64, s64, 1
 s_lshl_b32 s64, s64, 29
 v_lshrrev_b32 v22, 1, v0
M a[24:27], a[164:167], a[84:87], a[24:27]
 s_waitcnt lgkmcnt(6)
 v_min_u32 v22, 1, v22
M a[28:31], a[164:167], a[92:95], a[28:31]
 buffer_load_dwordx4 v14, s[48:51], s22 offen offset:2048   lds
M a[28:31], a[160:163], a[88:91], a[28:31]
 v_lshlrev_b32 v22, 29, v22
M v[60:63], a[168:171], a[88:91], v[60:63]
 ds_read_b128 a[160:163], v5 offset:4096
 ds_read_b128 a[164:167], v6 offset:4096
M v[60:63], a[172:175], a[92:95], v[60:63]
 ds_read_b64_tr_b16 a[108:109], v2 offset:40960
 ds_read_b64_tr_b16 a[110:111], v2 offset:41984
M v[56:59], a[172:175], a[84:87], v[56:59]
 buffer_load_dwordx4 v15, s[48:51], s22 offen offset:3072   lds
M v[56:59], a[168:171], a[80:83], v[56:59]
 s_sub_u32 s22, s22, 2097024
 v_lshl_or_b32 v22, v0, 2, v22
M v[52:55], a[168:171], a[72:75], v[52:55]
 v_or_b32 v22, s64, v22
M v[52:55], a[172:175], a[76:79], v[52:55]
 ds_read_b64_tr_b16 a[112:113], v3 offset:32768
 ds_read_b64_tr_b16 a[114:115], v3 offset:33792
M v[48:51], a[172:175], a[68:71], v[48:51]
 s_add_u32 m0, s23, 16384
 v_cvt_pk_bf16_f32 v23, v23, v23
M v[48:51], a[168:171], a[64:67], v[48:51]
 buffer_load_dwordx4 v8, s[16:19], s21 offen offset:0  nt lds
M v[44:47], a[168:171], a[56:59], v[44:47]
 v_and_b32 v23, 0xffff0000, v23
M v[44:47], a[172:175], a[60:63], v[44:47]
 s_mov_b32 s64, 234913792
M v[40:43], a[172:175], a[52:55], v[40:43]
 ds_read_b64_tr_b16 a[116:117], v3 offset:40960
 ds_read_b64_tr_b16 a[118:119], v3 offset:41984
M v[40:43], a[168:171], a[48:51], v[40:43]
 buffer_store_dword v24, v22, s[8:11], s64 offen sc1
M v[36:39], a[168:171], a[40:43], v[36:39]
 buffer_load_dwordx4 v9, s[16:19], s21 offen offset:1024  nt lds
M v[36:39], a[172:175], a[44:47], v[36:39]
 s_waitcnt lgkmcnt(6)
M v[32:35], a[172:175], a[36:39], v[32:35]
 buffer_store_dword v23, v22, s[8:11], s64 offen offset:8 sc1
M v[32:35], a[168:171], a[32:35], v[32:35]
 ds_read_b64_tr_b16 a[120:121], v4 offset:32768
 ds_read_b64_tr_b16 a[122:123], v4 offset:33792
M v[64:67], a[160:163], a[32:35], v[64:67]
 ds_read_b128 a[168:171], v5 offset:6144
 ds_read_b128 a[172:175], v6 offset:6144
M v[64:67], a[164:167], a[36:39], v[64:67]
 buffer_load_dwordx4 v10, s[16:19], s21 offen offset:2048  nt lds
M v[68:71], a[164:167], a[44:47], v[68:71]
 v_add_u32 v25, 159744, v7
M v[68:71], a[160:163], a[40:43], v[68:71]
 ds_read_b128 v[16:19], v25
M v[72:75], a[160:163], a[48:51], v[72:75]
 ds_read_b64_tr_b16 a[124:125], v4 offset:40960
 ds_read_b64_tr_b16 a[126:127], v4 offset:41984
M v[72:75], a[164:167], a[52:55], v[72:75]
 ds_read_b128 v[28:31], v25 offset:1024
 v_sub_f32 v48, v48, v27
M v[76:79], a[164:167], a[60:63], v[76:79]
 buffer_load_dwordx4 v11, s[16:19], s21 offen offset:3072  nt lds
M v[76:79], a[160:163], a[56:59], v[76:79]
 s_add_u32 s21, s21, 524160
 ds_read_b128 v[20:23], v25 offset:2048
 v_sub_f32 v49, v49, v27
M v[80:83], a[160:163], a[64:67], v[80:83]
 v_sub_f32 v50, v50, v27
 v_sub_f32 v51, v51, v27
M v[80:83], a[164:167], a[68:71], v[80:83]
 v_sub_f32 v52, v52, v27
 v_sub_f32 v53, v53, v27
M v[84:87], a[164:167], a[76:79], v[84:87]
 v_sub_f32 v54, v54, v27
 v_sub_f32 v55, v55, v27
M v[84:87], a[160:163], a[72:75], v[84:87]
 v_sub_f32 v56, v56, v27
 v_sub_f32 v57, v57, v27
M v[88:91], a[160:163], a[80:83], v[88:91]
 v_sub_f32 v58, v58, v27
 v_sub_f32 v59, v59, v27
M v[88:91], a[164:167], a[84:87], v[88:91]
 s_waitcnt lgkmcnt(5)
 v_sub_f32 v60, v60, v27
 v_sub_f32 v61, v61, v27
M v[92:95], a[164:167], a[92:95], v[92:95]
 s_waitcnt vmcnt(22) lgkmcnt(0)
 v_sub_f32 v62, v62, v27
 v_sub_f32 v63, v63, v27
M v[92:95], a[160:163], a[88:91], v[92:95]
 s_barrier
M v[124:127], a[168:171], a[88:91], v[124:127]
 ds_read_b128 a[160:163], v5 offset:16384
 ds_read_b128 a[164:167], v6 offset:16384
M v[124:127], a[172:175], a[92:95], v[124:127]
 v_add_f32 v16, v28, v16
M v[120:123], a[172:175], a[84:87], v[120:123]
 s_add_u32 m0, s24, 0
 ds_read_b64_tr_b16 a[128:129], v1 offset:49152
 ds_read_b64_tr_b16 a[130:131], v1 offset:50176
M v[120:123], a[168:171], a[80:83], v[120:123]
 buffer_load_dwordx4 v12, s[48:51], s22 offen offset:0   lds
M v[116:119], a[168:171], a[72:75], v[116:119]
 v_add_f32 v17, v29, v17
 v_sub_f32 v80, v80, v27
M v[116:119], a[172:175], a[76:79], v[116:119]
 v_add_f32 v18, v30, v18
 v_sub_f32 v81, v81, v27
M v[112:115], a[172:175], a[68:71], v[112:115]
 v_add_f32 v19, v31, v19
 v_sub_f32 v82, v82, v27
M v[112:115], a[168:171], a[64:67], v[112:115]
 ds_read_b128 v[28:31], v25 offset:3072
 v_sub_f32 v83, v83, v27
M v[108:111], a[168:171], a[56:59], v[108:111]
 v_cvt_pk_bf16_f32 v25, v16, v17
 v_sub_f32 v84, v84, v27
M v[108:111], a[172:175], a[60:63], v[108:111]
 ds_read_b64_tr_b16 a[132:133], v1 offset:57344
 ds_read_b64_tr_b16 a[134:135], v1 offset:58368
M v[104:107], a[172:175], a[52:55], v[104:107]
 buffer_load_dwordx4 v13, s[48:51], s22 offen offset:1024   lds
M v[104:107], a[168:171], a[48:51], v[104:107]
 v_lshlrev_b32 v16, 16, v25
 v_sub_f32 v85, v85, v27
M v[100:103], a[168:171], a[40:43], v[100:103]
 v_and_b32 v17, 0xffff0000, v25
 v_sub_f32 v86, v86, v27
M v[100:103], a[172:175], a[44:47], v[100:103]
 s_waitcnt lgkmcnt(5)
 v_cvt_pk_bf16_f32 v25, v18, v19
 v_sub_f32 v87, v87, v27
M v[96:99], a[172:175], a[36:39], v[96:99]
 v_lshlrev_b32 v18, 16, v25
 v_sub_f32 v88, v88, v27
M v[96:99], a[168:171], a[32:35], v[96:99]
 v_and_b32 v19, 0xffff0000, v25
 v_sub_f32 v89, v89, v27
M v[128:131], a[160:163], a[32:35], v[128:131]
 ds_read_b128 a[168:171], v5 offset:18432
 ds_read_b128 a[172:175], v6 offset:18432
M v[128:131], a[164:167], a[36:39], v[128:131]
 ds_read_b64_tr_b16 a[136:137], v2 offset:49152
 ds_read_b64_tr_b16 a[138:139], v2 offset:50176
M v[132:135], a[164:167], a[44:47], v[132:135]
 buffer_load_dwordx4 v14, s[48:51], s22 offen offset:2048   lds
M v[132:135], a[160:163], a[40:43], v[132:135]
 s_waitcnt lgkmcnt(6)
 v_add_f32 v20, v28, v20
 v_sub_f32 v90, v90, v27
M v[136:139], a[160:163], a[48:51], v[136:139]
 v_add_f32 v21, v29, v21
 v_sub_f32 v91, v91, v27
M v[136:139], a[164:167], a[52:55], v[136:139]
 v_add_f32 v22, v30, v22
 v_sub_f32 v92, v92, v27
M v[140:143], a[164:167], a[60:63], v[140:143]
 v_add_f32 v23, v31, v23
 v_sub_f32 v93, v93, v27
M v[140:143], a[160:163], a[56:59], v[140:143]
 ds_read_b64_tr_b16 a[140:141], v2 offset:57344
 ds_read_b64_tr_b16 a[142:143], v2 offset:58368
M v[144:147], a[160:163], a[64:67], v[144:147]
 buffer_load_dwordx4 v15, s[48:51], s22 offen offset:3072   lds
M v[144:147], a[164:167], a[68:71], v[144:147]
 s_add_u32 s22, s22, 2097152
 v_mul_f32 v28, 0xbfb8aa3b, v16
 v_sub_f32 v94, v94, v27
M v[148:151], a[164:167], a[76:79], v[148:151]
 v_mul_f32 v29, 0xbfb8aa3b, v17
 v_sub_f32 v95, v95, v27
M v[148:151], a[160:163], a[72:75], v[148:151]
 v_mul_f32 v30, 0xbfb8aa3b, v18
 v_sub_f32 v112, v112, v27
M v[152:155], a[160:163], a[80:83], v[152:155]
 v_mul_f32 v31, 0xbfb8aa3b, v19
 v_sub_f32 v113, v113, v27
M v[152:155], a[164:167], a[84:87], v[152:155]
 s_waitcnt lgkmcnt(4)
 v_exp_f32 v28, v28
M v[156:159], a[164:167], a[92:95], v[156:159]
 s_add_u32 m0, s23, 32768
 ds_read_b64_tr_b16 a[144:145], v3 offset:49152
 ds_read_b64_tr_b16 a[146:147], v3 offset:50176
M v[156:159], a[160:163], a[88:91], v[156:159]
 buffer_load_dwordx4 v8, s[16:19], s21 offen offset:0  nt lds
M v[188:191], a[168:171], a[88:91], v[188:191]
 ds_read_b128 a[160:163], v5 offset:20480
 ds_read_b128 a[164:167], v6 offset:20480
M v[188:191], a[172:175], a[92:95], v[188:191]
 v_exp_f32 v29, v29
M v[184:187], a[172:175], a[84:87], v[184:187]
 v_exp_f32 v30, v30
M v[184:187], a[168:171], a[80:83], v[184:187]
 v_exp_f32 v31, v31
M v[180:183], a[168:171], a[72:75], v[180:183]
 v_cvt_pk_bf16_f32 v25, v20, v21
 v_sub_f32 v114, v114, v27
M v[180:183], a[172:175], a[76:79], v[180:183]
 ds_read_b64_tr_b16 a[148:149], v3 offset:57344
 ds_read_b64_tr_b16 a[150:151], v3 offset:58368
M v[176:179], a[172:175], a[68:71], v[176:179]
 buffer_load_dwordx4 v9, s[16:19], s21 offen offset:1024  nt lds
M v[176:179], a[168:171], a[64:67], v[176:179]
 v_lshlrev_b32 v20, 16, v25
 v_sub_f32 v115, v115, v27
M v[172:175], a[168:171], a[56:59], v[172:175]
 v_and_b32 v21, 0xffff0000, v25
 v_sub_f32 v116, v116, v27
M v[172:175], a[172:175], a[60:63], v[172:175]
 v_cvt_pk_bf16_f32 v25, v22, v23
 v_sub_f32 v117, v117, v27
M v[168:171], a[172:175], a[52:55], v[168:171]
 v_lshlrev_b32 v22, 16, v25
 v_sub_f32 v118, v118, v27
M v[168:171], a[168:171], a[48:51], v[168:171]
 v_and_b32 v23, 0xffff0000, v25
 v_sub_f32 v119, v119, v27
M v[164:167], a[168:171], a[40:43], v[164:167]
 ds_read_b64_tr_b16 a[152:153], v4 offset:49152
 ds_read_b64_tr_b16 a[154:155], v4 offset:50176
M v[164:167], a[172:175], a[44:47], v[164:167]
 s_waitcnt lgkmcnt(4)
 v_add_f32 v28, 1.0, v28
 v_sub_f32 v120, v120, v27
M v[160:163], a[172:175], a[36:39], v[160:163]
 buffer_load_dwordx4 v10, s[16:19], s21 offen offset:2048  nt lds
M v[160:163], a[168:171], a[32:35], v[160:163]
 v_add_f32 v29, 1.0, v29
 v_sub_f32 v121, v121, v27
M v[192:195], a[160:163], a[32:35], v[192:195]
 ds_read_b128 a[168:171], v5 offset:22528
 ds_read_b128 a[172:175], v6 offset:22528
M v[192:195], a[164:167], a[36:39], v[192:195]
 v_add_f32 v30, 1.0, v30
 v_sub_f32 v122, v122, v27
M v[196:199], a[164:167], a[44:47], v[196:199]
 v_add_f32 v31, 1.0, v31
 v_sub_f32 v123, v123, v27
M v[196:199], a[160:163], a[40:43], v[196:199]
 ds_read_b64_tr_b16 a[156:157], v4 offset:57344
 ds_read_b64_tr_b16 a[158:159], v4 offset:58368
M v[200:203], a[160:163], a[48:51], v[200:203]
 buffer_load_dwordx4 v11, s[16:19], s21 offen offset:3072  nt lds
M v[200:203], a[164:167], a[52:55], v[200:203]
 s_add_u32 s21, s21, 128
 v_rcp_f32 v28, v28
M v[204:207], a[164:167], a[60:63], v[204:207]
 v_rcp_f32 v29, v29
M v[204:207], a[160:163], a[56:59], v[204:207]
 v_rcp_f32 v30, v30
M v[208:211], a[160:163], a[64:67], v[208:211]
 v_rcp_f32 v31, v31
M v[208:211], a[164:167], a[68:71], v[208:211]
 v_mul_f32 v16, v28, v16
 v_sub_f32 v124, v124, v27
M v[212:215], a[164:167], a[76:79], v[212:215]
 v_mul_f32 v17, v29, v17
 v_sub_f32 v125, v125, v27
M v[212:215], a[160:163], a[72:75], v[212:215]
 v_mul_f32 v18, v30, v18
 v_sub_f32 v126, v126, v27
M v[216:219], a[160:163], a[80:83], v[216:219]
 v_mul_f32 v19, v31, v19
 v_sub_f32 v127, v127, v27
M v[216:219], a[164:167], a[84:87], v[216:219]
 s_waitcnt lgkmcnt(2)
 v_cvt_pk_bf16_f32 v25, v16, v17
 v_sub_f32 v128, v128, v27
M v[220:223], a[164:167], a[92:95], v[220:223]
 s_waitcnt vmcnt(22) lgkmcnt(0)
 v_lshlrev_b32 v16, 16, v25
 v_sub_f32 v129, v129, v27
M v[220:223], a[160:163], a[88:91], v[220:223]
 s_barrier
M v[252:255], a[168:171], a[88:91], v[252:255]
 ds_read_b128 a[160:163], v5 offset:32768
 ds_read_b128 a[164:167], v6 offset:32768
M v[252:255], a[172:175], a[92:95], v[252:255]
 v_and_b32 v17, 0xffff0000, v25
 v_sub_f32 v130, v130, v27
M v[248:251], a[172:175], a[84:87], v[248:251]
 v_cvt_pk_bf16_f32 v25, v18, v19
 v_sub_f32 v131, v131, v27
M v[248:251], a[168:171], a[80:83], v[248:251]
 v_lshlrev_b32 v18, 16, v25
 v_sub_f32 v132, v132, v27
M v[244:247], a[168:171], a[72:75], v[244:247]
 v_and_b32 v19, 0xffff0000, v25
 v_sub_f32 v133, v133, v27
M v[244:247], a[172:175], a[76:79], v[244:247]
 v_mul_f32 v16, v20, v16
 v_sub_f32 v134, v134, v27
M v[240:243], a[172:175], a[68:71], v[240:243]
 v_mul_f32 v17, v21, v17
 v_sub_f32 v135, v135, v27
M v[240:243], a[168:171], a[64:67], v[240:243]
 v_mul_f32 v18, v22, v18
 v_sub_f32 v136, v136, v27
M v[236:239], a[168:171], a[56:59], v[236:239]
 v_mul_f32 v19, v23, v19
 v_sub_f32 v137, v137, v27
M v[236:239], a[172:175], a[60:63], v[236:239]
 v_cvt_pk_bf16_f32 v16, v16, v17
 v_sub_f32 v138, v138, v27
M v[232:235], a[172:175], a[52:55], v[232:235]
 v_cvt_pk_bf16_f32 v17, v18, v19
 v_sub_f32 v139, v139, v27
M v[232:235], a[168:171], a[48:51], v[232:235]
 v_sub_f32 v140, v140, v27
 v_sub_f32 v141, v141, v27
M v[228:231], a[168:171], a[40:43], v[228:231]
 v_sub_f32 v142, v142, v27
 v_sub_f32 v143, v143, v27
M v[228:231], a[172:175], a[44:47], v[228:231]
 s_waitcnt lgkmcnt(0)
 v_sub_f32 v144, v144, v27
 v_sub_f32 v145, v145, v27
M v[224:227], a[172:175], a[36:39], v[224:227]
 v_sub_f32 v146, v146, v27
 v_sub_f32 v147, v147, v27
M v[224:227], a[168:171], a[32:35], v[224:227]
 v_sub_f32 v148, v148, v27
 v_sub_f32 v149, v149, v27
M a[0:3], a[160:163], a[96:99], a[0:3]
 ds_read_b128 a[168:171], v5 offset:34816
 ds_read_b128 a[172:175], v6 offset:34816
M a[0:3], a[164:167], a[100:103], a[0:3]
 ds_read_b64_tr_b16 a[32:33], v1 offset:0
 ds_read_b64_tr_b16 a[34:35], v1 offset:1024
M a[4:7], a[164:167], a[108:111], a[4:7]
 s_add_u32 m0, s24, 16384
 v_lshrrev_b32 v28, 2, v0
 v_lshlrev_b32 v28, 8, v28
M a[4:7], a[160:163], a[104:107], a[4:7]
 buffer_load_dwordx4 v12, s[48:51], s22 offen offset:0   lds
M a[8:11], a[160:163], a[112:115], a[8:11]
 v_and_b32 v29, 3, v0
 v_lshl_add_u32 v28, v29, 3, v28
M a[8:11], a[164:167], a[116:119], a[8:11]
 v_add_u32 v28, s87, v28
 v_sub_f32 v150, v150, v27
M a[12:15], a[164:167], a[124:127], a[12:15]
 s_waitcnt vmcnt(19)
 ds_read_b64_tr_b16 a[36:37], v1 offset:8192
 ds_read_b64_tr_b16 a[38:39], v1 offset:9216
M a[12:15], a[160:163], a[120:123], a[12:15]
 ds_read_b64_tr_b16 a[176:177], v28 offset:0
 v_sub_f32 v151, v151, v27
M a[16:19], a[160:163], a[128:131], a[16:19]
 buffer_load_dwordx4 v13, s[48:51], s22 offen offset:1024   lds
M a[16:19], a[164:167], a[132:135], a[16:19]
 ds_read_b64_tr_b16 a[178:179], v28 offset:32
 ds_read_b64_tr_b16 a[180:181], v28 offset:64
M a[20:23], a[164:167], a[140:143], a[20:23]
 ds_read_b64_tr_b16 a[182:183], v28 offset:96
 v_sub_f32 v152, v152, v27
M a[20:23], a[160:163], a[136:139], a[20:23]
 ds_read_b64_tr_b16 a[40:41], v2 offset:0
 ds_read_b64_tr_b16 a[42:43], v2 offset:1024
M a[24:27], a[160:163], a[144:147], a[24:27]
 ds_read_b64_tr_b16 a[184:185], v28 offset:128
 v_sub_f32 v153, v153, v27
M a[24:27], a[164:167], a[148:151], a[24:27]
 s_waitcnt lgkmcnt(11)
 ds_read_b64_tr_b16 a[186:187], v28 offset:160
 ds_read_b64_tr_b16 a[188:189], v28 offset:192
M a[28:31], a[164:167], a[156:159], a[28:31]
 buffer_load_dwordx4 v14, s[48:51], s22 offen offset:2048   lds
M a[28:31], a[160:163], a[152:155], a[28:31]
 v_sub_f32 v154, v154, v27
 v_sub_f32 v155, v155, v27
M v[60:63], a[168:171], a[152:155], v[60:63]
 ds_read_b128 a[160:163], v5 offset:36864
 ds_read_b128 a[164:167], v6 offset:36864
M v[60:63], a[172:175], a[156:159], v[60:63]
 ds_read_b64_tr_b16 a[44:45], v2 offset:8192
 ds_read_b64_tr_b16 a[46:47], v2 offset:9216
M v[56:59], a[172:175], a[148:151], v[56:59]
 buffer_load_dwordx4 v15, s[48:51], s22 offen offset:3072   lds
M v[56:59], a[168:171], a[144:147], v[56:59]
 s_sub_u32 s22, s22, 2097024
 v_sub_f32 v156, v156, v27
 v_sub_f32 v157, v157, v27
M v[52:55], a[168:171], a[136:139], v[52:55]
 v_sub_f32 v158, v158, v27
 v_sub_f32 v159, v159, v27
M v[52:55], a[172:175], a[140:143], v[52:55]
 ds_read_b64_tr_b16 a[48:49], v3 offset:0
 ds_read_b64_tr_b16 a[50:51], v3 offset:1024
M v[48:51], a[172:175], a[132:135], v[48:51]
 s_add_u32 m0, s23, 49152
M v[48:51], a[168:171], a[128:131], v[48:51]
 buffer_load_dwordx4 v8, s[16:19], s21 offen offset:0  nt lds
M v[44:47], a[168:171], a[120:123], v[44:47]
M v[44:47], a[172:175], a[124:127], v[44:47]
M v[40:43], a[172:175], a[116:119], v[40:43]
 ds_read_b64_tr_b16 a[52:53], v3 offset:8192
 ds_read_b64_tr_b16 a[54:55], v3 offset:9216
M v[40:43], a[168:171], a[112:115], v[40:43]
M v[36:39], a[168:171], a[104:107], v[36:39]
 buffer_load_dwordx4 v9, s[16:19], s21 offen offset:1024  nt lds
M v[36:39], a[172:175], a[108:111], v[36:39]
 s_waitcnt lgkmcnt(6)
M v[32:35], a[172:175], a[100:103], v[32:35]
M v[32:35], a[168:171], a[96:99], v[32:35]
 ds_read_b64_tr_b16 a[56:57], v4 offset:0
 ds_read_b64_tr_b16 a[58:59], v4 offset:1024
M v[64:67], a[160:163], a[96:99], v[64:67]
 ds_read_b128 a[168:171], v5 offset:38912
 ds_read_b128 a[172:175], v6 offset:38912
M v[64:67], a[164:167], a[100:103], v[64:67]
 buffer_load_dwordx4 v10, s[16:19], s21 offen offset:2048  nt lds
M v[68:71], a[164:167], a[108:111], v[68:71]
M v[68:71], a[160:163], a[104:107], v[68:71]
M v[72:75], a[160:163], a[112:115], v[72:75]
 ds_read_b64_tr_b16 a[60:61], v4 offset:8192
 ds_read_b64_tr_b16 a[62:63], v4 offset:9216
M v[72:75], a[164:167], a[116:119], v[72:75]
M v[76:79], a[164:167], a[124:127], v[76:79]
 buffer_load_dwordx4 v11, s[16:19], s21 offen offset:3072  nt lds
M v[76:79], a[160:163], a[120:123], v[76:79]
 s_add_u32 s21, s21, 524160
M v[80:83], a[160:163], a[128:131], v[80:83]
M v[80:83], a[164:167], a[132:135], v[80:83]
M v[84:87], a[164:167], a[140:143], v[84:87]
M v[84:87], a[160:163], a[136:139], v[84:87]
M v[88:91], a[160:163], a[144:147], v[88:91]
M v[88:91], a[164:167], a[148:151], v[88:91]
 s_waitcnt lgkmcnt(2)
M v[92:95], a[164:167], a[156:159], v[92:95]
 s_waitcnt vmcnt(16) lgkmcnt(0)
M v[92:95], a[160:163], a[152:155], v[92:95]
 s_barrier
 v_mfma_f32_16x16x16_bf16 a[208:211], a[176:177], v[16:17], 0
 v_mfma_f32_16x16x16_bf16 a[212:215], a[178:179], v[16:17], 0
 v_mfma_f32_16x16x16_bf16 a[216:219], a[180:181], v[16:17], 0
 v_mfma_f32_16x16x16_bf16 a[220:223], a[182:183], v[16:17], 0
 v_mfma_f32_16x16x16_bf16 a[224:227], a[184:185], v[16:17], 0
 v_mfma_f32_16x16x16_bf16 a[228:231], a[186:187], v[16:17], 0
 v_mfma_f32_16x16x16_bf16 a[232:235], a[188:189], v[16:17], 0
M v[124:127], a[168:171], a[152:155], v[124:127]
 ds_read_b128 a[160:163], v5 offset:49152
 ds_read_b128 a[164:167], v6 offset:49152
M v[124:127], a[172:175], a[156:159], v[124:127]
M v[120:123], a[172:175], a[148:151], v[120:123]
 s_add_u32 m0, s24, 32768
 ds_read_b64_tr_b16 a[64:65], v1 offset:16384
 ds_read_b64_tr_b16 a[66:67], v1 offset:17408
M v[120:123], a[168:171], a[144:147], v[120:123]
 buffer_load_dwordx4 v12, s[48:51], s22 offen offset:0   lds
M v[116:119], a[168:171], a[136:139], v[116:119]
M v[116:119], a[172:175], a[140:143], v[116:119]
M v[112:115], a[172:175], a[132:135], v[112:115]
M v[112:115], a[168:171], a[128:131], v[112:115]
M v[108:111], a[168:171], a[120:123], v[108:111]
M v[108:111], a[172:175], a[124:127], v[108:111]
 ds_read_b64_tr_b16 a[68:69], v1 offset:24576
 ds_read_b64_tr_b16 a[70:71], v1 offset:25600
M v[104:107], a[172:175], a[116:119], v[104:107]
 buffer_load_dwordx4 v13, s[48:51], s22 offen offset:1024   lds
M v[104:107], a[168:171], a[112:115], v[104:107]
M v[100:103], a[168:171], a[104:107], v[100:103]
M v[100:103], a[172:175], a[108:111], v[100:103]
 s_waitcnt lgkmcnt(4)
M v[96:99], a[172:175], a[100:103], v[96:99]
M v[96:99], a[168:171], a[96:99], v[96:99]
M v[128:131], a[160:163], a[96:99], v[128:131]
 ds_read_b128 a[168:171], v5 offset:51200
 ds_read_b128 a[172:175], v6 offset:51200
M v[128:131], a[164:167], a[100:103], v[128:131]
 ds_read_b64_tr_b16 a[72:73], v2 offset:16384
 ds_read_b64_tr_b16 a[74:75], v2 offset:17408
M v[132:135], a[164:167], a[108:111], v[132:135]
 buffer_load_dwordx4 v14, s[48:51], s22 offen offset:2048   lds
M v[132:135], a[160:163], a[104:107], v[132:135]
M v[136:139], a[160:163], a[112:115], v[136:139]
M v[136:139], a[164:167], a[116:119], v[136:139]
M v[140:143], a[164:167], a[124:127], v[140:143]
M v[140:143], a[160:163], a[120:123], v[140:143]
 ds_read_b64_tr_b16 a[76:77], v2 offset:24576
 ds_read_b64_tr_b16 a[78:79], v2 offset:25600
M v[144:147], a[160:163], a[128:131], v[144:147]
 buffer_load_dwordx4 v15, s[48:51], s22 offen offset:3072   lds
M v[144:147], a[164:167], a[132:135], v[144:147]
 s_add_u32 s22, s22, 2097152
M v[148:151], a[164:167], a[140:143], v[148:151]
M v[148:151], a[160:163], a[136:139], v[148:151]
M v[152:155], a[160:163], a[144:147], v[152:155]
M v[152:155], a[164:167], a[148:151], v[152:155]
 s_waitcnt lgkmcnt(4)
M v[156:159], a[164:167], a[156:159], v[156:159]
 s_add_u32 m0, s23, 0
 ds_read_b64_tr_b16 a[80:81], v3 offset:16384
 ds_read_b64_tr_b16 a[82:83], v3 offset:17408
M v[156:159], a[160:163], a[152:155], v[156:159]
 buffer_load_dwordx4 v8, s[52:55], s28 offen offset:0   lds
M v[188:191], a[168:171], a[152:155], v[188:191]
 ds_read_b128 a[160:163], v5 offset:53248
 ds_read_b128 a[164:167], v6 offset:53248
M v[188:191], a[172:175], a[156:159], v[188:191]
M v[184:187], a[172:175], a[148:151], v[184:187]
M v[184:187], a[168:171], a[144:147], v[184:187]
M v[180:183], a[168:171], a[136:139], v[180:183]
M v[180:183], a[172:175], a[140:143], v[180:183]
 ds_read_b64_tr_b16 a[84:85], v3 offset:24576
 ds_read_b64_tr_b16 a[86:87], v3 offset:25600
M v[176:179], a[172:175], a[132:135], v[176:179]
 buffer_load_dwordx4 v9, s[52:55], s28 offen offset:1024   lds
M v[176:179], a[168:171], a[128:131], v[176:179]
M v[172:175], a[168:171], a[120:123], v[172:175]
M v[172:175], a[172:175], a[124:127], v[172:175]
M v[168:171], a[172:175], a[116:119], v[168:171]
M v[168:171], a[168:171], a[112:115], v[168:171]
M v[164:167], a[168:171], a[104:107], v[164:167]
 ds_read_b64_tr_b16 a[88:89], v4 offset:16384
 ds_read_b64_tr_b16 a[90:91], v4 offset:17408
M v[164:167], a[172:175], a[108:111], v[164:167]
 s_waitcnt lgkmcnt(4)
M v[160:163], a[172:175], a[100:103], v[160:163]
 buffer_load_dwordx4 v10, s[52:55], s28 offen offset:2048   lds
M v[160:163], a[168:171], a[96:99], v[160:163]
M v[192:195], a[160:163], a[96:99], v[192:195]
 ds_read_b128 a[168:171], v5 offset:55296
 ds_read_b128 a[172:175], v6 offset:55296
M v[192:195], a[164:167], a[100:103], v[192:195]
M v[196:199], a[164:167], a[108:111], v[196:199]
M v[196:199], a[160:163], a[104:107], v[196:199]
 ds_read_b64_tr_b16 a[92:93], v4 offset:24576
 ds_read_b64_tr_b16 a[94:95], v4 offset:25600
M v[200:203], a[160:163], a[112:115], v[200:203]
 buffer_load_dwordx4 v11, s[52:55], s28 offen offset:3072   lds
M v[200:203], a[164:167], a[116:119], v[200:203]
 s_add_u32 s28, s28, 128
 v_sub_f32 v160, v160, v27
 v_sub_f32 v161, v161, v27
M v[204:207], a[164:167], a[124:127], v[204:207]
 v_sub_f32 v162, v162, v27
 v_sub_f32 v163, v163, v27
M v[204:207], a[160:163], a[120:123], v[204:207]
 v_sub_f32 v164, v164, v27
 v_sub_f32 v165, v165, v27
M v[208:211], a[160:163], a[128:131], v[208:211]
 v_sub_f32 v166, v166, v27
 v_sub_f32 v167, v167, v27
M v[208:211], a[164:167], a[132:135], v[208:211]
 v_sub_f32 v168, v168, v27
 v_sub_f32 v169, v169, v27
M v[212:215], a[164:167], a[140:143], v[212:215]
 v_sub_f32 v170, v170, v27
 v_sub_f32 v171, v171, v27
M v[212:215], a[160:163], a[136:139], v[212:215]
 v_sub_f32 v172, v172, v27
 v_sub_f32 v173, v173, v27
M v[216:219], a[160:163], a[144:147], v[216:219]
 v_sub_f32 v174, v174, v27
 v_sub_f32 v175, v175, v27
M v[216:219], a[164:167], a[148:151], v[216:219]
 s_waitcnt lgkmcnt(2)
 v_sub_f32 v176, v176, v27
 v_sub_f32 v177, v177, v27
M v[220:223], a[164:167], a[156:159], v[220:223]
 s_waitcnt vmcnt(16) lgkmcnt(0)
 v_sub_f32 v178, v178, v27
 v_sub_f32 v179, v179, v27
M v[220:223], a[160:163], a[152:155], v[220:223]
 s_barrier
M v[252:255], a[168:171], a[152:155], v[252:255]
 ds_read_b128 a[160:163], v5 offset:0
 ds_read_b128 a[164:167], v6 offset:0
M v[252:255], a[172:175], a[156:159], v[252:255]
 v_and_b32 v26, 48, v0
 v_lshlrev_b32 v26, 17, v26
M v[248:251], a[172:175], a[148:151], v[248:251]
 v_or_b32 v26, v26, v0
 v_lshl_add_u32 v26, v26, 7, s95
M v[248:251], a[168:171], a[144:147], v[248:251]
 buffer_load_dword a240, v26, s[76:79], 0 offen offset:0
M v[244:247], a[168:171], a[136:139], v[244:247]
 v_sub_f32 v180, v180, v27
 v_sub_f32 v181, v181, v27
M v[244:247], a[172:175], a[140:143], v[244:247]
 v_sub_f32 v182, v182, v27
 v_sub_f32 v183, v183, v27
M v[240:243], a[172:175], a[132:135], v[240:243]
 v_sub_f32 v184, v184, v27
 v_sub_f32 v185, v185, v27
M v[240:243], a[168:171], a[128:131], v[240:243]
 v_sub_f32 v186, v186, v27
 v_sub_f32 v187, v187, v27
M v[236:239], a[168:171], a[120:123], v[236:239]
 v_sub_f32 v188, v188, v27
 v_sub_f32 v189, v189, v27
M v[236:239], a[172:175], a[124:127], v[236:239]
 v_sub_f32 v190, v190, v27
 v_sub_f32 v191, v191, v27
M v[232:235], a[172:175], a[116:119], v[232:235]
 v_sub_f32 v192, v192, v27
 v_sub_f32 v193, v193, v27
M v[232:235], a[168:171], a[112:115], v[232:235]
 v_sub_f32 v194, v194, v27
 v_sub_f32 v195, v195, v27
M v[228:231], a[168:171], a[104:107], v[228:231]
 v_sub_f32 v196, v196, v27
 v_sub_f32 v197, v197, v27
M v[228:231], a[172:175], a[108:111], v[228:231]
 s_waitcnt lgkmcnt(0)
 v_sub_f32 v198, v198, v27
 v_sub_f32 v199, v199, v27
M v[224:227], a[172:175], a[100:103], v[224:227]
 v_sub_f32 v200, v200, v27
 v_sub_f32 v201, v201, v27
M v[224:227], a[168:171], a[96:99], v[224:227]
 v_sub_f32 v202, v202, v27
 v_sub_f32 v203, v203, v27
M a[0:3], a[160:163], a[32:35], a[0:3]
 ds_read_b128 a[168:171], v5 offset:2048
 ds_read_b128 a[172:175], v6 offset:2048
M a[0:3], a[164:167], a[36:39], a[0:3]
 ds_read_b64_tr_b16 a[96:97], v1 offset:32768
 ds_read_b64_tr_b16 a[98:99], v1 offset:33792
M a[4:7], a[164:167], a[44:47], a[4:7]
 s_add_u32 m0, s24, 49152
 v_lshrrev_b32 v28, 4, v0
 v_add_u32 v28, 0, v28
M a[4:7], a[160:163], a[40:43], a[4:7]
 buffer_load_dwordx4 v12, s[48:51], s22 offen offset:0   lds
M a[8:11], a[160:163], a[48:51], a[8:11]
 v_and_b32 v29, 7, v0
 v_xor_b32 v28, v28, v29
M a[8:11], a[164:167], a[52:55], a[8:11]
 v_lshlrev_b32 v28, 4, v28
 v_lshrrev_b32 v29, 3, v0
M a[12:15], a[164:167], a[60:63], a[12:15]
 ds_read_b64_tr_b16 a[100:101], v1 offset:40960
 ds_read_b64_tr_b16 a[102:103], v1 offset:41984
M a[12:15], a[160:163], a[56:59], a[12:15]
 buffer_load_dwordx4 v13, s[48:51], s22 offen offset:1024   lds
M a[16:19], a[160:163], a[64:67], a[16:19]
 v_mul_u32_u24 v29, 896, v29
 s_mul_i32 s64, s20, 28672
M a[16:19], a[164:167], a[68:71], a[16:19]
 buffer_load_dwordx4 v14, s[48:51], s22 offen offset:2048   lds
M a[20:23], a[164:167], a[76:79], a[20:23]
 s_add_u32 s64, s64, 0
 v_add3_u32 v16, v29, v28, s64
M a[20:23], a[160:163], a[72:75], a[20:23]
 ds_read_b64_tr_b16 a[104:105], v2 offset:32768
 ds_read_b64_tr_b16 a[106:107], v2 offset:33792
M a[24:27], a[160:163], a[80:83], a[24:27]
 v_add_u32 v18, 12288, v16
 v_lshrrev_b32 v28, 4, v0
M a[24:27], a[164:167], a[84:87], a[24:27]
 s_waitcnt lgkmcnt(6)
 v_add_u32 v28, 4, v28
 v_and_b32 v29, 7, v0
M a[28:31], a[164:167], a[92:95], a[28:31]
 buffer_load_dwordx4 v15, s[48:51], s22 offen offset:3072   lds
M a[28:31], a[160:163], a[88:91], a[28:31]
 s_sub_u32 s22, s22, 2097024
 v_xor_b32 v28, v28, v29
 v_lshlrev_b32 v28, 4, v28
M v[60:63], a[168:171], a[88:91], v[60:63]
 s_add_u32 m0, s23, 16384
 ds_read_b128 a[160:163], v5 offset:4096
 ds_read_b128 a[164:167], v6 offset:4096
M v[60:63], a[172:175], a[92:95], v[60:63]
 ds_read_b64_tr_b16 a[108:109], v2 offset:40960
 ds_read_b64_tr_b16 a[110:111], v2 offset:41984
M v[56:59], a[172:175], a[84:87], v[56:59]
 buffer_load_dwordx4 v8, s[52:55], s28 offen offset:0   lds
M v[56:59], a[168:171], a[80:83], v[56:59]
 v_lshrrev_b32 v29, 3, v0
 v_mul_u32_u24 v29, 896, v29
M v[52:55], a[168:171], a[72:75], v[52:55]
 buffer_load_dwordx4 v9, s[52:55], s28 offen offset:1024   lds
M v[52:55], a[172:175], a[76:79], v[52:55]
 ds_read_b64_tr_b16 a[112:113], v3 offset:32768
 ds_read_b64_tr_b16 a[114:115], v3 offset:33792
M v[48:51], a[172:175], a[68:71], v[48:51]
 s_mul_i32 s64, s20, 28672
 s_add_u32 s64, s64, 6144
M v[48:51], a[168:171], a[64:67], v[48:51]
 buffer_load_dwordx4 v10, s[52:55], s28 offen offset:2048   lds
M v[44:47], a[168:171], a[56:59], v[44:47]
 v_add3_u32 v17, v29, v28, s64
 v_add_u32 v19, 12288, v17
M v[44:47], a[172:175], a[60:63], v[44:47]
 v_add_u32 v20, 0x20000, v1
 v_add_u32 v21, 0x20000, v2
M v[40:43], a[172:175], a[52:55], v[40:43]
 ds_read_b64_tr_b16 a[116:117], v3 offset:40960
 ds_read_b64_tr_b16 a[118:119], v3 offset:41984
M v[40:43], a[168:171], a[48:51], v[40:43]
 buffer_load_dwordx4 v11, s[52:55], s28 offen offset:3072   lds
M v[36:39], a[168:171], a[40:43], v[36:39]
 s_add_u32 s28, s28, 1048448
 v_add_u32 v22, 0x20000, v3
 v_add_u32 v23, 0x20000, v4
M v[36:39], a[172:175], a[44:47], v[36:39]
 s_waitcnt lgkmcnt(6)
 v_sub_f32 v204, v204, v27
 v_sub_f32 v205, v205, v27
M v[32:35], a[172:175], a[36:39], v[32:35]
 s_add_u32 m0, s23, 131072
 v_sub_f32 v206, v206, v27
 v_sub_f32 v207, v207, v27
M v[32:35], a[168:171], a[32:35], v[32:35]
 ds_read_b64_tr_b16 a[120:121], v4 offset:32768
 ds_read_b64_tr_b16 a[122:123], v4 offset:33792
M v[64:67], a[160:163], a[32:35], v[64:67]
 ds_read_b128 a[168:171], v5 offset:6144
 ds_read_b128 a[172:175], v6 offset:6144
M v[64:67], a[164:167], a[36:39], v[64:67]
 buffer_load_dwordx4 v8, s[52:55], s28 offen offset:0   lds
M v[68:71], a[164:167], a[44:47], v[68:71]
 buffer_load_dwordx4 v9, s[52:55], s28 offen offset:1024   lds
M v[68:71], a[160:163], a[40:43], v[68:71]
 v_sub_f32 v208, v208, v27
 v_sub_f32 v209, v209, v27
M v[72:75], a[160:163], a[48:51], v[72:75]
 ds_read_b64_tr_b16 a[124:125], v4 offset:40960
 ds_read_b64_tr_b16 a[126:127], v4 offset:41984
M v[72:75], a[164:167], a[52:55], v[72:75]
 buffer_load_dwordx4 v10, s[52:55], s28 offen offset:2048   lds
M v[76:79], a[164:167], a[60:63], v[76:79]
 v_sub_f32 v210, v210, v27
 v_sub_f32 v211, v211, v27
M v[76:79], a[160:163], a[56:59], v[76:79]
 v_sub_f32 v212, v212, v27
 v_sub_f32 v213, v213, v27
M v[80:83], a[160:163], a[64:67], v[80:83]
 buffer_load_dwordx4 v11, s[52:55], s28 offen offset:3072   lds
M v[80:83], a[164:167], a[68:71], v[80:83]
 s_sub_u32 s28, s28, 524288
 v_sub_f32 v214, v214, v27
 v_sub_f32 v215, v215, v27
M v[84:87], a[164:167], a[76:79], v[84:87]
 v_sub_f32 v216, v216, v27
 v_sub_f32 v217, v217, v27
M v[84:87], a[160:163], a[72:75], v[84:87]
 v_sub_f32 v218, v218, v27
 v_sub_f32 v219, v219, v27
M v[88:91], a[160:163], a[80:83], v[88:91]
 v_sub_f32 v220, v220, v27
 v_sub_f32 v221, v221, v27
M v[88:91], a[164:167], a[84:87], v[88:91]
 s_waitcnt lgkmcnt(2)
 v_sub_f32 v222, v222, v27
 v_sub_f32 v223, v223, v27
M v[92:95], a[164:167], a[92:95], v[92:95]
 s_waitcnt vmcnt(21) lgkmcnt(0)
 v_sub_f32 v224, v224, v27
 v_sub_f32 v225, v225, v27
M v[92:95], a[160:163], a[88:91], v[92:95]
 s_barrier
M v[124:127], a[168:171], a[88:91], v[124:127]
 ds_read_b128 a[160:163], v5 offset:16384
 ds_read_b128 a[164:167], v6 offset:16384
M v[124:127], a[172:175], a[92:95], v[124:127]
 v_sub_f32 v226, v226, v27
 v_sub_f32 v227, v227, v27
M v[120:123], a[172:175], a[84:87], v[120:123]
 s_add_u32 m0, s24, 0
 ds_read_b64_tr_b16 a[128:129], v1 offset:49152
 ds_read_b64_tr_b16 a[130:131], v1 offset:50176
M v[120:123], a[168:171], a[80:83], v[120:123]
 buffer_load_dwordx4 v16, s[56:59], s29 offen offset:0   lds
M v[116:119], a[168:171], a[72:75], v[116:119]
 s_mul_i32 s72, s41, 16512
 v_sub_f32 v228, v228, v27
M v[116:119], a[172:175], a[76:79], v[116:119]
 s_add_u32 s46, s72, 234946560
 v_sub_f32 v229, v229, v27
 v_sub_f32 v230, v230, v27
M v[112:115], a[172:175], a[68:71], v[112:115]
 s_and_b32 s64, s41, 7
 s_lshr_b32 s64, s101, s64
 s_and_b32 s64, s64, 1
M v[112:115], a[168:171], a[64:67], v[112:115]
 buffer_load_dwordx4 v17, s[56:59], s29 offen offset:1024   lds
M v[108:111], a[168:171], a[56:59], v[108:111]
 s_lshl_b32 s64, s64, 13
 v_sub_f32 v231, v231, v27
M v[108:111], a[172:175], a[60:63], v[108:111]
 s_add_u32 s46, s46, s64
 ds_read_b64_tr_b16 a[132:133], v1 offset:57344
 ds_read_b64_tr_b16 a[134:135], v1 offset:58368
M v[104:107], a[172:175], a[52:55], v[104:107]
 s_lshl_b32 s45, s42, 7
 v_sub_f32 v232, v232, v27
 v_sub_f32 v233, v233, v27
M v[104:107], a[168:171], a[48:51], v[104:107]
 s_add_u32 s45, s45, s46
 s_sub_u32 s66, 15, s42
 s_min_u32 s66, s66, s42
M v[100:103], a[168:171], a[40:43], v[100:103]
 buffer_load_dwordx4 v18, s[56:59], s29 offen offset:2048   lds
M v[100:103], a[172:175], a[44:47], v[100:103]
 s_waitcnt lgkmcnt(4)
 s_lshl_b32 s47, s66, 7
 v_sub_f32 v234, v234, v27
M v[96:99], a[172:175], a[36:39], v[96:99]
 s_add_u32 s47, s47, s46
 v_sub_f32 v235, v235, v27
 v_sub_f32 v236, v236, v27
M v[96:99], a[168:171], a[32:35], v[96:99]
 s_add_u32 s47, s47, 2112
 v_sub_f32 v237, v237, v27
 v_sub_f32 v238, v238, v27
M v[128:131], a[160:163], a[32:35], v[128:131]
 s_lshl2_add_u32 s47, s20, s47
 ds_read_b128 a[168:171], v5 offset:18432
 ds_read_b128 a[172:175], v6 offset:18432
M v[128:131], a[164:167], a[36:39], v[128:131]
 s_lshl_b32 s65, s27, 3
 ds_read_b64_tr_b16 a[136:137], v2 offset:49152
 ds_read_b64_tr_b16 a[138:139], v2 offset:50176
M v[132:135], a[164:167], a[44:47], v[132:135]
 buffer_load_dwordx4 v19, s[56:59], s29 offen offset:3072   lds
M v[132:135], a[160:163], a[40:43], v[132:135]
 s_add_u32 s29, s29, 128
 s_add_u32 s65, s65, s66
 v_sub_f32 v239, v239, v27
M v[136:139], a[160:163], a[48:51], v[136:139]
 s_mul_i32 s34, s65, 262144
 s_add_u32 s34, s34, 167772160
 s_lshl_b32 s65, s42, 4
M v[136:139], a[164:167], a[52:55], v[136:139]
 s_add_u32 m0, s23, 32768
 s_add_u32 s65, s65, s41
 s_mul_i32 s33, s65, 262144
M v[140:143], a[164:167], a[60:63], v[140:143]
 buffer_load_dwordx4 v8, s[52:55], s28 offen offset:0   lds
M v[140:143], a[160:163], a[56:59], v[140:143]
 ds_read_b64_tr_b16 a[140:141], v2 offset:57344
 ds_read_b64_tr_b16 a[142:143], v2 offset:58368
M v[144:147], a[160:163], a[64:67], v[144:147]
 s_mul_i32 s65, s20, 65536
 v_sub_f32 v240, v240, v27
M v[144:147], a[164:167], a[68:71], v[144:147]
 s_add_u32 s33, s33, s65
 s_add_u32 s33, s33, 67108864
 s_sub_u32 s65, 15, s66
M v[148:151], a[164:167], a[76:79], v[148:151]
 buffer_load_dwordx4 v9, s[52:55], s28 offen offset:1024   lds
M v[148:151], a[160:163], a[72:75], v[148:151]
 s_lshl_b32 s65, s65, 17
 v_sub_f32 v241, v241, v27
M v[152:155], a[160:163], a[80:83], v[152:155]
 s_lshl_b32 s64, s27, 21
 s_add_u32 s32, s64, s65
 s_lshl_b32 s65, s20, 15
M v[152:155], a[164:167], a[84:87], v[152:155]
 s_waitcnt lgkmcnt(4)
 s_add_u32 s32, s32, s65
 v_sub_f32 v242, v242, v27
M v[156:159], a[164:167], a[92:95], v[156:159]
 s_add_u32 s32, s32, 134217728
 ds_read_b64_tr_b16 a[144:145], v3 offset:49152
 ds_read_b64_tr_b16 a[146:147], v3 offset:50176
M v[156:159], a[160:163], a[88:91], v[156:159]
 buffer_load_dwordx4 v10, s[52:55], s28 offen offset:2048   lds
M v[188:191], a[168:171], a[88:91], v[188:191]
 ds_read_b128 a[160:163], v5 offset:20480
 ds_read_b128 a[164:167], v6 offset:20480
M v[188:191], a[172:175], a[92:95], v[188:191]
 s_and_b32 s64, s41, 7
 v_sub_f32 v243, v243, v27
M v[184:187], a[172:175], a[84:87], v[184:187]
 s_lshr_b32 s64, s101, s64
 v_sub_f32 v244, v244, v27
 v_sub_f32 v245, v245, v27
M v[184:187], a[168:171], a[80:83], v[184:187]
 s_lshr_b32 s65, s41, 3
 s_xor_b32 s64, s64, s65
 s_and_b32 s64, s64, 1
M v[180:183], a[168:171], a[72:75], v[180:183]
 buffer_load_dwordx4 v11, s[52:55], s28 offen offset:3072   lds
M v[180:183], a[172:175], a[76:79], v[180:183]
 s_add_u32 s28, s28, 524416
 ds_read_b64_tr_b16 a[148:149], v3 offset:57344
 ds_read_b64_tr_b16 a[150:151], v3 offset:58368
M v[176:179], a[172:175], a[68:71], v[176:179]
 s_lshl_b32 s92, s64, 13
 v_sub_f32 v246, v246, v27
M v[176:179], a[168:171], a[64:67], v[176:179]
 s_add_u32 s93, s93, s92
 s_add_u32 s34, s34, s92
 s_add_u32 s32, s32, s92
M v[172:175], a[168:171], a[56:59], v[172:175]
 s_add_u32 m0, s23, 147456
 s_lshl_b32 s64, s20, 1
 s_lshr_b32 s64, s101, s64
M v[172:175], a[172:175], a[60:63], v[172:175]
 buffer_load_dwordx4 v8, s[52:55], s28 offen offset:0   lds
M v[168:171], a[172:175], a[52:55], v[168:171]
 s_xor_b32 s64, s64, s65
 v_sub_f32 v247, v247, v27
M v[168:171], a[168:171], a[48:51], v[168:171]
 s_and_b32 s64, s64, 1
 v_sub_f32 v248, v248, v27
 v_sub_f32 v249, v249, v27
M v[164:167], a[168:171], a[40:43], v[164:167]
 s_lshl_b32 s64, s64, 13
 ds_read_b64_tr_b16 a[152:153], v4 offset:49152
 ds_read_b64_tr_b16 a[154:155], v4 offset:50176
M v[164:167], a[172:175], a[44:47], v[164:167]
 s_waitcnt lgkmcnt(4)
 s_add_u32 s33, s33, s64
 s_mov_b32 s31, 0x53800000
M v[160:163], a[172:175], a[36:39], v[160:163]
 buffer_load_dwordx4 v9, s[52:55], s28 offen offset:1024   lds
M v[160:163], a[168:171], a[32:35], v[160:163]
 s_mov_b32 s40, 1
 v_sub_f32 v250, v250, v27
M v[192:195], a[160:163], a[32:35], v[192:195]
 s_sub_u32 s64, s42, 10
 ds_read_b128 a[168:171], v5 offset:22528
 ds_read_b128 a[172:175], v6 offset:22528
M v[192:195], a[164:167], a[36:39], v[192:195]
 s_and_b32 s35, s64, 536870912
 v_sub_f32 v251, v251, v27
 v_sub_f32 v252, v252, v27
M v[196:199], a[164:167], a[44:47], v[196:199]
 buffer_load_dwordx4 v10, s[52:55], s28 offen offset:2048   lds
M v[196:199], a[160:163], a[40:43], v[196:199]
 ds_read_b64_tr_b16 a[156:157], v4 offset:57344
 ds_read_b64_tr_b16 a[158:159], v4 offset:58368
M v[200:203], a[160:163], a[48:51], v[200:203]
 v_sub_f32 v253, v253, v27
 v_sub_f32 v254, v254, v27
M v[200:203], a[164:167], a[52:55], v[200:203]
 v_sub_f32 v255, v255, v27
M v[204:207], a[164:167], a[60:63], v[204:207]
M v[204:207], a[160:163], a[56:59], v[204:207]
 buffer_load_dwordx4 v11, s[52:55], s28 offen offset:3072   lds
M v[208:211], a[160:163], a[64:67], v[208:211]
 s_sub_u32 s28, s28, 524288
M v[208:211], a[164:167], a[68:71], v[208:211]
M v[212:215], a[164:167], a[76:79], v[212:215]
M v[212:215], a[160:163], a[72:75], v[212:215]
M v[216:219], a[160:163], a[80:83], v[216:219]
M v[216:219], a[164:167], a[84:87], v[216:219]
 s_waitcnt lgkmcnt(2)
M v[220:223], a[164:167], a[92:95], v[220:223]
 s_waitcnt vmcnt(25) lgkmcnt(0)
M v[220:223], a[160:163], a[88:91], v[220:223]
 s_barrier
M v[252:255], a[168:171], a[88:91], v[252:255]
 ds_read_b128 a[160:163], v5 offset:32768
 ds_read_b128 a[164:167], v6 offset:32768
M v[252:255], a[172:175], a[92:95], v[252:255]
M v[248:251], a[172:175], a[84:87], v[248:251]
M v[248:251], a[168:171], a[80:83], v[248:251]
M v[244:247], a[168:171], a[72:75], v[244:247]
M v[244:247], a[172:175], a[76:79], v[244:247]
M v[240:243], a[172:175], a[68:71], v[240:243]
M v[240:243], a[168:171], a[64:67], v[240:243]
M v[236:239], a[168:171], a[56:59], v[236:239]
M v[236:239], a[172:175], a[60:63], v[236:239]
M v[232:235], a[172:175], a[52:55], v[232:235]
M v[232:235], a[168:171], a[48:51], v[232:235]
M v[228:231], a[168:171], a[40:43], v[228:231]
M v[228:231], a[172:175], a[44:47], v[228:231]
 s_waitcnt lgkmcnt(0)
M v[224:227], a[172:175], a[36:39], v[224:227]
M v[224:227], a[168:171], a[32:35], v[224:227]
M a[0:3], a[160:163], a[96:99], a[0:3]
 ds_read_b128 a[168:171], v5 offset:34816
 ds_read_b128 a[172:175], v6 offset:34816
M a[0:3], a[164:167], a[100:103], a[0:3]
 ds_read_b64_tr_b16 a[32:33], v1 offset:0
 ds_read_b64_tr_b16 a[34:35], v1 offset:1024
M a[4:7], a[164:167], a[108:111], a[4:7]
 s_add_u32 m0, s24, 16384
M a[4:7], a[160:163], a[104:107], a[4:7]
 buffer_load_dwordx4 v16, s[56:59], s29 offen offset:0   lds
M a[8:11], a[160:163], a[112:115], a[8:11]
M a[8:11], a[164:167], a[116:119], a[8:11]
M a[12:15], a[164:167], a[124:127], a[12:15]
 ds_read_b64_tr_b16 a[36:37], v1 offset:8192
 ds_read_b64_tr_b16 a[38:39], v1 offset:9216
M a[12:15], a[160:163], a[120:123], a[12:15]
M a[16:19], a[160:163], a[128:131], a[16:19]
 buffer_load_dwordx4 v17, s[56:59], s29 offen offset:1024   lds
M a[16:19], a[164:167], a[132:135], a[16:19]
M a[20:23], a[164:167], a[140:143], a[20:23]
M a[20:23], a[160:163], a[136:139], a[20:23]
 ds_read_b64_tr_b16 a[40:41], v2 offset:0
 ds_read_b64_tr_b16 a[42:43], v2 offset:1024
M a[24:27], a[160:163], a[144:147], a[24:27]
M a[24:27], a[164:167], a[148:151], a[24:27]
 s_waitcnt lgkmcnt(6)
 buffer_load_dwordx4 v18, s[56:59], s29 offen offset:2048   lds
M a[28:31], a[164:167], a[156:159], a[28:31]
M a[28:31], a[160:163], a[152:155], a[28:31]
M v[32:35], a[168:171], a[96:99], v[32:35]
 ds_read_b128 a[160:163], v5 offset:36864
 ds_read_b128 a[164:167], v6 offset:36864
M v[32:35], a[172:175], a[100:103], v[32:35]
 ds_read_b64_tr_b16 a[44:45], v2 offset:8192
 ds_read_b64_tr_b16 a[46:47], v2 offset:9216
M v[36:39], a[172:175], a[108:111], v[36:39]
 buffer_load_dwordx4 v19, s[56:59], s29 offen offset:3072   lds
M v[36:39], a[168:171], a[104:107], v[36:39]
 s_add_u32 s29, s29, 128
M v[40:43], a[168:171], a[112:115], v[40:43]
M v[40:43], a[172:175], a[116:119], v[40:43]
 ds_read_b64_tr_b16 a[48:49], v3 offset:0
 ds_read_b64_tr_b16 a[50:51], v3 offset:1024
M v[44:47], a[172:175], a[124:127], v[44:47]
 s_add_u32 m0, s23, 49152
 v_accvgpr_read_b32 v24, a0
 v_accvgpr_read_b32 v25, a1
M v[44:47], a[168:171], a[120:123], v[44:47]
 buffer_load_dwordx4 v8, s[52:55], s28 offen offset:0   lds
M v[48:51], a[168:171], a[128:131], v[48:51]
 v_accvgpr_read_b32 v26, a2
 v_accvgpr_read_b32 v27, a3
M v[48:51], a[172:175], a[132:135], v[48:51]
 v_cvt_pk_bf16_f32 v24, v24, v25
 v_cvt_pk_bf16_f32 v25, v26, v27
M v[52:55], a[172:175], a[140:143], v[52:55]
 ds_read_b64_tr_b16 a[52:53], v3 offset:8192
 ds_read_b64_tr_b16 a[54:55], v3 offset:9216
M v[52:55], a[168:171], a[136:139], v[52:55]
 v_cvt_pk_bf16_f32 v26, v32, v33
 v_cvt_pk_bf16_f32 v27, v34, v35
M v[56:59], a[168:171], a[144:147], v[56:59]
 s_add_u32 s3, s93, 0
 buffer_load_dwordx4 v9, s[52:55], s28 offen offset:1024   lds
M v[56:59], a[172:175], a[148:151], v[56:59]
 s_waitcnt lgkmcnt(6)
M v[60:63], a[172:175], a[156:159], v[60:63]
 buffer_store_dwordx4 v[24:27], v7, s[8:11], s3 offen offset:0 sc1
M v[60:63], a[168:171], a[152:155], v[60:63]
 ds_read_b64_tr_b16 a[56:57], v4 offset:0
 ds_read_b64_tr_b16 a[58:59], v4 offset:1024
M v[64:67], a[160:163], a[96:99], v[64:67]
 ds_read_b128 a[168:171], v5 offset:38912
 ds_read_b128 a[172:175], v6 offset:38912
M v[64:67], a[164:167], a[100:103], v[64:67]
 buffer_load_dwordx4 v10, s[52:55], s28 offen offset:2048   lds
M v[68:71], a[164:167], a[108:111], v[68:71]
 v_accvgpr_read_b32 v24, a4
 v_accvgpr_read_b32 v25, a5
M v[68:71], a[160:163], a[104:107], v[68:71]
 v_accvgpr_read_b32 v26, a6
 v_accvgpr_read_b32 v27, a7
M v[72:75], a[160:163], a[112:115], v[72:75]
 ds_read_b64_tr_b16 a[60:61], v4 offset:8192
 ds_read_b64_tr_b16 a[62:63], v4 offset:9216
M v[72:75], a[164:167], a[116:119], v[72:75]
 v_cvt_pk_bf16_f32 v24, v24, v25
 v_cvt_pk_bf16_f32 v25, v26, v27
M v[76:79], a[164:167], a[124:127], v[76:79]
 buffer_load_dwordx4 v11, s[52:55], s28 offen offset:3072   lds
M v[76:79], a[160:163], a[120:123], v[76:79]
 s_add_u32 s28, s28, 1048448
 v_cvt_pk_bf16_f32 v26, v36, v37
 v_cvt_pk_bf16_f32 v27, v38, v39
M v[80:83], a[160:163], a[128:131], v[80:83]
M v[80:83], a[164:167], a[132:135], v[80:83]
M v[84:87], a[164:167], a[140:143], v[84:87]
 buffer_store_dwordx4 v[24:27], v7, s[8:11], s3 offen offset:2048 sc1
M v[84:87], a[160:163], a[136:139], v[84:87]
M v[88:91], a[160:163], a[144:147], v[88:91]
M v[88:91], a[164:167], a[148:151], v[88:91]
 s_waitcnt lgkmcnt(2)
M v[92:95], a[164:167], a[156:159], v[92:95]
 s_waitcnt vmcnt(26) lgkmcnt(0)
 v_accvgpr_read_b32 v24, a8
 v_accvgpr_read_b32 v25, a9
M v[92:95], a[160:163], a[152:155], v[92:95]
 s_barrier
M v[96:99], a[168:171], a[96:99], v[96:99]
 ds_read_b128 a[160:163], v5 offset:49152
 ds_read_b128 a[164:167], v6 offset:49152
M v[96:99], a[172:175], a[100:103], v[96:99]
 v_accvgpr_read_b32 v26, a10
 v_accvgpr_read_b32 v27, a11
M v[100:103], a[172:175], a[108:111], v[100:103]
 s_add_u32 m0, s24, 32768
 ds_read_b64_tr_b16 a[64:65], v1 offset:16384
 ds_read_b64_tr_b16 a[66:67], v1 offset:17408
M v[100:103], a[168:171], a[104:107], v[100:103]
 buffer_load_dwordx4 v16, s[56:59], s29 offen offset:0   lds
M v[104:107], a[168:171], a[112:115], v[104:107]
 v_cvt_pk_bf16_f32 v24, v24, v25
 v_cvt_pk_bf16_f32 v25, v26, v27
M v[104:107], a[172:175], a[116:119], v[104:107]
 v_cvt_pk_bf16_f32 v26, v40, v41
 v_cvt_pk_bf16_f32 v27, v42, v43
M v[108:111], a[172:175], a[124:127], v[108:111]
 s_add_u32 s3, s93, 4096
 buffer_store_dwordx4 v[24:27], v7, s[8:11], s3 offen offset:0 sc1
M v[108:111], a[168:171], a[120:123], v[108:111]
 v_cvt_pk_bf16_f32 v64, v64, v65
 v_cvt_pk_bf16_f32 v65, v66, v67
M v[112:115], a[168:171], a[128:131], v[112:115]
 v_cvt_pk_bf16_f32 v66, v96, v97
 v_cvt_pk_bf16_f32 v67, v98, v99
M v[112:115], a[172:175], a[132:135], v[112:115]
 ds_read_b64_tr_b16 a[68:69], v1 offset:24576
 ds_read_b64_tr_b16 a[70:71], v1 offset:25600
M v[116:119], a[172:175], a[140:143], v[116:119]
 buffer_load_dwordx4 v17, s[56:59], s29 offen offset:1024   lds
M v[116:119], a[168:171], a[136:139], v[116:119]
 v_accvgpr_read_b32 v24, a12
 v_accvgpr_read_b32 v25, a13
M v[120:123], a[168:171], a[144:147], v[120:123]
 v_accvgpr_read_b32 v26, a14
 v_accvgpr_read_b32 v27, a15
M v[120:123], a[172:175], a[148:151], v[120:123]
 s_waitcnt lgkmcnt(4)
 v_cvt_pk_bf16_f32 v24, v24, v25
 v_cvt_pk_bf16_f32 v25, v26, v27
M v[124:127], a[172:175], a[156:159], v[124:127]
 v_cvt_pk_bf16_f32 v26, v44, v45
 v_cvt_pk_bf16_f32 v27, v46, v47
M v[124:127], a[168:171], a[152:155], v[124:127]
 buffer_store_dwordx4 v[24:27], v7, s[8:11], s3 offen offset:2048 sc1
M v[128:131], a[160:163], a[96:99], v[128:131]
 ds_read_b128 a[168:171], v5 offset:51200
 ds_read_b128 a[172:175], v6 offset:51200
M v[128:131], a[164:167], a[100:103], v[128:131]
 ds_read_b64_tr_b16 a[72:73], v2 offset:16384
 ds_read_b64_tr_b16 a[74:75], v2 offset:17408
M v[132:135], a[164:167], a[108:111], v[132:135]
 buffer_load_dwordx4 v18, s[56:59], s29 offen offset:2048   lds
M v[132:135], a[160:163], a[104:107], v[132:135]
 v_cvt_pk_bf16_f32 v68, v68, v69
 v_cvt_pk_bf16_f32 v69, v70, v71
M v[136:139], a[160:163], a[112:115], v[136:139]
 v_cvt_pk_bf16_f32 v70, v100, v101
 v_cvt_pk_bf16_f32 v71, v102, v103
M v[136:139], a[164:167], a[116:119], v[136:139]
 v_cvt_pk_bf16_f32 v72, v72, v73
 v_cvt_pk_bf16_f32 v73, v74, v75
M v[140:143], a[164:167], a[124:127], v[140:143]
 v_accvgpr_read_b32 v24, a16
 v_accvgpr_read_b32 v25, a17
M v[140:143], a[160:163], a[120:123], v[140:143]
 ds_read_b64_tr_b16 a[76:77], v2 offset:24576
 ds_read_b64_tr_b16 a[78:79], v2 offset:25600
M v[144:147], a[160:163], a[128:131], v[144:147]
 buffer_load_dwordx4 v19, s[56:59], s29 offen offset:3072   lds
M v[144:147], a[164:167], a[132:135], v[144:147]
 s_add_u32 s29, s29, 128
 v_accvgpr_read_b32 v26, a18
 v_accvgpr_read_b32 v27, a19
M v[148:151], a[164:167], a[140:143], v[148:151]
 v_cvt_pk_bf16_f32 v24, v24, v25
 v_cvt_pk_bf16_f32 v25, v26, v27
M v[148:151], a[160:163], a[136:139], v[148:151]
 v_cvt_pk_bf16_f32 v26, v48, v49
 v_cvt_pk_bf16_f32 v27, v50, v51
M v[152:155], a[160:163], a[144:147], v[152:155]
 s_add_u32 s3, s93, 16384
 buffer_store_dwordx4 v[24:27], v7, s[8:11], s3 offen offset:0 sc1
M v[152:155], a[164:167], a[148:151], v[152:155]
 s_waitcnt lgkmcnt(4)
 v_cvt_pk_bf16_f32 v74, v104, v105
 v_cvt_pk_bf16_f32 v75, v106, v107
M v[156:159], a[164:167], a[156:159], v[156:159]
 s_add_u32 m0, s23, 0
 ds_read_b64_tr_b16 a[80:81], v3 offset:16384
 ds_read_b64_tr_b16 a[82:83], v3 offset:17408
M v[156:159], a[160:163], a[152:155], v[156:159]
 buffer_load_dwordx4 v8, s[52:55], s28 offen offset:0   lds
M v[160:163], a[168:171], a[96:99], v[160:163]
 ds_read_b128 a[160:163], v5 offset:53248
 ds_read_b128 a[164:167], v6 offset:53248
M v[160:163], a[172:175], a[100:103], v[160:163]
 v_cvt_pk_bf16_f32 v76, v76, v77
 v_cvt_pk_bf16_f32 v77, v78, v79
M v[164:167], a[172:175], a[108:111], v[164:167]
 v_accvgpr_read_b32 v24, a20
 v_accvgpr_read_b32 v25, a21
M v[164:167], a[168:171], a[104:107], v[164:167]
 v_accvgpr_read_b32 v26, a22
 v_accvgpr_read_b32 v27, a23
M v[168:171], a[168:171], a[112:115], v[168:171]
 v_cvt_pk_bf16_f32 v24, v24, v25
 v_cvt_pk_bf16_f32 v25, v26, v27
M v[168:171], a[172:175], a[116:119], v[168:171]
 ds_read_b64_tr_b16 a[84:85], v3 offset:24576
 ds_read_b64_tr_b16 a[86:87], v3 offset:25600
M v[172:175], a[172:175], a[124:127], v[172:175]
 buffer_load_dwordx4 v9, s[52:55], s28 offen offset:1024   lds
M v[172:175], a[168:171], a[120:123], v[172:175]
 v_cvt_pk_bf16_f32 v26, v52, v53
 v_cvt_pk_bf16_f32 v27, v54, v55
M v[176:179], a[168:171], a[128:131], v[176:179]
 v_cvt_pk_bf16_f32 v78, v108, v109
 v_cvt_pk_bf16_f32 v79, v110, v111
M v[176:179], a[172:175], a[132:135], v[176:179]
 buffer_store_dwordx4 v[24:27], v7, s[8:11], s3 offen offset:2048 sc1
M v[180:183], a[172:175], a[140:143], v[180:183]
 v_cvt_pk_bf16_f32 v80, v80, v81
 v_cvt_pk_bf16_f32 v81, v82, v83
M v[180:183], a[168:171], a[136:139], v[180:183]
 v_cvt_pk_bf16_f32 v82, v112, v113
 v_cvt_pk_bf16_f32 v83, v114, v115
M v[184:187], a[168:171], a[144:147], v[184:187]
 ds_read_b64_tr_b16 a[88:89], v4 offset:16384
 ds_read_b64_tr_b16 a[90:91], v4 offset:17408
M v[184:187], a[172:175], a[148:151], v[184:187]
 s_waitcnt lgkmcnt(4)
 buffer_load_dwordx4 v10, s[52:55], s28 offen offset:2048   lds
M v[188:191], a[172:175], a[156:159], v[188:191]
 v_accvgpr_read_b32 v24, a24
 v_accvgpr_read_b32 v25, a25
M v[188:191], a[168:171], a[152:155], v[188:191]
 v_accvgpr_read_b32 v26, a26
 v_accvgpr_read_b32 v27, a27
M v[192:195], a[160:163], a[96:99], v[192:195]
 ds_read_b128 a[168:171], v5 offset:55296
 ds_read_b128 a[172:175], v6 offset:55296
M v[192:195], a[164:167], a[100:103], v[192:195]
 v_cvt_pk_bf16_f32 v24, v24, v25
 v_cvt_pk_bf16_f32 v25, v26, v27
M v[196:199], a[164:167], a[108:111], v[196:199]
 v_cvt_pk_bf16_f32 v26, v56, v57
 v_cvt_pk_bf16_f32 v27, v58, v59
M v[196:199], a[160:163], a[104:107], v[196:199]
 s_add_u32 s3, s93, 20480
 ds_read_b64_tr_b16 a[92:93], v4 offset:24576
 ds_read_b64_tr_b16 a[94:95], v4 offset:25600
M v[200:203], a[160:163], a[112:115], v[200:203]
 buffer_load_dwordx4 v11, s[52:55], s28 offen offset:3072   lds
M v[200:203], a[164:167], a[116:119], v[200:203]
 s_add_u32 s28, s28, 128
 v_cvt_pk_bf16_f32 v84, v84, v85
 v_cvt_pk_bf16_f32 v85, v86, v87
M v[204:207], a[164:167], a[124:127], v[204:207]
 v_cvt_pk_bf16_f32 v86, v116, v117
 v_cvt_pk_bf16_f32 v87, v118, v119
M v[204:207], a[160:163], a[120:123], v[204:207]
 v_cvt_pk_bf16_f32 v88, v88, v89
 v_cvt_pk_bf16_f32 v89, v90, v91
M v[208:211], a[160:163], a[128:131], v[208:211]
 buffer_store_dwordx4 v[24:27], v7, s[8:11], s3 offen offset:0 sc1
M v[208:211], a[164:167], a[132:135], v[208:211]
 v_cvt_pk_bf16_f32 v90, v120, v121
 v_cvt_pk_bf16_f32 v91, v122, v123
M v[212:215], a[164:167], a[140:143], v[212:215]
 v_accvgpr_read_b32 v24, a28
 v_accvgpr_read_b32 v25, a29
M v[212:215], a[160:163], a[136:139], v[212:215]
 v_accvgpr_read_b32 v26, a30
 v_accvgpr_read_b32 v27, a31
M v[216:219], a[160:163], a[144:147], v[216:219]
 v_cvt_pk_bf16_f32 v24, v24, v25
 v_cvt_pk_bf16_f32 v25, v26, v27
M v[216:219], a[164:167], a[148:151], v[216:219]
 s_waitcnt lgkmcnt(2)
 v_cvt_pk_bf16_f32 v26, v60, v61
 v_cvt_pk_bf16_f32 v27, v62, v63
M v[220:223], a[164:167], a[156:159], v[220:223]
 s_waitcnt vmcnt(27) lgkmcnt(0)
 buffer_store_dwordx4 v[24:27], v7, s[8:11], s3 offen offset:2048 sc1
M v[220:223], a[160:163], a[152:155], v[220:223]
 s_barrier
M v[224:227], a[168:171], a[96:99], v[224:227]
 ds_read_b128 a[160:163], v5 offset:0
 ds_read_b128 a[164:167], v6 offset:0
M v[224:227], a[172:175], a[100:103], v[224:227]
 v_cvt_pk_bf16_f32 v92, v92, v93
 v_cvt_pk_bf16_f32 v93, v94, v95
M v[228:231], a[172:175], a[108:111], v[228:231]
 v_cvt_pk_bf16_f32 v94, v124, v125
 v_cvt_pk_bf16_f32 v95, v126, v127
M v[228:231], a[168:171], a[104:107], v[228:231]
 v_cvt_pk_bf16_f32 v128, v128, v129
 v_cvt_pk_bf16_f32 v129, v130, v131
M v[232:235], a[168:171], a[112:115], v[232:235]
 v_cvt_pk_bf16_f32 v130, v160, v161
 v_cvt_pk_bf16_f32 v131, v162, v163
M v[232:235], a[172:175], a[116:119], v[232:235]
 v_cvt_pk_bf16_f32 v132, v132, v133
 v_cvt_pk_bf16_f32 v133, v134, v135
M v[236:239], a[172:175], a[124:127], v[236:239]
 v_cvt_pk_bf16_f32 v134, v164, v165
 v_cvt_pk_bf16_f32 v135, v166, v167
M v[236:239], a[168:171], a[120:123], v[236:239]
 v_cvt_pk_bf16_f32 v136, v136, v137
 v_cvt_pk_bf16_f32 v137, v138, v139
M v[240:243], a[168:171], a[128:131], v[240:243]
 v_cvt_pk_bf16_f32 v138, v168, v169
 v_cvt_pk_bf16_f32 v139, v170, v171
M v[240:243], a[172:175], a[132:135], v[240:243]
 v_cvt_pk_bf16_f32 v140, v140, v141
 v_cvt_pk_bf16_f32 v141, v142, v143
M v[244:247], a[172:175], a[140:143], v[244:247]
 v_cvt_pk_bf16_f32 v142, v172, v173
 v_cvt_pk_bf16_f32 v143, v174, v175
M v[244:247], a[168:171], a[136:139], v[244:247]
 v_cvt_pk_bf16_f32 v144, v144, v145
 v_cvt_pk_bf16_f32 v145, v146, v147
M v[248:251], a[168:171], a[144:147], v[248:251]
 v_cvt_pk_bf16_f32 v146, v176, v177
 v_cvt_pk_bf16_f32 v147, v178, v179
M v[248:251], a[172:175], a[148:151], v[248:251]
 s_waitcnt lgkmcnt(0)
 v_cvt_pk_bf16_f32 v148, v148, v149
 v_cvt_pk_bf16_f32 v149, v150, v151
M v[252:255], a[172:175], a[156:159], v[252:255]
 v_cvt_pk_bf16_f32 v150, v180, v181
 v_cvt_pk_bf16_f32 v151, v182, v183
M v[252:255], a[168:171], a[152:155], v[252:255]
 v_cvt_pk_bf16_f32 v152, v152, v153
 v_cvt_pk_bf16_f32 v153, v154, v155
M v[32:35], a[32:35], a[160:163], 0
 s_add_u32 m0, s23, 16384
 ds_read_b128 a[168:171], v5 offset:2048
 ds_read_b128 a[172:175], v6 offset:2048
M v[32:35], a[36:39], a[164:167], v[32:35]
 ds_read_b64_tr_b16 a[96:97], v1 offset:32768
 ds_read_b64_tr_b16 a[98:99], v1 offset:33792
M v[36:39], a[44:47], a[164:167], 0
 buffer_load_dwordx4 v8, s[52:55], s28 offen offset:0   lds
M v[36:39], a[40:43], a[160:163], v[36:39]
 v_cvt_pk_bf16_f32 v154, v184, v185
 v_cvt_pk_bf16_f32 v155, v186, v187
M v[40:43], a[48:51], a[160:163], 0
 ds_read_b64_tr_b16 a[100:101], v1 offset:40960
 ds_read_b64_tr_b16 a[102:103], v1 offset:41984
M v[40:43], a[52:55], a[164:167], v[40:43]
 buffer_load_dwordx4 v9, s[52:55], s28 offen offset:1024   lds
M v[44:47], a[60:63], a[164:167], 0
 v_cvt_pk_bf16_f32 v156, v156, v157
 v_cvt_pk_bf16_f32 v157, v158, v159
M v[44:47], a[56:59], a[160:163], v[44:47]
 ds_read_b64_tr_b16 a[104:105], v2 offset:32768
 ds_read_b64_tr_b16 a[106:107], v2 offset:33792
M v[48:51], a[64:67], a[160:163], 0
 v_cvt_pk_bf16_f32 v158, v188, v189
 v_cvt_pk_bf16_f32 v159, v190, v191
M v[48:51], a[68:71], a[164:167], v[48:51]
 v_cvt_pk_bf16_f32 v192, v192, v193
 v_cvt_pk_bf16_f32 v193, v194, v195
M v[52:55], a[76:79], a[164:167], 0
 ds_read_b64_tr_b16 a[108:109], v2 offset:40960
 ds_read_b64_tr_b16 a[110:111], v2 offset:41984
M v[52:55], a[72:75], a[160:163], v[52:55]
 buffer_load_dwordx4 v10, s[52:55], s28 offen offset:2048   lds
M v[56:59], a[80:83], a[160:163], 0
 v_cvt_pk_bf16_f32 v194, v224, v225
 v_cvt_pk_bf16_f32 v195, v226, v227
M v[56:59], a[84:87], a[164:167], v[56:59]
 s_waitcnt lgkmcnt(8)
 ds_read_b64_tr_b16 a[112:113], v3 offset:32768
 ds_read_b64_tr_b16 a[114:115], v3 offset:33792
M v[60:63], a[92:95], a[164:167], 0
 v_cvt_pk_bf16_f32 v196, v196, v197
 v_cvt_pk_bf16_f32 v197, v198, v199
M v[60:63], a[88:91], a[160:163], v[60:63]
 buffer_load_dwordx4 v11, s[52:55], s28 offen offset:3072   lds
M v[96:99], a[32:35], a[168:171], 0
 s_add_u32 s28, s28, 524160
 ds_read_b128 a[160:163], v5 offset:4096
 ds_read_b128 a[164:167], v6 offset:4096
M v[96:99], a[36:39], a[172:175], v[96:99]
 ds_read_b64_tr_b16 a[116:117], v3 offset:40960
 ds_read_b64_tr_b16 a[118:119], v3 offset:41984
M v[100:103], a[44:47], a[172:175], 0
 v_cvt_pk_bf16_f32 v198, v228, v229
 v_cvt_pk_bf16_f32 v199, v230, v231
M v[100:103], a[40:43], a[168:171], v[100:103]
 s_add_u32 m0, s24, 49152
 ds_read_b64_tr_b16 a[120:121], v4 offset:32768
 ds_read_b64_tr_b16 a[122:123], v4 offset:33792
M v[104:107], a[48:51], a[168:171], 0
 buffer_load_dwordx4 v16, s[56:59], s29 offen offset:0   lds
M v[104:107], a[52:55], a[172:175], v[104:107]
 v_cvt_pk_bf16_f32 v200, v200, v201
 v_cvt_pk_bf16_f32 v201, v202, v203
M v[108:111], a[60:63], a[172:175], 0
 ds_read_b64_tr_b16 a[124:125], v4 offset:40960
 ds_read_b64_tr_b16 a[126:127], v4 offset:41984
M v[108:111], a[56:59], a[168:171], v[108:111]
 v_cvt_pk_bf16_f32 v202, v232, v233
 v_cvt_pk_bf16_f32 v203, v234, v235
M v[112:115], a[64:67], a[168:171], 0
 v_cvt_pk_bf16_f32 v204, v204, v205
 v_cvt_pk_bf16_f32 v205, v206, v207
M v[112:115], a[68:71], a[172:175], v[112:115]
 buffer_load_dwordx4 v17, s[56:59], s29 offen offset:1024   lds
M v[116:119], a[76:79], a[172:175], 0
 v_cvt_pk_bf16_f32 v206, v236, v237
 v_cvt_pk_bf16_f32 v207, v238, v239
M v[116:119], a[72:75], a[168:171], v[116:119]
 v_cvt_pk_bf16_f32 v208, v208, v209
 v_cvt_pk_bf16_f32 v209, v210, v211
M v[120:123], a[80:83], a[168:171], 0
 v_cvt_pk_bf16_f32 v210, v240, v241
 v_cvt_pk_bf16_f32 v211, v242, v243
M v[120:123], a[84:87], a[172:175], v[120:123]
 s_waitcnt lgkmcnt(6)
 v_cvt_pk_bf16_f32 v212, v212, v213
 v_cvt_pk_bf16_f32 v213, v214, v215
M v[124:127], a[92:95], a[172:175], 0
 s_waitcnt vmcnt(21) lgkmcnt(0)
 buffer_load_dwordx4 v18, s[56:59], s29 offen offset:2048   lds
M v[124:127], a[88:91], a[168:171], v[124:127]
 s_barrier
M v[160:163], a[32:35], a[160:163], 0
 ds_read_b128 a[168:171], v5 offset:6144
 ds_read_b128 a[172:175], v6 offset:6144
M v[160:163], a[36:39], a[164:167], v[160:163]
 ds_read_b64_tr_b16 a[128:129], v1 offset:49152
 ds_read_b64_tr_b16 a[130:131], v1 offset:50176
M v[164:167], a[44:47], a[164:167], 0
 v_cvt_pk_bf16_f32 v214, v244, v245
 v_cvt_pk_bf16_f32 v215, v246, v247
M v[164:167], a[40:43], a[160:163], v[164:167]
 buffer_load_dwordx4 v19, s[56:59], s29 offen offset:3072   lds
M v[168:171], a[48:51], a[160:163], 0
 s_add_u32 s29, s29, 128
 ds_read_b64_tr_b16 a[132:133], v1 offset:57344
 ds_read_b64_tr_b16 a[134:135], v1 offset:58368
M v[168:171], a[52:55], a[164:167], v[168:171]
 v_cvt_pk_bf16_f32 v216, v216, v217
 v_cvt_pk_bf16_f32 v217, v218, v219
M v[172:175], a[60:63], a[164:167], 0
 v_cvt_pk_bf16_f32 v218, v248, v249
 v_cvt_pk_bf16_f32 v219, v250, v251
M v[172:175], a[56:59], a[160:163], v[172:175]
 s_add_u32 m0, s23, 32768
 ds_read_b64_tr_b16 a[136:137], v2 offset:49152
 ds_read_b64_tr_b16 a[138:139], v2 offset:50176
M v[176:179], a[64:67], a[160:163], 0
 buffer_load_dwordx4 v8, s[52:55], s28 offen offset:0   lds
M v[176:179], a[68:71], a[164:167], v[176:179]
 v_cvt_pk_bf16_f32 v220, v220, v221
 v_cvt_pk_bf16_f32 v221, v222, v223
M v[180:183], a[76:79], a[164:167], 0
 ds_read_b64_tr_b16 a[140:141], v2 offset:57344
 ds_read_b64_tr_b16 a[142:143], v2 offset:58368
M v[180:183], a[72:75], a[160:163], v[180:183]
 v_cvt_pk_bf16_f32 v222, v252, v253
 v_cvt_pk_bf16_f32 v223, v254, v255
M v[184:187], a[80:83], a[160:163], 0
 s_add_u32 s3, s93, 524288
 v_mov_b32 v12, 1
 v_or_b32 v15, s20, v0
M v[184:187], a[84:87], a[164:167], v[184:187]
 s_waitcnt lgkmcnt(8)
 ds_read_b64_tr_b16 a[144:145], v3 offset:49152
 ds_read_b64_tr_b16 a[146:147], v3 offset:50176
M v[188:191], a[92:95], a[164:167], 0
 buffer_load_dwordx4 v9, s[52:55], s28 offen offset:1024   lds
M v[188:191], a[88:91], a[160:163], v[188:191]
 v_min_u32 v15, 1, v15
 v_lshlrev_b32 v15, 29, v15
M v[224:227], a[32:35], a[168:171], 0
 ds_read_b128 a[160:163], v5 offset:16384
 ds_read_b128 a[164:167], v6 offset:16384
M v[224:227], a[36:39], a[172:175], v[224:227]
 ds_read_b64_tr_b16 a[148:149], v3 offset:57344
 ds_read_b64_tr_b16 a[150:151], v3 offset:58368
M v[228:231], a[44:47], a[172:175], 0
 buffer_load_dwordx4 v10, s[52:55], s28 offen offset:2048   lds
M v[228:231], a[40:43], a[168:171], v[228:231]
 ds_read_b64_tr_b16 a[152:153], v4 offset:49152
 ds_read_b64_tr_b16 a[154:155], v4 offset:50176
M v[232:235], a[48:51], a[168:171], 0
 buffer_store_dwordx4 v[64:67], v7, s[8:11], s3 offen offset:0 sc1
M v[232:235], a[52:55], a[172:175], v[232:235]
M v[236:239], a[60:63], a[172:175], 0
 ds_read_b64_tr_b16 a[156:157], v4 offset:57344
 ds_read_b64_tr_b16 a[158:159], v4 offset:58368
M v[236:239], a[56:59], a[168:171], v[236:239]
 buffer_load_dwordx4 v11, s[52:55], s28 offen offset:3072   lds
M v[240:243], a[64:67], a[168:171], 0
 s_add_u32 s28, s28, 128
M v[240:243], a[68:71], a[172:175], v[240:243]
 buffer_store_dwordx4 v[68:71], v7, s[8:11], s3 offen offset:2048 sc1
M v[244:247], a[76:79], a[172:175], 0
M v[244:247], a[72:75], a[168:171], v[244:247]
M v[248:251], a[80:83], a[168:171], 0
M v[248:251], a[84:87], a[172:175], v[248:251]
 s_waitcnt lgkmcnt(6)
M v[252:255], a[92:95], a[172:175], 0
 s_waitcnt vmcnt(14) lgkmcnt(0)
M v[252:255], a[88:91], a[168:171], v[252:255]
 s_barrier
M v[32:35], a[96:99], a[160:163], v[32:35]
 s_add_u32 m0, s23, 49152
 ds_read_b128 a[168:171], v5 offset:18432
 ds_read_b128 a[172:175], v6 offset:18432
M v[32:35], a[100:103], a[164:167], v[32:35]
 ds_read_b64_tr_b16 a[32:33], v20 offset:0
 ds_read_b64_tr_b16 a[34:35], v20 offset:1024
M v[36:39], a[108:111], a[164:167], v[36:39]
 s_mov_b32 s39, 1347
 buffer_load_dwordx4 v8, s[52:55], s28 offen offset:0   lds
M v[36:39], a[104:107], a[160:163], v[36:39]
 s_cmp_lt_u32 s42, 2
 buffer_store_dword v12, v15, s[8:11], s45 offen sc1
M v[40:43], a[112:115], a[160:163], v[40:43]
 s_cselect_b32 s39, 1284, s39
 ds_read_b64_tr_b16 a[36:37], v20 offset:8192
 ds_read_b64_tr_b16 a[38:39], v20 offset:9216
M v[40:43], a[116:119], a[164:167], v[40:43]
 s_lshl_b32 s64, s20, 15
 buffer_load_dwordx4 v9, s[52:55], s28 offen offset:1024   lds
M v[44:47], a[124:127], a[164:167], v[44:47]
 s_add_u32 s12, s64, s34
 s_add_u32 s3, s93, 528384
M v[44:47], a[120:123], a[160:163], v[44:47]
 s_add_u32 s13, s12, 4096
 ds_read_b64_tr_b16 a[40:41], v21 offset:0
 ds_read_b64_tr_b16 a[42:43], v21 offset:1024
M v[48:51], a[128:131], a[160:163], v[48:51]
 s_add_u32 s14, s12, 16384
 buffer_store_dwordx4 v[72:75], v7, s[8:11], s3 offen offset:0 sc1
M v[48:51], a[132:135], a[164:167], v[48:51]
 s_add_u32 s15, s12, 20480
M v[52:55], a[140:143], a[164:167], v[52:55]
 ds_read_b64_tr_b16 a[44:45], v21 offset:8192
 ds_read_b64_tr_b16 a[46:47], v21 offset:9216
M v[52:55], a[136:139], a[160:163], v[52:55]
 buffer_load_dwordx4 v10, s[52:55], s28 offen offset:2048   lds
M v[56:59], a[144:147], a[160:163], v[56:59]
M v[56:59], a[148:151], a[164:167], v[56:59]
 s_waitcnt lgkmcnt(8)
 ds_read_b64_tr_b16 a[48:49], v22 offset:0
 ds_read_b64_tr_b16 a[50:51], v22 offset:1024
M v[60:63], a[156:159], a[164:167], v[60:63]
M v[60:63], a[152:155], a[160:163], v[60:63]
 buffer_load_dwordx4 v11, s[52:55], s28 offen offset:3072   lds
M v[96:99], a[96:99], a[168:171], v[96:99]
 s_add_u32 s28, s28, 524160
 ds_read_b128 a[160:163], v5 offset:20480
 ds_read_b128 a[164:167], v6 offset:20480
M v[96:99], a[100:103], a[172:175], v[96:99]
 ds_read_b64_tr_b16 a[52:53], v22 offset:8192
 ds_read_b64_tr_b16 a[54:55], v22 offset:9216
M v[100:103], a[108:111], a[172:175], v[100:103]
M v[100:103], a[104:107], a[168:171], v[100:103]
 s_add_u32 m0, s24, 0
 ds_read_b64_tr_b16 a[56:57], v23 offset:0
 ds_read_b64_tr_b16 a[58:59], v23 offset:1024
M v[104:107], a[112:115], a[168:171], v[104:107]
 buffer_load_dwordx4 v16, s[56:59], s29 offen offset:0   lds
M v[104:107], a[116:119], a[172:175], v[104:107]
M v[108:111], a[124:127], a[172:175], v[108:111]
 ds_read_b64_tr_b16 a[60:61], v23 offset:8192
 ds_read_b64_tr_b16 a[62:63], v23 offset:9216
M v[108:111], a[120:123], a[168:171], v[108:111]
M v[112:115], a[128:131], a[168:171], v[112:115]
M v[112:115], a[132:135], a[172:175], v[112:115]
 buffer_load_dwordx4 v17, s[56:59], s29 offen offset:1024   lds
M v[116:119], a[140:143], a[172:175], v[116:119]
M v[116:119], a[136:139], a[168:171], v[116:119]
M v[120:123], a[144:147], a[168:171], v[120:123]
M v[120:123], a[148:151], a[172:175], v[120:123]
 s_waitcnt lgkmcnt(6)
M v[124:127], a[156:159], a[172:175], v[124:127]
 s_waitcnt lgkmcnt(0)
 buffer_load_dwordx4 v18, s[56:59], s29 offen offset:2048   lds
M v[124:127], a[152:155], a[168:171], v[124:127]
 s_barrier
M v[160:163], a[96:99], a[160:163], v[160:163]
 ds_read_b128 a[168:171], v5 offset:22528
 ds_read_b128 a[172:175], v6 offset:22528
M v[160:163], a[100:103], a[164:167], v[160:163]
 ds_read_b64_tr_b16 a[64:65], v20 offset:16384
 ds_read_b64_tr_b16 a[66:67], v20 offset:17408
M v[164:167], a[108:111], a[164:167], v[164:167]
M v[164:167], a[104:107], a[160:163], v[164:167]
 buffer_load_dwordx4 v19, s[56:59], s29 offen offset:3072   lds
M v[168:171], a[112:115], a[160:163], v[168:171]
 s_add_u32 s29, s29, 128
 ds_read_b64_tr_b16 a[68:69], v20 offset:24576
 ds_read_b64_tr_b16 a[70:71], v20 offset:25600
M v[168:171], a[116:119], a[164:167], v[168:171]
 buffer_store_dwordx4 v[76:79], v7, s[8:11], s3 offen offset:2048 sc1
M v[172:175], a[124:127], a[164:167], v[172:175]
M v[172:175], a[120:123], a[160:163], v[172:175]
 s_add_u32 m0, s23, 131072
 ds_read_b64_tr_b16 a[72:73], v21 offset:16384
 ds_read_b64_tr_b16 a[74:75], v21 offset:17408
M v[176:179], a[128:131], a[160:163], v[176:179]
 buffer_load_dwordx4 v8, s[52:55], s28 offen offset:0   lds
M v[176:179], a[132:135], a[164:167], v[176:179]
M v[180:183], a[140:143], a[164:167], v[180:183]
 ds_read_b64_tr_b16 a[76:77], v21 offset:24576
 ds_read_b64_tr_b16 a[78:79], v21 offset:25600
M v[180:183], a[136:139], a[160:163], v[180:183]
M v[184:187], a[144:147], a[160:163], v[184:187]
M v[184:187], a[148:151], a[164:167], v[184:187]
 s_waitcnt lgkmcnt(8)
 ds_read_b64_tr_b16 a[80:81], v22 offset:16384
 ds_read_b64_tr_b16 a[82:83], v22 offset:17408
M v[188:191], a[156:159], a[164:167], v[188:191]
 buffer_load_dwordx4 v9, s[52:55], s28 offen offset:1024   lds
M v[188:191], a[152:155], a[160:163], v[188:191]
M v[224:227], a[96:99], a[168:171], v[224:227]
 ds_read_b128 a[160:163], v5 offset:32768
 ds_read_b128 a[164:167], v6 offset:32768
M v[224:227], a[100:103], a[172:175], v[224:227]
 ds_read_b64_tr_b16 a[84:85], v22 offset:24576
 ds_read_b64_tr_b16 a[86:87], v22 offset:25600
M v[228:231], a[108:111], a[172:175], v[228:231]
 buffer_load_dwordx4 v10, s[52:55], s28 offen offset:2048   lds
M v[228:231], a[104:107], a[168:171], v[228:231]
 ds_read_b64_tr_b16 a[88:89], v23 offset:16384
 ds_read_b64_tr_b16 a[90:91], v23 offset:17408
M v[232:235], a[112:115], a[168:171], v[232:235]
M v[232:235], a[116:119], a[172:175], v[232:235]
M v[236:239], a[124:127], a[172:175], v[236:239]
 ds_read_b64_tr_b16 a[92:93], v23 offset:24576
 ds_read_b64_tr_b16 a[94:95], v23 offset:25600
M v[236:239], a[120:123], a[168:171], v[236:239]
 buffer_load_dwordx4 v11, s[52:55], s28 offen offset:3072   lds
M v[240:243], a[128:131], a[168:171], v[240:243]
 s_add_u32 s28, s28, 128
M v[240:243], a[132:135], a[172:175], v[240:243]
M v[244:247], a[140:143], a[172:175], v[244:247]
M v[244:247], a[136:139], a[168:171], v[244:247]
M v[248:251], a[144:147], a[168:171], v[248:251]
M v[248:251], a[148:151], a[172:175], v[248:251]
 s_waitcnt lgkmcnt(6)
M v[252:255], a[156:159], a[172:175], v[252:255]
 s_waitcnt lgkmcnt(0)
M v[252:255], a[152:155], a[168:171], v[252:255]
 s_barrier
M v[32:35], a[32:35], a[160:163], v[32:35]
 s_add_u32 m0, s23, 147456
 ds_read_b128 a[168:171], v5 offset:34816
 ds_read_b128 a[172:175], v6 offset:34816
M v[32:35], a[36:39], a[164:167], v[32:35]
 ds_read_b64_tr_b16 a[96:97], v1 offset:0
 ds_read_b64_tr_b16 a[98:99], v1 offset:1024
M v[36:39], a[44:47], a[164:167], v[36:39]
 buffer_load_dwordx4 v8, s[52:55], s28 offen offset:0   lds
M v[36:39], a[40:43], a[160:163], v[36:39]
 v_and_b32 v29, 15, v0
 v_mul_u32_u24 v30, 1792, v29
M v[40:43], a[48:51], a[160:163], v[40:43]
 s_add_u32 s3, s93, 540672
 ds_read_b64_tr_b16 a[100:101], v1 offset:8192
 ds_read_b64_tr_b16 a[102:103], v1 offset:9216
M v[40:43], a[52:55], a[164:167], v[40:43]
 buffer_load_dwordx4 v9, s[52:55], s28 offen offset:1024   lds
M v[44:47], a[60:63], a[164:167], v[44:47]
 v_lshrrev_b32 v31, 4, v0
 v_lshl_add_u32 v30, v31, 4, v30
M v[44:47], a[56:59], a[160:163], v[44:47]
 ds_read_b64_tr_b16 a[104:105], v2 offset:0
 ds_read_b64_tr_b16 a[106:107], v2 offset:1024
M v[48:51], a[64:67], a[160:163], v[48:51]
 v_lshrrev_b32 v29, 1, v29
 v_min_u32 v29, 1, v29
M v[48:51], a[68:71], a[164:167], v[48:51]
 v_lshl_or_b32 v30, v29, 29, v30
 v_or_b32 v30, s88, v30
M v[52:55], a[76:79], a[164:167], v[52:55]
 s_mul_i32 s89, s86, 3584
 ds_read_b64_tr_b16 a[108:109], v2 offset:8192
 ds_read_b64_tr_b16 a[110:111], v2 offset:9216
M v[52:55], a[72:75], a[160:163], v[52:55]
 s_mul_i32 s64, s20, 448
 buffer_load_dwordx4 v10, s[52:55], s28 offen offset:2048   lds
M v[56:59], a[80:83], a[160:163], v[56:59]
 s_add_u32 s89, s89, s64
 s_add_u32 s89, s89, 235929600
M v[56:59], a[84:87], a[164:167], v[56:59]
 s_waitcnt lgkmcnt(8)
 ds_read_b64_tr_b16 a[112:113], v3 offset:0
 ds_read_b64_tr_b16 a[114:115], v3 offset:1024
M v[60:63], a[92:95], a[164:167], v[60:63]
 buffer_store_dwordx4 v[80:83], v7, s[8:11], s3 offen offset:0 sc1
M v[60:63], a[88:91], a[160:163], v[60:63]
 buffer_load_dwordx4 v11, s[52:55], s28 offen offset:3072   lds
M v[96:99], a[32:35], a[168:171], v[96:99]
 s_add_u32 s28, s28, 524160
 ds_read_b128 a[160:163], v5 offset:36864
 ds_read_b128 a[164:167], v6 offset:36864
M v[96:99], a[36:39], a[172:175], v[96:99]
 ds_read_b64_tr_b16 a[116:117], v3 offset:8192
 ds_read_b64_tr_b16 a[118:119], v3 offset:9216
M v[100:103], a[44:47], a[172:175], v[100:103]
M v[100:103], a[40:43], a[168:171], v[100:103]
 s_add_u32 m0, s24, 16384
 ds_read_b64_tr_b16 a[120:121], v4 offset:0
 ds_read_b64_tr_b16 a[122:123], v4 offset:1024
M v[104:107], a[48:51], a[168:171], v[104:107]
 buffer_load_dwordx4 v16, s[56:59], s29 offen offset:0   lds
M v[104:107], a[52:55], a[172:175], v[104:107]
M v[108:111], a[60:63], a[172:175], v[108:111]
 ds_read_b64_tr_b16 a[124:125], v4 offset:8192
 ds_read_b64_tr_b16 a[126:127], v4 offset:9216
M v[108:111], a[56:59], a[168:171], v[108:111]
M v[112:115], a[64:67], a[168:171], v[112:115]
M v[112:115], a[68:71], a[172:175], v[112:115]
 buffer_load_dwordx4 v17, s[56:59], s29 offen offset:1024   lds
M v[116:119], a[76:79], a[172:175], v[116:119]
M v[116:119], a[72:75], a[168:171], v[116:119]
M v[120:123], a[80:83], a[168:171], v[120:123]
M v[120:123], a[84:87], a[172:175], v[120:123]
 s_waitcnt lgkmcnt(6)
M v[124:127], a[92:95], a[172:175], v[124:127]
 s_waitcnt vmcnt(28) lgkmcnt(0)
 buffer_load_dwordx4 v18, s[56:59], s29 offen offset:2048   lds
M v[124:127], a[88:91], a[168:171], v[124:127]
 s_barrier
M v[160:163], a[32:35], a[160:163], v[160:163]
 ds_read_b128 a[168:171], v5 offset:38912
 ds_read_b128 a[172:175], v6 offset:38912
M v[160:163], a[36:39], a[164:167], v[160:163]
 ds_read_b64_tr_b16 a[128:129], v1 offset:16384
 ds_read_b64_tr_b16 a[130:131], v1 offset:17408
M v[164:167], a[44:47], a[164:167], v[164:167]
M v[164:167], a[40:43], a[160:163], v[164:167]
 buffer_load_dwordx4 v19, s[56:59], s29 offen offset:3072   lds
M v[168:171], a[48:51], a[160:163], v[168:171]
 s_add_u32 s29, s29, 128
 ds_read_b64_tr_b16 a[132:133], v1 offset:24576
 ds_read_b64_tr_b16 a[134:135], v1 offset:25600
M v[168:171], a[52:55], a[164:167], v[168:171]
 buffer_store_dwordx4 v[84:87], v7, s[8:11], s3 offen offset:2048 sc1
M v[172:175], a[60:63], a[164:167], v[172:175]
M v[172:175], a[56:59], a[160:163], v[172:175]
 s_add_u32 m0, s23, 0
 ds_read_b64_tr_b16 a[136:137], v2 offset:16384
 ds_read_b64_tr_b16 a[138:139], v2 offset:17408
M v[176:179], a[64:67], a[160:163], v[176:179]
 buffer_load_dwordx4 v8, s[52:55], s28 offen offset:0   lds
M v[176:179], a[68:71], a[164:167], v[176:179]
M v[180:183], a[76:79], a[164:167], v[180:183]
 ds_read_b64_tr_b16 a[140:141], v2 offset:24576
 ds_read_b64_tr_b16 a[142:143], v2 offset:25600
M v[180:183], a[72:75], a[160:163], v[180:183]
M v[184:187], a[80:83], a[160:163], v[184:187]
M v[184:187], a[84:87], a[164:167], v[184:187]
 s_waitcnt lgkmcnt(8)
 ds_read_b64_tr_b16 a[144:145], v3 offset:16384
 ds_read_b64_tr_b16 a[146:147], v3 offset:17408
M v[188:191], a[92:95], a[164:167], v[188:191]
 buffer_load_dwordx4 v9, s[52:55], s28 offen offset:1024   lds
M v[188:191], a[88:91], a[160:163], v[188:191]
M v[224:227], a[32:35], a[168:171], v[224:227]
 ds_read_b128 a[160:163], v5 offset:49152
 ds_read_b128 a[164:167], v6 offset:49152
M v[224:227], a[36:39], a[172:175], v[224:227]
 ds_read_b64_tr_b16 a[148:149], v3 offset:24576
 ds_read_b64_tr_b16 a[150:151], v3 offset:25600
M v[228:231], a[44:47], a[172:175], v[228:231]
 buffer_load_dwordx4 v10, s[52:55], s28 offen offset:2048   lds
M v[228:231], a[40:43], a[168:171], v[228:231]
 ds_read_b64_tr_b16 a[152:153], v4 offset:16384
 ds_read_b64_tr_b16 a[154:155], v4 offset:17408
M v[232:235], a[48:51], a[168:171], v[232:235]
M v[232:235], a[52:55], a[172:175], v[232:235]
M v[236:239], a[60:63], a[172:175], v[236:239]
 ds_read_b64_tr_b16 a[156:157], v4 offset:24576
 ds_read_b64_tr_b16 a[158:159], v4 offset:25600
M v[236:239], a[56:59], a[168:171], v[236:239]
 buffer_load_dwordx4 v11, s[52:55], s28 offen offset:3072   lds
M v[240:243], a[64:67], a[168:171], v[240:243]
 s_add_u32 s28, s28, 128
M v[240:243], a[68:71], a[172:175], v[240:243]
M v[244:247], a[76:79], a[172:175], v[244:247]
M v[244:247], a[72:75], a[168:171], v[244:247]
M v[248:251], a[80:83], a[168:171], v[248:251]
M v[248:251], a[84:87], a[172:175], v[248:251]
 s_waitcnt lgkmcnt(6)
M v[252:255], a[92:95], a[172:175], v[252:255]
 s_waitcnt vmcnt(30) lgkmcnt(0)
M v[252:255], a[88:91], a[168:171], v[252:255]
 s_barrier
M v[32:35], a[96:99], a[160:163], v[32:35]
 s_add_u32 m0, s23, 16384
 ds_read_b128 a[168:171], v5 offset:51200
 ds_read_b128 a[172:175], v6 offset:51200
M v[32:35], a[100:103], a[164:167], v[32:35]
 ds_read_b64_tr_b16 a[32:33], v1 offset:32768
 ds_read_b64_tr_b16 a[34:35], v1 offset:33792
M v[36:39], a[108:111], a[164:167], v[36:39]
 buffer_load_dwordx4 v8, s[52:55], s28 offen offset:0   lds
M v[36:39], a[104:107], a[160:163], v[36:39]
 v_min_u32 v25, 15, v0
 v_lshlrev_b32 v25, 7, v25
M v[40:43], a[112:115], a[160:163], v[40:43]
 s_add_u32 s3, s93, 544768
 ds_read_b64_tr_b16 a[36:37], v1 offset:40960
 ds_read_b64_tr_b16 a[38:39], v1 offset:41984
M v[40:43], a[116:119], a[164:167], v[40:43]
 v_max_u32 v13, 1024, v25
M v[44:47], a[124:127], a[164:167], v[44:47]
 buffer_store_dwordx4 v[88:91], v7, s[8:11], s3 offen offset:0 sc1
M v[44:47], a[120:123], a[160:163], v[44:47]
 ds_read_b64_tr_b16 a[40:41], v2 offset:32768
 ds_read_b64_tr_b16 a[42:43], v2 offset:33792
M v[48:51], a[128:131], a[160:163], v[48:51]
 buffer_load_dwordx4 v9, s[52:55], s28 offen offset:1024   lds
M v[48:51], a[132:135], a[164:167], v[48:51]
M v[52:55], a[140:143], a[164:167], v[52:55]
 ds_read_b64_tr_b16 a[44:45], v2 offset:40960
 ds_read_b64_tr_b16 a[46:47], v2 offset:41984
M v[52:55], a[136:139], a[160:163], v[52:55]
M v[56:59], a[144:147], a[160:163], v[56:59]
M v[56:59], a[148:151], a[164:167], v[56:59]
 s_waitcnt lgkmcnt(8)
 ds_read_b64_tr_b16 a[48:49], v3 offset:32768
 ds_read_b64_tr_b16 a[50:51], v3 offset:33792
M v[60:63], a[156:159], a[164:167], v[60:63]
 buffer_load_dwordx4 v10, s[52:55], s28 offen offset:2048   lds
M v[60:63], a[152:155], a[160:163], v[60:63]
M v[96:99], a[96:99], a[168:171], v[96:99]
 ds_read_b128 a[160:163], v5 offset:53248
 ds_read_b128 a[164:167], v6 offset:53248
M v[96:99], a[100:103], a[172:175], v[96:99]
 ds_read_b64_tr_b16 a[52:53], v3 offset:40960
 ds_read_b64_tr_b16 a[54:55], v3 offset:41984
M v[100:103], a[108:111], a[172:175], v[100:103]
 buffer_store_dwordx4 v[92:95], v7, s[8:11], s3 offen offset:2048 sc1
M v[100:103], a[104:107], a[168:171], v[100:103]
 ds_read_b64_tr_b16 a[56:57], v4 offset:32768
 ds_read_b64_tr_b16 a[58:59], v4 offset:33792
M v[104:107], a[112:115], a[168:171], v[104:107]
M v[104:107], a[116:119], a[172:175], v[104:107]
 buffer_load_dwordx4 v11, s[52:55], s28 offen offset:3072   lds
M v[108:111], a[124:127], a[172:175], v[108:111]
 s_add_u32 s28, s28, 524160
 ds_read_b64_tr_b16 a[60:61], v4 offset:40960
 ds_read_b64_tr_b16 a[62:63], v4 offset:41984
M v[108:111], a[120:123], a[168:171], v[108:111]
M v[112:115], a[128:131], a[168:171], v[112:115]
M v[112:115], a[132:135], a[172:175], v[112:115]
M v[116:119], a[140:143], a[172:175], v[116:119]
M v[116:119], a[136:139], a[168:171], v[116:119]
M v[120:123], a[144:147], a[168:171], v[120:123]
M v[120:123], a[148:151], a[172:175], v[120:123]
 s_waitcnt lgkmcnt(6)
M v[124:127], a[156:159], a[172:175], v[124:127]
 s_waitcnt vmcnt(25) lgkmcnt(0)
M v[124:127], a[152:155], a[168:171], v[124:127]
 s_barrier
M v[160:163], a[96:99], a[160:163], v[160:163]
 ds_read_b128 a[168:171], v5 offset:55296
 ds_read_b128 a[172:175], v6 offset:55296
M v[160:163], a[100:103], a[164:167], v[160:163]
 ds_read_b64_tr_b16 a[64:65], v1 offset:49152
 ds_read_b64_tr_b16 a[66:67], v1 offset:50176
M v[164:167], a[108:111], a[164:167], v[164:167]
 buffer_store_dwordx4 a[208:211], v30, s[8:11], s89 offen offset:0 sc1
M v[164:167], a[104:107], a[160:163], v[164:167]
M v[168:171], a[112:115], a[160:163], v[168:171]
 ds_read_b64_tr_b16 a[68:69], v1 offset:57344
 ds_read_b64_tr_b16 a[70:71], v1 offset:58368
M v[168:171], a[116:119], a[164:167], v[168:171]
M v[172:175], a[124:127], a[164:167], v[172:175]
M v[172:175], a[120:123], a[160:163], v[172:175]
 ds_read_b64_tr_b16 a[72:73], v2 offset:49152
 ds_read_b64_tr_b16 a[74:75], v2 offset:50176
M v[176:179], a[128:131], a[160:163], v[176:179]
M v[176:179], a[132:135], a[164:167], v[176:179]
M v[180:183], a[140:143], a[164:167], v[180:183]
 ds_read_b64_tr_b16 a[76:77], v2 offset:57344
 ds_read_b64_tr_b16 a[78:79], v2 offset:58368
M v[180:183], a[136:139], a[160:163], v[180:183]
M v[184:187], a[144:147], a[160:163], v[184:187]
M v[184:187], a[148:151], a[164:167], v[184:187]
 s_waitcnt lgkmcnt(8)
 ds_read_b64_tr_b16 a[80:81], v3 offset:49152
 ds_read_b64_tr_b16 a[82:83], v3 offset:50176
M v[188:191], a[156:159], a[164:167], v[188:191]
 buffer_store_dwordx4 a[212:215], v30, s[8:11], s89 offen offset:64 sc1
M v[188:191], a[152:155], a[160:163], v[188:191]
M v[224:227], a[96:99], a[168:171], v[224:227]
 ds_read_b128 a[160:163], v5 offset:0
 ds_read_b128 a[164:167], v6 offset:0
M v[224:227], a[100:103], a[172:175], v[224:227]
 ds_read_b64_tr_b16 a[84:85], v3 offset:57344
 ds_read_b64_tr_b16 a[86:87], v3 offset:58368
M v[228:231], a[108:111], a[172:175], v[228:231]
M v[228:231], a[104:107], a[168:171], v[228:231]
 ds_read_b64_tr_b16 a[88:89], v4 offset:49152
 ds_read_b64_tr_b16 a[90:91], v4 offset:50176
M v[232:235], a[112:115], a[168:171], v[232:235]
M v[232:235], a[116:119], a[172:175], v[232:235]
M v[236:239], a[124:127], a[172:175], v[236:239]
 ds_read_b64_tr_b16 a[92:93], v4 offset:57344
 ds_read_b64_tr_b16 a[94:95], v4 offset:58368
M v[236:239], a[120:123], a[168:171], v[236:239]
M v[240:243], a[128:131], a[168:171], v[240:243]
M v[240:243], a[132:135], a[172:175], v[240:243]
M v[244:247], a[140:143], a[172:175], v[244:247]
M v[244:247], a[136:139], a[168:171], v[244:247]
M v[248:251], a[144:147], a[168:171], v[248:251]
M v[248:251], a[148:151], a[172:175], v[248:251]
 s_waitcnt lgkmcnt(6)
M v[252:255], a[156:159], a[172:175], v[252:255]
 s_waitcnt vmcnt(22) lgkmcnt(0)
M v[252:255], a[152:155], a[168:171], v[252:255]
 s_barrier
M v[32:35], a[32:35], a[160:163], v[32:35]
 s_add_u32 m0, s23, 32768
 ds_read_b128 a[168:171], v5 offset:2048
 ds_read_b128 a[172:175], v6 offset:2048
M v[32:35], a[36:39], a[164:167], v[32:35]
 ds_read_b64_tr_b16 a[96:97], v20 offset:0
 ds_read_b64_tr_b16 a[98:99], v20 offset:1024
M v[36:39], a[44:47], a[164:167], v[36:39]
 buffer_load_dwordx4 v16, s[56:59], s29 offen offset:0   lds
M v[36:39], a[40:43], a[160:163], v[36:39]
 buffer_store_dwordx4 a[216:219], v30, s[8:11], s89 offen offset:128 sc1
M v[40:43], a[48:51], a[160:163], v[40:43]
 ds_read_b64_tr_b16 a[100:101], v20 offset:8192
 ds_read_b64_tr_b16 a[102:103], v20 offset:9216
M v[40:43], a[52:55], a[164:167], v[40:43]
 buffer_load_dwordx4 v17, s[56:59], s29 offen offset:1024   lds
M v[44:47], a[60:63], a[164:167], v[44:47]
M v[44:47], a[56:59], a[160:163], v[44:47]
 ds_read_b64_tr_b16 a[104:105], v21 offset:0
 ds_read_b64_tr_b16 a[106:107], v21 offset:1024
M v[48:51], a[64:67], a[160:163], v[48:51]
M v[48:51], a[68:71], a[164:167], v[48:51]
 buffer_load_dwordx4 v18, s[56:59], s29 offen offset:2048   lds
M v[52:55], a[76:79], a[164:167], v[52:55]
 ds_read_b64_tr_b16 a[108:109], v21 offset:8192
 ds_read_b64_tr_b16 a[110:111], v21 offset:9216
M v[52:55], a[72:75], a[160:163], v[52:55]
 buffer_store_dwordx4 a[220:223], v30, s[8:11], s89 offen offset:192 sc1
M v[56:59], a[80:83], a[160:163], v[56:59]
M v[56:59], a[84:87], a[164:167], v[56:59]
 s_waitcnt lgkmcnt(8)
 ds_read_b64_tr_b16 a[112:113], v22 offset:0
 ds_read_b64_tr_b16 a[114:115], v22 offset:1024
M v[60:63], a[92:95], a[164:167], v[60:63]
 buffer_load_dwordx4 v19, s[56:59], s29 offen offset:3072   lds
M v[60:63], a[88:91], a[160:163], v[60:63]
 s_add_u32 s29, s29, 128
M v[96:99], a[32:35], a[168:171], v[96:99]
 ds_read_b128 a[160:163], v5 offset:4096
 ds_read_b128 a[164:167], v6 offset:4096
M v[96:99], a[36:39], a[172:175], v[96:99]
 ds_read_b64_tr_b16 a[116:117], v22 offset:8192
 ds_read_b64_tr_b16 a[118:119], v22 offset:9216
M v[100:103], a[44:47], a[172:175], v[100:103]
 s_lshl_b32 s28, s20, 13
 buffer_store_dwordx4 a[224:227], v30, s[8:11], s89 offen offset:256 sc1
M v[100:103], a[40:43], a[168:171], v[100:103]
 s_lshl_b32 s21, s27, 21
 ds_read_b64_tr_b16 a[120:121], v23 offset:0
 ds_read_b64_tr_b16 a[122:123], v23 offset:1024
M v[104:107], a[48:51], a[168:171], v[104:107]
 s_mov_b32 s22, 0
M v[104:107], a[52:55], a[172:175], v[104:107]
 s_add_u32 s21, s21, s92
M v[108:111], a[60:63], a[172:175], v[108:111]
 s_add_u32 s7, s21, 201326592
 ds_read_b64_tr_b16 a[124:125], v23 offset:8192
 ds_read_b64_tr_b16 a[126:127], v23 offset:9216
M v[108:111], a[56:59], a[168:171], v[108:111]
 s_add_u32 s38, s7, 131072
 buffer_store_dwordx4 a[228:231], v30, s[8:11], s89 offen offset:320 sc1
M v[112:115], a[64:67], a[168:171], v[112:115]
 s_sub_u32 s27, s42, 1
M v[112:115], a[68:71], a[172:175], v[112:115]
 s_mov_b32 s43, 32767
M v[116:119], a[76:79], a[172:175], v[116:119]
 s_mov_b32 s4, 0
 buffer_load_dword v24, v13, s[8:11], s46 offen sc1
M v[116:119], a[72:75], a[168:171], v[116:119]
 s_add_u32 s26, s21, 1310720
 buffer_store_dwordx4 a[232:235], v30, s[8:11], s89 offen offset:384 sc1
M v[120:123], a[80:83], a[168:171], v[120:123]
 s_lshl_b32 s64, s42, 1
 s_add_u32 s65, s64, 4
 s_add_u32 s64, s64, 2
M v[120:123], a[84:87], a[172:175], v[120:123]
 s_waitcnt lgkmcnt(6)
 s_add_u32 s3, s93, 1048576
M v[124:127], a[92:95], a[172:175], v[124:127]
 s_waitcnt vmcnt(23) lgkmcnt(0)
M v[124:127], a[88:91], a[168:171], v[124:127]
 s_barrier
M v[160:163], a[32:35], a[160:163], v[160:163]
 s_cmp_le_u32 s42, 5
 ds_read_b128 a[168:171], v5 offset:6144
 ds_read_b128 a[172:175], v6 offset:6144
M v[160:163], a[36:39], a[164:167], v[160:163]
 s_cselect_b32 s25, s65, 32767
 ds_read_b64_tr_b16 a[128:129], v20 offset:16384
 ds_read_b64_tr_b16 a[130:131], v20 offset:17408
M v[164:167], a[44:47], a[164:167], v[164:167]
 s_cselect_b32 s6, 14, s64
 buffer_store_dwordx4 v[128:131], v7, s[8:11], s3 offen offset:0 sc1
M v[164:167], a[40:43], a[160:163], v[164:167]
 s_mov_b32 s23, 0
M v[168:171], a[48:51], a[160:163], v[168:171]
 ds_read_b64_tr_b16 a[132:133], v20 offset:24576
 ds_read_b64_tr_b16 a[134:135], v20 offset:25600
M v[168:171], a[52:55], a[164:167], v[168:171]
M v[172:175], a[60:63], a[164:167], v[172:175]
 buffer_store_dwordx4 v[132:135], v7, s[8:11], s3 offen offset:2048 sc1
M v[172:175], a[56:59], a[160:163], v[172:175]
 s_add_u32 s3, s93, 1052672
 ds_read_b64_tr_b16 a[136:137], v21 offset:16384
 ds_read_b64_tr_b16 a[138:139], v21 offset:17408
M v[176:179], a[64:67], a[160:163], v[176:179]
M v[176:179], a[68:71], a[164:167], v[176:179]
M v[180:183], a[76:79], a[164:167], v[180:183]
 ds_read_b64_tr_b16 a[140:141], v21 offset:24576
 ds_read_b64_tr_b16 a[142:143], v21 offset:25600
M v[180:183], a[72:75], a[160:163], v[180:183]
 buffer_store_dwordx4 v[136:139], v7, s[8:11], s3 offen offset:0 sc1
M v[184:187], a[80:83], a[160:163], v[184:187]
M v[184:187], a[84:87], a[164:167], v[184:187]
 s_waitcnt lgkmcnt(8)
 ds_read_b64_tr_b16 a[144:145], v22 offset:16384
 ds_read_b64_tr_b16 a[146:147], v22 offset:17408
M v[188:191], a[92:95], a[164:167], v[188:191]
M v[188:191], a[88:91], a[160:163], v[188:191]
 buffer_store_dwordx4 v[140:143], v7, s[8:11], s3 offen offset:2048 sc1
M v[224:227], a[32:35], a[168:171], v[224:227]
 ds_read_b128 a[160:163], v5 offset:16384
 ds_read_b128 a[164:167], v6 offset:16384
M v[224:227], a[36:39], a[172:175], v[224:227]
 s_add_u32 s3, s93, 1064960
 ds_read_b64_tr_b16 a[148:149], v22 offset:24576
 ds_read_b64_tr_b16 a[150:151], v22 offset:25600
M v[228:231], a[44:47], a[172:175], v[228:231]
M v[228:231], a[40:43], a[168:171], v[228:231]
 ds_read_b64_tr_b16 a[152:153], v23 offset:16384
 ds_read_b64_tr_b16 a[154:155], v23 offset:17408
M v[232:235], a[48:51], a[168:171], v[232:235]
 buffer_store_dwordx4 v[144:147], v7, s[8:11], s3 offen offset:0 sc1
M v[232:235], a[52:55], a[172:175], v[232:235]
M v[236:239], a[60:63], a[172:175], v[236:239]
 ds_read_b64_tr_b16 a[156:157], v23 offset:24576
 ds_read_b64_tr_b16 a[158:159], v23 offset:25600
M v[236:239], a[56:59], a[168:171], v[236:239]
M v[240:243], a[64:67], a[168:171], v[240:243]
M v[240:243], a[68:71], a[172:175], v[240:243]
M v[244:247], a[76:79], a[172:175], v[244:247]
M v[244:247], a[72:75], a[168:171], v[244:247]
M v[248:251], a[80:83], a[168:171], v[248:251]
M v[248:251], a[84:87], a[172:175], v[248:251]
 s_waitcnt lgkmcnt(6)
M v[252:255], a[92:95], a[172:175], v[252:255]
 s_waitcnt vmcnt(23) lgkmcnt(0)
M v[252:255], a[88:91], a[168:171], v[252:255]
 s_barrier
M v[32:35], a[96:99], a[160:163], v[32:35]
 ds_read_b128 a[168:171], v5 offset:18432
 ds_read_b128 a[172:175], v6 offset:18432
M v[32:35], a[100:103], a[164:167], v[32:35]
 ds_read_b64_tr_b16 a[32:33], v1 offset:0
 ds_read_b64_tr_b16 a[34:35], v1 offset:1024
M v[36:39], a[108:111], a[164:167], v[36:39]
 v_add_u32 v10, s28, v7
 v_add_u32 v10, s28, v10
M v[36:39], a[104:107], a[160:163], v[36:39]
 v_add_u32 v11, 0x1000, v10
 s_waitcnt vmcnt(6)
 v_cmp_eq_u32 vcc, 0, v24
M v[40:43], a[112:115], a[160:163], v[40:43]
 s_lshl_b32 s64, s20, 10
 ds_read_b64_tr_b16 a[36:37], v1 offset:8192
 ds_read_b64_tr_b16 a[38:39], v1 offset:9216
M v[40:43], a[116:119], a[164:167], v[40:43]
 s_cbranch_vccnz L_f1s04
L_f1r04:
M v[44:47], a[124:127], a[164:167], v[44:47]
 s_add_u32 m0, s28, 98304
 s_nop 0
 buffer_load_dwordx4 v10, s[8:11], s21 offen offset:0 sc1 lds
M v[44:47], a[120:123], a[160:163], v[44:47]
 ds_read_b64_tr_b16 a[40:41], v2 offset:0
 ds_read_b64_tr_b16 a[42:43], v2 offset:1024
M v[48:51], a[128:131], a[160:163], v[48:51]
 buffer_store_dwordx4 v[148:151], v7, s[8:11], s3 offen offset:2048 sc1
M v[48:51], a[132:135], a[164:167], v[48:51]
M v[52:55], a[140:143], a[164:167], v[52:55]
 ds_read_b64_tr_b16 a[44:45], v2 offset:8192
 ds_read_b64_tr_b16 a[46:47], v2 offset:9216
M v[52:55], a[136:139], a[160:163], v[52:55]
 buffer_load_dwordx4 v10, s[8:11], s21 offen offset:1024 sc1 lds
M v[56:59], a[144:147], a[160:163], v[56:59]
M v[56:59], a[148:151], a[164:167], v[56:59]
 s_waitcnt lgkmcnt(8)
 ds_read_b64_tr_b16 a[48:49], v3 offset:0
 ds_read_b64_tr_b16 a[50:51], v3 offset:1024
M v[60:63], a[156:159], a[164:167], v[60:63]
M v[60:63], a[152:155], a[160:163], v[60:63]
 s_add_u32 s3, s93, 1069056
 buffer_load_dwordx4 v10, s[8:11], s21 offen offset:2048 sc1 lds
M v[96:99], a[96:99], a[168:171], v[96:99]
 ds_read_b128 a[160:163], v5 offset:20480
 ds_read_b128 a[164:167], v6 offset:20480
M v[96:99], a[100:103], a[172:175], v[96:99]
 ds_read_b64_tr_b16 a[52:53], v3 offset:8192
 ds_read_b64_tr_b16 a[54:55], v3 offset:9216
M v[100:103], a[108:111], a[172:175], v[100:103]
 buffer_store_dwordx4 v[152:155], v7, s[8:11], s3 offen offset:0 sc1
M v[100:103], a[104:107], a[168:171], v[100:103]
 ds_read_b64_tr_b16 a[56:57], v4 offset:0
 ds_read_b64_tr_b16 a[58:59], v4 offset:1024
M v[104:107], a[112:115], a[168:171], v[104:107]
 buffer_load_dwordx4 v10, s[8:11], s21 offen offset:3072 sc1 lds
M v[104:107], a[116:119], a[172:175], v[104:107]
 s_add_u32 m0, s28, 102400
M v[108:111], a[124:127], a[172:175], v[108:111]
 ds_read_b64_tr_b16 a[60:61], v4 offset:8192
 ds_read_b64_tr_b16 a[62:63], v4 offset:9216
M v[108:111], a[120:123], a[168:171], v[108:111]
M v[112:115], a[128:131], a[168:171], v[112:115]
 buffer_load_dwordx4 v11, s[8:11], s21 offen offset:0 sc1 lds
M v[112:115], a[132:135], a[172:175], v[112:115]
M v[116:119], a[140:143], a[172:175], v[116:119]
 buffer_store_dwordx4 v[156:159], v7, s[8:11], s3 offen offset:2048 sc1
M v[116:119], a[136:139], a[168:171], v[116:119]
M v[120:123], a[144:147], a[168:171], v[120:123]
 buffer_load_dwordx4 v11, s[8:11], s21 offen offset:1024 sc1 lds
M v[120:123], a[148:151], a[172:175], v[120:123]
 s_waitcnt lgkmcnt(6)
M v[124:127], a[156:159], a[172:175], v[124:127]
 s_waitcnt lgkmcnt(0)
 buffer_load_dwordx4 v11, s[8:11], s21 offen offset:2048 sc1 lds
M v[124:127], a[152:155], a[168:171], v[124:127]
 s_barrier
M v[160:163], a[96:99], a[160:163], v[160:163]
 ds_read_b128 a[168:171], v5 offset:22528
 ds_read_b128 a[172:175], v6 offset:22528
M v[160:163], a[100:103], a[164:167], v[160:163]
 ds_read_b64_tr_b16 a[64:65], v1 offset:16384
 ds_read_b64_tr_b16 a[66:67], v1 offset:17408
M v[164:167], a[108:111], a[164:167], v[164:167]
 buffer_load_dwordx4 v11, s[8:11], s21 offen offset:3072 sc1 lds
M v[164:167], a[104:107], a[160:163], v[164:167]
 s_add_u32 s24, s23, 33554432
M v[168:171], a[112:115], a[160:163], v[168:171]
 s_mov_b32 s23, s21
 ds_read_b64_tr_b16 a[68:69], v1 offset:24576
 ds_read_b64_tr_b16 a[70:71], v1 offset:25600
M v[168:171], a[116:119], a[164:167], v[168:171]
 s_add_u32 s21, s21, 65536
 s_add_u32 s3, s93, 1572864
M v[172:175], a[124:127], a[164:167], v[172:175]
 s_add_u32 s22, s22, 1
 buffer_store_dwordx4 v[192:195], v7, s[8:11], s3 offen offset:0 sc1
M v[172:175], a[120:123], a[160:163], v[172:175]
 s_cmp_eq_u32 s22, s25
 ds_read_b64_tr_b16 a[72:73], v2 offset:16384
 ds_read_b64_tr_b16 a[74:75], v2 offset:17408
M v[176:179], a[128:131], a[160:163], v[176:179]
 s_cselect_b32 s21, s26, s21
 v_subrev_u32 v5, 0x10000, v5
 v_subrev_u32 v6, 0x10000, v6
M v[176:179], a[132:135], a[164:167], v[176:179]
 s_cmp_eq_u32 s22, s43
M v[180:183], a[140:143], a[164:167], v[180:183]
 s_cselect_b32 s21, s4, s21
 ds_read_b64_tr_b16 a[76:77], v2 offset:24576
 ds_read_b64_tr_b16 a[78:79], v2 offset:25600
M v[180:183], a[136:139], a[160:163], v[180:183]
 s_cmp_eq_u32 s22, s6
M v[184:187], a[144:147], a[160:163], v[184:187]
 s_cselect_b32 s21, s7, s21
 v_mov_b32 v9, v25
 v_lshrrev_b32 v24, 4, v0
M v[184:187], a[148:151], a[164:167], v[184:187]
 s_waitcnt lgkmcnt(8)
 ds_read_b64_tr_b16 a[80:81], v3 offset:16384
 ds_read_b64_tr_b16 a[82:83], v3 offset:17408
M v[188:191], a[156:159], a[164:167], v[188:191]
 v_lshlrev_b32 v24, 2, v24
 v_and_b32 v25, 15, v0
M v[188:191], a[152:155], a[160:163], v[188:191]
 v_sub_u32 v24, v24, v25
M v[224:227], a[96:99], a[168:171], v[224:227]
 s_add_u32 s64, s64, s34
 ds_read_b128 a[160:163], v5 offset:32768
 ds_read_b128 a[164:167], v6 offset:32768
M v[224:227], a[100:103], a[172:175], v[224:227]
 s_add_u32 s52, s64, 131072
 ds_read_b64_tr_b16 a[84:85], v3 offset:24576
 ds_read_b64_tr_b16 a[86:87], v3 offset:25600
M v[228:231], a[108:111], a[172:175], v[228:231]
 s_mov_b32 s55, 0x21800000
 buffer_store_dwordx4 v[196:199], v7, s[8:11], s3 offen offset:2048 sc1
M v[228:231], a[104:107], a[168:171], v[228:231]
 s_and_b32 s65, s39, 0
 ds_read_b64_tr_b16 a[88:89], v4 offset:16384
 ds_read_b64_tr_b16 a[90:91], v4 offset:17408
M v[232:235], a[112:115], a[168:171], v[232:235]
 s_cmp_eq_u32 s20, 0
M v[232:235], a[116:119], a[172:175], v[232:235]
 s_cselect_b32 s54, s39, s65
M v[236:239], a[124:127], a[172:175], v[236:239]
 s_lshr_b32 s64, s20, 1
 ds_read_b64_tr_b16 a[92:93], v4 offset:24576
 ds_read_b64_tr_b16 a[94:95], v4 offset:25600
M v[236:239], a[120:123], a[168:171], v[236:239]
 s_lshl_b32 s64, s64, 17
M v[240:243], a[128:131], a[168:171], v[240:243]
 s_and_b32 s65, s20, 1
M v[240:243], a[132:135], a[172:175], v[240:243]
 s_lshl_b32 s65, s65, 12
M v[244:247], a[140:143], a[172:175], v[244:247]
 s_add_u32 s64, s64, s65
 v_add_u32 v14, s64, v7
 v_mov_b32 v8, 0xff800000
M v[244:247], a[136:139], a[168:171], v[244:247]
 v_cmp_lt_i32 s[16:17], 0, v24
 v_cmp_lt_i32 s[18:19], -1, v24
M v[248:251], a[144:147], a[168:171], v[248:251]
 v_cmp_lt_i32 s[48:49], -2, v24
 v_cmp_lt_i32 s[50:51], -3, v24
M v[248:251], a[148:151], a[172:175], v[248:251]
 s_waitcnt lgkmcnt(6)
M v[252:255], a[156:159], a[172:175], v[252:255]
 s_waitcnt lgkmcnt(0)
M v[252:255], a[152:155], a[168:171], v[252:255]
 s_barrier
M v[32:35], a[32:35], a[160:163], v[32:35]
 ds_read_b128 a[168:171], v5 offset:34816
 ds_read_b128 a[172:175], v6 offset:34816
M v[32:35], a[36:39], a[164:167], v[32:35]
 buffer_load_dword v24, v9, s[8:11], s46 offen sc1
M v[36:39], a[44:47], a[164:167], v[36:39]
 v_mov_b32 v1, v15
 v_add_u32 v2, 0x10000, v7
M v[36:39], a[40:43], a[160:163], v[36:39]
 v_mov_b32 v3, v10
 v_mov_b32 v4, v11
M v[40:43], a[48:51], a[160:163], v[40:43]
 s_mov_b64 s[60:61], s[76:77]
M v[40:43], a[52:55], a[164:167], v[40:43]
 s_mov_b32 s62, s78
M v[44:47], a[60:63], a[164:167], v[44:47]
 s_mov_b32 s63, 0x20000
 v_lshl_add_u32 v10, v0, 7, s95
 v_and_b32 v0, 48, v0
M v[44:47], a[56:59], a[160:163], v[44:47]
 v_lshl_add_u32 v0, v0, 24, v10
 v_mul_f32 v32, s5, v32
M v[48:51], a[64:67], a[160:163], v[48:51]
 v_mul_f32 v33, s5, v33
 v_mul_f32 v34, s5, v34
M v[48:51], a[68:71], a[164:167], v[48:51]
 v_mul_f32 v35, s5, v35
 v_mul_f32 v36, s5, v36
M v[52:55], a[76:79], a[164:167], v[52:55]
 v_mul_f32 v37, s5, v37
 v_mul_f32 v38, s5, v38
M v[52:55], a[72:75], a[160:163], v[52:55]
 v_mul_f32 v39, s5, v39
 v_cvt_pk_bf16_f32 v32, v32, v33
M v[56:59], a[80:83], a[160:163], v[56:59]
 v_cvt_pk_bf16_f32 v33, v34, v35
 v_cvt_pk_bf16_f32 v34, v36, v37
M v[56:59], a[84:87], a[164:167], v[56:59]
 s_waitcnt lgkmcnt(0)
 v_cvt_pk_bf16_f32 v35, v38, v39
 ds_write_b128 v14, v[32:35] offset:0
M v[60:63], a[92:95], a[164:167], v[60:63]
 s_add_u32 s3, s93, 1576960
 buffer_store_dwordx4 v[200:203], v7, s[8:11], s3 offen offset:0 sc1
M v[60:63], a[88:91], a[160:163], v[60:63]
 v_mul_f32 v40, s5, v40
 v_mul_f32 v41, s5, v41
M v[96:99], a[32:35], a[168:171], v[96:99]
 ds_read_b128 a[160:163], v5 offset:36864
 ds_read_b128 a[164:167], v6 offset:36864
M v[96:99], a[36:39], a[172:175], v[96:99]
 v_mul_f32 v42, s5, v42
 v_mul_f32 v43, s5, v43
M v[100:103], a[44:47], a[172:175], v[100:103]
 v_mul_f32 v44, s5, v44
 v_mul_f32 v45, s5, v45
M v[100:103], a[40:43], a[168:171], v[100:103]
 v_mul_f32 v46, s5, v46
 v_mul_f32 v47, s5, v47
M v[104:107], a[48:51], a[168:171], v[104:107]
 v_cvt_pk_bf16_f32 v40, v40, v41
 v_cvt_pk_bf16_f32 v41, v42, v43
M v[104:107], a[52:55], a[172:175], v[104:107]
 v_cvt_pk_bf16_f32 v42, v44, v45
 v_cvt_pk_bf16_f32 v43, v46, v47
M v[108:111], a[60:63], a[172:175], v[108:111]
 ds_write_b128 v14, v[40:43] offset:1024
M v[108:111], a[56:59], a[168:171], v[108:111]
 buffer_store_dwordx4 v[204:207], v7, s[8:11], s3 offen offset:2048 sc1
M v[112:115], a[64:67], a[168:171], v[112:115]
 v_mul_f32 v48, s5, v48
 v_mul_f32 v49, s5, v49
M v[112:115], a[68:71], a[172:175], v[112:115]
 v_mul_f32 v50, s5, v50
 v_mul_f32 v51, s5, v51
M v[116:119], a[76:79], a[172:175], v[116:119]
 v_mul_f32 v52, s5, v52
 v_mul_f32 v53, s5, v53
M v[116:119], a[72:75], a[168:171], v[116:119]
 v_mul_f32 v54, s5, v54
 v_mul_f32 v55, s5, v55
M v[120:123], a[80:83], a[168:171], v[120:123]
 v_cvt_pk_bf16_f32 v48, v48, v49
 v_cvt_pk_bf16_f32 v49, v50, v51
M v[120:123], a[84:87], a[172:175], v[120:123]
 s_waitcnt lgkmcnt(1)
 v_cvt_pk_bf16_f32 v50, v52, v53
 v_cvt_pk_bf16_f32 v51, v54, v55
M v[124:127], a[92:95], a[172:175], v[124:127]
 ds_write_b128 v14, v[48:51] offset:2048
M v[124:127], a[88:91], a[168:171], v[124:127]
 s_add_u32 s3, s93, 1589248
 buffer_store_dwordx4 v[208:211], v7, s[8:11], s3 offen offset:0 sc1
M v[160:163], a[32:35], a[160:163], v[160:163]
 ds_read_b128 a[168:171], v5 offset:38912
 ds_read_b128 a[172:175], v6 offset:38912
M v[160:163], a[36:39], a[164:167], v[160:163]
 v_mul_f32 v56, s5, v56
 v_mul_f32 v57, s5, v57
M v[164:167], a[44:47], a[164:167], v[164:167]
 v_mul_f32 v58, s5, v58
 v_mul_f32 v59, s5, v59
M v[164:167], a[40:43], a[160:163], v[164:167]
 v_mul_f32 v60, s5, v60
 v_mul_f32 v61, s5, v61
M v[168:171], a[48:51], a[160:163], v[168:171]
 v_mul_f32 v62, s5, v62
 v_mul_f32 v63, s5, v63
M v[168:171], a[52:55], a[164:167], v[168:171]
 v_cvt_pk_bf16_f32 v56, v56, v57
 v_cvt_pk_bf16_f32 v57, v58, v59
M v[172:175], a[60:63], a[164:167], v[172:175]
 v_cvt_pk_bf16_f32 v58, v60, v61
 v_cvt_pk_bf16_f32 v59, v62, v63
M v[172:175], a[56:59], a[160:163], v[172:175]
 s_waitcnt lgkmcnt(0)
 ds_write_b128 v14, v[56:59] offset:3072
M v[176:179], a[64:67], a[160:163], v[176:179]
 s_barrier
M v[176:179], a[68:71], a[164:167], v[176:179]
M v[180:183], a[76:79], a[164:167], v[180:183]
 s_add_u32 m0, s28, 32768
 s_nop 0
 buffer_load_dwordx4 v3, s[8:11], s21 offen offset:0 sc1 lds
M v[180:183], a[72:75], a[160:163], v[180:183]
M v[184:187], a[80:83], a[160:163], v[184:187]
 buffer_store_dwordx4 v[212:215], v7, s[8:11], s3 offen offset:2048 sc1
M v[184:187], a[84:87], a[164:167], v[184:187]
 v_mul_f32 v96, s5, v96
 v_mul_f32 v97, s5, v97
M v[188:191], a[92:95], a[164:167], v[188:191]
 buffer_load_dwordx4 v3, s[8:11], s21 offen offset:1024 sc1 lds
M v[188:191], a[88:91], a[160:163], v[188:191]
 v_mul_f32 v98, s5, v98
 v_mul_f32 v99, s5, v99
M v[224:227], a[32:35], a[168:171], v[224:227]
 v_mul_f32 v100, s5, v100
 v_mul_f32 v101, s5, v101
M v[224:227], a[36:39], a[172:175], v[224:227]
 v_mul_f32 v102, s5, v102
 v_mul_f32 v103, s5, v103
M v[228:231], a[44:47], a[172:175], v[228:231]
 buffer_load_dwordx4 v3, s[8:11], s21 offen offset:2048 sc1 lds
M v[228:231], a[40:43], a[168:171], v[228:231]
 v_cvt_pk_bf16_f32 v96, v96, v97
 v_cvt_pk_bf16_f32 v97, v98, v99
M v[232:235], a[48:51], a[168:171], v[232:235]
 v_cvt_pk_bf16_f32 v98, v100, v101
 v_cvt_pk_bf16_f32 v99, v102, v103
M v[232:235], a[52:55], a[172:175], v[232:235]
 ds_write_b128 v14, v[96:99] offset:8192
M v[236:239], a[60:63], a[172:175], v[236:239]
 s_add_u32 s3, s93, 1593344
 buffer_load_dwordx4 v3, s[8:11], s21 offen offset:3072 sc1 lds
M v[236:239], a[56:59], a[168:171], v[236:239]
 s_add_u32 m0, s28, 36864
M v[240:243], a[64:67], a[168:171], v[240:243]
 buffer_store_dwordx4 v[216:219], v7, s[8:11], s3 offen offset:0 sc1
M v[240:243], a[68:71], a[172:175], v[240:243]
 v_mul_f32 v104, s5, v104
 v_mul_f32 v105, s5, v105
M v[244:247], a[76:79], a[172:175], v[244:247]
 buffer_load_dwordx4 v4, s[8:11], s21 offen offset:0 sc1 lds
M v[244:247], a[72:75], a[168:171], v[244:247]
 v_mul_f32 v106, s5, v106
 v_mul_f32 v107, s5, v107
M v[248:251], a[80:83], a[168:171], v[248:251]
 v_mul_f32 v108, s5, v108
 v_mul_f32 v109, s5, v109
M v[248:251], a[84:87], a[172:175], v[248:251]
 v_mul_f32 v110, s5, v110
 v_mul_f32 v111, s5, v111
M v[252:255], a[92:95], a[172:175], v[252:255]
 buffer_load_dwordx4 v4, s[8:11], s21 offen offset:1024 sc1 lds
M v[252:255], a[88:91], a[168:171], v[252:255]
 buffer_load_dwordx4 v4, s[8:11], s21 offen offset:2048 sc1 lds
 buffer_load_dwordx4 v4, s[8:11], s21 offen offset:3072 sc1 lds
 s_add_u32 s24, s23, 33554432
 s_mov_b32 s23, s21
 s_add_u32 s21, s21, 65536
 s_add_u32 s22, s22, 1
 s_cmp_eq_u32 s22, s25
 s_cselect_b32 s21, s26, s21
 s_cmp_eq_u32 s22, s43
 s_cselect_b32 s21, s4, s21
 s_cmp_eq_u32 s22, s6
 s_cselect_b32 s21, s7, s21
 v_cvt_pk_bf16_f32 v104, v104, v105
 v_cvt_pk_bf16_f32 v105, v106, v107
 v_cvt_pk_bf16_f32 v106, v108, v109
 v_cvt_pk_bf16_f32 v107, v110, v111
 ds_write_b128 v14, v[104:107] offset:9216
 buffer_store_dwordx4 v[220:223], v7, s[8:11], s3 offen offset:2048 sc1
 v_pk_mul_f32 v[112:113], v[112:113], s[4:5] op_sel:[0,1] op_sel_hi:[1,1]
 v_pk_mul_f32 v[114:115], v[114:115], s[4:5] op_sel:[0,1] op_sel_hi:[1,1]
 v_pk_mul_f32 v[116:117], v[116:117], s[4:5] op_sel:[0,1] op_sel_hi:[1,1]
 v_pk_mul_f32 v[118:119], v[118:119], s[4:5] op_sel:[0,1] op_sel_hi:[1,1]
 v_cvt_pk_bf16_f32 v112, v112, v113
 v_cvt_pk_bf16_f32 v113, v114, v115
 v_cvt_pk_bf16_f32 v114, v116, v117
 v_cvt_pk_bf16_f32 v115, v118, v119
 ds_write_b128 v14, v[112:115] offset:10240
 v_pk_mul_f32 v[120:121], v[120:121], s[4:5] op_sel:[0,1] op_sel_hi:[1,1]
 v_pk_mul_f32 v[122:123], v[122:123], s[4:5] op_sel:[0,1] op_sel_hi:[1,1]
 v_pk_mul_f32 v[124:125], v[124:125], s[4:5] op_sel:[0,1] op_sel_hi:[1,1]
 v_pk_mul_f32 v[126:127], v[126:127], s[4:5] op_sel:[0,1] op_sel_hi:[1,1]
 v_cvt_pk_bf16_f32 v120, v120, v121
 v_cvt_pk_bf16_f32 v121, v122, v123
 v_cvt_pk_bf16_f32 v122, v124, v125
 v_cvt_pk_bf16_f32 v123, v126, v127
 ds_write_b128 v14, v[120:123] offset:11264
 v_pk_mul_f32 v[160:161], v[160:161], s[4:5] op_sel:[0,1] op_sel_hi:[1,1]
 v_pk_mul_f32 v[162:163], v[162:163], s[4:5] op_sel:[0,1] op_sel_hi:[1,1]
 v_pk_mul_f32 v[164:165], v[164:165], s[4:5] op_sel:[0,1] op_sel_hi:[1,1]
 v_pk_mul_f32 v[166:167], v[166:167], s[4:5] op_sel:[0,1] op_sel_hi:[1,1]
 v_cvt_pk_bf16_f32 v160, v160, v161
 v_cvt_pk_bf16_f32 v161, v162, v163
 v_cvt_pk_bf16_f32 v162, v164, v165
 v_cvt_pk_bf16_f32 v163, v166, v167
 ds_write_b128 v14, v[160:163] offset:16384
 v_pk_mul_f32 v[168:169], v[168:169], s[4:5] op_sel:[0,1] op_sel_hi:[1,1]
 v_pk_mul_f32 v[170:171], v[170:171], s[4:5] op_sel:[0,1] op_sel_hi:[1,1]
 v_pk_mul_f32 v[172:173], v[172:173], s[4:5] op_sel:[0,1] op_sel_hi:[1,1]
 v_pk_mul_f32 v[174:175], v[174:175], s[4:5] op_sel:[0,1] op_sel_hi:[1,1]
 v_cvt_pk_bf16_f32 v168, v168, v169
 v_cvt_pk_bf16_f32 v169, v170, v171
 v_cvt_pk_bf16_f32 v170, v172, v173
 v_cvt_pk_bf16_f32 v171, v174, v175
 ds_write_b128 v14, v[168:171] offset:17408
 v_pk_mul_f32 v[176:177], v[176:177], s[4:5] op_sel:[0,1] op_sel_hi:[1,1]
 v_pk_mul_f32 v[178:179], v[178:179], s[4:5] op_sel:[0,1] op_sel_hi:[1,1]
 v_pk_mul_f32 v[180:181], v[180:181], s[4:5] op_sel:[0,1] op_sel_hi:[1,1]
 v_pk_mul_f32 v[182:183], v[182:183], s[4:5] op_sel:[0,1] op_sel_hi:[1,1]
 v_cvt_pk_bf16_f32 v176, v176, v177
 v_cvt_pk_bf16_f32 v177, v178, v179
 v_cvt_pk_bf16_f32 v178, v180, v181
 v_cvt_pk_bf16_f32 v179, v182, v183
 ds_write_b128 v14, v[176:179] offset:18432
 v_pk_mul_f32 v[184:185], v[184:185], s[4:5] op_sel:[0,1] op_sel_hi:[1,1]
 v_pk_mul_f32 v[186:187], v[186:187], s[4:5] op_sel:[0,1] op_sel_hi:[1,1]
 v_pk_mul_f32 v[188:189], v[188:189], s[4:5] op_sel:[0,1] op_sel_hi:[1,1]
 v_pk_mul_f32 v[190:191], v[190:191], s[4:5] op_sel:[0,1] op_sel_hi:[1,1]
 v_cvt_pk_bf16_f32 v184, v184, v185
 v_cvt_pk_bf16_f32 v185, v186, v187
 v_cvt_pk_bf16_f32 v186, v188, v189
 v_cvt_pk_bf16_f32 v187, v190, v191
 ds_write_b128 v14, v[184:187] offset:19456
 v_pk_mul_f32 v[224:225], v[224:225], s[4:5] op_sel:[0,1] op_sel_hi:[1,1]
 v_pk_mul_f32 v[226:227], v[226:227], s[4:5] op_sel:[0,1] op_sel_hi:[1,1]
 v_pk_mul_f32 v[228:229], v[228:229], s[4:5] op_sel:[0,1] op_sel_hi:[1,1]
 v_pk_mul_f32 v[230:231], v[230:231], s[4:5] op_sel:[0,1] op_sel_hi:[1,1]
 v_cvt_pk_bf16_f32 v224, v224, v225
 v_cvt_pk_bf16_f32 v225, v226, v227
 v_cvt_pk_bf16_f32 v226, v228, v229
 v_cvt_pk_bf16_f32 v227, v230, v231
 ds_write_b128 v14, v[224:227] offset:24576
 v_pk_mul_f32 v[232:233], v[232:233], s[4:5] op_sel:[0,1] op_sel_hi:[1,1]
 v_pk_mul_f32 v[234:235], v[234:235], s[4:5] op_sel:[0,1] op_sel_hi:[1,1]
 v_pk_mul_f32 v[236:237], v[236:237], s[4:5] op_sel:[0,1] op_sel_hi:[1,1]
 v_pk_mul_f32 v[238:239], v[238:239], s[4:5] op_sel:[0,1] op_sel_hi:[1,1]
 v_cvt_pk_bf16_f32 v232, v232, v233
 v_cvt_pk_bf16_f32 v233, v234, v235
 v_cvt_pk_bf16_f32 v234, v236, v237
 v_cvt_pk_bf16_f32 v235, v238, v239
 ds_write_b128 v14, v[232:235] offset:25600
 v_pk_mul_f32 v[240:241], v[240:241], s[4:5] op_sel:[0,1] op_sel_hi:[1,1]
 v_pk_mul_f32 v[242:243], v[242:243], s[4:5] op_sel:[0,1] op_sel_hi:[1,1]
 v_pk_mul_f32 v[244:245], v[244:245], s[4:5] op_sel:[0,1] op_sel_hi:[1,1]
 v_pk_mul_f32 v[246:247], v[246:247], s[4:5] op_sel:[0,1] op_sel_hi:[1,1]
 v_cvt_pk_bf16_f32 v240, v240, v241
 v_cvt_pk_bf16_f32 v241, v242, v243
 v_cvt_pk_bf16_f32 v242, v244, v245
 v_cvt_pk_bf16_f32 v243, v246, v247
 ds_write_b128 v14, v[240:243] offset:26624
 v_pk_mul_f32 v[248:249], v[248:249], s[4:5] op_sel:[0,1] op_sel_hi:[1,1]
 v_pk_mul_f32 v[250:251], v[250:251], s[4:5] op_sel:[0,1] op_sel_hi:[1,1]
 v_pk_mul_f32 v[252:253], v[252:253], s[4:5] op_sel:[0,1] op_sel_hi:[1,1]
 v_pk_mul_f32 v[254:255], v[254:255], s[4:5] op_sel:[0,1] op_sel_hi:[1,1]
 v_cvt_pk_bf16_f32 v248, v248, v249
 v_cvt_pk_bf16_f32 v249, v250, v251
 v_cvt_pk_bf16_f32 v250, v252, v253
 v_cvt_pk_bf16_f32 v251, v254, v255
 ds_write_b128 v14, v[248:251] offset:27648
 s_waitcnt vmcnt(17) lgkmcnt(0)
 s_barrier
 ds_read_b128 a[64:67], v2 offset:32768
 ds_read_b128 a[68:71], v2 offset:33792
 ds_read_b128 a[72:75], v2 offset:34816
 ds_read_b128 a[76:79], v2 offset:35840
 ds_read_b128 a[80:83], v2 offset:36864
 ds_read_b128 a[84:87], v2 offset:37888
 ds_read_b128 a[88:91], v2 offset:38912
 ds_read_b128 a[92:95], v2 offset:39936
 s_lshl_b32 s64, s20, 13
 s_sub_u32 s65, 155648, s64
 v_add_u32 v10, s64, v7
 v_add_u32 v11, s65, v7
 ds_read_b128 a[0:3], v10 offset:0
 ds_read_b128 a[4:7], v10 offset:1024
 ds_read_b128 a[8:11], v10 offset:2048
 ds_read_b128 a[12:15], v10 offset:3072
 ds_read_b128 a[16:19], v10 offset:4096
 ds_read_b128 a[20:23], v10 offset:5120
 ds_read_b128 a[24:27], v10 offset:6144
 ds_read_b128 a[28:31], v10 offset:7168
 ds_read_b128 a[32:35], v11 offset:0
 ds_read_b128 a[36:39], v11 offset:1024
 ds_read_b128 a[40:43], v11 offset:2048
 ds_read_b128 a[44:47], v11 offset:3072
 ds_read_b128 a[48:51], v11 offset:4096
 ds_read_b128 a[52:55], v11 offset:5120
 ds_read_b128 a[56:59], v11 offset:6144
 ds_read_b128 a[60:63], v11 offset:7168
 s_waitcnt vmcnt(14)
 v_cmp_eq_u32 vcc, 0, v24
 v_mov_b32 v17, 5
 v_or_b32 v6, s35, v7
 s_cbranch_vccnz L_f1s05
L_f1r05:
 s_mov_b32 s30, s93
 s_add_u32 s29, s94, s92
 s_cmp_eq_u32 s20, 0
 s_cselect_b32 s5, 0, 0
 v_mov_b32 v32, 0xc1800000
 v_mov_b32 v33, 0xc1800000
 v_mov_b32 v34, 0xc1800000
 v_mov_b32 v35, 0xc1800000
 v_mov_b32 v36, 0xc1800000
 v_mov_b32 v37, 0xc1800000
 v_mov_b32 v38, 0xc1800000
 v_mov_b32 v39, 0xc1800000
 s_waitcnt lgkmcnt(0)
M v[64:67], a[64:67], a[0:3], v[32:35]
 ds_read_b128 a[96:99], v2 offset:40960
 v_mov_b32 v30, 0
M v[64:67], a[68:71], a[4:7], v[64:67]
 s_add_u32 m0, s28, 65536
 ds_read_b128 a[100:103], v2 offset:41984
 v_mov_b32 v31, 0
M v[64:67], a[72:75], a[8:11], v[64:67]
 buffer_load_dwordx4 v3, s[8:11], s24 offen offset:0 sc1 lds
M v[64:67], a[76:79], a[12:15], v[64:67]
 ds_read_b128 a[104:107], v2 offset:43008
M v[64:67], a[80:83], a[16:19], v[64:67]
 ds_read_b128 a[108:111], v2 offset:44032
M v[64:67], a[84:87], a[20:23], v[64:67]
 buffer_load_dwordx4 v3, s[8:11], s24 offen offset:1024 sc1 lds
M v[64:67], a[88:91], a[24:27], v[64:67]
 ds_read_b128 a[112:115], v2 offset:45056
M v[64:67], a[92:95], a[28:31], v[64:67]
 ds_read_b128 a[116:119], v2 offset:46080
M v[68:71], a[92:95], a[60:63], v[36:39]
M v[68:71], a[88:91], a[56:59], v[68:71]
 ds_read_b128 a[120:123], v2 offset:47104
M v[68:71], a[84:87], a[52:55], v[68:71]
 ds_read_b128 a[124:127], v2 offset:48128
M v[68:71], a[80:83], a[48:51], v[68:71]
 buffer_load_dwordx4 v3, s[8:11], s24 offen offset:2048 sc1 lds
M v[68:71], a[76:79], a[44:47], v[68:71]
 v_exp_f32 v18, v64
M v[68:71], a[72:75], a[40:43], v[68:71]
 v_exp_f32 v19, v65
M v[68:71], a[68:71], a[36:39], v[68:71]
 v_exp_f32 v20, v66
M v[68:71], a[64:67], a[32:35], v[68:71]
 s_waitcnt lgkmcnt(0)
 v_exp_f32 v21, v67
M v[72:75], a[96:99], a[0:3], v[32:35]
 ds_read_b128 a[64:67], v2 offset:49152
 v_add_f32 v26, v18, v19
M v[72:75], a[100:103], a[4:7], v[72:75]
 ds_read_b128 a[68:71], v2 offset:50176
 v_cvt_pk_bf16_f32 v40, v18, v19
M v[72:75], a[104:107], a[8:11], v[72:75]
 buffer_load_dwordx4 v3, s[8:11], s24 offen offset:3072 sc1 lds
M v[72:75], a[108:111], a[12:15], v[72:75]
 ds_read_b128 a[72:75], v2 offset:51200
 v_add_f32 v26, v20, v26
M v[72:75], a[112:115], a[16:19], v[72:75]
 s_add_u32 m0, s28, 69632
 ds_read_b128 a[76:79], v2 offset:52224
 v_cvt_pk_bf16_f32 v41, v20, v21
M v[72:75], a[116:119], a[20:23], v[72:75]
 buffer_load_dwordx4 v4, s[8:11], s24 offen offset:0 sc1 lds
M v[72:75], a[120:123], a[24:27], v[72:75]
 ds_read_b128 a[80:83], v2 offset:53248
 v_add_f32 v26, v21, v26
M v[72:75], a[124:127], a[28:31], v[72:75]
 ds_read_b128 a[84:87], v2 offset:54272
M v[76:79], a[124:127], a[60:63], v[36:39]
 v_exp_f32 v22, v68
M v[76:79], a[120:123], a[56:59], v[76:79]
 ds_read_b128 a[88:91], v2 offset:55296
M v[76:79], a[116:119], a[52:55], v[76:79]
 ds_read_b128 a[92:95], v2 offset:56320
M v[76:79], a[112:115], a[48:51], v[76:79]
 buffer_load_dwordx4 v4, s[8:11], s24 offen offset:1024 sc1 lds
M v[76:79], a[108:111], a[44:47], v[76:79]
 v_exp_f32 v23, v69
M v[76:79], a[104:107], a[40:43], v[76:79]
 v_exp_f32 v24, v70
M v[76:79], a[100:103], a[36:39], v[76:79]
 buffer_load_dwordx4 v4, s[8:11], s24 offen offset:2048 sc1 lds
M v[76:79], a[96:99], a[32:35], v[76:79]
 s_waitcnt lgkmcnt(0)
 v_exp_f32 v25, v71
M v[80:83], a[64:67], a[0:3], v[32:35]
 ds_read_b128 a[96:99], v2 offset:57344
 v_add_f32 v27, v22, v23
M v[80:83], a[68:71], a[4:7], v[80:83]
 ds_read_b128 a[100:103], v2 offset:58368
 v_cvt_pk_bf16_f32 v44, v22, v23
M v[80:83], a[72:75], a[8:11], v[80:83]
 v_exp_f32 v18, v72
M v[80:83], a[76:79], a[12:15], v[80:83]
 ds_read_b128 a[104:107], v2 offset:59392
 v_add_f32 v27, v24, v27
M v[80:83], a[80:83], a[16:19], v[80:83]
 ds_read_b128 a[108:111], v2 offset:60416
 v_cvt_pk_bf16_f32 v45, v24, v25
M v[80:83], a[84:87], a[20:23], v[80:83]
 buffer_load_dwordx4 v4, s[8:11], s24 offen offset:3072 sc1 lds
M v[80:83], a[88:91], a[24:27], v[80:83]
 ds_read_b128 a[112:115], v2 offset:61440
 v_add_f32 v27, v25, v27
M v[80:83], a[92:95], a[28:31], v[80:83]
 ds_read_b128 a[116:119], v2 offset:62464
M v[84:87], a[92:95], a[60:63], v[36:39]
 v_exp_f32 v19, v73
M v[84:87], a[88:91], a[56:59], v[84:87]
 ds_read_b128 a[120:123], v2 offset:63488
 v_add_f32 v26, v18, v26
M v[84:87], a[84:87], a[52:55], v[84:87]
 ds_read_b128 a[124:127], v2 offset:64512
 v_cvt_pk_bf16_f32 v42, v18, v19
M v[84:87], a[80:83], a[48:51], v[84:87]
 v_exp_f32 v20, v74
M v[84:87], a[76:79], a[44:47], v[84:87]
 v_exp_f32 v21, v75
M v[84:87], a[72:75], a[40:43], v[84:87]
 v_exp_f32 v22, v76
M v[84:87], a[68:71], a[36:39], v[84:87]
 s_waitcnt vmcnt(8) lgkmcnt(0)
 v_exp_f32 v23, v77
M v[84:87], a[64:67], a[32:35], v[84:87]
 s_barrier
M v[88:91], a[96:99], a[0:3], v[32:35]
 ds_read_b128 a[64:67], v7 offset:32768
 v_add_f32 v26, v19, v26
M v[88:91], a[100:103], a[4:7], v[88:91]
 ds_read_b128 a[68:71], v7 offset:33792
 v_add_f32 v26, v20, v26
M v[88:91], a[104:107], a[8:11], v[88:91]
 buffer_store_dword v17, v1, s[8:11], s45 offen sc1
M v[88:91], a[108:111], a[12:15], v[88:91]
 ds_read_b128 a[72:75], v7 offset:34816
 v_cvt_pk_bf16_f32 v43, v20, v21
M v[88:91], a[112:115], a[16:19], v[88:91]
 ds_read_b128 a[76:79], v7 offset:35840
 v_add_f32 v26, v21, v26
M v[88:91], a[116:119], a[20:23], v[88:91]
 v_exp_f32 v24, v78
M v[88:91], a[120:123], a[24:27], v[88:91]
 ds_read_b128 a[80:83], v7 offset:36864
 v_add_f32 v27, v22, v27
M v[88:91], a[124:127], a[28:31], v[88:91]
 ds_read_b128 a[84:87], v7 offset:37888
 v_cvt_pk_bf16_f32 v46, v22, v23
M v[92:95], a[124:127], a[60:63], v[36:39]
 v_exp_f32 v25, v79
M v[92:95], a[120:123], a[56:59], v[92:95]
 ds_read_b128 a[88:91], v7 offset:38912
 v_add_f32 v27, v23, v27
M v[92:95], a[116:119], a[52:55], v[92:95]
 ds_read_b128 a[92:95], v7 offset:39936
 v_add_f32 v27, v24, v27
M v[92:95], a[112:115], a[48:51], v[92:95]
 v_cvt_pk_bf16_f32 v47, v24, v25
 v_add_f32 v27, v25, v27
M v[92:95], a[108:111], a[44:47], v[92:95]
M v[92:95], a[104:107], a[40:43], v[92:95]
M v[92:95], a[100:103], a[36:39], v[92:95]
 s_waitcnt lgkmcnt(0)
M v[92:95], a[96:99], a[32:35], v[92:95]
 s_cmp_eq_u32 s42, 0
 s_cbranch_scc1 L_j0
M v[96:99], a[64:67], a[0:3], v[32:35]
 s_add_u32 m0, s28, 98304
 ds_read_b128 a[96:99], v7 offset:40960
M v[96:99], a[68:71], a[4:7], v[96:99]
 ds_read_b128 a[100:103], v7 offset:41984
M v[96:99], a[72:75], a[8:11], v[96:99]
 buffer_load_dwordx4 v3, s[8:11], s21 offen offset:0 sc1 lds
M v[96:99], a[76:79], a[12:15], v[96:99]
 s_cmp_eq_u32 s20, 0
 ds_read_b128 a[104:107], v7 offset:43008
M v[96:99], a[80:83], a[16:19], v[96:99]
 s_cselect_b64 s[64:65], s[16:17], 0
 ds_read_b128 a[108:111], v7 offset:44032
M v[96:99], a[84:87], a[20:23], v[96:99]
 buffer_load_dwordx4 v3, s[8:11], s21 offen offset:1024 sc1 lds
M v[96:99], a[88:91], a[24:27], v[96:99]
 s_cselect_b64 s[66:67], s[18:19], 0
 ds_read_b128 a[112:115], v7 offset:45056
M v[96:99], a[92:95], a[28:31], v[96:99]
 s_cselect_b64 s[68:69], s[48:49], 0
 ds_read_b128 a[116:119], v7 offset:46080
M v[100:103], a[92:95], a[60:63], v[36:39]
 s_cselect_b64 s[70:71], s[50:51], 0
 v_exp_f32 v18, v80
M v[100:103], a[88:91], a[56:59], v[100:103]
 s_cmp_lt_u32 s20, 1
 ds_read_b128 a[120:123], v7 offset:47104
M v[100:103], a[84:87], a[52:55], v[100:103]
 s_cselect_b64 s[78:79], -1, 0
 ds_read_b128 a[124:127], v7 offset:48128
M v[100:103], a[80:83], a[48:51], v[100:103]
 buffer_load_dwordx4 v3, s[8:11], s21 offen offset:2048 sc1 lds
M v[100:103], a[76:79], a[44:47], v[100:103]
 s_cmp_eq_u32 s20, 1
 v_exp_f32 v19, v81
M v[100:103], a[72:75], a[40:43], v[100:103]
 s_cselect_b64 s[72:73], s[16:17], s[78:79]
 v_exp_f32 v20, v82
M v[100:103], a[68:71], a[36:39], v[100:103]
 s_cselect_b64 s[74:75], s[18:19], s[78:79]
 v_exp_f32 v21, v83
M v[100:103], a[64:67], a[32:35], v[100:103]
 s_waitcnt lgkmcnt(0)
 v_exp_f32 v22, v88
M v[108:111], a[96:99], a[32:35], v[36:39]
 s_cselect_b64 s[76:77], s[48:49], s[78:79]
 ds_read_b128 a[64:67], v7 offset:49152
 v_add_f32 v26, v18, v26
M v[108:111], a[100:103], a[36:39], v[108:111]
 s_cselect_b64 s[78:79], s[50:51], s[78:79]
 ds_read_b128 a[68:71], v7 offset:50176
 v_cvt_pk_bf16_f32 v56, v18, v19
M v[108:111], a[104:107], a[40:43], v[108:111]
 buffer_load_dwordx4 v3, s[8:11], s21 offen offset:3072 sc1 lds
M v[108:111], a[108:111], a[44:47], v[108:111]
 s_add_u32 m0, s28, 102400
 ds_read_b128 a[72:75], v7 offset:51200
 v_add_f32 v26, v19, v26
M v[108:111], a[112:115], a[48:51], v[108:111]
 s_cmp_lt_u32 s20, 2
 ds_read_b128 a[76:79], v7 offset:52224
 v_add_f32 v26, v20, v26
M v[108:111], a[116:119], a[52:55], v[108:111]
 buffer_load_dwordx4 v4, s[8:11], s21 offen offset:0 sc1 lds
M v[108:111], a[120:123], a[56:59], v[108:111]
 s_cselect_b64 s[86:87], -1, 0
 ds_read_b128 a[80:83], v7 offset:53248
 v_cvt_pk_bf16_f32 v57, v20, v21
M v[108:111], a[124:127], a[60:63], v[108:111]
 s_cmp_eq_u32 s20, 2
 ds_read_b128 a[84:87], v7 offset:54272
 v_add_f32 v26, v21, v26
M v[104:107], a[124:127], a[28:31], v[32:35]
 s_cselect_b64 s[80:81], s[16:17], s[86:87]
 v_exp_f32 v23, v89
M v[104:107], a[120:123], a[24:27], v[104:107]
 s_cselect_b64 s[82:83], s[18:19], s[86:87]
 ds_read_b128 a[88:91], v7 offset:55296
 v_add_f32 v26, v22, v26
M v[104:107], a[116:119], a[20:23], v[104:107]
 s_cselect_b64 s[84:85], s[48:49], s[86:87]
 ds_read_b128 a[92:95], v7 offset:56320
 v_cvt_pk_bf16_f32 v58, v22, v23
M v[104:107], a[112:115], a[16:19], v[104:107]
 buffer_load_dwordx4 v4, s[8:11], s21 offen offset:1024 sc1 lds
M v[104:107], a[108:111], a[12:15], v[104:107]
 s_cselect_b64 s[86:87], s[50:51], s[86:87]
 v_exp_f32 v24, v90
M v[104:107], a[104:107], a[8:11], v[104:107]
 s_cmp_eq_u32 s20, 3
 v_exp_f32 v25, v91
M v[104:107], a[100:103], a[4:7], v[104:107]
 buffer_load_dwordx4 v4, s[8:11], s21 offen offset:2048 sc1 lds
M v[104:107], a[96:99], a[0:3], v[104:107]
 s_waitcnt lgkmcnt(0)
 v_exp_f32 v18, v84
M v[112:115], a[64:67], a[0:3], v[32:35]
 s_cselect_b64 s[88:89], s[16:17], -1
 ds_read_b128 a[96:99], v7 offset:57344
 v_add_f32 v26, v23, v26
M v[112:115], a[68:71], a[4:7], v[112:115]
 s_cselect_b64 s[90:91], s[18:19], -1
 ds_read_b128 a[100:103], v7 offset:58368
 v_add_f32 v26, v24, v26
M v[112:115], a[72:75], a[8:11], v[112:115]
 s_cselect_b64 s[92:93], s[48:49], -1
 v_exp_f32 v19, v85
M v[112:115], a[76:79], a[12:15], v[112:115]
 s_cselect_b64 s[94:95], s[50:51], -1
 ds_read_b128 a[104:107], v7 offset:59392
 v_cvt_pk_bf16_f32 v59, v24, v25
M v[112:115], a[80:83], a[16:19], v[112:115]
 ds_read_b128 a[108:111], v7 offset:60416
 v_add_f32 v26, v25, v26
M v[112:115], a[84:87], a[20:23], v[112:115]
 buffer_load_dwordx4 v4, s[8:11], s21 offen offset:3072 sc1 lds
M v[112:115], a[88:91], a[24:27], v[112:115]
 s_add_u32 s24, s23, 33554432
 ds_read_b128 a[112:115], v7 offset:61440
 v_add_f32 v27, v18, v27
M v[112:115], a[92:95], a[28:31], v[112:115]
 s_mov_b32 s23, s21
 ds_read_b128 a[116:119], v7 offset:62464
 v_cvt_pk_bf16_f32 v60, v18, v19
M v[116:119], a[92:95], a[60:63], v[36:39]
 s_add_u32 s21, s21, 65536
 v_exp_f32 v20, v86
M v[116:119], a[88:91], a[56:59], v[116:119]
 s_add_u32 s22, s22, 1
 ds_read_b128 a[120:123], v7 offset:63488
 v_add_f32 v27, v19, v27
M v[116:119], a[84:87], a[52:55], v[116:119]
 s_cmp_eq_u32 s22, s25
 ds_read_b128 a[124:127], v7 offset:64512
M v[116:119], a[80:83], a[48:51], v[116:119]
 s_cselect_b32 s21, s26, s21
 v_exp_f32 v21, v87
M v[116:119], a[76:79], a[44:47], v[116:119]
 s_cmp_eq_u32 s22, s43
 v_exp_f32 v22, v92
M v[116:119], a[72:75], a[40:43], v[116:119]
 s_cselect_b32 s21, s4, s21
 v_exp_f32 v23, v93
M v[116:119], a[68:71], a[36:39], v[116:119]
 s_waitcnt vmcnt(9) lgkmcnt(0)
 v_add_f32 v27, v20, v27
 v_cvt_pk_bf16_f32 v61, v20, v21
M v[116:119], a[64:67], a[32:35], v[116:119]
 s_barrier
M v[124:127], a[96:99], a[32:35], v[36:39]
 s_cmp_eq_u32 s22, s6
 ds_read_b128 a[64:67], v2 offset:0
 v_add_f32 v27, v21, v27
M v[124:127], a[100:103], a[36:39], v[124:127]
 s_cselect_b32 s21, s7, s21
 ds_read_b128 a[68:71], v2 offset:1024
 v_add_f32 v27, v22, v27
M v[124:127], a[104:107], a[40:43], v[124:127]
 v_exp_f32 v24, v94
M v[124:127], a[108:111], a[44:47], v[124:127]
 ds_read_b128 a[72:75], v2 offset:2048
 v_cvt_pk_bf16_f32 v62, v22, v23
M v[124:127], a[112:115], a[48:51], v[124:127]
 ds_read_b128 a[76:79], v2 offset:3072
 v_add_f32 v27, v23, v27
M v[124:127], a[116:119], a[52:55], v[124:127]
 v_exp_f32 v25, v95
M v[124:127], a[120:123], a[56:59], v[124:127]
 ds_read_b128 a[80:83], v2 offset:4096
 v_add_f32 v27, v24, v27
M v[124:127], a[124:127], a[60:63], v[124:127]
 ds_read_b128 a[84:87], v2 offset:5120
 v_cvt_pk_bf16_f32 v63, v24, v25
M v[120:123], a[124:127], a[28:31], v[32:35]
 v_add_f32 v27, v25, v27
M v[120:123], a[120:123], a[24:27], v[120:123]
 ds_read_b128 a[88:91], v2 offset:6144
 v_max_f32 v10, v26, v27
M v[120:123], a[116:119], a[20:23], v[120:123]
 ds_read_b128 a[92:95], v2 offset:7168
 v_min_f32 v11, v26, v27
M v[120:123], a[112:115], a[16:19], v[120:123]
 v_cmp_lt_f32 s[36:37], s31, v10
M v[120:123], a[108:111], a[12:15], v[120:123]
 v_cmp_gt_f32 vcc, s55, v11
M v[120:123], a[104:107], a[8:11], v[120:123]
M v[120:123], a[100:103], a[4:7], v[120:123]
 s_waitcnt lgkmcnt(0)
 s_or_b64 vcc, vcc, s[36:37]
M v[120:123], a[96:99], a[0:3], v[120:123]
 s_cbranch_vccnz L_st10
L_rt10:
M v[128:131], a[64:67], v[40:43], 0
 s_add_u32 m0, s28, 0
 ds_read_b128 a[96:99], v2 offset:8192
 ds_read_b128 a[100:103], v2 offset:9216
M v[128:131], a[68:71], v[56:59], v[128:131]
 buffer_load_dwordx4 v3, s[8:11], s24 offen offset:0 sc1 lds
M v[132:135], a[68:71], v[60:63], 0
 v_exp_f32 v18, v96
M v[132:135], a[64:67], v[44:47], v[132:135]
 ds_read_b128 a[104:107], v2 offset:10240
 ds_read_b128 a[108:111], v2 offset:11264
M v[140:143], a[72:75], v[44:47], 0
 buffer_load_dwordx4 v3, s[8:11], s24 offen offset:1024 sc1 lds
M v[140:143], a[76:79], v[60:63], v[140:143]
 v_exp_f32 v19, v97
M v[136:139], a[76:79], v[56:59], 0
 ds_read_b128 a[112:115], v2 offset:12288
 ds_read_b128 a[116:119], v2 offset:13312
M v[136:139], a[72:75], v[40:43], v[136:139]
 buffer_load_dwordx4 v3, s[8:11], s24 offen offset:2048 sc1 lds
M v[144:147], a[80:83], v[40:43], 0
 v_exp_f32 v20, v98
M v[144:147], a[84:87], v[56:59], v[144:147]
 ds_read_b128 a[120:123], v2 offset:14336
 ds_read_b128 a[124:127], v2 offset:15360
M v[148:151], a[84:87], v[60:63], 0
 buffer_load_dwordx4 v3, s[8:11], s24 offen offset:3072 sc1 lds
M v[148:151], a[80:83], v[44:47], v[148:151]
 s_add_u32 m0, s28, 4096
 v_exp_f32 v21, v99
M v[156:159], a[88:91], v[44:47], 0
 buffer_load_dwordx4 v4, s[8:11], s24 offen offset:0 sc1 lds
M v[156:159], a[92:95], v[60:63], v[156:159]
 v_add_f32 v30, v26, v30
 v_add_f32 v31, v27, v31
M v[152:155], a[92:95], v[56:59], 0
 v_exp_f32 v22, v104
M v[152:155], a[88:91], v[40:43], v[152:155]
 s_waitcnt lgkmcnt(0)
 v_add_f32 v28, v18, v19
 v_cvt_pk_bf16_f32 v48, v18, v19
M v[160:163], a[96:99], v[40:43], 0
 ds_read_b128 a[64:67], v2 offset:16384
 ds_read_b128 a[68:71], v2 offset:17408
M v[160:163], a[100:103], v[56:59], v[160:163]
 buffer_load_dwordx4 v4, s[8:11], s24 offen offset:1024 sc1 lds
M v[164:167], a[100:103], v[60:63], 0
 v_exp_f32 v23, v105
M v[164:167], a[96:99], v[44:47], v[164:167]
 ds_read_b128 a[72:75], v2 offset:18432
 ds_read_b128 a[76:79], v2 offset:19456
M v[172:175], a[104:107], v[44:47], 0
 buffer_load_dwordx4 v4, s[8:11], s24 offen offset:2048 sc1 lds
M v[172:175], a[108:111], v[60:63], v[172:175]
 v_add_f32 v28, v20, v28
 v_cvt_pk_bf16_f32 v49, v20, v21
M v[168:171], a[108:111], v[56:59], 0
 ds_read_b128 a[80:83], v2 offset:20480
 ds_read_b128 a[84:87], v2 offset:21504
M v[168:171], a[104:107], v[40:43], v[168:171]
 buffer_load_dwordx4 v4, s[8:11], s24 offen offset:3072 sc1 lds
M v[176:179], a[112:115], v[40:43], 0
 v_exp_f32 v24, v106
M v[176:179], a[116:119], v[56:59], v[176:179]
 s_add_u32 m0, s28, 32768
 ds_read_b128 a[88:91], v2 offset:22528
 ds_read_b128 a[92:95], v2 offset:23552
M v[180:183], a[116:119], v[60:63], 0
 buffer_load_dwordx4 v3, s[8:11], s21 offen offset:0 sc1 lds
M v[180:183], a[112:115], v[44:47], v[180:183]
 v_exp_f32 v25, v107
M v[188:191], a[120:123], v[44:47], 0
 buffer_load_dwordx4 v3, s[8:11], s21 offen offset:1024 sc1 lds
M v[188:191], a[124:127], v[60:63], v[188:191]
 v_exp_f32 v18, v100
M v[184:187], a[124:127], v[56:59], 0
 buffer_load_dwordx4 v3, s[8:11], s21 offen offset:2048 sc1 lds
M v[184:187], a[120:123], v[40:43], v[184:187]
 s_waitcnt lgkmcnt(0)
 v_add_f32 v28, v21, v28
 v_add_f32 v28, v22, v28
M v[192:195], a[64:67], v[40:43], 0
 ds_read_b128 a[96:99], v2 offset:24576
 ds_read_b128 a[100:103], v2 offset:25600
M v[192:195], a[68:71], v[56:59], v[192:195]
 buffer_load_dwordx4 v3, s[8:11], s21 offen offset:3072 sc1 lds
M v[196:199], a[68:71], v[60:63], 0
 v_exp_f32 v19, v101
M v[196:199], a[64:67], v[44:47], v[196:199]
 s_add_u32 m0, s28, 36864
 ds_read_b128 a[104:107], v2 offset:26624
 ds_read_b128 a[108:111], v2 offset:27648
M v[204:207], a[72:75], v[44:47], 0
 buffer_load_dwordx4 v4, s[8:11], s21 offen offset:0 sc1 lds
M v[204:207], a[76:79], v[60:63], v[204:207]
 v_exp_f32 v20, v102
M v[200:203], a[76:79], v[56:59], 0
 ds_read_b128 a[112:115], v2 offset:28672
 ds_read_b128 a[116:119], v2 offset:29696
M v[200:203], a[72:75], v[40:43], v[200:203]
 buffer_load_dwordx4 v4, s[8:11], s21 offen offset:1024 sc1 lds
M v[208:211], a[80:83], v[40:43], 0
 v_exp_f32 v21, v103
M v[208:211], a[84:87], v[56:59], v[208:211]
 ds_read_b128 a[120:123], v2 offset:30720
 ds_read_b128 a[124:127], v2 offset:31744
M v[212:215], a[84:87], v[60:63], 0
 buffer_load_dwordx4 v4, s[8:11], s21 offen offset:2048 sc1 lds
M v[212:215], a[80:83], v[44:47], v[212:215]
 v_cvt_pk_bf16_f32 v50, v22, v23
 v_add_f32 v28, v23, v28
M v[220:223], a[88:91], v[44:47], 0
 v_exp_f32 v22, v108
M v[220:223], a[92:95], v[60:63], v[220:223]
 buffer_load_dwordx4 v4, s[8:11], s21 offen offset:3072 sc1 lds
M v[216:219], a[92:95], v[56:59], 0
 s_waitcnt vmcnt(16) lgkmcnt(0)
 s_add_u32 s24, s23, 33554432
 s_mov_b32 s23, s21
M v[216:219], a[88:91], v[40:43], v[216:219]
 s_barrier
M v[224:227], a[96:99], v[40:43], 0
 ds_read_b128 a[64:67], v2 offset:32768
 ds_read_b128 a[68:71], v2 offset:33792
M v[224:227], a[100:103], v[56:59], v[224:227]
 s_add_u32 s21, s21, 65536
 v_add_f32 v28, v24, v28
M v[228:231], a[100:103], v[60:63], 0
 s_add_u32 s22, s22, 1
 v_exp_f32 v23, v109
M v[228:231], a[96:99], v[44:47], v[228:231]
 s_cmp_eq_u32 s22, s25
 ds_read_b128 a[72:75], v2 offset:34816
 ds_read_b128 a[76:79], v2 offset:35840
M v[236:239], a[104:107], v[44:47], 0
 s_cselect_b32 s21, s26, s21
 v_cvt_pk_bf16_f32 v51, v24, v25
 v_add_f32 v28, v25, v28
M v[236:239], a[108:111], v[60:63], v[236:239]
 s_cmp_eq_u32 s22, s43
 v_exp_f32 v24, v110
M v[232:235], a[108:111], v[56:59], 0
 s_cselect_b32 s21, s4, s21
 ds_read_b128 a[80:83], v2 offset:36864
 ds_read_b128 a[84:87], v2 offset:37888
M v[232:235], a[104:107], v[40:43], v[232:235]
 s_cmp_eq_u32 s22, s6
 v_exp_f32 v25, v111
M v[240:243], a[112:115], v[40:43], 0
 s_cselect_b32 s21, s7, s21
 v_add_f32 v29, v18, v19
 v_cvt_pk_bf16_f32 v52, v18, v19
M v[240:243], a[116:119], v[56:59], v[240:243]
 ds_read_b128 a[88:91], v2 offset:38912
 ds_read_b128 a[92:95], v2 offset:39936
M v[244:247], a[116:119], v[60:63], 0
 v_add_f32 v29, v20, v29
 v_cvt_pk_bf16_f32 v53, v20, v21
M v[244:247], a[112:115], v[44:47], v[244:247]
 v_add_f32 v29, v21, v29
 v_add_f32 v29, v22, v29
M v[252:255], a[120:123], v[44:47], 0
 v_cvt_pk_bf16_f32 v54, v22, v23
 v_add_f32 v29, v23, v29
M v[252:255], a[124:127], v[60:63], v[252:255]
 s_cmp_lg_u32 s27, 0
 v_add_f32 v29, v24, v29
 v_cvt_pk_bf16_f32 v55, v24, v25
M v[248:251], a[124:127], v[56:59], 0
 s_waitcnt lgkmcnt(0)
 v_add_f32 v29, v25, v29
M v[248:251], a[120:123], v[40:43], v[248:251]
 s_cbranch_scc1 L_loop_top
 s_branch L_p1
L_j0:
 s_cmp_eq_u32 s20, 0
 s_cselect_b64 s[64:65], s[16:17], 0
 s_cselect_b64 s[66:67], s[18:19], 0
 s_cselect_b64 s[68:69], s[48:49], 0
 s_cselect_b64 s[70:71], s[50:51], 0
 s_cmp_lt_u32 s20, 1
 s_cselect_b64 s[78:79], -1, 0
 s_cmp_eq_u32 s20, 1
 s_cselect_b64 s[72:73], s[16:17], s[78:79]
 s_cselect_b64 s[74:75], s[18:19], s[78:79]
 s_cselect_b64 s[76:77], s[48:49], s[78:79]
 s_cselect_b64 s[78:79], s[50:51], s[78:79]
 s_cmp_lt_u32 s20, 2
 s_cselect_b64 s[86:87], -1, 0
 s_cmp_eq_u32 s20, 2
 s_cselect_b64 s[80:81], s[16:17], s[86:87]
 s_cselect_b64 s[82:83], s[18:19], s[86:87]
 s_cselect_b64 s[84:85], s[48:49], s[86:87]
 s_cselect_b64 s[86:87], s[50:51], s[86:87]
 s_cmp_eq_u32 s20, 3
 s_cselect_b64 s[88:89], s[16:17], -1
 s_cselect_b64 s[90:91], s[18:19], -1
 s_cselect_b64 s[92:93], s[48:49], -1
 s_cselect_b64 s[94:95], s[50:51], -1
 v_mov_b32 v56, 0
 v_mov_b32 v57, 0
 v_mov_b32 v58, 0
 v_mov_b32 v59, 0
 v_accvgpr_write_b32 a242, 0
 v_accvgpr_write_b32 a243, 0
 v_cndmask_b32 v64, v64, v8, s[64:65]
 v_cndmask_b32 v65, v65, v8, s[66:67]
 v_cndmask_b32 v66, v66, v8, s[68:69]
 v_cndmask_b32 v67, v67, v8, s[70:71]
 v_cndmask_b32 v72, v72, v8, s[72:73]
 v_cndmask_b32 v73, v73, v8, s[74:75]
 v_cndmask_b32 v74, v74, v8, s[76:77]
 v_cndmask_b32 v75, v75, v8, s[78:79]
 v_cndmask_b32 v80, v80, v8, s[80:81]
 v_cndmask_b32 v81, v81, v8, s[82:83]
 v_cndmask_b32 v82, v82, v8, s[84:85]
 v_cndmask_b32 v83, v83, v8, s[86:87]
 v_cndmask_b32 v88, v88, v8, s[88:89]
 v_cndmask_b32 v89, v89, v8, s[90:91]
 v_cndmask_b32 v90, v90, v8, s[92:93]
 v_cndmask_b32 v91, v91, v8, s[94:95]
 s_cmp_eq_u32 s20, 3
 s_cselect_b64 s[64:65], s[16:17], 0
 s_cselect_b64 s[66:67], s[18:19], 0
 s_cselect_b64 s[68:69], s[48:49], 0
 s_cselect_b64 s[70:71], s[50:51], 0
 s_cmp_gt_u32 s20, 2
 s_cselect_b64 s[78:79], -1, 0
 s_cmp_eq_u32 s20, 2
 s_cselect_b64 s[72:73], s[16:17], s[78:79]
 s_cselect_b64 s[74:75], s[18:19], s[78:79]
 s_cselect_b64 s[76:77], s[48:49], s[78:79]
 s_cselect_b64 s[78:79], s[50:51], s[78:79]
 s_cmp_gt_u32 s20, 1
 s_cselect_b64 s[86:87], -1, 0
 s_cmp_eq_u32 s20, 1
 s_cselect_b64 s[80:81], s[16:17], s[86:87]
 s_cselect_b64 s[82:83], s[18:19], s[86:87]
 s_cselect_b64 s[84:85], s[48:49], s[86:87]
 s_cselect_b64 s[86:87], s[50:51], s[86:87]
 s_cmp_eq_u32 s20, 0
 s_cselect_b64 s[88:89], s[16:17], -1
 s_cselect_b64 s[90:91], s[18:19], -1
 s_cselect_b64 s[92:93], s[48:49], -1
 s_cselect_b64 s[94:95], s[50:51], -1
 s_add_u32 m0, s28, 98304
 v_max3_f32 v10, v64, v65, v66
 buffer_load_dwordx4 v3, s[8:11], s21 offen offset:0 sc1 lds
 v_max3_f32 v10, v67, v72, v10
 v_max3_f32 v10, v73, v74, v10
 v_max3_f32 v10, v75, v80, v10
 v_max3_f32 v10, v81, v82, v10
 v_max3_f32 v10, v83, v88, v10
 v_max3_f32 v10, v89, v90, v10
 v_max_f32 v10, v91, v10
 v_max3_f32 v11, v68, v69, v70
 v_max3_f32 v11, v71, v76, v11
 v_max3_f32 v11, v77, v78, v11
 v_max3_f32 v11, v79, v84, v11
 v_mfma_f32_32x32x16_bf16 v[128:143], v[56:59], v[56:59], 0
 buffer_load_dwordx4 v3, s[8:11], s21 offen offset:1024 sc1 lds
 v_max3_f32 v11, v85, v86, v11
 v_max3_f32 v11, v87, v92, v11
 v_max3_f32 v11, v93, v94, v11
 v_max_f32 v11, v95, v11
 v_mov_b32 v12, v10
 v_mov_b32 v13, v11
 s_nop 0
 v_permlane16_swap_b32 v12, v10
 v_permlane16_swap_b32 v13, v11
 v_max_f32 v10, v12, v10
 v_max_f32 v11, v13, v11
 v_mov_b32 v12, v10
 buffer_load_dwordx4 v3, s[8:11], s21 offen offset:2048 sc1 lds
 v_mov_b32 v13, v11
 v_mfma_f32_32x32x16_bf16 v[144:159], v[56:59], v[56:59], 0
 v_permlane32_swap_b32 v12, v10
 v_permlane32_swap_b32 v13, v11
 v_max_f32 v10, v12, v10
 v_max_f32 v11, v13, v11
 v_ceil_f32 v10, v10
 v_ceil_f32 v11, v11
 v_sub_f32 v32, v32, v10
 v_sub_f32 v33, v33, v10
 v_sub_f32 v34, v34, v10
 v_sub_f32 v35, v35, v10
 buffer_load_dwordx4 v3, s[8:11], s21 offen offset:3072 sc1 lds
 v_sub_f32 v36, v36, v11
 v_sub_f32 v37, v37, v11
 v_sub_f32 v38, v38, v11
 v_mfma_f32_32x32x16_bf16 v[160:175], v[56:59], v[56:59], 0
 v_sub_f32 v39, v39, v11
 v_sub_f32 v64, v64, v10
 v_sub_f32 v65, v65, v10
 v_sub_f32 v66, v66, v10
 v_sub_f32 v67, v67, v10
 v_sub_f32 v68, v68, v11
 v_sub_f32 v69, v69, v11
 s_add_u32 m0, s28, 102400
 v_sub_f32 v70, v70, v11
 buffer_load_dwordx4 v4, s[8:11], s21 offen offset:0 sc1 lds
 v_sub_f32 v71, v71, v11
 v_sub_f32 v72, v72, v10
 v_sub_f32 v73, v73, v10
 v_sub_f32 v74, v74, v10
 v_mfma_f32_32x32x16_bf16 v[176:191], v[56:59], v[56:59], 0
 v_sub_f32 v75, v75, v10
 v_sub_f32 v76, v76, v11
 v_sub_f32 v77, v77, v11
 v_sub_f32 v78, v78, v11
 v_sub_f32 v79, v79, v11
 v_sub_f32 v80, v80, v10
 v_sub_f32 v81, v81, v10
 buffer_load_dwordx4 v4, s[8:11], s21 offen offset:1024 sc1 lds
 v_sub_f32 v82, v82, v10
 v_sub_f32 v83, v83, v10
 v_sub_f32 v84, v84, v11
 v_sub_f32 v85, v85, v11
 v_sub_f32 v86, v86, v11
 v_sub_f32 v87, v87, v11
 v_mfma_f32_32x32x16_bf16 v[192:207], v[56:59], v[56:59], 0
 v_sub_f32 v88, v88, v10
 v_sub_f32 v89, v89, v10
 v_sub_f32 v90, v90, v10
 v_sub_f32 v91, v91, v10
 v_sub_f32 v92, v92, v11
 buffer_load_dwordx4 v4, s[8:11], s21 offen offset:2048 sc1 lds
 v_sub_f32 v93, v93, v11
 v_sub_f32 v94, v94, v11
 v_sub_f32 v95, v95, v11
 v_exp_f32 v18, v64
 v_exp_f32 v19, v65
 v_exp_f32 v20, v66
 v_add_f32 v26, v18, v19
 v_cvt_pk_bf16_f32 v40, v18, v19
 v_mfma_f32_32x32x16_bf16 v[208:223], v[56:59], v[56:59], 0
 v_exp_f32 v21, v67
 v_exp_f32 v22, v72
 v_add_f32 v26, v20, v26
 buffer_load_dwordx4 v4, s[8:11], s21 offen offset:3072 sc1 lds
 v_cvt_pk_bf16_f32 v41, v20, v21
 v_exp_f32 v23, v73
 v_add_f32 v26, v21, v26
 v_exp_f32 v24, v74
 v_add_f32 v26, v22, v26
 v_cvt_pk_bf16_f32 v42, v22, v23
 v_exp_f32 v25, v75
 v_add_f32 v26, v23, v26
 v_exp_f32 v18, v68
 v_add_f32 v26, v24, v26
 v_mfma_f32_32x32x16_bf16 v[224:239], v[56:59], v[56:59], 0
 s_add_u32 s24, s23, 33554432
 s_mov_b32 s23, s21
 s_add_u32 s21, s21, 65536
 s_add_u32 s22, s22, 1
 s_cmp_eq_u32 s22, s25
 s_cselect_b32 s21, s26, s21
 s_cmp_eq_u32 s22, s43
 s_cselect_b32 s21, s4, s21
 s_cmp_eq_u32 s22, s6
 s_cselect_b32 s21, s7, s21
 v_cvt_pk_bf16_f32 v43, v24, v25
 buffer_load_dword v5, off, s[8:11], s47 sc1
 v_exp_f32 v19, v69
 v_add_f32 v26, v25, v26
 v_mfma_f32_32x32x16_bf16 v[240:255], v[56:59], v[56:59], 0
 v_exp_f32 v20, v70
 v_add_f32 v27, v18, v19
 v_cvt_pk_bf16_f32 v44, v18, v19
 v_exp_f32 v21, v71
 v_exp_f32 v22, v76
 v_add_f32 v27, v20, v27
 v_cvt_pk_bf16_f32 v45, v20, v21
 v_exp_f32 v23, v77
 v_add_f32 v27, v21, v27
 v_exp_f32 v24, v78
 v_add_f32 v27, v22, v27
 v_cvt_pk_bf16_f32 v46, v22, v23
 v_exp_f32 v25, v79
 v_add_f32 v27, v23, v27
 v_add_f32 v27, v24, v27
 v_cvt_pk_bf16_f32 v47, v24, v25
 v_add_f32 v27, v25, v27
 v_cndmask_b32 v100, v36, v8, s[64:65]
 v_cndmask_b32 v101, v36, v8, s[66:67]
 v_cndmask_b32 v102, v36, v8, s[68:69]
 v_cndmask_b32 v103, v36, v8, s[70:71]
 v_cndmask_b32 v108, v36, v8, s[72:73]
 v_cndmask_b32 v109, v36, v8, s[74:75]
 v_cndmask_b32 v110, v36, v8, s[76:77]
 v_cndmask_b32 v111, v36, v8, s[78:79]
 v_cndmask_b32 v116, v36, v8, s[80:81]
 v_cndmask_b32 v117, v36, v8, s[82:83]
 v_cndmask_b32 v118, v36, v8, s[84:85]
 v_cndmask_b32 v119, v36, v8, s[86:87]
 v_cndmask_b32 v124, v36, v8, s[88:89]
 v_cndmask_b32 v125, v36, v8, s[90:91]
 v_cndmask_b32 v126, v36, v8, s[92:93]
 v_cndmask_b32 v127, v36, v8, s[94:95]
 s_branch L_p2
L_kv1:
 s_mov_b32 s60, s90
 s_and_b32 s61, s91, 0xffff
 s_mov_b32 s62, 3670016
 s_mov_b32 s63, 0x20000
 s_cmp_lg_u32 s42, 8
 s_cbranch_scc1 L_nut
 s_lshl_b32 s67, s20, 2
 s_add_u32 s67, s67, 163808
 v_mov_b32 v17, s67
 s_waitcnt lgkmcnt(0)
 s_memtime s[72:73]
 s_waitcnt lgkmcnt(0)
 s_load_dword s43, s[46:47], 0x40000
 s_load_dword s40, s[46:47], 0x60000
 s_load_dword s26, s[46:47], 0x80000
 s_waitcnt lgkmcnt(2)
 s_memtime s[64:65]
 s_waitcnt lgkmcnt(0)
 s_sub_u32 s64, s64, s72
 s_min_u32 s64, s64, 2500
 v_mov_b32 v16, s64
 ds_write_b32 v17, v16
 s_waitcnt lgkmcnt(0)
L_nut:
 s_waitcnt vmcnt(4)
 s_barrier
 ds_read_b128 a[160:163], v5 offset:0
 ds_read_b128 a[164:167], v6 offset:0
 ds_read_b64_tr_b16 a[32:33], v1 offset:0
 ds_read_b64_tr_b16 a[34:35], v1 offset:1024
 ds_read_b64_tr_b16 a[36:37], v1 offset:8192
 ds_read_b64_tr_b16 a[38:39], v1 offset:9216
 ds_read_b64_tr_b16 a[40:41], v2 offset:0
 ds_read_b64_tr_b16 a[42:43], v2 offset:1024
 ds_read_b64_tr_b16 a[44:45], v2 offset:8192
 ds_read_b64_tr_b16 a[46:47], v2 offset:9216
 ds_read_b128 a[168:171], v5 offset:2048
 ds_read_b128 a[172:175], v6 offset:2048
 ds_read_b64_tr_b16 a[48:49], v3 offset:0
 ds_read_b64_tr_b16 a[50:51], v3 offset:1024
 ds_read_b64_tr_b16 a[52:53], v3 offset:8192
 ds_read_b64_tr_b16 a[54:55], v3 offset:9216
 ds_read_b64_tr_b16 a[56:57], v4 offset:0
 ds_read_b64_tr_b16 a[58:59], v4 offset:1024
 ds_read_b64_tr_b16 a[60:61], v4 offset:8192
 ds_read_b64_tr_b16 a[62:63], v4 offset:9216
 ds_read_b128 a[176:179], v5 offset:4096
 ds_read_b128 a[180:183], v6 offset:4096
 ds_read_b128 a[184:187], v5 offset:6144
 ds_read_b128 a[188:191], v6 offset:6144
 s_add_u32 m0, s24, 16384
 s_nop 0
 buffer_load_dwordx4 v12, s[48:51], s22 offen offset:0   lds
 buffer_load_dwordx4 v13, s[48:51], s22 offen offset:1024   lds
 buffer_load_dwordx4 v14, s[48:51], s22 offen offset:2048   lds
 buffer_load_dwordx4 v15, s[48:51], s22 offen offset:3072   lds
 s_sub_u32 s22, s22, 2097024
 s_add_u32 m0, s23, 32768
 s_nop 0
 buffer_load_dwordx4 v8, s[16:19], s21 offen offset:0  nt lds
 buffer_load_dwordx4 v9, s[16:19], s21 offen offset:1024  nt lds
 buffer_load_dwordx4 v10, s[16:19], s21 offen offset:2048  nt lds
 buffer_load_dwordx4 v11, s[16:19], s21 offen offset:3072  nt lds
 s_add_u32 s21, s21, 128
 s_waitcnt lgkmcnt(15)
M a[0:3], a[32:35], a[160:163], 0
M a[0:3], a[36:39], a[164:167], a[0:3]
 s_waitcnt lgkmcnt(14)
M a[4:7], a[44:47], a[164:167], 0
M a[4:7], a[40:43], a[160:163], a[4:7]
 s_waitcnt lgkmcnt(8)
M a[8:11], a[48:51], a[160:163], 0
M a[8:11], a[52:55], a[164:167], a[8:11]
 s_waitcnt lgkmcnt(4)
M a[12:15], a[60:63], a[164:167], 0
 s_add_u32 m0, s23, 49152
M a[12:15], a[56:59], a[160:163], a[12:15]
 buffer_load_dwordx4 v8, s[16:19], s21 offen offset:0  nt lds
M v[32:35], a[32:35], a[168:171], 0
 buffer_load_dwordx4 v9, s[16:19], s21 offen offset:1024  nt lds
M v[32:35], a[36:39], a[172:175], v[32:35]
M v[36:39], a[44:47], a[172:175], 0
 buffer_load_dwordx4 v10, s[16:19], s21 offen offset:2048  nt lds
M v[36:39], a[40:43], a[168:171], v[36:39]
M v[40:43], a[48:51], a[168:171], 0
 buffer_load_dwordx4 v11, s[16:19], s21 offen offset:3072  nt lds
M v[40:43], a[52:55], a[172:175], v[40:43]
 s_add_u32 s21, s21, 524160
M v[44:47], a[60:63], a[172:175], 0
 s_waitcnt vmcnt(12) lgkmcnt(0)
M v[44:47], a[56:59], a[168:171], v[44:47]
 s_barrier
M v[64:67], a[32:35], a[176:179], 0
 s_add_u32 m0, s24, 32768
 ds_read_b64_tr_b16 a[64:65], v1 offset:16384
 ds_read_b64_tr_b16 a[66:67], v1 offset:17408
M v[64:67], a[36:39], a[180:183], v[64:67]
 ds_read_b64_tr_b16 a[68:69], v1 offset:24576
 ds_read_b64_tr_b16 a[70:71], v1 offset:25600
M v[68:71], a[44:47], a[180:183], 0
 buffer_load_dwordx4 v12, s[48:51], s22 offen offset:0   lds
M v[68:71], a[40:43], a[176:179], v[68:71]
 ds_read_b64_tr_b16 a[72:73], v2 offset:16384
 ds_read_b64_tr_b16 a[74:75], v2 offset:17408
M v[72:75], a[48:51], a[176:179], 0
 ds_read_b64_tr_b16 a[76:77], v2 offset:24576
 ds_read_b64_tr_b16 a[78:79], v2 offset:25600
M v[72:75], a[52:55], a[180:183], v[72:75]
 buffer_load_dwordx4 v13, s[48:51], s22 offen offset:1024   lds
M v[76:79], a[60:63], a[180:183], 0
 ds_read_b64_tr_b16 a[80:81], v3 offset:16384
 ds_read_b64_tr_b16 a[82:83], v3 offset:17408
M v[76:79], a[56:59], a[176:179], v[76:79]
 ds_read_b64_tr_b16 a[84:85], v3 offset:24576
 ds_read_b64_tr_b16 a[86:87], v3 offset:25600
M v[96:99], a[32:35], a[184:187], 0
 buffer_load_dwordx4 v14, s[48:51], s22 offen offset:2048   lds
M v[96:99], a[36:39], a[188:191], v[96:99]
 ds_read_b64_tr_b16 a[88:89], v4 offset:16384
 ds_read_b64_tr_b16 a[90:91], v4 offset:17408
M v[100:103], a[44:47], a[188:191], 0
 ds_read_b64_tr_b16 a[92:93], v4 offset:24576
 ds_read_b64_tr_b16 a[94:95], v4 offset:25600
M v[100:103], a[40:43], a[184:187], v[100:103]
 buffer_load_dwordx4 v15, s[48:51], s22 offen offset:3072   lds
M v[104:107], a[48:51], a[184:187], 0
 s_add_u32 s22, s22, 2097152
 v_max3_f32 v20, |v32|, |v33|, |v34|
 v_max3_f32 v20, |v35|, |v36|, v20
M v[104:107], a[52:55], a[188:191], v[104:107]
 v_max3_f32 v20, |v37|, |v38|, v20
 v_max3_f32 v21, |v64|, |v65|, |v66|
M v[108:111], a[60:63], a[188:191], 0
 s_add_u32 m0, s23, 0
 v_max3_f32 v21, |v67|, |v68|, v21
 v_max3_f32 v21, |v69|, |v70|, v21
M v[108:111], a[56:59], a[184:187], v[108:111]
 s_waitcnt lgkmcnt(0)
 v_min_f32 v20, v20, v21
 v_mul_f32 v20, 0x41000000, v20
M a[16:19], a[64:67], a[160:163], 0
 buffer_load_dwordx4 v8, s[16:19], s21 offen offset:0  nt lds
M a[16:19], a[68:71], a[164:167], a[16:19]
 v_mov_b32 v21, v20
 v_mov_b32 v22, v20
M a[20:23], a[76:79], a[164:167], 0
 buffer_load_dwordx4 v9, s[16:19], s21 offen offset:1024  nt lds
M a[20:23], a[72:75], a[160:163], a[20:23]
 v_mov_b32 v23, v20
 v_accvgpr_write_b32 a241, v20
M a[24:27], a[80:83], a[160:163], 0
M a[24:27], a[84:87], a[164:167], a[24:27]
M a[28:31], a[92:95], a[164:167], 0
 buffer_load_dwordx4 v10, s[16:19], s21 offen offset:2048  nt lds
M a[28:31], a[88:91], a[160:163], a[28:31]
M v[48:51], a[64:67], a[168:171], v[20:23]
M v[48:51], a[68:71], a[172:175], v[48:51]
 buffer_load_dwordx4 v11, s[16:19], s21 offen offset:3072  nt lds
M v[52:55], a[76:79], a[172:175], v[20:23]
 s_add_u32 s21, s21, 128
M v[52:55], a[72:75], a[168:171], v[52:55]
M v[56:59], a[80:83], a[168:171], v[20:23]
M v[56:59], a[84:87], a[172:175], v[56:59]
M v[60:63], a[92:95], a[172:175], v[20:23]
 s_waitcnt vmcnt(12)
M v[60:63], a[88:91], a[168:171], v[60:63]
 s_barrier
M v[80:83], a[64:67], a[176:179], v[20:23]
 s_add_u32 m0, s24, 49152
 ds_read_b128 a[160:163], v5 offset:16384
 ds_read_b128 a[164:167], v6 offset:16384
M v[80:83], a[68:71], a[180:183], v[80:83]
 buffer_load_dwordx4 v12, s[48:51], s22 offen offset:0   lds
M v[84:87], a[76:79], a[180:183], v[20:23]
 ds_read_b64_tr_b16 a[96:97], v1 offset:32768
 ds_read_b64_tr_b16 a[98:99], v1 offset:33792
M v[84:87], a[72:75], a[176:179], v[84:87]
M v[88:91], a[80:83], a[176:179], v[20:23]
 buffer_load_dwordx4 v13, s[48:51], s22 offen offset:1024   lds
M v[88:91], a[84:87], a[180:183], v[88:91]
 ds_read_b64_tr_b16 a[100:101], v1 offset:40960
 ds_read_b64_tr_b16 a[102:103], v1 offset:41984
M v[92:95], a[92:95], a[180:183], v[20:23]
M v[92:95], a[88:91], a[176:179], v[92:95]
M v[112:115], a[64:67], a[184:187], v[20:23]
 ds_read_b64_tr_b16 a[104:105], v2 offset:32768
 ds_read_b64_tr_b16 a[106:107], v2 offset:33792
M v[112:115], a[68:71], a[188:191], v[112:115]
 buffer_load_dwordx4 v14, s[48:51], s22 offen offset:2048   lds
M v[116:119], a[76:79], a[188:191], v[20:23]
M v[116:119], a[72:75], a[184:187], v[116:119]
 ds_read_b64_tr_b16 a[108:109], v2 offset:40960
 ds_read_b64_tr_b16 a[110:111], v2 offset:41984
M v[120:123], a[80:83], a[184:187], v[20:23]
 buffer_load_dwordx4 v15, s[48:51], s22 offen offset:3072   lds
M v[120:123], a[84:87], a[188:191], v[120:123]
 s_waitcnt lgkmcnt(8)
M v[124:127], a[92:95], a[188:191], v[20:23]
 s_sub_u32 s22, s22, 2097024
M v[124:127], a[88:91], a[184:187], v[124:127]
 s_add_u32 m0, s23, 16384
 ds_read_b64_tr_b16 a[112:113], v3 offset:32768
 ds_read_b64_tr_b16 a[114:115], v3 offset:33792
M v[128:131], a[32:35], a[160:163], v[20:23]
 ds_read_b128 a[168:171], v5 offset:18432
 ds_read_b128 a[172:175], v6 offset:18432
M v[128:131], a[36:39], a[164:167], v[128:131]
 buffer_load_dwordx4 v8, s[16:19], s21 offen offset:0  nt lds
M v[132:135], a[44:47], a[164:167], v[20:23]
 ds_read_b64_tr_b16 a[116:117], v3 offset:40960
 ds_read_b64_tr_b16 a[118:119], v3 offset:41984
M v[132:135], a[40:43], a[160:163], v[132:135]
 buffer_load_dwordx4 v9, s[16:19], s21 offen offset:1024  nt lds
M v[136:139], a[48:51], a[160:163], v[20:23]
M v[136:139], a[52:55], a[164:167], v[136:139]
 ds_read_b64_tr_b16 a[120:121], v4 offset:32768
 ds_read_b64_tr_b16 a[122:123], v4 offset:33792
M v[140:143], a[60:63], a[164:167], v[20:23]
 buffer_load_dwordx4 v10, s[16:19], s21 offen offset:2048  nt lds
M v[140:143], a[56:59], a[160:163], v[140:143]
M v[144:147], a[64:67], a[160:163], v[20:23]
 ds_read_b64_tr_b16 a[124:125], v4 offset:40960
 ds_read_b64_tr_b16 a[126:127], v4 offset:41984
M v[144:147], a[68:71], a[164:167], v[144:147]
 buffer_load_dwordx4 v11, s[16:19], s21 offen offset:3072  nt lds
M v[148:151], a[76:79], a[164:167], v[20:23]
 s_add_u32 s21, s21, 524160
M v[148:151], a[72:75], a[160:163], v[148:151]
M v[152:155], a[80:83], a[160:163], v[20:23]
M v[152:155], a[84:87], a[164:167], v[152:155]
 s_waitcnt lgkmcnt(6)
M v[156:159], a[92:95], a[164:167], v[20:23]
 s_waitcnt vmcnt(16) lgkmcnt(0)
M v[156:159], a[88:91], a[160:163], v[156:159]
 s_barrier
M v[160:163], a[32:35], a[168:171], v[20:23]
 s_add_u32 m0, s24, 0
 ds_read_b128 a[160:163], v5 offset:20480
 ds_read_b128 a[164:167], v6 offset:20480
M v[160:163], a[36:39], a[172:175], v[160:163]
 buffer_load_dwordx4 v12, s[48:51], s22 offen offset:0   lds
M v[164:167], a[44:47], a[172:175], v[20:23]
 ds_read_b64_tr_b16 a[128:129], v1 offset:49152
 ds_read_b64_tr_b16 a[130:131], v1 offset:50176
M v[164:167], a[40:43], a[168:171], v[164:167]
M v[168:171], a[48:51], a[168:171], v[20:23]
 buffer_load_dwordx4 v13, s[48:51], s22 offen offset:1024   lds
M v[168:171], a[52:55], a[172:175], v[168:171]
 ds_read_b64_tr_b16 a[132:133], v1 offset:57344
 ds_read_b64_tr_b16 a[134:135], v1 offset:58368
M v[172:175], a[60:63], a[172:175], v[20:23]
M v[172:175], a[56:59], a[168:171], v[172:175]
M v[176:179], a[64:67], a[168:171], v[20:23]
 ds_read_b64_tr_b16 a[136:137], v2 offset:49152
 ds_read_b64_tr_b16 a[138:139], v2 offset:50176
M v[176:179], a[68:71], a[172:175], v[176:179]
 buffer_load_dwordx4 v14, s[48:51], s22 offen offset:2048   lds
M v[180:183], a[76:79], a[172:175], v[20:23]
M v[180:183], a[72:75], a[168:171], v[180:183]
 ds_read_b64_tr_b16 a[140:141], v2 offset:57344
 ds_read_b64_tr_b16 a[142:143], v2 offset:58368
M v[184:187], a[80:83], a[168:171], v[20:23]
 buffer_load_dwordx4 v15, s[48:51], s22 offen offset:3072   lds
M v[184:187], a[84:87], a[172:175], v[184:187]
 s_waitcnt lgkmcnt(8)
M v[188:191], a[92:95], a[172:175], v[20:23]
 s_add_u32 s22, s22, 2097152
M v[188:191], a[88:91], a[168:171], v[188:191]
 s_add_u32 m0, s23, 32768
 ds_read_b64_tr_b16 a[144:145], v3 offset:49152
 ds_read_b64_tr_b16 a[146:147], v3 offset:50176
M v[192:195], a[32:35], a[160:163], v[20:23]
 ds_read_b128 a[168:171], v5 offset:22528
 ds_read_b128 a[172:175], v6 offset:22528
M v[192:195], a[36:39], a[164:167], v[192:195]
 buffer_load_dwordx4 v8, s[16:19], s21 offen offset:0  nt lds
M v[196:199], a[44:47], a[164:167], v[20:23]
 ds_read_b64_tr_b16 a[148:149], v3 offset:57344
 ds_read_b64_tr_b16 a[150:151], v3 offset:58368
M v[196:199], a[40:43], a[160:163], v[196:199]
 buffer_load_dwordx4 v9, s[16:19], s21 offen offset:1024  nt lds
M v[200:203], a[48:51], a[160:163], v[20:23]
M v[200:203], a[52:55], a[164:167], v[200:203]
 ds_read_b64_tr_b16 a[152:153], v4 offset:49152
 ds_read_b64_tr_b16 a[154:155], v4 offset:50176
M v[204:207], a[60:63], a[164:167], v[20:23]
 buffer_load_dwordx4 v10, s[16:19], s21 offen offset:2048  nt lds
M v[204:207], a[56:59], a[160:163], v[204:207]
M v[208:211], a[64:67], a[160:163], v[20:23]
 ds_read_b64_tr_b16 a[156:157], v4 offset:57344
 ds_read_b64_tr_b16 a[158:159], v4 offset:58368
M v[208:211], a[68:71], a[164:167], v[208:211]
 buffer_load_dwordx4 v11, s[16:19], s21 offen offset:3072  nt lds
M v[212:215], a[76:79], a[164:167], v[20:23]
 s_add_u32 s21, s21, 128
M v[212:215], a[72:75], a[160:163], v[212:215]
M v[216:219], a[80:83], a[160:163], v[20:23]
M v[216:219], a[84:87], a[164:167], v[216:219]
 s_waitcnt lgkmcnt(6)
M v[220:223], a[92:95], a[164:167], v[20:23]
 s_waitcnt vmcnt(16) lgkmcnt(0)
M v[220:223], a[88:91], a[160:163], v[220:223]
 s_barrier
M v[224:227], a[32:35], a[168:171], v[20:23]
 ds_read_b128 a[160:163], v5 offset:32768
 ds_read_b128 a[164:167], v6 offset:32768
M v[224:227], a[36:39], a[172:175], v[224:227]
 buffer_load_dword a240, v24, s[32:35], 0 offen offset:512
M v[228:231], a[44:47], a[172:175], v[20:23]
M v[228:231], a[40:43], a[168:171], v[228:231]
M v[232:235], a[48:51], a[168:171], v[20:23]
M v[232:235], a[52:55], a[172:175], v[232:235]
M v[236:239], a[60:63], a[172:175], v[20:23]
M v[236:239], a[56:59], a[168:171], v[236:239]
M v[240:243], a[64:67], a[168:171], v[20:23]
M v[240:243], a[68:71], a[172:175], v[240:243]
M v[244:247], a[76:79], a[172:175], v[20:23]
M v[244:247], a[72:75], a[168:171], v[244:247]
M v[248:251], a[80:83], a[168:171], v[20:23]
M v[248:251], a[84:87], a[172:175], v[248:251]
 s_waitcnt lgkmcnt(0)
M v[252:255], a[92:95], a[172:175], v[20:23]
M v[252:255], a[88:91], a[168:171], v[252:255]
M a[0:3], a[96:99], a[160:163], a[0:3]
 ds_read_b128 a[168:171], v5 offset:34816
 ds_read_b128 a[172:175], v6 offset:34816
M a[0:3], a[100:103], a[164:167], a[0:3]
 ds_read_b64_tr_b16 a[32:33], v1 offset:0
 ds_read_b64_tr_b16 a[34:35], v1 offset:1024
M a[4:7], a[108:111], a[164:167], a[4:7]
 s_add_u32 m0, s24, 16384
M a[4:7], a[104:107], a[160:163], a[4:7]
 buffer_load_dwordx4 v12, s[48:51], s22 offen offset:0   lds
M a[8:11], a[112:115], a[160:163], a[8:11]
M a[8:11], a[116:119], a[164:167], a[8:11]
M a[12:15], a[124:127], a[164:167], a[12:15]
 ds_read_b64_tr_b16 a[36:37], v1 offset:8192
 ds_read_b64_tr_b16 a[38:39], v1 offset:9216
M a[12:15], a[120:123], a[160:163], a[12:15]
M a[16:19], a[128:131], a[160:163], a[16:19]
 buffer_load_dwordx4 v13, s[48:51], s22 offen offset:1024   lds
M a[16:19], a[132:135], a[164:167], a[16:19]
M a[20:23], a[140:143], a[164:167], a[20:23]
M a[20:23], a[136:139], a[160:163], a[20:23]
 ds_read_b64_tr_b16 a[40:41], v2 offset:0
 ds_read_b64_tr_b16 a[42:43], v2 offset:1024
M a[24:27], a[144:147], a[160:163], a[24:27]
M a[24:27], a[148:151], a[164:167], a[24:27]
 s_waitcnt lgkmcnt(6)
M a[28:31], a[156:159], a[164:167], a[28:31]
 buffer_load_dwordx4 v14, s[48:51], s22 offen offset:2048   lds
M a[28:31], a[152:155], a[160:163], a[28:31]
M v[60:63], a[152:155], a[168:171], v[60:63]
 ds_read_b128 a[160:163], v5 offset:36864
 ds_read_b128 a[164:167], v6 offset:36864
M v[60:63], a[156:159], a[172:175], v[60:63]
 ds_read_b64_tr_b16 a[44:45], v2 offset:8192
 ds_read_b64_tr_b16 a[46:47], v2 offset:9216
M v[56:59], a[148:151], a[172:175], v[56:59]
 buffer_load_dwordx4 v15, s[48:51], s22 offen offset:3072   lds
M v[56:59], a[144:147], a[168:171], v[56:59]
 s_sub_u32 s22, s22, 2097024
M v[52:55], a[136:139], a[168:171], v[52:55]
M v[52:55], a[140:143], a[172:175], v[52:55]
 ds_read_b64_tr_b16 a[48:49], v3 offset:0
 ds_read_b64_tr_b16 a[50:51], v3 offset:1024
M v[48:51], a[132:135], a[172:175], v[48:51]
 s_add_u32 m0, s23, 49152
M v[48:51], a[128:131], a[168:171], v[48:51]
 buffer_load_dwordx4 v8, s[16:19], s21 offen offset:0  nt lds
M v[44:47], a[120:123], a[168:171], v[44:47]
M v[44:47], a[124:127], a[172:175], v[44:47]
M v[40:43], a[116:119], a[172:175], v[40:43]
 ds_read_b64_tr_b16 a[52:53], v3 offset:8192
 ds_read_b64_tr_b16 a[54:55], v3 offset:9216
M v[40:43], a[112:115], a[168:171], v[40:43]
M v[36:39], a[104:107], a[168:171], v[36:39]
 buffer_load_dwordx4 v9, s[16:19], s21 offen offset:1024  nt lds
M v[36:39], a[108:111], a[172:175], v[36:39]
 s_waitcnt lgkmcnt(6)
M v[32:35], a[100:103], a[172:175], v[32:35]
M v[32:35], a[96:99], a[168:171], v[32:35]
 ds_read_b64_tr_b16 a[56:57], v4 offset:0
 ds_read_b64_tr_b16 a[58:59], v4 offset:1024
M v[64:67], a[96:99], a[160:163], v[64:67]
 ds_read_b128 a[168:171], v5 offset:38912
 ds_read_b128 a[172:175], v6 offset:38912
M v[64:67], a[100:103], a[164:167], v[64:67]
 buffer_load_dwordx4 v10, s[16:19], s21 offen offset:2048  nt lds
M v[68:71], a[108:111], a[164:167], v[68:71]
M v[68:71], a[104:107], a[160:163], v[68:71]
M v[72:75], a[112:115], a[160:163], v[72:75]
 ds_read_b64_tr_b16 a[60:61], v4 offset:8192
 ds_read_b64_tr_b16 a[62:63], v4 offset:9216
M v[72:75], a[116:119], a[164:167], v[72:75]
M v[76:79], a[124:127], a[164:167], v[76:79]
 buffer_load_dwordx4 v11, s[16:19], s21 offen offset:3072  nt lds
M v[76:79], a[120:123], a[160:163], v[76:79]
 s_add_u32 s21, s21, 524160
M v[80:83], a[128:131], a[160:163], v[80:83]
M v[80:83], a[132:135], a[164:167], v[80:83]
M v[84:87], a[140:143], a[164:167], v[84:87]
M v[84:87], a[136:139], a[160:163], v[84:87]
M v[88:91], a[144:147], a[160:163], v[88:91]
M v[88:91], a[148:151], a[164:167], v[88:91]
 s_waitcnt lgkmcnt(2)
M v[92:95], a[156:159], a[164:167], v[92:95]
 s_waitcnt vmcnt(17) lgkmcnt(0)
M v[92:95], a[152:155], a[160:163], v[92:95]
 s_barrier
M v[124:127], a[152:155], a[168:171], v[124:127]
 ds_read_b128 a[160:163], v5 offset:49152
 ds_read_b128 a[164:167], v6 offset:49152
M v[124:127], a[156:159], a[172:175], v[124:127]
M v[120:123], a[148:151], a[172:175], v[120:123]
 s_add_u32 m0, s24, 32768
 ds_read_b64_tr_b16 a[64:65], v1 offset:16384
 ds_read_b64_tr_b16 a[66:67], v1 offset:17408
M v[120:123], a[144:147], a[168:171], v[120:123]
 buffer_load_dwordx4 v12, s[48:51], s22 offen offset:0   lds
M v[116:119], a[136:139], a[168:171], v[116:119]
 v_mov_b32 v26, 163808
 ds_read_b128 v[28:31], v26
M v[116:119], a[140:143], a[172:175], v[116:119]
 s_getreg_b32 s92, hwreg(20, 2, 1)
M v[112:115], a[132:135], a[172:175], v[112:115]
 s_lshl_b32 s101, s41, 2
M v[112:115], a[128:131], a[168:171], v[112:115]
 s_and_b32 s100, s42, 7
M v[108:111], a[120:123], a[168:171], v[108:111]
 s_min_u32 s100, s100, 1
M v[108:111], a[124:127], a[172:175], v[108:111]
 s_lshl_b32 s100, s100, 29
 ds_read_b64_tr_b16 a[68:69], v1 offset:24576
 ds_read_b64_tr_b16 a[70:71], v1 offset:25600
M v[104:107], a[116:119], a[172:175], v[104:107]
 buffer_load_dwordx4 v13, s[48:51], s22 offen offset:1024   lds
M v[104:107], a[112:115], a[168:171], v[104:107]
 s_or_b32 s101, s101, s100
M v[100:103], a[104:107], a[168:171], v[100:103]
 s_lshl_b32 s100, s92, 30
 s_add_u32 s100, s100, 0x4000
 s_lshl_b32 s92, s92, 1
M v[100:103], a[108:111], a[172:175], v[100:103]
 s_waitcnt lgkmcnt(5)
 s_sub_u32 s92, 1, s92
 v_or_b32 v26, s20, v0
M v[96:99], a[100:103], a[172:175], v[96:99]
 v_min_u32 v26, 1, v26
 v_lshlrev_b32 v26, 29, v26
M v[96:99], a[96:99], a[168:171], v[96:99]
 s_waitcnt lgkmcnt(2)
 v_sub_u32 v28, v28, v29
 v_sub_u32 v30, v30, v31
M v[128:131], a[96:99], a[160:163], v[128:131]
 ds_read_b128 a[168:171], v5 offset:51200
 ds_read_b128 a[172:175], v6 offset:51200
M v[128:131], a[100:103], a[164:167], v[128:131]
 ds_read_b64_tr_b16 a[72:73], v2 offset:16384
 ds_read_b64_tr_b16 a[74:75], v2 offset:17408
M v[132:135], a[108:111], a[164:167], v[132:135]
 buffer_load_dwordx4 v14, s[48:51], s22 offen offset:2048   lds
M v[132:135], a[104:107], a[160:163], v[132:135]
 v_max_i32 v28, -400, v28
 v_max_i32 v30, -400, v30
M v[136:139], a[112:115], a[160:163], v[136:139]
 v_min_i32 v28, 400, v28
 v_min_i32 v30, 400, v30
M v[136:139], a[116:119], a[164:167], v[136:139]
 v_add_u32 v28, v28, v30
 v_mul_i32_i24 v28, s92, v28
M v[140:143], a[124:127], a[164:167], v[140:143]
 v_add_u32 v28, s100, v28
M v[140:143], a[120:123], a[160:163], v[140:143]
 ds_read_b64_tr_b16 a[76:77], v2 offset:24576
 ds_read_b64_tr_b16 a[78:79], v2 offset:25600
M v[144:147], a[128:131], a[160:163], v[144:147]
 buffer_load_dwordx4 v15, s[48:51], s22 offen offset:3072   lds
M v[144:147], a[132:135], a[164:167], v[144:147]
 s_add_u32 s22, s22, 2097152
M v[148:151], a[140:143], a[164:167], v[148:151]
 buffer_store_dword v28, v26, s[12:15], s101 offen sc1
M v[148:151], a[136:139], a[160:163], v[148:151]
M v[152:155], a[144:147], a[160:163], v[152:155]
M v[152:155], a[148:151], a[164:167], v[152:155]
 s_waitcnt lgkmcnt(4)
M v[156:159], a[156:159], a[164:167], v[156:159]
 s_add_u32 m0, s23, 0
 ds_read_b64_tr_b16 a[80:81], v3 offset:16384
 ds_read_b64_tr_b16 a[82:83], v3 offset:17408
M v[156:159], a[152:155], a[160:163], v[156:159]
 buffer_load_dwordx4 v8, s[16:19], s21 offen offset:0  nt lds
M v[188:191], a[152:155], a[168:171], v[188:191]
 ds_read_b128 a[160:163], v5 offset:53248
 ds_read_b128 a[164:167], v6 offset:53248
M v[188:191], a[156:159], a[172:175], v[188:191]
M v[184:187], a[148:151], a[172:175], v[184:187]
M v[184:187], a[144:147], a[168:171], v[184:187]
M v[180:183], a[136:139], a[168:171], v[180:183]
M v[180:183], a[140:143], a[172:175], v[180:183]
 ds_read_b64_tr_b16 a[84:85], v3 offset:24576
 ds_read_b64_tr_b16 a[86:87], v3 offset:25600
M v[176:179], a[132:135], a[172:175], v[176:179]
 buffer_load_dwordx4 v9, s[16:19], s21 offen offset:1024  nt lds
M v[176:179], a[128:131], a[168:171], v[176:179]
M v[172:175], a[120:123], a[168:171], v[172:175]
M v[172:175], a[124:127], a[172:175], v[172:175]
M v[168:171], a[116:119], a[172:175], v[168:171]
M v[168:171], a[112:115], a[168:171], v[168:171]
M v[164:167], a[104:107], a[168:171], v[164:167]
 ds_read_b64_tr_b16 a[88:89], v4 offset:16384
 ds_read_b64_tr_b16 a[90:91], v4 offset:17408
M v[164:167], a[108:111], a[172:175], v[164:167]
 s_waitcnt lgkmcnt(4)
M v[160:163], a[100:103], a[172:175], v[160:163]
 buffer_load_dwordx4 v10, s[16:19], s21 offen offset:2048  nt lds
M v[160:163], a[96:99], a[168:171], v[160:163]
M v[192:195], a[96:99], a[160:163], v[192:195]
 ds_read_b128 a[168:171], v5 offset:55296
 ds_read_b128 a[172:175], v6 offset:55296
M v[192:195], a[100:103], a[164:167], v[192:195]
M v[196:199], a[108:111], a[164:167], v[196:199]
M v[196:199], a[104:107], a[160:163], v[196:199]
 ds_read_b64_tr_b16 a[92:93], v4 offset:24576
 ds_read_b64_tr_b16 a[94:95], v4 offset:25600
M v[200:203], a[112:115], a[160:163], v[200:203]
 buffer_load_dwordx4 v11, s[16:19], s21 offen offset:3072  nt lds
M v[200:203], a[116:119], a[164:167], v[200:203]
 s_add_u32 s21, s21, 128
M v[204:207], a[124:127], a[164:167], v[204:207]
M v[204:207], a[120:123], a[160:163], v[204:207]
M v[208:211], a[128:131], a[160:163], v[208:211]
M v[208:211], a[132:135], a[164:167], v[208:211]
M v[212:215], a[140:143], a[164:167], v[212:215]
M v[212:215], a[136:139], a[160:163], v[212:215]
M v[216:219], a[144:147], a[160:163], v[216:219]
M v[216:219], a[148:151], a[164:167], v[216:219]
 s_waitcnt lgkmcnt(2)
M v[220:223], a[156:159], a[164:167], v[220:223]
 s_waitcnt vmcnt(18) lgkmcnt(0)
M v[220:223], a[152:155], a[160:163], v[220:223]
 s_barrier
M v[252:255], a[152:155], a[168:171], v[252:255]
 ds_read_b128 a[160:163], v5 offset:0
 ds_read_b128 a[164:167], v6 offset:0
M v[252:255], a[156:159], a[172:175], v[252:255]
M v[248:251], a[148:151], a[172:175], v[248:251]
M v[248:251], a[144:147], a[168:171], v[248:251]
M v[244:247], a[136:139], a[168:171], v[244:247]
M v[244:247], a[140:143], a[172:175], v[244:247]
M v[240:243], a[132:135], a[172:175], v[240:243]
M v[240:243], a[128:131], a[168:171], v[240:243]
M v[236:239], a[120:123], a[168:171], v[236:239]
M v[236:239], a[124:127], a[172:175], v[236:239]
M v[232:235], a[116:119], a[172:175], v[232:235]
M v[232:235], a[112:115], a[168:171], v[232:235]
M v[228:231], a[104:107], a[168:171], v[228:231]
M v[228:231], a[108:111], a[172:175], v[228:231]
 s_waitcnt lgkmcnt(0)
M v[224:227], a[100:103], a[172:175], v[224:227]
M v[224:227], a[96:99], a[168:171], v[224:227]
M a[0:3], a[32:35], a[160:163], a[0:3]
 ds_read_b128 a[168:171], v5 offset:2048
 ds_read_b128 a[172:175], v6 offset:2048
M a[0:3], a[36:39], a[164:167], a[0:3]
 ds_read_b64_tr_b16 a[96:97], v1 offset:32768
 ds_read_b64_tr_b16 a[98:99], v1 offset:33792
M a[4:7], a[44:47], a[164:167], a[4:7]
 s_add_u32 m0, s24, 49152
M a[4:7], a[40:43], a[160:163], a[4:7]
 buffer_load_dwordx4 v12, s[48:51], s22 offen offset:0   lds
M a[8:11], a[48:51], a[160:163], a[8:11]
M a[8:11], a[52:55], a[164:167], a[8:11]
M a[12:15], a[60:63], a[164:167], a[12:15]
 ds_read_b64_tr_b16 a[100:101], v1 offset:40960
 ds_read_b64_tr_b16 a[102:103], v1 offset:41984
M a[12:15], a[56:59], a[160:163], a[12:15]
M a[16:19], a[64:67], a[160:163], a[16:19]
 buffer_load_dwordx4 v13, s[48:51], s22 offen offset:1024   lds
M a[16:19], a[68:71], a[164:167], a[16:19]
M a[20:23], a[76:79], a[164:167], a[20:23]
 v_mov_b32 v16, 0x3f80
M a[20:23], a[72:75], a[160:163], a[20:23]
 ds_read_b64_tr_b16 a[104:105], v2 offset:32768
 ds_read_b64_tr_b16 a[106:107], v2 offset:33792
M a[24:27], a[80:83], a[160:163], a[24:27]
 v_lshrrev_b32 v17, 8, v7
M a[24:27], a[84:87], a[164:167], a[24:27]
 s_waitcnt lgkmcnt(6)
 v_bfe_u32 v18, v7, 6, 2
M a[28:31], a[92:95], a[164:167], a[28:31]
 buffer_load_dwordx4 v14, s[48:51], s22 offen offset:2048   lds
M a[28:31], a[88:91], a[160:163], a[28:31]
 v_and_b32 v19, 16, v7
M v[60:63], a[88:91], a[168:171], v[60:63]
 ds_read_b128 a[160:163], v5 offset:4096
 ds_read_b128 a[164:167], v6 offset:4096
M v[60:63], a[92:95], a[172:175], v[60:63]
 ds_read_b64_tr_b16 a[108:109], v2 offset:40960
 ds_read_b64_tr_b16 a[110:111], v2 offset:41984
M v[56:59], a[84:87], a[172:175], v[56:59]
 buffer_load_dwordx4 v15, s[48:51], s22 offen offset:3072   lds
M v[56:59], a[80:83], a[168:171], v[56:59]
 s_sub_u32 s22, s22, 2097024
 v_lshlrev_b32 v19, v19, v16
M v[52:55], a[72:75], a[168:171], v[52:55]
 v_cmp_eq_u32 vcc, v17, v18
M v[52:55], a[76:79], a[172:175], v[52:55]
 ds_read_b64_tr_b16 a[112:113], v3 offset:32768
 ds_read_b64_tr_b16 a[114:115], v3 offset:33792
M v[48:51], a[68:71], a[172:175], v[48:51]
 s_add_u32 m0, s23, 16384
 v_and_b32 v16, 32, v7
M v[48:51], a[64:67], a[168:171], v[48:51]
 buffer_load_dwordx4 v8, s[16:19], s21 offen offset:0  nt lds
M v[44:47], a[56:59], a[168:171], v[44:47]
 v_accvgpr_write_b32 a244, 0
M v[44:47], a[60:63], a[172:175], v[44:47]
 v_accvgpr_write_b32 a245, 0
M v[40:43], a[52:55], a[172:175], v[40:43]
 ds_read_b64_tr_b16 a[116:117], v3 offset:40960
 ds_read_b64_tr_b16 a[118:119], v3 offset:41984
M v[40:43], a[48:51], a[168:171], v[40:43]
 v_cndmask_b32 v19, 0, v19, vcc
M v[36:39], a[40:43], a[168:171], v[36:39]
 buffer_load_dwordx4 v9, s[16:19], s21 offen offset:1024  nt lds
M v[36:39], a[44:47], a[172:175], v[36:39]
 s_waitcnt lgkmcnt(6)
 v_cmp_eq_u32 vcc, 0, v16
M v[32:35], a[36:39], a[172:175], v[32:35]
 v_accvgpr_write_b32 a248, 0
M v[32:35], a[32:35], a[168:171], v[32:35]
 ds_read_b64_tr_b16 a[120:121], v4 offset:32768
 ds_read_b64_tr_b16 a[122:123], v4 offset:33792
M v[64:67], a[32:35], a[160:163], v[64:67]
 ds_read_b128 a[168:171], v5 offset:6144
 ds_read_b128 a[172:175], v6 offset:6144
M v[64:67], a[36:39], a[164:167], v[64:67]
 buffer_load_dwordx4 v10, s[16:19], s21 offen offset:2048  nt lds
M v[68:71], a[44:47], a[164:167], v[68:71]
 v_accvgpr_write_b32 a249, 0
M v[68:71], a[40:43], a[160:163], v[68:71]
 v_cndmask_b32 v17, 0, v19, vcc
M v[72:75], a[48:51], a[160:163], v[72:75]
 ds_read_b64_tr_b16 a[124:125], v4 offset:40960
 ds_read_b64_tr_b16 a[126:127], v4 offset:41984
M v[72:75], a[52:55], a[164:167], v[72:75]
 v_sub_u32 v18, v19, v17
M v[76:79], a[60:63], a[164:167], v[76:79]
 buffer_load_dwordx4 v11, s[16:19], s21 offen offset:3072  nt lds
M v[76:79], a[56:59], a[160:163], v[76:79]
 s_add_u32 s21, s21, 524160
 v_accvgpr_write_b32 a246, v17
M v[80:83], a[64:67], a[160:163], v[80:83]
 v_accvgpr_write_b32 a247, v18
M v[80:83], a[68:71], a[164:167], v[80:83]
M v[84:87], a[76:79], a[164:167], v[84:87]
M v[84:87], a[72:75], a[160:163], v[84:87]
M v[88:91], a[80:83], a[160:163], v[88:91]
M v[88:91], a[84:87], a[164:167], v[88:91]
 s_waitcnt lgkmcnt(2)
M v[92:95], a[92:95], a[164:167], v[92:95]
 s_waitcnt vmcnt(17) lgkmcnt(0)
M v[92:95], a[88:91], a[160:163], v[92:95]
 s_barrier
M v[124:127], a[88:91], a[168:171], v[124:127]
 ds_read_b128 a[160:163], v5 offset:16384
 ds_read_b128 a[164:167], v6 offset:16384
M v[124:127], a[92:95], a[172:175], v[124:127]
M v[120:123], a[84:87], a[172:175], v[120:123]
 s_add_u32 m0, s24, 0
 ds_read_b64_tr_b16 a[128:129], v1 offset:49152
 ds_read_b64_tr_b16 a[130:131], v1 offset:50176
M v[120:123], a[80:83], a[168:171], v[120:123]
 buffer_load_dwordx4 v12, s[48:51], s22 offen offset:0   lds
M v[116:119], a[72:75], a[168:171], v[116:119]
M v[116:119], a[76:79], a[172:175], v[116:119]
M v[112:115], a[68:71], a[172:175], v[112:115]
M v[112:115], a[64:67], a[168:171], v[112:115]
M v[108:111], a[56:59], a[168:171], v[108:111]
M v[108:111], a[60:63], a[172:175], v[108:111]
 ds_read_b64_tr_b16 a[132:133], v1 offset:57344
 ds_read_b64_tr_b16 a[134:135], v1 offset:58368
M v[104:107], a[52:55], a[172:175], v[104:107]
 buffer_load_dwordx4 v13, s[48:51], s22 offen offset:1024   lds
M v[104:107], a[48:51], a[168:171], v[104:107]
M v[100:103], a[40:43], a[168:171], v[100:103]
M v[100:103], a[44:47], a[172:175], v[100:103]
 s_waitcnt lgkmcnt(4)
M v[96:99], a[36:39], a[172:175], v[96:99]
M v[96:99], a[32:35], a[168:171], v[96:99]
M v[128:131], a[32:35], a[160:163], v[128:131]
 ds_read_b128 a[168:171], v5 offset:18432
 ds_read_b128 a[172:175], v6 offset:18432
M v[128:131], a[36:39], a[164:167], v[128:131]
 ds_read_b64_tr_b16 a[136:137], v2 offset:49152
 ds_read_b64_tr_b16 a[138:139], v2 offset:50176
M v[132:135], a[44:47], a[164:167], v[132:135]
 buffer_load_dwordx4 v14, s[48:51], s22 offen offset:2048   lds
M v[132:135], a[40:43], a[160:163], v[132:135]
M v[136:139], a[48:51], a[160:163], v[136:139]
M v[136:139], a[52:55], a[164:167], v[136:139]
M v[140:143], a[60:63], a[164:167], v[140:143]
M v[140:143], a[56:59], a[160:163], v[140:143]
 ds_read_b64_tr_b16 a[140:141], v2 offset:57344
 ds_read_b64_tr_b16 a[142:143], v2 offset:58368
M v[144:147], a[64:67], a[160:163], v[144:147]
 buffer_load_dwordx4 v15, s[48:51], s22 offen offset:3072   lds
M v[144:147], a[68:71], a[164:167], v[144:147]
 s_add_u32 s22, s22, 2097152
M v[148:151], a[76:79], a[164:167], v[148:151]
M v[148:151], a[72:75], a[160:163], v[148:151]
M v[152:155], a[80:83], a[160:163], v[152:155]
M v[152:155], a[84:87], a[164:167], v[152:155]
 s_waitcnt lgkmcnt(4)
M v[156:159], a[92:95], a[164:167], v[156:159]
 s_add_u32 m0, s23, 32768
 ds_read_b64_tr_b16 a[144:145], v3 offset:49152
 ds_read_b64_tr_b16 a[146:147], v3 offset:50176
M v[156:159], a[88:91], a[160:163], v[156:159]
 buffer_load_dwordx4 v8, s[16:19], s21 offen offset:0  nt lds
M v[188:191], a[88:91], a[168:171], v[188:191]
 ds_read_b128 a[160:163], v5 offset:20480
 ds_read_b128 a[164:167], v6 offset:20480
M v[188:191], a[92:95], a[172:175], v[188:191]
M v[184:187], a[84:87], a[172:175], v[184:187]
M v[184:187], a[80:83], a[168:171], v[184:187]
M v[180:183], a[72:75], a[168:171], v[180:183]
M v[180:183], a[76:79], a[172:175], v[180:183]
 ds_read_b64_tr_b16 a[148:149], v3 offset:57344
 ds_read_b64_tr_b16 a[150:151], v3 offset:58368
M v[176:179], a[68:71], a[172:175], v[176:179]
 buffer_load_dwordx4 v9, s[16:19], s21 offen offset:1024  nt lds
M v[176:179], a[64:67], a[168:171], v[176:179]
M v[172:175], a[56:59], a[168:171], v[172:175]
M v[172:175], a[60:63], a[172:175], v[172:175]
M v[168:171], a[52:55], a[172:175], v[168:171]
M v[168:171], a[48:51], a[168:171], v[168:171]
M v[164:167], a[40:43], a[168:171], v[164:167]
 ds_read_b64_tr_b16 a[152:153], v4 offset:49152
 ds_read_b64_tr_b16 a[154:155], v4 offset:50176
M v[164:167], a[44:47], a[172:175], v[164:167]
 s_waitcnt lgkmcnt(4)
M v[160:163], a[36:39], a[172:175], v[160:163]
 buffer_load_dwordx4 v10, s[16:19], s21 offen offset:2048  nt lds
M v[160:163], a[32:35], a[168:171], v[160:163]
M v[192:195], a[32:35], a[160:163], v[192:195]
 ds_read_b128 a[168:171], v5 offset:22528
 ds_read_b128 a[172:175], v6 offset:22528
M v[192:195], a[36:39], a[164:167], v[192:195]
M v[196:199], a[44:47], a[164:167], v[196:199]
M v[196:199], a[40:43], a[160:163], v[196:199]
 ds_read_b64_tr_b16 a[156:157], v4 offset:57344
 ds_read_b64_tr_b16 a[158:159], v4 offset:58368
M v[200:203], a[48:51], a[160:163], v[200:203]
 buffer_load_dwordx4 v11, s[16:19], s21 offen offset:3072  nt lds
M v[200:203], a[52:55], a[164:167], v[200:203]
 s_add_u32 s21, s21, 128
M v[204:207], a[60:63], a[164:167], v[204:207]
M v[204:207], a[56:59], a[160:163], v[204:207]
M v[208:211], a[64:67], a[160:163], v[208:211]
M v[208:211], a[68:71], a[164:167], v[208:211]
M v[212:215], a[76:79], a[164:167], v[212:215]
M v[212:215], a[72:75], a[160:163], v[212:215]
M v[216:219], a[80:83], a[160:163], v[216:219]
M v[216:219], a[84:87], a[164:167], v[216:219]
 s_waitcnt lgkmcnt(2)
M v[220:223], a[92:95], a[164:167], v[220:223]
 s_waitcnt vmcnt(16) lgkmcnt(0)
M v[220:223], a[88:91], a[160:163], v[220:223]
 s_barrier
M v[252:255], a[88:91], a[168:171], v[252:255]
 ds_read_b128 a[160:163], v5 offset:32768
 ds_read_b128 a[164:167], v6 offset:32768
M v[252:255], a[92:95], a[172:175], v[252:255]
M v[248:251], a[84:87], a[172:175], v[248:251]
M v[248:251], a[80:83], a[168:171], v[248:251]
M v[244:247], a[72:75], a[168:171], v[244:247]
M v[244:247], a[76:79], a[172:175], v[244:247]
M v[240:243], a[68:71], a[172:175], v[240:243]
M v[240:243], a[64:67], a[168:171], v[240:243]
M v[236:239], a[56:59], a[168:171], v[236:239]
M v[236:239], a[60:63], a[172:175], v[236:239]
M v[232:235], a[52:55], a[172:175], v[232:235]
M v[232:235], a[48:51], a[168:171], v[232:235]
M v[228:231], a[40:43], a[168:171], v[228:231]
M v[228:231], a[44:47], a[172:175], v[228:231]
 s_waitcnt lgkmcnt(0)
M v[224:227], a[36:39], a[172:175], v[224:227]
M v[224:227], a[32:35], a[168:171], v[224:227]
M a[0:3], a[96:99], a[160:163], a[0:3]
 ds_read_b128 a[168:171], v5 offset:34816
 ds_read_b128 a[172:175], v6 offset:34816
M a[0:3], a[100:103], a[164:167], a[0:3]
 ds_read_b64_tr_b16 a[32:33], v1 offset:0
 ds_read_b64_tr_b16 a[34:35], v1 offset:1024
M a[4:7], a[108:111], a[164:167], a[4:7]
 s_add_u32 m0, s24, 16384
M a[4:7], a[104:107], a[160:163], a[4:7]
 buffer_load_dwordx4 v12, s[48:51], s22 offen offset:0   lds
M a[8:11], a[112:115], a[160:163], a[8:11]
M a[8:11], a[116:119], a[164:167], a[8:11]
M a[12:15], a[124:127], a[164:167], a[12:15]
 ds_read_b64_tr_b16 a[36:37], v1 offset:8192
 ds_read_b64_tr_b16 a[38:39], v1 offset:9216
M a[12:15], a[120:123], a[160:163], a[12:15]
M a[16:19], a[128:131], a[160:163], a[16:19]
 buffer_load_dwordx4 v13, s[48:51], s22 offen offset:1024   lds
M a[16:19], a[132:135], a[164:167], a[16:19]
M a[20:23], a[140:143], a[164:167], a[20:23]
M a[20:23], a[136:139], a[160:163], a[20:23]
 ds_read_b64_tr_b16 a[40:41], v2 offset:0
 ds_read_b64_tr_b16 a[42:43], v2 offset:1024
M a[24:27], a[144:147], a[160:163], a[24:27]
M a[24:27], a[148:151], a[164:167], a[24:27]
 s_waitcnt lgkmcnt(6)
M a[28:31], a[156:159], a[164:167], a[28:31]
 buffer_load_dwordx4 v14, s[48:51], s22 offen offset:2048   lds
M a[28:31], a[152:155], a[160:163], a[28:31]
M v[60:63], a[152:155], a[168:171], v[60:63]
 ds_read_b128 a[160:163], v5 offset:36864
 ds_read_b128 a[164:167], v6 offset:36864
M v[60:63], a[156:159], a[172:175], v[60:63]
 ds_read_b64_tr_b16 a[44:45], v2 offset:8192
 ds_read_b64_tr_b16 a[46:47], v2 offset:9216
M v[56:59], a[148:151], a[172:175], v[56:59]
 buffer_load_dwordx4 v15, s[48:51], s22 offen offset:3072   lds
M v[56:59], a[144:147], a[168:171], v[56:59]
 s_sub_u32 s22, s22, 2097024
M v[52:55], a[136:139], a[168:171], v[52:55]
M v[52:55], a[140:143], a[172:175], v[52:55]
 ds_read_b64_tr_b16 a[48:49], v3 offset:0
 ds_read_b64_tr_b16 a[50:51], v3 offset:1024
M v[48:51], a[132:135], a[172:175], v[48:51]
 s_add_u32 m0, s23, 49152
M v[48:51], a[128:131], a[168:171], v[48:51]
 buffer_load_dwordx4 v8, s[16:19], s21 offen offset:0  nt lds
M v[44:47], a[120:123], a[168:171], v[44:47]
M v[44:47], a[124:127], a[172:175], v[44:47]
M v[40:43], a[116:119], a[172:175], v[40:43]
 ds_read_b64_tr_b16 a[52:53], v3 offset:8192
 ds_read_b64_tr_b16 a[54:55], v3 offset:9216
M v[40:43], a[112:115], a[168:171], v[40:43]
M v[36:39], a[104:107], a[168:171], v[36:39]
 buffer_load_dwordx4 v9, s[16:19], s21 offen offset:1024  nt lds
M v[36:39], a[108:111], a[172:175], v[36:39]
 s_waitcnt lgkmcnt(6)
M v[32:35], a[100:103], a[172:175], v[32:35]
M v[32:35], a[96:99], a[168:171], v[32:35]
 ds_read_b64_tr_b16 a[56:57], v4 offset:0
 ds_read_b64_tr_b16 a[58:59], v4 offset:1024
M v[64:67], a[96:99], a[160:163], v[64:67]
 ds_read_b128 a[168:171], v5 offset:38912
 ds_read_b128 a[172:175], v6 offset:38912
M v[64:67], a[100:103], a[164:167], v[64:67]
 buffer_load_dwordx4 v10, s[16:19], s21 offen offset:2048  nt lds
M v[68:71], a[108:111], a[164:167], v[68:71]
M v[68:71], a[104:107], a[160:163], v[68:71]
M v[72:75], a[112:115], a[160:163], v[72:75]
 ds_read_b64_tr_b16 a[60:61], v4 offset:8192
 ds_read_b64_tr_b16 a[62:63], v4 offset:9216
M v[72:75], a[116:119], a[164:167], v[72:75]
M v[76:79], a[124:127], a[164:167], v[76:79]
 buffer_load_dwordx4 v11, s[16:19], s21 offen offset:3072  nt lds
M v[76:79], a[120:123], a[160:163], v[76:79]
 s_add_u32 s21, s21, 524160
M v[80:83], a[128:131], a[160:163], v[80:83]
M v[80:83], a[132:135], a[164:167], v[80:83]
M v[84:87], a[140:143], a[164:167], v[84:87]
M v[84:87], a[136:139], a[160:163], v[84:87]
M v[88:91], a[144:147], a[160:163], v[88:91]
M v[88:91], a[148:151], a[164:167], v[88:91]
 s_waitcnt lgkmcnt(2)
M v[92:95], a[156:159], a[164:167], v[92:95]
 s_waitcnt vmcnt(16) lgkmcnt(0)
M v[92:95], a[152:155], a[160:163], v[92:95]
 s_barrier
M v[124:127], a[152:155], a[168:171], v[124:127]
 ds_read_b128 a[160:163], v5 offset:49152
 ds_read_b128 a[164:167], v6 offset:49152
M v[124:127], a[156:159], a[172:175], v[124:127]
M v[120:123], a[148:151], a[172:175], v[120:123]
 s_add_u32 m0, s24, 32768
 ds_read_b64_tr_b16 a[64:65], v1 offset:16384
 ds_read_b64_tr_b16 a[66:67], v1 offset:17408
M v[120:123], a[144:147], a[168:171], v[120:123]
 buffer_load_dwordx4 v12, s[48:51], s22 offen offset:0   lds
M v[116:119], a[136:139], a[168:171], v[116:119]
 v_min_u32 v16, 56, v0
 v_lshlrev_b32 v16, 2, v16
M v[116:119], a[140:143], a[172:175], v[116:119]
 buffer_load_dword v17, v16, s[12:15], 0 offen offset:0 sc1
M v[112:115], a[132:135], a[172:175], v[112:115]
M v[112:115], a[128:131], a[168:171], v[112:115]
M v[108:111], a[120:123], a[168:171], v[108:111]
M v[108:111], a[124:127], a[172:175], v[108:111]
 ds_read_b64_tr_b16 a[68:69], v1 offset:24576
 ds_read_b64_tr_b16 a[70:71], v1 offset:25600
M v[104:107], a[116:119], a[172:175], v[104:107]
 buffer_load_dwordx4 v13, s[48:51], s22 offen offset:1024   lds
M v[104:107], a[112:115], a[168:171], v[104:107]
M v[100:103], a[104:107], a[168:171], v[100:103]
M v[100:103], a[108:111], a[172:175], v[100:103]
 s_waitcnt lgkmcnt(4)
M v[96:99], a[100:103], a[172:175], v[96:99]
M v[96:99], a[96:99], a[168:171], v[96:99]
M v[128:131], a[96:99], a[160:163], v[128:131]
 ds_read_b128 a[168:171], v5 offset:51200
 ds_read_b128 a[172:175], v6 offset:51200
M v[128:131], a[100:103], a[164:167], v[128:131]
 ds_read_b64_tr_b16 a[72:73], v2 offset:16384
 ds_read_b64_tr_b16 a[74:75], v2 offset:17408
M v[132:135], a[108:111], a[164:167], v[132:135]
 buffer_load_dwordx4 v14, s[48:51], s22 offen offset:2048   lds
M v[132:135], a[104:107], a[160:163], v[132:135]
M v[136:139], a[112:115], a[160:163], v[136:139]
M v[136:139], a[116:119], a[164:167], v[136:139]
M v[140:143], a[124:127], a[164:167], v[140:143]
M v[140:143], a[120:123], a[160:163], v[140:143]
 ds_read_b64_tr_b16 a[76:77], v2 offset:24576
 ds_read_b64_tr_b16 a[78:79], v2 offset:25600
M v[144:147], a[128:131], a[160:163], v[144:147]
 buffer_load_dwordx4 v15, s[48:51], s22 offen offset:3072   lds
M v[144:147], a[132:135], a[164:167], v[144:147]
 s_add_u32 s22, s22, 2097152
M v[148:151], a[140:143], a[164:167], v[148:151]
M v[148:151], a[136:139], a[160:163], v[148:151]
M v[152:155], a[144:147], a[160:163], v[152:155]
M v[152:155], a[148:151], a[164:167], v[152:155]
 s_waitcnt lgkmcnt(4)
M v[156:159], a[156:159], a[164:167], v[156:159]
 s_add_u32 m0, s23, 0
 ds_read_b64_tr_b16 a[80:81], v3 offset:16384
 ds_read_b64_tr_b16 a[82:83], v3 offset:17408
M v[156:159], a[152:155], a[160:163], v[156:159]
 buffer_load_dwordx4 v8, s[16:19], s21 offen offset:0  nt lds
M v[188:191], a[152:155], a[168:171], v[188:191]
 ds_read_b128 a[160:163], v5 offset:53248
 ds_read_b128 a[164:167], v6 offset:53248
M v[188:191], a[156:159], a[172:175], v[188:191]
M v[184:187], a[148:151], a[172:175], v[184:187]
M v[184:187], a[144:147], a[168:171], v[184:187]
M v[180:183], a[136:139], a[168:171], v[180:183]
M v[180:183], a[140:143], a[172:175], v[180:183]
 ds_read_b64_tr_b16 a[84:85], v3 offset:24576
 ds_read_b64_tr_b16 a[86:87], v3 offset:25600
M v[176:179], a[132:135], a[172:175], v[176:179]
 buffer_load_dwordx4 v9, s[16:19], s21 offen offset:1024  nt lds
M v[176:179], a[128:131], a[168:171], v[176:179]
M v[172:175], a[120:123], a[168:171], v[172:175]
M v[172:175], a[124:127], a[172:175], v[172:175]
M v[168:171], a[116:119], a[172:175], v[168:171]
M v[168:171], a[112:115], a[168:171], v[168:171]
M v[164:167], a[104:107], a[168:171], v[164:167]
 ds_read_b64_tr_b16 a[88:89], v4 offset:16384
 ds_read_b64_tr_b16 a[90:91], v4 offset:17408
M v[164:167], a[108:111], a[172:175], v[164:167]
 s_waitcnt lgkmcnt(4)
M v[160:163], a[100:103], a[172:175], v[160:163]
 buffer_load_dwordx4 v10, s[16:19], s21 offen offset:2048  nt lds
M v[160:163], a[96:99], a[168:171], v[160:163]
M v[192:195], a[96:99], a[160:163], v[192:195]
 ds_read_b128 a[168:171], v5 offset:55296
 ds_read_b128 a[172:175], v6 offset:55296
M v[192:195], a[100:103], a[164:167], v[192:195]
M v[196:199], a[108:111], a[164:167], v[196:199]
M v[196:199], a[104:107], a[160:163], v[196:199]
 ds_read_b64_tr_b16 a[92:93], v4 offset:24576
 ds_read_b64_tr_b16 a[94:95], v4 offset:25600
M v[200:203], a[112:115], a[160:163], v[200:203]
 buffer_load_dwordx4 v11, s[16:19], s21 offen offset:3072  nt lds
M v[200:203], a[116:119], a[164:167], v[200:203]
 s_add_u32 s21, s21, 128
M v[204:207], a[124:127], a[164:167], v[204:207]
M v[204:207], a[120:123], a[160:163], v[204:207]
M v[208:211], a[128:131], a[160:163], v[208:211]
M v[208:211], a[132:135], a[164:167], v[208:211]
M v[212:215], a[140:143], a[164:167], v[212:215]
M v[212:215], a[136:139], a[160:163], v[212:215]
M v[216:219], a[144:147], a[160:163], v[216:219]
M v[216:219], a[148:151], a[164:167], v[216:219]
 s_waitcnt lgkmcnt(2)
M v[220:223], a[156:159], a[164:167], v[220:223]
 s_waitcnt vmcnt(17) lgkmcnt(0)
M v[220:223], a[152:155], a[160:163], v[220:223]
 s_barrier
M v[252:255], a[152:155], a[168:171], v[252:255]
 ds_read_b128 a[160:163], v5 offset:0
 ds_read_b128 a[164:167], v6 offset:0
M v[252:255], a[156:159], a[172:175], v[252:255]
M v[248:251], a[148:151], a[172:175], v[248:251]
M v[248:251], a[144:147], a[168:171], v[248:251]
M v[244:247], a[136:139], a[168:171], v[244:247]
M v[244:247], a[140:143], a[172:175], v[244:247]
M v[240:243], a[132:135], a[172:175], v[240:243]
M v[240:243], a[128:131], a[168:171], v[240:243]
M v[236:239], a[120:123], a[168:171], v[236:239]
M v[236:239], a[124:127], a[172:175], v[236:239]
M v[232:235], a[116:119], a[172:175], v[232:235]
M v[232:235], a[112:115], a[168:171], v[232:235]
M v[228:231], a[104:107], a[168:171], v[228:231]
M v[228:231], a[108:111], a[172:175], v[228:231]
 s_waitcnt lgkmcnt(0)
M v[224:227], a[100:103], a[172:175], v[224:227]
M v[224:227], a[96:99], a[168:171], v[224:227]
M a[0:3], a[32:35], a[160:163], a[0:3]
 ds_read_b128 a[168:171], v5 offset:2048
 ds_read_b128 a[172:175], v6 offset:2048
M a[0:3], a[36:39], a[164:167], a[0:3]
 ds_read_b64_tr_b16 a[96:97], v1 offset:32768
 ds_read_b64_tr_b16 a[98:99], v1 offset:33792
M a[4:7], a[44:47], a[164:167], a[4:7]
 s_add_u32 m0, s24, 49152
M a[4:7], a[40:43], a[160:163], a[4:7]
 buffer_load_dwordx4 v12, s[48:51], s22 offen offset:0   lds
M a[8:11], a[48:51], a[160:163], a[8:11]
M a[8:11], a[52:55], a[164:167], a[8:11]
M a[12:15], a[60:63], a[164:167], a[12:15]
 ds_read_b64_tr_b16 a[100:101], v1 offset:40960
 ds_read_b64_tr_b16 a[102:103], v1 offset:41984
M a[12:15], a[56:59], a[160:163], a[12:15]
M a[16:19], a[64:67], a[160:163], a[16:19]
 buffer_load_dwordx4 v13, s[48:51], s22 offen offset:1024   lds
M a[16:19], a[68:71], a[164:167], a[16:19]
M a[20:23], a[76:79], a[164:167], a[20:23]
M a[20:23], a[72:75], a[160:163], a[20:23]
 ds_read_b64_tr_b16 a[104:105], v2 offset:32768
 ds_read_b64_tr_b16 a[106:107], v2 offset:33792
M a[24:27], a[80:83], a[160:163], a[24:27]
M a[24:27], a[84:87], a[164:167], a[24:27]
 s_waitcnt lgkmcnt(6)
M a[28:31], a[92:95], a[164:167], a[28:31]
 buffer_load_dwordx4 v14, s[48:51], s22 offen offset:2048   lds
M a[28:31], a[88:91], a[160:163], a[28:31]
M v[60:63], a[88:91], a[168:171], v[60:63]
 ds_read_b128 a[160:163], v5 offset:4096
 ds_read_b128 a[164:167], v6 offset:4096
M v[60:63], a[92:95], a[172:175], v[60:63]
 ds_read_b64_tr_b16 a[108:109], v2 offset:40960
 ds_read_b64_tr_b16 a[110:111], v2 offset:41984
M v[56:59], a[84:87], a[172:175], v[56:59]
 buffer_load_dwordx4 v15, s[48:51], s22 offen offset:3072   lds
M v[56:59], a[80:83], a[168:171], v[56:59]
 s_sub_u32 s22, s22, 2097024
M v[52:55], a[72:75], a[168:171], v[52:55]
M v[52:55], a[76:79], a[172:175], v[52:55]
 ds_read_b64_tr_b16 a[112:113], v3 offset:32768
 ds_read_b64_tr_b16 a[114:115], v3 offset:33792
M v[48:51], a[68:71], a[172:175], v[48:51]
 s_add_u32 m0, s23, 16384
M v[48:51], a[64:67], a[168:171], v[48:51]
 buffer_load_dwordx4 v8, s[16:19], s21 offen offset:0  nt lds
M v[44:47], a[56:59], a[168:171], v[44:47]
M v[44:47], a[60:63], a[172:175], v[44:47]
M v[40:43], a[52:55], a[172:175], v[40:43]
 ds_read_b64_tr_b16 a[116:117], v3 offset:40960
 ds_read_b64_tr_b16 a[118:119], v3 offset:41984
M v[40:43], a[48:51], a[168:171], v[40:43]
M v[36:39], a[40:43], a[168:171], v[36:39]
 buffer_load_dwordx4 v9, s[16:19], s21 offen offset:1024  nt lds
M v[36:39], a[44:47], a[172:175], v[36:39]
 s_waitcnt lgkmcnt(6)
M v[32:35], a[36:39], a[172:175], v[32:35]
M v[32:35], a[32:35], a[168:171], v[32:35]
 ds_read_b64_tr_b16 a[120:121], v4 offset:32768
 ds_read_b64_tr_b16 a[122:123], v4 offset:33792
M v[64:67], a[32:35], a[160:163], v[64:67]
 ds_read_b128 a[168:171], v5 offset:6144
 ds_read_b128 a[172:175], v6 offset:6144
M v[64:67], a[36:39], a[164:167], v[64:67]
 buffer_load_dwordx4 v10, s[16:19], s21 offen offset:2048  nt lds
M v[68:71], a[44:47], a[164:167], v[68:71]
M v[68:71], a[40:43], a[160:163], v[68:71]
M v[72:75], a[48:51], a[160:163], v[72:75]
 ds_read_b64_tr_b16 a[124:125], v4 offset:40960
 ds_read_b64_tr_b16 a[126:127], v4 offset:41984
M v[72:75], a[52:55], a[164:167], v[72:75]
M v[76:79], a[60:63], a[164:167], v[76:79]
 buffer_load_dwordx4 v11, s[16:19], s21 offen offset:3072  nt lds
M v[76:79], a[56:59], a[160:163], v[76:79]
 s_add_u32 s21, s21, 524160
M v[80:83], a[64:67], a[160:163], v[80:83]
M v[80:83], a[68:71], a[164:167], v[80:83]
M v[84:87], a[76:79], a[164:167], v[84:87]
M v[84:87], a[72:75], a[160:163], v[84:87]
M v[88:91], a[80:83], a[160:163], v[88:91]
M v[88:91], a[84:87], a[164:167], v[88:91]
 s_waitcnt lgkmcnt(2)
M v[92:95], a[92:95], a[164:167], v[92:95]
 s_waitcnt vmcnt(17) lgkmcnt(0)
M v[92:95], a[88:91], a[160:163], v[92:95]
 s_barrier
M v[124:127], a[88:91], a[168:171], v[124:127]
 ds_read_b128 a[160:163], v5 offset:16384
 ds_read_b128 a[164:167], v6 offset:16384
M v[124:127], a[92:95], a[172:175], v[124:127]
M v[120:123], a[84:87], a[172:175], v[120:123]
 s_add_u32 m0, s24, 0
 ds_read_b64_tr_b16 a[128:129], v1 offset:49152
 ds_read_b64_tr_b16 a[130:131], v1 offset:50176
M v[120:123], a[80:83], a[168:171], v[120:123]
 buffer_load_dwordx4 v12, s[48:51], s22 offen offset:0   lds
M v[116:119], a[72:75], a[168:171], v[116:119]
M v[116:119], a[76:79], a[172:175], v[116:119]
M v[112:115], a[68:71], a[172:175], v[112:115]
M v[112:115], a[64:67], a[168:171], v[112:115]
M v[108:111], a[56:59], a[168:171], v[108:111]
M v[108:111], a[60:63], a[172:175], v[108:111]
 ds_read_b64_tr_b16 a[132:133], v1 offset:57344
 ds_read_b64_tr_b16 a[134:135], v1 offset:58368
M v[104:107], a[52:55], a[172:175], v[104:107]
 buffer_load_dwordx4 v13, s[48:51], s22 offen offset:1024   lds
M v[104:107], a[48:51], a[168:171], v[104:107]
M v[100:103], a[40:43], a[168:171], v[100:103]
M v[100:103], a[44:47], a[172:175], v[100:103]
 s_waitcnt lgkmcnt(4)
M v[96:99], a[36:39], a[172:175], v[96:99]
M v[96:99], a[32:35], a[168:171], v[96:99]
M v[128:131], a[32:35], a[160:163], v[128:131]
 ds_read_b128 a[168:171], v5 offset:18432
 ds_read_b128 a[172:175], v6 offset:18432
M v[128:131], a[36:39], a[164:167], v[128:131]
 ds_read_b64_tr_b16 a[136:137], v2 offset:49152
 ds_read_b64_tr_b16 a[138:139], v2 offset:50176
M v[132:135], a[44:47], a[164:167], v[132:135]
 buffer_load_dwordx4 v14, s[48:51], s22 offen offset:2048   lds
M v[132:135], a[40:43], a[160:163], v[132:135]
M v[136:139], a[48:51], a[160:163], v[136:139]
M v[136:139], a[52:55], a[164:167], v[136:139]
M v[140:143], a[60:63], a[164:167], v[140:143]
M v[140:143], a[56:59], a[160:163], v[140:143]
 ds_read_b64_tr_b16 a[140:141], v2 offset:57344
 ds_read_b64_tr_b16 a[142:143], v2 offset:58368
M v[144:147], a[64:67], a[160:163], v[144:147]
 buffer_load_dwordx4 v15, s[48:51], s22 offen offset:3072   lds
M v[144:147], a[68:71], a[164:167], v[144:147]
 s_add_u32 s22, s22, 2097152
M v[148:151], a[76:79], a[164:167], v[148:151]
M v[148:151], a[72:75], a[160:163], v[148:151]
M v[152:155], a[80:83], a[160:163], v[152:155]
M v[152:155], a[84:87], a[164:167], v[152:155]
 s_waitcnt lgkmcnt(4)
M v[156:159], a[92:95], a[164:167], v[156:159]
 s_add_u32 m0, s23, 32768
 ds_read_b64_tr_b16 a[144:145], v3 offset:49152
 ds_read_b64_tr_b16 a[146:147], v3 offset:50176
M v[156:159], a[88:91], a[160:163], v[156:159]
 buffer_load_dwordx4 v8, s[16:19], s21 offen offset:0  nt lds
M v[188:191], a[88:91], a[168:171], v[188:191]
 ds_read_b128 a[160:163], v5 offset:20480
 ds_read_b128 a[164:167], v6 offset:20480
M v[188:191], a[92:95], a[172:175], v[188:191]
M v[184:187], a[84:87], a[172:175], v[184:187]
M v[184:187], a[80:83], a[168:171], v[184:187]
M v[180:183], a[72:75], a[168:171], v[180:183]
M v[180:183], a[76:79], a[172:175], v[180:183]
 ds_read_b64_tr_b16 a[148:149], v3 offset:57344
 ds_read_b64_tr_b16 a[150:151], v3 offset:58368
M v[176:179], a[68:71], a[172:175], v[176:179]
 buffer_load_dwordx4 v9, s[16:19], s21 offen offset:1024  nt lds
M v[176:179], a[64:67], a[168:171], v[176:179]
M v[172:175], a[56:59], a[168:171], v[172:175]
M v[172:175], a[60:63], a[172:175], v[172:175]
M v[168:171], a[52:55], a[172:175], v[168:171]
M v[168:171], a[48:51], a[168:171], v[168:171]
M v[164:167], a[40:43], a[168:171], v[164:167]
 ds_read_b64_tr_b16 a[152:153], v4 offset:49152
 ds_read_b64_tr_b16 a[154:155], v4 offset:50176
M v[164:167], a[44:47], a[172:175], v[164:167]
 s_waitcnt lgkmcnt(4)
M v[160:163], a[36:39], a[172:175], v[160:163]
 buffer_load_dwordx4 v10, s[16:19], s21 offen offset:2048  nt lds
M v[160:163], a[32:35], a[168:171], v[160:163]
M v[192:195], a[32:35], a[160:163], v[192:195]
 ds_read_b128 a[168:171], v5 offset:22528
 ds_read_b128 a[172:175], v6 offset:22528
M v[192:195], a[36:39], a[164:167], v[192:195]
M v[196:199], a[44:47], a[164:167], v[196:199]
M v[196:199], a[40:43], a[160:163], v[196:199]
 ds_read_b64_tr_b16 a[156:157], v4 offset:57344
 ds_read_b64_tr_b16 a[158:159], v4 offset:58368
M v[200:203], a[48:51], a[160:163], v[200:203]
 buffer_load_dwordx4 v11, s[16:19], s21 offen offset:3072  nt lds
M v[200:203], a[52:55], a[164:167], v[200:203]
 s_add_u32 s21, s21, 128
M v[204:207], a[60:63], a[164:167], v[204:207]
M v[204:207], a[56:59], a[160:163], v[204:207]
M v[208:211], a[64:67], a[160:163], v[208:211]
M v[208:211], a[68:71], a[164:167], v[208:211]
M v[212:215], a[76:79], a[164:167], v[212:215]
M v[212:215], a[72:75], a[160:163], v[212:215]
M v[216:219], a[80:83], a[160:163], v[216:219]
M v[216:219], a[84:87], a[164:167], v[216:219]
 s_waitcnt lgkmcnt(2)
M v[220:223], a[92:95], a[164:167], v[220:223]
 s_waitcnt vmcnt(16) lgkmcnt(0)
M v[220:223], a[88:91], a[160:163], v[220:223]
 s_barrier
M v[252:255], a[88:91], a[168:171], v[252:255]
 ds_read_b128 a[160:163], v5 offset:32768
 ds_read_b128 a[164:167], v6 offset:32768
M v[252:255], a[92:95], a[172:175], v[252:255]
 v_cmp_eq_u32 vcc, 0, v17
M v[248:251], a[84:87], a[172:175], v[248:251]
 s_nop 0
M v[248:251], a[80:83], a[168:171], v[248:251]
 s_cbranch_vccnz L_zs1
L_zr1:
M v[244:247], a[72:75], a[168:171], v[244:247]
 buffer_load_dword a240, v24, s[32:35], 0 offen offset:1024
M v[244:247], a[76:79], a[172:175], v[244:247]
M v[240:243], a[68:71], a[172:175], v[240:243]
M v[240:243], a[64:67], a[168:171], v[240:243]
M v[236:239], a[56:59], a[168:171], v[236:239]
M v[236:239], a[60:63], a[172:175], v[236:239]
M v[232:235], a[52:55], a[172:175], v[232:235]
M v[232:235], a[48:51], a[168:171], v[232:235]
M v[228:231], a[40:43], a[168:171], v[228:231]
M v[228:231], a[44:47], a[172:175], v[228:231]
 s_waitcnt lgkmcnt(0)
M v[224:227], a[36:39], a[172:175], v[224:227]
M v[224:227], a[32:35], a[168:171], v[224:227]
M a[0:3], a[96:99], a[160:163], a[0:3]
 ds_read_b128 a[168:171], v5 offset:34816
 ds_read_b128 a[172:175], v6 offset:34816
M a[0:3], a[100:103], a[164:167], a[0:3]
 ds_read_b64_tr_b16 a[32:33], v1 offset:0
 ds_read_b64_tr_b16 a[34:35], v1 offset:1024
M a[4:7], a[108:111], a[164:167], a[4:7]
 s_add_u32 m0, s24, 16384
 v_cmp_le_u32 vcc, 0x40000000, v17
 v_and_b32 v17, 0xffff, v17
M a[4:7], a[104:107], a[160:163], a[4:7]
 buffer_load_dwordx4 v12, s[48:51], s22 offen offset:0   lds
M a[8:11], a[112:115], a[160:163], a[8:11]
 s_nop 0
M a[8:11], a[116:119], a[164:167], a[8:11]
 s_and_b32 s101, vcc_lo, 0xff
 v_add_u32 v17, v17, v17 row_ror:8 row_mask:0xf bank_mask:0xf
 s_nop 1
 v_add_u32 v17, v17, v17 row_ror:4 row_mask:0xf bank_mask:0xf
M a[12:15], a[124:127], a[164:167], a[12:15]
 ds_read_b64_tr_b16 a[36:37], v1 offset:8192
 ds_read_b64_tr_b16 a[38:39], v1 offset:9216
M a[12:15], a[120:123], a[160:163], a[12:15]
 v_add_u32 v17, v17, v17 row_ror:2 row_mask:0xf bank_mask:0xf
 s_nop 1
 v_add_u32 v17, v17, v17 row_ror:1 row_mask:0xf bank_mask:0xf
M a[16:19], a[128:131], a[160:163], a[16:19]
 buffer_load_dwordx4 v13, s[48:51], s22 offen offset:1024   lds
M a[16:19], a[132:135], a[164:167], a[16:19]
 v_cmp_lt_u32 vcc, 262144, v17
M a[20:23], a[140:143], a[164:167], a[20:23]
 s_nop 0
M a[20:23], a[136:139], a[160:163], a[20:23]
 s_nop 0
 ds_read_b64_tr_b16 a[40:41], v2 offset:0
 ds_read_b64_tr_b16 a[42:43], v2 offset:1024
M a[24:27], a[144:147], a[160:163], a[24:27]
 s_and_b32 s92, vcc_lo, 1
 s_mul_i32 s92, s92, 0xff
 s_xor_b32 s101, s101, s92
M a[24:27], a[148:151], a[164:167], a[24:27]
 s_waitcnt lgkmcnt(6)
M a[28:31], a[156:159], a[164:167], a[28:31]
 buffer_load_dwordx4 v14, s[48:51], s22 offen offset:2048   lds
M a[28:31], a[152:155], a[160:163], a[28:31]
M v[60:63], a[152:155], a[168:171], v[60:63]
 ds_read_b128 a[160:163], v5 offset:36864
 ds_read_b128 a[164:167], v6 offset:36864
M v[60:63], a[156:159], a[172:175], v[60:63]
 ds_read_b64_tr_b16 a[44:45], v2 offset:8192
 ds_read_b64_tr_b16 a[46:47], v2 offset:9216
M v[56:59], a[148:151], a[172:175], v[56:59]
 buffer_load_dwordx4 v15, s[48:51], s22 offen offset:3072   lds
M v[56:59], a[144:147], a[168:171], v[56:59]
 s_sub_u32 s22, s22, 2097024
M v[52:55], a[136:139], a[168:171], v[52:55]
M v[52:55], a[140:143], a[172:175], v[52:55]
 ds_read_b64_tr_b16 a[48:49], v3 offset:0
 ds_read_b64_tr_b16 a[50:51], v3 offset:1024
M v[48:51], a[132:135], a[172:175], v[48:51]
 s_add_u32 m0, s23, 49152
M v[48:51], a[128:131], a[168:171], v[48:51]
 buffer_load_dwordx4 v8, s[16:19], s21 offen offset:0  nt lds
M v[44:47], a[120:123], a[168:171], v[44:47]
M v[44:47], a[124:127], a[172:175], v[44:47]
M v[40:43], a[116:119], a[172:175], v[40:43]
 ds_read_b64_tr_b16 a[52:53], v3 offset:8192
 ds_read_b64_tr_b16 a[54:55], v3 offset:9216
M v[40:43], a[112:115], a[168:171], v[40:43]
M v[36:39], a[104:107], a[168:171], v[36:39]
 buffer_load_dwordx4 v9, s[16:19], s21 offen offset:1024  nt lds
M v[36:39], a[108:111], a[172:175], v[36:39]
 s_waitcnt lgkmcnt(6)
M v[32:35], a[100:103], a[172:175], v[32:35]
M v[32:35], a[96:99], a[168:171], v[32:35]
 ds_read_b64_tr_b16 a[56:57], v4 offset:0
 ds_read_b64_tr_b16 a[58:59], v4 offset:1024
M v[64:67], a[96:99], a[160:163], v[64:67]
 ds_read_b128 a[168:171], v5 offset:38912
 ds_read_b128 a[172:175], v6 offset:38912
M v[64:67], a[100:103], a[164:167], v[64:67]
 buffer_load_dwordx4 v10, s[16:19], s21 offen offset:2048  nt lds
M v[68:71], a[108:111], a[164:167], v[68:71]
M v[68:71], a[104:107], a[160:163], v[68:71]
M v[72:75], a[112:115], a[160:163], v[72:75]
 ds_read_b64_tr_b16 a[60:61], v4 offset:8192
 ds_read_b64_tr_b16 a[62:63], v4 offset:9216
M v[72:75], a[116:119], a[164:167], v[72:75]
M v[76:79], a[124:127], a[164:167], v[76:79]
 buffer_load_dwordx4 v11, s[16:19], s21 offen offset:3072  nt lds
M v[76:79], a[120:123], a[160:163], v[76:79]
 s_add_u32 s21, s21, 524160
M v[80:83], a[128:131], a[160:163], v[80:83]
M v[80:83], a[132:135], a[164:167], v[80:83]
M v[84:87], a[140:143], a[164:167], v[84:87]
M v[84:87], a[136:139], a[160:163], v[84:87]
 s_and_b32 s64, s42, 7
M v[88:91], a[144:147], a[160:163], v[88:91]
 s_lshl_b32 s72, s41, 3
 s_add_u32 s64, s64, s72
 s_lshl_b32 s64, s64, 2
M v[88:91], a[148:151], a[164:167], v[88:91]
 s_waitcnt lgkmcnt(2)
 s_add_u32 s64, s64, s20
 s_mul_i32 s67, s64, 7168
M v[92:95], a[156:159], a[164:167], v[92:95]
 s_waitcnt vmcnt(17) lgkmcnt(0)
 s_mul_i32 s86, s20, 7168
 s_add_u32 s86, s86, 131072
M v[92:95], a[152:155], a[160:163], v[92:95]
 s_barrier
M v[124:127], a[152:155], a[168:171], v[124:127]
 ds_read_b128 a[160:163], v5 offset:49152
 ds_read_b128 a[164:167], v6 offset:49152
M v[124:127], a[156:159], a[172:175], v[124:127]
M v[120:123], a[148:151], a[172:175], v[120:123]
 s_add_u32 m0, s24, 32768
 ds_read_b64_tr_b16 a[64:65], v1 offset:16384
 ds_read_b64_tr_b16 a[66:67], v1 offset:17408
M v[120:123], a[144:147], a[168:171], v[120:123]
 buffer_load_dwordx4 v12, s[48:51], s22 offen offset:0   lds
M v[116:119], a[136:139], a[168:171], v[116:119]
M v[116:119], a[140:143], a[172:175], v[116:119]
M v[112:115], a[132:135], a[172:175], v[112:115]
M v[112:115], a[128:131], a[168:171], v[112:115]
 buffer_load_dwordx4 v13, s[48:51], s22 offen offset:1024   lds
M v[108:111], a[120:123], a[168:171], v[108:111]
M v[108:111], a[124:127], a[172:175], v[108:111]
 ds_read_b64_tr_b16 a[68:69], v1 offset:24576
 ds_read_b64_tr_b16 a[70:71], v1 offset:25600
M v[104:107], a[116:119], a[172:175], v[104:107]
M v[104:107], a[112:115], a[168:171], v[104:107]
M v[100:103], a[104:107], a[168:171], v[100:103]
 buffer_load_dwordx4 v14, s[48:51], s22 offen offset:2048   lds
M v[100:103], a[108:111], a[172:175], v[100:103]
 s_waitcnt lgkmcnt(4)
M v[96:99], a[100:103], a[172:175], v[96:99]
M v[96:99], a[96:99], a[168:171], v[96:99]
M v[128:131], a[96:99], a[160:163], v[128:131]
 ds_read_b128 a[168:171], v5 offset:51200
 ds_read_b128 a[172:175], v6 offset:51200
M v[128:131], a[100:103], a[164:167], v[128:131]
 ds_read_b64_tr_b16 a[72:73], v2 offset:16384
 ds_read_b64_tr_b16 a[74:75], v2 offset:17408
M v[132:135], a[108:111], a[164:167], v[132:135]
 buffer_load_dwordx4 v15, s[48:51], s22 offen offset:3072   lds
M v[132:135], a[104:107], a[160:163], v[132:135]
 s_add_u32 s22, s22, 2097152
M v[136:139], a[112:115], a[160:163], v[136:139]
M v[136:139], a[116:119], a[164:167], v[136:139]
 s_add_u32 m0, s23, 0
M v[140:143], a[124:127], a[164:167], v[140:143]
 buffer_load_dwordx4 v8, s[16:19], s21 offen offset:0  nt lds
M v[140:143], a[120:123], a[160:163], v[140:143]
 ds_read_b64_tr_b16 a[76:77], v2 offset:24576
 ds_read_b64_tr_b16 a[78:79], v2 offset:25600
M v[144:147], a[128:131], a[160:163], v[144:147]
M v[144:147], a[132:135], a[164:167], v[144:147]
M v[148:151], a[140:143], a[164:167], v[148:151]
 buffer_load_dwordx4 v9, s[16:19], s21 offen offset:1024  nt lds
M v[148:151], a[136:139], a[160:163], v[148:151]
M v[152:155], a[144:147], a[160:163], v[152:155]
M v[152:155], a[148:151], a[164:167], v[152:155]
 s_waitcnt lgkmcnt(4)
M v[156:159], a[156:159], a[164:167], v[156:159]
 ds_read_b64_tr_b16 a[80:81], v3 offset:16384
 ds_read_b64_tr_b16 a[82:83], v3 offset:17408
M v[156:159], a[152:155], a[160:163], v[156:159]
 buffer_load_dwordx4 v10, s[16:19], s21 offen offset:2048  nt lds
M v[188:191], a[152:155], a[168:171], v[188:191]
 ds_read_b128 a[160:163], v5 offset:53248
 ds_read_b128 a[164:167], v6 offset:53248
M v[188:191], a[156:159], a[172:175], v[188:191]
M v[184:187], a[148:151], a[172:175], v[184:187]
M v[184:187], a[144:147], a[168:171], v[184:187]
M v[180:183], a[136:139], a[168:171], v[180:183]
 buffer_load_dwordx4 v11, s[16:19], s21 offen offset:3072  nt lds
M v[180:183], a[140:143], a[172:175], v[180:183]
 s_add_u32 s21, s21, 128
 ds_read_b64_tr_b16 a[84:85], v3 offset:24576
 ds_read_b64_tr_b16 a[86:87], v3 offset:25600
M v[176:179], a[132:135], a[172:175], v[176:179]
M v[176:179], a[128:131], a[168:171], v[176:179]
M v[172:175], a[120:123], a[168:171], v[172:175]
 s_add_u32 m0, s86, 0
M v[172:175], a[124:127], a[172:175], v[172:175]
 buffer_load_dwordx4 v7, s[60:63], s67 offen offset:0 nt lds
M v[168:171], a[116:119], a[172:175], v[168:171]
M v[168:171], a[112:115], a[168:171], v[168:171]
M v[164:167], a[104:107], a[168:171], v[164:167]
 ds_read_b64_tr_b16 a[88:89], v4 offset:16384
 ds_read_b64_tr_b16 a[90:91], v4 offset:17408
M v[164:167], a[108:111], a[172:175], v[164:167]
 s_waitcnt lgkmcnt(4)
M v[160:163], a[100:103], a[172:175], v[160:163]
 buffer_load_dwordx4 v7, s[60:63], s67 offen offset:1024 nt lds
M v[160:163], a[96:99], a[168:171], v[160:163]
M v[192:195], a[96:99], a[160:163], v[192:195]
 ds_read_b128 a[168:171], v5 offset:55296
 ds_read_b128 a[172:175], v6 offset:55296
M v[192:195], a[100:103], a[164:167], v[192:195]
M v[196:199], a[108:111], a[164:167], v[196:199]
 buffer_load_dwordx4 v7, s[60:63], s67 offen offset:2048 nt lds
M v[196:199], a[104:107], a[160:163], v[196:199]
 ds_read_b64_tr_b16 a[92:93], v4 offset:24576
 ds_read_b64_tr_b16 a[94:95], v4 offset:25600
M v[200:203], a[112:115], a[160:163], v[200:203]
M v[200:203], a[116:119], a[164:167], v[200:203]
M v[204:207], a[124:127], a[164:167], v[204:207]
M v[204:207], a[120:123], a[160:163], v[204:207]
 buffer_load_dwordx4 v7, s[60:63], s67 offen offset:3072 nt lds
M v[208:211], a[128:131], a[160:163], v[208:211]
 s_add_u32 s67, s67, 4096
M v[208:211], a[132:135], a[164:167], v[208:211]
M v[212:215], a[140:143], a[164:167], v[212:215]
M v[212:215], a[136:139], a[160:163], v[212:215]
M v[216:219], a[144:147], a[160:163], v[216:219]
M v[216:219], a[148:151], a[164:167], v[216:219]
 s_waitcnt lgkmcnt(2)
M v[220:223], a[156:159], a[164:167], v[220:223]
 s_waitcnt vmcnt(21) lgkmcnt(0)
M v[220:223], a[152:155], a[160:163], v[220:223]
 s_barrier
M v[252:255], a[152:155], a[168:171], v[252:255]
 ds_read_b128 a[160:163], v5 offset:0
 ds_read_b128 a[164:167], v6 offset:0
M v[252:255], a[156:159], a[172:175], v[252:255]
M v[248:251], a[148:151], a[172:175], v[248:251]
M v[248:251], a[144:147], a[168:171], v[248:251]
M v[244:247], a[136:139], a[168:171], v[244:247]
M v[244:247], a[140:143], a[172:175], v[244:247]
M v[240:243], a[132:135], a[172:175], v[240:243]
M v[240:243], a[128:131], a[168:171], v[240:243]
M v[236:239], a[120:123], a[168:171], v[236:239]
M v[236:239], a[124:127], a[172:175], v[236:239]
M v[232:235], a[116:119], a[172:175], v[232:235]
M v[232:235], a[112:115], a[168:171], v[232:235]
M v[228:231], a[104:107], a[168:171], v[228:231]
M v[228:231], a[108:111], a[172:175], v[228:231]
 s_waitcnt lgkmcnt(0)
M v[224:227], a[100:103], a[172:175], v[224:227]
M v[224:227], a[96:99], a[168:171], v[224:227]
M a[0:3], a[32:35], a[160:163], a[0:3]
 ds_read_b128 a[168:171], v5 offset:2048
 ds_read_b128 a[172:175], v6 offset:2048
M a[0:3], a[36:39], a[164:167], a[0:3]
 ds_read_b64_tr_b16 a[96:97], v1 offset:32768
 ds_read_b64_tr_b16 a[98:99], v1 offset:33792
M a[4:7], a[44:47], a[164:167], a[4:7]
 s_add_u32 m0, s24, 49152
M a[4:7], a[40:43], a[160:163], a[4:7]
 buffer_load_dwordx4 v12, s[48:51], s22 offen offset:0   lds
M a[8:11], a[48:51], a[160:163], a[8:11]
M a[8:11], a[52:55], a[164:167], a[8:11]
M a[12:15], a[60:63], a[164:167], a[12:15]
 ds_read_b64_tr_b16 a[100:101], v1 offset:40960
 ds_read_b64_tr_b16 a[102:103], v1 offset:41984
M a[12:15], a[56:59], a[160:163], a[12:15]
M a[16:19], a[64:67], a[160:163], a[16:19]
 buffer_load_dwordx4 v13, s[48:51], s22 offen offset:1024   lds
M a[16:19], a[68:71], a[164:167], a[16:19]
M a[20:23], a[76:79], a[164:167], a[20:23]
M a[20:23], a[72:75], a[160:163], a[20:23]
 ds_read_b64_tr_b16 a[104:105], v2 offset:32768
 ds_read_b64_tr_b16 a[106:107], v2 offset:33792
M a[24:27], a[80:83], a[160:163], a[24:27]
M a[24:27], a[84:87], a[164:167], a[24:27]
 s_waitcnt lgkmcnt(6)
M a[28:31], a[92:95], a[164:167], a[28:31]
 buffer_load_dwordx4 v14, s[48:51], s22 offen offset:2048   lds
M a[28:31], a[88:91], a[160:163], a[28:31]
M v[60:63], a[88:91], a[168:171], v[60:63]
 ds_read_b128 a[160:163], v5 offset:4096
 ds_read_b128 a[164:167], v6 offset:4096
M v[60:63], a[92:95], a[172:175], v[60:63]
 ds_read_b64_tr_b16 a[108:109], v2 offset:40960
 ds_read_b64_tr_b16 a[110:111], v2 offset:41984
M v[56:59], a[84:87], a[172:175], v[56:59]
 buffer_load_dwordx4 v15, s[48:51], s22 offen offset:3072   lds
M v[56:59], a[80:83], a[168:171], v[56:59]
 s_sub_u32 s22, s22, 2097024
M v[52:55], a[72:75], a[168:171], v[52:55]
M v[52:55], a[76:79], a[172:175], v[52:55]
 ds_read_b64_tr_b16 a[112:113], v3 offset:32768
 ds_read_b64_tr_b16 a[114:115], v3 offset:33792
M v[48:51], a[68:71], a[172:175], v[48:51]
 s_add_u32 m0, s23, 16384
M v[48:51], a[64:67], a[168:171], v[48:51]
 buffer_load_dwordx4 v8, s[16:19], s21 offen offset:0  nt lds
M v[44:47], a[56:59], a[168:171], v[44:47]
M v[44:47], a[60:63], a[172:175], v[44:47]
M v[40:43], a[52:55], a[172:175], v[40:43]
 ds_read_b64_tr_b16 a[116:117], v3 offset:40960
 ds_read_b64_tr_b16 a[118:119], v3 offset:41984
M v[40:43], a[48:51], a[168:171], v[40:43]
M v[36:39], a[40:43], a[168:171], v[36:39]
 buffer_load_dwordx4 v9, s[16:19], s21 offen offset:1024  nt lds
M v[36:39], a[44:47], a[172:175], v[36:39]
 s_waitcnt lgkmcnt(6)
M v[32:35], a[36:39], a[172:175], v[32:35]
M v[32:35], a[32:35], a[168:171], v[32:35]
 ds_read_b64_tr_b16 a[120:121], v4 offset:32768
 ds_read_b64_tr_b16 a[122:123], v4 offset:33792
M v[64:67], a[32:35], a[160:163], v[64:67]
 ds_read_b128 a[168:171], v5 offset:6144
 ds_read_b128 a[172:175], v6 offset:6144
M v[64:67], a[36:39], a[164:167], v[64:67]
 buffer_load_dwordx4 v10, s[16:19], s21 offen offset:2048  nt lds
M v[68:71], a[44:47], a[164:167], v[68:71]
M v[68:71], a[40:43], a[160:163], v[68:71]
M v[72:75], a[48:51], a[160:163], v[72:75]
 ds_read_b64_tr_b16 a[124:125], v4 offset:40960
 ds_read_b64_tr_b16 a[126:127], v4 offset:41984
M v[72:75], a[52:55], a[164:167], v[72:75]
M v[76:79], a[60:63], a[164:167], v[76:79]
 buffer_load_dwordx4 v11, s[16:19], s21 offen offset:3072  nt lds
M v[76:79], a[56:59], a[160:163], v[76:79]
 s_add_u32 s21, s21, 524160
M v[80:83], a[64:67], a[160:163], v[80:83]
M v[80:83], a[68:71], a[164:167], v[80:83]
M v[84:87], a[76:79], a[164:167], v[84:87]
M v[84:87], a[72:75], a[160:163], v[84:87]
M v[88:91], a[80:83], a[160:163], v[88:91]
M v[88:91], a[84:87], a[164:167], v[88:91]
 s_waitcnt lgkmcnt(2)
M v[92:95], a[92:95], a[164:167], v[92:95]
 s_waitcnt vmcnt(20) lgkmcnt(0)
M v[92:95], a[88:91], a[160:163], v[92:95]
 s_barrier
M v[124:127], a[88:91], a[168:171], v[124:127]
 ds_read_b128 a[160:163], v5 offset:16384
 ds_read_b128 a[164:167], v6 offset:16384
M v[124:127], a[92:95], a[172:175], v[124:127]
M v[120:123], a[84:87], a[172:175], v[120:123]
 s_add_u32 m0, s24, 0
 ds_read_b64_tr_b16 a[128:129], v1 offset:49152
 ds_read_b64_tr_b16 a[130:131], v1 offset:50176
M v[120:123], a[80:83], a[168:171], v[120:123]
 buffer_load_dwordx4 v12, s[48:51], s22 offen offset:0   lds
M v[116:119], a[72:75], a[168:171], v[116:119]
M v[116:119], a[76:79], a[172:175], v[116:119]
M v[112:115], a[68:71], a[172:175], v[112:115]
M v[112:115], a[64:67], a[168:171], v[112:115]
M v[108:111], a[56:59], a[168:171], v[108:111]
 buffer_load_dwordx4 v13, s[48:51], s22 offen offset:1024   lds
M v[108:111], a[60:63], a[172:175], v[108:111]
 ds_read_b64_tr_b16 a[132:133], v1 offset:57344
 ds_read_b64_tr_b16 a[134:135], v1 offset:58368
M v[104:107], a[52:55], a[172:175], v[104:107]
M v[104:107], a[48:51], a[168:171], v[104:107]
M v[100:103], a[40:43], a[168:171], v[100:103]
M v[100:103], a[44:47], a[172:175], v[100:103]
 s_waitcnt lgkmcnt(4)
M v[96:99], a[36:39], a[172:175], v[96:99]
 buffer_load_dwordx4 v14, s[48:51], s22 offen offset:2048   lds
M v[96:99], a[32:35], a[168:171], v[96:99]
M v[128:131], a[32:35], a[160:163], v[128:131]
 ds_read_b128 a[168:171], v5 offset:18432
 ds_read_b128 a[172:175], v6 offset:18432
M v[128:131], a[36:39], a[164:167], v[128:131]
 ds_read_b64_tr_b16 a[136:137], v2 offset:49152
 ds_read_b64_tr_b16 a[138:139], v2 offset:50176
M v[132:135], a[44:47], a[164:167], v[132:135]
 buffer_load_dwordx4 v15, s[48:51], s22 offen offset:3072   lds
M v[132:135], a[40:43], a[160:163], v[132:135]
 s_add_u32 s22, s22, 2097152
M v[136:139], a[48:51], a[160:163], v[136:139]
M v[136:139], a[52:55], a[164:167], v[136:139]
M v[140:143], a[60:63], a[164:167], v[140:143]
 s_add_u32 m0, s23, 32768
M v[140:143], a[56:59], a[160:163], v[140:143]
 ds_read_b64_tr_b16 a[140:141], v2 offset:57344
 ds_read_b64_tr_b16 a[142:143], v2 offset:58368
M v[144:147], a[64:67], a[160:163], v[144:147]
 buffer_load_dwordx4 v8, s[16:19], s21 offen offset:0  nt lds
M v[144:147], a[68:71], a[164:167], v[144:147]
M v[148:151], a[76:79], a[164:167], v[148:151]
M v[148:151], a[72:75], a[160:163], v[148:151]
M v[152:155], a[80:83], a[160:163], v[152:155]
 buffer_load_dwordx4 v9, s[16:19], s21 offen offset:1024  nt lds
M v[152:155], a[84:87], a[164:167], v[152:155]
 s_waitcnt lgkmcnt(4)
M v[156:159], a[92:95], a[164:167], v[156:159]
 ds_read_b64_tr_b16 a[144:145], v3 offset:49152
 ds_read_b64_tr_b16 a[146:147], v3 offset:50176
M v[156:159], a[88:91], a[160:163], v[156:159]
M v[188:191], a[88:91], a[168:171], v[188:191]
 ds_read_b128 a[160:163], v5 offset:20480
 ds_read_b128 a[164:167], v6 offset:20480
M v[188:191], a[92:95], a[172:175], v[188:191]
M v[184:187], a[84:87], a[172:175], v[184:187]
 buffer_load_dwordx4 v10, s[16:19], s21 offen offset:2048  nt lds
M v[184:187], a[80:83], a[168:171], v[184:187]
M v[180:183], a[72:75], a[168:171], v[180:183]
M v[180:183], a[76:79], a[172:175], v[180:183]
 ds_read_b64_tr_b16 a[148:149], v3 offset:57344
 ds_read_b64_tr_b16 a[150:151], v3 offset:58368
M v[176:179], a[68:71], a[172:175], v[176:179]
M v[176:179], a[64:67], a[168:171], v[176:179]
 buffer_load_dwordx4 v11, s[16:19], s21 offen offset:3072  nt lds
M v[172:175], a[56:59], a[168:171], v[172:175]
 s_add_u32 s21, s21, 128
M v[172:175], a[60:63], a[172:175], v[172:175]
M v[168:171], a[52:55], a[172:175], v[168:171]
M v[168:171], a[48:51], a[168:171], v[168:171]
 s_add_u32 m0, s86, 4096
M v[164:167], a[40:43], a[168:171], v[164:167]
 ds_read_b64_tr_b16 a[152:153], v4 offset:49152
 ds_read_b64_tr_b16 a[154:155], v4 offset:50176
M v[164:167], a[44:47], a[172:175], v[164:167]
 s_waitcnt lgkmcnt(4)
M v[160:163], a[36:39], a[172:175], v[160:163]
 buffer_load_dwordx4 v7, s[60:63], s67 offen offset:0 nt lds
M v[160:163], a[32:35], a[168:171], v[160:163]
M v[192:195], a[32:35], a[160:163], v[192:195]
 ds_read_b128 a[168:171], v5 offset:22528
 ds_read_b128 a[172:175], v6 offset:22528
M v[192:195], a[36:39], a[164:167], v[192:195]
 buffer_load_dwordx4 v7, s[60:63], s67 offen offset:1024 nt lds
M v[196:199], a[44:47], a[164:167], v[196:199]
M v[196:199], a[40:43], a[160:163], v[196:199]
 ds_read_b64_tr_b16 a[156:157], v4 offset:57344
 ds_read_b64_tr_b16 a[158:159], v4 offset:58368
M v[200:203], a[48:51], a[160:163], v[200:203]
M v[200:203], a[52:55], a[164:167], v[200:203]
M v[204:207], a[60:63], a[164:167], v[204:207]
 buffer_load_dwordx4 v7, s[60:63], s67 offen offset:2048 nt lds
M v[204:207], a[56:59], a[160:163], v[204:207]
 s_add_u32 s67, s67, 4096
M v[208:211], a[64:67], a[160:163], v[208:211]
M v[208:211], a[68:71], a[164:167], v[208:211]
M v[212:215], a[76:79], a[164:167], v[212:215]
M v[212:215], a[72:75], a[160:163], v[212:215]
M v[216:219], a[80:83], a[160:163], v[216:219]
M v[216:219], a[84:87], a[164:167], v[216:219]
 s_waitcnt lgkmcnt(2)
M v[220:223], a[92:95], a[164:167], v[220:223]
 s_waitcnt vmcnt(23) lgkmcnt(0)
M v[220:223], a[88:91], a[160:163], v[220:223]
 s_barrier
M v[252:255], a[88:91], a[168:171], v[252:255]
 ds_read_b128 a[160:163], v5 offset:32768
 ds_read_b128 a[164:167], v6 offset:32768
M v[252:255], a[92:95], a[172:175], v[252:255]
 v_and_b32 v26, 48, v0
 v_lshlrev_b32 v26, 17, v26
M v[248:251], a[84:87], a[172:175], v[248:251]
 v_or_b32 v26, v26, v0
 v_lshl_add_u32 v26, v26, 7, s95
M v[248:251], a[80:83], a[168:171], v[248:251]
 buffer_load_dword a240, v26, s[76:79], 0 offen offset:0
M v[244:247], a[72:75], a[168:171], v[244:247]
M v[244:247], a[76:79], a[172:175], v[244:247]
M v[240:243], a[68:71], a[172:175], v[240:243]
M v[240:243], a[64:67], a[168:171], v[240:243]
M v[236:239], a[56:59], a[168:171], v[236:239]
M v[236:239], a[60:63], a[172:175], v[236:239]
M v[232:235], a[52:55], a[172:175], v[232:235]
M v[232:235], a[48:51], a[168:171], v[232:235]
M v[228:231], a[40:43], a[168:171], v[228:231]
M v[228:231], a[44:47], a[172:175], v[228:231]
 s_waitcnt lgkmcnt(0)
M v[224:227], a[36:39], a[172:175], v[224:227]
M v[224:227], a[32:35], a[168:171], v[224:227]
M a[0:3], a[96:99], a[160:163], a[0:3]
 ds_read_b128 a[168:171], v5 offset:34816
 ds_read_b128 a[172:175], v6 offset:34816
M a[0:3], a[100:103], a[164:167], a[0:3]
 ds_read_b64_tr_b16 a[32:33], v1 offset:0
 ds_read_b64_tr_b16 a[34:35], v1 offset:1024
M a[4:7], a[108:111], a[164:167], a[4:7]
 s_add_u32 m0, s24, 16384
M a[4:7], a[104:107], a[160:163], a[4:7]
 buffer_load_dwordx4 v12, s[48:51], s22 offen offset:0   lds
M a[8:11], a[112:115], a[160:163], a[8:11]
M a[8:11], a[116:119], a[164:167], a[8:11]
M a[12:15], a[124:127], a[164:167], a[12:15]
 ds_read_b64_tr_b16 a[36:37], v1 offset:8192
 ds_read_b64_tr_b16 a[38:39], v1 offset:9216
M a[12:15], a[120:123], a[160:163], a[12:15]
M a[16:19], a[128:131], a[160:163], a[16:19]
 buffer_load_dwordx4 v13, s[48:51], s22 offen offset:1024   lds
M a[16:19], a[132:135], a[164:167], a[16:19]
M a[20:23], a[140:143], a[164:167], a[20:23]
M a[20:23], a[136:139], a[160:163], a[20:23]
 ds_read_b64_tr_b16 a[40:41], v2 offset:0
 ds_read_b64_tr_b16 a[42:43], v2 offset:1024
M a[24:27], a[144:147], a[160:163], a[24:27]
M a[24:27], a[148:151], a[164:167], a[24:27]
 s_waitcnt lgkmcnt(6)
M a[28:31], a[156:159], a[164:167], a[28:31]
 buffer_load_dwordx4 v14, s[48:51], s22 offen offset:2048   lds
M a[28:31], a[152:155], a[160:163], a[28:31]
M v[60:63], a[152:155], a[168:171], v[60:63]
 ds_read_b128 a[160:163], v5 offset:36864
 ds_read_b128 a[164:167], v6 offset:36864
M v[60:63], a[156:159], a[172:175], v[60:63]
 ds_read_b64_tr_b16 a[44:45], v2 offset:8192
 ds_read_b64_tr_b16 a[46:47], v2 offset:9216
M v[56:59], a[148:151], a[172:175], v[56:59]
 buffer_load_dwordx4 v15, s[48:51], s22 offen offset:3072   lds
M v[56:59], a[144:147], a[168:171], v[56:59]
 s_sub_u32 s22, s22, 2097024
M v[52:55], a[136:139], a[168:171], v[52:55]
M v[52:55], a[140:143], a[172:175], v[52:55]
 ds_read_b64_tr_b16 a[48:49], v3 offset:0
 ds_read_b64_tr_b16 a[50:51], v3 offset:1024
M v[48:51], a[132:135], a[172:175], v[48:51]
 s_add_u32 m0, s23, 49152
M v[48:51], a[128:131], a[168:171], v[48:51]
 buffer_load_dwordx4 v8, s[16:19], s21 offen offset:0  nt lds
M v[44:47], a[120:123], a[168:171], v[44:47]
M v[44:47], a[124:127], a[172:175], v[44:47]
M v[40:43], a[116:119], a[172:175], v[40:43]
 ds_read_b64_tr_b16 a[52:53], v3 offset:8192
 ds_read_b64_tr_b16 a[54:55], v3 offset:9216
M v[40:43], a[112:115], a[168:171], v[40:43]
M v[36:39], a[104:107], a[168:171], v[36:39]
 buffer_load_dwordx4 v9, s[16:19], s21 offen offset:1024  nt lds
M v[36:39], a[108:111], a[172:175], v[36:39]
 s_waitcnt lgkmcnt(6)
M v[32:35], a[100:103], a[172:175], v[32:35]
M v[32:35], a[96:99], a[168:171], v[32:35]
 ds_read_b64_tr_b16 a[56:57], v4 offset:0
 ds_read_b64_tr_b16 a[58:59], v4 offset:1024
M v[64:67], a[96:99], a[160:163], v[64:67]
 ds_read_b128 a[168:171], v5 offset:38912
 ds_read_b128 a[172:175], v6 offset:38912
M v[64:67], a[100:103], a[164:167], v[64:67]
 buffer_load_dwordx4 v10, s[16:19], s21 offen offset:2048  nt lds
M v[68:71], a[108:111], a[164:167], v[68:71]
M v[68:71], a[104:107], a[160:163], v[68:71]
M v[72:75], a[112:115], a[160:163], v[72:75]
 ds_read_b64_tr_b16 a[60:61], v4 offset:8192
 ds_read_b64_tr_b16 a[62:63], v4 offset:9216
M v[72:75], a[116:119], a[164:167], v[72:75]
M v[76:79], a[124:127], a[164:167], v[76:79]
 buffer_load_dwordx4 v11, s[16:19], s21 offen offset:3072  nt lds
M v[76:79], a[120:123], a[160:163], v[76:79]
 s_add_u32 s21, s21, 524160
M v[80:83], a[128:131], a[160:163], v[80:83]
M v[80:83], a[132:135], a[164:167], v[80:83]
M v[84:87], a[140:143], a[164:167], v[84:87]
M v[84:87], a[136:139], a[160:163], v[84:87]
M v[88:91], a[144:147], a[160:163], v[88:91]
M v[88:91], a[148:151], a[164:167], v[88:91]
 s_waitcnt lgkmcnt(2)
M v[92:95], a[156:159], a[164:167], v[92:95]
 s_waitcnt vmcnt(20) lgkmcnt(0)
M v[92:95], a[152:155], a[160:163], v[92:95]
 s_barrier
M v[124:127], a[152:155], a[168:171], v[124:127]
 ds_read_b128 a[160:163], v5 offset:49152
 ds_read_b128 a[164:167], v6 offset:49152
M v[124:127], a[156:159], a[172:175], v[124:127]
M v[120:123], a[148:151], a[172:175], v[120:123]
 s_add_u32 m0, s24, 32768
 ds_read_b64_tr_b16 a[64:65], v1 offset:16384
 ds_read_b64_tr_b16 a[66:67], v1 offset:17408
M v[120:123], a[144:147], a[168:171], v[120:123]
 buffer_load_dwordx4 v12, s[48:51], s22 offen offset:0   lds
M v[116:119], a[136:139], a[168:171], v[116:119]
M v[116:119], a[140:143], a[172:175], v[116:119]
M v[112:115], a[132:135], a[172:175], v[112:115]
M v[112:115], a[128:131], a[168:171], v[112:115]
M v[108:111], a[120:123], a[168:171], v[108:111]
M v[108:111], a[124:127], a[172:175], v[108:111]
 ds_read_b64_tr_b16 a[68:69], v1 offset:24576
 ds_read_b64_tr_b16 a[70:71], v1 offset:25600
M v[104:107], a[116:119], a[172:175], v[104:107]
 buffer_load_dwordx4 v13, s[48:51], s22 offen offset:1024   lds
M v[104:107], a[112:115], a[168:171], v[104:107]
M v[100:103], a[104:107], a[168:171], v[100:103]
M v[100:103], a[108:111], a[172:175], v[100:103]
 s_waitcnt lgkmcnt(4)
M v[96:99], a[100:103], a[172:175], v[96:99]
M v[96:99], a[96:99], a[168:171], v[96:99]
M v[128:131], a[96:99], a[160:163], v[128:131]
 ds_read_b128 a[168:171], v5 offset:51200
 ds_read_b128 a[172:175], v6 offset:51200
M v[128:131], a[100:103], a[164:167], v[128:131]
 ds_read_b64_tr_b16 a[72:73], v2 offset:16384
 ds_read_b64_tr_b16 a[74:75], v2 offset:17408
M v[132:135], a[108:111], a[164:167], v[132:135]
 buffer_load_dwordx4 v14, s[48:51], s22 offen offset:2048   lds
M v[132:135], a[104:107], a[160:163], v[132:135]
M v[136:139], a[112:115], a[160:163], v[136:139]
M v[136:139], a[116:119], a[164:167], v[136:139]
M v[140:143], a[124:127], a[164:167], v[140:143]
M v[140:143], a[120:123], a[160:163], v[140:143]
 ds_read_b64_tr_b16 a[76:77], v2 offset:24576
 ds_read_b64_tr_b16 a[78:79], v2 offset:25600
M v[144:147], a[128:131], a[160:163], v[144:147]
 buffer_load_dwordx4 v15, s[48:51], s22 offen offset:3072   lds
M v[144:147], a[132:135], a[164:167], v[144:147]
 s_add_u32 s22, s22, 2097152
M v[148:151], a[140:143], a[164:167], v[148:151]
M v[148:151], a[136:139], a[160:163], v[148:151]
M v[152:155], a[144:147], a[160:163], v[152:155]
M v[152:155], a[148:151], a[164:167], v[152:155]
 s_waitcnt lgkmcnt(4)
M v[156:159], a[156:159], a[164:167], v[156:159]
 s_add_u32 m0, s23, 0
 ds_read_b64_tr_b16 a[80:81], v3 offset:16384
 ds_read_b64_tr_b16 a[82:83], v3 offset:17408
M v[156:159], a[152:155], a[160:163], v[156:159]
 buffer_load_dwordx4 v8, s[16:19], s21 offen offset:0  nt lds
M v[188:191], a[152:155], a[168:171], v[188:191]
 ds_read_b128 a[160:163], v5 offset:53248
 ds_read_b128 a[164:167], v6 offset:53248
M v[188:191], a[156:159], a[172:175], v[188:191]
M v[184:187], a[148:151], a[172:175], v[184:187]
M v[184:187], a[144:147], a[168:171], v[184:187]
M v[180:183], a[136:139], a[168:171], v[180:183]
M v[180:183], a[140:143], a[172:175], v[180:183]
 ds_read_b64_tr_b16 a[84:85], v3 offset:24576
 ds_read_b64_tr_b16 a[86:87], v3 offset:25600
M v[176:179], a[132:135], a[172:175], v[176:179]
 buffer_load_dwordx4 v9, s[16:19], s21 offen offset:1024  nt lds
M v[176:179], a[128:131], a[168:171], v[176:179]
M v[172:175], a[120:123], a[168:171], v[172:175]
M v[172:175], a[124:127], a[172:175], v[172:175]
M v[168:171], a[116:119], a[172:175], v[168:171]
M v[168:171], a[112:115], a[168:171], v[168:171]
M v[164:167], a[104:107], a[168:171], v[164:167]
 ds_read_b64_tr_b16 a[88:89], v4 offset:16384
 ds_read_b64_tr_b16 a[90:91], v4 offset:17408
M v[164:167], a[108:111], a[172:175], v[164:167]
 s_waitcnt lgkmcnt(4)
M v[160:163], a[100:103], a[172:175], v[160:163]
 buffer_load_dwordx4 v10, s[16:19], s21 offen offset:2048  nt lds
M v[160:163], a[96:99], a[168:171], v[160:163]
M v[192:195], a[96:99], a[160:163], v[192:195]
 ds_read_b128 a[168:171], v5 offset:55296
 ds_read_b128 a[172:175], v6 offset:55296
M v[192:195], a[100:103], a[164:167], v[192:195]
M v[196:199], a[108:111], a[164:167], v[196:199]
M v[196:199], a[104:107], a[160:163], v[196:199]
 ds_read_b64_tr_b16 a[92:93], v4 offset:24576
 ds_read_b64_tr_b16 a[94:95], v4 offset:25600
M v[200:203], a[112:115], a[160:163], v[200:203]
 buffer_load_dwordx4 v11, s[16:19], s21 offen offset:3072  nt lds
M v[200:203], a[116:119], a[164:167], v[200:203]
 s_add_u32 s21, s21, 128
M v[204:207], a[124:127], a[164:167], v[204:207]
M v[204:207], a[120:123], a[160:163], v[204:207]
M v[208:211], a[128:131], a[160:163], v[208:211]
M v[208:211], a[132:135], a[164:167], v[208:211]
M v[212:215], a[140:143], a[164:167], v[212:215]
M v[212:215], a[136:139], a[160:163], v[212:215]
M v[216:219], a[144:147], a[160:163], v[216:219]
M v[216:219], a[148:151], a[164:167], v[216:219]
 s_waitcnt lgkmcnt(2)
M v[220:223], a[156:159], a[164:167], v[220:223]
 s_waitcnt vmcnt(17) lgkmcnt(0)
M v[220:223], a[152:155], a[160:163], v[220:223]
 s_barrier
M v[252:255], a[152:155], a[168:171], v[252:255]
 ds_read_b128 a[160:163], v5 offset:0
 ds_read_b128 a[164:167], v6 offset:0
M v[252:255], a[156:159], a[172:175], v[252:255]
M v[248:251], a[148:151], a[172:175], v[248:251]
M v[248:251], a[144:147], a[168:171], v[248:251]
M v[244:247], a[136:139], a[168:171], v[244:247]
M v[244:247], a[140:143], a[172:175], v[244:247]
M v[240:243], a[132:135], a[172:175], v[240:243]
M v[240:243], a[128:131], a[168:171], v[240:243]
M v[236:239], a[120:123], a[168:171], v[236:239]
M v[236:239], a[124:127], a[172:175], v[236:239]
M v[232:235], a[116:119], a[172:175], v[232:235]
M v[232:235], a[112:115], a[168:171], v[232:235]
M v[228:231], a[104:107], a[168:171], v[228:231]
M v[228:231], a[108:111], a[172:175], v[228:231]
 s_waitcnt lgkmcnt(0)
M v[224:227], a[100:103], a[172:175], v[224:227]
M v[224:227], a[96:99], a[168:171], v[224:227]
M a[0:3], a[32:35], a[160:163], a[0:3]
 ds_read_b128 a[168:171], v5 offset:2048
 ds_read_b128 a[172:175], v6 offset:2048
M a[0:3], a[36:39], a[164:167], a[0:3]
 ds_read_b64_tr_b16 a[96:97], v1 offset:32768
 ds_read_b64_tr_b16 a[98:99], v1 offset:33792
M a[4:7], a[44:47], a[164:167], a[4:7]
 s_add_u32 m0, s24, 49152
 v_lshrrev_b32 v28, 2, v0
M a[4:7], a[40:43], a[160:163], a[4:7]
 buffer_load_dwordx4 v12, s[48:51], s22 offen offset:0   lds
M a[8:11], a[48:51], a[160:163], a[8:11]
 v_mul_u32_u24 v28, 896, v28
M a[8:11], a[52:55], a[164:167], a[8:11]
M a[12:15], a[60:63], a[164:167], a[12:15]
 ds_read_b64_tr_b16 a[100:101], v1 offset:40960
 ds_read_b64_tr_b16 a[102:103], v1 offset:41984
M a[12:15], a[56:59], a[160:163], a[12:15]
 v_and_b32 v29, 3, v0
M a[16:19], a[64:67], a[160:163], a[16:19]
 buffer_load_dwordx4 v13, s[48:51], s22 offen offset:1024   lds
M a[16:19], a[68:71], a[164:167], a[16:19]
 v_lshl_add_u32 v28, v29, 4, v28
M a[20:23], a[76:79], a[164:167], a[20:23]
M a[20:23], a[72:75], a[160:163], a[20:23]
 s_lshr_b32 s64, s20, 1
 ds_read_b64_tr_b16 a[104:105], v2 offset:32768
 ds_read_b64_tr_b16 a[106:107], v2 offset:33792
M a[24:27], a[80:83], a[160:163], a[24:27]
 s_lshl_b32 s64, s64, 6
 s_and_b32 s72, s20, 1
 s_lshl_b32 s72, s72, 3
M a[24:27], a[84:87], a[164:167], a[24:27]
 s_waitcnt lgkmcnt(6)
 s_add_u32 s64, s64, s72
 s_add_u32 s64, s64, 131072
M a[28:31], a[92:95], a[164:167], a[28:31]
 buffer_load_dwordx4 v14, s[48:51], s22 offen offset:2048   lds
M a[28:31], a[88:91], a[160:163], a[28:31]
 v_add_u32 v28, s64, v28
M v[60:63], a[88:91], a[168:171], v[60:63]
 ds_read_b128 a[160:163], v5 offset:4096
 ds_read_b128 a[164:167], v6 offset:4096
M v[60:63], a[92:95], a[172:175], v[60:63]
 s_lshl_b32 s94, s27, 21
 ds_read_b64_tr_b16 a[108:109], v2 offset:40960
 ds_read_b64_tr_b16 a[110:111], v2 offset:41984
M v[56:59], a[84:87], a[172:175], v[56:59]
 buffer_load_dwordx4 v15, s[48:51], s22 offen offset:3072   lds
M v[56:59], a[80:83], a[168:171], v[56:59]
 s_sub_u32 s22, s22, 2097024
 s_and_b32 s64, s42, 7
M v[52:55], a[72:75], a[168:171], v[52:55]
 s_lshl_b32 s64, s64, 10
M v[52:55], a[76:79], a[172:175], v[52:55]
 s_add_u32 s94, s94, s64
 ds_read_b64_tr_b16 a[112:113], v3 offset:32768
 ds_read_b64_tr_b16 a[114:115], v3 offset:33792
M v[48:51], a[68:71], a[172:175], v[48:51]
 s_add_u32 m0, s23, 16384
 s_lshl_b32 s64, s20, 14
 s_add_u32 s94, s94, s64
M v[48:51], a[64:67], a[168:171], v[48:51]
 buffer_load_dwordx4 v8, s[16:19], s21 offen offset:0  nt lds
M v[44:47], a[56:59], a[168:171], v[44:47]
 s_add_u32 s94, s94, 201326592
 ds_read_b64_tr_b16 a[192:193], v28 offset:0
M v[44:47], a[60:63], a[172:175], v[44:47]
M v[40:43], a[52:55], a[172:175], v[40:43]
 ds_read_b64_tr_b16 a[116:117], v3 offset:40960
 ds_read_b64_tr_b16 a[118:119], v3 offset:41984
M v[40:43], a[48:51], a[168:171], v[40:43]
 ds_read_b64_tr_b16 a[194:195], v28 offset:14336
M v[36:39], a[40:43], a[168:171], v[36:39]
 buffer_load_dwordx4 v9, s[16:19], s21 offen offset:1024  nt lds
M v[36:39], a[44:47], a[172:175], v[36:39]
 s_waitcnt lgkmcnt(8)
 ds_read_b64_tr_b16 a[196:197], v28 offset:128
M v[32:35], a[36:39], a[172:175], v[32:35]
M v[32:35], a[32:35], a[168:171], v[32:35]
 ds_read_b64_tr_b16 a[120:121], v4 offset:32768
 ds_read_b64_tr_b16 a[122:123], v4 offset:33792
M v[64:67], a[32:35], a[160:163], v[64:67]
 ds_read_b128 a[168:171], v5 offset:6144
 ds_read_b128 a[172:175], v6 offset:6144
M v[64:67], a[36:39], a[164:167], v[64:67]
 buffer_load_dwordx4 v10, s[16:19], s21 offen offset:2048  nt lds
M v[68:71], a[44:47], a[164:167], v[68:71]
 ds_read_b64_tr_b16 a[198:199], v28 offset:14464
M v[68:71], a[40:43], a[160:163], v[68:71]
M v[72:75], a[48:51], a[160:163], v[72:75]
 ds_read_b64_tr_b16 a[124:125], v4 offset:40960
 ds_read_b64_tr_b16 a[126:127], v4 offset:41984
M v[72:75], a[52:55], a[164:167], v[72:75]
 ds_read_b64_tr_b16 a[200:201], v28 offset:256
M v[76:79], a[60:63], a[164:167], v[76:79]
 buffer_load_dwordx4 v11, s[16:19], s21 offen offset:3072  nt lds
M v[76:79], a[56:59], a[160:163], v[76:79]
 s_add_u32 s21, s21, 524160
 ds_read_b64_tr_b16 a[202:203], v28 offset:14592
M v[80:83], a[64:67], a[160:163], v[80:83]
M v[80:83], a[68:71], a[164:167], v[80:83]
 ds_read_b64_tr_b16 a[204:205], v28 offset:384
M v[84:87], a[76:79], a[164:167], v[84:87]
M v[84:87], a[72:75], a[160:163], v[84:87]
 ds_read_b64_tr_b16 a[206:207], v28 offset:14720
M v[88:91], a[80:83], a[160:163], v[88:91]
M v[88:91], a[84:87], a[164:167], v[88:91]
 s_waitcnt lgkmcnt(7)
 ds_read_b64_tr_b16 a[208:209], v28 offset:512
M v[92:95], a[92:95], a[164:167], v[92:95]
 s_waitcnt vmcnt(16) lgkmcnt(0)
M v[92:95], a[88:91], a[160:163], v[92:95]
 s_barrier
M v[124:127], a[88:91], a[168:171], v[124:127]
 ds_read_b128 a[160:163], v5 offset:16384
 ds_read_b128 a[164:167], v6 offset:16384
M v[124:127], a[92:95], a[172:175], v[124:127]
 ds_read_b64_tr_b16 a[210:211], v28 offset:14848
M v[120:123], a[84:87], a[172:175], v[120:123]
 s_add_u32 m0, s24, 0
 ds_read_b64_tr_b16 a[128:129], v1 offset:49152
 ds_read_b64_tr_b16 a[130:131], v1 offset:50176
M v[120:123], a[80:83], a[168:171], v[120:123]
 buffer_load_dwordx4 v12, s[48:51], s22 offen offset:0   lds
M v[116:119], a[72:75], a[168:171], v[116:119]
 ds_read_b64_tr_b16 a[212:213], v28 offset:640
M v[116:119], a[76:79], a[172:175], v[116:119]
M v[112:115], a[68:71], a[172:175], v[112:115]
 ds_read_b64_tr_b16 a[214:215], v28 offset:14976
M v[112:115], a[64:67], a[168:171], v[112:115]
M v[108:111], a[56:59], a[168:171], v[108:111]
 ds_read_b64_tr_b16 a[216:217], v28 offset:768
M v[108:111], a[60:63], a[172:175], v[108:111]
 ds_read_b64_tr_b16 a[132:133], v1 offset:57344
 ds_read_b64_tr_b16 a[134:135], v1 offset:58368
M v[104:107], a[52:55], a[172:175], v[104:107]
 buffer_load_dwordx4 v13, s[48:51], s22 offen offset:1024   lds
M v[104:107], a[48:51], a[168:171], v[104:107]
 ds_read_b64_tr_b16 a[218:219], v28 offset:15104
M v[100:103], a[40:43], a[168:171], v[100:103]
M v[100:103], a[44:47], a[172:175], v[100:103]
 s_waitcnt lgkmcnt(9)
M v[96:99], a[36:39], a[172:175], v[96:99]
M v[96:99], a[32:35], a[168:171], v[96:99]
M v[128:131], a[32:35], a[160:163], v[128:131]
 ds_read_b128 a[168:171], v5 offset:18432
 ds_read_b128 a[172:175], v6 offset:18432
M v[128:131], a[36:39], a[164:167], v[128:131]
 ds_read_b64_tr_b16 a[136:137], v2 offset:49152
 ds_read_b64_tr_b16 a[138:139], v2 offset:50176
M v[132:135], a[44:47], a[164:167], v[132:135]
 buffer_load_dwordx4 v14, s[48:51], s22 offen offset:2048   lds
M v[132:135], a[40:43], a[160:163], v[132:135]
M v[136:139], a[48:51], a[160:163], v[136:139]
M v[136:139], a[52:55], a[164:167], v[136:139]
M v[140:143], a[60:63], a[164:167], v[140:143]
M v[140:143], a[56:59], a[160:163], v[140:143]
 ds_read_b64_tr_b16 a[140:141], v2 offset:57344
 ds_read_b64_tr_b16 a[142:143], v2 offset:58368
M v[144:147], a[64:67], a[160:163], v[144:147]
 buffer_load_dwordx4 v15, s[48:51], s22 offen offset:3072   lds
M v[144:147], a[68:71], a[164:167], v[144:147]
 s_add_u32 s22, s22, 2097152
M v[148:151], a[76:79], a[164:167], v[148:151]
M v[148:151], a[72:75], a[160:163], v[148:151]
M v[152:155], a[80:83], a[160:163], v[152:155]
M v[152:155], a[84:87], a[164:167], v[152:155]
 s_waitcnt lgkmcnt(4)
M v[156:159], a[92:95], a[164:167], v[156:159]
 s_add_u32 m0, s23, 32768
 ds_read_b64_tr_b16 a[144:145], v3 offset:49152
 ds_read_b64_tr_b16 a[146:147], v3 offset:50176
M v[156:159], a[88:91], a[160:163], v[156:159]
 buffer_load_dwordx4 v8, s[16:19], s21 offen offset:0  nt lds
M v[188:191], a[88:91], a[168:171], v[188:191]
 ds_read_b128 a[160:163], v5 offset:20480
 ds_read_b128 a[164:167], v6 offset:20480
M v[188:191], a[92:95], a[172:175], v[188:191]
M v[184:187], a[84:87], a[172:175], v[184:187]
M v[184:187], a[80:83], a[168:171], v[184:187]
M v[180:183], a[72:75], a[168:171], v[180:183]
M v[180:183], a[76:79], a[172:175], v[180:183]
 ds_read_b64_tr_b16 a[148:149], v3 offset:57344
 ds_read_b64_tr_b16 a[150:151], v3 offset:58368
M v[176:179], a[68:71], a[172:175], v[176:179]
 buffer_load_dwordx4 v9, s[16:19], s21 offen offset:1024  nt lds
M v[176:179], a[64:67], a[168:171], v[176:179]
M v[172:175], a[56:59], a[168:171], v[172:175]
M v[172:175], a[60:63], a[172:175], v[172:175]
M v[168:171], a[52:55], a[172:175], v[168:171]
M v[168:171], a[48:51], a[168:171], v[168:171]
M v[164:167], a[40:43], a[168:171], v[164:167]
 ds_read_b64_tr_b16 a[152:153], v4 offset:49152
 ds_read_b64_tr_b16 a[154:155], v4 offset:50176
M v[164:167], a[44:47], a[172:175], v[164:167]
 s_waitcnt lgkmcnt(4)
M v[160:163], a[36:39], a[172:175], v[160:163]
 buffer_load_dwordx4 v10, s[16:19], s21 offen offset:2048  nt lds
M v[160:163], a[32:35], a[168:171], v[160:163]
M v[192:195], a[32:35], a[160:163], v[192:195]
 ds_read_b128 a[168:171], v5 offset:22528
 ds_read_b128 a[172:175], v6 offset:22528
M v[192:195], a[36:39], a[164:167], v[192:195]
M v[196:199], a[44:47], a[164:167], v[196:199]
M v[196:199], a[40:43], a[160:163], v[196:199]
 ds_read_b64_tr_b16 a[156:157], v4 offset:57344
 ds_read_b64_tr_b16 a[158:159], v4 offset:58368
M v[200:203], a[48:51], a[160:163], v[200:203]
 buffer_load_dwordx4 v11, s[16:19], s21 offen offset:3072  nt lds
M v[200:203], a[52:55], a[164:167], v[200:203]
 s_add_u32 s21, s21, 128
M v[204:207], a[60:63], a[164:167], v[204:207]
M v[204:207], a[56:59], a[160:163], v[204:207]
M v[208:211], a[64:67], a[160:163], v[208:211]
M v[208:211], a[68:71], a[164:167], v[208:211]
M v[212:215], a[76:79], a[164:167], v[212:215]
M v[212:215], a[72:75], a[160:163], v[212:215]
M v[216:219], a[80:83], a[160:163], v[216:219]
M v[216:219], a[84:87], a[164:167], v[216:219]
 s_waitcnt lgkmcnt(2)
M v[220:223], a[92:95], a[164:167], v[220:223]
 s_waitcnt vmcnt(16) lgkmcnt(0)
M v[220:223], a[88:91], a[160:163], v[220:223]
 s_barrier
M v[252:255], a[88:91], a[168:171], v[252:255]
 ds_read_b128 a[160:163], v5 offset:32768
 ds_read_b128 a[164:167], v6 offset:32768
M v[252:255], a[92:95], a[172:175], v[252:255]
 buffer_load_dword a240, v24, s[32:35], 0 offen offset:1536
M v[248:251], a[84:87], a[172:175], v[248:251]
M v[248:251], a[80:83], a[168:171], v[248:251]
M v[244:247], a[72:75], a[168:171], v[244:247]
M v[244:247], a[76:79], a[172:175], v[244:247]
M v[240:243], a[68:71], a[172:175], v[240:243]
M v[240:243], a[64:67], a[168:171], v[240:243]
M v[236:239], a[56:59], a[168:171], v[236:239]
M v[236:239], a[60:63], a[172:175], v[236:239]
M v[232:235], a[52:55], a[172:175], v[232:235]
M v[232:235], a[48:51], a[168:171], v[232:235]
M v[228:231], a[40:43], a[168:171], v[228:231]
M v[228:231], a[44:47], a[172:175], v[228:231]
 s_waitcnt lgkmcnt(0)
M v[224:227], a[36:39], a[172:175], v[224:227]
M v[224:227], a[32:35], a[168:171], v[224:227]
M a[0:3], a[96:99], a[160:163], a[0:3]
 ds_read_b128 a[168:171], v5 offset:34816
 ds_read_b128 a[172:175], v6 offset:34816
M a[0:3], a[100:103], a[164:167], a[0:3]
 ds_read_b64_tr_b16 a[32:33], v1 offset:0
 ds_read_b64_tr_b16 a[34:35], v1 offset:1024
M a[4:7], a[108:111], a[164:167], a[4:7]
 s_add_u32 m0, s24, 16384
M a[4:7], a[104:107], a[160:163], a[4:7]
 buffer_load_dwordx4 v12, s[48:51], s22 offen offset:0   lds
M a[8:11], a[112:115], a[160:163], a[8:11]
M a[8:11], a[116:119], a[164:167], a[8:11]
M a[12:15], a[124:127], a[164:167], a[12:15]
 ds_read_b64_tr_b16 a[36:37], v1 offset:8192
 ds_read_b64_tr_b16 a[38:39], v1 offset:9216
M a[12:15], a[120:123], a[160:163], a[12:15]
M a[16:19], a[128:131], a[160:163], a[16:19]
 buffer_load_dwordx4 v13, s[48:51], s22 offen offset:1024   lds
M a[16:19], a[132:135], a[164:167], a[16:19]
M a[20:23], a[140:143], a[164:167], a[20:23]
M a[20:23], a[136:139], a[160:163], a[20:23]
 ds_read_b64_tr_b16 a[40:41], v2 offset:0
 ds_read_b64_tr_b16 a[42:43], v2 offset:1024
M a[24:27], a[144:147], a[160:163], a[24:27]
M a[24:27], a[148:151], a[164:167], a[24:27]
 s_waitcnt lgkmcnt(6)
M a[28:31], a[156:159], a[164:167], a[28:31]
 buffer_load_dwordx4 v14, s[48:51], s22 offen offset:2048   lds
M a[28:31], a[152:155], a[160:163], a[28:31]
M v[60:63], a[152:155], a[168:171], v[60:63]
 ds_read_b128 a[160:163], v5 offset:36864
 ds_read_b128 a[164:167], v6 offset:36864
M v[60:63], a[156:159], a[172:175], v[60:63]
 ds_read_b64_tr_b16 a[44:45], v2 offset:8192
 ds_read_b64_tr_b16 a[46:47], v2 offset:9216
M v[56:59], a[148:151], a[172:175], v[56:59]
 buffer_load_dwordx4 v15, s[48:51], s22 offen offset:3072   lds
M v[56:59], a[144:147], a[168:171], v[56:59]
 s_sub_u32 s22, s22, 2097024
M v[52:55], a[136:139], a[168:171], v[52:55]
M v[52:55], a[140:143], a[172:175], v[52:55]
 ds_read_b64_tr_b16 a[48:49], v3 offset:0
 ds_read_b64_tr_b16 a[50:51], v3 offset:1024
M v[48:51], a[132:135], a[172:175], v[48:51]
 s_add_u32 m0, s23, 49152
M v[48:51], a[128:131], a[168:171], v[48:51]
 buffer_load_dwordx4 v8, s[16:19], s21 offen offset:0  nt lds
M v[44:47], a[120:123], a[168:171], v[44:47]
M v[44:47], a[124:127], a[172:175], v[44:47]
M v[40:43], a[116:119], a[172:175], v[40:43]
 ds_read_b64_tr_b16 a[52:53], v3 offset:8192
 ds_read_b64_tr_b16 a[54:55], v3 offset:9216
M v[40:43], a[112:115], a[168:171], v[40:43]
M v[36:39], a[104:107], a[168:171], v[36:39]
 buffer_load_dwordx4 v9, s[16:19], s21 offen offset:1024  nt lds
M v[36:39], a[108:111], a[172:175], v[36:39]
 s_waitcnt lgkmcnt(6)
M v[32:35], a[100:103], a[172:175], v[32:35]
M v[32:35], a[96:99], a[168:171], v[32:35]
 ds_read_b64_tr_b16 a[56:57], v4 offset:0
 ds_read_b64_tr_b16 a[58:59], v4 offset:1024
M v[64:67], a[96:99], a[160:163], v[64:67]
 ds_read_b128 a[168:171], v5 offset:38912
 ds_read_b128 a[172:175], v6 offset:38912
M v[64:67], a[100:103], a[164:167], v[64:67]
 buffer_load_dwordx4 v10, s[16:19], s21 offen offset:2048  nt lds
M v[68:71], a[108:111], a[164:167], v[68:71]
M v[68:71], a[104:107], a[160:163], v[68:71]
M v[72:75], a[112:115], a[160:163], v[72:75]
 ds_read_b64_tr_b16 a[60:61], v4 offset:8192
 ds_read_b64_tr_b16 a[62:63], v4 offset:9216
M v[72:75], a[116:119], a[164:167], v[72:75]
M v[76:79], a[124:127], a[164:167], v[76:79]
 buffer_load_dwordx4 v11, s[16:19], s21 offen offset:3072  nt lds
M v[76:79], a[120:123], a[160:163], v[76:79]
 s_add_u32 s21, s21, 524160
M v[80:83], a[128:131], a[160:163], v[80:83]
M v[80:83], a[132:135], a[164:167], v[80:83]
M v[84:87], a[140:143], a[164:167], v[84:87]
M v[84:87], a[136:139], a[160:163], v[84:87]
M v[88:91], a[144:147], a[160:163], v[88:91]
M v[88:91], a[148:151], a[164:167], v[88:91]
 s_waitcnt lgkmcnt(2)
M v[92:95], a[156:159], a[164:167], v[92:95]
 s_waitcnt vmcnt(17) lgkmcnt(0)
M v[92:95], a[152:155], a[160:163], v[92:95]
 s_barrier
M v[124:127], a[152:155], a[168:171], v[124:127]
 ds_read_b128 a[160:163], v5 offset:49152
 ds_read_b128 a[164:167], v6 offset:49152
M v[124:127], a[156:159], a[172:175], v[124:127]
M v[120:123], a[148:151], a[172:175], v[120:123]
 s_add_u32 m0, s24, 32768
 ds_read_b64_tr_b16 a[64:65], v1 offset:16384
 ds_read_b64_tr_b16 a[66:67], v1 offset:17408
M v[120:123], a[144:147], a[168:171], v[120:123]
 buffer_load_dwordx4 v12, s[48:51], s22 offen offset:0   lds
M v[116:119], a[136:139], a[168:171], v[116:119]
M v[116:119], a[140:143], a[172:175], v[116:119]
M v[112:115], a[132:135], a[172:175], v[112:115]
M v[112:115], a[128:131], a[168:171], v[112:115]
M v[108:111], a[120:123], a[168:171], v[108:111]
M v[108:111], a[124:127], a[172:175], v[108:111]
 ds_read_b64_tr_b16 a[68:69], v1 offset:24576
 ds_read_b64_tr_b16 a[70:71], v1 offset:25600
M v[104:107], a[116:119], a[172:175], v[104:107]
 buffer_load_dwordx4 v13, s[48:51], s22 offen offset:1024   lds
M v[104:107], a[112:115], a[168:171], v[104:107]
M v[100:103], a[104:107], a[168:171], v[100:103]
 s_and_b32 s64, s42, 7
 s_lshl_b32 s64, s64, 2
M v[100:103], a[108:111], a[172:175], v[100:103]
 s_waitcnt lgkmcnt(4)
 s_add_u32 s64, s64, s20
M v[96:99], a[100:103], a[172:175], v[96:99]
 s_mul_i32 s64, s64, 114688
 v_bfe_u32 v28, v0, 2, 2
 v_and_b32 v29, 3, v0
M v[96:99], a[96:99], a[168:171], v[96:99]
 v_lshlrev_b32 v29, 7, v29
 v_lshl_add_u32 v28, v28, 13, v29
M v[128:131], a[96:99], a[160:163], v[128:131]
 ds_read_b128 a[168:171], v5 offset:51200
 ds_read_b128 a[172:175], v6 offset:51200
M v[128:131], a[100:103], a[164:167], v[128:131]
 ds_read_b64_tr_b16 a[72:73], v2 offset:16384
 ds_read_b64_tr_b16 a[74:75], v2 offset:17408
M v[132:135], a[108:111], a[164:167], v[132:135]
 buffer_load_dwordx4 v14, s[48:51], s22 offen offset:2048   lds
M v[132:135], a[104:107], a[160:163], v[132:135]
 v_add_u32 v23, s64, v28
 v_and_b32 v28, 48, v0
M v[136:139], a[112:115], a[160:163], v[136:139]
 v_lshl_add_u32 v23, v28, 24, v23
M v[136:139], a[116:119], a[164:167], v[136:139]
M v[140:143], a[124:127], a[164:167], v[140:143]
M v[140:143], a[120:123], a[160:163], v[140:143]
 ds_read_b64_tr_b16 a[76:77], v2 offset:24576
 ds_read_b64_tr_b16 a[78:79], v2 offset:25600
M v[144:147], a[128:131], a[160:163], v[144:147]
 buffer_load_dwordx4 v15, s[48:51], s22 offen offset:3072   lds
M v[144:147], a[132:135], a[164:167], v[144:147]
 s_add_u32 s22, s22, 2097152
M v[148:151], a[140:143], a[164:167], v[148:151]
M v[148:151], a[136:139], a[160:163], v[148:151]
M v[152:155], a[144:147], a[160:163], v[152:155]
M v[152:155], a[148:151], a[164:167], v[152:155]
 s_waitcnt lgkmcnt(4)
M v[156:159], a[156:159], a[164:167], v[156:159]
 s_add_u32 m0, s23, 0
 ds_read_b64_tr_b16 a[80:81], v3 offset:16384
 ds_read_b64_tr_b16 a[82:83], v3 offset:17408
M v[156:159], a[152:155], a[160:163], v[156:159]
 buffer_load_dwordx4 v8, s[16:19], s21 offen offset:0  nt lds
M v[188:191], a[152:155], a[168:171], v[188:191]
 ds_read_b128 a[160:163], v5 offset:53248
 ds_read_b128 a[164:167], v6 offset:53248
M v[188:191], a[156:159], a[172:175], v[188:191]
M v[184:187], a[148:151], a[172:175], v[184:187]
M v[184:187], a[144:147], a[168:171], v[184:187]
M v[180:183], a[136:139], a[168:171], v[180:183]
M v[180:183], a[140:143], a[172:175], v[180:183]
 ds_read_b64_tr_b16 a[84:85], v3 offset:24576
 ds_read_b64_tr_b16 a[86:87], v3 offset:25600
M v[176:179], a[132:135], a[172:175], v[176:179]
 buffer_load_dwordx4 v9, s[16:19], s21 offen offset:1024  nt lds
M v[176:179], a[128:131], a[168:171], v[176:179]
M v[172:175], a[120:123], a[168:171], v[172:175]
M v[172:175], a[124:127], a[172:175], v[172:175]
M v[168:171], a[116:119], a[172:175], v[168:171]
M v[168:171], a[112:115], a[168:171], v[168:171]
M v[164:167], a[104:107], a[168:171], v[164:167]
 ds_read_b64_tr_b16 a[88:89], v4 offset:16384
 ds_read_b64_tr_b16 a[90:91], v4 offset:17408
M v[164:167], a[108:111], a[172:175], v[164:167]
 s_waitcnt lgkmcnt(4)
M v[160:163], a[100:103], a[172:175], v[160:163]
 buffer_load_dwordx4 v10, s[16:19], s21 offen offset:2048  nt lds
M v[160:163], a[96:99], a[168:171], v[160:163]
M v[192:195], a[96:99], a[160:163], v[192:195]
 ds_read_b128 a[168:171], v5 offset:55296
 ds_read_b128 a[172:175], v6 offset:55296
M v[192:195], a[100:103], a[164:167], v[192:195]
M v[196:199], a[108:111], a[164:167], v[196:199]
M v[196:199], a[104:107], a[160:163], v[196:199]
 ds_read_b64_tr_b16 a[92:93], v4 offset:24576
 ds_read_b64_tr_b16 a[94:95], v4 offset:25600
M v[200:203], a[112:115], a[160:163], v[200:203]
 buffer_load_dwordx4 v11, s[16:19], s21 offen offset:3072  nt lds
M v[200:203], a[116:119], a[164:167], v[200:203]
 s_add_u32 s21, s21, 128
M v[204:207], a[124:127], a[164:167], v[204:207]
M v[204:207], a[120:123], a[160:163], v[204:207]
M v[208:211], a[128:131], a[160:163], v[208:211]
M v[208:211], a[132:135], a[164:167], v[208:211]
M v[212:215], a[140:143], a[164:167], v[212:215]
M v[212:215], a[136:139], a[160:163], v[212:215]
M v[216:219], a[144:147], a[160:163], v[216:219]
M v[216:219], a[148:151], a[164:167], v[216:219]
 s_waitcnt lgkmcnt(2)
M v[220:223], a[156:159], a[164:167], v[220:223]
 s_waitcnt vmcnt(17) lgkmcnt(0)
M v[220:223], a[152:155], a[160:163], v[220:223]
 s_barrier
M v[252:255], a[152:155], a[168:171], v[252:255]
 ds_read_b128 a[160:163], v5 offset:0
 ds_read_b128 a[164:167], v6 offset:0
M v[252:255], a[156:159], a[172:175], v[252:255]
 buffer_load_dword a240, v23, s[52:55], 0 offen offset:0
M v[248:251], a[148:151], a[172:175], v[248:251]
 v_add_u32 v23, 32768, v23
M v[248:251], a[144:147], a[168:171], v[248:251]
M v[244:247], a[136:139], a[168:171], v[244:247]
M v[244:247], a[140:143], a[172:175], v[244:247]
M v[240:243], a[132:135], a[172:175], v[240:243]
M v[240:243], a[128:131], a[168:171], v[240:243]
M v[236:239], a[120:123], a[168:171], v[236:239]
M v[236:239], a[124:127], a[172:175], v[236:239]
M v[232:235], a[116:119], a[172:175], v[232:235]
M v[232:235], a[112:115], a[168:171], v[232:235]
M v[228:231], a[104:107], a[168:171], v[228:231]
M v[228:231], a[108:111], a[172:175], v[228:231]
 s_waitcnt lgkmcnt(0)
M v[224:227], a[100:103], a[172:175], v[224:227]
M v[224:227], a[96:99], a[168:171], v[224:227]
M a[0:3], a[32:35], a[160:163], a[0:3]
 ds_read_b128 a[168:171], v5 offset:2048
 ds_read_b128 a[172:175], v6 offset:2048
M a[0:3], a[36:39], a[164:167], a[0:3]
 ds_read_b64_tr_b16 a[96:97], v1 offset:32768
 ds_read_b64_tr_b16 a[98:99], v1 offset:33792
M a[4:7], a[44:47], a[164:167], a[4:7]
 s_add_u32 m0, s24, 49152
M a[4:7], a[40:43], a[160:163], a[4:7]
 buffer_load_dwordx4 v12, s[48:51], s22 offen offset:0   lds
M a[8:11], a[48:51], a[160:163], a[8:11]
M a[8:11], a[52:55], a[164:167], a[8:11]
M a[12:15], a[60:63], a[164:167], a[12:15]
 ds_read_b64_tr_b16 a[100:101], v1 offset:40960
 ds_read_b64_tr_b16 a[102:103], v1 offset:41984
M a[12:15], a[56:59], a[160:163], a[12:15]
M a[16:19], a[64:67], a[160:163], a[16:19]
 buffer_load_dwordx4 v13, s[48:51], s22 offen offset:1024   lds
M a[16:19], a[68:71], a[164:167], a[16:19]
M a[20:23], a[76:79], a[164:167], a[20:23]
M a[20:23], a[72:75], a[160:163], a[20:23]
 ds_read_b64_tr_b16 a[104:105], v2 offset:32768
 ds_read_b64_tr_b16 a[106:107], v2 offset:33792
M a[24:27], a[80:83], a[160:163], a[24:27]
M a[24:27], a[84:87], a[164:167], a[24:27]
 s_waitcnt lgkmcnt(6)
M a[28:31], a[92:95], a[164:167], a[28:31]
 buffer_load_dwordx4 v14, s[48:51], s22 offen offset:2048   lds
M a[28:31], a[88:91], a[160:163], a[28:31]
M v[60:63], a[88:91], a[168:171], v[60:63]
 ds_read_b128 a[160:163], v5 offset:4096
 ds_read_b128 a[164:167], v6 offset:4096
M v[60:63], a[92:95], a[172:175], v[60:63]
 ds_read_b64_tr_b16 a[108:109], v2 offset:40960
 ds_read_b64_tr_b16 a[110:111], v2 offset:41984
M v[56:59], a[84:87], a[172:175], v[56:59]
 buffer_load_dwordx4 v15, s[48:51], s22 offen offset:3072   lds
M v[56:59], a[80:83], a[168:171], v[56:59]
 s_sub_u32 s22, s22, 2097024
M v[52:55], a[72:75], a[168:171], v[52:55]
M v[52:55], a[76:79], a[172:175], v[52:55]
 ds_read_b64_tr_b16 a[112:113], v3 offset:32768
 ds_read_b64_tr_b16 a[114:115], v3 offset:33792
M v[48:51], a[68:71], a[172:175], v[48:51]
 s_add_u32 m0, s23, 16384
M v[48:51], a[64:67], a[168:171], v[48:51]
 buffer_load_dwordx4 v8, s[16:19], s21 offen offset:0  nt lds
M v[44:47], a[56:59], a[168:171], v[44:47]
M v[44:47], a[60:63], a[172:175], v[44:47]
M v[40:43], a[52:55], a[172:175], v[40:43]
 ds_read_b64_tr_b16 a[116:117], v3 offset:40960
 ds_read_b64_tr_b16 a[118:119], v3 offset:41984
M v[40:43], a[48:51], a[168:171], v[40:43]
M v[36:39], a[40:43], a[168:171], v[36:39]
 buffer_load_dwordx4 v9, s[16:19], s21 offen offset:1024  nt lds
M v[36:39], a[44:47], a[172:175], v[36:39]
 s_waitcnt lgkmcnt(6)
M v[32:35], a[36:39], a[172:175], v[32:35]
M v[32:35], a[32:35], a[168:171], v[32:35]
 ds_read_b64_tr_b16 a[120:121], v4 offset:32768
 ds_read_b64_tr_b16 a[122:123], v4 offset:33792
M v[64:67], a[32:35], a[160:163], v[64:67]
 ds_read_b128 a[168:171], v5 offset:6144
 ds_read_b128 a[172:175], v6 offset:6144
M v[64:67], a[36:39], a[164:167], v[64:67]
 buffer_load_dwordx4 v10, s[16:19], s21 offen offset:2048  nt lds
M v[68:71], a[44:47], a[164:167], v[68:71]
M v[68:71], a[40:43], a[160:163], v[68:71]
M v[72:75], a[48:51], a[160:163], v[72:75]
 ds_read_b64_tr_b16 a[124:125], v4 offset:40960
 ds_read_b64_tr_b16 a[126:127], v4 offset:41984
M v[72:75], a[52:55], a[164:167], v[72:75]
M v[76:79], a[60:63], a[164:167], v[76:79]
 buffer_load_dwordx4 v11, s[16:19], s21 offen offset:3072  nt lds
M v[76:79], a[56:59], a[160:163], v[76:79]
 s_add_u32 s21, s21, 524160
M v[80:83], a[64:67], a[160:163], v[80:83]
M v[80:83], a[68:71], a[164:167], v[80:83]
M v[84:87], a[76:79], a[164:167], v[84:87]
M v[84:87], a[72:75], a[160:163], v[84:87]
M v[88:91], a[80:83], a[160:163], v[88:91]
M v[88:91], a[84:87], a[164:167], v[88:91]
 s_waitcnt lgkmcnt(2)
M v[92:95], a[92:95], a[164:167], v[92:95]
 s_waitcnt vmcnt(17) lgkmcnt(0)
M v[92:95], a[88:91], a[160:163], v[92:95]
 s_barrier
M v[124:127], a[88:91], a[168:171], v[124:127]
 ds_read_b128 a[160:163], v5 offset:16384
 ds_read_b128 a[164:167], v6 offset:16384
M v[124:127], a[92:95], a[172:175], v[124:127]
M v[120:123], a[84:87], a[172:175], v[120:123]
 s_add_u32 m0, s24, 0
 ds_read_b64_tr_b16 a[128:129], v1 offset:49152
 ds_read_b64_tr_b16 a[130:131], v1 offset:50176
M v[120:123], a[80:83], a[168:171], v[120:123]
 buffer_load_dwordx4 v12, s[48:51], s22 offen offset:0   lds
M v[116:119], a[72:75], a[168:171], v[116:119]
M v[116:119], a[76:79], a[172:175], v[116:119]
M v[112:115], a[68:71], a[172:175], v[112:115]
M v[112:115], a[64:67], a[168:171], v[112:115]
M v[108:111], a[56:59], a[168:171], v[108:111]
M v[108:111], a[60:63], a[172:175], v[108:111]
 ds_read_b64_tr_b16 a[132:133], v1 offset:57344
 ds_read_b64_tr_b16 a[134:135], v1 offset:58368
M v[104:107], a[52:55], a[172:175], v[104:107]
 buffer_load_dwordx4 v13, s[48:51], s22 offen offset:1024   lds
M v[104:107], a[48:51], a[168:171], v[104:107]
M v[100:103], a[40:43], a[168:171], v[100:103]
M v[100:103], a[44:47], a[172:175], v[100:103]
 s_waitcnt lgkmcnt(4)
M v[96:99], a[36:39], a[172:175], v[96:99]
M v[96:99], a[32:35], a[168:171], v[96:99]
M v[128:131], a[32:35], a[160:163], v[128:131]
 ds_read_b128 a[168:171], v5 offset:18432
 ds_read_b128 a[172:175], v6 offset:18432
M v[128:131], a[36:39], a[164:167], v[128:131]
 ds_read_b64_tr_b16 a[136:137], v2 offset:49152
 ds_read_b64_tr_b16 a[138:139], v2 offset:50176
M v[132:135], a[44:47], a[164:167], v[132:135]
 buffer_load_dwordx4 v14, s[48:51], s22 offen offset:2048   lds
M v[132:135], a[40:43], a[160:163], v[132:135]
M v[136:139], a[48:51], a[160:163], v[136:139]
M v[136:139], a[52:55], a[164:167], v[136:139]
M v[140:143], a[60:63], a[164:167], v[140:143]
M v[140:143], a[56:59], a[160:163], v[140:143]
 ds_read_b64_tr_b16 a[140:141], v2 offset:57344
 ds_read_b64_tr_b16 a[142:143], v2 offset:58368
M v[144:147], a[64:67], a[160:163], v[144:147]
 buffer_load_dwordx4 v15, s[48:51], s22 offen offset:3072   lds
M v[144:147], a[68:71], a[164:167], v[144:147]
 s_add_u32 s22, s22, 2097152
M v[148:151], a[76:79], a[164:167], v[148:151]
M v[148:151], a[72:75], a[160:163], v[148:151]
M v[152:155], a[80:83], a[160:163], v[152:155]
M v[152:155], a[84:87], a[164:167], v[152:155]
 s_waitcnt lgkmcnt(4)
M v[156:159], a[92:95], a[164:167], v[156:159]
 s_add_u32 m0, s23, 32768
 ds_read_b64_tr_b16 a[144:145], v3 offset:49152
 ds_read_b64_tr_b16 a[146:147], v3 offset:50176
M v[156:159], a[88:91], a[160:163], v[156:159]
 buffer_load_dwordx4 v8, s[16:19], s21 offen offset:0  nt lds
M v[188:191], a[88:91], a[168:171], v[188:191]
 ds_read_b128 a[160:163], v5 offset:20480
 ds_read_b128 a[164:167], v6 offset:20480
M v[188:191], a[92:95], a[172:175], v[188:191]
M v[184:187], a[84:87], a[172:175], v[184:187]
M v[184:187], a[80:83], a[168:171], v[184:187]
M v[180:183], a[72:75], a[168:171], v[180:183]
M v[180:183], a[76:79], a[172:175], v[180:183]
 ds_read_b64_tr_b16 a[148:149], v3 offset:57344
 ds_read_b64_tr_b16 a[150:151], v3 offset:58368
M v[176:179], a[68:71], a[172:175], v[176:179]
 buffer_load_dwordx4 v9, s[16:19], s21 offen offset:1024  nt lds
M v[176:179], a[64:67], a[168:171], v[176:179]
M v[172:175], a[56:59], a[168:171], v[172:175]
M v[172:175], a[60:63], a[172:175], v[172:175]
M v[168:171], a[52:55], a[172:175], v[168:171]
M v[168:171], a[48:51], a[168:171], v[168:171]
M v[164:167], a[40:43], a[168:171], v[164:167]
 ds_read_b64_tr_b16 a[152:153], v4 offset:49152
 ds_read_b64_tr_b16 a[154:155], v4 offset:50176
M v[164:167], a[44:47], a[172:175], v[164:167]
 s_waitcnt lgkmcnt(4)
M v[160:163], a[36:39], a[172:175], v[160:163]
 buffer_load_dwordx4 v10, s[16:19], s21 offen offset:2048  nt lds
M v[160:163], a[32:35], a[168:171], v[160:163]
M v[192:195], a[32:35], a[160:163], v[192:195]
 ds_read_b128 a[168:171], v5 offset:22528
 ds_read_b128 a[172:175], v6 offset:22528
M v[192:195], a[36:39], a[164:167], v[192:195]
M v[196:199], a[44:47], a[164:167], v[196:199]
M v[196:199], a[40:43], a[160:163], v[196:199]
 ds_read_b64_tr_b16 a[156:157], v4 offset:57344
 ds_read_b64_tr_b16 a[158:159], v4 offset:58368
M v[200:203], a[48:51], a[160:163], v[200:203]
 buffer_load_dwordx4 v11, s[16:19], s21 offen offset:3072  nt lds
M v[200:203], a[52:55], a[164:167], v[200:203]
 s_add_u32 s21, s21, 128
M v[204:207], a[60:63], a[164:167], v[204:207]
M v[204:207], a[56:59], a[160:163], v[204:207]
M v[208:211], a[64:67], a[160:163], v[208:211]
M v[208:211], a[68:71], a[164:167], v[208:211]
M v[212:215], a[76:79], a[164:167], v[212:215]
M v[212:215], a[72:75], a[160:163], v[212:215]
M v[216:219], a[80:83], a[160:163], v[216:219]
M v[216:219], a[84:87], a[164:167], v[216:219]
 s_waitcnt lgkmcnt(2)
M v[220:223], a[92:95], a[164:167], v[220:223]
 s_waitcnt vmcnt(17) lgkmcnt(0)
M v[220:223], a[88:91], a[160:163], v[220:223]
 s_barrier
M v[252:255], a[88:91], a[168:171], v[252:255]
 ds_read_b128 a[160:163], v5 offset:32768
 ds_read_b128 a[164:167], v6 offset:32768
M v[252:255], a[92:95], a[172:175], v[252:255]
 buffer_load_dword a240, v23, s[52:55], 0 offen offset:0
M v[248:251], a[84:87], a[172:175], v[248:251]
 v_add_u32 v23, 32768, v23
M v[248:251], a[80:83], a[168:171], v[248:251]
M v[244:247], a[72:75], a[168:171], v[244:247]
M v[244:247], a[76:79], a[172:175], v[244:247]
M v[240:243], a[68:71], a[172:175], v[240:243]
M v[240:243], a[64:67], a[168:171], v[240:243]
M v[236:239], a[56:59], a[168:171], v[236:239]
M v[236:239], a[60:63], a[172:175], v[236:239]
M v[232:235], a[52:55], a[172:175], v[232:235]
M v[232:235], a[48:51], a[168:171], v[232:235]
M v[228:231], a[40:43], a[168:171], v[228:231]
M v[228:231], a[44:47], a[172:175], v[228:231]
 s_waitcnt lgkmcnt(0)
M v[224:227], a[36:39], a[172:175], v[224:227]
M v[224:227], a[32:35], a[168:171], v[224:227]
M a[0:3], a[96:99], a[160:163], a[0:3]
 ds_read_b128 a[168:171], v5 offset:34816
 ds_read_b128 a[172:175], v6 offset:34816
M a[0:3], a[100:103], a[164:167], a[0:3]
 ds_read_b64_tr_b16 a[32:33], v1 offset:0
 ds_read_b64_tr_b16 a[34:35], v1 offset:1024
M a[4:7], a[108:111], a[164:167], a[4:7]
 s_add_u32 m0, s24, 16384
M a[4:7], a[104:107], a[160:163], a[4:7]
 buffer_load_dwordx4 v12, s[48:51], s22 offen offset:0   lds
M a[8:11], a[112:115], a[160:163], a[8:11]
M a[8:11], a[116:119], a[164:167], a[8:11]
M a[12:15], a[124:127], a[164:167], a[12:15]
 ds_read_b64_tr_b16 a[36:37], v1 offset:8192
 ds_read_b64_tr_b16 a[38:39], v1 offset:9216
M a[12:15], a[120:123], a[160:163], a[12:15]
M a[16:19], a[128:131], a[160:163], a[16:19]
 buffer_load_dwordx4 v13, s[48:51], s22 offen offset:1024   lds
M a[16:19], a[132:135], a[164:167], a[16:19]
M a[20:23], a[140:143], a[164:167], a[20:23]
M a[20:23], a[136:139], a[160:163], a[20:23]
 ds_read_b64_tr_b16 a[40:41], v2 offset:0
 ds_read_b64_tr_b16 a[42:43], v2 offset:1024
M a[24:27], a[144:147], a[160:163], a[24:27]
M a[24:27], a[148:151], a[164:167], a[24:27]
 s_waitcnt lgkmcnt(6)
M a[28:31], a[156:159], a[164:167], a[28:31]
 buffer_load_dwordx4 v14, s[48:51], s22 offen offset:2048   lds
M a[28:31], a[152:155], a[160:163], a[28:31]
M v[60:63], a[152:155], a[168:171], v[60:63]
 ds_read_b128 a[160:163], v5 offset:36864
 ds_read_b128 a[164:167], v6 offset:36864
M v[60:63], a[156:159], a[172:175], v[60:63]
 ds_read_b64_tr_b16 a[44:45], v2 offset:8192
 ds_read_b64_tr_b16 a[46:47], v2 offset:9216
M v[56:59], a[148:151], a[172:175], v[56:59]
 buffer_load_dwordx4 v15, s[48:51], s22 offen offset:3072   lds
M v[56:59], a[144:147], a[168:171], v[56:59]
 s_sub_u32 s22, s22, 2097024
M v[52:55], a[136:139], a[168:171], v[52:55]
M v[52:55], a[140:143], a[172:175], v[52:55]
 ds_read_b64_tr_b16 a[48:49], v3 offset:0
 ds_read_b64_tr_b16 a[50:51], v3 offset:1024
M v[48:51], a[132:135], a[172:175], v[48:51]
 s_add_u32 m0, s23, 49152
M v[48:51], a[128:131], a[168:171], v[48:51]
 buffer_load_dwordx4 v8, s[16:19], s21 offen offset:0  nt lds
M v[44:47], a[120:123], a[168:171], v[44:47]
M v[44:47], a[124:127], a[172:175], v[44:47]
M v[40:43], a[116:119], a[172:175], v[40:43]
 ds_read_b64_tr_b16 a[52:53], v3 offset:8192
 ds_read_b64_tr_b16 a[54:55], v3 offset:9216
M v[40:43], a[112:115], a[168:171], v[40:43]
M v[36:39], a[104:107], a[168:171], v[36:39]
 buffer_load_dwordx4 v9, s[16:19], s21 offen offset:1024  nt lds
M v[36:39], a[108:111], a[172:175], v[36:39]
 s_waitcnt lgkmcnt(6)
M v[32:35], a[100:103], a[172:175], v[32:35]
M v[32:35], a[96:99], a[168:171], v[32:35]
 ds_read_b64_tr_b16 a[56:57], v4 offset:0
 ds_read_b64_tr_b16 a[58:59], v4 offset:1024
M v[64:67], a[96:99], a[160:163], v[64:67]
 ds_read_b128 a[168:171], v5 offset:38912
 ds_read_b128 a[172:175], v6 offset:38912
M v[64:67], a[100:103], a[164:167], v[64:67]
 buffer_load_dwordx4 v10, s[16:19], s21 offen offset:2048  nt lds
M v[68:71], a[108:111], a[164:167], v[68:71]
M v[68:71], a[104:107], a[160:163], v[68:71]
M v[72:75], a[112:115], a[160:163], v[72:75]
 ds_read_b64_tr_b16 a[60:61], v4 offset:8192
 ds_read_b64_tr_b16 a[62:63], v4 offset:9216
M v[72:75], a[116:119], a[164:167], v[72:75]
M v[76:79], a[124:127], a[164:167], v[76:79]
 buffer_load_dwordx4 v11, s[16:19], s21 offen offset:3072  nt lds
M v[76:79], a[120:123], a[160:163], v[76:79]
 s_add_u32 s21, s21, 524160
M v[80:83], a[128:131], a[160:163], v[80:83]
M v[80:83], a[132:135], a[164:167], v[80:83]
M v[84:87], a[140:143], a[164:167], v[84:87]
M v[84:87], a[136:139], a[160:163], v[84:87]
M v[88:91], a[144:147], a[160:163], v[88:91]
M v[88:91], a[148:151], a[164:167], v[88:91]
 s_waitcnt lgkmcnt(2)
M v[92:95], a[156:159], a[164:167], v[92:95]
 s_waitcnt vmcnt(17) lgkmcnt(0)
M v[92:95], a[152:155], a[160:163], v[92:95]
 s_barrier
M v[124:127], a[152:155], a[168:171], v[124:127]
 ds_read_b128 a[160:163], v5 offset:49152
 ds_read_b128 a[164:167], v6 offset:49152
M v[124:127], a[156:159], a[172:175], v[124:127]
M v[120:123], a[148:151], a[172:175], v[120:123]
 s_add_u32 m0, s24, 32768
 ds_read_b64_tr_b16 a[64:65], v1 offset:16384
 ds_read_b64_tr_b16 a[66:67], v1 offset:17408
M v[120:123], a[144:147], a[168:171], v[120:123]
 buffer_load_dwordx4 v12, s[48:51], s22 offen offset:0   lds
M v[116:119], a[136:139], a[168:171], v[116:119]
M v[116:119], a[140:143], a[172:175], v[116:119]
M v[112:115], a[132:135], a[172:175], v[112:115]
M v[112:115], a[128:131], a[168:171], v[112:115]
M v[108:111], a[120:123], a[168:171], v[108:111]
M v[108:111], a[124:127], a[172:175], v[108:111]
 ds_read_b64_tr_b16 a[68:69], v1 offset:24576
 ds_read_b64_tr_b16 a[70:71], v1 offset:25600
M v[104:107], a[116:119], a[172:175], v[104:107]
 buffer_load_dwordx4 v13, s[48:51], s22 offen offset:1024   lds
M v[104:107], a[112:115], a[168:171], v[104:107]
M v[100:103], a[104:107], a[168:171], v[100:103]
M v[100:103], a[108:111], a[172:175], v[100:103]
 s_waitcnt lgkmcnt(4)
M v[96:99], a[100:103], a[172:175], v[96:99]
M v[96:99], a[96:99], a[168:171], v[96:99]
M v[128:131], a[96:99], a[160:163], v[128:131]
 ds_read_b128 a[168:171], v5 offset:51200
 ds_read_b128 a[172:175], v6 offset:51200
M v[128:131], a[100:103], a[164:167], v[128:131]
 ds_read_b64_tr_b16 a[72:73], v2 offset:16384
 ds_read_b64_tr_b16 a[74:75], v2 offset:17408
M v[132:135], a[108:111], a[164:167], v[132:135]
 buffer_load_dwordx4 v14, s[48:51], s22 offen offset:2048   lds
M v[132:135], a[104:107], a[160:163], v[132:135]
M v[136:139], a[112:115], a[160:163], v[136:139]
M v[136:139], a[116:119], a[164:167], v[136:139]
M v[140:143], a[124:127], a[164:167], v[140:143]
M v[140:143], a[120:123], a[160:163], v[140:143]
 ds_read_b64_tr_b16 a[76:77], v2 offset:24576
 ds_read_b64_tr_b16 a[78:79], v2 offset:25600
M v[144:147], a[128:131], a[160:163], v[144:147]
 buffer_load_dwordx4 v15, s[48:51], s22 offen offset:3072   lds
M v[144:147], a[132:135], a[164:167], v[144:147]
 s_add_u32 s22, s22, 2097152
M v[148:151], a[140:143], a[164:167], v[148:151]
M v[148:151], a[136:139], a[160:163], v[148:151]
M v[152:155], a[144:147], a[160:163], v[152:155]
M v[152:155], a[148:151], a[164:167], v[152:155]
 s_waitcnt lgkmcnt(4)
M v[156:159], a[156:159], a[164:167], v[156:159]
 s_add_u32 m0, s23, 0
 ds_read_b64_tr_b16 a[80:81], v3 offset:16384
 ds_read_b64_tr_b16 a[82:83], v3 offset:17408
M v[156:159], a[152:155], a[160:163], v[156:159]
 buffer_load_dwordx4 v8, s[16:19], s21 offen offset:0  nt lds
M v[188:191], a[152:155], a[168:171], v[188:191]
 ds_read_b128 a[160:163], v5 offset:53248
 ds_read_b128 a[164:167], v6 offset:53248
M v[188:191], a[156:159], a[172:175], v[188:191]
M v[184:187], a[148:151], a[172:175], v[184:187]
M v[184:187], a[144:147], a[168:171], v[184:187]
M v[180:183], a[136:139], a[168:171], v[180:183]
M v[180:183], a[140:143], a[172:175], v[180:183]
 ds_read_b64_tr_b16 a[84:85], v3 offset:24576
 ds_read_b64_tr_b16 a[86:87], v3 offset:25600
M v[176:179], a[132:135], a[172:175], v[176:179]
 buffer_load_dwordx4 v9, s[16:19], s21 offen offset:1024  nt lds
M v[176:179], a[128:131], a[168:171], v[176:179]
M v[172:175], a[120:123], a[168:171], v[172:175]
M v[172:175], a[124:127], a[172:175], v[172:175]
M v[168:171], a[116:119], a[172:175], v[168:171]
M v[168:171], a[112:115], a[168:171], v[168:171]
M v[164:167], a[104:107], a[168:171], v[164:167]
 ds_read_b64_tr_b16 a[88:89], v4 offset:16384
 ds_read_b64_tr_b16 a[90:91], v4 offset:17408
M v[164:167], a[108:111], a[172:175], v[164:167]
 s_waitcnt lgkmcnt(4)
M v[160:163], a[100:103], a[172:175], v[160:163]
 buffer_load_dwordx4 v10, s[16:19], s21 offen offset:2048  nt lds
M v[160:163], a[96:99], a[168:171], v[160:163]
M v[192:195], a[96:99], a[160:163], v[192:195]
 ds_read_b128 a[168:171], v5 offset:55296
 ds_read_b128 a[172:175], v6 offset:55296
M v[192:195], a[100:103], a[164:167], v[192:195]
M v[196:199], a[108:111], a[164:167], v[196:199]
M v[196:199], a[104:107], a[160:163], v[196:199]
 ds_read_b64_tr_b16 a[92:93], v4 offset:24576
 ds_read_b64_tr_b16 a[94:95], v4 offset:25600
M v[200:203], a[112:115], a[160:163], v[200:203]
 buffer_load_dwordx4 v11, s[16:19], s21 offen offset:3072  nt lds
M v[200:203], a[116:119], a[164:167], v[200:203]
 s_add_u32 s21, s21, 128
M v[204:207], a[124:127], a[164:167], v[204:207]
M v[204:207], a[120:123], a[160:163], v[204:207]
M v[208:211], a[128:131], a[160:163], v[208:211]
M v[208:211], a[132:135], a[164:167], v[208:211]
M v[212:215], a[140:143], a[164:167], v[212:215]
M v[212:215], a[136:139], a[160:163], v[212:215]
M v[216:219], a[144:147], a[160:163], v[216:219]
M v[216:219], a[148:151], a[164:167], v[216:219]
 s_waitcnt lgkmcnt(2)
M v[220:223], a[156:159], a[164:167], v[220:223]
 s_waitcnt vmcnt(17) lgkmcnt(0)
M v[220:223], a[152:155], a[160:163], v[220:223]
 s_barrier
M v[252:255], a[152:155], a[168:171], v[252:255]
 ds_read_b128 a[160:163], v5 offset:0
 ds_read_b128 a[164:167], v6 offset:0
M v[252:255], a[156:159], a[172:175], v[252:255]
 buffer_load_dword a240, v23, s[52:55], 0 offen offset:0
M v[248:251], a[148:151], a[172:175], v[248:251]
 v_add_u32 v23, 16384, v23
M v[248:251], a[144:147], a[168:171], v[248:251]
M v[244:247], a[136:139], a[168:171], v[244:247]
M v[244:247], a[140:143], a[172:175], v[244:247]
M v[240:243], a[132:135], a[172:175], v[240:243]
M v[240:243], a[128:131], a[168:171], v[240:243]
M v[236:239], a[120:123], a[168:171], v[236:239]
M v[236:239], a[124:127], a[172:175], v[236:239]
M v[232:235], a[116:119], a[172:175], v[232:235]
M v[232:235], a[112:115], a[168:171], v[232:235]
M v[228:231], a[104:107], a[168:171], v[228:231]
M v[228:231], a[108:111], a[172:175], v[228:231]
 s_waitcnt lgkmcnt(0)
M v[224:227], a[100:103], a[172:175], v[224:227]
M v[224:227], a[96:99], a[168:171], v[224:227]
M a[0:3], a[32:35], a[160:163], a[0:3]
 ds_read_b128 a[168:171], v5 offset:2048
 ds_read_b128 a[172:175], v6 offset:2048
M a[0:3], a[36:39], a[164:167], a[0:3]
 ds_read_b64_tr_b16 a[96:97], v1 offset:32768
 ds_read_b64_tr_b16 a[98:99], v1 offset:33792
M a[4:7], a[44:47], a[164:167], a[4:7]
 s_add_u32 m0, s24, 49152
 v_accvgpr_read_b32 v27, a241
M a[4:7], a[40:43], a[160:163], a[4:7]
 buffer_load_dwordx4 v12, s[48:51], s22 offen offset:0   lds
M a[8:11], a[48:51], a[160:163], a[8:11]
M a[8:11], a[52:55], a[164:167], a[8:11]
M a[12:15], a[60:63], a[164:167], a[12:15]
 ds_read_b64_tr_b16 a[100:101], v1 offset:40960
 ds_read_b64_tr_b16 a[102:103], v1 offset:41984
M a[12:15], a[56:59], a[160:163], a[12:15]
M a[16:19], a[64:67], a[160:163], a[16:19]
 buffer_load_dwordx4 v13, s[48:51], s22 offen offset:1024   lds
M a[16:19], a[68:71], a[164:167], a[16:19]
M a[20:23], a[76:79], a[164:167], a[20:23]
M a[20:23], a[72:75], a[160:163], a[20:23]
 ds_read_b64_tr_b16 a[104:105], v2 offset:32768
 ds_read_b64_tr_b16 a[106:107], v2 offset:33792
M a[24:27], a[80:83], a[160:163], a[24:27]
M a[24:27], a[84:87], a[164:167], a[24:27]
 s_waitcnt lgkmcnt(6)
M a[28:31], a[92:95], a[164:167], a[28:31]
 buffer_load_dwordx4 v14, s[48:51], s22 offen offset:2048   lds
M a[28:31], a[88:91], a[160:163], a[28:31]
M v[60:63], a[88:91], a[168:171], v[60:63]
 ds_read_b128 a[160:163], v5 offset:4096
 ds_read_b128 a[164:167], v6 offset:4096
M v[60:63], a[92:95], a[172:175], v[60:63]
 ds_read_b64_tr_b16 a[108:109], v2 offset:40960
 ds_read_b64_tr_b16 a[110:111], v2 offset:41984
M v[56:59], a[84:87], a[172:175], v[56:59]
 buffer_load_dwordx4 v15, s[48:51], s22 offen offset:3072   lds
M v[56:59], a[80:83], a[168:171], v[56:59]
 s_sub_u32 s22, s22, 2097024
M v[52:55], a[72:75], a[168:171], v[52:55]
M v[52:55], a[76:79], a[172:175], v[52:55]
 ds_read_b64_tr_b16 a[112:113], v3 offset:32768
 ds_read_b64_tr_b16 a[114:115], v3 offset:33792
M v[48:51], a[68:71], a[172:175], v[48:51]
 s_add_u32 m0, s23, 16384
M v[48:51], a[64:67], a[168:171], v[48:51]
 buffer_load_dwordx4 v8, s[16:19], s21 offen offset:0  nt lds
M v[44:47], a[56:59], a[168:171], v[44:47]
M v[44:47], a[60:63], a[172:175], v[44:47]
M v[40:43], a[52:55], a[172:175], v[40:43]
 ds_read_b64_tr_b16 a[116:117], v3 offset:40960
 ds_read_b64_tr_b16 a[118:119], v3 offset:41984
M v[40:43], a[48:51], a[168:171], v[40:43]
M v[36:39], a[40:43], a[168:171], v[36:39]
 buffer_load_dwordx4 v9, s[16:19], s21 offen offset:1024  nt lds
M v[36:39], a[44:47], a[172:175], v[36:39]
 s_waitcnt lgkmcnt(6)
M v[32:35], a[36:39], a[172:175], v[32:35]
M v[32:35], a[32:35], a[168:171], v[32:35]
 ds_read_b64_tr_b16 a[120:121], v4 offset:32768
 ds_read_b64_tr_b16 a[122:123], v4 offset:33792
M v[64:67], a[32:35], a[160:163], v[64:67]
 ds_read_b128 a[168:171], v5 offset:6144
 ds_read_b128 a[172:175], v6 offset:6144
M v[64:67], a[36:39], a[164:167], v[64:67]
 buffer_load_dwordx4 v10, s[16:19], s21 offen offset:2048  nt lds
M v[68:71], a[44:47], a[164:167], v[68:71]
M v[68:71], a[40:43], a[160:163], v[68:71]
M v[72:75], a[48:51], a[160:163], v[72:75]
 ds_read_b64_tr_b16 a[124:125], v4 offset:40960
 ds_read_b64_tr_b16 a[126:127], v4 offset:41984
M v[72:75], a[52:55], a[164:167], v[72:75]
 v_sub_f32 v48, v48, v27
 v_sub_f32 v49, v49, v27
M v[76:79], a[60:63], a[164:167], v[76:79]
 buffer_load_dwordx4 v11, s[16:19], s21 offen offset:3072  nt lds
M v[76:79], a[56:59], a[160:163], v[76:79]
 s_add_u32 s21, s21, 524160
 v_sub_f32 v50, v50, v27
 v_sub_f32 v51, v51, v27
M v[80:83], a[64:67], a[160:163], v[80:83]
 v_sub_f32 v52, v52, v27
 v_sub_f32 v53, v53, v27
M v[80:83], a[68:71], a[164:167], v[80:83]
 v_sub_f32 v54, v54, v27
 v_sub_f32 v55, v55, v27
M v[84:87], a[76:79], a[164:167], v[84:87]
 v_sub_f32 v56, v56, v27
 v_sub_f32 v57, v57, v27
M v[84:87], a[72:75], a[160:163], v[84:87]
 v_sub_f32 v58, v58, v27
 v_sub_f32 v59, v59, v27
M v[88:91], a[80:83], a[160:163], v[88:91]
 v_sub_f32 v60, v60, v27
 v_sub_f32 v61, v61, v27
M v[88:91], a[84:87], a[164:167], v[88:91]
 s_waitcnt lgkmcnt(2)
 v_sub_f32 v62, v62, v27
 v_sub_f32 v63, v63, v27
M v[92:95], a[92:95], a[164:167], v[92:95]
 s_waitcnt vmcnt(17) lgkmcnt(0)
M v[92:95], a[88:91], a[160:163], v[92:95]
 s_barrier
M v[124:127], a[88:91], a[168:171], v[124:127]
 ds_read_b128 a[160:163], v5 offset:16384
 ds_read_b128 a[164:167], v6 offset:16384
M v[124:127], a[92:95], a[172:175], v[124:127]
M v[120:123], a[84:87], a[172:175], v[120:123]
 s_add_u32 m0, s24, 0
 ds_read_b64_tr_b16 a[128:129], v1 offset:49152
 ds_read_b64_tr_b16 a[130:131], v1 offset:50176
M v[120:123], a[80:83], a[168:171], v[120:123]
 buffer_load_dwordx4 v12, s[48:51], s22 offen offset:0   lds
M v[116:119], a[72:75], a[168:171], v[116:119]
 v_sub_f32 v80, v80, v27
 v_sub_f32 v81, v81, v27
M v[116:119], a[76:79], a[172:175], v[116:119]
 v_sub_f32 v82, v82, v27
 v_sub_f32 v83, v83, v27
M v[112:115], a[68:71], a[172:175], v[112:115]
 v_sub_f32 v84, v84, v27
 v_sub_f32 v85, v85, v27
M v[112:115], a[64:67], a[168:171], v[112:115]
 v_sub_f32 v86, v86, v27
 v_sub_f32 v87, v87, v27
M v[108:111], a[56:59], a[168:171], v[108:111]
 v_sub_f32 v88, v88, v27
 v_sub_f32 v89, v89, v27
M v[108:111], a[60:63], a[172:175], v[108:111]
 ds_read_b64_tr_b16 a[132:133], v1 offset:57344
 ds_read_b64_tr_b16 a[134:135], v1 offset:58368
M v[104:107], a[52:55], a[172:175], v[104:107]
 buffer_load_dwordx4 v13, s[48:51], s22 offen offset:1024   lds
M v[104:107], a[48:51], a[168:171], v[104:107]
 v_sub_f32 v90, v90, v27
 v_sub_f32 v91, v91, v27
M v[100:103], a[40:43], a[168:171], v[100:103]
 v_sub_f32 v92, v92, v27
 v_sub_f32 v93, v93, v27
M v[100:103], a[44:47], a[172:175], v[100:103]
 s_waitcnt lgkmcnt(4)
 v_sub_f32 v94, v94, v27
 v_sub_f32 v95, v95, v27
M v[96:99], a[36:39], a[172:175], v[96:99]
M v[96:99], a[32:35], a[168:171], v[96:99]
M v[128:131], a[32:35], a[160:163], v[128:131]
 ds_read_b128 a[168:171], v5 offset:18432
 ds_read_b128 a[172:175], v6 offset:18432
M v[128:131], a[36:39], a[164:167], v[128:131]
 ds_read_b64_tr_b16 a[136:137], v2 offset:49152
 ds_read_b64_tr_b16 a[138:139], v2 offset:50176
M v[132:135], a[44:47], a[164:167], v[132:135]
 buffer_load_dwordx4 v14, s[48:51], s22 offen offset:2048   lds
M v[132:135], a[40:43], a[160:163], v[132:135]
M v[136:139], a[48:51], a[160:163], v[136:139]
 v_sub_f32 v112, v112, v27
 v_sub_f32 v113, v113, v27
M v[136:139], a[52:55], a[164:167], v[136:139]
 v_sub_f32 v114, v114, v27
 v_sub_f32 v115, v115, v27
M v[140:143], a[60:63], a[164:167], v[140:143]
 v_sub_f32 v116, v116, v27
 v_sub_f32 v117, v117, v27
M v[140:143], a[56:59], a[160:163], v[140:143]
 ds_read_b64_tr_b16 a[140:141], v2 offset:57344
 ds_read_b64_tr_b16 a[142:143], v2 offset:58368
M v[144:147], a[64:67], a[160:163], v[144:147]
 buffer_load_dwordx4 v15, s[48:51], s22 offen offset:3072   lds
M v[144:147], a[68:71], a[164:167], v[144:147]
 s_add_u32 s22, s22, 2097152
 v_sub_f32 v118, v118, v27
 v_sub_f32 v119, v119, v27
M v[148:151], a[76:79], a[164:167], v[148:151]
 v_sub_f32 v120, v120, v27
 v_sub_f32 v121, v121, v27
M v[148:151], a[72:75], a[160:163], v[148:151]
 v_sub_f32 v122, v122, v27
 v_sub_f32 v123, v123, v27
M v[152:155], a[80:83], a[160:163], v[152:155]
 v_sub_f32 v124, v124, v27
 v_sub_f32 v125, v125, v27
M v[152:155], a[84:87], a[164:167], v[152:155]
 s_waitcnt lgkmcnt(4)
 v_sub_f32 v126, v126, v27
 v_sub_f32 v127, v127, v27
M v[156:159], a[92:95], a[164:167], v[156:159]
 s_add_u32 m0, s23, 32768
 ds_read_b64_tr_b16 a[144:145], v3 offset:49152
 ds_read_b64_tr_b16 a[146:147], v3 offset:50176
M v[156:159], a[88:91], a[160:163], v[156:159]
 buffer_load_dwordx4 v8, s[16:19], s21 offen offset:0  nt lds
M v[188:191], a[88:91], a[168:171], v[188:191]
 ds_read_b128 a[160:163], v5 offset:20480
 ds_read_b128 a[164:167], v6 offset:20480
M v[188:191], a[92:95], a[172:175], v[188:191]
M v[184:187], a[84:87], a[172:175], v[184:187]
M v[184:187], a[80:83], a[168:171], v[184:187]
M v[180:183], a[72:75], a[168:171], v[180:183]
 v_sub_f32 v128, v128, v27
 v_sub_f32 v129, v129, v27
M v[180:183], a[76:79], a[172:175], v[180:183]
 ds_read_b64_tr_b16 a[148:149], v3 offset:57344
 ds_read_b64_tr_b16 a[150:151], v3 offset:58368
M v[176:179], a[68:71], a[172:175], v[176:179]
 buffer_load_dwordx4 v9, s[16:19], s21 offen offset:1024  nt lds
M v[176:179], a[64:67], a[168:171], v[176:179]
 v_sub_f32 v130, v130, v27
 v_sub_f32 v131, v131, v27
M v[172:175], a[56:59], a[168:171], v[172:175]
 v_sub_f32 v132, v132, v27
 v_sub_f32 v133, v133, v27
M v[172:175], a[60:63], a[172:175], v[172:175]
 v_sub_f32 v134, v134, v27
 v_sub_f32 v135, v135, v27
M v[168:171], a[52:55], a[172:175], v[168:171]
 v_sub_f32 v136, v136, v27
 v_sub_f32 v137, v137, v27
M v[168:171], a[48:51], a[168:171], v[168:171]
 v_sub_f32 v138, v138, v27
 v_sub_f32 v139, v139, v27
M v[164:167], a[40:43], a[168:171], v[164:167]
 ds_read_b64_tr_b16 a[152:153], v4 offset:49152
 ds_read_b64_tr_b16 a[154:155], v4 offset:50176
M v[164:167], a[44:47], a[172:175], v[164:167]
 s_waitcnt lgkmcnt(4)
 v_sub_f32 v140, v140, v27
 v_sub_f32 v141, v141, v27
M v[160:163], a[36:39], a[172:175], v[160:163]
 buffer_load_dwordx4 v10, s[16:19], s21 offen offset:2048  nt lds
M v[160:163], a[32:35], a[168:171], v[160:163]
 v_sub_f32 v142, v142, v27
 v_sub_f32 v143, v143, v27
M v[192:195], a[32:35], a[160:163], v[192:195]
 ds_read_b128 a[168:171], v5 offset:22528
 ds_read_b128 a[172:175], v6 offset:22528
M v[192:195], a[36:39], a[164:167], v[192:195]
 v_sub_f32 v144, v144, v27
 v_sub_f32 v145, v145, v27
M v[196:199], a[44:47], a[164:167], v[196:199]
 v_sub_f32 v146, v146, v27
 v_sub_f32 v147, v147, v27
M v[196:199], a[40:43], a[160:163], v[196:199]
 ds_read_b64_tr_b16 a[156:157], v4 offset:57344
 ds_read_b64_tr_b16 a[158:159], v4 offset:58368
M v[200:203], a[48:51], a[160:163], v[200:203]
 buffer_load_dwordx4 v11, s[16:19], s21 offen offset:3072  nt lds
M v[200:203], a[52:55], a[164:167], v[200:203]
 s_add_u32 s21, s21, 128
 v_sub_f32 v148, v148, v27
 v_sub_f32 v149, v149, v27
M v[204:207], a[60:63], a[164:167], v[204:207]
 v_sub_f32 v150, v150, v27
 v_sub_f32 v151, v151, v27
M v[204:207], a[56:59], a[160:163], v[204:207]
 v_sub_f32 v152, v152, v27
 v_sub_f32 v153, v153, v27
M v[208:211], a[64:67], a[160:163], v[208:211]
 v_sub_f32 v154, v154, v27
 v_sub_f32 v155, v155, v27
M v[208:211], a[68:71], a[164:167], v[208:211]
 v_sub_f32 v156, v156, v27
 v_sub_f32 v157, v157, v27
M v[212:215], a[76:79], a[164:167], v[212:215]
 v_sub_f32 v158, v158, v27
 v_sub_f32 v159, v159, v27
M v[212:215], a[72:75], a[160:163], v[212:215]
M v[216:219], a[80:83], a[160:163], v[216:219]
M v[216:219], a[84:87], a[164:167], v[216:219]
 s_waitcnt lgkmcnt(2)
M v[220:223], a[92:95], a[164:167], v[220:223]
 s_waitcnt vmcnt(17) lgkmcnt(0)
M v[220:223], a[88:91], a[160:163], v[220:223]
 s_barrier
M v[252:255], a[88:91], a[168:171], v[252:255]
 ds_read_b128 a[160:163], v5 offset:32768
 ds_read_b128 a[164:167], v6 offset:32768
M v[252:255], a[92:95], a[172:175], v[252:255]
 buffer_load_dword a240, v23, s[52:55], 0 offen offset:0
M v[248:251], a[84:87], a[172:175], v[248:251]
 v_add_u32 v23, 16384, v23
M v[248:251], a[80:83], a[168:171], v[248:251]
M v[244:247], a[72:75], a[168:171], v[244:247]
M v[244:247], a[76:79], a[172:175], v[244:247]
M v[240:243], a[68:71], a[172:175], v[240:243]
M v[240:243], a[64:67], a[168:171], v[240:243]
M v[236:239], a[56:59], a[168:171], v[236:239]
M v[236:239], a[60:63], a[172:175], v[236:239]
M v[232:235], a[52:55], a[172:175], v[232:235]
M v[232:235], a[48:51], a[168:171], v[232:235]
M v[228:231], a[40:43], a[168:171], v[228:231]
M v[228:231], a[44:47], a[172:175], v[228:231]
 s_waitcnt lgkmcnt(0)
M v[224:227], a[36:39], a[172:175], v[224:227]
M v[224:227], a[32:35], a[168:171], v[224:227]
M a[0:3], a[96:99], a[160:163], a[0:3]
 ds_read_b128 a[168:171], v5 offset:34816
 ds_read_b128 a[172:175], v6 offset:34816
M a[0:3], a[100:103], a[164:167], a[0:3]
 ds_read_b64_tr_b16 a[32:33], v1 offset:0
 ds_read_b64_tr_b16 a[34:35], v1 offset:1024
M a[4:7], a[108:111], a[164:167], a[4:7]
 s_add_u32 m0, s24, 16384
M a[4:7], a[104:107], a[160:163], a[4:7]
 buffer_load_dwordx4 v12, s[48:51], s22 offen offset:0   lds
M a[8:11], a[112:115], a[160:163], a[8:11]
M a[8:11], a[116:119], a[164:167], a[8:11]
M a[12:15], a[124:127], a[164:167], a[12:15]
 ds_read_b64_tr_b16 a[36:37], v1 offset:8192
 ds_read_b64_tr_b16 a[38:39], v1 offset:9216
M a[12:15], a[120:123], a[160:163], a[12:15]
M a[16:19], a[128:131], a[160:163], a[16:19]
 buffer_load_dwordx4 v13, s[48:51], s22 offen offset:1024   lds
M a[16:19], a[132:135], a[164:167], a[16:19]
M a[20:23], a[140:143], a[164:167], a[20:23]
M a[20:23], a[136:139], a[160:163], a[20:23]
 ds_read_b64_tr_b16 a[40:41], v2 offset:0
 ds_read_b64_tr_b16 a[42:43], v2 offset:1024
M a[24:27], a[144:147], a[160:163], a[24:27]
M a[24:27], a[148:151], a[164:167], a[24:27]
 s_waitcnt lgkmcnt(6)
M a[28:31], a[156:159], a[164:167], a[28:31]
 buffer_load_dwordx4 v14, s[48:51], s22 offen offset:2048   lds
M a[28:31], a[152:155], a[160:163], a[28:31]
M v[60:63], a[152:155], a[168:171], v[60:63]
 ds_read_b128 a[160:163], v5 offset:36864
 ds_read_b128 a[164:167], v6 offset:36864
M v[60:63], a[156:159], a[172:175], v[60:63]
 ds_read_b64_tr_b16 a[44:45], v2 offset:8192
 ds_read_b64_tr_b16 a[46:47], v2 offset:9216
M v[56:59], a[148:151], a[172:175], v[56:59]
 buffer_load_dwordx4 v15, s[48:51], s22 offen offset:3072   lds
M v[56:59], a[144:147], a[168:171], v[56:59]
 s_sub_u32 s22, s22, 2097024
M v[52:55], a[136:139], a[168:171], v[52:55]
M v[52:55], a[140:143], a[172:175], v[52:55]
 ds_read_b64_tr_b16 a[48:49], v3 offset:0
 ds_read_b64_tr_b16 a[50:51], v3 offset:1024
M v[48:51], a[132:135], a[172:175], v[48:51]
 s_add_u32 m0, s23, 49152
M v[48:51], a[128:131], a[168:171], v[48:51]
 buffer_load_dwordx4 v8, s[16:19], s21 offen offset:0  nt lds
M v[44:47], a[120:123], a[168:171], v[44:47]
M v[44:47], a[124:127], a[172:175], v[44:47]
M v[40:43], a[116:119], a[172:175], v[40:43]
 ds_read_b64_tr_b16 a[52:53], v3 offset:8192
 ds_read_b64_tr_b16 a[54:55], v3 offset:9216
M v[40:43], a[112:115], a[168:171], v[40:43]
M v[36:39], a[104:107], a[168:171], v[36:39]
 buffer_load_dwordx4 v9, s[16:19], s21 offen offset:1024  nt lds
M v[36:39], a[108:111], a[172:175], v[36:39]
 s_waitcnt lgkmcnt(6)
M v[32:35], a[100:103], a[172:175], v[32:35]
M v[32:35], a[96:99], a[168:171], v[32:35]
 ds_read_b64_tr_b16 a[56:57], v4 offset:0
 ds_read_b64_tr_b16 a[58:59], v4 offset:1024
M v[64:67], a[96:99], a[160:163], v[64:67]
 ds_read_b128 a[168:171], v5 offset:38912
 ds_read_b128 a[172:175], v6 offset:38912
M v[64:67], a[100:103], a[164:167], v[64:67]
 buffer_load_dwordx4 v10, s[16:19], s21 offen offset:2048  nt lds
M v[68:71], a[108:111], a[164:167], v[68:71]
M v[68:71], a[104:107], a[160:163], v[68:71]
M v[72:75], a[112:115], a[160:163], v[72:75]
 ds_read_b64_tr_b16 a[60:61], v4 offset:8192
 ds_read_b64_tr_b16 a[62:63], v4 offset:9216
M v[72:75], a[116:119], a[164:167], v[72:75]
M v[76:79], a[124:127], a[164:167], v[76:79]
 buffer_load_dwordx4 v11, s[16:19], s21 offen offset:3072  nt lds
M v[76:79], a[120:123], a[160:163], v[76:79]
 s_add_u32 s21, s21, 524160
M v[80:83], a[128:131], a[160:163], v[80:83]
M v[80:83], a[132:135], a[164:167], v[80:83]
M v[84:87], a[140:143], a[164:167], v[84:87]
M v[84:87], a[136:139], a[160:163], v[84:87]
M v[88:91], a[144:147], a[160:163], v[88:91]
M v[88:91], a[148:151], a[164:167], v[88:91]
 s_waitcnt lgkmcnt(2)
M v[92:95], a[156:159], a[164:167], v[92:95]
 s_waitcnt vmcnt(17) lgkmcnt(0)
M v[92:95], a[152:155], a[160:163], v[92:95]
 s_barrier
M v[124:127], a[152:155], a[168:171], v[124:127]
 ds_read_b128 a[160:163], v5 offset:49152
 ds_read_b128 a[164:167], v6 offset:49152
M v[124:127], a[156:159], a[172:175], v[124:127]
M v[120:123], a[148:151], a[172:175], v[120:123]
 s_add_u32 m0, s24, 32768
 ds_read_b64_tr_b16 a[64:65], v1 offset:16384
 ds_read_b64_tr_b16 a[66:67], v1 offset:17408
M v[120:123], a[144:147], a[168:171], v[120:123]
 buffer_load_dwordx4 v12, s[48:51], s22 offen offset:0   lds
M v[116:119], a[136:139], a[168:171], v[116:119]
M v[116:119], a[140:143], a[172:175], v[116:119]
M v[112:115], a[132:135], a[172:175], v[112:115]
M v[112:115], a[128:131], a[168:171], v[112:115]
M v[108:111], a[120:123], a[168:171], v[108:111]
M v[108:111], a[124:127], a[172:175], v[108:111]
 ds_read_b64_tr_b16 a[68:69], v1 offset:24576
 ds_read_b64_tr_b16 a[70:71], v1 offset:25600
M v[104:107], a[116:119], a[172:175], v[104:107]
 buffer_load_dwordx4 v13, s[48:51], s22 offen offset:1024   lds
M v[104:107], a[112:115], a[168:171], v[104:107]
M v[100:103], a[104:107], a[168:171], v[100:103]
M v[100:103], a[108:111], a[172:175], v[100:103]
 s_waitcnt lgkmcnt(4)
M v[96:99], a[100:103], a[172:175], v[96:99]
M v[96:99], a[96:99], a[168:171], v[96:99]
M v[128:131], a[96:99], a[160:163], v[128:131]
 ds_read_b128 a[168:171], v5 offset:51200
 ds_read_b128 a[172:175], v6 offset:51200
M v[128:131], a[100:103], a[164:167], v[128:131]
 ds_read_b64_tr_b16 a[72:73], v2 offset:16384
 ds_read_b64_tr_b16 a[74:75], v2 offset:17408
M v[132:135], a[108:111], a[164:167], v[132:135]
 buffer_load_dwordx4 v14, s[48:51], s22 offen offset:2048   lds
M v[132:135], a[104:107], a[160:163], v[132:135]
M v[136:139], a[112:115], a[160:163], v[136:139]
M v[136:139], a[116:119], a[164:167], v[136:139]
M v[140:143], a[124:127], a[164:167], v[140:143]
M v[140:143], a[120:123], a[160:163], v[140:143]
 ds_read_b64_tr_b16 a[76:77], v2 offset:24576
 ds_read_b64_tr_b16 a[78:79], v2 offset:25600
M v[144:147], a[128:131], a[160:163], v[144:147]
 buffer_load_dwordx4 v15, s[48:51], s22 offen offset:3072   lds
M v[144:147], a[132:135], a[164:167], v[144:147]
 s_add_u32 s22, s22, 2097152
M v[148:151], a[140:143], a[164:167], v[148:151]
M v[148:151], a[136:139], a[160:163], v[148:151]
M v[152:155], a[144:147], a[160:163], v[152:155]
M v[152:155], a[148:151], a[164:167], v[152:155]
 s_waitcnt lgkmcnt(4)
M v[156:159], a[156:159], a[164:167], v[156:159]
 s_add_u32 m0, s23, 0
 ds_read_b64_tr_b16 a[80:81], v3 offset:16384
 ds_read_b64_tr_b16 a[82:83], v3 offset:17408
M v[156:159], a[152:155], a[160:163], v[156:159]
 buffer_load_dwordx4 v8, s[52:55], s28 offen offset:0   lds
M v[188:191], a[152:155], a[168:171], v[188:191]
 ds_read_b128 a[160:163], v5 offset:53248
 ds_read_b128 a[164:167], v6 offset:53248
M v[188:191], a[156:159], a[172:175], v[188:191]
M v[184:187], a[148:151], a[172:175], v[184:187]
M v[184:187], a[144:147], a[168:171], v[184:187]
M v[180:183], a[136:139], a[168:171], v[180:183]
M v[180:183], a[140:143], a[172:175], v[180:183]
 ds_read_b64_tr_b16 a[84:85], v3 offset:24576
 ds_read_b64_tr_b16 a[86:87], v3 offset:25600
M v[176:179], a[132:135], a[172:175], v[176:179]
 buffer_load_dwordx4 v9, s[52:55], s28 offen offset:1024   lds
M v[176:179], a[128:131], a[168:171], v[176:179]
M v[172:175], a[120:123], a[168:171], v[172:175]
M v[172:175], a[124:127], a[172:175], v[172:175]
M v[168:171], a[116:119], a[172:175], v[168:171]
M v[168:171], a[112:115], a[168:171], v[168:171]
M v[164:167], a[104:107], a[168:171], v[164:167]
 ds_read_b64_tr_b16 a[88:89], v4 offset:16384
 ds_read_b64_tr_b16 a[90:91], v4 offset:17408
M v[164:167], a[108:111], a[172:175], v[164:167]
 s_waitcnt lgkmcnt(4)
M v[160:163], a[100:103], a[172:175], v[160:163]
 buffer_load_dwordx4 v10, s[52:55], s28 offen offset:2048   lds
M v[160:163], a[96:99], a[168:171], v[160:163]
M v[192:195], a[96:99], a[160:163], v[192:195]
 ds_read_b128 a[168:171], v5 offset:55296
 ds_read_b128 a[172:175], v6 offset:55296
M v[192:195], a[100:103], a[164:167], v[192:195]
M v[196:199], a[108:111], a[164:167], v[196:199]
M v[196:199], a[104:107], a[160:163], v[196:199]
 ds_read_b64_tr_b16 a[92:93], v4 offset:24576
 ds_read_b64_tr_b16 a[94:95], v4 offset:25600
M v[200:203], a[112:115], a[160:163], v[200:203]
 buffer_load_dwordx4 v11, s[52:55], s28 offen offset:3072   lds
M v[200:203], a[116:119], a[164:167], v[200:203]
 s_add_u32 s28, s28, 128
 v_sub_f32 v160, v160, v27
 v_sub_f32 v161, v161, v27
M v[204:207], a[124:127], a[164:167], v[204:207]
 v_sub_f32 v162, v162, v27
 v_sub_f32 v163, v163, v27
M v[204:207], a[120:123], a[160:163], v[204:207]
 v_sub_f32 v164, v164, v27
 v_sub_f32 v165, v165, v27
M v[208:211], a[128:131], a[160:163], v[208:211]
 v_sub_f32 v166, v166, v27
 v_sub_f32 v167, v167, v27
M v[208:211], a[132:135], a[164:167], v[208:211]
 v_sub_f32 v168, v168, v27
 v_sub_f32 v169, v169, v27
M v[212:215], a[140:143], a[164:167], v[212:215]
 v_sub_f32 v170, v170, v27
 v_sub_f32 v171, v171, v27
M v[212:215], a[136:139], a[160:163], v[212:215]
 v_sub_f32 v172, v172, v27
 v_sub_f32 v173, v173, v27
M v[216:219], a[144:147], a[160:163], v[216:219]
 v_sub_f32 v174, v174, v27
 v_sub_f32 v175, v175, v27
M v[216:219], a[148:151], a[164:167], v[216:219]
 s_waitcnt lgkmcnt(2)
 v_sub_f32 v176, v176, v27
 v_sub_f32 v177, v177, v27
M v[220:223], a[156:159], a[164:167], v[220:223]
 s_waitcnt vmcnt(17) lgkmcnt(0)
 v_sub_f32 v178, v178, v27
 v_sub_f32 v179, v179, v27
M v[220:223], a[152:155], a[160:163], v[220:223]
 s_barrier
M v[252:255], a[152:155], a[168:171], v[252:255]
 ds_read_b128 a[160:163], v5 offset:0
 ds_read_b128 a[164:167], v6 offset:0
M v[252:255], a[156:159], a[172:175], v[252:255]
 v_and_b32 v26, 48, v0
 v_lshlrev_b32 v26, 17, v26
M v[248:251], a[148:151], a[172:175], v[248:251]
 v_or_b32 v26, v26, v0
 v_lshl_add_u32 v26, v26, 7, s95
M v[248:251], a[144:147], a[168:171], v[248:251]
 buffer_load_dword a240, v26, s[76:79], 0 offen offset:0
M v[244:247], a[136:139], a[168:171], v[244:247]
 v_sub_f32 v180, v180, v27
 v_sub_f32 v181, v181, v27
M v[244:247], a[140:143], a[172:175], v[244:247]
 v_sub_f32 v182, v182, v27
 v_sub_f32 v183, v183, v27
M v[240:243], a[132:135], a[172:175], v[240:243]
 v_sub_f32 v184, v184, v27
 v_sub_f32 v185, v185, v27
M v[240:243], a[128:131], a[168:171], v[240:243]
 v_sub_f32 v186, v186, v27
 v_sub_f32 v187, v187, v27
M v[236:239], a[120:123], a[168:171], v[236:239]
 v_sub_f32 v188, v188, v27
 v_sub_f32 v189, v189, v27
M v[236:239], a[124:127], a[172:175], v[236:239]
 v_sub_f32 v190, v190, v27
 v_sub_f32 v191, v191, v27
M v[232:235], a[116:119], a[172:175], v[232:235]
 v_sub_f32 v192, v192, v27
 v_sub_f32 v193, v193, v27
M v[232:235], a[112:115], a[168:171], v[232:235]
 v_sub_f32 v194, v194, v27
 v_sub_f32 v195, v195, v27
M v[228:231], a[104:107], a[168:171], v[228:231]
 v_sub_f32 v196, v196, v27
 v_sub_f32 v197, v197, v27
M v[228:231], a[108:111], a[172:175], v[228:231]
 s_waitcnt lgkmcnt(0)
 v_sub_f32 v198, v198, v27
 v_sub_f32 v199, v199, v27
M v[224:227], a[100:103], a[172:175], v[224:227]
 v_sub_f32 v200, v200, v27
 v_sub_f32 v201, v201, v27
M v[224:227], a[96:99], a[168:171], v[224:227]
 v_sub_f32 v202, v202, v27
 v_sub_f32 v203, v203, v27
M a[0:3], a[32:35], a[160:163], a[0:3]
 ds_read_b128 a[168:171], v5 offset:2048
 ds_read_b128 a[172:175], v6 offset:2048
M a[0:3], a[36:39], a[164:167], a[0:3]
 ds_read_b64_tr_b16 a[96:97], v1 offset:32768
 ds_read_b64_tr_b16 a[98:99], v1 offset:33792
M a[4:7], a[44:47], a[164:167], a[4:7]
 s_add_u32 m0, s24, 49152
 v_lshrrev_b32 v28, 4, v0
 v_add_u32 v28, 0, v28
M a[4:7], a[40:43], a[160:163], a[4:7]
 buffer_load_dwordx4 v12, s[48:51], s22 offen offset:0   lds
M a[8:11], a[48:51], a[160:163], a[8:11]
 v_and_b32 v29, 7, v0
 v_xor_b32 v28, v28, v29
M a[8:11], a[52:55], a[164:167], a[8:11]
 v_lshlrev_b32 v28, 4, v28
 v_lshrrev_b32 v29, 3, v0
M a[12:15], a[60:63], a[164:167], a[12:15]
 ds_read_b64_tr_b16 a[100:101], v1 offset:40960
 ds_read_b64_tr_b16 a[102:103], v1 offset:41984
M a[12:15], a[56:59], a[160:163], a[12:15]
 buffer_load_dwordx4 v13, s[48:51], s22 offen offset:1024   lds
M a[16:19], a[64:67], a[160:163], a[16:19]
 v_mul_u32_u24 v29, 896, v29
 s_mul_i32 s64, s20, 28672
M a[16:19], a[68:71], a[164:167], a[16:19]
 buffer_load_dwordx4 v14, s[48:51], s22 offen offset:2048   lds
M a[20:23], a[76:79], a[164:167], a[20:23]
 s_add_u32 s64, s64, 0
 v_add3_u32 v16, v29, v28, s64
M a[20:23], a[72:75], a[160:163], a[20:23]
 ds_read_b64_tr_b16 a[104:105], v2 offset:32768
 ds_read_b64_tr_b16 a[106:107], v2 offset:33792
M a[24:27], a[80:83], a[160:163], a[24:27]
 v_add_u32 v18, 12288, v16
 v_lshrrev_b32 v28, 4, v0
M a[24:27], a[84:87], a[164:167], a[24:27]
 s_waitcnt lgkmcnt(6)
 v_add_u32 v28, 4, v28
 v_and_b32 v29, 7, v0
M a[28:31], a[92:95], a[164:167], a[28:31]
 buffer_load_dwordx4 v15, s[48:51], s22 offen offset:3072   lds
M a[28:31], a[88:91], a[160:163], a[28:31]
 s_sub_u32 s22, s22, 2097024
 v_xor_b32 v28, v28, v29
 v_lshlrev_b32 v28, 4, v28
M v[60:63], a[88:91], a[168:171], v[60:63]
 s_add_u32 m0, s23, 16384
 ds_read_b128 a[160:163], v5 offset:4096
 ds_read_b128 a[164:167], v6 offset:4096
M v[60:63], a[92:95], a[172:175], v[60:63]
 ds_read_b64_tr_b16 a[108:109], v2 offset:40960
 ds_read_b64_tr_b16 a[110:111], v2 offset:41984
M v[56:59], a[84:87], a[172:175], v[56:59]
 buffer_load_dwordx4 v8, s[52:55], s28 offen offset:0   lds
M v[56:59], a[80:83], a[168:171], v[56:59]
 v_lshrrev_b32 v29, 3, v0
 v_mul_u32_u24 v29, 896, v29
M v[52:55], a[72:75], a[168:171], v[52:55]
 buffer_load_dwordx4 v9, s[52:55], s28 offen offset:1024   lds
M v[52:55], a[76:79], a[172:175], v[52:55]
 ds_read_b64_tr_b16 a[112:113], v3 offset:32768
 ds_read_b64_tr_b16 a[114:115], v3 offset:33792
M v[48:51], a[68:71], a[172:175], v[48:51]
 s_mul_i32 s64, s20, 28672
 s_add_u32 s64, s64, 6144
M v[48:51], a[64:67], a[168:171], v[48:51]
 buffer_load_dwordx4 v10, s[52:55], s28 offen offset:2048   lds
M v[44:47], a[56:59], a[168:171], v[44:47]
 v_add3_u32 v17, v29, v28, s64
 v_add_u32 v19, 12288, v17
M v[44:47], a[60:63], a[172:175], v[44:47]
 v_add_u32 v20, 0x20000, v1
 v_add_u32 v21, 0x20000, v2
M v[40:43], a[52:55], a[172:175], v[40:43]
 ds_read_b64_tr_b16 a[116:117], v3 offset:40960
 ds_read_b64_tr_b16 a[118:119], v3 offset:41984
M v[40:43], a[48:51], a[168:171], v[40:43]
 buffer_load_dwordx4 v11, s[52:55], s28 offen offset:3072   lds
M v[36:39], a[40:43], a[168:171], v[36:39]
 s_add_u32 s28, s28, 1048448
 v_add_u32 v22, 0x20000, v3
 v_add_u32 v23, 0x20000, v4
M v[36:39], a[44:47], a[172:175], v[36:39]
 s_waitcnt lgkmcnt(6)
 v_sub_f32 v204, v204, v27
 v_sub_f32 v205, v205, v27
M v[32:35], a[36:39], a[172:175], v[32:35]
 s_add_u32 m0, s23, 131072
 v_sub_f32 v206, v206, v27
 v_sub_f32 v207, v207, v27
M v[32:35], a[32:35], a[168:171], v[32:35]
 ds_read_b64_tr_b16 a[120:121], v4 offset:32768
 ds_read_b64_tr_b16 a[122:123], v4 offset:33792
M v[64:67], a[32:35], a[160:163], v[64:67]
 ds_read_b128 a[168:171], v5 offset:6144
 ds_read_b128 a[172:175], v6 offset:6144
M v[64:67], a[36:39], a[164:167], v[64:67]
 buffer_load_dwordx4 v8, s[52:55], s28 offen offset:0   lds
M v[68:71], a[44:47], a[164:167], v[68:71]
 buffer_load_dwordx4 v9, s[52:55], s28 offen offset:1024   lds
M v[68:71], a[40:43], a[160:163], v[68:71]
 v_sub_f32 v208, v208, v27
 v_sub_f32 v209, v209, v27
M v[72:75], a[48:51], a[160:163], v[72:75]
 ds_read_b64_tr_b16 a[124:125], v4 offset:40960
 ds_read_b64_tr_b16 a[126:127], v4 offset:41984
M v[72:75], a[52:55], a[164:167], v[72:75]
 buffer_load_dwordx4 v10, s[52:55], s28 offen offset:2048   lds
M v[76:79], a[60:63], a[164:167], v[76:79]
 v_sub_f32 v210, v210, v27
 v_sub_f32 v211, v211, v27
M v[76:79], a[56:59], a[160:163], v[76:79]
 v_sub_f32 v212, v212, v27
 v_sub_f32 v213, v213, v27
M v[80:83], a[64:67], a[160:163], v[80:83]
 buffer_load_dwordx4 v11, s[52:55], s28 offen offset:3072   lds
M v[80:83], a[68:71], a[164:167], v[80:83]
 s_sub_u32 s28, s28, 524288
 v_sub_f32 v214, v214, v27
 v_sub_f32 v215, v215, v27
M v[84:87], a[76:79], a[164:167], v[84:87]
 v_sub_f32 v216, v216, v27
 v_sub_f32 v217, v217, v27
M v[84:87], a[72:75], a[160:163], v[84:87]
 v_sub_f32 v218, v218, v27
 v_sub_f32 v219, v219, v27
M v[88:91], a[80:83], a[160:163], v[88:91]
 v_sub_f32 v220, v220, v27
 v_sub_f32 v221, v221, v27
M v[88:91], a[84:87], a[164:167], v[88:91]
 s_waitcnt lgkmcnt(2)
 v_sub_f32 v222, v222, v27
 v_sub_f32 v223, v223, v27
M v[92:95], a[92:95], a[164:167], v[92:95]
 s_waitcnt vmcnt(21) lgkmcnt(0)
 v_sub_f32 v224, v224, v27
 v_sub_f32 v225, v225, v27
M v[92:95], a[88:91], a[160:163], v[92:95]
 s_barrier
M v[124:127], a[88:91], a[168:171], v[124:127]
 ds_read_b128 a[160:163], v5 offset:16384
 ds_read_b128 a[164:167], v6 offset:16384
M v[124:127], a[92:95], a[172:175], v[124:127]
 v_sub_f32 v226, v226, v27
 v_sub_f32 v227, v227, v27
M v[120:123], a[84:87], a[172:175], v[120:123]
 s_add_u32 m0, s24, 0
 ds_read_b64_tr_b16 a[128:129], v1 offset:49152
 ds_read_b64_tr_b16 a[130:131], v1 offset:50176
M v[120:123], a[80:83], a[168:171], v[120:123]
 buffer_load_dwordx4 v16, s[56:59], s29 offen offset:0   lds
M v[116:119], a[72:75], a[168:171], v[116:119]
 s_mul_i32 s72, s41, 16512
 v_sub_f32 v228, v228, v27
M v[116:119], a[76:79], a[172:175], v[116:119]
 s_add_u32 s46, s72, 234946560
 v_sub_f32 v229, v229, v27
 v_sub_f32 v230, v230, v27
M v[112:115], a[68:71], a[172:175], v[112:115]
 s_and_b32 s64, s41, 7
 s_lshr_b32 s64, s101, s64
 s_and_b32 s64, s64, 1
M v[112:115], a[64:67], a[168:171], v[112:115]
 buffer_load_dwordx4 v17, s[56:59], s29 offen offset:1024   lds
M v[108:111], a[56:59], a[168:171], v[108:111]
 s_lshl_b32 s64, s64, 13
 v_sub_f32 v231, v231, v27
M v[108:111], a[60:63], a[172:175], v[108:111]
 s_add_u32 s46, s46, s64
 ds_read_b64_tr_b16 a[132:133], v1 offset:57344
 ds_read_b64_tr_b16 a[134:135], v1 offset:58368
M v[104:107], a[52:55], a[172:175], v[104:107]
 s_lshl_b32 s45, s42, 7
 v_sub_f32 v232, v232, v27
 v_sub_f32 v233, v233, v27
M v[104:107], a[48:51], a[168:171], v[104:107]
 s_add_u32 s45, s45, s46
 s_sub_u32 s66, 15, s42
 s_min_u32 s66, s66, s42
M v[100:103], a[40:43], a[168:171], v[100:103]
 buffer_load_dwordx4 v18, s[56:59], s29 offen offset:2048   lds
M v[100:103], a[44:47], a[172:175], v[100:103]
 s_waitcnt lgkmcnt(4)
 s_lshl_b32 s47, s66, 7
 v_sub_f32 v234, v234, v27
M v[96:99], a[36:39], a[172:175], v[96:99]
 s_add_u32 s47, s47, s46
 v_sub_f32 v235, v235, v27
 v_sub_f32 v236, v236, v27
M v[96:99], a[32:35], a[168:171], v[96:99]
 s_add_u32 s47, s47, 2048
 v_sub_f32 v237, v237, v27
 v_sub_f32 v238, v238, v27
M v[128:131], a[32:35], a[160:163], v[128:131]
 s_lshl2_add_u32 s47, s20, s47
 ds_read_b128 a[168:171], v5 offset:18432
 ds_read_b128 a[172:175], v6 offset:18432
M v[128:131], a[36:39], a[164:167], v[128:131]
 s_lshl_b32 s65, s27, 3
 ds_read_b64_tr_b16 a[136:137], v2 offset:49152
 ds_read_b64_tr_b16 a[138:139], v2 offset:50176
M v[132:135], a[44:47], a[164:167], v[132:135]
 buffer_load_dwordx4 v19, s[56:59], s29 offen offset:3072   lds
M v[132:135], a[40:43], a[160:163], v[132:135]
 s_add_u32 s29, s29, 128
 s_add_u32 s65, s65, s66
 v_sub_f32 v239, v239, v27
M v[136:139], a[48:51], a[160:163], v[136:139]
 s_mul_i32 s34, s65, 262144
 s_add_u32 s34, s34, 167772160
 s_lshl_b32 s65, s42, 4
M v[136:139], a[52:55], a[164:167], v[136:139]
 s_add_u32 m0, s23, 32768
 s_add_u32 s65, s65, s41
 s_mul_i32 s33, s65, 262144
M v[140:143], a[60:63], a[164:167], v[140:143]
 buffer_load_dwordx4 v8, s[52:55], s28 offen offset:0   lds
M v[140:143], a[56:59], a[160:163], v[140:143]
 ds_read_b64_tr_b16 a[140:141], v2 offset:57344
 ds_read_b64_tr_b16 a[142:143], v2 offset:58368
M v[144:147], a[64:67], a[160:163], v[144:147]
 s_mul_i32 s65, s20, 65536
 v_sub_f32 v240, v240, v27
M v[144:147], a[68:71], a[164:167], v[144:147]
 s_add_u32 s33, s33, s65
 s_add_u32 s33, s33, 67108864
 s_sub_u32 s65, 15, s66
M v[148:151], a[76:79], a[164:167], v[148:151]
 buffer_load_dwordx4 v9, s[52:55], s28 offen offset:1024   lds
M v[148:151], a[72:75], a[160:163], v[148:151]
 s_lshl_b32 s65, s65, 17
 v_sub_f32 v241, v241, v27
M v[152:155], a[80:83], a[160:163], v[152:155]
 s_lshl_b32 s64, s27, 21
 s_add_u32 s32, s64, s65
 s_lshl_b32 s65, s20, 15
M v[152:155], a[84:87], a[164:167], v[152:155]
 s_waitcnt lgkmcnt(4)
 s_add_u32 s32, s32, s65
 v_sub_f32 v242, v242, v27
M v[156:159], a[92:95], a[164:167], v[156:159]
 s_add_u32 s32, s32, 134217728
 ds_read_b64_tr_b16 a[144:145], v3 offset:49152
 ds_read_b64_tr_b16 a[146:147], v3 offset:50176
M v[156:159], a[88:91], a[160:163], v[156:159]
 buffer_load_dwordx4 v10, s[52:55], s28 offen offset:2048   lds
M v[188:191], a[88:91], a[168:171], v[188:191]
 ds_read_b128 a[160:163], v5 offset:20480
 ds_read_b128 a[164:167], v6 offset:20480
M v[188:191], a[92:95], a[172:175], v[188:191]
 s_and_b32 s64, s41, 7
 v_sub_f32 v243, v243, v27
M v[184:187], a[84:87], a[172:175], v[184:187]
 s_lshr_b32 s64, s101, s64
 v_sub_f32 v244, v244, v27
 v_sub_f32 v245, v245, v27
M v[184:187], a[80:83], a[168:171], v[184:187]
 s_lshr_b32 s65, s41, 3
 s_xor_b32 s64, s64, s65
 s_and_b32 s64, s64, 1
M v[180:183], a[72:75], a[168:171], v[180:183]
 buffer_load_dwordx4 v11, s[52:55], s28 offen offset:3072   lds
M v[180:183], a[76:79], a[172:175], v[180:183]
 s_add_u32 s28, s28, 524416
 ds_read_b64_tr_b16 a[148:149], v3 offset:57344
 ds_read_b64_tr_b16 a[150:151], v3 offset:58368
M v[176:179], a[68:71], a[172:175], v[176:179]
 s_lshl_b32 s92, s64, 13
 v_sub_f32 v246, v246, v27
M v[176:179], a[64:67], a[168:171], v[176:179]
 s_add_u32 s93, s93, s92
 s_add_u32 s34, s34, s92
 s_add_u32 s32, s32, s92
M v[172:175], a[56:59], a[168:171], v[172:175]
 s_add_u32 m0, s23, 147456
 s_lshl_b32 s64, s20, 1
 s_lshr_b32 s64, s101, s64
M v[172:175], a[60:63], a[172:175], v[172:175]
 buffer_load_dwordx4 v8, s[52:55], s28 offen offset:0   lds
M v[168:171], a[52:55], a[172:175], v[168:171]
 s_xor_b32 s64, s64, s65
 v_sub_f32 v247, v247, v27
M v[168:171], a[48:51], a[168:171], v[168:171]
 s_and_b32 s64, s64, 1
 v_sub_f32 v248, v248, v27
 v_sub_f32 v249, v249, v27
M v[164:167], a[40:43], a[168:171], v[164:167]
 s_lshl_b32 s64, s64, 13
 ds_read_b64_tr_b16 a[152:153], v4 offset:49152
 ds_read_b64_tr_b16 a[154:155], v4 offset:50176
M v[164:167], a[44:47], a[172:175], v[164:167]
 s_waitcnt lgkmcnt(4)
 s_add_u32 s33, s33, s64
 s_mov_b32 s31, 0x53800000
M v[160:163], a[36:39], a[172:175], v[160:163]
 buffer_load_dwordx4 v9, s[52:55], s28 offen offset:1024   lds
M v[160:163], a[32:35], a[168:171], v[160:163]
 s_mov_b32 s40, 1
 v_sub_f32 v250, v250, v27
M v[192:195], a[32:35], a[160:163], v[192:195]
 s_sub_u32 s64, s42, 10
 ds_read_b128 a[168:171], v5 offset:22528
 ds_read_b128 a[172:175], v6 offset:22528
M v[192:195], a[36:39], a[164:167], v[192:195]
 s_and_b32 s35, s64, 536870912
 v_sub_f32 v251, v251, v27
 v_sub_f32 v252, v252, v27
M v[196:199], a[44:47], a[164:167], v[196:199]
 buffer_load_dwordx4 v10, s[52:55], s28 offen offset:2048   lds
M v[196:199], a[40:43], a[160:163], v[196:199]
 ds_read_b64_tr_b16 a[156:157], v4 offset:57344
 ds_read_b64_tr_b16 a[158:159], v4 offset:58368
M v[200:203], a[48:51], a[160:163], v[200:203]
 v_sub_f32 v253, v253, v27
 v_sub_f32 v254, v254, v27
M v[200:203], a[52:55], a[164:167], v[200:203]
 v_sub_f32 v255, v255, v27
M v[204:207], a[60:63], a[164:167], v[204:207]
M v[204:207], a[56:59], a[160:163], v[204:207]
 buffer_load_dwordx4 v11, s[52:55], s28 offen offset:3072   lds
M v[208:211], a[64:67], a[160:163], v[208:211]
 s_sub_u32 s28, s28, 524288
M v[208:211], a[68:71], a[164:167], v[208:211]
M v[212:215], a[76:79], a[164:167], v[212:215]
M v[212:215], a[72:75], a[160:163], v[212:215]
M v[216:219], a[80:83], a[160:163], v[216:219]
M v[216:219], a[84:87], a[164:167], v[216:219]
 s_waitcnt lgkmcnt(2)
M v[220:223], a[92:95], a[164:167], v[220:223]
 s_waitcnt vmcnt(25) lgkmcnt(0)
M v[220:223], a[88:91], a[160:163], v[220:223]
 s_barrier
M v[252:255], a[88:91], a[168:171], v[252:255]
 ds_read_b128 a[160:163], v5 offset:32768
 ds_read_b128 a[164:167], v6 offset:32768
M v[252:255], a[92:95], a[172:175], v[252:255]
M v[248:251], a[84:87], a[172:175], v[248:251]
M v[248:251], a[80:83], a[168:171], v[248:251]
M v[244:247], a[72:75], a[168:171], v[244:247]
M v[244:247], a[76:79], a[172:175], v[244:247]
M v[240:243], a[68:71], a[172:175], v[240:243]
M v[240:243], a[64:67], a[168:171], v[240:243]
M v[236:239], a[56:59], a[168:171], v[236:239]
M v[236:239], a[60:63], a[172:175], v[236:239]
M v[232:235], a[52:55], a[172:175], v[232:235]
M v[232:235], a[48:51], a[168:171], v[232:235]
M v[228:231], a[40:43], a[168:171], v[228:231]
M v[228:231], a[44:47], a[172:175], v[228:231]
 s_waitcnt lgkmcnt(0)
M v[224:227], a[36:39], a[172:175], v[224:227]
M v[224:227], a[32:35], a[168:171], v[224:227]
M a[0:3], a[96:99], a[160:163], a[0:3]
 ds_read_b128 a[168:171], v5 offset:34816
 ds_read_b128 a[172:175], v6 offset:34816
M a[0:3], a[100:103], a[164:167], a[0:3]
 ds_read_b64_tr_b16 a[32:33], v1 offset:0
 ds_read_b64_tr_b16 a[34:35], v1 offset:1024
M a[4:7], a[108:111], a[164:167], a[4:7]
 s_add_u32 m0, s24, 16384
M a[4:7], a[104:107], a[160:163], a[4:7]
 buffer_load_dwordx4 v16, s[56:59], s29 offen offset:0   lds
M a[8:11], a[112:115], a[160:163], a[8:11]
M a[8:11], a[116:119], a[164:167], a[8:11]
M a[12:15], a[124:127], a[164:167], a[12:15]
 ds_read_b64_tr_b16 a[36:37], v1 offset:8192
 ds_read_b64_tr_b16 a[38:39], v1 offset:9216
M a[12:15], a[120:123], a[160:163], a[12:15]
M a[16:19], a[128:131], a[160:163], a[16:19]
 buffer_load_dwordx4 v17, s[56:59], s29 offen offset:1024   lds
M a[16:19], a[132:135], a[164:167], a[16:19]
 v_accvgpr_read_b32 v24, a0
 v_accvgpr_read_b32 v25, a1
M a[20:23], a[140:143], a[164:167], a[20:23]
 v_accvgpr_read_b32 v26, a2
 v_accvgpr_read_b32 v27, a3
M a[20:23], a[136:139], a[160:163], a[20:23]
 ds_read_b64_tr_b16 a[40:41], v2 offset:0
 ds_read_b64_tr_b16 a[42:43], v2 offset:1024
M a[24:27], a[144:147], a[160:163], a[24:27]
 v_accvgpr_read_b32 v28, a4
 v_accvgpr_read_b32 v29, a5
M a[24:27], a[148:151], a[164:167], a[24:27]
 s_waitcnt lgkmcnt(6)
 buffer_load_dwordx4 v18, s[56:59], s29 offen offset:2048   lds
M a[28:31], a[156:159], a[164:167], a[28:31]
 v_accvgpr_read_b32 v30, a6
 v_accvgpr_read_b32 v31, a7
M a[28:31], a[152:155], a[160:163], a[28:31]
 v_cvt_pk_bf16_f32 v24, v24, v25
 v_cvt_pk_bf16_f32 v25, v26, v27
M v[32:35], a[96:99], a[168:171], v[32:35]
 ds_read_b128 a[160:163], v5 offset:36864
 ds_read_b128 a[164:167], v6 offset:36864
M v[32:35], a[100:103], a[172:175], v[32:35]
 ds_read_b64_tr_b16 a[44:45], v2 offset:8192
 ds_read_b64_tr_b16 a[46:47], v2 offset:9216
M v[36:39], a[108:111], a[172:175], v[36:39]
 buffer_load_dwordx4 v19, s[56:59], s29 offen offset:3072   lds
M v[36:39], a[104:107], a[168:171], v[36:39]
 s_add_u32 s29, s29, 128
 v_cvt_pk_bf16_f32 v26, v28, v29
 v_cvt_pk_bf16_f32 v27, v30, v31
M v[40:43], a[112:115], a[168:171], v[40:43]
 s_add_u32 s3, s93, 0
 buffer_store_dwordx4 v[24:27], v7, s[8:11], s3 offen offset:0 sc1
M v[40:43], a[116:119], a[172:175], v[40:43]
 ds_read_b64_tr_b16 a[48:49], v3 offset:0
 ds_read_b64_tr_b16 a[50:51], v3 offset:1024
M v[44:47], a[124:127], a[172:175], v[44:47]
 s_add_u32 m0, s23, 49152
 v_accvgpr_read_b32 v24, a8
 v_accvgpr_read_b32 v25, a9
M v[44:47], a[120:123], a[168:171], v[44:47]
 buffer_load_dwordx4 v8, s[52:55], s28 offen offset:0   lds
M v[48:51], a[128:131], a[168:171], v[48:51]
 v_accvgpr_read_b32 v26, a10
 v_accvgpr_read_b32 v27, a11
M v[48:51], a[132:135], a[172:175], v[48:51]
 v_accvgpr_read_b32 v28, a12
 v_accvgpr_read_b32 v29, a13
M v[52:55], a[140:143], a[172:175], v[52:55]
 ds_read_b64_tr_b16 a[52:53], v3 offset:8192
 ds_read_b64_tr_b16 a[54:55], v3 offset:9216
M v[52:55], a[136:139], a[168:171], v[52:55]
 v_accvgpr_read_b32 v30, a14
 v_accvgpr_read_b32 v31, a15
M v[56:59], a[144:147], a[168:171], v[56:59]
 buffer_load_dwordx4 v9, s[52:55], s28 offen offset:1024   lds
M v[56:59], a[148:151], a[172:175], v[56:59]
 s_waitcnt lgkmcnt(6)
 v_cvt_pk_bf16_f32 v24, v24, v25
 v_cvt_pk_bf16_f32 v25, v26, v27
M v[60:63], a[156:159], a[172:175], v[60:63]
 v_cvt_pk_bf16_f32 v26, v28, v29
 v_cvt_pk_bf16_f32 v27, v30, v31
M v[60:63], a[152:155], a[168:171], v[60:63]
 ds_read_b64_tr_b16 a[56:57], v4 offset:0
 ds_read_b64_tr_b16 a[58:59], v4 offset:1024
M v[64:67], a[96:99], a[160:163], v[64:67]
 ds_read_b128 a[168:171], v5 offset:38912
 ds_read_b128 a[172:175], v6 offset:38912
M v[64:67], a[100:103], a[164:167], v[64:67]
 buffer_load_dwordx4 v10, s[52:55], s28 offen offset:2048   lds
M v[68:71], a[108:111], a[164:167], v[68:71]
M v[68:71], a[104:107], a[160:163], v[68:71]
 buffer_store_dwordx4 v[24:27], v7, s[8:11], s3 offen offset:1024 sc1
M v[72:75], a[112:115], a[160:163], v[72:75]
 ds_read_b64_tr_b16 a[60:61], v4 offset:8192
 ds_read_b64_tr_b16 a[62:63], v4 offset:9216
M v[72:75], a[116:119], a[164:167], v[72:75]
 v_accvgpr_read_b32 v24, a16
 v_accvgpr_read_b32 v25, a17
M v[76:79], a[124:127], a[164:167], v[76:79]
 buffer_load_dwordx4 v11, s[52:55], s28 offen offset:3072   lds
M v[76:79], a[120:123], a[160:163], v[76:79]
 s_add_u32 s28, s28, 1048448
 v_accvgpr_read_b32 v26, a18
 v_accvgpr_read_b32 v27, a19
M v[80:83], a[128:131], a[160:163], v[80:83]
 v_accvgpr_read_b32 v28, a20
 v_accvgpr_read_b32 v29, a21
M v[80:83], a[132:135], a[164:167], v[80:83]
 v_accvgpr_read_b32 v30, a22
 v_accvgpr_read_b32 v31, a23
M v[84:87], a[140:143], a[164:167], v[84:87]
 v_cvt_pk_bf16_f32 v24, v24, v25
 v_cvt_pk_bf16_f32 v25, v26, v27
M v[84:87], a[136:139], a[160:163], v[84:87]
 v_cvt_pk_bf16_f32 v26, v28, v29
 v_cvt_pk_bf16_f32 v27, v30, v31
M v[88:91], a[144:147], a[160:163], v[88:91]
 buffer_store_dwordx4 v[24:27], v7, s[8:11], s3 offen offset:2048 sc1
M v[88:91], a[148:151], a[164:167], v[88:91]
 s_waitcnt lgkmcnt(2)
 v_accvgpr_read_b32 v24, a24
 v_accvgpr_read_b32 v25, a25
M v[92:95], a[156:159], a[164:167], v[92:95]
 s_waitcnt vmcnt(27) lgkmcnt(0)
 v_accvgpr_read_b32 v26, a26
 v_accvgpr_read_b32 v27, a27
M v[92:95], a[152:155], a[160:163], v[92:95]
 s_barrier
M v[96:99], a[96:99], a[168:171], v[96:99]
 ds_read_b128 a[160:163], v5 offset:49152
 ds_read_b128 a[164:167], v6 offset:49152
M v[96:99], a[100:103], a[172:175], v[96:99]
 v_accvgpr_read_b32 v28, a28
 v_accvgpr_read_b32 v29, a29
M v[100:103], a[108:111], a[172:175], v[100:103]
 s_add_u32 m0, s24, 32768
 ds_read_b64_tr_b16 a[64:65], v1 offset:16384
 ds_read_b64_tr_b16 a[66:67], v1 offset:17408
M v[100:103], a[104:107], a[168:171], v[100:103]
 buffer_load_dwordx4 v16, s[56:59], s29 offen offset:0   lds
M v[104:107], a[112:115], a[168:171], v[104:107]
 v_accvgpr_read_b32 v30, a30
 v_accvgpr_read_b32 v31, a31
M v[104:107], a[116:119], a[172:175], v[104:107]
 v_cvt_pk_bf16_f32 v24, v24, v25
 v_cvt_pk_bf16_f32 v25, v26, v27
M v[108:111], a[124:127], a[172:175], v[108:111]
 v_cvt_pk_bf16_f32 v26, v28, v29
 v_cvt_pk_bf16_f32 v27, v30, v31
M v[108:111], a[120:123], a[168:171], v[108:111]
 buffer_store_dwordx4 v[24:27], v7, s[8:11], s3 offen offset:3072 sc1
M v[112:115], a[128:131], a[168:171], v[112:115]
 v_cvt_pk_bf16_f32 v32, v32, v33
 v_cvt_pk_bf16_f32 v33, v34, v35
M v[112:115], a[132:135], a[172:175], v[112:115]
 ds_read_b64_tr_b16 a[68:69], v1 offset:24576
 ds_read_b64_tr_b16 a[70:71], v1 offset:25600
M v[116:119], a[140:143], a[172:175], v[116:119]
 buffer_load_dwordx4 v17, s[56:59], s29 offen offset:1024   lds
M v[116:119], a[136:139], a[168:171], v[116:119]
 v_cvt_pk_bf16_f32 v34, v36, v37
 v_cvt_pk_bf16_f32 v35, v38, v39
M v[120:123], a[144:147], a[168:171], v[120:123]
 v_accvgpr_write_b32 a4, v32
 v_accvgpr_write_b32 a5, v33
M v[120:123], a[148:151], a[172:175], v[120:123]
 s_waitcnt lgkmcnt(4)
 v_accvgpr_write_b32 a6, v34
 v_accvgpr_write_b32 a7, v35
M v[124:127], a[156:159], a[172:175], v[124:127]
 v_cvt_pk_bf16_f32 v40, v40, v41
 v_cvt_pk_bf16_f32 v41, v42, v43
M v[124:127], a[152:155], a[168:171], v[124:127]
 v_cvt_pk_bf16_f32 v42, v44, v45
 v_cvt_pk_bf16_f32 v43, v46, v47
M v[128:131], a[96:99], a[160:163], v[128:131]
 ds_read_b128 a[168:171], v5 offset:51200
 ds_read_b128 a[172:175], v6 offset:51200
M v[128:131], a[100:103], a[164:167], v[128:131]
 ds_read_b64_tr_b16 a[72:73], v2 offset:16384
 ds_read_b64_tr_b16 a[74:75], v2 offset:17408
M v[132:135], a[108:111], a[164:167], v[132:135]
 buffer_load_dwordx4 v18, s[56:59], s29 offen offset:2048   lds
M v[132:135], a[104:107], a[160:163], v[132:135]
 v_accvgpr_write_b32 a12, v40
 v_accvgpr_write_b32 a13, v41
M v[136:139], a[112:115], a[160:163], v[136:139]
 v_accvgpr_write_b32 a14, v42
 v_accvgpr_write_b32 a15, v43
M v[136:139], a[116:119], a[164:167], v[136:139]
 v_cvt_pk_bf16_f32 v48, v48, v49
 v_cvt_pk_bf16_f32 v49, v50, v51
M v[140:143], a[124:127], a[164:167], v[140:143]
 v_cvt_pk_bf16_f32 v50, v52, v53
 v_cvt_pk_bf16_f32 v51, v54, v55
M v[140:143], a[120:123], a[160:163], v[140:143]
 ds_read_b64_tr_b16 a[76:77], v2 offset:24576
 ds_read_b64_tr_b16 a[78:79], v2 offset:25600
M v[144:147], a[128:131], a[160:163], v[144:147]
 buffer_load_dwordx4 v19, s[56:59], s29 offen offset:3072   lds
M v[144:147], a[132:135], a[164:167], v[144:147]
 s_add_u32 s29, s29, 128
 v_accvgpr_write_b32 a20, v48
 v_accvgpr_write_b32 a21, v49
M v[148:151], a[140:143], a[164:167], v[148:151]
 v_accvgpr_write_b32 a22, v50
 v_accvgpr_write_b32 a23, v51
M v[148:151], a[136:139], a[160:163], v[148:151]
 v_cvt_pk_bf16_f32 v56, v56, v57
 v_cvt_pk_bf16_f32 v57, v58, v59
M v[152:155], a[144:147], a[160:163], v[152:155]
 v_cvt_pk_bf16_f32 v58, v60, v61
 v_cvt_pk_bf16_f32 v59, v62, v63
M v[152:155], a[148:151], a[164:167], v[152:155]
 s_waitcnt lgkmcnt(4)
 v_accvgpr_write_b32 a28, v56
 v_accvgpr_write_b32 a29, v57
M v[156:159], a[156:159], a[164:167], v[156:159]
 s_add_u32 m0, s23, 0
 ds_read_b64_tr_b16 a[80:81], v3 offset:16384
 ds_read_b64_tr_b16 a[82:83], v3 offset:17408
M v[156:159], a[152:155], a[160:163], v[156:159]
 buffer_load_dwordx4 v8, s[52:55], s28 offen offset:0   lds
M v[160:163], a[96:99], a[168:171], v[160:163]
 ds_read_b128 a[160:163], v5 offset:53248
 ds_read_b128 a[164:167], v6 offset:53248
M v[160:163], a[100:103], a[172:175], v[160:163]
 v_accvgpr_write_b32 a30, v58
 v_accvgpr_write_b32 a31, v59
M v[164:167], a[108:111], a[172:175], v[164:167]
 v_cvt_pk_bf16_f32 v64, v64, v65
 v_cvt_pk_bf16_f32 v65, v66, v67
M v[164:167], a[104:107], a[168:171], v[164:167]
 v_cvt_pk_bf16_f32 v66, v68, v69
 v_cvt_pk_bf16_f32 v67, v70, v71
M v[168:171], a[112:115], a[168:171], v[168:171]
 v_cvt_pk_bf16_f32 v72, v72, v73
 v_cvt_pk_bf16_f32 v73, v74, v75
M v[168:171], a[116:119], a[172:175], v[168:171]
 ds_read_b64_tr_b16 a[84:85], v3 offset:24576
 ds_read_b64_tr_b16 a[86:87], v3 offset:25600
M v[172:175], a[124:127], a[172:175], v[172:175]
 buffer_load_dwordx4 v9, s[52:55], s28 offen offset:1024   lds
M v[172:175], a[120:123], a[168:171], v[172:175]
 v_cvt_pk_bf16_f32 v74, v76, v77
 v_cvt_pk_bf16_f32 v75, v78, v79
M v[176:179], a[128:131], a[168:171], v[176:179]
 v_cvt_pk_bf16_f32 v80, v80, v81
 v_cvt_pk_bf16_f32 v81, v82, v83
M v[176:179], a[132:135], a[172:175], v[176:179]
 v_cvt_pk_bf16_f32 v82, v84, v85
 v_cvt_pk_bf16_f32 v83, v86, v87
M v[180:183], a[140:143], a[172:175], v[180:183]
 v_cvt_pk_bf16_f32 v88, v88, v89
 v_cvt_pk_bf16_f32 v89, v90, v91
M v[180:183], a[136:139], a[168:171], v[180:183]
 v_cvt_pk_bf16_f32 v90, v92, v93
 v_cvt_pk_bf16_f32 v91, v94, v95
M v[184:187], a[144:147], a[168:171], v[184:187]
 ds_read_b64_tr_b16 a[88:89], v4 offset:16384
 ds_read_b64_tr_b16 a[90:91], v4 offset:17408
M v[184:187], a[148:151], a[172:175], v[184:187]
 s_waitcnt lgkmcnt(4)
 buffer_load_dwordx4 v10, s[52:55], s28 offen offset:2048   lds
M v[188:191], a[156:159], a[172:175], v[188:191]
 v_cvt_pk_bf16_f32 v96, v96, v97
 v_cvt_pk_bf16_f32 v97, v98, v99
M v[188:191], a[152:155], a[168:171], v[188:191]
 v_cvt_pk_bf16_f32 v98, v100, v101
 v_cvt_pk_bf16_f32 v99, v102, v103
M v[192:195], a[96:99], a[160:163], v[192:195]
 ds_read_b128 a[168:171], v5 offset:55296
 ds_read_b128 a[172:175], v6 offset:55296
M v[192:195], a[100:103], a[164:167], v[192:195]
 v_cvt_pk_bf16_f32 v104, v104, v105
 v_cvt_pk_bf16_f32 v105, v106, v107
M v[196:199], a[108:111], a[164:167], v[196:199]
 v_cvt_pk_bf16_f32 v106, v108, v109
 v_cvt_pk_bf16_f32 v107, v110, v111
M v[196:199], a[104:107], a[160:163], v[196:199]
 ds_read_b64_tr_b16 a[92:93], v4 offset:24576
 ds_read_b64_tr_b16 a[94:95], v4 offset:25600
M v[200:203], a[112:115], a[160:163], v[200:203]
 buffer_load_dwordx4 v11, s[52:55], s28 offen offset:3072   lds
M v[200:203], a[116:119], a[164:167], v[200:203]
 s_add_u32 s28, s28, 128
 v_cvt_pk_bf16_f32 v112, v112, v113
 v_cvt_pk_bf16_f32 v113, v114, v115
M v[204:207], a[124:127], a[164:167], v[204:207]
 v_cvt_pk_bf16_f32 v114, v116, v117
 v_cvt_pk_bf16_f32 v115, v118, v119
M v[204:207], a[120:123], a[160:163], v[204:207]
 v_cvt_pk_bf16_f32 v120, v120, v121
 v_cvt_pk_bf16_f32 v121, v122, v123
M v[208:211], a[128:131], a[160:163], v[208:211]
 v_cvt_pk_bf16_f32 v122, v124, v125
 v_cvt_pk_bf16_f32 v123, v126, v127
M v[208:211], a[132:135], a[164:167], v[208:211]
 v_cvt_pk_bf16_f32 v128, v128, v129
 v_cvt_pk_bf16_f32 v129, v130, v131
M v[212:215], a[140:143], a[164:167], v[212:215]
 v_cvt_pk_bf16_f32 v130, v132, v133
 v_cvt_pk_bf16_f32 v131, v134, v135
M v[212:215], a[136:139], a[160:163], v[212:215]
 v_cvt_pk_bf16_f32 v136, v136, v137
 v_cvt_pk_bf16_f32 v137, v138, v139
M v[216:219], a[144:147], a[160:163], v[216:219]
 v_cvt_pk_bf16_f32 v138, v140, v141
 v_cvt_pk_bf16_f32 v139, v142, v143
M v[216:219], a[148:151], a[164:167], v[216:219]
 s_waitcnt lgkmcnt(2)
 v_cvt_pk_bf16_f32 v144, v144, v145
 v_cvt_pk_bf16_f32 v145, v146, v147
M v[220:223], a[156:159], a[164:167], v[220:223]
 s_waitcnt vmcnt(24) lgkmcnt(0)
 v_cvt_pk_bf16_f32 v146, v148, v149
 v_cvt_pk_bf16_f32 v147, v150, v151
M v[220:223], a[152:155], a[160:163], v[220:223]
 s_barrier
M v[224:227], a[96:99], a[168:171], v[224:227]
 ds_read_b128 a[160:163], v5 offset:0
 ds_read_b128 a[164:167], v6 offset:0
M v[224:227], a[100:103], a[172:175], v[224:227]
 v_cvt_pk_bf16_f32 v152, v152, v153
 v_cvt_pk_bf16_f32 v153, v154, v155
M v[228:231], a[108:111], a[172:175], v[228:231]
 v_cvt_pk_bf16_f32 v154, v156, v157
 v_cvt_pk_bf16_f32 v155, v158, v159
M v[228:231], a[104:107], a[168:171], v[228:231]
 v_cvt_pk_bf16_f32 v160, v160, v161
 v_cvt_pk_bf16_f32 v161, v162, v163
M v[232:235], a[112:115], a[168:171], v[232:235]
 v_cvt_pk_bf16_f32 v162, v164, v165
 v_cvt_pk_bf16_f32 v163, v166, v167
M v[232:235], a[116:119], a[172:175], v[232:235]
 v_cvt_pk_bf16_f32 v168, v168, v169
 v_cvt_pk_bf16_f32 v169, v170, v171
M v[236:239], a[124:127], a[172:175], v[236:239]
 v_cvt_pk_bf16_f32 v170, v172, v173
 v_cvt_pk_bf16_f32 v171, v174, v175
M v[236:239], a[120:123], a[168:171], v[236:239]
 v_cvt_pk_bf16_f32 v176, v176, v177
 v_cvt_pk_bf16_f32 v177, v178, v179
M v[240:243], a[128:131], a[168:171], v[240:243]
 v_cvt_pk_bf16_f32 v178, v180, v181
 v_cvt_pk_bf16_f32 v179, v182, v183
M v[240:243], a[132:135], a[172:175], v[240:243]
 v_cvt_pk_bf16_f32 v184, v184, v185
 v_cvt_pk_bf16_f32 v185, v186, v187
M v[244:247], a[140:143], a[172:175], v[244:247]
 v_cvt_pk_bf16_f32 v186, v188, v189
 v_cvt_pk_bf16_f32 v187, v190, v191
M v[244:247], a[136:139], a[168:171], v[244:247]
 v_cvt_pk_bf16_f32 v192, v192, v193
 v_cvt_pk_bf16_f32 v193, v194, v195
M v[248:251], a[144:147], a[168:171], v[248:251]
 v_cvt_pk_bf16_f32 v194, v196, v197
 v_cvt_pk_bf16_f32 v195, v198, v199
M v[248:251], a[148:151], a[172:175], v[248:251]
 s_waitcnt lgkmcnt(0)
 v_cvt_pk_bf16_f32 v200, v200, v201
 v_cvt_pk_bf16_f32 v201, v202, v203
M v[252:255], a[156:159], a[172:175], v[252:255]
 v_cvt_pk_bf16_f32 v202, v204, v205
 v_cvt_pk_bf16_f32 v203, v206, v207
M v[252:255], a[152:155], a[168:171], v[252:255]
 v_cvt_pk_bf16_f32 v208, v208, v209
 v_cvt_pk_bf16_f32 v209, v210, v211
M v[32:35], a[32:35], a[160:163], 0
 s_add_u32 m0, s23, 16384
 ds_read_b128 a[168:171], v5 offset:2048
 ds_read_b128 a[172:175], v6 offset:2048
M v[32:35], a[36:39], a[164:167], v[32:35]
 ds_read_b64_tr_b16 a[96:97], v1 offset:32768
 ds_read_b64_tr_b16 a[98:99], v1 offset:33792
M v[36:39], a[44:47], a[164:167], 0
 buffer_load_dwordx4 v8, s[52:55], s28 offen offset:0   lds
M v[36:39], a[40:43], a[160:163], v[36:39]
 v_cvt_pk_bf16_f32 v210, v212, v213
 v_cvt_pk_bf16_f32 v211, v214, v215
M v[40:43], a[48:51], a[160:163], 0
 ds_read_b64_tr_b16 a[100:101], v1 offset:40960
 ds_read_b64_tr_b16 a[102:103], v1 offset:41984
M v[40:43], a[52:55], a[164:167], v[40:43]
 buffer_load_dwordx4 v9, s[52:55], s28 offen offset:1024   lds
M v[44:47], a[60:63], a[164:167], 0
 v_cvt_pk_bf16_f32 v216, v216, v217
 v_cvt_pk_bf16_f32 v217, v218, v219
M v[44:47], a[56:59], a[160:163], v[44:47]
 ds_read_b64_tr_b16 a[104:105], v2 offset:32768
 ds_read_b64_tr_b16 a[106:107], v2 offset:33792
M v[48:51], a[64:67], a[160:163], 0
 v_cvt_pk_bf16_f32 v218, v220, v221
 v_cvt_pk_bf16_f32 v219, v222, v223
M v[48:51], a[68:71], a[164:167], v[48:51]
 v_cvt_pk_bf16_f32 v224, v224, v225
 v_cvt_pk_bf16_f32 v225, v226, v227
M v[52:55], a[76:79], a[164:167], 0
 ds_read_b64_tr_b16 a[108:109], v2 offset:40960
 ds_read_b64_tr_b16 a[110:111], v2 offset:41984
M v[52:55], a[72:75], a[160:163], v[52:55]
 buffer_load_dwordx4 v10, s[52:55], s28 offen offset:2048   lds
M v[56:59], a[80:83], a[160:163], 0
 v_cvt_pk_bf16_f32 v226, v228, v229
 v_cvt_pk_bf16_f32 v227, v230, v231
M v[56:59], a[84:87], a[164:167], v[56:59]
 s_waitcnt lgkmcnt(8)
 ds_read_b64_tr_b16 a[112:113], v3 offset:32768
 ds_read_b64_tr_b16 a[114:115], v3 offset:33792
M v[60:63], a[92:95], a[164:167], 0
 v_cvt_pk_bf16_f32 v232, v232, v233
 v_cvt_pk_bf16_f32 v233, v234, v235
M v[60:63], a[88:91], a[160:163], v[60:63]
 buffer_load_dwordx4 v11, s[52:55], s28 offen offset:3072   lds
M v[68:71], a[32:35], a[168:171], 0
 s_add_u32 s28, s28, 524160
 ds_read_b128 a[160:163], v5 offset:4096
 ds_read_b128 a[164:167], v6 offset:4096
M v[68:71], a[36:39], a[172:175], v[68:71]
 ds_read_b64_tr_b16 a[116:117], v3 offset:40960
 ds_read_b64_tr_b16 a[118:119], v3 offset:41984
M v[76:79], a[44:47], a[172:175], 0
 v_cvt_pk_bf16_f32 v234, v236, v237
 v_cvt_pk_bf16_f32 v235, v238, v239
M v[76:79], a[40:43], a[168:171], v[76:79]
 s_add_u32 m0, s24, 49152
 ds_read_b64_tr_b16 a[120:121], v4 offset:32768
 ds_read_b64_tr_b16 a[122:123], v4 offset:33792
M v[84:87], a[48:51], a[168:171], 0
 buffer_load_dwordx4 v16, s[56:59], s29 offen offset:0   lds
M v[84:87], a[52:55], a[172:175], v[84:87]
 v_cvt_pk_bf16_f32 v240, v240, v241
 v_cvt_pk_bf16_f32 v241, v242, v243
M v[92:95], a[60:63], a[172:175], 0
 ds_read_b64_tr_b16 a[124:125], v4 offset:40960
 ds_read_b64_tr_b16 a[126:127], v4 offset:41984
M v[92:95], a[56:59], a[168:171], v[92:95]
 v_cvt_pk_bf16_f32 v242, v244, v245
 v_cvt_pk_bf16_f32 v243, v246, v247
M v[100:103], a[64:67], a[168:171], 0
 v_cvt_pk_bf16_f32 v248, v248, v249
 v_cvt_pk_bf16_f32 v249, v250, v251
M v[100:103], a[68:71], a[172:175], v[100:103]
 buffer_load_dwordx4 v17, s[56:59], s29 offen offset:1024   lds
M v[108:111], a[76:79], a[172:175], 0
 v_cvt_pk_bf16_f32 v250, v252, v253
 v_cvt_pk_bf16_f32 v251, v254, v255
M v[108:111], a[72:75], a[168:171], v[108:111]
 s_add_u32 s3, s93, 16384
 v_mov_b32 v12, 1
 v_or_b32 v15, s20, v0
M v[116:119], a[80:83], a[168:171], 0
 v_min_u32 v15, 1, v15
 v_lshlrev_b32 v15, 29, v15
M v[116:119], a[84:87], a[172:175], v[116:119]
 s_waitcnt lgkmcnt(6)
 buffer_store_dwordx4 a[4:7], v7, s[8:11], s3 offen offset:0 sc1
M v[124:127], a[92:95], a[172:175], 0
 s_waitcnt vmcnt(17) lgkmcnt(0)
 buffer_load_dwordx4 v18, s[56:59], s29 offen offset:2048   lds
M v[124:127], a[88:91], a[168:171], v[124:127]
 s_barrier
M v[132:135], a[32:35], a[160:163], 0
 ds_read_b128 a[168:171], v5 offset:6144
 ds_read_b128 a[172:175], v6 offset:6144
M v[132:135], a[36:39], a[164:167], v[132:135]
 ds_read_b64_tr_b16 a[128:129], v1 offset:49152
 ds_read_b64_tr_b16 a[130:131], v1 offset:50176
M v[140:143], a[44:47], a[164:167], 0
M v[140:143], a[40:43], a[160:163], v[140:143]
 buffer_load_dwordx4 v19, s[56:59], s29 offen offset:3072   lds
M v[148:151], a[48:51], a[160:163], 0
 s_add_u32 s29, s29, 128
 ds_read_b64_tr_b16 a[132:133], v1 offset:57344
 ds_read_b64_tr_b16 a[134:135], v1 offset:58368
M v[148:151], a[52:55], a[164:167], v[148:151]
 buffer_store_dwordx4 a[12:15], v7, s[8:11], s3 offen offset:1024 sc1
M v[156:159], a[60:63], a[164:167], 0
M v[156:159], a[56:59], a[160:163], v[156:159]
 s_add_u32 m0, s23, 32768
 ds_read_b64_tr_b16 a[136:137], v2 offset:49152
 ds_read_b64_tr_b16 a[138:139], v2 offset:50176
M v[164:167], a[64:67], a[160:163], 0
 buffer_load_dwordx4 v8, s[52:55], s28 offen offset:0   lds
M v[164:167], a[68:71], a[164:167], v[164:167]
M v[172:175], a[76:79], a[164:167], 0
 ds_read_b64_tr_b16 a[140:141], v2 offset:57344
 ds_read_b64_tr_b16 a[142:143], v2 offset:58368
M v[172:175], a[72:75], a[160:163], v[172:175]
M v[180:183], a[80:83], a[160:163], 0
M v[180:183], a[84:87], a[164:167], v[180:183]
 s_waitcnt lgkmcnt(8)
 ds_read_b64_tr_b16 a[144:145], v3 offset:49152
 ds_read_b64_tr_b16 a[146:147], v3 offset:50176
M v[188:191], a[92:95], a[164:167], 0
 buffer_load_dwordx4 v9, s[52:55], s28 offen offset:1024   lds
M v[188:191], a[88:91], a[160:163], v[188:191]
M v[196:199], a[32:35], a[168:171], 0
 ds_read_b128 a[160:163], v5 offset:16384
 ds_read_b128 a[164:167], v6 offset:16384
M v[196:199], a[36:39], a[172:175], v[196:199]
 ds_read_b64_tr_b16 a[148:149], v3 offset:57344
 ds_read_b64_tr_b16 a[150:151], v3 offset:58368
M v[204:207], a[44:47], a[172:175], 0
 buffer_load_dwordx4 v10, s[52:55], s28 offen offset:2048   lds
M v[204:207], a[40:43], a[168:171], v[204:207]
 ds_read_b64_tr_b16 a[152:153], v4 offset:49152
 ds_read_b64_tr_b16 a[154:155], v4 offset:50176
M v[212:215], a[48:51], a[168:171], 0
M v[212:215], a[52:55], a[172:175], v[212:215]
M v[220:223], a[60:63], a[172:175], 0
 ds_read_b64_tr_b16 a[156:157], v4 offset:57344
 ds_read_b64_tr_b16 a[158:159], v4 offset:58368
M v[220:223], a[56:59], a[168:171], v[220:223]
 buffer_load_dwordx4 v11, s[52:55], s28 offen offset:3072   lds
M v[228:231], a[64:67], a[168:171], 0
 s_add_u32 s28, s28, 128
M v[228:231], a[68:71], a[172:175], v[228:231]
M v[236:239], a[76:79], a[172:175], 0
M v[236:239], a[72:75], a[168:171], v[236:239]
M v[244:247], a[80:83], a[168:171], 0
M v[244:247], a[84:87], a[172:175], v[244:247]
 s_waitcnt lgkmcnt(6)
M v[252:255], a[92:95], a[172:175], 0
 s_waitcnt lgkmcnt(0)
M v[252:255], a[88:91], a[168:171], v[252:255]
 s_barrier
M v[32:35], a[96:99], a[160:163], v[32:35]
 s_add_u32 m0, s23, 49152
 ds_read_b128 a[168:171], v5 offset:18432
 ds_read_b128 a[172:175], v6 offset:18432
M v[32:35], a[100:103], a[164:167], v[32:35]
 ds_read_b64_tr_b16 a[32:33], v20 offset:0
 ds_read_b64_tr_b16 a[34:35], v20 offset:1024
M v[36:39], a[108:111], a[164:167], v[36:39]
 s_mov_b32 s39, 1280
 buffer_load_dwordx4 v8, s[52:55], s28 offen offset:0   lds
M v[36:39], a[104:107], a[160:163], v[36:39]
 s_cmp_ge_u32 s42, 10
M v[40:43], a[112:115], a[160:163], v[40:43]
 s_cselect_b32 s64, 0xf000000, 0
 ds_read_b64_tr_b16 a[36:37], v20 offset:8192
 ds_read_b64_tr_b16 a[38:39], v20 offset:9216
M v[40:43], a[116:119], a[164:167], v[40:43]
 s_or_b32 s39, s39, s64
 buffer_load_dwordx4 v9, s[52:55], s28 offen offset:1024   lds
M v[44:47], a[124:127], a[164:167], v[44:47]
 s_lshl_b32 s64, s20, 15
M v[44:47], a[120:123], a[160:163], v[44:47]
 s_add_u32 s12, s64, s34
 ds_read_b64_tr_b16 a[40:41], v21 offset:0
 ds_read_b64_tr_b16 a[42:43], v21 offset:1024
M v[48:51], a[128:131], a[160:163], v[48:51]
 s_add_u32 s13, s12, 4096
 buffer_store_dwordx4 a[20:23], v7, s[8:11], s3 offen offset:2048 sc1
M v[48:51], a[132:135], a[164:167], v[48:51]
 s_add_u32 s14, s12, 16384
M v[52:55], a[140:143], a[164:167], v[52:55]
 s_add_u32 s15, s12, 20480
 ds_read_b64_tr_b16 a[44:45], v21 offset:8192
 ds_read_b64_tr_b16 a[46:47], v21 offset:9216
M v[52:55], a[136:139], a[160:163], v[52:55]
 buffer_load_dwordx4 v10, s[52:55], s28 offen offset:2048   lds
M v[56:59], a[144:147], a[160:163], v[56:59]
M v[56:59], a[148:151], a[164:167], v[56:59]
 s_waitcnt lgkmcnt(8)
 ds_read_b64_tr_b16 a[48:49], v22 offset:0
 ds_read_b64_tr_b16 a[50:51], v22 offset:1024
M v[60:63], a[156:159], a[164:167], v[60:63]
M v[60:63], a[152:155], a[160:163], v[60:63]
 buffer_load_dwordx4 v11, s[52:55], s28 offen offset:3072   lds
M v[68:71], a[96:99], a[168:171], v[68:71]
 s_add_u32 s28, s28, 524160
 ds_read_b128 a[160:163], v5 offset:20480
 ds_read_b128 a[164:167], v6 offset:20480
M v[68:71], a[100:103], a[172:175], v[68:71]
 ds_read_b64_tr_b16 a[52:53], v22 offset:8192
 ds_read_b64_tr_b16 a[54:55], v22 offset:9216
M v[76:79], a[108:111], a[172:175], v[76:79]
M v[76:79], a[104:107], a[168:171], v[76:79]
 s_add_u32 m0, s24, 0
 ds_read_b64_tr_b16 a[56:57], v23 offset:0
 ds_read_b64_tr_b16 a[58:59], v23 offset:1024
M v[84:87], a[112:115], a[168:171], v[84:87]
 buffer_load_dwordx4 v16, s[56:59], s29 offen offset:0   lds
M v[84:87], a[116:119], a[172:175], v[84:87]
M v[92:95], a[124:127], a[172:175], v[92:95]
 ds_read_b64_tr_b16 a[60:61], v23 offset:8192
 ds_read_b64_tr_b16 a[62:63], v23 offset:9216
M v[92:95], a[120:123], a[168:171], v[92:95]
M v[100:103], a[128:131], a[168:171], v[100:103]
M v[100:103], a[132:135], a[172:175], v[100:103]
 buffer_load_dwordx4 v17, s[56:59], s29 offen offset:1024   lds
M v[108:111], a[140:143], a[172:175], v[108:111]
M v[108:111], a[136:139], a[168:171], v[108:111]
M v[116:119], a[144:147], a[168:171], v[116:119]
M v[116:119], a[148:151], a[172:175], v[116:119]
 s_waitcnt lgkmcnt(6)
M v[124:127], a[156:159], a[172:175], v[124:127]
 s_waitcnt vmcnt(25) lgkmcnt(0)
 buffer_load_dwordx4 v18, s[56:59], s29 offen offset:2048   lds
M v[124:127], a[152:155], a[168:171], v[124:127]
 s_barrier
M v[132:135], a[96:99], a[160:163], v[132:135]
 ds_read_b128 a[168:171], v5 offset:22528
 ds_read_b128 a[172:175], v6 offset:22528
M v[132:135], a[100:103], a[164:167], v[132:135]
 ds_read_b64_tr_b16 a[64:65], v20 offset:16384
 ds_read_b64_tr_b16 a[66:67], v20 offset:17408
M v[140:143], a[108:111], a[164:167], v[140:143]
M v[140:143], a[104:107], a[160:163], v[140:143]
 buffer_load_dwordx4 v19, s[56:59], s29 offen offset:3072   lds
M v[148:151], a[112:115], a[160:163], v[148:151]
 s_add_u32 s29, s29, 128
 ds_read_b64_tr_b16 a[68:69], v20 offset:24576
 ds_read_b64_tr_b16 a[70:71], v20 offset:25600
M v[148:151], a[116:119], a[164:167], v[148:151]
 buffer_store_dwordx4 a[28:31], v7, s[8:11], s3 offen offset:3072 sc1
M v[156:159], a[124:127], a[164:167], v[156:159]
M v[156:159], a[120:123], a[160:163], v[156:159]
 s_add_u32 m0, s23, 131072
 ds_read_b64_tr_b16 a[72:73], v21 offset:16384
 ds_read_b64_tr_b16 a[74:75], v21 offset:17408
M v[164:167], a[128:131], a[160:163], v[164:167]
 buffer_load_dwordx4 v8, s[52:55], s28 offen offset:0   lds
M v[164:167], a[132:135], a[164:167], v[164:167]
M v[172:175], a[140:143], a[164:167], v[172:175]
 ds_read_b64_tr_b16 a[76:77], v21 offset:24576
 ds_read_b64_tr_b16 a[78:79], v21 offset:25600
M v[172:175], a[136:139], a[160:163], v[172:175]
M v[180:183], a[144:147], a[160:163], v[180:183]
M v[180:183], a[148:151], a[164:167], v[180:183]
 s_waitcnt lgkmcnt(8)
 ds_read_b64_tr_b16 a[80:81], v22 offset:16384
 ds_read_b64_tr_b16 a[82:83], v22 offset:17408
M v[188:191], a[156:159], a[164:167], v[188:191]
 buffer_load_dwordx4 v9, s[52:55], s28 offen offset:1024   lds
M v[188:191], a[152:155], a[160:163], v[188:191]
M v[196:199], a[96:99], a[168:171], v[196:199]
 ds_read_b128 a[160:163], v5 offset:32768
 ds_read_b128 a[164:167], v6 offset:32768
M v[196:199], a[100:103], a[172:175], v[196:199]
 ds_read_b64_tr_b16 a[84:85], v22 offset:24576
 ds_read_b64_tr_b16 a[86:87], v22 offset:25600
M v[204:207], a[108:111], a[172:175], v[204:207]
 buffer_load_dwordx4 v10, s[52:55], s28 offen offset:2048   lds
M v[204:207], a[104:107], a[168:171], v[204:207]
 ds_read_b64_tr_b16 a[88:89], v23 offset:16384
 ds_read_b64_tr_b16 a[90:91], v23 offset:17408
M v[212:215], a[112:115], a[168:171], v[212:215]
M v[212:215], a[116:119], a[172:175], v[212:215]
M v[220:223], a[124:127], a[172:175], v[220:223]
 ds_read_b64_tr_b16 a[92:93], v23 offset:24576
 ds_read_b64_tr_b16 a[94:95], v23 offset:25600
M v[220:223], a[120:123], a[168:171], v[220:223]
 buffer_load_dwordx4 v11, s[52:55], s28 offen offset:3072   lds
M v[228:231], a[128:131], a[168:171], v[228:231]
 s_add_u32 s28, s28, 128
M v[228:231], a[132:135], a[172:175], v[228:231]
M v[236:239], a[140:143], a[172:175], v[236:239]
M v[236:239], a[136:139], a[168:171], v[236:239]
M v[244:247], a[144:147], a[168:171], v[244:247]
M v[244:247], a[148:151], a[172:175], v[244:247]
 s_waitcnt lgkmcnt(6)
M v[252:255], a[156:159], a[172:175], v[252:255]
 s_waitcnt vmcnt(28) lgkmcnt(0)
M v[252:255], a[152:155], a[168:171], v[252:255]
 s_barrier
M v[32:35], a[32:35], a[160:163], v[32:35]
 s_add_u32 m0, s23, 147456
 ds_read_b128 a[168:171], v5 offset:34816
 ds_read_b128 a[172:175], v6 offset:34816
M v[32:35], a[36:39], a[164:167], v[32:35]
 ds_read_b64_tr_b16 a[96:97], v1 offset:0
 ds_read_b64_tr_b16 a[98:99], v1 offset:1024
M v[36:39], a[44:47], a[164:167], v[36:39]
 buffer_load_dwordx4 v8, s[52:55], s28 offen offset:0   lds
M v[36:39], a[40:43], a[160:163], v[36:39]
M v[40:43], a[48:51], a[160:163], v[40:43]
 ds_read_b64_tr_b16 a[100:101], v1 offset:8192
 ds_read_b64_tr_b16 a[102:103], v1 offset:9216
M v[40:43], a[52:55], a[164:167], v[40:43]
 buffer_load_dwordx4 v9, s[52:55], s28 offen offset:1024   lds
M v[44:47], a[60:63], a[164:167], v[44:47]
M v[44:47], a[56:59], a[160:163], v[44:47]
 ds_read_b64_tr_b16 a[104:105], v2 offset:0
 ds_read_b64_tr_b16 a[106:107], v2 offset:1024
M v[48:51], a[64:67], a[160:163], v[48:51]
M v[48:51], a[68:71], a[164:167], v[48:51]
M v[52:55], a[76:79], a[164:167], v[52:55]
 ds_read_b64_tr_b16 a[108:109], v2 offset:8192
 ds_read_b64_tr_b16 a[110:111], v2 offset:9216
M v[52:55], a[72:75], a[160:163], v[52:55]
 buffer_load_dwordx4 v10, s[52:55], s28 offen offset:2048   lds
M v[56:59], a[80:83], a[160:163], v[56:59]
M v[56:59], a[84:87], a[164:167], v[56:59]
 s_waitcnt lgkmcnt(8)
 ds_read_b64_tr_b16 a[112:113], v3 offset:0
 ds_read_b64_tr_b16 a[114:115], v3 offset:1024
M v[60:63], a[92:95], a[164:167], v[60:63]
M v[60:63], a[88:91], a[160:163], v[60:63]
 buffer_load_dwordx4 v11, s[52:55], s28 offen offset:3072   lds
M v[68:71], a[32:35], a[168:171], v[68:71]
 s_add_u32 s28, s28, 524160
 ds_read_b128 a[160:163], v5 offset:36864
 ds_read_b128 a[164:167], v6 offset:36864
M v[68:71], a[36:39], a[172:175], v[68:71]
 ds_read_b64_tr_b16 a[116:117], v3 offset:8192
 ds_read_b64_tr_b16 a[118:119], v3 offset:9216
M v[76:79], a[44:47], a[172:175], v[76:79]
M v[76:79], a[40:43], a[168:171], v[76:79]
 s_add_u32 m0, s24, 16384
 ds_read_b64_tr_b16 a[120:121], v4 offset:0
 ds_read_b64_tr_b16 a[122:123], v4 offset:1024
M v[84:87], a[48:51], a[168:171], v[84:87]
 buffer_load_dwordx4 v16, s[56:59], s29 offen offset:0   lds
M v[84:87], a[52:55], a[172:175], v[84:87]
M v[92:95], a[60:63], a[172:175], v[92:95]
 ds_read_b64_tr_b16 a[124:125], v4 offset:8192
 ds_read_b64_tr_b16 a[126:127], v4 offset:9216
M v[92:95], a[56:59], a[168:171], v[92:95]
M v[100:103], a[64:67], a[168:171], v[100:103]
M v[100:103], a[68:71], a[172:175], v[100:103]
 buffer_load_dwordx4 v17, s[56:59], s29 offen offset:1024   lds
M v[108:111], a[76:79], a[172:175], v[108:111]
M v[108:111], a[72:75], a[168:171], v[108:111]
M v[116:119], a[80:83], a[168:171], v[116:119]
M v[116:119], a[84:87], a[172:175], v[116:119]
 s_waitcnt lgkmcnt(6)
M v[124:127], a[92:95], a[172:175], v[124:127]
 s_waitcnt vmcnt(25) lgkmcnt(0)
 buffer_load_dwordx4 v18, s[56:59], s29 offen offset:2048   lds
M v[124:127], a[88:91], a[168:171], v[124:127]
 s_barrier
M v[132:135], a[32:35], a[160:163], v[132:135]
 ds_read_b128 a[168:171], v5 offset:38912
 ds_read_b128 a[172:175], v6 offset:38912
M v[132:135], a[36:39], a[164:167], v[132:135]
 ds_read_b64_tr_b16 a[128:129], v1 offset:16384
 ds_read_b64_tr_b16 a[130:131], v1 offset:17408
M v[140:143], a[44:47], a[164:167], v[140:143]
M v[140:143], a[40:43], a[160:163], v[140:143]
 buffer_load_dwordx4 v19, s[56:59], s29 offen offset:3072   lds
M v[148:151], a[48:51], a[160:163], v[148:151]
 s_add_u32 s29, s29, 128
 ds_read_b64_tr_b16 a[132:133], v1 offset:24576
 ds_read_b64_tr_b16 a[134:135], v1 offset:25600
M v[148:151], a[52:55], a[164:167], v[148:151]
M v[156:159], a[60:63], a[164:167], v[156:159]
M v[156:159], a[56:59], a[160:163], v[156:159]
 s_add_u32 m0, s23, 0
 ds_read_b64_tr_b16 a[136:137], v2 offset:16384
 ds_read_b64_tr_b16 a[138:139], v2 offset:17408
M v[164:167], a[64:67], a[160:163], v[164:167]
 buffer_load_dwordx4 v8, s[52:55], s28 offen offset:0   lds
M v[164:167], a[68:71], a[164:167], v[164:167]
M v[172:175], a[76:79], a[164:167], v[172:175]
 ds_read_b64_tr_b16 a[140:141], v2 offset:24576
 ds_read_b64_tr_b16 a[142:143], v2 offset:25600
M v[172:175], a[72:75], a[160:163], v[172:175]
M v[180:183], a[80:83], a[160:163], v[180:183]
M v[180:183], a[84:87], a[164:167], v[180:183]
 s_waitcnt lgkmcnt(8)
 ds_read_b64_tr_b16 a[144:145], v3 offset:16384
 ds_read_b64_tr_b16 a[146:147], v3 offset:17408
M v[188:191], a[92:95], a[164:167], v[188:191]
 buffer_load_dwordx4 v9, s[52:55], s28 offen offset:1024   lds
M v[188:191], a[88:91], a[160:163], v[188:191]
M v[196:199], a[32:35], a[168:171], v[196:199]
 ds_read_b128 a[160:163], v5 offset:49152
 ds_read_b128 a[164:167], v6 offset:49152
M v[196:199], a[36:39], a[172:175], v[196:199]
 ds_read_b64_tr_b16 a[148:149], v3 offset:24576
 ds_read_b64_tr_b16 a[150:151], v3 offset:25600
M v[204:207], a[44:47], a[172:175], v[204:207]
 buffer_load_dwordx4 v10, s[52:55], s28 offen offset:2048   lds
M v[204:207], a[40:43], a[168:171], v[204:207]
 ds_read_b64_tr_b16 a[152:153], v4 offset:16384
 ds_read_b64_tr_b16 a[154:155], v4 offset:17408
M v[212:215], a[48:51], a[168:171], v[212:215]
M v[212:215], a[52:55], a[172:175], v[212:215]
M v[220:223], a[60:63], a[172:175], v[220:223]
 ds_read_b64_tr_b16 a[156:157], v4 offset:24576
 ds_read_b64_tr_b16 a[158:159], v4 offset:25600
M v[220:223], a[56:59], a[168:171], v[220:223]
 buffer_load_dwordx4 v11, s[52:55], s28 offen offset:3072   lds
M v[228:231], a[64:67], a[168:171], v[228:231]
 s_add_u32 s28, s28, 128
M v[228:231], a[68:71], a[172:175], v[228:231]
M v[236:239], a[76:79], a[172:175], v[236:239]
M v[236:239], a[72:75], a[168:171], v[236:239]
M v[244:247], a[80:83], a[168:171], v[244:247]
M v[244:247], a[84:87], a[172:175], v[244:247]
 s_waitcnt lgkmcnt(6)
M v[252:255], a[92:95], a[172:175], v[252:255]
 s_waitcnt vmcnt(16) lgkmcnt(0)
M v[252:255], a[88:91], a[168:171], v[252:255]
 s_barrier
M v[32:35], a[96:99], a[160:163], v[32:35]
 s_add_u32 m0, s23, 16384
 ds_read_b128 a[168:171], v5 offset:51200
 ds_read_b128 a[172:175], v6 offset:51200
M v[32:35], a[100:103], a[164:167], v[32:35]
 ds_read_b64_tr_b16 a[32:33], v1 offset:32768
 ds_read_b64_tr_b16 a[34:35], v1 offset:33792
M v[36:39], a[108:111], a[164:167], v[36:39]
 buffer_load_dwordx4 v8, s[52:55], s28 offen offset:0   lds
M v[36:39], a[104:107], a[160:163], v[36:39]
 buffer_store_dword v12, v15, s[8:11], s45 offen sc1
M v[40:43], a[112:115], a[160:163], v[40:43]
 s_add_u32 s3, s93, 524288
 ds_read_b64_tr_b16 a[36:37], v1 offset:40960
 ds_read_b64_tr_b16 a[38:39], v1 offset:41984
M v[40:43], a[116:119], a[164:167], v[40:43]
 v_min_u32 v25, 15, v0
 v_lshlrev_b32 v25, 7, v25
M v[44:47], a[124:127], a[164:167], v[44:47]
 v_max_u32 v13, 1024, v25
M v[44:47], a[120:123], a[160:163], v[44:47]
 ds_read_b64_tr_b16 a[40:41], v2 offset:32768
 ds_read_b64_tr_b16 a[42:43], v2 offset:33792
M v[48:51], a[128:131], a[160:163], v[48:51]
 buffer_load_dwordx4 v9, s[52:55], s28 offen offset:1024   lds
M v[48:51], a[132:135], a[164:167], v[48:51]
 buffer_store_dwordx4 v[64:67], v7, s[8:11], s3 offen offset:0 sc1
M v[52:55], a[140:143], a[164:167], v[52:55]
 ds_read_b64_tr_b16 a[44:45], v2 offset:40960
 ds_read_b64_tr_b16 a[46:47], v2 offset:41984
M v[52:55], a[136:139], a[160:163], v[52:55]
M v[56:59], a[144:147], a[160:163], v[56:59]
M v[56:59], a[148:151], a[164:167], v[56:59]
 s_waitcnt lgkmcnt(8)
 ds_read_b64_tr_b16 a[48:49], v3 offset:32768
 ds_read_b64_tr_b16 a[50:51], v3 offset:33792
M v[60:63], a[156:159], a[164:167], v[60:63]
 buffer_load_dwordx4 v10, s[52:55], s28 offen offset:2048   lds
M v[60:63], a[152:155], a[160:163], v[60:63]
M v[68:71], a[96:99], a[168:171], v[68:71]
 ds_read_b128 a[160:163], v5 offset:53248
 ds_read_b128 a[164:167], v6 offset:53248
M v[68:71], a[100:103], a[172:175], v[68:71]
 ds_read_b64_tr_b16 a[52:53], v3 offset:40960
 ds_read_b64_tr_b16 a[54:55], v3 offset:41984
M v[76:79], a[108:111], a[172:175], v[76:79]
 buffer_store_dwordx4 v[72:75], v7, s[8:11], s3 offen offset:1024 sc1
M v[76:79], a[104:107], a[168:171], v[76:79]
 ds_read_b64_tr_b16 a[56:57], v4 offset:32768
 ds_read_b64_tr_b16 a[58:59], v4 offset:33792
M v[84:87], a[112:115], a[168:171], v[84:87]
M v[84:87], a[116:119], a[172:175], v[84:87]
 buffer_load_dwordx4 v11, s[52:55], s28 offen offset:3072   lds
M v[92:95], a[124:127], a[172:175], v[92:95]
 s_add_u32 s28, s28, 524160
 ds_read_b64_tr_b16 a[60:61], v4 offset:40960
 ds_read_b64_tr_b16 a[62:63], v4 offset:41984
M v[92:95], a[120:123], a[168:171], v[92:95]
M v[100:103], a[128:131], a[168:171], v[100:103]
M v[100:103], a[132:135], a[172:175], v[100:103]
M v[108:111], a[140:143], a[172:175], v[108:111]
M v[108:111], a[136:139], a[168:171], v[108:111]
M v[116:119], a[144:147], a[168:171], v[116:119]
M v[116:119], a[148:151], a[172:175], v[116:119]
 s_waitcnt lgkmcnt(6)
M v[124:127], a[156:159], a[172:175], v[124:127]
 s_waitcnt lgkmcnt(0)
M v[124:127], a[152:155], a[168:171], v[124:127]
 s_barrier
M v[132:135], a[96:99], a[160:163], v[132:135]
 ds_read_b128 a[168:171], v5 offset:55296
 ds_read_b128 a[172:175], v6 offset:55296
M v[132:135], a[100:103], a[164:167], v[132:135]
 ds_read_b64_tr_b16 a[64:65], v1 offset:49152
 ds_read_b64_tr_b16 a[66:67], v1 offset:50176
M v[140:143], a[108:111], a[164:167], v[140:143]
 buffer_store_dwordx4 v[80:83], v7, s[8:11], s3 offen offset:2048 sc1
M v[140:143], a[104:107], a[160:163], v[140:143]
M v[148:151], a[112:115], a[160:163], v[148:151]
 ds_read_b64_tr_b16 a[68:69], v1 offset:57344
 ds_read_b64_tr_b16 a[70:71], v1 offset:58368
M v[148:151], a[116:119], a[164:167], v[148:151]
M v[156:159], a[124:127], a[164:167], v[156:159]
M v[156:159], a[120:123], a[160:163], v[156:159]
 ds_read_b64_tr_b16 a[72:73], v2 offset:49152
 ds_read_b64_tr_b16 a[74:75], v2 offset:50176
M v[164:167], a[128:131], a[160:163], v[164:167]
M v[164:167], a[132:135], a[164:167], v[164:167]
M v[172:175], a[140:143], a[164:167], v[172:175]
 ds_read_b64_tr_b16 a[76:77], v2 offset:57344
 ds_read_b64_tr_b16 a[78:79], v2 offset:58368
M v[172:175], a[136:139], a[160:163], v[172:175]
M v[180:183], a[144:147], a[160:163], v[180:183]
M v[180:183], a[148:151], a[164:167], v[180:183]
 s_waitcnt lgkmcnt(8)
 ds_read_b64_tr_b16 a[80:81], v3 offset:49152
 ds_read_b64_tr_b16 a[82:83], v3 offset:50176
M v[188:191], a[156:159], a[164:167], v[188:191]
 buffer_store_dwordx4 v[88:91], v7, s[8:11], s3 offen offset:3072 sc1
M v[188:191], a[152:155], a[160:163], v[188:191]
M v[196:199], a[96:99], a[168:171], v[196:199]
 ds_read_b128 a[160:163], v5 offset:0
 ds_read_b128 a[164:167], v6 offset:0
M v[196:199], a[100:103], a[172:175], v[196:199]
 ds_read_b64_tr_b16 a[84:85], v3 offset:57344
 ds_read_b64_tr_b16 a[86:87], v3 offset:58368
M v[204:207], a[108:111], a[172:175], v[204:207]
M v[204:207], a[104:107], a[168:171], v[204:207]
 ds_read_b64_tr_b16 a[88:89], v4 offset:49152
 ds_read_b64_tr_b16 a[90:91], v4 offset:50176
M v[212:215], a[112:115], a[168:171], v[212:215]
M v[212:215], a[116:119], a[172:175], v[212:215]
M v[220:223], a[124:127], a[172:175], v[220:223]
 ds_read_b64_tr_b16 a[92:93], v4 offset:57344
 ds_read_b64_tr_b16 a[94:95], v4 offset:58368
M v[220:223], a[120:123], a[168:171], v[220:223]
M v[228:231], a[128:131], a[168:171], v[228:231]
M v[228:231], a[132:135], a[172:175], v[228:231]
M v[236:239], a[140:143], a[172:175], v[236:239]
M v[236:239], a[136:139], a[168:171], v[236:239]
M v[244:247], a[144:147], a[168:171], v[244:247]
M v[244:247], a[148:151], a[172:175], v[244:247]
 s_waitcnt lgkmcnt(6)
M v[252:255], a[156:159], a[172:175], v[252:255]
 s_waitcnt vmcnt(21) lgkmcnt(0)
M v[252:255], a[152:155], a[168:171], v[252:255]
 s_barrier
M v[32:35], a[32:35], a[160:163], v[32:35]
 s_add_u32 m0, s23, 32768
 ds_read_b128 a[168:171], v5 offset:2048
 ds_read_b128 a[172:175], v6 offset:2048
M v[32:35], a[36:39], a[164:167], v[32:35]
 ds_read_b64_tr_b16 a[96:97], v20 offset:0
 ds_read_b64_tr_b16 a[98:99], v20 offset:1024
M v[36:39], a[44:47], a[164:167], v[36:39]
 buffer_load_dwordx4 v16, s[56:59], s29 offen offset:0   lds
M v[36:39], a[40:43], a[160:163], v[36:39]
M v[40:43], a[48:51], a[160:163], v[40:43]
 s_add_u32 s3, s93, 540672
 ds_read_b64_tr_b16 a[100:101], v20 offset:8192
 ds_read_b64_tr_b16 a[102:103], v20 offset:9216
M v[40:43], a[52:55], a[164:167], v[40:43]
 buffer_load_dwordx4 v17, s[56:59], s29 offen offset:1024   lds
M v[44:47], a[60:63], a[164:167], v[44:47]
 buffer_store_dwordx4 v[96:99], v7, s[8:11], s3 offen offset:0 sc1
M v[44:47], a[56:59], a[160:163], v[44:47]
 ds_read_b64_tr_b16 a[104:105], v21 offset:0
 ds_read_b64_tr_b16 a[106:107], v21 offset:1024
M v[48:51], a[64:67], a[160:163], v[48:51]
M v[48:51], a[68:71], a[164:167], v[48:51]
 buffer_load_dwordx4 v18, s[56:59], s29 offen offset:2048   lds
M v[52:55], a[76:79], a[164:167], v[52:55]
 ds_read_b64_tr_b16 a[108:109], v21 offset:8192
 ds_read_b64_tr_b16 a[110:111], v21 offset:9216
M v[52:55], a[72:75], a[160:163], v[52:55]
M v[56:59], a[80:83], a[160:163], v[56:59]
M v[56:59], a[84:87], a[164:167], v[56:59]
 s_waitcnt lgkmcnt(8)
 ds_read_b64_tr_b16 a[112:113], v22 offset:0
 ds_read_b64_tr_b16 a[114:115], v22 offset:1024
M v[60:63], a[92:95], a[164:167], v[60:63]
 buffer_load_dwordx4 v19, s[56:59], s29 offen offset:3072   lds
M v[60:63], a[88:91], a[160:163], v[60:63]
 s_add_u32 s29, s29, 128
M v[68:71], a[32:35], a[168:171], v[68:71]
 ds_read_b128 a[160:163], v5 offset:4096
 ds_read_b128 a[164:167], v6 offset:4096
M v[68:71], a[36:39], a[172:175], v[68:71]
 ds_read_b64_tr_b16 a[116:117], v22 offset:8192
 ds_read_b64_tr_b16 a[118:119], v22 offset:9216
M v[76:79], a[44:47], a[172:175], v[76:79]
 s_lshl_b32 s28, s20, 13
 buffer_store_dwordx4 v[104:107], v7, s[8:11], s3 offen offset:1024 sc1
M v[76:79], a[40:43], a[168:171], v[76:79]
 s_lshl_b32 s21, s27, 21
 ds_read_b64_tr_b16 a[120:121], v23 offset:0
 ds_read_b64_tr_b16 a[122:123], v23 offset:1024
M v[84:87], a[48:51], a[168:171], v[84:87]
 s_mov_b32 s22, 0
M v[84:87], a[52:55], a[172:175], v[84:87]
 s_add_u32 s21, s21, s92
M v[92:95], a[60:63], a[172:175], v[92:95]
 s_add_u32 s7, s21, 201326592
 ds_read_b64_tr_b16 a[124:125], v23 offset:8192
 ds_read_b64_tr_b16 a[126:127], v23 offset:9216
M v[92:95], a[56:59], a[168:171], v[92:95]
 s_add_u32 s38, s7, 131072
M v[100:103], a[64:67], a[168:171], v[100:103]
 s_add_u32 s64, s42, 1
M v[100:103], a[68:71], a[172:175], v[100:103]
 s_min_u32 s64, s64, 10
M v[108:111], a[76:79], a[172:175], v[108:111]
 s_sub_u32 s27, s64, 3
 buffer_load_dword v24, v13, s[8:11], s46 offen sc1
M v[108:111], a[72:75], a[168:171], v[108:111]
 s_lshl_b32 s6, s64, 1
M v[116:119], a[80:83], a[168:171], v[116:119]
 s_sub_u32 s43, s6, 2
 s_lshl_b32 s64, s42, 17
 s_add_u32 s4, s21, s64
M v[116:119], a[84:87], a[172:175], v[116:119]
 s_waitcnt lgkmcnt(6)
 s_sub_u32 s26, 2228224, s64
 s_add_u32 s26, s26, s21
M v[124:127], a[92:95], a[172:175], v[124:127]
 s_waitcnt vmcnt(20) lgkmcnt(0)
 s_lshl_b32 s64, s42, 1
 s_sub_u32 s64, 32, s64
M v[124:127], a[88:91], a[168:171], v[124:127]
 s_barrier
M v[132:135], a[32:35], a[160:163], v[132:135]
 s_cmp_ge_u32 s42, 10
 ds_read_b128 a[168:171], v5 offset:6144
 ds_read_b128 a[172:175], v6 offset:6144
M v[132:135], a[36:39], a[164:167], v[132:135]
 s_cselect_b32 s25, s64, 32767
 ds_read_b64_tr_b16 a[128:129], v20 offset:16384
 ds_read_b64_tr_b16 a[130:131], v20 offset:17408
M v[140:143], a[44:47], a[164:167], v[140:143]
 s_mov_b32 s23, 0
 buffer_store_dwordx4 v[112:115], v7, s[8:11], s3 offen offset:2048 sc1
M v[140:143], a[40:43], a[160:163], v[140:143]
M v[148:151], a[48:51], a[160:163], v[148:151]
 ds_read_b64_tr_b16 a[132:133], v20 offset:24576
 ds_read_b64_tr_b16 a[134:135], v20 offset:25600
M v[148:151], a[52:55], a[164:167], v[148:151]
M v[156:159], a[60:63], a[164:167], v[156:159]
M v[156:159], a[56:59], a[160:163], v[156:159]
 ds_read_b64_tr_b16 a[136:137], v21 offset:16384
 ds_read_b64_tr_b16 a[138:139], v21 offset:17408
M v[164:167], a[64:67], a[160:163], v[164:167]
M v[164:167], a[68:71], a[164:167], v[164:167]
M v[172:175], a[76:79], a[164:167], v[172:175]
 ds_read_b64_tr_b16 a[140:141], v21 offset:24576
 ds_read_b64_tr_b16 a[142:143], v21 offset:25600
M v[172:175], a[72:75], a[160:163], v[172:175]
M v[180:183], a[80:83], a[160:163], v[180:183]
M v[180:183], a[84:87], a[164:167], v[180:183]
 s_waitcnt lgkmcnt(8)
 ds_read_b64_tr_b16 a[144:145], v22 offset:16384
 ds_read_b64_tr_b16 a[146:147], v22 offset:17408
M v[188:191], a[92:95], a[164:167], v[188:191]
 buffer_store_dwordx4 v[120:123], v7, s[8:11], s3 offen offset:3072 sc1
M v[188:191], a[88:91], a[160:163], v[188:191]
M v[196:199], a[32:35], a[168:171], v[196:199]
 ds_read_b128 a[160:163], v5 offset:16384
 ds_read_b128 a[164:167], v6 offset:16384
M v[196:199], a[36:39], a[172:175], v[196:199]
 ds_read_b64_tr_b16 a[148:149], v22 offset:24576
 ds_read_b64_tr_b16 a[150:151], v22 offset:25600
M v[204:207], a[44:47], a[172:175], v[204:207]
M v[204:207], a[40:43], a[168:171], v[204:207]
 ds_read_b64_tr_b16 a[152:153], v23 offset:16384
 ds_read_b64_tr_b16 a[154:155], v23 offset:17408
M v[212:215], a[48:51], a[168:171], v[212:215]
M v[212:215], a[52:55], a[172:175], v[212:215]
M v[220:223], a[60:63], a[172:175], v[220:223]
 ds_read_b64_tr_b16 a[156:157], v23 offset:24576
 ds_read_b64_tr_b16 a[158:159], v23 offset:25600
M v[220:223], a[56:59], a[168:171], v[220:223]
M v[228:231], a[64:67], a[168:171], v[228:231]
M v[228:231], a[68:71], a[172:175], v[228:231]
M v[236:239], a[76:79], a[172:175], v[236:239]
M v[236:239], a[72:75], a[168:171], v[236:239]
M v[244:247], a[80:83], a[168:171], v[244:247]
M v[244:247], a[84:87], a[172:175], v[244:247]
 s_waitcnt lgkmcnt(6)
M v[252:255], a[92:95], a[172:175], v[252:255]
 s_waitcnt vmcnt(18) lgkmcnt(0)
M v[252:255], a[88:91], a[168:171], v[252:255]
 s_barrier
M v[32:35], a[96:99], a[160:163], v[32:35]
 ds_read_b128 a[168:171], v5 offset:18432
 ds_read_b128 a[172:175], v6 offset:18432
M v[32:35], a[100:103], a[164:167], v[32:35]
 ds_read_b64_tr_b16 a[32:33], v1 offset:0
 ds_read_b64_tr_b16 a[34:35], v1 offset:1024
M v[36:39], a[108:111], a[164:167], v[36:39]
 v_add_u32 v10, s28, v7
 v_add_u32 v10, s28, v10
M v[36:39], a[104:107], a[160:163], v[36:39]
 v_add_u32 v11, 0x1000, v10
 s_waitcnt vmcnt(2)
 v_cmp_eq_u32 vcc, 0, v24
M v[40:43], a[112:115], a[160:163], v[40:43]
 s_lshl_b32 s64, s20, 10
 ds_read_b64_tr_b16 a[36:37], v1 offset:8192
 ds_read_b64_tr_b16 a[38:39], v1 offset:9216
M v[40:43], a[116:119], a[164:167], v[40:43]
 s_cbranch_vccnz L_f1s14
L_f1r14:
 s_add_u32 s3, s93, 1048576
M v[44:47], a[124:127], a[164:167], v[44:47]
 s_add_u32 m0, s28, 98304
 s_nop 0
 buffer_load_dwordx4 v10, s[8:11], s21 offen offset:0 sc1 lds
M v[44:47], a[120:123], a[160:163], v[44:47]
 ds_read_b64_tr_b16 a[40:41], v2 offset:0
 ds_read_b64_tr_b16 a[42:43], v2 offset:1024
M v[48:51], a[128:131], a[160:163], v[48:51]
 buffer_store_dwordx4 v[128:131], v7, s[8:11], s3 offen offset:0 sc1
M v[48:51], a[132:135], a[164:167], v[48:51]
M v[52:55], a[140:143], a[164:167], v[52:55]
 ds_read_b64_tr_b16 a[44:45], v2 offset:8192
 ds_read_b64_tr_b16 a[46:47], v2 offset:9216
M v[52:55], a[136:139], a[160:163], v[52:55]
 buffer_load_dwordx4 v10, s[8:11], s21 offen offset:1024 sc1 lds
M v[56:59], a[144:147], a[160:163], v[56:59]
M v[56:59], a[148:151], a[164:167], v[56:59]
 s_waitcnt lgkmcnt(8)
 ds_read_b64_tr_b16 a[48:49], v3 offset:0
 ds_read_b64_tr_b16 a[50:51], v3 offset:1024
M v[60:63], a[156:159], a[164:167], v[60:63]
M v[60:63], a[152:155], a[160:163], v[60:63]
 buffer_load_dwordx4 v10, s[8:11], s21 offen offset:2048 sc1 lds
M v[68:71], a[96:99], a[168:171], v[68:71]
 ds_read_b128 a[160:163], v5 offset:20480
 ds_read_b128 a[164:167], v6 offset:20480
M v[68:71], a[100:103], a[172:175], v[68:71]
 ds_read_b64_tr_b16 a[52:53], v3 offset:8192
 ds_read_b64_tr_b16 a[54:55], v3 offset:9216
M v[76:79], a[108:111], a[172:175], v[76:79]
 buffer_store_dwordx4 v[136:139], v7, s[8:11], s3 offen offset:1024 sc1
M v[76:79], a[104:107], a[168:171], v[76:79]
 ds_read_b64_tr_b16 a[56:57], v4 offset:0
 ds_read_b64_tr_b16 a[58:59], v4 offset:1024
M v[84:87], a[112:115], a[168:171], v[84:87]
 buffer_load_dwordx4 v10, s[8:11], s21 offen offset:3072 sc1 lds
M v[84:87], a[116:119], a[172:175], v[84:87]
 s_add_u32 m0, s28, 102400
M v[92:95], a[124:127], a[172:175], v[92:95]
 ds_read_b64_tr_b16 a[60:61], v4 offset:8192
 ds_read_b64_tr_b16 a[62:63], v4 offset:9216
M v[92:95], a[120:123], a[168:171], v[92:95]
M v[100:103], a[128:131], a[168:171], v[100:103]
 buffer_load_dwordx4 v11, s[8:11], s21 offen offset:0 sc1 lds
M v[100:103], a[132:135], a[172:175], v[100:103]
M v[108:111], a[140:143], a[172:175], v[108:111]
M v[108:111], a[136:139], a[168:171], v[108:111]
M v[116:119], a[144:147], a[168:171], v[116:119]
 buffer_load_dwordx4 v11, s[8:11], s21 offen offset:1024 sc1 lds
M v[116:119], a[148:151], a[172:175], v[116:119]
 s_waitcnt lgkmcnt(6)
M v[124:127], a[156:159], a[172:175], v[124:127]
 s_waitcnt lgkmcnt(0)
 buffer_load_dwordx4 v11, s[8:11], s21 offen offset:2048 sc1 lds
M v[124:127], a[152:155], a[168:171], v[124:127]
 s_barrier
M v[132:135], a[96:99], a[160:163], v[132:135]
 ds_read_b128 a[168:171], v5 offset:22528
 ds_read_b128 a[172:175], v6 offset:22528
M v[132:135], a[100:103], a[164:167], v[132:135]
 ds_read_b64_tr_b16 a[64:65], v1 offset:16384
 ds_read_b64_tr_b16 a[66:67], v1 offset:17408
M v[140:143], a[108:111], a[164:167], v[140:143]
 buffer_load_dwordx4 v11, s[8:11], s21 offen offset:3072 sc1 lds
M v[140:143], a[104:107], a[160:163], v[140:143]
 s_add_u32 s24, s23, 33554432
 buffer_store_dwordx4 v[144:147], v7, s[8:11], s3 offen offset:2048 sc1
M v[148:151], a[112:115], a[160:163], v[148:151]
 s_mov_b32 s23, s21
 ds_read_b64_tr_b16 a[68:69], v1 offset:24576
 ds_read_b64_tr_b16 a[70:71], v1 offset:25600
M v[148:151], a[116:119], a[164:167], v[148:151]
 s_add_u32 s21, s21, 65536
M v[156:159], a[124:127], a[164:167], v[156:159]
 s_add_u32 s22, s22, 1
M v[156:159], a[120:123], a[160:163], v[156:159]
 s_cmp_eq_u32 s22, s25
 ds_read_b64_tr_b16 a[72:73], v2 offset:16384
 ds_read_b64_tr_b16 a[74:75], v2 offset:17408
M v[164:167], a[128:131], a[160:163], v[164:167]
 s_cselect_b32 s21, s26, s21
 v_subrev_u32 v5, 0x10000, v5
 v_subrev_u32 v6, 0x10000, v6
M v[164:167], a[132:135], a[164:167], v[164:167]
 s_cmp_eq_u32 s22, s43
M v[172:175], a[140:143], a[164:167], v[172:175]
 s_cselect_b32 s21, s4, s21
 ds_read_b64_tr_b16 a[76:77], v2 offset:24576
 ds_read_b64_tr_b16 a[78:79], v2 offset:25600
M v[172:175], a[136:139], a[160:163], v[172:175]
 s_cmp_eq_u32 s22, s6
M v[180:183], a[144:147], a[160:163], v[180:183]
 s_cselect_b32 s21, s7, s21
 v_mov_b32 v9, v25
 v_lshrrev_b32 v24, 4, v0
M v[180:183], a[148:151], a[164:167], v[180:183]
 s_waitcnt lgkmcnt(8)
 ds_read_b64_tr_b16 a[80:81], v3 offset:16384
 ds_read_b64_tr_b16 a[82:83], v3 offset:17408
M v[188:191], a[156:159], a[164:167], v[188:191]
 v_lshlrev_b32 v24, 2, v24
 v_and_b32 v25, 15, v0
M v[188:191], a[152:155], a[160:163], v[188:191]
 v_sub_u32 v24, v24, v25
M v[196:199], a[96:99], a[168:171], v[196:199]
 s_add_u32 s64, s64, s34
 ds_read_b128 a[160:163], v5 offset:32768
 ds_read_b128 a[164:167], v6 offset:32768
M v[196:199], a[100:103], a[172:175], v[196:199]
 s_add_u32 s52, s64, 131072
 ds_read_b64_tr_b16 a[84:85], v3 offset:24576
 ds_read_b64_tr_b16 a[86:87], v3 offset:25600
M v[204:207], a[108:111], a[172:175], v[204:207]
 s_mov_b32 s55, 0x21800000
 buffer_store_dwordx4 v[152:155], v7, s[8:11], s3 offen offset:3072 sc1
M v[204:207], a[104:107], a[168:171], v[204:207]
 s_and_b32 s65, s39, 0xf000000
 ds_read_b64_tr_b16 a[88:89], v4 offset:16384
 ds_read_b64_tr_b16 a[90:91], v4 offset:17408
M v[212:215], a[112:115], a[168:171], v[212:215]
 s_cmp_eq_u32 s20, 0
M v[212:215], a[116:119], a[172:175], v[212:215]
 s_cselect_b32 s54, s39, s65
M v[220:223], a[124:127], a[172:175], v[220:223]
 s_lshr_b32 s64, s20, 1
 ds_read_b64_tr_b16 a[92:93], v4 offset:24576
 ds_read_b64_tr_b16 a[94:95], v4 offset:25600
M v[220:223], a[120:123], a[168:171], v[220:223]
 s_lshl_b32 s64, s64, 17
M v[228:231], a[128:131], a[168:171], v[228:231]
 s_and_b32 s65, s20, 1
M v[228:231], a[132:135], a[172:175], v[228:231]
 s_lshl_b32 s65, s65, 12
M v[236:239], a[140:143], a[172:175], v[236:239]
 s_add_u32 s64, s64, s65
 v_add_u32 v14, s64, v7
 v_mov_b32 v8, 0xff800000
M v[236:239], a[136:139], a[168:171], v[236:239]
 v_cmp_lt_i32 s[16:17], 0, v24
 v_cmp_lt_i32 s[18:19], -1, v24
M v[244:247], a[144:147], a[168:171], v[244:247]
 v_cmp_lt_i32 s[48:49], -2, v24
 v_cmp_lt_i32 s[50:51], -3, v24
M v[244:247], a[148:151], a[172:175], v[244:247]
 s_waitcnt lgkmcnt(6)
M v[252:255], a[156:159], a[172:175], v[252:255]
 s_waitcnt lgkmcnt(0)
M v[252:255], a[152:155], a[168:171], v[252:255]
 s_barrier
M v[32:35], a[32:35], a[160:163], v[32:35]
 ds_read_b128 a[168:171], v5 offset:34816
 ds_read_b128 a[172:175], v6 offset:34816
M v[32:35], a[36:39], a[164:167], v[32:35]
 buffer_load_dword v24, v9, s[8:11], s46 offen sc1
M v[36:39], a[44:47], a[164:167], v[36:39]
 v_mov_b32 v1, v15
 v_add_u32 v2, 0x10000, v7
M v[36:39], a[40:43], a[160:163], v[36:39]
 v_mov_b32 v3, v10
 v_mov_b32 v4, v11
M v[40:43], a[48:51], a[160:163], v[40:43]
 s_mov_b64 s[60:61], s[76:77]
M v[40:43], a[52:55], a[164:167], v[40:43]
 s_mov_b32 s62, s78
M v[44:47], a[60:63], a[164:167], v[44:47]
 s_mov_b32 s63, 0x20000
 v_lshl_add_u32 v10, v0, 7, s95
 v_and_b32 v0, 48, v0
M v[44:47], a[56:59], a[160:163], v[44:47]
 v_lshl_add_u32 v0, v0, 24, v10
 v_mul_f32 v32, s5, v32
M v[48:51], a[64:67], a[160:163], v[48:51]
 v_mul_f32 v33, s5, v33
 v_mul_f32 v34, s5, v34
M v[48:51], a[68:71], a[164:167], v[48:51]
 v_mul_f32 v35, s5, v35
 v_mul_f32 v36, s5, v36
M v[52:55], a[76:79], a[164:167], v[52:55]
 v_mul_f32 v37, s5, v37
 v_mul_f32 v38, s5, v38
M v[52:55], a[72:75], a[160:163], v[52:55]
 v_mul_f32 v39, s5, v39
 v_cvt_pk_bf16_f32 v32, v32, v33
M v[56:59], a[80:83], a[160:163], v[56:59]
 v_cvt_pk_bf16_f32 v33, v34, v35
 v_cvt_pk_bf16_f32 v34, v36, v37
M v[56:59], a[84:87], a[164:167], v[56:59]
 s_waitcnt lgkmcnt(0)
 v_cvt_pk_bf16_f32 v35, v38, v39
 ds_write_b128 v14, v[32:35] offset:0
M v[60:63], a[92:95], a[164:167], v[60:63]
 s_add_u32 s3, s93, 1064960
 buffer_store_dwordx4 v[160:163], v7, s[8:11], s3 offen offset:0 sc1
M v[60:63], a[88:91], a[160:163], v[60:63]
 v_mul_f32 v40, s5, v40
 v_mul_f32 v41, s5, v41
M v[68:71], a[32:35], a[168:171], v[68:71]
 ds_read_b128 a[160:163], v5 offset:36864
 ds_read_b128 a[164:167], v6 offset:36864
M v[68:71], a[36:39], a[172:175], v[68:71]
 v_mul_f32 v42, s5, v42
 v_mul_f32 v43, s5, v43
M v[76:79], a[44:47], a[172:175], v[76:79]
 v_mul_f32 v44, s5, v44
 v_mul_f32 v45, s5, v45
M v[76:79], a[40:43], a[168:171], v[76:79]
 v_mul_f32 v46, s5, v46
 v_mul_f32 v47, s5, v47
M v[84:87], a[48:51], a[168:171], v[84:87]
 v_cvt_pk_bf16_f32 v40, v40, v41
 v_cvt_pk_bf16_f32 v41, v42, v43
M v[84:87], a[52:55], a[172:175], v[84:87]
 v_cvt_pk_bf16_f32 v42, v44, v45
 v_cvt_pk_bf16_f32 v43, v46, v47
M v[92:95], a[60:63], a[172:175], v[92:95]
 ds_write_b128 v14, v[40:43] offset:1024
M v[92:95], a[56:59], a[168:171], v[92:95]
 buffer_store_dwordx4 v[168:171], v7, s[8:11], s3 offen offset:1024 sc1
M v[100:103], a[64:67], a[168:171], v[100:103]
 v_mul_f32 v48, s5, v48
 v_mul_f32 v49, s5, v49
M v[100:103], a[68:71], a[172:175], v[100:103]
 v_mul_f32 v50, s5, v50
 v_mul_f32 v51, s5, v51
M v[108:111], a[76:79], a[172:175], v[108:111]
 v_mul_f32 v52, s5, v52
 v_mul_f32 v53, s5, v53
M v[108:111], a[72:75], a[168:171], v[108:111]
 v_mul_f32 v54, s5, v54
 v_mul_f32 v55, s5, v55
M v[116:119], a[80:83], a[168:171], v[116:119]
 v_cvt_pk_bf16_f32 v48, v48, v49
 v_cvt_pk_bf16_f32 v49, v50, v51
M v[116:119], a[84:87], a[172:175], v[116:119]
 s_waitcnt lgkmcnt(1)
 v_cvt_pk_bf16_f32 v50, v52, v53
 v_cvt_pk_bf16_f32 v51, v54, v55
M v[124:127], a[92:95], a[172:175], v[124:127]
 ds_write_b128 v14, v[48:51] offset:2048
M v[124:127], a[88:91], a[168:171], v[124:127]
 buffer_store_dwordx4 v[176:179], v7, s[8:11], s3 offen offset:2048 sc1
M v[132:135], a[32:35], a[160:163], v[132:135]
 ds_read_b128 a[168:171], v5 offset:38912
 ds_read_b128 a[172:175], v6 offset:38912
M v[132:135], a[36:39], a[164:167], v[132:135]
 v_mul_f32 v56, s5, v56
 v_mul_f32 v57, s5, v57
M v[140:143], a[44:47], a[164:167], v[140:143]
 v_mul_f32 v58, s5, v58
 v_mul_f32 v59, s5, v59
M v[140:143], a[40:43], a[160:163], v[140:143]
 v_mul_f32 v60, s5, v60
 v_mul_f32 v61, s5, v61
M v[148:151], a[48:51], a[160:163], v[148:151]
 v_mul_f32 v62, s5, v62
 v_mul_f32 v63, s5, v63
M v[148:151], a[52:55], a[164:167], v[148:151]
 v_cvt_pk_bf16_f32 v56, v56, v57
 v_cvt_pk_bf16_f32 v57, v58, v59
M v[156:159], a[60:63], a[164:167], v[156:159]
 v_cvt_pk_bf16_f32 v58, v60, v61
 v_cvt_pk_bf16_f32 v59, v62, v63
M v[156:159], a[56:59], a[160:163], v[156:159]
 s_waitcnt lgkmcnt(0)
 ds_write_b128 v14, v[56:59] offset:3072
M v[164:167], a[64:67], a[160:163], v[164:167]
 s_barrier
M v[164:167], a[68:71], a[164:167], v[164:167]
M v[172:175], a[76:79], a[164:167], v[172:175]
 s_add_u32 m0, s28, 32768
 s_nop 0
 buffer_load_dwordx4 v3, s[8:11], s21 offen offset:0 sc1 lds
M v[172:175], a[72:75], a[160:163], v[172:175]
M v[180:183], a[80:83], a[160:163], v[180:183]
 buffer_store_dwordx4 v[184:187], v7, s[8:11], s3 offen offset:3072 sc1
M v[180:183], a[84:87], a[164:167], v[180:183]
 v_mul_f32 v68, s5, v68
 v_mul_f32 v69, s5, v69
M v[188:191], a[92:95], a[164:167], v[188:191]
 buffer_load_dwordx4 v3, s[8:11], s21 offen offset:1024 sc1 lds
M v[188:191], a[88:91], a[160:163], v[188:191]
 v_mul_f32 v70, s5, v70
 v_mul_f32 v71, s5, v71
M v[196:199], a[32:35], a[168:171], v[196:199]
 v_mul_f32 v76, s5, v76
 v_mul_f32 v77, s5, v77
M v[196:199], a[36:39], a[172:175], v[196:199]
 v_mul_f32 v78, s5, v78
 v_mul_f32 v79, s5, v79
M v[204:207], a[44:47], a[172:175], v[204:207]
 buffer_load_dwordx4 v3, s[8:11], s21 offen offset:2048 sc1 lds
M v[204:207], a[40:43], a[168:171], v[204:207]
 v_cvt_pk_bf16_f32 v68, v68, v69
 v_cvt_pk_bf16_f32 v69, v70, v71
M v[212:215], a[48:51], a[168:171], v[212:215]
 v_cvt_pk_bf16_f32 v70, v76, v77
 v_cvt_pk_bf16_f32 v71, v78, v79
M v[212:215], a[52:55], a[172:175], v[212:215]
 ds_write_b128 v14, v[68:71] offset:8192
 v_mul_f32 v84, s5, v84
M v[220:223], a[60:63], a[172:175], v[220:223]
 buffer_load_dwordx4 v3, s[8:11], s21 offen offset:3072 sc1 lds
M v[220:223], a[56:59], a[168:171], v[220:223]
 s_add_u32 m0, s28, 36864
 v_mul_f32 v85, s5, v85
 v_mul_f32 v86, s5, v86
M v[228:231], a[64:67], a[168:171], v[228:231]
 v_mul_f32 v87, s5, v87
 v_mul_f32 v92, s5, v92
M v[228:231], a[68:71], a[172:175], v[228:231]
 v_mul_f32 v93, s5, v93
 v_mul_f32 v94, s5, v94
M v[236:239], a[76:79], a[172:175], v[236:239]
 buffer_load_dwordx4 v4, s[8:11], s21 offen offset:0 sc1 lds
M v[236:239], a[72:75], a[168:171], v[236:239]
 v_mul_f32 v95, s5, v95
 v_cvt_pk_bf16_f32 v84, v84, v85
M v[244:247], a[80:83], a[168:171], v[244:247]
 v_cvt_pk_bf16_f32 v85, v86, v87
 v_cvt_pk_bf16_f32 v86, v92, v93
M v[244:247], a[84:87], a[172:175], v[244:247]
 v_cvt_pk_bf16_f32 v87, v94, v95
 ds_write_b128 v14, v[84:87] offset:9216
M v[252:255], a[92:95], a[172:175], v[252:255]
 buffer_load_dwordx4 v4, s[8:11], s21 offen offset:1024 sc1 lds
M v[252:255], a[88:91], a[168:171], v[252:255]
 buffer_load_dwordx4 v4, s[8:11], s21 offen offset:2048 sc1 lds
 buffer_load_dwordx4 v4, s[8:11], s21 offen offset:3072 sc1 lds
 s_add_u32 s24, s23, 33554432
 s_mov_b32 s23, s21
 s_add_u32 s21, s21, 65536
 s_add_u32 s22, s22, 1
 s_cmp_eq_u32 s22, s25
 s_cselect_b32 s21, s26, s21
 s_cmp_eq_u32 s22, s43
 s_cselect_b32 s21, s4, s21
 s_cmp_eq_u32 s22, s6
 s_cselect_b32 s21, s7, s21
 v_mul_f32 v100, s5, v100
 v_mul_f32 v101, s5, v101
 v_mul_f32 v102, s5, v102
 v_mul_f32 v103, s5, v103
 v_mul_f32 v108, s5, v108
 v_mul_f32 v109, s5, v109
 v_mul_f32 v110, s5, v110
 v_mul_f32 v111, s5, v111
 v_cvt_pk_bf16_f32 v100, v100, v101
 v_cvt_pk_bf16_f32 v101, v102, v103
 v_cvt_pk_bf16_f32 v102, v108, v109
 v_cvt_pk_bf16_f32 v103, v110, v111
 ds_write_b128 v14, v[100:103] offset:10240
 v_pk_mul_f32 v[116:117], v[116:117], s[4:5] op_sel:[0,1] op_sel_hi:[1,1]
 v_pk_mul_f32 v[118:119], v[118:119], s[4:5] op_sel:[0,1] op_sel_hi:[1,1]
 v_pk_mul_f32 v[124:125], v[124:125], s[4:5] op_sel:[0,1] op_sel_hi:[1,1]
 v_pk_mul_f32 v[126:127], v[126:127], s[4:5] op_sel:[0,1] op_sel_hi:[1,1]
 v_cvt_pk_bf16_f32 v116, v116, v117
 v_cvt_pk_bf16_f32 v117, v118, v119
 v_cvt_pk_bf16_f32 v118, v124, v125
 v_cvt_pk_bf16_f32 v119, v126, v127
 ds_write_b128 v14, v[116:119] offset:11264
 v_pk_mul_f32 v[132:133], v[132:133], s[4:5] op_sel:[0,1] op_sel_hi:[1,1]
 v_pk_mul_f32 v[134:135], v[134:135], s[4:5] op_sel:[0,1] op_sel_hi:[1,1]
 v_pk_mul_f32 v[140:141], v[140:141], s[4:5] op_sel:[0,1] op_sel_hi:[1,1]
 v_pk_mul_f32 v[142:143], v[142:143], s[4:5] op_sel:[0,1] op_sel_hi:[1,1]
 v_cvt_pk_bf16_f32 v132, v132, v133
 v_cvt_pk_bf16_f32 v133, v134, v135
 v_cvt_pk_bf16_f32 v134, v140, v141
 v_cvt_pk_bf16_f32 v135, v142, v143
 ds_write_b128 v14, v[132:135] offset:16384
 v_pk_mul_f32 v[148:149], v[148:149], s[4:5] op_sel:[0,1] op_sel_hi:[1,1]
 v_pk_mul_f32 v[150:151], v[150:151], s[4:5] op_sel:[0,1] op_sel_hi:[1,1]
 v_pk_mul_f32 v[156:157], v[156:157], s[4:5] op_sel:[0,1] op_sel_hi:[1,1]
 v_pk_mul_f32 v[158:159], v[158:159], s[4:5] op_sel:[0,1] op_sel_hi:[1,1]
 v_cvt_pk_bf16_f32 v148, v148, v149
 v_cvt_pk_bf16_f32 v149, v150, v151
 v_cvt_pk_bf16_f32 v150, v156, v157
 v_cvt_pk_bf16_f32 v151, v158, v159
 ds_write_b128 v14, v[148:151] offset:17408
 v_pk_mul_f32 v[164:165], v[164:165], s[4:5] op_sel:[0,1] op_sel_hi:[1,1]
 v_pk_mul_f32 v[166:167], v[166:167], s[4:5] op_sel:[0,1] op_sel_hi:[1,1]
 v_pk_mul_f32 v[172:173], v[172:173], s[4:5] op_sel:[0,1] op_sel_hi:[1,1]
 v_pk_mul_f32 v[174:175], v[174:175], s[4:5] op_sel:[0,1] op_sel_hi:[1,1]
 v_cvt_pk_bf16_f32 v164, v164, v165
 v_cvt_pk_bf16_f32 v165, v166, v167
 v_cvt_pk_bf16_f32 v166, v172, v173
 v_cvt_pk_bf16_f32 v167, v174, v175
 ds_write_b128 v14, v[164:167] offset:18432
 v_pk_mul_f32 v[180:181], v[180:181], s[4:5] op_sel:[0,1] op_sel_hi:[1,1]
 v_pk_mul_f32 v[182:183], v[182:183], s[4:5] op_sel:[0,1] op_sel_hi:[1,1]
 v_pk_mul_f32 v[188:189], v[188:189], s[4:5] op_sel:[0,1] op_sel_hi:[1,1]
 v_pk_mul_f32 v[190:191], v[190:191], s[4:5] op_sel:[0,1] op_sel_hi:[1,1]
 v_cvt_pk_bf16_f32 v180, v180, v181
 v_cvt_pk_bf16_f32 v181, v182, v183
 v_cvt_pk_bf16_f32 v182, v188, v189
 v_cvt_pk_bf16_f32 v183, v190, v191
 ds_write_b128 v14, v[180:183] offset:19456
 v_pk_mul_f32 v[196:197], v[196:197], s[4:5] op_sel:[0,1] op_sel_hi:[1,1]
 v_pk_mul_f32 v[198:199], v[198:199], s[4:5] op_sel:[0,1] op_sel_hi:[1,1]
 v_pk_mul_f32 v[204:205], v[204:205], s[4:5] op_sel:[0,1] op_sel_hi:[1,1]
 v_pk_mul_f32 v[206:207], v[206:207], s[4:5] op_sel:[0,1] op_sel_hi:[1,1]
 v_cvt_pk_bf16_f32 v196, v196, v197
 v_cvt_pk_bf16_f32 v197, v198, v199
 v_cvt_pk_bf16_f32 v198, v204, v205
 v_cvt_pk_bf16_f32 v199, v206, v207
 ds_write_b128 v14, v[196:199] offset:24576
 v_pk_mul_f32 v[212:213], v[212:213], s[4:5] op_sel:[0,1] op_sel_hi:[1,1]
 v_pk_mul_f32 v[214:215], v[214:215], s[4:5] op_sel:[0,1] op_sel_hi:[1,1]
 v_pk_mul_f32 v[220:221], v[220:221], s[4:5] op_sel:[0,1] op_sel_hi:[1,1]
 v_pk_mul_f32 v[222:223], v[222:223], s[4:5] op_sel:[0,1] op_sel_hi:[1,1]
 v_cvt_pk_bf16_f32 v212, v212, v213
 v_cvt_pk_bf16_f32 v213, v214, v215
 v_cvt_pk_bf16_f32 v214, v220, v221
 v_cvt_pk_bf16_f32 v215, v222, v223
 ds_write_b128 v14, v[212:215] offset:25600
 v_pk_mul_f32 v[228:229], v[228:229], s[4:5] op_sel:[0,1] op_sel_hi:[1,1]
 v_pk_mul_f32 v[230:231], v[230:231], s[4:5] op_sel:[0,1] op_sel_hi:[1,1]
 v_pk_mul_f32 v[236:237], v[236:237], s[4:5] op_sel:[0,1] op_sel_hi:[1,1]
 v_pk_mul_f32 v[238:239], v[238:239], s[4:5] op_sel:[0,1] op_sel_hi:[1,1]
 v_cvt_pk_bf16_f32 v228, v228, v229
 v_cvt_pk_bf16_f32 v229, v230, v231
 v_cvt_pk_bf16_f32 v230, v236, v237
 v_cvt_pk_bf16_f32 v231, v238, v239
 ds_write_b128 v14, v[228:231] offset:26624
 v_pk_mul_f32 v[244:245], v[244:245], s[4:5] op_sel:[0,1] op_sel_hi:[1,1]
 v_pk_mul_f32 v[246:247], v[246:247], s[4:5] op_sel:[0,1] op_sel_hi:[1,1]
 v_pk_mul_f32 v[252:253], v[252:253], s[4:5] op_sel:[0,1] op_sel_hi:[1,1]
 v_pk_mul_f32 v[254:255], v[254:255], s[4:5] op_sel:[0,1] op_sel_hi:[1,1]
 v_cvt_pk_bf16_f32 v244, v244, v245
 v_cvt_pk_bf16_f32 v245, v246, v247
 v_cvt_pk_bf16_f32 v246, v252, v253
 v_cvt_pk_bf16_f32 v247, v254, v255
 ds_write_b128 v14, v[244:247] offset:27648
 s_waitcnt vmcnt(15) lgkmcnt(0)
 s_barrier
 ds_read_b128 a[64:67], v2 offset:32768
 ds_read_b128 a[68:71], v2 offset:33792
 ds_read_b128 a[72:75], v2 offset:34816
 ds_read_b128 a[76:79], v2 offset:35840
 ds_read_b128 a[80:83], v2 offset:36864
 ds_read_b128 a[84:87], v2 offset:37888
 ds_read_b128 a[88:91], v2 offset:38912
 ds_read_b128 a[92:95], v2 offset:39936
 s_lshl_b32 s64, s20, 13
 s_sub_u32 s65, 155648, s64
 v_add_u32 v10, s64, v7
 v_add_u32 v11, s65, v7
 ds_read_b128 a[0:3], v10 offset:0
 ds_read_b128 a[4:7], v10 offset:1024
 ds_read_b128 a[8:11], v10 offset:2048
 ds_read_b128 a[12:15], v10 offset:3072
 ds_read_b128 a[16:19], v10 offset:4096
 ds_read_b128 a[20:23], v10 offset:5120
 ds_read_b128 a[24:27], v10 offset:6144
 ds_read_b128 a[28:31], v10 offset:7168
 ds_read_b128 a[32:35], v11 offset:0
 ds_read_b128 a[36:39], v11 offset:1024
 ds_read_b128 a[40:43], v11 offset:2048
 ds_read_b128 a[44:47], v11 offset:3072
 ds_read_b128 a[48:51], v11 offset:4096
 ds_read_b128 a[52:55], v11 offset:5120
 ds_read_b128 a[56:59], v11 offset:6144
 ds_read_b128 a[60:63], v11 offset:7168
 s_waitcnt vmcnt(12)
 v_cmp_eq_u32 vcc, 0, v24
 v_mov_b32 v17, 3
 v_or_b32 v6, s35, v7
 s_cbranch_vccnz L_f1s15
L_f1r15:
 s_mov_b32 s30, s93
 s_add_u32 s29, s94, s92
 s_cmp_eq_u32 s20, 0
 s_cselect_b32 s5, 5, 0
 v_mov_b32 v32, 0xc1800000
 v_mov_b32 v33, 0xc1800000
 v_mov_b32 v34, 0xc1800000
 v_mov_b32 v35, 0xc1800000
 v_mov_b32 v36, 0xc1800000
 v_mov_b32 v37, 0xc1800000
 v_mov_b32 v38, 0xc1800000
 v_mov_b32 v39, 0xc1800000
 s_waitcnt lgkmcnt(0)
M v[64:67], a[64:67], a[0:3], v[32:35]
 ds_read_b128 a[96:99], v2 offset:40960
 v_mov_b32 v30, 0
M v[64:67], a[68:71], a[4:7], v[64:67]
 s_add_u32 m0, s28, 65536
 ds_read_b128 a[100:103], v2 offset:41984
 v_mov_b32 v31, 0
M v[64:67], a[72:75], a[8:11], v[64:67]
 buffer_load_dwordx4 v3, s[8:11], s24 offen offset:0 sc1 lds
M v[64:67], a[76:79], a[12:15], v[64:67]
 ds_read_b128 a[104:107], v2 offset:43008
 v_accvgpr_write_b32 a128, v192
M v[64:67], a[80:83], a[16:19], v[64:67]
 ds_read_b128 a[108:111], v2 offset:44032
 v_accvgpr_write_b32 a129, v193
M v[64:67], a[84:87], a[20:23], v[64:67]
 buffer_load_dwordx4 v3, s[8:11], s24 offen offset:1024 sc1 lds
M v[64:67], a[88:91], a[24:27], v[64:67]
 ds_read_b128 a[112:115], v2 offset:45056
 v_accvgpr_write_b32 a130, v194
M v[64:67], a[92:95], a[28:31], v[64:67]
 ds_read_b128 a[116:119], v2 offset:46080
 v_accvgpr_write_b32 a131, v195
M v[68:71], a[92:95], a[60:63], v[36:39]
 v_accvgpr_write_b32 a132, v200
 v_accvgpr_write_b32 a133, v201
M v[68:71], a[88:91], a[56:59], v[68:71]
 ds_read_b128 a[120:123], v2 offset:47104
 v_accvgpr_write_b32 a134, v202
M v[68:71], a[84:87], a[52:55], v[68:71]
 ds_read_b128 a[124:127], v2 offset:48128
 v_accvgpr_write_b32 a135, v203
M v[68:71], a[80:83], a[48:51], v[68:71]
 buffer_load_dwordx4 v3, s[8:11], s24 offen offset:2048 sc1 lds
M v[68:71], a[76:79], a[44:47], v[68:71]
 v_accvgpr_write_b32 a136, v208
 v_accvgpr_write_b32 a137, v209
M v[68:71], a[72:75], a[40:43], v[68:71]
 v_accvgpr_write_b32 a138, v210
 v_accvgpr_write_b32 a139, v211
M v[68:71], a[68:71], a[36:39], v[68:71]
 v_exp_f32 v18, v64
M v[68:71], a[64:67], a[32:35], v[68:71]
 s_waitcnt lgkmcnt(0)
 v_exp_f32 v19, v65
M v[72:75], a[96:99], a[0:3], v[32:35]
 ds_read_b128 a[64:67], v2 offset:49152
 v_add_f32 v26, v18, v19
M v[72:75], a[100:103], a[4:7], v[72:75]
 ds_read_b128 a[68:71], v2 offset:50176
 v_cvt_pk_bf16_f32 v40, v18, v19
M v[72:75], a[104:107], a[8:11], v[72:75]
 buffer_load_dwordx4 v3, s[8:11], s24 offen offset:3072 sc1 lds
M v[72:75], a[108:111], a[12:15], v[72:75]
 ds_read_b128 a[72:75], v2 offset:51200
 v_accvgpr_write_b32 a140, v216
M v[72:75], a[112:115], a[16:19], v[72:75]
 s_add_u32 m0, s28, 69632
 ds_read_b128 a[76:79], v2 offset:52224
 v_accvgpr_write_b32 a141, v217
M v[72:75], a[116:119], a[20:23], v[72:75]
 buffer_load_dwordx4 v4, s[8:11], s24 offen offset:0 sc1 lds
M v[72:75], a[120:123], a[24:27], v[72:75]
 ds_read_b128 a[80:83], v2 offset:53248
 v_accvgpr_write_b32 a142, v218
M v[72:75], a[124:127], a[28:31], v[72:75]
 s_add_u32 s3, s32, 0
 ds_read_b128 a[84:87], v2 offset:54272
 v_accvgpr_write_b32 a143, v219
M v[76:79], a[124:127], a[60:63], v[36:39]
 buffer_store_dwordx4 a[0:3], v6, s[8:11], s3 offen offset:0 sc1
M v[76:79], a[120:123], a[56:59], v[76:79]
 ds_read_b128 a[88:91], v2 offset:55296
 v_accvgpr_write_b32 a144, v224
M v[76:79], a[116:119], a[52:55], v[76:79]
 ds_read_b128 a[92:95], v2 offset:56320
 v_accvgpr_write_b32 a145, v225
M v[76:79], a[112:115], a[48:51], v[76:79]
 buffer_load_dwordx4 v4, s[8:11], s24 offen offset:1024 sc1 lds
M v[76:79], a[108:111], a[44:47], v[76:79]
 v_exp_f32 v20, v66
M v[76:79], a[104:107], a[40:43], v[76:79]
 buffer_store_dwordx4 a[4:7], v6, s[8:11], s3 offen offset:1024 sc1
M v[76:79], a[100:103], a[36:39], v[76:79]
 v_exp_f32 v21, v67
M v[76:79], a[96:99], a[32:35], v[76:79]
 s_waitcnt lgkmcnt(0)
 v_exp_f32 v22, v68
M v[80:83], a[64:67], a[0:3], v[32:35]
 ds_read_b128 a[96:99], v2 offset:57344
 v_add_f32 v26, v20, v26
M v[80:83], a[68:71], a[4:7], v[80:83]
 ds_read_b128 a[100:103], v2 offset:58368
 v_cvt_pk_bf16_f32 v41, v20, v21
M v[80:83], a[72:75], a[8:11], v[80:83]
 buffer_load_dwordx4 v4, s[8:11], s24 offen offset:2048 sc1 lds
M v[80:83], a[76:79], a[12:15], v[80:83]
 ds_read_b128 a[104:107], v2 offset:59392
 v_add_f32 v26, v21, v26
M v[80:83], a[80:83], a[16:19], v[80:83]
 ds_read_b128 a[108:111], v2 offset:60416
 v_accvgpr_write_b32 a146, v226
M v[80:83], a[84:87], a[20:23], v[80:83]
 buffer_store_dwordx4 a[8:11], v6, s[8:11], s3 offen offset:2048 sc1
M v[80:83], a[88:91], a[24:27], v[80:83]
 ds_read_b128 a[112:115], v2 offset:61440
 v_accvgpr_write_b32 a147, v227
M v[80:83], a[92:95], a[28:31], v[80:83]
 ds_read_b128 a[116:119], v2 offset:62464
 v_accvgpr_write_b32 a148, v232
M v[84:87], a[92:95], a[60:63], v[36:39]
 buffer_load_dwordx4 v4, s[8:11], s24 offen offset:3072 sc1 lds
M v[84:87], a[88:91], a[56:59], v[84:87]
 ds_read_b128 a[120:123], v2 offset:63488
 v_accvgpr_write_b32 a149, v233
M v[84:87], a[84:87], a[52:55], v[84:87]
 ds_read_b128 a[124:127], v2 offset:64512
 v_accvgpr_write_b32 a150, v234
M v[84:87], a[80:83], a[48:51], v[84:87]
 buffer_store_dwordx4 a[12:15], v6, s[8:11], s3 offen offset:3072 sc1
M v[84:87], a[76:79], a[44:47], v[84:87]
 s_add_u32 s3, s32, 4096
 v_exp_f32 v23, v69
M v[84:87], a[72:75], a[40:43], v[84:87]
 buffer_store_dwordx4 a[16:19], v6, s[8:11], s3 offen offset:0 sc1
M v[84:87], a[68:71], a[36:39], v[84:87]
 s_waitcnt vmcnt(13) lgkmcnt(0)
 v_exp_f32 v24, v70
M v[84:87], a[64:67], a[32:35], v[84:87]
 s_barrier
M v[88:91], a[96:99], a[0:3], v[32:35]
 ds_read_b128 a[64:67], v7 offset:32768
 v_add_f32 v27, v22, v23
M v[88:91], a[100:103], a[4:7], v[88:91]
 ds_read_b128 a[68:71], v7 offset:33792
 v_cvt_pk_bf16_f32 v44, v22, v23
M v[88:91], a[104:107], a[8:11], v[88:91]
 buffer_store_dword v17, v1, s[8:11], s45 offen sc1
M v[88:91], a[108:111], a[12:15], v[88:91]
 ds_read_b128 a[72:75], v7 offset:34816
 v_accvgpr_write_b32 a151, v235
M v[88:91], a[112:115], a[16:19], v[88:91]
 ds_read_b128 a[76:79], v7 offset:35840
 v_accvgpr_write_b32 a152, v240
M v[88:91], a[116:119], a[20:23], v[88:91]
 buffer_store_dwordx4 a[20:23], v6, s[8:11], s3 offen offset:1024 sc1
M v[88:91], a[120:123], a[24:27], v[88:91]
 ds_read_b128 a[80:83], v7 offset:36864
 v_accvgpr_write_b32 a153, v241
M v[88:91], a[124:127], a[28:31], v[88:91]
 ds_read_b128 a[84:87], v7 offset:37888
 v_accvgpr_write_b32 a154, v242
M v[92:95], a[124:127], a[60:63], v[36:39]
 buffer_store_dwordx4 a[24:27], v6, s[8:11], s3 offen offset:2048 sc1
M v[92:95], a[120:123], a[56:59], v[92:95]
 ds_read_b128 a[88:91], v7 offset:38912
 v_accvgpr_write_b32 a155, v243
M v[92:95], a[116:119], a[52:55], v[92:95]
 ds_read_b128 a[92:95], v7 offset:39936
 v_accvgpr_write_b32 a156, v248
M v[92:95], a[112:115], a[48:51], v[92:95]
 buffer_store_dwordx4 a[28:31], v6, s[8:11], s3 offen offset:3072 sc1
M v[92:95], a[108:111], a[44:47], v[92:95]
 v_exp_f32 v25, v71
M v[92:95], a[104:107], a[40:43], v[92:95]
 v_exp_f32 v18, v72
M v[92:95], a[100:103], a[36:39], v[92:95]
 s_waitcnt lgkmcnt(0)
 v_exp_f32 v19, v73
M v[92:95], a[96:99], a[32:35], v[92:95]
 v_exp_f32 v20, v74
M v[96:99], a[64:67], a[0:3], v[32:35]
 s_add_u32 m0, s28, 98304
 ds_read_b128 a[96:99], v7 offset:40960
 ds_read_b128 a[100:103], v7 offset:41984
M v[96:99], a[68:71], a[4:7], v[96:99]
 buffer_load_dwordx4 v3, s[8:11], s21 offen offset:0 sc1 lds
M v[96:99], a[72:75], a[8:11], v[96:99]
 v_exp_f32 v21, v75
M v[96:99], a[76:79], a[12:15], v[96:99]
 s_add_u32 s3, s32, 16384
 ds_read_b128 a[104:107], v7 offset:43008
 ds_read_b128 a[108:111], v7 offset:44032
M v[96:99], a[80:83], a[16:19], v[96:99]
 buffer_store_dwordx4 a[32:35], v6, s[8:11], s3 offen offset:0 sc1
M v[96:99], a[84:87], a[20:23], v[96:99]
 v_exp_f32 v22, v76
M v[96:99], a[88:91], a[24:27], v[96:99]
 ds_read_b128 a[112:115], v7 offset:45056
 ds_read_b128 a[116:119], v7 offset:46080
M v[96:99], a[92:95], a[28:31], v[96:99]
 buffer_load_dwordx4 v3, s[8:11], s21 offen offset:1024 sc1 lds
M v[100:103], a[92:95], a[60:63], v[36:39]
 v_exp_f32 v23, v77
M v[100:103], a[88:91], a[56:59], v[100:103]
 ds_read_b128 a[120:123], v7 offset:47104
 ds_read_b128 a[124:127], v7 offset:48128
M v[100:103], a[84:87], a[52:55], v[100:103]
 buffer_store_dwordx4 a[36:39], v6, s[8:11], s3 offen offset:1024 sc1
M v[100:103], a[80:83], a[48:51], v[100:103]
 v_add_f32 v27, v24, v27
 v_cvt_pk_bf16_f32 v45, v24, v25
M v[100:103], a[76:79], a[44:47], v[100:103]
 buffer_load_dwordx4 v3, s[8:11], s21 offen offset:2048 sc1 lds
M v[100:103], a[72:75], a[40:43], v[100:103]
 v_add_f32 v27, v25, v27
 v_add_f32 v26, v18, v26
M v[100:103], a[68:71], a[36:39], v[100:103]
 v_exp_f32 v24, v78
M v[100:103], a[64:67], a[32:35], v[100:103]
 s_waitcnt lgkmcnt(0)
 v_exp_f32 v25, v79
M v[108:111], a[96:99], a[32:35], v[36:39]
 ds_read_b128 a[64:67], v7 offset:49152
 ds_read_b128 a[68:71], v7 offset:50176
M v[108:111], a[100:103], a[36:39], v[108:111]
 buffer_load_dwordx4 v3, s[8:11], s21 offen offset:3072 sc1 lds
M v[108:111], a[104:107], a[40:43], v[108:111]
 v_cvt_pk_bf16_f32 v42, v18, v19
 v_add_f32 v26, v19, v26
M v[108:111], a[108:111], a[44:47], v[108:111]
 ds_read_b128 a[72:75], v7 offset:51200
 ds_read_b128 a[76:79], v7 offset:52224
M v[108:111], a[112:115], a[48:51], v[108:111]
 buffer_store_dwordx4 a[40:43], v6, s[8:11], s3 offen offset:2048 sc1
M v[108:111], a[116:119], a[52:55], v[108:111]
 v_exp_f32 v18, v80
M v[108:111], a[120:123], a[56:59], v[108:111]
 s_add_u32 m0, s28, 102400
 ds_read_b128 a[80:83], v7 offset:53248
 ds_read_b128 a[84:87], v7 offset:54272
M v[108:111], a[124:127], a[60:63], v[108:111]
 buffer_load_dwordx4 v4, s[8:11], s21 offen offset:0 sc1 lds
M v[104:107], a[124:127], a[28:31], v[32:35]
 v_exp_f32 v19, v81
M v[104:107], a[120:123], a[24:27], v[104:107]
 ds_read_b128 a[88:91], v7 offset:55296
 ds_read_b128 a[92:95], v7 offset:56320
M v[104:107], a[116:119], a[20:23], v[104:107]
 buffer_store_dwordx4 a[44:47], v6, s[8:11], s3 offen offset:3072 sc1
M v[104:107], a[112:115], a[16:19], v[104:107]
 v_add_f32 v26, v20, v26
 v_cvt_pk_bf16_f32 v43, v20, v21
M v[104:107], a[108:111], a[12:15], v[104:107]
 buffer_load_dwordx4 v4, s[8:11], s21 offen offset:1024 sc1 lds
M v[104:107], a[104:107], a[8:11], v[104:107]
 s_add_u32 s3, s32, 20480
 v_add_f32 v26, v21, v26
 v_add_f32 v27, v22, v27
M v[104:107], a[100:103], a[4:7], v[104:107]
 buffer_store_dwordx4 a[48:51], v6, s[8:11], s3 offen offset:0 sc1
M v[104:107], a[96:99], a[0:3], v[104:107]
 s_waitcnt lgkmcnt(0)
 v_exp_f32 v20, v82
M v[112:115], a[64:67], a[0:3], v[32:35]
 ds_read_b128 a[96:99], v7 offset:57344
 ds_read_b128 a[100:103], v7 offset:58368
M v[112:115], a[68:71], a[4:7], v[112:115]
 buffer_load_dwordx4 v4, s[8:11], s21 offen offset:2048 sc1 lds
M v[112:115], a[72:75], a[8:11], v[112:115]
 v_exp_f32 v21, v83
M v[112:115], a[76:79], a[12:15], v[112:115]
 ds_read_b128 a[104:107], v7 offset:59392
 ds_read_b128 a[108:111], v7 offset:60416
M v[112:115], a[80:83], a[16:19], v[112:115]
 buffer_load_dwordx4 v4, s[8:11], s21 offen offset:3072 sc1 lds
M v[112:115], a[84:87], a[20:23], v[112:115]
 s_add_u32 s24, s23, 33554432
 v_cvt_pk_bf16_f32 v46, v22, v23
 v_add_f32 v27, v23, v27
M v[112:115], a[88:91], a[24:27], v[112:115]
 s_mov_b32 s23, s21
 ds_read_b128 a[112:115], v7 offset:61440
 ds_read_b128 a[116:119], v7 offset:62464
M v[112:115], a[92:95], a[28:31], v[112:115]
 buffer_store_dwordx4 a[52:55], v6, s[8:11], s3 offen offset:1024 sc1
M v[116:119], a[92:95], a[60:63], v[36:39]
 s_add_u32 s21, s21, 65536
 v_add_f32 v27, v24, v27
M v[116:119], a[88:91], a[56:59], v[116:119]
 s_add_u32 s22, s22, 1
 ds_read_b128 a[120:123], v7 offset:63488
 ds_read_b128 a[124:127], v7 offset:64512
M v[116:119], a[84:87], a[52:55], v[116:119]
 s_cmp_eq_u32 s22, s25
 v_exp_f32 v22, v88
M v[116:119], a[80:83], a[48:51], v[116:119]
 s_cselect_b32 s21, s26, s21
 v_exp_f32 v23, v89
M v[116:119], a[76:79], a[44:47], v[116:119]
 buffer_store_dwordx4 a[56:59], v6, s[8:11], s3 offen offset:2048 sc1
M v[116:119], a[72:75], a[40:43], v[116:119]
 s_cmp_eq_u32 s22, s43
 v_cvt_pk_bf16_f32 v47, v24, v25
 v_add_f32 v27, v25, v27
M v[116:119], a[68:71], a[36:39], v[116:119]
 s_waitcnt vmcnt(21) lgkmcnt(0)
 v_exp_f32 v24, v90
M v[116:119], a[64:67], a[32:35], v[116:119]
 s_barrier
M v[124:127], a[96:99], a[32:35], v[36:39]
 s_cselect_b32 s21, s4, s21
 ds_read_b128 a[64:67], v2 offset:0
 ds_read_b128 a[68:71], v2 offset:1024
M v[124:127], a[100:103], a[36:39], v[124:127]
 s_cmp_eq_u32 s22, s6
 v_exp_f32 v25, v91
M v[124:127], a[104:107], a[40:43], v[124:127]
 s_cselect_b32 s21, s7, s21
 v_add_f32 v26, v18, v26
 v_cvt_pk_bf16_f32 v56, v18, v19
M v[124:127], a[108:111], a[44:47], v[124:127]
 ds_read_b128 a[72:75], v2 offset:2048
 ds_read_b128 a[76:79], v2 offset:3072
M v[124:127], a[112:115], a[48:51], v[124:127]
 buffer_store_dwordx4 a[60:63], v6, s[8:11], s3 offen offset:3072 sc1
M v[124:127], a[116:119], a[52:55], v[124:127]
 v_add_f32 v26, v19, v26
 v_add_f32 v26, v20, v26
M v[124:127], a[120:123], a[56:59], v[124:127]
 ds_read_b128 a[80:83], v2 offset:4096
 ds_read_b128 a[84:87], v2 offset:5120
M v[124:127], a[124:127], a[60:63], v[124:127]
 v_exp_f32 v18, v84
M v[120:123], a[124:127], a[28:31], v[32:35]
 v_exp_f32 v19, v85
M v[120:123], a[120:123], a[24:27], v[120:123]
 ds_read_b128 a[88:91], v2 offset:6144
 ds_read_b128 a[92:95], v2 offset:7168
M v[120:123], a[116:119], a[20:23], v[120:123]
 v_cvt_pk_bf16_f32 v57, v20, v21
 v_add_f32 v26, v21, v26
M v[120:123], a[112:115], a[16:19], v[120:123]
 v_exp_f32 v20, v86
M v[120:123], a[108:111], a[12:15], v[120:123]
 v_exp_f32 v21, v87
M v[120:123], a[104:107], a[8:11], v[120:123]
 v_add_f32 v26, v22, v26
 v_cvt_pk_bf16_f32 v58, v22, v23
M v[120:123], a[100:103], a[4:7], v[120:123]
 s_waitcnt lgkmcnt(0)
 v_add_f32 v26, v23, v26
 v_add_f32 v26, v24, v26
M v[120:123], a[96:99], a[0:3], v[120:123]
 v_exp_f32 v22, v92
 v_cvt_pk_bf16_f32 v59, v24, v25
 v_add_f32 v26, v25, v26
 v_add_f32 v27, v18, v27
 v_cvt_pk_bf16_f32 v60, v18, v19
 v_add_f32 v27, v19, v27
 v_exp_f32 v23, v93
 v_add_f32 v27, v20, v27
 v_cvt_pk_bf16_f32 v61, v20, v21
 v_add_f32 v27, v21, v27
 v_exp_f32 v24, v94
 v_add_f32 v27, v22, v27
 v_cvt_pk_bf16_f32 v62, v22, v23
 v_exp_f32 v25, v95
 v_add_f32 v27, v23, v27
 v_add_f32 v27, v24, v27
 v_cvt_pk_bf16_f32 v63, v24, v25
 v_add_f32 v27, v25, v27
 v_max_f32 v10, v26, v27
 v_min_f32 v11, v26, v27
 v_cmp_lt_f32 s[36:37], s31, v10
 v_cmp_gt_f32 vcc, s55, v11
 s_nop 0
 s_or_b64 vcc, vcc, s[36:37]
 s_cbranch_vccnz L_st8
L_rt8:
M v[128:131], a[64:67], v[40:43], 0
 s_add_u32 m0, s28, 0
 ds_read_b128 a[96:99], v2 offset:8192
 ds_read_b128 a[100:103], v2 offset:9216
M v[128:131], a[68:71], v[56:59], v[128:131]
 buffer_load_dwordx4 v3, s[8:11], s24 offen offset:0 sc1 lds
M v[132:135], a[68:71], v[60:63], 0
 v_accvgpr_write_b32 a157, v249
 v_accvgpr_write_b32 a158, v250
M v[132:135], a[64:67], v[44:47], v[132:135]
 ds_read_b128 a[104:107], v2 offset:10240
 ds_read_b128 a[108:111], v2 offset:11264
M v[140:143], a[72:75], v[44:47], 0
 buffer_load_dwordx4 v3, s[8:11], s24 offen offset:1024 sc1 lds
M v[140:143], a[76:79], v[60:63], v[140:143]
 v_accvgpr_write_b32 a159, v251
 v_add_f32 v30, v26, v30
M v[136:139], a[76:79], v[56:59], 0
 ds_read_b128 a[112:115], v2 offset:12288
 ds_read_b128 a[116:119], v2 offset:13312
M v[136:139], a[72:75], v[40:43], v[136:139]
 buffer_load_dwordx4 v3, s[8:11], s24 offen offset:2048 sc1 lds
M v[144:147], a[80:83], v[40:43], 0
 v_exp_f32 v18, v96
M v[144:147], a[84:87], v[56:59], v[144:147]
 ds_read_b128 a[120:123], v2 offset:14336
 ds_read_b128 a[124:127], v2 offset:15360
M v[148:151], a[84:87], v[60:63], 0
 buffer_load_dwordx4 v3, s[8:11], s24 offen offset:3072 sc1 lds
M v[148:151], a[80:83], v[44:47], v[148:151]
 s_add_u32 m0, s28, 4096
 v_exp_f32 v19, v97
M v[156:159], a[88:91], v[44:47], 0
 buffer_load_dwordx4 v4, s[8:11], s24 offen offset:0 sc1 lds
M v[156:159], a[92:95], v[60:63], v[156:159]
 v_exp_f32 v20, v98
M v[152:155], a[92:95], v[56:59], 0
 v_exp_f32 v21, v99
M v[152:155], a[88:91], v[40:43], v[152:155]
 s_waitcnt lgkmcnt(0)
 v_exp_f32 v22, v104
M v[160:163], a[96:99], v[40:43], 0
 ds_read_b128 a[64:67], v2 offset:16384
 ds_read_b128 a[68:71], v2 offset:17408
M v[160:163], a[100:103], v[56:59], v[160:163]
 buffer_load_dwordx4 v4, s[8:11], s24 offen offset:1024 sc1 lds
M v[164:167], a[100:103], v[60:63], 0
 v_exp_f32 v23, v105
M v[164:167], a[96:99], v[44:47], v[164:167]
 ds_read_b128 a[72:75], v2 offset:18432
 ds_read_b128 a[76:79], v2 offset:19456
M v[172:175], a[104:107], v[44:47], 0
 buffer_load_dwordx4 v4, s[8:11], s24 offen offset:2048 sc1 lds
M v[172:175], a[108:111], v[60:63], v[172:175]
 v_add_f32 v31, v27, v31
 v_add_f32 v28, v18, v19
M v[168:171], a[108:111], v[56:59], 0
 ds_read_b128 a[80:83], v2 offset:20480
 ds_read_b128 a[84:87], v2 offset:21504
M v[168:171], a[104:107], v[40:43], v[168:171]
 buffer_load_dwordx4 v4, s[8:11], s24 offen offset:3072 sc1 lds
M v[176:179], a[112:115], v[40:43], 0
 v_exp_f32 v24, v106
M v[176:179], a[116:119], v[56:59], v[176:179]
 s_add_u32 m0, s28, 32768
 ds_read_b128 a[88:91], v2 offset:22528
 ds_read_b128 a[92:95], v2 offset:23552
M v[180:183], a[116:119], v[60:63], 0
 buffer_load_dwordx4 v3, s[8:11], s21 offen offset:0 sc1 lds
M v[180:183], a[112:115], v[44:47], v[180:183]
 v_exp_f32 v25, v107
M v[188:191], a[120:123], v[44:47], 0
 buffer_load_dwordx4 v3, s[8:11], s21 offen offset:1024 sc1 lds
M v[188:191], a[124:127], v[60:63], v[188:191]
 v_cvt_pk_bf16_f32 v48, v18, v19
 v_add_f32 v28, v20, v28
M v[184:187], a[124:127], v[56:59], 0
 buffer_load_dwordx4 v3, s[8:11], s21 offen offset:2048 sc1 lds
M v[184:187], a[120:123], v[40:43], v[184:187]
 s_waitcnt lgkmcnt(0)
 v_exp_f32 v18, v100
M v[192:195], a[64:67], v[40:43], 0
 ds_read_b128 a[96:99], v2 offset:24576
 ds_read_b128 a[100:103], v2 offset:25600
M v[192:195], a[68:71], v[56:59], v[192:195]
 buffer_load_dwordx4 v3, s[8:11], s21 offen offset:3072 sc1 lds
M v[196:199], a[68:71], v[60:63], 0
 v_exp_f32 v19, v101
M v[196:199], a[64:67], v[44:47], v[196:199]
 s_add_u32 m0, s28, 36864
 ds_read_b128 a[104:107], v2 offset:26624
 ds_read_b128 a[108:111], v2 offset:27648
M v[204:207], a[72:75], v[44:47], 0
 buffer_load_dwordx4 v4, s[8:11], s21 offen offset:0 sc1 lds
M v[204:207], a[76:79], v[60:63], v[204:207]
 v_cvt_pk_bf16_f32 v49, v20, v21
 v_add_f32 v28, v21, v28
M v[200:203], a[76:79], v[56:59], 0
 ds_read_b128 a[112:115], v2 offset:28672
 ds_read_b128 a[116:119], v2 offset:29696
M v[200:203], a[72:75], v[40:43], v[200:203]
 buffer_load_dwordx4 v4, s[8:11], s21 offen offset:1024 sc1 lds
M v[208:211], a[80:83], v[40:43], 0
 v_exp_f32 v20, v102
M v[208:211], a[84:87], v[56:59], v[208:211]
 ds_read_b128 a[120:123], v2 offset:30720
 ds_read_b128 a[124:127], v2 offset:31744
M v[212:215], a[84:87], v[60:63], 0
 buffer_load_dwordx4 v4, s[8:11], s21 offen offset:2048 sc1 lds
M v[212:215], a[80:83], v[44:47], v[212:215]
 v_exp_f32 v21, v103
M v[220:223], a[88:91], v[44:47], 0
 v_add_f32 v28, v22, v28
 v_cvt_pk_bf16_f32 v50, v22, v23
M v[220:223], a[92:95], v[60:63], v[220:223]
 buffer_load_dwordx4 v4, s[8:11], s21 offen offset:3072 sc1 lds
M v[216:219], a[92:95], v[56:59], 0
 s_waitcnt vmcnt(16) lgkmcnt(0)
 s_add_u32 s24, s23, 33554432
 s_mov_b32 s23, s21
M v[216:219], a[88:91], v[40:43], v[216:219]
 s_barrier
M v[224:227], a[96:99], v[40:43], 0
 ds_read_b128 a[64:67], v2 offset:32768
 ds_read_b128 a[68:71], v2 offset:33792
M v[224:227], a[100:103], v[56:59], v[224:227]
 s_xor_b32 s3, s47, 64
 v_mov_b32 v5, 1
M v[228:231], a[100:103], v[60:63], 0
 v_min_u32 v6, 1, v7
 v_lshlrev_b32 v6, 29, v6
M v[228:231], a[96:99], v[44:47], v[228:231]
 ds_read_b128 a[72:75], v2 offset:34816
 ds_read_b128 a[76:79], v2 offset:35840
M v[236:239], a[104:107], v[44:47], 0
 v_or_b32 v6, s35, v6
 s_add_u32 s21, s21, 65536
M v[236:239], a[108:111], v[60:63], v[236:239]
 buffer_store_dword v5, v6, s[8:11], s3 offen sc1
M v[232:235], a[108:111], v[56:59], 0
 ds_read_b128 a[80:83], v2 offset:36864
 ds_read_b128 a[84:87], v2 offset:37888
M v[232:235], a[104:107], v[40:43], v[232:235]
 s_add_u32 s22, s22, 1
 v_add_f32 v28, v23, v28
M v[240:243], a[112:115], v[40:43], 0
 s_cmp_eq_u32 s22, s25
 v_exp_f32 v22, v108
M v[240:243], a[116:119], v[56:59], v[240:243]
 s_cselect_b32 s21, s26, s21
 ds_read_b128 a[88:91], v2 offset:38912
 ds_read_b128 a[92:95], v2 offset:39936
M v[244:247], a[116:119], v[60:63], 0
 s_cmp_eq_u32 s22, s43
 v_exp_f32 v23, v109
M v[244:247], a[112:115], v[44:47], v[244:247]
 s_cselect_b32 s21, s4, s21
 v_add_f32 v28, v24, v28
 v_cvt_pk_bf16_f32 v51, v24, v25
M v[252:255], a[120:123], v[44:47], 0
 s_cmp_eq_u32 s22, s6
 v_add_f32 v28, v25, v28
 v_add_f32 v29, v18, v19
M v[252:255], a[124:127], v[60:63], v[252:255]
 s_cselect_b32 s21, s7, s21
 v_exp_f32 v24, v110
M v[248:251], a[124:127], v[56:59], 0
 s_waitcnt lgkmcnt(0)
 v_exp_f32 v25, v111
M v[248:251], a[120:123], v[40:43], v[248:251]
 v_cvt_pk_bf16_f32 v52, v18, v19
 v_add_f32 v29, v20, v29
 v_cvt_pk_bf16_f32 v53, v20, v21
 v_add_f32 v29, v21, v29
 v_add_f32 v29, v22, v29
 v_cvt_pk_bf16_f32 v54, v22, v23
 v_add_f32 v29, v23, v29
 v_add_f32 v29, v24, v29
 v_cvt_pk_bf16_f32 v55, v24, v25
 v_add_f32 v29, v25, v29
M v[64:67], a[64:67], a[0:3], v[32:35]
 s_add_u32 m0, s28, 65536
 ds_read_b128 a[96:99], v2 offset:40960
 ds_read_b128 a[100:103], v2 offset:41984
M v[64:67], a[68:71], a[4:7], v[64:67]
 buffer_load_dwordx4 v3, s[8:11], s24 offen offset:0 sc1 lds
M v[64:67], a[72:75], a[8:11], v[64:67]
 v_exp_f32 v18, v112
M v[64:67], a[76:79], a[12:15], v[64:67]
 s_add_u32 s3, s30, 1572864
 ds_read_b128 a[104:107], v2 offset:43008
 ds_read_b128 a[108:111], v2 offset:44032
M v[64:67], a[80:83], a[16:19], v[64:67]
 buffer_store_dwordx4 a[128:131], v7, s[8:11], s3 offen offset:0 sc1
M v[64:67], a[84:87], a[20:23], v[64:67]
 v_exp_f32 v19, v113
M v[64:67], a[88:91], a[24:27], v[64:67]
 ds_read_b128 a[112:115], v2 offset:45056
 ds_read_b128 a[116:119], v2 offset:46080
M v[64:67], a[92:95], a[28:31], v[64:67]
 buffer_load_dwordx4 v3, s[8:11], s24 offen offset:1024 sc1 lds
M v[68:71], a[92:95], a[60:63], v[36:39]
 v_exp_f32 v20, v114
M v[68:71], a[88:91], a[56:59], v[68:71]
 ds_read_b128 a[120:123], v2 offset:47104
 ds_read_b128 a[124:127], v2 offset:48128
M v[68:71], a[84:87], a[52:55], v[68:71]
 v_exp_f32 v21, v115
M v[68:71], a[80:83], a[48:51], v[68:71]
 v_add_f32 v28, v18, v28
 v_cvt_pk_bf16_f32 v56, v18, v19
M v[68:71], a[76:79], a[44:47], v[68:71]
 v_add_f32 v28, v19, v28
 v_add_f32 v28, v20, v28
M v[68:71], a[72:75], a[40:43], v[68:71]
 buffer_load_dwordx4 v3, s[8:11], s24 offen offset:2048 sc1 lds
M v[68:71], a[68:71], a[36:39], v[68:71]
 v_exp_f32 v22, v120
M v[68:71], a[64:67], a[32:35], v[68:71]
 s_waitcnt lgkmcnt(0)
 v_cvt_pk_bf16_f32 v57, v20, v21
 v_add_f32 v28, v21, v28
M v[76:79], a[96:99], a[32:35], v[36:39]
 ds_read_b128 a[64:67], v2 offset:49152
 ds_read_b128 a[68:71], v2 offset:50176
M v[76:79], a[100:103], a[36:39], v[76:79]
 buffer_store_dwordx4 a[132:135], v7, s[8:11], s3 offen offset:1024 sc1
M v[76:79], a[104:107], a[40:43], v[76:79]
 v_exp_f32 v23, v121
M v[76:79], a[108:111], a[44:47], v[76:79]
 ds_read_b128 a[72:75], v2 offset:51200
 ds_read_b128 a[76:79], v2 offset:52224
M v[76:79], a[112:115], a[48:51], v[76:79]
 buffer_load_dwordx4 v3, s[8:11], s24 offen offset:3072 sc1 lds
M v[76:79], a[116:119], a[52:55], v[76:79]
 v_exp_f32 v24, v122
M v[76:79], a[120:123], a[56:59], v[76:79]
 ds_read_b128 a[80:83], v2 offset:53248
 ds_read_b128 a[84:87], v2 offset:54272
M v[76:79], a[124:127], a[60:63], v[76:79]
 v_add_f32 v28, v22, v28
 v_cvt_pk_bf16_f32 v58, v22, v23
M v[72:75], a[124:127], a[28:31], v[32:35]
 v_exp_f32 v25, v123
M v[72:75], a[120:123], a[24:27], v[72:75]
 s_add_u32 m0, s28, 69632
 ds_read_b128 a[88:91], v2 offset:55296
 ds_read_b128 a[92:95], v2 offset:56320
M v[72:75], a[116:119], a[20:23], v[72:75]
 buffer_load_dwordx4 v4, s[8:11], s24 offen offset:0 sc1 lds
M v[72:75], a[112:115], a[16:19], v[72:75]
 v_add_f32 v28, v23, v28
 v_add_f32 v28, v24, v28
M v[72:75], a[108:111], a[12:15], v[72:75]
 v_exp_f32 v18, v116
M v[72:75], a[104:107], a[8:11], v[72:75]
 v_cvt_pk_bf16_f32 v59, v24, v25
 v_add_f32 v28, v25, v28
M v[72:75], a[100:103], a[4:7], v[72:75]
M v[72:75], a[96:99], a[0:3], v[72:75]
 s_waitcnt lgkmcnt(0)
 v_exp_f32 v19, v117
M v[80:83], a[64:67], a[0:3], v[32:35]
 ds_read_b128 a[96:99], v2 offset:57344
 ds_read_b128 a[100:103], v2 offset:58368
M v[80:83], a[68:71], a[4:7], v[80:83]
 buffer_store_dwordx4 a[136:139], v7, s[8:11], s3 offen offset:2048 sc1
M v[80:83], a[72:75], a[8:11], v[80:83]
 v_add_f32 v29, v18, v29
 v_cvt_pk_bf16_f32 v60, v18, v19
M v[80:83], a[76:79], a[12:15], v[80:83]
 ds_read_b128 a[104:107], v2 offset:59392
 ds_read_b128 a[108:111], v2 offset:60416
M v[80:83], a[80:83], a[16:19], v[80:83]
 buffer_load_dwordx4 v4, s[8:11], s24 offen offset:1024 sc1 lds
M v[80:83], a[84:87], a[20:23], v[80:83]
 v_exp_f32 v20, v118
M v[80:83], a[88:91], a[24:27], v[80:83]
 ds_read_b128 a[112:115], v2 offset:61440
 ds_read_b128 a[116:119], v2 offset:62464
M v[80:83], a[92:95], a[28:31], v[80:83]
 buffer_load_dwordx4 v4, s[8:11], s24 offen offset:2048 sc1 lds
M v[84:87], a[92:95], a[60:63], v[36:39]
 v_exp_f32 v21, v119
M v[84:87], a[88:91], a[56:59], v[84:87]
 ds_read_b128 a[120:123], v2 offset:63488
 ds_read_b128 a[124:127], v2 offset:64512
M v[84:87], a[84:87], a[52:55], v[84:87]
 v_exp_f32 v22, v124
M v[84:87], a[80:83], a[48:51], v[84:87]
 buffer_load_dwordx4 v4, s[8:11], s24 offen offset:3072 sc1 lds
M v[84:87], a[76:79], a[44:47], v[84:87]
 v_add_f32 v29, v19, v29
 v_add_f32 v29, v20, v29
M v[84:87], a[72:75], a[40:43], v[84:87]
 buffer_store_dwordx4 a[140:143], v7, s[8:11], s3 offen offset:3072 sc1
M v[84:87], a[68:71], a[36:39], v[84:87]
 s_waitcnt vmcnt(21) lgkmcnt(0)
 v_exp_f32 v23, v125
M v[84:87], a[64:67], a[32:35], v[84:87]
 s_barrier
M v[92:95], a[96:99], a[32:35], v[36:39]
 ds_read_b128 a[64:67], v7 offset:0
 ds_read_b128 a[68:71], v7 offset:1024
M v[92:95], a[100:103], a[36:39], v[92:95]
 v_exp_f32 v24, v126
M v[92:95], a[104:107], a[40:43], v[92:95]
 v_cvt_pk_bf16_f32 v61, v20, v21
 v_add_f32 v29, v21, v29
M v[92:95], a[108:111], a[44:47], v[92:95]
 ds_read_b128 a[72:75], v7 offset:2048
 ds_read_b128 a[76:79], v7 offset:3072
M v[92:95], a[112:115], a[48:51], v[92:95]
 v_exp_f32 v25, v127
M v[92:95], a[116:119], a[52:55], v[92:95]
 v_add_f32 v29, v22, v29
 v_cvt_pk_bf16_f32 v62, v22, v23
M v[92:95], a[120:123], a[56:59], v[92:95]
 ds_read_b128 a[80:83], v7 offset:4096
 ds_read_b128 a[84:87], v7 offset:5120
M v[92:95], a[124:127], a[60:63], v[92:95]
 v_add_f32 v29, v23, v29
 v_add_f32 v29, v24, v29
M v[88:91], a[124:127], a[28:31], v[32:35]
 v_cvt_pk_bf16_f32 v63, v24, v25
 v_add_f32 v29, v25, v29
M v[88:91], a[120:123], a[24:27], v[88:91]
 ds_read_b128 a[88:91], v7 offset:6144
 ds_read_b128 a[92:95], v7 offset:7168
M v[88:91], a[116:119], a[20:23], v[88:91]
 v_max_f32 v10, v28, v29
M v[88:91], a[112:115], a[16:19], v[88:91]
 v_cmp_lt_f32 vcc, s31, v10
M v[88:91], a[108:111], a[12:15], v[88:91]
M v[88:91], a[104:107], a[8:11], v[88:91]
M v[88:91], a[100:103], a[4:7], v[88:91]
 s_waitcnt lgkmcnt(0)
M v[88:91], a[96:99], a[0:3], v[88:91]
 s_cbranch_vccnz L_st9
L_rt9:
M v[128:131], a[64:67], v[48:51], v[128:131]
 s_add_u32 m0, s28, 98304
 ds_read_b128 a[96:99], v7 offset:8192
 ds_read_b128 a[100:103], v7 offset:9216
M v[128:131], a[68:71], v[56:59], v[128:131]
 buffer_load_dwordx4 v3, s[8:11], s21 offen offset:0 sc1 lds
M v[132:135], a[68:71], v[60:63], v[132:135]
 v_exp_f32 v18, v64
M v[132:135], a[64:67], v[52:55], v[132:135]
 s_add_u32 s3, s30, 1589248
 ds_read_b128 a[104:107], v7 offset:10240
 ds_read_b128 a[108:111], v7 offset:11264
M v[140:143], a[72:75], v[52:55], v[140:143]
 buffer_store_dwordx4 a[144:147], v7, s[8:11], s3 offen offset:0 sc1
M v[140:143], a[76:79], v[60:63], v[140:143]
 v_exp_f32 v19, v65
M v[136:139], a[76:79], v[56:59], v[136:139]
 ds_read_b128 a[112:115], v7 offset:12288
 ds_read_b128 a[116:119], v7 offset:13312
M v[136:139], a[72:75], v[48:51], v[136:139]
 buffer_load_dwordx4 v3, s[8:11], s21 offen offset:1024 sc1 lds
M v[144:147], a[80:83], v[48:51], v[144:147]
 v_exp_f32 v20, v66
M v[144:147], a[84:87], v[56:59], v[144:147]
 ds_read_b128 a[120:123], v7 offset:14336
 ds_read_b128 a[124:127], v7 offset:15360
M v[148:151], a[84:87], v[60:63], v[148:151]
 v_add_f32 v30, v28, v30
 v_add_f32 v31, v29, v31
M v[148:151], a[80:83], v[52:55], v[148:151]
 buffer_load_dwordx4 v3, s[8:11], s21 offen offset:2048 sc1 lds
M v[156:159], a[88:91], v[52:55], v[156:159]
 v_exp_f32 v21, v67
M v[156:159], a[92:95], v[60:63], v[156:159]
 v_add_f32 v26, v18, v19
 v_cvt_pk_bf16_f32 v40, v18, v19
M v[152:155], a[92:95], v[56:59], v[152:155]
 v_exp_f32 v22, v72
M v[152:155], a[88:91], v[48:51], v[152:155]
 s_waitcnt lgkmcnt(0)
 v_add_f32 v26, v20, v26
 v_cvt_pk_bf16_f32 v41, v20, v21
M v[160:163], a[96:99], v[48:51], v[160:163]
 ds_read_b128 a[64:67], v7 offset:16384
 ds_read_b128 a[68:71], v7 offset:17408
M v[160:163], a[100:103], v[56:59], v[160:163]
 buffer_store_dwordx4 a[148:151], v7, s[8:11], s3 offen offset:1024 sc1
M v[164:167], a[100:103], v[60:63], v[164:167]
 v_exp_f32 v23, v73
M v[164:167], a[96:99], v[52:55], v[164:167]
 ds_read_b128 a[72:75], v7 offset:18432
 ds_read_b128 a[76:79], v7 offset:19456
M v[172:175], a[104:107], v[52:55], v[172:175]
 buffer_load_dwordx4 v3, s[8:11], s21 offen offset:3072 sc1 lds
M v[172:175], a[108:111], v[60:63], v[172:175]
 v_add_f32 v26, v21, v26
 v_add_f32 v26, v22, v26
M v[168:171], a[108:111], v[56:59], v[168:171]
 s_add_u32 m0, s28, 102400
 ds_read_b128 a[80:83], v7 offset:20480
 ds_read_b128 a[84:87], v7 offset:21504
M v[168:171], a[104:107], v[48:51], v[168:171]
 buffer_load_dwordx4 v4, s[8:11], s21 offen offset:0 sc1 lds
M v[176:179], a[112:115], v[48:51], v[176:179]
 v_exp_f32 v24, v74
M v[176:179], a[116:119], v[56:59], v[176:179]
 ds_read_b128 a[88:91], v7 offset:22528
 ds_read_b128 a[92:95], v7 offset:23552
M v[180:183], a[116:119], v[60:63], v[180:183]
 v_exp_f32 v25, v75
M v[180:183], a[112:115], v[52:55], v[180:183]
 buffer_load_dwordx4 v4, s[8:11], s21 offen offset:1024 sc1 lds
M v[188:191], a[120:123], v[52:55], v[188:191]
 v_cvt_pk_bf16_f32 v42, v22, v23
 v_add_f32 v26, v23, v26
M v[188:191], a[124:127], v[60:63], v[188:191]
 v_exp_f32 v18, v68
M v[184:187], a[124:127], v[56:59], v[184:187]
 v_add_f32 v26, v24, v26
 v_cvt_pk_bf16_f32 v43, v24, v25
M v[184:187], a[120:123], v[48:51], v[184:187]
 s_waitcnt lgkmcnt(0)
 v_add_f32 v26, v25, v26
M v[192:195], a[64:67], v[48:51], v[192:195]
 ds_read_b128 a[96:99], v7 offset:24576
 ds_read_b128 a[100:103], v7 offset:25600
M v[192:195], a[68:71], v[56:59], v[192:195]
 buffer_store_dwordx4 a[152:155], v7, s[8:11], s3 offen offset:2048 sc1
M v[196:199], a[68:71], v[60:63], v[196:199]
 v_exp_f32 v19, v69
M v[196:199], a[64:67], v[52:55], v[196:199]
 ds_read_b128 a[104:107], v7 offset:26624
 ds_read_b128 a[108:111], v7 offset:27648
M v[204:207], a[72:75], v[52:55], v[204:207]
 buffer_load_dwordx4 v4, s[8:11], s21 offen offset:2048 sc1 lds
M v[204:207], a[76:79], v[60:63], v[204:207]
 v_exp_f32 v20, v70
M v[200:203], a[76:79], v[56:59], v[200:203]
 ds_read_b128 a[112:115], v7 offset:28672
 ds_read_b128 a[116:119], v7 offset:29696
M v[200:203], a[72:75], v[48:51], v[200:203]
 buffer_load_dwordx4 v4, s[8:11], s21 offen offset:3072 sc1 lds
M v[208:211], a[80:83], v[48:51], v[208:211]
 s_add_u32 s24, s23, 33554432
 v_exp_f32 v21, v71
M v[208:211], a[84:87], v[56:59], v[208:211]
 s_mov_b32 s23, s21
 ds_read_b128 a[120:123], v7 offset:30720
 ds_read_b128 a[124:127], v7 offset:31744
M v[212:215], a[84:87], v[60:63], v[212:215]
 s_add_u32 s21, s21, 65536
 v_add_f32 v27, v18, v19
 v_cvt_pk_bf16_f32 v44, v18, v19
M v[212:215], a[80:83], v[52:55], v[212:215]
 s_add_u32 s22, s22, 1
 v_add_f32 v27, v20, v27
 v_cvt_pk_bf16_f32 v45, v20, v21
M v[220:223], a[88:91], v[52:55], v[220:223]
 s_cmp_eq_u32 s22, s25
 v_exp_f32 v22, v76
M v[220:223], a[92:95], v[60:63], v[220:223]
 buffer_store_dwordx4 a[156:159], v7, s[8:11], s3 offen offset:3072 sc1
M v[216:219], a[92:95], v[56:59], v[216:219]
 s_waitcnt vmcnt(25) lgkmcnt(0)
 v_add_f32 v27, v21, v27
M v[216:219], a[88:91], v[48:51], v[216:219]
 s_barrier
M v[224:227], a[96:99], v[48:51], v[224:227]
 s_cselect_b32 s21, s26, s21
 ds_read_b128 a[64:67], v7 offset:32768
 ds_read_b128 a[68:71], v7 offset:33792
M v[224:227], a[100:103], v[56:59], v[224:227]
 s_cmp_eq_u32 s22, s43
 v_exp_f32 v23, v77
M v[228:231], a[100:103], v[60:63], v[228:231]
 s_cselect_b32 s21, s4, s21
 v_add_f32 v27, v22, v27
 v_cvt_pk_bf16_f32 v46, v22, v23
M v[228:231], a[96:99], v[52:55], v[228:231]
 s_cmp_eq_u32 s22, s6
 ds_read_b128 a[72:75], v7 offset:34816
 ds_read_b128 a[76:79], v7 offset:35840
M v[236:239], a[104:107], v[52:55], v[236:239]
 s_cselect_b32 s21, s7, s21
 v_exp_f32 v24, v78
M v[236:239], a[108:111], v[60:63], v[236:239]
 v_add_f32 v27, v23, v27
M v[232:235], a[108:111], v[56:59], v[232:235]
 ds_read_b128 a[80:83], v7 offset:36864
 ds_read_b128 a[84:87], v7 offset:37888
M v[232:235], a[104:107], v[48:51], v[232:235]
 v_exp_f32 v25, v79
M v[240:243], a[112:115], v[48:51], v[240:243]
 v_add_f32 v27, v24, v27
 v_cvt_pk_bf16_f32 v47, v24, v25
M v[240:243], a[116:119], v[56:59], v[240:243]
 ds_read_b128 a[88:91], v7 offset:38912
 ds_read_b128 a[92:95], v7 offset:39936
M v[244:247], a[116:119], v[60:63], v[244:247]
 v_add_f32 v27, v25, v27
M v[244:247], a[112:115], v[52:55], v[244:247]
M v[252:255], a[120:123], v[52:55], v[252:255]
M v[252:255], a[124:127], v[60:63], v[252:255]
M v[248:251], a[124:127], v[56:59], v[248:251]
 s_waitcnt lgkmcnt(0)
M v[248:251], a[120:123], v[48:51], v[248:251]
M v[96:99], a[64:67], a[0:3], v[32:35]
 s_add_u32 m0, s28, 0
 ds_read_b128 a[96:99], v7 offset:40960
M v[96:99], a[68:71], a[4:7], v[96:99]
 ds_read_b128 a[100:103], v7 offset:41984
M v[96:99], a[72:75], a[8:11], v[96:99]
 buffer_load_dword v6, v9, s[8:11], s46 offen sc1
M v[96:99], a[76:79], a[12:15], v[96:99]
 s_cmp_eq_u32 s20, 0
 ds_read_b128 a[104:107], v7 offset:43008
M v[96:99], a[80:83], a[16:19], v[96:99]
 s_cselect_b64 s[64:65], s[16:17], 0
 ds_read_b128 a[108:111], v7 offset:44032
M v[96:99], a[84:87], a[20:23], v[96:99]
 buffer_load_dwordx4 v3, s[8:11], s24 offen offset:0 sc1 lds
M v[96:99], a[88:91], a[24:27], v[96:99]
 s_cselect_b64 s[66:67], s[18:19], 0
 ds_read_b128 a[112:115], v7 offset:45056
M v[96:99], a[92:95], a[28:31], v[96:99]
 s_cselect_b64 s[68:69], s[48:49], 0
 ds_read_b128 a[116:119], v7 offset:46080
M v[100:103], a[92:95], a[60:63], v[36:39]
 buffer_load_dwordx4 v3, s[8:11], s24 offen offset:1024 sc1 lds
M v[100:103], a[88:91], a[56:59], v[100:103]
 s_cselect_b64 s[70:71], s[50:51], 0
 ds_read_b128 a[120:123], v7 offset:47104
M v[100:103], a[84:87], a[52:55], v[100:103]
 s_cmp_lt_u32 s20, 1
 ds_read_b128 a[124:127], v7 offset:48128
M v[100:103], a[80:83], a[48:51], v[100:103]
 s_cselect_b64 s[78:79], -1, 0
 v_exp_f32 v18, v80
M v[100:103], a[76:79], a[44:47], v[100:103]
 buffer_load_dwordx4 v3, s[8:11], s24 offen offset:2048 sc1 lds
M v[100:103], a[72:75], a[40:43], v[100:103]
 s_cmp_eq_u32 s20, 1
 v_exp_f32 v19, v81
M v[100:103], a[68:71], a[36:39], v[100:103]
 s_cselect_b64 s[72:73], s[16:17], s[78:79]
 v_exp_f32 v20, v82
M v[100:103], a[64:67], a[32:35], v[100:103]
 s_waitcnt lgkmcnt(0)
 v_exp_f32 v21, v83
M v[108:111], a[96:99], a[32:35], v[36:39]
 s_cselect_b64 s[74:75], s[18:19], s[78:79]
 ds_read_b128 a[64:67], v7 offset:49152
 v_add_f32 v26, v18, v26
M v[108:111], a[100:103], a[36:39], v[108:111]
 s_cselect_b64 s[76:77], s[48:49], s[78:79]
 ds_read_b128 a[68:71], v7 offset:50176
 v_cvt_pk_bf16_f32 v56, v18, v19
M v[108:111], a[104:107], a[40:43], v[108:111]
 buffer_load_dwordx4 v3, s[8:11], s24 offen offset:3072 sc1 lds
M v[108:111], a[108:111], a[44:47], v[108:111]
 s_cselect_b64 s[78:79], s[50:51], s[78:79]
 ds_read_b128 a[72:75], v7 offset:51200
 v_add_f32 v26, v19, v26
M v[108:111], a[112:115], a[48:51], v[108:111]
 s_add_u32 s3, s29, 0
 ds_read_b128 a[76:79], v7 offset:52224
 v_add_f32 v26, v20, v26
M v[108:111], a[116:119], a[52:55], v[108:111]
 buffer_store_dwordx4 a[192:195], v7, s[8:11], s3 offen sc1
M v[108:111], a[120:123], a[56:59], v[108:111]
 s_add_u32 m0, s28, 4096
 ds_read_b128 a[80:83], v7 offset:53248
 v_cvt_pk_bf16_f32 v57, v20, v21
M v[108:111], a[124:127], a[60:63], v[108:111]
 ds_read_b128 a[84:87], v7 offset:54272
 v_add_f32 v26, v21, v26
M v[104:107], a[124:127], a[28:31], v[32:35]
 buffer_load_dwordx4 v4, s[8:11], s24 offen offset:0 sc1 lds
M v[104:107], a[120:123], a[24:27], v[104:107]
 ds_read_b128 a[88:91], v7 offset:55296
M v[104:107], a[116:119], a[20:23], v[104:107]
 ds_read_b128 a[92:95], v7 offset:56320
M v[104:107], a[112:115], a[16:19], v[104:107]
 v_exp_f32 v22, v88
M v[104:107], a[108:111], a[12:15], v[104:107]
 buffer_load_dwordx4 v4, s[8:11], s24 offen offset:1024 sc1 lds
M v[104:107], a[104:107], a[8:11], v[104:107]
 v_exp_f32 v23, v89
M v[104:107], a[100:103], a[4:7], v[104:107]
 v_exp_f32 v24, v90
M v[104:107], a[96:99], a[0:3], v[104:107]
 s_waitcnt lgkmcnt(0)
 v_exp_f32 v25, v91
M v[112:115], a[64:67], a[0:3], v[32:35]
 s_add_u32 s3, s29, 65536
 ds_read_b128 a[96:99], v7 offset:57344
 v_add_f32 v26, v22, v26
M v[112:115], a[68:71], a[4:7], v[112:115]
 ds_read_b128 a[100:103], v7 offset:58368
 v_cvt_pk_bf16_f32 v58, v22, v23
M v[112:115], a[72:75], a[8:11], v[112:115]
 buffer_load_dwordx4 v4, s[8:11], s24 offen offset:2048 sc1 lds
M v[112:115], a[76:79], a[12:15], v[112:115]
 ds_read_b128 a[104:107], v7 offset:59392
 v_add_f32 v26, v23, v26
M v[112:115], a[80:83], a[16:19], v[112:115]
 ds_read_b128 a[108:111], v7 offset:60416
 v_add_f32 v26, v24, v26
M v[112:115], a[84:87], a[20:23], v[112:115]
 buffer_store_dwordx4 a[196:199], v7, s[8:11], s3 offen sc1
M v[112:115], a[88:91], a[24:27], v[112:115]
 ds_read_b128 a[112:115], v7 offset:61440
 v_cvt_pk_bf16_f32 v59, v24, v25
M v[112:115], a[92:95], a[28:31], v[112:115]
 ds_read_b128 a[116:119], v7 offset:62464
 v_add_f32 v26, v25, v26
M v[116:119], a[92:95], a[60:63], v[36:39]
 buffer_load_dwordx4 v4, s[8:11], s24 offen offset:3072 sc1 lds
M v[116:119], a[88:91], a[56:59], v[116:119]
 ds_read_b128 a[120:123], v7 offset:63488
M v[116:119], a[84:87], a[52:55], v[116:119]
 ds_read_b128 a[124:127], v7 offset:64512
M v[116:119], a[80:83], a[48:51], v[116:119]
 v_exp_f32 v18, v84
M v[116:119], a[76:79], a[44:47], v[116:119]
 v_exp_f32 v19, v85
M v[116:119], a[72:75], a[40:43], v[116:119]
 v_exp_f32 v20, v86
M v[116:119], a[68:71], a[36:39], v[116:119]
 s_waitcnt vmcnt(24) lgkmcnt(0)
 v_exp_f32 v21, v87
M v[116:119], a[64:67], a[32:35], v[116:119]
 s_barrier
M v[124:127], a[96:99], a[32:35], v[36:39]
 ds_read_b128 a[64:67], v2 offset:0
 v_add_f32 v27, v18, v27
M v[124:127], a[100:103], a[36:39], v[124:127]
 ds_read_b128 a[68:71], v2 offset:1024
 v_cvt_pk_bf16_f32 v60, v18, v19
M v[124:127], a[104:107], a[40:43], v[124:127]
 v_exp_f32 v22, v92
M v[124:127], a[108:111], a[44:47], v[124:127]
 ds_read_b128 a[72:75], v2 offset:2048
 v_add_f32 v27, v19, v27
M v[124:127], a[112:115], a[48:51], v[124:127]
 ds_read_b128 a[76:79], v2 offset:3072
 v_add_f32 v27, v20, v27
M v[124:127], a[116:119], a[52:55], v[124:127]
 v_exp_f32 v23, v93
M v[124:127], a[120:123], a[56:59], v[124:127]
 ds_read_b128 a[80:83], v2 offset:4096
 v_cvt_pk_bf16_f32 v61, v20, v21
M v[124:127], a[124:127], a[60:63], v[124:127]
 ds_read_b128 a[84:87], v2 offset:5120
 v_add_f32 v27, v21, v27
M v[120:123], a[124:127], a[28:31], v[32:35]
 v_exp_f32 v24, v94
M v[120:123], a[120:123], a[24:27], v[120:123]
 ds_read_b128 a[88:91], v2 offset:6144
 v_add_f32 v27, v22, v27
M v[120:123], a[116:119], a[20:23], v[120:123]
 ds_read_b128 a[92:95], v2 offset:7168
 v_cvt_pk_bf16_f32 v62, v22, v23
M v[120:123], a[112:115], a[16:19], v[120:123]
 v_exp_f32 v25, v95
M v[120:123], a[108:111], a[12:15], v[120:123]
 v_add_f32 v27, v23, v27
 v_add_f32 v27, v24, v27
M v[120:123], a[104:107], a[8:11], v[120:123]
 v_cvt_pk_bf16_f32 v63, v24, v25
 v_add_f32 v27, v25, v27
M v[120:123], a[100:103], a[4:7], v[120:123]
 s_waitcnt lgkmcnt(0)
M v[120:123], a[96:99], a[0:3], v[120:123]
 v_max_f32 v10, v26, v27
 v_cmp_lt_f32 vcc, s31, v10
 s_nop 0
 s_cbranch_vccnz L_st12
L_rt12:
M v[128:131], a[64:67], v[40:43], v[128:131]
 s_add_u32 m0, s28, 32768
 ds_read_b128 a[96:99], v2 offset:8192
 v_add_f32 v30, v26, v30
M v[128:131], a[68:71], v[56:59], v[128:131]
 ds_read_b128 a[100:103], v2 offset:9216
 v_add_f32 v31, v27, v31
M v[132:135], a[68:71], v[60:63], v[132:135]
 buffer_load_dwordx4 v3, s[8:11], s21 offen offset:0 sc1 lds
M v[132:135], a[64:67], v[44:47], v[132:135]
 s_add_u32 s3, s29, 131072
 ds_read_b128 a[104:107], v2 offset:10240
M v[140:143], a[72:75], v[44:47], v[140:143]
 ds_read_b128 a[108:111], v2 offset:11264
M v[140:143], a[76:79], v[60:63], v[140:143]
 buffer_load_dwordx4 v3, s[8:11], s21 offen offset:1024 sc1 lds
M v[136:139], a[76:79], v[56:59], v[136:139]
 ds_read_b128 a[112:115], v2 offset:12288
M v[136:139], a[72:75], v[40:43], v[136:139]
 ds_read_b128 a[116:119], v2 offset:13312
M v[144:147], a[80:83], v[40:43], v[144:147]
 buffer_store_dwordx4 a[200:203], v7, s[8:11], s3 offen sc1
M v[144:147], a[84:87], v[56:59], v[144:147]
 ds_read_b128 a[120:123], v2 offset:14336
M v[148:151], a[84:87], v[60:63], v[148:151]
 ds_read_b128 a[124:127], v2 offset:15360
M v[148:151], a[80:83], v[44:47], v[148:151]
 buffer_load_dwordx4 v3, s[8:11], s21 offen offset:2048 sc1 lds
M v[156:159], a[88:91], v[44:47], v[156:159]
 v_exp_f32 v18, v96
M v[156:159], a[92:95], v[60:63], v[156:159]
 v_exp_f32 v19, v97
M v[152:155], a[92:95], v[56:59], v[152:155]
 buffer_load_dwordx4 v3, s[8:11], s21 offen offset:3072 sc1 lds
M v[152:155], a[88:91], v[40:43], v[152:155]
 s_waitcnt lgkmcnt(0)
 v_exp_f32 v20, v98
M v[160:163], a[96:99], v[40:43], v[160:163]
 ds_read_b128 a[64:67], v2 offset:16384
 v_add_f32 v28, v18, v19
M v[160:163], a[100:103], v[56:59], v[160:163]
 s_add_u32 m0, s28, 36864
 ds_read_b128 a[68:71], v2 offset:17408
 v_cvt_pk_bf16_f32 v48, v18, v19
M v[164:167], a[100:103], v[60:63], v[164:167]
 buffer_load_dwordx4 v4, s[8:11], s21 offen offset:0 sc1 lds
M v[164:167], a[96:99], v[44:47], v[164:167]
 ds_read_b128 a[72:75], v2 offset:18432
M v[172:175], a[104:107], v[44:47], v[172:175]
 ds_read_b128 a[76:79], v2 offset:19456
M v[172:175], a[108:111], v[60:63], v[172:175]
 v_exp_f32 v21, v99
M v[168:171], a[108:111], v[56:59], v[168:171]
 ds_read_b128 a[80:83], v2 offset:20480
 v_add_f32 v28, v20, v28
M v[168:171], a[104:107], v[40:43], v[168:171]
 s_add_u32 s3, s29, 196608
 ds_read_b128 a[84:87], v2 offset:21504
 v_cvt_pk_bf16_f32 v49, v20, v21
M v[176:179], a[112:115], v[40:43], v[176:179]
 buffer_load_dwordx4 v4, s[8:11], s21 offen offset:1024 sc1 lds
M v[176:179], a[116:119], v[56:59], v[176:179]
 ds_read_b128 a[88:91], v2 offset:22528
 v_add_f32 v28, v21, v28
M v[180:183], a[116:119], v[60:63], v[180:183]
 ds_read_b128 a[92:95], v2 offset:23552
M v[180:183], a[112:115], v[44:47], v[180:183]
 buffer_load_dwordx4 v4, s[8:11], s21 offen offset:2048 sc1 lds
M v[188:191], a[120:123], v[44:47], v[188:191]
 buffer_store_dwordx4 a[204:207], v7, s[8:11], s3 offen sc1
M v[188:191], a[124:127], v[60:63], v[188:191]
 v_exp_f32 v22, v104
M v[184:187], a[124:127], v[56:59], v[184:187]
 v_exp_f32 v23, v105
M v[184:187], a[120:123], v[40:43], v[184:187]
 s_waitcnt lgkmcnt(0)
 v_exp_f32 v24, v106
M v[192:195], a[64:67], v[40:43], v[192:195]
 ds_read_b128 a[96:99], v2 offset:24576
 v_add_f32 v28, v22, v28
M v[192:195], a[68:71], v[56:59], v[192:195]
 ds_read_b128 a[100:103], v2 offset:25600
 v_cvt_pk_bf16_f32 v50, v22, v23
M v[196:199], a[68:71], v[60:63], v[196:199]
 buffer_load_dwordx4 v4, s[8:11], s21 offen offset:3072 sc1 lds
M v[196:199], a[64:67], v[44:47], v[196:199]
 s_add_u32 s24, s23, 33554432
 ds_read_b128 a[104:107], v2 offset:26624
 v_add_f32 v28, v23, v28
M v[204:207], a[72:75], v[44:47], v[204:207]
 s_mov_b32 s23, s21
 ds_read_b128 a[108:111], v2 offset:27648
M v[204:207], a[76:79], v[60:63], v[204:207]
 s_add_u32 s21, s21, 65536
 v_exp_f32 v25, v107
M v[200:203], a[76:79], v[56:59], v[200:203]
 s_add_u32 s22, s22, 1
 ds_read_b128 a[112:115], v2 offset:28672
 v_add_f32 v28, v24, v28
M v[200:203], a[72:75], v[40:43], v[200:203]
 s_cmp_eq_u32 s22, s25
 ds_read_b128 a[116:119], v2 offset:29696
 v_cvt_pk_bf16_f32 v51, v24, v25
M v[208:211], a[80:83], v[40:43], v[208:211]
 s_cselect_b32 s21, s26, s21
 v_exp_f32 v18, v100
M v[208:211], a[84:87], v[56:59], v[208:211]
 s_cmp_eq_u32 s22, s43
 ds_read_b128 a[120:123], v2 offset:30720
 v_add_f32 v28, v25, v28
M v[212:215], a[84:87], v[60:63], v[212:215]
 s_cselect_b32 s21, s4, s21
 ds_read_b128 a[124:127], v2 offset:31744
M v[212:215], a[80:83], v[44:47], v[212:215]
 s_cmp_eq_u32 s22, s6
 v_exp_f32 v19, v101
M v[220:223], a[88:91], v[44:47], v[220:223]
 s_cselect_b32 s21, s7, s21
 v_exp_f32 v20, v102
M v[220:223], a[92:95], v[60:63], v[220:223]
 v_exp_f32 v21, v103
M v[216:219], a[92:95], v[56:59], v[216:219]
 s_waitcnt vmcnt(21) lgkmcnt(0)
 v_exp_f32 v22, v108
M v[216:219], a[88:91], v[40:43], v[216:219]
 s_barrier
M v[224:227], a[96:99], v[40:43], v[224:227]
 ds_read_b128 a[64:67], v2 offset:32768
 v_add_f32 v29, v18, v19
M v[224:227], a[100:103], v[56:59], v[224:227]
 ds_read_b128 a[68:71], v2 offset:33792
 v_mov_b32 v17, 4
M v[228:231], a[100:103], v[60:63], v[228:231]
 s_waitcnt vmcnt(20)
 v_cmp_gt_u32 vcc, 3, v6
 v_cvt_pk_bf16_f32 v52, v18, v19
M v[228:231], a[96:99], v[44:47], v[228:231]
 ds_read_b128 a[72:75], v2 offset:34816
 v_add_f32 v29, v20, v29
M v[236:239], a[104:107], v[44:47], v[236:239]
 ds_read_b128 a[76:79], v2 offset:35840
 v_cvt_pk_bf16_f32 v53, v20, v21
M v[236:239], a[108:111], v[60:63], v[236:239]
 s_cbranch_vccnz L_f4s
L_f4r:
 v_exp_f32 v23, v109
M v[232:235], a[108:111], v[56:59], v[232:235]
 ds_read_b128 a[80:83], v2 offset:36864
 v_add_f32 v29, v21, v29
M v[232:235], a[104:107], v[40:43], v[232:235]
 ds_read_b128 a[84:87], v2 offset:37888
 v_add_f32 v29, v22, v29
M v[240:243], a[112:115], v[40:43], v[240:243]
 buffer_store_dword v17, v1, s[8:11], s45 offen sc1
M v[240:243], a[116:119], v[56:59], v[240:243]
 ds_read_b128 a[88:91], v2 offset:38912
 v_cvt_pk_bf16_f32 v54, v22, v23
M v[244:247], a[116:119], v[60:63], v[244:247]
 ds_read_b128 a[92:95], v2 offset:39936
 v_add_f32 v29, v23, v29
M v[244:247], a[112:115], v[44:47], v[244:247]
 v_exp_f32 v24, v110
M v[252:255], a[120:123], v[44:47], v[252:255]
 v_exp_f32 v25, v111
M v[252:255], a[124:127], v[60:63], v[252:255]
 v_add_f32 v29, v24, v29
 v_cvt_pk_bf16_f32 v55, v24, v25
M v[248:251], a[124:127], v[56:59], v[248:251]
 s_waitcnt lgkmcnt(0)
 v_add_f32 v29, v25, v29
M v[248:251], a[120:123], v[40:43], v[248:251]
M v[64:67], a[64:67], a[0:3], v[32:35]
 s_add_u32 m0, s28, 65536
 ds_read_b128 a[96:99], v2 offset:40960
M v[64:67], a[68:71], a[4:7], v[64:67]
 ds_read_b128 a[100:103], v2 offset:41984
M v[64:67], a[72:75], a[8:11], v[64:67]
 buffer_load_dwordx4 v3, s[8:11], s24 offen offset:0 sc1 lds
M v[64:67], a[76:79], a[12:15], v[64:67]
 s_cmp_lt_u32 s20, 2
 ds_read_b128 a[104:107], v2 offset:43008
M v[64:67], a[80:83], a[16:19], v[64:67]
 s_cselect_b64 s[86:87], -1, 0
 ds_read_b128 a[108:111], v2 offset:44032
M v[64:67], a[84:87], a[20:23], v[64:67]
 s_cmp_eq_u32 s20, 2
 v_exp_f32 v18, v112
M v[64:67], a[88:91], a[24:27], v[64:67]
 s_cselect_b64 s[80:81], s[16:17], s[86:87]
 ds_read_b128 a[112:115], v2 offset:45056
M v[64:67], a[92:95], a[28:31], v[64:67]
 s_cselect_b64 s[82:83], s[18:19], s[86:87]
 ds_read_b128 a[116:119], v2 offset:46080
M v[68:71], a[92:95], a[60:63], v[36:39]
 buffer_load_dwordx4 v3, s[8:11], s24 offen offset:1024 sc1 lds
M v[68:71], a[88:91], a[56:59], v[68:71]
 s_cselect_b64 s[84:85], s[48:49], s[86:87]
 ds_read_b128 a[120:123], v2 offset:47104
M v[68:71], a[84:87], a[52:55], v[68:71]
 s_cselect_b64 s[86:87], s[50:51], s[86:87]
 ds_read_b128 a[124:127], v2 offset:48128
M v[68:71], a[80:83], a[48:51], v[68:71]
 s_cmp_eq_u32 s20, 3
 v_exp_f32 v19, v113
M v[68:71], a[76:79], a[44:47], v[68:71]
 buffer_load_dwordx4 v3, s[8:11], s24 offen offset:2048 sc1 lds
M v[68:71], a[72:75], a[40:43], v[68:71]
 s_cselect_b64 s[88:89], s[16:17], -1
 v_exp_f32 v20, v114
M v[68:71], a[68:71], a[36:39], v[68:71]
 s_cselect_b64 s[90:91], s[18:19], -1
 v_exp_f32 v21, v115
M v[68:71], a[64:67], a[32:35], v[68:71]
 s_waitcnt lgkmcnt(0)
 v_exp_f32 v22, v120
M v[76:79], a[96:99], a[32:35], v[36:39]
 s_cselect_b64 s[92:93], s[48:49], -1
 ds_read_b128 a[64:67], v2 offset:49152
 v_add_f32 v28, v18, v28
M v[76:79], a[100:103], a[36:39], v[76:79]
 s_cselect_b64 s[94:95], s[50:51], -1
 ds_read_b128 a[68:71], v2 offset:50176
 v_cvt_pk_bf16_f32 v56, v18, v19
M v[76:79], a[104:107], a[40:43], v[76:79]
 buffer_load_dwordx4 v3, s[8:11], s24 offen offset:3072 sc1 lds
M v[76:79], a[108:111], a[44:47], v[76:79]
 s_add_u32 s3, s29, 262144
 ds_read_b128 a[72:75], v2 offset:51200
 v_add_f32 v28, v19, v28
M v[76:79], a[112:115], a[48:51], v[76:79]
 ds_read_b128 a[76:79], v2 offset:52224
 v_add_f32 v28, v20, v28
M v[76:79], a[116:119], a[52:55], v[76:79]
 buffer_store_dwordx4 a[208:211], v7, s[8:11], s3 offen sc1
M v[76:79], a[120:123], a[56:59], v[76:79]
 s_add_u32 m0, s28, 69632
 ds_read_b128 a[80:83], v2 offset:53248
 v_cvt_pk_bf16_f32 v57, v20, v21
M v[76:79], a[124:127], a[60:63], v[76:79]
 ds_read_b128 a[84:87], v2 offset:54272
 v_add_f32 v28, v21, v28
M v[72:75], a[124:127], a[28:31], v[32:35]
 buffer_load_dwordx4 v4, s[8:11], s24 offen offset:0 sc1 lds
M v[72:75], a[120:123], a[24:27], v[72:75]
 ds_read_b128 a[88:91], v2 offset:55296
M v[72:75], a[116:119], a[20:23], v[72:75]
 ds_read_b128 a[92:95], v2 offset:56320
M v[72:75], a[112:115], a[16:19], v[72:75]
 v_exp_f32 v23, v121
M v[72:75], a[108:111], a[12:15], v[72:75]
 buffer_load_dwordx4 v4, s[8:11], s24 offen offset:1024 sc1 lds
M v[72:75], a[104:107], a[8:11], v[72:75]
 v_exp_f32 v24, v122
M v[72:75], a[100:103], a[4:7], v[72:75]
 s_add_u32 s3, s29, 327680
 v_exp_f32 v25, v123
M v[72:75], a[96:99], a[0:3], v[72:75]
 s_waitcnt lgkmcnt(0)
 v_exp_f32 v18, v116
M v[80:83], a[64:67], a[0:3], v[32:35]
 ds_read_b128 a[96:99], v2 offset:57344
 v_add_f32 v28, v22, v28
M v[80:83], a[68:71], a[4:7], v[80:83]
 ds_read_b128 a[100:103], v2 offset:58368
 v_cvt_pk_bf16_f32 v58, v22, v23
M v[80:83], a[72:75], a[8:11], v[80:83]
 buffer_load_dwordx4 v4, s[8:11], s24 offen offset:2048 sc1 lds
M v[80:83], a[76:79], a[12:15], v[80:83]
 ds_read_b128 a[104:107], v2 offset:59392
 v_add_f32 v28, v23, v28
M v[80:83], a[80:83], a[16:19], v[80:83]
 ds_read_b128 a[108:111], v2 offset:60416
 v_add_f32 v28, v24, v28
M v[80:83], a[84:87], a[20:23], v[80:83]
 buffer_store_dwordx4 a[212:215], v7, s[8:11], s3 offen sc1
M v[80:83], a[88:91], a[24:27], v[80:83]
 ds_read_b128 a[112:115], v2 offset:61440
 v_cvt_pk_bf16_f32 v59, v24, v25
M v[80:83], a[92:95], a[28:31], v[80:83]
 ds_read_b128 a[116:119], v2 offset:62464
 v_add_f32 v28, v25, v28
M v[84:87], a[92:95], a[60:63], v[36:39]
 buffer_load_dwordx4 v4, s[8:11], s24 offen offset:3072 sc1 lds
M v[84:87], a[88:91], a[56:59], v[84:87]
 ds_read_b128 a[120:123], v2 offset:63488
M v[84:87], a[84:87], a[52:55], v[84:87]
 ds_read_b128 a[124:127], v2 offset:64512
M v[84:87], a[80:83], a[48:51], v[84:87]
 v_exp_f32 v19, v117
M v[84:87], a[76:79], a[44:47], v[84:87]
 v_exp_f32 v20, v118
M v[84:87], a[72:75], a[40:43], v[84:87]
 v_exp_f32 v21, v119
M v[84:87], a[68:71], a[36:39], v[84:87]
 s_waitcnt vmcnt(21) lgkmcnt(0)
 v_exp_f32 v22, v124
M v[84:87], a[64:67], a[32:35], v[84:87]
 s_barrier
M v[92:95], a[96:99], a[32:35], v[36:39]
 ds_read_b128 a[64:67], v7 offset:0
 v_add_f32 v29, v18, v29
M v[92:95], a[100:103], a[36:39], v[92:95]
 ds_read_b128 a[68:71], v7 offset:1024
 v_cvt_pk_bf16_f32 v60, v18, v19
M v[92:95], a[104:107], a[40:43], v[92:95]
 v_exp_f32 v23, v125
M v[92:95], a[108:111], a[44:47], v[92:95]
 ds_read_b128 a[72:75], v7 offset:2048
 v_add_f32 v29, v19, v29
M v[92:95], a[112:115], a[48:51], v[92:95]
 ds_read_b128 a[76:79], v7 offset:3072
 v_add_f32 v29, v20, v29
M v[92:95], a[116:119], a[52:55], v[92:95]
 v_exp_f32 v24, v126
M v[92:95], a[120:123], a[56:59], v[92:95]
 ds_read_b128 a[80:83], v7 offset:4096
 v_cvt_pk_bf16_f32 v61, v20, v21
M v[92:95], a[124:127], a[60:63], v[92:95]
 ds_read_b128 a[84:87], v7 offset:5120
 v_add_f32 v29, v21, v29
M v[88:91], a[124:127], a[28:31], v[32:35]
 v_exp_f32 v25, v127
M v[88:91], a[120:123], a[24:27], v[88:91]
 ds_read_b128 a[88:91], v7 offset:6144
 v_add_f32 v29, v22, v29
M v[88:91], a[116:119], a[20:23], v[88:91]
 ds_read_b128 a[92:95], v7 offset:7168
 v_cvt_pk_bf16_f32 v62, v22, v23
M v[88:91], a[112:115], a[16:19], v[88:91]
 v_add_f32 v29, v23, v29
 v_add_f32 v29, v24, v29
M v[88:91], a[108:111], a[12:15], v[88:91]
 v_cvt_pk_bf16_f32 v63, v24, v25
 v_add_f32 v29, v25, v29
M v[88:91], a[104:107], a[8:11], v[88:91]
M v[88:91], a[100:103], a[4:7], v[88:91]
 s_waitcnt lgkmcnt(0)
M v[88:91], a[96:99], a[0:3], v[88:91]
 v_max_f32 v10, v28, v29
 v_cmp_lt_f32 vcc, s31, v10
 s_nop 0
 s_cbranch_vccnz L_st13
L_rt13:
M v[128:131], a[64:67], v[48:51], v[128:131]
 s_add_u32 m0, s28, 98304
 ds_read_b128 a[96:99], v7 offset:8192
 v_add_f32 v30, v28, v30
M v[128:131], a[68:71], v[56:59], v[128:131]
 s_add_u32 s3, s29, 393216
 ds_read_b128 a[100:103], v7 offset:9216
 v_add_f32 v31, v29, v31
M v[132:135], a[68:71], v[60:63], v[132:135]
 buffer_load_dwordx4 v3, s[8:11], s21 offen offset:0 sc1 lds
M v[132:135], a[64:67], v[52:55], v[132:135]
 ds_read_b128 a[104:107], v7 offset:10240
M v[140:143], a[72:75], v[52:55], v[140:143]
 ds_read_b128 a[108:111], v7 offset:11264
M v[140:143], a[76:79], v[60:63], v[140:143]
 buffer_load_dwordx4 v3, s[8:11], s21 offen offset:1024 sc1 lds
M v[136:139], a[76:79], v[56:59], v[136:139]
 ds_read_b128 a[112:115], v7 offset:12288
M v[136:139], a[72:75], v[48:51], v[136:139]
 ds_read_b128 a[116:119], v7 offset:13312
M v[144:147], a[80:83], v[48:51], v[144:147]
 buffer_store_dwordx4 a[216:219], v7, s[8:11], s3 offen sc1
M v[144:147], a[84:87], v[56:59], v[144:147]
 ds_read_b128 a[120:123], v7 offset:14336
M v[148:151], a[84:87], v[60:63], v[148:151]
 ds_read_b128 a[124:127], v7 offset:15360
M v[148:151], a[80:83], v[52:55], v[148:151]
 buffer_load_dwordx4 v3, s[8:11], s21 offen offset:2048 sc1 lds
M v[156:159], a[88:91], v[52:55], v[156:159]
 v_exp_f32 v18, v64
M v[156:159], a[92:95], v[60:63], v[156:159]
 v_exp_f32 v19, v65
M v[152:155], a[92:95], v[56:59], v[152:155]
 buffer_load_dwordx4 v3, s[8:11], s21 offen offset:3072 sc1 lds
M v[152:155], a[88:91], v[48:51], v[152:155]
 s_waitcnt lgkmcnt(0)
 v_exp_f32 v20, v66
M v[160:163], a[96:99], v[48:51], v[160:163]
 ds_read_b128 a[64:67], v7 offset:16384
 v_add_f32 v26, v18, v19
M v[160:163], a[100:103], v[56:59], v[160:163]
 s_add_u32 m0, s28, 102400
 ds_read_b128 a[68:71], v7 offset:17408
 v_cvt_pk_bf16_f32 v40, v18, v19
M v[164:167], a[100:103], v[60:63], v[164:167]
 buffer_load_dwordx4 v4, s[8:11], s21 offen offset:0 sc1 lds
M v[164:167], a[96:99], v[52:55], v[164:167]
 ds_read_b128 a[72:75], v7 offset:18432
M v[172:175], a[104:107], v[52:55], v[172:175]
 ds_read_b128 a[76:79], v7 offset:19456
M v[172:175], a[108:111], v[60:63], v[172:175]
 v_exp_f32 v21, v67
M v[168:171], a[108:111], v[56:59], v[168:171]
 ds_read_b128 a[80:83], v7 offset:20480
 v_add_f32 v26, v20, v26
M v[168:171], a[104:107], v[48:51], v[168:171]
 ds_read_b128 a[84:87], v7 offset:21504
 v_cvt_pk_bf16_f32 v41, v20, v21
M v[176:179], a[112:115], v[48:51], v[176:179]
 buffer_load_dwordx4 v4, s[8:11], s21 offen offset:1024 sc1 lds
M v[176:179], a[116:119], v[56:59], v[176:179]
 ds_read_b128 a[88:91], v7 offset:22528
 v_add_f32 v26, v21, v26
M v[180:183], a[116:119], v[60:63], v[180:183]
 ds_read_b128 a[92:95], v7 offset:23552
M v[180:183], a[112:115], v[52:55], v[180:183]
 buffer_load_dwordx4 v4, s[8:11], s21 offen offset:2048 sc1 lds
M v[188:191], a[120:123], v[52:55], v[188:191]
 v_exp_f32 v22, v72
M v[188:191], a[124:127], v[60:63], v[188:191]
 v_exp_f32 v23, v73
M v[184:187], a[124:127], v[56:59], v[184:187]
 v_exp_f32 v24, v74
M v[184:187], a[120:123], v[48:51], v[184:187]
 s_waitcnt lgkmcnt(0)
 v_exp_f32 v25, v75
M v[192:195], a[64:67], v[48:51], v[192:195]
 ds_read_b128 a[96:99], v7 offset:24576
 v_add_f32 v26, v22, v26
M v[192:195], a[68:71], v[56:59], v[192:195]
 ds_read_b128 a[100:103], v7 offset:25600
 v_cvt_pk_bf16_f32 v42, v22, v23
M v[196:199], a[68:71], v[60:63], v[196:199]
 buffer_load_dwordx4 v4, s[8:11], s21 offen offset:3072 sc1 lds
M v[196:199], a[64:67], v[52:55], v[196:199]
 s_add_u32 s24, s23, 33554432
 ds_read_b128 a[104:107], v7 offset:26624
 v_add_f32 v26, v23, v26
M v[204:207], a[72:75], v[52:55], v[204:207]
 s_mov_b32 s23, s21
 ds_read_b128 a[108:111], v7 offset:27648
 v_add_f32 v26, v24, v26
M v[204:207], a[76:79], v[60:63], v[204:207]
 s_add_u32 s21, s21, 65536
 v_exp_f32 v18, v68
M v[200:203], a[76:79], v[56:59], v[200:203]
 s_add_u32 s22, s22, 1
 ds_read_b128 a[112:115], v7 offset:28672
 v_cvt_pk_bf16_f32 v43, v24, v25
M v[200:203], a[72:75], v[48:51], v[200:203]
 s_cmp_eq_u32 s22, s25
 ds_read_b128 a[116:119], v7 offset:29696
 v_add_f32 v26, v25, v26
M v[208:211], a[80:83], v[48:51], v[208:211]
 s_cselect_b32 s21, s26, s21
 v_exp_f32 v19, v69
M v[208:211], a[84:87], v[56:59], v[208:211]
 s_cmp_eq_u32 s22, s43
 ds_read_b128 a[120:123], v7 offset:30720
 v_add_f32 v27, v18, v19
M v[212:215], a[84:87], v[60:63], v[212:215]
 s_cselect_b32 s21, s4, s21
 ds_read_b128 a[124:127], v7 offset:31744
 v_cvt_pk_bf16_f32 v44, v18, v19
M v[212:215], a[80:83], v[52:55], v[212:215]
 s_cmp_eq_u32 s22, s6
 v_exp_f32 v20, v70
M v[220:223], a[88:91], v[52:55], v[220:223]
 s_cselect_b32 s21, s7, s21
 v_exp_f32 v21, v71
M v[220:223], a[92:95], v[60:63], v[220:223]
 v_exp_f32 v22, v76
M v[216:219], a[92:95], v[56:59], v[216:219]
 s_waitcnt vmcnt(20) lgkmcnt(0)
 v_add_f32 v27, v20, v27
 v_cvt_pk_bf16_f32 v45, v20, v21
M v[216:219], a[88:91], v[48:51], v[216:219]
 s_barrier
M v[224:227], a[96:99], v[48:51], v[224:227]
 ds_read_b128 a[64:67], v7 offset:32768
 v_add_f32 v27, v21, v27
M v[224:227], a[100:103], v[56:59], v[224:227]
 ds_read_b128 a[68:71], v7 offset:33792
M v[228:231], a[100:103], v[60:63], v[228:231]
 v_exp_f32 v23, v77
M v[228:231], a[96:99], v[52:55], v[228:231]
 ds_read_b128 a[72:75], v7 offset:34816
 v_add_f32 v27, v22, v27
M v[236:239], a[104:107], v[52:55], v[236:239]
 ds_read_b128 a[76:79], v7 offset:35840
 v_cvt_pk_bf16_f32 v46, v22, v23
M v[236:239], a[108:111], v[60:63], v[236:239]
 v_exp_f32 v24, v78
M v[232:235], a[108:111], v[56:59], v[232:235]
 ds_read_b128 a[80:83], v7 offset:36864
 v_add_f32 v27, v23, v27
M v[232:235], a[104:107], v[48:51], v[232:235]
 ds_read_b128 a[84:87], v7 offset:37888
M v[240:243], a[112:115], v[48:51], v[240:243]
 v_exp_f32 v25, v79
M v[240:243], a[116:119], v[56:59], v[240:243]
 ds_read_b128 a[88:91], v7 offset:38912
 v_add_f32 v27, v24, v27
M v[244:247], a[116:119], v[60:63], v[244:247]
 ds_read_b128 a[92:95], v7 offset:39936
 v_cvt_pk_bf16_f32 v47, v24, v25
M v[244:247], a[112:115], v[52:55], v[244:247]
 v_add_f32 v27, v25, v27
M v[252:255], a[120:123], v[52:55], v[252:255]
M v[252:255], a[124:127], v[60:63], v[252:255]
M v[248:251], a[124:127], v[56:59], v[248:251]
 s_waitcnt lgkmcnt(0)
M v[248:251], a[120:123], v[48:51], v[248:251]
 s_branch L_loop_mid
L_zs0:
 s_mov_b32 s64, 65536
L_zs0_l:
 s_sleep 2
 buffer_load_dword v17, v16, s[12:15], 0 offen offset:0 sc1
 s_sub_u32 s64, s64, 1
 s_cbranch_scc1 L_zs0_x
 s_waitcnt vmcnt(0)
 v_cmp_eq_u32 vcc, 0, v17
 s_nop 0
 s_cbranch_vccnz L_zs0_l
L_zs0_x:
 s_waitcnt vmcnt(0)
 s_branch L_zr0
L_zs1:
 s_mov_b32 s64, 65536
L_zs1_l:
 s_sleep 2
 buffer_load_dword v17, v16, s[12:15], 0 offen offset:0 sc1
 s_sub_u32 s64, s64, 1
 s_cbranch_scc1 L_zs1_x
 s_waitcnt vmcnt(0)
 v_cmp_eq_u32 vcc, 0, v17
 s_nop 0
 s_cbranch_vccnz L_zs1_l
L_zs1_x:
 s_waitcnt vmcnt(0)
 s_branch L_zr1
L_hs:
 s_mov_b32 s91, 65536
L_hs_l:
 buffer_load_dwordx4 v[16:19], v7, s[8:11], s67 offen offset:0 sc1
 buffer_load_dwordx4 v[20:23], v7, s[8:11], s67 offen offset:1024 sc1
 s_waitcnt vmcnt(0)
 s_sub_u32 s91, s91, 1
 s_cbranch_scc1 L_hr
 v_min3_u32 v28, v16, v17, v18
 v_min3_u32 v28, v28, v19, v20
 v_min3_u32 v28, v28, v21, v22
 v_min_u32 v28, v28, v23
 v_cmp_eq_u32 vcc, 0, v28
 s_nop 0
 s_cbranch_vccnz L_hs_l
 s_branch L_hr
L_f1s04:
 s_mov_b32 s91, 65536
L_f1s04_l:
 s_sleep 2
 buffer_load_dword v24, v13, s[8:11], s46 offen sc1
 s_sub_u32 s91, s91, 1
 s_cbranch_scc1 L_f1s04_x
 s_waitcnt vmcnt(0)
 v_cmp_eq_u32 vcc, 0, v24
 s_nop 0
 s_cbranch_vccnz L_f1s04_l
L_f1s04_x:
 s_waitcnt vmcnt(0)
 s_branch L_f1r04
L_f1s05:
 s_mov_b32 s91, 65536
L_f1s05_l:
 s_sleep 2
 buffer_load_dword v24, v9, s[8:11], s46 offen sc1
 s_sub_u32 s91, s91, 1
 s_cbranch_scc1 L_f1s05_x
 s_waitcnt vmcnt(0)
 v_cmp_eq_u32 vcc, 0, v24
 s_nop 0
 s_cbranch_vccnz L_f1s05_l
L_f1s05_x:
 s_waitcnt vmcnt(0)
 s_branch L_f1r05
L_f1s14:
 s_mov_b32 s91, 65536
L_f1s14_l:
 s_sleep 2
 buffer_load_dword v24, v13, s[8:11], s46 offen sc1
 s_sub_u32 s91, s91, 1
 s_cbranch_scc1 L_f1s14_x
 s_waitcnt vmcnt(0)
 v_cmp_eq_u32 vcc, 0, v24
 s_nop 0
 s_cbranch_vccnz L_f1s14_l
L_f1s14_x:
 s_waitcnt vmcnt(0)
 s_branch L_f1r14
L_f1s15:
 s_mov_b32 s91, 65536
L_f1s15_l:
 s_sleep 2
 buffer_load_dword v24, v9, s[8:11], s46 offen sc1
 s_sub_u32 s91, s91, 1
 s_cbranch_scc1 L_f1s15_x
 s_waitcnt vmcnt(0)
 v_cmp_eq_u32 vcc, 0, v24
 s_nop 0
 s_cbranch_vccnz L_f1s15_l
L_f1s15_x:
 s_waitcnt vmcnt(0)
 s_branch L_f1r15
.p2align 6
L_loop_top:
M v[64:67], a[64:67], a[0:3], v[32:35]
 s_add_u32 m0, s28, 65536
 ds_read_b128 a[96:99], v2 offset:40960
M v[64:67], a[68:71], a[4:7], v[64:67]
 ds_read_b128 a[100:103], v2 offset:41984
M v[64:67], a[72:75], a[8:11], v[64:67]
 buffer_load_dword a240, v0, s[60:63], 0 offen offset:0
M v[64:67], a[76:79], a[12:15], v[64:67]
 ds_read_b128 a[104:107], v2 offset:43008
M v[64:67], a[80:83], a[16:19], v[64:67]
 ds_read_b128 a[108:111], v2 offset:44032
M v[64:67], a[84:87], a[20:23], v[64:67]
 buffer_load_dwordx4 v3, s[8:11], s24 offen offset:0 sc1 lds
M v[64:67], a[88:91], a[24:27], v[64:67]
 ds_read_b128 a[112:115], v2 offset:45056
M v[64:67], a[92:95], a[28:31], v[64:67]
 ds_read_b128 a[116:119], v2 offset:46080
M v[68:71], a[92:95], a[60:63], v[36:39]
 buffer_load_dwordx4 v3, s[8:11], s24 offen offset:1024 sc1 lds
M v[68:71], a[88:91], a[56:59], v[68:71]
 ds_read_b128 a[120:123], v2 offset:47104
M v[68:71], a[84:87], a[52:55], v[68:71]
 ds_read_b128 a[124:127], v2 offset:48128
M v[68:71], a[80:83], a[48:51], v[68:71]
 v_exp_f32 v18, v112
M v[68:71], a[76:79], a[44:47], v[68:71]
 buffer_load_dwordx4 v3, s[8:11], s24 offen offset:2048 sc1 lds
M v[68:71], a[72:75], a[40:43], v[68:71]
 v_exp_f32 v19, v113
M v[68:71], a[68:71], a[36:39], v[68:71]
 v_exp_f32 v20, v114
M v[68:71], a[64:67], a[32:35], v[68:71]
 s_waitcnt lgkmcnt(0)
 v_exp_f32 v21, v115
M v[76:79], a[96:99], a[32:35], v[36:39]
 ds_read_b128 a[64:67], v2 offset:49152
 v_add_f32 v28, v18, v28
M v[76:79], a[100:103], a[36:39], v[76:79]
 ds_read_b128 a[68:71], v2 offset:50176
 v_cvt_pk_bf16_f32 v56, v18, v19
M v[76:79], a[104:107], a[40:43], v[76:79]
 buffer_load_dwordx4 v3, s[8:11], s24 offen offset:3072 sc1 lds
M v[76:79], a[108:111], a[44:47], v[76:79]
 ds_read_b128 a[72:75], v2 offset:51200
 v_add_f32 v28, v19, v28
M v[76:79], a[112:115], a[48:51], v[76:79]
 ds_read_b128 a[76:79], v2 offset:52224
 v_add_f32 v28, v20, v28
M v[76:79], a[116:119], a[52:55], v[76:79]
 v_exp_f32 v22, v120
M v[76:79], a[120:123], a[56:59], v[76:79]
 s_add_u32 m0, s28, 69632
 ds_read_b128 a[80:83], v2 offset:53248
 v_cvt_pk_bf16_f32 v57, v20, v21
M v[76:79], a[124:127], a[60:63], v[76:79]
 ds_read_b128 a[84:87], v2 offset:54272
 v_add_f32 v28, v21, v28
M v[72:75], a[124:127], a[28:31], v[32:35]
 buffer_load_dwordx4 v4, s[8:11], s24 offen offset:0 sc1 lds
M v[72:75], a[120:123], a[24:27], v[72:75]
 ds_read_b128 a[88:91], v2 offset:55296
M v[72:75], a[116:119], a[20:23], v[72:75]
 ds_read_b128 a[92:95], v2 offset:56320
M v[72:75], a[112:115], a[16:19], v[72:75]
 v_exp_f32 v23, v121
M v[72:75], a[108:111], a[12:15], v[72:75]
 buffer_load_dwordx4 v4, s[8:11], s24 offen offset:1024 sc1 lds
M v[72:75], a[104:107], a[8:11], v[72:75]
 v_exp_f32 v24, v122
M v[72:75], a[100:103], a[4:7], v[72:75]
 v_exp_f32 v25, v123
M v[72:75], a[96:99], a[0:3], v[72:75]
 s_waitcnt lgkmcnt(0)
 v_exp_f32 v18, v116
M v[80:83], a[64:67], a[0:3], v[32:35]
 ds_read_b128 a[96:99], v2 offset:57344
 v_add_f32 v28, v22, v28
M v[80:83], a[68:71], a[4:7], v[80:83]
 ds_read_b128 a[100:103], v2 offset:58368
 v_cvt_pk_bf16_f32 v58, v22, v23
M v[80:83], a[72:75], a[8:11], v[80:83]
 buffer_load_dwordx4 v4, s[8:11], s24 offen offset:2048 sc1 lds
M v[80:83], a[76:79], a[12:15], v[80:83]
 ds_read_b128 a[104:107], v2 offset:59392
 v_add_f32 v28, v23, v28
M v[80:83], a[80:83], a[16:19], v[80:83]
 ds_read_b128 a[108:111], v2 offset:60416
 v_add_f32 v28, v24, v28
M v[80:83], a[84:87], a[20:23], v[80:83]
 v_exp_f32 v19, v117
M v[80:83], a[88:91], a[24:27], v[80:83]
 ds_read_b128 a[112:115], v2 offset:61440
 v_cvt_pk_bf16_f32 v59, v24, v25
M v[80:83], a[92:95], a[28:31], v[80:83]
 ds_read_b128 a[116:119], v2 offset:62464
 v_add_f32 v28, v25, v28
M v[84:87], a[92:95], a[60:63], v[36:39]
 buffer_load_dwordx4 v4, s[8:11], s24 offen offset:3072 sc1 lds
M v[84:87], a[88:91], a[56:59], v[84:87]
 ds_read_b128 a[120:123], v2 offset:63488
 v_add_f32 v29, v18, v29
M v[84:87], a[84:87], a[52:55], v[84:87]
 ds_read_b128 a[124:127], v2 offset:64512
 v_cvt_pk_bf16_f32 v60, v18, v19
M v[84:87], a[80:83], a[48:51], v[84:87]
 v_exp_f32 v20, v118
M v[84:87], a[76:79], a[44:47], v[84:87]
 v_exp_f32 v21, v119
M v[84:87], a[72:75], a[40:43], v[84:87]
 v_exp_f32 v22, v124
M v[84:87], a[68:71], a[36:39], v[84:87]
 s_waitcnt vmcnt(17) lgkmcnt(0)
 v_exp_f32 v23, v125
M v[84:87], a[64:67], a[32:35], v[84:87]
 s_barrier
M v[92:95], a[96:99], a[32:35], v[36:39]
 ds_read_b128 a[64:67], v7 offset:0
 v_add_f32 v29, v19, v29
M v[92:95], a[100:103], a[36:39], v[92:95]
 ds_read_b128 a[68:71], v7 offset:1024
 v_add_f32 v29, v20, v29
M v[92:95], a[104:107], a[40:43], v[92:95]
 v_exp_f32 v24, v126
M v[92:95], a[108:111], a[44:47], v[92:95]
 ds_read_b128 a[72:75], v7 offset:2048
 v_cvt_pk_bf16_f32 v61, v20, v21
M v[92:95], a[112:115], a[48:51], v[92:95]
 ds_read_b128 a[76:79], v7 offset:3072
 v_add_f32 v29, v21, v29
M v[92:95], a[116:119], a[52:55], v[92:95]
 v_exp_f32 v25, v127
M v[92:95], a[120:123], a[56:59], v[92:95]
 ds_read_b128 a[80:83], v7 offset:4096
 v_add_f32 v29, v22, v29
M v[92:95], a[124:127], a[60:63], v[92:95]
 ds_read_b128 a[84:87], v7 offset:5120
 v_cvt_pk_bf16_f32 v62, v22, v23
M v[88:91], a[124:127], a[28:31], v[32:35]
 v_add_f32 v29, v23, v29
 v_add_f32 v29, v24, v29
M v[88:91], a[120:123], a[24:27], v[88:91]
 ds_read_b128 a[88:91], v7 offset:6144
 v_cvt_pk_bf16_f32 v63, v24, v25
M v[88:91], a[116:119], a[20:23], v[88:91]
 ds_read_b128 a[92:95], v7 offset:7168
 v_add_f32 v29, v25, v29
M v[88:91], a[112:115], a[16:19], v[88:91]
 v_max_f32 v10, v28, v29
M v[88:91], a[108:111], a[12:15], v[88:91]
 v_cmp_lt_f32 vcc, s31, v10
M v[88:91], a[104:107], a[8:11], v[88:91]
M v[88:91], a[100:103], a[4:7], v[88:91]
 s_waitcnt lgkmcnt(0)
M v[88:91], a[96:99], a[0:3], v[88:91]
 s_cbranch_vccnz L_st1
L_rt1:
M v[128:131], a[64:67], v[48:51], v[128:131]
 s_add_u32 m0, s28, 98304
 ds_read_b128 a[96:99], v7 offset:8192
 v_add_f32 v30, v28, v30
M v[128:131], a[68:71], v[56:59], v[128:131]
 ds_read_b128 a[100:103], v7 offset:9216
 v_add_f32 v31, v29, v31
M v[132:135], a[68:71], v[60:63], v[132:135]
 buffer_load_dwordx4 v3, s[8:11], s21 offen offset:0 sc1 lds
M v[132:135], a[64:67], v[52:55], v[132:135]
 ds_read_b128 a[104:107], v7 offset:10240
M v[140:143], a[72:75], v[52:55], v[140:143]
 ds_read_b128 a[108:111], v7 offset:11264
M v[140:143], a[76:79], v[60:63], v[140:143]
 buffer_load_dwordx4 v3, s[8:11], s21 offen offset:1024 sc1 lds
M v[136:139], a[76:79], v[56:59], v[136:139]
 ds_read_b128 a[112:115], v7 offset:12288
M v[136:139], a[72:75], v[48:51], v[136:139]
 ds_read_b128 a[116:119], v7 offset:13312
M v[144:147], a[80:83], v[48:51], v[144:147]
 v_exp_f32 v18, v64
M v[144:147], a[84:87], v[56:59], v[144:147]
 ds_read_b128 a[120:123], v7 offset:14336
M v[148:151], a[84:87], v[60:63], v[148:151]
 ds_read_b128 a[124:127], v7 offset:15360
M v[148:151], a[80:83], v[52:55], v[148:151]
 buffer_load_dwordx4 v3, s[8:11], s21 offen offset:2048 sc1 lds
M v[156:159], a[88:91], v[52:55], v[156:159]
 v_exp_f32 v19, v65
M v[156:159], a[92:95], v[60:63], v[156:159]
 v_exp_f32 v20, v66
M v[152:155], a[92:95], v[56:59], v[152:155]
 buffer_load_dwordx4 v3, s[8:11], s21 offen offset:3072 sc1 lds
M v[152:155], a[88:91], v[48:51], v[152:155]
 s_waitcnt lgkmcnt(0)
 v_exp_f32 v21, v67
M v[160:163], a[96:99], v[48:51], v[160:163]
 ds_read_b128 a[64:67], v7 offset:16384
 v_add_f32 v26, v18, v19
M v[160:163], a[100:103], v[56:59], v[160:163]
 s_add_u32 m0, s28, 102400
 ds_read_b128 a[68:71], v7 offset:17408
 v_cvt_pk_bf16_f32 v40, v18, v19
M v[164:167], a[100:103], v[60:63], v[164:167]
 buffer_load_dwordx4 v4, s[8:11], s21 offen offset:0 sc1 lds
M v[164:167], a[96:99], v[52:55], v[164:167]
 ds_read_b128 a[72:75], v7 offset:18432
 v_add_f32 v26, v20, v26
M v[172:175], a[104:107], v[52:55], v[172:175]
 ds_read_b128 a[76:79], v7 offset:19456
 v_cvt_pk_bf16_f32 v41, v20, v21
M v[172:175], a[108:111], v[60:63], v[172:175]
 v_exp_f32 v22, v72
M v[168:171], a[108:111], v[56:59], v[168:171]
 ds_read_b128 a[80:83], v7 offset:20480
 v_add_f32 v26, v21, v26
M v[168:171], a[104:107], v[48:51], v[168:171]
 ds_read_b128 a[84:87], v7 offset:21504
M v[176:179], a[112:115], v[48:51], v[176:179]
 buffer_load_dwordx4 v4, s[8:11], s21 offen offset:1024 sc1 lds
M v[176:179], a[116:119], v[56:59], v[176:179]
 ds_read_b128 a[88:91], v7 offset:22528
M v[180:183], a[116:119], v[60:63], v[180:183]
 ds_read_b128 a[92:95], v7 offset:23552
M v[180:183], a[112:115], v[52:55], v[180:183]
 buffer_load_dwordx4 v4, s[8:11], s21 offen offset:2048 sc1 lds
M v[188:191], a[120:123], v[52:55], v[188:191]
 v_exp_f32 v23, v73
M v[188:191], a[124:127], v[60:63], v[188:191]
 v_exp_f32 v24, v74
M v[184:187], a[124:127], v[56:59], v[184:187]
 v_exp_f32 v25, v75
M v[184:187], a[120:123], v[48:51], v[184:187]
 s_waitcnt lgkmcnt(0)
 v_exp_f32 v18, v68
M v[192:195], a[64:67], v[48:51], v[192:195]
 ds_read_b128 a[96:99], v7 offset:24576
 v_add_f32 v26, v22, v26
M v[192:195], a[68:71], v[56:59], v[192:195]
 ds_read_b128 a[100:103], v7 offset:25600
 v_cvt_pk_bf16_f32 v42, v22, v23
M v[196:199], a[68:71], v[60:63], v[196:199]
 buffer_load_dwordx4 v4, s[8:11], s21 offen offset:3072 sc1 lds
M v[196:199], a[64:67], v[52:55], v[196:199]
 s_add_u32 s24, s23, 33554432
 ds_read_b128 a[104:107], v7 offset:26624
 v_add_f32 v26, v23, v26
M v[204:207], a[72:75], v[52:55], v[204:207]
 s_mov_b32 s23, s21
 ds_read_b128 a[108:111], v7 offset:27648
 v_add_f32 v26, v24, v26
M v[204:207], a[76:79], v[60:63], v[204:207]
 s_add_u32 s21, s21, 65536
 v_exp_f32 v19, v69
M v[200:203], a[76:79], v[56:59], v[200:203]
 s_add_u32 s22, s22, 1
 ds_read_b128 a[112:115], v7 offset:28672
 v_cvt_pk_bf16_f32 v43, v24, v25
M v[200:203], a[72:75], v[48:51], v[200:203]
 s_cmp_eq_u32 s22, s25
 ds_read_b128 a[116:119], v7 offset:29696
 v_add_f32 v26, v25, v26
M v[208:211], a[80:83], v[48:51], v[208:211]
 s_cselect_b32 s21, s26, s21
 v_exp_f32 v20, v70
M v[208:211], a[84:87], v[56:59], v[208:211]
 s_cmp_eq_u32 s22, s43
 ds_read_b128 a[120:123], v7 offset:30720
 v_add_f32 v27, v18, v19
M v[212:215], a[84:87], v[60:63], v[212:215]
 s_cselect_b32 s21, s4, s21
 ds_read_b128 a[124:127], v7 offset:31744
 v_cvt_pk_bf16_f32 v44, v18, v19
M v[212:215], a[80:83], v[52:55], v[212:215]
 s_cmp_eq_u32 s22, s6
 v_exp_f32 v21, v71
M v[220:223], a[88:91], v[52:55], v[220:223]
 s_cselect_b32 s21, s7, s21
 v_exp_f32 v22, v76
M v[220:223], a[92:95], v[60:63], v[220:223]
 v_add_f32 v27, v20, v27
 v_cvt_pk_bf16_f32 v45, v20, v21
M v[216:219], a[92:95], v[56:59], v[216:219]
 s_waitcnt vmcnt(17) lgkmcnt(0)
 v_add_f32 v27, v21, v27
M v[216:219], a[88:91], v[48:51], v[216:219]
 s_barrier
M v[224:227], a[96:99], v[48:51], v[224:227]
 ds_read_b128 a[64:67], v7 offset:32768
M v[224:227], a[100:103], v[56:59], v[224:227]
 ds_read_b128 a[68:71], v7 offset:33792
M v[228:231], a[100:103], v[60:63], v[228:231]
 v_exp_f32 v23, v77
M v[228:231], a[96:99], v[52:55], v[228:231]
 ds_read_b128 a[72:75], v7 offset:34816
 v_add_f32 v27, v22, v27
M v[236:239], a[104:107], v[52:55], v[236:239]
 ds_read_b128 a[76:79], v7 offset:35840
 v_cvt_pk_bf16_f32 v46, v22, v23
M v[236:239], a[108:111], v[60:63], v[236:239]
 v_exp_f32 v24, v78
M v[232:235], a[108:111], v[56:59], v[232:235]
 ds_read_b128 a[80:83], v7 offset:36864
 v_add_f32 v27, v23, v27
M v[232:235], a[104:107], v[48:51], v[232:235]
 ds_read_b128 a[84:87], v7 offset:37888
M v[240:243], a[112:115], v[48:51], v[240:243]
 v_exp_f32 v25, v79
M v[240:243], a[116:119], v[56:59], v[240:243]
 ds_read_b128 a[88:91], v7 offset:38912
 v_add_f32 v27, v24, v27
M v[244:247], a[116:119], v[60:63], v[244:247]
 ds_read_b128 a[92:95], v7 offset:39936
 v_cvt_pk_bf16_f32 v47, v24, v25
M v[244:247], a[112:115], v[52:55], v[244:247]
 v_add_f32 v27, v25, v27
M v[252:255], a[120:123], v[52:55], v[252:255]
M v[252:255], a[124:127], v[60:63], v[252:255]
M v[248:251], a[124:127], v[56:59], v[248:251]
 s_waitcnt lgkmcnt(0)
M v[248:251], a[120:123], v[48:51], v[248:251]
L_loop_mid:
M v[96:99], a[64:67], a[0:3], v[32:35]
 s_and_b32 s39, s54, 15
 ds_read_b128 a[96:99], v7 offset:40960
M v[96:99], a[68:71], a[4:7], v[96:99]
 s_cbranch_scc1 L_fll
L_fllr:
 ds_read_b128 a[100:103], v7 offset:41984
M v[96:99], a[72:75], a[8:11], v[96:99]
 s_lshr_b32 s54, s54, 4
 v_exp_f32 v18, v80
M v[96:99], a[76:79], a[12:15], v[96:99]
 s_add_u32 m0, s28, 0
 ds_read_b128 a[104:107], v7 offset:43008
M v[96:99], a[80:83], a[16:19], v[96:99]
 ds_read_b128 a[108:111], v7 offset:44032
M v[96:99], a[84:87], a[20:23], v[96:99]
 buffer_load_dwordx4 v3, s[8:11], s24 offen offset:0 sc1 lds
M v[96:99], a[88:91], a[24:27], v[96:99]
 ds_read_b128 a[112:115], v7 offset:45056
M v[96:99], a[92:95], a[28:31], v[96:99]
 ds_read_b128 a[116:119], v7 offset:46080
M v[100:103], a[92:95], a[60:63], v[36:39]
 v_exp_f32 v19, v81
M v[100:103], a[88:91], a[56:59], v[100:103]
 ds_read_b128 a[120:123], v7 offset:47104
 v_add_f32 v26, v18, v26
M v[100:103], a[84:87], a[52:55], v[100:103]
 ds_read_b128 a[124:127], v7 offset:48128
 v_cvt_pk_bf16_f32 v56, v18, v19
M v[100:103], a[80:83], a[48:51], v[100:103]
 buffer_load_dwordx4 v3, s[8:11], s24 offen offset:1024 sc1 lds
M v[100:103], a[76:79], a[44:47], v[100:103]
 v_exp_f32 v20, v82
M v[100:103], a[72:75], a[40:43], v[100:103]
 v_exp_f32 v21, v83
M v[100:103], a[68:71], a[36:39], v[100:103]
 buffer_load_dwordx4 v3, s[8:11], s24 offen offset:2048 sc1 lds
M v[100:103], a[64:67], a[32:35], v[100:103]
 s_waitcnt lgkmcnt(0)
 v_exp_f32 v22, v88
M v[108:111], a[96:99], a[32:35], v[36:39]
 ds_read_b128 a[64:67], v7 offset:49152
 v_add_f32 v26, v19, v26
M v[108:111], a[100:103], a[36:39], v[108:111]
 ds_read_b128 a[68:71], v7 offset:50176
 v_add_f32 v26, v20, v26
M v[108:111], a[104:107], a[40:43], v[108:111]
 v_exp_f32 v23, v89
M v[108:111], a[108:111], a[44:47], v[108:111]
 ds_read_b128 a[72:75], v7 offset:51200
 v_cvt_pk_bf16_f32 v57, v20, v21
M v[108:111], a[112:115], a[48:51], v[108:111]
 ds_read_b128 a[76:79], v7 offset:52224
 v_add_f32 v26, v21, v26
M v[108:111], a[116:119], a[52:55], v[108:111]
 buffer_load_dwordx4 v3, s[8:11], s24 offen offset:3072 sc1 lds
M v[108:111], a[120:123], a[56:59], v[108:111]
 ds_read_b128 a[80:83], v7 offset:53248
 v_add_f32 v26, v22, v26
M v[108:111], a[124:127], a[60:63], v[108:111]
 s_add_u32 m0, s28, 4096
 ds_read_b128 a[84:87], v7 offset:54272
 v_cvt_pk_bf16_f32 v58, v22, v23
M v[104:107], a[124:127], a[28:31], v[32:35]
 buffer_load_dwordx4 v4, s[8:11], s24 offen offset:0 sc1 lds
M v[104:107], a[120:123], a[24:27], v[104:107]
 ds_read_b128 a[88:91], v7 offset:55296
 v_add_f32 v26, v23, v26
M v[104:107], a[116:119], a[20:23], v[104:107]
 ds_read_b128 a[92:95], v7 offset:56320
M v[104:107], a[112:115], a[16:19], v[104:107]
 v_exp_f32 v24, v90
M v[104:107], a[108:111], a[12:15], v[104:107]
 v_exp_f32 v25, v91
M v[104:107], a[104:107], a[8:11], v[104:107]
 buffer_load_dwordx4 v4, s[8:11], s24 offen offset:1024 sc1 lds
M v[104:107], a[100:103], a[4:7], v[104:107]
 v_exp_f32 v18, v84
M v[104:107], a[96:99], a[0:3], v[104:107]
 s_waitcnt lgkmcnt(0)
 v_exp_f32 v19, v85
M v[112:115], a[64:67], a[0:3], v[32:35]
 ds_read_b128 a[96:99], v7 offset:57344
 v_add_f32 v26, v24, v26
M v[112:115], a[68:71], a[4:7], v[112:115]
 ds_read_b128 a[100:103], v7 offset:58368
 v_cvt_pk_bf16_f32 v59, v24, v25
M v[112:115], a[72:75], a[8:11], v[112:115]
 buffer_load_dwordx4 v4, s[8:11], s24 offen offset:2048 sc1 lds
M v[112:115], a[76:79], a[12:15], v[112:115]
 ds_read_b128 a[104:107], v7 offset:59392
 v_add_f32 v26, v25, v26
M v[112:115], a[80:83], a[16:19], v[112:115]
 ds_read_b128 a[108:111], v7 offset:60416
 v_add_f32 v27, v18, v27
M v[112:115], a[84:87], a[20:23], v[112:115]
 v_exp_f32 v20, v86
M v[112:115], a[88:91], a[24:27], v[112:115]
 ds_read_b128 a[112:115], v7 offset:61440
 v_cvt_pk_bf16_f32 v60, v18, v19
M v[112:115], a[92:95], a[28:31], v[112:115]
 ds_read_b128 a[116:119], v7 offset:62464
 v_add_f32 v27, v19, v27
M v[116:119], a[92:95], a[60:63], v[36:39]
 buffer_load_dwordx4 v4, s[8:11], s24 offen offset:3072 sc1 lds
M v[116:119], a[88:91], a[56:59], v[116:119]
 ds_read_b128 a[120:123], v7 offset:63488
M v[116:119], a[84:87], a[52:55], v[116:119]
 ds_read_b128 a[124:127], v7 offset:64512
M v[116:119], a[80:83], a[48:51], v[116:119]
 v_exp_f32 v21, v87
M v[116:119], a[76:79], a[44:47], v[116:119]
 v_exp_f32 v22, v92
M v[116:119], a[72:75], a[40:43], v[116:119]
 v_exp_f32 v23, v93
M v[116:119], a[68:71], a[36:39], v[116:119]
 s_waitcnt vmcnt(16) lgkmcnt(0)
 v_add_f32 v27, v20, v27
 v_cvt_pk_bf16_f32 v61, v20, v21
M v[116:119], a[64:67], a[32:35], v[116:119]
 s_barrier
M v[124:127], a[96:99], a[32:35], v[36:39]
 ds_read_b128 a[64:67], v2 offset:0
 v_add_f32 v27, v21, v27
M v[124:127], a[100:103], a[36:39], v[124:127]
 ds_read_b128 a[68:71], v2 offset:1024
 v_add_f32 v27, v22, v27
M v[124:127], a[104:107], a[40:43], v[124:127]
 v_exp_f32 v24, v94
M v[124:127], a[108:111], a[44:47], v[124:127]
 ds_read_b128 a[72:75], v2 offset:2048
 v_cvt_pk_bf16_f32 v62, v22, v23
M v[124:127], a[112:115], a[48:51], v[124:127]
 ds_read_b128 a[76:79], v2 offset:3072
 v_add_f32 v27, v23, v27
M v[124:127], a[116:119], a[52:55], v[124:127]
 v_exp_f32 v25, v95
M v[124:127], a[120:123], a[56:59], v[124:127]
 ds_read_b128 a[80:83], v2 offset:4096
 v_add_f32 v27, v24, v27
M v[124:127], a[124:127], a[60:63], v[124:127]
 ds_read_b128 a[84:87], v2 offset:5120
 v_cvt_pk_bf16_f32 v63, v24, v25
M v[120:123], a[124:127], a[28:31], v[32:35]
 v_add_f32 v27, v25, v27
M v[120:123], a[120:123], a[24:27], v[120:123]
 ds_read_b128 a[88:91], v2 offset:6144
M v[120:123], a[116:119], a[20:23], v[120:123]
 ds_read_b128 a[92:95], v2 offset:7168
 v_max_f32 v10, v26, v27
M v[120:123], a[112:115], a[16:19], v[120:123]
 v_cmp_lt_f32 vcc, s31, v10
M v[120:123], a[108:111], a[12:15], v[120:123]
M v[120:123], a[104:107], a[8:11], v[120:123]
M v[120:123], a[100:103], a[4:7], v[120:123]
 s_waitcnt lgkmcnt(0)
M v[120:123], a[96:99], a[0:3], v[120:123]
 s_cbranch_vccnz L_st0
L_rt0:
M v[128:131], a[64:67], v[40:43], v[128:131]
 s_add_u32 m0, s28, 32768
 ds_read_b128 a[96:99], v2 offset:8192
 v_add_f32 v30, v26, v30
M v[128:131], a[68:71], v[56:59], v[128:131]
 ds_read_b128 a[100:103], v2 offset:9216
 v_add_f32 v31, v27, v31
M v[132:135], a[68:71], v[60:63], v[132:135]
 buffer_load_dwordx4 v3, s[8:11], s21 offen offset:0 sc1 lds
M v[132:135], a[64:67], v[44:47], v[132:135]
 ds_read_b128 a[104:107], v2 offset:10240
M v[140:143], a[72:75], v[44:47], v[140:143]
 ds_read_b128 a[108:111], v2 offset:11264
M v[140:143], a[76:79], v[60:63], v[140:143]
 buffer_load_dwordx4 v3, s[8:11], s21 offen offset:1024 sc1 lds
M v[136:139], a[76:79], v[56:59], v[136:139]
 ds_read_b128 a[112:115], v2 offset:12288
M v[136:139], a[72:75], v[40:43], v[136:139]
 ds_read_b128 a[116:119], v2 offset:13312
M v[144:147], a[80:83], v[40:43], v[144:147]
 v_exp_f32 v18, v96
M v[144:147], a[84:87], v[56:59], v[144:147]
 ds_read_b128 a[120:123], v2 offset:14336
M v[148:151], a[84:87], v[60:63], v[148:151]
 ds_read_b128 a[124:127], v2 offset:15360
M v[148:151], a[80:83], v[44:47], v[148:151]
 buffer_load_dwordx4 v3, s[8:11], s21 offen offset:2048 sc1 lds
M v[156:159], a[88:91], v[44:47], v[156:159]
 v_exp_f32 v19, v97
M v[156:159], a[92:95], v[60:63], v[156:159]
 v_exp_f32 v20, v98
M v[152:155], a[92:95], v[56:59], v[152:155]
 buffer_load_dwordx4 v3, s[8:11], s21 offen offset:3072 sc1 lds
M v[152:155], a[88:91], v[40:43], v[152:155]
 s_waitcnt lgkmcnt(0)
 v_exp_f32 v21, v99
M v[160:163], a[96:99], v[40:43], v[160:163]
 ds_read_b128 a[64:67], v2 offset:16384
 v_add_f32 v28, v18, v19
M v[160:163], a[100:103], v[56:59], v[160:163]
 s_add_u32 m0, s28, 36864
 ds_read_b128 a[68:71], v2 offset:17408
 v_cvt_pk_bf16_f32 v48, v18, v19
M v[164:167], a[100:103], v[60:63], v[164:167]
 buffer_load_dwordx4 v4, s[8:11], s21 offen offset:0 sc1 lds
M v[164:167], a[96:99], v[44:47], v[164:167]
 ds_read_b128 a[72:75], v2 offset:18432
 v_add_f32 v28, v20, v28
M v[172:175], a[104:107], v[44:47], v[172:175]
 ds_read_b128 a[76:79], v2 offset:19456
 v_cvt_pk_bf16_f32 v49, v20, v21
M v[172:175], a[108:111], v[60:63], v[172:175]
 v_exp_f32 v22, v104
M v[168:171], a[108:111], v[56:59], v[168:171]
 ds_read_b128 a[80:83], v2 offset:20480
 v_add_f32 v28, v21, v28
M v[168:171], a[104:107], v[40:43], v[168:171]
 ds_read_b128 a[84:87], v2 offset:21504
M v[176:179], a[112:115], v[40:43], v[176:179]
 buffer_load_dwordx4 v4, s[8:11], s21 offen offset:1024 sc1 lds
M v[176:179], a[116:119], v[56:59], v[176:179]
 ds_read_b128 a[88:91], v2 offset:22528
M v[180:183], a[116:119], v[60:63], v[180:183]
 ds_read_b128 a[92:95], v2 offset:23552
M v[180:183], a[112:115], v[44:47], v[180:183]
 buffer_load_dwordx4 v4, s[8:11], s21 offen offset:2048 sc1 lds
M v[188:191], a[120:123], v[44:47], v[188:191]
 v_exp_f32 v23, v105
M v[188:191], a[124:127], v[60:63], v[188:191]
 v_exp_f32 v24, v106
M v[184:187], a[124:127], v[56:59], v[184:187]
 v_exp_f32 v25, v107
M v[184:187], a[120:123], v[40:43], v[184:187]
 s_waitcnt lgkmcnt(0)
 v_exp_f32 v18, v100
M v[192:195], a[64:67], v[40:43], v[192:195]
 ds_read_b128 a[96:99], v2 offset:24576
 v_add_f32 v28, v22, v28
M v[192:195], a[68:71], v[56:59], v[192:195]
 ds_read_b128 a[100:103], v2 offset:25600
 v_cvt_pk_bf16_f32 v50, v22, v23
M v[196:199], a[68:71], v[60:63], v[196:199]
 buffer_load_dwordx4 v4, s[8:11], s21 offen offset:3072 sc1 lds
M v[196:199], a[64:67], v[44:47], v[196:199]
 s_add_u32 s24, s23, 33554432
 ds_read_b128 a[104:107], v2 offset:26624
 v_add_f32 v28, v23, v28
M v[204:207], a[72:75], v[44:47], v[204:207]
 s_mov_b32 s23, s21
 ds_read_b128 a[108:111], v2 offset:27648
 v_add_f32 v28, v24, v28
M v[204:207], a[76:79], v[60:63], v[204:207]
 s_add_u32 s21, s21, 65536
 v_exp_f32 v19, v101
M v[200:203], a[76:79], v[56:59], v[200:203]
 s_add_u32 s22, s22, 1
 ds_read_b128 a[112:115], v2 offset:28672
 v_cvt_pk_bf16_f32 v51, v24, v25
M v[200:203], a[72:75], v[40:43], v[200:203]
 s_cmp_eq_u32 s22, s25
 ds_read_b128 a[116:119], v2 offset:29696
 v_add_f32 v28, v25, v28
M v[208:211], a[80:83], v[40:43], v[208:211]
 s_cselect_b32 s21, s26, s21
 v_exp_f32 v20, v102
M v[208:211], a[84:87], v[56:59], v[208:211]
 s_cmp_eq_u32 s22, s43
 ds_read_b128 a[120:123], v2 offset:30720
 v_add_f32 v29, v18, v19
M v[212:215], a[84:87], v[60:63], v[212:215]
 s_cselect_b32 s21, s4, s21
 ds_read_b128 a[124:127], v2 offset:31744
 v_cvt_pk_bf16_f32 v52, v18, v19
M v[212:215], a[80:83], v[44:47], v[212:215]
 s_cmp_eq_u32 s22, s6
 v_exp_f32 v21, v103
M v[220:223], a[88:91], v[44:47], v[220:223]
 s_cselect_b32 s21, s7, s21
 v_exp_f32 v22, v108
M v[220:223], a[92:95], v[60:63], v[220:223]
 v_add_f32 v29, v20, v29
 v_cvt_pk_bf16_f32 v53, v20, v21
M v[216:219], a[92:95], v[56:59], v[216:219]
 s_waitcnt vmcnt(16) lgkmcnt(0)
 v_exp_f32 v23, v109
M v[216:219], a[88:91], v[40:43], v[216:219]
 s_barrier
M v[224:227], a[96:99], v[40:43], v[224:227]
 ds_read_b128 a[64:67], v2 offset:32768
 v_add_f32 v29, v21, v29
M v[224:227], a[100:103], v[56:59], v[224:227]
 ds_read_b128 a[68:71], v2 offset:33792
 v_add_f32 v29, v22, v29
M v[228:231], a[100:103], v[60:63], v[228:231]
 v_cmp_gt_u32 vcc, s39, v6
 v_cvt_pk_bf16_f32 v54, v22, v23
M v[228:231], a[96:99], v[44:47], v[228:231]
 ds_read_b128 a[72:75], v2 offset:34816
 v_add_f32 v29, v23, v29
M v[236:239], a[104:107], v[44:47], v[236:239]
 ds_read_b128 a[76:79], v2 offset:35840
M v[236:239], a[108:111], v[60:63], v[236:239]
 s_cbranch_vccnz L_fls0
L_flr0:
 v_exp_f32 v24, v110
M v[232:235], a[108:111], v[56:59], v[232:235]
 s_and_b32 s3, s5, 15
 ds_read_b128 a[80:83], v2 offset:36864
M v[232:235], a[104:107], v[40:43], v[232:235]
 s_cbranch_scc1 L_pub3
L_pub3r:
 ds_read_b128 a[84:87], v2 offset:37888
M v[240:243], a[112:115], v[40:43], v[240:243]
 s_lshr_b32 s5, s5, 4
 v_exp_f32 v25, v111
M v[240:243], a[116:119], v[56:59], v[240:243]
 ds_read_b128 a[88:91], v2 offset:38912
 v_add_f32 v29, v24, v29
M v[244:247], a[116:119], v[60:63], v[244:247]
 ds_read_b128 a[92:95], v2 offset:39936
 v_cvt_pk_bf16_f32 v55, v24, v25
M v[244:247], a[112:115], v[44:47], v[244:247]
 v_add_f32 v29, v25, v29
M v[252:255], a[120:123], v[44:47], v[252:255]
 s_sub_u32 s27, s27, 1
M v[252:255], a[124:127], v[60:63], v[252:255]
 s_cmp_lg_u32 s27, 0
M v[248:251], a[124:127], v[56:59], v[248:251]
 s_waitcnt lgkmcnt(0)
M v[248:251], a[120:123], v[40:43], v[248:251]
 s_cbranch_scc1 L_loop_top
L_p1:
 s_cmp_eq_u32 s40, 0
 s_cbranch_scc1 L_final_h
 s_cmp_lt_u32 s42, 10
 s_cbranch_scc1 L_p1n
L_p1c:
 v_cndmask_b32 v64, v32, v8, s[64:65]
 v_cndmask_b32 v65, v32, v8, s[66:67]
 v_cndmask_b32 v66, v32, v8, s[68:69]
 v_cndmask_b32 v67, v32, v8, s[70:71]
 s_nop 1
M v[64:67], a[64:67], a[0:3], v[64:67]
 s_add_u32 m0, s28, 65536
 ds_read_b128 a[96:99], v2 offset:40960
 ds_read_b128 a[100:103], v2 offset:41984
M v[64:67], a[68:71], a[4:7], v[64:67]
 buffer_load_dwordx4 v3, s[8:11], s24 offen offset:0 sc1 lds
M v[64:67], a[72:75], a[8:11], v[64:67]
 v_exp_f32 v18, v112
M v[64:67], a[76:79], a[12:15], v[64:67]
 ds_read_b128 a[104:107], v2 offset:43008
 ds_read_b128 a[108:111], v2 offset:44032
M v[64:67], a[80:83], a[16:19], v[64:67]
 buffer_load_dwordx4 v[14:17], v7, s[8:11], s52 offen sc1
M v[64:67], a[84:87], a[20:23], v[64:67]
 s_cmp_eq_u32 s20, 3
 v_exp_f32 v19, v113
M v[64:67], a[88:91], a[24:27], v[64:67]
 s_cselect_b64 s[64:65], s[16:17], 0
 ds_read_b128 a[112:115], v2 offset:45056
 ds_read_b128 a[116:119], v2 offset:46080
M v[64:67], a[92:95], a[28:31], v[64:67]
 s_cselect_b64 s[66:67], s[18:19], 0
 v_exp_f32 v20, v114
M v[68:71], a[92:95], a[60:63], v[36:39]
 s_cselect_b64 s[68:69], s[48:49], 0
 v_add_f32 v28, v18, v28
 v_cvt_pk_bf16_f32 v56, v18, v19
M v[68:71], a[88:91], a[56:59], v[68:71]
 s_cselect_b64 s[70:71], s[50:51], 0
 ds_read_b128 a[120:123], v2 offset:47104
 ds_read_b128 a[124:127], v2 offset:48128
M v[68:71], a[84:87], a[52:55], v[68:71]
 buffer_load_dwordx4 v3, s[8:11], s24 offen offset:1024 sc1 lds
M v[68:71], a[80:83], a[48:51], v[68:71]
 v_cndmask_b32 v72, v32, v8, s[72:73]
 v_cndmask_b32 v73, v32, v8, s[74:75]
M v[68:71], a[76:79], a[44:47], v[68:71]
 v_cndmask_b32 v74, v32, v8, s[76:77]
 v_cndmask_b32 v75, v32, v8, s[78:79]
M v[68:71], a[72:75], a[40:43], v[68:71]
 buffer_load_dwordx4 a[128:131], v7, s[8:11], s12 offen offset:0 sc1
M v[68:71], a[68:71], a[36:39], v[68:71]
 buffer_load_dwordx4 a[132:135], v7, s[8:11], s12 offen offset:1024 sc1
M v[68:71], a[64:67], a[32:35], v[68:71]
 s_waitcnt lgkmcnt(0)
 v_exp_f32 v21, v115
M v[72:75], a[96:99], a[0:3], v[72:75]
 ds_read_b128 a[64:67], v2 offset:49152
 ds_read_b128 a[68:71], v2 offset:50176
M v[72:75], a[100:103], a[4:7], v[72:75]
 buffer_load_dwordx4 v3, s[8:11], s24 offen offset:2048 sc1 lds
M v[72:75], a[104:107], a[8:11], v[72:75]
 v_exp_f32 v22, v120
M v[72:75], a[108:111], a[12:15], v[72:75]
 ds_read_b128 a[72:75], v2 offset:51200
 ds_read_b128 a[76:79], v2 offset:52224
M v[72:75], a[112:115], a[16:19], v[72:75]
 buffer_load_dwordx4 v3, s[8:11], s24 offen offset:3072 sc1 lds
M v[72:75], a[116:119], a[20:23], v[72:75]
 s_cmp_gt_u32 s20, 2
 v_exp_f32 v23, v121
M v[72:75], a[120:123], a[24:27], v[72:75]
 s_cselect_b64 s[78:79], -1, 0
 ds_read_b128 a[80:83], v2 offset:53248
 ds_read_b128 a[84:87], v2 offset:54272
M v[72:75], a[124:127], a[28:31], v[72:75]
 s_cmp_eq_u32 s20, 2
 v_exp_f32 v24, v122
M v[76:79], a[124:127], a[60:63], v[36:39]
 s_cselect_b64 s[72:73], s[16:17], s[78:79]
 v_exp_f32 v25, v123
M v[76:79], a[120:123], a[56:59], v[76:79]
 s_cselect_b64 s[74:75], s[18:19], s[78:79]
 ds_read_b128 a[88:91], v2 offset:55296
 ds_read_b128 a[92:95], v2 offset:56320
M v[76:79], a[116:119], a[52:55], v[76:79]
 s_cselect_b64 s[76:77], s[48:49], s[78:79]
 v_add_f32 v28, v19, v28
 v_add_f32 v28, v20, v28
M v[76:79], a[112:115], a[48:51], v[76:79]
 s_cselect_b64 s[78:79], s[50:51], s[78:79]
 v_cndmask_b32 v80, v32, v8, s[80:81]
 v_cndmask_b32 v81, v32, v8, s[82:83]
M v[76:79], a[108:111], a[44:47], v[76:79]
 s_add_u32 m0, s28, 69632
 v_cndmask_b32 v82, v32, v8, s[84:85]
 v_cndmask_b32 v83, v32, v8, s[86:87]
M v[76:79], a[104:107], a[40:43], v[76:79]
 buffer_load_dwordx4 a[136:139], v7, s[8:11], s12 offen offset:2048 sc1
M v[76:79], a[100:103], a[36:39], v[76:79]
 buffer_load_dwordx4 v4, s[8:11], s24 offen offset:0 sc1 lds
M v[76:79], a[96:99], a[32:35], v[76:79]
 s_waitcnt lgkmcnt(0)
 v_exp_f32 v18, v116
M v[80:83], a[64:67], a[0:3], v[80:83]
 ds_read_b128 a[96:99], v2 offset:57344
 ds_read_b128 a[100:103], v2 offset:58368
M v[80:83], a[68:71], a[4:7], v[80:83]
 buffer_load_dwordx4 a[140:143], v7, s[8:11], s12 offen offset:3072 sc1
M v[80:83], a[72:75], a[8:11], v[80:83]
 buffer_load_dwordx4 v4, s[8:11], s24 offen offset:1024 sc1 lds
M v[80:83], a[76:79], a[12:15], v[80:83]
 ds_read_b128 a[104:107], v2 offset:59392
 ds_read_b128 a[108:111], v2 offset:60416
M v[80:83], a[80:83], a[16:19], v[80:83]
 buffer_load_dwordx4 a[144:147], v7, s[8:11], s13 offen offset:0 sc1
M v[80:83], a[84:87], a[20:23], v[80:83]
 s_cmp_gt_u32 s20, 1
 v_exp_f32 v19, v117
M v[80:83], a[88:91], a[24:27], v[80:83]
 s_cselect_b64 s[86:87], -1, 0
 ds_read_b128 a[112:115], v2 offset:61440
 ds_read_b128 a[116:119], v2 offset:62464
M v[80:83], a[92:95], a[28:31], v[80:83]
 s_cmp_eq_u32 s20, 1
 v_cvt_pk_bf16_f32 v57, v20, v21
 v_add_f32 v28, v21, v28
M v[84:87], a[92:95], a[60:63], v[36:39]
 s_cselect_b64 s[80:81], s[16:17], s[86:87]
 v_exp_f32 v20, v118
M v[84:87], a[88:91], a[56:59], v[84:87]
 s_cselect_b64 s[82:83], s[18:19], s[86:87]
 ds_read_b128 a[120:123], v2 offset:63488
 ds_read_b128 a[124:127], v2 offset:64512
M v[84:87], a[84:87], a[52:55], v[84:87]
 s_cselect_b64 s[84:85], s[48:49], s[86:87]
 v_exp_f32 v21, v119
M v[84:87], a[80:83], a[48:51], v[84:87]
 s_cselect_b64 s[86:87], s[50:51], s[86:87]
 v_cndmask_b32 v88, v32, v8, s[88:89]
 v_cndmask_b32 v89, v32, v8, s[90:91]
M v[84:87], a[76:79], a[44:47], v[84:87]
 v_cndmask_b32 v90, v32, v8, s[92:93]
 v_cndmask_b32 v91, v32, v8, s[94:95]
M v[84:87], a[72:75], a[40:43], v[84:87]
 buffer_load_dwordx4 v4, s[8:11], s24 offen offset:2048 sc1 lds
M v[84:87], a[68:71], a[36:39], v[84:87]
 s_waitcnt vmcnt(21) lgkmcnt(0)
 v_add_f32 v28, v22, v28
 v_cvt_pk_bf16_f32 v58, v22, v23
M v[84:87], a[64:67], a[32:35], v[84:87]
 s_barrier
M v[88:91], a[96:99], a[0:3], v[88:91]
 ds_read_b128 a[64:67], v7 offset:0
 ds_read_b128 a[68:71], v7 offset:1024
M v[88:91], a[100:103], a[4:7], v[88:91]
 s_cmp_eq_u32 s20, 0
 v_add_f32 v28, v23, v28
 v_add_f32 v28, v24, v28
M v[88:91], a[104:107], a[8:11], v[88:91]
 s_cselect_b64 s[88:89], s[16:17], -1
 v_exp_f32 v22, v124
M v[88:91], a[108:111], a[12:15], v[88:91]
 s_cselect_b64 s[90:91], s[18:19], -1
 ds_read_b128 a[72:75], v7 offset:2048
 ds_read_b128 a[76:79], v7 offset:3072
M v[88:91], a[112:115], a[16:19], v[88:91]
 s_cselect_b64 s[92:93], s[48:49], -1
 v_exp_f32 v23, v125
M v[88:91], a[116:119], a[20:23], v[88:91]
 s_cselect_b64 s[94:95], s[50:51], -1
 v_cvt_pk_bf16_f32 v59, v24, v25
 v_add_f32 v28, v25, v28
M v[88:91], a[120:123], a[24:27], v[88:91]
 ds_read_b128 a[80:83], v7 offset:4096
 ds_read_b128 a[84:87], v7 offset:5120
M v[88:91], a[124:127], a[28:31], v[88:91]
 buffer_load_dwordx4 a[148:151], v7, s[8:11], s13 offen offset:1024 sc1
M v[92:95], a[124:127], a[60:63], v[36:39]
 buffer_load_dwordx4 v4, s[8:11], s24 offen offset:3072 sc1 lds
M v[92:95], a[120:123], a[56:59], v[92:95]
 ds_read_b128 a[88:91], v7 offset:6144
 ds_read_b128 a[92:95], v7 offset:7168
M v[92:95], a[116:119], a[52:55], v[92:95]
 buffer_load_dwordx4 a[152:155], v7, s[8:11], s13 offen offset:2048 sc1
M v[92:95], a[112:115], a[48:51], v[92:95]
 v_exp_f32 v24, v126
M v[92:95], a[108:111], a[44:47], v[92:95]
 buffer_load_dwordx4 a[156:159], v7, s[8:11], s13 offen offset:3072 sc1
M v[92:95], a[104:107], a[40:43], v[92:95]
 v_exp_f32 v25, v127
M v[92:95], a[100:103], a[36:39], v[92:95]
 s_waitcnt lgkmcnt(0)
 v_add_f32 v29, v18, v29
 v_cvt_pk_bf16_f32 v60, v18, v19
M v[92:95], a[96:99], a[32:35], v[92:95]
 v_add_f32 v29, v19, v29
 v_add_f32 v29, v20, v29
 v_cvt_pk_bf16_f32 v61, v20, v21
 v_add_f32 v29, v21, v29
 v_add_f32 v29, v22, v29
 v_cvt_pk_bf16_f32 v62, v22, v23
 v_add_f32 v29, v23, v29
 v_add_f32 v29, v24, v29
 v_cvt_pk_bf16_f32 v63, v24, v25
 v_add_f32 v29, v25, v29
 v_max_f32 v10, v28, v29
 v_cmp_lt_f32 vcc, s31, v10
 s_nop 0
 s_cbranch_vccnz L_st3
L_rt3:
M v[128:131], a[64:67], v[48:51], v[128:131]
 s_add_u32 m0, s28, 98304
 ds_read_b128 a[96:99], v7 offset:8192
 ds_read_b128 a[100:103], v7 offset:9216
M v[128:131], a[68:71], v[56:59], v[128:131]
 buffer_load_dwordx4 v3, s[8:11], s21 offen offset:0 sc1 lds
M v[132:135], a[68:71], v[60:63], v[132:135]
 v_exp_f32 v18, v64
M v[132:135], a[64:67], v[52:55], v[132:135]
 ds_read_b128 a[104:107], v7 offset:10240
 ds_read_b128 a[108:111], v7 offset:11264
M v[140:143], a[72:75], v[52:55], v[140:143]
 buffer_load_dwordx4 a[160:163], v7, s[8:11], s14 offen offset:0 sc1
M v[140:143], a[76:79], v[60:63], v[140:143]
 v_cndmask_b32 v100, v36, v8, s[64:65]
 v_add_f32 v30, v28, v30
M v[136:139], a[76:79], v[56:59], v[136:139]
 ds_read_b128 a[112:115], v7 offset:12288
 ds_read_b128 a[116:119], v7 offset:13312
M v[136:139], a[72:75], v[48:51], v[136:139]
 buffer_load_dwordx4 v3, s[8:11], s21 offen offset:1024 sc1 lds
M v[144:147], a[80:83], v[48:51], v[144:147]
 v_cndmask_b32 v101, v36, v8, s[66:67]
 v_add_f32 v31, v29, v31
M v[144:147], a[84:87], v[56:59], v[144:147]
 ds_read_b128 a[120:123], v7 offset:14336
 ds_read_b128 a[124:127], v7 offset:15360
M v[148:151], a[84:87], v[60:63], v[148:151]
 buffer_load_dwordx4 a[164:167], v7, s[8:11], s14 offen offset:1024 sc1
M v[148:151], a[80:83], v[52:55], v[148:151]
 v_cndmask_b32 v102, v36, v8, s[68:69]
M v[156:159], a[88:91], v[52:55], v[156:159]
 buffer_load_dwordx4 v3, s[8:11], s21 offen offset:2048 sc1 lds
M v[156:159], a[92:95], v[60:63], v[156:159]
 v_exp_f32 v19, v65
M v[152:155], a[92:95], v[56:59], v[152:155]
 buffer_load_dwordx4 a[168:171], v7, s[8:11], s14 offen offset:2048 sc1
M v[152:155], a[88:91], v[48:51], v[152:155]
 s_waitcnt lgkmcnt(0)
 v_cndmask_b32 v103, v36, v8, s[70:71]
 v_add_f32 v26, v18, v19
M v[160:163], a[96:99], v[48:51], v[160:163]
 ds_read_b128 a[64:67], v7 offset:16384
 ds_read_b128 a[68:71], v7 offset:17408
M v[160:163], a[100:103], v[56:59], v[160:163]
 buffer_load_dwordx4 v3, s[8:11], s21 offen offset:3072 sc1 lds
M v[164:167], a[100:103], v[60:63], v[164:167]
 v_cndmask_b32 v108, v36, v8, s[72:73]
 v_cvt_pk_bf16_f32 v40, v18, v19
M v[164:167], a[96:99], v[52:55], v[164:167]
 ds_read_b128 a[72:75], v7 offset:18432
 ds_read_b128 a[76:79], v7 offset:19456
M v[172:175], a[104:107], v[52:55], v[172:175]
 buffer_load_dwordx4 a[172:175], v7, s[8:11], s14 offen offset:3072 sc1
M v[172:175], a[108:111], v[60:63], v[172:175]
 v_exp_f32 v20, v66
M v[168:171], a[108:111], v[56:59], v[168:171]
 s_add_u32 m0, s28, 102400
 ds_read_b128 a[80:83], v7 offset:20480
 ds_read_b128 a[84:87], v7 offset:21504
M v[168:171], a[104:107], v[48:51], v[168:171]
 buffer_load_dwordx4 v4, s[8:11], s21 offen offset:0 sc1 lds
M v[176:179], a[112:115], v[48:51], v[176:179]
 v_cndmask_b32 v109, v36, v8, s[74:75]
M v[176:179], a[116:119], v[56:59], v[176:179]
 ds_read_b128 a[88:91], v7 offset:22528
 ds_read_b128 a[92:95], v7 offset:23552
M v[180:183], a[116:119], v[60:63], v[180:183]
 buffer_load_dwordx4 a[176:179], v7, s[8:11], s15 offen offset:0 sc1
M v[180:183], a[112:115], v[52:55], v[180:183]
 v_cndmask_b32 v110, v36, v8, s[76:77]
M v[188:191], a[120:123], v[52:55], v[188:191]
 buffer_load_dwordx4 v4, s[8:11], s21 offen offset:1024 sc1 lds
M v[188:191], a[124:127], v[60:63], v[188:191]
 v_cndmask_b32 v111, v36, v8, s[78:79]
M v[184:187], a[124:127], v[56:59], v[184:187]
 buffer_load_dwordx4 a[180:183], v7, s[8:11], s15 offen offset:1024 sc1
M v[184:187], a[120:123], v[48:51], v[184:187]
 s_waitcnt lgkmcnt(0)
 v_exp_f32 v21, v67
M v[192:195], a[64:67], v[48:51], v[192:195]
 ds_read_b128 a[96:99], v7 offset:24576
 ds_read_b128 a[100:103], v7 offset:25600
M v[192:195], a[68:71], v[56:59], v[192:195]
 buffer_load_dwordx4 v4, s[8:11], s21 offen offset:2048 sc1 lds
M v[196:199], a[68:71], v[60:63], v[196:199]
 v_cndmask_b32 v116, v36, v8, s[80:81]
 v_add_f32 v26, v20, v26
M v[196:199], a[64:67], v[52:55], v[196:199]
 ds_read_b128 a[104:107], v7 offset:26624
 ds_read_b128 a[108:111], v7 offset:27648
M v[204:207], a[72:75], v[52:55], v[204:207]
 buffer_load_dwordx4 a[184:187], v7, s[8:11], s15 offen offset:2048 sc1
M v[204:207], a[76:79], v[60:63], v[204:207]
 v_cndmask_b32 v117, v36, v8, s[82:83]
 v_cvt_pk_bf16_f32 v41, v20, v21
M v[200:203], a[76:79], v[56:59], v[200:203]
 ds_read_b128 a[112:115], v7 offset:28672
 ds_read_b128 a[116:119], v7 offset:29696
M v[200:203], a[72:75], v[48:51], v[200:203]
 buffer_load_dwordx4 v4, s[8:11], s21 offen offset:3072 sc1 lds
M v[208:211], a[80:83], v[48:51], v[208:211]
 s_add_u32 s24, s23, 33554432
 v_cndmask_b32 v118, v36, v8, s[84:85]
 v_add_f32 v26, v21, v26
M v[208:211], a[84:87], v[56:59], v[208:211]
 s_mov_b32 s23, s21
 ds_read_b128 a[120:123], v7 offset:30720
 ds_read_b128 a[124:127], v7 offset:31744
M v[212:215], a[84:87], v[60:63], v[212:215]
 buffer_load_dwordx4 a[188:191], v7, s[8:11], s15 offen offset:3072 sc1
M v[212:215], a[80:83], v[52:55], v[212:215]
 s_add_u32 s21, s21, 65536
 v_cndmask_b32 v119, v36, v8, s[86:87]
M v[220:223], a[88:91], v[52:55], v[220:223]
 s_add_u32 s22, s22, 1
 v_exp_f32 v22, v72
M v[220:223], a[92:95], v[60:63], v[220:223]
 s_cmp_eq_u32 s22, s25
 v_exp_f32 v23, v73
M v[216:219], a[92:95], v[56:59], v[216:219]
 s_waitcnt vmcnt(33) lgkmcnt(0)
 v_exp_f32 v24, v74
M v[216:219], a[88:91], v[48:51], v[216:219]
 s_barrier
M v[224:227], a[96:99], v[48:51], v[224:227]
 s_cselect_b32 s21, s26, s21
 ds_read_b128 a[64:67], v7 offset:32768
 ds_read_b128 a[68:71], v7 offset:33792
M v[224:227], a[100:103], v[56:59], v[224:227]
 s_cmp_eq_u32 s22, s43
 v_cndmask_b32 v124, v36, v8, s[88:89]
 v_add_f32 v26, v22, v26
M v[228:231], a[100:103], v[60:63], v[228:231]
 s_cselect_b32 s21, s4, s21
 v_exp_f32 v25, v75
M v[228:231], a[96:99], v[52:55], v[228:231]
 s_cmp_eq_u32 s22, s6
 ds_read_b128 a[72:75], v7 offset:34816
 ds_read_b128 a[76:79], v7 offset:35840
M v[236:239], a[104:107], v[52:55], v[236:239]
 s_cselect_b32 s21, s7, s21
 v_cndmask_b32 v125, v36, v8, s[90:91]
 v_cvt_pk_bf16_f32 v42, v22, v23
M v[236:239], a[108:111], v[60:63], v[236:239]
 v_exp_f32 v18, v68
M v[232:235], a[108:111], v[56:59], v[232:235]
 ds_read_b128 a[80:83], v7 offset:36864
 ds_read_b128 a[84:87], v7 offset:37888
M v[232:235], a[104:107], v[48:51], v[232:235]
 v_cndmask_b32 v126, v36, v8, s[92:93]
 v_add_f32 v26, v23, v26
M v[240:243], a[112:115], v[48:51], v[240:243]
 v_exp_f32 v19, v69
M v[240:243], a[116:119], v[56:59], v[240:243]
 ds_read_b128 a[88:91], v7 offset:38912
 ds_read_b128 a[92:95], v7 offset:39936
M v[244:247], a[116:119], v[60:63], v[244:247]
 v_cndmask_b32 v127, v36, v8, s[94:95]
 v_add_f32 v26, v24, v26
M v[244:247], a[112:115], v[52:55], v[244:247]
 v_exp_f32 v20, v70
M v[252:255], a[120:123], v[52:55], v[252:255]
 v_exp_f32 v21, v71
M v[252:255], a[124:127], v[60:63], v[252:255]
 v_exp_f32 v22, v76
M v[248:251], a[124:127], v[56:59], v[248:251]
 s_waitcnt lgkmcnt(0)
 v_exp_f32 v23, v77
M v[248:251], a[120:123], v[48:51], v[248:251]
 v_cvt_pk_bf16_f32 v43, v24, v25
 v_add_f32 v26, v25, v26
 v_add_f32 v27, v18, v19
 v_cvt_pk_bf16_f32 v44, v18, v19
 v_add_f32 v27, v20, v27
 v_cvt_pk_bf16_f32 v45, v20, v21
 v_add_f32 v27, v21, v27
 v_exp_f32 v24, v78
 v_add_f32 v27, v22, v27
 v_cvt_pk_bf16_f32 v46, v22, v23
 v_exp_f32 v25, v79
 v_add_f32 v27, v23, v27
 v_add_f32 v27, v24, v27
 v_cvt_pk_bf16_f32 v47, v24, v25
 v_add_f32 v27, v25, v27
 s_waitcnt vmcnt(31)
 v_cmp_neq_f32 vcc, v32, v14
 v_cmp_neq_f32 s[64:65], v36, v15
 s_nop 0
 s_or_b64 vcc, vcc, s[64:65]
 s_cbranch_vccnz L_comb
 v_add_f32 v30, v16, v30
 v_add_f32 v31, v17, v31
M v[100:103], a[64:67], a[32:35], v[100:103]
 ds_read_b128 a[96:99], v7 offset:40960
 ds_read_b128 a[100:103], v7 offset:41984
M v[100:103], a[68:71], a[36:39], v[100:103]
 ds_read_b128 a[104:107], v7 offset:43008
M v[100:103], a[72:75], a[40:43], v[100:103]
 ds_read_b128 a[108:111], v7 offset:44032
 ds_read_b128 a[112:115], v7 offset:45056
M v[100:103], a[76:79], a[44:47], v[100:103]
 ds_read_b128 a[116:119], v7 offset:46080
M v[100:103], a[80:83], a[48:51], v[100:103]
 s_add_u32 m0, s28, 0
 ds_read_b128 a[120:123], v7 offset:47104
 ds_read_b128 a[124:127], v7 offset:48128
M v[100:103], a[84:87], a[52:55], v[100:103]
 buffer_load_dwordx4 v3, s[8:11], s24 offen offset:0 sc1 lds
M v[100:103], a[88:91], a[56:59], v[100:103]
 ds_read_b128 a[0:3], v7 offset:49152
 ds_read_b128 a[4:7], v7 offset:50176
M v[100:103], a[92:95], a[60:63], v[100:103]
 s_waitcnt lgkmcnt(2)
 ds_read_b128 a[8:11], v7 offset:51200
M v[108:111], a[124:127], a[60:63], v[108:111]
 ds_read_b128 a[12:15], v7 offset:52224
 ds_read_b128 a[16:19], v7 offset:53248
M v[108:111], a[120:123], a[56:59], v[108:111]
 buffer_load_dwordx4 v3, s[8:11], s24 offen offset:1024 sc1 lds
M v[108:111], a[116:119], a[52:55], v[108:111]
 ds_read_b128 a[20:23], v7 offset:54272
 ds_read_b128 a[24:27], v7 offset:55296
M v[108:111], a[112:115], a[48:51], v[108:111]
 ds_read_b128 a[28:31], v7 offset:56320
M v[108:111], a[108:111], a[44:47], v[108:111]
 ds_read_b128 a[192:195], v7 offset:57344
 ds_read_b128 a[196:199], v7 offset:58368
M v[108:111], a[104:107], a[40:43], v[108:111]
 v_exp_f32 v18, v80
M v[108:111], a[100:103], a[36:39], v[108:111]
 ds_read_b128 a[200:203], v7 offset:59392
 ds_read_b128 a[204:207], v7 offset:60416
M v[108:111], a[96:99], a[32:35], v[108:111]
 s_waitcnt lgkmcnt(4)
 ds_read_b128 a[208:211], v7 offset:61440
M v[116:119], a[0:3], a[32:35], v[116:119]
 ds_read_b128 a[212:215], v7 offset:62464
 ds_read_b128 a[216:219], v7 offset:63488
M v[116:119], a[4:7], a[36:39], v[116:119]
 ds_read_b128 a[220:223], v7 offset:64512
M v[116:119], a[8:11], a[40:43], v[116:119]
 buffer_load_dwordx4 v3, s[8:11], s24 offen offset:2048 sc1 lds
M v[116:119], a[12:15], a[44:47], v[116:119]
 v_exp_f32 v19, v81
M v[116:119], a[16:19], a[48:51], v[116:119]
 buffer_load_dwordx4 v3, s[8:11], s24 offen offset:3072 sc1 lds
M v[116:119], a[20:23], a[52:55], v[116:119]
 v_exp_f32 v20, v82
M v[116:119], a[24:27], a[56:59], v[116:119]
 s_add_u32 m0, s28, 4096
 v_exp_f32 v21, v83
M v[116:119], a[28:31], a[60:63], v[116:119]
 s_waitcnt lgkmcnt(0)
 v_exp_f32 v22, v88
M v[124:127], a[220:223], a[60:63], v[124:127]
 buffer_load_dwordx4 v4, s[8:11], s24 offen offset:0 sc1 lds
M v[124:127], a[216:219], a[56:59], v[124:127]
 v_exp_f32 v23, v89
M v[124:127], a[212:215], a[52:55], v[124:127]
 v_exp_f32 v24, v90
M v[124:127], a[208:211], a[48:51], v[124:127]
 v_exp_f32 v25, v91
M v[124:127], a[204:207], a[44:47], v[124:127]
 v_add_f32 v26, v18, v26
 v_cvt_pk_bf16_f32 v56, v18, v19
M v[124:127], a[200:203], a[40:43], v[124:127]
 buffer_load_dwordx4 v4, s[8:11], s24 offen offset:1024 sc1 lds
M v[124:127], a[196:199], a[36:39], v[124:127]
 v_add_f32 v26, v19, v26
 v_add_f32 v26, v20, v26
M v[124:127], a[192:195], a[32:35], v[124:127]
 s_waitcnt vmcnt(22)
 v_exp_f32 v18, v84
M v[128:131], a[246:249], a[128:131], v[128:131]
 v_exp_f32 v19, v85
M v[136:139], a[244:247], a[128:131], v[136:139]
 v_cvt_pk_bf16_f32 v57, v20, v21
 v_add_f32 v26, v21, v26
M v[144:147], a[246:249], a[132:135], v[144:147]
 buffer_load_dwordx4 v4, s[8:11], s24 offen offset:2048 sc1 lds
M v[152:155], a[244:247], a[132:135], v[152:155]
 v_exp_f32 v20, v86
M v[160:163], a[246:249], a[136:139], v[160:163]
 v_add_f32 v26, v22, v26
 v_cvt_pk_bf16_f32 v58, v22, v23
M v[168:171], a[244:247], a[136:139], v[168:171]
 v_add_f32 v26, v23, v26
 v_add_f32 v26, v24, v26
M v[176:179], a[246:249], a[140:143], v[176:179]
 v_exp_f32 v21, v87
M v[184:187], a[244:247], a[140:143], v[184:187]
 buffer_load_dwordx4 v4, s[8:11], s24 offen offset:3072 sc1 lds
M v[192:195], a[246:249], a[144:147], v[192:195]
 v_cvt_pk_bf16_f32 v59, v24, v25
 v_add_f32 v26, v25, v26
M v[200:203], a[244:247], a[144:147], v[200:203]
 v_add_f32 v27, v18, v27
 v_cvt_pk_bf16_f32 v60, v18, v19
M v[208:211], a[246:249], a[148:151], v[208:211]
 v_exp_f32 v22, v92
M v[216:219], a[244:247], a[148:151], v[216:219]
 v_add_f32 v27, v19, v27
 v_add_f32 v27, v20, v27
M v[224:227], a[246:249], a[152:155], v[224:227]
 v_cvt_pk_bf16_f32 v61, v20, v21
 v_add_f32 v27, v21, v27
M v[232:235], a[244:247], a[152:155], v[232:235]
 s_waitcnt vmcnt(8)
 v_exp_f32 v23, v93
M v[240:243], a[246:249], a[156:159], v[240:243]
 v_add_f32 v27, v22, v27
 v_cvt_pk_bf16_f32 v62, v22, v23
M v[248:251], a[244:247], a[156:159], v[248:251]
 s_barrier
M v[132:135], a[246:249], a[160:163], v[132:135]
 ds_read_b128 a[64:67], v2 offset:0
 v_add_f32 v27, v23, v27
M v[140:143], a[244:247], a[160:163], v[140:143]
 ds_read_b128 a[68:71], v2 offset:1024
M v[148:151], a[246:249], a[164:167], v[148:151]
 v_exp_f32 v24, v94
M v[156:159], a[244:247], a[164:167], v[156:159]
 ds_read_b128 a[72:75], v2 offset:2048
M v[164:167], a[246:249], a[168:171], v[164:167]
 ds_read_b128 a[76:79], v2 offset:3072
M v[172:175], a[244:247], a[168:171], v[172:175]
 v_exp_f32 v25, v95
M v[180:183], a[246:249], a[172:175], v[180:183]
 ds_read_b128 a[80:83], v2 offset:4096
 v_add_f32 v27, v24, v27
M v[188:191], a[244:247], a[172:175], v[188:191]
 ds_read_b128 a[84:87], v2 offset:5120
 v_cvt_pk_bf16_f32 v63, v24, v25
M v[196:199], a[246:249], a[176:179], v[196:199]
 v_add_f32 v27, v25, v27
M v[204:207], a[244:247], a[176:179], v[204:207]
 ds_read_b128 a[88:91], v2 offset:6144
M v[212:215], a[246:249], a[180:183], v[212:215]
 ds_read_b128 a[92:95], v2 offset:7168
 v_max_f32 v10, v26, v27
M v[220:223], a[244:247], a[180:183], v[220:223]
 v_cmp_lt_f32 vcc, s31, v10
M v[228:231], a[246:249], a[184:187], v[228:231]
M v[236:239], a[244:247], a[184:187], v[236:239]
M v[244:247], a[246:249], a[188:191], v[244:247]
 s_waitcnt lgkmcnt(0)
M v[252:255], a[244:247], a[188:191], v[252:255]
 s_cbranch_vccnz L_st14
L_rt14:
L_p3o:
M v[128:131], a[64:67], v[40:43], v[128:131]
 s_add_u32 m0, s28, 32768
 ds_read_b128 a[96:99], v2 offset:8192
 v_add_f32 v30, v26, v30
M v[128:131], a[68:71], v[56:59], v[128:131]
 ds_read_b128 a[100:103], v2 offset:9216
 v_add_f32 v31, v27, v31
M v[132:135], a[68:71], v[60:63], v[132:135]
 buffer_load_dwordx4 v3, s[8:11], s21 offen offset:0 sc1 lds
M v[132:135], a[64:67], v[44:47], v[132:135]
 ds_read_b128 a[104:107], v2 offset:10240
M v[140:143], a[72:75], v[44:47], v[140:143]
 ds_read_b128 a[108:111], v2 offset:11264
M v[140:143], a[76:79], v[60:63], v[140:143]
 buffer_load_dwordx4 v3, s[8:11], s21 offen offset:1024 sc1 lds
M v[136:139], a[76:79], v[56:59], v[136:139]
 ds_read_b128 a[112:115], v2 offset:12288
M v[136:139], a[72:75], v[40:43], v[136:139]
 ds_read_b128 a[116:119], v2 offset:13312
M v[144:147], a[80:83], v[40:43], v[144:147]
 v_exp_f32 v18, v100
M v[144:147], a[84:87], v[56:59], v[144:147]
 ds_read_b128 a[120:123], v2 offset:14336
M v[148:151], a[84:87], v[60:63], v[148:151]
 ds_read_b128 a[124:127], v2 offset:15360
M v[148:151], a[80:83], v[44:47], v[148:151]
 buffer_load_dwordx4 v3, s[8:11], s21 offen offset:2048 sc1 lds
M v[156:159], a[88:91], v[44:47], v[156:159]
 v_exp_f32 v19, v101
M v[156:159], a[92:95], v[60:63], v[156:159]
 v_exp_f32 v20, v102
M v[152:155], a[92:95], v[56:59], v[152:155]
 buffer_load_dwordx4 v3, s[8:11], s21 offen offset:3072 sc1 lds
M v[152:155], a[88:91], v[40:43], v[152:155]
 s_waitcnt lgkmcnt(0)
 v_exp_f32 v21, v103
M v[160:163], a[96:99], v[40:43], v[160:163]
 ds_read_b128 a[64:67], v2 offset:16384
 v_add_f32 v29, v18, v19
M v[160:163], a[100:103], v[56:59], v[160:163]
 s_add_u32 m0, s28, 36864
 ds_read_b128 a[68:71], v2 offset:17408
 v_cvt_pk_bf16_f32 v52, v18, v19
M v[164:167], a[100:103], v[60:63], v[164:167]
 buffer_load_dwordx4 v4, s[8:11], s21 offen offset:0 sc1 lds
M v[164:167], a[96:99], v[44:47], v[164:167]
 ds_read_b128 a[72:75], v2 offset:18432
 v_add_f32 v29, v20, v29
M v[172:175], a[104:107], v[44:47], v[172:175]
 ds_read_b128 a[76:79], v2 offset:19456
 v_cvt_pk_bf16_f32 v53, v20, v21
M v[172:175], a[108:111], v[60:63], v[172:175]
 v_exp_f32 v22, v108
M v[168:171], a[108:111], v[56:59], v[168:171]
 ds_read_b128 a[80:83], v2 offset:20480
 v_add_f32 v29, v21, v29
M v[168:171], a[104:107], v[40:43], v[168:171]
 ds_read_b128 a[84:87], v2 offset:21504
M v[176:179], a[112:115], v[40:43], v[176:179]
 buffer_load_dwordx4 v4, s[8:11], s21 offen offset:1024 sc1 lds
M v[176:179], a[116:119], v[56:59], v[176:179]
 ds_read_b128 a[88:91], v2 offset:22528
M v[180:183], a[116:119], v[60:63], v[180:183]
 ds_read_b128 a[92:95], v2 offset:23552
M v[180:183], a[112:115], v[44:47], v[180:183]
 buffer_load_dwordx4 v4, s[8:11], s21 offen offset:2048 sc1 lds
M v[188:191], a[120:123], v[44:47], v[188:191]
 v_exp_f32 v23, v109
M v[188:191], a[124:127], v[60:63], v[188:191]
 v_exp_f32 v24, v110
M v[184:187], a[124:127], v[56:59], v[184:187]
 v_exp_f32 v25, v111
M v[184:187], a[120:123], v[40:43], v[184:187]
 s_waitcnt lgkmcnt(0)
 v_exp_f32 v18, v116
M v[192:195], a[64:67], v[40:43], v[192:195]
 ds_read_b128 a[96:99], v2 offset:24576
 v_add_f32 v29, v22, v29
M v[192:195], a[68:71], v[56:59], v[192:195]
 ds_read_b128 a[100:103], v2 offset:25600
 v_cvt_pk_bf16_f32 v54, v22, v23
M v[196:199], a[68:71], v[60:63], v[196:199]
 buffer_load_dwordx4 v4, s[8:11], s21 offen offset:3072 sc1 lds
M v[196:199], a[64:67], v[44:47], v[196:199]
 s_add_u32 s24, s23, 33554432
 ds_read_b128 a[104:107], v2 offset:26624
 v_add_f32 v29, v23, v29
M v[204:207], a[72:75], v[44:47], v[204:207]
 s_mov_b32 s23, s21
 ds_read_b128 a[108:111], v2 offset:27648
 v_add_f32 v29, v24, v29
M v[204:207], a[76:79], v[60:63], v[204:207]
 s_add_u32 s21, s21, 65536
 v_exp_f32 v19, v117
M v[200:203], a[76:79], v[56:59], v[200:203]
 s_add_u32 s22, s22, 1
 ds_read_b128 a[112:115], v2 offset:28672
 v_cvt_pk_bf16_f32 v55, v24, v25
M v[200:203], a[72:75], v[40:43], v[200:203]
 s_cmp_eq_u32 s22, s25
 ds_read_b128 a[116:119], v2 offset:29696
 v_add_f32 v29, v25, v29
M v[208:211], a[80:83], v[40:43], v[208:211]
 s_cselect_b32 s21, s26, s21
 v_exp_f32 v20, v118
M v[208:211], a[84:87], v[56:59], v[208:211]
 s_cmp_eq_u32 s22, s43
 ds_read_b128 a[120:123], v2 offset:30720
 v_add_f32 v29, v18, v29
M v[212:215], a[84:87], v[60:63], v[212:215]
 s_cselect_b32 s21, s4, s21
 ds_read_b128 a[124:127], v2 offset:31744
 v_cvt_pk_bf16_f32 v48, v18, v19
M v[212:215], a[80:83], v[44:47], v[212:215]
 s_cmp_eq_u32 s22, s6
 v_exp_f32 v21, v119
M v[220:223], a[88:91], v[44:47], v[220:223]
 s_cselect_b32 s21, s7, s21
 v_exp_f32 v22, v124
M v[220:223], a[92:95], v[60:63], v[220:223]
 v_exp_f32 v23, v125
M v[216:219], a[92:95], v[56:59], v[216:219]
 s_waitcnt vmcnt(8) lgkmcnt(0)
 v_add_f32 v29, v19, v29
 v_add_f32 v29, v20, v29
M v[216:219], a[88:91], v[40:43], v[216:219]
 s_barrier
M v[224:227], a[96:99], v[40:43], v[224:227]
 ds_read_b128 a[64:67], v7 offset:0
 v_cvt_pk_bf16_f32 v49, v20, v21
M v[224:227], a[100:103], v[56:59], v[224:227]
 ds_read_b128 a[68:71], v7 offset:1024
 v_add_f32 v29, v21, v29
M v[228:231], a[100:103], v[60:63], v[228:231]
 v_exp_f32 v24, v126
M v[228:231], a[96:99], v[44:47], v[228:231]
 ds_read_b128 a[72:75], v7 offset:2048
 v_add_f32 v29, v22, v29
M v[236:239], a[104:107], v[44:47], v[236:239]
 ds_read_b128 a[76:79], v7 offset:3072
 v_cvt_pk_bf16_f32 v50, v22, v23
M v[236:239], a[108:111], v[60:63], v[236:239]
 v_exp_f32 v25, v127
M v[232:235], a[108:111], v[56:59], v[232:235]
 ds_read_b128 a[80:83], v7 offset:4096
 v_add_f32 v29, v23, v29
M v[232:235], a[104:107], v[40:43], v[232:235]
 ds_read_b128 a[84:87], v7 offset:5120
 v_add_f32 v29, v24, v29
M v[240:243], a[112:115], v[40:43], v[240:243]
 v_cvt_pk_bf16_f32 v51, v24, v25
 v_add_f32 v29, v25, v29
M v[240:243], a[116:119], v[56:59], v[240:243]
 ds_read_b128 a[88:91], v7 offset:6144
M v[244:247], a[116:119], v[60:63], v[244:247]
 ds_read_b128 a[92:95], v7 offset:7168
M v[244:247], a[112:115], v[44:47], v[244:247]
 v_cmp_lt_f32 vcc, s31, v29
M v[252:255], a[120:123], v[44:47], v[252:255]
M v[252:255], a[124:127], v[60:63], v[252:255]
M v[248:251], a[124:127], v[56:59], v[248:251]
 s_waitcnt lgkmcnt(0)
M v[248:251], a[120:123], v[40:43], v[248:251]
 s_cbranch_vccnz L_st2
L_rt2:
L_pBo:
M v[132:135], a[64:67], v[52:55], v[132:135]
 ds_read_b128 a[96:99], v7 offset:8192
 ds_read_b128 a[100:103], v7 offset:9216
M v[132:135], a[68:71], v[48:51], v[132:135]
 ds_read_b128 a[104:107], v7 offset:10240
 v_cvt_pk_bf16_f32 v128, v128, v129
 v_cvt_pk_bf16_f32 v129, v130, v131
M v[140:143], a[76:79], v[48:51], v[140:143]
 ds_read_b128 a[108:111], v7 offset:11264
 ds_read_b128 a[112:115], v7 offset:12288
 v_cvt_pk_bf16_f32 v130, v136, v137
M v[140:143], a[72:75], v[52:55], v[140:143]
 ds_read_b128 a[116:119], v7 offset:13312
 v_cvt_pk_bf16_f32 v131, v138, v139
 v_cvt_pk_bf16_f32 v144, v144, v145
M v[148:151], a[80:83], v[52:55], v[148:151]
 s_add_u32 m0, s28, 65536
 ds_read_b128 a[120:123], v7 offset:14336
 ds_read_b128 a[124:127], v7 offset:15360
M v[148:151], a[84:87], v[48:51], v[148:151]
 buffer_load_dwordx4 v3, s[8:11], s38 offen offset:0 sc1 lds
M v[156:159], a[92:95], v[48:51], v[156:159]
 ds_read_b128 a[128:131], v7 offset:16384
 ds_read_b128 a[132:135], v7 offset:17408
 v_cvt_pk_bf16_f32 v145, v146, v147
M v[156:159], a[88:91], v[52:55], v[156:159]
 s_waitcnt lgkmcnt(2)
 ds_read_b128 a[136:139], v7 offset:18432
 v_cvt_pk_bf16_f32 v146, v152, v153
 v_cvt_pk_bf16_f32 v147, v154, v155
M v[164:167], a[96:99], v[52:55], v[164:167]
 ds_read_b128 a[140:143], v7 offset:19456
 ds_read_b128 a[144:147], v7 offset:20480
 v_cvt_pk_bf16_f32 v160, v160, v161
M v[164:167], a[100:103], v[48:51], v[164:167]
 buffer_load_dwordx4 v3, s[8:11], s38 offen offset:1024 sc1 lds
M v[172:175], a[108:111], v[48:51], v[172:175]
 ds_read_b128 a[148:151], v7 offset:21504
 ds_read_b128 a[152:155], v7 offset:22528
 v_cvt_pk_bf16_f32 v161, v162, v163
M v[172:175], a[104:107], v[52:55], v[172:175]
 ds_read_b128 a[156:159], v7 offset:23552
 v_cvt_pk_bf16_f32 v162, v168, v169
 v_cvt_pk_bf16_f32 v163, v170, v171
M v[180:183], a[112:115], v[52:55], v[180:183]
 ds_read_b128 a[160:163], v7 offset:24576
 ds_read_b128 a[164:167], v7 offset:25600
 v_cvt_pk_bf16_f32 v176, v176, v177
M v[180:183], a[116:119], v[48:51], v[180:183]
 buffer_load_dwordx4 v3, s[8:11], s38 offen offset:2048 sc1 lds
M v[188:191], a[124:127], v[48:51], v[188:191]
 ds_read_b128 a[168:171], v7 offset:26624
 ds_read_b128 a[172:175], v7 offset:27648
 v_cvt_pk_bf16_f32 v177, v178, v179
M v[188:191], a[120:123], v[52:55], v[188:191]
 s_waitcnt lgkmcnt(4)
 ds_read_b128 a[176:179], v7 offset:28672
 v_cvt_pk_bf16_f32 v178, v184, v185
M v[196:199], a[128:131], v[52:55], v[196:199]
 ds_read_b128 a[180:183], v7 offset:29696
 ds_read_b128 a[184:187], v7 offset:30720
 v_cvt_pk_bf16_f32 v179, v186, v187
M v[196:199], a[132:135], v[48:51], v[196:199]
 ds_read_b128 a[188:191], v7 offset:31744
 v_cvt_pk_bf16_f32 v192, v192, v193
 v_cvt_pk_bf16_f32 v193, v194, v195
M v[204:207], a[140:143], v[48:51], v[204:207]
 buffer_load_dwordx4 v3, s[8:11], s38 offen offset:3072 sc1 lds
M v[204:207], a[136:139], v[52:55], v[204:207]
 s_add_u32 m0, s28, 69632
 v_cvt_pk_bf16_f32 v194, v200, v201
 v_cvt_pk_bf16_f32 v195, v202, v203
 v_cvt_pk_bf16_f32 v208, v208, v209
M v[212:215], a[144:147], v[52:55], v[212:215]
 buffer_load_dwordx4 v4, s[8:11], s38 offen offset:0 sc1 lds
M v[212:215], a[148:151], v[48:51], v[212:215]
 s_waitcnt lgkmcnt(0)
 v_cvt_pk_bf16_f32 v209, v210, v211
 v_cvt_pk_bf16_f32 v210, v216, v217
 v_cvt_pk_bf16_f32 v211, v218, v219
M v[220:223], a[156:159], v[48:51], v[220:223]
 s_barrier
M v[220:223], a[152:155], v[52:55], v[220:223]
 ds_read_b128 a[64:67], v2 offset:32768
 ds_read_b128 a[68:71], v2 offset:33792
 v_cvt_pk_bf16_f32 v224, v224, v225
M v[228:231], a[160:163], v[52:55], v[228:231]
 ds_read_b128 a[72:75], v2 offset:34816
 v_cvt_pk_bf16_f32 v225, v226, v227
 v_cvt_pk_bf16_f32 v226, v232, v233
M v[228:231], a[164:167], v[48:51], v[228:231]
 ds_read_b128 a[76:79], v2 offset:35840
 ds_read_b128 a[80:83], v2 offset:36864
M v[236:239], a[172:175], v[48:51], v[236:239]
 ds_read_b128 a[84:87], v2 offset:37888
 v_cvt_pk_bf16_f32 v227, v234, v235
 v_cvt_pk_bf16_f32 v240, v240, v241
M v[236:239], a[168:171], v[52:55], v[236:239]
 ds_read_b128 a[88:91], v2 offset:38912
 ds_read_b128 a[92:95], v2 offset:39936
 v_cvt_pk_bf16_f32 v241, v242, v243
M v[244:247], a[176:179], v[52:55], v[244:247]
 buffer_load_dwordx4 v4, s[8:11], s38 offen offset:1024 sc1 lds
M v[244:247], a[180:183], v[48:51], v[244:247]
 buffer_load_dwordx4 v4, s[8:11], s38 offen offset:2048 sc1 lds
M v[252:255], a[188:191], v[48:51], v[252:255]
 buffer_load_dwordx4 v4, s[8:11], s38 offen offset:3072 sc1 lds
M v[252:255], a[184:187], v[52:55], v[252:255]
 s_waitcnt lgkmcnt(0)
 s_add_u32 s38, s38, 65536
 v_cvt_pk_bf16_f32 v242, v248, v249
 v_cvt_pk_bf16_f32 v243, v250, v251
L_op1:
M v[64:67], a[64:67], v[128:131], 0
 ds_read_b128 a[96:99], v2 offset:40960
 ds_read_b128 a[100:103], v2 offset:41984
M v[64:67], a[68:71], v[144:147], v[64:67]
 ds_read_b128 a[104:107], v2 offset:43008
 v_cvt_pk_bf16_f32 v132, v132, v133
 v_cvt_pk_bf16_f32 v133, v134, v135
M v[64:67], a[72:75], v[160:163], v[64:67]
 ds_read_b128 a[108:111], v2 offset:44032
 ds_read_b128 a[112:115], v2 offset:45056
M v[64:67], a[76:79], v[176:179], v[64:67]
 ds_read_b128 a[116:119], v2 offset:46080
 v_cvt_pk_bf16_f32 v134, v140, v141
 v_cvt_pk_bf16_f32 v135, v142, v143
M v[64:67], a[80:83], v[192:195], v[64:67]
 s_add_u32 m0, s28, 0
 ds_read_b128 a[120:123], v2 offset:47104
 ds_read_b128 a[124:127], v2 offset:48128
M v[64:67], a[84:87], v[208:211], v[64:67]
 buffer_load_dwordx4 v3, s[8:11], s38 offen offset:0 sc1 lds
M v[64:67], a[88:91], v[224:227], v[64:67]
 ds_read_b128 a[128:131], v2 offset:49152
 ds_read_b128 a[132:135], v2 offset:50176
 v_cvt_pk_bf16_f32 v148, v148, v149
M v[64:67], a[92:95], v[240:243], v[64:67]
 s_waitcnt lgkmcnt(2)
 ds_read_b128 a[136:139], v2 offset:51200
 v_cvt_pk_bf16_f32 v149, v150, v151
M v[72:75], a[96:99], v[128:131], 0
 ds_read_b128 a[140:143], v2 offset:52224
 ds_read_b128 a[144:147], v2 offset:53248
M v[72:75], a[100:103], v[144:147], v[72:75]
 buffer_load_dwordx4 v3, s[8:11], s38 offen offset:1024 sc1 lds
M v[72:75], a[104:107], v[160:163], v[72:75]
 ds_read_b128 a[148:151], v2 offset:54272
 ds_read_b128 a[152:155], v2 offset:55296
 v_cvt_pk_bf16_f32 v150, v156, v157
M v[72:75], a[108:111], v[176:179], v[72:75]
 ds_read_b128 a[156:159], v2 offset:56320
 v_cvt_pk_bf16_f32 v151, v158, v159
M v[72:75], a[112:115], v[192:195], v[72:75]
 ds_read_b128 a[160:163], v2 offset:57344
 ds_read_b128 a[164:167], v2 offset:58368
 v_cvt_pk_bf16_f32 v164, v164, v165
M v[72:75], a[116:119], v[208:211], v[72:75]
 buffer_load_dwordx4 v3, s[8:11], s38 offen offset:2048 sc1 lds
M v[72:75], a[120:123], v[224:227], v[72:75]
 ds_read_b128 a[168:171], v2 offset:59392
 ds_read_b128 a[172:175], v2 offset:60416
M v[72:75], a[124:127], v[240:243], v[72:75]
 s_waitcnt lgkmcnt(4)
 ds_read_b128 a[176:179], v2 offset:61440
 v_cvt_pk_bf16_f32 v165, v166, v167
 v_cvt_pk_bf16_f32 v166, v172, v173
M v[80:83], a[128:131], v[128:131], 0
 ds_read_b128 a[180:183], v2 offset:62464
 ds_read_b128 a[184:187], v2 offset:63488
M v[80:83], a[132:135], v[144:147], v[80:83]
 ds_read_b128 a[188:191], v2 offset:64512
 v_cvt_pk_bf16_f32 v167, v174, v175
 v_cvt_pk_bf16_f32 v180, v180, v181
M v[80:83], a[136:139], v[160:163], v[80:83]
 buffer_load_dwordx4 v3, s[8:11], s38 offen offset:3072 sc1 lds
M v[80:83], a[140:143], v[176:179], v[80:83]
 s_add_u32 m0, s28, 4096
 v_cvt_pk_bf16_f32 v181, v182, v183
 v_cvt_pk_bf16_f32 v182, v188, v189
M v[80:83], a[144:147], v[192:195], v[80:83]
 buffer_load_dwordx4 v4, s[8:11], s38 offen offset:0 sc1 lds
M v[80:83], a[148:151], v[208:211], v[80:83]
 v_cvt_pk_bf16_f32 v183, v190, v191
 v_cvt_pk_bf16_f32 v196, v196, v197
M v[80:83], a[152:155], v[224:227], v[80:83]
 buffer_load_dwordx4 v4, s[8:11], s38 offen offset:1024 sc1 lds
M v[80:83], a[156:159], v[240:243], v[80:83]
 s_waitcnt lgkmcnt(0)
 v_cvt_pk_bf16_f32 v197, v198, v199
 v_cvt_pk_bf16_f32 v198, v204, v205
 v_cvt_pk_bf16_f32 v199, v206, v207
M v[88:91], a[160:163], v[128:131], 0
 v_cvt_pk_bf16_f32 v212, v212, v213
 v_cvt_pk_bf16_f32 v213, v214, v215
M v[88:91], a[164:167], v[144:147], v[88:91]
 v_cvt_pk_bf16_f32 v214, v220, v221
 v_cvt_pk_bf16_f32 v215, v222, v223
 v_cvt_pk_bf16_f32 v228, v228, v229
M v[88:91], a[168:171], v[160:163], v[88:91]
 buffer_load_dwordx4 v4, s[8:11], s38 offen offset:2048 sc1 lds
M v[88:91], a[172:175], v[176:179], v[88:91]
 v_cvt_pk_bf16_f32 v229, v230, v231
 v_cvt_pk_bf16_f32 v230, v236, v237
M v[88:91], a[176:179], v[192:195], v[88:91]
 v_cvt_pk_bf16_f32 v231, v238, v239
 v_cvt_pk_bf16_f32 v244, v244, v245
 v_cvt_pk_bf16_f32 v245, v246, v247
M v[88:91], a[180:183], v[208:211], v[88:91]
 buffer_load_dwordx4 v4, s[8:11], s38 offen offset:3072 sc1 lds
M v[88:91], a[184:187], v[224:227], v[88:91]
 v_cvt_pk_bf16_f32 v246, v252, v253
 v_cvt_pk_bf16_f32 v247, v254, v255
M v[88:91], a[188:191], v[240:243], v[88:91]
 s_add_u32 s38, s38, 65536
 v_add_f32 v31, v29, v31
 v_mov_b32 v10, v30
M v[68:71], a[64:67], v[132:135], 0
 s_add_u32 m0, s28, 131072
 v_mov_b32 v11, v31
 v_permlane16_swap_b32 v10, v30
M v[68:71], a[68:71], v[148:151], v[68:71]
 buffer_load_dwordx4 v3, s[8:11], s38 offen offset:0 sc1 lds
M v[68:71], a[72:75], v[164:167], v[68:71]
 v_permlane16_swap_b32 v11, v31
 v_add_f32 v30, v10, v30
M v[68:71], a[76:79], v[180:183], v[68:71]
 v_add_f32 v31, v11, v31
 v_mov_b32 v10, v30
M v[68:71], a[80:83], v[196:199], v[68:71]
 buffer_load_dwordx4 v3, s[8:11], s38 offen offset:1024 sc1 lds
M v[68:71], a[84:87], v[212:215], v[68:71]
 v_mov_b32 v11, v31
 v_permlane32_swap_b32 v10, v30
M v[68:71], a[88:91], v[228:231], v[68:71]
 v_permlane32_swap_b32 v11, v31
 v_add_f32 v30, v10, v30
M v[68:71], a[92:95], v[244:247], v[68:71]
 v_add_f32 v31, v11, v31
 s_lshl_b32 s64, s20, 1
M v[76:79], a[96:99], v[132:135], 0
 buffer_load_dwordx4 v3, s[8:11], s38 offen offset:2048 sc1 lds
M v[76:79], a[100:103], v[148:151], v[76:79]
 v_rcp_f32 v5, v30
 v_max3_f32 v32, |v64|, |v65|, |v66|
M v[76:79], a[104:107], v[164:167], v[76:79]
 v_rcp_f32 v6, v31
M v[76:79], a[108:111], v[180:183], v[76:79]
 buffer_load_dwordx4 v3, s[8:11], s38 offen offset:3072 sc1 lds
M v[76:79], a[112:115], v[196:199], v[76:79]
 s_lshr_b32 s64, s101, s64
 v_max3_f32 v32, |v67|, |v72|, v32
 v_max3_f32 v32, |v73|, |v74|, v32
M v[76:79], a[116:119], v[212:215], v[76:79]
 s_lshr_b32 s93, s64, 1
 s_xor_b32 s64, s64, s93
 s_and_b32 s64, s64, 1
M v[76:79], a[120:123], v[228:231], v[76:79]
 s_waitcnt vmcnt(20)
 s_lshl_b32 s64, s64, 13
 s_xor_b32 s93, s33, s64
 v_mul_f32 v32, 2.0, v32
M v[76:79], a[124:127], v[244:247], v[76:79]
 s_barrier
M v[84:87], a[128:131], v[132:135], 0
 ds_read_b128 a[64:67], v7 offset:32768
 s_add_u32 s93, s93, 32768
M v[84:87], a[132:135], v[148:151], v[84:87]
 s_add_u32 m0, s28, 135168
 ds_read_b128 a[68:71], v7 offset:33792
 v_mov_b32 v33, v32
 v_mov_b32 v34, v32
M v[84:87], a[136:139], v[164:167], v[84:87]
 buffer_load_dwordx4 v4, s[8:11], s38 offen offset:0 sc1 lds
M v[84:87], a[140:143], v[180:183], v[84:87]
 ds_read_b128 a[72:75], v7 offset:34816
 v_mov_b32 v35, v32
M v[84:87], a[144:147], v[196:199], v[84:87]
 ds_read_b128 a[76:79], v7 offset:35840
 v_max3_f32 v36, |v68|, |v69|, |v70|
M v[84:87], a[148:151], v[212:215], v[84:87]
 buffer_load_dwordx4 v4, s[8:11], s38 offen offset:1024 sc1 lds
M v[84:87], a[152:155], v[228:231], v[84:87]
 ds_read_b128 a[80:83], v7 offset:36864
M v[84:87], a[156:159], v[244:247], v[84:87]
 ds_read_b128 a[84:87], v7 offset:37888
 v_max3_f32 v36, |v71|, |v76|, v36
M v[92:95], a[160:163], v[132:135], 0
 buffer_load_dwordx4 v4, s[8:11], s38 offen offset:2048 sc1 lds
M v[92:95], a[164:167], v[148:151], v[92:95]
 ds_read_b128 a[88:91], v7 offset:38912
 v_max3_f32 v36, |v77|, |v78|, v36
M v[92:95], a[168:171], v[164:167], v[92:95]
 ds_read_b128 a[92:95], v7 offset:39936
 v_mul_f32 v36, 2.0, v36
M v[92:95], a[172:175], v[180:183], v[92:95]
 buffer_load_dwordx4 v4, s[8:11], s38 offen offset:3072 sc1 lds
M v[92:95], a[176:179], v[196:199], v[92:95]
 s_add_u32 s38, s38, 65536
 v_mov_b32 v37, v36
M v[92:95], a[180:183], v[212:215], v[92:95]
 v_mov_b32 v38, v36
 v_mov_b32 v39, v36
M v[92:95], a[184:187], v[228:231], v[92:95]
 s_waitcnt lgkmcnt(0)
 s_cmp_eq_u32 s42, 6
M v[92:95], a[188:191], v[244:247], v[92:95]
 s_cbranch_scc1 L_y1
L_y1r:
M v[96:99], a[64:67], v[128:131], v[32:35]
 s_add_u32 m0, s28, 98304
 ds_read_b128 a[96:99], v7 offset:40960
M v[96:99], a[68:71], v[144:147], v[96:99]
 ds_read_b128 a[100:103], v7 offset:41984
M v[96:99], a[72:75], v[160:163], v[96:99]
 buffer_load_dwordx4 v3, s[8:11], s38 offen offset:0 sc1 lds
M v[96:99], a[76:79], v[176:179], v[96:99]
 ds_read_b128 a[104:107], v7 offset:43008
 s_add_u32 s29, s33, 0
M v[96:99], a[80:83], v[192:195], v[96:99]
 ds_read_b128 a[108:111], v7 offset:44032
 s_add_u32 s30, s93, 0
M v[96:99], a[84:87], v[208:211], v[96:99]
 buffer_load_dwordx4 v3, s[8:11], s38 offen offset:1024 sc1 lds
M v[96:99], a[88:91], v[224:227], v[96:99]
 ds_read_b128 a[112:115], v7 offset:45056
 v_mul_f32 v28, -v32, v5
M v[96:99], a[92:95], v[240:243], v[96:99]
 ds_read_b128 a[116:119], v7 offset:46080
 v_mul_f32 v64, v5, v64
M v[100:103], a[92:95], v[244:247], v[36:39]
 buffer_load_dwordx4 v3, s[8:11], s38 offen offset:2048 sc1 lds
M v[100:103], a[88:91], v[228:231], v[100:103]
 ds_read_b128 a[120:123], v7 offset:47104
 v_mul_f32 v65, v5, v65
M v[100:103], a[84:87], v[212:215], v[100:103]
 ds_read_b128 a[124:127], v7 offset:48128
 v_mul_f32 v66, v5, v66
M v[100:103], a[80:83], v[196:199], v[100:103]
 buffer_load_dwordx4 v3, s[8:11], s38 offen offset:3072 sc1 lds
M v[100:103], a[76:79], v[180:183], v[100:103]
 s_add_u32 m0, s28, 102400
 v_mul_f32 v67, v5, v67
 v_mul_f32 v72, v5, v72
M v[100:103], a[72:75], v[164:167], v[100:103]
 buffer_load_dwordx4 v4, s[8:11], s38 offen offset:0 sc1 lds
M v[100:103], a[68:71], v[148:151], v[100:103]
 v_mul_f32 v73, v5, v73
 v_mul_f32 v74, v5, v74
M v[100:103], a[64:67], v[132:135], v[100:103]
 s_waitcnt lgkmcnt(0)
 v_mul_f32 v75, v5, v75
 v_cvt_pk_bf16_f32 v64, v64, v65
M v[108:111], a[96:99], v[132:135], v[36:39]
 ds_read_b128 a[64:67], v7 offset:49152
 v_cvt_pk_bf16_f32 v65, v66, v67
M v[108:111], a[100:103], v[148:151], v[108:111]
 ds_read_b128 a[68:71], v7 offset:50176
 v_cvt_pk_bf16_f32 v66, v72, v73
M v[108:111], a[104:107], v[164:167], v[108:111]
 buffer_load_dwordx4 v4, s[8:11], s38 offen offset:1024 sc1 lds
M v[108:111], a[108:111], v[180:183], v[108:111]
 ds_read_b128 a[72:75], v7 offset:51200
 v_cvt_pk_bf16_f32 v67, v74, v75
M v[108:111], a[112:115], v[196:199], v[108:111]
 ds_read_b128 a[76:79], v7 offset:52224
M v[108:111], a[116:119], v[212:215], v[108:111]
 buffer_load_dwordx4 v4, s[8:11], s38 offen offset:2048 sc1 lds
M v[108:111], a[120:123], v[228:231], v[108:111]
 ds_read_b128 a[80:83], v7 offset:53248
M v[108:111], a[124:127], v[244:247], v[108:111]
 ds_read_b128 a[84:87], v7 offset:54272
M v[104:107], a[124:127], v[240:243], v[32:35]
 buffer_load_dwordx4 v4, s[8:11], s38 offen offset:3072 sc1 lds
M v[104:107], a[120:123], v[224:227], v[104:107]
 s_add_u32 s38, s38, 65536
 ds_read_b128 a[88:91], v7 offset:55296
M v[104:107], a[116:119], v[208:211], v[104:107]
 ds_read_b128 a[92:95], v7 offset:56320
M v[104:107], a[112:115], v[192:195], v[104:107]
 buffer_store_dwordx4 v[64:67], v7, s[8:11], s29 offen offset:0 sc1
M v[104:107], a[108:111], v[176:179], v[104:107]
 v_mul_f32 v29, -v36, v6
 v_mul_f32 v68, v6, v68
M v[104:107], a[104:107], v[160:163], v[104:107]
 v_mul_f32 v69, v6, v69
 v_mul_f32 v70, v6, v70
M v[104:107], a[100:103], v[144:147], v[104:107]
 v_mul_f32 v71, v6, v71
 v_mul_f32 v76, v6, v76
M v[104:107], a[96:99], v[128:131], v[104:107]
 s_waitcnt lgkmcnt(0)
 v_mul_f32 v77, v6, v77
 v_mul_f32 v78, v6, v78
M v[112:115], a[64:67], v[128:131], v[32:35]
 ds_read_b128 a[96:99], v7 offset:57344
 v_mul_f32 v79, v6, v79
M v[112:115], a[68:71], v[144:147], v[112:115]
 ds_read_b128 a[100:103], v7 offset:58368
 v_cvt_pk_bf16_f32 v68, v68, v69
M v[112:115], a[72:75], v[160:163], v[112:115]
 v_cvt_pk_bf16_f32 v69, v70, v71
 v_cvt_pk_bf16_f32 v70, v76, v77
M v[112:115], a[76:79], v[176:179], v[112:115]
 ds_read_b128 a[104:107], v7 offset:59392
 v_cvt_pk_bf16_f32 v71, v78, v79
M v[112:115], a[80:83], v[192:195], v[112:115]
 ds_read_b128 a[108:111], v7 offset:60416
M v[112:115], a[84:87], v[208:211], v[112:115]
 buffer_store_dwordx4 v[68:71], v7, s[8:11], s30 offen offset:0 sc1
M v[112:115], a[88:91], v[224:227], v[112:115]
 ds_read_b128 a[112:115], v7 offset:61440
 v_mul_f32 v80, v5, v80
M v[112:115], a[92:95], v[240:243], v[112:115]
 ds_read_b128 a[116:119], v7 offset:62464
 v_mul_f32 v81, v5, v81
M v[116:119], a[92:95], v[244:247], v[36:39]
 v_mul_f32 v82, v5, v82
 v_mul_f32 v83, v5, v83
M v[116:119], a[88:91], v[228:231], v[116:119]
 ds_read_b128 a[120:123], v7 offset:63488
 v_mul_f32 v88, v5, v88
M v[116:119], a[84:87], v[212:215], v[116:119]
 ds_read_b128 a[124:127], v7 offset:64512
 v_mul_f32 v89, v5, v89
M v[116:119], a[80:83], v[196:199], v[116:119]
 v_mul_f32 v90, v5, v90
 v_mul_f32 v91, v5, v91
M v[116:119], a[76:79], v[180:183], v[116:119]
 v_cvt_pk_bf16_f32 v80, v80, v81
 v_cvt_pk_bf16_f32 v81, v82, v83
M v[116:119], a[72:75], v[164:167], v[116:119]
 v_cvt_pk_bf16_f32 v82, v88, v89
 v_cvt_pk_bf16_f32 v83, v90, v91
M v[116:119], a[68:71], v[148:151], v[116:119]
 s_waitcnt vmcnt(26) lgkmcnt(0)
M v[116:119], a[64:67], v[132:135], v[116:119]
 s_barrier
M v[124:127], a[96:99], v[132:135], v[36:39]
 ds_read_b128 a[64:67], v2 offset:0
M v[124:127], a[100:103], v[148:151], v[124:127]
 ds_read_b128 a[68:71], v2 offset:1024
M v[124:127], a[104:107], v[164:167], v[124:127]
 buffer_store_dwordx4 v[80:83], v7, s[8:11], s29 offen offset:1024 sc1
M v[124:127], a[108:111], v[180:183], v[124:127]
 ds_read_b128 a[72:75], v2 offset:2048
 v_mul_f32 v84, v6, v84
M v[124:127], a[112:115], v[196:199], v[124:127]
 ds_read_b128 a[76:79], v2 offset:3072
 v_mul_f32 v85, v6, v85
M v[124:127], a[116:119], v[212:215], v[124:127]
 v_mul_f32 v86, v6, v86
 v_mul_f32 v87, v6, v87
M v[124:127], a[120:123], v[228:231], v[124:127]
 ds_read_b128 a[80:83], v2 offset:4096
 v_mul_f32 v92, v6, v92
M v[124:127], a[124:127], v[244:247], v[124:127]
 ds_read_b128 a[84:87], v2 offset:5120
 v_mul_f32 v93, v6, v93
M v[120:123], a[124:127], v[240:243], v[32:35]
 v_mul_f32 v94, v6, v94
 v_mul_f32 v95, v6, v95
M v[120:123], a[120:123], v[224:227], v[120:123]
 ds_read_b128 a[88:91], v2 offset:6144
 v_cvt_pk_bf16_f32 v84, v84, v85
M v[120:123], a[116:119], v[208:211], v[120:123]
 ds_read_b128 a[92:95], v2 offset:7168
 v_cvt_pk_bf16_f32 v85, v86, v87
M v[120:123], a[112:115], v[192:195], v[120:123]
 v_cvt_pk_bf16_f32 v86, v92, v93
 v_cvt_pk_bf16_f32 v87, v94, v95
M v[120:123], a[108:111], v[176:179], v[120:123]
 buffer_store_dwordx4 v[84:87], v7, s[8:11], s30 offen offset:1024 sc1
M v[120:123], a[104:107], v[160:163], v[120:123]
M v[120:123], a[100:103], v[144:147], v[120:123]
 s_waitcnt lgkmcnt(0)
M v[120:123], a[96:99], v[128:131], v[120:123]
M v[64:67], a[64:67], v[128:131], v[32:35]
 s_add_u32 m0, s28, 32768
 ds_read_b128 a[96:99], v2 offset:8192
M v[64:67], a[68:71], v[144:147], v[64:67]
 ds_read_b128 a[100:103], v2 offset:9216
 s_and_b32 s79, s101, 1
M v[64:67], a[72:75], v[160:163], v[64:67]
 buffer_load_dwordx4 v3, s[8:11], s38 offen offset:0 sc1 lds
M v[64:67], a[76:79], v[176:179], v[64:67]
 ds_read_b128 a[104:107], v2 offset:10240
 s_lshl_b32 s79, s79, 13
M v[64:67], a[80:83], v[192:195], v[64:67]
 s_add_u32 s79, s79, 234946560
 ds_read_b128 a[108:111], v2 offset:11264
 s_add_u32 s29, s33, 2048
M v[64:67], a[84:87], v[208:211], v[64:67]
 buffer_load_dwordx4 v3, s[8:11], s38 offen offset:1024 sc1 lds
M v[64:67], a[88:91], v[224:227], v[64:67]
 ds_read_b128 a[112:115], v2 offset:12288
 s_add_u32 s30, s93, 2048
M v[64:67], a[92:95], v[240:243], v[64:67]
 ds_read_b128 a[116:119], v2 offset:13312
 v_fma_f32 v96, v96, v5, v28
M v[68:71], a[92:95], v[244:247], v[36:39]
 buffer_load_dwordx4 v3, s[8:11], s38 offen offset:2048 sc1 lds
M v[68:71], a[88:91], v[228:231], v[68:71]
 ds_read_b128 a[120:123], v2 offset:14336
 v_fma_f32 v97, v97, v5, v28
M v[68:71], a[84:87], v[212:215], v[68:71]
 ds_read_b128 a[124:127], v2 offset:15360
 v_fma_f32 v98, v98, v5, v28
M v[68:71], a[80:83], v[196:199], v[68:71]
 buffer_load_dwordx4 v3, s[8:11], s38 offen offset:3072 sc1 lds
M v[68:71], a[76:79], v[180:183], v[68:71]
 s_add_u32 m0, s28, 36864
 v_fma_f32 v99, v99, v5, v28
 v_fma_f32 v104, v104, v5, v28
M v[68:71], a[72:75], v[164:167], v[68:71]
 buffer_load_dwordx4 v4, s[8:11], s38 offen offset:0 sc1 lds
M v[68:71], a[68:71], v[148:151], v[68:71]
 buffer_load_dword v24, off, s[8:11], s79 sc1
M v[68:71], a[64:67], v[132:135], v[68:71]
 s_waitcnt lgkmcnt(0)
 v_lshrrev_b32 v0, 4, v7
 v_and_b32 v14, 15, v0
M v[76:79], a[96:99], v[132:135], v[36:39]
 ds_read_b128 a[64:67], v2 offset:16384
 v_lshlrev_b32 v14, 2, v14
M v[76:79], a[100:103], v[148:151], v[76:79]
 ds_read_b128 a[68:71], v2 offset:17408
 v_lshrrev_b32 v11, 4, v0
M v[76:79], a[104:107], v[164:167], v[76:79]
 buffer_load_dwordx4 v4, s[8:11], s38 offen offset:1024 sc1 lds
M v[76:79], a[108:111], v[180:183], v[76:79]
 ds_read_b128 a[72:75], v2 offset:18432
 s_mov_b32 s52, s96
M v[76:79], a[112:115], v[196:199], v[76:79]
 s_and_b32 s53, s97, 0xffff
 ds_read_b128 a[76:79], v2 offset:19456
 s_mov_b32 s54, 1835008
M v[76:79], a[116:119], v[212:215], v[76:79]
 buffer_load_dwordx4 v4, s[8:11], s38 offen offset:2048 sc1 lds
M v[76:79], a[120:123], v[228:231], v[76:79]
 ds_read_b128 a[80:83], v2 offset:20480
 s_mov_b32 s55, 0x20000
M v[76:79], a[124:127], v[244:247], v[76:79]
 s_lshr_b32 s74, s41, 3
 ds_read_b128 a[84:87], v2 offset:21504
 s_xor_b32 s74, s74, 0
M v[72:75], a[124:127], v[240:243], v[32:35]
 buffer_load_dwordx4 v4, s[8:11], s38 offen offset:3072 sc1 lds
M v[72:75], a[120:123], v[224:227], v[72:75]
 s_add_u32 s38, s38, 65536
 ds_read_b128 a[88:91], v2 offset:22528
 s_mul_i32 s67, s74, -2
M v[72:75], a[116:119], v[208:211], v[72:75]
 s_mul_i32 s74, s74, 8
 ds_read_b128 a[92:95], v2 offset:23552
 v_fma_f32 v105, v105, v5, v28
M v[72:75], a[112:115], v[192:195], v[72:75]
 s_add_u32 s74, s74, s20
 v_fma_f32 v106, v106, v5, v28
 v_fma_f32 v107, v107, v5, v28
M v[72:75], a[108:111], v[176:179], v[72:75]
 s_lshl_b32 s75, s74, 6
 v_cvt_pk_bf16_f32 v96, v96, v97
 v_cvt_pk_bf16_f32 v97, v98, v99
M v[72:75], a[104:107], v[160:163], v[72:75]
 s_add_u32 s76, s75, 256
 v_cvt_pk_bf16_f32 v98, v104, v105
 v_cvt_pk_bf16_f32 v99, v106, v107
M v[72:75], a[100:103], v[144:147], v[72:75]
 s_add_u32 s67, s67, 3
 v_add_u32 v43, 0x20000, v7
 s_sub_u32 s67, s67, s20
M v[72:75], a[96:99], v[128:131], v[72:75]
 s_waitcnt lgkmcnt(0)
 s_and_b32 s67, s67, 536870912
M v[80:83], a[64:67], v[128:131], v[32:35]
 s_or_b32 s76, s76, s67
 ds_read_b128 a[96:99], v2 offset:24576
 v_or_b32 v27, s67, v7
M v[80:83], a[68:71], v[144:147], v[80:83]
 ds_read_b128 a[100:103], v2 offset:25600
 v_add_u32 v27, 4096, v27
M v[80:83], a[72:75], v[160:163], v[80:83]
 buffer_store_dwordx4 v[96:99], v7, s[8:11], s29 offen offset:0 sc1
M v[80:83], a[76:79], v[176:179], v[80:83]
 ds_read_b128 a[104:107], v2 offset:26624
 v_fma_f32 v100, v100, v6, v29
M v[80:83], a[80:83], v[192:195], v[80:83]
 ds_read_b128 a[108:111], v2 offset:27648
 v_fma_f32 v101, v101, v6, v29
M v[80:83], a[84:87], v[208:211], v[80:83]
 v_fma_f32 v102, v102, v6, v29
 v_fma_f32 v103, v103, v6, v29
M v[80:83], a[88:91], v[224:227], v[80:83]
 ds_read_b128 a[112:115], v2 offset:28672
 v_fma_f32 v108, v108, v6, v29
M v[80:83], a[92:95], v[240:243], v[80:83]
 ds_read_b128 a[116:119], v2 offset:29696
 v_fma_f32 v109, v109, v6, v29
M v[84:87], a[92:95], v[244:247], v[36:39]
 v_fma_f32 v110, v110, v6, v29
 v_fma_f32 v111, v111, v6, v29
M v[84:87], a[88:91], v[228:231], v[84:87]
 ds_read_b128 a[120:123], v2 offset:30720
 v_cvt_pk_bf16_f32 v100, v100, v101
M v[84:87], a[84:87], v[212:215], v[84:87]
 ds_read_b128 a[124:127], v2 offset:31744
 v_cvt_pk_bf16_f32 v101, v102, v103
M v[84:87], a[80:83], v[196:199], v[84:87]
 v_cvt_pk_bf16_f32 v102, v108, v109
 v_cvt_pk_bf16_f32 v103, v110, v111
M v[84:87], a[76:79], v[180:183], v[84:87]
 buffer_store_dwordx4 v[100:103], v7, s[8:11], s30 offen offset:0 sc1
M v[84:87], a[72:75], v[164:167], v[84:87]
 v_fma_f32 v112, v112, v5, v28
 v_fma_f32 v113, v113, v5, v28
M v[84:87], a[68:71], v[148:151], v[84:87]
 s_waitcnt vmcnt(31) lgkmcnt(0)
 v_fma_f32 v114, v114, v5, v28
 v_fma_f32 v115, v115, v5, v28
M v[84:87], a[64:67], v[132:135], v[84:87]
 s_barrier
M v[92:95], a[96:99], v[132:135], v[36:39]
 ds_read_b128 a[64:67], v7 offset:0
 v_fma_f32 v120, v120, v5, v28
M v[92:95], a[100:103], v[148:151], v[92:95]
 ds_read_b128 a[68:71], v7 offset:1024
 v_fma_f32 v121, v121, v5, v28
M v[92:95], a[104:107], v[164:167], v[92:95]
 v_fma_f32 v122, v122, v5, v28
 v_fma_f32 v123, v123, v5, v28
M v[92:95], a[108:111], v[180:183], v[92:95]
 ds_read_b128 a[72:75], v7 offset:2048
 v_cvt_pk_bf16_f32 v112, v112, v113
M v[92:95], a[112:115], v[196:199], v[92:95]
 ds_read_b128 a[76:79], v7 offset:3072
 v_cvt_pk_bf16_f32 v113, v114, v115
M v[92:95], a[116:119], v[212:215], v[92:95]
 v_cvt_pk_bf16_f32 v114, v120, v121
 v_cvt_pk_bf16_f32 v115, v122, v123
M v[92:95], a[120:123], v[228:231], v[92:95]
 ds_read_b128 a[80:83], v7 offset:4096
M v[92:95], a[124:127], v[244:247], v[92:95]
 ds_read_b128 a[84:87], v7 offset:5120
M v[88:91], a[124:127], v[240:243], v[32:35]
 buffer_store_dwordx4 v[112:115], v7, s[8:11], s29 offen offset:1024 sc1
M v[88:91], a[120:123], v[224:227], v[88:91]
 ds_read_b128 a[88:91], v7 offset:6144
 v_fma_f32 v116, v116, v6, v29
M v[88:91], a[116:119], v[208:211], v[88:91]
 ds_read_b128 a[92:95], v7 offset:7168
 v_fma_f32 v117, v117, v6, v29
M v[88:91], a[112:115], v[192:195], v[88:91]
 v_fma_f32 v118, v118, v6, v29
 v_fma_f32 v119, v119, v6, v29
M v[88:91], a[108:111], v[176:179], v[88:91]
 v_fma_f32 v124, v124, v6, v29
 v_fma_f32 v125, v125, v6, v29
M v[88:91], a[104:107], v[160:163], v[88:91]
 v_fma_f32 v126, v126, v6, v29
 v_fma_f32 v127, v127, v6, v29
M v[88:91], a[100:103], v[144:147], v[88:91]
 s_waitcnt lgkmcnt(0)
 v_cvt_pk_bf16_f32 v116, v116, v117
 v_cvt_pk_bf16_f32 v117, v118, v119
M v[88:91], a[96:99], v[128:131], v[88:91]
 v_cvt_pk_bf16_f32 v118, v124, v125
 v_cvt_pk_bf16_f32 v119, v126, v127
 buffer_store_dwordx4 v[116:119], v7, s[8:11], s30 offen offset:1024 sc1
M v[96:99], a[64:67], v[128:131], v[32:35]
 ds_read_b128 a[96:99], v7 offset:8192
M v[96:99], a[68:71], v[144:147], v[96:99]
 ds_read_b128 a[100:103], v7 offset:9216
M v[96:99], a[72:75], v[160:163], v[96:99]
 s_sub_u32 s64, 15, s42
M v[96:99], a[76:79], v[176:179], v[96:99]
 s_min_u32 s64, s64, s42
 ds_read_b128 a[104:107], v7 offset:10240
 s_add_u32 s29, s33, 4096
M v[96:99], a[80:83], v[192:195], v[96:99]
 s_mul_i32 s45, s64, 33024
 ds_read_b128 a[108:111], v7 offset:11264
 s_add_u32 s30, s93, 4096
M v[96:99], a[84:87], v[208:211], v[96:99]
 s_lshl_b32 s64, s20, 6
 v_fma_f32 v64, v64, v5, v28
 v_fma_f32 v65, v65, v5, v28
M v[96:99], a[88:91], v[224:227], v[96:99]
 s_add_u32 s64, s64, s41
 ds_read_b128 a[112:115], v7 offset:12288
 v_fma_f32 v66, v66, v5, v28
M v[96:99], a[92:95], v[240:243], v[96:99]
 s_lshl2_add_u32 s45, s64, s45
 ds_read_b128 a[116:119], v7 offset:13312
 v_fma_f32 v67, v67, v5, v28
M v[100:103], a[92:95], v[244:247], v[36:39]
 s_add_u32 s45, s45, 235210752
 v_fma_f32 v72, v72, v5, v28
M v[100:103], a[88:91], v[228:231], v[100:103]
 s_movk_i32 s65, 1024
 ds_read_b128 a[120:123], v7 offset:14336
 v_fma_f32 v73, v73, v5, v28
M v[100:103], a[84:87], v[212:215], v[100:103]
 s_cmp_lt_u32 s42, 8
 ds_read_b128 a[124:127], v7 offset:15360
 v_fma_f32 v74, v74, v5, v28
M v[100:103], a[80:83], v[196:199], v[100:103]
 s_cselect_b32 s64, 16512, s65
 v_fma_f32 v75, v75, v5, v28
M v[100:103], a[76:79], v[180:183], v[100:103]
 s_cselect_b32 s65, 0, 64
 v_cvt_pk_bf16_f32 v64, v64, v65
M v[100:103], a[72:75], v[164:167], v[100:103]
 s_cselect_b32 s66, 32, 64
 v_cvt_pk_bf16_f32 v65, v66, v67
M v[100:103], a[68:71], v[148:151], v[100:103]
 s_add_u32 s3, s45, s64
 s_add_u32 s45, s45, s65
 v_lshrrev_b32 v42, 5, v7
M v[100:103], a[64:67], v[132:135], v[100:103]
 s_waitcnt lgkmcnt(0)
 v_mul_u32_u24 v42, 16512, v42
 v_and_b32 v41, 16, v7
M v[108:111], a[96:99], v[132:135], v[36:39]
 ds_read_b128 a[64:67], v7 offset:16384
 v_lshl_add_u32 v41, v41, 3, v42
M v[108:111], a[100:103], v[148:151], v[108:111]
 s_lshl_b32 s65, s20, 1
 ds_read_b128 a[68:71], v7 offset:17408
 v_cvt_pk_bf16_f32 v66, v72, v73
M v[108:111], a[104:107], v[164:167], v[108:111]
 s_lshr_b32 s65, s101, s65
 v_bfe_u32 v42, v7, 4, 1
 v_lshrrev_b32 v42, v42, s65
M v[108:111], a[108:111], v[180:183], v[108:111]
 ds_read_b128 a[72:75], v7 offset:18432
 v_and_b32 v42, 1, v42
M v[108:111], a[112:115], v[196:199], v[108:111]
 ds_read_b128 a[76:79], v7 offset:19456
 v_lshl_add_u32 v41, v42, 13, v41
M v[108:111], a[116:119], v[212:215], v[108:111]
 v_mov_b32 v42, 536870912
 v_cmp_gt_u32 vcc, s66, v7
M v[108:111], a[120:123], v[228:231], v[108:111]
 ds_read_b128 a[80:83], v7 offset:20480
 v_mov_b32 v40, 1
M v[108:111], a[124:127], v[244:247], v[108:111]
 s_nop 0
 ds_read_b128 a[84:87], v7 offset:21504
 v_cndmask_b32 v41, v42, v41, vcc
M v[104:107], a[124:127], v[240:243], v[32:35]
 v_cvt_pk_bf16_f32 v67, v74, v75
M v[104:107], a[120:123], v[224:227], v[104:107]
 ds_read_b128 a[88:91], v7 offset:22528
M v[104:107], a[116:119], v[208:211], v[104:107]
 ds_read_b128 a[92:95], v7 offset:23552
M v[104:107], a[112:115], v[192:195], v[104:107]
 buffer_store_dwordx4 v[64:67], v7, s[8:11], s29 offen offset:0 sc1
M v[104:107], a[108:111], v[176:179], v[104:107]
 v_fma_f32 v68, v68, v6, v29
 v_fma_f32 v69, v69, v6, v29
M v[104:107], a[104:107], v[160:163], v[104:107]
 v_fma_f32 v70, v70, v6, v29
 v_fma_f32 v71, v71, v6, v29
M v[104:107], a[100:103], v[144:147], v[104:107]
 v_fma_f32 v76, v76, v6, v29
 v_fma_f32 v77, v77, v6, v29
M v[104:107], a[96:99], v[128:131], v[104:107]
 s_waitcnt lgkmcnt(0)
 v_fma_f32 v78, v78, v6, v29
 v_fma_f32 v79, v79, v6, v29
M v[112:115], a[64:67], v[128:131], v[32:35]
 ds_read_b128 a[96:99], v7 offset:24576
 v_cvt_pk_bf16_f32 v68, v68, v69
M v[112:115], a[68:71], v[144:147], v[112:115]
 ds_read_b128 a[100:103], v7 offset:25600
 v_cvt_pk_bf16_f32 v69, v70, v71
M v[112:115], a[72:75], v[160:163], v[112:115]
 v_cvt_pk_bf16_f32 v70, v76, v77
 v_cvt_pk_bf16_f32 v71, v78, v79
M v[112:115], a[76:79], v[176:179], v[112:115]
 ds_read_b128 a[104:107], v7 offset:26624
M v[112:115], a[80:83], v[192:195], v[112:115]
 ds_read_b128 a[108:111], v7 offset:27648
M v[112:115], a[84:87], v[208:211], v[112:115]
 buffer_store_dwordx4 v[68:71], v7, s[8:11], s30 offen offset:0 sc1
M v[112:115], a[88:91], v[224:227], v[112:115]
 ds_read_b128 a[112:115], v7 offset:28672
 v_fma_f32 v80, v80, v5, v28
M v[112:115], a[92:95], v[240:243], v[112:115]
 ds_read_b128 a[116:119], v7 offset:29696
 v_fma_f32 v81, v81, v5, v28
M v[116:119], a[92:95], v[244:247], v[36:39]
 v_fma_f32 v82, v82, v5, v28
 v_fma_f32 v83, v83, v5, v28
M v[116:119], a[88:91], v[228:231], v[116:119]
 ds_read_b128 a[120:123], v7 offset:30720
 v_fma_f32 v88, v88, v5, v28
M v[116:119], a[84:87], v[212:215], v[116:119]
 ds_read_b128 a[124:127], v7 offset:31744
 v_fma_f32 v89, v89, v5, v28
M v[116:119], a[80:83], v[196:199], v[116:119]
 v_fma_f32 v90, v90, v5, v28
 v_fma_f32 v91, v91, v5, v28
M v[116:119], a[76:79], v[180:183], v[116:119]
 v_cvt_pk_bf16_f32 v80, v80, v81
 v_cvt_pk_bf16_f32 v81, v82, v83
M v[116:119], a[72:75], v[164:167], v[116:119]
 v_cvt_pk_bf16_f32 v82, v88, v89
 v_cvt_pk_bf16_f32 v83, v90, v91
M v[116:119], a[68:71], v[148:151], v[116:119]
 s_waitcnt vmcnt(27) lgkmcnt(0)
M v[116:119], a[64:67], v[132:135], v[116:119]
 s_barrier
M v[124:127], a[96:99], v[132:135], v[36:39]
 ds_read_b128 a[64:67], v43 offset:0
M v[124:127], a[100:103], v[148:151], v[124:127]
 ds_read_b128 a[68:71], v43 offset:1024
M v[124:127], a[104:107], v[164:167], v[124:127]
 buffer_store_dwordx4 v[80:83], v7, s[8:11], s29 offen offset:1024 sc1
M v[124:127], a[108:111], v[180:183], v[124:127]
 ds_read_b128 a[72:75], v43 offset:2048
 v_fma_f32 v84, v84, v6, v29
M v[124:127], a[112:115], v[196:199], v[124:127]
 ds_read_b128 a[76:79], v43 offset:3072
 v_fma_f32 v85, v85, v6, v29
M v[124:127], a[116:119], v[212:215], v[124:127]
 v_fma_f32 v86, v86, v6, v29
 v_fma_f32 v87, v87, v6, v29
M v[124:127], a[120:123], v[228:231], v[124:127]
 ds_read_b128 a[80:83], v43 offset:4096
 v_fma_f32 v92, v92, v6, v29
M v[124:127], a[124:127], v[244:247], v[124:127]
 ds_read_b128 a[84:87], v43 offset:5120
 v_fma_f32 v93, v93, v6, v29
M v[120:123], a[124:127], v[240:243], v[32:35]
 v_fma_f32 v94, v94, v6, v29
 v_fma_f32 v95, v95, v6, v29
M v[120:123], a[120:123], v[224:227], v[120:123]
 ds_read_b128 a[88:91], v43 offset:6144
 v_cvt_pk_bf16_f32 v84, v84, v85
M v[120:123], a[116:119], v[208:211], v[120:123]
 ds_read_b128 a[92:95], v43 offset:7168
 v_cvt_pk_bf16_f32 v85, v86, v87
M v[120:123], a[112:115], v[192:195], v[120:123]
 v_cvt_pk_bf16_f32 v86, v92, v93
 v_cvt_pk_bf16_f32 v87, v94, v95
M v[120:123], a[108:111], v[176:179], v[120:123]
 buffer_store_dwordx4 v[84:87], v7, s[8:11], s30 offen offset:1024 sc1
M v[120:123], a[104:107], v[160:163], v[120:123]
M v[120:123], a[100:103], v[144:147], v[120:123]
 s_waitcnt lgkmcnt(0)
 s_cmp_eq_u32 s42, 6
M v[120:123], a[96:99], v[128:131], v[120:123]
 s_cbranch_scc1 L_y2
L_y2r:
M v[64:67], a[64:67], v[128:131], v[32:35]
 ds_read_b128 a[96:99], v43 offset:8192
M v[64:67], a[68:71], v[144:147], v[64:67]
 ds_read_b128 a[100:103], v43 offset:9216
M v[64:67], a[72:75], v[160:163], v[64:67]
 s_waitcnt vmcnt(11)
 v_cmp_gt_u32 vcc, 1, v24
M v[64:67], a[76:79], v[176:179], v[64:67]
 s_mov_b32 s65, 234913792
 ds_read_b128 a[104:107], v43 offset:10240
 s_add_u32 s29, s33, 6144
M v[64:67], a[80:83], v[192:195], v[64:67]
 s_cbranch_vccnz L_fhs1
L_fhr1:
 ds_read_b128 a[108:111], v43 offset:11264
 s_add_u32 s30, s93, 6144
M v[64:67], a[84:87], v[208:211], v[64:67]
 buffer_load_dword v25, v14, s[8:11], s65 offen sc1
M v[64:67], a[88:91], v[224:227], v[64:67]
 ds_read_b128 a[112:115], v43 offset:12288
 v_fma_f32 v96, v96, v5, v28
M v[64:67], a[92:95], v[240:243], v[64:67]
 ds_read_b128 a[116:119], v43 offset:13312
 v_fma_f32 v97, v97, v5, v28
M v[68:71], a[92:95], v[244:247], v[36:39]
 v_fma_f32 v98, v98, v5, v28
 v_fma_f32 v99, v99, v5, v28
M v[68:71], a[88:91], v[228:231], v[68:71]
 ds_read_b128 a[120:123], v43 offset:14336
 v_fma_f32 v104, v104, v5, v28
M v[68:71], a[84:87], v[212:215], v[68:71]
 ds_read_b128 a[124:127], v43 offset:15360
 v_fma_f32 v105, v105, v5, v28
M v[68:71], a[80:83], v[196:199], v[68:71]
 v_fma_f32 v106, v106, v5, v28
 v_fma_f32 v107, v107, v5, v28
M v[68:71], a[76:79], v[180:183], v[68:71]
 v_cvt_pk_bf16_f32 v96, v96, v97
M v[68:71], a[72:75], v[164:167], v[68:71]
 v_cvt_pk_bf16_f32 v97, v98, v99
M v[68:71], a[68:71], v[148:151], v[68:71]
 v_cvt_pk_bf16_f32 v98, v104, v105
M v[68:71], a[64:67], v[132:135], v[68:71]
 s_waitcnt lgkmcnt(0)
 v_cvt_pk_bf16_f32 v99, v106, v107
M v[76:79], a[96:99], v[132:135], v[36:39]
 ds_read_b128 a[64:67], v43 offset:16384
M v[76:79], a[100:103], v[148:151], v[76:79]
 ds_read_b128 a[68:71], v43 offset:17408
M v[76:79], a[104:107], v[164:167], v[76:79]
 buffer_store_dwordx4 v[96:99], v7, s[8:11], s29 offen offset:0 sc1
M v[76:79], a[108:111], v[180:183], v[76:79]
 ds_read_b128 a[72:75], v43 offset:18432
 v_fma_f32 v100, v100, v6, v29
M v[76:79], a[112:115], v[196:199], v[76:79]
 ds_read_b128 a[76:79], v43 offset:19456
 v_fma_f32 v101, v101, v6, v29
M v[76:79], a[116:119], v[212:215], v[76:79]
 v_fma_f32 v102, v102, v6, v29
 v_fma_f32 v103, v103, v6, v29
M v[76:79], a[120:123], v[228:231], v[76:79]
 ds_read_b128 a[80:83], v43 offset:20480
 v_fma_f32 v108, v108, v6, v29
M v[76:79], a[124:127], v[244:247], v[76:79]
 ds_read_b128 a[84:87], v43 offset:21504
 v_fma_f32 v109, v109, v6, v29
M v[72:75], a[124:127], v[240:243], v[32:35]
 v_fma_f32 v110, v110, v6, v29
 v_fma_f32 v111, v111, v6, v29
M v[72:75], a[120:123], v[224:227], v[72:75]
 ds_read_b128 a[88:91], v43 offset:22528
 v_cvt_pk_bf16_f32 v100, v100, v101
M v[72:75], a[116:119], v[208:211], v[72:75]
 ds_read_b128 a[92:95], v43 offset:23552
 v_cvt_pk_bf16_f32 v101, v102, v103
M v[72:75], a[112:115], v[192:195], v[72:75]
 v_cvt_pk_bf16_f32 v102, v108, v109
M v[72:75], a[108:111], v[176:179], v[72:75]
 v_cvt_pk_bf16_f32 v103, v110, v111
M v[72:75], a[104:107], v[160:163], v[72:75]
 buffer_store_dwordx4 v[100:103], v7, s[8:11], s30 offen offset:0 sc1
M v[72:75], a[100:103], v[144:147], v[72:75]
M v[72:75], a[96:99], v[128:131], v[72:75]
 s_waitcnt lgkmcnt(0)
 v_fma_f32 v112, v112, v5, v28
M v[80:83], a[64:67], v[128:131], v[32:35]
 ds_read_b128 a[96:99], v43 offset:24576
 v_fma_f32 v113, v113, v5, v28
M v[80:83], a[68:71], v[144:147], v[80:83]
 ds_read_b128 a[100:103], v43 offset:25600
 v_fma_f32 v114, v114, v5, v28
M v[80:83], a[72:75], v[160:163], v[80:83]
 v_fma_f32 v115, v115, v5, v28
M v[80:83], a[76:79], v[176:179], v[80:83]
 ds_read_b128 a[104:107], v43 offset:26624
 v_fma_f32 v120, v120, v5, v28
M v[80:83], a[80:83], v[192:195], v[80:83]
 ds_read_b128 a[108:111], v43 offset:27648
 v_fma_f32 v121, v121, v5, v28
M v[80:83], a[84:87], v[208:211], v[80:83]
 v_fma_f32 v122, v122, v5, v28
M v[80:83], a[88:91], v[224:227], v[80:83]
 ds_read_b128 a[112:115], v43 offset:28672
 v_fma_f32 v123, v123, v5, v28
M v[80:83], a[92:95], v[240:243], v[80:83]
 ds_read_b128 a[116:119], v43 offset:29696
 v_cvt_pk_bf16_f32 v112, v112, v113
M v[84:87], a[92:95], v[244:247], v[36:39]
 v_cvt_pk_bf16_f32 v113, v114, v115
 v_cvt_pk_bf16_f32 v114, v120, v121
M v[84:87], a[88:91], v[228:231], v[84:87]
 ds_read_b128 a[120:123], v43 offset:30720
 v_cvt_pk_bf16_f32 v115, v122, v123
M v[84:87], a[84:87], v[212:215], v[84:87]
 ds_read_b128 a[124:127], v43 offset:31744
M v[84:87], a[80:83], v[196:199], v[84:87]
 buffer_store_dwordx4 v[112:115], v7, s[8:11], s29 offen offset:1024 sc1
M v[84:87], a[76:79], v[180:183], v[84:87]
 v_fma_f32 v116, v116, v6, v29
M v[84:87], a[72:75], v[164:167], v[84:87]
 v_fma_f32 v117, v117, v6, v29
M v[84:87], a[68:71], v[148:151], v[84:87]
 s_waitcnt lgkmcnt(0)
 v_fma_f32 v118, v118, v6, v29
M v[84:87], a[64:67], v[132:135], v[84:87]
 s_barrier
M v[92:95], a[96:99], v[132:135], v[36:39]
 ds_read_b128 a[64:67], v2 offset:32768
 v_fma_f32 v119, v119, v6, v29
M v[92:95], a[100:103], v[148:151], v[92:95]
 ds_read_b128 a[68:71], v2 offset:33792
 v_fma_f32 v124, v124, v6, v29
M v[92:95], a[104:107], v[164:167], v[92:95]
 v_fma_f32 v125, v125, v6, v29
 v_fma_f32 v126, v126, v6, v29
M v[92:95], a[108:111], v[180:183], v[92:95]
 ds_read_b128 a[72:75], v2 offset:34816
 v_fma_f32 v127, v127, v6, v29
M v[92:95], a[112:115], v[196:199], v[92:95]
 ds_read_b128 a[76:79], v2 offset:35840
 v_cvt_pk_bf16_f32 v116, v116, v117
M v[92:95], a[116:119], v[212:215], v[92:95]
 v_cvt_pk_bf16_f32 v117, v118, v119
M v[92:95], a[120:123], v[228:231], v[92:95]
 ds_read_b128 a[80:83], v2 offset:36864
 v_cvt_pk_bf16_f32 v118, v124, v125
M v[92:95], a[124:127], v[244:247], v[92:95]
 ds_read_b128 a[84:87], v2 offset:37888
 v_cvt_pk_bf16_f32 v119, v126, v127
M v[88:91], a[124:127], v[240:243], v[32:35]
 buffer_store_dwordx4 v[116:119], v7, s[8:11], s30 offen offset:1024 sc1
M v[88:91], a[120:123], v[224:227], v[88:91]
 ds_read_b128 a[88:91], v2 offset:38912
M v[88:91], a[116:119], v[208:211], v[88:91]
 ds_read_b128 a[92:95], v2 offset:39936
M v[88:91], a[112:115], v[192:195], v[88:91]
M v[88:91], a[108:111], v[176:179], v[88:91]
M v[88:91], a[104:107], v[160:163], v[88:91]
M v[88:91], a[100:103], v[144:147], v[88:91]
 s_waitcnt lgkmcnt(0)
M v[88:91], a[96:99], v[128:131], v[88:91]
M v[96:99], a[64:67], v[128:131], v[32:35]
 ds_read_b128 a[96:99], v2 offset:40960
M v[96:99], a[68:71], v[144:147], v[96:99]
 ds_read_b128 a[100:103], v2 offset:41984
M v[96:99], a[72:75], v[160:163], v[96:99]
M v[96:99], a[76:79], v[176:179], v[96:99]
 ds_read_b128 a[104:107], v2 offset:43008
 s_add_u32 s29, s33, 16384
M v[96:99], a[80:83], v[192:195], v[96:99]
 ds_read_b128 a[108:111], v2 offset:44032
 s_add_u32 s30, s93, 16384
M v[96:99], a[84:87], v[208:211], v[96:99]
 v_fma_f32 v64, v64, v5, v28
 v_fma_f32 v65, v65, v5, v28
M v[96:99], a[88:91], v[224:227], v[96:99]
 ds_read_b128 a[112:115], v2 offset:45056
 v_fma_f32 v66, v66, v5, v28
M v[96:99], a[92:95], v[240:243], v[96:99]
 ds_read_b128 a[116:119], v2 offset:46080
 v_fma_f32 v67, v67, v5, v28
M v[100:103], a[92:95], v[244:247], v[36:39]
 v_fma_f32 v72, v72, v5, v28
M v[100:103], a[88:91], v[228:231], v[100:103]
 ds_read_b128 a[120:123], v2 offset:47104
 v_fma_f32 v73, v73, v5, v28
M v[100:103], a[84:87], v[212:215], v[100:103]
 ds_read_b128 a[124:127], v2 offset:48128
 v_fma_f32 v74, v74, v5, v28
M v[100:103], a[80:83], v[196:199], v[100:103]
 v_fma_f32 v75, v75, v5, v28
M v[100:103], a[76:79], v[180:183], v[100:103]
 v_cvt_pk_bf16_f32 v64, v64, v65
M v[100:103], a[72:75], v[164:167], v[100:103]
 v_cvt_pk_bf16_f32 v65, v66, v67
M v[100:103], a[68:71], v[148:151], v[100:103]
 v_cvt_pk_bf16_f32 v66, v72, v73
M v[100:103], a[64:67], v[132:135], v[100:103]
 s_waitcnt lgkmcnt(0)
 v_cvt_pk_bf16_f32 v67, v74, v75
M v[108:111], a[96:99], v[132:135], v[36:39]
 ds_read_b128 a[64:67], v2 offset:49152
M v[108:111], a[100:103], v[148:151], v[108:111]
 ds_read_b128 a[68:71], v2 offset:50176
M v[108:111], a[104:107], v[164:167], v[108:111]
 buffer_store_dwordx4 v[64:67], v7, s[8:11], s29 offen offset:0 sc1
M v[108:111], a[108:111], v[180:183], v[108:111]
 ds_read_b128 a[72:75], v2 offset:51200
 v_fma_f32 v68, v68, v6, v29
M v[108:111], a[112:115], v[196:199], v[108:111]
 ds_read_b128 a[76:79], v2 offset:52224
 v_fma_f32 v69, v69, v6, v29
M v[108:111], a[116:119], v[212:215], v[108:111]
 v_fma_f32 v70, v70, v6, v29
 v_fma_f32 v71, v71, v6, v29
M v[108:111], a[120:123], v[228:231], v[108:111]
 ds_read_b128 a[80:83], v2 offset:53248
 v_fma_f32 v76, v76, v6, v29
M v[108:111], a[124:127], v[244:247], v[108:111]
 ds_read_b128 a[84:87], v2 offset:54272
 v_fma_f32 v77, v77, v6, v29
M v[104:107], a[124:127], v[240:243], v[32:35]
 v_fma_f32 v78, v78, v6, v29
 v_fma_f32 v79, v79, v6, v29
M v[104:107], a[120:123], v[224:227], v[104:107]
 ds_read_b128 a[88:91], v2 offset:55296
 v_cvt_pk_bf16_f32 v68, v68, v69
M v[104:107], a[116:119], v[208:211], v[104:107]
 ds_read_b128 a[92:95], v2 offset:56320
 v_cvt_pk_bf16_f32 v69, v70, v71
M v[104:107], a[112:115], v[192:195], v[104:107]
 v_cvt_pk_bf16_f32 v70, v76, v77
M v[104:107], a[108:111], v[176:179], v[104:107]
 v_cvt_pk_bf16_f32 v71, v78, v79
M v[104:107], a[104:107], v[160:163], v[104:107]
 buffer_store_dwordx4 v[68:71], v7, s[8:11], s30 offen offset:0 sc1
M v[104:107], a[100:103], v[144:147], v[104:107]
M v[104:107], a[96:99], v[128:131], v[104:107]
 s_waitcnt lgkmcnt(0)
 v_fma_f32 v80, v80, v5, v28
M v[112:115], a[64:67], v[128:131], v[32:35]
 ds_read_b128 a[96:99], v2 offset:57344
 v_fma_f32 v81, v81, v5, v28
M v[112:115], a[68:71], v[144:147], v[112:115]
 ds_read_b128 a[100:103], v2 offset:58368
 v_fma_f32 v82, v82, v5, v28
M v[112:115], a[72:75], v[160:163], v[112:115]
 v_fma_f32 v83, v83, v5, v28
M v[112:115], a[76:79], v[176:179], v[112:115]
 ds_read_b128 a[104:107], v2 offset:59392
 v_fma_f32 v88, v88, v5, v28
M v[112:115], a[80:83], v[192:195], v[112:115]
 ds_read_b128 a[108:111], v2 offset:60416
 v_fma_f32 v89, v89, v5, v28
M v[112:115], a[84:87], v[208:211], v[112:115]
 v_fma_f32 v90, v90, v5, v28
M v[112:115], a[88:91], v[224:227], v[112:115]
 ds_read_b128 a[112:115], v2 offset:61440
 v_fma_f32 v91, v91, v5, v28
M v[112:115], a[92:95], v[240:243], v[112:115]
 ds_read_b128 a[116:119], v2 offset:62464
 v_cvt_pk_bf16_f32 v80, v80, v81
M v[116:119], a[92:95], v[244:247], v[36:39]
 s_waitcnt vmcnt(6)
 v_readlane_b32 s84, v25, 0
 v_readlane_b32 s85, v25, 1
M v[116:119], a[88:91], v[228:231], v[116:119]
 ds_read_b128 a[120:123], v2 offset:63488
 v_mov_b32 v24, 0x3f80
M v[116:119], a[84:87], v[212:215], v[116:119]
 ds_read_b128 a[124:127], v2 offset:64512
 v_mov_b32 v25, 0x3f800000
M v[116:119], a[80:83], v[196:199], v[116:119]
 v_cvt_pk_bf16_f32 v81, v82, v83
 v_cvt_pk_bf16_f32 v82, v88, v89
M v[116:119], a[76:79], v[180:183], v[116:119]
 v_cvt_pk_bf16_f32 v83, v90, v91
M v[116:119], a[72:75], v[164:167], v[116:119]
 buffer_store_dwordx4 v[80:83], v7, s[8:11], s29 offen offset:1024 sc1
M v[116:119], a[68:71], v[148:151], v[116:119]
 s_waitcnt lgkmcnt(0)
 v_fma_f32 v84, v84, v6, v29
 v_fma_f32 v85, v85, v6, v29
M v[116:119], a[64:67], v[132:135], v[116:119]
 s_barrier
M v[124:127], a[96:99], v[132:135], v[36:39]
 ds_read_b128 a[64:67], v7 offset:32768
 v_fma_f32 v86, v86, v6, v29
M v[124:127], a[100:103], v[148:151], v[124:127]
 ds_read_b128 a[68:71], v7 offset:33792
 v_fma_f32 v87, v87, v6, v29
M v[124:127], a[104:107], v[164:167], v[124:127]
 v_fma_f32 v92, v92, v6, v29
 v_fma_f32 v93, v93, v6, v29
M v[124:127], a[108:111], v[180:183], v[124:127]
 ds_read_b128 a[72:75], v7 offset:34816
 v_fma_f32 v94, v94, v6, v29
M v[124:127], a[112:115], v[196:199], v[124:127]
 ds_read_b128 a[76:79], v7 offset:35840
 v_fma_f32 v95, v95, v6, v29
M v[124:127], a[116:119], v[212:215], v[124:127]
 s_waitcnt vmcnt(3)
 v_cvt_pk_bf16_f32 v84, v84, v85
 v_cvt_pk_bf16_f32 v85, v86, v87
M v[124:127], a[120:123], v[228:231], v[124:127]
 ds_read_b128 a[80:83], v7 offset:36864
 v_cvt_pk_bf16_f32 v86, v92, v93
M v[124:127], a[124:127], v[244:247], v[124:127]
 ds_read_b128 a[84:87], v7 offset:37888
 v_cvt_pk_bf16_f32 v87, v94, v95
M v[120:123], a[124:127], v[240:243], v[32:35]
 buffer_store_dword v40, v41, s[8:11], s45 offen sc1
M v[120:123], a[120:123], v[224:227], v[120:123]
 ds_read_b128 a[88:91], v7 offset:38912
M v[120:123], a[116:119], v[208:211], v[120:123]
 ds_read_b128 a[92:95], v7 offset:39936
M v[120:123], a[112:115], v[192:195], v[120:123]
 buffer_store_dwordx4 v[84:87], v7, s[8:11], s30 offen offset:1024 sc1
M v[120:123], a[108:111], v[176:179], v[120:123]
M v[120:123], a[104:107], v[160:163], v[120:123]
M v[120:123], a[100:103], v[144:147], v[120:123]
 s_waitcnt lgkmcnt(0)
 s_cmp_eq_u32 s42, 6
M v[120:123], a[96:99], v[128:131], v[120:123]
 s_cbranch_scc1 L_y3
L_y3r:
M v[64:67], a[64:67], v[128:131], v[32:35]
 ds_read_b128 a[96:99], v7 offset:40960
M v[64:67], a[68:71], v[144:147], v[64:67]
 ds_read_b128 a[100:103], v7 offset:41984
M v[64:67], a[72:75], v[160:163], v[64:67]
M v[64:67], a[76:79], v[176:179], v[64:67]
 ds_read_b128 a[104:107], v7 offset:43008
 s_add_u32 s29, s33, 18432
M v[64:67], a[80:83], v[192:195], v[64:67]
 ds_read_b128 a[108:111], v7 offset:44032
 s_add_u32 s30, s93, 18432
M v[64:67], a[84:87], v[208:211], v[64:67]
 v_fma_f32 v96, v96, v5, v28
 v_fma_f32 v97, v97, v5, v28
M v[64:67], a[88:91], v[224:227], v[64:67]
 ds_read_b128 a[112:115], v7 offset:45056
 v_fma_f32 v98, v98, v5, v28
M v[64:67], a[92:95], v[240:243], v[64:67]
 ds_read_b128 a[116:119], v7 offset:46080
 v_fma_f32 v99, v99, v5, v28
M v[68:71], a[92:95], v[244:247], v[36:39]
 v_fma_f32 v104, v104, v5, v28
 v_fma_f32 v105, v105, v5, v28
M v[68:71], a[88:91], v[228:231], v[68:71]
 ds_read_b128 a[120:123], v7 offset:47104
 v_fma_f32 v106, v106, v5, v28
M v[68:71], a[84:87], v[212:215], v[68:71]
 ds_read_b128 a[124:127], v7 offset:48128
 v_fma_f32 v107, v107, v5, v28
M v[68:71], a[80:83], v[196:199], v[68:71]
 v_cvt_pk_bf16_f32 v96, v96, v97
 v_cvt_pk_bf16_f32 v97, v98, v99
M v[68:71], a[76:79], v[180:183], v[68:71]
 v_cvt_pk_bf16_f32 v98, v104, v105
 v_cvt_pk_bf16_f32 v99, v106, v107
M v[68:71], a[72:75], v[164:167], v[68:71]
 buffer_store_dwordx4 v[96:99], v7, s[8:11], s29 offen offset:0 sc1
M v[68:71], a[68:71], v[148:151], v[68:71]
 v_fma_f32 v100, v100, v6, v29
 v_fma_f32 v101, v101, v6, v29
M v[68:71], a[64:67], v[132:135], v[68:71]
 s_waitcnt lgkmcnt(0)
 v_fma_f32 v102, v102, v6, v29
 v_fma_f32 v103, v103, v6, v29
M v[72:75], a[96:99], v[128:131], v[32:35]
 ds_read_b128 a[64:67], v7 offset:49152
 v_fma_f32 v108, v108, v6, v29
M v[72:75], a[100:103], v[144:147], v[72:75]
 ds_read_b128 a[68:71], v7 offset:50176
 v_fma_f32 v109, v109, v6, v29
M v[72:75], a[104:107], v[160:163], v[72:75]
 v_fma_f32 v110, v110, v6, v29
 v_fma_f32 v111, v111, v6, v29
M v[72:75], a[108:111], v[176:179], v[72:75]
 ds_read_b128 a[72:75], v7 offset:51200
 v_cvt_pk_bf16_f32 v100, v100, v101
M v[72:75], a[112:115], v[192:195], v[72:75]
 ds_read_b128 a[76:79], v7 offset:52224
 v_cvt_pk_bf16_f32 v101, v102, v103
M v[72:75], a[116:119], v[208:211], v[72:75]
 v_cvt_pk_bf16_f32 v102, v108, v109
 v_cvt_pk_bf16_f32 v103, v110, v111
M v[72:75], a[120:123], v[224:227], v[72:75]
 ds_read_b128 a[80:83], v7 offset:53248
M v[72:75], a[124:127], v[240:243], v[72:75]
 ds_read_b128 a[84:87], v7 offset:54272
M v[76:79], a[124:127], v[244:247], v[36:39]
 buffer_store_dwordx4 v[100:103], v7, s[8:11], s30 offen offset:0 sc1
M v[76:79], a[120:123], v[228:231], v[76:79]
 ds_read_b128 a[88:91], v7 offset:55296
 v_fma_f32 v112, v112, v5, v28
M v[76:79], a[116:119], v[212:215], v[76:79]
 ds_read_b128 a[92:95], v7 offset:56320
 v_fma_f32 v113, v113, v5, v28
M v[76:79], a[112:115], v[196:199], v[76:79]
 v_fma_f32 v114, v114, v5, v28
 v_fma_f32 v115, v115, v5, v28
M v[76:79], a[108:111], v[180:183], v[76:79]
 v_fma_f32 v120, v120, v5, v28
 v_fma_f32 v121, v121, v5, v28
M v[76:79], a[104:107], v[164:167], v[76:79]
 v_fma_f32 v122, v122, v5, v28
 v_fma_f32 v123, v123, v5, v28
M v[76:79], a[100:103], v[148:151], v[76:79]
 v_cvt_pk_bf16_f32 v112, v112, v113
 v_cvt_pk_bf16_f32 v113, v114, v115
M v[76:79], a[96:99], v[132:135], v[76:79]
 s_waitcnt lgkmcnt(0)
 v_cvt_pk_bf16_f32 v114, v120, v121
 v_cvt_pk_bf16_f32 v115, v122, v123
M v[80:83], a[64:67], v[128:131], v[32:35]
 ds_read_b128 a[96:99], v7 offset:57344
M v[80:83], a[68:71], v[144:147], v[80:83]
 ds_read_b128 a[100:103], v7 offset:58368
M v[80:83], a[72:75], v[160:163], v[80:83]
 buffer_store_dwordx4 v[112:115], v7, s[8:11], s29 offen offset:1024 sc1
M v[80:83], a[76:79], v[176:179], v[80:83]
 ds_read_b128 a[104:107], v7 offset:59392
 v_fma_f32 v116, v116, v6, v29
M v[80:83], a[80:83], v[192:195], v[80:83]
 ds_read_b128 a[108:111], v7 offset:60416
 v_fma_f32 v117, v117, v6, v29
M v[80:83], a[84:87], v[208:211], v[80:83]
 v_fma_f32 v118, v118, v6, v29
 v_fma_f32 v119, v119, v6, v29
M v[80:83], a[88:91], v[224:227], v[80:83]
 ds_read_b128 a[112:115], v7 offset:61440
 v_fma_f32 v124, v124, v6, v29
M v[80:83], a[92:95], v[240:243], v[80:83]
 ds_read_b128 a[116:119], v7 offset:62464
 v_fma_f32 v125, v125, v6, v29
M v[84:87], a[92:95], v[244:247], v[36:39]
 v_fma_f32 v126, v126, v6, v29
 v_fma_f32 v127, v127, v6, v29
M v[84:87], a[88:91], v[228:231], v[84:87]
 ds_read_b128 a[120:123], v7 offset:63488
 v_cvt_pk_bf16_f32 v116, v116, v117
M v[84:87], a[84:87], v[212:215], v[84:87]
 ds_read_b128 a[124:127], v7 offset:64512
 v_cvt_pk_bf16_f32 v117, v118, v119
M v[84:87], a[80:83], v[196:199], v[84:87]
 v_cvt_pk_bf16_f32 v118, v124, v125
 v_cvt_pk_bf16_f32 v119, v126, v127
M v[84:87], a[76:79], v[180:183], v[84:87]
 buffer_store_dwordx4 v[116:119], v7, s[8:11], s30 offen offset:1024 sc1
M v[84:87], a[72:75], v[164:167], v[84:87]
 s_add_u32 s29, s33, 20480
M v[84:87], a[68:71], v[148:151], v[84:87]
 s_add_u32 s30, s93, 20480
 v_fma_f32 v64, v64, v5, v28
 v_fma_f32 v65, v65, v5, v28
M v[84:87], a[64:67], v[132:135], v[84:87]
 s_waitcnt lgkmcnt(0)
 v_fma_f32 v66, v66, v5, v28
 v_fma_f32 v67, v67, v5, v28
M v[88:91], a[96:99], v[128:131], v[32:35]
 v_fma_f32 v72, v72, v5, v28
 v_fma_f32 v73, v73, v5, v28
M v[88:91], a[100:103], v[144:147], v[88:91]
 v_fma_f32 v74, v74, v5, v28
 v_fma_f32 v75, v75, v5, v28
M v[88:91], a[104:107], v[160:163], v[88:91]
 v_cvt_pk_bf16_f32 v64, v64, v65
 v_cvt_pk_bf16_f32 v65, v66, v67
M v[88:91], a[108:111], v[176:179], v[88:91]
 v_cvt_pk_bf16_f32 v66, v72, v73
 v_cvt_pk_bf16_f32 v67, v74, v75
M v[88:91], a[112:115], v[192:195], v[88:91]
 buffer_store_dwordx4 v[64:67], v7, s[8:11], s29 offen offset:0 sc1
M v[88:91], a[116:119], v[208:211], v[88:91]
 v_fma_f32 v68, v68, v6, v29
 v_fma_f32 v69, v69, v6, v29
M v[88:91], a[120:123], v[224:227], v[88:91]
 v_fma_f32 v70, v70, v6, v29
 v_fma_f32 v71, v71, v6, v29
M v[88:91], a[124:127], v[240:243], v[88:91]
 v_fma_f32 v76, v76, v6, v29
 v_fma_f32 v77, v77, v6, v29
M v[92:95], a[124:127], v[244:247], v[36:39]
 v_fma_f32 v78, v78, v6, v29
 v_fma_f32 v79, v79, v6, v29
M v[92:95], a[120:123], v[228:231], v[92:95]
 v_cvt_pk_bf16_f32 v68, v68, v69
 v_cvt_pk_bf16_f32 v69, v70, v71
M v[92:95], a[116:119], v[212:215], v[92:95]
 v_cvt_pk_bf16_f32 v70, v76, v77
 v_cvt_pk_bf16_f32 v71, v78, v79
M v[92:95], a[112:115], v[196:199], v[92:95]
 buffer_store_dwordx4 v[68:71], v7, s[8:11], s30 offen offset:0 sc1
M v[92:95], a[108:111], v[180:183], v[92:95]
M v[92:95], a[104:107], v[164:167], v[92:95]
M v[92:95], a[100:103], v[148:151], v[92:95]
M v[92:95], a[96:99], v[132:135], v[92:95]
 v_fma_f32 v80, v80, v5, v28
 v_fma_f32 v81, v81, v5, v28
 v_fma_f32 v82, v82, v5, v28
 v_fma_f32 v83, v83, v5, v28
 v_fma_f32 v88, v88, v5, v28
 v_fma_f32 v89, v89, v5, v28
 v_fma_f32 v90, v90, v5, v28
 v_fma_f32 v91, v91, v5, v28
 v_cvt_pk_bf16_f32 v80, v80, v81
 v_cvt_pk_bf16_f32 v81, v82, v83
 v_cvt_pk_bf16_f32 v82, v88, v89
 v_cvt_pk_bf16_f32 v83, v90, v91
 buffer_store_dwordx4 v[80:83], v7, s[8:11], s29 offen offset:1024 sc1
 v_fma_f32 v84, v84, v6, v29
 v_fma_f32 v85, v85, v6, v29
 v_fma_f32 v86, v86, v6, v29
 v_fma_f32 v87, v87, v6, v29
 v_fma_f32 v92, v92, v6, v29
 v_fma_f32 v93, v93, v6, v29
 v_fma_f32 v94, v94, v6, v29
 v_fma_f32 v95, v95, v6, v29
 v_cvt_pk_bf16_f32 v84, v84, v85
 v_cvt_pk_bf16_f32 v85, v86, v87
 v_cvt_pk_bf16_f32 v86, v92, v93
 v_cvt_pk_bf16_f32 v87, v94, v95
 buffer_store_dwordx4 v[84:87], v7, s[8:11], s30 offen offset:1024 sc1
 s_cmp_lt_u32 s42, 8
 s_cbranch_scc1 L_red
 s_cmp_eq_u32 s20, 3
 s_cbranch_scc1 L_vend3
 s_sub_u32 s64, 15, s42
 s_lshl_b32 s64, s64, 1
 s_lshr_b32 s65, s41, 3
 s_add_u32 s46, s64, s65
 s_mul_i32 s46, s46, 16512
 s_and_b32 s72, s41, 7
 s_lshl_b32 s66, s72, 7
 s_add_u32 s46, s46, s66
 s_add_u32 s46, s46, 235211776
 s_and_b32 s66, s41, 7
 s_lshr_b32 s66, s101, s66
 s_and_b32 s66, s66, 1
 s_lshl_b32 s66, s66, 13
 s_add_u32 s46, s46, s66
 v_and_b32 v14, 15, v0
 v_lshlrev_b32 v14, 2, v14
 buffer_load_dword v9, v14, s[8:11], s46 offen sc1
 s_mul_i32 s86, s65, 3
 s_add_u32 s86, s86, s20
 s_add_u32 s86, s86, 8
 s_mul_i32 s77, s42, 4194304
 s_mul_i32 s78, s72, 32768
 s_add_u32 s77, s77, s78
 s_add_u32 s77, s77, 67108864
 s_lshr_b32 s78, s101, s72
 s_and_b32 s78, s78, 1
 s_lshl_b32 s78, s78, 13
 s_add_u32 s77, s77, s78
 s_lshl_b32 s78, s86, 10
 s_add_u32 s77, s77, s78
 s_add_u32 s77, s77, 8192
 s_lshl_b32 s86, s86, 6
 s_lshr_b32 s73, s72, 1
 s_sub_u32 s65, 7, s73
 s_bitcmp1_b32 s72, 0
 s_cselect_b32 s73, s65, s73
 s_lshl_b32 s73, s73, 4
 s_lshl_b32 s65, s42, 7
 s_add_u32 s73, s73, s65
 v_and_b32 v10, 15, v0
 v_add_u32 v10, s73, v10
 s_mov_b32 s64, 234881088
 v_mul_u32_u24 v12, 896, v10
 v_lshl_add_u32 v12, v11, 4, v12
 v_lshrrev_b32 v13, 4, v10
 v_lshlrev_b32 v13, 5, v13
 v_and_b32 v104, 15, v10
 v_add_lshl_u32 v13, v13, v104, 2
 buffer_load_dword v15, v13, s[8:11], s64 offen sc1
 buffer_load_dwordx4 v[16:19], v12, s[56:59], s86 offen
 v_mov_b32 v48, 0
 v_mov_b32 v49, 0
 v_mov_b32 v50, 0
 v_mov_b32 v51, 0
 v_mov_b32 v52, 0
 v_mov_b32 v53, 0
 v_mov_b32 v54, 0
 v_mov_b32 v55, 0
 s_waitcnt vmcnt(3)
 buffer_store_dword v40, v41, s[8:11], s3 offen sc1
 s_waitcnt vmcnt(3)
 v_cmp_eq_u32 vcc, 1, v9
 s_mov_b32 s91, 65536
 s_mov_b32 s69, 0
 s_and_b32 s70, vcc_lo, 0xffff
 s_or_b32 s68, s70, 0xffff0000
 s_cmp_lg_u32 s70, 0
 s_cbranch_scc1 L_vk0
 s_call_b64 s[36:37], L_rpoll
L_vk0:
 s_ff1_i32_b32 s71, s70
 s_bitset0_b32 s70, s71
 s_and_b32 s72, s71, 8
 s_lshl_b32 s72, s72, 10
 s_xor_b32 s72, s72, s77
 s_mul_i32 s71, s71, 262144
 s_add_u32 s12, s71, s72
 buffer_load_dwordx4 v[128:131], v7, s[8:11], s12 offen sc1
 s_cmp_lg_u32 s70, 0
 s_cbranch_scc1 L_vk1
 s_call_b64 s[36:37], L_rpoll
L_vk1:
 s_ff1_i32_b32 s71, s70
 s_bitset0_b32 s70, s71
 s_and_b32 s72, s71, 8
 s_lshl_b32 s72, s72, 10
 s_xor_b32 s72, s72, s77
 s_mul_i32 s71, s71, 262144
 s_add_u32 s13, s71, s72
 buffer_load_dwordx4 v[132:135], v7, s[8:11], s13 offen sc1
 s_waitcnt vmcnt(3)
 v_lshlrev_b32 v32, 16, v16
 v_and_b32 v33, 0xffff0000, v16
 v_lshlrev_b32 v34, 16, v17
 v_and_b32 v35, 0xffff0000, v17
 v_lshlrev_b32 v36, 16, v18
 v_and_b32 v37, 0xffff0000, v18
 v_lshlrev_b32 v38, 16, v19
 v_and_b32 v39, 0xffff0000, v19
 v_sub_f32 v13, 1.0, v15
 v_cmp_eq_u32 s[80:81], s84, v10
 v_cmp_eq_u32 s[82:83], s85, v10
 s_nop 0
 s_or_b64 vcc, s[80:81], s[82:83]
 s_cbranch_vccnz L_moe2
L_moe_ret2:
 v_mul_f32 v32, v13, v32
 v_mul_f32 v33, v13, v33
 v_mul_f32 v34, v13, v34
 v_mul_f32 v35, v13, v35
 v_mul_f32 v36, v13, v36
 v_mul_f32 v37, v13, v37
 v_mul_f32 v38, v13, v38
 v_mul_f32 v39, v13, v39
 s_cmp_lg_u32 s70, 0
 s_cbranch_scc1 L_vk2
 s_call_b64 s[36:37], L_rpoll
L_vk2:
 s_ff1_i32_b32 s71, s70
 s_bitset0_b32 s70, s71
 s_and_b32 s72, s71, 8
 s_lshl_b32 s72, s72, 10
 s_xor_b32 s72, s72, s77
 s_mul_i32 s71, s71, 262144
 s_add_u32 s14, s71, s72
 buffer_load_dwordx4 v[136:139], v7, s[8:11], s14 offen sc1
 s_cmp_lg_u32 s70, 0
 s_cbranch_scc1 L_vk3
 s_call_b64 s[36:37], L_rpoll
L_vk3:
 s_ff1_i32_b32 s71, s70
 s_bitset0_b32 s70, s71
 s_and_b32 s72, s71, 8
 s_lshl_b32 s72, s72, 10
 s_xor_b32 s72, s72, s77
 s_mul_i32 s71, s71, 262144
 s_add_u32 s15, s71, s72
 buffer_load_dwordx4 v[140:143], v7, s[8:11], s15 offen sc1
 s_cmp_lg_u32 s70, 0
 s_cbranch_scc1 L_vk4
 s_call_b64 s[36:37], L_rpoll
L_vk4:
 s_ff1_i32_b32 s71, s70
 s_bitset0_b32 s70, s71
 s_and_b32 s72, s71, 8
 s_lshl_b32 s72, s72, 10
 s_xor_b32 s72, s72, s77
 s_mul_i32 s71, s71, 262144
 s_add_u32 s16, s71, s72
 buffer_load_dwordx4 v[144:147], v7, s[8:11], s16 offen sc1
 s_cmp_lg_u32 s70, 0
 s_cbranch_scc1 L_vk5
 s_call_b64 s[36:37], L_rpoll
L_vk5:
 s_ff1_i32_b32 s71, s70
 s_bitset0_b32 s70, s71
 s_and_b32 s72, s71, 8
 s_lshl_b32 s72, s72, 10
 s_xor_b32 s72, s72, s77
 s_mul_i32 s71, s71, 262144
 s_add_u32 s17, s71, s72
 buffer_load_dwordx4 v[148:151], v7, s[8:11], s17 offen sc1
 s_cmp_lg_u32 s70, 0
 s_cbranch_scc1 L_vk6
 s_call_b64 s[36:37], L_rpoll
L_vk6:
 s_ff1_i32_b32 s71, s70
 s_bitset0_b32 s70, s71
 s_and_b32 s72, s71, 8
 s_lshl_b32 s72, s72, 10
 s_xor_b32 s72, s72, s77
 s_mul_i32 s71, s71, 262144
 s_add_u32 s18, s71, s72
 buffer_load_dwordx4 v[152:155], v7, s[8:11], s18 offen sc1
 s_cmp_lg_u32 s70, 0
 s_cbranch_scc1 L_vk7
 s_call_b64 s[36:37], L_rpoll
L_vk7:
 s_ff1_i32_b32 s71, s70
 s_bitset0_b32 s70, s71
 s_and_b32 s72, s71, 8
 s_lshl_b32 s72, s72, 10
 s_xor_b32 s72, s72, s77
 s_mul_i32 s71, s71, 262144
 s_add_u32 s19, s71, s72
 buffer_load_dwordx4 v[156:159], v7, s[8:11], s19 offen sc1
 s_cmp_lg_u32 s70, 0
 s_cbranch_scc1 L_vk8
 s_call_b64 s[36:37], L_rpoll
L_vk8:
 s_ff1_i32_b32 s71, s70
 s_bitset0_b32 s70, s71
 s_and_b32 s72, s71, 8
 s_lshl_b32 s72, s72, 10
 s_xor_b32 s72, s72, s77
 s_mul_i32 s71, s71, 262144
 s_add_u32 s21, s71, s72
 buffer_load_dwordx4 v[160:163], v7, s[8:11], s21 offen sc1
 s_cmp_lg_u32 s70, 0
 s_cbranch_scc1 L_vk9
 s_call_b64 s[36:37], L_rpoll
L_vk9:
 s_ff1_i32_b32 s71, s70
 s_bitset0_b32 s70, s71
 s_and_b32 s72, s71, 8
 s_lshl_b32 s72, s72, 10
 s_xor_b32 s72, s72, s77
 s_mul_i32 s71, s71, 262144
 s_add_u32 s22, s71, s72
 buffer_load_dwordx4 v[164:167], v7, s[8:11], s22 offen sc1
 s_cmp_lg_u32 s70, 0
 s_cbranch_scc1 L_vk10
 s_call_b64 s[36:37], L_rpoll
L_vk10:
 s_ff1_i32_b32 s71, s70
 s_bitset0_b32 s70, s71
 s_and_b32 s72, s71, 8
 s_lshl_b32 s72, s72, 10
 s_xor_b32 s72, s72, s77
 s_mul_i32 s71, s71, 262144
 s_add_u32 s23, s71, s72
 buffer_load_dwordx4 v[168:171], v7, s[8:11], s23 offen sc1
 s_cmp_lg_u32 s70, 0
 s_cbranch_scc1 L_vk11
 s_call_b64 s[36:37], L_rpoll
L_vk11:
 s_ff1_i32_b32 s71, s70
 s_bitset0_b32 s70, s71
 s_and_b32 s72, s71, 8
 s_lshl_b32 s72, s72, 10
 s_xor_b32 s72, s72, s77
 s_mul_i32 s71, s71, 262144
 s_add_u32 s24, s71, s72
 buffer_load_dwordx4 v[172:175], v7, s[8:11], s24 offen sc1
 s_cmp_lg_u32 s70, 0
 s_cbranch_scc1 L_vk12
 s_call_b64 s[36:37], L_rpoll
L_vk12:
 s_ff1_i32_b32 s71, s70
 s_bitset0_b32 s70, s71
 s_and_b32 s72, s71, 8
 s_lshl_b32 s72, s72, 10
 s_xor_b32 s72, s72, s77
 s_mul_i32 s71, s71, 262144
 s_add_u32 s48, s71, s72
 buffer_load_dwordx4 v[176:179], v7, s[8:11], s48 offen sc1
 s_cmp_lg_u32 s70, 0
 s_cbranch_scc1 L_vk13
 s_call_b64 s[36:37], L_rpoll
L_vk13:
 s_ff1_i32_b32 s71, s70
 s_bitset0_b32 s70, s71
 s_and_b32 s72, s71, 8
 s_lshl_b32 s72, s72, 10
 s_xor_b32 s72, s72, s77
 s_mul_i32 s71, s71, 262144
 s_add_u32 s49, s71, s72
 buffer_load_dwordx4 v[180:183], v7, s[8:11], s49 offen sc1
 s_cmp_lg_u32 s70, 0
 s_cbranch_scc1 L_vk14
 s_call_b64 s[36:37], L_rpoll
L_vk14:
 s_ff1_i32_b32 s71, s70
 s_bitset0_b32 s70, s71
 s_and_b32 s72, s71, 8
 s_lshl_b32 s72, s72, 10
 s_xor_b32 s72, s72, s77
 s_mul_i32 s71, s71, 262144
 s_add_u32 s50, s71, s72
 buffer_load_dwordx4 v[184:187], v7, s[8:11], s50 offen sc1
 s_cmp_lg_u32 s70, 0
 s_cbranch_scc1 L_vk15
 s_call_b64 s[36:37], L_rpoll
L_vk15:
 s_ff1_i32_b32 s71, s70
 s_bitset0_b32 s70, s71
 s_and_b32 s72, s71, 8
 s_lshl_b32 s72, s72, 10
 s_xor_b32 s72, s72, s77
 s_mul_i32 s71, s71, 262144
 s_add_u32 s51, s71, s72
 buffer_load_dwordx4 v[188:191], v7, s[8:11], s51 offen sc1
 s_waitcnt vmcnt(15)
 v_dot2c_f32_bf16 v48, v128, v24
 v_dot2c_f32_bf16 v49, v128, v25
 v_dot2c_f32_bf16 v50, v129, v24
 v_dot2c_f32_bf16 v51, v129, v25
 v_dot2c_f32_bf16 v52, v130, v24
 v_dot2c_f32_bf16 v53, v130, v25
 v_dot2c_f32_bf16 v54, v131, v24
 v_dot2c_f32_bf16 v55, v131, v25
 s_waitcnt vmcnt(14)
 v_dot2c_f32_bf16 v48, v132, v24
 v_dot2c_f32_bf16 v49, v132, v25
 v_dot2c_f32_bf16 v50, v133, v24
 v_dot2c_f32_bf16 v51, v133, v25
 v_dot2c_f32_bf16 v52, v134, v24
 v_dot2c_f32_bf16 v53, v134, v25
 v_dot2c_f32_bf16 v54, v135, v24
 v_dot2c_f32_bf16 v55, v135, v25
 s_waitcnt vmcnt(13)
 v_dot2c_f32_bf16 v48, v136, v24
 v_dot2c_f32_bf16 v49, v136, v25
 v_dot2c_f32_bf16 v50, v137, v24
 v_dot2c_f32_bf16 v51, v137, v25
 v_dot2c_f32_bf16 v52, v138, v24
 v_dot2c_f32_bf16 v53, v138, v25
 v_dot2c_f32_bf16 v54, v139, v24
 v_dot2c_f32_bf16 v55, v139, v25
 s_waitcnt vmcnt(12)
 v_dot2c_f32_bf16 v48, v140, v24
 v_dot2c_f32_bf16 v49, v140, v25
 v_dot2c_f32_bf16 v50, v141, v24
 v_dot2c_f32_bf16 v51, v141, v25
 v_dot2c_f32_bf16 v52, v142, v24
 v_dot2c_f32_bf16 v53, v142, v25
 v_dot2c_f32_bf16 v54, v143, v24
 v_dot2c_f32_bf16 v55, v143, v25
 s_waitcnt vmcnt(11)
 v_dot2c_f32_bf16 v48, v144, v24
 v_dot2c_f32_bf16 v49, v144, v25
 v_dot2c_f32_bf16 v50, v145, v24
 v_dot2c_f32_bf16 v51, v145, v25
 v_dot2c_f32_bf16 v52, v146, v24
 v_dot2c_f32_bf16 v53, v146, v25
 v_dot2c_f32_bf16 v54, v147, v24
 v_dot2c_f32_bf16 v55, v147, v25
 s_waitcnt vmcnt(10)
 v_dot2c_f32_bf16 v48, v148, v24
 v_dot2c_f32_bf16 v49, v148, v25
 v_dot2c_f32_bf16 v50, v149, v24
 v_dot2c_f32_bf16 v51, v149, v25
 v_dot2c_f32_bf16 v52, v150, v24
 v_dot2c_f32_bf16 v53, v150, v25
 v_dot2c_f32_bf16 v54, v151, v24
 v_dot2c_f32_bf16 v55, v151, v25
 s_waitcnt vmcnt(9)
 v_dot2c_f32_bf16 v48, v152, v24
 v_dot2c_f32_bf16 v49, v152, v25
 v_dot2c_f32_bf16 v50, v153, v24
 v_dot2c_f32_bf16 v51, v153, v25
 v_dot2c_f32_bf16 v52, v154, v24
 v_dot2c_f32_bf16 v53, v154, v25
 v_dot2c_f32_bf16 v54, v155, v24
 v_dot2c_f32_bf16 v55, v155, v25
 s_waitcnt vmcnt(8)
 v_dot2c_f32_bf16 v48, v156, v24
 v_dot2c_f32_bf16 v49, v156, v25
 v_dot2c_f32_bf16 v50, v157, v24
 v_dot2c_f32_bf16 v51, v157, v25
 v_dot2c_f32_bf16 v52, v158, v24
 v_dot2c_f32_bf16 v53, v158, v25
 v_dot2c_f32_bf16 v54, v159, v24
 v_dot2c_f32_bf16 v55, v159, v25
 s_waitcnt vmcnt(7)
 v_dot2c_f32_bf16 v48, v160, v24
 v_dot2c_f32_bf16 v49, v160, v25
 v_dot2c_f32_bf16 v50, v161, v24
 v_dot2c_f32_bf16 v51, v161, v25
 v_dot2c_f32_bf16 v52, v162, v24
 v_dot2c_f32_bf16 v53, v162, v25
 v_dot2c_f32_bf16 v54, v163, v24
 v_dot2c_f32_bf16 v55, v163, v25
 s_waitcnt vmcnt(6)
 v_dot2c_f32_bf16 v48, v164, v24
 v_dot2c_f32_bf16 v49, v164, v25
 v_dot2c_f32_bf16 v50, v165, v24
 v_dot2c_f32_bf16 v51, v165, v25
 v_dot2c_f32_bf16 v52, v166, v24
 v_dot2c_f32_bf16 v53, v166, v25
 v_dot2c_f32_bf16 v54, v167, v24
 v_dot2c_f32_bf16 v55, v167, v25
 s_waitcnt vmcnt(5)
 v_dot2c_f32_bf16 v48, v168, v24
 v_dot2c_f32_bf16 v49, v168, v25
 v_dot2c_f32_bf16 v50, v169, v24
 v_dot2c_f32_bf16 v51, v169, v25
 v_dot2c_f32_bf16 v52, v170, v24
 v_dot2c_f32_bf16 v53, v170, v25
 v_dot2c_f32_bf16 v54, v171, v24
 v_dot2c_f32_bf16 v55, v171, v25
 s_waitcnt vmcnt(4)
 v_dot2c_f32_bf16 v48, v172, v24
 v_dot2c_f32_bf16 v49, v172, v25
 v_dot2c_f32_bf16 v50, v173, v24
 v_dot2c_f32_bf16 v51, v173, v25
 v_dot2c_f32_bf16 v52, v174, v24
 v_dot2c_f32_bf16 v53, v174, v25
 v_dot2c_f32_bf16 v54, v175, v24
 v_dot2c_f32_bf16 v55, v175, v25
 s_waitcnt vmcnt(3)
 v_dot2c_f32_bf16 v48, v176, v24
 v_dot2c_f32_bf16 v49, v176, v25
 v_dot2c_f32_bf16 v50, v177, v24
 v_dot2c_f32_bf16 v51, v177, v25
 v_dot2c_f32_bf16 v52, v178, v24
 v_dot2c_f32_bf16 v53, v178, v25
 v_dot2c_f32_bf16 v54, v179, v24
 v_dot2c_f32_bf16 v55, v179, v25
 s_waitcnt vmcnt(2)
 v_dot2c_f32_bf16 v48, v180, v24
 v_dot2c_f32_bf16 v49, v180, v25
 v_dot2c_f32_bf16 v50, v181, v24
 v_dot2c_f32_bf16 v51, v181, v25
 v_dot2c_f32_bf16 v52, v182, v24
 v_dot2c_f32_bf16 v53, v182, v25
 v_dot2c_f32_bf16 v54, v183, v24
 v_dot2c_f32_bf16 v55, v183, v25
 s_waitcnt vmcnt(1)
 v_dot2c_f32_bf16 v48, v184, v24
 v_dot2c_f32_bf16 v49, v184, v25
 v_dot2c_f32_bf16 v50, v185, v24
 v_dot2c_f32_bf16 v51, v185, v25
 v_dot2c_f32_bf16 v52, v186, v24
 v_dot2c_f32_bf16 v53, v186, v25
 v_dot2c_f32_bf16 v54, v187, v24
 v_dot2c_f32_bf16 v55, v187, v25
 s_waitcnt vmcnt(0)
 v_dot2c_f32_bf16 v48, v188, v24
 v_dot2c_f32_bf16 v49, v188, v25
 v_dot2c_f32_bf16 v50, v189, v24
 v_dot2c_f32_bf16 v51, v189, v25
 v_dot2c_f32_bf16 v52, v190, v24
 v_dot2c_f32_bf16 v53, v190, v25
 v_dot2c_f32_bf16 v54, v191, v24
 v_dot2c_f32_bf16 v55, v191, v25
 s_nop 1
 v_fmac_f32 v32, v15, v48
 v_fmac_f32 v33, v15, v49
 v_fmac_f32 v34, v15, v50
 v_fmac_f32 v35, v15, v51
 v_fmac_f32 v36, v15, v52
 v_fmac_f32 v37, v15, v53
 v_fmac_f32 v38, v15, v54
 v_fmac_f32 v39, v15, v55
 v_cvt_pk_bf16_f32 v16, v32, v33
 v_cvt_pk_bf16_f32 v17, v34, v35
 v_cvt_pk_bf16_f32 v18, v36, v37
 v_cvt_pk_bf16_f32 v19, v38, v39
 buffer_store_dwordx4 v[16:19], v12, s[52:55], s86 offen sc1
L_vend:
 s_endpgm
L_vend3:
 s_waitcnt vmcnt(0)
 buffer_store_dword v40, v41, s[8:11], s3 offen sc1
 s_branch L_vend
 s_waitcnt vmcnt(0)
L_p1n:
 v_cndmask_b32 v64, v32, v8, s[64:65]
 v_cndmask_b32 v65, v32, v8, s[66:67]
 v_cndmask_b32 v66, v32, v8, s[68:69]
 v_cndmask_b32 v67, v32, v8, s[70:71]
 s_nop 1
M v[64:67], a[64:67], a[0:3], v[64:67]
 s_add_u32 m0, s28, 65536
 ds_read_b128 a[96:99], v2 offset:40960
 v_cndmask_b32 v72, v32, v8, s[72:73]
M v[64:67], a[68:71], a[4:7], v[64:67]
 ds_read_b128 a[100:103], v2 offset:41984
 v_cndmask_b32 v73, v32, v8, s[74:75]
M v[64:67], a[72:75], a[8:11], v[64:67]
 buffer_load_dwordx4 v3, s[8:11], s24 offen offset:0 sc1 lds
M v[64:67], a[76:79], a[12:15], v[64:67]
 ds_read_b128 a[104:107], v2 offset:43008
 v_cndmask_b32 v74, v32, v8, s[76:77]
M v[64:67], a[80:83], a[16:19], v[64:67]
 ds_read_b128 a[108:111], v2 offset:44032
 v_cndmask_b32 v75, v32, v8, s[78:79]
M v[64:67], a[84:87], a[20:23], v[64:67]
 v_exp_f32 v18, v112
M v[64:67], a[88:91], a[24:27], v[64:67]
 ds_read_b128 a[112:115], v2 offset:45056
M v[64:67], a[92:95], a[28:31], v[64:67]
 ds_read_b128 a[116:119], v2 offset:46080
M v[68:71], a[92:95], a[60:63], v[36:39]
 buffer_load_dwordx4 v3, s[8:11], s24 offen offset:1024 sc1 lds
M v[68:71], a[88:91], a[56:59], v[68:71]
 ds_read_b128 a[120:123], v2 offset:47104
M v[68:71], a[84:87], a[52:55], v[68:71]
 ds_read_b128 a[124:127], v2 offset:48128
M v[68:71], a[80:83], a[48:51], v[68:71]
 v_exp_f32 v19, v113
M v[68:71], a[76:79], a[44:47], v[68:71]
 buffer_load_dwordx4 v3, s[8:11], s24 offen offset:2048 sc1 lds
M v[68:71], a[72:75], a[40:43], v[68:71]
 v_exp_f32 v20, v114
M v[68:71], a[68:71], a[36:39], v[68:71]
 v_exp_f32 v21, v115
M v[68:71], a[64:67], a[32:35], v[68:71]
 s_waitcnt lgkmcnt(0)
 v_exp_f32 v22, v120
M v[72:75], a[96:99], a[0:3], v[72:75]
 ds_read_b128 a[64:67], v2 offset:49152
 v_cndmask_b32 v80, v32, v8, s[80:81]
M v[72:75], a[100:103], a[4:7], v[72:75]
 ds_read_b128 a[68:71], v2 offset:50176
 v_cndmask_b32 v81, v32, v8, s[82:83]
M v[72:75], a[104:107], a[8:11], v[72:75]
 buffer_load_dwordx4 v3, s[8:11], s24 offen offset:3072 sc1 lds
M v[72:75], a[108:111], a[12:15], v[72:75]
 ds_read_b128 a[72:75], v2 offset:51200
 v_cndmask_b32 v82, v32, v8, s[84:85]
M v[72:75], a[112:115], a[16:19], v[72:75]
 ds_read_b128 a[76:79], v2 offset:52224
 v_cndmask_b32 v83, v32, v8, s[86:87]
M v[72:75], a[116:119], a[20:23], v[72:75]
 v_exp_f32 v23, v121
M v[72:75], a[120:123], a[24:27], v[72:75]
 s_add_u32 m0, s28, 69632
 ds_read_b128 a[80:83], v2 offset:53248
 v_add_f32 v28, v18, v28
M v[72:75], a[124:127], a[28:31], v[72:75]
 ds_read_b128 a[84:87], v2 offset:54272
 v_cvt_pk_bf16_f32 v56, v18, v19
M v[76:79], a[124:127], a[60:63], v[36:39]
 buffer_load_dwordx4 v4, s[8:11], s24 offen offset:0 sc1 lds
M v[76:79], a[120:123], a[56:59], v[76:79]
 ds_read_b128 a[88:91], v2 offset:55296
 v_add_f32 v28, v19, v28
M v[76:79], a[116:119], a[52:55], v[76:79]
 ds_read_b128 a[92:95], v2 offset:56320
 v_add_f32 v28, v20, v28
M v[76:79], a[112:115], a[48:51], v[76:79]
 v_exp_f32 v24, v122
M v[76:79], a[108:111], a[44:47], v[76:79]
 buffer_load_dwordx4 v4, s[8:11], s24 offen offset:1024 sc1 lds
M v[76:79], a[104:107], a[40:43], v[76:79]
 v_exp_f32 v25, v123
M v[76:79], a[100:103], a[36:39], v[76:79]
 v_exp_f32 v18, v116
M v[76:79], a[96:99], a[32:35], v[76:79]
 s_waitcnt lgkmcnt(0)
 v_exp_f32 v19, v117
M v[80:83], a[64:67], a[0:3], v[80:83]
 ds_read_b128 a[96:99], v2 offset:57344
 v_cndmask_b32 v88, v32, v8, s[88:89]
M v[80:83], a[68:71], a[4:7], v[80:83]
 ds_read_b128 a[100:103], v2 offset:58368
 v_cndmask_b32 v89, v32, v8, s[90:91]
M v[80:83], a[72:75], a[8:11], v[80:83]
 buffer_load_dwordx4 v4, s[8:11], s24 offen offset:2048 sc1 lds
M v[80:83], a[76:79], a[12:15], v[80:83]
 ds_read_b128 a[104:107], v2 offset:59392
 v_cndmask_b32 v90, v32, v8, s[92:93]
M v[80:83], a[80:83], a[16:19], v[80:83]
 ds_read_b128 a[108:111], v2 offset:60416
 v_cndmask_b32 v91, v32, v8, s[94:95]
M v[80:83], a[84:87], a[20:23], v[80:83]
 v_cvt_pk_bf16_f32 v57, v20, v21
 v_add_f32 v28, v21, v28
M v[80:83], a[88:91], a[24:27], v[80:83]
 ds_read_b128 a[112:115], v2 offset:61440
 v_add_f32 v28, v22, v28
M v[80:83], a[92:95], a[28:31], v[80:83]
 ds_read_b128 a[116:119], v2 offset:62464
 v_cvt_pk_bf16_f32 v58, v22, v23
M v[84:87], a[92:95], a[60:63], v[36:39]
 buffer_load_dwordx4 v4, s[8:11], s24 offen offset:3072 sc1 lds
M v[84:87], a[88:91], a[56:59], v[84:87]
 ds_read_b128 a[120:123], v2 offset:63488
 v_add_f32 v28, v23, v28
M v[84:87], a[84:87], a[52:55], v[84:87]
 ds_read_b128 a[124:127], v2 offset:64512
 v_add_f32 v28, v24, v28
M v[84:87], a[80:83], a[48:51], v[84:87]
 v_exp_f32 v20, v118
M v[84:87], a[76:79], a[44:47], v[84:87]
 v_exp_f32 v21, v119
M v[84:87], a[72:75], a[40:43], v[84:87]
 v_exp_f32 v22, v124
M v[84:87], a[68:71], a[36:39], v[84:87]
 s_waitcnt vmcnt(16) lgkmcnt(0)
 v_exp_f32 v23, v125
M v[84:87], a[64:67], a[32:35], v[84:87]
 s_barrier
M v[88:91], a[96:99], a[0:3], v[88:91]
 ds_read_b128 a[64:67], v7 offset:0
 v_cvt_pk_bf16_f32 v59, v24, v25
M v[88:91], a[100:103], a[4:7], v[88:91]
 ds_read_b128 a[68:71], v7 offset:1024
 v_add_f32 v28, v25, v28
M v[88:91], a[104:107], a[8:11], v[88:91]
 v_exp_f32 v24, v126
M v[88:91], a[108:111], a[12:15], v[88:91]
 ds_read_b128 a[72:75], v7 offset:2048
 v_add_f32 v29, v18, v29
M v[88:91], a[112:115], a[16:19], v[88:91]
 ds_read_b128 a[76:79], v7 offset:3072
 v_cvt_pk_bf16_f32 v60, v18, v19
M v[88:91], a[116:119], a[20:23], v[88:91]
 v_exp_f32 v25, v127
M v[88:91], a[120:123], a[24:27], v[88:91]
 ds_read_b128 a[80:83], v7 offset:4096
 v_add_f32 v29, v19, v29
M v[88:91], a[124:127], a[28:31], v[88:91]
 ds_read_b128 a[84:87], v7 offset:5120
 v_add_f32 v29, v20, v29
M v[92:95], a[124:127], a[60:63], v[36:39]
 v_cvt_pk_bf16_f32 v61, v20, v21
 v_add_f32 v29, v21, v29
M v[92:95], a[120:123], a[56:59], v[92:95]
 ds_read_b128 a[88:91], v7 offset:6144
 v_add_f32 v29, v22, v29
M v[92:95], a[116:119], a[52:55], v[92:95]
 ds_read_b128 a[92:95], v7 offset:7168
 v_cvt_pk_bf16_f32 v62, v22, v23
M v[92:95], a[112:115], a[48:51], v[92:95]
 v_add_f32 v29, v23, v29
 v_add_f32 v29, v24, v29
M v[92:95], a[108:111], a[44:47], v[92:95]
 v_cvt_pk_bf16_f32 v63, v24, v25
 v_add_f32 v29, v25, v29
M v[92:95], a[104:107], a[40:43], v[92:95]
M v[92:95], a[100:103], a[36:39], v[92:95]
 s_waitcnt lgkmcnt(0)
M v[92:95], a[96:99], a[32:35], v[92:95]
 v_max_f32 v10, v28, v29
 v_cmp_lt_f32 vcc, s31, v10
 s_nop 0
 s_cbranch_vccnz L_st5
L_rt5:
M v[128:131], a[64:67], v[48:51], v[128:131]
 s_add_u32 m0, s28, 98304
 ds_read_b128 a[96:99], v7 offset:8192
 v_add_f32 v30, v28, v30
M v[128:131], a[68:71], v[56:59], v[128:131]
 ds_read_b128 a[100:103], v7 offset:9216
 v_add_f32 v31, v29, v31
M v[132:135], a[68:71], v[60:63], v[132:135]
 buffer_load_dwordx4 v3, s[8:11], s21 offen offset:0 sc1 lds
M v[132:135], a[64:67], v[52:55], v[132:135]
 s_cmp_eq_u32 s20, 3
 ds_read_b128 a[104:107], v7 offset:10240
M v[140:143], a[72:75], v[52:55], v[140:143]
 s_cselect_b64 s[64:65], s[16:17], 0
 ds_read_b128 a[108:111], v7 offset:11264
M v[140:143], a[76:79], v[60:63], v[140:143]
 buffer_load_dwordx4 v3, s[8:11], s21 offen offset:1024 sc1 lds
M v[136:139], a[76:79], v[56:59], v[136:139]
 s_cselect_b64 s[66:67], s[18:19], 0
 ds_read_b128 a[112:115], v7 offset:12288
M v[136:139], a[72:75], v[48:51], v[136:139]
 s_cselect_b64 s[68:69], s[48:49], 0
 ds_read_b128 a[116:119], v7 offset:13312
M v[144:147], a[80:83], v[48:51], v[144:147]
 s_cselect_b64 s[70:71], s[50:51], 0
 v_exp_f32 v18, v64
M v[144:147], a[84:87], v[56:59], v[144:147]
 s_cmp_gt_u32 s20, 2
 ds_read_b128 a[120:123], v7 offset:14336
M v[148:151], a[84:87], v[60:63], v[148:151]
 s_cselect_b64 s[78:79], -1, 0
 ds_read_b128 a[124:127], v7 offset:15360
M v[148:151], a[80:83], v[52:55], v[148:151]
 buffer_load_dwordx4 v3, s[8:11], s21 offen offset:2048 sc1 lds
M v[156:159], a[88:91], v[52:55], v[156:159]
 v_exp_f32 v19, v65
M v[156:159], a[92:95], v[60:63], v[156:159]
 v_exp_f32 v20, v66
M v[152:155], a[92:95], v[56:59], v[152:155]
 buffer_load_dwordx4 v3, s[8:11], s21 offen offset:3072 sc1 lds
M v[152:155], a[88:91], v[48:51], v[152:155]
 s_waitcnt lgkmcnt(0)
 v_exp_f32 v21, v67
M v[160:163], a[96:99], v[48:51], v[160:163]
 ds_read_b128 a[64:67], v7 offset:16384
 v_add_f32 v26, v18, v19
M v[160:163], a[100:103], v[56:59], v[160:163]
 s_add_u32 m0, s28, 102400
 ds_read_b128 a[68:71], v7 offset:17408
 v_cvt_pk_bf16_f32 v40, v18, v19
M v[164:167], a[100:103], v[60:63], v[164:167]
 buffer_load_dwordx4 v4, s[8:11], s21 offen offset:0 sc1 lds
M v[164:167], a[96:99], v[52:55], v[164:167]
 s_cmp_eq_u32 s20, 2
 ds_read_b128 a[72:75], v7 offset:18432
 v_add_f32 v26, v20, v26
M v[172:175], a[104:107], v[52:55], v[172:175]
 s_cselect_b64 s[72:73], s[16:17], s[78:79]
 ds_read_b128 a[76:79], v7 offset:19456
 v_cvt_pk_bf16_f32 v41, v20, v21
M v[172:175], a[108:111], v[60:63], v[172:175]
 s_cselect_b64 s[74:75], s[18:19], s[78:79]
 v_exp_f32 v22, v72
M v[168:171], a[108:111], v[56:59], v[168:171]
 s_cselect_b64 s[76:77], s[48:49], s[78:79]
 ds_read_b128 a[80:83], v7 offset:20480
 v_add_f32 v26, v21, v26
M v[168:171], a[104:107], v[48:51], v[168:171]
 s_cselect_b64 s[78:79], s[50:51], s[78:79]
 ds_read_b128 a[84:87], v7 offset:21504
M v[176:179], a[112:115], v[48:51], v[176:179]
 buffer_load_dwordx4 v4, s[8:11], s21 offen offset:1024 sc1 lds
M v[176:179], a[116:119], v[56:59], v[176:179]
 s_cmp_gt_u32 s20, 1
 ds_read_b128 a[88:91], v7 offset:22528
M v[180:183], a[116:119], v[60:63], v[180:183]
 s_cselect_b64 s[86:87], -1, 0
 ds_read_b128 a[92:95], v7 offset:23552
M v[180:183], a[112:115], v[52:55], v[180:183]
 buffer_load_dwordx4 v4, s[8:11], s21 offen offset:2048 sc1 lds
M v[188:191], a[120:123], v[52:55], v[188:191]
 s_cmp_eq_u32 s20, 1
 v_exp_f32 v23, v73
M v[188:191], a[124:127], v[60:63], v[188:191]
 s_cselect_b64 s[80:81], s[16:17], s[86:87]
 v_exp_f32 v24, v74
M v[184:187], a[124:127], v[56:59], v[184:187]
 s_cselect_b64 s[82:83], s[18:19], s[86:87]
 v_exp_f32 v25, v75
M v[184:187], a[120:123], v[48:51], v[184:187]
 s_waitcnt lgkmcnt(0)
 v_exp_f32 v18, v68
M v[192:195], a[64:67], v[48:51], v[192:195]
 s_cselect_b64 s[84:85], s[48:49], s[86:87]
 ds_read_b128 a[96:99], v7 offset:24576
 v_add_f32 v26, v22, v26
M v[192:195], a[68:71], v[56:59], v[192:195]
 s_cselect_b64 s[86:87], s[50:51], s[86:87]
 ds_read_b128 a[100:103], v7 offset:25600
 v_cvt_pk_bf16_f32 v42, v22, v23
M v[196:199], a[68:71], v[60:63], v[196:199]
 buffer_load_dwordx4 v4, s[8:11], s21 offen offset:3072 sc1 lds
M v[196:199], a[64:67], v[52:55], v[196:199]
 s_add_u32 s24, s23, 33554432
 ds_read_b128 a[104:107], v7 offset:26624
 v_add_f32 v26, v23, v26
M v[204:207], a[72:75], v[52:55], v[204:207]
 s_mov_b32 s23, s21
 ds_read_b128 a[108:111], v7 offset:27648
 v_add_f32 v26, v24, v26
M v[204:207], a[76:79], v[60:63], v[204:207]
 s_add_u32 s21, s21, 65536
 v_exp_f32 v19, v69
M v[200:203], a[76:79], v[56:59], v[200:203]
 s_add_u32 s22, s22, 1
 ds_read_b128 a[112:115], v7 offset:28672
 v_cvt_pk_bf16_f32 v43, v24, v25
M v[200:203], a[72:75], v[48:51], v[200:203]
 s_cmp_eq_u32 s22, s25
 ds_read_b128 a[116:119], v7 offset:29696
 v_add_f32 v26, v25, v26
M v[208:211], a[80:83], v[48:51], v[208:211]
 s_cselect_b32 s21, s26, s21
 v_exp_f32 v20, v70
M v[208:211], a[84:87], v[56:59], v[208:211]
 s_cmp_eq_u32 s22, s43
 ds_read_b128 a[120:123], v7 offset:30720
 v_add_f32 v27, v18, v19
M v[212:215], a[84:87], v[60:63], v[212:215]
 s_cselect_b32 s21, s4, s21
 ds_read_b128 a[124:127], v7 offset:31744
 v_cvt_pk_bf16_f32 v44, v18, v19
M v[212:215], a[80:83], v[52:55], v[212:215]
 s_cmp_eq_u32 s22, s6
 v_exp_f32 v21, v71
M v[220:223], a[88:91], v[52:55], v[220:223]
 s_cselect_b32 s21, s7, s21
 v_exp_f32 v22, v76
M v[220:223], a[92:95], v[60:63], v[220:223]
 s_cmp_eq_u32 s20, 0
 v_exp_f32 v23, v77
M v[216:219], a[92:95], v[56:59], v[216:219]
 s_waitcnt vmcnt(16) lgkmcnt(0)
 v_exp_f32 v24, v78
M v[216:219], a[88:91], v[48:51], v[216:219]
 s_barrier
M v[224:227], a[96:99], v[48:51], v[224:227]
 s_cselect_b64 s[88:89], s[16:17], -1
 ds_read_b128 a[64:67], v7 offset:32768
 v_add_f32 v27, v20, v27
M v[224:227], a[100:103], v[56:59], v[224:227]
 s_cselect_b64 s[90:91], s[18:19], -1
 ds_read_b128 a[68:71], v7 offset:33792
 v_cvt_pk_bf16_f32 v45, v20, v21
M v[228:231], a[100:103], v[60:63], v[228:231]
 buffer_load_dword v5, off, s[8:11], s47 sc1
M v[228:231], a[96:99], v[52:55], v[228:231]
 s_cselect_b64 s[92:93], s[48:49], -1
 ds_read_b128 a[72:75], v7 offset:34816
 v_add_f32 v27, v21, v27
M v[236:239], a[104:107], v[52:55], v[236:239]
 s_cselect_b64 s[94:95], s[50:51], -1
 ds_read_b128 a[76:79], v7 offset:35840
 v_add_f32 v27, v22, v27
M v[236:239], a[108:111], v[60:63], v[236:239]
 v_cndmask_b32 v100, v36, v8, s[64:65]
 v_cndmask_b32 v101, v36, v8, s[66:67]
M v[232:235], a[108:111], v[56:59], v[232:235]
 ds_read_b128 a[80:83], v7 offset:36864
 v_cndmask_b32 v102, v36, v8, s[68:69]
M v[232:235], a[104:107], v[48:51], v[232:235]
 ds_read_b128 a[84:87], v7 offset:37888
 v_cndmask_b32 v103, v36, v8, s[70:71]
M v[240:243], a[112:115], v[48:51], v[240:243]
 v_cndmask_b32 v108, v36, v8, s[72:73]
 v_cndmask_b32 v109, v36, v8, s[74:75]
M v[240:243], a[116:119], v[56:59], v[240:243]
 ds_read_b128 a[88:91], v7 offset:38912
 v_cndmask_b32 v110, v36, v8, s[76:77]
M v[244:247], a[116:119], v[60:63], v[244:247]
 ds_read_b128 a[92:95], v7 offset:39936
 v_cndmask_b32 v111, v36, v8, s[78:79]
M v[244:247], a[112:115], v[52:55], v[244:247]
 v_cndmask_b32 v116, v36, v8, s[80:81]
 v_cndmask_b32 v117, v36, v8, s[82:83]
M v[252:255], a[120:123], v[52:55], v[252:255]
 v_cndmask_b32 v118, v36, v8, s[84:85]
 v_cndmask_b32 v119, v36, v8, s[86:87]
M v[252:255], a[124:127], v[60:63], v[252:255]
 v_cndmask_b32 v124, v36, v8, s[88:89]
 v_cndmask_b32 v125, v36, v8, s[90:91]
M v[248:251], a[124:127], v[56:59], v[248:251]
 s_waitcnt lgkmcnt(0)
 v_cndmask_b32 v126, v36, v8, s[92:93]
 v_cndmask_b32 v127, v36, v8, s[94:95]
M v[248:251], a[120:123], v[48:51], v[248:251]
 v_exp_f32 v25, v79
 v_cvt_pk_bf16_f32 v46, v22, v23
 v_add_f32 v27, v23, v27
 v_add_f32 v27, v24, v27
 v_cvt_pk_bf16_f32 v47, v24, v25
 v_add_f32 v27, v25, v27
L_p2:
M v[100:103], a[64:67], a[32:35], v[100:103]
 ds_read_b128 a[96:99], v7 offset:40960
 ds_read_b128 a[100:103], v7 offset:41984
 v_exp_f32 v18, v80
M v[100:103], a[68:71], a[36:39], v[100:103]
 ds_read_b128 a[104:107], v7 offset:43008
 v_exp_f32 v19, v81
M v[100:103], a[72:75], a[40:43], v[100:103]
 ds_read_b128 a[108:111], v7 offset:44032
 ds_read_b128 a[112:115], v7 offset:45056
 v_exp_f32 v20, v82
 v_add_f32 v26, v18, v26
M v[100:103], a[76:79], a[44:47], v[100:103]
 ds_read_b128 a[116:119], v7 offset:46080
 v_cvt_pk_bf16_f32 v56, v18, v19
 v_exp_f32 v21, v83
M v[100:103], a[80:83], a[48:51], v[100:103]
 s_add_u32 m0, s28, 0
 ds_read_b128 a[120:123], v7 offset:47104
 ds_read_b128 a[124:127], v7 offset:48128
 v_add_f32 v26, v19, v26
M v[100:103], a[84:87], a[52:55], v[100:103]
 buffer_load_dwordx4 v3, s[8:11], s24 offen offset:0 sc1 lds
M v[100:103], a[88:91], a[56:59], v[100:103]
 ds_read_b128 a[128:131], v7 offset:49152
 ds_read_b128 a[132:135], v7 offset:50176
 v_exp_f32 v22, v88
 v_add_f32 v26, v20, v26
 v_cvt_pk_bf16_f32 v57, v20, v21
M v[100:103], a[92:95], a[60:63], v[100:103]
 s_waitcnt lgkmcnt(2)
 ds_read_b128 a[136:139], v7 offset:51200
 v_exp_f32 v23, v89
 v_add_f32 v26, v21, v26
M v[108:111], a[124:127], a[60:63], v[108:111]
 ds_read_b128 a[140:143], v7 offset:52224
 ds_read_b128 a[144:147], v7 offset:53248
 v_exp_f32 v24, v90
M v[108:111], a[120:123], a[56:59], v[108:111]
 buffer_load_dwordx4 v3, s[8:11], s24 offen offset:1024 sc1 lds
M v[108:111], a[116:119], a[52:55], v[108:111]
 ds_read_b128 a[148:151], v7 offset:54272
 ds_read_b128 a[152:155], v7 offset:55296
 v_add_f32 v26, v22, v26
 v_cvt_pk_bf16_f32 v58, v22, v23
M v[108:111], a[112:115], a[48:51], v[108:111]
 ds_read_b128 a[156:159], v7 offset:56320
 v_exp_f32 v25, v91
 v_add_f32 v26, v23, v26
M v[108:111], a[108:111], a[44:47], v[108:111]
 ds_read_b128 a[160:163], v7 offset:57344
 ds_read_b128 a[164:167], v7 offset:58368
 v_exp_f32 v18, v84
M v[108:111], a[104:107], a[40:43], v[108:111]
 buffer_load_dwordx4 v3, s[8:11], s24 offen offset:2048 sc1 lds
M v[108:111], a[100:103], a[36:39], v[108:111]
 ds_read_b128 a[168:171], v7 offset:59392
 ds_read_b128 a[172:175], v7 offset:60416
 v_add_f32 v26, v24, v26
 v_cvt_pk_bf16_f32 v59, v24, v25
M v[108:111], a[96:99], a[32:35], v[108:111]
 s_waitcnt lgkmcnt(4)
 ds_read_b128 a[176:179], v7 offset:61440
 v_exp_f32 v19, v85
 v_add_f32 v26, v25, v26
M v[116:119], a[128:131], a[32:35], v[116:119]
 ds_read_b128 a[180:183], v7 offset:62464
 ds_read_b128 a[184:187], v7 offset:63488
 v_exp_f32 v20, v86
M v[116:119], a[132:135], a[36:39], v[116:119]
 ds_read_b128 a[188:191], v7 offset:64512
 v_add_f32 v27, v18, v27
 v_cvt_pk_bf16_f32 v60, v18, v19
M v[116:119], a[136:139], a[40:43], v[116:119]
 buffer_load_dwordx4 v3, s[8:11], s24 offen offset:3072 sc1 lds
M v[116:119], a[140:143], a[44:47], v[116:119]
 s_add_u32 m0, s28, 4096
 v_exp_f32 v21, v87
 v_add_f32 v27, v19, v27
 v_exp_f32 v22, v92
M v[116:119], a[144:147], a[48:51], v[116:119]
 buffer_load_dwordx4 v4, s[8:11], s24 offen offset:0 sc1 lds
M v[116:119], a[148:151], a[52:55], v[116:119]
 s_waitcnt vmcnt(14) lgkmcnt(0)
 v_add_f32 v27, v20, v27
 v_cvt_pk_bf16_f32 v61, v20, v21
 v_exp_f32 v23, v93
 v_add_f32 v27, v21, v27
M v[116:119], a[152:155], a[56:59], v[116:119]
 s_barrier
M v[116:119], a[156:159], a[60:63], v[116:119]
 ds_read_b128 a[64:67], v2 offset:0
 ds_read_b128 a[68:71], v2 offset:1024
 v_exp_f32 v24, v94
M v[124:127], a[188:191], a[60:63], v[124:127]
 ds_read_b128 a[72:75], v2 offset:2048
 v_add_f32 v27, v22, v27
 v_cvt_pk_bf16_f32 v62, v22, v23
M v[124:127], a[184:187], a[56:59], v[124:127]
 ds_read_b128 a[76:79], v2 offset:3072
 ds_read_b128 a[80:83], v2 offset:4096
 v_exp_f32 v25, v95
 v_add_f32 v27, v23, v27
M v[124:127], a[180:183], a[52:55], v[124:127]
 ds_read_b128 a[84:87], v2 offset:5120
 v_add_f32 v27, v24, v27
 v_cvt_pk_bf16_f32 v63, v24, v25
 v_add_f32 v27, v25, v27
M v[124:127], a[176:179], a[48:51], v[124:127]
 ds_read_b128 a[88:91], v2 offset:6144
 ds_read_b128 a[92:95], v2 offset:7168
 v_max_f32 v10, v26, v27
 v_cmp_lt_f32 vcc, s31, v10
M v[124:127], a[172:175], a[44:47], v[124:127]
 buffer_load_dwordx4 v4, s[8:11], s24 offen offset:1024 sc1 lds
M v[124:127], a[168:171], a[40:43], v[124:127]
 buffer_load_dwordx4 v4, s[8:11], s24 offen offset:2048 sc1 lds
M v[124:127], a[164:167], a[36:39], v[124:127]
 buffer_load_dwordx4 v4, s[8:11], s24 offen offset:3072 sc1 lds
M v[124:127], a[160:163], a[32:35], v[124:127]
 s_waitcnt lgkmcnt(0)
 s_cbranch_vccnz L_st6
L_rt6:
 s_cmp_gt_u32 s42, 5
 s_cbranch_scc1 L_p3o
L_p3k:
 s_mov_b32 s72, s32
 s_add_u32 s73, s72, 4096
 s_add_u32 s74, s72, 16384
 s_add_u32 s75, s72, 20480
 s_waitcnt vmcnt(8)
 v_cmp_ne_u32 vcc, 1, v5
 s_nop 0
 s_cbranch_vccnz L_fps1
L_fpr1:
M v[128:131], a[64:67], v[40:43], v[128:131]
 ds_read_b128 a[96:99], v2 offset:8192
 ds_read_b128 a[100:103], v2 offset:9216
M v[128:131], a[68:71], v[56:59], v[128:131]
 buffer_load_dwordx4 a[0:3], v7, s[8:11], s72 offen offset:0 sc1
M v[132:135], a[68:71], v[60:63], v[132:135]
 v_exp_f32 v18, v100
M v[132:135], a[64:67], v[44:47], v[132:135]
 ds_read_b128 a[104:107], v2 offset:10240
 ds_read_b128 a[108:111], v2 offset:11264
M v[140:143], a[72:75], v[44:47], v[140:143]
 buffer_load_dwordx4 a[4:7], v7, s[8:11], s72 offen offset:1024 sc1
M v[140:143], a[76:79], v[60:63], v[140:143]
 v_exp_f32 v19, v101
M v[136:139], a[76:79], v[56:59], v[136:139]
 ds_read_b128 a[112:115], v2 offset:12288
 ds_read_b128 a[116:119], v2 offset:13312
M v[136:139], a[72:75], v[40:43], v[136:139]
 buffer_load_dwordx4 a[8:11], v7, s[8:11], s72 offen offset:2048 sc1
M v[144:147], a[80:83], v[40:43], v[144:147]
 v_exp_f32 v20, v102
M v[144:147], a[84:87], v[56:59], v[144:147]
 ds_read_b128 a[120:123], v2 offset:14336
 ds_read_b128 a[124:127], v2 offset:15360
M v[148:151], a[84:87], v[60:63], v[148:151]
 v_exp_f32 v21, v103
M v[148:151], a[80:83], v[44:47], v[148:151]
 buffer_load_dwordx4 a[12:15], v7, s[8:11], s72 offen offset:3072 sc1
M v[156:159], a[88:91], v[44:47], v[156:159]
 v_add_f32 v30, v26, v30
 v_add_f32 v31, v27, v31
M v[156:159], a[92:95], v[60:63], v[156:159]
 v_add_f32 v29, v18, v19
 v_cvt_pk_bf16_f32 v52, v18, v19
M v[152:155], a[92:95], v[56:59], v[152:155]
 v_exp_f32 v22, v108
M v[152:155], a[88:91], v[40:43], v[152:155]
 s_waitcnt lgkmcnt(0)
 v_add_f32 v29, v20, v29
 v_cvt_pk_bf16_f32 v53, v20, v21
M v[160:163], a[96:99], v[40:43], v[160:163]
 ds_read_b128 a[64:67], v2 offset:16384
 ds_read_b128 a[68:71], v2 offset:17408
M v[160:163], a[100:103], v[56:59], v[160:163]
 buffer_load_dwordx4 a[16:19], v7, s[8:11], s73 offen offset:0 sc1
M v[164:167], a[100:103], v[60:63], v[164:167]
 v_exp_f32 v23, v109
M v[164:167], a[96:99], v[44:47], v[164:167]
 ds_read_b128 a[72:75], v2 offset:18432
 ds_read_b128 a[76:79], v2 offset:19456
M v[172:175], a[104:107], v[44:47], v[172:175]
 buffer_load_dwordx4 a[20:23], v7, s[8:11], s73 offen offset:1024 sc1
M v[172:175], a[108:111], v[60:63], v[172:175]
 v_exp_f32 v24, v110
M v[168:171], a[108:111], v[56:59], v[168:171]
 ds_read_b128 a[80:83], v2 offset:20480
 ds_read_b128 a[84:87], v2 offset:21504
M v[168:171], a[104:107], v[40:43], v[168:171]
 buffer_load_dwordx4 a[24:27], v7, s[8:11], s73 offen offset:2048 sc1
M v[176:179], a[112:115], v[40:43], v[176:179]
 v_exp_f32 v25, v111
M v[176:179], a[116:119], v[56:59], v[176:179]
 ds_read_b128 a[88:91], v2 offset:22528
 ds_read_b128 a[92:95], v2 offset:23552
M v[180:183], a[116:119], v[60:63], v[180:183]
 buffer_load_dwordx4 a[28:31], v7, s[8:11], s73 offen offset:3072 sc1
M v[180:183], a[112:115], v[44:47], v[180:183]
 v_add_f32 v29, v21, v29
 v_add_f32 v29, v22, v29
M v[188:191], a[120:123], v[44:47], v[188:191]
 v_exp_f32 v18, v116
M v[188:191], a[124:127], v[60:63], v[188:191]
 v_cvt_pk_bf16_f32 v54, v22, v23
 v_add_f32 v29, v23, v29
M v[184:187], a[124:127], v[56:59], v[184:187]
 buffer_load_dwordx4 a[32:35], v7, s[8:11], s74 offen offset:0 sc1
M v[184:187], a[120:123], v[40:43], v[184:187]
 s_waitcnt lgkmcnt(0)
 v_exp_f32 v19, v117
M v[192:195], a[64:67], v[40:43], v[192:195]
 ds_read_b128 a[96:99], v2 offset:24576
 ds_read_b128 a[100:103], v2 offset:25600
M v[192:195], a[68:71], v[56:59], v[192:195]
 buffer_load_dwordx4 a[36:39], v7, s[8:11], s74 offen offset:1024 sc1
M v[196:199], a[68:71], v[60:63], v[196:199]
 v_add_f32 v29, v24, v29
 v_cvt_pk_bf16_f32 v55, v24, v25
M v[196:199], a[64:67], v[44:47], v[196:199]
 ds_read_b128 a[104:107], v2 offset:26624
 ds_read_b128 a[108:111], v2 offset:27648
M v[204:207], a[72:75], v[44:47], v[204:207]
 v_exp_f32 v20, v118
M v[204:207], a[76:79], v[60:63], v[204:207]
 buffer_load_dwordx4 a[40:43], v7, s[8:11], s74 offen offset:2048 sc1
M v[200:203], a[76:79], v[56:59], v[200:203]
 ds_read_b128 a[112:115], v2 offset:28672
 ds_read_b128 a[116:119], v2 offset:29696
M v[200:203], a[72:75], v[40:43], v[200:203]
 v_exp_f32 v21, v119
M v[208:211], a[80:83], v[40:43], v[208:211]
 v_add_f32 v29, v25, v29
 v_add_f32 v29, v18, v29
M v[208:211], a[84:87], v[56:59], v[208:211]
 ds_read_b128 a[120:123], v2 offset:30720
 ds_read_b128 a[124:127], v2 offset:31744
M v[212:215], a[84:87], v[60:63], v[212:215]
 buffer_load_dwordx4 a[44:47], v7, s[8:11], s74 offen offset:3072 sc1
M v[212:215], a[80:83], v[44:47], v[212:215]
 v_exp_f32 v22, v124
M v[220:223], a[88:91], v[44:47], v[220:223]
 v_cvt_pk_bf16_f32 v48, v18, v19
 v_add_f32 v29, v19, v29
M v[220:223], a[92:95], v[60:63], v[220:223]
 buffer_load_dwordx4 a[48:51], v7, s[8:11], s75 offen offset:0 sc1
M v[216:219], a[92:95], v[56:59], v[216:219]
 s_waitcnt vmcnt(13) lgkmcnt(0)
 v_exp_f32 v23, v125
M v[216:219], a[88:91], v[40:43], v[216:219]
 s_barrier
M v[224:227], a[96:99], v[40:43], v[224:227]
 ds_read_b128 a[64:67], v7 offset:0
 ds_read_b128 a[68:71], v7 offset:1024
M v[224:227], a[100:103], v[56:59], v[224:227]
 buffer_load_dwordx4 a[52:55], v7, s[8:11], s75 offen offset:1024 sc1
M v[228:231], a[100:103], v[60:63], v[228:231]
 v_exp_f32 v24, v126
M v[228:231], a[96:99], v[44:47], v[228:231]
 ds_read_b128 a[72:75], v7 offset:2048
 ds_read_b128 a[76:79], v7 offset:3072
M v[236:239], a[104:107], v[44:47], v[236:239]
 buffer_load_dwordx4 a[56:59], v7, s[8:11], s75 offen offset:2048 sc1
M v[236:239], a[108:111], v[60:63], v[236:239]
 v_exp_f32 v25, v127
M v[232:235], a[108:111], v[56:59], v[232:235]
 ds_read_b128 a[80:83], v7 offset:4096
 ds_read_b128 a[84:87], v7 offset:5120
M v[232:235], a[104:107], v[40:43], v[232:235]
 v_add_f32 v29, v20, v29
 v_cvt_pk_bf16_f32 v49, v20, v21
M v[240:243], a[112:115], v[40:43], v[240:243]
 buffer_load_dwordx4 a[60:63], v7, s[8:11], s75 offen offset:3072 sc1
M v[240:243], a[116:119], v[56:59], v[240:243]
 ds_read_b128 a[88:91], v7 offset:6144
 ds_read_b128 a[92:95], v7 offset:7168
M v[244:247], a[116:119], v[60:63], v[244:247]
 v_add_f32 v29, v21, v29
 v_add_f32 v29, v22, v29
M v[244:247], a[112:115], v[44:47], v[244:247]
 v_cvt_pk_bf16_f32 v50, v22, v23
 v_add_f32 v29, v23, v29
M v[252:255], a[120:123], v[44:47], v[252:255]
 v_add_f32 v29, v24, v29
 v_cvt_pk_bf16_f32 v51, v24, v25
M v[252:255], a[124:127], v[60:63], v[252:255]
 v_add_f32 v29, v25, v29
M v[248:251], a[124:127], v[56:59], v[248:251]
 s_waitcnt lgkmcnt(0)
M v[248:251], a[120:123], v[40:43], v[248:251]
 v_cmp_lt_f32 vcc, s31, v29
 s_nop 0
 s_cbranch_vccnz L_st7
L_rt7:
M v[132:135], a[64:67], v[52:55], v[132:135]
 ds_read_b128 a[96:99], v7 offset:8192
 ds_read_b128 a[100:103], v7 offset:9216
M v[132:135], a[68:71], v[48:51], v[132:135]
 ds_read_b128 a[104:107], v7 offset:10240
 v_add_f32 v31, v29, v31
M v[140:143], a[76:79], v[48:51], v[140:143]
 s_sub_u32 s27, 5, s42
 ds_read_b128 a[108:111], v7 offset:11264
 ds_read_b128 a[112:115], v7 offset:12288
M v[140:143], a[72:75], v[52:55], v[140:143]
 s_mov_b32 s40, 0
 ds_read_b128 a[116:119], v7 offset:13312
 v_mov_b32 v10, v30
M v[148:151], a[80:83], v[52:55], v[148:151]
 s_add_u32 m0, s28, 32768
 ds_read_b128 a[120:123], v7 offset:14336
 ds_read_b128 a[124:127], v7 offset:15360
M v[148:151], a[84:87], v[48:51], v[148:151]
 buffer_load_dwordx4 v3, s[8:11], s21 offen offset:0 sc1 lds
M v[156:159], a[92:95], v[48:51], v[156:159]
 ds_read_b128 a[128:131], v7 offset:16384
 ds_read_b128 a[132:135], v7 offset:17408
M v[156:159], a[88:91], v[52:55], v[156:159]
 s_waitcnt lgkmcnt(2)
 ds_read_b128 a[136:139], v7 offset:18432
 v_mov_b32 v11, v31
M v[164:167], a[96:99], v[52:55], v[164:167]
 ds_read_b128 a[140:143], v7 offset:19456
 ds_read_b128 a[144:147], v7 offset:20480
M v[164:167], a[100:103], v[48:51], v[164:167]
 buffer_load_dwordx4 v3, s[8:11], s21 offen offset:1024 sc1 lds
M v[172:175], a[108:111], v[48:51], v[172:175]
 ds_read_b128 a[148:151], v7 offset:21504
 ds_read_b128 a[152:155], v7 offset:22528
M v[172:175], a[104:107], v[52:55], v[172:175]
 ds_read_b128 a[156:159], v7 offset:23552
 v_permlane16_swap_b32 v10, v30
M v[180:183], a[112:115], v[52:55], v[180:183]
 ds_read_b128 a[160:163], v7 offset:24576
 ds_read_b128 a[164:167], v7 offset:25600
M v[180:183], a[116:119], v[48:51], v[180:183]
 buffer_load_dwordx4 v3, s[8:11], s21 offen offset:2048 sc1 lds
M v[188:191], a[124:127], v[48:51], v[188:191]
 ds_read_b128 a[168:171], v7 offset:26624
 ds_read_b128 a[172:175], v7 offset:27648
M v[188:191], a[120:123], v[52:55], v[188:191]
 s_waitcnt lgkmcnt(4)
 ds_read_b128 a[176:179], v7 offset:28672
 v_permlane16_swap_b32 v11, v31
M v[196:199], a[128:131], v[52:55], v[196:199]
 ds_read_b128 a[180:183], v7 offset:29696
 ds_read_b128 a[184:187], v7 offset:30720
M v[196:199], a[132:135], v[48:51], v[196:199]
 ds_read_b128 a[188:191], v7 offset:31744
 v_add_f32 v30, v10, v30
M v[204:207], a[140:143], v[48:51], v[204:207]
 buffer_load_dwordx4 v3, s[8:11], s21 offen offset:3072 sc1 lds
M v[204:207], a[136:139], v[52:55], v[204:207]
 s_add_u32 m0, s28, 36864
 v_add_f32 v31, v11, v31
 v_mov_b32 v10, v30
M v[212:215], a[144:147], v[52:55], v[212:215]
 buffer_load_dwordx4 v4, s[8:11], s21 offen offset:0 sc1 lds
M v[212:215], a[148:151], v[48:51], v[212:215]
 s_waitcnt lgkmcnt(0)
 v_mov_b32 v11, v31
 v_permlane32_swap_b32 v10, v30
M v[220:223], a[156:159], v[48:51], v[220:223]
 s_barrier
M v[220:223], a[152:155], v[52:55], v[220:223]
 ds_read_b128 a[64:67], v2 offset:32768
 ds_read_b128 a[68:71], v2 offset:33792
M v[228:231], a[160:163], v[52:55], v[228:231]
 ds_read_b128 a[72:75], v2 offset:34816
 v_permlane32_swap_b32 v11, v31
M v[228:231], a[164:167], v[48:51], v[228:231]
 ds_read_b128 a[76:79], v2 offset:35840
 ds_read_b128 a[80:83], v2 offset:36864
M v[236:239], a[172:175], v[48:51], v[236:239]
 ds_read_b128 a[84:87], v2 offset:37888
 v_add_f32 v30, v10, v30
M v[236:239], a[168:171], v[52:55], v[236:239]
 ds_read_b128 a[88:91], v2 offset:38912
 ds_read_b128 a[92:95], v2 offset:39936
M v[244:247], a[176:179], v[52:55], v[244:247]
 buffer_load_dwordx4 v4, s[8:11], s21 offen offset:1024 sc1 lds
M v[244:247], a[180:183], v[48:51], v[244:247]
 buffer_load_dwordx4 v4, s[8:11], s21 offen offset:2048 sc1 lds
M v[252:255], a[188:191], v[48:51], v[252:255]
 buffer_load_dwordx4 v4, s[8:11], s21 offen offset:3072 sc1 lds
M v[252:255], a[184:187], v[52:55], v[252:255]
 s_waitcnt lgkmcnt(0)
 s_add_u32 s24, s23, 33554432
 s_mov_b32 s23, s21
 s_add_u32 s21, s21, 65536
 s_add_u32 s22, s22, 1
 s_cmp_eq_u32 s22, s25
 s_cselect_b32 s21, s26, s21
 s_cmp_eq_u32 s22, s43
 s_cselect_b32 s21, s4, s21
 s_cmp_eq_u32 s22, s6
 s_cselect_b32 s21, s7, s21
 v_add_f32 v31, v11, v31
 v_rcp_f32 v5, v30
 v_rcp_f32 v6, v31
 v_accvgpr_write_b32 a192, v5
 v_accvgpr_write_b32 a193, v6
 v_mov_b32 v30, 0
 v_mov_b32 v31, 0
 v_mov_b32 v32, 0xc1800000
 v_mov_b32 v33, 0xc1800000
 v_mov_b32 v34, 0xc1800000
 v_mov_b32 v35, 0xc1800000
 v_mov_b32 v36, 0xc1800000
 v_mov_b32 v37, 0xc1800000
 v_mov_b32 v38, 0xc1800000
 v_mov_b32 v39, 0xc1800000
 s_waitcnt vmcnt(8)
M v[64:67], a[64:67], a[0:3], v[32:35]
 ds_read_b128 a[96:99], v2 offset:40960
 v_cvt_pk_bf16_f32 v128, v128, v129
M v[64:67], a[68:71], a[4:7], v[64:67]
 ds_read_b128 a[100:103], v2 offset:41984
 v_cvt_pk_bf16_f32 v129, v130, v131
M v[64:67], a[72:75], a[8:11], v[64:67]
 buffer_load_dword v6, v9, s[8:11], s46 offen sc1
M v[64:67], a[76:79], a[12:15], v[64:67]
 ds_read_b128 a[104:107], v2 offset:43008
 v_cvt_pk_bf16_f32 v130, v136, v137
M v[64:67], a[80:83], a[16:19], v[64:67]
 s_add_u32 m0, s28, 65536
 ds_read_b128 a[108:111], v2 offset:44032
 v_cvt_pk_bf16_f32 v131, v138, v139
M v[64:67], a[84:87], a[20:23], v[64:67]
 buffer_load_dwordx4 v3, s[8:11], s24 offen offset:0 sc1 lds
M v[64:67], a[88:91], a[24:27], v[64:67]
 ds_read_b128 a[112:115], v2 offset:45056
 v_accvgpr_write_b32 a128, v128
M v[64:67], a[92:95], a[28:31], v[64:67]
 ds_read_b128 a[116:119], v2 offset:46080
 v_accvgpr_write_b32 a129, v129
M v[68:71], a[92:95], a[60:63], v[36:39]
 buffer_load_dwordx4 v3, s[8:11], s24 offen offset:1024 sc1 lds
M v[68:71], a[88:91], a[56:59], v[68:71]
 ds_read_b128 a[120:123], v2 offset:47104
 v_accvgpr_write_b32 a130, v130
M v[68:71], a[84:87], a[52:55], v[68:71]
 ds_read_b128 a[124:127], v2 offset:48128
 v_accvgpr_write_b32 a131, v131
M v[68:71], a[80:83], a[48:51], v[68:71]
 v_exp_f32 v18, v64
M v[68:71], a[76:79], a[44:47], v[68:71]
 v_exp_f32 v19, v65
M v[68:71], a[72:75], a[40:43], v[68:71]
 buffer_load_dwordx4 v3, s[8:11], s24 offen offset:2048 sc1 lds
M v[68:71], a[68:71], a[36:39], v[68:71]
 v_exp_f32 v20, v66
M v[68:71], a[64:67], a[32:35], v[68:71]
 s_waitcnt lgkmcnt(0)
 v_exp_f32 v21, v67
M v[72:75], a[96:99], a[0:3], v[32:35]
 ds_read_b128 a[64:67], v2 offset:49152
 v_add_f32 v26, v18, v19
M v[72:75], a[100:103], a[4:7], v[72:75]
 ds_read_b128 a[68:71], v2 offset:50176
 v_cvt_pk_bf16_f32 v40, v18, v19
M v[72:75], a[104:107], a[8:11], v[72:75]
 buffer_load_dwordx4 v3, s[8:11], s24 offen offset:3072 sc1 lds
M v[72:75], a[108:111], a[12:15], v[72:75]
 ds_read_b128 a[72:75], v2 offset:51200
 v_add_f32 v26, v20, v26
M v[72:75], a[112:115], a[16:19], v[72:75]
 ds_read_b128 a[76:79], v2 offset:52224
 v_cvt_pk_bf16_f32 v41, v20, v21
M v[72:75], a[116:119], a[20:23], v[72:75]
 v_exp_f32 v22, v68
M v[72:75], a[120:123], a[24:27], v[72:75]
 ds_read_b128 a[80:83], v2 offset:53248
 v_add_f32 v26, v21, v26
M v[72:75], a[124:127], a[28:31], v[72:75]
 s_add_u32 m0, s28, 69632
 ds_read_b128 a[84:87], v2 offset:54272
 v_cvt_pk_bf16_f32 v132, v132, v133
M v[76:79], a[124:127], a[60:63], v[36:39]
 buffer_load_dwordx4 v4, s[8:11], s24 offen offset:0 sc1 lds
M v[76:79], a[120:123], a[56:59], v[76:79]
 ds_read_b128 a[88:91], v2 offset:55296
 v_cvt_pk_bf16_f32 v133, v134, v135
M v[76:79], a[116:119], a[52:55], v[76:79]
 ds_read_b128 a[92:95], v2 offset:56320
 v_cvt_pk_bf16_f32 v134, v140, v141
M v[76:79], a[112:115], a[48:51], v[76:79]
 v_exp_f32 v23, v69
M v[76:79], a[108:111], a[44:47], v[76:79]
 buffer_load_dwordx4 v4, s[8:11], s24 offen offset:1024 sc1 lds
M v[76:79], a[104:107], a[40:43], v[76:79]
 v_exp_f32 v24, v70
M v[76:79], a[100:103], a[36:39], v[76:79]
 v_exp_f32 v25, v71
M v[76:79], a[96:99], a[32:35], v[76:79]
 s_waitcnt lgkmcnt(0)
 v_exp_f32 v18, v72
M v[80:83], a[64:67], a[0:3], v[32:35]
 ds_read_b128 a[96:99], v2 offset:57344
 v_add_f32 v27, v22, v23
M v[80:83], a[68:71], a[4:7], v[80:83]
 ds_read_b128 a[100:103], v2 offset:58368
 v_cvt_pk_bf16_f32 v44, v22, v23
M v[80:83], a[72:75], a[8:11], v[80:83]
 buffer_load_dwordx4 v4, s[8:11], s24 offen offset:2048 sc1 lds
M v[80:83], a[76:79], a[12:15], v[80:83]
 ds_read_b128 a[104:107], v2 offset:59392
 v_add_f32 v27, v24, v27
M v[80:83], a[80:83], a[16:19], v[80:83]
 ds_read_b128 a[108:111], v2 offset:60416
 v_cvt_pk_bf16_f32 v45, v24, v25
M v[80:83], a[84:87], a[20:23], v[80:83]
 v_exp_f32 v19, v73
M v[80:83], a[88:91], a[24:27], v[80:83]
 ds_read_b128 a[112:115], v2 offset:61440
 v_add_f32 v27, v25, v27
M v[80:83], a[92:95], a[28:31], v[80:83]
 ds_read_b128 a[116:119], v2 offset:62464
 v_add_f32 v26, v18, v26
M v[84:87], a[92:95], a[60:63], v[36:39]
 s_waitcnt vmcnt(7)
 v_cmp_gt_u32 vcc, 3, v6
 v_cvt_pk_bf16_f32 v42, v18, v19
M v[84:87], a[88:91], a[56:59], v[84:87]
 ds_read_b128 a[120:123], v2 offset:63488
 v_add_f32 v26, v19, v26
M v[84:87], a[84:87], a[52:55], v[84:87]
 ds_read_b128 a[124:127], v2 offset:64512
 v_cvt_pk_bf16_f32 v135, v142, v143
M v[84:87], a[80:83], a[48:51], v[84:87]
 s_cbranch_vccnz L_f2s
L_f2r:
 v_exp_f32 v20, v74
M v[84:87], a[76:79], a[44:47], v[84:87]
 buffer_load_dwordx4 v4, s[8:11], s24 offen offset:3072 sc1 lds
M v[84:87], a[72:75], a[40:43], v[84:87]
 v_exp_f32 v21, v75
M v[84:87], a[68:71], a[36:39], v[84:87]
 s_waitcnt lgkmcnt(0)
 v_exp_f32 v22, v76
M v[84:87], a[64:67], a[32:35], v[84:87]
 s_barrier
M v[88:91], a[96:99], a[0:3], v[32:35]
 ds_read_b128 a[64:67], v7 offset:32768
 v_add_f32 v26, v20, v26
M v[88:91], a[100:103], a[4:7], v[88:91]
 ds_read_b128 a[68:71], v7 offset:33792
 v_cvt_pk_bf16_f32 v43, v20, v21
M v[88:91], a[104:107], a[8:11], v[88:91]
 v_exp_f32 v23, v77
M v[88:91], a[108:111], a[12:15], v[88:91]
 ds_read_b128 a[72:75], v7 offset:34816
 v_add_f32 v26, v21, v26
M v[88:91], a[112:115], a[16:19], v[88:91]
 ds_read_b128 a[76:79], v7 offset:35840
 v_add_f32 v27, v22, v27
M v[88:91], a[116:119], a[20:23], v[88:91]
 v_exp_f32 v24, v78
M v[88:91], a[120:123], a[24:27], v[88:91]
 ds_read_b128 a[80:83], v7 offset:36864
 v_cvt_pk_bf16_f32 v46, v22, v23
M v[88:91], a[124:127], a[28:31], v[88:91]
 ds_read_b128 a[84:87], v7 offset:37888
 v_add_f32 v27, v23, v27
M v[92:95], a[124:127], a[60:63], v[36:39]
 v_exp_f32 v25, v79
M v[92:95], a[120:123], a[56:59], v[92:95]
 ds_read_b128 a[88:91], v7 offset:38912
 v_add_f32 v27, v24, v27
M v[92:95], a[116:119], a[52:55], v[92:95]
 ds_read_b128 a[92:95], v7 offset:39936
 v_cvt_pk_bf16_f32 v47, v24, v25
M v[92:95], a[112:115], a[48:51], v[92:95]
 v_add_f32 v27, v25, v27
 v_accvgpr_write_b32 a160, v132
M v[92:95], a[108:111], a[44:47], v[92:95]
 v_accvgpr_write_b32 a161, v133
 v_accvgpr_write_b32 a162, v134
M v[92:95], a[104:107], a[40:43], v[92:95]
 v_accvgpr_write_b32 a163, v135
 v_cvt_pk_bf16_f32 v144, v144, v145
M v[92:95], a[100:103], a[36:39], v[92:95]
 s_waitcnt lgkmcnt(0)
 v_cvt_pk_bf16_f32 v145, v146, v147
 v_cvt_pk_bf16_f32 v146, v152, v153
M v[92:95], a[96:99], a[32:35], v[92:95]
 v_cvt_pk_bf16_f32 v147, v154, v155
 v_accvgpr_write_b32 a132, v144
M v[96:99], a[64:67], a[0:3], v[32:35]
 s_add_u32 m0, s28, 98304
 ds_read_b128 a[96:99], v7 offset:40960
 v_accvgpr_write_b32 a133, v145
M v[96:99], a[68:71], a[4:7], v[96:99]
 ds_read_b128 a[100:103], v7 offset:41984
 v_accvgpr_write_b32 a134, v146
M v[96:99], a[72:75], a[8:11], v[96:99]
 buffer_load_dwordx4 v3, s[8:11], s21 offen offset:0 sc1 lds
M v[96:99], a[76:79], a[12:15], v[96:99]
 ds_read_b128 a[104:107], v7 offset:43008
 v_accvgpr_write_b32 a135, v147
M v[96:99], a[80:83], a[16:19], v[96:99]
 ds_read_b128 a[108:111], v7 offset:44032
 v_cvt_pk_bf16_f32 v148, v148, v149
M v[96:99], a[84:87], a[20:23], v[96:99]
 buffer_load_dwordx4 v3, s[8:11], s21 offen offset:1024 sc1 lds
M v[96:99], a[88:91], a[24:27], v[96:99]
 ds_read_b128 a[112:115], v7 offset:45056
 v_cvt_pk_bf16_f32 v149, v150, v151
M v[96:99], a[92:95], a[28:31], v[96:99]
 ds_read_b128 a[116:119], v7 offset:46080
 v_cvt_pk_bf16_f32 v150, v156, v157
M v[100:103], a[92:95], a[60:63], v[36:39]
 v_exp_f32 v18, v80
M v[100:103], a[88:91], a[56:59], v[100:103]
 ds_read_b128 a[120:123], v7 offset:47104
 v_cvt_pk_bf16_f32 v151, v158, v159
M v[100:103], a[84:87], a[52:55], v[100:103]
 ds_read_b128 a[124:127], v7 offset:48128
 v_accvgpr_write_b32 a164, v148
M v[100:103], a[80:83], a[48:51], v[100:103]
 buffer_load_dwordx4 v3, s[8:11], s21 offen offset:2048 sc1 lds
M v[100:103], a[76:79], a[44:47], v[100:103]
 v_exp_f32 v19, v81
M v[100:103], a[72:75], a[40:43], v[100:103]
 v_exp_f32 v20, v82
M v[100:103], a[68:71], a[36:39], v[100:103]
 v_exp_f32 v21, v83
M v[100:103], a[64:67], a[32:35], v[100:103]
 s_waitcnt lgkmcnt(0)
 v_exp_f32 v22, v88
M v[108:111], a[96:99], a[32:35], v[36:39]
 ds_read_b128 a[64:67], v7 offset:49152
 v_add_f32 v26, v18, v26
M v[108:111], a[100:103], a[36:39], v[108:111]
 ds_read_b128 a[68:71], v7 offset:50176
 v_cvt_pk_bf16_f32 v56, v18, v19
M v[108:111], a[104:107], a[40:43], v[108:111]
 buffer_load_dwordx4 v3, s[8:11], s21 offen offset:3072 sc1 lds
M v[108:111], a[108:111], a[44:47], v[108:111]
 s_add_u32 m0, s28, 102400
 ds_read_b128 a[72:75], v7 offset:51200
 v_add_f32 v26, v19, v26
M v[108:111], a[112:115], a[48:51], v[108:111]
 ds_read_b128 a[76:79], v7 offset:52224
 v_add_f32 v26, v20, v26
M v[108:111], a[116:119], a[52:55], v[108:111]
 buffer_load_dwordx4 v4, s[8:11], s21 offen offset:0 sc1 lds
M v[108:111], a[120:123], a[56:59], v[108:111]
 ds_read_b128 a[80:83], v7 offset:53248
 v_cvt_pk_bf16_f32 v57, v20, v21
M v[108:111], a[124:127], a[60:63], v[108:111]
 ds_read_b128 a[84:87], v7 offset:54272
 v_add_f32 v26, v21, v26
M v[104:107], a[124:127], a[28:31], v[32:35]
 v_exp_f32 v23, v89
M v[104:107], a[120:123], a[24:27], v[104:107]
 ds_read_b128 a[88:91], v7 offset:55296
 v_add_f32 v26, v22, v26
M v[104:107], a[116:119], a[20:23], v[104:107]
 ds_read_b128 a[92:95], v7 offset:56320
 v_cvt_pk_bf16_f32 v58, v22, v23
M v[104:107], a[112:115], a[16:19], v[104:107]
 buffer_load_dwordx4 v4, s[8:11], s21 offen offset:1024 sc1 lds
M v[104:107], a[108:111], a[12:15], v[104:107]
 v_exp_f32 v24, v90
M v[104:107], a[104:107], a[8:11], v[104:107]
 v_exp_f32 v25, v91
M v[104:107], a[100:103], a[4:7], v[104:107]
 buffer_load_dwordx4 v4, s[8:11], s21 offen offset:2048 sc1 lds
M v[104:107], a[96:99], a[0:3], v[104:107]
 s_waitcnt lgkmcnt(0)
 v_exp_f32 v18, v84
M v[112:115], a[64:67], a[0:3], v[32:35]
 ds_read_b128 a[96:99], v7 offset:57344
 v_add_f32 v26, v23, v26
M v[112:115], a[68:71], a[4:7], v[112:115]
 ds_read_b128 a[100:103], v7 offset:58368
 v_add_f32 v26, v24, v26
M v[112:115], a[72:75], a[8:11], v[112:115]
 v_exp_f32 v19, v85
M v[112:115], a[76:79], a[12:15], v[112:115]
 ds_read_b128 a[104:107], v7 offset:59392
 v_cvt_pk_bf16_f32 v59, v24, v25
M v[112:115], a[80:83], a[16:19], v[112:115]
 ds_read_b128 a[108:111], v7 offset:60416
 v_add_f32 v26, v25, v26
M v[112:115], a[84:87], a[20:23], v[112:115]
 buffer_load_dwordx4 v4, s[8:11], s21 offen offset:3072 sc1 lds
M v[112:115], a[88:91], a[24:27], v[112:115]
 s_add_u32 s24, s23, 33554432
 ds_read_b128 a[112:115], v7 offset:61440
 v_add_f32 v27, v18, v27
M v[112:115], a[92:95], a[28:31], v[112:115]
 s_mov_b32 s23, s21
 ds_read_b128 a[116:119], v7 offset:62464
 v_cvt_pk_bf16_f32 v60, v18, v19
M v[116:119], a[92:95], a[60:63], v[36:39]
 s_add_u32 s21, s21, 65536
 v_exp_f32 v20, v86
M v[116:119], a[88:91], a[56:59], v[116:119]
 s_add_u32 s22, s22, 1
 ds_read_b128 a[120:123], v7 offset:63488
 v_add_f32 v27, v19, v27
M v[116:119], a[84:87], a[52:55], v[116:119]
 s_cmp_eq_u32 s22, s25
 ds_read_b128 a[124:127], v7 offset:64512
 v_accvgpr_write_b32 a165, v149
M v[116:119], a[80:83], a[48:51], v[116:119]
 s_cselect_b32 s21, s26, s21
 v_exp_f32 v21, v87
M v[116:119], a[76:79], a[44:47], v[116:119]
 s_cmp_eq_u32 s22, s43
 v_exp_f32 v22, v92
M v[116:119], a[72:75], a[40:43], v[116:119]
 s_cselect_b32 s21, s4, s21
 v_exp_f32 v23, v93
M v[116:119], a[68:71], a[36:39], v[116:119]
 s_waitcnt vmcnt(8) lgkmcnt(0)
 v_add_f32 v27, v20, v27
 v_cvt_pk_bf16_f32 v61, v20, v21
M v[116:119], a[64:67], a[32:35], v[116:119]
 s_barrier
M v[124:127], a[96:99], a[32:35], v[36:39]
 s_cmp_eq_u32 s22, s6
 ds_read_b128 a[64:67], v2 offset:0
 v_add_f32 v27, v21, v27
M v[124:127], a[100:103], a[36:39], v[124:127]
 s_cselect_b32 s21, s7, s21
 ds_read_b128 a[68:71], v2 offset:1024
 v_add_f32 v27, v22, v27
M v[124:127], a[104:107], a[40:43], v[124:127]
 v_exp_f32 v24, v94
M v[124:127], a[108:111], a[44:47], v[124:127]
 ds_read_b128 a[72:75], v2 offset:2048
 v_cvt_pk_bf16_f32 v62, v22, v23
M v[124:127], a[112:115], a[48:51], v[124:127]
 ds_read_b128 a[76:79], v2 offset:3072
 v_add_f32 v27, v23, v27
M v[124:127], a[116:119], a[52:55], v[124:127]
 v_exp_f32 v25, v95
M v[124:127], a[120:123], a[56:59], v[124:127]
 ds_read_b128 a[80:83], v2 offset:4096
 v_add_f32 v27, v24, v27
M v[124:127], a[124:127], a[60:63], v[124:127]
 ds_read_b128 a[84:87], v2 offset:5120
 v_cvt_pk_bf16_f32 v63, v24, v25
M v[120:123], a[124:127], a[28:31], v[32:35]
 v_add_f32 v27, v25, v27
 v_accvgpr_write_b32 a166, v150
M v[120:123], a[120:123], a[24:27], v[120:123]
 ds_read_b128 a[88:91], v2 offset:6144
 v_max_f32 v10, v26, v27
M v[120:123], a[116:119], a[20:23], v[120:123]
 ds_read_b128 a[92:95], v2 offset:7168
 v_min_f32 v11, v26, v27
M v[120:123], a[112:115], a[16:19], v[120:123]
 v_cmp_lt_f32 s[36:37], s31, v10
 v_accvgpr_write_b32 a167, v151
M v[120:123], a[108:111], a[12:15], v[120:123]
 v_cmp_gt_f32 vcc, s55, v11
 v_cvt_pk_bf16_f32 v160, v160, v161
M v[120:123], a[104:107], a[8:11], v[120:123]
 v_cvt_pk_bf16_f32 v161, v162, v163
 v_cvt_pk_bf16_f32 v162, v168, v169
M v[120:123], a[100:103], a[4:7], v[120:123]
 s_waitcnt lgkmcnt(0)
 s_or_b64 vcc, vcc, s[36:37]
M v[120:123], a[96:99], a[0:3], v[120:123]
 s_cbranch_vccnz L_st11
L_rt11:
 v_cvt_pk_bf16_f32 v163, v170, v171
 v_accvgpr_write_b32 a136, v160
 v_accvgpr_write_b32 a137, v161
 v_accvgpr_write_b32 a138, v162
 v_accvgpr_write_b32 a139, v163
 v_cvt_pk_bf16_f32 v164, v164, v165
 v_cvt_pk_bf16_f32 v165, v166, v167
 v_cvt_pk_bf16_f32 v166, v172, v173
 v_cvt_pk_bf16_f32 v167, v174, v175
 v_accvgpr_write_b32 a168, v164
 v_accvgpr_write_b32 a169, v165
 v_accvgpr_write_b32 a170, v166
 v_accvgpr_write_b32 a171, v167
 v_cvt_pk_bf16_f32 v176, v176, v177
 v_cvt_pk_bf16_f32 v177, v178, v179
 v_cvt_pk_bf16_f32 v178, v184, v185
 v_cvt_pk_bf16_f32 v179, v186, v187
 v_accvgpr_write_b32 a140, v176
 v_accvgpr_write_b32 a141, v177
 v_accvgpr_write_b32 a142, v178
 v_accvgpr_write_b32 a143, v179
 v_cvt_pk_bf16_f32 v180, v180, v181
 v_cvt_pk_bf16_f32 v181, v182, v183
 v_cvt_pk_bf16_f32 v182, v188, v189
 v_cvt_pk_bf16_f32 v183, v190, v191
 v_accvgpr_write_b32 a172, v180
 v_accvgpr_write_b32 a173, v181
 v_accvgpr_write_b32 a174, v182
 v_accvgpr_write_b32 a175, v183
 v_cvt_pk_bf16_f32 v192, v192, v193
 v_cvt_pk_bf16_f32 v193, v194, v195
 v_cvt_pk_bf16_f32 v194, v200, v201
 v_cvt_pk_bf16_f32 v195, v202, v203
 v_accvgpr_write_b32 a144, v192
 v_accvgpr_write_b32 a145, v193
 v_accvgpr_write_b32 a146, v194
 v_accvgpr_write_b32 a147, v195
 v_cvt_pk_bf16_f32 v196, v196, v197
 v_cvt_pk_bf16_f32 v197, v198, v199
 v_cvt_pk_bf16_f32 v198, v204, v205
 v_cvt_pk_bf16_f32 v199, v206, v207
 v_accvgpr_write_b32 a176, v196
 v_accvgpr_write_b32 a177, v197
 v_accvgpr_write_b32 a178, v198
 v_accvgpr_write_b32 a179, v199
 v_cvt_pk_bf16_f32 v208, v208, v209
 v_cvt_pk_bf16_f32 v209, v210, v211
 v_cvt_pk_bf16_f32 v210, v216, v217
 v_cvt_pk_bf16_f32 v211, v218, v219
 v_accvgpr_write_b32 a148, v208
 v_accvgpr_write_b32 a149, v209
 v_accvgpr_write_b32 a150, v210
 v_accvgpr_write_b32 a151, v211
 v_cvt_pk_bf16_f32 v212, v212, v213
 v_cvt_pk_bf16_f32 v213, v214, v215
 v_cvt_pk_bf16_f32 v214, v220, v221
 v_cvt_pk_bf16_f32 v215, v222, v223
 v_accvgpr_write_b32 a180, v212
 v_accvgpr_write_b32 a181, v213
 v_accvgpr_write_b32 a182, v214
 v_accvgpr_write_b32 a183, v215
 v_cvt_pk_bf16_f32 v224, v224, v225
 v_cvt_pk_bf16_f32 v225, v226, v227
 v_cvt_pk_bf16_f32 v226, v232, v233
 v_cvt_pk_bf16_f32 v227, v234, v235
 v_accvgpr_write_b32 a152, v224
 v_accvgpr_write_b32 a153, v225
 v_accvgpr_write_b32 a154, v226
 v_accvgpr_write_b32 a155, v227
 v_cvt_pk_bf16_f32 v228, v228, v229
 v_cvt_pk_bf16_f32 v229, v230, v231
 v_cvt_pk_bf16_f32 v230, v236, v237
 v_cvt_pk_bf16_f32 v231, v238, v239
 v_accvgpr_write_b32 a184, v228
 v_accvgpr_write_b32 a185, v229
 v_accvgpr_write_b32 a186, v230
 v_accvgpr_write_b32 a187, v231
M v[128:131], a[64:67], v[40:43], 0
 s_add_u32 m0, s28, 0
 ds_read_b128 a[96:99], v2 offset:8192
 ds_read_b128 a[100:103], v2 offset:9216
M v[128:131], a[68:71], v[56:59], v[128:131]
 buffer_load_dwordx4 v3, s[8:11], s24 offen offset:0 sc1 lds
M v[132:135], a[68:71], v[60:63], 0
 v_cvt_pk_bf16_f32 v240, v240, v241
 v_cvt_pk_bf16_f32 v241, v242, v243
M v[132:135], a[64:67], v[44:47], v[132:135]
 ds_read_b128 a[104:107], v2 offset:10240
 ds_read_b128 a[108:111], v2 offset:11264
M v[140:143], a[72:75], v[44:47], 0
 buffer_load_dwordx4 v3, s[8:11], s24 offen offset:1024 sc1 lds
M v[140:143], a[76:79], v[60:63], v[140:143]
 v_cvt_pk_bf16_f32 v242, v248, v249
 v_cvt_pk_bf16_f32 v243, v250, v251
M v[136:139], a[76:79], v[56:59], 0
 ds_read_b128 a[112:115], v2 offset:12288
 ds_read_b128 a[116:119], v2 offset:13312
M v[136:139], a[72:75], v[40:43], v[136:139]
 buffer_load_dwordx4 v3, s[8:11], s24 offen offset:2048 sc1 lds
M v[144:147], a[80:83], v[40:43], 0
 v_accvgpr_write_b32 a156, v240
 v_accvgpr_write_b32 a157, v241
M v[144:147], a[84:87], v[56:59], v[144:147]
 ds_read_b128 a[120:123], v2 offset:14336
 ds_read_b128 a[124:127], v2 offset:15360
M v[148:151], a[84:87], v[60:63], 0
 buffer_load_dwordx4 v3, s[8:11], s24 offen offset:3072 sc1 lds
M v[148:151], a[80:83], v[44:47], v[148:151]
 s_add_u32 m0, s28, 4096
 v_accvgpr_write_b32 a158, v242
 v_accvgpr_write_b32 a159, v243
M v[156:159], a[88:91], v[44:47], 0
 buffer_load_dwordx4 v4, s[8:11], s24 offen offset:0 sc1 lds
M v[156:159], a[92:95], v[60:63], v[156:159]
 v_cvt_pk_bf16_f32 v244, v244, v245
 v_cvt_pk_bf16_f32 v245, v246, v247
M v[152:155], a[92:95], v[56:59], 0
 v_cvt_pk_bf16_f32 v246, v252, v253
 v_cvt_pk_bf16_f32 v247, v254, v255
M v[152:155], a[88:91], v[40:43], v[152:155]
 s_waitcnt lgkmcnt(0)
 v_accvgpr_write_b32 a188, v244
 v_accvgpr_write_b32 a189, v245
M v[160:163], a[96:99], v[40:43], 0
 ds_read_b128 a[64:67], v2 offset:16384
 ds_read_b128 a[68:71], v2 offset:17408
M v[160:163], a[100:103], v[56:59], v[160:163]
 buffer_load_dwordx4 v4, s[8:11], s24 offen offset:1024 sc1 lds
M v[164:167], a[100:103], v[60:63], 0
 v_accvgpr_write_b32 a190, v246
 v_accvgpr_write_b32 a191, v247
M v[164:167], a[96:99], v[44:47], v[164:167]
 ds_read_b128 a[72:75], v2 offset:18432
 ds_read_b128 a[76:79], v2 offset:19456
M v[172:175], a[104:107], v[44:47], 0
 buffer_load_dwordx4 v4, s[8:11], s24 offen offset:2048 sc1 lds
M v[172:175], a[108:111], v[60:63], v[172:175]
 v_exp_f32 v18, v96
M v[168:171], a[108:111], v[56:59], 0
 ds_read_b128 a[80:83], v2 offset:20480
 ds_read_b128 a[84:87], v2 offset:21504
M v[168:171], a[104:107], v[40:43], v[168:171]
 buffer_load_dwordx4 v4, s[8:11], s24 offen offset:3072 sc1 lds
M v[176:179], a[112:115], v[40:43], 0
 v_exp_f32 v19, v97
M v[176:179], a[116:119], v[56:59], v[176:179]
 s_add_u32 m0, s28, 32768
 ds_read_b128 a[88:91], v2 offset:22528
 ds_read_b128 a[92:95], v2 offset:23552
M v[180:183], a[116:119], v[60:63], 0
 buffer_load_dwordx4 v3, s[8:11], s21 offen offset:0 sc1 lds
M v[180:183], a[112:115], v[44:47], v[180:183]
 v_exp_f32 v20, v98
M v[188:191], a[120:123], v[44:47], 0
 buffer_load_dwordx4 v3, s[8:11], s21 offen offset:1024 sc1 lds
M v[188:191], a[124:127], v[60:63], v[188:191]
 v_exp_f32 v21, v99
M v[184:187], a[124:127], v[56:59], 0
 buffer_load_dwordx4 v3, s[8:11], s21 offen offset:2048 sc1 lds
M v[184:187], a[120:123], v[40:43], v[184:187]
 s_waitcnt lgkmcnt(0)
 v_exp_f32 v22, v104
M v[192:195], a[64:67], v[40:43], 0
 ds_read_b128 a[96:99], v2 offset:24576
 ds_read_b128 a[100:103], v2 offset:25600
M v[192:195], a[68:71], v[56:59], v[192:195]
 buffer_load_dwordx4 v3, s[8:11], s21 offen offset:3072 sc1 lds
M v[196:199], a[68:71], v[60:63], 0
 v_exp_f32 v23, v105
M v[196:199], a[64:67], v[44:47], v[196:199]
 s_add_u32 m0, s28, 36864
 ds_read_b128 a[104:107], v2 offset:26624
 ds_read_b128 a[108:111], v2 offset:27648
M v[204:207], a[72:75], v[44:47], 0
 buffer_load_dwordx4 v4, s[8:11], s21 offen offset:0 sc1 lds
M v[204:207], a[76:79], v[60:63], v[204:207]
 v_add_f32 v30, v26, v30
 v_add_f32 v31, v27, v31
M v[200:203], a[76:79], v[56:59], 0
 ds_read_b128 a[112:115], v2 offset:28672
 ds_read_b128 a[116:119], v2 offset:29696
M v[200:203], a[72:75], v[40:43], v[200:203]
 buffer_load_dwordx4 v4, s[8:11], s21 offen offset:1024 sc1 lds
M v[208:211], a[80:83], v[40:43], 0
 v_exp_f32 v24, v106
M v[208:211], a[84:87], v[56:59], v[208:211]
 ds_read_b128 a[120:123], v2 offset:30720
 ds_read_b128 a[124:127], v2 offset:31744
M v[212:215], a[84:87], v[60:63], 0
 buffer_load_dwordx4 v4, s[8:11], s21 offen offset:2048 sc1 lds
M v[212:215], a[80:83], v[44:47], v[212:215]
 v_exp_f32 v25, v107
M v[220:223], a[88:91], v[44:47], 0
 v_add_f32 v28, v18, v19
 v_cvt_pk_bf16_f32 v48, v18, v19
M v[220:223], a[92:95], v[60:63], v[220:223]
 buffer_load_dwordx4 v4, s[8:11], s21 offen offset:3072 sc1 lds
M v[216:219], a[92:95], v[56:59], 0
 s_waitcnt vmcnt(16) lgkmcnt(0)
 s_add_u32 s24, s23, 33554432
 s_mov_b32 s23, s21
M v[216:219], a[88:91], v[40:43], v[216:219]
 s_barrier
M v[224:227], a[96:99], v[40:43], 0
 ds_read_b128 a[64:67], v2 offset:32768
 ds_read_b128 a[68:71], v2 offset:33792
M v[224:227], a[100:103], v[56:59], v[224:227]
 s_add_u32 s21, s21, 65536
 v_add_f32 v28, v20, v28
M v[228:231], a[100:103], v[60:63], 0
 s_add_u32 s22, s22, 1
 v_exp_f32 v18, v100
M v[228:231], a[96:99], v[44:47], v[228:231]
 s_cmp_eq_u32 s22, s25
 ds_read_b128 a[72:75], v2 offset:34816
 ds_read_b128 a[76:79], v2 offset:35840
M v[236:239], a[104:107], v[44:47], 0
 s_cselect_b32 s21, s26, s21
 v_exp_f32 v19, v101
M v[236:239], a[108:111], v[60:63], v[236:239]
 s_cmp_eq_u32 s22, s43
 v_cvt_pk_bf16_f32 v49, v20, v21
 v_add_f32 v28, v21, v28
M v[232:235], a[108:111], v[56:59], 0
 s_cselect_b32 s21, s4, s21
 ds_read_b128 a[80:83], v2 offset:36864
 ds_read_b128 a[84:87], v2 offset:37888
M v[232:235], a[104:107], v[40:43], v[232:235]
 s_cmp_eq_u32 s22, s6
 v_exp_f32 v20, v102
M v[240:243], a[112:115], v[40:43], 0
 s_cselect_b32 s21, s7, s21
 v_exp_f32 v21, v103
M v[240:243], a[116:119], v[56:59], v[240:243]
 ds_read_b128 a[88:91], v2 offset:38912
 ds_read_b128 a[92:95], v2 offset:39936
M v[244:247], a[116:119], v[60:63], 0
 v_add_f32 v28, v22, v28
 v_cvt_pk_bf16_f32 v50, v22, v23
M v[244:247], a[112:115], v[44:47], v[244:247]
 v_add_f32 v28, v23, v28
 v_add_f32 v28, v24, v28
M v[252:255], a[120:123], v[44:47], 0
 v_exp_f32 v22, v108
M v[252:255], a[124:127], v[60:63], v[252:255]
 s_cmp_lg_u32 s27, 0
 v_exp_f32 v23, v109
M v[248:251], a[124:127], v[56:59], 0
 s_waitcnt lgkmcnt(0)
 v_cvt_pk_bf16_f32 v51, v24, v25
 v_add_f32 v28, v25, v28
M v[248:251], a[120:123], v[40:43], v[248:251]
 v_exp_f32 v24, v110
 v_add_f32 v29, v18, v19
 v_cvt_pk_bf16_f32 v52, v18, v19
 v_add_f32 v29, v20, v29
 v_cvt_pk_bf16_f32 v53, v20, v21
 v_add_f32 v29, v21, v29
 v_exp_f32 v25, v111
 v_add_f32 v29, v22, v29
 v_cvt_pk_bf16_f32 v54, v22, v23
 v_add_f32 v29, v23, v29
 v_add_f32 v29, v24, v29
 v_cvt_pk_bf16_f32 v55, v24, v25
 v_add_f32 v29, v25, v29
 s_cbranch_scc1 L_loop_top
L_final_h:
 s_waitcnt vmcnt(8)
 s_barrier
 ds_read_b128 a[64:67], v7 offset:0
 ds_read_b128 a[68:71], v7 offset:1024
 ds_read_b128 a[72:75], v7 offset:2048
 ds_read_b128 a[76:79], v7 offset:3072
 ds_read_b128 a[80:83], v7 offset:4096
 ds_read_b128 a[84:87], v7 offset:5120
 ds_read_b128 a[88:91], v7 offset:6144
 ds_read_b128 a[92:95], v7 offset:7168
 s_add_u32 m0, s28, 65536
 v_exp_f32 v18, v112
 buffer_load_dwordx4 v3, s[8:11], s38 offen offset:0 sc1 lds
 v_exp_f32 v19, v113
 v_exp_f32 v20, v114
 v_add_f32 v28, v18, v28
 v_cvt_pk_bf16_f32 v56, v18, v19
 buffer_load_dwordx4 v3, s[8:11], s38 offen offset:1024 sc1 lds
 v_exp_f32 v21, v115
 v_add_f32 v28, v19, v28
 v_exp_f32 v22, v120
 v_add_f32 v28, v20, v28
 v_cvt_pk_bf16_f32 v57, v20, v21
 buffer_load_dwordx4 v3, s[8:11], s38 offen offset:2048 sc1 lds
 v_exp_f32 v23, v121
 v_add_f32 v28, v21, v28
 v_exp_f32 v24, v122
 v_add_f32 v28, v22, v28
 v_cvt_pk_bf16_f32 v58, v22, v23
 buffer_load_dwordx4 v3, s[8:11], s38 offen offset:3072 sc1 lds
 v_exp_f32 v25, v123
 v_add_f32 v28, v23, v28
 v_exp_f32 v18, v116
 v_add_f32 v28, v24, v28
 s_add_u32 m0, s28, 69632
 v_cvt_pk_bf16_f32 v59, v24, v25
 buffer_load_dwordx4 v4, s[8:11], s38 offen offset:0 sc1 lds
 v_exp_f32 v19, v117
 v_add_f32 v28, v25, v28
 v_exp_f32 v20, v118
 v_add_f32 v29, v18, v29
 v_cvt_pk_bf16_f32 v60, v18, v19
 buffer_load_dwordx4 v4, s[8:11], s38 offen offset:1024 sc1 lds
 v_exp_f32 v21, v119
 v_add_f32 v29, v19, v29
 v_exp_f32 v22, v124
 v_add_f32 v29, v20, v29
 v_cvt_pk_bf16_f32 v61, v20, v21
 buffer_load_dwordx4 v4, s[8:11], s38 offen offset:2048 sc1 lds
 v_exp_f32 v23, v125
 v_add_f32 v29, v21, v29
 v_exp_f32 v24, v126
 v_add_f32 v29, v22, v29
 v_cvt_pk_bf16_f32 v62, v22, v23
 buffer_load_dwordx4 v4, s[8:11], s38 offen offset:3072 sc1 lds
 s_add_u32 s38, s38, 65536
 v_exp_f32 v25, v127
 v_add_f32 v29, v23, v29
 v_add_f32 v29, v24, v29
 v_cvt_pk_bf16_f32 v63, v24, v25
 v_add_f32 v29, v25, v29
 v_max_f32 v10, v28, v29
 v_cmp_lt_f32 vcc, s31, v10
 s_nop 0
 s_cbranch_vccnz L_st4
L_rt4:
 v_add_f32 v30, v28, v30
 v_add_f32 v31, v29, v31
 v_mov_b32 v12, v32
 v_mov_b32 v13, v36
 v_mov_b32 v14, v30
 v_mov_b32 v15, v31
 buffer_store_dwordx4 v[12:15], v7, s[8:11], s52 offen sc1
 s_waitcnt lgkmcnt(0)
M v[128:131], a[64:67], v[48:51], v[128:131]
 ds_read_b128 a[96:99], v7 offset:8192
M v[128:131], a[68:71], v[56:59], v[128:131]
 ds_read_b128 a[100:103], v7 offset:9216
M v[132:135], a[68:71], v[60:63], v[132:135]
M v[132:135], a[64:67], v[52:55], v[132:135]
 ds_read_b128 a[104:107], v7 offset:10240
M v[140:143], a[72:75], v[52:55], v[140:143]
 ds_read_b128 a[108:111], v7 offset:11264
M v[140:143], a[76:79], v[60:63], v[140:143]
M v[136:139], a[76:79], v[56:59], v[136:139]
 ds_read_b128 a[112:115], v7 offset:12288
M v[136:139], a[72:75], v[48:51], v[136:139]
 ds_read_b128 a[116:119], v7 offset:13312
M v[144:147], a[80:83], v[48:51], v[144:147]
M v[144:147], a[84:87], v[56:59], v[144:147]
 ds_read_b128 a[120:123], v7 offset:14336
M v[148:151], a[84:87], v[60:63], v[148:151]
 ds_read_b128 a[124:127], v7 offset:15360
M v[148:151], a[80:83], v[52:55], v[148:151]
 v_cvt_pk_bf16_f32 v128, v128, v129
 v_cvt_pk_bf16_f32 v129, v130, v131
M v[156:159], a[88:91], v[52:55], v[156:159]
 v_cvt_pk_bf16_f32 v130, v136, v137
 v_cvt_pk_bf16_f32 v131, v138, v139
M v[156:159], a[92:95], v[60:63], v[156:159]
 buffer_store_dwordx4 v[128:131], v7, s[8:11], s12 offen offset:0 sc1
M v[152:155], a[92:95], v[56:59], v[152:155]
 v_cvt_pk_bf16_f32 v132, v132, v133
 v_cvt_pk_bf16_f32 v133, v134, v135
M v[152:155], a[88:91], v[48:51], v[152:155]
 s_waitcnt lgkmcnt(0)
 v_cvt_pk_bf16_f32 v134, v140, v141
 v_cvt_pk_bf16_f32 v135, v142, v143
M v[160:163], a[96:99], v[48:51], v[160:163]
 ds_read_b128 a[64:67], v7 offset:16384
M v[160:163], a[100:103], v[56:59], v[160:163]
 ds_read_b128 a[68:71], v7 offset:17408
M v[164:167], a[100:103], v[60:63], v[164:167]
 buffer_store_dwordx4 v[132:135], v7, s[8:11], s14 offen offset:0 sc1
M v[164:167], a[96:99], v[52:55], v[164:167]
 ds_read_b128 a[72:75], v7 offset:18432
 v_cvt_pk_bf16_f32 v144, v144, v145
M v[172:175], a[104:107], v[52:55], v[172:175]
 ds_read_b128 a[76:79], v7 offset:19456
 v_cvt_pk_bf16_f32 v145, v146, v147
M v[172:175], a[108:111], v[60:63], v[172:175]
 v_cvt_pk_bf16_f32 v146, v152, v153
 v_cvt_pk_bf16_f32 v147, v154, v155
M v[168:171], a[108:111], v[56:59], v[168:171]
 ds_read_b128 a[80:83], v7 offset:20480
M v[168:171], a[104:107], v[48:51], v[168:171]
 ds_read_b128 a[84:87], v7 offset:21504
M v[176:179], a[112:115], v[48:51], v[176:179]
 buffer_store_dwordx4 v[144:147], v7, s[8:11], s12 offen offset:1024 sc1
M v[176:179], a[116:119], v[56:59], v[176:179]
 ds_read_b128 a[88:91], v7 offset:22528
 v_cvt_pk_bf16_f32 v148, v148, v149
M v[180:183], a[116:119], v[60:63], v[180:183]
 ds_read_b128 a[92:95], v7 offset:23552
 v_cvt_pk_bf16_f32 v149, v150, v151
M v[180:183], a[112:115], v[52:55], v[180:183]
 v_cvt_pk_bf16_f32 v150, v156, v157
 v_cvt_pk_bf16_f32 v151, v158, v159
M v[188:191], a[120:123], v[52:55], v[188:191]
 buffer_store_dwordx4 v[148:151], v7, s[8:11], s14 offen offset:1024 sc1
M v[188:191], a[124:127], v[60:63], v[188:191]
 v_cvt_pk_bf16_f32 v160, v160, v161
 v_cvt_pk_bf16_f32 v161, v162, v163
M v[184:187], a[124:127], v[56:59], v[184:187]
 v_cvt_pk_bf16_f32 v162, v168, v169
 v_cvt_pk_bf16_f32 v163, v170, v171
M v[184:187], a[120:123], v[48:51], v[184:187]
 s_waitcnt lgkmcnt(0)
M v[192:195], a[64:67], v[48:51], v[192:195]
 ds_read_b128 a[96:99], v7 offset:24576
M v[192:195], a[68:71], v[56:59], v[192:195]
 ds_read_b128 a[100:103], v7 offset:25600
M v[196:199], a[68:71], v[60:63], v[196:199]
 buffer_store_dwordx4 v[160:163], v7, s[8:11], s12 offen offset:2048 sc1
M v[196:199], a[64:67], v[52:55], v[196:199]
 ds_read_b128 a[104:107], v7 offset:26624
 v_cvt_pk_bf16_f32 v164, v164, v165
M v[204:207], a[72:75], v[52:55], v[204:207]
 ds_read_b128 a[108:111], v7 offset:27648
 v_cvt_pk_bf16_f32 v165, v166, v167
M v[204:207], a[76:79], v[60:63], v[204:207]
 v_cvt_pk_bf16_f32 v166, v172, v173
 v_cvt_pk_bf16_f32 v167, v174, v175
M v[200:203], a[76:79], v[56:59], v[200:203]
 ds_read_b128 a[112:115], v7 offset:28672
M v[200:203], a[72:75], v[48:51], v[200:203]
 ds_read_b128 a[116:119], v7 offset:29696
M v[208:211], a[80:83], v[48:51], v[208:211]
 buffer_store_dwordx4 v[164:167], v7, s[8:11], s14 offen offset:2048 sc1
M v[208:211], a[84:87], v[56:59], v[208:211]
 ds_read_b128 a[120:123], v7 offset:30720
 v_cvt_pk_bf16_f32 v176, v176, v177
M v[212:215], a[84:87], v[60:63], v[212:215]
 ds_read_b128 a[124:127], v7 offset:31744
 v_cvt_pk_bf16_f32 v177, v178, v179
M v[212:215], a[80:83], v[52:55], v[212:215]
 v_cvt_pk_bf16_f32 v178, v184, v185
 v_cvt_pk_bf16_f32 v179, v186, v187
M v[220:223], a[88:91], v[52:55], v[220:223]
 buffer_store_dwordx4 v[176:179], v7, s[8:11], s12 offen offset:3072 sc1
M v[220:223], a[92:95], v[60:63], v[220:223]
 v_cvt_pk_bf16_f32 v180, v180, v181
 v_cvt_pk_bf16_f32 v181, v182, v183
M v[216:219], a[92:95], v[56:59], v[216:219]
 s_waitcnt lgkmcnt(0)
 v_cvt_pk_bf16_f32 v182, v188, v189
 v_cvt_pk_bf16_f32 v183, v190, v191
M v[216:219], a[88:91], v[48:51], v[216:219]
 s_barrier
M v[224:227], a[96:99], v[48:51], v[224:227]
 ds_read_b128 a[64:67], v2 offset:32768
M v[224:227], a[100:103], v[56:59], v[224:227]
 ds_read_b128 a[68:71], v2 offset:33792
M v[228:231], a[100:103], v[60:63], v[228:231]
 buffer_store_dwordx4 v[180:183], v7, s[8:11], s14 offen offset:3072 sc1
M v[228:231], a[96:99], v[52:55], v[228:231]
 ds_read_b128 a[72:75], v2 offset:34816
 v_cvt_pk_bf16_f32 v192, v192, v193
M v[236:239], a[104:107], v[52:55], v[236:239]
 ds_read_b128 a[76:79], v2 offset:35840
 v_cvt_pk_bf16_f32 v193, v194, v195
M v[236:239], a[108:111], v[60:63], v[236:239]
 v_cvt_pk_bf16_f32 v194, v200, v201
 v_cvt_pk_bf16_f32 v195, v202, v203
M v[232:235], a[108:111], v[56:59], v[232:235]
 ds_read_b128 a[80:83], v2 offset:36864
M v[232:235], a[104:107], v[48:51], v[232:235]
 ds_read_b128 a[84:87], v2 offset:37888
M v[240:243], a[112:115], v[48:51], v[240:243]
 buffer_store_dwordx4 v[192:195], v7, s[8:11], s13 offen offset:0 sc1
M v[240:243], a[116:119], v[56:59], v[240:243]
 ds_read_b128 a[88:91], v2 offset:38912
 v_cvt_pk_bf16_f32 v196, v196, v197
M v[244:247], a[116:119], v[60:63], v[244:247]
 ds_read_b128 a[92:95], v2 offset:39936
 v_cvt_pk_bf16_f32 v197, v198, v199
M v[244:247], a[112:115], v[52:55], v[244:247]
 v_cvt_pk_bf16_f32 v198, v204, v205
 v_cvt_pk_bf16_f32 v199, v206, v207
M v[252:255], a[120:123], v[52:55], v[252:255]
 buffer_store_dwordx4 v[196:199], v7, s[8:11], s15 offen offset:0 sc1
M v[252:255], a[124:127], v[60:63], v[252:255]
 v_cvt_pk_bf16_f32 v208, v208, v209
 v_cvt_pk_bf16_f32 v209, v210, v211
M v[248:251], a[124:127], v[56:59], v[248:251]
 s_waitcnt lgkmcnt(0)
 v_cvt_pk_bf16_f32 v210, v216, v217
 v_cvt_pk_bf16_f32 v211, v218, v219
M v[248:251], a[120:123], v[48:51], v[248:251]
 buffer_store_dwordx4 v[208:211], v7, s[8:11], s13 offen offset:1024 sc1
 v_cvt_pk_bf16_f32 v212, v212, v213
 v_cvt_pk_bf16_f32 v213, v214, v215
 v_cvt_pk_bf16_f32 v214, v220, v221
 v_cvt_pk_bf16_f32 v215, v222, v223
 buffer_store_dwordx4 v[212:215], v7, s[8:11], s15 offen offset:1024 sc1
 v_cvt_pk_bf16_f32 v224, v224, v225
 v_cvt_pk_bf16_f32 v225, v226, v227
 v_cvt_pk_bf16_f32 v226, v232, v233
 v_cvt_pk_bf16_f32 v227, v234, v235
 buffer_store_dwordx4 v[224:227], v7, s[8:11], s13 offen offset:2048 sc1
 v_cvt_pk_bf16_f32 v228, v228, v229
 v_cvt_pk_bf16_f32 v229, v230, v231
 v_cvt_pk_bf16_f32 v230, v236, v237
 v_cvt_pk_bf16_f32 v231, v238, v239
 buffer_store_dwordx4 v[228:231], v7, s[8:11], s15 offen offset:2048 sc1
 v_cvt_pk_bf16_f32 v240, v240, v241
 v_cvt_pk_bf16_f32 v241, v242, v243
 v_cvt_pk_bf16_f32 v242, v248, v249
 v_cvt_pk_bf16_f32 v243, v250, v251
 buffer_store_dwordx4 v[240:243], v7, s[8:11], s13 offen offset:3072 sc1
 v_cvt_pk_bf16_f32 v244, v244, v245
 v_cvt_pk_bf16_f32 v245, v246, v247
 v_cvt_pk_bf16_f32 v246, v252, v253
 v_cvt_pk_bf16_f32 v247, v254, v255
 buffer_store_dwordx4 v[244:247], v7, s[8:11], s15 offen offset:3072 sc1
M v[64:67], a[64:67], a[128:131], 0
 ds_read_b128 a[96:99], v2 offset:40960
M v[64:67], a[68:71], a[132:135], v[64:67]
 s_add_u32 m0, s28, 0
 ds_read_b128 a[100:103], v2 offset:41984
M v[64:67], a[72:75], a[136:139], v[64:67]
 buffer_load_dwordx4 v3, s[8:11], s38 offen offset:0 sc1 lds
M v[64:67], a[76:79], a[140:143], v[64:67]
 ds_read_b128 a[104:107], v2 offset:43008
 v_accvgpr_read_b32 v5, a192
M v[64:67], a[80:83], a[144:147], v[64:67]
 ds_read_b128 a[108:111], v2 offset:44032
 v_accvgpr_read_b32 v6, a193
M v[64:67], a[84:87], a[148:151], v[64:67]
 buffer_load_dwordx4 v3, s[8:11], s38 offen offset:1024 sc1 lds
M v[64:67], a[88:91], a[152:155], v[64:67]
 ds_read_b128 a[112:115], v2 offset:45056
M v[64:67], a[92:95], a[156:159], v[64:67]
 ds_read_b128 a[116:119], v2 offset:46080
M v[68:71], a[92:95], a[188:191], 0
 buffer_load_dwordx4 v3, s[8:11], s38 offen offset:2048 sc1 lds
M v[68:71], a[88:91], a[184:187], v[68:71]
 ds_read_b128 a[120:123], v2 offset:47104
M v[68:71], a[84:87], a[180:183], v[68:71]
 ds_read_b128 a[124:127], v2 offset:48128
M v[68:71], a[80:83], a[176:179], v[68:71]
M v[68:71], a[76:79], a[172:175], v[68:71]
 buffer_load_dwordx4 v3, s[8:11], s38 offen offset:3072 sc1 lds
M v[68:71], a[72:75], a[168:171], v[68:71]
M v[68:71], a[68:71], a[164:167], v[68:71]
M v[68:71], a[64:67], a[160:163], v[68:71]
 s_waitcnt lgkmcnt(0)
M v[76:79], a[96:99], a[160:163], 0
 ds_read_b128 a[64:67], v2 offset:49152
M v[76:79], a[100:103], a[164:167], v[76:79]
 s_add_u32 m0, s28, 4096
 ds_read_b128 a[68:71], v2 offset:50176
M v[76:79], a[104:107], a[168:171], v[76:79]
 buffer_load_dwordx4 v4, s[8:11], s38 offen offset:0 sc1 lds
M v[76:79], a[108:111], a[172:175], v[76:79]
 ds_read_b128 a[72:75], v2 offset:51200
M v[76:79], a[112:115], a[176:179], v[76:79]
 s_xor_b32 s47, s47, 64
 ds_read_b128 a[76:79], v2 offset:52224
M v[76:79], a[116:119], a[180:183], v[76:79]
 v_mov_b32 v18, 1
 v_min_u32 v19, 1, v7
M v[76:79], a[120:123], a[184:187], v[76:79]
 ds_read_b128 a[80:83], v2 offset:53248
 v_lshlrev_b32 v19, 29, v19
M v[76:79], a[124:127], a[188:191], v[76:79]
 s_waitcnt vmcnt(5)
 ds_read_b128 a[84:87], v2 offset:54272
M v[72:75], a[124:127], a[156:159], 0
 buffer_store_dword v18, v19, s[8:11], s47 offen sc1
M v[72:75], a[120:123], a[152:155], v[72:75]
 ds_read_b128 a[88:91], v2 offset:55296
M v[72:75], a[116:119], a[148:151], v[72:75]
 ds_read_b128 a[92:95], v2 offset:56320
M v[72:75], a[112:115], a[144:147], v[72:75]
 buffer_load_dwordx4 v4, s[8:11], s38 offen offset:1024 sc1 lds
M v[72:75], a[108:111], a[140:143], v[72:75]
M v[72:75], a[104:107], a[136:139], v[72:75]
 buffer_load_dwordx4 v4, s[8:11], s38 offen offset:2048 sc1 lds
M v[72:75], a[100:103], a[132:135], v[72:75]
 s_lshl_b32 s64, s20, 1
 s_lshr_b32 s64, s101, s64
M v[72:75], a[96:99], a[128:131], v[72:75]
 s_waitcnt lgkmcnt(0)
 s_lshr_b32 s93, s64, 1
M v[80:83], a[64:67], a[128:131], 0
 s_xor_b32 s64, s64, s93
 ds_read_b128 a[96:99], v2 offset:57344
M v[80:83], a[68:71], a[132:135], v[80:83]
 s_and_b32 s64, s64, 1
 ds_read_b128 a[100:103], v2 offset:58368
 s_lshl_b32 s64, s64, 13
M v[80:83], a[72:75], a[136:139], v[80:83]
 buffer_load_dwordx4 v4, s[8:11], s38 offen offset:3072 sc1 lds
M v[80:83], a[76:79], a[140:143], v[80:83]
 s_add_u32 s38, s38, 65536
 ds_read_b128 a[104:107], v2 offset:59392
 s_xor_b32 s93, s33, s64
M v[80:83], a[80:83], a[144:147], v[80:83]
 s_add_u32 m0, s28, 131072
 ds_read_b128 a[108:111], v2 offset:60416
 s_add_u32 s93, s93, 32768
M v[80:83], a[84:87], a[148:151], v[80:83]
 buffer_load_dwordx4 v3, s[8:11], s38 offen offset:0 sc1 lds
M v[80:83], a[88:91], a[152:155], v[80:83]
 ds_read_b128 a[112:115], v2 offset:61440
M v[80:83], a[92:95], a[156:159], v[80:83]
 ds_read_b128 a[116:119], v2 offset:62464
 v_max3_f32 v32, |v64|, |v65|, |v66|
M v[84:87], a[92:95], a[188:191], 0
 buffer_load_dwordx4 v3, s[8:11], s38 offen offset:1024 sc1 lds
M v[84:87], a[88:91], a[184:187], v[84:87]
 ds_read_b128 a[120:123], v2 offset:63488
 v_max3_f32 v32, |v67|, |v72|, v32
M v[84:87], a[84:87], a[180:183], v[84:87]
 ds_read_b128 a[124:127], v2 offset:64512
M v[84:87], a[80:83], a[176:179], v[84:87]
 buffer_load_dwordx4 v3, s[8:11], s38 offen offset:2048 sc1 lds
M v[84:87], a[76:79], a[172:175], v[84:87]
 v_max3_f32 v32, |v73|, |v74|, v32
 v_mul_f32 v32, 2.0, v32
M v[84:87], a[72:75], a[168:171], v[84:87]
 buffer_load_dwordx4 v3, s[8:11], s38 offen offset:3072 sc1 lds
M v[84:87], a[68:71], a[164:167], v[84:87]
 s_waitcnt lgkmcnt(0)
 v_mov_b32 v33, v32
 v_mov_b32 v34, v32
M v[84:87], a[64:67], a[160:163], v[84:87]
 s_barrier
M v[92:95], a[96:99], a[160:163], 0
 ds_read_b128 a[64:67], v7 offset:32768
M v[92:95], a[100:103], a[164:167], v[92:95]
 s_add_u32 m0, s28, 135168
 ds_read_b128 a[68:71], v7 offset:33792
 v_mov_b32 v35, v32
M v[92:95], a[104:107], a[168:171], v[92:95]
 buffer_load_dwordx4 v4, s[8:11], s38 offen offset:0 sc1 lds
M v[92:95], a[108:111], a[172:175], v[92:95]
 ds_read_b128 a[72:75], v7 offset:34816
M v[92:95], a[112:115], a[176:179], v[92:95]
 ds_read_b128 a[76:79], v7 offset:35840
 v_max3_f32 v36, |v68|, |v69|, |v70|
M v[92:95], a[116:119], a[180:183], v[92:95]
 buffer_load_dwordx4 v4, s[8:11], s38 offen offset:1024 sc1 lds
M v[92:95], a[120:123], a[184:187], v[92:95]
 ds_read_b128 a[80:83], v7 offset:36864
 v_max3_f32 v36, |v71|, |v76|, v36
M v[92:95], a[124:127], a[188:191], v[92:95]
 ds_read_b128 a[84:87], v7 offset:37888
M v[88:91], a[124:127], a[156:159], 0
 buffer_load_dwordx4 v4, s[8:11], s38 offen offset:2048 sc1 lds
M v[88:91], a[120:123], a[152:155], v[88:91]
 ds_read_b128 a[88:91], v7 offset:38912
 v_max3_f32 v36, |v77|, |v78|, v36
M v[88:91], a[116:119], a[148:151], v[88:91]
 ds_read_b128 a[92:95], v7 offset:39936
 v_mul_f32 v36, 2.0, v36
M v[88:91], a[112:115], a[144:147], v[88:91]
 buffer_load_dwordx4 v4, s[8:11], s38 offen offset:3072 sc1 lds
M v[88:91], a[108:111], a[140:143], v[88:91]
 s_add_u32 s38, s38, 65536
 v_mov_b32 v37, v36
M v[88:91], a[104:107], a[136:139], v[88:91]
 v_mov_b32 v38, v36
 v_mov_b32 v39, v36
M v[88:91], a[100:103], a[132:135], v[88:91]
 s_waitcnt lgkmcnt(0)
M v[88:91], a[96:99], a[128:131], v[88:91]
M v[96:99], a[64:67], a[128:131], v[32:35]
 s_add_u32 m0, s28, 98304
 ds_read_b128 a[96:99], v7 offset:40960
M v[96:99], a[68:71], a[132:135], v[96:99]
 ds_read_b128 a[100:103], v7 offset:41984
M v[96:99], a[72:75], a[136:139], v[96:99]
 buffer_load_dwordx4 v3, s[8:11], s38 offen offset:0 sc1 lds
M v[96:99], a[76:79], a[140:143], v[96:99]
 ds_read_b128 a[104:107], v7 offset:43008
 s_add_u32 s29, s33, 0
M v[96:99], a[80:83], a[144:147], v[96:99]
 ds_read_b128 a[108:111], v7 offset:44032
 s_add_u32 s30, s93, 0
M v[96:99], a[84:87], a[148:151], v[96:99]
 buffer_load_dwordx4 v3, s[8:11], s38 offen offset:1024 sc1 lds
M v[96:99], a[88:91], a[152:155], v[96:99]
 ds_read_b128 a[112:115], v7 offset:45056
 v_mul_f32 v28, -v32, v5
M v[96:99], a[92:95], a[156:159], v[96:99]
 ds_read_b128 a[116:119], v7 offset:46080
 v_mul_f32 v64, v5, v64
M v[100:103], a[92:95], a[188:191], v[36:39]
 buffer_load_dwordx4 v3, s[8:11], s38 offen offset:2048 sc1 lds
M v[100:103], a[88:91], a[184:187], v[100:103]
 ds_read_b128 a[120:123], v7 offset:47104
 v_mul_f32 v65, v5, v65
M v[100:103], a[84:87], a[180:183], v[100:103]
 ds_read_b128 a[124:127], v7 offset:48128
 v_mul_f32 v66, v5, v66
M v[100:103], a[80:83], a[176:179], v[100:103]
 buffer_load_dwordx4 v3, s[8:11], s38 offen offset:3072 sc1 lds
M v[100:103], a[76:79], a[172:175], v[100:103]
 s_add_u32 m0, s28, 102400
 v_mul_f32 v67, v5, v67
 v_mul_f32 v72, v5, v72
M v[100:103], a[72:75], a[168:171], v[100:103]
 buffer_load_dwordx4 v4, s[8:11], s38 offen offset:0 sc1 lds
M v[100:103], a[68:71], a[164:167], v[100:103]
 v_mul_f32 v73, v5, v73
 v_mul_f32 v74, v5, v74
M v[100:103], a[64:67], a[160:163], v[100:103]
 s_waitcnt lgkmcnt(0)
 v_mul_f32 v75, v5, v75
 v_cvt_pk_bf16_f32 v64, v64, v65
M v[108:111], a[96:99], a[160:163], v[36:39]
 ds_read_b128 a[64:67], v7 offset:49152
 v_cvt_pk_bf16_f32 v65, v66, v67
M v[108:111], a[100:103], a[164:167], v[108:111]
 ds_read_b128 a[68:71], v7 offset:50176
 v_cvt_pk_bf16_f32 v66, v72, v73
M v[108:111], a[104:107], a[168:171], v[108:111]
 buffer_load_dwordx4 v4, s[8:11], s38 offen offset:1024 sc1 lds
M v[108:111], a[108:111], a[172:175], v[108:111]
 ds_read_b128 a[72:75], v7 offset:51200
 v_cvt_pk_bf16_f32 v67, v74, v75
M v[108:111], a[112:115], a[176:179], v[108:111]
 ds_read_b128 a[76:79], v7 offset:52224
M v[108:111], a[116:119], a[180:183], v[108:111]
 buffer_load_dwordx4 v4, s[8:11], s38 offen offset:2048 sc1 lds
M v[108:111], a[120:123], a[184:187], v[108:111]
 ds_read_b128 a[80:83], v7 offset:53248
M v[108:111], a[124:127], a[188:191], v[108:111]
 ds_read_b128 a[84:87], v7 offset:54272
M v[104:107], a[124:127], a[156:159], v[32:35]
 buffer_load_dwordx4 v4, s[8:11], s38 offen offset:3072 sc1 lds
M v[104:107], a[120:123], a[152:155], v[104:107]
 s_add_u32 s38, s38, 65536
 ds_read_b128 a[88:91], v7 offset:55296
M v[104:107], a[116:119], a[148:151], v[104:107]
 ds_read_b128 a[92:95], v7 offset:56320
M v[104:107], a[112:115], a[144:147], v[104:107]
 buffer_store_dwordx4 v[64:67], v7, s[8:11], s29 offen offset:0 sc1
M v[104:107], a[108:111], a[140:143], v[104:107]
 v_mul_f32 v29, -v36, v6
 v_mul_f32 v68, v6, v68
M v[104:107], a[104:107], a[136:139], v[104:107]
 v_mul_f32 v69, v6, v69
 v_mul_f32 v70, v6, v70
M v[104:107], a[100:103], a[132:135], v[104:107]
 v_mul_f32 v71, v6, v71
 v_mul_f32 v76, v6, v76
M v[104:107], a[96:99], a[128:131], v[104:107]
 s_waitcnt lgkmcnt(0)
 v_mul_f32 v77, v6, v77
 v_mul_f32 v78, v6, v78
M v[112:115], a[64:67], a[128:131], v[32:35]
 ds_read_b128 a[96:99], v7 offset:57344
 v_mul_f32 v79, v6, v79
M v[112:115], a[68:71], a[132:135], v[112:115]
 ds_read_b128 a[100:103], v7 offset:58368
 v_cvt_pk_bf16_f32 v68, v68, v69
M v[112:115], a[72:75], a[136:139], v[112:115]
 v_cvt_pk_bf16_f32 v69, v70, v71
 v_cvt_pk_bf16_f32 v70, v76, v77
M v[112:115], a[76:79], a[140:143], v[112:115]
 ds_read_b128 a[104:107], v7 offset:59392
 v_cvt_pk_bf16_f32 v71, v78, v79
M v[112:115], a[80:83], a[144:147], v[112:115]
 ds_read_b128 a[108:111], v7 offset:60416
M v[112:115], a[84:87], a[148:151], v[112:115]
 buffer_store_dwordx4 v[68:71], v7, s[8:11], s30 offen offset:0 sc1
M v[112:115], a[88:91], a[152:155], v[112:115]
 ds_read_b128 a[112:115], v7 offset:61440
 v_mul_f32 v80, v5, v80
M v[112:115], a[92:95], a[156:159], v[112:115]
 ds_read_b128 a[116:119], v7 offset:62464
 v_mul_f32 v81, v5, v81
M v[116:119], a[92:95], a[188:191], v[36:39]
 v_mul_f32 v82, v5, v82
 v_mul_f32 v83, v5, v83
M v[116:119], a[88:91], a[184:187], v[116:119]
 ds_read_b128 a[120:123], v7 offset:63488
 v_mul_f32 v88, v5, v88
M v[116:119], a[84:87], a[180:183], v[116:119]
 ds_read_b128 a[124:127], v7 offset:64512
 v_mul_f32 v89, v5, v89
M v[116:119], a[80:83], a[176:179], v[116:119]
 v_mul_f32 v90, v5, v90
 v_mul_f32 v91, v5, v91
M v[116:119], a[76:79], a[172:175], v[116:119]
 v_cvt_pk_bf16_f32 v80, v80, v81
 v_cvt_pk_bf16_f32 v81, v82, v83
M v[116:119], a[72:75], a[168:171], v[116:119]
 v_cvt_pk_bf16_f32 v82, v88, v89
 v_cvt_pk_bf16_f32 v83, v90, v91
M v[116:119], a[68:71], a[164:167], v[116:119]
 s_waitcnt lgkmcnt(0)
M v[116:119], a[64:67], a[160:163], v[116:119]
 s_barrier
M v[124:127], a[96:99], a[160:163], v[36:39]
 ds_read_b128 a[64:67], v2 offset:0
M v[124:127], a[100:103], a[164:167], v[124:127]
 ds_read_b128 a[68:71], v2 offset:1024
M v[124:127], a[104:107], a[168:171], v[124:127]
 buffer_store_dwordx4 v[80:83], v7, s[8:11], s29 offen offset:1024 sc1
M v[124:127], a[108:111], a[172:175], v[124:127]
 ds_read_b128 a[72:75], v2 offset:2048
 v_mul_f32 v84, v6, v84
M v[124:127], a[112:115], a[176:179], v[124:127]
 ds_read_b128 a[76:79], v2 offset:3072
 v_mul_f32 v85, v6, v85
M v[124:127], a[116:119], a[180:183], v[124:127]
 v_mul_f32 v86, v6, v86
 v_mul_f32 v87, v6, v87
M v[124:127], a[120:123], a[184:187], v[124:127]
 ds_read_b128 a[80:83], v2 offset:4096
 v_mul_f32 v92, v6, v92
M v[124:127], a[124:127], a[188:191], v[124:127]
 ds_read_b128 a[84:87], v2 offset:5120
 v_mul_f32 v93, v6, v93
M v[120:123], a[124:127], a[156:159], v[32:35]
 v_mul_f32 v94, v6, v94
 v_mul_f32 v95, v6, v95
M v[120:123], a[120:123], a[152:155], v[120:123]
 ds_read_b128 a[88:91], v2 offset:6144
 v_cvt_pk_bf16_f32 v84, v84, v85
M v[120:123], a[116:119], a[148:151], v[120:123]
 ds_read_b128 a[92:95], v2 offset:7168
 v_cvt_pk_bf16_f32 v85, v86, v87
M v[120:123], a[112:115], a[144:147], v[120:123]
 v_cvt_pk_bf16_f32 v86, v92, v93
 v_cvt_pk_bf16_f32 v87, v94, v95
M v[120:123], a[108:111], a[140:143], v[120:123]
 buffer_store_dwordx4 v[84:87], v7, s[8:11], s30 offen offset:1024 sc1
M v[120:123], a[104:107], a[136:139], v[120:123]
M v[120:123], a[100:103], a[132:135], v[120:123]
 s_waitcnt lgkmcnt(0)
M v[120:123], a[96:99], a[128:131], v[120:123]
M v[64:67], a[64:67], a[128:131], v[32:35]
 s_add_u32 m0, s28, 32768
 ds_read_b128 a[96:99], v2 offset:8192
M v[64:67], a[68:71], a[132:135], v[64:67]
 ds_read_b128 a[100:103], v2 offset:9216
 s_and_b32 s79, s101, 1
M v[64:67], a[72:75], a[136:139], v[64:67]
 buffer_load_dwordx4 v3, s[8:11], s38 offen offset:0 sc1 lds
M v[64:67], a[76:79], a[140:143], v[64:67]
 ds_read_b128 a[104:107], v2 offset:10240
 s_lshl_b32 s79, s79, 13
M v[64:67], a[80:83], a[144:147], v[64:67]
 s_add_u32 s79, s79, 234946560
 ds_read_b128 a[108:111], v2 offset:11264
 s_add_u32 s29, s33, 2048
M v[64:67], a[84:87], a[148:151], v[64:67]
 buffer_load_dwordx4 v3, s[8:11], s38 offen offset:1024 sc1 lds
M v[64:67], a[88:91], a[152:155], v[64:67]
 ds_read_b128 a[112:115], v2 offset:12288
 s_add_u32 s30, s93, 2048
M v[64:67], a[92:95], a[156:159], v[64:67]
 ds_read_b128 a[116:119], v2 offset:13312
 v_fma_f32 v96, v96, v5, v28
M v[68:71], a[92:95], a[188:191], v[36:39]
 buffer_load_dwordx4 v3, s[8:11], s38 offen offset:2048 sc1 lds
M v[68:71], a[88:91], a[184:187], v[68:71]
 ds_read_b128 a[120:123], v2 offset:14336
 v_fma_f32 v97, v97, v5, v28
M v[68:71], a[84:87], a[180:183], v[68:71]
 ds_read_b128 a[124:127], v2 offset:15360
 v_fma_f32 v98, v98, v5, v28
M v[68:71], a[80:83], a[176:179], v[68:71]
 buffer_load_dwordx4 v3, s[8:11], s38 offen offset:3072 sc1 lds
M v[68:71], a[76:79], a[172:175], v[68:71]
 s_add_u32 m0, s28, 36864
 v_fma_f32 v99, v99, v5, v28
 v_fma_f32 v104, v104, v5, v28
M v[68:71], a[72:75], a[168:171], v[68:71]
 buffer_load_dwordx4 v4, s[8:11], s38 offen offset:0 sc1 lds
M v[68:71], a[68:71], a[164:167], v[68:71]
 buffer_load_dword v24, off, s[8:11], s79 sc1
M v[68:71], a[64:67], a[160:163], v[68:71]
 s_waitcnt lgkmcnt(0)
 v_lshrrev_b32 v0, 4, v7
 v_and_b32 v14, 15, v0
M v[76:79], a[96:99], a[160:163], v[36:39]
 ds_read_b128 a[64:67], v2 offset:16384
 v_lshlrev_b32 v14, 2, v14
M v[76:79], a[100:103], a[164:167], v[76:79]
 ds_read_b128 a[68:71], v2 offset:17408
 v_lshrrev_b32 v11, 4, v0
M v[76:79], a[104:107], a[168:171], v[76:79]
 buffer_load_dwordx4 v4, s[8:11], s38 offen offset:1024 sc1 lds
M v[76:79], a[108:111], a[172:175], v[76:79]
 ds_read_b128 a[72:75], v2 offset:18432
 s_mov_b32 s52, s96
M v[76:79], a[112:115], a[176:179], v[76:79]
 s_and_b32 s53, s97, 0xffff
 ds_read_b128 a[76:79], v2 offset:19456
 s_mov_b32 s54, 1835008
M v[76:79], a[116:119], a[180:183], v[76:79]
 buffer_load_dwordx4 v4, s[8:11], s38 offen offset:2048 sc1 lds
M v[76:79], a[120:123], a[184:187], v[76:79]
 ds_read_b128 a[80:83], v2 offset:20480
 s_mov_b32 s55, 0x20000
M v[76:79], a[124:127], a[188:191], v[76:79]
 s_lshr_b32 s74, s41, 3
 ds_read_b128 a[84:87], v2 offset:21504
 s_xor_b32 s74, s74, 0
M v[72:75], a[124:127], a[156:159], v[32:35]
 buffer_load_dwordx4 v4, s[8:11], s38 offen offset:3072 sc1 lds
M v[72:75], a[120:123], a[152:155], v[72:75]
 s_add_u32 s38, s38, 65536
 ds_read_b128 a[88:91], v2 offset:22528
 s_mul_i32 s67, s74, -2
M v[72:75], a[116:119], a[148:151], v[72:75]
 s_mul_i32 s74, s74, 8
 ds_read_b128 a[92:95], v2 offset:23552
 v_fma_f32 v105, v105, v5, v28
M v[72:75], a[112:115], a[144:147], v[72:75]
 s_add_u32 s74, s74, s20
 v_fma_f32 v106, v106, v5, v28
 v_fma_f32 v107, v107, v5, v28
M v[72:75], a[108:111], a[140:143], v[72:75]
 s_lshl_b32 s75, s74, 6
 v_cvt_pk_bf16_f32 v96, v96, v97
 v_cvt_pk_bf16_f32 v97, v98, v99
M v[72:75], a[104:107], a[136:139], v[72:75]
 s_add_u32 s76, s75, 256
 v_cvt_pk_bf16_f32 v98, v104, v105
 v_cvt_pk_bf16_f32 v99, v106, v107
M v[72:75], a[100:103], a[132:135], v[72:75]
 s_add_u32 s67, s67, 3
 v_add_u32 v43, 0x20000, v7
 s_sub_u32 s67, s67, s20
M v[72:75], a[96:99], a[128:131], v[72:75]
 s_waitcnt lgkmcnt(0)
 s_and_b32 s67, s67, 536870912
M v[80:83], a[64:67], a[128:131], v[32:35]
 s_or_b32 s76, s76, s67
 ds_read_b128 a[96:99], v2 offset:24576
 v_or_b32 v27, s67, v7
M v[80:83], a[68:71], a[132:135], v[80:83]
 ds_read_b128 a[100:103], v2 offset:25600
 v_add_u32 v27, 4096, v27
M v[80:83], a[72:75], a[136:139], v[80:83]
 buffer_store_dwordx4 v[96:99], v7, s[8:11], s29 offen offset:0 sc1
M v[80:83], a[76:79], a[140:143], v[80:83]
 ds_read_b128 a[104:107], v2 offset:26624
 v_fma_f32 v100, v100, v6, v29
M v[80:83], a[80:83], a[144:147], v[80:83]
 ds_read_b128 a[108:111], v2 offset:27648
 v_fma_f32 v101, v101, v6, v29
M v[80:83], a[84:87], a[148:151], v[80:83]
 v_fma_f32 v102, v102, v6, v29
 v_fma_f32 v103, v103, v6, v29
M v[80:83], a[88:91], a[152:155], v[80:83]
 ds_read_b128 a[112:115], v2 offset:28672
 v_fma_f32 v108, v108, v6, v29
M v[80:83], a[92:95], a[156:159], v[80:83]
 ds_read_b128 a[116:119], v2 offset:29696
 v_fma_f32 v109, v109, v6, v29
M v[84:87], a[92:95], a[188:191], v[36:39]
 v_fma_f32 v110, v110, v6, v29
 v_fma_f32 v111, v111, v6, v29
M v[84:87], a[88:91], a[184:187], v[84:87]
 ds_read_b128 a[120:123], v2 offset:30720
 v_cvt_pk_bf16_f32 v100, v100, v101
M v[84:87], a[84:87], a[180:183], v[84:87]
 ds_read_b128 a[124:127], v2 offset:31744
 v_cvt_pk_bf16_f32 v101, v102, v103
M v[84:87], a[80:83], a[176:179], v[84:87]
 v_cvt_pk_bf16_f32 v102, v108, v109
 v_cvt_pk_bf16_f32 v103, v110, v111
M v[84:87], a[76:79], a[172:175], v[84:87]
 buffer_store_dwordx4 v[100:103], v7, s[8:11], s30 offen offset:0 sc1
M v[84:87], a[72:75], a[168:171], v[84:87]
 v_fma_f32 v112, v112, v5, v28
 v_fma_f32 v113, v113, v5, v28
M v[84:87], a[68:71], a[164:167], v[84:87]
 s_waitcnt vmcnt(31) lgkmcnt(0)
 v_fma_f32 v114, v114, v5, v28
 v_fma_f32 v115, v115, v5, v28
M v[84:87], a[64:67], a[160:163], v[84:87]
 s_barrier
M v[92:95], a[96:99], a[160:163], v[36:39]
 ds_read_b128 a[64:67], v7 offset:0
 v_fma_f32 v120, v120, v5, v28
M v[92:95], a[100:103], a[164:167], v[92:95]
 ds_read_b128 a[68:71], v7 offset:1024
 v_fma_f32 v121, v121, v5, v28
M v[92:95], a[104:107], a[168:171], v[92:95]
 v_fma_f32 v122, v122, v5, v28
 v_fma_f32 v123, v123, v5, v28
M v[92:95], a[108:111], a[172:175], v[92:95]
 ds_read_b128 a[72:75], v7 offset:2048
 v_cvt_pk_bf16_f32 v112, v112, v113
M v[92:95], a[112:115], a[176:179], v[92:95]
 ds_read_b128 a[76:79], v7 offset:3072
 v_cvt_pk_bf16_f32 v113, v114, v115
M v[92:95], a[116:119], a[180:183], v[92:95]
 v_cvt_pk_bf16_f32 v114, v120, v121
 v_cvt_pk_bf16_f32 v115, v122, v123
M v[92:95], a[120:123], a[184:187], v[92:95]
 ds_read_b128 a[80:83], v7 offset:4096
M v[92:95], a[124:127], a[188:191], v[92:95]
 ds_read_b128 a[84:87], v7 offset:5120
M v[88:91], a[124:127], a[156:159], v[32:35]
 buffer_store_dwordx4 v[112:115], v7, s[8:11], s29 offen offset:1024 sc1
M v[88:91], a[120:123], a[152:155], v[88:91]
 ds_read_b128 a[88:91], v7 offset:6144
 v_fma_f32 v116, v116, v6, v29
M v[88:91], a[116:119], a[148:151], v[88:91]
 ds_read_b128 a[92:95], v7 offset:7168
 v_fma_f32 v117, v117, v6, v29
M v[88:91], a[112:115], a[144:147], v[88:91]
 v_fma_f32 v118, v118, v6, v29
 v_fma_f32 v119, v119, v6, v29
M v[88:91], a[108:111], a[140:143], v[88:91]
 v_fma_f32 v124, v124, v6, v29
 v_fma_f32 v125, v125, v6, v29
M v[88:91], a[104:107], a[136:139], v[88:91]
 v_fma_f32 v126, v126, v6, v29
 v_fma_f32 v127, v127, v6, v29
M v[88:91], a[100:103], a[132:135], v[88:91]
 s_waitcnt lgkmcnt(0)
 v_cvt_pk_bf16_f32 v116, v116, v117
 v_cvt_pk_bf16_f32 v117, v118, v119
M v[88:91], a[96:99], a[128:131], v[88:91]
 v_cvt_pk_bf16_f32 v118, v124, v125
 v_cvt_pk_bf16_f32 v119, v126, v127
 buffer_store_dwordx4 v[116:119], v7, s[8:11], s30 offen offset:1024 sc1
M v[96:99], a[64:67], a[128:131], v[32:35]
 ds_read_b128 a[96:99], v7 offset:8192
M v[96:99], a[68:71], a[132:135], v[96:99]
 ds_read_b128 a[100:103], v7 offset:9216
M v[96:99], a[72:75], a[136:139], v[96:99]
 s_sub_u32 s64, 15, s42
M v[96:99], a[76:79], a[140:143], v[96:99]
 s_min_u32 s64, s64, s42
 ds_read_b128 a[104:107], v7 offset:10240
 s_add_u32 s29, s33, 4096
M v[96:99], a[80:83], a[144:147], v[96:99]
 s_mul_i32 s45, s64, 33024
 ds_read_b128 a[108:111], v7 offset:11264
 s_add_u32 s30, s93, 4096
M v[96:99], a[84:87], a[148:151], v[96:99]
 s_lshl_b32 s64, s20, 6
 v_fma_f32 v64, v64, v5, v28
 v_fma_f32 v65, v65, v5, v28
M v[96:99], a[88:91], a[152:155], v[96:99]
 s_add_u32 s64, s64, s41
 ds_read_b128 a[112:115], v7 offset:12288
 v_fma_f32 v66, v66, v5, v28
M v[96:99], a[92:95], a[156:159], v[96:99]
 s_lshl2_add_u32 s45, s64, s45
 ds_read_b128 a[116:119], v7 offset:13312
 v_fma_f32 v67, v67, v5, v28
M v[100:103], a[92:95], a[188:191], v[36:39]
 s_add_u32 s45, s45, 235210752
 v_fma_f32 v72, v72, v5, v28
M v[100:103], a[88:91], a[184:187], v[100:103]
 s_movk_i32 s65, 1024
 ds_read_b128 a[120:123], v7 offset:14336
 v_fma_f32 v73, v73, v5, v28
M v[100:103], a[84:87], a[180:183], v[100:103]
 s_cmp_lt_u32 s42, 8
 ds_read_b128 a[124:127], v7 offset:15360
 v_fma_f32 v74, v74, v5, v28
M v[100:103], a[80:83], a[176:179], v[100:103]
 s_cselect_b32 s64, 16512, s65
 v_fma_f32 v75, v75, v5, v28
M v[100:103], a[76:79], a[172:175], v[100:103]
 s_cselect_b32 s65, 0, 64
 v_cvt_pk_bf16_f32 v64, v64, v65
M v[100:103], a[72:75], a[168:171], v[100:103]
 s_cselect_b32 s66, 32, 64
 v_cvt_pk_bf16_f32 v65, v66, v67
M v[100:103], a[68:71], a[164:167], v[100:103]
 s_add_u32 s3, s45, s64
 s_add_u32 s45, s45, s65
 v_lshrrev_b32 v42, 5, v7
M v[100:103], a[64:67], a[160:163], v[100:103]
 s_waitcnt lgkmcnt(0)
 v_mul_u32_u24 v42, 16512, v42
 v_and_b32 v41, 16, v7
M v[108:111], a[96:99], a[160:163], v[36:39]
 ds_read_b128 a[64:67], v7 offset:16384
 v_lshl_add_u32 v41, v41, 3, v42
M v[108:111], a[100:103], a[164:167], v[108:111]
 s_lshl_b32 s65, s20, 1
 ds_read_b128 a[68:71], v7 offset:17408
 v_cvt_pk_bf16_f32 v66, v72, v73
M v[108:111], a[104:107], a[168:171], v[108:111]
 s_lshr_b32 s65, s101, s65
 v_bfe_u32 v42, v7, 4, 1
 v_lshrrev_b32 v42, v42, s65
M v[108:111], a[108:111], a[172:175], v[108:111]
 ds_read_b128 a[72:75], v7 offset:18432
 v_and_b32 v42, 1, v42
M v[108:111], a[112:115], a[176:179], v[108:111]
 ds_read_b128 a[76:79], v7 offset:19456
 v_lshl_add_u32 v41, v42, 13, v41
M v[108:111], a[116:119], a[180:183], v[108:111]
 v_mov_b32 v42, 536870912
 v_cmp_gt_u32 vcc, s66, v7
M v[108:111], a[120:123], a[184:187], v[108:111]
 ds_read_b128 a[80:83], v7 offset:20480
 v_mov_b32 v40, 1
M v[108:111], a[124:127], a[188:191], v[108:111]
 s_nop 0
 ds_read_b128 a[84:87], v7 offset:21504
 v_cndmask_b32 v41, v42, v41, vcc
M v[104:107], a[124:127], a[156:159], v[32:35]
 v_cvt_pk_bf16_f32 v67, v74, v75
M v[104:107], a[120:123], a[152:155], v[104:107]
 ds_read_b128 a[88:91], v7 offset:22528
M v[104:107], a[116:119], a[148:151], v[104:107]
 ds_read_b128 a[92:95], v7 offset:23552
M v[104:107], a[112:115], a[144:147], v[104:107]
 buffer_store_dwordx4 v[64:67], v7, s[8:11], s29 offen offset:0 sc1
M v[104:107], a[108:111], a[140:143], v[104:107]
 v_fma_f32 v68, v68, v6, v29
 v_fma_f32 v69, v69, v6, v29
M v[104:107], a[104:107], a[136:139], v[104:107]
 v_fma_f32 v70, v70, v6, v29
 v_fma_f32 v71, v71, v6, v29
M v[104:107], a[100:103], a[132:135], v[104:107]
 v_fma_f32 v76, v76, v6, v29
 v_fma_f32 v77, v77, v6, v29
M v[104:107], a[96:99], a[128:131], v[104:107]
 s_waitcnt lgkmcnt(0)
 v_fma_f32 v78, v78, v6, v29
 v_fma_f32 v79, v79, v6, v29
M v[112:115], a[64:67], a[128:131], v[32:35]
 ds_read_b128 a[96:99], v7 offset:24576
 v_cvt_pk_bf16_f32 v68, v68, v69
M v[112:115], a[68:71], a[132:135], v[112:115]
 ds_read_b128 a[100:103], v7 offset:25600
 v_cvt_pk_bf16_f32 v69, v70, v71
M v[112:115], a[72:75], a[136:139], v[112:115]
 v_cvt_pk_bf16_f32 v70, v76, v77
 v_cvt_pk_bf16_f32 v71, v78, v79
M v[112:115], a[76:79], a[140:143], v[112:115]
 ds_read_b128 a[104:107], v7 offset:26624
M v[112:115], a[80:83], a[144:147], v[112:115]
 ds_read_b128 a[108:111], v7 offset:27648
M v[112:115], a[84:87], a[148:151], v[112:115]
 buffer_store_dwordx4 v[68:71], v7, s[8:11], s30 offen offset:0 sc1
M v[112:115], a[88:91], a[152:155], v[112:115]
 ds_read_b128 a[112:115], v7 offset:28672
 v_fma_f32 v80, v80, v5, v28
M v[112:115], a[92:95], a[156:159], v[112:115]
 ds_read_b128 a[116:119], v7 offset:29696
 v_fma_f32 v81, v81, v5, v28
M v[116:119], a[92:95], a[188:191], v[36:39]
 v_fma_f32 v82, v82, v5, v28
 v_fma_f32 v83, v83, v5, v28
M v[116:119], a[88:91], a[184:187], v[116:119]
 ds_read_b128 a[120:123], v7 offset:30720
 v_fma_f32 v88, v88, v5, v28
M v[116:119], a[84:87], a[180:183], v[116:119]
 ds_read_b128 a[124:127], v7 offset:31744
 v_fma_f32 v89, v89, v5, v28
M v[116:119], a[80:83], a[176:179], v[116:119]
 v_fma_f32 v90, v90, v5, v28
 v_fma_f32 v91, v91, v5, v28
M v[116:119], a[76:79], a[172:175], v[116:119]
 v_cvt_pk_bf16_f32 v80, v80, v81
 v_cvt_pk_bf16_f32 v81, v82, v83
M v[116:119], a[72:75], a[168:171], v[116:119]
 v_cvt_pk_bf16_f32 v82, v88, v89
 v_cvt_pk_bf16_f32 v83, v90, v91
M v[116:119], a[68:71], a[164:167], v[116:119]
 s_waitcnt vmcnt(27) lgkmcnt(0)
M v[116:119], a[64:67], a[160:163], v[116:119]
 s_barrier
M v[124:127], a[96:99], a[160:163], v[36:39]
 ds_read_b128 a[64:67], v43 offset:0
M v[124:127], a[100:103], a[164:167], v[124:127]
 ds_read_b128 a[68:71], v43 offset:1024
M v[124:127], a[104:107], a[168:171], v[124:127]
 buffer_store_dwordx4 v[80:83], v7, s[8:11], s29 offen offset:1024 sc1
M v[124:127], a[108:111], a[172:175], v[124:127]
 ds_read_b128 a[72:75], v43 offset:2048
 v_fma_f32 v84, v84, v6, v29
M v[124:127], a[112:115], a[176:179], v[124:127]
 ds_read_b128 a[76:79], v43 offset:3072
 v_fma_f32 v85, v85, v6, v29
M v[124:127], a[116:119], a[180:183], v[124:127]
 v_fma_f32 v86, v86, v6, v29
 v_fma_f32 v87, v87, v6, v29
M v[124:127], a[120:123], a[184:187], v[124:127]
 ds_read_b128 a[80:83], v43 offset:4096
 v_fma_f32 v92, v92, v6, v29
M v[124:127], a[124:127], a[188:191], v[124:127]
 ds_read_b128 a[84:87], v43 offset:5120
 v_fma_f32 v93, v93, v6, v29
M v[120:123], a[124:127], a[156:159], v[32:35]
 v_fma_f32 v94, v94, v6, v29
 v_fma_f32 v95, v95, v6, v29
M v[120:123], a[120:123], a[152:155], v[120:123]
 ds_read_b128 a[88:91], v43 offset:6144
 v_cvt_pk_bf16_f32 v84, v84, v85
M v[120:123], a[116:119], a[148:151], v[120:123]
 ds_read_b128 a[92:95], v43 offset:7168
 v_cvt_pk_bf16_f32 v85, v86, v87
M v[120:123], a[112:115], a[144:147], v[120:123]
 v_cvt_pk_bf16_f32 v86, v92, v93
 v_cvt_pk_bf16_f32 v87, v94, v95
M v[120:123], a[108:111], a[140:143], v[120:123]
 buffer_store_dwordx4 v[84:87], v7, s[8:11], s30 offen offset:1024 sc1
M v[120:123], a[104:107], a[136:139], v[120:123]
M v[120:123], a[100:103], a[132:135], v[120:123]
 s_waitcnt lgkmcnt(0)
M v[120:123], a[96:99], a[128:131], v[120:123]
M v[64:67], a[64:67], a[128:131], v[32:35]
 ds_read_b128 a[96:99], v43 offset:8192
M v[64:67], a[68:71], a[132:135], v[64:67]
 ds_read_b128 a[100:103], v43 offset:9216
M v[64:67], a[72:75], a[136:139], v[64:67]
 s_waitcnt vmcnt(11)
 v_cmp_gt_u32 vcc, 1, v24
M v[64:67], a[76:79], a[140:143], v[64:67]
 s_mov_b32 s65, 234913792
 ds_read_b128 a[104:107], v43 offset:10240
 s_add_u32 s29, s33, 6144
M v[64:67], a[80:83], a[144:147], v[64:67]
 s_cbranch_vccnz L_fhs0
L_fhr0:
 ds_read_b128 a[108:111], v43 offset:11264
 s_add_u32 s30, s93, 6144
M v[64:67], a[84:87], a[148:151], v[64:67]
 buffer_load_dword v25, v14, s[8:11], s65 offen sc1
M v[64:67], a[88:91], a[152:155], v[64:67]
 ds_read_b128 a[112:115], v43 offset:12288
 v_fma_f32 v96, v96, v5, v28
M v[64:67], a[92:95], a[156:159], v[64:67]
 ds_read_b128 a[116:119], v43 offset:13312
 v_fma_f32 v97, v97, v5, v28
M v[68:71], a[92:95], a[188:191], v[36:39]
 v_fma_f32 v98, v98, v5, v28
 v_fma_f32 v99, v99, v5, v28
M v[68:71], a[88:91], a[184:187], v[68:71]
 ds_read_b128 a[120:123], v43 offset:14336
 v_fma_f32 v104, v104, v5, v28
M v[68:71], a[84:87], a[180:183], v[68:71]
 ds_read_b128 a[124:127], v43 offset:15360
 v_fma_f32 v105, v105, v5, v28
M v[68:71], a[80:83], a[176:179], v[68:71]
 v_fma_f32 v106, v106, v5, v28
 v_fma_f32 v107, v107, v5, v28
M v[68:71], a[76:79], a[172:175], v[68:71]
 v_cvt_pk_bf16_f32 v96, v96, v97
M v[68:71], a[72:75], a[168:171], v[68:71]
 v_cvt_pk_bf16_f32 v97, v98, v99
M v[68:71], a[68:71], a[164:167], v[68:71]
 v_cvt_pk_bf16_f32 v98, v104, v105
M v[68:71], a[64:67], a[160:163], v[68:71]
 s_waitcnt lgkmcnt(0)
 v_cvt_pk_bf16_f32 v99, v106, v107
M v[76:79], a[96:99], a[160:163], v[36:39]
 ds_read_b128 a[64:67], v43 offset:16384
M v[76:79], a[100:103], a[164:167], v[76:79]
 ds_read_b128 a[68:71], v43 offset:17408
M v[76:79], a[104:107], a[168:171], v[76:79]
 buffer_store_dwordx4 v[96:99], v7, s[8:11], s29 offen offset:0 sc1
M v[76:79], a[108:111], a[172:175], v[76:79]
 ds_read_b128 a[72:75], v43 offset:18432
 v_fma_f32 v100, v100, v6, v29
M v[76:79], a[112:115], a[176:179], v[76:79]
 ds_read_b128 a[76:79], v43 offset:19456
 v_fma_f32 v101, v101, v6, v29
M v[76:79], a[116:119], a[180:183], v[76:79]
 v_fma_f32 v102, v102, v6, v29
 v_fma_f32 v103, v103, v6, v29
M v[76:79], a[120:123], a[184:187], v[76:79]
 ds_read_b128 a[80:83], v43 offset:20480
 v_fma_f32 v108, v108, v6, v29
M v[76:79], a[124:127], a[188:191], v[76:79]
 ds_read_b128 a[84:87], v43 offset:21504
 v_fma_f32 v109, v109, v6, v29
M v[72:75], a[124:127], a[156:159], v[32:35]
 v_fma_f32 v110, v110, v6, v29
 v_fma_f32 v111, v111, v6, v29
M v[72:75], a[120:123], a[152:155], v[72:75]
 ds_read_b128 a[88:91], v43 offset:22528
 v_cvt_pk_bf16_f32 v100, v100, v101
M v[72:75], a[116:119], a[148:151], v[72:75]
 ds_read_b128 a[92:95], v43 offset:23552
 v_cvt_pk_bf16_f32 v101, v102, v103
M v[72:75], a[112:115], a[144:147], v[72:75]
 v_cvt_pk_bf16_f32 v102, v108, v109
M v[72:75], a[108:111], a[140:143], v[72:75]
 v_cvt_pk_bf16_f32 v103, v110, v111
M v[72:75], a[104:107], a[136:139], v[72:75]
 buffer_store_dwordx4 v[100:103], v7, s[8:11], s30 offen offset:0 sc1
M v[72:75], a[100:103], a[132:135], v[72:75]
M v[72:75], a[96:99], a[128:131], v[72:75]
 s_waitcnt lgkmcnt(0)
 v_fma_f32 v112, v112, v5, v28
M v[80:83], a[64:67], a[128:131], v[32:35]
 ds_read_b128 a[96:99], v43 offset:24576
 v_fma_f32 v113, v113, v5, v28
M v[80:83], a[68:71], a[132:135], v[80:83]
 ds_read_b128 a[100:103], v43 offset:25600
 v_fma_f32 v114, v114, v5, v28
M v[80:83], a[72:75], a[136:139], v[80:83]
 v_fma_f32 v115, v115, v5, v28
M v[80:83], a[76:79], a[140:143], v[80:83]
 ds_read_b128 a[104:107], v43 offset:26624
 v_fma_f32 v120, v120, v5, v28
M v[80:83], a[80:83], a[144:147], v[80:83]
 ds_read_b128 a[108:111], v43 offset:27648
 v_fma_f32 v121, v121, v5, v28
M v[80:83], a[84:87], a[148:151], v[80:83]
 v_fma_f32 v122, v122, v5, v28
M v[80:83], a[88:91], a[152:155], v[80:83]
 ds_read_b128 a[112:115], v43 offset:28672
 v_fma_f32 v123, v123, v5, v28
M v[80:83], a[92:95], a[156:159], v[80:83]
 ds_read_b128 a[116:119], v43 offset:29696
 v_cvt_pk_bf16_f32 v112, v112, v113
M v[84:87], a[92:95], a[188:191], v[36:39]
 v_cvt_pk_bf16_f32 v113, v114, v115
 v_cvt_pk_bf16_f32 v114, v120, v121
M v[84:87], a[88:91], a[184:187], v[84:87]
 ds_read_b128 a[120:123], v43 offset:30720
 v_cvt_pk_bf16_f32 v115, v122, v123
M v[84:87], a[84:87], a[180:183], v[84:87]
 ds_read_b128 a[124:127], v43 offset:31744
M v[84:87], a[80:83], a[176:179], v[84:87]
 buffer_store_dwordx4 v[112:115], v7, s[8:11], s29 offen offset:1024 sc1
M v[84:87], a[76:79], a[172:175], v[84:87]
 v_fma_f32 v116, v116, v6, v29
M v[84:87], a[72:75], a[168:171], v[84:87]
 v_fma_f32 v117, v117, v6, v29
M v[84:87], a[68:71], a[164:167], v[84:87]
 s_waitcnt lgkmcnt(0)
 v_fma_f32 v118, v118, v6, v29
M v[84:87], a[64:67], a[160:163], v[84:87]
 s_barrier
M v[92:95], a[96:99], a[160:163], v[36:39]
 ds_read_b128 a[64:67], v2 offset:32768
 v_fma_f32 v119, v119, v6, v29
M v[92:95], a[100:103], a[164:167], v[92:95]
 ds_read_b128 a[68:71], v2 offset:33792
 v_fma_f32 v124, v124, v6, v29
M v[92:95], a[104:107], a[168:171], v[92:95]
 v_fma_f32 v125, v125, v6, v29
 v_fma_f32 v126, v126, v6, v29
M v[92:95], a[108:111], a[172:175], v[92:95]
 ds_read_b128 a[72:75], v2 offset:34816
 v_fma_f32 v127, v127, v6, v29
M v[92:95], a[112:115], a[176:179], v[92:95]
 ds_read_b128 a[76:79], v2 offset:35840
 v_cvt_pk_bf16_f32 v116, v116, v117
M v[92:95], a[116:119], a[180:183], v[92:95]
 v_cvt_pk_bf16_f32 v117, v118, v119
M v[92:95], a[120:123], a[184:187], v[92:95]
 ds_read_b128 a[80:83], v2 offset:36864
 v_cvt_pk_bf16_f32 v118, v124, v125
M v[92:95], a[124:127], a[188:191], v[92:95]
 ds_read_b128 a[84:87], v2 offset:37888
 v_cvt_pk_bf16_f32 v119, v126, v127
M v[88:91], a[124:127], a[156:159], v[32:35]
 buffer_store_dwordx4 v[116:119], v7, s[8:11], s30 offen offset:1024 sc1
M v[88:91], a[120:123], a[152:155], v[88:91]
 ds_read_b128 a[88:91], v2 offset:38912
M v[88:91], a[116:119], a[148:151], v[88:91]
 ds_read_b128 a[92:95], v2 offset:39936
M v[88:91], a[112:115], a[144:147], v[88:91]
M v[88:91], a[108:111], a[140:143], v[88:91]
M v[88:91], a[104:107], a[136:139], v[88:91]
M v[88:91], a[100:103], a[132:135], v[88:91]
 s_waitcnt lgkmcnt(0)
M v[88:91], a[96:99], a[128:131], v[88:91]
M v[96:99], a[64:67], a[128:131], v[32:35]
 ds_read_b128 a[96:99], v2 offset:40960
M v[96:99], a[68:71], a[132:135], v[96:99]
 ds_read_b128 a[100:103], v2 offset:41984
M v[96:99], a[72:75], a[136:139], v[96:99]
M v[96:99], a[76:79], a[140:143], v[96:99]
 ds_read_b128 a[104:107], v2 offset:43008
 s_add_u32 s29, s33, 16384
M v[96:99], a[80:83], a[144:147], v[96:99]
 ds_read_b128 a[108:111], v2 offset:44032
 s_add_u32 s30, s93, 16384
M v[96:99], a[84:87], a[148:151], v[96:99]
 v_fma_f32 v64, v64, v5, v28
 v_fma_f32 v65, v65, v5, v28
M v[96:99], a[88:91], a[152:155], v[96:99]
 ds_read_b128 a[112:115], v2 offset:45056
 v_fma_f32 v66, v66, v5, v28
M v[96:99], a[92:95], a[156:159], v[96:99]
 ds_read_b128 a[116:119], v2 offset:46080
 v_fma_f32 v67, v67, v5, v28
M v[100:103], a[92:95], a[188:191], v[36:39]
 v_fma_f32 v72, v72, v5, v28
M v[100:103], a[88:91], a[184:187], v[100:103]
 ds_read_b128 a[120:123], v2 offset:47104
 v_fma_f32 v73, v73, v5, v28
M v[100:103], a[84:87], a[180:183], v[100:103]
 ds_read_b128 a[124:127], v2 offset:48128
 v_fma_f32 v74, v74, v5, v28
M v[100:103], a[80:83], a[176:179], v[100:103]
 v_fma_f32 v75, v75, v5, v28
M v[100:103], a[76:79], a[172:175], v[100:103]
 v_cvt_pk_bf16_f32 v64, v64, v65
M v[100:103], a[72:75], a[168:171], v[100:103]
 v_cvt_pk_bf16_f32 v65, v66, v67
M v[100:103], a[68:71], a[164:167], v[100:103]
 v_cvt_pk_bf16_f32 v66, v72, v73
M v[100:103], a[64:67], a[160:163], v[100:103]
 s_waitcnt lgkmcnt(0)
 v_cvt_pk_bf16_f32 v67, v74, v75
M v[108:111], a[96:99], a[160:163], v[36:39]
 ds_read_b128 a[64:67], v2 offset:49152
M v[108:111], a[100:103], a[164:167], v[108:111]
 ds_read_b128 a[68:71], v2 offset:50176
M v[108:111], a[104:107], a[168:171], v[108:111]
 buffer_store_dwordx4 v[64:67], v7, s[8:11], s29 offen offset:0 sc1
M v[108:111], a[108:111], a[172:175], v[108:111]
 ds_read_b128 a[72:75], v2 offset:51200
 v_fma_f32 v68, v68, v6, v29
M v[108:111], a[112:115], a[176:179], v[108:111]
 ds_read_b128 a[76:79], v2 offset:52224
 v_fma_f32 v69, v69, v6, v29
M v[108:111], a[116:119], a[180:183], v[108:111]
 v_fma_f32 v70, v70, v6, v29
 v_fma_f32 v71, v71, v6, v29
M v[108:111], a[120:123], a[184:187], v[108:111]
 ds_read_b128 a[80:83], v2 offset:53248
 v_fma_f32 v76, v76, v6, v29
M v[108:111], a[124:127], a[188:191], v[108:111]
 ds_read_b128 a[84:87], v2 offset:54272
 v_fma_f32 v77, v77, v6, v29
M v[104:107], a[124:127], a[156:159], v[32:35]
 v_fma_f32 v78, v78, v6, v29
 v_fma_f32 v79, v79, v6, v29
M v[104:107], a[120:123], a[152:155], v[104:107]
 ds_read_b128 a[88:91], v2 offset:55296
 v_cvt_pk_bf16_f32 v68, v68, v69
M v[104:107], a[116:119], a[148:151], v[104:107]
 ds_read_b128 a[92:95], v2 offset:56320
 v_cvt_pk_bf16_f32 v69, v70, v71
M v[104:107], a[112:115], a[144:147], v[104:107]
 v_cvt_pk_bf16_f32 v70, v76, v77
M v[104:107], a[108:111], a[140:143], v[104:107]
 v_cvt_pk_bf16_f32 v71, v78, v79
M v[104:107], a[104:107], a[136:139], v[104:107]
 buffer_store_dwordx4 v[68:71], v7, s[8:11], s30 offen offset:0 sc1
M v[104:107], a[100:103], a[132:135], v[104:107]
M v[104:107], a[96:99], a[128:131], v[104:107]
 s_waitcnt lgkmcnt(0)
 v_fma_f32 v80, v80, v5, v28
M v[112:115], a[64:67], a[128:131], v[32:35]
 ds_read_b128 a[96:99], v2 offset:57344
 v_fma_f32 v81, v81, v5, v28
M v[112:115], a[68:71], a[132:135], v[112:115]
 ds_read_b128 a[100:103], v2 offset:58368
 v_fma_f32 v82, v82, v5, v28
M v[112:115], a[72:75], a[136:139], v[112:115]
 v_fma_f32 v83, v83, v5, v28
M v[112:115], a[76:79], a[140:143], v[112:115]
 ds_read_b128 a[104:107], v2 offset:59392
 v_fma_f32 v88, v88, v5, v28
M v[112:115], a[80:83], a[144:147], v[112:115]
 ds_read_b128 a[108:111], v2 offset:60416
 v_fma_f32 v89, v89, v5, v28
M v[112:115], a[84:87], a[148:151], v[112:115]
 v_fma_f32 v90, v90, v5, v28
M v[112:115], a[88:91], a[152:155], v[112:115]
 ds_read_b128 a[112:115], v2 offset:61440
 v_fma_f32 v91, v91, v5, v28
M v[112:115], a[92:95], a[156:159], v[112:115]
 ds_read_b128 a[116:119], v2 offset:62464
 v_cvt_pk_bf16_f32 v80, v80, v81
M v[116:119], a[92:95], a[188:191], v[36:39]
 s_waitcnt vmcnt(6)
 v_readlane_b32 s84, v25, 0
 v_readlane_b32 s85, v25, 1
M v[116:119], a[88:91], a[184:187], v[116:119]
 ds_read_b128 a[120:123], v2 offset:63488
 v_mov_b32 v24, 0x3f80
M v[116:119], a[84:87], a[180:183], v[116:119]
 ds_read_b128 a[124:127], v2 offset:64512
 v_mov_b32 v25, 0x3f800000
M v[116:119], a[80:83], a[176:179], v[116:119]
 v_cvt_pk_bf16_f32 v81, v82, v83
 v_cvt_pk_bf16_f32 v82, v88, v89
M v[116:119], a[76:79], a[172:175], v[116:119]
 v_cvt_pk_bf16_f32 v83, v90, v91
M v[116:119], a[72:75], a[168:171], v[116:119]
 buffer_store_dwordx4 v[80:83], v7, s[8:11], s29 offen offset:1024 sc1
M v[116:119], a[68:71], a[164:167], v[116:119]
 s_waitcnt lgkmcnt(0)
 v_fma_f32 v84, v84, v6, v29
 v_fma_f32 v85, v85, v6, v29
M v[116:119], a[64:67], a[160:163], v[116:119]
 s_barrier
M v[124:127], a[96:99], a[160:163], v[36:39]
 ds_read_b128 a[64:67], v7 offset:32768
 v_fma_f32 v86, v86, v6, v29
M v[124:127], a[100:103], a[164:167], v[124:127]
 ds_read_b128 a[68:71], v7 offset:33792
 v_fma_f32 v87, v87, v6, v29
M v[124:127], a[104:107], a[168:171], v[124:127]
 v_fma_f32 v92, v92, v6, v29
 v_fma_f32 v93, v93, v6, v29
M v[124:127], a[108:111], a[172:175], v[124:127]
 ds_read_b128 a[72:75], v7 offset:34816
 v_fma_f32 v94, v94, v6, v29
M v[124:127], a[112:115], a[176:179], v[124:127]
 ds_read_b128 a[76:79], v7 offset:35840
 v_fma_f32 v95, v95, v6, v29
M v[124:127], a[116:119], a[180:183], v[124:127]
 s_waitcnt vmcnt(3)
 v_cvt_pk_bf16_f32 v84, v84, v85
 v_cvt_pk_bf16_f32 v85, v86, v87
M v[124:127], a[120:123], a[184:187], v[124:127]
 ds_read_b128 a[80:83], v7 offset:36864
 v_cvt_pk_bf16_f32 v86, v92, v93
M v[124:127], a[124:127], a[188:191], v[124:127]
 ds_read_b128 a[84:87], v7 offset:37888
 v_cvt_pk_bf16_f32 v87, v94, v95
M v[120:123], a[124:127], a[156:159], v[32:35]
 buffer_store_dword v40, v41, s[8:11], s45 offen sc1
M v[120:123], a[120:123], a[152:155], v[120:123]
 ds_read_b128 a[88:91], v7 offset:38912
M v[120:123], a[116:119], a[148:151], v[120:123]
 ds_read_b128 a[92:95], v7 offset:39936
M v[120:123], a[112:115], a[144:147], v[120:123]
 buffer_store_dwordx4 v[84:87], v7, s[8:11], s30 offen offset:1024 sc1
M v[120:123], a[108:111], a[140:143], v[120:123]
M v[120:123], a[104:107], a[136:139], v[120:123]
M v[120:123], a[100:103], a[132:135], v[120:123]
 s_waitcnt lgkmcnt(0)
M v[120:123], a[96:99], a[128:131], v[120:123]
M v[64:67], a[64:67], a[128:131], v[32:35]
 ds_read_b128 a[96:99], v7 offset:40960
M v[64:67], a[68:71], a[132:135], v[64:67]
 ds_read_b128 a[100:103], v7 offset:41984
M v[64:67], a[72:75], a[136:139], v[64:67]
M v[64:67], a[76:79], a[140:143], v[64:67]
 ds_read_b128 a[104:107], v7 offset:43008
 s_add_u32 s29, s33, 18432
M v[64:67], a[80:83], a[144:147], v[64:67]
 ds_read_b128 a[108:111], v7 offset:44032
 s_add_u32 s30, s93, 18432
M v[64:67], a[84:87], a[148:151], v[64:67]
 v_fma_f32 v96, v96, v5, v28
 v_fma_f32 v97, v97, v5, v28
M v[64:67], a[88:91], a[152:155], v[64:67]
 ds_read_b128 a[112:115], v7 offset:45056
 v_fma_f32 v98, v98, v5, v28
M v[64:67], a[92:95], a[156:159], v[64:67]
 ds_read_b128 a[116:119], v7 offset:46080
 v_fma_f32 v99, v99, v5, v28
M v[68:71], a[92:95], a[188:191], v[36:39]
 v_fma_f32 v104, v104, v5, v28
 v_fma_f32 v105, v105, v5, v28
M v[68:71], a[88:91], a[184:187], v[68:71]
 ds_read_b128 a[120:123], v7 offset:47104
 v_fma_f32 v106, v106, v5, v28
M v[68:71], a[84:87], a[180:183], v[68:71]
 ds_read_b128 a[124:127], v7 offset:48128
 v_fma_f32 v107, v107, v5, v28
M v[68:71], a[80:83], a[176:179], v[68:71]
 v_cvt_pk_bf16_f32 v96, v96, v97
 v_cvt_pk_bf16_f32 v97, v98, v99
M v[68:71], a[76:79], a[172:175], v[68:71]
 v_cvt_pk_bf16_f32 v98, v104, v105
 v_cvt_pk_bf16_f32 v99, v106, v107
M v[68:71], a[72:75], a[168:171], v[68:71]
 buffer_store_dwordx4 v[96:99], v7, s[8:11], s29 offen offset:0 sc1
M v[68:71], a[68:71], a[164:167], v[68:71]
 v_fma_f32 v100, v100, v6, v29
 v_fma_f32 v101, v101, v6, v29
M v[68:71], a[64:67], a[160:163], v[68:71]
 s_waitcnt lgkmcnt(0)
 v_fma_f32 v102, v102, v6, v29
 v_fma_f32 v103, v103, v6, v29
M v[72:75], a[96:99], a[128:131], v[32:35]
 ds_read_b128 a[64:67], v7 offset:49152
 v_fma_f32 v108, v108, v6, v29
M v[72:75], a[100:103], a[132:135], v[72:75]
 ds_read_b128 a[68:71], v7 offset:50176
 v_fma_f32 v109, v109, v6, v29
M v[72:75], a[104:107], a[136:139], v[72:75]
 v_fma_f32 v110, v110, v6, v29
 v_fma_f32 v111, v111, v6, v29
M v[72:75], a[108:111], a[140:143], v[72:75]
 ds_read_b128 a[72:75], v7 offset:51200
 v_cvt_pk_bf16_f32 v100, v100, v101
M v[72:75], a[112:115], a[144:147], v[72:75]
 ds_read_b128 a[76:79], v7 offset:52224
 v_cvt_pk_bf16_f32 v101, v102, v103
M v[72:75], a[116:119], a[148:151], v[72:75]
 v_cvt_pk_bf16_f32 v102, v108, v109
 v_cvt_pk_bf16_f32 v103, v110, v111
M v[72:75], a[120:123], a[152:155], v[72:75]
 ds_read_b128 a[80:83], v7 offset:53248
M v[72:75], a[124:127], a[156:159], v[72:75]
 ds_read_b128 a[84:87], v7 offset:54272
M v[76:79], a[124:127], a[188:191], v[36:39]
 buffer_store_dwordx4 v[100:103], v7, s[8:11], s30 offen offset:0 sc1
M v[76:79], a[120:123], a[184:187], v[76:79]
 ds_read_b128 a[88:91], v7 offset:55296
 v_fma_f32 v112, v112, v5, v28
M v[76:79], a[116:119], a[180:183], v[76:79]
 ds_read_b128 a[92:95], v7 offset:56320
 v_fma_f32 v113, v113, v5, v28
M v[76:79], a[112:115], a[176:179], v[76:79]
 v_fma_f32 v114, v114, v5, v28
 v_fma_f32 v115, v115, v5, v28
M v[76:79], a[108:111], a[172:175], v[76:79]
 v_fma_f32 v120, v120, v5, v28
 v_fma_f32 v121, v121, v5, v28
M v[76:79], a[104:107], a[168:171], v[76:79]
 v_fma_f32 v122, v122, v5, v28
 v_fma_f32 v123, v123, v5, v28
M v[76:79], a[100:103], a[164:167], v[76:79]
 v_cvt_pk_bf16_f32 v112, v112, v113
 v_cvt_pk_bf16_f32 v113, v114, v115
M v[76:79], a[96:99], a[160:163], v[76:79]
 s_waitcnt lgkmcnt(0)
 v_cvt_pk_bf16_f32 v114, v120, v121
 v_cvt_pk_bf16_f32 v115, v122, v123
M v[80:83], a[64:67], a[128:131], v[32:35]
 ds_read_b128 a[96:99], v7 offset:57344
M v[80:83], a[68:71], a[132:135], v[80:83]
 ds_read_b128 a[100:103], v7 offset:58368
M v[80:83], a[72:75], a[136:139], v[80:83]
 buffer_store_dwordx4 v[112:115], v7, s[8:11], s29 offen offset:1024 sc1
M v[80:83], a[76:79], a[140:143], v[80:83]
 ds_read_b128 a[104:107], v7 offset:59392
 v_fma_f32 v116, v116, v6, v29
M v[80:83], a[80:83], a[144:147], v[80:83]
 ds_read_b128 a[108:111], v7 offset:60416
 v_fma_f32 v117, v117, v6, v29
M v[80:83], a[84:87], a[148:151], v[80:83]
 v_fma_f32 v118, v118, v6, v29
 v_fma_f32 v119, v119, v6, v29
M v[80:83], a[88:91], a[152:155], v[80:83]
 ds_read_b128 a[112:115], v7 offset:61440
 v_fma_f32 v124, v124, v6, v29
M v[80:83], a[92:95], a[156:159], v[80:83]
 ds_read_b128 a[116:119], v7 offset:62464
 v_fma_f32 v125, v125, v6, v29
M v[84:87], a[92:95], a[188:191], v[36:39]
 v_fma_f32 v126, v126, v6, v29
 v_fma_f32 v127, v127, v6, v29
M v[84:87], a[88:91], a[184:187], v[84:87]
 ds_read_b128 a[120:123], v7 offset:63488
 v_cvt_pk_bf16_f32 v116, v116, v117
M v[84:87], a[84:87], a[180:183], v[84:87]
 ds_read_b128 a[124:127], v7 offset:64512
 v_cvt_pk_bf16_f32 v117, v118, v119
M v[84:87], a[80:83], a[176:179], v[84:87]
 v_cvt_pk_bf16_f32 v118, v124, v125
 v_cvt_pk_bf16_f32 v119, v126, v127
M v[84:87], a[76:79], a[172:175], v[84:87]
 buffer_store_dwordx4 v[116:119], v7, s[8:11], s30 offen offset:1024 sc1
M v[84:87], a[72:75], a[168:171], v[84:87]
 s_add_u32 s29, s33, 20480
M v[84:87], a[68:71], a[164:167], v[84:87]
 s_add_u32 s30, s93, 20480
 v_fma_f32 v64, v64, v5, v28
 v_fma_f32 v65, v65, v5, v28
M v[84:87], a[64:67], a[160:163], v[84:87]
 s_waitcnt lgkmcnt(0)
 v_fma_f32 v66, v66, v5, v28
 v_fma_f32 v67, v67, v5, v28
M v[88:91], a[96:99], a[128:131], v[32:35]
 v_fma_f32 v72, v72, v5, v28
 v_fma_f32 v73, v73, v5, v28
M v[88:91], a[100:103], a[132:135], v[88:91]
 v_fma_f32 v74, v74, v5, v28
 v_fma_f32 v75, v75, v5, v28
M v[88:91], a[104:107], a[136:139], v[88:91]
 v_cvt_pk_bf16_f32 v64, v64, v65
 v_cvt_pk_bf16_f32 v65, v66, v67
M v[88:91], a[108:111], a[140:143], v[88:91]
 v_cvt_pk_bf16_f32 v66, v72, v73
 v_cvt_pk_bf16_f32 v67, v74, v75
M v[88:91], a[112:115], a[144:147], v[88:91]
 buffer_store_dwordx4 v[64:67], v7, s[8:11], s29 offen offset:0 sc1
M v[88:91], a[116:119], a[148:151], v[88:91]
 v_fma_f32 v68, v68, v6, v29
 v_fma_f32 v69, v69, v6, v29
M v[88:91], a[120:123], a[152:155], v[88:91]
 v_fma_f32 v70, v70, v6, v29
 v_fma_f32 v71, v71, v6, v29
M v[88:91], a[124:127], a[156:159], v[88:91]
 v_fma_f32 v76, v76, v6, v29
 v_fma_f32 v77, v77, v6, v29
M v[92:95], a[124:127], a[188:191], v[36:39]
 v_fma_f32 v78, v78, v6, v29
 v_fma_f32 v79, v79, v6, v29
M v[92:95], a[120:123], a[184:187], v[92:95]
 v_cvt_pk_bf16_f32 v68, v68, v69
 v_cvt_pk_bf16_f32 v69, v70, v71
M v[92:95], a[116:119], a[180:183], v[92:95]
 v_cvt_pk_bf16_f32 v70, v76, v77
 v_cvt_pk_bf16_f32 v71, v78, v79
M v[92:95], a[112:115], a[176:179], v[92:95]
 buffer_store_dwordx4 v[68:71], v7, s[8:11], s30 offen offset:0 sc1
M v[92:95], a[108:111], a[172:175], v[92:95]
M v[92:95], a[104:107], a[168:171], v[92:95]
M v[92:95], a[100:103], a[164:167], v[92:95]
M v[92:95], a[96:99], a[160:163], v[92:95]
 v_fma_f32 v80, v80, v5, v28
 v_fma_f32 v81, v81, v5, v28
 v_fma_f32 v82, v82, v5, v28
 v_fma_f32 v83, v83, v5, v28
 v_fma_f32 v88, v88, v5, v28
 v_fma_f32 v89, v89, v5, v28
 v_fma_f32 v90, v90, v5, v28
 v_fma_f32 v91, v91, v5, v28
 v_cvt_pk_bf16_f32 v80, v80, v81
 v_cvt_pk_bf16_f32 v81, v82, v83
 v_cvt_pk_bf16_f32 v82, v88, v89
 v_cvt_pk_bf16_f32 v83, v90, v91
 buffer_store_dwordx4 v[80:83], v7, s[8:11], s29 offen offset:1024 sc1
 v_fma_f32 v84, v84, v6, v29
 v_fma_f32 v85, v85, v6, v29
 v_fma_f32 v86, v86, v6, v29
 v_fma_f32 v87, v87, v6, v29
 v_fma_f32 v92, v92, v6, v29
 v_fma_f32 v93, v93, v6, v29
 v_fma_f32 v94, v94, v6, v29
 v_fma_f32 v95, v95, v6, v29
 v_cvt_pk_bf16_f32 v84, v84, v85
 v_cvt_pk_bf16_f32 v85, v86, v87
 v_cvt_pk_bf16_f32 v86, v92, v93
 v_cvt_pk_bf16_f32 v87, v94, v95
 buffer_store_dwordx4 v[84:87], v7, s[8:11], s30 offen offset:1024 sc1
L_red:
 s_lshl_b32 s64, s42, 1
 s_lshr_b32 s65, s41, 3
 s_add_u32 s46, s64, s65
 s_mul_i32 s46, s46, 16512
 s_and_b32 s72, s41, 7
 s_lshl_b32 s66, s72, 7
 s_add_u32 s46, s46, s66
 s_add_u32 s46, s46, 235210752
 s_and_b32 s66, s41, 7
 s_lshr_b32 s66, s101, s66
 s_and_b32 s66, s66, 1
 s_lshl_b32 s66, s66, 13
 s_add_u32 s46, s46, s66
 v_and_b32 v14, 31, v0
 v_lshlrev_b32 v14, 2, v14
 buffer_load_dword v9, v14, s[8:11], s46 offen sc1
 s_mul_i32 s86, s65, 4
 s_add_u32 s86, s86, s20
 s_mul_i32 s77, s42, 4194304
 s_mul_i32 s78, s72, 32768
 s_add_u32 s77, s77, s78
 s_add_u32 s77, s77, 67108864
 s_lshr_b32 s78, s101, s72
 s_and_b32 s78, s78, 1
 s_lshl_b32 s78, s78, 13
 s_add_u32 s77, s77, s78
 s_sub_u32 s64, 15, s64
 s_sub_u32 s78, s64, 1
 s_mul_i32 s78, s78, 4194304
 s_add_u32 s78, s78, s77
 s_lshl_b32 s66, s86, 10
 s_add_u32 s78, s78, s66
 s_lshl_b32 s66, s74, 10
 s_add_u32 s77, s77, s66
 s_and_b32 s66, s66, 8192
 s_add_u32 s77, s77, s66
 s_lshl_b32 s66, s64, 7
 s_lshl_b32 s86, s86, 6
 s_lshr_b32 s73, s72, 1
 s_sub_u32 s65, 7, s73
 s_bitcmp1_b32 s72, 0
 s_cselect_b32 s73, s65, s73
 s_lshl_b32 s73, s73, 4
 s_lshl_b32 s65, s42, 7
 s_add_u32 s73, s73, s65
 v_and_b32 v10, 15, v0
 v_add_u32 v10, s73, v10
 v_add_u32 v29, s66, v10
 s_mov_b32 s64, 234881088
 v_mul_u32_u24 v12, 896, v10
 v_lshl_add_u32 v12, v11, 4, v12
 v_lshrrev_b32 v13, 4, v10
 v_lshlrev_b32 v13, 5, v13
 v_and_b32 v104, 15, v10
 v_add_lshl_u32 v13, v13, v104, 2
 buffer_load_dword v15, v13, s[8:11], s64 offen sc1
 buffer_load_dwordx4 v[16:19], v12, s[56:59], s75 offen
 buffer_load_dwordx4 v[20:23], v12, s[56:59], s76 offen
 v_mov_b32 v48, 0
 v_mov_b32 v49, 0
 v_mov_b32 v50, 0
 v_mov_b32 v51, 0
 v_mov_b32 v52, 0
 v_mov_b32 v53, 0
 v_mov_b32 v54, 0
 v_mov_b32 v55, 0
 v_mov_b32 v56, 0
 v_mov_b32 v57, 0
 v_mov_b32 v58, 0
 v_mov_b32 v59, 0
 v_mov_b32 v60, 0
 v_mov_b32 v61, 0
 v_mov_b32 v62, 0
 v_mov_b32 v63, 0
 v_mul_u32_u24 v28, 896, v29
 v_lshl_add_u32 v28, v11, 4, v28
 v_lshrrev_b32 v13, 4, v29
 v_lshlrev_b32 v13, 5, v13
 v_and_b32 v104, 15, v29
 v_add_lshl_u32 v13, v13, v104, 2
 buffer_load_dword v26, v13, s[8:11], s64 offen sc1
 buffer_load_dwordx4 v[96:99], v28, s[56:59], s86 offen
 v_mov_b32 v64, 0
 v_mov_b32 v65, 0
 v_mov_b32 v66, 0
 v_mov_b32 v67, 0
 v_mov_b32 v68, 0
 v_mov_b32 v69, 0
 v_mov_b32 v70, 0
 v_mov_b32 v71, 0
 s_waitcnt vmcnt(6)
 buffer_store_dword v40, v41, s[8:11], s3 offen sc1
 s_waitcnt vmcnt(6)
 v_cmp_eq_u32 vcc, 1, v9
 s_mov_b32 s91, 65536
 s_mov_b32 s69, 0
 s_mov_b32 s70, vcc_lo
 s_mov_b32 s68, vcc_lo
 s_cmp_lg_u32 s70, 0
 s_cbranch_scc1 L_rk0
 s_call_b64 s[36:37], L_rpoll
L_rk0:
 s_ff1_i32_b32 s71, s70
 s_bitset0_b32 s70, s71
 s_cmp_ge_u32 s71, 16
 s_cselect_b32 s72, s78, s77
 s_cselect_b32 s73, 0x1, 0
 s_cselect_b32 s87, 536870912, 0
 s_and_b32 s89, s71, 8
 s_lshl_b32 s89, s89, 10
 s_xor_b32 s72, s72, s89
 s_mul_i32 s71, s71, 262144
 s_add_u32 s71, s71, s72
 buffer_load_dwordx4 v[128:131], v7, s[8:11], s71 offen sc1
 s_or_b32 s69, s69, s73
 s_or_b32 s71, s71, s87
 buffer_load_dwordx4 v[132:135], v27, s[8:11], s71 offen sc1
 s_cmp_lg_u32 s70, 0
 s_cbranch_scc1 L_rk1
 s_call_b64 s[36:37], L_rpoll
L_rk1:
 s_ff1_i32_b32 s71, s70
 s_bitset0_b32 s70, s71
 s_cmp_ge_u32 s71, 16
 s_cselect_b32 s72, s78, s77
 s_cselect_b32 s73, 0x2, 0
 s_cselect_b32 s87, 536870912, 0
 s_and_b32 s89, s71, 8
 s_lshl_b32 s89, s89, 10
 s_xor_b32 s72, s72, s89
 s_mul_i32 s71, s71, 262144
 s_add_u32 s71, s71, s72
 buffer_load_dwordx4 v[136:139], v7, s[8:11], s71 offen sc1
 s_or_b32 s69, s69, s73
 s_or_b32 s71, s71, s87
 buffer_load_dwordx4 v[140:143], v27, s[8:11], s71 offen sc1
 s_waitcnt vmcnt(8)
 v_lshlrev_b32 v32, 16, v16
 v_and_b32 v33, 0xffff0000, v16
 v_lshlrev_b32 v34, 16, v17
 v_and_b32 v35, 0xffff0000, v17
 v_lshlrev_b32 v36, 16, v18
 v_and_b32 v37, 0xffff0000, v18
 v_lshlrev_b32 v38, 16, v19
 v_and_b32 v39, 0xffff0000, v19
 s_waitcnt vmcnt(7)
 v_lshlrev_b32 v40, 16, v20
 v_and_b32 v41, 0xffff0000, v20
 v_lshlrev_b32 v42, 16, v21
 v_and_b32 v43, 0xffff0000, v21
 v_lshlrev_b32 v44, 16, v22
 v_and_b32 v45, 0xffff0000, v22
 v_lshlrev_b32 v46, 16, v23
 v_and_b32 v47, 0xffff0000, v23
 v_sub_f32 v13, 1.0, v15
 v_cmp_eq_u32 s[80:81], s84, v10
 v_cmp_eq_u32 s[82:83], s85, v10
 s_nop 0
 s_or_b64 vcc, s[80:81], s[82:83]
 s_cbranch_vccnz L_moe0
L_moe_ret0:
 v_mul_f32 v32, v13, v32
 v_mul_f32 v33, v13, v33
 v_mul_f32 v34, v13, v34
 v_mul_f32 v35, v13, v35
 v_mul_f32 v36, v13, v36
 v_mul_f32 v37, v13, v37
 v_mul_f32 v38, v13, v38
 v_mul_f32 v39, v13, v39
 v_mul_f32 v40, v13, v40
 v_mul_f32 v41, v13, v41
 v_mul_f32 v42, v13, v42
 v_mul_f32 v43, v13, v43
 v_mul_f32 v44, v13, v44
 v_mul_f32 v45, v13, v45
 v_mul_f32 v46, v13, v46
 v_mul_f32 v47, v13, v47
 s_cmp_lg_u32 s70, 0
 s_cbranch_scc1 L_rk2
 s_call_b64 s[36:37], L_rpoll
L_rk2:
 s_ff1_i32_b32 s71, s70
 s_bitset0_b32 s70, s71
 s_cmp_ge_u32 s71, 16
 s_cselect_b32 s72, s78, s77
 s_cselect_b32 s73, 0x4, 0
 s_cselect_b32 s87, 536870912, 0
 s_and_b32 s89, s71, 8
 s_lshl_b32 s89, s89, 10
 s_xor_b32 s72, s72, s89
 s_mul_i32 s71, s71, 262144
 s_add_u32 s71, s71, s72
 buffer_load_dwordx4 v[144:147], v7, s[8:11], s71 offen sc1
 s_or_b32 s69, s69, s73
 s_or_b32 s71, s71, s87
 buffer_load_dwordx4 v[148:151], v27, s[8:11], s71 offen sc1
 s_waitcnt vmcnt(7)
 v_lshlrev_b32 v80, 16, v96
 v_and_b32 v81, 0xffff0000, v96
 v_lshlrev_b32 v82, 16, v97
 v_and_b32 v83, 0xffff0000, v97
 v_lshlrev_b32 v84, 16, v98
 v_and_b32 v85, 0xffff0000, v98
 v_lshlrev_b32 v86, 16, v99
 v_and_b32 v87, 0xffff0000, v99
 v_sub_f32 v13, 1.0, v26
 v_cmp_eq_u32 s[80:81], s84, v29
 v_cmp_eq_u32 s[82:83], s85, v29
 s_nop 0
 s_or_b64 vcc, s[80:81], s[82:83]
 s_cbranch_vccnz L_moe1
L_moe_ret1:
 v_mul_f32 v80, v13, v80
 v_mul_f32 v81, v13, v81
 v_mul_f32 v82, v13, v82
 v_mul_f32 v83, v13, v83
 v_mul_f32 v84, v13, v84
 v_mul_f32 v85, v13, v85
 v_mul_f32 v86, v13, v86
 v_mul_f32 v87, v13, v87
 s_cmp_lg_u32 s70, 0
 s_cbranch_scc1 L_rk3
 s_call_b64 s[36:37], L_rpoll
L_rk3:
 s_ff1_i32_b32 s71, s70
 s_bitset0_b32 s70, s71
 s_cmp_ge_u32 s71, 16
 s_cselect_b32 s72, s78, s77
 s_cselect_b32 s73, 0x8, 0
 s_cselect_b32 s87, 536870912, 0
 s_and_b32 s89, s71, 8
 s_lshl_b32 s89, s89, 10
 s_xor_b32 s72, s72, s89
 s_mul_i32 s71, s71, 262144
 s_add_u32 s71, s71, s72
 buffer_load_dwordx4 v[152:155], v7, s[8:11], s71 offen sc1
 s_or_b32 s69, s69, s73
 s_or_b32 s71, s71, s87
 buffer_load_dwordx4 v[156:159], v27, s[8:11], s71 offen sc1
 s_cmp_lg_u32 s70, 0
 s_cbranch_scc1 L_rk4
 s_call_b64 s[36:37], L_rpoll
L_rk4:
 s_ff1_i32_b32 s71, s70
 s_bitset0_b32 s70, s71
 s_cmp_ge_u32 s71, 16
 s_cselect_b32 s72, s78, s77
 s_cselect_b32 s73, 0x10, 0
 s_cselect_b32 s87, 536870912, 0
 s_and_b32 s89, s71, 8
 s_lshl_b32 s89, s89, 10
 s_xor_b32 s72, s72, s89
 s_mul_i32 s71, s71, 262144
 s_add_u32 s71, s71, s72
 buffer_load_dwordx4 v[160:163], v7, s[8:11], s71 offen sc1
 s_or_b32 s69, s69, s73
 s_or_b32 s71, s71, s87
 buffer_load_dwordx4 v[164:167], v27, s[8:11], s71 offen sc1
 s_cmp_lg_u32 s70, 0
 s_cbranch_scc1 L_rk5
 s_call_b64 s[36:37], L_rpoll
L_rk5:
 s_ff1_i32_b32 s71, s70
 s_bitset0_b32 s70, s71
 s_cmp_ge_u32 s71, 16
 s_cselect_b32 s72, s78, s77
 s_cselect_b32 s73, 0x20, 0
 s_cselect_b32 s87, 536870912, 0
 s_and_b32 s89, s71, 8
 s_lshl_b32 s89, s89, 10
 s_xor_b32 s72, s72, s89
 s_mul_i32 s71, s71, 262144
 s_add_u32 s71, s71, s72
 buffer_load_dwordx4 v[168:171], v7, s[8:11], s71 offen sc1
 s_or_b32 s69, s69, s73
 s_or_b32 s71, s71, s87
 buffer_load_dwordx4 v[172:175], v27, s[8:11], s71 offen sc1
 s_cmp_lg_u32 s70, 0
 s_cbranch_scc1 L_rk6
 s_call_b64 s[36:37], L_rpoll
L_rk6:
 s_ff1_i32_b32 s71, s70
 s_bitset0_b32 s70, s71
 s_cmp_ge_u32 s71, 16
 s_cselect_b32 s72, s78, s77
 s_cselect_b32 s73, 0x40, 0
 s_cselect_b32 s87, 536870912, 0
 s_and_b32 s89, s71, 8
 s_lshl_b32 s89, s89, 10
 s_xor_b32 s72, s72, s89
 s_mul_i32 s71, s71, 262144
 s_add_u32 s71, s71, s72
 buffer_load_dwordx4 v[176:179], v7, s[8:11], s71 offen sc1
 s_or_b32 s69, s69, s73
 s_or_b32 s71, s71, s87
 buffer_load_dwordx4 v[180:183], v27, s[8:11], s71 offen sc1
 s_cmp_lg_u32 s70, 0
 s_cbranch_scc1 L_rk7
 s_call_b64 s[36:37], L_rpoll
L_rk7:
 s_ff1_i32_b32 s71, s70
 s_bitset0_b32 s70, s71
 s_cmp_ge_u32 s71, 16
 s_cselect_b32 s72, s78, s77
 s_cselect_b32 s73, 0x80, 0
 s_cselect_b32 s87, 536870912, 0
 s_and_b32 s89, s71, 8
 s_lshl_b32 s89, s89, 10
 s_xor_b32 s72, s72, s89
 s_mul_i32 s71, s71, 262144
 s_add_u32 s71, s71, s72
 buffer_load_dwordx4 v[184:187], v7, s[8:11], s71 offen sc1
 s_or_b32 s69, s69, s73
 s_or_b32 s71, s71, s87
 buffer_load_dwordx4 v[188:191], v27, s[8:11], s71 offen sc1
 s_cmp_lg_u32 s70, 0
 s_cbranch_scc1 L_rk8
 s_call_b64 s[36:37], L_rpoll
L_rk8:
 s_ff1_i32_b32 s71, s70
 s_bitset0_b32 s70, s71
 s_cmp_ge_u32 s71, 16
 s_cselect_b32 s72, s78, s77
 s_cselect_b32 s73, 0x100, 0
 s_cselect_b32 s87, 536870912, 0
 s_and_b32 s89, s71, 8
 s_lshl_b32 s89, s89, 10
 s_xor_b32 s72, s72, s89
 s_mul_i32 s71, s71, 262144
 s_add_u32 s71, s71, s72
 buffer_load_dwordx4 v[192:195], v7, s[8:11], s71 offen sc1
 s_or_b32 s69, s69, s73
 s_or_b32 s71, s71, s87
 buffer_load_dwordx4 v[196:199], v27, s[8:11], s71 offen sc1
 s_waitcnt vmcnt(16)
 s_bitcmp1_b32 s69, 0
 s_cbranch_scc1 L_rx0
 v_dot2c_f32_bf16 v48, v128, v24
 v_dot2c_f32_bf16 v49, v128, v25
 v_dot2c_f32_bf16 v50, v129, v24
 v_dot2c_f32_bf16 v51, v129, v25
 v_dot2c_f32_bf16 v52, v130, v24
 v_dot2c_f32_bf16 v53, v130, v25
 v_dot2c_f32_bf16 v54, v131, v24
 v_dot2c_f32_bf16 v55, v131, v25
 v_dot2c_f32_bf16 v56, v132, v24
 v_dot2c_f32_bf16 v57, v132, v25
 v_dot2c_f32_bf16 v58, v133, v24
 v_dot2c_f32_bf16 v59, v133, v25
 v_dot2c_f32_bf16 v60, v134, v24
 v_dot2c_f32_bf16 v61, v134, v25
 v_dot2c_f32_bf16 v62, v135, v24
 v_dot2c_f32_bf16 v63, v135, v25
L_ry0:
 s_cmp_lg_u32 s70, 0
 s_cbranch_scc1 L_rk9
 s_call_b64 s[36:37], L_rpoll
L_rk9:
 s_ff1_i32_b32 s71, s70
 s_bitset0_b32 s70, s71
 s_cmp_ge_u32 s71, 16
 s_cselect_b32 s72, s78, s77
 s_cselect_b32 s73, 0x200, 0
 s_cselect_b32 s87, 536870912, 0
 s_and_b32 s89, s71, 8
 s_lshl_b32 s89, s89, 10
 s_xor_b32 s72, s72, s89
 s_mul_i32 s71, s71, 262144
 s_add_u32 s71, s71, s72
 buffer_load_dwordx4 v[200:203], v7, s[8:11], s71 offen sc1
 s_or_b32 s69, s69, s73
 s_or_b32 s71, s71, s87
 buffer_load_dwordx4 v[204:207], v27, s[8:11], s71 offen sc1
 s_waitcnt vmcnt(16)
 s_bitcmp1_b32 s69, 1
 s_cbranch_scc1 L_rx1
 v_dot2c_f32_bf16 v48, v136, v24
 v_dot2c_f32_bf16 v49, v136, v25
 v_dot2c_f32_bf16 v50, v137, v24
 v_dot2c_f32_bf16 v51, v137, v25
 v_dot2c_f32_bf16 v52, v138, v24
 v_dot2c_f32_bf16 v53, v138, v25
 v_dot2c_f32_bf16 v54, v139, v24
 v_dot2c_f32_bf16 v55, v139, v25
 v_dot2c_f32_bf16 v56, v140, v24
 v_dot2c_f32_bf16 v57, v140, v25
 v_dot2c_f32_bf16 v58, v141, v24
 v_dot2c_f32_bf16 v59, v141, v25
 v_dot2c_f32_bf16 v60, v142, v24
 v_dot2c_f32_bf16 v61, v142, v25
 v_dot2c_f32_bf16 v62, v143, v24
 v_dot2c_f32_bf16 v63, v143, v25
L_ry1:
 s_cmp_lg_u32 s70, 0
 s_cbranch_scc1 L_rk10
 s_call_b64 s[36:37], L_rpoll
L_rk10:
 s_ff1_i32_b32 s71, s70
 s_bitset0_b32 s70, s71
 s_cmp_ge_u32 s71, 16
 s_cselect_b32 s72, s78, s77
 s_cselect_b32 s73, 0x400, 0
 s_cselect_b32 s87, 536870912, 0
 s_and_b32 s89, s71, 8
 s_lshl_b32 s89, s89, 10
 s_xor_b32 s72, s72, s89
 s_mul_i32 s71, s71, 262144
 s_add_u32 s71, s71, s72
 buffer_load_dwordx4 v[208:211], v7, s[8:11], s71 offen sc1
 s_or_b32 s69, s69, s73
 s_or_b32 s71, s71, s87
 buffer_load_dwordx4 v[212:215], v27, s[8:11], s71 offen sc1
 s_waitcnt vmcnt(16)
 s_bitcmp1_b32 s69, 2
 s_cbranch_scc1 L_rx2
 v_dot2c_f32_bf16 v48, v144, v24
 v_dot2c_f32_bf16 v49, v144, v25
 v_dot2c_f32_bf16 v50, v145, v24
 v_dot2c_f32_bf16 v51, v145, v25
 v_dot2c_f32_bf16 v52, v146, v24
 v_dot2c_f32_bf16 v53, v146, v25
 v_dot2c_f32_bf16 v54, v147, v24
 v_dot2c_f32_bf16 v55, v147, v25
 v_dot2c_f32_bf16 v56, v148, v24
 v_dot2c_f32_bf16 v57, v148, v25
 v_dot2c_f32_bf16 v58, v149, v24
 v_dot2c_f32_bf16 v59, v149, v25
 v_dot2c_f32_bf16 v60, v150, v24
 v_dot2c_f32_bf16 v61, v150, v25
 v_dot2c_f32_bf16 v62, v151, v24
 v_dot2c_f32_bf16 v63, v151, v25
L_ry2:
 s_cmp_lg_u32 s70, 0
 s_cbranch_scc1 L_rk11
 s_call_b64 s[36:37], L_rpoll
L_rk11:
 s_ff1_i32_b32 s71, s70
 s_bitset0_b32 s70, s71
 s_cmp_ge_u32 s71, 16
 s_cselect_b32 s72, s78, s77
 s_cselect_b32 s73, 0x800, 0
 s_cselect_b32 s87, 536870912, 0
 s_and_b32 s89, s71, 8
 s_lshl_b32 s89, s89, 10
 s_xor_b32 s72, s72, s89
 s_mul_i32 s71, s71, 262144
 s_add_u32 s71, s71, s72
 buffer_load_dwordx4 v[216:219], v7, s[8:11], s71 offen sc1
 s_or_b32 s69, s69, s73
 s_or_b32 s71, s71, s87
 buffer_load_dwordx4 v[220:223], v27, s[8:11], s71 offen sc1
 s_waitcnt vmcnt(16)
 s_bitcmp1_b32 s69, 3
 s_cbranch_scc1 L_rx3
 v_dot2c_f32_bf16 v48, v152, v24
 v_dot2c_f32_bf16 v49, v152, v25
 v_dot2c_f32_bf16 v50, v153, v24
 v_dot2c_f32_bf16 v51, v153, v25
 v_dot2c_f32_bf16 v52, v154, v24
 v_dot2c_f32_bf16 v53, v154, v25
 v_dot2c_f32_bf16 v54, v155, v24
 v_dot2c_f32_bf16 v55, v155, v25
 v_dot2c_f32_bf16 v56, v156, v24
 v_dot2c_f32_bf16 v57, v156, v25
 v_dot2c_f32_bf16 v58, v157, v24
 v_dot2c_f32_bf16 v59, v157, v25
 v_dot2c_f32_bf16 v60, v158, v24
 v_dot2c_f32_bf16 v61, v158, v25
 v_dot2c_f32_bf16 v62, v159, v24
 v_dot2c_f32_bf16 v63, v159, v25
L_ry3:
 s_cmp_lg_u32 s70, 0
 s_cbranch_scc1 L_rk12
 s_call_b64 s[36:37], L_rpoll
L_rk12:
 s_ff1_i32_b32 s71, s70
 s_bitset0_b32 s70, s71
 s_cmp_ge_u32 s71, 16
 s_cselect_b32 s72, s78, s77
 s_cselect_b32 s73, 0x1000, 0
 s_cselect_b32 s87, 536870912, 0
 s_and_b32 s89, s71, 8
 s_lshl_b32 s89, s89, 10
 s_xor_b32 s72, s72, s89
 s_mul_i32 s71, s71, 262144
 s_add_u32 s71, s71, s72
 buffer_load_dwordx4 v[224:227], v7, s[8:11], s71 offen sc1
 s_or_b32 s69, s69, s73
 s_or_b32 s71, s71, s87
 buffer_load_dwordx4 v[228:231], v27, s[8:11], s71 offen sc1
 s_waitcnt vmcnt(16)
 s_bitcmp1_b32 s69, 4
 s_cbranch_scc1 L_rx4
 v_dot2c_f32_bf16 v48, v160, v24
 v_dot2c_f32_bf16 v49, v160, v25
 v_dot2c_f32_bf16 v50, v161, v24
 v_dot2c_f32_bf16 v51, v161, v25
 v_dot2c_f32_bf16 v52, v162, v24
 v_dot2c_f32_bf16 v53, v162, v25
 v_dot2c_f32_bf16 v54, v163, v24
 v_dot2c_f32_bf16 v55, v163, v25
 v_dot2c_f32_bf16 v56, v164, v24
 v_dot2c_f32_bf16 v57, v164, v25
 v_dot2c_f32_bf16 v58, v165, v24
 v_dot2c_f32_bf16 v59, v165, v25
 v_dot2c_f32_bf16 v60, v166, v24
 v_dot2c_f32_bf16 v61, v166, v25
 v_dot2c_f32_bf16 v62, v167, v24
 v_dot2c_f32_bf16 v63, v167, v25
L_ry4:
 s_cmp_lg_u32 s70, 0
 s_cbranch_scc1 L_rk13
 s_call_b64 s[36:37], L_rpoll
L_rk13:
 s_ff1_i32_b32 s71, s70
 s_bitset0_b32 s70, s71
 s_cmp_ge_u32 s71, 16
 s_cselect_b32 s72, s78, s77
 s_cselect_b32 s73, 0x2000, 0
 s_cselect_b32 s87, 536870912, 0
 s_and_b32 s89, s71, 8
 s_lshl_b32 s89, s89, 10
 s_xor_b32 s72, s72, s89
 s_mul_i32 s71, s71, 262144
 s_add_u32 s71, s71, s72
 buffer_load_dwordx4 v[232:235], v7, s[8:11], s71 offen sc1
 s_or_b32 s69, s69, s73
 s_or_b32 s71, s71, s87
 buffer_load_dwordx4 v[236:239], v27, s[8:11], s71 offen sc1
 s_waitcnt vmcnt(16)
 s_bitcmp1_b32 s69, 5
 s_cbranch_scc1 L_rx5
 v_dot2c_f32_bf16 v48, v168, v24
 v_dot2c_f32_bf16 v49, v168, v25
 v_dot2c_f32_bf16 v50, v169, v24
 v_dot2c_f32_bf16 v51, v169, v25
 v_dot2c_f32_bf16 v52, v170, v24
 v_dot2c_f32_bf16 v53, v170, v25
 v_dot2c_f32_bf16 v54, v171, v24
 v_dot2c_f32_bf16 v55, v171, v25
 v_dot2c_f32_bf16 v56, v172, v24
 v_dot2c_f32_bf16 v57, v172, v25
 v_dot2c_f32_bf16 v58, v173, v24
 v_dot2c_f32_bf16 v59, v173, v25
 v_dot2c_f32_bf16 v60, v174, v24
 v_dot2c_f32_bf16 v61, v174, v25
 v_dot2c_f32_bf16 v62, v175, v24
 v_dot2c_f32_bf16 v63, v175, v25
L_ry5:
 s_cmp_lg_u32 s70, 0
 s_cbranch_scc1 L_rk14
 s_call_b64 s[36:37], L_rpoll
L_rk14:
 s_ff1_i32_b32 s71, s70
 s_bitset0_b32 s70, s71
 s_cmp_ge_u32 s71, 16
 s_cselect_b32 s72, s78, s77
 s_cselect_b32 s73, 0x4000, 0
 s_cselect_b32 s87, 536870912, 0
 s_and_b32 s89, s71, 8
 s_lshl_b32 s89, s89, 10
 s_xor_b32 s72, s72, s89
 s_mul_i32 s71, s71, 262144
 s_add_u32 s71, s71, s72
 buffer_load_dwordx4 v[240:243], v7, s[8:11], s71 offen sc1
 s_or_b32 s69, s69, s73
 s_or_b32 s71, s71, s87
 buffer_load_dwordx4 v[244:247], v27, s[8:11], s71 offen sc1
 s_waitcnt vmcnt(16)
 s_bitcmp1_b32 s69, 6
 s_cbranch_scc1 L_rx6
 v_dot2c_f32_bf16 v48, v176, v24
 v_dot2c_f32_bf16 v49, v176, v25
 v_dot2c_f32_bf16 v50, v177, v24
 v_dot2c_f32_bf16 v51, v177, v25
 v_dot2c_f32_bf16 v52, v178, v24
 v_dot2c_f32_bf16 v53, v178, v25
 v_dot2c_f32_bf16 v54, v179, v24
 v_dot2c_f32_bf16 v55, v179, v25
 v_dot2c_f32_bf16 v56, v180, v24
 v_dot2c_f32_bf16 v57, v180, v25
 v_dot2c_f32_bf16 v58, v181, v24
 v_dot2c_f32_bf16 v59, v181, v25
 v_dot2c_f32_bf16 v60, v182, v24
 v_dot2c_f32_bf16 v61, v182, v25
 v_dot2c_f32_bf16 v62, v183, v24
 v_dot2c_f32_bf16 v63, v183, v25
L_ry6:
 s_cmp_lg_u32 s70, 0
 s_cbranch_scc1 L_rk15
 s_call_b64 s[36:37], L_rpoll
L_rk15:
 s_ff1_i32_b32 s71, s70
 s_bitset0_b32 s70, s71
 s_cmp_ge_u32 s71, 16
 s_cselect_b32 s72, s78, s77
 s_cselect_b32 s73, 0x8000, 0
 s_cselect_b32 s87, 536870912, 0
 s_and_b32 s89, s71, 8
 s_lshl_b32 s89, s89, 10
 s_xor_b32 s72, s72, s89
 s_mul_i32 s71, s71, 262144
 s_add_u32 s71, s71, s72
 buffer_load_dwordx4 v[248:251], v7, s[8:11], s71 offen sc1
 s_or_b32 s69, s69, s73
 s_or_b32 s71, s71, s87
 buffer_load_dwordx4 v[252:255], v27, s[8:11], s71 offen sc1
 s_waitcnt vmcnt(16)
 s_bitcmp1_b32 s69, 7
 s_cbranch_scc1 L_rx7
 v_dot2c_f32_bf16 v48, v184, v24
 v_dot2c_f32_bf16 v49, v184, v25
 v_dot2c_f32_bf16 v50, v185, v24
 v_dot2c_f32_bf16 v51, v185, v25
 v_dot2c_f32_bf16 v52, v186, v24
 v_dot2c_f32_bf16 v53, v186, v25
 v_dot2c_f32_bf16 v54, v187, v24
 v_dot2c_f32_bf16 v55, v187, v25
 v_dot2c_f32_bf16 v56, v188, v24
 v_dot2c_f32_bf16 v57, v188, v25
 v_dot2c_f32_bf16 v58, v189, v24
 v_dot2c_f32_bf16 v59, v189, v25
 v_dot2c_f32_bf16 v60, v190, v24
 v_dot2c_f32_bf16 v61, v190, v25
 v_dot2c_f32_bf16 v62, v191, v24
 v_dot2c_f32_bf16 v63, v191, v25
L_ry7:
 s_cmp_lg_u32 s70, 0
 s_cbranch_scc1 L_rk16
 s_call_b64 s[36:37], L_rpoll
L_rk16:
 s_ff1_i32_b32 s71, s70
 s_bitset0_b32 s70, s71
 s_cmp_ge_u32 s71, 16
 s_cselect_b32 s72, s78, s77
 s_cselect_b32 s73, 0x10000, 0
 s_cselect_b32 s87, 536870912, 0
 s_and_b32 s89, s71, 8
 s_lshl_b32 s89, s89, 10
 s_xor_b32 s72, s72, s89
 s_mul_i32 s71, s71, 262144
 s_add_u32 s71, s71, s72
 buffer_load_dwordx4 v[128:131], v7, s[8:11], s71 offen sc1
 s_or_b32 s69, s69, s73
 s_or_b32 s71, s71, s87
 buffer_load_dwordx4 v[132:135], v27, s[8:11], s71 offen sc1
 s_waitcnt vmcnt(16)
 s_bitcmp1_b32 s69, 8
 s_cbranch_scc1 L_rx8
 v_dot2c_f32_bf16 v48, v192, v24
 v_dot2c_f32_bf16 v49, v192, v25
 v_dot2c_f32_bf16 v50, v193, v24
 v_dot2c_f32_bf16 v51, v193, v25
 v_dot2c_f32_bf16 v52, v194, v24
 v_dot2c_f32_bf16 v53, v194, v25
 v_dot2c_f32_bf16 v54, v195, v24
 v_dot2c_f32_bf16 v55, v195, v25
 v_dot2c_f32_bf16 v56, v196, v24
 v_dot2c_f32_bf16 v57, v196, v25
 v_dot2c_f32_bf16 v58, v197, v24
 v_dot2c_f32_bf16 v59, v197, v25
 v_dot2c_f32_bf16 v60, v198, v24
 v_dot2c_f32_bf16 v61, v198, v25
 v_dot2c_f32_bf16 v62, v199, v24
 v_dot2c_f32_bf16 v63, v199, v25
L_ry8:
 s_cmp_lg_u32 s70, 0
 s_cbranch_scc1 L_rk17
 s_call_b64 s[36:37], L_rpoll
L_rk17:
 s_ff1_i32_b32 s71, s70
 s_bitset0_b32 s70, s71
 s_cmp_ge_u32 s71, 16
 s_cselect_b32 s72, s78, s77
 s_cselect_b32 s73, 0x20000, 0
 s_cselect_b32 s87, 536870912, 0
 s_and_b32 s89, s71, 8
 s_lshl_b32 s89, s89, 10
 s_xor_b32 s72, s72, s89
 s_mul_i32 s71, s71, 262144
 s_add_u32 s71, s71, s72
 buffer_load_dwordx4 v[136:139], v7, s[8:11], s71 offen sc1
 s_or_b32 s69, s69, s73
 s_or_b32 s71, s71, s87
 buffer_load_dwordx4 v[140:143], v27, s[8:11], s71 offen sc1
 s_waitcnt vmcnt(16)
 s_bitcmp1_b32 s69, 9
 s_cbranch_scc1 L_rx9
 v_dot2c_f32_bf16 v48, v200, v24
 v_dot2c_f32_bf16 v49, v200, v25
 v_dot2c_f32_bf16 v50, v201, v24
 v_dot2c_f32_bf16 v51, v201, v25
 v_dot2c_f32_bf16 v52, v202, v24
 v_dot2c_f32_bf16 v53, v202, v25
 v_dot2c_f32_bf16 v54, v203, v24
 v_dot2c_f32_bf16 v55, v203, v25
 v_dot2c_f32_bf16 v56, v204, v24
 v_dot2c_f32_bf16 v57, v204, v25
 v_dot2c_f32_bf16 v58, v205, v24
 v_dot2c_f32_bf16 v59, v205, v25
 v_dot2c_f32_bf16 v60, v206, v24
 v_dot2c_f32_bf16 v61, v206, v25
 v_dot2c_f32_bf16 v62, v207, v24
 v_dot2c_f32_bf16 v63, v207, v25
L_ry9:
 s_cmp_lg_u32 s70, 0
 s_cbranch_scc1 L_rk18
 s_call_b64 s[36:37], L_rpoll
L_rk18:
 s_ff1_i32_b32 s71, s70
 s_bitset0_b32 s70, s71
 s_cmp_ge_u32 s71, 16
 s_cselect_b32 s72, s78, s77
 s_cselect_b32 s73, 0x40000, 0
 s_cselect_b32 s87, 536870912, 0
 s_and_b32 s89, s71, 8
 s_lshl_b32 s89, s89, 10
 s_xor_b32 s72, s72, s89
 s_mul_i32 s71, s71, 262144
 s_add_u32 s71, s71, s72
 buffer_load_dwordx4 v[144:147], v7, s[8:11], s71 offen sc1
 s_or_b32 s69, s69, s73
 s_or_b32 s71, s71, s87
 buffer_load_dwordx4 v[148:151], v27, s[8:11], s71 offen sc1
 s_waitcnt vmcnt(16)
 s_bitcmp1_b32 s69, 10
 s_cbranch_scc1 L_rx10
 v_dot2c_f32_bf16 v48, v208, v24
 v_dot2c_f32_bf16 v49, v208, v25
 v_dot2c_f32_bf16 v50, v209, v24
 v_dot2c_f32_bf16 v51, v209, v25
 v_dot2c_f32_bf16 v52, v210, v24
 v_dot2c_f32_bf16 v53, v210, v25
 v_dot2c_f32_bf16 v54, v211, v24
 v_dot2c_f32_bf16 v55, v211, v25
 v_dot2c_f32_bf16 v56, v212, v24
 v_dot2c_f32_bf16 v57, v212, v25
 v_dot2c_f32_bf16 v58, v213, v24
 v_dot2c_f32_bf16 v59, v213, v25
 v_dot2c_f32_bf16 v60, v214, v24
 v_dot2c_f32_bf16 v61, v214, v25
 v_dot2c_f32_bf16 v62, v215, v24
 v_dot2c_f32_bf16 v63, v215, v25
L_ry10:
 s_cmp_lg_u32 s70, 0
 s_cbranch_scc1 L_rk19
 s_call_b64 s[36:37], L_rpoll
L_rk19:
 s_ff1_i32_b32 s71, s70
 s_bitset0_b32 s70, s71
 s_cmp_ge_u32 s71, 16
 s_cselect_b32 s72, s78, s77
 s_cselect_b32 s73, 0x80000, 0
 s_cselect_b32 s87, 536870912, 0
 s_and_b32 s89, s71, 8
 s_lshl_b32 s89, s89, 10
 s_xor_b32 s72, s72, s89
 s_mul_i32 s71, s71, 262144
 s_add_u32 s71, s71, s72
 buffer_load_dwordx4 v[152:155], v7, s[8:11], s71 offen sc1
 s_or_b32 s69, s69, s73
 s_or_b32 s71, s71, s87
 buffer_load_dwordx4 v[156:159], v27, s[8:11], s71 offen sc1
 s_waitcnt vmcnt(16)
 s_bitcmp1_b32 s69, 11
 s_cbranch_scc1 L_rx11
 v_dot2c_f32_bf16 v48, v216, v24
 v_dot2c_f32_bf16 v49, v216, v25
 v_dot2c_f32_bf16 v50, v217, v24
 v_dot2c_f32_bf16 v51, v217, v25
 v_dot2c_f32_bf16 v52, v218, v24
 v_dot2c_f32_bf16 v53, v218, v25
 v_dot2c_f32_bf16 v54, v219, v24
 v_dot2c_f32_bf16 v55, v219, v25
 v_dot2c_f32_bf16 v56, v220, v24
 v_dot2c_f32_bf16 v57, v220, v25
 v_dot2c_f32_bf16 v58, v221, v24
 v_dot2c_f32_bf16 v59, v221, v25
 v_dot2c_f32_bf16 v60, v222, v24
 v_dot2c_f32_bf16 v61, v222, v25
 v_dot2c_f32_bf16 v62, v223, v24
 v_dot2c_f32_bf16 v63, v223, v25
L_ry11:
 s_cmp_lg_u32 s70, 0
 s_cbranch_scc1 L_rk20
 s_call_b64 s[36:37], L_rpoll
L_rk20:
 s_ff1_i32_b32 s71, s70
 s_bitset0_b32 s70, s71
 s_cmp_ge_u32 s71, 16
 s_cselect_b32 s72, s78, s77
 s_cselect_b32 s73, 0x100000, 0
 s_cselect_b32 s87, 536870912, 0
 s_and_b32 s89, s71, 8
 s_lshl_b32 s89, s89, 10
 s_xor_b32 s72, s72, s89
 s_mul_i32 s71, s71, 262144
 s_add_u32 s71, s71, s72
 buffer_load_dwordx4 v[160:163], v7, s[8:11], s71 offen sc1
 s_or_b32 s69, s69, s73
 s_or_b32 s71, s71, s87
 buffer_load_dwordx4 v[164:167], v27, s[8:11], s71 offen sc1
 s_waitcnt vmcnt(16)
 s_bitcmp1_b32 s69, 12
 s_cbranch_scc1 L_rx12
 v_dot2c_f32_bf16 v48, v224, v24
 v_dot2c_f32_bf16 v49, v224, v25
 v_dot2c_f32_bf16 v50, v225, v24
 v_dot2c_f32_bf16 v51, v225, v25
 v_dot2c_f32_bf16 v52, v226, v24
 v_dot2c_f32_bf16 v53, v226, v25
 v_dot2c_f32_bf16 v54, v227, v24
 v_dot2c_f32_bf16 v55, v227, v25
 v_dot2c_f32_bf16 v56, v228, v24
 v_dot2c_f32_bf16 v57, v228, v25
 v_dot2c_f32_bf16 v58, v229, v24
 v_dot2c_f32_bf16 v59, v229, v25
 v_dot2c_f32_bf16 v60, v230, v24
 v_dot2c_f32_bf16 v61, v230, v25
 v_dot2c_f32_bf16 v62, v231, v24
 v_dot2c_f32_bf16 v63, v231, v25
L_ry12:
 s_cmp_lg_u32 s70, 0
 s_cbranch_scc1 L_rk21
 s_call_b64 s[36:37], L_rpoll
L_rk21:
 s_ff1_i32_b32 s71, s70
 s_bitset0_b32 s70, s71
 s_cmp_ge_u32 s71, 16
 s_cselect_b32 s72, s78, s77
 s_cselect_b32 s73, 0x200000, 0
 s_cselect_b32 s87, 536870912, 0
 s_and_b32 s89, s71, 8
 s_lshl_b32 s89, s89, 10
 s_xor_b32 s72, s72, s89
 s_mul_i32 s71, s71, 262144
 s_add_u32 s71, s71, s72
 buffer_load_dwordx4 v[168:171], v7, s[8:11], s71 offen sc1
 s_or_b32 s69, s69, s73
 s_or_b32 s71, s71, s87
 buffer_load_dwordx4 v[172:175], v27, s[8:11], s71 offen sc1
 s_waitcnt vmcnt(16)
 s_bitcmp1_b32 s69, 13
 s_cbranch_scc1 L_rx13
 v_dot2c_f32_bf16 v48, v232, v24
 v_dot2c_f32_bf16 v49, v232, v25
 v_dot2c_f32_bf16 v50, v233, v24
 v_dot2c_f32_bf16 v51, v233, v25
 v_dot2c_f32_bf16 v52, v234, v24
 v_dot2c_f32_bf16 v53, v234, v25
 v_dot2c_f32_bf16 v54, v235, v24
 v_dot2c_f32_bf16 v55, v235, v25
 v_dot2c_f32_bf16 v56, v236, v24
 v_dot2c_f32_bf16 v57, v236, v25
 v_dot2c_f32_bf16 v58, v237, v24
 v_dot2c_f32_bf16 v59, v237, v25
 v_dot2c_f32_bf16 v60, v238, v24
 v_dot2c_f32_bf16 v61, v238, v25
 v_dot2c_f32_bf16 v62, v239, v24
 v_dot2c_f32_bf16 v63, v239, v25
L_ry13:
 s_cmp_lg_u32 s70, 0
 s_cbranch_scc1 L_rk22
 s_call_b64 s[36:37], L_rpoll
L_rk22:
 s_ff1_i32_b32 s71, s70
 s_bitset0_b32 s70, s71
 s_cmp_ge_u32 s71, 16
 s_cselect_b32 s72, s78, s77
 s_cselect_b32 s73, 0x400000, 0
 s_cselect_b32 s87, 536870912, 0
 s_and_b32 s89, s71, 8
 s_lshl_b32 s89, s89, 10
 s_xor_b32 s72, s72, s89
 s_mul_i32 s71, s71, 262144
 s_add_u32 s71, s71, s72
 buffer_load_dwordx4 v[176:179], v7, s[8:11], s71 offen sc1
 s_or_b32 s69, s69, s73
 s_or_b32 s71, s71, s87
 buffer_load_dwordx4 v[180:183], v27, s[8:11], s71 offen sc1
 s_waitcnt vmcnt(16)
 s_bitcmp1_b32 s69, 14
 s_cbranch_scc1 L_rx14
 v_dot2c_f32_bf16 v48, v240, v24
 v_dot2c_f32_bf16 v49, v240, v25
 v_dot2c_f32_bf16 v50, v241, v24
 v_dot2c_f32_bf16 v51, v241, v25
 v_dot2c_f32_bf16 v52, v242, v24
 v_dot2c_f32_bf16 v53, v242, v25
 v_dot2c_f32_bf16 v54, v243, v24
 v_dot2c_f32_bf16 v55, v243, v25
 v_dot2c_f32_bf16 v56, v244, v24
 v_dot2c_f32_bf16 v57, v244, v25
 v_dot2c_f32_bf16 v58, v245, v24
 v_dot2c_f32_bf16 v59, v245, v25
 v_dot2c_f32_bf16 v60, v246, v24
 v_dot2c_f32_bf16 v61, v246, v25
 v_dot2c_f32_bf16 v62, v247, v24
 v_dot2c_f32_bf16 v63, v247, v25
L_ry14:
 s_cmp_lg_u32 s70, 0
 s_cbranch_scc1 L_rk23
 s_call_b64 s[36:37], L_rpoll
L_rk23:
 s_ff1_i32_b32 s71, s70
 s_bitset0_b32 s70, s71
 s_cmp_ge_u32 s71, 16
 s_cselect_b32 s72, s78, s77
 s_cselect_b32 s73, 0x800000, 0
 s_cselect_b32 s87, 536870912, 0
 s_and_b32 s89, s71, 8
 s_lshl_b32 s89, s89, 10
 s_xor_b32 s72, s72, s89
 s_mul_i32 s71, s71, 262144
 s_add_u32 s71, s71, s72
 buffer_load_dwordx4 v[184:187], v7, s[8:11], s71 offen sc1
 s_or_b32 s69, s69, s73
 s_or_b32 s71, s71, s87
 buffer_load_dwordx4 v[188:191], v27, s[8:11], s71 offen sc1
 s_waitcnt vmcnt(16)
 s_bitcmp1_b32 s69, 15
 s_cbranch_scc1 L_rx15
 v_dot2c_f32_bf16 v48, v248, v24
 v_dot2c_f32_bf16 v49, v248, v25
 v_dot2c_f32_bf16 v50, v249, v24
 v_dot2c_f32_bf16 v51, v249, v25
 v_dot2c_f32_bf16 v52, v250, v24
 v_dot2c_f32_bf16 v53, v250, v25
 v_dot2c_f32_bf16 v54, v251, v24
 v_dot2c_f32_bf16 v55, v251, v25
 v_dot2c_f32_bf16 v56, v252, v24
 v_dot2c_f32_bf16 v57, v252, v25
 v_dot2c_f32_bf16 v58, v253, v24
 v_dot2c_f32_bf16 v59, v253, v25
 v_dot2c_f32_bf16 v60, v254, v24
 v_dot2c_f32_bf16 v61, v254, v25
 v_dot2c_f32_bf16 v62, v255, v24
 v_dot2c_f32_bf16 v63, v255, v25
L_ry15:
 s_cmp_lg_u32 s70, 0
 s_cbranch_scc1 L_rk24
 s_call_b64 s[36:37], L_rpoll
L_rk24:
 s_ff1_i32_b32 s71, s70
 s_bitset0_b32 s70, s71
 s_cmp_ge_u32 s71, 16
 s_cselect_b32 s72, s78, s77
 s_cselect_b32 s73, 0x1000000, 0
 s_cselect_b32 s87, 536870912, 0
 s_and_b32 s89, s71, 8
 s_lshl_b32 s89, s89, 10
 s_xor_b32 s72, s72, s89
 s_mul_i32 s71, s71, 262144
 s_add_u32 s71, s71, s72
 buffer_load_dwordx4 v[192:195], v7, s[8:11], s71 offen sc1
 s_or_b32 s69, s69, s73
 s_or_b32 s71, s71, s87
 buffer_load_dwordx4 v[196:199], v27, s[8:11], s71 offen sc1
 s_waitcnt vmcnt(16)
 s_bitcmp0_b32 s69, 16
 s_cbranch_scc1 L_rx16
 v_dot2c_f32_bf16 v64, v128, v24
 v_dot2c_f32_bf16 v65, v128, v25
 v_dot2c_f32_bf16 v66, v129, v24
 v_dot2c_f32_bf16 v67, v129, v25
 v_dot2c_f32_bf16 v68, v130, v24
 v_dot2c_f32_bf16 v69, v130, v25
 v_dot2c_f32_bf16 v70, v131, v24
 v_dot2c_f32_bf16 v71, v131, v25
L_ry16:
 s_cmp_lg_u32 s70, 0
 s_cbranch_scc1 L_rk25
 s_call_b64 s[36:37], L_rpoll
L_rk25:
 s_ff1_i32_b32 s71, s70
 s_bitset0_b32 s70, s71
 s_cmp_ge_u32 s71, 16
 s_cselect_b32 s72, s78, s77
 s_cselect_b32 s73, 0x2000000, 0
 s_cselect_b32 s87, 536870912, 0
 s_and_b32 s89, s71, 8
 s_lshl_b32 s89, s89, 10
 s_xor_b32 s72, s72, s89
 s_mul_i32 s71, s71, 262144
 s_add_u32 s71, s71, s72
 buffer_load_dwordx4 v[200:203], v7, s[8:11], s71 offen sc1
 s_or_b32 s69, s69, s73
 s_or_b32 s71, s71, s87
 buffer_load_dwordx4 v[204:207], v27, s[8:11], s71 offen sc1
 s_waitcnt vmcnt(16)
 s_bitcmp0_b32 s69, 17
 s_cbranch_scc1 L_rx17
 v_dot2c_f32_bf16 v64, v136, v24
 v_dot2c_f32_bf16 v65, v136, v25
 v_dot2c_f32_bf16 v66, v137, v24
 v_dot2c_f32_bf16 v67, v137, v25
 v_dot2c_f32_bf16 v68, v138, v24
 v_dot2c_f32_bf16 v69, v138, v25
 v_dot2c_f32_bf16 v70, v139, v24
 v_dot2c_f32_bf16 v71, v139, v25
L_ry17:
 s_cmp_lg_u32 s70, 0
 s_cbranch_scc1 L_rk26
 s_call_b64 s[36:37], L_rpoll
L_rk26:
 s_ff1_i32_b32 s71, s70
 s_bitset0_b32 s70, s71
 s_cmp_ge_u32 s71, 16
 s_cselect_b32 s72, s78, s77
 s_cselect_b32 s73, 0x4000000, 0
 s_cselect_b32 s87, 536870912, 0
 s_and_b32 s89, s71, 8
 s_lshl_b32 s89, s89, 10
 s_xor_b32 s72, s72, s89
 s_mul_i32 s71, s71, 262144
 s_add_u32 s71, s71, s72
 buffer_load_dwordx4 v[208:211], v7, s[8:11], s71 offen sc1
 s_or_b32 s69, s69, s73
 s_or_b32 s71, s71, s87
 buffer_load_dwordx4 v[212:215], v27, s[8:11], s71 offen sc1
 s_waitcnt vmcnt(16)
 s_bitcmp0_b32 s69, 18
 s_cbranch_scc1 L_rx18
 v_dot2c_f32_bf16 v64, v144, v24
 v_dot2c_f32_bf16 v65, v144, v25
 v_dot2c_f32_bf16 v66, v145, v24
 v_dot2c_f32_bf16 v67, v145, v25
 v_dot2c_f32_bf16 v68, v146, v24
 v_dot2c_f32_bf16 v69, v146, v25
 v_dot2c_f32_bf16 v70, v147, v24
 v_dot2c_f32_bf16 v71, v147, v25
L_ry18:
 s_cmp_lg_u32 s70, 0
 s_cbranch_scc1 L_rk27
 s_call_b64 s[36:37], L_rpoll
L_rk27:
 s_ff1_i32_b32 s71, s70
 s_bitset0_b32 s70, s71
 s_cmp_ge_u32 s71, 16
 s_cselect_b32 s72, s78, s77
 s_cselect_b32 s73, 0x8000000, 0
 s_cselect_b32 s87, 536870912, 0
 s_and_b32 s89, s71, 8
 s_lshl_b32 s89, s89, 10
 s_xor_b32 s72, s72, s89
 s_mul_i32 s71, s71, 262144
 s_add_u32 s71, s71, s72
 buffer_load_dwordx4 v[216:219], v7, s[8:11], s71 offen sc1
 s_or_b32 s69, s69, s73
 s_or_b32 s71, s71, s87
 buffer_load_dwordx4 v[220:223], v27, s[8:11], s71 offen sc1
 s_waitcnt vmcnt(16)
 s_bitcmp0_b32 s69, 19
 s_cbranch_scc1 L_rx19
 v_dot2c_f32_bf16 v64, v152, v24
 v_dot2c_f32_bf16 v65, v152, v25
 v_dot2c_f32_bf16 v66, v153, v24
 v_dot2c_f32_bf16 v67, v153, v25
 v_dot2c_f32_bf16 v68, v154, v24
 v_dot2c_f32_bf16 v69, v154, v25
 v_dot2c_f32_bf16 v70, v155, v24
 v_dot2c_f32_bf16 v71, v155, v25
L_ry19:
 s_and_b32 s71, s69, 0xfffff
 s_bcnt1_i32_b32 s71, s71
 s_cmp_eq_u32 s71, 4
 s_cselect_b32 s66, 1, 0
 s_cbranch_scc0 L_rne
 v_fmac_f32 v32, v15, v48
 v_fmac_f32 v33, v15, v49
 v_fmac_f32 v34, v15, v50
 v_fmac_f32 v35, v15, v51
 v_fmac_f32 v36, v15, v52
 v_fmac_f32 v37, v15, v53
 v_fmac_f32 v38, v15, v54
 v_fmac_f32 v39, v15, v55
 v_cvt_pk_bf16_f32 v16, v32, v33
 v_cvt_pk_bf16_f32 v17, v34, v35
 v_cvt_pk_bf16_f32 v18, v36, v37
 v_cvt_pk_bf16_f32 v19, v38, v39
 buffer_store_dwordx4 v[16:19], v12, s[52:55], s75 offen sc1
 v_fmac_f32 v40, v15, v56
 v_fmac_f32 v41, v15, v57
 v_fmac_f32 v42, v15, v58
 v_fmac_f32 v43, v15, v59
 v_fmac_f32 v44, v15, v60
 v_fmac_f32 v45, v15, v61
 v_fmac_f32 v46, v15, v62
 v_fmac_f32 v47, v15, v63
 v_cvt_pk_bf16_f32 v20, v40, v41
 v_cvt_pk_bf16_f32 v21, v42, v43
 v_cvt_pk_bf16_f32 v22, v44, v45
 v_cvt_pk_bf16_f32 v23, v46, v47
 buffer_store_dwordx4 v[20:23], v12, s[52:55], s76 offen sc1
L_rne:
 s_cmp_lg_u32 s70, 0
 s_cbranch_scc1 L_rk28
 s_call_b64 s[36:37], L_rpoll
L_rk28:
 s_ff1_i32_b32 s71, s70
 s_bitset0_b32 s70, s71
 s_cmp_ge_u32 s71, 16
 s_cselect_b32 s72, s78, s77
 s_cselect_b32 s73, 0x10000000, 0
 s_cselect_b32 s87, 536870912, 0
 s_and_b32 s89, s71, 8
 s_lshl_b32 s89, s89, 10
 s_xor_b32 s72, s72, s89
 s_mul_i32 s71, s71, 262144
 s_add_u32 s71, s71, s72
 buffer_load_dwordx4 v[224:227], v7, s[8:11], s71 offen sc1
 s_or_b32 s69, s69, s73
 s_or_b32 s71, s71, s87
 buffer_load_dwordx4 v[228:231], v27, s[8:11], s71 offen sc1
 s_waitcnt vmcnt(16)
 s_bitcmp0_b32 s69, 20
 s_cbranch_scc1 L_rx20
 v_dot2c_f32_bf16 v64, v160, v24
 v_dot2c_f32_bf16 v65, v160, v25
 v_dot2c_f32_bf16 v66, v161, v24
 v_dot2c_f32_bf16 v67, v161, v25
 v_dot2c_f32_bf16 v68, v162, v24
 v_dot2c_f32_bf16 v69, v162, v25
 v_dot2c_f32_bf16 v70, v163, v24
 v_dot2c_f32_bf16 v71, v163, v25
L_ry20:
 s_cmp_lg_u32 s70, 0
 s_cbranch_scc1 L_rk29
 s_call_b64 s[36:37], L_rpoll
L_rk29:
 s_ff1_i32_b32 s71, s70
 s_bitset0_b32 s70, s71
 s_cmp_ge_u32 s71, 16
 s_cselect_b32 s72, s78, s77
 s_cselect_b32 s73, 0x20000000, 0
 s_cselect_b32 s87, 536870912, 0
 s_and_b32 s89, s71, 8
 s_lshl_b32 s89, s89, 10
 s_xor_b32 s72, s72, s89
 s_mul_i32 s71, s71, 262144
 s_add_u32 s71, s71, s72
 buffer_load_dwordx4 v[232:235], v7, s[8:11], s71 offen sc1
 s_or_b32 s69, s69, s73
 s_or_b32 s71, s71, s87
 buffer_load_dwordx4 v[236:239], v27, s[8:11], s71 offen sc1
 s_waitcnt vmcnt(16)
 s_bitcmp0_b32 s69, 21
 s_cbranch_scc1 L_rx21
 v_dot2c_f32_bf16 v64, v168, v24
 v_dot2c_f32_bf16 v65, v168, v25
 v_dot2c_f32_bf16 v66, v169, v24
 v_dot2c_f32_bf16 v67, v169, v25
 v_dot2c_f32_bf16 v68, v170, v24
 v_dot2c_f32_bf16 v69, v170, v25
 v_dot2c_f32_bf16 v70, v171, v24
 v_dot2c_f32_bf16 v71, v171, v25
L_ry21:
 s_cmp_lg_u32 s70, 0
 s_cbranch_scc1 L_rk30
 s_call_b64 s[36:37], L_rpoll
L_rk30:
 s_ff1_i32_b32 s71, s70
 s_bitset0_b32 s70, s71
 s_cmp_ge_u32 s71, 16
 s_cselect_b32 s72, s78, s77
 s_cselect_b32 s73, 0x40000000, 0
 s_cselect_b32 s87, 536870912, 0
 s_and_b32 s89, s71, 8
 s_lshl_b32 s89, s89, 10
 s_xor_b32 s72, s72, s89
 s_mul_i32 s71, s71, 262144
 s_add_u32 s71, s71, s72
 buffer_load_dwordx4 v[240:243], v7, s[8:11], s71 offen sc1
 s_or_b32 s69, s69, s73
 s_or_b32 s71, s71, s87
 buffer_load_dwordx4 v[244:247], v27, s[8:11], s71 offen sc1
 s_waitcnt vmcnt(16)
 s_bitcmp0_b32 s69, 22
 s_cbranch_scc1 L_rx22
 v_dot2c_f32_bf16 v64, v176, v24
 v_dot2c_f32_bf16 v65, v176, v25
 v_dot2c_f32_bf16 v66, v177, v24
 v_dot2c_f32_bf16 v67, v177, v25
 v_dot2c_f32_bf16 v68, v178, v24
 v_dot2c_f32_bf16 v69, v178, v25
 v_dot2c_f32_bf16 v70, v179, v24
 v_dot2c_f32_bf16 v71, v179, v25
L_ry22:
 s_cmp_lg_u32 s70, 0
 s_cbranch_scc1 L_rk31
 s_call_b64 s[36:37], L_rpoll
L_rk31:
 s_ff1_i32_b32 s71, s70
 s_bitset0_b32 s70, s71
 s_cmp_ge_u32 s71, 16
 s_cselect_b32 s72, s78, s77
 s_cselect_b32 s73, 0x80000000, 0
 s_cselect_b32 s87, 536870912, 0
 s_and_b32 s89, s71, 8
 s_lshl_b32 s89, s89, 10
 s_xor_b32 s72, s72, s89
 s_mul_i32 s71, s71, 262144
 s_add_u32 s71, s71, s72
 buffer_load_dwordx4 v[248:251], v7, s[8:11], s71 offen sc1
 s_or_b32 s69, s69, s73
 s_or_b32 s71, s71, s87
 buffer_load_dwordx4 v[252:255], v27, s[8:11], s71 offen sc1
 s_waitcnt vmcnt(16)
 s_bitcmp0_b32 s69, 23
 s_cbranch_scc1 L_rx23
 v_dot2c_f32_bf16 v64, v184, v24
 v_dot2c_f32_bf16 v65, v184, v25
 v_dot2c_f32_bf16 v66, v185, v24
 v_dot2c_f32_bf16 v67, v185, v25
 v_dot2c_f32_bf16 v68, v186, v24
 v_dot2c_f32_bf16 v69, v186, v25
 v_dot2c_f32_bf16 v70, v187, v24
 v_dot2c_f32_bf16 v71, v187, v25
L_ry23:
 s_waitcnt vmcnt(14)
 s_bitcmp0_b32 s69, 24
 s_cbranch_scc1 L_rx24
 v_dot2c_f32_bf16 v64, v192, v24
 v_dot2c_f32_bf16 v65, v192, v25
 v_dot2c_f32_bf16 v66, v193, v24
 v_dot2c_f32_bf16 v67, v193, v25
 v_dot2c_f32_bf16 v68, v194, v24
 v_dot2c_f32_bf16 v69, v194, v25
 v_dot2c_f32_bf16 v70, v195, v24
 v_dot2c_f32_bf16 v71, v195, v25
L_ry24:
 s_waitcnt vmcnt(12)
 s_bitcmp0_b32 s69, 25
 s_cbranch_scc1 L_rx25
 v_dot2c_f32_bf16 v64, v200, v24
 v_dot2c_f32_bf16 v65, v200, v25
 v_dot2c_f32_bf16 v66, v201, v24
 v_dot2c_f32_bf16 v67, v201, v25
 v_dot2c_f32_bf16 v68, v202, v24
 v_dot2c_f32_bf16 v69, v202, v25
 v_dot2c_f32_bf16 v70, v203, v24
 v_dot2c_f32_bf16 v71, v203, v25
L_ry25:
 s_waitcnt vmcnt(10)
 s_bitcmp0_b32 s69, 26
 s_cbranch_scc1 L_rx26
 v_dot2c_f32_bf16 v64, v208, v24
 v_dot2c_f32_bf16 v65, v208, v25
 v_dot2c_f32_bf16 v66, v209, v24
 v_dot2c_f32_bf16 v67, v209, v25
 v_dot2c_f32_bf16 v68, v210, v24
 v_dot2c_f32_bf16 v69, v210, v25
 v_dot2c_f32_bf16 v70, v211, v24
 v_dot2c_f32_bf16 v71, v211, v25
L_ry26:
 s_waitcnt vmcnt(8)
 s_bitcmp0_b32 s69, 27
 s_cbranch_scc1 L_rx27
 v_dot2c_f32_bf16 v64, v216, v24
 v_dot2c_f32_bf16 v65, v216, v25
 v_dot2c_f32_bf16 v66, v217, v24
 v_dot2c_f32_bf16 v67, v217, v25
 v_dot2c_f32_bf16 v68, v218, v24
 v_dot2c_f32_bf16 v69, v218, v25
 v_dot2c_f32_bf16 v70, v219, v24
 v_dot2c_f32_bf16 v71, v219, v25
L_ry27:
 s_waitcnt vmcnt(6)
 s_bitcmp0_b32 s69, 28
 s_cbranch_scc1 L_rx28
 v_dot2c_f32_bf16 v64, v224, v24
 v_dot2c_f32_bf16 v65, v224, v25
 v_dot2c_f32_bf16 v66, v225, v24
 v_dot2c_f32_bf16 v67, v225, v25
 v_dot2c_f32_bf16 v68, v226, v24
 v_dot2c_f32_bf16 v69, v226, v25
 v_dot2c_f32_bf16 v70, v227, v24
 v_dot2c_f32_bf16 v71, v227, v25
L_ry28:
 s_waitcnt vmcnt(4)
 s_bitcmp0_b32 s69, 29
 s_cbranch_scc1 L_rx29
 v_dot2c_f32_bf16 v64, v232, v24
 v_dot2c_f32_bf16 v65, v232, v25
 v_dot2c_f32_bf16 v66, v233, v24
 v_dot2c_f32_bf16 v67, v233, v25
 v_dot2c_f32_bf16 v68, v234, v24
 v_dot2c_f32_bf16 v69, v234, v25
 v_dot2c_f32_bf16 v70, v235, v24
 v_dot2c_f32_bf16 v71, v235, v25
L_ry29:
 s_waitcnt vmcnt(2)
 s_bitcmp0_b32 s69, 30
 s_cbranch_scc1 L_rx30
 v_dot2c_f32_bf16 v64, v240, v24
 v_dot2c_f32_bf16 v65, v240, v25
 v_dot2c_f32_bf16 v66, v241, v24
 v_dot2c_f32_bf16 v67, v241, v25
 v_dot2c_f32_bf16 v68, v242, v24
 v_dot2c_f32_bf16 v69, v242, v25
 v_dot2c_f32_bf16 v70, v243, v24
 v_dot2c_f32_bf16 v71, v243, v25
L_ry30:
 s_waitcnt vmcnt(0)
 s_bitcmp0_b32 s69, 31
 s_cbranch_scc1 L_rx31
 v_dot2c_f32_bf16 v64, v248, v24
 v_dot2c_f32_bf16 v65, v248, v25
 v_dot2c_f32_bf16 v66, v249, v24
 v_dot2c_f32_bf16 v67, v249, v25
 v_dot2c_f32_bf16 v68, v250, v24
 v_dot2c_f32_bf16 v69, v250, v25
 v_dot2c_f32_bf16 v70, v251, v24
 v_dot2c_f32_bf16 v71, v251, v25
L_ry31:
 s_nop 1
 v_fmac_f32 v80, v26, v64
 v_fmac_f32 v81, v26, v65
 v_fmac_f32 v82, v26, v66
 v_fmac_f32 v83, v26, v67
 v_fmac_f32 v84, v26, v68
 v_fmac_f32 v85, v26, v69
 v_fmac_f32 v86, v26, v70
 v_fmac_f32 v87, v26, v71
 v_cvt_pk_bf16_f32 v96, v80, v81
 v_cvt_pk_bf16_f32 v97, v82, v83
 v_cvt_pk_bf16_f32 v98, v84, v85
 v_cvt_pk_bf16_f32 v99, v86, v87
 buffer_store_dwordx4 v[96:99], v28, s[52:55], s86 offen sc1
 s_cmp_eq_u32 s66, 1
 s_cbranch_scc1 L_rdone
 v_fmac_f32 v32, v15, v48
 v_fmac_f32 v33, v15, v49
 v_fmac_f32 v34, v15, v50
 v_fmac_f32 v35, v15, v51
 v_fmac_f32 v36, v15, v52
 v_fmac_f32 v37, v15, v53
 v_fmac_f32 v38, v15, v54
 v_fmac_f32 v39, v15, v55
 v_cvt_pk_bf16_f32 v16, v32, v33
 v_cvt_pk_bf16_f32 v17, v34, v35
 v_cvt_pk_bf16_f32 v18, v36, v37
 v_cvt_pk_bf16_f32 v19, v38, v39
 buffer_store_dwordx4 v[16:19], v12, s[52:55], s75 offen sc1
 v_fmac_f32 v40, v15, v56
 v_fmac_f32 v41, v15, v57
 v_fmac_f32 v42, v15, v58
 v_fmac_f32 v43, v15, v59
 v_fmac_f32 v44, v15, v60
 v_fmac_f32 v45, v15, v61
 v_fmac_f32 v46, v15, v62
 v_fmac_f32 v47, v15, v63
 v_cvt_pk_bf16_f32 v20, v40, v41
 v_cvt_pk_bf16_f32 v21, v42, v43
 v_cvt_pk_bf16_f32 v22, v44, v45
 v_cvt_pk_bf16_f32 v23, v46, v47
 buffer_store_dwordx4 v[20:23], v12, s[52:55], s76 offen sc1
L_rdone:
 s_endpgm
L_rx0:
 v_dot2c_f32_bf16 v64, v128, v24
 v_dot2c_f32_bf16 v65, v128, v25
 v_dot2c_f32_bf16 v66, v129, v24
 v_dot2c_f32_bf16 v67, v129, v25
 v_dot2c_f32_bf16 v68, v130, v24
 v_dot2c_f32_bf16 v69, v130, v25
 v_dot2c_f32_bf16 v70, v131, v24
 v_dot2c_f32_bf16 v71, v131, v25
 s_branch L_ry0
L_rx1:
 v_dot2c_f32_bf16 v64, v136, v24
 v_dot2c_f32_bf16 v65, v136, v25
 v_dot2c_f32_bf16 v66, v137, v24
 v_dot2c_f32_bf16 v67, v137, v25
 v_dot2c_f32_bf16 v68, v138, v24
 v_dot2c_f32_bf16 v69, v138, v25
 v_dot2c_f32_bf16 v70, v139, v24
 v_dot2c_f32_bf16 v71, v139, v25
 s_branch L_ry1
L_rx2:
 v_dot2c_f32_bf16 v64, v144, v24
 v_dot2c_f32_bf16 v65, v144, v25
 v_dot2c_f32_bf16 v66, v145, v24
 v_dot2c_f32_bf16 v67, v145, v25
 v_dot2c_f32_bf16 v68, v146, v24
 v_dot2c_f32_bf16 v69, v146, v25
 v_dot2c_f32_bf16 v70, v147, v24
 v_dot2c_f32_bf16 v71, v147, v25
 s_branch L_ry2
L_rx3:
 v_dot2c_f32_bf16 v64, v152, v24
 v_dot2c_f32_bf16 v65, v152, v25
 v_dot2c_f32_bf16 v66, v153, v24
 v_dot2c_f32_bf16 v67, v153, v25
 v_dot2c_f32_bf16 v68, v154, v24
 v_dot2c_f32_bf16 v69, v154, v25
 v_dot2c_f32_bf16 v70, v155, v24
 v_dot2c_f32_bf16 v71, v155, v25
 s_branch L_ry3
L_rx4:
 v_dot2c_f32_bf16 v64, v160, v24
 v_dot2c_f32_bf16 v65, v160, v25
 v_dot2c_f32_bf16 v66, v161, v24
 v_dot2c_f32_bf16 v67, v161, v25
 v_dot2c_f32_bf16 v68, v162, v24
 v_dot2c_f32_bf16 v69, v162, v25
 v_dot2c_f32_bf16 v70, v163, v24
 v_dot2c_f32_bf16 v71, v163, v25
 s_branch L_ry4
L_rx5:
 v_dot2c_f32_bf16 v64, v168, v24
 v_dot2c_f32_bf16 v65, v168, v25
 v_dot2c_f32_bf16 v66, v169, v24
 v_dot2c_f32_bf16 v67, v169, v25
 v_dot2c_f32_bf16 v68, v170, v24
 v_dot2c_f32_bf16 v69, v170, v25
 v_dot2c_f32_bf16 v70, v171, v24
 v_dot2c_f32_bf16 v71, v171, v25
 s_branch L_ry5
L_rx6:
 v_dot2c_f32_bf16 v64, v176, v24
 v_dot2c_f32_bf16 v65, v176, v25
 v_dot2c_f32_bf16 v66, v177, v24
 v_dot2c_f32_bf16 v67, v177, v25
 v_dot2c_f32_bf16 v68, v178, v24
 v_dot2c_f32_bf16 v69, v178, v25
 v_dot2c_f32_bf16 v70, v179, v24
 v_dot2c_f32_bf16 v71, v179, v25
 s_branch L_ry6
L_rx7:
 v_dot2c_f32_bf16 v64, v184, v24
 v_dot2c_f32_bf16 v65, v184, v25
 v_dot2c_f32_bf16 v66, v185, v24
 v_dot2c_f32_bf16 v67, v185, v25
 v_dot2c_f32_bf16 v68, v186, v24
 v_dot2c_f32_bf16 v69, v186, v25
 v_dot2c_f32_bf16 v70, v187, v24
 v_dot2c_f32_bf16 v71, v187, v25
 s_branch L_ry7
L_rx8:
 v_dot2c_f32_bf16 v64, v192, v24
 v_dot2c_f32_bf16 v65, v192, v25
 v_dot2c_f32_bf16 v66, v193, v24
 v_dot2c_f32_bf16 v67, v193, v25
 v_dot2c_f32_bf16 v68, v194, v24
 v_dot2c_f32_bf16 v69, v194, v25
 v_dot2c_f32_bf16 v70, v195, v24
 v_dot2c_f32_bf16 v71, v195, v25
 s_branch L_ry8
L_rx9:
 v_dot2c_f32_bf16 v64, v200, v24
 v_dot2c_f32_bf16 v65, v200, v25
 v_dot2c_f32_bf16 v66, v201, v24
 v_dot2c_f32_bf16 v67, v201, v25
 v_dot2c_f32_bf16 v68, v202, v24
 v_dot2c_f32_bf16 v69, v202, v25
 v_dot2c_f32_bf16 v70, v203, v24
 v_dot2c_f32_bf16 v71, v203, v25
 s_branch L_ry9
L_rx10:
 v_dot2c_f32_bf16 v64, v208, v24
 v_dot2c_f32_bf16 v65, v208, v25
 v_dot2c_f32_bf16 v66, v209, v24
 v_dot2c_f32_bf16 v67, v209, v25
 v_dot2c_f32_bf16 v68, v210, v24
 v_dot2c_f32_bf16 v69, v210, v25
 v_dot2c_f32_bf16 v70, v211, v24
 v_dot2c_f32_bf16 v71, v211, v25
 s_branch L_ry10
L_rx11:
 v_dot2c_f32_bf16 v64, v216, v24
 v_dot2c_f32_bf16 v65, v216, v25
 v_dot2c_f32_bf16 v66, v217, v24
 v_dot2c_f32_bf16 v67, v217, v25
 v_dot2c_f32_bf16 v68, v218, v24
 v_dot2c_f32_bf16 v69, v218, v25
 v_dot2c_f32_bf16 v70, v219, v24
 v_dot2c_f32_bf16 v71, v219, v25
 s_branch L_ry11
L_rx12:
 v_dot2c_f32_bf16 v64, v224, v24
 v_dot2c_f32_bf16 v65, v224, v25
 v_dot2c_f32_bf16 v66, v225, v24
 v_dot2c_f32_bf16 v67, v225, v25
 v_dot2c_f32_bf16 v68, v226, v24
 v_dot2c_f32_bf16 v69, v226, v25
 v_dot2c_f32_bf16 v70, v227, v24
 v_dot2c_f32_bf16 v71, v227, v25
 s_branch L_ry12
L_rx13:
 v_dot2c_f32_bf16 v64, v232, v24
 v_dot2c_f32_bf16 v65, v232, v25
 v_dot2c_f32_bf16 v66, v233, v24
 v_dot2c_f32_bf16 v67, v233, v25
 v_dot2c_f32_bf16 v68, v234, v24
 v_dot2c_f32_bf16 v69, v234, v25
 v_dot2c_f32_bf16 v70, v235, v24
 v_dot2c_f32_bf16 v71, v235, v25
 s_branch L_ry13
L_rx14:
 v_dot2c_f32_bf16 v64, v240, v24
 v_dot2c_f32_bf16 v65, v240, v25
 v_dot2c_f32_bf16 v66, v241, v24
 v_dot2c_f32_bf16 v67, v241, v25
 v_dot2c_f32_bf16 v68, v242, v24
 v_dot2c_f32_bf16 v69, v242, v25
 v_dot2c_f32_bf16 v70, v243, v24
 v_dot2c_f32_bf16 v71, v243, v25
 s_branch L_ry14
L_rx15:
 v_dot2c_f32_bf16 v64, v248, v24
 v_dot2c_f32_bf16 v65, v248, v25
 v_dot2c_f32_bf16 v66, v249, v24
 v_dot2c_f32_bf16 v67, v249, v25
 v_dot2c_f32_bf16 v68, v250, v24
 v_dot2c_f32_bf16 v69, v250, v25
 v_dot2c_f32_bf16 v70, v251, v24
 v_dot2c_f32_bf16 v71, v251, v25
 s_branch L_ry15
L_rx16:
 v_dot2c_f32_bf16 v48, v128, v24
 v_dot2c_f32_bf16 v49, v128, v25
 v_dot2c_f32_bf16 v50, v129, v24
 v_dot2c_f32_bf16 v51, v129, v25
 v_dot2c_f32_bf16 v52, v130, v24
 v_dot2c_f32_bf16 v53, v130, v25
 v_dot2c_f32_bf16 v54, v131, v24
 v_dot2c_f32_bf16 v55, v131, v25
 v_dot2c_f32_bf16 v56, v132, v24
 v_dot2c_f32_bf16 v57, v132, v25
 v_dot2c_f32_bf16 v58, v133, v24
 v_dot2c_f32_bf16 v59, v133, v25
 v_dot2c_f32_bf16 v60, v134, v24
 v_dot2c_f32_bf16 v61, v134, v25
 v_dot2c_f32_bf16 v62, v135, v24
 v_dot2c_f32_bf16 v63, v135, v25
 s_branch L_ry16
L_rx17:
 v_dot2c_f32_bf16 v48, v136, v24
 v_dot2c_f32_bf16 v49, v136, v25
 v_dot2c_f32_bf16 v50, v137, v24
 v_dot2c_f32_bf16 v51, v137, v25
 v_dot2c_f32_bf16 v52, v138, v24
 v_dot2c_f32_bf16 v53, v138, v25
 v_dot2c_f32_bf16 v54, v139, v24
 v_dot2c_f32_bf16 v55, v139, v25
 v_dot2c_f32_bf16 v56, v140, v24
 v_dot2c_f32_bf16 v57, v140, v25
 v_dot2c_f32_bf16 v58, v141, v24
 v_dot2c_f32_bf16 v59, v141, v25
 v_dot2c_f32_bf16 v60, v142, v24
 v_dot2c_f32_bf16 v61, v142, v25
 v_dot2c_f32_bf16 v62, v143, v24
 v_dot2c_f32_bf16 v63, v143, v25
 s_branch L_ry17
L_rx18:
 v_dot2c_f32_bf16 v48, v144, v24
 v_dot2c_f32_bf16 v49, v144, v25
 v_dot2c_f32_bf16 v50, v145, v24
 v_dot2c_f32_bf16 v51, v145, v25
 v_dot2c_f32_bf16 v52, v146, v24
 v_dot2c_f32_bf16 v53, v146, v25
 v_dot2c_f32_bf16 v54, v147, v24
 v_dot2c_f32_bf16 v55, v147, v25
 v_dot2c_f32_bf16 v56, v148, v24
 v_dot2c_f32_bf16 v57, v148, v25
 v_dot2c_f32_bf16 v58, v149, v24
 v_dot2c_f32_bf16 v59, v149, v25
 v_dot2c_f32_bf16 v60, v150, v24
 v_dot2c_f32_bf16 v61, v150, v25
 v_dot2c_f32_bf16 v62, v151, v24
 v_dot2c_f32_bf16 v63, v151, v25
 s_branch L_ry18
L_rx19:
 v_dot2c_f32_bf16 v48, v152, v24
 v_dot2c_f32_bf16 v49, v152, v25
 v_dot2c_f32_bf16 v50, v153, v24
 v_dot2c_f32_bf16 v51, v153, v25
 v_dot2c_f32_bf16 v52, v154, v24
 v_dot2c_f32_bf16 v53, v154, v25
 v_dot2c_f32_bf16 v54, v155, v24
 v_dot2c_f32_bf16 v55, v155, v25
 v_dot2c_f32_bf16 v56, v156, v24
 v_dot2c_f32_bf16 v57, v156, v25
 v_dot2c_f32_bf16 v58, v157, v24
 v_dot2c_f32_bf16 v59, v157, v25
 v_dot2c_f32_bf16 v60, v158, v24
 v_dot2c_f32_bf16 v61, v158, v25
 v_dot2c_f32_bf16 v62, v159, v24
 v_dot2c_f32_bf16 v63, v159, v25
 s_branch L_ry19
L_rx20:
 v_dot2c_f32_bf16 v48, v160, v24
 v_dot2c_f32_bf16 v49, v160, v25
 v_dot2c_f32_bf16 v50, v161, v24
 v_dot2c_f32_bf16 v51, v161, v25
 v_dot2c_f32_bf16 v52, v162, v24
 v_dot2c_f32_bf16 v53, v162, v25
 v_dot2c_f32_bf16 v54, v163, v24
 v_dot2c_f32_bf16 v55, v163, v25
 v_dot2c_f32_bf16 v56, v164, v24
 v_dot2c_f32_bf16 v57, v164, v25
 v_dot2c_f32_bf16 v58, v165, v24
 v_dot2c_f32_bf16 v59, v165, v25
 v_dot2c_f32_bf16 v60, v166, v24
 v_dot2c_f32_bf16 v61, v166, v25
 v_dot2c_f32_bf16 v62, v167, v24
 v_dot2c_f32_bf16 v63, v167, v25
 s_branch L_ry20
L_rx21:
 v_dot2c_f32_bf16 v48, v168, v24
 v_dot2c_f32_bf16 v49, v168, v25
 v_dot2c_f32_bf16 v50, v169, v24
 v_dot2c_f32_bf16 v51, v169, v25
 v_dot2c_f32_bf16 v52, v170, v24
 v_dot2c_f32_bf16 v53, v170, v25
 v_dot2c_f32_bf16 v54, v171, v24
 v_dot2c_f32_bf16 v55, v171, v25
 v_dot2c_f32_bf16 v56, v172, v24
 v_dot2c_f32_bf16 v57, v172, v25
 v_dot2c_f32_bf16 v58, v173, v24
 v_dot2c_f32_bf16 v59, v173, v25
 v_dot2c_f32_bf16 v60, v174, v24
 v_dot2c_f32_bf16 v61, v174, v25
 v_dot2c_f32_bf16 v62, v175, v24
 v_dot2c_f32_bf16 v63, v175, v25
 s_branch L_ry21
L_rx22:
 v_dot2c_f32_bf16 v48, v176, v24
 v_dot2c_f32_bf16 v49, v176, v25
 v_dot2c_f32_bf16 v50, v177, v24
 v_dot2c_f32_bf16 v51, v177, v25
 v_dot2c_f32_bf16 v52, v178, v24
 v_dot2c_f32_bf16 v53, v178, v25
 v_dot2c_f32_bf16 v54, v179, v24
 v_dot2c_f32_bf16 v55, v179, v25
 v_dot2c_f32_bf16 v56, v180, v24
 v_dot2c_f32_bf16 v57, v180, v25
 v_dot2c_f32_bf16 v58, v181, v24
 v_dot2c_f32_bf16 v59, v181, v25
 v_dot2c_f32_bf16 v60, v182, v24
 v_dot2c_f32_bf16 v61, v182, v25
 v_dot2c_f32_bf16 v62, v183, v24
 v_dot2c_f32_bf16 v63, v183, v25
 s_branch L_ry22
L_rx23:
 v_dot2c_f32_bf16 v48, v184, v24
 v_dot2c_f32_bf16 v49, v184, v25
 v_dot2c_f32_bf16 v50, v185, v24
 v_dot2c_f32_bf16 v51, v185, v25
 v_dot2c_f32_bf16 v52, v186, v24
 v_dot2c_f32_bf16 v53, v186, v25
 v_dot2c_f32_bf16 v54, v187, v24
 v_dot2c_f32_bf16 v55, v187, v25
 v_dot2c_f32_bf16 v56, v188, v24
 v_dot2c_f32_bf16 v57, v188, v25
 v_dot2c_f32_bf16 v58, v189, v24
 v_dot2c_f32_bf16 v59, v189, v25
 v_dot2c_f32_bf16 v60, v190, v24
 v_dot2c_f32_bf16 v61, v190, v25
 v_dot2c_f32_bf16 v62, v191, v24
 v_dot2c_f32_bf16 v63, v191, v25
 s_branch L_ry23
L_rx24:
 v_dot2c_f32_bf16 v48, v192, v24
 v_dot2c_f32_bf16 v49, v192, v25
 v_dot2c_f32_bf16 v50, v193, v24
 v_dot2c_f32_bf16 v51, v193, v25
 v_dot2c_f32_bf16 v52, v194, v24
 v_dot2c_f32_bf16 v53, v194, v25
 v_dot2c_f32_bf16 v54, v195, v24
 v_dot2c_f32_bf16 v55, v195, v25
 v_dot2c_f32_bf16 v56, v196, v24
 v_dot2c_f32_bf16 v57, v196, v25
 v_dot2c_f32_bf16 v58, v197, v24
 v_dot2c_f32_bf16 v59, v197, v25
 v_dot2c_f32_bf16 v60, v198, v24
 v_dot2c_f32_bf16 v61, v198, v25
 v_dot2c_f32_bf16 v62, v199, v24
 v_dot2c_f32_bf16 v63, v199, v25
 s_branch L_ry24
L_rx25:
 v_dot2c_f32_bf16 v48, v200, v24
 v_dot2c_f32_bf16 v49, v200, v25
 v_dot2c_f32_bf16 v50, v201, v24
 v_dot2c_f32_bf16 v51, v201, v25
 v_dot2c_f32_bf16 v52, v202, v24
 v_dot2c_f32_bf16 v53, v202, v25
 v_dot2c_f32_bf16 v54, v203, v24
 v_dot2c_f32_bf16 v55, v203, v25
 v_dot2c_f32_bf16 v56, v204, v24
 v_dot2c_f32_bf16 v57, v204, v25
 v_dot2c_f32_bf16 v58, v205, v24
 v_dot2c_f32_bf16 v59, v205, v25
 v_dot2c_f32_bf16 v60, v206, v24
 v_dot2c_f32_bf16 v61, v206, v25
 v_dot2c_f32_bf16 v62, v207, v24
 v_dot2c_f32_bf16 v63, v207, v25
 s_branch L_ry25
L_rx26:
 v_dot2c_f32_bf16 v48, v208, v24
 v_dot2c_f32_bf16 v49, v208, v25
 v_dot2c_f32_bf16 v50, v209, v24
 v_dot2c_f32_bf16 v51, v209, v25
 v_dot2c_f32_bf16 v52, v210, v24
 v_dot2c_f32_bf16 v53, v210, v25
 v_dot2c_f32_bf16 v54, v211, v24
 v_dot2c_f32_bf16 v55, v211, v25
 v_dot2c_f32_bf16 v56, v212, v24
 v_dot2c_f32_bf16 v57, v212, v25
 v_dot2c_f32_bf16 v58, v213, v24
 v_dot2c_f32_bf16 v59, v213, v25
 v_dot2c_f32_bf16 v60, v214, v24
 v_dot2c_f32_bf16 v61, v214, v25
 v_dot2c_f32_bf16 v62, v215, v24
 v_dot2c_f32_bf16 v63, v215, v25
 s_branch L_ry26
L_rx27:
 v_dot2c_f32_bf16 v48, v216, v24
 v_dot2c_f32_bf16 v49, v216, v25
 v_dot2c_f32_bf16 v50, v217, v24
 v_dot2c_f32_bf16 v51, v217, v25
 v_dot2c_f32_bf16 v52, v218, v24
 v_dot2c_f32_bf16 v53, v218, v25
 v_dot2c_f32_bf16 v54, v219, v24
 v_dot2c_f32_bf16 v55, v219, v25
 v_dot2c_f32_bf16 v56, v220, v24
 v_dot2c_f32_bf16 v57, v220, v25
 v_dot2c_f32_bf16 v58, v221, v24
 v_dot2c_f32_bf16 v59, v221, v25
 v_dot2c_f32_bf16 v60, v222, v24
 v_dot2c_f32_bf16 v61, v222, v25
 v_dot2c_f32_bf16 v62, v223, v24
 v_dot2c_f32_bf16 v63, v223, v25
 s_branch L_ry27
L_rx28:
 v_dot2c_f32_bf16 v48, v224, v24
 v_dot2c_f32_bf16 v49, v224, v25
 v_dot2c_f32_bf16 v50, v225, v24
 v_dot2c_f32_bf16 v51, v225, v25
 v_dot2c_f32_bf16 v52, v226, v24
 v_dot2c_f32_bf16 v53, v226, v25
 v_dot2c_f32_bf16 v54, v227, v24
 v_dot2c_f32_bf16 v55, v227, v25
 v_dot2c_f32_bf16 v56, v228, v24
 v_dot2c_f32_bf16 v57, v228, v25
 v_dot2c_f32_bf16 v58, v229, v24
 v_dot2c_f32_bf16 v59, v229, v25
 v_dot2c_f32_bf16 v60, v230, v24
 v_dot2c_f32_bf16 v61, v230, v25
 v_dot2c_f32_bf16 v62, v231, v24
 v_dot2c_f32_bf16 v63, v231, v25
 s_branch L_ry28
L_rx29:
 v_dot2c_f32_bf16 v48, v232, v24
 v_dot2c_f32_bf16 v49, v232, v25
 v_dot2c_f32_bf16 v50, v233, v24
 v_dot2c_f32_bf16 v51, v233, v25
 v_dot2c_f32_bf16 v52, v234, v24
 v_dot2c_f32_bf16 v53, v234, v25
 v_dot2c_f32_bf16 v54, v235, v24
 v_dot2c_f32_bf16 v55, v235, v25
 v_dot2c_f32_bf16 v56, v236, v24
 v_dot2c_f32_bf16 v57, v236, v25
 v_dot2c_f32_bf16 v58, v237, v24
 v_dot2c_f32_bf16 v59, v237, v25
 v_dot2c_f32_bf16 v60, v238, v24
 v_dot2c_f32_bf16 v61, v238, v25
 v_dot2c_f32_bf16 v62, v239, v24
 v_dot2c_f32_bf16 v63, v239, v25
 s_branch L_ry29
L_rx30:
 v_dot2c_f32_bf16 v48, v240, v24
 v_dot2c_f32_bf16 v49, v240, v25
 v_dot2c_f32_bf16 v50, v241, v24
 v_dot2c_f32_bf16 v51, v241, v25
 v_dot2c_f32_bf16 v52, v242, v24
 v_dot2c_f32_bf16 v53, v242, v25
 v_dot2c_f32_bf16 v54, v243, v24
 v_dot2c_f32_bf16 v55, v243, v25
 v_dot2c_f32_bf16 v56, v244, v24
 v_dot2c_f32_bf16 v57, v244, v25
 v_dot2c_f32_bf16 v58, v245, v24
 v_dot2c_f32_bf16 v59, v245, v25
 v_dot2c_f32_bf16 v60, v246, v24
 v_dot2c_f32_bf16 v61, v246, v25
 v_dot2c_f32_bf16 v62, v247, v24
 v_dot2c_f32_bf16 v63, v247, v25
 s_branch L_ry30
L_rx31:
 v_dot2c_f32_bf16 v48, v248, v24
 v_dot2c_f32_bf16 v49, v248, v25
 v_dot2c_f32_bf16 v50, v249, v24
 v_dot2c_f32_bf16 v51, v249, v25
 v_dot2c_f32_bf16 v52, v250, v24
 v_dot2c_f32_bf16 v53, v250, v25
 v_dot2c_f32_bf16 v54, v251, v24
 v_dot2c_f32_bf16 v55, v251, v25
 v_dot2c_f32_bf16 v56, v252, v24
 v_dot2c_f32_bf16 v57, v252, v25
 v_dot2c_f32_bf16 v58, v253, v24
 v_dot2c_f32_bf16 v59, v253, v25
 v_dot2c_f32_bf16 v60, v254, v24
 v_dot2c_f32_bf16 v61, v254, v25
 v_dot2c_f32_bf16 v62, v255, v24
 v_dot2c_f32_bf16 v63, v255, v25
 s_branch L_ry31
L_rpoll0:
 s_sleep 1
L_rpoll:
 buffer_load_dword v9, v14, s[8:11], s46 offen sc1
 s_waitcnt vmcnt(0)
 v_cmp_eq_u32 vcc, 1, v9
 s_sub_u32 s91, s91, 1
 s_cselect_b32 s70, -1, 0
 s_or_b32 s70, s70, vcc_lo
 s_andn2_b32 s70, s70, s68
 s_cbranch_scc0 L_rpoll0
 s_or_b32 s68, s68, s70
 s_setpc_b64 s[36:37]
L_comb:
 buffer_load_dwordx4 v[14:17], v7, s[8:11], s52 offen sc1
 s_waitcnt vmcnt(0)
 s_nop 7
 v_sub_f32 v10, v32, v14
 v_sub_f32 v11, v36, v15
 v_max_f32 v10, 0, v10
 v_max_f32 v11, 0, v11
 v_sub_f32 v100, v100, v11
 v_sub_f32 v101, v101, v11
 v_sub_f32 v102, v102, v11
 v_sub_f32 v103, v103, v11
 v_sub_f32 v108, v108, v11
 v_sub_f32 v109, v109, v11
 v_sub_f32 v110, v110, v11
 v_sub_f32 v111, v111, v11
 v_sub_f32 v116, v116, v11
 v_sub_f32 v117, v117, v11
 v_sub_f32 v118, v118, v11
 v_sub_f32 v119, v119, v11
 v_sub_f32 v124, v124, v11
 v_sub_f32 v125, v125, v11
 v_sub_f32 v126, v126, v11
 v_sub_f32 v127, v127, v11
 v_sub_f32 v64, v64, v10
 v_sub_f32 v65, v65, v10
 v_sub_f32 v66, v66, v10
 v_sub_f32 v67, v67, v10
 v_sub_f32 v68, v68, v11
 v_sub_f32 v69, v69, v11
 v_sub_f32 v70, v70, v11
 v_sub_f32 v71, v71, v11
 v_sub_f32 v72, v72, v10
 v_sub_f32 v73, v73, v10
 v_sub_f32 v74, v74, v10
 v_sub_f32 v75, v75, v10
 v_sub_f32 v76, v76, v11
 v_sub_f32 v77, v77, v11
 v_sub_f32 v78, v78, v11
 v_sub_f32 v79, v79, v11
 v_sub_f32 v80, v80, v10
 v_sub_f32 v81, v81, v10
 v_sub_f32 v82, v82, v10
 v_sub_f32 v83, v83, v10
 v_sub_f32 v84, v84, v11
 v_sub_f32 v85, v85, v11
 v_sub_f32 v86, v86, v11
 v_sub_f32 v87, v87, v11
 v_sub_f32 v88, v88, v10
 v_sub_f32 v89, v89, v10
 v_sub_f32 v90, v90, v10
 v_sub_f32 v91, v91, v10
 v_sub_f32 v92, v92, v11
 v_sub_f32 v93, v93, v11
 v_sub_f32 v94, v94, v11
 v_sub_f32 v95, v95, v11
 v_sub_f32 v32, v32, v10
 v_sub_f32 v33, v33, v10
 v_sub_f32 v34, v34, v10
 v_sub_f32 v35, v35, v10
 v_sub_f32 v36, v36, v11
 v_sub_f32 v37, v37, v11
 v_sub_f32 v38, v38, v11
 v_sub_f32 v39, v39, v11
 v_exp_f32 v12, -v10
 v_exp_f32 v13, -v11
 v_mul_f32 v30, v12, v30
 v_mul_f32 v31, v13, v31
 v_mul_f32 v128, v12, v128
 v_mul_f32 v129, v12, v129
 v_mul_f32 v130, v12, v130
 v_mul_f32 v131, v12, v131
 v_mul_f32 v132, v13, v132
 v_mul_f32 v133, v13, v133
 v_mul_f32 v134, v13, v134
 v_mul_f32 v135, v13, v135
 v_mul_f32 v136, v12, v136
 v_mul_f32 v137, v12, v137
 v_mul_f32 v138, v12, v138
 v_mul_f32 v139, v12, v139
 v_mul_f32 v140, v13, v140
 v_mul_f32 v141, v13, v141
 v_mul_f32 v142, v13, v142
 v_mul_f32 v143, v13, v143
 v_mul_f32 v144, v12, v144
 v_mul_f32 v145, v12, v145
 v_mul_f32 v146, v12, v146
 v_mul_f32 v147, v12, v147
 v_mul_f32 v148, v13, v148
 v_mul_f32 v149, v13, v149
 v_mul_f32 v150, v13, v150
 v_mul_f32 v151, v13, v151
 v_mul_f32 v152, v12, v152
 v_mul_f32 v153, v12, v153
 v_mul_f32 v154, v12, v154
 v_mul_f32 v155, v12, v155
 v_mul_f32 v156, v13, v156
 v_mul_f32 v157, v13, v157
 v_mul_f32 v158, v13, v158
 v_mul_f32 v159, v13, v159
 v_mul_f32 v160, v12, v160
 v_mul_f32 v161, v12, v161
 v_mul_f32 v162, v12, v162
 v_mul_f32 v163, v12, v163
 v_mul_f32 v164, v13, v164
 v_mul_f32 v165, v13, v165
 v_mul_f32 v166, v13, v166
 v_mul_f32 v167, v13, v167
 v_mul_f32 v168, v12, v168
 v_mul_f32 v169, v12, v169
 v_mul_f32 v170, v12, v170
 v_mul_f32 v171, v12, v171
 v_mul_f32 v172, v13, v172
 v_mul_f32 v173, v13, v173
 v_mul_f32 v174, v13, v174
 v_mul_f32 v175, v13, v175
 v_mul_f32 v176, v12, v176
 v_mul_f32 v177, v12, v177
 v_mul_f32 v178, v12, v178
 v_mul_f32 v179, v12, v179
 v_mul_f32 v180, v13, v180
 v_mul_f32 v181, v13, v181
 v_mul_f32 v182, v13, v182
 v_mul_f32 v183, v13, v183
 v_mul_f32 v184, v12, v184
 v_mul_f32 v185, v12, v185
 v_mul_f32 v186, v12, v186
 v_mul_f32 v187, v12, v187
 v_mul_f32 v188, v13, v188
 v_mul_f32 v189, v13, v189
 v_mul_f32 v190, v13, v190
 v_mul_f32 v191, v13, v191
 v_mul_f32 v192, v12, v192
 v_mul_f32 v193, v12, v193
 v_mul_f32 v194, v12, v194
 v_mul_f32 v195, v12, v195
 v_mul_f32 v196, v13, v196
 v_mul_f32 v197, v13, v197
 v_mul_f32 v198, v13, v198
 v_mul_f32 v199, v13, v199
 v_mul_f32 v200, v12, v200
 v_mul_f32 v201, v12, v201
 v_mul_f32 v202, v12, v202
 v_mul_f32 v203, v12, v203
 v_mul_f32 v204, v13, v204
 v_mul_f32 v205, v13, v205
 v_mul_f32 v206, v13, v206
 v_mul_f32 v207, v13, v207
 v_mul_f32 v208, v12, v208
 v_mul_f32 v209, v12, v209
 v_mul_f32 v210, v12, v210
 v_mul_f32 v211, v12, v211
 v_mul_f32 v212, v13, v212
 v_mul_f32 v213, v13, v213
 v_mul_f32 v214, v13, v214
 v_mul_f32 v215, v13, v215
 v_mul_f32 v216, v12, v216
 v_mul_f32 v217, v12, v217
 v_mul_f32 v218, v12, v218
 v_mul_f32 v219, v12, v219
 v_mul_f32 v220, v13, v220
 v_mul_f32 v221, v13, v221
 v_mul_f32 v222, v13, v222
 v_mul_f32 v223, v13, v223
 v_mul_f32 v224, v12, v224
 v_mul_f32 v225, v12, v225
 v_mul_f32 v226, v12, v226
 v_mul_f32 v227, v12, v227
 v_mul_f32 v228, v13, v228
 v_mul_f32 v229, v13, v229
 v_mul_f32 v230, v13, v230
 v_mul_f32 v231, v13, v231
 v_mul_f32 v232, v12, v232
 v_mul_f32 v233, v12, v233
 v_mul_f32 v234, v12, v234
 v_mul_f32 v235, v12, v235
 v_mul_f32 v236, v13, v236
 v_mul_f32 v237, v13, v237
 v_mul_f32 v238, v13, v238
 v_mul_f32 v239, v13, v239
 v_mul_f32 v240, v12, v240
 v_mul_f32 v241, v12, v241
 v_mul_f32 v242, v12, v242
 v_mul_f32 v243, v12, v243
 v_mul_f32 v244, v13, v244
 v_mul_f32 v245, v13, v245
 v_mul_f32 v246, v13, v246
 v_mul_f32 v247, v13, v247
 v_mul_f32 v248, v12, v248
 v_mul_f32 v249, v12, v249
 v_mul_f32 v250, v12, v250
 v_mul_f32 v251, v12, v251
 v_mul_f32 v252, v13, v252
 v_mul_f32 v253, v13, v253
 v_mul_f32 v254, v13, v254
 v_mul_f32 v255, v13, v255
 v_exp_f32 v18, v64
 v_exp_f32 v19, v65
 v_exp_f32 v20, v66
 v_add_f32 v26, v18, v19
 v_cvt_pk_bf16_f32 v40, v18, v19
 v_exp_f32 v21, v67
 v_exp_f32 v22, v72
 v_add_f32 v26, v20, v26
 v_cvt_pk_bf16_f32 v41, v20, v21
 v_exp_f32 v23, v73
 v_add_f32 v26, v21, v26
 v_exp_f32 v24, v74
 v_add_f32 v26, v22, v26
 v_cvt_pk_bf16_f32 v42, v22, v23
 v_exp_f32 v25, v75
 v_add_f32 v26, v23, v26
 v_exp_f32 v18, v68
 v_add_f32 v26, v24, v26
 v_cvt_pk_bf16_f32 v43, v24, v25
 v_exp_f32 v19, v69
 v_add_f32 v26, v25, v26
 v_exp_f32 v20, v70
 v_add_f32 v27, v18, v19
 v_cvt_pk_bf16_f32 v44, v18, v19
 v_exp_f32 v21, v71
 v_exp_f32 v22, v76
 v_add_f32 v27, v20, v27
 v_cvt_pk_bf16_f32 v45, v20, v21
 v_exp_f32 v23, v77
 v_add_f32 v27, v21, v27
 v_exp_f32 v24, v78
 v_add_f32 v27, v22, v27
 v_cvt_pk_bf16_f32 v46, v22, v23
 v_exp_f32 v25, v79
 v_add_f32 v27, v23, v27
 v_add_f32 v27, v24, v27
 v_cvt_pk_bf16_f32 v47, v24, v25
 v_add_f32 v27, v25, v27
 v_sub_f32 v10, v32, v14
 v_sub_f32 v11, v36, v15
 v_cvt_i32_f32 v10, v10
 v_cvt_i32_f32 v11, v11
 v_ldexp_f32 v10, 1.0, v10
 v_ldexp_f32 v11, 1.0, v11
 v_and_b32 v10, 0xffff0000, v10
 v_and_b32 v11, 0xffff0000, v11
 v_fmac_f32 v30, v10, v16
 v_fmac_f32 v31, v11, v17
 v_lshrrev_b32 v12, 16, v10
 v_lshrrev_b32 v13, 16, v11
 v_accvgpr_read_b32 v18, a128
 v_dot2c_f32_bf16 v128, v18, v12
 v_dot2c_f32_bf16 v129, v18, v10
 v_accvgpr_read_b32 v19, a129
 v_dot2c_f32_bf16 v130, v19, v12
 v_dot2c_f32_bf16 v131, v19, v10
 v_accvgpr_read_b32 v20, a130
 v_dot2c_f32_bf16 v136, v20, v12
 v_dot2c_f32_bf16 v137, v20, v10
 v_accvgpr_read_b32 v21, a131
 v_dot2c_f32_bf16 v138, v21, v12
 v_dot2c_f32_bf16 v139, v21, v10
 v_accvgpr_read_b32 v22, a132
 v_dot2c_f32_bf16 v144, v22, v12
 v_dot2c_f32_bf16 v145, v22, v10
 v_accvgpr_read_b32 v23, a133
 v_dot2c_f32_bf16 v146, v23, v12
 v_dot2c_f32_bf16 v147, v23, v10
 v_accvgpr_read_b32 v24, a134
 v_dot2c_f32_bf16 v152, v24, v12
 v_dot2c_f32_bf16 v153, v24, v10
 v_accvgpr_read_b32 v25, a135
 v_dot2c_f32_bf16 v154, v25, v12
 v_dot2c_f32_bf16 v155, v25, v10
 v_accvgpr_read_b32 v18, a136
 v_dot2c_f32_bf16 v160, v18, v12
 v_dot2c_f32_bf16 v161, v18, v10
 v_accvgpr_read_b32 v19, a137
 v_dot2c_f32_bf16 v162, v19, v12
 v_dot2c_f32_bf16 v163, v19, v10
 v_accvgpr_read_b32 v20, a138
 v_dot2c_f32_bf16 v168, v20, v12
 v_dot2c_f32_bf16 v169, v20, v10
 v_accvgpr_read_b32 v21, a139
 v_dot2c_f32_bf16 v170, v21, v12
 v_dot2c_f32_bf16 v171, v21, v10
 v_accvgpr_read_b32 v22, a140
 v_dot2c_f32_bf16 v176, v22, v12
 v_dot2c_f32_bf16 v177, v22, v10
 v_accvgpr_read_b32 v23, a141
 v_dot2c_f32_bf16 v178, v23, v12
 v_dot2c_f32_bf16 v179, v23, v10
 v_accvgpr_read_b32 v24, a142
 v_dot2c_f32_bf16 v184, v24, v12
 v_dot2c_f32_bf16 v185, v24, v10
 v_accvgpr_read_b32 v25, a143
 v_dot2c_f32_bf16 v186, v25, v12
 v_dot2c_f32_bf16 v187, v25, v10
 v_accvgpr_read_b32 v18, a144
 v_dot2c_f32_bf16 v192, v18, v12
 v_dot2c_f32_bf16 v193, v18, v10
 v_accvgpr_read_b32 v19, a145
 v_dot2c_f32_bf16 v194, v19, v12
 v_dot2c_f32_bf16 v195, v19, v10
 v_accvgpr_read_b32 v20, a146
 v_dot2c_f32_bf16 v200, v20, v12
 v_dot2c_f32_bf16 v201, v20, v10
 v_accvgpr_read_b32 v21, a147
 v_dot2c_f32_bf16 v202, v21, v12
 v_dot2c_f32_bf16 v203, v21, v10
 v_accvgpr_read_b32 v22, a148
 v_dot2c_f32_bf16 v208, v22, v12
 v_dot2c_f32_bf16 v209, v22, v10
 v_accvgpr_read_b32 v23, a149
 v_dot2c_f32_bf16 v210, v23, v12
 v_dot2c_f32_bf16 v211, v23, v10
 v_accvgpr_read_b32 v24, a150
 v_dot2c_f32_bf16 v216, v24, v12
 v_dot2c_f32_bf16 v217, v24, v10
 v_accvgpr_read_b32 v25, a151
 v_dot2c_f32_bf16 v218, v25, v12
 v_dot2c_f32_bf16 v219, v25, v10
 v_accvgpr_read_b32 v18, a152
 v_dot2c_f32_bf16 v224, v18, v12
 v_dot2c_f32_bf16 v225, v18, v10
 v_accvgpr_read_b32 v19, a153
 v_dot2c_f32_bf16 v226, v19, v12
 v_dot2c_f32_bf16 v227, v19, v10
 v_accvgpr_read_b32 v20, a154
 v_dot2c_f32_bf16 v232, v20, v12
 v_dot2c_f32_bf16 v233, v20, v10
 v_accvgpr_read_b32 v21, a155
 v_dot2c_f32_bf16 v234, v21, v12
 v_dot2c_f32_bf16 v235, v21, v10
 v_accvgpr_read_b32 v22, a156
 v_dot2c_f32_bf16 v240, v22, v12
 v_dot2c_f32_bf16 v241, v22, v10
 v_accvgpr_read_b32 v23, a157
 v_dot2c_f32_bf16 v242, v23, v12
 v_dot2c_f32_bf16 v243, v23, v10
 v_accvgpr_read_b32 v24, a158
 v_dot2c_f32_bf16 v248, v24, v12
 v_dot2c_f32_bf16 v249, v24, v10
 v_accvgpr_read_b32 v25, a159
 v_dot2c_f32_bf16 v250, v25, v12
 v_dot2c_f32_bf16 v251, v25, v10
 v_accvgpr_read_b32 v18, a160
 v_dot2c_f32_bf16 v132, v18, v13
 v_dot2c_f32_bf16 v133, v18, v11
 v_accvgpr_read_b32 v19, a161
 v_dot2c_f32_bf16 v134, v19, v13
 v_dot2c_f32_bf16 v135, v19, v11
 v_accvgpr_read_b32 v20, a162
 v_dot2c_f32_bf16 v140, v20, v13
 v_dot2c_f32_bf16 v141, v20, v11
 v_accvgpr_read_b32 v21, a163
 v_dot2c_f32_bf16 v142, v21, v13
 v_dot2c_f32_bf16 v143, v21, v11
 v_accvgpr_read_b32 v22, a164
 v_dot2c_f32_bf16 v148, v22, v13
 v_dot2c_f32_bf16 v149, v22, v11
 v_accvgpr_read_b32 v23, a165
 v_dot2c_f32_bf16 v150, v23, v13
 v_dot2c_f32_bf16 v151, v23, v11
 v_accvgpr_read_b32 v24, a166
 v_dot2c_f32_bf16 v156, v24, v13
 v_dot2c_f32_bf16 v157, v24, v11
 v_accvgpr_read_b32 v25, a167
 v_dot2c_f32_bf16 v158, v25, v13
 v_dot2c_f32_bf16 v159, v25, v11
 v_accvgpr_read_b32 v18, a168
 v_dot2c_f32_bf16 v164, v18, v13
 v_dot2c_f32_bf16 v165, v18, v11
 v_accvgpr_read_b32 v19, a169
 v_dot2c_f32_bf16 v166, v19, v13
 v_dot2c_f32_bf16 v167, v19, v11
 v_accvgpr_read_b32 v20, a170
 v_dot2c_f32_bf16 v172, v20, v13
 v_dot2c_f32_bf16 v173, v20, v11
 v_accvgpr_read_b32 v21, a171
 v_dot2c_f32_bf16 v174, v21, v13
 v_dot2c_f32_bf16 v175, v21, v11
 v_accvgpr_read_b32 v22, a172
 v_dot2c_f32_bf16 v180, v22, v13
 v_dot2c_f32_bf16 v181, v22, v11
 v_accvgpr_read_b32 v23, a173
 v_dot2c_f32_bf16 v182, v23, v13
 v_dot2c_f32_bf16 v183, v23, v11
 v_accvgpr_read_b32 v24, a174
 v_dot2c_f32_bf16 v188, v24, v13
 v_dot2c_f32_bf16 v189, v24, v11
 v_accvgpr_read_b32 v25, a175
 v_dot2c_f32_bf16 v190, v25, v13
 v_dot2c_f32_bf16 v191, v25, v11
 v_accvgpr_read_b32 v18, a176
 v_dot2c_f32_bf16 v196, v18, v13
 v_dot2c_f32_bf16 v197, v18, v11
 v_accvgpr_read_b32 v19, a177
 v_dot2c_f32_bf16 v198, v19, v13
 v_dot2c_f32_bf16 v199, v19, v11
 v_accvgpr_read_b32 v20, a178
 v_dot2c_f32_bf16 v204, v20, v13
 v_dot2c_f32_bf16 v205, v20, v11
 v_accvgpr_read_b32 v21, a179
 v_dot2c_f32_bf16 v206, v21, v13
 v_dot2c_f32_bf16 v207, v21, v11
 v_accvgpr_read_b32 v22, a180
 v_dot2c_f32_bf16 v212, v22, v13
 v_dot2c_f32_bf16 v213, v22, v11
 v_accvgpr_read_b32 v23, a181
 v_dot2c_f32_bf16 v214, v23, v13
 v_dot2c_f32_bf16 v215, v23, v11
 v_accvgpr_read_b32 v24, a182
 v_dot2c_f32_bf16 v220, v24, v13
 v_dot2c_f32_bf16 v221, v24, v11
 v_accvgpr_read_b32 v25, a183
 v_dot2c_f32_bf16 v222, v25, v13
 v_dot2c_f32_bf16 v223, v25, v11
 v_accvgpr_read_b32 v18, a184
 v_dot2c_f32_bf16 v228, v18, v13
 v_dot2c_f32_bf16 v229, v18, v11
 v_accvgpr_read_b32 v19, a185
 v_dot2c_f32_bf16 v230, v19, v13
 v_dot2c_f32_bf16 v231, v19, v11
 v_accvgpr_read_b32 v20, a186
 v_dot2c_f32_bf16 v236, v20, v13
 v_dot2c_f32_bf16 v237, v20, v11
 v_accvgpr_read_b32 v21, a187
 v_dot2c_f32_bf16 v238, v21, v13
 v_dot2c_f32_bf16 v239, v21, v11
 v_accvgpr_read_b32 v22, a188
 v_dot2c_f32_bf16 v244, v22, v13
 v_dot2c_f32_bf16 v245, v22, v11
 v_accvgpr_read_b32 v23, a189
 v_dot2c_f32_bf16 v246, v23, v13
 v_dot2c_f32_bf16 v247, v23, v11
 v_accvgpr_read_b32 v24, a190
 v_dot2c_f32_bf16 v252, v24, v13
 v_dot2c_f32_bf16 v253, v24, v11
 v_accvgpr_read_b32 v25, a191
 v_dot2c_f32_bf16 v254, v25, v13
 v_dot2c_f32_bf16 v255, v25, v11
 s_nop 3
 s_branch L_p2
L_st0:
 s_call_b64 s[36:37], L_slow0
 s_branch L_rt0
L_st1:
 s_call_b64 s[36:37], L_slow1
 s_branch L_rt1
L_st2:
 s_call_b64 s[36:37], L_slowB
 s_branch L_rt2
L_st3:
 s_call_b64 s[36:37], L_slow1
 s_branch L_rt3
L_st4:
 s_call_b64 s[36:37], L_slow1n
 s_branch L_rt4
L_st5:
 s_call_b64 s[36:37], L_slow1
 s_branch L_rt5
L_st6:
 s_call_b64 s[36:37], L_slow0B
 s_branch L_rt6
L_st7:
 s_call_b64 s[36:37], L_slowB
 s_branch L_rt7
L_st8:
 s_call_b64 s[36:37], L_slowf
 s_branch L_rt8
L_st9:
 s_call_b64 s[36:37], L_slow1
 s_branch L_rt9
L_st10:
 s_call_b64 s[36:37], L_slowf
 s_branch L_rt10
L_st11:
 s_call_b64 s[36:37], L_slowf
 s_branch L_rt11
L_st14:
 s_call_b64 s[36:37], L_slow0B
 s_branch L_rt14
L_st12:
 s_call_b64 s[36:37], L_slow0
 s_branch L_rt12
L_st13:
 s_call_b64 s[36:37], L_slow1
 s_branch L_rt13
L_slow0:
 s_nop 7
 s_nop 3
 v_max3_f32 v10, v64, v65, v66
 v_max3_f32 v10, v67, v72, v10
 v_max3_f32 v10, v73, v74, v10
 v_max3_f32 v10, v75, v80, v10
 v_max3_f32 v10, v81, v82, v10
 v_max3_f32 v10, v83, v88, v10
 v_max3_f32 v10, v89, v90, v10
 v_max_f32 v10, v91, v10
 v_max3_f32 v11, v68, v69, v70
 v_max3_f32 v11, v71, v76, v11
 v_max3_f32 v11, v77, v78, v11
 v_max3_f32 v11, v79, v84, v11
 v_max3_f32 v11, v85, v86, v11
 v_max3_f32 v11, v87, v92, v11
 v_max3_f32 v11, v93, v94, v11
 v_max_f32 v11, v95, v11
 v_mov_b32 v12, v10
 v_mov_b32 v13, v11
 s_nop 0
 v_permlane16_swap_b32 v12, v10
 v_permlane16_swap_b32 v13, v11
 v_max_f32 v10, v12, v10
 v_max_f32 v11, v13, v11
 v_mov_b32 v12, v10
 v_mov_b32 v13, v11
 s_nop 0
 v_permlane32_swap_b32 v12, v10
 v_permlane32_swap_b32 v13, v11
 v_max_f32 v10, v12, v10
 v_max_f32 v11, v13, v11
 v_ceil_f32 v10, v10
 v_ceil_f32 v11, v11
 v_max_f32 v10, 0, v10
 v_max_f32 v11, 0, v11
 v_sub_f32 v64, v64, v10
 v_sub_f32 v65, v65, v10
 v_sub_f32 v66, v66, v10
 v_sub_f32 v67, v67, v10
 v_sub_f32 v68, v68, v11
 v_sub_f32 v69, v69, v11
 v_sub_f32 v70, v70, v11
 v_sub_f32 v71, v71, v11
 v_sub_f32 v72, v72, v10
 v_sub_f32 v73, v73, v10
 v_sub_f32 v74, v74, v10
 v_sub_f32 v75, v75, v10
 v_sub_f32 v76, v76, v11
 v_sub_f32 v77, v77, v11
 v_sub_f32 v78, v78, v11
 v_sub_f32 v79, v79, v11
 v_sub_f32 v80, v80, v10
 v_sub_f32 v81, v81, v10
 v_sub_f32 v82, v82, v10
 v_sub_f32 v83, v83, v10
 v_sub_f32 v84, v84, v11
 v_sub_f32 v85, v85, v11
 v_sub_f32 v86, v86, v11
 v_sub_f32 v87, v87, v11
 v_sub_f32 v88, v88, v10
 v_sub_f32 v89, v89, v10
 v_sub_f32 v90, v90, v10
 v_sub_f32 v91, v91, v10
 v_sub_f32 v92, v92, v11
 v_sub_f32 v93, v93, v11
 v_sub_f32 v94, v94, v11
 v_sub_f32 v95, v95, v11
 v_sub_f32 v96, v96, v10
 v_sub_f32 v97, v97, v10
 v_sub_f32 v98, v98, v10
 v_sub_f32 v99, v99, v10
 v_sub_f32 v100, v100, v11
 v_sub_f32 v101, v101, v11
 v_sub_f32 v102, v102, v11
 v_sub_f32 v103, v103, v11
 v_sub_f32 v104, v104, v10
 v_sub_f32 v105, v105, v10
 v_sub_f32 v106, v106, v10
 v_sub_f32 v107, v107, v10
 v_sub_f32 v108, v108, v11
 v_sub_f32 v109, v109, v11
 v_sub_f32 v110, v110, v11
 v_sub_f32 v111, v111, v11
 v_sub_f32 v112, v112, v10
 v_sub_f32 v113, v113, v10
 v_sub_f32 v114, v114, v10
 v_sub_f32 v115, v115, v10
 v_sub_f32 v116, v116, v11
 v_sub_f32 v117, v117, v11
 v_sub_f32 v118, v118, v11
 v_sub_f32 v119, v119, v11
 v_sub_f32 v120, v120, v10
 v_sub_f32 v121, v121, v10
 v_sub_f32 v122, v122, v10
 v_sub_f32 v123, v123, v10
 v_sub_f32 v124, v124, v11
 v_sub_f32 v125, v125, v11
 v_sub_f32 v126, v126, v11
 v_sub_f32 v127, v127, v11
 v_sub_f32 v32, v32, v10
 v_sub_f32 v33, v33, v10
 v_sub_f32 v34, v34, v10
 v_sub_f32 v35, v35, v10
 v_sub_f32 v36, v36, v11
 v_sub_f32 v37, v37, v11
 v_sub_f32 v38, v38, v11
 v_sub_f32 v39, v39, v11
 v_exp_f32 v12, -v10
 v_exp_f32 v13, -v11
 v_mul_f32 v30, v12, v30
 v_mul_f32 v31, v13, v31
 v_mul_f32 v128, v12, v128
 v_mul_f32 v129, v12, v129
 v_mul_f32 v130, v12, v130
 v_mul_f32 v131, v12, v131
 v_mul_f32 v132, v13, v132
 v_mul_f32 v133, v13, v133
 v_mul_f32 v134, v13, v134
 v_mul_f32 v135, v13, v135
 v_mul_f32 v136, v12, v136
 v_mul_f32 v137, v12, v137
 v_mul_f32 v138, v12, v138
 v_mul_f32 v139, v12, v139
 v_mul_f32 v140, v13, v140
 v_mul_f32 v141, v13, v141
 v_mul_f32 v142, v13, v142
 v_mul_f32 v143, v13, v143
 v_mul_f32 v144, v12, v144
 v_mul_f32 v145, v12, v145
 v_mul_f32 v146, v12, v146
 v_mul_f32 v147, v12, v147
 v_mul_f32 v148, v13, v148
 v_mul_f32 v149, v13, v149
 v_mul_f32 v150, v13, v150
 v_mul_f32 v151, v13, v151
 v_mul_f32 v152, v12, v152
 v_mul_f32 v153, v12, v153
 v_mul_f32 v154, v12, v154
 v_mul_f32 v155, v12, v155
 v_mul_f32 v156, v13, v156
 v_mul_f32 v157, v13, v157
 v_mul_f32 v158, v13, v158
 v_mul_f32 v159, v13, v159
 v_mul_f32 v160, v12, v160
 v_mul_f32 v161, v12, v161
 v_mul_f32 v162, v12, v162
 v_mul_f32 v163, v12, v163
 v_mul_f32 v164, v13, v164
 v_mul_f32 v165, v13, v165
 v_mul_f32 v166, v13, v166
 v_mul_f32 v167, v13, v167
 v_mul_f32 v168, v12, v168
 v_mul_f32 v169, v12, v169
 v_mul_f32 v170, v12, v170
 v_mul_f32 v171, v12, v171
 v_mul_f32 v172, v13, v172
 v_mul_f32 v173, v13, v173
 v_mul_f32 v174, v13, v174
 v_mul_f32 v175, v13, v175
 v_mul_f32 v176, v12, v176
 v_mul_f32 v177, v12, v177
 v_mul_f32 v178, v12, v178
 v_mul_f32 v179, v12, v179
 v_mul_f32 v180, v13, v180
 v_mul_f32 v181, v13, v181
 v_mul_f32 v182, v13, v182
 v_mul_f32 v183, v13, v183
 v_mul_f32 v184, v12, v184
 v_mul_f32 v185, v12, v185
 v_mul_f32 v186, v12, v186
 v_mul_f32 v187, v12, v187
 v_mul_f32 v188, v13, v188
 v_mul_f32 v189, v13, v189
 v_mul_f32 v190, v13, v190
 v_mul_f32 v191, v13, v191
 v_mul_f32 v192, v12, v192
 v_mul_f32 v193, v12, v193
 v_mul_f32 v194, v12, v194
 v_mul_f32 v195, v12, v195
 v_mul_f32 v196, v13, v196
 v_mul_f32 v197, v13, v197
 v_mul_f32 v198, v13, v198
 v_mul_f32 v199, v13, v199
 v_mul_f32 v200, v12, v200
 v_mul_f32 v201, v12, v201
 v_mul_f32 v202, v12, v202
 v_mul_f32 v203, v12, v203
 v_mul_f32 v204, v13, v204
 v_mul_f32 v205, v13, v205
 v_mul_f32 v206, v13, v206
 v_mul_f32 v207, v13, v207
 v_mul_f32 v208, v12, v208
 v_mul_f32 v209, v12, v209
 v_mul_f32 v210, v12, v210
 v_mul_f32 v211, v12, v211
 v_mul_f32 v212, v13, v212
 v_mul_f32 v213, v13, v213
 v_mul_f32 v214, v13, v214
 v_mul_f32 v215, v13, v215
 v_mul_f32 v216, v12, v216
 v_mul_f32 v217, v12, v217
 v_mul_f32 v218, v12, v218
 v_mul_f32 v219, v12, v219
 v_mul_f32 v220, v13, v220
 v_mul_f32 v221, v13, v221
 v_mul_f32 v222, v13, v222
 v_mul_f32 v223, v13, v223
 v_mul_f32 v224, v12, v224
 v_mul_f32 v225, v12, v225
 v_mul_f32 v226, v12, v226
 v_mul_f32 v227, v12, v227
 v_mul_f32 v228, v13, v228
 v_mul_f32 v229, v13, v229
 v_mul_f32 v230, v13, v230
 v_mul_f32 v231, v13, v231
 v_mul_f32 v232, v12, v232
 v_mul_f32 v233, v12, v233
 v_mul_f32 v234, v12, v234
 v_mul_f32 v235, v12, v235
 v_mul_f32 v236, v13, v236
 v_mul_f32 v237, v13, v237
 v_mul_f32 v238, v13, v238
 v_mul_f32 v239, v13, v239
 v_mul_f32 v240, v12, v240
 v_mul_f32 v241, v12, v241
 v_mul_f32 v242, v12, v242
 v_mul_f32 v243, v12, v243
 v_mul_f32 v244, v13, v244
 v_mul_f32 v245, v13, v245
 v_mul_f32 v246, v13, v246
 v_mul_f32 v247, v13, v247
 v_mul_f32 v248, v12, v248
 v_mul_f32 v249, v12, v249
 v_mul_f32 v250, v12, v250
 v_mul_f32 v251, v12, v251
 v_mul_f32 v252, v13, v252
 v_mul_f32 v253, v13, v253
 v_mul_f32 v254, v13, v254
 v_mul_f32 v255, v13, v255
 v_exp_f32 v18, v64
 v_exp_f32 v19, v65
 v_exp_f32 v20, v66
 v_add_f32 v26, v18, v19
 v_cvt_pk_bf16_f32 v40, v18, v19
 v_exp_f32 v21, v67
 v_exp_f32 v22, v72
 v_add_f32 v26, v20, v26
 v_cvt_pk_bf16_f32 v41, v20, v21
 v_exp_f32 v23, v73
 v_add_f32 v26, v21, v26
 v_exp_f32 v24, v74
 v_add_f32 v26, v22, v26
 v_cvt_pk_bf16_f32 v42, v22, v23
 v_exp_f32 v25, v75
 v_add_f32 v26, v23, v26
 v_exp_f32 v18, v68
 v_add_f32 v26, v24, v26
 v_cvt_pk_bf16_f32 v43, v24, v25
 v_exp_f32 v19, v69
 v_add_f32 v26, v25, v26
 v_exp_f32 v20, v70
 v_add_f32 v27, v18, v19
 v_cvt_pk_bf16_f32 v44, v18, v19
 v_exp_f32 v21, v71
 v_exp_f32 v22, v76
 v_add_f32 v27, v20, v27
 v_cvt_pk_bf16_f32 v45, v20, v21
 v_exp_f32 v23, v77
 v_add_f32 v27, v21, v27
 v_exp_f32 v24, v78
 v_add_f32 v27, v22, v27
 v_cvt_pk_bf16_f32 v46, v22, v23
 v_exp_f32 v25, v79
 v_add_f32 v27, v23, v27
 v_add_f32 v27, v24, v27
 v_cvt_pk_bf16_f32 v47, v24, v25
 v_add_f32 v27, v25, v27
 v_exp_f32 v18, v80
 v_exp_f32 v19, v81
 v_exp_f32 v20, v82
 v_add_f32 v26, v18, v26
 v_cvt_pk_bf16_f32 v56, v18, v19
 v_exp_f32 v21, v83
 v_add_f32 v26, v19, v26
 v_exp_f32 v22, v88
 v_add_f32 v26, v20, v26
 v_cvt_pk_bf16_f32 v57, v20, v21
 v_exp_f32 v23, v89
 v_add_f32 v26, v21, v26
 v_exp_f32 v24, v90
 v_add_f32 v26, v22, v26
 v_cvt_pk_bf16_f32 v58, v22, v23
 v_exp_f32 v25, v91
 v_add_f32 v26, v23, v26
 v_exp_f32 v18, v84
 v_add_f32 v26, v24, v26
 v_cvt_pk_bf16_f32 v59, v24, v25
 v_exp_f32 v19, v85
 v_add_f32 v26, v25, v26
 v_exp_f32 v20, v86
 v_add_f32 v27, v18, v27
 v_cvt_pk_bf16_f32 v60, v18, v19
 v_exp_f32 v21, v87
 v_add_f32 v27, v19, v27
 v_exp_f32 v22, v92
 v_add_f32 v27, v20, v27
 v_cvt_pk_bf16_f32 v61, v20, v21
 v_exp_f32 v23, v93
 v_add_f32 v27, v21, v27
 v_exp_f32 v24, v94
 v_add_f32 v27, v22, v27
 v_cvt_pk_bf16_f32 v62, v22, v23
 v_exp_f32 v25, v95
 v_add_f32 v27, v23, v27
 v_add_f32 v27, v24, v27
 v_cvt_pk_bf16_f32 v63, v24, v25
 v_add_f32 v27, v25, v27
 s_nop 3
 s_setpc_b64 s[36:37]
L_slow1:
 s_nop 7
 s_nop 3
 v_max3_f32 v10, v96, v97, v98
 v_max3_f32 v10, v99, v104, v10
 v_max3_f32 v10, v105, v106, v10
 v_max3_f32 v10, v107, v112, v10
 v_max3_f32 v10, v113, v114, v10
 v_max3_f32 v10, v115, v120, v10
 v_max3_f32 v10, v121, v122, v10
 v_max_f32 v10, v123, v10
 v_max3_f32 v11, v100, v101, v102
 v_max3_f32 v11, v103, v108, v11
 v_max3_f32 v11, v109, v110, v11
 v_max3_f32 v11, v111, v116, v11
 v_max3_f32 v11, v117, v118, v11
 v_max3_f32 v11, v119, v124, v11
 v_max3_f32 v11, v125, v126, v11
 v_max_f32 v11, v127, v11
 v_mov_b32 v12, v10
 v_mov_b32 v13, v11
 s_nop 0
 v_permlane16_swap_b32 v12, v10
 v_permlane16_swap_b32 v13, v11
 v_max_f32 v10, v12, v10
 v_max_f32 v11, v13, v11
 v_mov_b32 v12, v10
 v_mov_b32 v13, v11
 s_nop 0
 v_permlane32_swap_b32 v12, v10
 v_permlane32_swap_b32 v13, v11
 v_max_f32 v10, v12, v10
 v_max_f32 v11, v13, v11
 v_ceil_f32 v10, v10
 v_ceil_f32 v11, v11
 v_max_f32 v10, 0, v10
 v_max_f32 v11, 0, v11
 v_sub_f32 v96, v96, v10
 v_sub_f32 v97, v97, v10
 v_sub_f32 v98, v98, v10
 v_sub_f32 v99, v99, v10
 v_sub_f32 v100, v100, v11
 v_sub_f32 v101, v101, v11
 v_sub_f32 v102, v102, v11
 v_sub_f32 v103, v103, v11
 v_sub_f32 v104, v104, v10
 v_sub_f32 v105, v105, v10
 v_sub_f32 v106, v106, v10
 v_sub_f32 v107, v107, v10
 v_sub_f32 v108, v108, v11
 v_sub_f32 v109, v109, v11
 v_sub_f32 v110, v110, v11
 v_sub_f32 v111, v111, v11
 v_sub_f32 v112, v112, v10
 v_sub_f32 v113, v113, v10
 v_sub_f32 v114, v114, v10
 v_sub_f32 v115, v115, v10
 v_sub_f32 v116, v116, v11
 v_sub_f32 v117, v117, v11
 v_sub_f32 v118, v118, v11
 v_sub_f32 v119, v119, v11
 v_sub_f32 v120, v120, v10
 v_sub_f32 v121, v121, v10
 v_sub_f32 v122, v122, v10
 v_sub_f32 v123, v123, v10
 v_sub_f32 v124, v124, v11
 v_sub_f32 v125, v125, v11
 v_sub_f32 v126, v126, v11
 v_sub_f32 v127, v127, v11
 v_sub_f32 v64, v64, v10
 v_sub_f32 v65, v65, v10
 v_sub_f32 v66, v66, v10
 v_sub_f32 v67, v67, v10
 v_sub_f32 v68, v68, v11
 v_sub_f32 v69, v69, v11
 v_sub_f32 v70, v70, v11
 v_sub_f32 v71, v71, v11
 v_sub_f32 v72, v72, v10
 v_sub_f32 v73, v73, v10
 v_sub_f32 v74, v74, v10
 v_sub_f32 v75, v75, v10
 v_sub_f32 v76, v76, v11
 v_sub_f32 v77, v77, v11
 v_sub_f32 v78, v78, v11
 v_sub_f32 v79, v79, v11
 v_sub_f32 v80, v80, v10
 v_sub_f32 v81, v81, v10
 v_sub_f32 v82, v82, v10
 v_sub_f32 v83, v83, v10
 v_sub_f32 v84, v84, v11
 v_sub_f32 v85, v85, v11
 v_sub_f32 v86, v86, v11
 v_sub_f32 v87, v87, v11
 v_sub_f32 v88, v88, v10
 v_sub_f32 v89, v89, v10
 v_sub_f32 v90, v90, v10
 v_sub_f32 v91, v91, v10
 v_sub_f32 v92, v92, v11
 v_sub_f32 v93, v93, v11
 v_sub_f32 v94, v94, v11
 v_sub_f32 v95, v95, v11
 v_sub_f32 v32, v32, v10
 v_sub_f32 v33, v33, v10
 v_sub_f32 v34, v34, v10
 v_sub_f32 v35, v35, v10
 v_sub_f32 v36, v36, v11
 v_sub_f32 v37, v37, v11
 v_sub_f32 v38, v38, v11
 v_sub_f32 v39, v39, v11
 v_exp_f32 v12, -v10
 v_exp_f32 v13, -v11
 v_mul_f32 v30, v12, v30
 v_mul_f32 v31, v13, v31
 v_mul_f32 v128, v12, v128
 v_mul_f32 v129, v12, v129
 v_mul_f32 v130, v12, v130
 v_mul_f32 v131, v12, v131
 v_mul_f32 v132, v13, v132
 v_mul_f32 v133, v13, v133
 v_mul_f32 v134, v13, v134
 v_mul_f32 v135, v13, v135
 v_mul_f32 v136, v12, v136
 v_mul_f32 v137, v12, v137
 v_mul_f32 v138, v12, v138
 v_mul_f32 v139, v12, v139
 v_mul_f32 v140, v13, v140
 v_mul_f32 v141, v13, v141
 v_mul_f32 v142, v13, v142
 v_mul_f32 v143, v13, v143
 v_mul_f32 v144, v12, v144
 v_mul_f32 v145, v12, v145
 v_mul_f32 v146, v12, v146
 v_mul_f32 v147, v12, v147
 v_mul_f32 v148, v13, v148
 v_mul_f32 v149, v13, v149
 v_mul_f32 v150, v13, v150
 v_mul_f32 v151, v13, v151
 v_mul_f32 v152, v12, v152
 v_mul_f32 v153, v12, v153
 v_mul_f32 v154, v12, v154
 v_mul_f32 v155, v12, v155
 v_mul_f32 v156, v13, v156
 v_mul_f32 v157, v13, v157
 v_mul_f32 v158, v13, v158
 v_mul_f32 v159, v13, v159
 v_mul_f32 v160, v12, v160
 v_mul_f32 v161, v12, v161
 v_mul_f32 v162, v12, v162
 v_mul_f32 v163, v12, v163
 v_mul_f32 v164, v13, v164
 v_mul_f32 v165, v13, v165
 v_mul_f32 v166, v13, v166
 v_mul_f32 v167, v13, v167
 v_mul_f32 v168, v12, v168
 v_mul_f32 v169, v12, v169
 v_mul_f32 v170, v12, v170
 v_mul_f32 v171, v12, v171
 v_mul_f32 v172, v13, v172
 v_mul_f32 v173, v13, v173
 v_mul_f32 v174, v13, v174
 v_mul_f32 v175, v13, v175
 v_mul_f32 v176, v12, v176
 v_mul_f32 v177, v12, v177
 v_mul_f32 v178, v12, v178
 v_mul_f32 v179, v12, v179
 v_mul_f32 v180, v13, v180
 v_mul_f32 v181, v13, v181
 v_mul_f32 v182, v13, v182
 v_mul_f32 v183, v13, v183
 v_mul_f32 v184, v12, v184
 v_mul_f32 v185, v12, v185
 v_mul_f32 v186, v12, v186
 v_mul_f32 v187, v12, v187
 v_mul_f32 v188, v13, v188
 v_mul_f32 v189, v13, v189
 v_mul_f32 v190, v13, v190
 v_mul_f32 v191, v13, v191
 v_mul_f32 v192, v12, v192
 v_mul_f32 v193, v12, v193
 v_mul_f32 v194, v12, v194
 v_mul_f32 v195, v12, v195
 v_mul_f32 v196, v13, v196
 v_mul_f32 v197, v13, v197
 v_mul_f32 v198, v13, v198
 v_mul_f32 v199, v13, v199
 v_mul_f32 v200, v12, v200
 v_mul_f32 v201, v12, v201
 v_mul_f32 v202, v12, v202
 v_mul_f32 v203, v12, v203
 v_mul_f32 v204, v13, v204
 v_mul_f32 v205, v13, v205
 v_mul_f32 v206, v13, v206
 v_mul_f32 v207, v13, v207
 v_mul_f32 v208, v12, v208
 v_mul_f32 v209, v12, v209
 v_mul_f32 v210, v12, v210
 v_mul_f32 v211, v12, v211
 v_mul_f32 v212, v13, v212
 v_mul_f32 v213, v13, v213
 v_mul_f32 v214, v13, v214
 v_mul_f32 v215, v13, v215
 v_mul_f32 v216, v12, v216
 v_mul_f32 v217, v12, v217
 v_mul_f32 v218, v12, v218
 v_mul_f32 v219, v12, v219
 v_mul_f32 v220, v13, v220
 v_mul_f32 v221, v13, v221
 v_mul_f32 v222, v13, v222
 v_mul_f32 v223, v13, v223
 v_mul_f32 v224, v12, v224
 v_mul_f32 v225, v12, v225
 v_mul_f32 v226, v12, v226
 v_mul_f32 v227, v12, v227
 v_mul_f32 v228, v13, v228
 v_mul_f32 v229, v13, v229
 v_mul_f32 v230, v13, v230
 v_mul_f32 v231, v13, v231
 v_mul_f32 v232, v12, v232
 v_mul_f32 v233, v12, v233
 v_mul_f32 v234, v12, v234
 v_mul_f32 v235, v12, v235
 v_mul_f32 v236, v13, v236
 v_mul_f32 v237, v13, v237
 v_mul_f32 v238, v13, v238
 v_mul_f32 v239, v13, v239
 v_mul_f32 v240, v12, v240
 v_mul_f32 v241, v12, v241
 v_mul_f32 v242, v12, v242
 v_mul_f32 v243, v12, v243
 v_mul_f32 v244, v13, v244
 v_mul_f32 v245, v13, v245
 v_mul_f32 v246, v13, v246
 v_mul_f32 v247, v13, v247
 v_mul_f32 v248, v12, v248
 v_mul_f32 v249, v12, v249
 v_mul_f32 v250, v12, v250
 v_mul_f32 v251, v12, v251
 v_mul_f32 v252, v13, v252
 v_mul_f32 v253, v13, v253
 v_mul_f32 v254, v13, v254
 v_mul_f32 v255, v13, v255
 v_exp_f32 v18, v96
 v_exp_f32 v19, v97
 v_exp_f32 v20, v98
 v_add_f32 v28, v18, v19
 v_cvt_pk_bf16_f32 v48, v18, v19
 v_exp_f32 v21, v99
 v_exp_f32 v22, v104
 v_add_f32 v28, v20, v28
 v_cvt_pk_bf16_f32 v49, v20, v21
 v_exp_f32 v23, v105
 v_add_f32 v28, v21, v28
 v_exp_f32 v24, v106
 v_add_f32 v28, v22, v28
 v_cvt_pk_bf16_f32 v50, v22, v23
 v_exp_f32 v25, v107
 v_add_f32 v28, v23, v28
 v_exp_f32 v18, v100
 v_add_f32 v28, v24, v28
 v_cvt_pk_bf16_f32 v51, v24, v25
 v_exp_f32 v19, v101
 v_add_f32 v28, v25, v28
 v_exp_f32 v20, v102
 v_add_f32 v29, v18, v19
 v_cvt_pk_bf16_f32 v52, v18, v19
 v_exp_f32 v21, v103
 v_exp_f32 v22, v108
 v_add_f32 v29, v20, v29
 v_cvt_pk_bf16_f32 v53, v20, v21
 v_exp_f32 v23, v109
 v_add_f32 v29, v21, v29
 v_exp_f32 v24, v110
 v_add_f32 v29, v22, v29
 v_cvt_pk_bf16_f32 v54, v22, v23
 v_exp_f32 v25, v111
 v_add_f32 v29, v23, v29
 v_add_f32 v29, v24, v29
 v_cvt_pk_bf16_f32 v55, v24, v25
 v_add_f32 v29, v25, v29
 v_exp_f32 v18, v112
 v_exp_f32 v19, v113
 v_exp_f32 v20, v114
 v_add_f32 v28, v18, v28
 v_cvt_pk_bf16_f32 v56, v18, v19
 v_exp_f32 v21, v115
 v_add_f32 v28, v19, v28
 v_exp_f32 v22, v120
 v_add_f32 v28, v20, v28
 v_cvt_pk_bf16_f32 v57, v20, v21
 v_exp_f32 v23, v121
 v_add_f32 v28, v21, v28
 v_exp_f32 v24, v122
 v_add_f32 v28, v22, v28
 v_cvt_pk_bf16_f32 v58, v22, v23
 v_exp_f32 v25, v123
 v_add_f32 v28, v23, v28
 v_exp_f32 v18, v116
 v_add_f32 v28, v24, v28
 v_cvt_pk_bf16_f32 v59, v24, v25
 v_exp_f32 v19, v117
 v_add_f32 v28, v25, v28
 v_exp_f32 v20, v118
 v_add_f32 v29, v18, v29
 v_cvt_pk_bf16_f32 v60, v18, v19
 v_exp_f32 v21, v119
 v_add_f32 v29, v19, v29
 v_exp_f32 v22, v124
 v_add_f32 v29, v20, v29
 v_cvt_pk_bf16_f32 v61, v20, v21
 v_exp_f32 v23, v125
 v_add_f32 v29, v21, v29
 v_exp_f32 v24, v126
 v_add_f32 v29, v22, v29
 v_cvt_pk_bf16_f32 v62, v22, v23
 v_exp_f32 v25, v127
 v_add_f32 v29, v23, v29
 v_add_f32 v29, v24, v29
 v_cvt_pk_bf16_f32 v63, v24, v25
 v_add_f32 v29, v25, v29
 s_nop 3
 s_setpc_b64 s[36:37]
L_slow1n:
 s_nop 7
 s_nop 3
 v_max3_f32 v10, v96, v97, v98
 v_max3_f32 v10, v99, v104, v10
 v_max3_f32 v10, v105, v106, v10
 v_max3_f32 v10, v107, v112, v10
 v_max3_f32 v10, v113, v114, v10
 v_max3_f32 v10, v115, v120, v10
 v_max3_f32 v10, v121, v122, v10
 v_max_f32 v10, v123, v10
 v_max3_f32 v11, v100, v101, v102
 v_max3_f32 v11, v103, v108, v11
 v_max3_f32 v11, v109, v110, v11
 v_max3_f32 v11, v111, v116, v11
 v_max3_f32 v11, v117, v118, v11
 v_max3_f32 v11, v119, v124, v11
 v_max3_f32 v11, v125, v126, v11
 v_max_f32 v11, v127, v11
 v_mov_b32 v12, v10
 v_mov_b32 v13, v11
 s_nop 0
 v_permlane16_swap_b32 v12, v10
 v_permlane16_swap_b32 v13, v11
 v_max_f32 v10, v12, v10
 v_max_f32 v11, v13, v11
 v_mov_b32 v12, v10
 v_mov_b32 v13, v11
 s_nop 0
 v_permlane32_swap_b32 v12, v10
 v_permlane32_swap_b32 v13, v11
 v_max_f32 v10, v12, v10
 v_max_f32 v11, v13, v11
 v_ceil_f32 v10, v10
 v_ceil_f32 v11, v11
 v_max_f32 v10, 0, v10
 v_max_f32 v11, 0, v11
 v_sub_f32 v96, v96, v10
 v_sub_f32 v97, v97, v10
 v_sub_f32 v98, v98, v10
 v_sub_f32 v99, v99, v10
 v_sub_f32 v100, v100, v11
 v_sub_f32 v101, v101, v11
 v_sub_f32 v102, v102, v11
 v_sub_f32 v103, v103, v11
 v_sub_f32 v104, v104, v10
 v_sub_f32 v105, v105, v10
 v_sub_f32 v106, v106, v10
 v_sub_f32 v107, v107, v10
 v_sub_f32 v108, v108, v11
 v_sub_f32 v109, v109, v11
 v_sub_f32 v110, v110, v11
 v_sub_f32 v111, v111, v11
 v_sub_f32 v112, v112, v10
 v_sub_f32 v113, v113, v10
 v_sub_f32 v114, v114, v10
 v_sub_f32 v115, v115, v10
 v_sub_f32 v116, v116, v11
 v_sub_f32 v117, v117, v11
 v_sub_f32 v118, v118, v11
 v_sub_f32 v119, v119, v11
 v_sub_f32 v120, v120, v10
 v_sub_f32 v121, v121, v10
 v_sub_f32 v122, v122, v10
 v_sub_f32 v123, v123, v10
 v_sub_f32 v124, v124, v11
 v_sub_f32 v125, v125, v11
 v_sub_f32 v126, v126, v11
 v_sub_f32 v127, v127, v11
 v_sub_f32 v32, v32, v10
 v_sub_f32 v33, v33, v10
 v_sub_f32 v34, v34, v10
 v_sub_f32 v35, v35, v10
 v_sub_f32 v36, v36, v11
 v_sub_f32 v37, v37, v11
 v_sub_f32 v38, v38, v11
 v_sub_f32 v39, v39, v11
 v_exp_f32 v12, -v10
 v_exp_f32 v13, -v11
 v_mul_f32 v30, v12, v30
 v_mul_f32 v31, v13, v31
 v_mul_f32 v128, v12, v128
 v_mul_f32 v129, v12, v129
 v_mul_f32 v130, v12, v130
 v_mul_f32 v131, v12, v131
 v_mul_f32 v132, v13, v132
 v_mul_f32 v133, v13, v133
 v_mul_f32 v134, v13, v134
 v_mul_f32 v135, v13, v135
 v_mul_f32 v136, v12, v136
 v_mul_f32 v137, v12, v137
 v_mul_f32 v138, v12, v138
 v_mul_f32 v139, v12, v139
 v_mul_f32 v140, v13, v140
 v_mul_f32 v141, v13, v141
 v_mul_f32 v142, v13, v142
 v_mul_f32 v143, v13, v143
 v_mul_f32 v144, v12, v144
 v_mul_f32 v145, v12, v145
 v_mul_f32 v146, v12, v146
 v_mul_f32 v147, v12, v147
 v_mul_f32 v148, v13, v148
 v_mul_f32 v149, v13, v149
 v_mul_f32 v150, v13, v150
 v_mul_f32 v151, v13, v151
 v_mul_f32 v152, v12, v152
 v_mul_f32 v153, v12, v153
 v_mul_f32 v154, v12, v154
 v_mul_f32 v155, v12, v155
 v_mul_f32 v156, v13, v156
 v_mul_f32 v157, v13, v157
 v_mul_f32 v158, v13, v158
 v_mul_f32 v159, v13, v159
 v_mul_f32 v160, v12, v160
 v_mul_f32 v161, v12, v161
 v_mul_f32 v162, v12, v162
 v_mul_f32 v163, v12, v163
 v_mul_f32 v164, v13, v164
 v_mul_f32 v165, v13, v165
 v_mul_f32 v166, v13, v166
 v_mul_f32 v167, v13, v167
 v_mul_f32 v168, v12, v168
 v_mul_f32 v169, v12, v169
 v_mul_f32 v170, v12, v170
 v_mul_f32 v171, v12, v171
 v_mul_f32 v172, v13, v172
 v_mul_f32 v173, v13, v173
 v_mul_f32 v174, v13, v174
 v_mul_f32 v175, v13, v175
 v_mul_f32 v176, v12, v176
 v_mul_f32 v177, v12, v177
 v_mul_f32 v178, v12, v178
 v_mul_f32 v179, v12, v179
 v_mul_f32 v180, v13, v180
 v_mul_f32 v181, v13, v181
 v_mul_f32 v182, v13, v182
 v_mul_f32 v183, v13, v183
 v_mul_f32 v184, v12, v184
 v_mul_f32 v185, v12, v185
 v_mul_f32 v186, v12, v186
 v_mul_f32 v187, v12, v187
 v_mul_f32 v188, v13, v188
 v_mul_f32 v189, v13, v189
 v_mul_f32 v190, v13, v190
 v_mul_f32 v191, v13, v191
 v_mul_f32 v192, v12, v192
 v_mul_f32 v193, v12, v193
 v_mul_f32 v194, v12, v194
 v_mul_f32 v195, v12, v195
 v_mul_f32 v196, v13, v196
 v_mul_f32 v197, v13, v197
 v_mul_f32 v198, v13, v198
 v_mul_f32 v199, v13, v199
 v_mul_f32 v200, v12, v200
 v_mul_f32 v201, v12, v201
 v_mul_f32 v202, v12, v202
 v_mul_f32 v203, v12, v203
 v_mul_f32 v204, v13, v204
 v_mul_f32 v205, v13, v205
 v_mul_f32 v206, v13, v206
 v_mul_f32 v207, v13, v207
 v_mul_f32 v208, v12, v208
 v_mul_f32 v209, v12, v209
 v_mul_f32 v210, v12, v210
 v_mul_f32 v211, v12, v211
 v_mul_f32 v212, v13, v212
 v_mul_f32 v213, v13, v213
 v_mul_f32 v214, v13, v214
 v_mul_f32 v215, v13, v215
 v_mul_f32 v216, v12, v216
 v_mul_f32 v217, v12, v217
 v_mul_f32 v218, v12, v218
 v_mul_f32 v219, v12, v219
 v_mul_f32 v220, v13, v220
 v_mul_f32 v221, v13, v221
 v_mul_f32 v222, v13, v222
 v_mul_f32 v223, v13, v223
 v_mul_f32 v224, v12, v224
 v_mul_f32 v225, v12, v225
 v_mul_f32 v226, v12, v226
 v_mul_f32 v227, v12, v227
 v_mul_f32 v228, v13, v228
 v_mul_f32 v229, v13, v229
 v_mul_f32 v230, v13, v230
 v_mul_f32 v231, v13, v231
 v_mul_f32 v232, v12, v232
 v_mul_f32 v233, v12, v233
 v_mul_f32 v234, v12, v234
 v_mul_f32 v235, v12, v235
 v_mul_f32 v236, v13, v236
 v_mul_f32 v237, v13, v237
 v_mul_f32 v238, v13, v238
 v_mul_f32 v239, v13, v239
 v_mul_f32 v240, v12, v240
 v_mul_f32 v241, v12, v241
 v_mul_f32 v242, v12, v242
 v_mul_f32 v243, v12, v243
 v_mul_f32 v244, v13, v244
 v_mul_f32 v245, v13, v245
 v_mul_f32 v246, v13, v246
 v_mul_f32 v247, v13, v247
 v_mul_f32 v248, v12, v248
 v_mul_f32 v249, v12, v249
 v_mul_f32 v250, v12, v250
 v_mul_f32 v251, v12, v251
 v_mul_f32 v252, v13, v252
 v_mul_f32 v253, v13, v253
 v_mul_f32 v254, v13, v254
 v_mul_f32 v255, v13, v255
 v_exp_f32 v18, v96
 v_exp_f32 v19, v97
 v_exp_f32 v20, v98
 v_add_f32 v28, v18, v19
 v_cvt_pk_bf16_f32 v48, v18, v19
 v_exp_f32 v21, v99
 v_exp_f32 v22, v104
 v_add_f32 v28, v20, v28
 v_cvt_pk_bf16_f32 v49, v20, v21
 v_exp_f32 v23, v105
 v_add_f32 v28, v21, v28
 v_exp_f32 v24, v106
 v_add_f32 v28, v22, v28
 v_cvt_pk_bf16_f32 v50, v22, v23
 v_exp_f32 v25, v107
 v_add_f32 v28, v23, v28
 v_exp_f32 v18, v100
 v_add_f32 v28, v24, v28
 v_cvt_pk_bf16_f32 v51, v24, v25
 v_exp_f32 v19, v101
 v_add_f32 v28, v25, v28
 v_exp_f32 v20, v102
 v_add_f32 v29, v18, v19
 v_cvt_pk_bf16_f32 v52, v18, v19
 v_exp_f32 v21, v103
 v_exp_f32 v22, v108
 v_add_f32 v29, v20, v29
 v_cvt_pk_bf16_f32 v53, v20, v21
 v_exp_f32 v23, v109
 v_add_f32 v29, v21, v29
 v_exp_f32 v24, v110
 v_add_f32 v29, v22, v29
 v_cvt_pk_bf16_f32 v54, v22, v23
 v_exp_f32 v25, v111
 v_add_f32 v29, v23, v29
 v_add_f32 v29, v24, v29
 v_cvt_pk_bf16_f32 v55, v24, v25
 v_add_f32 v29, v25, v29
 v_exp_f32 v18, v112
 v_exp_f32 v19, v113
 v_exp_f32 v20, v114
 v_add_f32 v28, v18, v28
 v_cvt_pk_bf16_f32 v56, v18, v19
 v_exp_f32 v21, v115
 v_add_f32 v28, v19, v28
 v_exp_f32 v22, v120
 v_add_f32 v28, v20, v28
 v_cvt_pk_bf16_f32 v57, v20, v21
 v_exp_f32 v23, v121
 v_add_f32 v28, v21, v28
 v_exp_f32 v24, v122
 v_add_f32 v28, v22, v28
 v_cvt_pk_bf16_f32 v58, v22, v23
 v_exp_f32 v25, v123
 v_add_f32 v28, v23, v28
 v_exp_f32 v18, v116
 v_add_f32 v28, v24, v28
 v_cvt_pk_bf16_f32 v59, v24, v25
 v_exp_f32 v19, v117
 v_add_f32 v28, v25, v28
 v_exp_f32 v20, v118
 v_add_f32 v29, v18, v29
 v_cvt_pk_bf16_f32 v60, v18, v19
 v_exp_f32 v21, v119
 v_add_f32 v29, v19, v29
 v_exp_f32 v22, v124
 v_add_f32 v29, v20, v29
 v_cvt_pk_bf16_f32 v61, v20, v21
 v_exp_f32 v23, v125
 v_add_f32 v29, v21, v29
 v_exp_f32 v24, v126
 v_add_f32 v29, v22, v29
 v_cvt_pk_bf16_f32 v62, v22, v23
 v_exp_f32 v25, v127
 v_add_f32 v29, v23, v29
 v_add_f32 v29, v24, v29
 v_cvt_pk_bf16_f32 v63, v24, v25
 v_add_f32 v29, v25, v29
 s_nop 3
 s_setpc_b64 s[36:37]
L_slow0B:
 s_nop 7
 s_nop 3
 v_max3_f32 v10, v64, v65, v66
 v_max3_f32 v10, v67, v72, v10
 v_max3_f32 v10, v73, v74, v10
 v_max3_f32 v10, v75, v80, v10
 v_max3_f32 v10, v81, v82, v10
 v_max3_f32 v10, v83, v88, v10
 v_max3_f32 v10, v89, v90, v10
 v_max_f32 v10, v91, v10
 v_max3_f32 v11, v68, v69, v70
 v_max3_f32 v11, v71, v76, v11
 v_max3_f32 v11, v77, v78, v11
 v_max3_f32 v11, v79, v84, v11
 v_max3_f32 v11, v85, v86, v11
 v_max3_f32 v11, v87, v92, v11
 v_max3_f32 v11, v93, v94, v11
 v_max_f32 v11, v95, v11
 v_mov_b32 v12, v10
 v_mov_b32 v13, v11
 s_nop 0
 v_permlane16_swap_b32 v12, v10
 v_permlane16_swap_b32 v13, v11
 v_max_f32 v10, v12, v10
 v_max_f32 v11, v13, v11
 v_mov_b32 v12, v10
 v_mov_b32 v13, v11
 s_nop 0
 v_permlane32_swap_b32 v12, v10
 v_permlane32_swap_b32 v13, v11
 v_max_f32 v10, v12, v10
 v_max_f32 v11, v13, v11
 v_ceil_f32 v10, v10
 v_ceil_f32 v11, v11
 v_max_f32 v10, 0, v10
 v_max_f32 v11, 0, v11
 v_sub_f32 v64, v64, v10
 v_sub_f32 v65, v65, v10
 v_sub_f32 v66, v66, v10
 v_sub_f32 v67, v67, v10
 v_sub_f32 v68, v68, v11
 v_sub_f32 v69, v69, v11
 v_sub_f32 v70, v70, v11
 v_sub_f32 v71, v71, v11
 v_sub_f32 v72, v72, v10
 v_sub_f32 v73, v73, v10
 v_sub_f32 v74, v74, v10
 v_sub_f32 v75, v75, v10
 v_sub_f32 v76, v76, v11
 v_sub_f32 v77, v77, v11
 v_sub_f32 v78, v78, v11
 v_sub_f32 v79, v79, v11
 v_sub_f32 v80, v80, v10
 v_sub_f32 v81, v81, v10
 v_sub_f32 v82, v82, v10
 v_sub_f32 v83, v83, v10
 v_sub_f32 v84, v84, v11
 v_sub_f32 v85, v85, v11
 v_sub_f32 v86, v86, v11
 v_sub_f32 v87, v87, v11
 v_sub_f32 v88, v88, v10
 v_sub_f32 v89, v89, v10
 v_sub_f32 v90, v90, v10
 v_sub_f32 v91, v91, v10
 v_sub_f32 v92, v92, v11
 v_sub_f32 v93, v93, v11
 v_sub_f32 v94, v94, v11
 v_sub_f32 v95, v95, v11
 v_sub_f32 v100, v100, v11
 v_sub_f32 v101, v101, v11
 v_sub_f32 v102, v102, v11
 v_sub_f32 v103, v103, v11
 v_sub_f32 v108, v108, v11
 v_sub_f32 v109, v109, v11
 v_sub_f32 v110, v110, v11
 v_sub_f32 v111, v111, v11
 v_sub_f32 v116, v116, v11
 v_sub_f32 v117, v117, v11
 v_sub_f32 v118, v118, v11
 v_sub_f32 v119, v119, v11
 v_sub_f32 v124, v124, v11
 v_sub_f32 v125, v125, v11
 v_sub_f32 v126, v126, v11
 v_sub_f32 v127, v127, v11
 v_sub_f32 v32, v32, v10
 v_sub_f32 v33, v33, v10
 v_sub_f32 v34, v34, v10
 v_sub_f32 v35, v35, v10
 v_sub_f32 v36, v36, v11
 v_sub_f32 v37, v37, v11
 v_sub_f32 v38, v38, v11
 v_sub_f32 v39, v39, v11
 v_exp_f32 v12, -v10
 v_exp_f32 v13, -v11
 v_mul_f32 v30, v12, v30
 v_mul_f32 v31, v13, v31
 v_mul_f32 v128, v12, v128
 v_mul_f32 v129, v12, v129
 v_mul_f32 v130, v12, v130
 v_mul_f32 v131, v12, v131
 v_mul_f32 v132, v13, v132
 v_mul_f32 v133, v13, v133
 v_mul_f32 v134, v13, v134
 v_mul_f32 v135, v13, v135
 v_mul_f32 v136, v12, v136
 v_mul_f32 v137, v12, v137
 v_mul_f32 v138, v12, v138
 v_mul_f32 v139, v12, v139
 v_mul_f32 v140, v13, v140
 v_mul_f32 v141, v13, v141
 v_mul_f32 v142, v13, v142
 v_mul_f32 v143, v13, v143
 v_mul_f32 v144, v12, v144
 v_mul_f32 v145, v12, v145
 v_mul_f32 v146, v12, v146
 v_mul_f32 v147, v12, v147
 v_mul_f32 v148, v13, v148
 v_mul_f32 v149, v13, v149
 v_mul_f32 v150, v13, v150
 v_mul_f32 v151, v13, v151
 v_mul_f32 v152, v12, v152
 v_mul_f32 v153, v12, v153
 v_mul_f32 v154, v12, v154
 v_mul_f32 v155, v12, v155
 v_mul_f32 v156, v13, v156
 v_mul_f32 v157, v13, v157
 v_mul_f32 v158, v13, v158
 v_mul_f32 v159, v13, v159
 v_mul_f32 v160, v12, v160
 v_mul_f32 v161, v12, v161
 v_mul_f32 v162, v12, v162
 v_mul_f32 v163, v12, v163
 v_mul_f32 v164, v13, v164
 v_mul_f32 v165, v13, v165
 v_mul_f32 v166, v13, v166
 v_mul_f32 v167, v13, v167
 v_mul_f32 v168, v12, v168
 v_mul_f32 v169, v12, v169
 v_mul_f32 v170, v12, v170
 v_mul_f32 v171, v12, v171
 v_mul_f32 v172, v13, v172
 v_mul_f32 v173, v13, v173
 v_mul_f32 v174, v13, v174
 v_mul_f32 v175, v13, v175
 v_mul_f32 v176, v12, v176
 v_mul_f32 v177, v12, v177
 v_mul_f32 v178, v12, v178
 v_mul_f32 v179, v12, v179
 v_mul_f32 v180, v13, v180
 v_mul_f32 v181, v13, v181
 v_mul_f32 v182, v13, v182
 v_mul_f32 v183, v13, v183
 v_mul_f32 v184, v12, v184
 v_mul_f32 v185, v12, v185
 v_mul_f32 v186, v12, v186
 v_mul_f32 v187, v12, v187
 v_mul_f32 v188, v13, v188
 v_mul_f32 v189, v13, v189
 v_mul_f32 v190, v13, v190
 v_mul_f32 v191, v13, v191
 v_mul_f32 v192, v12, v192
 v_mul_f32 v193, v12, v193
 v_mul_f32 v194, v12, v194
 v_mul_f32 v195, v12, v195
 v_mul_f32 v196, v13, v196
 v_mul_f32 v197, v13, v197
 v_mul_f32 v198, v13, v198
 v_mul_f32 v199, v13, v199
 v_mul_f32 v200, v12, v200
 v_mul_f32 v201, v12, v201
 v_mul_f32 v202, v12, v202
 v_mul_f32 v203, v12, v203
 v_mul_f32 v204, v13, v204
 v_mul_f32 v205, v13, v205
 v_mul_f32 v206, v13, v206
 v_mul_f32 v207, v13, v207
 v_mul_f32 v208, v12, v208
 v_mul_f32 v209, v12, v209
 v_mul_f32 v210, v12, v210
 v_mul_f32 v211, v12, v211
 v_mul_f32 v212, v13, v212
 v_mul_f32 v213, v13, v213
 v_mul_f32 v214, v13, v214
 v_mul_f32 v215, v13, v215
 v_mul_f32 v216, v12, v216
 v_mul_f32 v217, v12, v217
 v_mul_f32 v218, v12, v218
 v_mul_f32 v219, v12, v219
 v_mul_f32 v220, v13, v220
 v_mul_f32 v221, v13, v221
 v_mul_f32 v222, v13, v222
 v_mul_f32 v223, v13, v223
 v_mul_f32 v224, v12, v224
 v_mul_f32 v225, v12, v225
 v_mul_f32 v226, v12, v226
 v_mul_f32 v227, v12, v227
 v_mul_f32 v228, v13, v228
 v_mul_f32 v229, v13, v229
 v_mul_f32 v230, v13, v230
 v_mul_f32 v231, v13, v231
 v_mul_f32 v232, v12, v232
 v_mul_f32 v233, v12, v233
 v_mul_f32 v234, v12, v234
 v_mul_f32 v235, v12, v235
 v_mul_f32 v236, v13, v236
 v_mul_f32 v237, v13, v237
 v_mul_f32 v238, v13, v238
 v_mul_f32 v239, v13, v239
 v_mul_f32 v240, v12, v240
 v_mul_f32 v241, v12, v241
 v_mul_f32 v242, v12, v242
 v_mul_f32 v243, v12, v243
 v_mul_f32 v244, v13, v244
 v_mul_f32 v245, v13, v245
 v_mul_f32 v246, v13, v246
 v_mul_f32 v247, v13, v247
 v_mul_f32 v248, v12, v248
 v_mul_f32 v249, v12, v249
 v_mul_f32 v250, v12, v250
 v_mul_f32 v251, v12, v251
 v_mul_f32 v252, v13, v252
 v_mul_f32 v253, v13, v253
 v_mul_f32 v254, v13, v254
 v_mul_f32 v255, v13, v255
 v_exp_f32 v18, v64
 v_exp_f32 v19, v65
 v_exp_f32 v20, v66
 v_add_f32 v26, v18, v19
 v_cvt_pk_bf16_f32 v40, v18, v19
 v_exp_f32 v21, v67
 v_exp_f32 v22, v72
 v_add_f32 v26, v20, v26
 v_cvt_pk_bf16_f32 v41, v20, v21
 v_exp_f32 v23, v73
 v_add_f32 v26, v21, v26
 v_exp_f32 v24, v74
 v_add_f32 v26, v22, v26
 v_cvt_pk_bf16_f32 v42, v22, v23
 v_exp_f32 v25, v75
 v_add_f32 v26, v23, v26
 v_exp_f32 v18, v68
 v_add_f32 v26, v24, v26
 v_cvt_pk_bf16_f32 v43, v24, v25
 v_exp_f32 v19, v69
 v_add_f32 v26, v25, v26
 v_exp_f32 v20, v70
 v_add_f32 v27, v18, v19
 v_cvt_pk_bf16_f32 v44, v18, v19
 v_exp_f32 v21, v71
 v_exp_f32 v22, v76
 v_add_f32 v27, v20, v27
 v_cvt_pk_bf16_f32 v45, v20, v21
 v_exp_f32 v23, v77
 v_add_f32 v27, v21, v27
 v_exp_f32 v24, v78
 v_add_f32 v27, v22, v27
 v_cvt_pk_bf16_f32 v46, v22, v23
 v_exp_f32 v25, v79
 v_add_f32 v27, v23, v27
 v_add_f32 v27, v24, v27
 v_cvt_pk_bf16_f32 v47, v24, v25
 v_add_f32 v27, v25, v27
 v_exp_f32 v18, v80
 v_exp_f32 v19, v81
 v_exp_f32 v20, v82
 v_add_f32 v26, v18, v26
 v_cvt_pk_bf16_f32 v56, v18, v19
 v_exp_f32 v21, v83
 v_add_f32 v26, v19, v26
 v_exp_f32 v22, v88
 v_add_f32 v26, v20, v26
 v_cvt_pk_bf16_f32 v57, v20, v21
 v_exp_f32 v23, v89
 v_add_f32 v26, v21, v26
 v_exp_f32 v24, v90
 v_add_f32 v26, v22, v26
 v_cvt_pk_bf16_f32 v58, v22, v23
 v_exp_f32 v25, v91
 v_add_f32 v26, v23, v26
 v_exp_f32 v18, v84
 v_add_f32 v26, v24, v26
 v_cvt_pk_bf16_f32 v59, v24, v25
 v_exp_f32 v19, v85
 v_add_f32 v26, v25, v26
 v_exp_f32 v20, v86
 v_add_f32 v27, v18, v27
 v_cvt_pk_bf16_f32 v60, v18, v19
 v_exp_f32 v21, v87
 v_add_f32 v27, v19, v27
 v_exp_f32 v22, v92
 v_add_f32 v27, v20, v27
 v_cvt_pk_bf16_f32 v61, v20, v21
 v_exp_f32 v23, v93
 v_add_f32 v27, v21, v27
 v_exp_f32 v24, v94
 v_add_f32 v27, v22, v27
 v_cvt_pk_bf16_f32 v62, v22, v23
 v_exp_f32 v25, v95
 v_add_f32 v27, v23, v27
 v_add_f32 v27, v24, v27
 v_cvt_pk_bf16_f32 v63, v24, v25
 v_add_f32 v27, v25, v27
 s_nop 3
 s_setpc_b64 s[36:37]
L_slowB:
 s_nop 7
 s_nop 3
 v_max3_f32 v11, v100, v101, v102
 v_max3_f32 v11, v103, v108, v11
 v_max3_f32 v11, v109, v110, v11
 v_max3_f32 v11, v111, v116, v11
 v_max3_f32 v11, v117, v118, v11
 v_max3_f32 v11, v119, v124, v11
 v_max3_f32 v11, v125, v126, v11
 v_max_f32 v11, v127, v11
 v_mov_b32 v13, v11
 s_nop 1
 v_permlane16_swap_b32 v13, v11
 v_max_f32 v11, v13, v11
 v_mov_b32 v13, v11
 s_nop 1
 v_permlane32_swap_b32 v13, v11
 v_max_f32 v11, v13, v11
 v_ceil_f32 v11, v11
 v_max_f32 v11, 0, v11
 v_sub_f32 v100, v100, v11
 v_sub_f32 v101, v101, v11
 v_sub_f32 v102, v102, v11
 v_sub_f32 v103, v103, v11
 v_sub_f32 v108, v108, v11
 v_sub_f32 v109, v109, v11
 v_sub_f32 v110, v110, v11
 v_sub_f32 v111, v111, v11
 v_sub_f32 v116, v116, v11
 v_sub_f32 v117, v117, v11
 v_sub_f32 v118, v118, v11
 v_sub_f32 v119, v119, v11
 v_sub_f32 v124, v124, v11
 v_sub_f32 v125, v125, v11
 v_sub_f32 v126, v126, v11
 v_sub_f32 v127, v127, v11
 v_sub_f32 v36, v36, v11
 v_sub_f32 v37, v37, v11
 v_sub_f32 v38, v38, v11
 v_sub_f32 v39, v39, v11
 v_exp_f32 v13, -v11
 s_nop 0
 v_mul_f32 v31, v13, v31
 v_mul_f32 v132, v13, v132
 v_mul_f32 v133, v13, v133
 v_mul_f32 v134, v13, v134
 v_mul_f32 v135, v13, v135
 v_mul_f32 v140, v13, v140
 v_mul_f32 v141, v13, v141
 v_mul_f32 v142, v13, v142
 v_mul_f32 v143, v13, v143
 v_mul_f32 v148, v13, v148
 v_mul_f32 v149, v13, v149
 v_mul_f32 v150, v13, v150
 v_mul_f32 v151, v13, v151
 v_mul_f32 v156, v13, v156
 v_mul_f32 v157, v13, v157
 v_mul_f32 v158, v13, v158
 v_mul_f32 v159, v13, v159
 v_mul_f32 v164, v13, v164
 v_mul_f32 v165, v13, v165
 v_mul_f32 v166, v13, v166
 v_mul_f32 v167, v13, v167
 v_mul_f32 v172, v13, v172
 v_mul_f32 v173, v13, v173
 v_mul_f32 v174, v13, v174
 v_mul_f32 v175, v13, v175
 v_mul_f32 v180, v13, v180
 v_mul_f32 v181, v13, v181
 v_mul_f32 v182, v13, v182
 v_mul_f32 v183, v13, v183
 v_mul_f32 v188, v13, v188
 v_mul_f32 v189, v13, v189
 v_mul_f32 v190, v13, v190
 v_mul_f32 v191, v13, v191
 v_mul_f32 v196, v13, v196
 v_mul_f32 v197, v13, v197
 v_mul_f32 v198, v13, v198
 v_mul_f32 v199, v13, v199
 v_mul_f32 v204, v13, v204
 v_mul_f32 v205, v13, v205
 v_mul_f32 v206, v13, v206
 v_mul_f32 v207, v13, v207
 v_mul_f32 v212, v13, v212
 v_mul_f32 v213, v13, v213
 v_mul_f32 v214, v13, v214
 v_mul_f32 v215, v13, v215
 v_mul_f32 v220, v13, v220
 v_mul_f32 v221, v13, v221
 v_mul_f32 v222, v13, v222
 v_mul_f32 v223, v13, v223
 v_mul_f32 v228, v13, v228
 v_mul_f32 v229, v13, v229
 v_mul_f32 v230, v13, v230
 v_mul_f32 v231, v13, v231
 v_mul_f32 v236, v13, v236
 v_mul_f32 v237, v13, v237
 v_mul_f32 v238, v13, v238
 v_mul_f32 v239, v13, v239
 v_mul_f32 v244, v13, v244
 v_mul_f32 v245, v13, v245
 v_mul_f32 v246, v13, v246
 v_mul_f32 v247, v13, v247
 v_mul_f32 v252, v13, v252
 v_mul_f32 v253, v13, v253
 v_mul_f32 v254, v13, v254
 v_mul_f32 v255, v13, v255
 v_exp_f32 v18, v100
 v_exp_f32 v19, v101
 v_exp_f32 v20, v102
 v_add_f32 v29, v18, v19
 v_cvt_pk_bf16_f32 v52, v18, v19
 v_exp_f32 v21, v103
 v_exp_f32 v22, v108
 v_add_f32 v29, v20, v29
 v_cvt_pk_bf16_f32 v53, v20, v21
 v_exp_f32 v23, v109
 v_add_f32 v29, v21, v29
 v_exp_f32 v24, v110
 v_add_f32 v29, v22, v29
 v_cvt_pk_bf16_f32 v54, v22, v23
 v_exp_f32 v25, v111
 v_add_f32 v29, v23, v29
 v_exp_f32 v18, v116
 v_add_f32 v29, v24, v29
 v_cvt_pk_bf16_f32 v55, v24, v25
 v_exp_f32 v19, v117
 v_add_f32 v29, v25, v29
 v_exp_f32 v20, v118
 v_add_f32 v29, v18, v29
 v_cvt_pk_bf16_f32 v48, v18, v19
 v_exp_f32 v21, v119
 v_add_f32 v29, v19, v29
 v_exp_f32 v22, v124
 v_add_f32 v29, v20, v29
 v_cvt_pk_bf16_f32 v49, v20, v21
 v_exp_f32 v23, v125
 v_add_f32 v29, v21, v29
 v_exp_f32 v24, v126
 v_add_f32 v29, v22, v29
 v_cvt_pk_bf16_f32 v50, v22, v23
 v_exp_f32 v25, v127
 v_add_f32 v29, v23, v29
 v_add_f32 v29, v24, v29
 v_cvt_pk_bf16_f32 v51, v24, v25
 v_add_f32 v29, v25, v29
 s_nop 3
 s_setpc_b64 s[36:37]
L_slowf:
 s_nop 7
 s_nop 3
 v_max3_f32 v10, v64, v65, v66
 v_max3_f32 v10, v67, v72, v10
 v_max3_f32 v10, v73, v74, v10
 v_max3_f32 v10, v75, v80, v10
 v_max3_f32 v10, v81, v82, v10
 v_max3_f32 v10, v83, v88, v10
 v_max3_f32 v10, v89, v90, v10
 v_max_f32 v10, v91, v10
 v_max3_f32 v11, v68, v69, v70
 v_max3_f32 v11, v71, v76, v11
 v_max3_f32 v11, v77, v78, v11
 v_max3_f32 v11, v79, v84, v11
 v_max3_f32 v11, v85, v86, v11
 v_max3_f32 v11, v87, v92, v11
 v_max3_f32 v11, v93, v94, v11
 v_max_f32 v11, v95, v11
 v_mov_b32 v12, v10
 v_mov_b32 v13, v11
 s_nop 0
 v_permlane16_swap_b32 v12, v10
 v_permlane16_swap_b32 v13, v11
 v_max_f32 v10, v12, v10
 v_max_f32 v11, v13, v11
 v_mov_b32 v12, v10
 v_mov_b32 v13, v11
 s_nop 0
 v_permlane32_swap_b32 v12, v10
 v_permlane32_swap_b32 v13, v11
 v_max_f32 v10, v12, v10
 v_max_f32 v11, v13, v11
 v_ceil_f32 v10, v10
 v_ceil_f32 v11, v11
 v_sub_f32 v64, v64, v10
 v_sub_f32 v65, v65, v10
 v_sub_f32 v66, v66, v10
 v_sub_f32 v67, v67, v10
 v_sub_f32 v68, v68, v11
 v_sub_f32 v69, v69, v11
 v_sub_f32 v70, v70, v11
 v_sub_f32 v71, v71, v11
 v_sub_f32 v72, v72, v10
 v_sub_f32 v73, v73, v10
 v_sub_f32 v74, v74, v10
 v_sub_f32 v75, v75, v10
 v_sub_f32 v76, v76, v11
 v_sub_f32 v77, v77, v11
 v_sub_f32 v78, v78, v11
 v_sub_f32 v79, v79, v11
 v_sub_f32 v80, v80, v10
 v_sub_f32 v81, v81, v10
 v_sub_f32 v82, v82, v10
 v_sub_f32 v83, v83, v10
 v_sub_f32 v84, v84, v11
 v_sub_f32 v85, v85, v11
 v_sub_f32 v86, v86, v11
 v_sub_f32 v87, v87, v11
 v_sub_f32 v88, v88, v10
 v_sub_f32 v89, v89, v10
 v_sub_f32 v90, v90, v10
 v_sub_f32 v91, v91, v10
 v_sub_f32 v92, v92, v11
 v_sub_f32 v93, v93, v11
 v_sub_f32 v94, v94, v11
 v_sub_f32 v95, v95, v11
 v_sub_f32 v96, v96, v10
 v_sub_f32 v97, v97, v10
 v_sub_f32 v98, v98, v10
 v_sub_f32 v99, v99, v10
 v_sub_f32 v100, v100, v11
 v_sub_f32 v101, v101, v11
 v_sub_f32 v102, v102, v11
 v_sub_f32 v103, v103, v11
 v_sub_f32 v104, v104, v10
 v_sub_f32 v105, v105, v10
 v_sub_f32 v106, v106, v10
 v_sub_f32 v107, v107, v10
 v_sub_f32 v108, v108, v11
 v_sub_f32 v109, v109, v11
 v_sub_f32 v110, v110, v11
 v_sub_f32 v111, v111, v11
 v_sub_f32 v112, v112, v10
 v_sub_f32 v113, v113, v10
 v_sub_f32 v114, v114, v10
 v_sub_f32 v115, v115, v10
 v_sub_f32 v116, v116, v11
 v_sub_f32 v117, v117, v11
 v_sub_f32 v118, v118, v11
 v_sub_f32 v119, v119, v11
 v_sub_f32 v120, v120, v10
 v_sub_f32 v121, v121, v10
 v_sub_f32 v122, v122, v10
 v_sub_f32 v123, v123, v10
 v_sub_f32 v124, v124, v11
 v_sub_f32 v125, v125, v11
 v_sub_f32 v126, v126, v11
 v_sub_f32 v127, v127, v11
 v_sub_f32 v32, v32, v10
 v_sub_f32 v33, v33, v10
 v_sub_f32 v34, v34, v10
 v_sub_f32 v35, v35, v10
 v_sub_f32 v36, v36, v11
 v_sub_f32 v37, v37, v11
 v_sub_f32 v38, v38, v11
 v_sub_f32 v39, v39, v11
 v_exp_f32 v18, v64
 v_exp_f32 v19, v65
 v_exp_f32 v20, v66
 v_add_f32 v26, v18, v19
 v_cvt_pk_bf16_f32 v40, v18, v19
 v_exp_f32 v21, v67
 v_exp_f32 v22, v72
 v_add_f32 v26, v20, v26
 v_cvt_pk_bf16_f32 v41, v20, v21
 v_exp_f32 v23, v73
 v_add_f32 v26, v21, v26
 v_exp_f32 v24, v74
 v_add_f32 v26, v22, v26
 v_cvt_pk_bf16_f32 v42, v22, v23
 v_exp_f32 v25, v75
 v_add_f32 v26, v23, v26
 v_exp_f32 v18, v68
 v_add_f32 v26, v24, v26
 v_cvt_pk_bf16_f32 v43, v24, v25
 v_exp_f32 v19, v69
 v_add_f32 v26, v25, v26
 v_exp_f32 v20, v70
 v_add_f32 v27, v18, v19
 v_cvt_pk_bf16_f32 v44, v18, v19
 v_exp_f32 v21, v71
 v_exp_f32 v22, v76
 v_add_f32 v27, v20, v27
 v_cvt_pk_bf16_f32 v45, v20, v21
 v_exp_f32 v23, v77
 v_add_f32 v27, v21, v27
 v_exp_f32 v24, v78
 v_add_f32 v27, v22, v27
 v_cvt_pk_bf16_f32 v46, v22, v23
 v_exp_f32 v25, v79
 v_add_f32 v27, v23, v27
 v_add_f32 v27, v24, v27
 v_cvt_pk_bf16_f32 v47, v24, v25
 v_add_f32 v27, v25, v27
 v_exp_f32 v18, v80
 v_exp_f32 v19, v81
 v_exp_f32 v20, v82
 v_add_f32 v26, v18, v26
 v_cvt_pk_bf16_f32 v56, v18, v19
 v_exp_f32 v21, v83
 v_add_f32 v26, v19, v26
 v_exp_f32 v22, v88
 v_add_f32 v26, v20, v26
 v_cvt_pk_bf16_f32 v57, v20, v21
 v_exp_f32 v23, v89
 v_add_f32 v26, v21, v26
 v_exp_f32 v24, v90
 v_add_f32 v26, v22, v26
 v_cvt_pk_bf16_f32 v58, v22, v23
 v_exp_f32 v25, v91
 v_add_f32 v26, v23, v26
 v_exp_f32 v18, v84
 v_add_f32 v26, v24, v26
 v_cvt_pk_bf16_f32 v59, v24, v25
 v_exp_f32 v19, v85
 v_add_f32 v26, v25, v26
 v_exp_f32 v20, v86
 v_add_f32 v27, v18, v27
 v_cvt_pk_bf16_f32 v60, v18, v19
 v_exp_f32 v21, v87
 v_add_f32 v27, v19, v27
 v_exp_f32 v22, v92
 v_add_f32 v27, v20, v27
 v_cvt_pk_bf16_f32 v61, v20, v21
 v_exp_f32 v23, v93
 v_add_f32 v27, v21, v27
 v_exp_f32 v24, v94
 v_add_f32 v27, v22, v27
 v_cvt_pk_bf16_f32 v62, v22, v23
 v_exp_f32 v25, v95
 v_add_f32 v27, v23, v27
 v_add_f32 v27, v24, v27
 v_cvt_pk_bf16_f32 v63, v24, v25
 v_add_f32 v27, v25, v27
 s_nop 3
 s_setpc_b64 s[36:37]
L_moe0:
 s_lshl_b32 s88, s75, 1
 s_call_b64 s[36:37], L_moe
 v_add_f32 v32, v108, v32
 v_add_f32 v33, v109, v33
 v_add_f32 v34, v110, v34
 v_add_f32 v35, v111, v35
 v_add_f32 v36, v112, v36
 v_add_f32 v37, v113, v37
 v_add_f32 v38, v114, v38
 v_add_f32 v39, v115, v39
 v_add_f32 v40, v116, v40
 v_add_f32 v41, v117, v41
 v_add_f32 v42, v118, v42
 v_add_f32 v43, v119, v43
 v_add_f32 v44, v120, v44
 v_add_f32 v45, v121, v45
 v_add_f32 v46, v122, v46
 v_add_f32 v47, v123, v47
 s_mov_b64 exec, -1
 s_branch L_moe_ret0
L_moe1:
 s_lshl_b32 s88, s86, 1
 s_call_b64 s[36:37], L_moe
 v_add_f32 v80, v108, v80
 v_add_f32 v81, v109, v81
 v_add_f32 v82, v110, v82
 v_add_f32 v83, v111, v83
 v_add_f32 v84, v112, v84
 v_add_f32 v85, v113, v85
 v_add_f32 v86, v114, v86
 v_add_f32 v87, v115, v87
 s_mov_b64 exec, -1
 s_branch L_moe_ret1
L_moe2:
 s_lshl_b32 s88, s86, 1
 s_call_b64 s[36:37], L_moe
 v_add_f32 v32, v108, v32
 v_add_f32 v33, v109, v33
 v_add_f32 v34, v110, v34
 v_add_f32 v35, v111, v35
 v_add_f32 v36, v112, v36
 v_add_f32 v37, v113, v37
 v_add_f32 v38, v114, v38
 v_add_f32 v39, v115, v39
 s_mov_b64 exec, -1
 s_branch L_moe_ret2
L_moe:
 v_min_u32 v104, 27, v0
 v_lshlrev_b32 v104, 2, v104
 s_mov_b32 s64, 235475456
 s_mov_b32 s65, 65536
 s_mov_b32 exec_lo, 0xffffffff
 s_mov_b32 exec_hi, 0xffffffff
L_pfy:
 buffer_load_dword v105, v104, s[8:11], s64 offen sc1
 s_sub_u32 s65, s65, 1
 s_cbranch_scc1 L_pfy_x
 s_waitcnt vmcnt(0)
 v_cmp_ne_u32 vcc, 1, v105
 s_nop 0
 s_cbranch_vccz L_pfy_x
 s_sleep 2
 s_branch L_pfy
L_pfy_x:
 s_waitcnt vmcnt(0)
 s_mov_b64 exec, -1
 s_or_b64 exec, s[80:81], s[82:83]
 v_mov_b32 v104, 1792
 v_cndmask_b32 v104, v104, 0, s[80:81]
 v_lshl_add_u32 v104, v11, 5, v104
 s_add_u32 s88, s88, 234921984
 buffer_load_dwordx4 v[108:111], v104, s[8:11], s88 offen sc1
 buffer_load_dwordx4 v[112:115], v104, s[8:11], s88 offen offset:16 sc1
 buffer_load_dwordx4 v[116:119], v104, s[8:11], s88 offen offset:512 sc1
 buffer_load_dwordx4 v[120:123], v104, s[8:11], s88 offen offset:528 sc1
 s_waitcnt vmcnt(0)
 s_setpc_b64 s[36:37]
L_y1:
 s_lshl_b32 s89, s41, 1
 s_add_u32 s89, s89, s20
 s_cmp_ge_u32 s20, 2
 s_cselect_b32 s89, 28, s89
 s_cmp_ge_u32 s89, 28
 s_cbranch_scc1 L_y1r
 v_lshrrev_b32 v50, 4, v7
 v_lshrrev_b32 v51, 3, v50
 v_lshrrev_b32 v52, v51, s101
 v_and_b32 v53, 1, v52
 v_mul_u32_u24 v51, 16512, v51
 v_and_b32 v52, 7, v50
 v_lshl_add_u32 v51, v52, 7, v51
 v_lshl_add_u32 v51, v53, 13, v51
 s_mov_b32 s90, 234946560
 s_mov_b32 s88, 235078656
 s_mov_b32 s91, 65536
L_yp:
 buffer_load_dword v52, v51, s[8:11], s90 offen sc1
 buffer_load_dword v53, v51, s[8:11], s88 offen sc1
 s_waitcnt vmcnt(0)
 v_min_u32 v52, v52, v53
 v_cmp_gt_u32 vcc, 4, v52
 s_sub_u32 s91, s91, 1
 s_cbranch_scc1 L_ypx
 s_cbranch_vccnz L_yp
L_ypx:
 s_cmp_lt_u32 s89, 14
 s_cselect_b32 s90, 8, 12
 s_add_u32 s90, s90, 234913792
 buffer_load_dword v53, off, s[8:11], s90 sc1
 v_lshrrev_b32 v51, 3, v50
 v_mul_u32_u24 v51, 3584, v51
 v_and_b32 v52, 7, v50
 v_lshl_add_u32 v51, v52, 4, v51
 s_lshl_b32 s88, s89, 7
 s_add_u32 s90, s88, 234921984
 s_add_u32 s88, s88, 235929600
 buffer_load_dwordx4 v[136:139], v51, s[8:11], s88 offen sc1
 s_add_u32 s88, s88, 28672
 buffer_load_dwordx4 v[140:143], v51, s[8:11], s88 offen sc1
 s_add_u32 s88, s88, 28672
 buffer_load_dwordx4 v[152:155], v51, s[8:11], s88 offen sc1
 s_add_u32 s88, s88, 28672
 buffer_load_dwordx4 v[156:159], v51, s[8:11], s88 offen sc1
 s_add_u32 s88, s88, 28672
 buffer_load_dwordx4 v[168:171], v51, s[8:11], s88 offen sc1
 s_add_u32 s88, s88, 28672
 buffer_load_dwordx4 v[172:175], v51, s[8:11], s88 offen sc1
 s_add_u32 s88, s88, 28672
 buffer_load_dwordx4 v[184:187], v51, s[8:11], s88 offen sc1
 s_add_u32 s88, s88, 28672
 buffer_load_dwordx4 v[188:191], v51, s[8:11], s88 offen sc1
 s_add_u32 s88, s88, 28672
 buffer_load_dwordx4 v[200:203], v51, s[8:11], s88 offen sc1
 s_add_u32 s88, s88, 28672
 buffer_load_dwordx4 v[204:207], v51, s[8:11], s88 offen sc1
 s_add_u32 s88, s88, 28672
 buffer_load_dwordx4 v[216:219], v51, s[8:11], s88 offen sc1
 s_add_u32 s88, s88, 28672
 buffer_load_dwordx4 v[220:223], v51, s[8:11], s88 offen sc1
 s_add_u32 s88, s88, 28672
 buffer_load_dwordx4 v[232:235], v51, s[8:11], s88 offen sc1
 s_add_u32 s88, s88, 28672
 buffer_load_dwordx4 v[236:239], v51, s[8:11], s88 offen sc1
 s_add_u32 s88, s88, 28672
 s_branch L_y1r
L_y2:
 s_cmp_ge_u32 s89, 28
 s_cbranch_scc1 L_y2r
 s_waitcnt vmcnt(24)
 s_waitcnt vmcnt(12)
 v_add_f32 v136, v140, v136
 v_add_f32 v137, v141, v137
 v_add_f32 v138, v142, v138
 v_add_f32 v139, v143, v139
 s_waitcnt vmcnt(11)
 v_add_f32 v136, v152, v136
 v_add_f32 v137, v153, v137
 v_add_f32 v138, v154, v138
 v_add_f32 v139, v155, v139
 s_waitcnt vmcnt(10)
 v_add_f32 v136, v156, v136
 v_add_f32 v137, v157, v137
 v_add_f32 v138, v158, v138
 v_add_f32 v139, v159, v139
 s_waitcnt vmcnt(9)
 v_add_f32 v136, v168, v136
 v_add_f32 v137, v169, v137
 v_add_f32 v138, v170, v138
 v_add_f32 v139, v171, v139
 s_waitcnt vmcnt(8)
 v_add_f32 v136, v172, v136
 v_add_f32 v137, v173, v137
 v_add_f32 v138, v174, v138
 v_add_f32 v139, v175, v139
 s_waitcnt vmcnt(7)
 v_add_f32 v136, v184, v136
 v_add_f32 v137, v185, v137
 v_add_f32 v138, v186, v138
 v_add_f32 v139, v187, v139
 s_waitcnt vmcnt(6)
 v_add_f32 v136, v188, v136
 v_add_f32 v137, v189, v137
 v_add_f32 v138, v190, v138
 v_add_f32 v139, v191, v139
 s_waitcnt vmcnt(5)
 v_add_f32 v136, v200, v136
 v_add_f32 v137, v201, v137
 v_add_f32 v138, v202, v138
 v_add_f32 v139, v203, v139
 s_waitcnt vmcnt(4)
 v_add_f32 v136, v204, v136
 v_add_f32 v137, v205, v137
 v_add_f32 v138, v206, v138
 v_add_f32 v139, v207, v139
 s_waitcnt vmcnt(3)
 v_add_f32 v136, v216, v136
 v_add_f32 v137, v217, v137
 v_add_f32 v138, v218, v138
 v_add_f32 v139, v219, v139
 s_waitcnt vmcnt(2)
 v_add_f32 v136, v220, v136
 v_add_f32 v137, v221, v137
 v_add_f32 v138, v222, v138
 v_add_f32 v139, v223, v139
 s_waitcnt vmcnt(1)
 v_add_f32 v136, v232, v136
 v_add_f32 v137, v233, v137
 v_add_f32 v138, v234, v138
 v_add_f32 v139, v235, v139
 s_waitcnt vmcnt(0)
 v_add_f32 v136, v236, v136
 v_add_f32 v137, v237, v137
 v_add_f32 v138, v238, v138
 v_add_f32 v139, v239, v139
 v_add_f32 v136, v136, v136 row_ror:8 row_mask:0xf bank_mask:0xf
 v_add_f32 v137, v137, v137 row_ror:8 row_mask:0xf bank_mask:0xf
 v_add_f32 v138, v138, v138 row_ror:8 row_mask:0xf bank_mask:0xf
 v_add_f32 v139, v139, v139 row_ror:8 row_mask:0xf bank_mask:0xf
 v_mov_b32 v140, v136
 v_mov_b32 v141, v137
 v_mov_b32 v142, v138
 v_mov_b32 v143, v139
 v_permlane16_swap_b32 v140, v136
 v_permlane16_swap_b32 v141, v137
 v_permlane16_swap_b32 v142, v138
 v_permlane16_swap_b32 v143, v139
 v_add_f32 v136, v140, v136
 v_add_f32 v137, v141, v137
 v_add_f32 v138, v142, v138
 v_add_f32 v139, v143, v139
 v_mov_b32 v140, v136
 v_mov_b32 v141, v137
 v_mov_b32 v142, v138
 v_mov_b32 v143, v139
 v_permlane32_swap_b32 v140, v136
 v_permlane32_swap_b32 v141, v137
 v_permlane32_swap_b32 v142, v138
 v_permlane32_swap_b32 v143, v139
 v_add_f32 v136, v140, v136
 v_add_f32 v137, v141, v137
 v_add_f32 v138, v142, v138
 v_add_f32 v139, v143, v139
 v_cvt_pk_bf16_f32 v51, v136, v137
 v_lshlrev_b32 v136, 16, v51
 v_and_b32 v137, 0xffff0000, v51
 v_cvt_pk_bf16_f32 v51, v138, v139
 v_lshlrev_b32 v138, 16, v51
 v_and_b32 v139, 0xffff0000, v51
 v_mul_f32 v136, v53, v136
 v_mul_f32 v137, v53, v137
 v_mul_f32 v138, v53, v138
 v_mul_f32 v139, v53, v139
 v_cvt_pk_bf16_f32 v51, v136, v137
 v_lshlrev_b32 v136, 16, v51
 v_and_b32 v137, 0xffff0000, v51
 v_cvt_pk_bf16_f32 v51, v138, v139
 v_lshlrev_b32 v138, 16, v51
 v_and_b32 v139, 0xffff0000, v51
 s_mov_b64 exec, 0xff
 buffer_store_dwordx4 v[136:139], v7, s[8:11], s90 offen sc1
 s_mov_b64 exec, -1
 s_branch L_y2r
L_y3:
 s_cmp_ge_u32 s89, 28
 s_cbranch_scc1 L_y3r
 v_mov_b32 v52, 1
 s_lshl_b32 s89, s89, 2
 s_add_u32 s89, s89, 235475456
 s_mov_b64 exec, 1
 s_waitcnt vmcnt(5)
 buffer_store_dword v52, off, s[8:11], s89 sc1
 s_mov_b64 exec, -1
 s_branch L_y3r
L_fll:
 s_cmp_lg_u32 s39, 15
 s_cbranch_scc1 L_fll1
 v_mov_b32 v9, 0
 s_mov_b32 s46, s47
 s_mov_b32 s39, 1
L_fll1:
 buffer_load_dword v6, v9, s[8:11], s46 offen sc1
 s_branch L_fllr
L_pub3:
 v_mov_b32 v17, s3
 buffer_store_dword v17, v1, s[8:11], s45 offen sc1
 s_branch L_pub3r
L_fhs0:
 s_mov_b32 s91, 65536
L_fhs0_l:
 s_sleep 2
 buffer_load_dword v24, off, s[8:11], s79 sc1
 s_sub_u32 s91, s91, 1
 s_cbranch_scc1 L_fhs0_x
 s_waitcnt vmcnt(0)
 v_cmp_gt_u32 vcc, 1, v24
 s_nop 0
 s_cbranch_vccnz L_fhs0_l
L_fhs0_x:
 s_waitcnt vmcnt(0)
 s_branch L_fhr0
L_fhs1:
 s_mov_b32 s91, 65536
L_fhs1_l:
 s_sleep 2
 buffer_load_dword v24, off, s[8:11], s79 sc1
 s_sub_u32 s91, s91, 1
 s_cbranch_scc1 L_fhs1_x
 s_waitcnt vmcnt(0)
 v_cmp_gt_u32 vcc, 1, v24
 s_nop 0
 s_cbranch_vccnz L_fhs1_l
L_fhs1_x:
 s_waitcnt vmcnt(0)
 s_branch L_fhr1
L_fps1:
 s_mov_b32 s53, 65536
L_fps1_l:
 s_sleep 2
 buffer_load_dword v5, off, s[8:11], s47 sc1
 s_sub_u32 s53, s53, 1
 s_cbranch_scc1 L_fps1_x
 s_waitcnt vmcnt(0)
 v_cmp_ne_u32 vcc, 1, v5
 s_nop 0
 s_cbranch_vccnz L_fps1_l
L_fps1_x:
 s_waitcnt vmcnt(0)
 s_branch L_fpr1
L_f4s:
 s_mov_b32 s53, 65536
L_f4s_l:
 s_sleep 2
 buffer_load_dword v6, v9, s[8:11], s46 offen sc1
 s_sub_u32 s53, s53, 1
 s_cbranch_scc1 L_f4s_x
 s_waitcnt vmcnt(0)
 v_cmp_gt_u32 vcc, 3, v6
 s_nop 0
 s_cbranch_vccnz L_f4s_l
L_f4s_x:
 s_waitcnt vmcnt(0)
 s_branch L_f4r
L_f2s:
 s_mov_b32 s53, 65536
L_f2s_l:
 s_sleep 2
 buffer_load_dword v6, v9, s[8:11], s46 offen sc1
 s_sub_u32 s53, s53, 1
 s_cbranch_scc1 L_f2s_x
 s_waitcnt vmcnt(0)
 v_cmp_gt_u32 vcc, 3, v6
 s_nop 0
 s_cbranch_vccnz L_f2s_l
L_f2s_x:
 s_waitcnt vmcnt(0)
 s_branch L_f2r
L_fls0:
 s_mov_b32 s53, 65536
L_fls0_l:
 s_sleep 2
 buffer_load_dword v6, v9, s[8:11], s46 offen sc1
 s_sub_u32 s53, s53, 1
 s_cbranch_scc1 L_fls0_x
 s_waitcnt vmcnt(0)
 v_cmp_gt_u32 vcc, s39, v6
 s_nop 0
 s_cbranch_vccnz L_fls0_l
L_fls0_x:
 s_waitcnt vmcnt(0)
 s_branch L_flr0
L_code_end:
.section .rodata,"a"
.p2align 6
.amdhsa_kernel gated_mix__compressed_kv_cla__moe_arch_mod__prompt_kernel
  .amdhsa_next_free_vgpr 512
  .amdhsa_next_free_sgpr 102
  .amdhsa_accum_offset 256
  .amdhsa_group_segment_fixed_size 0
  .amdhsa_kernarg_size 120
  .amdhsa_user_sgpr_count 2
  .amdhsa_user_sgpr_kernarg_segment_ptr 1
  .amdhsa_system_sgpr_workgroup_id_x 1
  .amdhsa_float_denorm_mode_32 3
.end_amdhsa_kernel
```

```asm
; @launch grid=(256,1,1) block=(256,1,1) lds=163840
.amdgcn_target "amdgcn-amd-amdhsa--gfx950"
.text
.macro M d, a, b, c
v_mfma_f32_16x16x32_bf16 \d, \a, \b, \c
.endm
.globl gated_mix__compressed_kv_cla__moe_arch_mod__prompt_kernel
.p2align 8
.type gated_mix__compressed_kv_cla__moe_arch_mod__prompt_kernel,@function
gated_mix__compressed_kv_cla__moe_arch_mod__prompt_kernel:
 s_cmp_lt_u32 s2, 256
 s_cbranch_scc1 L_go
 s_endpgm
L_go:
 s_load_dwordx8 s[80:87], s[0:1], 0
 s_load_dwordx4 s[88:91], s[0:1], 32
 s_load_dwordx2 s[92:93], s[0:1], 56
 s_load_dwordx2 s[30:31], s[0:1], 88
 s_load_dwordx4 s[4:7], s[0:1], 104
 v_lshrrev_b32 v24, 6, v0
 v_and_b32 v0, 63, v0
 v_readfirstlane_b32 s20, v24
 s_getpc_b64 s[76:77]
L_pc0:
 s_and_b32 s77, s77, 0xffff
 s_mov_b32 s78, L_code_end-L_pc0
 s_mov_b32 s79, 0x20000
 s_lshr_b32 s64, s2, 3
 s_lshl_b32 s64, s64, 2
 s_add_u32 s64, s64, s20
 s_lshl_b32 s95, s64, 11
 v_lshl_add_u32 v29, v0, 7, s95
 v_and_b32 v28, 48, v0
 v_lshl_add_u32 v28, v28, 24, v29
 buffer_load_dword a240, v28, s[76:79], 0 offen offset:0
 s_and_b32 s41, s2, 7
 s_lshr_b32 s42, s2, 3
 s_lshr_b32 s64, s42, 4
 s_lshl_b32 s64, s64, 3
 s_add_u32 s41, s41, s64
 s_and_b32 s42, s42, 15
 s_lshr_b32 s45, s42, 3
 s_xor_b32 s45, s45, 1
 s_mov_b32 s44, 0
 v_accvgpr_write_b32 a250, 0
 v_accvgpr_write_b32 a251, 0
 v_and_b32 v24, 15, v0
 v_lshrrev_b32 v25, 4, v0
 v_lshlrev_b32 v7, 4, v0
 s_and_b32 s65, s20, 1
 s_lshr_b32 s66, s20, 1
 v_or_b32 v28, 0, v25
 v_lshlrev_b32 v28, 1, v28
 v_xor_b32 v28, v28, v24
 v_lshrrev_b32 v29, 3, v28
 v_lshlrev_b32 v29, 8, v29
 v_and_b32 v28, 7, v28
 v_lshl_add_u32 v28, v28, 4, v29
 v_lshl_add_u32 v28, v25, 13, v28
 s_lshl_b32 s64, s20, 17
 s_add_u32 s64, s64, 0
 v_add_u32 v8, s64, v28
 v_add_u32 v9, 31744, v8
 v_or_b32 v28, 4, v25
 v_lshlrev_b32 v28, 1, v28
 v_xor_b32 v28, v28, v24
 v_lshrrev_b32 v29, 3, v28
 v_lshlrev_b32 v29, 8, v29
 v_and_b32 v28, 7, v28
 v_lshl_add_u32 v28, v28, 4, v29
 v_lshl_add_u32 v28, v25, 13, v28
 s_lshl_b32 s64, s20, 17
 s_add_u32 s64, s64, 63488
 v_add_u32 v10, s64, v28
 v_add_u32 v11, 31744, v10
 v_add_u32 v28, 0, v25
 v_and_b32 v29, 7, v0
 v_xor_b32 v28, v28, v29
 v_lshlrev_b32 v28, 4, v28
 v_lshrrev_b32 v29, 3, v0
 v_lshl_add_u32 v30, v29, 11, v28
 s_lshl_b32 s64, s66, 19
 s_lshl_b32 s67, s65, 20
 s_add_u32 s64, s64, s67
 s_add_u32 s64, s64, 0
 v_add_u32 v12, s64, v30
 v_add_u32 v14, 30720, v12
 v_add_u32 v28, 4, v25
 v_and_b32 v29, 7, v0
 v_xor_b32 v28, v28, v29
 v_lshlrev_b32 v28, 4, v28
 v_lshrrev_b32 v29, 3, v0
 v_lshl_add_u32 v30, v29, 11, v28
 s_lshl_b32 s64, s66, 19
 s_lshl_b32 s67, s65, 20
 s_add_u32 s64, s64, s67
 s_add_u32 s64, s64, 15360
 v_add_u32 v13, s64, v30
 v_add_u32 v15, 30720, v13
 s_mov_b32 s21, 0
 s_mov_b32 s22, 0
 s_lshl_b32 s23, s20, 12
 s_add_u32 s24, s23, 65536
 s_lshl_b32 s74, s41, 9
 s_sub_u32 s18, 8388608, s74
 s_mov_b32 s19, 0x20000
 s_and_b32 s75, s42, 7
 s_lshl_b32 s75, s75, 16
 s_sub_u32 s50, 4194304, s75
 s_mov_b32 s51, 0x20000
 s_mov_b32 m0, s23
 s_cmp_eq_u32 s45, 0
 s_waitcnt lgkmcnt(0)
 s_cselect_b64 s[72:73], s[86:87], s[88:89]
 s_add_u32 s16, s72, s74
 s_addc_u32 s17, s73, 0
 s_and_b32 s17, s17, 0xffff
 buffer_load_dwordx4 v8, s[16:19], s21 offen offset:0  nt lds
 buffer_load_dwordx4 v9, s[16:19], s21 offen offset:1024  nt lds
 buffer_load_dwordx4 v10, s[16:19], s21 offen offset:2048  nt lds
 buffer_load_dwordx4 v11, s[16:19], s21 offen offset:3072  nt lds
 s_add_u32 s21, s21, 128
 s_add_u32 s48, s82, s75
 s_addc_u32 s49, s83, 0
 s_and_b32 s49, s49, 0xffff
 s_add_u32 m0, s24, 0
 s_nop 0
 buffer_load_dwordx4 v12, s[48:51], s22 offen offset:0   lds
 buffer_load_dwordx4 v13, s[48:51], s22 offen offset:1024   lds
 buffer_load_dwordx4 v14, s[48:51], s22 offen offset:2048   lds
 buffer_load_dwordx4 v15, s[48:51], s22 offen offset:3072   lds
 s_add_u32 s22, s22, 2097152
 s_add_u32 m0, s23, 16384
 s_nop 0
 buffer_load_dwordx4 v8, s[16:19], s21 offen offset:0  nt lds
 buffer_load_dwordx4 v9, s[16:19], s21 offen offset:1024  nt lds
 buffer_load_dwordx4 v10, s[16:19], s21 offen offset:2048  nt lds
 buffer_load_dwordx4 v11, s[16:19], s21 offen offset:3072  nt lds
 s_add_u32 s21, s21, 524160
 s_and_b32 s40, s42, 7
 s_min_u32 s40, s40, 5
 s_add_u32 s47, s40, 1
 s_lshr_b32 s47, s47, 2
 s_xor_b32 s47, s47, s20
 s_and_b32 s47, s47, 1
 s_lshl4_add_u32 s46, s40, s41
 s_xor_b32 s46, s46, 1
 s_lshl1_add_u32 s46, s46, s47
 s_lshl4_add_u32 s46, s46, s20
 s_lshl_b32 s46, s46, 9
 s_add_u32 s46, s46, 239075328
 s_add_u32 s46, s46, s6
 s_addc_u32 s47, s7, 0
 s_load_dword s43, s[46:47], 0
 v_lshrrev_b32 v26, 2, v24
 v_and_b32 v28, 1, v25
 v_lshl_or_b32 v28, v28, 2, v26
 v_lshl_add_u32 v29, v25, 3, v26
 v_lshlrev_b32 v29, 8, v29
 v_and_b32 v30, 3, v0
 v_lshl_add_u32 v29, v30, 3, v29
 s_lshl_b32 s64, s65, 2
 s_add_u32 s64, s64, 0
 v_xor_b32 v30, s64, v28
 v_lshl_add_u32 v1, v30, 5, v29
 s_lshl_b32 s64, s65, 2
 s_add_u32 s64, s64, 1
 v_xor_b32 v30, s64, v28
 v_lshl_add_u32 v2, v30, 5, v29
 s_lshl_b32 s64, s65, 2
 s_add_u32 s64, s64, 2
 v_xor_b32 v30, s64, v28
 v_lshl_add_u32 v3, v30, 5, v29
 s_lshl_b32 s64, s65, 2
 s_add_u32 s64, s64, 3
 v_xor_b32 v30, s64, v28
 v_lshl_add_u32 v4, v30, 5, v29
 v_add_u32 v28, 0, v25
 v_lshrrev_b32 v29, 1, v24
 v_xor_b32 v28, v28, v29
 v_lshlrev_b32 v28, 4, v28
 v_lshl_add_u32 v28, v24, 7, v28
 s_lshl_b32 s64, s66, 13
 s_add_u32 s64, s64, 65536
 v_add_u32 v5, s64, v28
 v_add_u32 v28, 4, v25
 v_lshrrev_b32 v29, 1, v24
 v_xor_b32 v28, v28, v29
 v_lshlrev_b32 v28, 4, v28
 v_lshl_add_u32 v28, v24, 7, v28
 s_lshl_b32 s64, s66, 13
 s_add_u32 s64, s64, 65536
 v_add_u32 v6, s64, v28
 s_lshl_b32 s64, s2, 2
 s_add_u32 s64, s64, s20
 s_lshl_b32 s64, s64, 12
 v_lshrrev_b32 v28, 2, v0
 v_and_b32 v29, 3, v0
 v_lshlrev_b32 v29, 7, v29
 v_lshl_add_u32 v28, v28, 11, v29
 v_add_u32 v24, s64, v28
 v_and_b32 v28, 56, v0
 v_lshl_add_u32 v24, v28, 24, v24
 s_mov_b32 s32, s82
 s_and_b32 s33, s83, 0xffff
 s_mov_b32 s34, 4194304
 s_mov_b32 s35, 0x20000
 s_mov_b32 s56, s80
 s_and_b32 s57, s81, 0xffff
 s_mov_b32 s58, 1835008
 s_mov_b32 s59, 0x20000
 s_mov_b32 s60, s92
 s_and_b32 s61, s93, 0xffff
 s_mov_b32 s62, 896
 s_mov_b32 s63, 0x20000
 s_mov_b32 s68, s30
 s_and_b32 s69, s31, 0xffff
 s_mov_b32 s70, 896
 s_mov_b32 s71, 0x20000
 s_mov_b32 s8, s6
 s_and_b32 s9, s7, 0xffff
 s_mov_b32 s10, 268435456
 s_mov_b32 s11, 0x20000
 s_mov_b32 s12, s4
 s_and_b32 s13, s5, 0xffff
 s_mov_b32 s14, 256
 s_mov_b32 s15, 0x20000
 s_add_u32 s72, s84, s74
 s_addc_u32 s73, s85, 0
 s_sub_u32 s75, 3670016, s74
 s_mov_b32 s52, s72
 s_and_b32 s53, s73, 0xffff
 s_mov_b32 s54, s75
 s_mov_b32 s55, 0x20000
 s_mov_b32 s5, 0x3db8aa3b
 s_mov_b32 s28, 0
 s_mul_i32 s29, s42, 114688
 s_lshl_b32 s72, s45, 25
 s_and_b32 s27, s41, 7
 s_lshr_b32 s73, s41, 3
 s_lshl1_add_u32 s27, s27, s73
 s_lshl_b32 s73, s27, 21
 s_add_u32 s72, s72, s73
 s_bfe_u32 s64, s42, 0x20001
 s_lshl_b32 s64, s64, 16
 s_add_u32 s72, s72, s64
 s_lshl_b32 s64, s66, 18
 s_add_u32 s72, s72, s64
 s_and_b32 s67, s42, 1
 s_cmp_eq_u32 s45, 0
 s_cselect_b32 s64, 12, 15
 s_cselect_b32 s75, 15, 10
 s_lshl_b32 s67, s67, s75
 s_add_u32 s72, s72, s67
 s_lshl_b32 s64, s65, s64
 s_add_u32 s93, s72, s64
 s_load_dwordx4 s[80:83], s[0:1], 64
 s_load_dwordx2 s[84:85], s[0:1], 80
 s_load_dwordx2 s[96:97], s[0:1], 96
 s_cmp_lt_u32 s42, 8
 s_cbranch_scc0 L_kv1
L_kv0:
 s_lshl_b32 s64, s42, 4
 s_add_u32 s64, s64, s41
 s_lshl_b32 s64, s64, 2
 s_add_u32 s64, s64, s20
 s_cmp_lt_u32 s64, 41
 s_cselect_b32 s39, 0, 536870912
 s_min_u32 s64, s64, 41
 s_lshl_b32 s38, s64, 2
 s_max_u32 s67, s64, 8
 s_sub_u32 s67, s67, 8
 s_mul_i32 s67, s67, 15488
 s_lshl_b32 s64, s64, 10
 s_add_u32 s64, s64, s67
 s_add_u32 s73, s64, 234938368
 v_or_b32 v64, s39, v7
 v_mov_b32 v68, 0
 v_mov_b32 v69, 0
 v_mov_b32 v70, 0
 v_mov_b32 v71, 0
 s_lshl_b32 s30, s41, 3
 s_add_u32 s30, s30, s42
 s_lshl_b32 s64, s30, 2
 s_add_u32 s64, s64, s20
 s_mul_i32 s72, s64, 3584
 v_mov_b32 v32, 536870912
 v_cmp_gt_u32 vcc, 56, v0
 s_lshl_b32 s67, s64, 2
 s_nop 0
 v_cndmask_b32 v32, v32, v7, vcc
 buffer_load_dwordx4 v[40:43], v32, s[56:59], s72 offen offset:0
 buffer_load_dwordx4 v[44:47], v32, s[56:59], s72 offen offset:896
 buffer_load_dwordx4 v[48:51], v32, s[56:59], s72 offen offset:1792
 buffer_load_dwordx4 v[52:55], v32, s[56:59], s72 offen offset:2688
 buffer_load_dwordx4 v[56:59], v32, s[60:63], 0 offen
 buffer_load_dwordx4 v[60:63], v32, s[68:71], 0 offen
 buffer_store_dwordx4 v[68:71], v64, s[8:11], s73 offen offset:0 sc1
 buffer_store_dwordx4 v[68:71], v64, s[8:11], s73 offen offset:1024 sc1
 buffer_store_dwordx4 v[68:71], v64, s[8:11], s73 offen offset:2048 sc1
 s_add_u32 s73, s73, 8192
 buffer_store_dwordx4 v[68:71], v64, s[8:11], s73 offen offset:0 sc1
 buffer_store_dwordx4 v[68:71], v64, s[8:11], s73 offen offset:1024 sc1
 buffer_store_dwordx4 v[68:71], v64, s[8:11], s73 offen offset:2048 sc1
 s_waitcnt vmcnt(16) lgkmcnt(0)
 s_barrier
 ds_read_b128 a[160:163], v5 offset:0
 ds_read_b128 a[164:167], v6 offset:0
 ds_read_b64_tr_b16 a[32:33], v1 offset:0
 ds_read_b64_tr_b16 a[34:35], v1 offset:1024
 ds_read_b64_tr_b16 a[36:37], v1 offset:8192
 ds_read_b64_tr_b16 a[38:39], v1 offset:9216
 ds_read_b64_tr_b16 a[40:41], v2 offset:0
 ds_read_b64_tr_b16 a[42:43], v2 offset:1024
 ds_read_b64_tr_b16 a[44:45], v2 offset:8192
 ds_read_b64_tr_b16 a[46:47], v2 offset:9216
 ds_read_b128 a[168:171], v5 offset:2048
 ds_read_b128 a[172:175], v6 offset:2048
 ds_read_b64_tr_b16 a[48:49], v3 offset:0
 ds_read_b64_tr_b16 a[50:51], v3 offset:1024
 ds_read_b64_tr_b16 a[52:53], v3 offset:8192
 ds_read_b64_tr_b16 a[54:55], v3 offset:9216
 ds_read_b64_tr_b16 a[56:57], v4 offset:0
 ds_read_b64_tr_b16 a[58:59], v4 offset:1024
 ds_read_b64_tr_b16 a[60:61], v4 offset:8192
 ds_read_b64_tr_b16 a[62:63], v4 offset:9216
 ds_read_b128 a[176:179], v5 offset:4096
 ds_read_b128 a[180:183], v6 offset:4096
 ds_read_b128 a[184:187], v5 offset:6144
 ds_read_b128 a[188:191], v6 offset:6144
 s_add_u32 m0, s24, 16384
 s_nop 0
 buffer_load_dwordx4 v12, s[48:51], s22 offen offset:0   lds
 buffer_load_dwordx4 v13, s[48:51], s22 offen offset:1024   lds
 buffer_load_dwordx4 v14, s[48:51], s22 offen offset:2048   lds
 buffer_load_dwordx4 v15, s[48:51], s22 offen offset:3072   lds
 s_sub_u32 s22, s22, 2097024
 s_add_u32 m0, s23, 32768
 s_nop 0
 buffer_load_dwordx4 v8, s[16:19], s21 offen offset:0  nt lds
 buffer_load_dwordx4 v9, s[16:19], s21 offen offset:1024  nt lds
 buffer_load_dwordx4 v10, s[16:19], s21 offen offset:2048  nt lds
 buffer_load_dwordx4 v11, s[16:19], s21 offen offset:3072  nt lds
 s_add_u32 s21, s21, 128
 v_mov_b32 v72, 0
 v_mov_b32 v73, 0
 v_mov_b32 v74, 0
 v_mov_b32 v75, 0
 v_mov_b32 v76, 0
 v_mov_b32 v77, 0
 v_mov_b32 v78, 0
 v_mov_b32 v79, 0
 s_waitcnt vmcnt(15)
 v_dot2c_f32_bf16 v72, v40, v56
 v_dot2c_f32_bf16 v73, v44, v56
 v_dot2c_f32_bf16 v74, v48, v56
 v_dot2c_f32_bf16 v75, v52, v56
 s_waitcnt vmcnt(14)
 v_dot2c_f32_bf16 v76, v40, v60
 v_dot2c_f32_bf16 v77, v44, v60
 v_dot2c_f32_bf16 v78, v48, v60
 v_dot2c_f32_bf16 v79, v52, v60
 v_dot2c_f32_bf16 v72, v41, v57
 v_dot2c_f32_bf16 v73, v45, v57
 v_dot2c_f32_bf16 v74, v49, v57
 v_dot2c_f32_bf16 v75, v53, v57
 v_dot2c_f32_bf16 v76, v41, v61
 v_dot2c_f32_bf16 v77, v45, v61
 v_dot2c_f32_bf16 v78, v49, v61
 v_dot2c_f32_bf16 v79, v53, v61
 v_dot2c_f32_bf16 v72, v42, v58
 v_dot2c_f32_bf16 v73, v46, v58
 v_dot2c_f32_bf16 v74, v50, v58
 v_dot2c_f32_bf16 v75, v54, v58
 v_dot2c_f32_bf16 v76, v42, v62
 v_dot2c_f32_bf16 v77, v46, v62
 v_dot2c_f32_bf16 v78, v50, v62
 v_dot2c_f32_bf16 v79, v54, v62
 v_dot2c_f32_bf16 v72, v43, v59
 v_dot2c_f32_bf16 v73, v47, v59
 v_dot2c_f32_bf16 v74, v51, v59
 v_dot2c_f32_bf16 v75, v55, v59
 v_dot2c_f32_bf16 v76, v43, v63
 v_dot2c_f32_bf16 v77, v47, v63
 v_dot2c_f32_bf16 v78, v51, v63
 v_dot2c_f32_bf16 v79, v55, v63
 v_permlane32_swap_b32 v72, v74
 v_permlane32_swap_b32 v73, v75
 v_permlane32_swap_b32 v76, v78
 v_permlane32_swap_b32 v77, v79
 v_add_f32 v72, v72, v74
 v_add_f32 v73, v73, v75
 v_add_f32 v76, v76, v78
 v_add_f32 v77, v77, v79
 v_lshrrev_b32 v80, 4, v0
 v_permlane16_swap_b32 v72, v73
 v_permlane16_swap_b32 v76, v77
 v_add_f32 v72, v72, v73
 v_add_f32 v76, v76, v77
 v_add_u32 v81, s67, v80
 v_add_f32 v72, v72, v72 row_ror:8 row_mask:0xf bank_mask:0xf
 v_add_f32 v76, v76, v76 row_ror:8 row_mask:0xf bank_mask:0xf
 s_nop 0
 v_add_f32 v72, v72, v72 row_ror:4 row_mask:0xf bank_mask:0xf
 v_add_f32 v76, v76, v76 row_ror:4 row_mask:0xf bank_mask:0xf
 s_nop 0
 v_add_f32 v72, v72, v72 row_ror:2 row_mask:0xf bank_mask:0xf
 v_add_f32 v76, v76, v76 row_ror:2 row_mask:0xf bank_mask:0xf
 s_nop 0
 v_add_f32 v72, v72, v72 row_ror:1 row_mask:0xf bank_mask:0xf
 v_add_f32 v76, v76, v76 row_ror:1 row_mask:0xf bank_mask:0xf
 v_ashrrev_i32 v82, 31, v72
 v_or_b32 v82, 0x80000000, v82
 v_xor_b32 v82, v82, v72
 v_and_b32 v82, 0xfffff800, v82
 v_sub_u32 v81, 2047, v81
 v_or_b32 v82, v82, v81
 v_max_u32 v82, 1, v82
 v_mul_f32 v77, 0xbfb8aa3b, v76
 v_exp_f32 v77, v77
 s_nop 0
 v_add_f32 v77, 1.0, v77
 v_rcp_f32 v76, v77
 s_lshl_b32 s72, s20, 4
 s_add_u32 s72, s72, 163584
 v_lshl_add_u32 v80, v80, 2, s72
 ds_write_b32 v80, v82
 ds_write_b32 v80, v72 offset:64
 ds_write_b32 v80, v76 offset:128
 s_waitcnt lgkmcnt(15)
M a[0:3], a[160:163], a[32:35], 0
M a[0:3], a[164:167], a[36:39], a[0:3]
M a[4:7], a[164:167], a[44:47], 0
M a[4:7], a[160:163], a[40:43], a[4:7]
 s_waitcnt lgkmcnt(11)
M a[8:11], a[160:163], a[48:51], 0
M a[8:11], a[164:167], a[52:55], a[8:11]
 s_waitcnt lgkmcnt(7)
M a[12:15], a[164:167], a[60:63], 0
 s_add_u32 m0, s23, 49152
M a[12:15], a[160:163], a[56:59], a[12:15]
 buffer_load_dwordx4 v8, s[16:19], s21 offen offset:0  nt lds
M v[32:35], a[168:171], a[32:35], 0
 buffer_load_dwordx4 v9, s[16:19], s21 offen offset:1024  nt lds
M v[32:35], a[172:175], a[36:39], v[32:35]
M v[36:39], a[172:175], a[44:47], 0
 buffer_load_dwordx4 v10, s[16:19], s21 offen offset:2048  nt lds
M v[36:39], a[168:171], a[40:43], v[36:39]
M v[40:43], a[168:171], a[48:51], 0
 buffer_load_dwordx4 v11, s[16:19], s21 offen offset:3072  nt lds
M v[40:43], a[172:175], a[52:55], v[40:43]
 s_add_u32 s21, s21, 524160
M v[44:47], a[172:175], a[60:63], 0
 s_waitcnt lgkmcnt(0)
M v[44:47], a[168:171], a[56:59], v[44:47]
 s_barrier
M v[64:67], a[176:179], a[32:35], 0
 s_add_u32 m0, s24, 32768
 ds_read_b64_tr_b16 a[64:65], v1 offset:16384
 ds_read_b64_tr_b16 a[66:67], v1 offset:17408
M v[64:67], a[180:183], a[36:39], v[64:67]
 ds_read_b64_tr_b16 a[68:69], v1 offset:24576
 ds_read_b64_tr_b16 a[70:71], v1 offset:25600
M v[68:71], a[180:183], a[44:47], 0
 buffer_load_dwordx4 v12, s[48:51], s22 offen offset:0   lds
M v[68:71], a[176:179], a[40:43], v[68:71]
 ds_read_b64_tr_b16 a[72:73], v2 offset:16384
 ds_read_b64_tr_b16 a[74:75], v2 offset:17408
M v[72:75], a[176:179], a[48:51], 0
 ds_read_b64_tr_b16 a[76:77], v2 offset:24576
 ds_read_b64_tr_b16 a[78:79], v2 offset:25600
M v[72:75], a[180:183], a[52:55], v[72:75]
 buffer_load_dwordx4 v13, s[48:51], s22 offen offset:1024   lds
M v[76:79], a[180:183], a[60:63], 0
 ds_read_b64_tr_b16 a[80:81], v3 offset:16384
 ds_read_b64_tr_b16 a[82:83], v3 offset:17408
M v[76:79], a[176:179], a[56:59], v[76:79]
 ds_read_b64_tr_b16 a[84:85], v3 offset:24576
 ds_read_b64_tr_b16 a[86:87], v3 offset:25600
M v[96:99], a[184:187], a[32:35], 0
 buffer_load_dwordx4 v14, s[48:51], s22 offen offset:2048   lds
M v[96:99], a[188:191], a[36:39], v[96:99]
 ds_read_b64_tr_b16 a[88:89], v4 offset:16384
 ds_read_b64_tr_b16 a[90:91], v4 offset:17408
M v[100:103], a[188:191], a[44:47], 0
 ds_read_b64_tr_b16 a[92:93], v4 offset:24576
 ds_read_b64_tr_b16 a[94:95], v4 offset:25600
M v[100:103], a[184:187], a[40:43], v[100:103]
 buffer_load_dwordx4 v15, s[48:51], s22 offen offset:3072   lds
M v[104:107], a[184:187], a[48:51], 0
 s_add_u32 s22, s22, 2097152
 v_max3_f32 v20, |v32|, |v33|, |v34|
 v_max3_f32 v20, |v35|, |v36|, v20
M v[104:107], a[188:191], a[52:55], v[104:107]
 v_max3_f32 v20, |v37|, |v38|, v20
 v_max3_f32 v21, |v64|, |v65|, |v66|
M v[108:111], a[188:191], a[60:63], 0
 s_add_u32 m0, s23, 0
 v_max3_f32 v21, |v67|, |v68|, v21
 v_max3_f32 v21, |v69|, |v70|, v21
M v[108:111], a[184:187], a[56:59], v[108:111]
 s_waitcnt lgkmcnt(0)
 v_min_f32 v20, v20, v21
 v_mul_f32 v20, 0x41000000, v20
M a[16:19], a[160:163], a[64:67], 0
 buffer_load_dwordx4 v8, s[16:19], s21 offen offset:0  nt lds
M a[16:19], a[164:167], a[68:71], a[16:19]
 v_mov_b32 v21, v20
 v_mov_b32 v22, v20
M a[20:23], a[164:167], a[76:79], 0
 buffer_load_dwordx4 v9, s[16:19], s21 offen offset:1024  nt lds
M a[20:23], a[160:163], a[72:75], a[20:23]
 v_mov_b32 v23, v20
 v_accvgpr_write_b32 a241, v20
M a[24:27], a[160:163], a[80:83], 0
M a[24:27], a[164:167], a[84:87], a[24:27]
M a[28:31], a[164:167], a[92:95], 0
 buffer_load_dwordx4 v10, s[16:19], s21 offen offset:2048  nt lds
M a[28:31], a[160:163], a[88:91], a[28:31]
M v[48:51], a[168:171], a[64:67], v[20:23]
M v[48:51], a[172:175], a[68:71], v[48:51]
 buffer_load_dwordx4 v11, s[16:19], s21 offen offset:3072  nt lds
M v[52:55], a[172:175], a[76:79], v[20:23]
 s_add_u32 s21, s21, 128
M v[52:55], a[168:171], a[72:75], v[52:55]
M v[56:59], a[168:171], a[80:83], v[20:23]
M v[56:59], a[172:175], a[84:87], v[56:59]
M v[60:63], a[172:175], a[92:95], v[20:23]
 s_waitcnt vmcnt(12)
M v[60:63], a[168:171], a[88:91], v[60:63]
 s_barrier
M v[80:83], a[176:179], a[64:67], v[20:23]
 s_add_u32 m0, s24, 49152
 ds_read_b128 a[160:163], v5 offset:16384
 ds_read_b128 a[164:167], v6 offset:16384
M v[80:83], a[180:183], a[68:71], v[80:83]
 buffer_load_dwordx4 v12, s[48:51], s22 offen offset:0   lds
M v[84:87], a[180:183], a[76:79], v[20:23]
 ds_read_b64_tr_b16 a[96:97], v1 offset:32768
 ds_read_b64_tr_b16 a[98:99], v1 offset:33792
M v[84:87], a[176:179], a[72:75], v[84:87]
M v[88:91], a[176:179], a[80:83], v[20:23]
 buffer_load_dwordx4 v13, s[48:51], s22 offen offset:1024   lds
M v[88:91], a[180:183], a[84:87], v[88:91]
 ds_read_b64_tr_b16 a[100:101], v1 offset:40960
 ds_read_b64_tr_b16 a[102:103], v1 offset:41984
M v[92:95], a[180:183], a[92:95], v[20:23]
M v[92:95], a[176:179], a[88:91], v[92:95]
M v[112:115], a[184:187], a[64:67], v[20:23]
 ds_read_b64_tr_b16 a[104:105], v2 offset:32768
 ds_read_b64_tr_b16 a[106:107], v2 offset:33792
M v[112:115], a[188:191], a[68:71], v[112:115]
 buffer_load_dwordx4 v14, s[48:51], s22 offen offset:2048   lds
M v[116:119], a[188:191], a[76:79], v[20:23]
M v[116:119], a[184:187], a[72:75], v[116:119]
 ds_read_b64_tr_b16 a[108:109], v2 offset:40960
 ds_read_b64_tr_b16 a[110:111], v2 offset:41984
M v[120:123], a[184:187], a[80:83], v[20:23]
 buffer_load_dwordx4 v15, s[48:51], s22 offen offset:3072   lds
M v[120:123], a[188:191], a[84:87], v[120:123]
 s_waitcnt lgkmcnt(8)
M v[124:127], a[188:191], a[92:95], v[20:23]
 s_sub_u32 s22, s22, 2097024
M v[124:127], a[184:187], a[88:91], v[124:127]
 s_add_u32 m0, s23, 16384
 ds_read_b64_tr_b16 a[112:113], v3 offset:32768
 ds_read_b64_tr_b16 a[114:115], v3 offset:33792
M v[128:131], a[160:163], a[32:35], v[20:23]
 ds_read_b128 a[168:171], v5 offset:18432
 ds_read_b128 a[172:175], v6 offset:18432
M v[128:131], a[164:167], a[36:39], v[128:131]
 buffer_load_dwordx4 v8, s[16:19], s21 offen offset:0  nt lds
M v[132:135], a[164:167], a[44:47], v[20:23]
 ds_read_b64_tr_b16 a[116:117], v3 offset:40960
 ds_read_b64_tr_b16 a[118:119], v3 offset:41984
M v[132:135], a[160:163], a[40:43], v[132:135]
 buffer_load_dwordx4 v9, s[16:19], s21 offen offset:1024  nt lds
M v[136:139], a[160:163], a[48:51], v[20:23]
M v[136:139], a[164:167], a[52:55], v[136:139]
 ds_read_b64_tr_b16 a[120:121], v4 offset:32768
 ds_read_b64_tr_b16 a[122:123], v4 offset:33792
M v[140:143], a[164:167], a[60:63], v[20:23]
 buffer_load_dwordx4 v10, s[16:19], s21 offen offset:2048  nt lds
M v[140:143], a[160:163], a[56:59], v[140:143]
M v[144:147], a[160:163], a[64:67], v[20:23]
 ds_read_b64_tr_b16 a[124:125], v4 offset:40960
 ds_read_b64_tr_b16 a[126:127], v4 offset:41984
M v[144:147], a[164:167], a[68:71], v[144:147]
 buffer_load_dwordx4 v11, s[16:19], s21 offen offset:3072  nt lds
M v[148:151], a[164:167], a[76:79], v[20:23]
 s_add_u32 s21, s21, 524160
M v[148:151], a[160:163], a[72:75], v[148:151]
M v[152:155], a[160:163], a[80:83], v[20:23]
M v[152:155], a[164:167], a[84:87], v[152:155]
 s_waitcnt lgkmcnt(6)
M v[156:159], a[164:167], a[92:95], v[20:23]
 s_waitcnt vmcnt(16) lgkmcnt(0)
M v[156:159], a[160:163], a[88:91], v[156:159]
 s_barrier
M v[160:163], a[168:171], a[32:35], v[20:23]
 s_add_u32 m0, s24, 0
 ds_read_b128 a[160:163], v5 offset:20480
 ds_read_b128 a[164:167], v6 offset:20480
M v[160:163], a[172:175], a[36:39], v[160:163]
 buffer_load_dwordx4 v12, s[48:51], s22 offen offset:0   lds
M v[164:167], a[172:175], a[44:47], v[20:23]
 ds_read_b64_tr_b16 a[128:129], v1 offset:49152
 ds_read_b64_tr_b16 a[130:131], v1 offset:50176
M v[164:167], a[168:171], a[40:43], v[164:167]
M v[168:171], a[168:171], a[48:51], v[20:23]
 buffer_load_dwordx4 v13, s[48:51], s22 offen offset:1024   lds
M v[168:171], a[172:175], a[52:55], v[168:171]
 ds_read_b64_tr_b16 a[132:133], v1 offset:57344
 ds_read_b64_tr_b16 a[134:135], v1 offset:58368
M v[172:175], a[172:175], a[60:63], v[20:23]
M v[172:175], a[168:171], a[56:59], v[172:175]
M v[176:179], a[168:171], a[64:67], v[20:23]
 ds_read_b64_tr_b16 a[136:137], v2 offset:49152
 ds_read_b64_tr_b16 a[138:139], v2 offset:50176
M v[176:179], a[172:175], a[68:71], v[176:179]
 buffer_load_dwordx4 v14, s[48:51], s22 offen offset:2048   lds
M v[180:183], a[172:175], a[76:79], v[20:23]
M v[180:183], a[168:171], a[72:75], v[180:183]
 ds_read_b64_tr_b16 a[140:141], v2 offset:57344
 ds_read_b64_tr_b16 a[142:143], v2 offset:58368
M v[184:187], a[168:171], a[80:83], v[20:23]
 buffer_load_dwordx4 v15, s[48:51], s22 offen offset:3072   lds
M v[184:187], a[172:175], a[84:87], v[184:187]
 s_waitcnt lgkmcnt(8)
M v[188:191], a[172:175], a[92:95], v[20:23]
 s_add_u32 s22, s22, 2097152
M v[188:191], a[168:171], a[88:91], v[188:191]
 s_add_u32 m0, s23, 32768
 ds_read_b64_tr_b16 a[144:145], v3 offset:49152
 ds_read_b64_tr_b16 a[146:147], v3 offset:50176
M v[192:195], a[160:163], a[32:35], v[20:23]
 ds_read_b128 a[168:171], v5 offset:22528
 ds_read_b128 a[172:175], v6 offset:22528
M v[192:195], a[164:167], a[36:39], v[192:195]
 buffer_load_dwordx4 v8, s[16:19], s21 offen offset:0  nt lds
M v[196:199], a[164:167], a[44:47], v[20:23]
 ds_read_b64_tr_b16 a[148:149], v3 offset:57344
 ds_read_b64_tr_b16 a[150:151], v3 offset:58368
M v[196:199], a[160:163], a[40:43], v[196:199]
 buffer_load_dwordx4 v9, s[16:19], s21 offen offset:1024  nt lds
M v[200:203], a[160:163], a[48:51], v[20:23]
M v[200:203], a[164:167], a[52:55], v[200:203]
 ds_read_b64_tr_b16 a[152:153], v4 offset:49152
 ds_read_b64_tr_b16 a[154:155], v4 offset:50176
M v[204:207], a[164:167], a[60:63], v[20:23]
 buffer_load_dwordx4 v10, s[16:19], s21 offen offset:2048  nt lds
M v[204:207], a[160:163], a[56:59], v[204:207]
M v[208:211], a[160:163], a[64:67], v[20:23]
 ds_read_b64_tr_b16 a[156:157], v4 offset:57344
 ds_read_b64_tr_b16 a[158:159], v4 offset:58368
M v[208:211], a[164:167], a[68:71], v[208:211]
 buffer_load_dwordx4 v11, s[16:19], s21 offen offset:3072  nt lds
M v[212:215], a[164:167], a[76:79], v[20:23]
 s_add_u32 s21, s21, 128
M v[212:215], a[160:163], a[72:75], v[212:215]
M v[216:219], a[160:163], a[80:83], v[20:23]
M v[216:219], a[164:167], a[84:87], v[216:219]
 s_waitcnt lgkmcnt(6)
M v[220:223], a[164:167], a[92:95], v[20:23]
 s_waitcnt vmcnt(16) lgkmcnt(0)
M v[220:223], a[160:163], a[88:91], v[220:223]
 s_barrier
M v[224:227], a[168:171], a[32:35], v[20:23]
 ds_read_b128 a[160:163], v5 offset:32768
 ds_read_b128 a[164:167], v6 offset:32768
M v[224:227], a[172:175], a[36:39], v[224:227]
 buffer_load_dword a240, v24, s[32:35], 0 offen offset:512
M v[228:231], a[172:175], a[44:47], v[20:23]
M v[228:231], a[168:171], a[40:43], v[228:231]
M v[232:235], a[168:171], a[48:51], v[20:23]
M v[232:235], a[172:175], a[52:55], v[232:235]
M v[236:239], a[172:175], a[60:63], v[20:23]
M v[236:239], a[168:171], a[56:59], v[236:239]
M v[240:243], a[168:171], a[64:67], v[20:23]
M v[240:243], a[172:175], a[68:71], v[240:243]
M v[244:247], a[172:175], a[76:79], v[20:23]
M v[244:247], a[168:171], a[72:75], v[244:247]
M v[248:251], a[168:171], a[80:83], v[20:23]
M v[248:251], a[172:175], a[84:87], v[248:251]
 s_waitcnt lgkmcnt(0)
M v[252:255], a[172:175], a[92:95], v[20:23]
M v[252:255], a[168:171], a[88:91], v[252:255]
M a[0:3], a[160:163], a[96:99], a[0:3]
 ds_read_b128 a[168:171], v5 offset:34816
 ds_read_b128 a[172:175], v6 offset:34816
M a[0:3], a[164:167], a[100:103], a[0:3]
 ds_read_b64_tr_b16 a[32:33], v1 offset:0
 ds_read_b64_tr_b16 a[34:35], v1 offset:1024
M a[4:7], a[164:167], a[108:111], a[4:7]
 s_add_u32 m0, s24, 16384
M a[4:7], a[160:163], a[104:107], a[4:7]
 buffer_load_dwordx4 v12, s[48:51], s22 offen offset:0   lds
M a[8:11], a[160:163], a[112:115], a[8:11]
M a[8:11], a[164:167], a[116:119], a[8:11]
M a[12:15], a[164:167], a[124:127], a[12:15]
 ds_read_b64_tr_b16 a[36:37], v1 offset:8192
 ds_read_b64_tr_b16 a[38:39], v1 offset:9216
M a[12:15], a[160:163], a[120:123], a[12:15]
M a[16:19], a[160:163], a[128:131], a[16:19]
 buffer_load_dwordx4 v13, s[48:51], s22 offen offset:1024   lds
M a[16:19], a[164:167], a[132:135], a[16:19]
M a[20:23], a[164:167], a[140:143], a[20:23]
M a[20:23], a[160:163], a[136:139], a[20:23]
 ds_read_b64_tr_b16 a[40:41], v2 offset:0
 ds_read_b64_tr_b16 a[42:43], v2 offset:1024
M a[24:27], a[160:163], a[144:147], a[24:27]
M a[24:27], a[164:167], a[148:151], a[24:27]
 s_waitcnt lgkmcnt(6)
M a[28:31], a[164:167], a[156:159], a[28:31]
 buffer_load_dwordx4 v14, s[48:51], s22 offen offset:2048   lds
M a[28:31], a[160:163], a[152:155], a[28:31]
M v[60:63], a[168:171], a[152:155], v[60:63]
 ds_read_b128 a[160:163], v5 offset:36864
 ds_read_b128 a[164:167], v6 offset:36864
M v[60:63], a[172:175], a[156:159], v[60:63]
 ds_read_b64_tr_b16 a[44:45], v2 offset:8192
 ds_read_b64_tr_b16 a[46:47], v2 offset:9216
M v[56:59], a[172:175], a[148:151], v[56:59]
 buffer_load_dwordx4 v15, s[48:51], s22 offen offset:3072   lds
M v[56:59], a[168:171], a[144:147], v[56:59]
 s_sub_u32 s22, s22, 2097024
M v[52:55], a[168:171], a[136:139], v[52:55]
M v[52:55], a[172:175], a[140:143], v[52:55]
 ds_read_b64_tr_b16 a[48:49], v3 offset:0
 ds_read_b64_tr_b16 a[50:51], v3 offset:1024
M v[48:51], a[172:175], a[132:135], v[48:51]
 s_add_u32 m0, s23, 49152
M v[48:51], a[168:171], a[128:131], v[48:51]
 buffer_load_dwordx4 v8, s[16:19], s21 offen offset:0  nt lds
M v[44:47], a[168:171], a[120:123], v[44:47]
M v[44:47], a[172:175], a[124:127], v[44:47]
M v[40:43], a[172:175], a[116:119], v[40:43]
 ds_read_b64_tr_b16 a[52:53], v3 offset:8192
 ds_read_b64_tr_b16 a[54:55], v3 offset:9216
M v[40:43], a[168:171], a[112:115], v[40:43]
M v[36:39], a[168:171], a[104:107], v[36:39]
 buffer_load_dwordx4 v9, s[16:19], s21 offen offset:1024  nt lds
M v[36:39], a[172:175], a[108:111], v[36:39]
 s_waitcnt lgkmcnt(6)
M v[32:35], a[172:175], a[100:103], v[32:35]
M v[32:35], a[168:171], a[96:99], v[32:35]
 ds_read_b64_tr_b16 a[56:57], v4 offset:0
 ds_read_b64_tr_b16 a[58:59], v4 offset:1024
M v[64:67], a[160:163], a[96:99], v[64:67]
 ds_read_b128 a[168:171], v5 offset:38912
 ds_read_b128 a[172:175], v6 offset:38912
M v[64:67], a[164:167], a[100:103], v[64:67]
 buffer_load_dwordx4 v10, s[16:19], s21 offen offset:2048  nt lds
M v[68:71], a[164:167], a[108:111], v[68:71]
M v[68:71], a[160:163], a[104:107], v[68:71]
M v[72:75], a[160:163], a[112:115], v[72:75]
 ds_read_b64_tr_b16 a[60:61], v4 offset:8192
 ds_read_b64_tr_b16 a[62:63], v4 offset:9216
M v[72:75], a[164:167], a[116:119], v[72:75]
M v[76:79], a[164:167], a[124:127], v[76:79]
 buffer_load_dwordx4 v11, s[16:19], s21 offen offset:3072  nt lds
M v[76:79], a[160:163], a[120:123], v[76:79]
 s_add_u32 s21, s21, 524160
M v[80:83], a[160:163], a[128:131], v[80:83]
M v[80:83], a[164:167], a[132:135], v[80:83]
M v[84:87], a[164:167], a[140:143], v[84:87]
M v[84:87], a[160:163], a[136:139], v[84:87]
M v[88:91], a[160:163], a[144:147], v[88:91]
M v[88:91], a[164:167], a[148:151], v[88:91]
 s_waitcnt lgkmcnt(2)
M v[92:95], a[164:167], a[156:159], v[92:95]
 s_waitcnt vmcnt(17) lgkmcnt(0)
M v[92:95], a[160:163], a[152:155], v[92:95]
 s_barrier
M v[124:127], a[168:171], a[152:155], v[124:127]
 ds_read_b128 a[160:163], v5 offset:49152
 ds_read_b128 a[164:167], v6 offset:49152
M v[124:127], a[172:175], a[156:159], v[124:127]
M v[120:123], a[172:175], a[148:151], v[120:123]
 s_add_u32 m0, s24, 32768
 ds_read_b64_tr_b16 a[64:65], v1 offset:16384
 ds_read_b64_tr_b16 a[66:67], v1 offset:17408
M v[120:123], a[168:171], a[144:147], v[120:123]
 buffer_load_dwordx4 v12, s[48:51], s22 offen offset:0   lds
M v[116:119], a[168:171], a[136:139], v[116:119]
M v[116:119], a[172:175], a[140:143], v[116:119]
M v[112:115], a[172:175], a[132:135], v[112:115]
M v[112:115], a[168:171], a[128:131], v[112:115]
M v[108:111], a[168:171], a[120:123], v[108:111]
M v[108:111], a[172:175], a[124:127], v[108:111]
 ds_read_b64_tr_b16 a[68:69], v1 offset:24576
 ds_read_b64_tr_b16 a[70:71], v1 offset:25600
M v[104:107], a[172:175], a[116:119], v[104:107]
 buffer_load_dwordx4 v13, s[48:51], s22 offen offset:1024   lds
M v[104:107], a[168:171], a[112:115], v[104:107]
M v[100:103], a[168:171], a[104:107], v[100:103]
M v[100:103], a[172:175], a[108:111], v[100:103]
 s_waitcnt lgkmcnt(4)
M v[96:99], a[172:175], a[100:103], v[96:99]
M v[96:99], a[168:171], a[96:99], v[96:99]
M v[128:131], a[160:163], a[96:99], v[128:131]
 ds_read_b128 a[168:171], v5 offset:51200
 ds_read_b128 a[172:175], v6 offset:51200
M v[128:131], a[164:167], a[100:103], v[128:131]
 ds_read_b64_tr_b16 a[72:73], v2 offset:16384
 ds_read_b64_tr_b16 a[74:75], v2 offset:17408
M v[132:135], a[164:167], a[108:111], v[132:135]
 buffer_load_dwordx4 v14, s[48:51], s22 offen offset:2048   lds
M v[132:135], a[160:163], a[104:107], v[132:135]
M v[136:139], a[160:163], a[112:115], v[136:139]
M v[136:139], a[164:167], a[116:119], v[136:139]
M v[140:143], a[164:167], a[124:127], v[140:143]
M v[140:143], a[160:163], a[120:123], v[140:143]
 ds_read_b64_tr_b16 a[76:77], v2 offset:24576
 ds_read_b64_tr_b16 a[78:79], v2 offset:25600
M v[144:147], a[160:163], a[128:131], v[144:147]
 buffer_load_dwordx4 v15, s[48:51], s22 offen offset:3072   lds
M v[144:147], a[164:167], a[132:135], v[144:147]
 s_add_u32 s22, s22, 2097152
M v[148:151], a[164:167], a[140:143], v[148:151]
M v[148:151], a[160:163], a[136:139], v[148:151]
M v[152:155], a[160:163], a[144:147], v[152:155]
M v[152:155], a[164:167], a[148:151], v[152:155]
 s_waitcnt lgkmcnt(4)
M v[156:159], a[164:167], a[156:159], v[156:159]
 s_add_u32 m0, s23, 0
 ds_read_b64_tr_b16 a[80:81], v3 offset:16384
 ds_read_b64_tr_b16 a[82:83], v3 offset:17408
M v[156:159], a[160:163], a[152:155], v[156:159]
 buffer_load_dwordx4 v8, s[16:19], s21 offen offset:0  nt lds
M v[188:191], a[168:171], a[152:155], v[188:191]
 ds_read_b128 a[160:163], v5 offset:53248
 ds_read_b128 a[164:167], v6 offset:53248
M v[188:191], a[172:175], a[156:159], v[188:191]
M v[184:187], a[172:175], a[148:151], v[184:187]
M v[184:187], a[168:171], a[144:147], v[184:187]
M v[180:183], a[168:171], a[136:139], v[180:183]
M v[180:183], a[172:175], a[140:143], v[180:183]
 ds_read_b64_tr_b16 a[84:85], v3 offset:24576
 ds_read_b64_tr_b16 a[86:87], v3 offset:25600
M v[176:179], a[172:175], a[132:135], v[176:179]
 buffer_load_dwordx4 v9, s[16:19], s21 offen offset:1024  nt lds
M v[176:179], a[168:171], a[128:131], v[176:179]
M v[172:175], a[168:171], a[120:123], v[172:175]
M v[172:175], a[172:175], a[124:127], v[172:175]
M v[168:171], a[172:175], a[116:119], v[168:171]
M v[168:171], a[168:171], a[112:115], v[168:171]
M v[164:167], a[168:171], a[104:107], v[164:167]
 ds_read_b64_tr_b16 a[88:89], v4 offset:16384
 ds_read_b64_tr_b16 a[90:91], v4 offset:17408
M v[164:167], a[172:175], a[108:111], v[164:167]
 s_waitcnt lgkmcnt(4)
M v[160:163], a[172:175], a[100:103], v[160:163]
 buffer_load_dwordx4 v10, s[16:19], s21 offen offset:2048  nt lds
M v[160:163], a[168:171], a[96:99], v[160:163]
M v[192:195], a[160:163], a[96:99], v[192:195]
 ds_read_b128 a[168:171], v5 offset:55296
 ds_read_b128 a[172:175], v6 offset:55296
M v[192:195], a[164:167], a[100:103], v[192:195]
M v[196:199], a[164:167], a[108:111], v[196:199]
M v[196:199], a[160:163], a[104:107], v[196:199]
 ds_read_b64_tr_b16 a[92:93], v4 offset:24576
 ds_read_b64_tr_b16 a[94:95], v4 offset:25600
M v[200:203], a[160:163], a[112:115], v[200:203]
 buffer_load_dwordx4 v11, s[16:19], s21 offen offset:3072  nt lds
M v[200:203], a[164:167], a[116:119], v[200:203]
 s_add_u32 s21, s21, 128
M v[204:207], a[164:167], a[124:127], v[204:207]
M v[204:207], a[160:163], a[120:123], v[204:207]
M v[208:211], a[160:163], a[128:131], v[208:211]
M v[208:211], a[164:167], a[132:135], v[208:211]
M v[212:215], a[164:167], a[140:143], v[212:215]
M v[212:215], a[160:163], a[136:139], v[212:215]
M v[216:219], a[160:163], a[144:147], v[216:219]
M v[216:219], a[164:167], a[148:151], v[216:219]
 s_waitcnt lgkmcnt(2)
M v[220:223], a[164:167], a[156:159], v[220:223]
 s_waitcnt vmcnt(17) lgkmcnt(0)
M v[220:223], a[160:163], a[152:155], v[220:223]
 s_barrier
M v[252:255], a[168:171], a[152:155], v[252:255]
 ds_read_b128 a[160:163], v5 offset:0
 ds_read_b128 a[164:167], v6 offset:0
M v[252:255], a[172:175], a[156:159], v[252:255]
 v_min_u32 v16, 1, v0
 v_lshlrev_b32 v16, 29, v16
M v[248:251], a[172:175], a[148:151], v[248:251]
 v_or_b32 v16, s39, v16
 v_mov_b32 v17, 1
M v[248:251], a[168:171], a[144:147], v[248:251]
M v[244:247], a[168:171], a[136:139], v[244:247]
 buffer_store_dword v17, v16, s[12:15], s38 offen offset:64 sc1
M v[244:247], a[172:175], a[140:143], v[244:247]
M v[240:243], a[172:175], a[132:135], v[240:243]
M v[240:243], a[168:171], a[128:131], v[240:243]
M v[236:239], a[168:171], a[120:123], v[236:239]
M v[236:239], a[172:175], a[124:127], v[236:239]
M v[232:235], a[172:175], a[116:119], v[232:235]
M v[232:235], a[168:171], a[112:115], v[232:235]
M v[228:231], a[168:171], a[104:107], v[228:231]
M v[228:231], a[172:175], a[108:111], v[228:231]
 s_waitcnt lgkmcnt(0)
M v[224:227], a[172:175], a[100:103], v[224:227]
M v[224:227], a[168:171], a[96:99], v[224:227]
M a[0:3], a[160:163], a[32:35], a[0:3]
 ds_read_b128 a[168:171], v5 offset:2048
 ds_read_b128 a[172:175], v6 offset:2048
M a[0:3], a[164:167], a[36:39], a[0:3]
 ds_read_b64_tr_b16 a[96:97], v1 offset:32768
 ds_read_b64_tr_b16 a[98:99], v1 offset:33792
M a[4:7], a[164:167], a[44:47], a[4:7]
 s_add_u32 m0, s24, 49152
M a[4:7], a[160:163], a[40:43], a[4:7]
 buffer_load_dwordx4 v12, s[48:51], s22 offen offset:0   lds
M a[8:11], a[160:163], a[48:51], a[8:11]
 v_and_b32 v20, 31, v0
M a[8:11], a[164:167], a[52:55], a[8:11]
 v_lshlrev_b32 v20, 2, v20
M a[12:15], a[164:167], a[60:63], a[12:15]
 ds_read_b64_tr_b16 a[100:101], v1 offset:40960
 ds_read_b64_tr_b16 a[102:103], v1 offset:41984
M a[12:15], a[160:163], a[56:59], a[12:15]
 v_add_u32 v21, 163584, v20
M a[16:19], a[160:163], a[64:67], a[16:19]
 buffer_load_dwordx4 v13, s[48:51], s22 offen offset:1024   lds
M a[16:19], a[164:167], a[68:71], a[16:19]
 ds_read_b32 v19, v21
M a[20:23], a[164:167], a[76:79], a[20:23]
 ds_read_b32 v21, v21 offset:64
M a[20:23], a[160:163], a[72:75], a[20:23]
 s_min_u32 s64, s20, 1
 ds_read_b64_tr_b16 a[104:105], v2 offset:32768
 ds_read_b64_tr_b16 a[106:107], v2 offset:33792
M a[24:27], a[160:163], a[80:83], a[24:27]
 s_lshl_b32 s64, s64, 29
 v_and_b32 v22, 32, v0
M a[24:27], a[164:167], a[84:87], a[24:27]
 s_waitcnt lgkmcnt(8)
 v_lshl_or_b32 v20, v22, 24, v20
M a[28:31], a[164:167], a[92:95], a[28:31]
 buffer_load_dwordx4 v14, s[48:51], s22 offen offset:2048   lds
M a[28:31], a[160:163], a[88:91], a[28:31]
 v_or_b32 v20, s64, v20
M v[60:63], a[168:171], a[88:91], v[60:63]
 ds_read_b128 a[160:163], v5 offset:4096
 ds_read_b128 a[164:167], v6 offset:4096
M v[60:63], a[172:175], a[92:95], v[60:63]
 ds_read_b64_tr_b16 a[108:109], v2 offset:40960
 ds_read_b64_tr_b16 a[110:111], v2 offset:41984
M v[56:59], a[172:175], a[84:87], v[56:59]
 buffer_load_dwordx4 v15, s[48:51], s22 offen offset:3072   lds
M v[56:59], a[168:171], a[80:83], v[56:59]
 s_sub_u32 s22, s22, 2097024
 v_and_b32 v22, 16, v0
M v[52:55], a[168:171], a[72:75], v[52:55]
 v_lshl_or_b32 v18, v22, 25, v20
M v[52:55], a[172:175], a[76:79], v[52:55]
 s_lshl_b32 s72, s30, 7
 ds_read_b64_tr_b16 a[112:113], v3 offset:32768
 ds_read_b64_tr_b16 a[114:115], v3 offset:33792
M v[48:51], a[172:175], a[68:71], v[48:51]
 s_add_u32 m0, s23, 16384
 s_add_u32 s72, s72, 234881024
M v[48:51], a[168:171], a[64:67], v[48:51]
 buffer_load_dwordx4 v8, s[16:19], s21 offen offset:0  nt lds
M v[44:47], a[168:171], a[56:59], v[44:47]
M v[44:47], a[172:175], a[60:63], v[44:47]
M v[40:43], a[172:175], a[52:55], v[40:43]
 ds_read_b64_tr_b16 a[116:117], v3 offset:40960
 ds_read_b64_tr_b16 a[118:119], v3 offset:41984
M v[40:43], a[168:171], a[48:51], v[40:43]
M v[36:39], a[168:171], a[40:43], v[36:39]
 buffer_load_dwordx4 v9, s[16:19], s21 offen offset:1024  nt lds
M v[36:39], a[172:175], a[44:47], v[36:39]
 s_waitcnt lgkmcnt(6)
M v[32:35], a[172:175], a[36:39], v[32:35]
 buffer_store_dword v21, v20, s[8:11], s72 offen sc1
M v[32:35], a[168:171], a[32:35], v[32:35]
 ds_read_b64_tr_b16 a[120:121], v4 offset:32768
 ds_read_b64_tr_b16 a[122:123], v4 offset:33792
M v[64:67], a[160:163], a[32:35], v[64:67]
 ds_read_b128 a[168:171], v5 offset:6144
 ds_read_b128 a[172:175], v6 offset:6144
M v[64:67], a[164:167], a[36:39], v[64:67]
 buffer_load_dwordx4 v10, s[16:19], s21 offen offset:2048  nt lds
M v[68:71], a[164:167], a[44:47], v[68:71]
M v[68:71], a[160:163], a[40:43], v[68:71]
M v[72:75], a[160:163], a[48:51], v[72:75]
 ds_read_b64_tr_b16 a[124:125], v4 offset:40960
 ds_read_b64_tr_b16 a[126:127], v4 offset:41984
M v[72:75], a[164:167], a[52:55], v[72:75]
M v[76:79], a[164:167], a[60:63], v[76:79]
 buffer_load_dwordx4 v11, s[16:19], s21 offen offset:3072  nt lds
M v[76:79], a[160:163], a[56:59], v[76:79]
 s_add_u32 s21, s21, 524160
M v[80:83], a[160:163], a[64:67], v[80:83]
M v[80:83], a[164:167], a[68:71], v[80:83]
M v[84:87], a[164:167], a[76:79], v[84:87]
M v[84:87], a[160:163], a[72:75], v[84:87]
 s_and_b32 s86, s41, 7
M v[88:91], a[160:163], a[80:83], v[88:91]
 s_mul_i32 s86, s86, 14
 s_lshr_b32 s64, s41, 3
 s_mul_i32 s64, s64, 7
M v[88:91], a[164:167], a[84:87], v[88:91]
 s_waitcnt lgkmcnt(2)
 s_add_u32 s86, s86, s64
 s_min_u32 s64, s42, 6
M v[92:95], a[164:167], a[92:95], v[92:95]
 s_waitcnt vmcnt(18) lgkmcnt(0)
 s_add_u32 s86, s86, s64
 s_sub_u32 s64, 6, s42
M v[92:95], a[160:163], a[88:91], v[92:95]
 s_barrier
M v[124:127], a[168:171], a[88:91], v[124:127]
 ds_read_b128 a[160:163], v5 offset:16384
 ds_read_b128 a[164:167], v6 offset:16384
M v[124:127], a[172:175], a[92:95], v[124:127]
 s_and_b32 s88, s64, 536870912
 s_mul_i32 s87, s20, 7168
M v[120:123], a[172:175], a[84:87], v[120:123]
 s_add_u32 m0, s24, 0
 ds_read_b64_tr_b16 a[128:129], v1 offset:49152
 ds_read_b64_tr_b16 a[130:131], v1 offset:50176
M v[120:123], a[168:171], a[80:83], v[120:123]
 buffer_load_dwordx4 v12, s[48:51], s22 offen offset:0   lds
M v[116:119], a[168:171], a[72:75], v[116:119]
 s_add_u32 s87, s87, 131072
M v[116:119], a[172:175], a[76:79], v[116:119]
 s_cmp_lt_u32 s20, 2
M v[112:115], a[172:175], a[68:71], v[112:115]
 s_cselect_b64 s[72:73], s[80:81], s[82:83]
M v[112:115], a[168:171], a[64:67], v[112:115]
 s_mov_b32 s60, s72
M v[108:111], a[168:171], a[56:59], v[108:111]
 s_and_b32 s61, s73, 0xffff
M v[108:111], a[172:175], a[60:63], v[108:111]
 s_mov_b32 s62, 1605632
 ds_read_b64_tr_b16 a[132:133], v1 offset:57344
 ds_read_b64_tr_b16 a[134:135], v1 offset:58368
M v[104:107], a[172:175], a[52:55], v[104:107]
 buffer_load_dwordx4 v13, s[48:51], s22 offen offset:1024   lds
M v[104:107], a[168:171], a[48:51], v[104:107]
 s_mov_b32 s63, 0x20000
M v[100:103], a[168:171], a[40:43], v[100:103]
 s_mov_b32 s68, s84
 s_and_b32 s69, s85, 0xffff
 s_mov_b32 s70, 1605632
M v[100:103], a[172:175], a[44:47], v[100:103]
 s_waitcnt lgkmcnt(4)
 s_mov_b32 s71, 0x20000
M v[96:99], a[172:175], a[36:39], v[96:99]
 s_lshl_b32 s89, s86, 5
 s_and_b32 s64, s20, 1
 s_mul_i32 s64, s64, 802816
M v[96:99], a[168:171], a[32:35], v[96:99]
 buffer_load_dwordx4 v14, s[48:51], s22 offen offset:2048   lds
M v[128:131], a[160:163], a[32:35], v[128:131]
 ds_read_b128 a[168:171], v5 offset:18432
 ds_read_b128 a[172:175], v6 offset:18432
M v[128:131], a[164:167], a[36:39], v[128:131]
 ds_read_b64_tr_b16 a[136:137], v2 offset:49152
 ds_read_b64_tr_b16 a[138:139], v2 offset:50176
M v[132:135], a[164:167], a[44:47], v[132:135]
 s_add_u32 s89, s89, s64
 v_lshrrev_b32 v28, 1, v0
M v[132:135], a[160:163], a[40:43], v[132:135]
 v_mul_u32_u24 v28, 3584, v28
 v_and_b32 v29, 1, v0
M v[136:139], a[160:163], a[48:51], v[136:139]
 v_lshl_add_u32 v25, v29, 4, v28
 v_or_b32 v25, s88, v25
M v[136:139], a[164:167], a[52:55], v[136:139]
M v[140:143], a[164:167], a[60:63], v[140:143]
 buffer_load_dwordx4 v15, s[48:51], s22 offen offset:3072   lds
M v[140:143], a[160:163], a[56:59], v[140:143]
 s_add_u32 s22, s22, 2097152
 ds_read_b64_tr_b16 a[140:141], v2 offset:57344
 ds_read_b64_tr_b16 a[142:143], v2 offset:58368
M v[144:147], a[160:163], a[64:67], v[144:147]
M v[144:147], a[164:167], a[68:71], v[144:147]
M v[148:151], a[164:167], a[76:79], v[148:151]
M v[148:151], a[160:163], a[72:75], v[148:151]
 s_add_u32 m0, s23, 32768
M v[152:155], a[160:163], a[80:83], v[152:155]
 buffer_load_dwordx4 v8, s[16:19], s21 offen offset:0  nt lds
M v[152:155], a[164:167], a[84:87], v[152:155]
 s_waitcnt lgkmcnt(4)
M v[156:159], a[164:167], a[92:95], v[156:159]
 ds_read_b64_tr_b16 a[144:145], v3 offset:49152
 ds_read_b64_tr_b16 a[146:147], v3 offset:50176
M v[156:159], a[160:163], a[88:91], v[156:159]
M v[188:191], a[168:171], a[88:91], v[188:191]
 ds_read_b128 a[160:163], v5 offset:20480
 ds_read_b128 a[164:167], v6 offset:20480
M v[188:191], a[172:175], a[92:95], v[188:191]
M v[184:187], a[172:175], a[84:87], v[184:187]
 buffer_load_dwordx4 v9, s[16:19], s21 offen offset:1024  nt lds
M v[184:187], a[168:171], a[80:83], v[184:187]
M v[180:183], a[168:171], a[72:75], v[180:183]
M v[180:183], a[172:175], a[76:79], v[180:183]
 ds_read_b64_tr_b16 a[148:149], v3 offset:57344
 ds_read_b64_tr_b16 a[150:151], v3 offset:58368
M v[176:179], a[172:175], a[68:71], v[176:179]
M v[176:179], a[168:171], a[64:67], v[176:179]
M v[172:175], a[168:171], a[56:59], v[172:175]
M v[172:175], a[172:175], a[60:63], v[172:175]
 buffer_load_dwordx4 v10, s[16:19], s21 offen offset:2048  nt lds
M v[168:171], a[172:175], a[52:55], v[168:171]
M v[168:171], a[168:171], a[48:51], v[168:171]
M v[164:167], a[168:171], a[40:43], v[164:167]
 ds_read_b64_tr_b16 a[152:153], v4 offset:49152
 ds_read_b64_tr_b16 a[154:155], v4 offset:50176
M v[164:167], a[172:175], a[44:47], v[164:167]
 s_waitcnt lgkmcnt(4)
M v[160:163], a[172:175], a[36:39], v[160:163]
M v[160:163], a[168:171], a[32:35], v[160:163]
 buffer_load_dwordx4 v11, s[16:19], s21 offen offset:3072  nt lds
M v[192:195], a[160:163], a[32:35], v[192:195]
 s_add_u32 s21, s21, 128
 ds_read_b128 a[168:171], v5 offset:22528
 ds_read_b128 a[172:175], v6 offset:22528
M v[192:195], a[164:167], a[36:39], v[192:195]
M v[196:199], a[164:167], a[44:47], v[196:199]
M v[196:199], a[160:163], a[40:43], v[196:199]
 ds_read_b64_tr_b16 a[156:157], v4 offset:57344
 ds_read_b64_tr_b16 a[158:159], v4 offset:58368
M v[200:203], a[160:163], a[48:51], v[200:203]
 s_add_u32 m0, s87, 0
M v[200:203], a[164:167], a[52:55], v[200:203]
 buffer_load_dwordx4 v25, s[60:63], s89 offen offset:0 nt lds
M v[204:207], a[164:167], a[60:63], v[204:207]
 s_add_u32 s89, s89, 114688
M v[204:207], a[160:163], a[56:59], v[204:207]
M v[208:211], a[160:163], a[64:67], v[208:211]
M v[208:211], a[164:167], a[68:71], v[208:211]
M v[212:215], a[164:167], a[76:79], v[212:215]
M v[212:215], a[160:163], a[72:75], v[212:215]
M v[216:219], a[160:163], a[80:83], v[216:219]
M v[216:219], a[164:167], a[84:87], v[216:219]
 s_waitcnt lgkmcnt(2)
M v[220:223], a[164:167], a[92:95], v[220:223]
 s_waitcnt vmcnt(19) lgkmcnt(0)
M v[220:223], a[160:163], a[88:91], v[220:223]
 s_barrier
M v[252:255], a[168:171], a[88:91], v[252:255]
 ds_read_b128 a[160:163], v5 offset:32768
 ds_read_b128 a[164:167], v6 offset:32768
M v[252:255], a[172:175], a[92:95], v[252:255]
M v[248:251], a[172:175], a[84:87], v[248:251]
M v[248:251], a[168:171], a[80:83], v[248:251]
M v[244:247], a[168:171], a[72:75], v[244:247]
M v[244:247], a[172:175], a[76:79], v[244:247]
M v[240:243], a[172:175], a[68:71], v[240:243]
M v[240:243], a[168:171], a[64:67], v[240:243]
M v[236:239], a[168:171], a[56:59], v[236:239]
M v[236:239], a[172:175], a[60:63], v[236:239]
M v[232:235], a[172:175], a[52:55], v[232:235]
M v[232:235], a[168:171], a[48:51], v[232:235]
M v[228:231], a[168:171], a[40:43], v[228:231]
M v[228:231], a[172:175], a[44:47], v[228:231]
 s_waitcnt lgkmcnt(0)
M v[224:227], a[172:175], a[36:39], v[224:227]
M v[224:227], a[168:171], a[32:35], v[224:227]
M a[0:3], a[160:163], a[96:99], a[0:3]
 ds_read_b128 a[168:171], v5 offset:34816
 ds_read_b128 a[172:175], v6 offset:34816
M a[0:3], a[164:167], a[100:103], a[0:3]
 ds_read_b64_tr_b16 a[32:33], v1 offset:0
 ds_read_b64_tr_b16 a[34:35], v1 offset:1024
M a[4:7], a[164:167], a[108:111], a[4:7]
 s_add_u32 m0, s24, 16384
M a[4:7], a[160:163], a[104:107], a[4:7]
 buffer_load_dwordx4 v12, s[48:51], s22 offen offset:0   lds
M a[8:11], a[160:163], a[112:115], a[8:11]
M a[8:11], a[164:167], a[116:119], a[8:11]
M a[12:15], a[164:167], a[124:127], a[12:15]
 ds_read_b64_tr_b16 a[36:37], v1 offset:8192
 ds_read_b64_tr_b16 a[38:39], v1 offset:9216
M a[12:15], a[160:163], a[120:123], a[12:15]
M a[16:19], a[160:163], a[128:131], a[16:19]
 buffer_load_dwordx4 v13, s[48:51], s22 offen offset:1024   lds
M a[16:19], a[164:167], a[132:135], a[16:19]
M a[20:23], a[164:167], a[140:143], a[20:23]
M a[20:23], a[160:163], a[136:139], a[20:23]
 ds_read_b64_tr_b16 a[40:41], v2 offset:0
 ds_read_b64_tr_b16 a[42:43], v2 offset:1024
M a[24:27], a[160:163], a[144:147], a[24:27]
M a[24:27], a[164:167], a[148:151], a[24:27]
 s_waitcnt lgkmcnt(6)
M a[28:31], a[164:167], a[156:159], a[28:31]
 buffer_load_dwordx4 v14, s[48:51], s22 offen offset:2048   lds
M a[28:31], a[160:163], a[152:155], a[28:31]
M v[60:63], a[168:171], a[152:155], v[60:63]
 ds_read_b128 a[160:163], v5 offset:36864
 ds_read_b128 a[164:167], v6 offset:36864
M v[60:63], a[172:175], a[156:159], v[60:63]
 ds_read_b64_tr_b16 a[44:45], v2 offset:8192
 ds_read_b64_tr_b16 a[46:47], v2 offset:9216
M v[56:59], a[172:175], a[148:151], v[56:59]
 buffer_load_dwordx4 v15, s[48:51], s22 offen offset:3072   lds
M v[56:59], a[168:171], a[144:147], v[56:59]
 s_sub_u32 s22, s22, 2097024
M v[52:55], a[168:171], a[136:139], v[52:55]
M v[52:55], a[172:175], a[140:143], v[52:55]
 ds_read_b64_tr_b16 a[48:49], v3 offset:0
 ds_read_b64_tr_b16 a[50:51], v3 offset:1024
M v[48:51], a[172:175], a[132:135], v[48:51]
 s_add_u32 m0, s23, 49152
M v[48:51], a[168:171], a[128:131], v[48:51]
 buffer_load_dwordx4 v8, s[16:19], s21 offen offset:0  nt lds
M v[44:47], a[168:171], a[120:123], v[44:47]
M v[44:47], a[172:175], a[124:127], v[44:47]
M v[40:43], a[172:175], a[116:119], v[40:43]
 ds_read_b64_tr_b16 a[52:53], v3 offset:8192
 ds_read_b64_tr_b16 a[54:55], v3 offset:9216
M v[40:43], a[168:171], a[112:115], v[40:43]
M v[36:39], a[168:171], a[104:107], v[36:39]
 buffer_load_dwordx4 v9, s[16:19], s21 offen offset:1024  nt lds
M v[36:39], a[172:175], a[108:111], v[36:39]
 s_waitcnt lgkmcnt(6)
M v[32:35], a[172:175], a[100:103], v[32:35]
M v[32:35], a[168:171], a[96:99], v[32:35]
 ds_read_b64_tr_b16 a[56:57], v4 offset:0
 ds_read_b64_tr_b16 a[58:59], v4 offset:1024
M v[64:67], a[160:163], a[96:99], v[64:67]
 ds_read_b128 a[168:171], v5 offset:38912
 ds_read_b128 a[172:175], v6 offset:38912
M v[64:67], a[164:167], a[100:103], v[64:67]
 buffer_load_dwordx4 v10, s[16:19], s21 offen offset:2048  nt lds
M v[68:71], a[164:167], a[108:111], v[68:71]
M v[68:71], a[160:163], a[104:107], v[68:71]
M v[72:75], a[160:163], a[112:115], v[72:75]
 ds_read_b64_tr_b16 a[60:61], v4 offset:8192
 ds_read_b64_tr_b16 a[62:63], v4 offset:9216
M v[72:75], a[164:167], a[116:119], v[72:75]
M v[76:79], a[164:167], a[124:127], v[76:79]
 buffer_load_dwordx4 v11, s[16:19], s21 offen offset:3072  nt lds
M v[76:79], a[160:163], a[120:123], v[76:79]
 s_add_u32 s21, s21, 524160
M v[80:83], a[160:163], a[128:131], v[80:83]
M v[80:83], a[164:167], a[132:135], v[80:83]
M v[84:87], a[164:167], a[140:143], v[84:87]
M v[84:87], a[160:163], a[136:139], v[84:87]
M v[88:91], a[160:163], a[144:147], v[88:91]
M v[88:91], a[164:167], a[148:151], v[88:91]
 s_waitcnt lgkmcnt(2)
M v[92:95], a[164:167], a[156:159], v[92:95]
 s_waitcnt vmcnt(17) lgkmcnt(0)
M v[92:95], a[160:163], a[152:155], v[92:95]
 s_barrier
M v[124:127], a[168:171], a[152:155], v[124:127]
 ds_read_b128 a[160:163], v5 offset:49152
 ds_read_b128 a[164:167], v6 offset:49152
M v[124:127], a[172:175], a[156:159], v[124:127]
M v[120:123], a[172:175], a[148:151], v[120:123]
 s_add_u32 m0, s24, 32768
 ds_read_b64_tr_b16 a[64:65], v1 offset:16384
 ds_read_b64_tr_b16 a[66:67], v1 offset:17408
M v[120:123], a[168:171], a[144:147], v[120:123]
 buffer_load_dwordx4 v12, s[48:51], s22 offen offset:0   lds
M v[116:119], a[168:171], a[136:139], v[116:119]
M v[116:119], a[172:175], a[140:143], v[116:119]
M v[112:115], a[172:175], a[132:135], v[112:115]
M v[112:115], a[168:171], a[128:131], v[112:115]
M v[108:111], a[168:171], a[120:123], v[108:111]
M v[108:111], a[172:175], a[124:127], v[108:111]
 ds_read_b64_tr_b16 a[68:69], v1 offset:24576
 ds_read_b64_tr_b16 a[70:71], v1 offset:25600
M v[104:107], a[172:175], a[116:119], v[104:107]
 buffer_load_dwordx4 v13, s[48:51], s22 offen offset:1024   lds
M v[104:107], a[168:171], a[112:115], v[104:107]
M v[100:103], a[168:171], a[104:107], v[100:103]
M v[100:103], a[172:175], a[108:111], v[100:103]
 s_waitcnt lgkmcnt(4)
M v[96:99], a[172:175], a[100:103], v[96:99]
M v[96:99], a[168:171], a[96:99], v[96:99]
 buffer_load_dwordx4 v14, s[48:51], s22 offen offset:2048   lds
M v[128:131], a[160:163], a[96:99], v[128:131]
 ds_read_b128 a[168:171], v5 offset:51200
 ds_read_b128 a[172:175], v6 offset:51200
M v[128:131], a[164:167], a[100:103], v[128:131]
 ds_read_b64_tr_b16 a[72:73], v2 offset:16384
 ds_read_b64_tr_b16 a[74:75], v2 offset:17408
M v[132:135], a[164:167], a[108:111], v[132:135]
M v[132:135], a[160:163], a[104:107], v[132:135]
M v[136:139], a[160:163], a[112:115], v[136:139]
M v[136:139], a[164:167], a[116:119], v[136:139]
M v[140:143], a[164:167], a[124:127], v[140:143]
 buffer_load_dwordx4 v15, s[48:51], s22 offen offset:3072   lds
M v[140:143], a[160:163], a[120:123], v[140:143]
 s_add_u32 s22, s22, 2097152
 ds_read_b64_tr_b16 a[76:77], v2 offset:24576
 ds_read_b64_tr_b16 a[78:79], v2 offset:25600
M v[144:147], a[160:163], a[128:131], v[144:147]
M v[144:147], a[164:167], a[132:135], v[144:147]
M v[148:151], a[164:167], a[140:143], v[148:151]
M v[148:151], a[160:163], a[136:139], v[148:151]
 s_add_u32 m0, s23, 0
M v[152:155], a[160:163], a[144:147], v[152:155]
 buffer_load_dwordx4 v8, s[16:19], s21 offen offset:0  nt lds
M v[152:155], a[164:167], a[148:151], v[152:155]
 s_waitcnt lgkmcnt(4)
M v[156:159], a[164:167], a[156:159], v[156:159]
 ds_read_b64_tr_b16 a[80:81], v3 offset:16384
 ds_read_b64_tr_b16 a[82:83], v3 offset:17408
M v[156:159], a[160:163], a[152:155], v[156:159]
M v[188:191], a[168:171], a[152:155], v[188:191]
 ds_read_b128 a[160:163], v5 offset:53248
 ds_read_b128 a[164:167], v6 offset:53248
M v[188:191], a[172:175], a[156:159], v[188:191]
M v[184:187], a[172:175], a[148:151], v[184:187]
 buffer_load_dwordx4 v9, s[16:19], s21 offen offset:1024  nt lds
M v[184:187], a[168:171], a[144:147], v[184:187]
M v[180:183], a[168:171], a[136:139], v[180:183]
M v[180:183], a[172:175], a[140:143], v[180:183]
 ds_read_b64_tr_b16 a[84:85], v3 offset:24576
 ds_read_b64_tr_b16 a[86:87], v3 offset:25600
M v[176:179], a[172:175], a[132:135], v[176:179]
M v[176:179], a[168:171], a[128:131], v[176:179]
M v[172:175], a[168:171], a[120:123], v[172:175]
M v[172:175], a[172:175], a[124:127], v[172:175]
 buffer_load_dwordx4 v10, s[16:19], s21 offen offset:2048  nt lds
M v[168:171], a[172:175], a[116:119], v[168:171]
 v_min_u32 v16, 56, v0
 v_lshlrev_b32 v16, 2, v16
M v[168:171], a[168:171], a[112:115], v[168:171]
 buffer_load_dword v17, v16, s[12:15], 0 offen offset:0 sc1
M v[164:167], a[168:171], a[104:107], v[164:167]
 ds_read_b64_tr_b16 a[88:89], v4 offset:16384
 ds_read_b64_tr_b16 a[90:91], v4 offset:17408
M v[164:167], a[172:175], a[108:111], v[164:167]
 s_waitcnt lgkmcnt(4)
M v[160:163], a[172:175], a[100:103], v[160:163]
M v[160:163], a[168:171], a[96:99], v[160:163]
 buffer_load_dwordx4 v11, s[16:19], s21 offen offset:3072  nt lds
M v[192:195], a[160:163], a[96:99], v[192:195]
 s_add_u32 s21, s21, 128
 ds_read_b128 a[168:171], v5 offset:55296
 ds_read_b128 a[172:175], v6 offset:55296
M v[192:195], a[164:167], a[100:103], v[192:195]
M v[196:199], a[164:167], a[108:111], v[196:199]
M v[196:199], a[160:163], a[104:107], v[196:199]
 ds_read_b64_tr_b16 a[92:93], v4 offset:24576
 ds_read_b64_tr_b16 a[94:95], v4 offset:25600
M v[200:203], a[160:163], a[112:115], v[200:203]
 s_add_u32 m0, s87, 1024
M v[200:203], a[164:167], a[116:119], v[200:203]
 buffer_load_dwordx4 v25, s[60:63], s89 offen offset:0 nt lds
M v[204:207], a[164:167], a[124:127], v[204:207]
 s_add_u32 s89, s89, 114688
M v[204:207], a[160:163], a[120:123], v[204:207]
M v[208:211], a[160:163], a[128:131], v[208:211]
M v[208:211], a[164:167], a[132:135], v[208:211]
M v[212:215], a[164:167], a[140:143], v[212:215]
M v[212:215], a[160:163], a[136:139], v[212:215]
M v[216:219], a[160:163], a[144:147], v[216:219]
M v[216:219], a[164:167], a[148:151], v[216:219]
 s_waitcnt lgkmcnt(2)
M v[220:223], a[164:167], a[156:159], v[220:223]
 s_waitcnt vmcnt(19) lgkmcnt(0)
M v[220:223], a[160:163], a[152:155], v[220:223]
 s_barrier
M v[252:255], a[168:171], a[152:155], v[252:255]
 ds_read_b128 a[160:163], v5 offset:0
 ds_read_b128 a[164:167], v6 offset:0
M v[252:255], a[172:175], a[156:159], v[252:255]
M v[248:251], a[172:175], a[148:151], v[248:251]
M v[248:251], a[168:171], a[144:147], v[248:251]
M v[244:247], a[168:171], a[136:139], v[244:247]
M v[244:247], a[172:175], a[140:143], v[244:247]
M v[240:243], a[172:175], a[132:135], v[240:243]
M v[240:243], a[168:171], a[128:131], v[240:243]
M v[236:239], a[168:171], a[120:123], v[236:239]
M v[236:239], a[172:175], a[124:127], v[236:239]
M v[232:235], a[172:175], a[116:119], v[232:235]
M v[232:235], a[168:171], a[112:115], v[232:235]
M v[228:231], a[168:171], a[104:107], v[228:231]
M v[228:231], a[172:175], a[108:111], v[228:231]
 s_waitcnt lgkmcnt(0)
M v[224:227], a[172:175], a[100:103], v[224:227]
M v[224:227], a[168:171], a[96:99], v[224:227]
M a[0:3], a[160:163], a[32:35], a[0:3]
 ds_read_b128 a[168:171], v5 offset:2048
 ds_read_b128 a[172:175], v6 offset:2048
M a[0:3], a[164:167], a[36:39], a[0:3]
 ds_read_b64_tr_b16 a[96:97], v1 offset:32768
 ds_read_b64_tr_b16 a[98:99], v1 offset:33792
M a[4:7], a[164:167], a[44:47], a[4:7]
 s_add_u32 m0, s24, 49152
M a[4:7], a[160:163], a[40:43], a[4:7]
 buffer_load_dwordx4 v12, s[48:51], s22 offen offset:0   lds
M a[8:11], a[160:163], a[48:51], a[8:11]
M a[8:11], a[164:167], a[52:55], a[8:11]
M a[12:15], a[164:167], a[60:63], a[12:15]
 ds_read_b64_tr_b16 a[100:101], v1 offset:40960
 ds_read_b64_tr_b16 a[102:103], v1 offset:41984
M a[12:15], a[160:163], a[56:59], a[12:15]
M a[16:19], a[160:163], a[64:67], a[16:19]
 buffer_load_dwordx4 v13, s[48:51], s22 offen offset:1024   lds
M a[16:19], a[164:167], a[68:71], a[16:19]
M a[20:23], a[164:167], a[76:79], a[20:23]
M a[20:23], a[160:163], a[72:75], a[20:23]
 ds_read_b64_tr_b16 a[104:105], v2 offset:32768
 ds_read_b64_tr_b16 a[106:107], v2 offset:33792
M a[24:27], a[160:163], a[80:83], a[24:27]
M a[24:27], a[164:167], a[84:87], a[24:27]
 s_waitcnt lgkmcnt(6)
M a[28:31], a[164:167], a[92:95], a[28:31]
 buffer_load_dwordx4 v14, s[48:51], s22 offen offset:2048   lds
M a[28:31], a[160:163], a[88:91], a[28:31]
M v[60:63], a[168:171], a[88:91], v[60:63]
 ds_read_b128 a[160:163], v5 offset:4096
 ds_read_b128 a[164:167], v6 offset:4096
M v[60:63], a[172:175], a[92:95], v[60:63]
 ds_read_b64_tr_b16 a[108:109], v2 offset:40960
 ds_read_b64_tr_b16 a[110:111], v2 offset:41984
M v[56:59], a[172:175], a[84:87], v[56:59]
 buffer_load_dwordx4 v15, s[48:51], s22 offen offset:3072   lds
M v[56:59], a[168:171], a[80:83], v[56:59]
 s_sub_u32 s22, s22, 2097024
M v[52:55], a[168:171], a[72:75], v[52:55]
M v[52:55], a[172:175], a[76:79], v[52:55]
 ds_read_b64_tr_b16 a[112:113], v3 offset:32768
 ds_read_b64_tr_b16 a[114:115], v3 offset:33792
M v[48:51], a[172:175], a[68:71], v[48:51]
 s_add_u32 m0, s23, 16384
M v[48:51], a[168:171], a[64:67], v[48:51]
 buffer_load_dwordx4 v8, s[16:19], s21 offen offset:0  nt lds
M v[44:47], a[168:171], a[56:59], v[44:47]
M v[44:47], a[172:175], a[60:63], v[44:47]
M v[40:43], a[172:175], a[52:55], v[40:43]
 ds_read_b64_tr_b16 a[116:117], v3 offset:40960
 ds_read_b64_tr_b16 a[118:119], v3 offset:41984
M v[40:43], a[168:171], a[48:51], v[40:43]
M v[36:39], a[168:171], a[40:43], v[36:39]
 buffer_load_dwordx4 v9, s[16:19], s21 offen offset:1024  nt lds
M v[36:39], a[172:175], a[44:47], v[36:39]
 s_waitcnt lgkmcnt(6)
M v[32:35], a[172:175], a[36:39], v[32:35]
M v[32:35], a[168:171], a[32:35], v[32:35]
 ds_read_b64_tr_b16 a[120:121], v4 offset:32768
 ds_read_b64_tr_b16 a[122:123], v4 offset:33792
M v[64:67], a[160:163], a[32:35], v[64:67]
 ds_read_b128 a[168:171], v5 offset:6144
 ds_read_b128 a[172:175], v6 offset:6144
M v[64:67], a[164:167], a[36:39], v[64:67]
 buffer_load_dwordx4 v10, s[16:19], s21 offen offset:2048  nt lds
M v[68:71], a[164:167], a[44:47], v[68:71]
M v[68:71], a[160:163], a[40:43], v[68:71]
M v[72:75], a[160:163], a[48:51], v[72:75]
 ds_read_b64_tr_b16 a[124:125], v4 offset:40960
 ds_read_b64_tr_b16 a[126:127], v4 offset:41984
M v[72:75], a[164:167], a[52:55], v[72:75]
M v[76:79], a[164:167], a[60:63], v[76:79]
 buffer_load_dwordx4 v11, s[16:19], s21 offen offset:3072  nt lds
M v[76:79], a[160:163], a[56:59], v[76:79]
 s_add_u32 s21, s21, 524160
M v[80:83], a[160:163], a[64:67], v[80:83]
M v[80:83], a[164:167], a[68:71], v[80:83]
M v[84:87], a[164:167], a[76:79], v[84:87]
M v[84:87], a[160:163], a[72:75], v[84:87]
M v[88:91], a[160:163], a[80:83], v[88:91]
M v[88:91], a[164:167], a[84:87], v[88:91]
 s_waitcnt lgkmcnt(2)
M v[92:95], a[164:167], a[92:95], v[92:95]
 s_waitcnt vmcnt(18) lgkmcnt(0)
M v[92:95], a[160:163], a[88:91], v[92:95]
 s_barrier
M v[124:127], a[168:171], a[88:91], v[124:127]
 ds_read_b128 a[160:163], v5 offset:16384
 ds_read_b128 a[164:167], v6 offset:16384
M v[124:127], a[172:175], a[92:95], v[124:127]
M v[120:123], a[172:175], a[84:87], v[120:123]
 s_add_u32 m0, s24, 0
 ds_read_b64_tr_b16 a[128:129], v1 offset:49152
 ds_read_b64_tr_b16 a[130:131], v1 offset:50176
M v[120:123], a[168:171], a[80:83], v[120:123]
 buffer_load_dwordx4 v12, s[48:51], s22 offen offset:0   lds
M v[116:119], a[168:171], a[72:75], v[116:119]
M v[116:119], a[172:175], a[76:79], v[116:119]
M v[112:115], a[172:175], a[68:71], v[112:115]
M v[112:115], a[168:171], a[64:67], v[112:115]
M v[108:111], a[168:171], a[56:59], v[108:111]
M v[108:111], a[172:175], a[60:63], v[108:111]
 ds_read_b64_tr_b16 a[132:133], v1 offset:57344
 ds_read_b64_tr_b16 a[134:135], v1 offset:58368
M v[104:107], a[172:175], a[52:55], v[104:107]
 buffer_load_dwordx4 v13, s[48:51], s22 offen offset:1024   lds
M v[104:107], a[168:171], a[48:51], v[104:107]
M v[100:103], a[168:171], a[40:43], v[100:103]
M v[100:103], a[172:175], a[44:47], v[100:103]
 s_waitcnt lgkmcnt(4)
M v[96:99], a[172:175], a[36:39], v[96:99]
M v[96:99], a[168:171], a[32:35], v[96:99]
 buffer_load_dwordx4 v14, s[48:51], s22 offen offset:2048   lds
M v[128:131], a[160:163], a[32:35], v[128:131]
 ds_read_b128 a[168:171], v5 offset:18432
 ds_read_b128 a[172:175], v6 offset:18432
M v[128:131], a[164:167], a[36:39], v[128:131]
 ds_read_b64_tr_b16 a[136:137], v2 offset:49152
 ds_read_b64_tr_b16 a[138:139], v2 offset:50176
M v[132:135], a[164:167], a[44:47], v[132:135]
M v[132:135], a[160:163], a[40:43], v[132:135]
M v[136:139], a[160:163], a[48:51], v[136:139]
M v[136:139], a[164:167], a[52:55], v[136:139]
M v[140:143], a[164:167], a[60:63], v[140:143]
 buffer_load_dwordx4 v15, s[48:51], s22 offen offset:3072   lds
M v[140:143], a[160:163], a[56:59], v[140:143]
 s_add_u32 s22, s22, 2097152
 ds_read_b64_tr_b16 a[140:141], v2 offset:57344
 ds_read_b64_tr_b16 a[142:143], v2 offset:58368
M v[144:147], a[160:163], a[64:67], v[144:147]
M v[144:147], a[164:167], a[68:71], v[144:147]
M v[148:151], a[164:167], a[76:79], v[148:151]
M v[148:151], a[160:163], a[72:75], v[148:151]
 s_add_u32 m0, s23, 32768
M v[152:155], a[160:163], a[80:83], v[152:155]
 buffer_load_dwordx4 v8, s[16:19], s21 offen offset:0  nt lds
M v[152:155], a[164:167], a[84:87], v[152:155]
 s_waitcnt lgkmcnt(4)
M v[156:159], a[164:167], a[92:95], v[156:159]
 ds_read_b64_tr_b16 a[144:145], v3 offset:49152
 ds_read_b64_tr_b16 a[146:147], v3 offset:50176
M v[156:159], a[160:163], a[88:91], v[156:159]
M v[188:191], a[168:171], a[88:91], v[188:191]
 ds_read_b128 a[160:163], v5 offset:20480
 ds_read_b128 a[164:167], v6 offset:20480
M v[188:191], a[172:175], a[92:95], v[188:191]
M v[184:187], a[172:175], a[84:87], v[184:187]
 buffer_load_dwordx4 v9, s[16:19], s21 offen offset:1024  nt lds
M v[184:187], a[168:171], a[80:83], v[184:187]
M v[180:183], a[168:171], a[72:75], v[180:183]
M v[180:183], a[172:175], a[76:79], v[180:183]
 ds_read_b64_tr_b16 a[148:149], v3 offset:57344
 ds_read_b64_tr_b16 a[150:151], v3 offset:58368
M v[176:179], a[172:175], a[68:71], v[176:179]
M v[176:179], a[168:171], a[64:67], v[176:179]
M v[172:175], a[168:171], a[56:59], v[172:175]
M v[172:175], a[172:175], a[60:63], v[172:175]
 buffer_load_dwordx4 v10, s[16:19], s21 offen offset:2048  nt lds
M v[168:171], a[172:175], a[52:55], v[168:171]
M v[168:171], a[168:171], a[48:51], v[168:171]
M v[164:167], a[168:171], a[40:43], v[164:167]
 ds_read_b64_tr_b16 a[152:153], v4 offset:49152
 ds_read_b64_tr_b16 a[154:155], v4 offset:50176
M v[164:167], a[172:175], a[44:47], v[164:167]
 s_waitcnt lgkmcnt(4)
M v[160:163], a[172:175], a[36:39], v[160:163]
M v[160:163], a[168:171], a[32:35], v[160:163]
 buffer_load_dwordx4 v11, s[16:19], s21 offen offset:3072  nt lds
M v[192:195], a[160:163], a[32:35], v[192:195]
 s_add_u32 s21, s21, 128
 ds_read_b128 a[168:171], v5 offset:22528
 ds_read_b128 a[172:175], v6 offset:22528
M v[192:195], a[164:167], a[36:39], v[192:195]
M v[196:199], a[164:167], a[44:47], v[196:199]
M v[196:199], a[160:163], a[40:43], v[196:199]
 ds_read_b64_tr_b16 a[156:157], v4 offset:57344
 ds_read_b64_tr_b16 a[158:159], v4 offset:58368
M v[200:203], a[160:163], a[48:51], v[200:203]
 s_add_u32 m0, s87, 2048
M v[200:203], a[164:167], a[52:55], v[200:203]
 buffer_load_dwordx4 v25, s[60:63], s89 offen offset:0 nt lds
M v[204:207], a[164:167], a[60:63], v[204:207]
 s_add_u32 s89, s89, 114688
M v[204:207], a[160:163], a[56:59], v[204:207]
M v[208:211], a[160:163], a[64:67], v[208:211]
M v[208:211], a[164:167], a[68:71], v[208:211]
M v[212:215], a[164:167], a[76:79], v[212:215]
M v[212:215], a[160:163], a[72:75], v[212:215]
M v[216:219], a[160:163], a[80:83], v[216:219]
M v[216:219], a[164:167], a[84:87], v[216:219]
 s_waitcnt lgkmcnt(2)
M v[220:223], a[164:167], a[92:95], v[220:223]
 s_waitcnt vmcnt(18) lgkmcnt(0)
M v[220:223], a[160:163], a[88:91], v[220:223]
 s_barrier
M v[252:255], a[168:171], a[88:91], v[252:255]
 ds_read_b128 a[160:163], v5 offset:32768
 ds_read_b128 a[164:167], v6 offset:32768
M v[252:255], a[172:175], a[92:95], v[252:255]
 v_cmp_eq_u32 vcc, 0, v17
M v[248:251], a[172:175], a[84:87], v[248:251]
 s_nop 0
M v[248:251], a[168:171], a[80:83], v[248:251]
 s_cbranch_vccnz L_zs0
L_zr0:
M v[244:247], a[168:171], a[72:75], v[244:247]
 buffer_load_dword a240, v24, s[32:35], 0 offen offset:1024
M v[244:247], a[172:175], a[76:79], v[244:247]
 s_lshl_b32 s72, s30, 6
M v[240:243], a[172:175], a[68:71], v[240:243]
 s_add_u32 s72, s72, 234938368
M v[240:243], a[168:171], a[64:67], v[240:243]
M v[236:239], a[168:171], a[56:59], v[236:239]
 buffer_store_dword v19, v18, s[8:11], s72 offen sc1
M v[236:239], a[172:175], a[60:63], v[236:239]
M v[232:235], a[172:175], a[52:55], v[232:235]
M v[232:235], a[168:171], a[48:51], v[232:235]
M v[228:231], a[168:171], a[40:43], v[228:231]
M v[228:231], a[172:175], a[44:47], v[228:231]
 s_waitcnt lgkmcnt(0)
M v[224:227], a[172:175], a[36:39], v[224:227]
M v[224:227], a[168:171], a[32:35], v[224:227]
M a[0:3], a[160:163], a[96:99], a[0:3]
 ds_read_b128 a[168:171], v5 offset:34816
 ds_read_b128 a[172:175], v6 offset:34816
M a[0:3], a[164:167], a[100:103], a[0:3]
 ds_read_b64_tr_b16 a[32:33], v1 offset:0
 ds_read_b64_tr_b16 a[34:35], v1 offset:1024
M a[4:7], a[164:167], a[108:111], a[4:7]
 s_add_u32 m0, s24, 16384
 v_cmp_le_u32 vcc, 0x40000000, v17
 v_and_b32 v17, 0xffff, v17
M a[4:7], a[160:163], a[104:107], a[4:7]
 buffer_load_dwordx4 v12, s[48:51], s22 offen offset:0   lds
M a[8:11], a[160:163], a[112:115], a[8:11]
 s_nop 0
M a[8:11], a[164:167], a[116:119], a[8:11]
 s_and_b32 s101, vcc_lo, 0xff
 v_add_u32 v17, v17, v17 row_ror:8 row_mask:0xf bank_mask:0xf
 s_nop 1
 v_add_u32 v17, v17, v17 row_ror:4 row_mask:0xf bank_mask:0xf
M a[12:15], a[164:167], a[124:127], a[12:15]
 ds_read_b64_tr_b16 a[36:37], v1 offset:8192
 ds_read_b64_tr_b16 a[38:39], v1 offset:9216
M a[12:15], a[160:163], a[120:123], a[12:15]
 v_add_u32 v17, v17, v17 row_ror:2 row_mask:0xf bank_mask:0xf
 s_nop 1
 v_add_u32 v17, v17, v17 row_ror:1 row_mask:0xf bank_mask:0xf
M a[16:19], a[160:163], a[128:131], a[16:19]
 buffer_load_dwordx4 v13, s[48:51], s22 offen offset:1024   lds
M a[16:19], a[164:167], a[132:135], a[16:19]
 v_cmp_lt_u32 vcc, 262144, v17
M a[20:23], a[164:167], a[140:143], a[20:23]
 s_nop 0
M a[20:23], a[160:163], a[136:139], a[20:23]
 s_nop 0
 ds_read_b64_tr_b16 a[40:41], v2 offset:0
 ds_read_b64_tr_b16 a[42:43], v2 offset:1024
M a[24:27], a[160:163], a[144:147], a[24:27]
 s_and_b32 s92, vcc_lo, 1
 s_mul_i32 s92, s92, 0xff
 s_xor_b32 s101, s101, s92
M a[24:27], a[164:167], a[148:151], a[24:27]
 s_waitcnt lgkmcnt(6)
M a[28:31], a[164:167], a[156:159], a[28:31]
 buffer_load_dwordx4 v14, s[48:51], s22 offen offset:2048   lds
M a[28:31], a[160:163], a[152:155], a[28:31]
M v[60:63], a[168:171], a[152:155], v[60:63]
 ds_read_b128 a[160:163], v5 offset:36864
 ds_read_b128 a[164:167], v6 offset:36864
M v[60:63], a[172:175], a[156:159], v[60:63]
 ds_read_b64_tr_b16 a[44:45], v2 offset:8192
 ds_read_b64_tr_b16 a[46:47], v2 offset:9216
M v[56:59], a[172:175], a[148:151], v[56:59]
 buffer_load_dwordx4 v15, s[48:51], s22 offen offset:3072   lds
M v[56:59], a[168:171], a[144:147], v[56:59]
 s_sub_u32 s22, s22, 2097024
M v[52:55], a[168:171], a[136:139], v[52:55]
M v[52:55], a[172:175], a[140:143], v[52:55]
 ds_read_b64_tr_b16 a[48:49], v3 offset:0
 ds_read_b64_tr_b16 a[50:51], v3 offset:1024
M v[48:51], a[172:175], a[132:135], v[48:51]
 s_add_u32 m0, s23, 49152
M v[48:51], a[168:171], a[128:131], v[48:51]
 buffer_load_dwordx4 v8, s[16:19], s21 offen offset:0  nt lds
M v[44:47], a[168:171], a[120:123], v[44:47]
M v[44:47], a[172:175], a[124:127], v[44:47]
M v[40:43], a[172:175], a[116:119], v[40:43]
 ds_read_b64_tr_b16 a[52:53], v3 offset:8192
 ds_read_b64_tr_b16 a[54:55], v3 offset:9216
M v[40:43], a[168:171], a[112:115], v[40:43]
M v[36:39], a[168:171], a[104:107], v[36:39]
 buffer_load_dwordx4 v9, s[16:19], s21 offen offset:1024  nt lds
M v[36:39], a[172:175], a[108:111], v[36:39]
 s_waitcnt lgkmcnt(6)
M v[32:35], a[172:175], a[100:103], v[32:35]
M v[32:35], a[168:171], a[96:99], v[32:35]
 ds_read_b64_tr_b16 a[56:57], v4 offset:0
 ds_read_b64_tr_b16 a[58:59], v4 offset:1024
M v[64:67], a[160:163], a[96:99], v[64:67]
 ds_read_b128 a[168:171], v5 offset:38912
 ds_read_b128 a[172:175], v6 offset:38912
M v[64:67], a[164:167], a[100:103], v[64:67]
 buffer_load_dwordx4 v10, s[16:19], s21 offen offset:2048  nt lds
M v[68:71], a[164:167], a[108:111], v[68:71]
M v[68:71], a[160:163], a[104:107], v[68:71]
M v[72:75], a[160:163], a[112:115], v[72:75]
 ds_read_b64_tr_b16 a[60:61], v4 offset:8192
 ds_read_b64_tr_b16 a[62:63], v4 offset:9216
M v[72:75], a[164:167], a[116:119], v[72:75]
M v[76:79], a[164:167], a[124:127], v[76:79]
 buffer_load_dwordx4 v11, s[16:19], s21 offen offset:3072  nt lds
M v[76:79], a[160:163], a[120:123], v[76:79]
 s_add_u32 s21, s21, 524160
M v[80:83], a[160:163], a[128:131], v[80:83]
M v[80:83], a[164:167], a[132:135], v[80:83]
M v[84:87], a[164:167], a[140:143], v[84:87]
M v[84:87], a[160:163], a[136:139], v[84:87]
M v[88:91], a[160:163], a[144:147], v[88:91]
M v[88:91], a[164:167], a[148:151], v[88:91]
 s_waitcnt lgkmcnt(2)
M v[92:95], a[164:167], a[156:159], v[92:95]
 s_waitcnt vmcnt(19) lgkmcnt(0)
M v[92:95], a[160:163], a[152:155], v[92:95]
 s_barrier
M v[124:127], a[168:171], a[152:155], v[124:127]
 ds_read_b128 a[160:163], v5 offset:49152
 ds_read_b128 a[164:167], v6 offset:49152
M v[124:127], a[172:175], a[156:159], v[124:127]
M v[120:123], a[172:175], a[148:151], v[120:123]
 s_add_u32 m0, s24, 32768
 ds_read_b64_tr_b16 a[64:65], v1 offset:16384
 ds_read_b64_tr_b16 a[66:67], v1 offset:17408
M v[120:123], a[168:171], a[144:147], v[120:123]
 buffer_load_dwordx4 v12, s[48:51], s22 offen offset:0   lds
M v[116:119], a[168:171], a[136:139], v[116:119]
M v[116:119], a[172:175], a[140:143], v[116:119]
M v[112:115], a[172:175], a[132:135], v[112:115]
M v[112:115], a[168:171], a[128:131], v[112:115]
M v[108:111], a[168:171], a[120:123], v[108:111]
M v[108:111], a[172:175], a[124:127], v[108:111]
 ds_read_b64_tr_b16 a[68:69], v1 offset:24576
 ds_read_b64_tr_b16 a[70:71], v1 offset:25600
M v[104:107], a[172:175], a[116:119], v[104:107]
 buffer_load_dwordx4 v13, s[48:51], s22 offen offset:1024   lds
M v[104:107], a[168:171], a[112:115], v[104:107]
M v[100:103], a[168:171], a[104:107], v[100:103]
M v[100:103], a[172:175], a[108:111], v[100:103]
 s_waitcnt lgkmcnt(4)
M v[96:99], a[172:175], a[100:103], v[96:99]
M v[96:99], a[168:171], a[96:99], v[96:99]
 buffer_load_dwordx4 v14, s[48:51], s22 offen offset:2048   lds
M v[128:131], a[160:163], a[96:99], v[128:131]
 ds_read_b128 a[168:171], v5 offset:51200
 ds_read_b128 a[172:175], v6 offset:51200
M v[128:131], a[164:167], a[100:103], v[128:131]
 ds_read_b64_tr_b16 a[72:73], v2 offset:16384
 ds_read_b64_tr_b16 a[74:75], v2 offset:17408
M v[132:135], a[164:167], a[108:111], v[132:135]
M v[132:135], a[160:163], a[104:107], v[132:135]
M v[136:139], a[160:163], a[112:115], v[136:139]
M v[136:139], a[164:167], a[116:119], v[136:139]
M v[140:143], a[164:167], a[124:127], v[140:143]
 buffer_load_dwordx4 v15, s[48:51], s22 offen offset:3072   lds
M v[140:143], a[160:163], a[120:123], v[140:143]
 s_add_u32 s22, s22, 2097152
 ds_read_b64_tr_b16 a[76:77], v2 offset:24576
 ds_read_b64_tr_b16 a[78:79], v2 offset:25600
M v[144:147], a[160:163], a[128:131], v[144:147]
M v[144:147], a[164:167], a[132:135], v[144:147]
M v[148:151], a[164:167], a[140:143], v[148:151]
M v[148:151], a[160:163], a[136:139], v[148:151]
 s_add_u32 m0, s23, 0
M v[152:155], a[160:163], a[144:147], v[152:155]
 buffer_load_dwordx4 v8, s[16:19], s21 offen offset:0  nt lds
M v[152:155], a[164:167], a[148:151], v[152:155]
 s_waitcnt lgkmcnt(4)
M v[156:159], a[164:167], a[156:159], v[156:159]
 ds_read_b64_tr_b16 a[80:81], v3 offset:16384
 ds_read_b64_tr_b16 a[82:83], v3 offset:17408
M v[156:159], a[160:163], a[152:155], v[156:159]
M v[188:191], a[168:171], a[152:155], v[188:191]
 ds_read_b128 a[160:163], v5 offset:53248
 ds_read_b128 a[164:167], v6 offset:53248
M v[188:191], a[172:175], a[156:159], v[188:191]
M v[184:187], a[172:175], a[148:151], v[184:187]
 buffer_load_dwordx4 v9, s[16:19], s21 offen offset:1024  nt lds
M v[184:187], a[168:171], a[144:147], v[184:187]
M v[180:183], a[168:171], a[136:139], v[180:183]
M v[180:183], a[172:175], a[140:143], v[180:183]
 ds_read_b64_tr_b16 a[84:85], v3 offset:24576
 ds_read_b64_tr_b16 a[86:87], v3 offset:25600
M v[176:179], a[172:175], a[132:135], v[176:179]
M v[176:179], a[168:171], a[128:131], v[176:179]
M v[172:175], a[168:171], a[120:123], v[172:175]
M v[172:175], a[172:175], a[124:127], v[172:175]
 buffer_load_dwordx4 v10, s[16:19], s21 offen offset:2048  nt lds
M v[168:171], a[172:175], a[116:119], v[168:171]
M v[168:171], a[168:171], a[112:115], v[168:171]
M v[164:167], a[168:171], a[104:107], v[164:167]
 ds_read_b64_tr_b16 a[88:89], v4 offset:16384
 ds_read_b64_tr_b16 a[90:91], v4 offset:17408
M v[164:167], a[172:175], a[108:111], v[164:167]
 s_waitcnt lgkmcnt(4)
M v[160:163], a[172:175], a[100:103], v[160:163]
M v[160:163], a[168:171], a[96:99], v[160:163]
 buffer_load_dwordx4 v11, s[16:19], s21 offen offset:3072  nt lds
M v[192:195], a[160:163], a[96:99], v[192:195]
 s_add_u32 s21, s21, 128
 ds_read_b128 a[168:171], v5 offset:55296
 ds_read_b128 a[172:175], v6 offset:55296
M v[192:195], a[164:167], a[100:103], v[192:195]
M v[196:199], a[164:167], a[108:111], v[196:199]
M v[196:199], a[160:163], a[104:107], v[196:199]
 ds_read_b64_tr_b16 a[92:93], v4 offset:24576
 ds_read_b64_tr_b16 a[94:95], v4 offset:25600
M v[200:203], a[160:163], a[112:115], v[200:203]
 s_add_u32 m0, s87, 3072
M v[200:203], a[164:167], a[116:119], v[200:203]
 buffer_load_dwordx4 v25, s[60:63], s89 offen offset:0 nt lds
M v[204:207], a[164:167], a[124:127], v[204:207]
 s_add_u32 s89, s89, 114688
M v[204:207], a[160:163], a[120:123], v[204:207]
M v[208:211], a[160:163], a[128:131], v[208:211]
M v[208:211], a[164:167], a[132:135], v[208:211]
M v[212:215], a[164:167], a[140:143], v[212:215]
M v[212:215], a[160:163], a[136:139], v[212:215]
M v[216:219], a[160:163], a[144:147], v[216:219]
M v[216:219], a[164:167], a[148:151], v[216:219]
 s_waitcnt lgkmcnt(2)
M v[220:223], a[164:167], a[156:159], v[220:223]
 s_waitcnt vmcnt(20) lgkmcnt(0)
M v[220:223], a[160:163], a[152:155], v[220:223]
 s_barrier
M v[252:255], a[168:171], a[152:155], v[252:255]
 ds_read_b128 a[160:163], v5 offset:0
 ds_read_b128 a[164:167], v6 offset:0
M v[252:255], a[172:175], a[156:159], v[252:255]
M v[248:251], a[172:175], a[148:151], v[248:251]
M v[248:251], a[168:171], a[144:147], v[248:251]
M v[244:247], a[168:171], a[136:139], v[244:247]
M v[244:247], a[172:175], a[140:143], v[244:247]
M v[240:243], a[172:175], a[132:135], v[240:243]
M v[240:243], a[168:171], a[128:131], v[240:243]
M v[236:239], a[168:171], a[120:123], v[236:239]
M v[236:239], a[172:175], a[124:127], v[236:239]
M v[232:235], a[172:175], a[116:119], v[232:235]
M v[232:235], a[168:171], a[112:115], v[232:235]
M v[228:231], a[168:171], a[104:107], v[228:231]
M v[228:231], a[172:175], a[108:111], v[228:231]
 s_waitcnt lgkmcnt(0)
M v[224:227], a[172:175], a[100:103], v[224:227]
M v[224:227], a[168:171], a[96:99], v[224:227]
M a[0:3], a[160:163], a[32:35], a[0:3]
 ds_read_b128 a[168:171], v5 offset:2048
 ds_read_b128 a[172:175], v6 offset:2048
M a[0:3], a[164:167], a[36:39], a[0:3]
 ds_read_b64_tr_b16 a[96:97], v1 offset:32768
 ds_read_b64_tr_b16 a[98:99], v1 offset:33792
M a[4:7], a[164:167], a[44:47], a[4:7]
 s_add_u32 m0, s24, 49152
M a[4:7], a[160:163], a[40:43], a[4:7]
 buffer_load_dwordx4 v12, s[48:51], s22 offen offset:0   lds
M a[8:11], a[160:163], a[48:51], a[8:11]
M a[8:11], a[164:167], a[52:55], a[8:11]
M a[12:15], a[164:167], a[60:63], a[12:15]
 ds_read_b64_tr_b16 a[100:101], v1 offset:40960
 ds_read_b64_tr_b16 a[102:103], v1 offset:41984
M a[12:15], a[160:163], a[56:59], a[12:15]
M a[16:19], a[160:163], a[64:67], a[16:19]
 buffer_load_dwordx4 v13, s[48:51], s22 offen offset:1024   lds
M a[16:19], a[164:167], a[68:71], a[16:19]
M a[20:23], a[164:167], a[76:79], a[20:23]
M a[20:23], a[160:163], a[72:75], a[20:23]
 ds_read_b64_tr_b16 a[104:105], v2 offset:32768
 ds_read_b64_tr_b16 a[106:107], v2 offset:33792
M a[24:27], a[160:163], a[80:83], a[24:27]
M a[24:27], a[164:167], a[84:87], a[24:27]
 s_waitcnt lgkmcnt(6)
M a[28:31], a[164:167], a[92:95], a[28:31]
 buffer_load_dwordx4 v14, s[48:51], s22 offen offset:2048   lds
M a[28:31], a[160:163], a[88:91], a[28:31]
M v[60:63], a[168:171], a[88:91], v[60:63]
 ds_read_b128 a[160:163], v5 offset:4096
 ds_read_b128 a[164:167], v6 offset:4096
M v[60:63], a[172:175], a[92:95], v[60:63]
 ds_read_b64_tr_b16 a[108:109], v2 offset:40960
 ds_read_b64_tr_b16 a[110:111], v2 offset:41984
M v[56:59], a[172:175], a[84:87], v[56:59]
 buffer_load_dwordx4 v15, s[48:51], s22 offen offset:3072   lds
M v[56:59], a[168:171], a[80:83], v[56:59]
 s_sub_u32 s22, s22, 2097024
M v[52:55], a[168:171], a[72:75], v[52:55]
M v[52:55], a[172:175], a[76:79], v[52:55]
 ds_read_b64_tr_b16 a[112:113], v3 offset:32768
 ds_read_b64_tr_b16 a[114:115], v3 offset:33792
M v[48:51], a[172:175], a[68:71], v[48:51]
 s_add_u32 m0, s23, 16384
M v[48:51], a[168:171], a[64:67], v[48:51]
 buffer_load_dwordx4 v8, s[16:19], s21 offen offset:0  nt lds
M v[44:47], a[168:171], a[56:59], v[44:47]
M v[44:47], a[172:175], a[60:63], v[44:47]
M v[40:43], a[172:175], a[52:55], v[40:43]
 ds_read_b64_tr_b16 a[116:117], v3 offset:40960
 ds_read_b64_tr_b16 a[118:119], v3 offset:41984
M v[40:43], a[168:171], a[48:51], v[40:43]
M v[36:39], a[168:171], a[40:43], v[36:39]
 buffer_load_dwordx4 v9, s[16:19], s21 offen offset:1024  nt lds
M v[36:39], a[172:175], a[44:47], v[36:39]
 s_waitcnt lgkmcnt(6)
M v[32:35], a[172:175], a[36:39], v[32:35]
M v[32:35], a[168:171], a[32:35], v[32:35]
 ds_read_b64_tr_b16 a[120:121], v4 offset:32768
 ds_read_b64_tr_b16 a[122:123], v4 offset:33792
M v[64:67], a[160:163], a[32:35], v[64:67]
 ds_read_b128 a[168:171], v5 offset:6144
 ds_read_b128 a[172:175], v6 offset:6144
M v[64:67], a[164:167], a[36:39], v[64:67]
 buffer_load_dwordx4 v10, s[16:19], s21 offen offset:2048  nt lds
M v[68:71], a[164:167], a[44:47], v[68:71]
M v[68:71], a[160:163], a[40:43], v[68:71]
M v[72:75], a[160:163], a[48:51], v[72:75]
 ds_read_b64_tr_b16 a[124:125], v4 offset:40960
 ds_read_b64_tr_b16 a[126:127], v4 offset:41984
M v[72:75], a[164:167], a[52:55], v[72:75]
M v[76:79], a[164:167], a[60:63], v[76:79]
 buffer_load_dwordx4 v11, s[16:19], s21 offen offset:3072  nt lds
M v[76:79], a[160:163], a[56:59], v[76:79]
 s_add_u32 s21, s21, 524160
M v[80:83], a[160:163], a[64:67], v[80:83]
M v[80:83], a[164:167], a[68:71], v[80:83]
M v[84:87], a[164:167], a[76:79], v[84:87]
M v[84:87], a[160:163], a[72:75], v[84:87]
M v[88:91], a[160:163], a[80:83], v[88:91]
M v[88:91], a[164:167], a[84:87], v[88:91]
 s_waitcnt lgkmcnt(2)
M v[92:95], a[164:167], a[92:95], v[92:95]
 s_waitcnt vmcnt(17) lgkmcnt(0)
M v[92:95], a[160:163], a[88:91], v[92:95]
 s_barrier
M v[124:127], a[168:171], a[88:91], v[124:127]
 ds_read_b128 a[160:163], v5 offset:16384
 ds_read_b128 a[164:167], v6 offset:16384
M v[124:127], a[172:175], a[92:95], v[124:127]
M v[120:123], a[172:175], a[84:87], v[120:123]
 s_add_u32 m0, s24, 0
 ds_read_b64_tr_b16 a[128:129], v1 offset:49152
 ds_read_b64_tr_b16 a[130:131], v1 offset:50176
M v[120:123], a[168:171], a[80:83], v[120:123]
 buffer_load_dwordx4 v12, s[48:51], s22 offen offset:0   lds
M v[116:119], a[168:171], a[72:75], v[116:119]
M v[116:119], a[172:175], a[76:79], v[116:119]
M v[112:115], a[172:175], a[68:71], v[112:115]
M v[112:115], a[168:171], a[64:67], v[112:115]
M v[108:111], a[168:171], a[56:59], v[108:111]
M v[108:111], a[172:175], a[60:63], v[108:111]
 ds_read_b64_tr_b16 a[132:133], v1 offset:57344
 ds_read_b64_tr_b16 a[134:135], v1 offset:58368
M v[104:107], a[172:175], a[52:55], v[104:107]
 buffer_load_dwordx4 v13, s[48:51], s22 offen offset:1024   lds
M v[104:107], a[168:171], a[48:51], v[104:107]
M v[100:103], a[168:171], a[40:43], v[100:103]
M v[100:103], a[172:175], a[44:47], v[100:103]
 s_waitcnt lgkmcnt(4)
M v[96:99], a[172:175], a[36:39], v[96:99]
M v[96:99], a[168:171], a[32:35], v[96:99]
 buffer_load_dwordx4 v14, s[48:51], s22 offen offset:2048   lds
M v[128:131], a[160:163], a[32:35], v[128:131]
 ds_read_b128 a[168:171], v5 offset:18432
 ds_read_b128 a[172:175], v6 offset:18432
M v[128:131], a[164:167], a[36:39], v[128:131]
 ds_read_b64_tr_b16 a[136:137], v2 offset:49152
 ds_read_b64_tr_b16 a[138:139], v2 offset:50176
M v[132:135], a[164:167], a[44:47], v[132:135]
M v[132:135], a[160:163], a[40:43], v[132:135]
M v[136:139], a[160:163], a[48:51], v[136:139]
M v[136:139], a[164:167], a[52:55], v[136:139]
M v[140:143], a[164:167], a[60:63], v[140:143]
 buffer_load_dwordx4 v15, s[48:51], s22 offen offset:3072   lds
M v[140:143], a[160:163], a[56:59], v[140:143]
 s_add_u32 s22, s22, 2097152
 ds_read_b64_tr_b16 a[140:141], v2 offset:57344
 ds_read_b64_tr_b16 a[142:143], v2 offset:58368
M v[144:147], a[160:163], a[64:67], v[144:147]
M v[144:147], a[164:167], a[68:71], v[144:147]
M v[148:151], a[164:167], a[76:79], v[148:151]
M v[148:151], a[160:163], a[72:75], v[148:151]
 s_add_u32 m0, s23, 32768
M v[152:155], a[160:163], a[80:83], v[152:155]
 buffer_load_dwordx4 v8, s[16:19], s21 offen offset:0  nt lds
M v[152:155], a[164:167], a[84:87], v[152:155]
 s_waitcnt lgkmcnt(4)
M v[156:159], a[164:167], a[92:95], v[156:159]
 ds_read_b64_tr_b16 a[144:145], v3 offset:49152
 ds_read_b64_tr_b16 a[146:147], v3 offset:50176
M v[156:159], a[160:163], a[88:91], v[156:159]
M v[188:191], a[168:171], a[88:91], v[188:191]
 ds_read_b128 a[160:163], v5 offset:20480
 ds_read_b128 a[164:167], v6 offset:20480
M v[188:191], a[172:175], a[92:95], v[188:191]
M v[184:187], a[172:175], a[84:87], v[184:187]
 buffer_load_dwordx4 v9, s[16:19], s21 offen offset:1024  nt lds
M v[184:187], a[168:171], a[80:83], v[184:187]
M v[180:183], a[168:171], a[72:75], v[180:183]
M v[180:183], a[172:175], a[76:79], v[180:183]
 ds_read_b64_tr_b16 a[148:149], v3 offset:57344
 ds_read_b64_tr_b16 a[150:151], v3 offset:58368
M v[176:179], a[172:175], a[68:71], v[176:179]
M v[176:179], a[168:171], a[64:67], v[176:179]
M v[172:175], a[168:171], a[56:59], v[172:175]
M v[172:175], a[172:175], a[60:63], v[172:175]
 buffer_load_dwordx4 v10, s[16:19], s21 offen offset:2048  nt lds
M v[168:171], a[172:175], a[52:55], v[168:171]
M v[168:171], a[168:171], a[48:51], v[168:171]
M v[164:167], a[168:171], a[40:43], v[164:167]
 ds_read_b64_tr_b16 a[152:153], v4 offset:49152
 ds_read_b64_tr_b16 a[154:155], v4 offset:50176
M v[164:167], a[172:175], a[44:47], v[164:167]
 s_waitcnt lgkmcnt(4)
M v[160:163], a[172:175], a[36:39], v[160:163]
M v[160:163], a[168:171], a[32:35], v[160:163]
 buffer_load_dwordx4 v11, s[16:19], s21 offen offset:3072  nt lds
M v[192:195], a[160:163], a[32:35], v[192:195]
 s_add_u32 s21, s21, 128
 ds_read_b128 a[168:171], v5 offset:22528
 ds_read_b128 a[172:175], v6 offset:22528
M v[192:195], a[164:167], a[36:39], v[192:195]
M v[196:199], a[164:167], a[44:47], v[196:199]
M v[196:199], a[160:163], a[40:43], v[196:199]
 ds_read_b64_tr_b16 a[156:157], v4 offset:57344
 ds_read_b64_tr_b16 a[158:159], v4 offset:58368
M v[200:203], a[160:163], a[48:51], v[200:203]
 s_add_u32 m0, s87, 4096
M v[200:203], a[164:167], a[52:55], v[200:203]
 buffer_load_dwordx4 v25, s[60:63], s89 offen offset:0 nt lds
M v[204:207], a[164:167], a[60:63], v[204:207]
 s_add_u32 s89, s89, 114688
M v[204:207], a[160:163], a[56:59], v[204:207]
M v[208:211], a[160:163], a[64:67], v[208:211]
M v[208:211], a[164:167], a[68:71], v[208:211]
M v[212:215], a[164:167], a[76:79], v[212:215]
M v[212:215], a[160:163], a[72:75], v[212:215]
M v[216:219], a[160:163], a[80:83], v[216:219]
M v[216:219], a[164:167], a[84:87], v[216:219]
 s_waitcnt lgkmcnt(2)
M v[220:223], a[164:167], a[92:95], v[220:223]
 s_waitcnt vmcnt(18) lgkmcnt(0)
M v[220:223], a[160:163], a[88:91], v[220:223]
 s_barrier
M v[252:255], a[168:171], a[88:91], v[252:255]
 ds_read_b128 a[160:163], v5 offset:32768
 ds_read_b128 a[164:167], v6 offset:32768
M v[252:255], a[172:175], a[92:95], v[252:255]
 v_and_b32 v26, 48, v0
 v_lshlrev_b32 v26, 17, v26
M v[248:251], a[172:175], a[84:87], v[248:251]
 v_or_b32 v26, v26, v0
 v_lshl_add_u32 v26, v26, 7, s95
M v[248:251], a[168:171], a[80:83], v[248:251]
 buffer_load_dword a240, v26, s[76:79], 0 offen offset:0
M v[244:247], a[168:171], a[72:75], v[244:247]
M v[244:247], a[172:175], a[76:79], v[244:247]
M v[240:243], a[172:175], a[68:71], v[240:243]
M v[240:243], a[168:171], a[64:67], v[240:243]
M v[236:239], a[168:171], a[56:59], v[236:239]
M v[236:239], a[172:175], a[60:63], v[236:239]
M v[232:235], a[172:175], a[52:55], v[232:235]
M v[232:235], a[168:171], a[48:51], v[232:235]
M v[228:231], a[168:171], a[40:43], v[228:231]
M v[228:231], a[172:175], a[44:47], v[228:231]
 s_waitcnt lgkmcnt(0)
M v[224:227], a[172:175], a[36:39], v[224:227]
M v[224:227], a[168:171], a[32:35], v[224:227]
M a[0:3], a[160:163], a[96:99], a[0:3]
 ds_read_b128 a[168:171], v5 offset:34816
 ds_read_b128 a[172:175], v6 offset:34816
M a[0:3], a[164:167], a[100:103], a[0:3]
 ds_read_b64_tr_b16 a[32:33], v1 offset:0
 ds_read_b64_tr_b16 a[34:35], v1 offset:1024
M a[4:7], a[164:167], a[108:111], a[4:7]
 s_add_u32 m0, s24, 16384
M a[4:7], a[160:163], a[104:107], a[4:7]
 buffer_load_dwordx4 v12, s[48:51], s22 offen offset:0   lds
M a[8:11], a[160:163], a[112:115], a[8:11]
M a[8:11], a[164:167], a[116:119], a[8:11]
 s_lshl_b32 s67, s20, 11
M a[12:15], a[164:167], a[124:127], a[12:15]
 s_add_u32 s67, s67, 234938368
 ds_read_b64_tr_b16 a[36:37], v1 offset:8192
 ds_read_b64_tr_b16 a[38:39], v1 offset:9216
M a[12:15], a[160:163], a[120:123], a[12:15]
M a[16:19], a[160:163], a[128:131], a[16:19]
 buffer_load_dwordx4 v13, s[48:51], s22 offen offset:1024   lds
M a[16:19], a[164:167], a[132:135], a[16:19]
M a[20:23], a[164:167], a[140:143], a[20:23]
 buffer_load_dwordx4 v[16:19], v7, s[8:11], s67 offen offset:0 sc1
M a[20:23], a[160:163], a[136:139], a[20:23]
 ds_read_b64_tr_b16 a[40:41], v2 offset:0
 ds_read_b64_tr_b16 a[42:43], v2 offset:1024
M a[24:27], a[160:163], a[144:147], a[24:27]
 buffer_load_dwordx4 v[20:23], v7, s[8:11], s67 offen offset:1024 sc1
M a[24:27], a[164:167], a[148:151], a[24:27]
 s_waitcnt lgkmcnt(6)
M a[28:31], a[164:167], a[156:159], a[28:31]
 buffer_load_dwordx4 v14, s[48:51], s22 offen offset:2048   lds
M a[28:31], a[160:163], a[152:155], a[28:31]
M v[60:63], a[168:171], a[152:155], v[60:63]
 ds_read_b128 a[160:163], v5 offset:36864
 ds_read_b128 a[164:167], v6 offset:36864
M v[60:63], a[172:175], a[156:159], v[60:63]
 ds_read_b64_tr_b16 a[44:45], v2 offset:8192
 ds_read_b64_tr_b16 a[46:47], v2 offset:9216
M v[56:59], a[172:175], a[148:151], v[56:59]
 buffer_load_dwordx4 v15, s[48:51], s22 offen offset:3072   lds
M v[56:59], a[168:171], a[144:147], v[56:59]
 s_sub_u32 s22, s22, 2097024
M v[52:55], a[168:171], a[136:139], v[52:55]
M v[52:55], a[172:175], a[140:143], v[52:55]
 ds_read_b64_tr_b16 a[48:49], v3 offset:0
 ds_read_b64_tr_b16 a[50:51], v3 offset:1024
M v[48:51], a[172:175], a[132:135], v[48:51]
 s_add_u32 m0, s23, 49152
M v[48:51], a[168:171], a[128:131], v[48:51]
 buffer_load_dwordx4 v8, s[16:19], s21 offen offset:0  nt lds
M v[44:47], a[168:171], a[120:123], v[44:47]
M v[44:47], a[172:175], a[124:127], v[44:47]
M v[40:43], a[172:175], a[116:119], v[40:43]
 ds_read_b64_tr_b16 a[52:53], v3 offset:8192
 ds_read_b64_tr_b16 a[54:55], v3 offset:9216
M v[40:43], a[168:171], a[112:115], v[40:43]
M v[36:39], a[168:171], a[104:107], v[36:39]
 buffer_load_dwordx4 v9, s[16:19], s21 offen offset:1024  nt lds
M v[36:39], a[172:175], a[108:111], v[36:39]
 s_waitcnt lgkmcnt(6)
M v[32:35], a[172:175], a[100:103], v[32:35]
M v[32:35], a[168:171], a[96:99], v[32:35]
 ds_read_b64_tr_b16 a[56:57], v4 offset:0
 ds_read_b64_tr_b16 a[58:59], v4 offset:1024
M v[64:67], a[160:163], a[96:99], v[64:67]
 ds_read_b128 a[168:171], v5 offset:38912
 ds_read_b128 a[172:175], v6 offset:38912
M v[64:67], a[164:167], a[100:103], v[64:67]
 buffer_load_dwordx4 v10, s[16:19], s21 offen offset:2048  nt lds
M v[68:71], a[164:167], a[108:111], v[68:71]
M v[68:71], a[160:163], a[104:107], v[68:71]
M v[72:75], a[160:163], a[112:115], v[72:75]
 ds_read_b64_tr_b16 a[60:61], v4 offset:8192
 ds_read_b64_tr_b16 a[62:63], v4 offset:9216
M v[72:75], a[164:167], a[116:119], v[72:75]
M v[76:79], a[164:167], a[124:127], v[76:79]
 buffer_load_dwordx4 v11, s[16:19], s21 offen offset:3072  nt lds
M v[76:79], a[160:163], a[120:123], v[76:79]
 s_add_u32 s21, s21, 524160
M v[80:83], a[160:163], a[128:131], v[80:83]
M v[80:83], a[164:167], a[132:135], v[80:83]
M v[84:87], a[164:167], a[140:143], v[84:87]
M v[84:87], a[160:163], a[136:139], v[84:87]
M v[88:91], a[160:163], a[144:147], v[88:91]
M v[88:91], a[164:167], a[148:151], v[88:91]
 s_waitcnt lgkmcnt(2)
M v[92:95], a[164:167], a[156:159], v[92:95]
 s_waitcnt vmcnt(20) lgkmcnt(0)
M v[92:95], a[160:163], a[152:155], v[92:95]
 s_barrier
M v[124:127], a[168:171], a[152:155], v[124:127]
 ds_read_b128 a[160:163], v5 offset:49152
 ds_read_b128 a[164:167], v6 offset:49152
M v[124:127], a[172:175], a[156:159], v[124:127]
M v[120:123], a[172:175], a[148:151], v[120:123]
 s_add_u32 m0, s24, 32768
 ds_read_b64_tr_b16 a[64:65], v1 offset:16384
 ds_read_b64_tr_b16 a[66:67], v1 offset:17408
M v[120:123], a[168:171], a[144:147], v[120:123]
 buffer_load_dwordx4 v12, s[48:51], s22 offen offset:0   lds
M v[116:119], a[168:171], a[136:139], v[116:119]
M v[116:119], a[172:175], a[140:143], v[116:119]
M v[112:115], a[172:175], a[132:135], v[112:115]
M v[112:115], a[168:171], a[128:131], v[112:115]
M v[108:111], a[168:171], a[120:123], v[108:111]
M v[108:111], a[172:175], a[124:127], v[108:111]
 ds_read_b64_tr_b16 a[68:69], v1 offset:24576
 ds_read_b64_tr_b16 a[70:71], v1 offset:25600
M v[104:107], a[172:175], a[116:119], v[104:107]
 buffer_load_dwordx4 v13, s[48:51], s22 offen offset:1024   lds
M v[104:107], a[168:171], a[112:115], v[104:107]
M v[100:103], a[168:171], a[104:107], v[100:103]
M v[100:103], a[172:175], a[108:111], v[100:103]
 s_waitcnt lgkmcnt(4)
M v[96:99], a[172:175], a[100:103], v[96:99]
M v[96:99], a[168:171], a[96:99], v[96:99]
 buffer_load_dwordx4 v14, s[48:51], s22 offen offset:2048   lds
M v[128:131], a[160:163], a[96:99], v[128:131]
 ds_read_b128 a[168:171], v5 offset:51200
 ds_read_b128 a[172:175], v6 offset:51200
M v[128:131], a[164:167], a[100:103], v[128:131]
 ds_read_b64_tr_b16 a[72:73], v2 offset:16384
 ds_read_b64_tr_b16 a[74:75], v2 offset:17408
M v[132:135], a[164:167], a[108:111], v[132:135]
M v[132:135], a[160:163], a[104:107], v[132:135]
M v[136:139], a[160:163], a[112:115], v[136:139]
M v[136:139], a[164:167], a[116:119], v[136:139]
M v[140:143], a[164:167], a[124:127], v[140:143]
 buffer_load_dwordx4 v15, s[48:51], s22 offen offset:3072   lds
M v[140:143], a[160:163], a[120:123], v[140:143]
 s_add_u32 s22, s22, 2097152
 ds_read_b64_tr_b16 a[76:77], v2 offset:24576
 ds_read_b64_tr_b16 a[78:79], v2 offset:25600
M v[144:147], a[160:163], a[128:131], v[144:147]
M v[144:147], a[164:167], a[132:135], v[144:147]
M v[148:151], a[164:167], a[140:143], v[148:151]
M v[148:151], a[160:163], a[136:139], v[148:151]
 s_add_u32 m0, s23, 0
M v[152:155], a[160:163], a[144:147], v[152:155]
 buffer_load_dwordx4 v8, s[16:19], s21 offen offset:0  nt lds
M v[152:155], a[164:167], a[148:151], v[152:155]
 s_waitcnt lgkmcnt(4)
M v[156:159], a[164:167], a[156:159], v[156:159]
 ds_read_b64_tr_b16 a[80:81], v3 offset:16384
 ds_read_b64_tr_b16 a[82:83], v3 offset:17408
M v[156:159], a[160:163], a[152:155], v[156:159]
M v[188:191], a[168:171], a[152:155], v[188:191]
 ds_read_b128 a[160:163], v5 offset:53248
 ds_read_b128 a[164:167], v6 offset:53248
M v[188:191], a[172:175], a[156:159], v[188:191]
M v[184:187], a[172:175], a[148:151], v[184:187]
 buffer_load_dwordx4 v9, s[16:19], s21 offen offset:1024  nt lds
M v[184:187], a[168:171], a[144:147], v[184:187]
M v[180:183], a[168:171], a[136:139], v[180:183]
M v[180:183], a[172:175], a[140:143], v[180:183]
 ds_read_b64_tr_b16 a[84:85], v3 offset:24576
 ds_read_b64_tr_b16 a[86:87], v3 offset:25600
M v[176:179], a[172:175], a[132:135], v[176:179]
M v[176:179], a[168:171], a[128:131], v[176:179]
M v[172:175], a[168:171], a[120:123], v[172:175]
M v[172:175], a[172:175], a[124:127], v[172:175]
 buffer_load_dwordx4 v10, s[16:19], s21 offen offset:2048  nt lds
M v[168:171], a[172:175], a[116:119], v[168:171]
M v[168:171], a[168:171], a[112:115], v[168:171]
M v[164:167], a[168:171], a[104:107], v[164:167]
 ds_read_b64_tr_b16 a[88:89], v4 offset:16384
 ds_read_b64_tr_b16 a[90:91], v4 offset:17408
M v[164:167], a[172:175], a[108:111], v[164:167]
 s_waitcnt lgkmcnt(4)
M v[160:163], a[172:175], a[100:103], v[160:163]
M v[160:163], a[168:171], a[96:99], v[160:163]
 buffer_load_dwordx4 v11, s[16:19], s21 offen offset:3072  nt lds
M v[192:195], a[160:163], a[96:99], v[192:195]
 s_add_u32 s21, s21, 128
 ds_read_b128 a[168:171], v5 offset:55296
 ds_read_b128 a[172:175], v6 offset:55296
M v[192:195], a[164:167], a[100:103], v[192:195]
M v[196:199], a[164:167], a[108:111], v[196:199]
M v[196:199], a[160:163], a[104:107], v[196:199]
 ds_read_b64_tr_b16 a[92:93], v4 offset:24576
 ds_read_b64_tr_b16 a[94:95], v4 offset:25600
M v[200:203], a[160:163], a[112:115], v[200:203]
 s_add_u32 m0, s87, 5120
M v[200:203], a[164:167], a[116:119], v[200:203]
 buffer_load_dwordx4 v25, s[60:63], s89 offen offset:0 nt lds
M v[204:207], a[164:167], a[124:127], v[204:207]
 s_add_u32 s89, s89, 114688
M v[204:207], a[160:163], a[120:123], v[204:207]
M v[208:211], a[160:163], a[128:131], v[208:211]
M v[208:211], a[164:167], a[132:135], v[208:211]
M v[212:215], a[164:167], a[140:143], v[212:215]
M v[212:215], a[160:163], a[136:139], v[212:215]
M v[216:219], a[160:163], a[144:147], v[216:219]
M v[216:219], a[164:167], a[148:151], v[216:219]
 s_waitcnt lgkmcnt(2)
M v[220:223], a[164:167], a[156:159], v[220:223]
 s_waitcnt vmcnt(21) lgkmcnt(0)
M v[220:223], a[160:163], a[152:155], v[220:223]
 s_barrier
M v[252:255], a[168:171], a[152:155], v[252:255]
 ds_read_b128 a[160:163], v5 offset:0
 ds_read_b128 a[164:167], v6 offset:0
M v[252:255], a[172:175], a[156:159], v[252:255]
M v[248:251], a[172:175], a[148:151], v[248:251]
M v[248:251], a[168:171], a[144:147], v[248:251]
M v[244:247], a[168:171], a[136:139], v[244:247]
M v[244:247], a[172:175], a[140:143], v[244:247]
M v[240:243], a[172:175], a[132:135], v[240:243]
M v[240:243], a[168:171], a[128:131], v[240:243]
M v[236:239], a[168:171], a[120:123], v[236:239]
M v[236:239], a[172:175], a[124:127], v[236:239]
M v[232:235], a[172:175], a[116:119], v[232:235]
M v[232:235], a[168:171], a[112:115], v[232:235]
M v[228:231], a[168:171], a[104:107], v[228:231]
M v[228:231], a[172:175], a[108:111], v[228:231]
 s_waitcnt lgkmcnt(0)
M v[224:227], a[172:175], a[100:103], v[224:227]
M v[224:227], a[168:171], a[96:99], v[224:227]
M a[0:3], a[160:163], a[32:35], a[0:3]
 ds_read_b128 a[168:171], v5 offset:2048
 ds_read_b128 a[172:175], v6 offset:2048
M a[0:3], a[164:167], a[36:39], a[0:3]
 ds_read_b64_tr_b16 a[96:97], v1 offset:32768
 ds_read_b64_tr_b16 a[98:99], v1 offset:33792
M a[4:7], a[164:167], a[44:47], a[4:7]
 s_add_u32 m0, s24, 49152
M a[4:7], a[160:163], a[40:43], a[4:7]
 buffer_load_dwordx4 v12, s[48:51], s22 offen offset:0   lds
M a[8:11], a[160:163], a[48:51], a[8:11]
M a[8:11], a[164:167], a[52:55], a[8:11]
M a[12:15], a[164:167], a[60:63], a[12:15]
 ds_read_b64_tr_b16 a[100:101], v1 offset:40960
 ds_read_b64_tr_b16 a[102:103], v1 offset:41984
M a[12:15], a[160:163], a[56:59], a[12:15]
M a[16:19], a[160:163], a[64:67], a[16:19]
 buffer_load_dwordx4 v13, s[48:51], s22 offen offset:1024   lds
M a[16:19], a[164:167], a[68:71], a[16:19]
M a[20:23], a[164:167], a[76:79], a[20:23]
 s_waitcnt vmcnt(18)
 v_min3_u32 v28, v16, v17, v18
M a[20:23], a[160:163], a[72:75], a[20:23]
 ds_read_b64_tr_b16 a[104:105], v2 offset:32768
 ds_read_b64_tr_b16 a[106:107], v2 offset:33792
M a[24:27], a[160:163], a[80:83], a[24:27]
 s_waitcnt vmcnt(17)
 v_min3_u32 v28, v28, v19, v20
M a[24:27], a[164:167], a[84:87], a[24:27]
 s_waitcnt lgkmcnt(6)
 v_min3_u32 v28, v28, v21, v22
M a[28:31], a[164:167], a[92:95], a[28:31]
 buffer_load_dwordx4 v14, s[48:51], s22 offen offset:2048   lds
M a[28:31], a[160:163], a[88:91], a[28:31]
 v_min_u32 v28, v28, v23
M v[60:63], a[168:171], a[88:91], v[60:63]
 ds_read_b128 a[160:163], v5 offset:4096
 ds_read_b128 a[164:167], v6 offset:4096
M v[60:63], a[172:175], a[92:95], v[60:63]
 ds_read_b64_tr_b16 a[108:109], v2 offset:40960
 ds_read_b64_tr_b16 a[110:111], v2 offset:41984
M v[56:59], a[172:175], a[84:87], v[56:59]
 buffer_load_dwordx4 v15, s[48:51], s22 offen offset:3072   lds
M v[56:59], a[168:171], a[80:83], v[56:59]
 s_sub_u32 s22, s22, 2097024
 v_cmp_eq_u32 vcc, 0, v28
M v[52:55], a[168:171], a[72:75], v[52:55]
 s_nop 0
M v[52:55], a[172:175], a[76:79], v[52:55]
 s_cbranch_vccnz L_hs
L_hr:
 ds_read_b64_tr_b16 a[112:113], v3 offset:32768
 ds_read_b64_tr_b16 a[114:115], v3 offset:33792
M v[48:51], a[172:175], a[68:71], v[48:51]
 s_add_u32 m0, s23, 16384
 v_max_u32 v28, v16, v17
M v[48:51], a[168:171], a[64:67], v[48:51]
 buffer_load_dwordx4 v8, s[16:19], s21 offen offset:0  nt lds
M v[44:47], a[168:171], a[56:59], v[44:47]
 v_min_u32 v29, v16, v17
M v[44:47], a[172:175], a[60:63], v[44:47]
 v_med3_u32 v29, v28, v29, v18
M v[40:43], a[172:175], a[52:55], v[40:43]
 ds_read_b64_tr_b16 a[116:117], v3 offset:40960
 ds_read_b64_tr_b16 a[118:119], v3 offset:41984
M v[40:43], a[168:171], a[48:51], v[40:43]
 v_max_u32 v28, v28, v18
M v[36:39], a[168:171], a[40:43], v[36:39]
 buffer_load_dwordx4 v9, s[16:19], s21 offen offset:1024  nt lds
M v[36:39], a[172:175], a[44:47], v[36:39]
 s_waitcnt lgkmcnt(6)
 v_med3_u32 v29, v28, v29, v19
M v[32:35], a[172:175], a[36:39], v[32:35]
 v_max_u32 v28, v28, v19
M v[32:35], a[168:171], a[32:35], v[32:35]
 ds_read_b64_tr_b16 a[120:121], v4 offset:32768
 ds_read_b64_tr_b16 a[122:123], v4 offset:33792
M v[64:67], a[160:163], a[32:35], v[64:67]
 ds_read_b128 a[168:171], v5 offset:6144
 ds_read_b128 a[172:175], v6 offset:6144
M v[64:67], a[164:167], a[36:39], v[64:67]
 buffer_load_dwordx4 v10, s[16:19], s21 offen offset:2048  nt lds
M v[68:71], a[164:167], a[44:47], v[68:71]
 v_med3_u32 v29, v28, v29, v20
M v[68:71], a[160:163], a[40:43], v[68:71]
 v_max_u32 v28, v28, v20
M v[72:75], a[160:163], a[48:51], v[72:75]
 ds_read_b64_tr_b16 a[124:125], v4 offset:40960
 ds_read_b64_tr_b16 a[126:127], v4 offset:41984
M v[72:75], a[164:167], a[52:55], v[72:75]
 v_med3_u32 v29, v28, v29, v21
M v[76:79], a[164:167], a[60:63], v[76:79]
 buffer_load_dwordx4 v11, s[16:19], s21 offen offset:3072  nt lds
M v[76:79], a[160:163], a[56:59], v[76:79]
 s_add_u32 s21, s21, 524160
 v_max_u32 v28, v28, v21
M v[80:83], a[160:163], a[64:67], v[80:83]
 v_med3_u32 v29, v28, v29, v22
M v[80:83], a[164:167], a[68:71], v[80:83]
 v_max_u32 v28, v28, v22
M v[84:87], a[164:167], a[76:79], v[84:87]
 v_med3_u32 v29, v28, v29, v23
M v[84:87], a[160:163], a[72:75], v[84:87]
 v_max_u32 v28, v28, v23
M v[88:91], a[160:163], a[80:83], v[88:91]
 s_nop 0
 v_mov_b32 v30, v28 row_ror:8 row_mask:0xf bank_mask:0xf
M v[88:91], a[164:167], a[84:87], v[88:91]
 s_waitcnt lgkmcnt(2)
 v_mov_b32 v31, v29 row_ror:8 row_mask:0xf bank_mask:0xf
M v[92:95], a[164:167], a[92:95], v[92:95]
 s_waitcnt vmcnt(17) lgkmcnt(0)
 v_min_u32 v16, v28, v30
M v[92:95], a[160:163], a[88:91], v[92:95]
 s_barrier
M v[124:127], a[168:171], a[88:91], v[124:127]
 ds_read_b128 a[160:163], v5 offset:16384
 ds_read_b128 a[164:167], v6 offset:16384
M v[124:127], a[172:175], a[92:95], v[124:127]
 v_max_u32 v28, v28, v30
M v[120:123], a[172:175], a[84:87], v[120:123]
 s_add_u32 m0, s24, 0
 ds_read_b64_tr_b16 a[128:129], v1 offset:49152
 ds_read_b64_tr_b16 a[130:131], v1 offset:50176
M v[120:123], a[168:171], a[80:83], v[120:123]
 buffer_load_dwordx4 v12, s[48:51], s22 offen offset:0   lds
M v[116:119], a[168:171], a[72:75], v[116:119]
 v_max3_u32 v29, v29, v31, v16
M v[116:119], a[172:175], a[76:79], v[116:119]
 v_mov_b32 v30, v28 row_ror:4 row_mask:0xf bank_mask:0xf
M v[112:115], a[172:175], a[68:71], v[112:115]
 v_mov_b32 v31, v29 row_ror:4 row_mask:0xf bank_mask:0xf
M v[112:115], a[168:171], a[64:67], v[112:115]
 v_min_u32 v16, v28, v30
M v[108:111], a[168:171], a[56:59], v[108:111]
 v_max_u32 v28, v28, v30
M v[108:111], a[172:175], a[60:63], v[108:111]
 ds_read_b64_tr_b16 a[132:133], v1 offset:57344
 ds_read_b64_tr_b16 a[134:135], v1 offset:58368
M v[104:107], a[172:175], a[52:55], v[104:107]
 buffer_load_dwordx4 v13, s[48:51], s22 offen offset:1024   lds
M v[104:107], a[168:171], a[48:51], v[104:107]
 v_max3_u32 v29, v29, v31, v16
M v[100:103], a[168:171], a[40:43], v[100:103]
 v_mov_b32 v30, v28 row_ror:2 row_mask:0xf bank_mask:0xf
M v[100:103], a[172:175], a[44:47], v[100:103]
 s_waitcnt lgkmcnt(4)
 v_mov_b32 v31, v29 row_ror:2 row_mask:0xf bank_mask:0xf
M v[96:99], a[172:175], a[36:39], v[96:99]
 v_min_u32 v16, v28, v30
M v[96:99], a[168:171], a[32:35], v[96:99]
 buffer_load_dwordx4 v14, s[48:51], s22 offen offset:2048   lds
M v[128:131], a[160:163], a[32:35], v[128:131]
 ds_read_b128 a[168:171], v5 offset:18432
 ds_read_b128 a[172:175], v6 offset:18432
M v[128:131], a[164:167], a[36:39], v[128:131]
 ds_read_b64_tr_b16 a[136:137], v2 offset:49152
 ds_read_b64_tr_b16 a[138:139], v2 offset:50176
M v[132:135], a[164:167], a[44:47], v[132:135]
 v_max_u32 v28, v28, v30
M v[132:135], a[160:163], a[40:43], v[132:135]
 v_max3_u32 v29, v29, v31, v16
M v[136:139], a[160:163], a[48:51], v[136:139]
 v_mov_b32 v30, v28 row_ror:1 row_mask:0xf bank_mask:0xf
M v[136:139], a[164:167], a[52:55], v[136:139]
 v_mov_b32 v31, v29 row_ror:1 row_mask:0xf bank_mask:0xf
M v[140:143], a[164:167], a[60:63], v[140:143]
 buffer_load_dwordx4 v15, s[48:51], s22 offen offset:3072   lds
M v[140:143], a[160:163], a[56:59], v[140:143]
 s_add_u32 s22, s22, 2097152
 ds_read_b64_tr_b16 a[140:141], v2 offset:57344
 ds_read_b64_tr_b16 a[142:143], v2 offset:58368
M v[144:147], a[160:163], a[64:67], v[144:147]
 v_min_u32 v16, v28, v30
M v[144:147], a[164:167], a[68:71], v[144:147]
 v_max_u32 v28, v28, v30
M v[148:151], a[164:167], a[76:79], v[148:151]
 v_max3_u32 v29, v29, v31, v16
M v[148:151], a[160:163], a[72:75], v[148:151]
 s_add_u32 m0, s23, 32768
 v_mov_b32 v30, v28
M v[152:155], a[160:163], a[80:83], v[152:155]
 buffer_load_dwordx4 v8, s[16:19], s21 offen offset:0  nt lds
M v[152:155], a[164:167], a[84:87], v[152:155]
 s_waitcnt lgkmcnt(4)
 v_mov_b32 v31, v29
M v[156:159], a[164:167], a[92:95], v[156:159]
 ds_read_b64_tr_b16 a[144:145], v3 offset:49152
 ds_read_b64_tr_b16 a[146:147], v3 offset:50176
M v[156:159], a[160:163], a[88:91], v[156:159]
 v_permlane16_swap_b32 v30, v28
M v[188:191], a[168:171], a[88:91], v[188:191]
 ds_read_b128 a[160:163], v5 offset:20480
 ds_read_b128 a[164:167], v6 offset:20480
M v[188:191], a[172:175], a[92:95], v[188:191]
 v_permlane16_swap_b32 v31, v29
M v[184:187], a[172:175], a[84:87], v[184:187]
 buffer_load_dwordx4 v9, s[16:19], s21 offen offset:1024  nt lds
M v[184:187], a[168:171], a[80:83], v[184:187]
 v_min_u32 v16, v28, v30
M v[180:183], a[168:171], a[72:75], v[180:183]
 v_max_u32 v28, v28, v30
M v[180:183], a[172:175], a[76:79], v[180:183]
 ds_read_b64_tr_b16 a[148:149], v3 offset:57344
 ds_read_b64_tr_b16 a[150:151], v3 offset:58368
M v[176:179], a[172:175], a[68:71], v[176:179]
 v_max3_u32 v29, v29, v31, v16
M v[176:179], a[168:171], a[64:67], v[176:179]
 v_mov_b32 v30, v28
M v[172:175], a[168:171], a[56:59], v[172:175]
 v_mov_b32 v31, v29
M v[172:175], a[172:175], a[60:63], v[172:175]
 buffer_load_dwordx4 v10, s[16:19], s21 offen offset:2048  nt lds
M v[168:171], a[172:175], a[52:55], v[168:171]
 v_permlane32_swap_b32 v30, v28
M v[168:171], a[168:171], a[48:51], v[168:171]
 v_permlane32_swap_b32 v31, v29
M v[164:167], a[168:171], a[40:43], v[164:167]
 ds_read_b64_tr_b16 a[152:153], v4 offset:49152
 ds_read_b64_tr_b16 a[154:155], v4 offset:50176
M v[164:167], a[172:175], a[44:47], v[164:167]
 s_waitcnt lgkmcnt(4)
 v_min_u32 v16, v28, v30
M v[160:163], a[172:175], a[36:39], v[160:163]
 v_max_u32 v28, v28, v30
M v[160:163], a[168:171], a[32:35], v[160:163]
 buffer_load_dwordx4 v11, s[16:19], s21 offen offset:3072  nt lds
M v[192:195], a[160:163], a[32:35], v[192:195]
 s_add_u32 s21, s21, 128
 ds_read_b128 a[168:171], v5 offset:22528
 ds_read_b128 a[172:175], v6 offset:22528
M v[192:195], a[164:167], a[36:39], v[192:195]
 v_max3_u32 v29, v29, v31, v16
M v[196:199], a[164:167], a[44:47], v[196:199]
 s_lshl_b32 s64, s20, 3
M v[196:199], a[160:163], a[40:43], v[196:199]
 s_add_u32 s64, s64, 159744
 ds_read_b64_tr_b16 a[156:157], v4 offset:57344
 ds_read_b64_tr_b16 a[158:159], v4 offset:58368
M v[200:203], a[160:163], a[48:51], v[200:203]
 s_add_u32 m0, s87, 6144
 v_mov_b32 v16, s64
M v[200:203], a[164:167], a[52:55], v[200:203]
 buffer_load_dwordx4 v25, s[60:63], s89 offen offset:0 nt lds
M v[204:207], a[164:167], a[60:63], v[204:207]
 s_add_u32 s89, s89, 114688
 ds_write_b64 v16, v[28:29]
M v[204:207], a[160:163], a[56:59], v[204:207]
M v[208:211], a[160:163], a[64:67], v[208:211]
M v[208:211], a[164:167], a[68:71], v[208:211]
M v[212:215], a[164:167], a[76:79], v[212:215]
M v[212:215], a[160:163], a[72:75], v[212:215]
M v[216:219], a[160:163], a[80:83], v[216:219]
M v[216:219], a[164:167], a[84:87], v[216:219]
 s_waitcnt lgkmcnt(3)
M v[220:223], a[164:167], a[92:95], v[220:223]
 s_waitcnt vmcnt(18) lgkmcnt(0)
M v[220:223], a[160:163], a[88:91], v[220:223]
 s_barrier
M v[252:255], a[168:171], a[88:91], v[252:255]
 ds_read_b128 a[160:163], v5 offset:32768
 ds_read_b128 a[164:167], v6 offset:32768
M v[252:255], a[172:175], a[92:95], v[252:255]
 buffer_load_dword a240, v24, s[32:35], 0 offen offset:1536
M v[248:251], a[172:175], a[84:87], v[248:251]
M v[248:251], a[168:171], a[80:83], v[248:251]
M v[244:247], a[168:171], a[72:75], v[244:247]
M v[244:247], a[172:175], a[76:79], v[244:247]
M v[240:243], a[172:175], a[68:71], v[240:243]
M v[240:243], a[168:171], a[64:67], v[240:243]
M v[236:239], a[168:171], a[56:59], v[236:239]
M v[236:239], a[172:175], a[60:63], v[236:239]
M v[232:235], a[172:175], a[52:55], v[232:235]
M v[232:235], a[168:171], a[48:51], v[232:235]
M v[228:231], a[168:171], a[40:43], v[228:231]
M v[228:231], a[172:175], a[44:47], v[228:231]
 s_waitcnt lgkmcnt(0)
M v[224:227], a[172:175], a[36:39], v[224:227]
M v[224:227], a[168:171], a[32:35], v[224:227]
M a[0:3], a[160:163], a[96:99], a[0:3]
 ds_read_b128 a[168:171], v5 offset:34816
 ds_read_b128 a[172:175], v6 offset:34816
M a[0:3], a[164:167], a[100:103], a[0:3]
 ds_read_b64_tr_b16 a[32:33], v1 offset:0
 ds_read_b64_tr_b16 a[34:35], v1 offset:1024
M a[4:7], a[164:167], a[108:111], a[4:7]
 s_add_u32 m0, s24, 16384
M a[4:7], a[160:163], a[104:107], a[4:7]
 buffer_load_dwordx4 v12, s[48:51], s22 offen offset:0   lds
M a[8:11], a[160:163], a[112:115], a[8:11]
 v_mov_b32 v28, 159744
M a[8:11], a[164:167], a[116:119], a[8:11]
 ds_read_b128 v[16:19], v28
M a[12:15], a[164:167], a[124:127], a[12:15]
 ds_read_b64_tr_b16 a[36:37], v1 offset:8192
 ds_read_b64_tr_b16 a[38:39], v1 offset:9216
M a[12:15], a[160:163], a[120:123], a[12:15]
 ds_read_b128 v[20:23], v28 offset:16
M a[16:19], a[160:163], a[128:131], a[16:19]
 buffer_load_dwordx4 v13, s[48:51], s22 offen offset:1024   lds
M a[16:19], a[164:167], a[132:135], a[16:19]
M a[20:23], a[164:167], a[140:143], a[20:23]
M a[20:23], a[160:163], a[136:139], a[20:23]
 ds_read_b64_tr_b16 a[40:41], v2 offset:0
 ds_read_b64_tr_b16 a[42:43], v2 offset:1024
M a[24:27], a[160:163], a[144:147], a[24:27]
M a[24:27], a[164:167], a[148:151], a[24:27]
 s_waitcnt lgkmcnt(8)
M a[28:31], a[164:167], a[156:159], a[28:31]
 buffer_load_dwordx4 v14, s[48:51], s22 offen offset:2048   lds
M a[28:31], a[160:163], a[152:155], a[28:31]
M v[60:63], a[168:171], a[152:155], v[60:63]
 ds_read_b128 a[160:163], v5 offset:36864
 ds_read_b128 a[164:167], v6 offset:36864
M v[60:63], a[172:175], a[156:159], v[60:63]
 ds_read_b64_tr_b16 a[44:45], v2 offset:8192
 ds_read_b64_tr_b16 a[46:47], v2 offset:9216
M v[56:59], a[172:175], a[148:151], v[56:59]
 buffer_load_dwordx4 v15, s[48:51], s22 offen offset:3072   lds
M v[56:59], a[168:171], a[144:147], v[56:59]
 s_sub_u32 s22, s22, 2097024
 s_waitcnt lgkmcnt(9)
 v_min_u32 v28, v16, v18
M v[52:55], a[168:171], a[136:139], v[52:55]
 v_max_u32 v16, v16, v18
M v[52:55], a[172:175], a[140:143], v[52:55]
 ds_read_b64_tr_b16 a[48:49], v3 offset:0
 ds_read_b64_tr_b16 a[50:51], v3 offset:1024
M v[48:51], a[172:175], a[132:135], v[48:51]
 s_add_u32 m0, s23, 49152
 v_max3_u32 v17, v17, v19, v28
M v[48:51], a[168:171], a[128:131], v[48:51]
 buffer_load_dwordx4 v8, s[16:19], s21 offen offset:0  nt lds
M v[44:47], a[168:171], a[120:123], v[44:47]
 s_waitcnt lgkmcnt(8)
 v_min_u32 v29, v20, v22
M v[44:47], a[172:175], a[124:127], v[44:47]
 v_max_u32 v20, v20, v22
M v[40:43], a[172:175], a[116:119], v[40:43]
 ds_read_b64_tr_b16 a[52:53], v3 offset:8192
 ds_read_b64_tr_b16 a[54:55], v3 offset:9216
M v[40:43], a[168:171], a[112:115], v[40:43]
 v_max3_u32 v21, v21, v23, v29
M v[36:39], a[168:171], a[104:107], v[36:39]
 buffer_load_dwordx4 v9, s[16:19], s21 offen offset:1024  nt lds
M v[36:39], a[172:175], a[108:111], v[36:39]
 s_waitcnt lgkmcnt(6)
 v_min_u32 v28, v16, v20
M v[32:35], a[172:175], a[100:103], v[32:35]
 v_max_u32 v16, v16, v20
M v[32:35], a[168:171], a[96:99], v[32:35]
 ds_read_b64_tr_b16 a[56:57], v4 offset:0
 ds_read_b64_tr_b16 a[58:59], v4 offset:1024
M v[64:67], a[160:163], a[96:99], v[64:67]
 ds_read_b128 a[168:171], v5 offset:38912
 ds_read_b128 a[172:175], v6 offset:38912
M v[64:67], a[164:167], a[100:103], v[64:67]
 buffer_load_dwordx4 v10, s[16:19], s21 offen offset:2048  nt lds
M v[68:71], a[164:167], a[108:111], v[68:71]
 v_max3_u32 v17, v17, v21, v28
M v[68:71], a[160:163], a[104:107], v[68:71]
 v_and_b32 v28, 1, v0
M v[72:75], a[160:163], a[112:115], v[72:75]
 ds_read_b64_tr_b16 a[60:61], v4 offset:8192
 ds_read_b64_tr_b16 a[62:63], v4 offset:9216
M v[72:75], a[164:167], a[116:119], v[72:75]
 v_cmp_eq_u32 vcc, 0, v28
M v[76:79], a[164:167], a[124:127], v[76:79]
 buffer_load_dwordx4 v11, s[16:19], s21 offen offset:3072  nt lds
M v[76:79], a[160:163], a[120:123], v[76:79]
 s_add_u32 s21, s21, 524160
 s_and_b32 s64, s20, 1
M v[80:83], a[160:163], a[128:131], v[80:83]
 s_mul_i32 s64, s64, 448
 v_cndmask_b32 v24, v17, v16, vcc
M v[80:83], a[164:167], a[132:135], v[80:83]
 v_and_b32 v24, 0x7ff, v24
M v[84:87], a[164:167], a[140:143], v[84:87]
 v_sub_u32 v24, 2047, v24
M v[84:87], a[160:163], a[136:139], v[84:87]
 v_mul_u32_u24 v28, 896, v24
M v[88:91], a[160:163], a[144:147], v[88:91]
 v_lshrrev_b32 v29, 4, v0
M v[88:91], a[164:167], a[148:151], v[88:91]
 s_waitcnt lgkmcnt(2)
 v_lshl_add_u32 v28, v29, 4, v28
M v[92:95], a[164:167], a[156:159], v[92:95]
 s_waitcnt vmcnt(18) lgkmcnt(0)
 v_bfe_u32 v30, v0, 1, 3
M v[92:95], a[160:163], a[152:155], v[92:95]
 s_barrier
M v[124:127], a[168:171], a[152:155], v[124:127]
 ds_read_b128 a[160:163], v5 offset:49152
 ds_read_b128 a[164:167], v6 offset:49152
M v[124:127], a[172:175], a[156:159], v[124:127]
 v_lshl_or_b32 v28, v30, 26, v28
M v[120:123], a[172:175], a[148:151], v[120:123]
 s_add_u32 m0, s24, 32768
 ds_read_b64_tr_b16 a[64:65], v1 offset:16384
 ds_read_b64_tr_b16 a[66:67], v1 offset:17408
M v[120:123], a[168:171], a[144:147], v[120:123]
 buffer_load_dwordx4 v12, s[48:51], s22 offen offset:0   lds
M v[116:119], a[168:171], a[136:139], v[116:119]
M v[116:119], a[172:175], a[140:143], v[116:119]
M v[112:115], a[172:175], a[132:135], v[112:115]
 buffer_load_dwordx4 a[208:211], v28, s[56:59], s64 offen offset:0
M v[112:115], a[168:171], a[128:131], v[112:115]
M v[108:111], a[168:171], a[120:123], v[108:111]
 buffer_load_dwordx4 a[212:215], v28, s[56:59], s64 offen offset:64
M v[108:111], a[172:175], a[124:127], v[108:111]
 ds_read_b64_tr_b16 a[68:69], v1 offset:24576
 ds_read_b64_tr_b16 a[70:71], v1 offset:25600
M v[104:107], a[172:175], a[116:119], v[104:107]
 buffer_load_dwordx4 v13, s[48:51], s22 offen offset:1024   lds
M v[104:107], a[168:171], a[112:115], v[104:107]
M v[100:103], a[168:171], a[104:107], v[100:103]
M v[100:103], a[172:175], a[108:111], v[100:103]
 s_waitcnt lgkmcnt(4)
M v[96:99], a[172:175], a[100:103], v[96:99]
 buffer_load_dwordx4 a[216:219], v28, s[56:59], s64 offen offset:128
M v[96:99], a[168:171], a[96:99], v[96:99]
M v[128:131], a[160:163], a[96:99], v[128:131]
 ds_read_b128 a[168:171], v5 offset:51200
 ds_read_b128 a[172:175], v6 offset:51200
M v[128:131], a[164:167], a[100:103], v[128:131]
 ds_read_b64_tr_b16 a[72:73], v2 offset:16384
 ds_read_b64_tr_b16 a[74:75], v2 offset:17408
M v[132:135], a[164:167], a[108:111], v[132:135]
 buffer_load_dwordx4 v14, s[48:51], s22 offen offset:2048   lds
M v[132:135], a[160:163], a[104:107], v[132:135]
M v[136:139], a[160:163], a[112:115], v[136:139]
 buffer_load_dwordx4 a[220:223], v28, s[56:59], s64 offen offset:192
M v[136:139], a[164:167], a[116:119], v[136:139]
M v[140:143], a[164:167], a[124:127], v[140:143]
 buffer_load_dwordx4 a[224:227], v28, s[56:59], s64 offen offset:256
M v[140:143], a[160:163], a[120:123], v[140:143]
 ds_read_b64_tr_b16 a[76:77], v2 offset:24576
 ds_read_b64_tr_b16 a[78:79], v2 offset:25600
M v[144:147], a[160:163], a[128:131], v[144:147]
 buffer_load_dwordx4 v15, s[48:51], s22 offen offset:3072   lds
M v[144:147], a[164:167], a[132:135], v[144:147]
 s_add_u32 s22, s22, 2097152
M v[148:151], a[164:167], a[140:143], v[148:151]
M v[148:151], a[160:163], a[136:139], v[148:151]
 buffer_load_dwordx4 a[228:231], v28, s[56:59], s64 offen offset:320
M v[152:155], a[160:163], a[144:147], v[152:155]
M v[152:155], a[164:167], a[148:151], v[152:155]
 s_waitcnt lgkmcnt(4)
M v[156:159], a[164:167], a[156:159], v[156:159]
 s_add_u32 m0, s23, 0
 ds_read_b64_tr_b16 a[80:81], v3 offset:16384
 ds_read_b64_tr_b16 a[82:83], v3 offset:17408
M v[156:159], a[160:163], a[152:155], v[156:159]
 buffer_load_dwordx4 v8, s[16:19], s21 offen offset:0  nt lds
M v[188:191], a[168:171], a[152:155], v[188:191]
 ds_read_b128 a[160:163], v5 offset:53248
 ds_read_b128 a[164:167], v6 offset:53248
M v[188:191], a[172:175], a[156:159], v[188:191]
 buffer_load_dwordx4 a[232:235], v28, s[56:59], s64 offen offset:384
M v[184:187], a[172:175], a[148:151], v[184:187]
 v_lshrrev_b32 v28, 4, v24
M v[184:187], a[168:171], a[144:147], v[184:187]
 v_lshlrev_b32 v28, 5, v28
M v[180:183], a[168:171], a[136:139], v[180:183]
 v_and_b32 v30, 15, v24
M v[180:183], a[172:175], a[140:143], v[180:183]
 ds_read_b64_tr_b16 a[84:85], v3 offset:24576
 ds_read_b64_tr_b16 a[86:87], v3 offset:25600
M v[176:179], a[172:175], a[132:135], v[176:179]
 buffer_load_dwordx4 v9, s[16:19], s21 offen offset:1024  nt lds
M v[176:179], a[168:171], a[128:131], v[176:179]
 v_add_lshl_u32 v28, v28, v30, 2
M v[172:175], a[168:171], a[120:123], v[172:175]
 v_lshrrev_b32 v30, 1, v0
M v[172:175], a[172:175], a[124:127], v[172:175]
 v_min_u32 v30, 1, v30
M v[168:171], a[172:175], a[116:119], v[168:171]
 v_lshl_or_b32 v28, v30, 29, v28
M v[168:171], a[168:171], a[112:115], v[168:171]
 s_mov_b32 s64, 234881024
M v[164:167], a[168:171], a[104:107], v[164:167]
 ds_read_b64_tr_b16 a[88:89], v4 offset:16384
 ds_read_b64_tr_b16 a[90:91], v4 offset:17408
M v[164:167], a[172:175], a[108:111], v[164:167]
 s_waitcnt lgkmcnt(4)
M v[160:163], a[172:175], a[100:103], v[160:163]
 buffer_load_dwordx4 v10, s[16:19], s21 offen offset:2048  nt lds
M v[160:163], a[168:171], a[96:99], v[160:163]
 buffer_load_dword v23, v28, s[8:11], s64 offen sc1
M v[192:195], a[160:163], a[96:99], v[192:195]
 ds_read_b128 a[168:171], v5 offset:55296
 ds_read_b128 a[172:175], v6 offset:55296
M v[192:195], a[164:167], a[100:103], v[192:195]
 v_bfe_u32 v28, v0, 2, 2
M v[196:199], a[164:167], a[108:111], v[196:199]
 v_lshl_add_u32 v28, v29, 3, v28
M v[196:199], a[160:163], a[104:107], v[196:199]
 ds_read_b64_tr_b16 a[92:93], v4 offset:24576
 ds_read_b64_tr_b16 a[94:95], v4 offset:25600
M v[200:203], a[160:163], a[112:115], v[200:203]
 buffer_load_dwordx4 v11, s[16:19], s21 offen offset:3072  nt lds
M v[200:203], a[164:167], a[116:119], v[200:203]
 s_add_u32 s21, s21, 128
 v_lshlrev_b32 v28, 5, v28
M v[204:207], a[164:167], a[124:127], v[204:207]
 v_and_b32 v30, 3, v0
M v[204:207], a[160:163], a[120:123], v[204:207]
 v_lshl_add_u32 v28, v30, 3, v28
M v[208:211], a[160:163], a[128:131], v[208:211]
 v_add_u32 v22, s87, v28
M v[208:211], a[164:167], a[132:135], v[208:211]
M v[212:215], a[164:167], a[140:143], v[212:215]
M v[212:215], a[160:163], a[136:139], v[212:215]
M v[216:219], a[160:163], a[144:147], v[216:219]
M v[216:219], a[164:167], a[148:151], v[216:219]
 s_waitcnt lgkmcnt(2)
M v[220:223], a[164:167], a[156:159], v[220:223]
 s_waitcnt vmcnt(26) lgkmcnt(0)
M v[220:223], a[160:163], a[152:155], v[220:223]
 s_barrier
M v[252:255], a[168:171], a[152:155], v[252:255]
 ds_read_b128 a[160:163], v5 offset:0
 ds_read_b128 a[164:167], v6 offset:0
M v[252:255], a[172:175], a[156:159], v[252:255]
M v[248:251], a[172:175], a[148:151], v[248:251]
M v[248:251], a[168:171], a[144:147], v[248:251]
M v[244:247], a[168:171], a[136:139], v[244:247]
M v[244:247], a[172:175], a[140:143], v[244:247]
M v[240:243], a[172:175], a[132:135], v[240:243]
M v[240:243], a[168:171], a[128:131], v[240:243]
M v[236:239], a[168:171], a[120:123], v[236:239]
M v[236:239], a[172:175], a[124:127], v[236:239]
M v[232:235], a[172:175], a[116:119], v[232:235]
M v[232:235], a[168:171], a[112:115], v[232:235]
M v[228:231], a[168:171], a[104:107], v[228:231]
M v[228:231], a[172:175], a[108:111], v[228:231]
 s_waitcnt lgkmcnt(0)
M v[224:227], a[172:175], a[100:103], v[224:227]
M v[224:227], a[168:171], a[96:99], v[224:227]
M a[0:3], a[160:163], a[32:35], a[0:3]
 ds_read_b128 a[168:171], v5 offset:2048
 ds_read_b128 a[172:175], v6 offset:2048
M a[0:3], a[164:167], a[36:39], a[0:3]
 ds_read_b64_tr_b16 a[96:97], v1 offset:32768
 ds_read_b64_tr_b16 a[98:99], v1 offset:33792
M a[4:7], a[164:167], a[44:47], a[4:7]
 s_add_u32 m0, s24, 49152
M a[4:7], a[160:163], a[40:43], a[4:7]
 buffer_load_dwordx4 v12, s[48:51], s22 offen offset:0   lds
M a[8:11], a[160:163], a[48:51], a[8:11]
M a[8:11], a[164:167], a[52:55], a[8:11]
M a[12:15], a[164:167], a[60:63], a[12:15]
 ds_read_b64_tr_b16 a[100:101], v1 offset:40960
 ds_read_b64_tr_b16 a[102:103], v1 offset:41984
M a[12:15], a[160:163], a[56:59], a[12:15]
M a[16:19], a[160:163], a[64:67], a[16:19]
 buffer_load_dwordx4 v13, s[48:51], s22 offen offset:1024   lds
M a[16:19], a[164:167], a[68:71], a[16:19]
M a[20:23], a[164:167], a[76:79], a[20:23]
M a[20:23], a[160:163], a[72:75], a[20:23]
 ds_read_b64_tr_b16 a[104:105], v2 offset:32768
 ds_read_b64_tr_b16 a[106:107], v2 offset:33792
M a[24:27], a[160:163], a[80:83], a[24:27]
M a[24:27], a[164:167], a[84:87], a[24:27]
 s_waitcnt lgkmcnt(6)
M a[28:31], a[164:167], a[92:95], a[28:31]
 buffer_load_dwordx4 v14, s[48:51], s22 offen offset:2048   lds
M a[28:31], a[160:163], a[88:91], a[28:31]
M v[60:63], a[168:171], a[88:91], v[60:63]
 ds_read_b128 a[160:163], v5 offset:4096
 ds_read_b128 a[164:167], v6 offset:4096
M v[60:63], a[172:175], a[92:95], v[60:63]
 ds_read_b64_tr_b16 a[108:109], v2 offset:40960
 ds_read_b64_tr_b16 a[110:111], v2 offset:41984
M v[56:59], a[172:175], a[84:87], v[56:59]
 buffer_load_dwordx4 v15, s[48:51], s22 offen offset:3072   lds
M v[56:59], a[168:171], a[80:83], v[56:59]
 s_sub_u32 s22, s22, 2097024
M v[52:55], a[168:171], a[72:75], v[52:55]
M v[52:55], a[172:175], a[76:79], v[52:55]
 ds_read_b64_tr_b16 a[112:113], v3 offset:32768
 ds_read_b64_tr_b16 a[114:115], v3 offset:33792
M v[48:51], a[172:175], a[68:71], v[48:51]
 s_add_u32 m0, s23, 16384
M v[48:51], a[168:171], a[64:67], v[48:51]
 buffer_load_dwordx4 v8, s[16:19], s21 offen offset:0  nt lds
M v[44:47], a[168:171], a[56:59], v[44:47]
M v[44:47], a[172:175], a[60:63], v[44:47]
M v[40:43], a[172:175], a[52:55], v[40:43]
 ds_read_b64_tr_b16 a[116:117], v3 offset:40960
 ds_read_b64_tr_b16 a[118:119], v3 offset:41984
M v[40:43], a[168:171], a[48:51], v[40:43]
M v[36:39], a[168:171], a[40:43], v[36:39]
 buffer_load_dwordx4 v9, s[16:19], s21 offen offset:1024  nt lds
M v[36:39], a[172:175], a[44:47], v[36:39]
 s_waitcnt lgkmcnt(6)
M v[32:35], a[172:175], a[36:39], v[32:35]
M v[32:35], a[168:171], a[32:35], v[32:35]
 ds_read_b64_tr_b16 a[120:121], v4 offset:32768
 ds_read_b64_tr_b16 a[122:123], v4 offset:33792
M v[64:67], a[160:163], a[32:35], v[64:67]
 ds_read_b128 a[168:171], v5 offset:6144
 ds_read_b128 a[172:175], v6 offset:6144
M v[64:67], a[164:167], a[36:39], v[64:67]
 buffer_load_dwordx4 v10, s[16:19], s21 offen offset:2048  nt lds
M v[68:71], a[164:167], a[44:47], v[68:71]
M v[68:71], a[160:163], a[40:43], v[68:71]
M v[72:75], a[160:163], a[48:51], v[72:75]
 ds_read_b64_tr_b16 a[124:125], v4 offset:40960
 ds_read_b64_tr_b16 a[126:127], v4 offset:41984
M v[72:75], a[164:167], a[52:55], v[72:75]
M v[76:79], a[164:167], a[60:63], v[76:79]
 buffer_load_dwordx4 v11, s[16:19], s21 offen offset:3072  nt lds
M v[76:79], a[160:163], a[56:59], v[76:79]
 s_add_u32 s21, s21, 524160
M v[80:83], a[160:163], a[64:67], v[80:83]
M v[80:83], a[164:167], a[68:71], v[80:83]
M v[84:87], a[164:167], a[76:79], v[84:87]
M v[84:87], a[160:163], a[72:75], v[84:87]
M v[88:91], a[160:163], a[80:83], v[88:91]
M v[88:91], a[164:167], a[84:87], v[88:91]
 s_waitcnt lgkmcnt(2)
M v[92:95], a[164:167], a[92:95], v[92:95]
 s_waitcnt vmcnt(24) lgkmcnt(0)
M v[92:95], a[160:163], a[88:91], v[92:95]
 s_barrier
M v[124:127], a[168:171], a[88:91], v[124:127]
 ds_read_b128 a[160:163], v5 offset:16384
 ds_read_b128 a[164:167], v6 offset:16384
M v[124:127], a[172:175], a[92:95], v[124:127]
M v[120:123], a[172:175], a[84:87], v[120:123]
 s_add_u32 m0, s24, 0
 ds_read_b64_tr_b16 a[128:129], v1 offset:49152
 ds_read_b64_tr_b16 a[130:131], v1 offset:50176
M v[120:123], a[168:171], a[80:83], v[120:123]
 buffer_load_dwordx4 v12, s[48:51], s22 offen offset:0   lds
M v[116:119], a[168:171], a[72:75], v[116:119]
 ds_read_b64_tr_b16 a[176:177], v22 offset:0
M v[116:119], a[172:175], a[76:79], v[116:119]
 ds_read_b64_tr_b16 a[178:179], v22 offset:128
 ds_read_b64_tr_b16 a[180:181], v22 offset:1024
M v[112:115], a[172:175], a[68:71], v[112:115]
 ds_read_b64_tr_b16 a[182:183], v22 offset:1152
M v[112:115], a[168:171], a[64:67], v[112:115]
 ds_read_b64_tr_b16 a[184:185], v22 offset:2048
 ds_read_b64_tr_b16 a[186:187], v22 offset:2176
M v[108:111], a[168:171], a[56:59], v[108:111]
 ds_read_b64_tr_b16 a[188:189], v22 offset:3072
M v[108:111], a[172:175], a[60:63], v[108:111]
 ds_read_b64_tr_b16 a[132:133], v1 offset:57344
 ds_read_b64_tr_b16 a[134:135], v1 offset:58368
M v[104:107], a[172:175], a[52:55], v[104:107]
 buffer_load_dwordx4 v13, s[48:51], s22 offen offset:1024   lds
M v[104:107], a[168:171], a[48:51], v[104:107]
 ds_read_b64_tr_b16 a[190:191], v22 offset:3200
M v[100:103], a[168:171], a[40:43], v[100:103]
M v[100:103], a[172:175], a[44:47], v[100:103]
 s_waitcnt lgkmcnt(12)
M v[96:99], a[172:175], a[36:39], v[96:99]
M v[96:99], a[168:171], a[32:35], v[96:99]
M v[128:131], a[160:163], a[32:35], v[128:131]
 ds_read_b128 a[168:171], v5 offset:18432
 ds_read_b128 a[172:175], v6 offset:18432
M v[128:131], a[164:167], a[36:39], v[128:131]
 ds_read_b64_tr_b16 a[136:137], v2 offset:49152
 ds_read_b64_tr_b16 a[138:139], v2 offset:50176
M v[132:135], a[164:167], a[44:47], v[132:135]
 buffer_load_dwordx4 v14, s[48:51], s22 offen offset:2048   lds
M v[132:135], a[160:163], a[40:43], v[132:135]
M v[136:139], a[160:163], a[48:51], v[136:139]
M v[136:139], a[164:167], a[52:55], v[136:139]
M v[140:143], a[164:167], a[60:63], v[140:143]
M v[140:143], a[160:163], a[56:59], v[140:143]
 ds_read_b64_tr_b16 a[140:141], v2 offset:57344
 ds_read_b64_tr_b16 a[142:143], v2 offset:58368
M v[144:147], a[160:163], a[64:67], v[144:147]
 buffer_load_dwordx4 v15, s[48:51], s22 offen offset:3072   lds
M v[144:147], a[164:167], a[68:71], v[144:147]
 s_add_u32 s22, s22, 2097152
M v[148:151], a[164:167], a[76:79], v[148:151]
M v[148:151], a[160:163], a[72:75], v[148:151]
M v[152:155], a[160:163], a[80:83], v[152:155]
M v[152:155], a[164:167], a[84:87], v[152:155]
 s_waitcnt lgkmcnt(4)
M v[156:159], a[164:167], a[92:95], v[156:159]
 s_add_u32 m0, s23, 32768
 ds_read_b64_tr_b16 a[144:145], v3 offset:49152
 ds_read_b64_tr_b16 a[146:147], v3 offset:50176
M v[156:159], a[160:163], a[88:91], v[156:159]
 buffer_load_dwordx4 v8, s[16:19], s21 offen offset:0  nt lds
 s_waitcnt vmcnt(27)
M v[16:19], a[176:179], a[208:211], 0
 s_waitcnt vmcnt(26)
M v[16:19], a[180:183], a[212:215], v[16:19]
 s_waitcnt vmcnt(24)
M v[16:19], a[184:187], a[216:219], v[16:19]
 s_waitcnt vmcnt(22)
M v[16:19], a[188:191], a[220:223], v[16:19]
M v[188:191], a[168:171], a[88:91], v[188:191]
 ds_read_b128 a[160:163], v5 offset:20480
 ds_read_b128 a[164:167], v6 offset:20480
M v[188:191], a[172:175], a[92:95], v[188:191]
 ds_read_b64_tr_b16 a[176:177], v22 offset:4096
M v[184:187], a[172:175], a[84:87], v[184:187]
 ds_read_b64_tr_b16 a[178:179], v22 offset:4224
 ds_read_b64_tr_b16 a[180:181], v22 offset:5120
M v[184:187], a[168:171], a[80:83], v[184:187]
 ds_read_b64_tr_b16 a[182:183], v22 offset:5248
M v[180:183], a[168:171], a[72:75], v[180:183]
 ds_read_b64_tr_b16 a[184:185], v22 offset:6144
M v[180:183], a[172:175], a[76:79], v[180:183]
 ds_read_b64_tr_b16 a[148:149], v3 offset:57344
 ds_read_b64_tr_b16 a[150:151], v3 offset:58368
M v[176:179], a[172:175], a[68:71], v[176:179]
 buffer_load_dwordx4 v9, s[16:19], s21 offen offset:1024  nt lds
M v[176:179], a[168:171], a[64:67], v[176:179]
 ds_read_b64_tr_b16 a[186:187], v22 offset:6272
M v[172:175], a[168:171], a[56:59], v[172:175]
M v[172:175], a[172:175], a[60:63], v[172:175]
M v[168:171], a[172:175], a[52:55], v[168:171]
M v[168:171], a[168:171], a[48:51], v[168:171]
M v[164:167], a[168:171], a[40:43], v[164:167]
 ds_read_b64_tr_b16 a[152:153], v4 offset:49152
 ds_read_b64_tr_b16 a[154:155], v4 offset:50176
M v[164:167], a[172:175], a[44:47], v[164:167]
 s_waitcnt lgkmcnt(10)
M v[160:163], a[172:175], a[36:39], v[160:163]
 buffer_load_dwordx4 v10, s[16:19], s21 offen offset:2048  nt lds
M v[160:163], a[168:171], a[32:35], v[160:163]
M v[192:195], a[160:163], a[32:35], v[192:195]
 ds_read_b128 a[168:171], v5 offset:22528
 ds_read_b128 a[172:175], v6 offset:22528
M v[192:195], a[164:167], a[36:39], v[192:195]
M v[196:199], a[164:167], a[44:47], v[196:199]
M v[196:199], a[160:163], a[40:43], v[196:199]
 ds_read_b64_tr_b16 a[156:157], v4 offset:57344
 ds_read_b64_tr_b16 a[158:159], v4 offset:58368
M v[200:203], a[160:163], a[48:51], v[200:203]
 buffer_load_dwordx4 v11, s[16:19], s21 offen offset:3072  nt lds
M v[200:203], a[164:167], a[52:55], v[200:203]
 s_add_u32 s21, s21, 128
M v[204:207], a[164:167], a[60:63], v[204:207]
M v[204:207], a[160:163], a[56:59], v[204:207]
M v[208:211], a[160:163], a[64:67], v[208:211]
M v[208:211], a[164:167], a[68:71], v[208:211]
M v[212:215], a[164:167], a[76:79], v[212:215]
M v[212:215], a[160:163], a[72:75], v[212:215]
M v[216:219], a[160:163], a[80:83], v[216:219]
M v[216:219], a[164:167], a[84:87], v[216:219]
 s_waitcnt lgkmcnt(2)
M v[220:223], a[164:167], a[92:95], v[220:223]
 s_waitcnt vmcnt(16) lgkmcnt(0)
M v[220:223], a[160:163], a[88:91], v[220:223]
 s_barrier
M v[16:19], a[176:179], a[224:227], v[16:19]
M v[16:19], a[180:183], a[228:231], v[16:19]
M v[16:19], a[184:187], a[232:235], v[16:19]
M v[252:255], a[168:171], a[88:91], v[252:255]
 ds_read_b128 a[160:163], v5 offset:32768
 ds_read_b128 a[164:167], v6 offset:32768
M v[252:255], a[172:175], a[92:95], v[252:255]
M v[248:251], a[172:175], a[84:87], v[248:251]
M v[248:251], a[168:171], a[80:83], v[248:251]
M v[244:247], a[168:171], a[72:75], v[244:247]
M v[244:247], a[172:175], a[76:79], v[244:247]
M v[240:243], a[172:175], a[68:71], v[240:243]
M v[240:243], a[168:171], a[64:67], v[240:243]
M v[236:239], a[168:171], a[56:59], v[236:239]
M v[236:239], a[172:175], a[60:63], v[236:239]
M v[232:235], a[172:175], a[52:55], v[232:235]
M v[232:235], a[168:171], a[48:51], v[232:235]
M v[228:231], a[168:171], a[40:43], v[228:231]
M v[228:231], a[172:175], a[44:47], v[228:231]
 s_waitcnt lgkmcnt(0)
M v[224:227], a[172:175], a[36:39], v[224:227]
M v[224:227], a[168:171], a[32:35], v[224:227]
M a[0:3], a[160:163], a[96:99], a[0:3]
 ds_read_b128 a[168:171], v5 offset:34816
 ds_read_b128 a[172:175], v6 offset:34816
M a[0:3], a[164:167], a[100:103], a[0:3]
 ds_read_b64_tr_b16 a[32:33], v1 offset:0
 ds_read_b64_tr_b16 a[34:35], v1 offset:1024
M a[4:7], a[164:167], a[108:111], a[4:7]
 s_add_u32 m0, s24, 16384
M a[4:7], a[160:163], a[104:107], a[4:7]
 buffer_load_dwordx4 v12, s[48:51], s22 offen offset:0   lds
M a[8:11], a[160:163], a[112:115], a[8:11]
M a[8:11], a[164:167], a[116:119], a[8:11]
 s_lshl_b32 s64, s20, 10
M a[12:15], a[164:167], a[124:127], a[12:15]
 s_add_u32 s64, s64, 159744
 ds_read_b64_tr_b16 a[36:37], v1 offset:8192
 ds_read_b64_tr_b16 a[38:39], v1 offset:9216
M a[12:15], a[160:163], a[120:123], a[12:15]
 v_add_u32 v21, s64, v7
 ds_write_b128 v21, v[16:19]
M a[16:19], a[160:163], a[128:131], a[16:19]
 buffer_load_dwordx4 v13, s[48:51], s22 offen offset:1024   lds
M a[16:19], a[164:167], a[132:135], a[16:19]
 s_mul_i32 s67, s86, 14336
M a[20:23], a[164:167], a[140:143], a[20:23]
 s_mul_i32 s64, s20, 224
M a[20:23], a[160:163], a[136:139], a[20:23]
 s_add_u32 s67, s67, s64
 ds_read_b64_tr_b16 a[40:41], v2 offset:0
 ds_read_b64_tr_b16 a[42:43], v2 offset:1024
M a[24:27], a[160:163], a[144:147], a[24:27]
 v_lshrrev_b32 v28, 4, v0
 v_mul_u32_u24 v28, 896, v28
M a[24:27], a[164:167], a[148:151], a[24:27]
 s_waitcnt lgkmcnt(7)
 v_and_b32 v29, 15, v0
 v_lshl_add_u32 v28, v29, 4, v28
M a[28:31], a[164:167], a[156:159], a[28:31]
 buffer_load_dwordx4 v14, s[48:51], s22 offen offset:2048   lds
M a[28:31], a[160:163], a[152:155], a[28:31]
 v_mov_b32 v30, 536870912
 v_cmp_gt_u32 vcc, 14, v29
M v[60:63], a[168:171], a[152:155], v[60:63]
 s_nop 0
 ds_read_b128 a[160:163], v5 offset:36864
 ds_read_b128 a[164:167], v6 offset:36864
M v[60:63], a[172:175], a[156:159], v[60:63]
 s_nop 0
 ds_read_b64_tr_b16 a[44:45], v2 offset:8192
 ds_read_b64_tr_b16 a[46:47], v2 offset:9216
M v[56:59], a[172:175], a[148:151], v[56:59]
 buffer_load_dwordx4 v15, s[48:51], s22 offen offset:3072   lds
M v[56:59], a[168:171], a[144:147], v[56:59]
 s_sub_u32 s22, s22, 2097024
 v_cndmask_b32 v28, v30, v28, vcc
 v_add_u32 v29, 2560, v28
M v[52:55], a[168:171], a[136:139], v[52:55]
 v_add_u32 v30, 5120, v28
 v_add_u32 v31, 7680, v28
M v[52:55], a[172:175], a[140:143], v[52:55]
 ds_read_b64_tr_b16 a[48:49], v3 offset:0
 ds_read_b64_tr_b16 a[50:51], v3 offset:1024
M v[48:51], a[172:175], a[132:135], v[48:51]
 s_add_u32 m0, s23, 49152
M v[48:51], a[168:171], a[128:131], v[48:51]
 buffer_load_dwordx4 v8, s[16:19], s21 offen offset:0  nt lds
M v[44:47], a[168:171], a[120:123], v[44:47]
M v[44:47], a[172:175], a[124:127], v[44:47]
M v[40:43], a[172:175], a[116:119], v[40:43]
 ds_read_b64_tr_b16 a[52:53], v3 offset:8192
 ds_read_b64_tr_b16 a[54:55], v3 offset:9216
M v[40:43], a[168:171], a[112:115], v[40:43]
M v[36:39], a[168:171], a[104:107], v[36:39]
 buffer_load_dwordx4 v9, s[16:19], s21 offen offset:1024  nt lds
M v[36:39], a[172:175], a[108:111], v[36:39]
 s_waitcnt lgkmcnt(6)
M v[32:35], a[172:175], a[100:103], v[32:35]
M v[32:35], a[168:171], a[96:99], v[32:35]
 ds_read_b64_tr_b16 a[56:57], v4 offset:0
 ds_read_b64_tr_b16 a[58:59], v4 offset:1024
M v[64:67], a[160:163], a[96:99], v[64:67]
 ds_read_b128 a[168:171], v5 offset:38912
 ds_read_b128 a[172:175], v6 offset:38912
M v[64:67], a[164:167], a[100:103], v[64:67]
 buffer_load_dwordx4 v10, s[16:19], s21 offen offset:2048  nt lds
M v[68:71], a[164:167], a[108:111], v[68:71]
M v[68:71], a[160:163], a[104:107], v[68:71]
M v[72:75], a[160:163], a[112:115], v[72:75]
 ds_read_b64_tr_b16 a[60:61], v4 offset:8192
 ds_read_b64_tr_b16 a[62:63], v4 offset:9216
M v[72:75], a[164:167], a[116:119], v[72:75]
M v[76:79], a[164:167], a[124:127], v[76:79]
 buffer_load_dwordx4 v11, s[16:19], s21 offen offset:3072  nt lds
M v[76:79], a[160:163], a[120:123], v[76:79]
 s_add_u32 s21, s21, 524160
M v[80:83], a[160:163], a[128:131], v[80:83]
M v[80:83], a[164:167], a[132:135], v[80:83]
M v[84:87], a[164:167], a[140:143], v[84:87]
M v[84:87], a[160:163], a[136:139], v[84:87]
M v[88:91], a[160:163], a[144:147], v[88:91]
M v[88:91], a[164:167], a[148:151], v[88:91]
 s_waitcnt lgkmcnt(2)
M v[92:95], a[164:167], a[156:159], v[92:95]
 s_waitcnt vmcnt(16) lgkmcnt(0)
M v[92:95], a[160:163], a[152:155], v[92:95]
 s_barrier
M v[124:127], a[168:171], a[152:155], v[124:127]
 ds_read_b128 a[160:163], v5 offset:49152
 ds_read_b128 a[164:167], v6 offset:49152
M v[124:127], a[172:175], a[156:159], v[124:127]
M v[120:123], a[172:175], a[148:151], v[120:123]
 s_add_u32 m0, s24, 32768
 ds_read_b64_tr_b16 a[64:65], v1 offset:16384
 ds_read_b64_tr_b16 a[66:67], v1 offset:17408
M v[120:123], a[168:171], a[144:147], v[120:123]
 buffer_load_dwordx4 v12, s[48:51], s22 offen offset:0   lds
M v[116:119], a[168:171], a[136:139], v[116:119]
M v[116:119], a[172:175], a[140:143], v[116:119]
M v[112:115], a[172:175], a[132:135], v[112:115]
M v[112:115], a[168:171], a[128:131], v[112:115]
 buffer_load_dwordx4 v13, s[48:51], s22 offen offset:1024   lds
M v[108:111], a[168:171], a[120:123], v[108:111]
M v[108:111], a[172:175], a[124:127], v[108:111]
 ds_read_b64_tr_b16 a[68:69], v1 offset:24576
 ds_read_b64_tr_b16 a[70:71], v1 offset:25600
M v[104:107], a[172:175], a[116:119], v[104:107]
M v[104:107], a[168:171], a[112:115], v[104:107]
M v[100:103], a[168:171], a[104:107], v[100:103]
 buffer_load_dwordx4 v14, s[48:51], s22 offen offset:2048   lds
M v[100:103], a[172:175], a[108:111], v[100:103]
 s_waitcnt lgkmcnt(4)
M v[96:99], a[172:175], a[100:103], v[96:99]
M v[96:99], a[168:171], a[96:99], v[96:99]
M v[128:131], a[160:163], a[96:99], v[128:131]
 ds_read_b128 a[168:171], v5 offset:51200
 ds_read_b128 a[172:175], v6 offset:51200
M v[128:131], a[164:167], a[100:103], v[128:131]
 ds_read_b64_tr_b16 a[72:73], v2 offset:16384
 ds_read_b64_tr_b16 a[74:75], v2 offset:17408
M v[132:135], a[164:167], a[108:111], v[132:135]
 buffer_load_dwordx4 v15, s[48:51], s22 offen offset:3072   lds
M v[132:135], a[160:163], a[104:107], v[132:135]
 s_add_u32 s22, s22, 2097152
M v[136:139], a[160:163], a[112:115], v[136:139]
M v[136:139], a[164:167], a[116:119], v[136:139]
 s_add_u32 m0, s23, 0
M v[140:143], a[164:167], a[124:127], v[140:143]
 buffer_load_dwordx4 v8, s[16:19], s21 offen offset:0  nt lds
M v[140:143], a[160:163], a[120:123], v[140:143]
 ds_read_b64_tr_b16 a[76:77], v2 offset:24576
 ds_read_b64_tr_b16 a[78:79], v2 offset:25600
M v[144:147], a[160:163], a[128:131], v[144:147]
M v[144:147], a[164:167], a[132:135], v[144:147]
M v[148:151], a[164:167], a[140:143], v[148:151]
 buffer_load_dwordx4 v9, s[16:19], s21 offen offset:1024  nt lds
M v[148:151], a[160:163], a[136:139], v[148:151]
M v[152:155], a[160:163], a[144:147], v[152:155]
M v[152:155], a[164:167], a[148:151], v[152:155]
 s_waitcnt lgkmcnt(4)
M v[156:159], a[164:167], a[156:159], v[156:159]
 ds_read_b64_tr_b16 a[80:81], v3 offset:16384
 ds_read_b64_tr_b16 a[82:83], v3 offset:17408
M v[156:159], a[160:163], a[152:155], v[156:159]
 buffer_load_dwordx4 v10, s[16:19], s21 offen offset:2048  nt lds
M v[188:191], a[168:171], a[152:155], v[188:191]
 ds_read_b128 a[160:163], v5 offset:53248
 ds_read_b128 a[164:167], v6 offset:53248
M v[188:191], a[172:175], a[156:159], v[188:191]
M v[184:187], a[172:175], a[148:151], v[184:187]
M v[184:187], a[168:171], a[144:147], v[184:187]
M v[180:183], a[168:171], a[136:139], v[180:183]
 buffer_load_dwordx4 v11, s[16:19], s21 offen offset:3072  nt lds
M v[180:183], a[172:175], a[140:143], v[180:183]
 s_add_u32 s21, s21, 128
 ds_read_b64_tr_b16 a[84:85], v3 offset:24576
 ds_read_b64_tr_b16 a[86:87], v3 offset:25600
M v[176:179], a[172:175], a[132:135], v[176:179]
M v[176:179], a[168:171], a[128:131], v[176:179]
M v[172:175], a[168:171], a[120:123], v[172:175]
 s_add_u32 m0, s87, 0
M v[172:175], a[172:175], a[124:127], v[172:175]
 buffer_load_dwordx4 v28, s[68:71], s67 offen offset:0 nt lds
M v[168:171], a[172:175], a[116:119], v[168:171]
M v[168:171], a[168:171], a[112:115], v[168:171]
M v[164:167], a[168:171], a[104:107], v[164:167]
 ds_read_b64_tr_b16 a[88:89], v4 offset:16384
 ds_read_b64_tr_b16 a[90:91], v4 offset:17408
M v[164:167], a[172:175], a[108:111], v[164:167]
 s_waitcnt lgkmcnt(4)
M v[160:163], a[172:175], a[100:103], v[160:163]
 buffer_load_dwordx4 v29, s[68:71], s67 offen offset:1024 nt lds
M v[160:163], a[168:171], a[96:99], v[160:163]
M v[192:195], a[160:163], a[96:99], v[192:195]
 ds_read_b128 a[168:171], v5 offset:55296
 ds_read_b128 a[172:175], v6 offset:55296
M v[192:195], a[164:167], a[100:103], v[192:195]
M v[196:199], a[164:167], a[108:111], v[196:199]
 buffer_load_dwordx4 v30, s[68:71], s67 offen offset:2048 nt lds
M v[196:199], a[160:163], a[104:107], v[196:199]
 ds_read_b64_tr_b16 a[92:93], v4 offset:24576
 ds_read_b64_tr_b16 a[94:95], v4 offset:25600
M v[200:203], a[160:163], a[112:115], v[200:203]
M v[200:203], a[164:167], a[116:119], v[200:203]
M v[204:207], a[164:167], a[124:127], v[204:207]
M v[204:207], a[160:163], a[120:123], v[204:207]
 buffer_load_dwordx4 v31, s[68:71], s67 offen offset:3072 nt lds
M v[208:211], a[160:163], a[128:131], v[208:211]
 s_add_u32 s67, s67, 0
M v[208:211], a[164:167], a[132:135], v[208:211]
M v[212:215], a[164:167], a[140:143], v[212:215]
M v[212:215], a[160:163], a[136:139], v[212:215]
M v[216:219], a[160:163], a[144:147], v[216:219]
M v[216:219], a[164:167], a[148:151], v[216:219]
 s_waitcnt lgkmcnt(2)
M v[220:223], a[164:167], a[156:159], v[220:223]
 s_waitcnt vmcnt(20) lgkmcnt(0)
M v[220:223], a[160:163], a[152:155], v[220:223]
 s_barrier
M v[252:255], a[168:171], a[152:155], v[252:255]
 ds_read_b128 a[160:163], v5 offset:0
 ds_read_b128 a[164:167], v6 offset:0
M v[252:255], a[172:175], a[156:159], v[252:255]
M v[248:251], a[172:175], a[148:151], v[248:251]
M v[248:251], a[168:171], a[144:147], v[248:251]
M v[244:247], a[168:171], a[136:139], v[244:247]
M v[244:247], a[172:175], a[140:143], v[244:247]
M v[240:243], a[172:175], a[132:135], v[240:243]
M v[240:243], a[168:171], a[128:131], v[240:243]
M v[236:239], a[168:171], a[120:123], v[236:239]
M v[236:239], a[172:175], a[124:127], v[236:239]
M v[232:235], a[172:175], a[116:119], v[232:235]
M v[232:235], a[168:171], a[112:115], v[232:235]
M v[228:231], a[168:171], a[104:107], v[228:231]
M v[228:231], a[172:175], a[108:111], v[228:231]
 s_waitcnt lgkmcnt(0)
M v[224:227], a[172:175], a[100:103], v[224:227]
M v[224:227], a[168:171], a[96:99], v[224:227]
M a[0:3], a[160:163], a[32:35], a[0:3]
 ds_read_b128 a[168:171], v5 offset:2048
 ds_read_b128 a[172:175], v6 offset:2048
M a[0:3], a[164:167], a[36:39], a[0:3]
 ds_read_b64_tr_b16 a[96:97], v1 offset:32768
 ds_read_b64_tr_b16 a[98:99], v1 offset:33792
M a[4:7], a[164:167], a[44:47], a[4:7]
 s_add_u32 m0, s24, 49152
 v_cvt_pk_bf16_f32 v23, v23, v23
 v_accvgpr_read_b32 v27, a241
M a[4:7], a[160:163], a[40:43], a[4:7]
 buffer_load_dwordx4 v12, s[48:51], s22 offen offset:0   lds
M a[8:11], a[160:163], a[48:51], a[8:11]
 v_and_b32 v23, 0xffff0000, v23
M a[8:11], a[164:167], a[52:55], a[8:11]
 v_mul_f32 v22, 0xbfb8aa3b, v23
M a[12:15], a[164:167], a[60:63], a[12:15]
 ds_read_b64_tr_b16 a[100:101], v1 offset:40960
 ds_read_b64_tr_b16 a[102:103], v1 offset:41984
M a[12:15], a[160:163], a[56:59], a[12:15]
 v_exp_f32 v22, v22
M a[16:19], a[160:163], a[64:67], a[16:19]
 buffer_load_dwordx4 v13, s[48:51], s22 offen offset:1024   lds
M a[16:19], a[164:167], a[68:71], a[16:19]
 v_add_f32 v22, 1.0, v22
M a[20:23], a[164:167], a[76:79], a[20:23]
 v_rcp_f32 v23, v22
M a[20:23], a[160:163], a[72:75], a[20:23]
 s_or_b32 s64, s86, s20
 ds_read_b64_tr_b16 a[104:105], v2 offset:32768
 ds_read_b64_tr_b16 a[106:107], v2 offset:33792
M a[24:27], a[160:163], a[80:83], a[24:27]
 s_min_u32 s64, s64, 1
 s_lshl_b32 s64, s64, 29
 v_lshrrev_b32 v22, 1, v0
M a[24:27], a[164:167], a[84:87], a[24:27]
 s_waitcnt lgkmcnt(6)
 v_min_u32 v22, 1, v22
M a[28:31], a[164:167], a[92:95], a[28:31]
 buffer_load_dwordx4 v14, s[48:51], s22 offen offset:2048   lds
M a[28:31], a[160:163], a[88:91], a[28:31]
 v_lshlrev_b32 v22, 29, v22
M v[60:63], a[168:171], a[88:91], v[60:63]
 ds_read_b128 a[160:163], v5 offset:4096
 ds_read_b128 a[164:167], v6 offset:4096
M v[60:63], a[172:175], a[92:95], v[60:63]
 ds_read_b64_tr_b16 a[108:109], v2 offset:40960
 ds_read_b64_tr_b16 a[110:111], v2 offset:41984
M v[56:59], a[172:175], a[84:87], v[56:59]
 buffer_load_dwordx4 v15, s[48:51], s22 offen offset:3072   lds
M v[56:59], a[168:171], a[80:83], v[56:59]
 s_sub_u32 s22, s22, 2097024
 v_lshl_or_b32 v22, v0, 2, v22
M v[52:55], a[168:171], a[72:75], v[52:55]
 v_or_b32 v22, s64, v22
M v[52:55], a[172:175], a[76:79], v[52:55]
 ds_read_b64_tr_b16 a[112:113], v3 offset:32768
 ds_read_b64_tr_b16 a[114:115], v3 offset:33792
M v[48:51], a[172:175], a[68:71], v[48:51]
 s_add_u32 m0, s23, 16384
 v_cvt_pk_bf16_f32 v23, v23, v23
M v[48:51], a[168:171], a[64:67], v[48:51]
 buffer_load_dwordx4 v8, s[16:19], s21 offen offset:0  nt lds
M v[44:47], a[168:171], a[56:59], v[44:47]
 v_and_b32 v23, 0xffff0000, v23
M v[44:47], a[172:175], a[60:63], v[44:47]
 s_mov_b32 s64, 234913792
M v[40:43], a[172:175], a[52:55], v[40:43]
 ds_read_b64_tr_b16 a[116:117], v3 offset:40960
 ds_read_b64_tr_b16 a[118:119], v3 offset:41984
M v[40:43], a[168:171], a[48:51], v[40:43]
 buffer_store_dword v24, v22, s[8:11], s64 offen sc1
M v[36:39], a[168:171], a[40:43], v[36:39]
 buffer_load_dwordx4 v9, s[16:19], s21 offen offset:1024  nt lds
M v[36:39], a[172:175], a[44:47], v[36:39]
 s_waitcnt lgkmcnt(6)
M v[32:35], a[172:175], a[36:39], v[32:35]
 buffer_store_dword v23, v22, s[8:11], s64 offen offset:8 sc1
M v[32:35], a[168:171], a[32:35], v[32:35]
 ds_read_b64_tr_b16 a[120:121], v4 offset:32768
 ds_read_b64_tr_b16 a[122:123], v4 offset:33792
M v[64:67], a[160:163], a[32:35], v[64:67]
 ds_read_b128 a[168:171], v5 offset:6144
 ds_read_b128 a[172:175], v6 offset:6144
M v[64:67], a[164:167], a[36:39], v[64:67]
 buffer_load_dwordx4 v10, s[16:19], s21 offen offset:2048  nt lds
M v[68:71], a[164:167], a[44:47], v[68:71]
 v_add_u32 v25, 159744, v7
M v[68:71], a[160:163], a[40:43], v[68:71]
 ds_read_b128 v[16:19], v25
M v[72:75], a[160:163], a[48:51], v[72:75]
 ds_read_b64_tr_b16 a[124:125], v4 offset:40960
 ds_read_b64_tr_b16 a[126:127], v4 offset:41984
M v[72:75], a[164:167], a[52:55], v[72:75]
 ds_read_b128 v[28:31], v25 offset:1024
 v_sub_f32 v48, v48, v27
M v[76:79], a[164:167], a[60:63], v[76:79]
 buffer_load_dwordx4 v11, s[16:19], s21 offen offset:3072  nt lds
M v[76:79], a[160:163], a[56:59], v[76:79]
 s_add_u32 s21, s21, 524160
 ds_read_b128 v[20:23], v25 offset:2048
 v_sub_f32 v49, v49, v27
M v[80:83], a[160:163], a[64:67], v[80:83]
 v_sub_f32 v50, v50, v27
 v_sub_f32 v51, v51, v27
M v[80:83], a[164:167], a[68:71], v[80:83]
 v_sub_f32 v52, v52, v27
 v_sub_f32 v53, v53, v27
M v[84:87], a[164:167], a[76:79], v[84:87]
 v_sub_f32 v54, v54, v27
 v_sub_f32 v55, v55, v27
M v[84:87], a[160:163], a[72:75], v[84:87]
 v_sub_f32 v56, v56, v27
 v_sub_f32 v57, v57, v27
M v[88:91], a[160:163], a[80:83], v[88:91]
 v_sub_f32 v58, v58, v27
 v_sub_f32 v59, v59, v27
M v[88:91], a[164:167], a[84:87], v[88:91]
 s_waitcnt lgkmcnt(5)
 v_sub_f32 v60, v60, v27
 v_sub_f32 v61, v61, v27
M v[92:95], a[164:167], a[92:95], v[92:95]
 s_waitcnt vmcnt(22) lgkmcnt(0)
 v_sub_f32 v62, v62, v27
 v_sub_f32 v63, v63, v27
M v[92:95], a[160:163], a[88:91], v[92:95]
 s_barrier
M v[124:127], a[168:171], a[88:91], v[124:127]
 ds_read_b128 a[160:163], v5 offset:16384
 ds_read_b128 a[164:167], v6 offset:16384
M v[124:127], a[172:175], a[92:95], v[124:127]
 v_add_f32 v16, v28, v16
M v[120:123], a[172:175], a[84:87], v[120:123]
 s_add_u32 m0, s24, 0
 ds_read_b64_tr_b16 a[128:129], v1 offset:49152
 ds_read_b64_tr_b16 a[130:131], v1 offset:50176
M v[120:123], a[168:171], a[80:83], v[120:123]
 buffer_load_dwordx4 v12, s[48:51], s22 offen offset:0   lds
M v[116:119], a[168:171], a[72:75], v[116:119]
 v_add_f32 v17, v29, v17
 v_sub_f32 v80, v80, v27
M v[116:119], a[172:175], a[76:79], v[116:119]
 v_add_f32 v18, v30, v18
 v_sub_f32 v81, v81, v27
M v[112:115], a[172:175], a[68:71], v[112:115]
 v_add_f32 v19, v31, v19
 v_sub_f32 v82, v82, v27
M v[112:115], a[168:171], a[64:67], v[112:115]
 ds_read_b128 v[28:31], v25 offset:3072
 v_sub_f32 v83, v83, v27
M v[108:111], a[168:171], a[56:59], v[108:111]
 v_cvt_pk_bf16_f32 v25, v16, v17
 v_sub_f32 v84, v84, v27
M v[108:111], a[172:175], a[60:63], v[108:111]
 ds_read_b64_tr_b16 a[132:133], v1 offset:57344
 ds_read_b64_tr_b16 a[134:135], v1 offset:58368
M v[104:107], a[172:175], a[52:55], v[104:107]
 buffer_load_dwordx4 v13, s[48:51], s22 offen offset:1024   lds
M v[104:107], a[168:171], a[48:51], v[104:107]
 v_lshlrev_b32 v16, 16, v25
 v_sub_f32 v85, v85, v27
M v[100:103], a[168:171], a[40:43], v[100:103]
 v_and_b32 v17, 0xffff0000, v25
 v_sub_f32 v86, v86, v27
M v[100:103], a[172:175], a[44:47], v[100:103]
 s_waitcnt lgkmcnt(5)
 v_cvt_pk_bf16_f32 v25, v18, v19
 v_sub_f32 v87, v87, v27
M v[96:99], a[172:175], a[36:39], v[96:99]
 v_lshlrev_b32 v18, 16, v25
 v_sub_f32 v88, v88, v27
M v[96:99], a[168:171], a[32:35], v[96:99]
 v_and_b32 v19, 0xffff0000, v25
 v_sub_f32 v89, v89, v27
M v[128:131], a[160:163], a[32:35], v[128:131]
 ds_read_b128 a[168:171], v5 offset:18432
 ds_read_b128 a[172:175], v6 offset:18432
M v[128:131], a[164:167], a[36:39], v[128:131]
 ds_read_b64_tr_b16 a[136:137], v2 offset:49152
 ds_read_b64_tr_b16 a[138:139], v2 offset:50176
M v[132:135], a[164:167], a[44:47], v[132:135]
 buffer_load_dwordx4 v14, s[48:51], s22 offen offset:2048   lds
M v[132:135], a[160:163], a[40:43], v[132:135]
 s_waitcnt lgkmcnt(6)
 v_add_f32 v20, v28, v20
 v_sub_f32 v90, v90, v27
M v[136:139], a[160:163], a[48:51], v[136:139]
 v_add_f32 v21, v29, v21
 v_sub_f32 v91, v91, v27
M v[136:139], a[164:167], a[52:55], v[136:139]
 v_add_f32 v22, v30, v22
 v_sub_f32 v92, v92, v27
M v[140:143], a[164:167], a[60:63], v[140:143]
 v_add_f32 v23, v31, v23
 v_sub_f32 v93, v93, v27
M v[140:143], a[160:163], a[56:59], v[140:143]
 ds_read_b64_tr_b16 a[140:141], v2 offset:57344
 ds_read_b64_tr_b16 a[142:143], v2 offset:58368
M v[144:147], a[160:163], a[64:67], v[144:147]
 buffer_load_dwordx4 v15, s[48:51], s22 offen offset:3072   lds
M v[144:147], a[164:167], a[68:71], v[144:147]
 s_add_u32 s22, s22, 2097152
 v_mul_f32 v28, 0xbfb8aa3b, v16
 v_sub_f32 v94, v94, v27
M v[148:151], a[164:167], a[76:79], v[148:151]
 v_mul_f32 v29, 0xbfb8aa3b, v17
 v_sub_f32 v95, v95, v27
M v[148:151], a[160:163], a[72:75], v[148:151]
 v_mul_f32 v30, 0xbfb8aa3b, v18
 v_sub_f32 v112, v112, v27
M v[152:155], a[160:163], a[80:83], v[152:155]
 v_mul_f32 v31, 0xbfb8aa3b, v19
 v_sub_f32 v113, v113, v27
M v[152:155], a[164:167], a[84:87], v[152:155]
 s_waitcnt lgkmcnt(4)
 v_exp_f32 v28, v28
M v[156:159], a[164:167], a[92:95], v[156:159]
 s_add_u32 m0, s23, 32768
 ds_read_b64_tr_b16 a[144:145], v3 offset:49152
 ds_read_b64_tr_b16 a[146:147], v3 offset:50176
M v[156:159], a[160:163], a[88:91], v[156:159]
 buffer_load_dwordx4 v8, s[16:19], s21 offen offset:0  nt lds
M v[188:191], a[168:171], a[88:91], v[188:191]
 ds_read_b128 a[160:163], v5 offset:20480
 ds_read_b128 a[164:167], v6 offset:20480
M v[188:191], a[172:175], a[92:95], v[188:191]
 v_exp_f32 v29, v29
M v[184:187], a[172:175], a[84:87], v[184:187]
 v_exp_f32 v30, v30
M v[184:187], a[168:171], a[80:83], v[184:187]
 v_exp_f32 v31, v31
M v[180:183], a[168:171], a[72:75], v[180:183]
 v_cvt_pk_bf16_f32 v25, v20, v21
 v_sub_f32 v114, v114, v27
M v[180:183], a[172:175], a[76:79], v[180:183]
 ds_read_b64_tr_b16 a[148:149], v3 offset:57344
 ds_read_b64_tr_b16 a[150:151], v3 offset:58368
M v[176:179], a[172:175], a[68:71], v[176:179]
 buffer_load_dwordx4 v9, s[16:19], s21 offen offset:1024  nt lds
M v[176:179], a[168:171], a[64:67], v[176:179]
 v_lshlrev_b32 v20, 16, v25
 v_sub_f32 v115, v115, v27
M v[172:175], a[168:171], a[56:59], v[172:175]
 v_and_b32 v21, 0xffff0000, v25
 v_sub_f32 v116, v116, v27
M v[172:175], a[172:175], a[60:63], v[172:175]
 v_cvt_pk_bf16_f32 v25, v22, v23
 v_sub_f32 v117, v117, v27
M v[168:171], a[172:175], a[52:55], v[168:171]
 v_lshlrev_b32 v22, 16, v25
 v_sub_f32 v118, v118, v27
M v[168:171], a[168:171], a[48:51], v[168:171]
 v_and_b32 v23, 0xffff0000, v25
 v_sub_f32 v119, v119, v27
M v[164:167], a[168:171], a[40:43], v[164:167]
 ds_read_b64_tr_b16 a[152:153], v4 offset:49152
 ds_read_b64_tr_b16 a[154:155], v4 offset:50176
M v[164:167], a[172:175], a[44:47], v[164:167]
 s_waitcnt lgkmcnt(4)
 v_add_f32 v28, 1.0, v28
 v_sub_f32 v120, v120, v27
M v[160:163], a[172:175], a[36:39], v[160:163]
 buffer_load_dwordx4 v10, s[16:19], s21 offen offset:2048  nt lds
M v[160:163], a[168:171], a[32:35], v[160:163]
 v_add_f32 v29, 1.0, v29
 v_sub_f32 v121, v121, v27
M v[192:195], a[160:163], a[32:35], v[192:195]
 ds_read_b128 a[168:171], v5 offset:22528
 ds_read_b128 a[172:175], v6 offset:22528
M v[192:195], a[164:167], a[36:39], v[192:195]
 v_add_f32 v30, 1.0, v30
 v_sub_f32 v122, v122, v27
M v[196:199], a[164:167], a[44:47], v[196:199]
 v_add_f32 v31, 1.0, v31
 v_sub_f32 v123, v123, v27
M v[196:199], a[160:163], a[40:43], v[196:199]
 ds_read_b64_tr_b16 a[156:157], v4 offset:57344
 ds_read_b64_tr_b16 a[158:159], v4 offset:58368
M v[200:203], a[160:163], a[48:51], v[200:203]
 buffer_load_dwordx4 v11, s[16:19], s21 offen offset:3072  nt lds
M v[200:203], a[164:167], a[52:55], v[200:203]
 s_add_u32 s21, s21, 128
 v_rcp_f32 v28, v28
M v[204:207], a[164:167], a[60:63], v[204:207]
 v_rcp_f32 v29, v29
M v[204:207], a[160:163], a[56:59], v[204:207]
 v_rcp_f32 v30, v30
M v[208:211], a[160:163], a[64:67], v[208:211]
 v_rcp_f32 v31, v31
M v[208:211], a[164:167], a[68:71], v[208:211]
 v_mul_f32 v16, v28, v16
 v_sub_f32 v124, v124, v27
M v[212:215], a[164:167], a[76:79], v[212:215]
 v_mul_f32 v17, v29, v17
 v_sub_f32 v125, v125, v27
M v[212:215], a[160:163], a[72:75], v[212:215]
 v_mul_f32 v18, v30, v18
 v_sub_f32 v126, v126, v27
M v[216:219], a[160:163], a[80:83], v[216:219]
 v_mul_f32 v19, v31, v19
 v_sub_f32 v127, v127, v27
M v[216:219], a[164:167], a[84:87], v[216:219]
 s_waitcnt lgkmcnt(2)
 v_cvt_pk_bf16_f32 v25, v16, v17
 v_sub_f32 v128, v128, v27
M v[220:223], a[164:167], a[92:95], v[220:223]
 s_waitcnt vmcnt(22) lgkmcnt(0)
 v_lshlrev_b32 v16, 16, v25
 v_sub_f32 v129, v129, v27
M v[220:223], a[160:163], a[88:91], v[220:223]
 s_barrier
M v[252:255], a[168:171], a[88:91], v[252:255]
 ds_read_b128 a[160:163], v5 offset:32768
 ds_read_b128 a[164:167], v6 offset:32768
M v[252:255], a[172:175], a[92:95], v[252:255]
 v_and_b32 v17, 0xffff0000, v25
 v_sub_f32 v130, v130, v27
M v[248:251], a[172:175], a[84:87], v[248:251]
 v_cvt_pk_bf16_f32 v25, v18, v19
 v_sub_f32 v131, v131, v27
M v[248:251], a[168:171], a[80:83], v[248:251]
 v_lshlrev_b32 v18, 16, v25
 v_sub_f32 v132, v132, v27
M v[244:247], a[168:171], a[72:75], v[244:247]
 v_and_b32 v19, 0xffff0000, v25
 v_sub_f32 v133, v133, v27
M v[244:247], a[172:175], a[76:79], v[244:247]
 v_mul_f32 v16, v20, v16
 v_sub_f32 v134, v134, v27
M v[240:243], a[172:175], a[68:71], v[240:243]
 v_mul_f32 v17, v21, v17
 v_sub_f32 v135, v135, v27
M v[240:243], a[168:171], a[64:67], v[240:243]
 v_mul_f32 v18, v22, v18
 v_sub_f32 v136, v136, v27
M v[236:239], a[168:171], a[56:59], v[236:239]
 v_mul_f32 v19, v23, v19
 v_sub_f32 v137, v137, v27
M v[236:239], a[172:175], a[60:63], v[236:239]
 v_cvt_pk_bf16_f32 v16, v16, v17
 v_sub_f32 v138, v138, v27
M v[232:235], a[172:175], a[52:55], v[232:235]
 v_cvt_pk_bf16_f32 v17, v18, v19
 v_sub_f32 v139, v139, v27
M v[232:235], a[168:171], a[48:51], v[232:235]
 v_sub_f32 v140, v140, v27
 v_sub_f32 v141, v141, v27
M v[228:231], a[168:171], a[40:43], v[228:231]
 v_sub_f32 v142, v142, v27
 v_sub_f32 v143, v143, v27
M v[228:231], a[172:175], a[44:47], v[228:231]
 s_waitcnt lgkmcnt(0)
 v_sub_f32 v144, v144, v27
 v_sub_f32 v145, v145, v27
M v[224:227], a[172:175], a[36:39], v[224:227]
 v_sub_f32 v146, v146, v27
 v_sub_f32 v147, v147, v27
M v[224:227], a[168:171], a[32:35], v[224:227]
 v_sub_f32 v148, v148, v27
 v_sub_f32 v149, v149, v27
M a[0:3], a[160:163], a[96:99], a[0:3]
 ds_read_b128 a[168:171], v5 offset:34816
 ds_read_b128 a[172:175], v6 offset:34816
M a[0:3], a[164:167], a[100:103], a[0:3]
 ds_read_b64_tr_b16 a[32:33], v1 offset:0
 ds_read_b64_tr_b16 a[34:35], v1 offset:1024
M a[4:7], a[164:167], a[108:111], a[4:7]
 s_add_u32 m0, s24, 16384
 v_lshrrev_b32 v28, 2, v0
 v_lshlrev_b32 v28, 8, v28
M a[4:7], a[160:163], a[104:107], a[4:7]
 buffer_load_dwordx4 v12, s[48:51], s22 offen offset:0   lds
M a[8:11], a[160:163], a[112:115], a[8:11]
 v_and_b32 v29, 3, v0
 v_lshl_add_u32 v28, v29, 3, v28
M a[8:11], a[164:167], a[116:119], a[8:11]
 v_add_u32 v28, s87, v28
 v_sub_f32 v150, v150, v27
M a[12:15], a[164:167], a[124:127], a[12:15]
 s_waitcnt vmcnt(19)
 ds_read_b64_tr_b16 a[36:37], v1 offset:8192
 ds_read_b64_tr_b16 a[38:39], v1 offset:9216
M a[12:15], a[160:163], a[120:123], a[12:15]
 ds_read_b64_tr_b16 a[176:177], v28 offset:0
 v_sub_f32 v151, v151, v27
M a[16:19], a[160:163], a[128:131], a[16:19]
 buffer_load_dwordx4 v13, s[48:51], s22 offen offset:1024   lds
M a[16:19], a[164:167], a[132:135], a[16:19]
 ds_read_b64_tr_b16 a[178:179], v28 offset:32
 ds_read_b64_tr_b16 a[180:181], v28 offset:64
M a[20:23], a[164:167], a[140:143], a[20:23]
 ds_read_b64_tr_b16 a[182:183], v28 offset:96
 v_sub_f32 v152, v152, v27
M a[20:23], a[160:163], a[136:139], a[20:23]
 ds_read_b64_tr_b16 a[40:41], v2 offset:0
 ds_read_b64_tr_b16 a[42:43], v2 offset:1024
M a[24:27], a[160:163], a[144:147], a[24:27]
 ds_read_b64_tr_b16 a[184:185], v28 offset:128
 v_sub_f32 v153, v153, v27
M a[24:27], a[164:167], a[148:151], a[24:27]
 s_waitcnt lgkmcnt(11)
 ds_read_b64_tr_b16 a[186:187], v28 offset:160
 ds_read_b64_tr_b16 a[188:189], v28 offset:192
M a[28:31], a[164:167], a[156:159], a[28:31]
 buffer_load_dwordx4 v14, s[48:51], s22 offen offset:2048   lds
M a[28:31], a[160:163], a[152:155], a[28:31]
 v_sub_f32 v154, v154, v27
 v_sub_f32 v155, v155, v27
M v[60:63], a[168:171], a[152:155], v[60:63]
 ds_read_b128 a[160:163], v5 offset:36864
 ds_read_b128 a[164:167], v6 offset:36864
M v[60:63], a[172:175], a[156:159], v[60:63]
 ds_read_b64_tr_b16 a[44:45], v2 offset:8192
 ds_read_b64_tr_b16 a[46:47], v2 offset:9216
M v[56:59], a[172:175], a[148:151], v[56:59]
 buffer_load_dwordx4 v15, s[48:51], s22 offen offset:3072   lds
M v[56:59], a[168:171], a[144:147], v[56:59]
 s_sub_u32 s22, s22, 2097024
 v_sub_f32 v156, v156, v27
 v_sub_f32 v157, v157, v27
M v[52:55], a[168:171], a[136:139], v[52:55]
 v_sub_f32 v158, v158, v27
 v_sub_f32 v159, v159, v27
M v[52:55], a[172:175], a[140:143], v[52:55]
 ds_read_b64_tr_b16 a[48:49], v3 offset:0
 ds_read_b64_tr_b16 a[50:51], v3 offset:1024
M v[48:51], a[172:175], a[132:135], v[48:51]
 s_add_u32 m0, s23, 49152
M v[48:51], a[168:171], a[128:131], v[48:51]
 buffer_load_dwordx4 v8, s[16:19], s21 offen offset:0  nt lds
M v[44:47], a[168:171], a[120:123], v[44:47]
M v[44:47], a[172:175], a[124:127], v[44:47]
M v[40:43], a[172:175], a[116:119], v[40:43]
 ds_read_b64_tr_b16 a[52:53], v3 offset:8192
 ds_read_b64_tr_b16 a[54:55], v3 offset:9216
M v[40:43], a[168:171], a[112:115], v[40:43]
M v[36:39], a[168:171], a[104:107], v[36:39]
 buffer_load_dwordx4 v9, s[16:19], s21 offen offset:1024  nt lds
M v[36:39], a[172:175], a[108:111], v[36:39]
 s_waitcnt lgkmcnt(6)
M v[32:35], a[172:175], a[100:103], v[32:35]
M v[32:35], a[168:171], a[96:99], v[32:35]
 ds_read_b64_tr_b16 a[56:57], v4 offset:0
 ds_read_b64_tr_b16 a[58:59], v4 offset:1024
M v[64:67], a[160:163], a[96:99], v[64:67]
 ds_read_b128 a[168:171], v5 offset:38912
 ds_read_b128 a[172:175], v6 offset:38912
M v[64:67], a[164:167], a[100:103], v[64:67]
 buffer_load_dwordx4 v10, s[16:19], s21 offen offset:2048  nt lds
M v[68:71], a[164:167], a[108:111], v[68:71]
M v[68:71], a[160:163], a[104:107], v[68:71]
M v[72:75], a[160:163], a[112:115], v[72:75]
 ds_read_b64_tr_b16 a[60:61], v4 offset:8192
 ds_read_b64_tr_b16 a[62:63], v4 offset:9216
M v[72:75], a[164:167], a[116:119], v[72:75]
M v[76:79], a[164:167], a[124:127], v[76:79]
 buffer_load_dwordx4 v11, s[16:19], s21 offen offset:3072  nt lds
M v[76:79], a[160:163], a[120:123], v[76:79]
 s_add_u32 s21, s21, 524160
M v[80:83], a[160:163], a[128:131], v[80:83]
M v[80:83], a[164:167], a[132:135], v[80:83]
M v[84:87], a[164:167], a[140:143], v[84:87]
M v[84:87], a[160:163], a[136:139], v[84:87]
M v[88:91], a[160:163], a[144:147], v[88:91]
M v[88:91], a[164:167], a[148:151], v[88:91]
 s_waitcnt lgkmcnt(2)
M v[92:95], a[164:167], a[156:159], v[92:95]
 s_waitcnt vmcnt(16) lgkmcnt(0)
M v[92:95], a[160:163], a[152:155], v[92:95]
 s_barrier
 v_mfma_f32_16x16x16_bf16 a[208:211], a[176:177], v[16:17], 0
 v_mfma_f32_16x16x16_bf16 a[212:215], a[178:179], v[16:17], 0
 v_mfma_f32_16x16x16_bf16 a[216:219], a[180:181], v[16:17], 0
 v_mfma_f32_16x16x16_bf16 a[220:223], a[182:183], v[16:17], 0
 v_mfma_f32_16x16x16_bf16 a[224:227], a[184:185], v[16:17], 0
 v_mfma_f32_16x16x16_bf16 a[228:231], a[186:187], v[16:17], 0
 v_mfma_f32_16x16x16_bf16 a[232:235], a[188:189], v[16:17], 0
M v[124:127], a[168:171], a[152:155], v[124:127]
 ds_read_b128 a[160:163], v5 offset:49152
 ds_read_b128 a[164:167], v6 offset:49152
M v[124:127], a[172:175], a[156:159], v[124:127]
M v[120:123], a[172:175], a[148:151], v[120:123]
 s_add_u32 m0, s24, 32768
 ds_read_b64_tr_b16 a[64:65], v1 offset:16384
 ds_read_b64_tr_b16 a[66:67], v1 offset:17408
M v[120:123], a[168:171], a[144:147], v[120:123]
 buffer_load_dwordx4 v12, s[48:51], s22 offen offset:0   lds
M v[116:119], a[168:171], a[136:139], v[116:119]
M v[116:119], a[172:175], a[140:143], v[116:119]
M v[112:115], a[172:175], a[132:135], v[112:115]
M v[112:115], a[168:171], a[128:131], v[112:115]
M v[108:111], a[168:171], a[120:123], v[108:111]
M v[108:111], a[172:175], a[124:127], v[108:111]
 ds_read_b64_tr_b16 a[68:69], v1 offset:24576
 ds_read_b64_tr_b16 a[70:71], v1 offset:25600
M v[104:107], a[172:175], a[116:119], v[104:107]
 buffer_load_dwordx4 v13, s[48:51], s22 offen offset:1024   lds
M v[104:107], a[168:171], a[112:115], v[104:107]
M v[100:103], a[168:171], a[104:107], v[100:103]
M v[100:103], a[172:175], a[108:111], v[100:103]
 s_waitcnt lgkmcnt(4)
M v[96:99], a[172:175], a[100:103], v[96:99]
M v[96:99], a[168:171], a[96:99], v[96:99]
M v[128:131], a[160:163], a[96:99], v[128:131]
 ds_read_b128 a[168:171], v5 offset:51200
 ds_read_b128 a[172:175], v6 offset:51200
M v[128:131], a[164:167], a[100:103], v[128:131]
 ds_read_b64_tr_b16 a[72:73], v2 offset:16384
 ds_read_b64_tr_b16 a[74:75], v2 offset:17408
M v[132:135], a[164:167], a[108:111], v[132:135]
 buffer_load_dwordx4 v14, s[48:51], s22 offen offset:2048   lds
M v[132:135], a[160:163], a[104:107], v[132:135]
M v[136:139], a[160:163], a[112:115], v[136:139]
M v[136:139], a[164:167], a[116:119], v[136:139]
M v[140:143], a[164:167], a[124:127], v[140:143]
M v[140:143], a[160:163], a[120:123], v[140:143]
 ds_read_b64_tr_b16 a[76:77], v2 offset:24576
 ds_read_b64_tr_b16 a[78:79], v2 offset:25600
M v[144:147], a[160:163], a[128:131], v[144:147]
 buffer_load_dwordx4 v15, s[48:51], s22 offen offset:3072   lds
M v[144:147], a[164:167], a[132:135], v[144:147]
 s_add_u32 s22, s22, 2097152
M v[148:151], a[164:167], a[140:143], v[148:151]
M v[148:151], a[160:163], a[136:139], v[148:151]
M v[152:155], a[160:163], a[144:147], v[152:155]
M v[152:155], a[164:167], a[148:151], v[152:155]
 s_waitcnt lgkmcnt(4)
M v[156:159], a[164:167], a[156:159], v[156:159]
 s_add_u32 m0, s23, 0
 ds_read_b64_tr_b16 a[80:81], v3 offset:16384
 ds_read_b64_tr_b16 a[82:83], v3 offset:17408
M v[156:159], a[160:163], a[152:155], v[156:159]
 buffer_load_dwordx4 v8, s[52:55], s28 offen offset:0   lds
M v[188:191], a[168:171], a[152:155], v[188:191]
 ds_read_b128 a[160:163], v5 offset:53248
 ds_read_b128 a[164:167], v6 offset:53248
M v[188:191], a[172:175], a[156:159], v[188:191]
M v[184:187], a[172:175], a[148:151], v[184:187]
M v[184:187], a[168:171], a[144:147], v[184:187]
M v[180:183], a[168:171], a[136:139], v[180:183]
M v[180:183], a[172:175], a[140:143], v[180:183]
 ds_read_b64_tr_b16 a[84:85], v3 offset:24576
 ds_read_b64_tr_b16 a[86:87], v3 offset:25600
M v[176:179], a[172:175], a[132:135], v[176:179]
 buffer_load_dwordx4 v9, s[52:55], s28 offen offset:1024   lds
M v[176:179], a[168:171], a[128:131], v[176:179]
M v[172:175], a[168:171], a[120:123], v[172:175]
M v[172:175], a[172:175], a[124:127], v[172:175]
M v[168:171], a[172:175], a[116:119], v[168:171]
M v[168:171], a[168:171], a[112:115], v[168:171]
M v[164:167], a[168:171], a[104:107], v[164:167]
 ds_read_b64_tr_b16 a[88:89], v4 offset:16384
 ds_read_b64_tr_b16 a[90:91], v4 offset:17408
M v[164:167], a[172:175], a[108:111], v[164:167]
 s_waitcnt lgkmcnt(4)
M v[160:163], a[172:175], a[100:103], v[160:163]
 buffer_load_dwordx4 v10, s[52:55], s28 offen offset:2048   lds
M v[160:163], a[168:171], a[96:99], v[160:163]
M v[192:195], a[160:163], a[96:99], v[192:195]
 ds_read_b128 a[168:171], v5 offset:55296
 ds_read_b128 a[172:175], v6 offset:55296
M v[192:195], a[164:167], a[100:103], v[192:195]
M v[196:199], a[164:167], a[108:111], v[196:199]
M v[196:199], a[160:163], a[104:107], v[196:199]
 ds_read_b64_tr_b16 a[92:93], v4 offset:24576
 ds_read_b64_tr_b16 a[94:95], v4 offset:25600
M v[200:203], a[160:163], a[112:115], v[200:203]
 buffer_load_dwordx4 v11, s[52:55], s28 offen offset:3072   lds
M v[200:203], a[164:167], a[116:119], v[200:203]
 s_add_u32 s28, s28, 128
 v_sub_f32 v160, v160, v27
 v_sub_f32 v161, v161, v27
M v[204:207], a[164:167], a[124:127], v[204:207]
 v_sub_f32 v162, v162, v27
 v_sub_f32 v163, v163, v27
M v[204:207], a[160:163], a[120:123], v[204:207]
 v_sub_f32 v164, v164, v27
 v_sub_f32 v165, v165, v27
M v[208:211], a[160:163], a[128:131], v[208:211]
 v_sub_f32 v166, v166, v27
 v_sub_f32 v167, v167, v27
M v[208:211], a[164:167], a[132:135], v[208:211]
 v_sub_f32 v168, v168, v27
 v_sub_f32 v169, v169, v27
M v[212:215], a[164:167], a[140:143], v[212:215]
 v_sub_f32 v170, v170, v27
 v_sub_f32 v171, v171, v27
M v[212:215], a[160:163], a[136:139], v[212:215]
 v_sub_f32 v172, v172, v27
 v_sub_f32 v173, v173, v27
M v[216:219], a[160:163], a[144:147], v[216:219]
 v_sub_f32 v174, v174, v27
 v_sub_f32 v175, v175, v27
M v[216:219], a[164:167], a[148:151], v[216:219]
 s_waitcnt lgkmcnt(2)
 v_sub_f32 v176, v176, v27
 v_sub_f32 v177, v177, v27
M v[220:223], a[164:167], a[156:159], v[220:223]
 s_waitcnt vmcnt(16) lgkmcnt(0)
 v_sub_f32 v178, v178, v27
 v_sub_f32 v179, v179, v27
M v[220:223], a[160:163], a[152:155], v[220:223]
 s_barrier
M v[252:255], a[168:171], a[152:155], v[252:255]
 ds_read_b128 a[160:163], v5 offset:0
 ds_read_b128 a[164:167], v6 offset:0
M v[252:255], a[172:175], a[156:159], v[252:255]
 v_and_b32 v26, 48, v0
 v_lshlrev_b32 v26, 17, v26
M v[248:251], a[172:175], a[148:151], v[248:251]
 v_or_b32 v26, v26, v0
 v_lshl_add_u32 v26, v26, 7, s95
M v[248:251], a[168:171], a[144:147], v[248:251]
 buffer_load_dword a240, v26, s[76:79], 0 offen offset:0
M v[244:247], a[168:171], a[136:139], v[244:247]
 v_sub_f32 v180, v180, v27
 v_sub_f32 v181, v181, v27
M v[244:247], a[172:175], a[140:143], v[244:247]
 v_sub_f32 v182, v182, v27
 v_sub_f32 v183, v183, v27
M v[240:243], a[172:175], a[132:135], v[240:243]
 v_sub_f32 v184, v184, v27
 v_sub_f32 v185, v185, v27
M v[240:243], a[168:171], a[128:131], v[240:243]
 v_sub_f32 v186, v186, v27
 v_sub_f32 v187, v187, v27
M v[236:239], a[168:171], a[120:123], v[236:239]
 v_sub_f32 v188, v188, v27
 v_sub_f32 v189, v189, v27
M v[236:239], a[172:175], a[124:127], v[236:239]
 v_sub_f32 v190, v190, v27
 v_sub_f32 v191, v191, v27
M v[232:235], a[172:175], a[116:119], v[232:235]
 v_sub_f32 v192, v192, v27
 v_sub_f32 v193, v193, v27
M v[232:235], a[168:171], a[112:115], v[232:235]
 v_sub_f32 v194, v194, v27
 v_sub_f32 v195, v195, v27
M v[228:231], a[168:171], a[104:107], v[228:231]
 v_sub_f32 v196, v196, v27
 v_sub_f32 v197, v197, v27
M v[228:231], a[172:175], a[108:111], v[228:231]
 s_waitcnt lgkmcnt(0)
 v_sub_f32 v198, v198, v27
 v_sub_f32 v199, v199, v27
M v[224:227], a[172:175], a[100:103], v[224:227]
 v_sub_f32 v200, v200, v27
 v_sub_f32 v201, v201, v27
M v[224:227], a[168:171], a[96:99], v[224:227]
 v_sub_f32 v202, v202, v27
 v_sub_f32 v203, v203, v27
M a[0:3], a[160:163], a[32:35], a[0:3]
 ds_read_b128 a[168:171], v5 offset:2048
 ds_read_b128 a[172:175], v6 offset:2048
M a[0:3], a[164:167], a[36:39], a[0:3]
 ds_read_b64_tr_b16 a[96:97], v1 offset:32768
 ds_read_b64_tr_b16 a[98:99], v1 offset:33792
M a[4:7], a[164:167], a[44:47], a[4:7]
 s_add_u32 m0, s24, 49152
 v_lshrrev_b32 v28, 4, v0
 v_add_u32 v28, 0, v28
M a[4:7], a[160:163], a[40:43], a[4:7]
 buffer_load_dwordx4 v12, s[48:51], s22 offen offset:0   lds
M a[8:11], a[160:163], a[48:51], a[8:11]
 v_and_b32 v29, 7, v0
 v_xor_b32 v28, v28, v29
M a[8:11], a[164:167], a[52:55], a[8:11]
 v_lshlrev_b32 v28, 4, v28
 v_lshrrev_b32 v29, 3, v0
M a[12:15], a[164:167], a[60:63], a[12:15]
 ds_read_b64_tr_b16 a[100:101], v1 offset:40960
 ds_read_b64_tr_b16 a[102:103], v1 offset:41984
M a[12:15], a[160:163], a[56:59], a[12:15]
 buffer_load_dwordx4 v13, s[48:51], s22 offen offset:1024   lds
M a[16:19], a[160:163], a[64:67], a[16:19]
 v_mul_u32_u24 v29, 896, v29
 s_mul_i32 s64, s20, 28672
M a[16:19], a[164:167], a[68:71], a[16:19]
 buffer_load_dwordx4 v14, s[48:51], s22 offen offset:2048   lds
M a[20:23], a[164:167], a[76:79], a[20:23]
 s_add_u32 s64, s64, 0
 v_add3_u32 v16, v29, v28, s64
M a[20:23], a[160:163], a[72:75], a[20:23]
 ds_read_b64_tr_b16 a[104:105], v2 offset:32768
 ds_read_b64_tr_b16 a[106:107], v2 offset:33792
M a[24:27], a[160:163], a[80:83], a[24:27]
 v_add_u32 v18, 12288, v16
 v_lshrrev_b32 v28, 4, v0
M a[24:27], a[164:167], a[84:87], a[24:27]
 s_waitcnt lgkmcnt(6)
 v_add_u32 v28, 4, v28
 v_and_b32 v29, 7, v0
M a[28:31], a[164:167], a[92:95], a[28:31]
 buffer_load_dwordx4 v15, s[48:51], s22 offen offset:3072   lds
M a[28:31], a[160:163], a[88:91], a[28:31]
 s_sub_u32 s22, s22, 2097024
 v_xor_b32 v28, v28, v29
 v_lshlrev_b32 v28, 4, v28
M v[60:63], a[168:171], a[88:91], v[60:63]
 s_add_u32 m0, s23, 16384
 ds_read_b128 a[160:163], v5 offset:4096
 ds_read_b128 a[164:167], v6 offset:4096
M v[60:63], a[172:175], a[92:95], v[60:63]
 ds_read_b64_tr_b16 a[108:109], v2 offset:40960
 ds_read_b64_tr_b16 a[110:111], v2 offset:41984
M v[56:59], a[172:175], a[84:87], v[56:59]
 buffer_load_dwordx4 v8, s[52:55], s28 offen offset:0   lds
M v[56:59], a[168:171], a[80:83], v[56:59]
 v_lshrrev_b32 v29, 3, v0
 v_mul_u32_u24 v29, 896, v29
M v[52:55], a[168:171], a[72:75], v[52:55]
 buffer_load_dwordx4 v9, s[52:55], s28 offen offset:1024   lds
M v[52:55], a[172:175], a[76:79], v[52:55]
 ds_read_b64_tr_b16 a[112:113], v3 offset:32768
 ds_read_b64_tr_b16 a[114:115], v3 offset:33792
M v[48:51], a[172:175], a[68:71], v[48:51]
 s_mul_i32 s64, s20, 28672
 s_add_u32 s64, s64, 6144
M v[48:51], a[168:171], a[64:67], v[48:51]
 buffer_load_dwordx4 v10, s[52:55], s28 offen offset:2048   lds
M v[44:47], a[168:171], a[56:59], v[44:47]
 v_add3_u32 v17, v29, v28, s64
 v_add_u32 v19, 12288, v17
M v[44:47], a[172:175], a[60:63], v[44:47]
 v_add_u32 v20, 0x20000, v1
 v_add_u32 v21, 0x20000, v2
M v[40:43], a[172:175], a[52:55], v[40:43]
 ds_read_b64_tr_b16 a[116:117], v3 offset:40960
 ds_read_b64_tr_b16 a[118:119], v3 offset:41984
M v[40:43], a[168:171], a[48:51], v[40:43]
 buffer_load_dwordx4 v11, s[52:55], s28 offen offset:3072   lds
M v[36:39], a[168:171], a[40:43], v[36:39]
 s_add_u32 s28, s28, 1048448
 v_add_u32 v22, 0x20000, v3
 v_add_u32 v23, 0x20000, v4
M v[36:39], a[172:175], a[44:47], v[36:39]
 s_waitcnt lgkmcnt(6)
 v_sub_f32 v204, v204, v27
 v_sub_f32 v205, v205, v27
M v[32:35], a[172:175], a[36:39], v[32:35]
 s_add_u32 m0, s23, 131072
 v_sub_f32 v206, v206, v27
 v_sub_f32 v207, v207, v27
M v[32:35], a[168:171], a[32:35], v[32:35]
 ds_read_b64_tr_b16 a[120:121], v4 offset:32768
 ds_read_b64_tr_b16 a[122:123], v4 offset:33792
M v[64:67], a[160:163], a[32:35], v[64:67]
 ds_read_b128 a[168:171], v5 offset:6144
 ds_read_b128 a[172:175], v6 offset:6144
M v[64:67], a[164:167], a[36:39], v[64:67]
 buffer_load_dwordx4 v8, s[52:55], s28 offen offset:0   lds
M v[68:71], a[164:167], a[44:47], v[68:71]
 buffer_load_dwordx4 v9, s[52:55], s28 offen offset:1024   lds
M v[68:71], a[160:163], a[40:43], v[68:71]
 v_sub_f32 v208, v208, v27
 v_sub_f32 v209, v209, v27
M v[72:75], a[160:163], a[48:51], v[72:75]
 ds_read_b64_tr_b16 a[124:125], v4 offset:40960
 ds_read_b64_tr_b16 a[126:127], v4 offset:41984
M v[72:75], a[164:167], a[52:55], v[72:75]
 buffer_load_dwordx4 v10, s[52:55], s28 offen offset:2048   lds
M v[76:79], a[164:167], a[60:63], v[76:79]
 v_sub_f32 v210, v210, v27
 v_sub_f32 v211, v211, v27
M v[76:79], a[160:163], a[56:59], v[76:79]
 v_sub_f32 v212, v212, v27
 v_sub_f32 v213, v213, v27
M v[80:83], a[160:163], a[64:67], v[80:83]
 buffer_load_dwordx4 v11, s[52:55], s28 offen offset:3072   lds
M v[80:83], a[164:167], a[68:71], v[80:83]
 s_sub_u32 s28, s28, 524288
 v_sub_f32 v214, v214, v27
 v_sub_f32 v215, v215, v27
M v[84:87], a[164:167], a[76:79], v[84:87]
 v_sub_f32 v216, v216, v27
 v_sub_f32 v217, v217, v27
M v[84:87], a[160:163], a[72:75], v[84:87]
 v_sub_f32 v218, v218, v27
 v_sub_f32 v219, v219, v27
M v[88:91], a[160:163], a[80:83], v[88:91]
 v_sub_f32 v220, v220, v27
 v_sub_f32 v221, v221, v27
M v[88:91], a[164:167], a[84:87], v[88:91]
 s_waitcnt lgkmcnt(2)
 v_sub_f32 v222, v222, v27
 v_sub_f32 v223, v223, v27
M v[92:95], a[164:167], a[92:95], v[92:95]
 s_waitcnt vmcnt(21) lgkmcnt(0)
 v_sub_f32 v224, v224, v27
 v_sub_f32 v225, v225, v27
M v[92:95], a[160:163], a[88:91], v[92:95]
 s_barrier
M v[124:127], a[168:171], a[88:91], v[124:127]
 ds_read_b128 a[160:163], v5 offset:16384
 ds_read_b128 a[164:167], v6 offset:16384
M v[124:127], a[172:175], a[92:95], v[124:127]
 v_sub_f32 v226, v226, v27
 v_sub_f32 v227, v227, v27
M v[120:123], a[172:175], a[84:87], v[120:123]
 s_add_u32 m0, s24, 0
 ds_read_b64_tr_b16 a[128:129], v1 offset:49152
 ds_read_b64_tr_b16 a[130:131], v1 offset:50176
M v[120:123], a[168:171], a[80:83], v[120:123]
 buffer_load_dwordx4 v16, s[56:59], s29 offen offset:0   lds
M v[116:119], a[168:171], a[72:75], v[116:119]
 s_mul_i32 s72, s41, 16512
 v_sub_f32 v228, v228, v27
M v[116:119], a[172:175], a[76:79], v[116:119]
 s_add_u32 s46, s72, 234946560
 v_sub_f32 v229, v229, v27
 v_sub_f32 v230, v230, v27
M v[112:115], a[172:175], a[68:71], v[112:115]
 s_and_b32 s64, s41, 7
 s_lshr_b32 s64, s101, s64
 s_and_b32 s64, s64, 1
M v[112:115], a[168:171], a[64:67], v[112:115]
 buffer_load_dwordx4 v17, s[56:59], s29 offen offset:1024   lds
M v[108:111], a[168:171], a[56:59], v[108:111]
 s_lshl_b32 s64, s64, 13
 v_sub_f32 v231, v231, v27
M v[108:111], a[172:175], a[60:63], v[108:111]
 s_add_u32 s46, s46, s64
 ds_read_b64_tr_b16 a[132:133], v1 offset:57344
 ds_read_b64_tr_b16 a[134:135], v1 offset:58368
M v[104:107], a[172:175], a[52:55], v[104:107]
 s_lshl_b32 s45, s42, 7
 v_sub_f32 v232, v232, v27
 v_sub_f32 v233, v233, v27
M v[104:107], a[168:171], a[48:51], v[104:107]
 s_add_u32 s45, s45, s46
 s_sub_u32 s66, 15, s42
 s_min_u32 s66, s66, s42
M v[100:103], a[168:171], a[40:43], v[100:103]
 buffer_load_dwordx4 v18, s[56:59], s29 offen offset:2048   lds
M v[100:103], a[172:175], a[44:47], v[100:103]
 s_waitcnt lgkmcnt(4)
 s_lshl_b32 s47, s66, 7
 v_sub_f32 v234, v234, v27
M v[96:99], a[172:175], a[36:39], v[96:99]
 s_add_u32 s47, s47, s46
 v_sub_f32 v235, v235, v27
 v_sub_f32 v236, v236, v27
M v[96:99], a[168:171], a[32:35], v[96:99]
 s_add_u32 s47, s47, 2112
 v_sub_f32 v237, v237, v27
 v_sub_f32 v238, v238, v27
M v[128:131], a[160:163], a[32:35], v[128:131]
 s_lshl2_add_u32 s47, s20, s47
 ds_read_b128 a[168:171], v5 offset:18432
 ds_read_b128 a[172:175], v6 offset:18432
M v[128:131], a[164:167], a[36:39], v[128:131]
 s_lshl_b32 s65, s27, 3
 ds_read_b64_tr_b16 a[136:137], v2 offset:49152
 ds_read_b64_tr_b16 a[138:139], v2 offset:50176
M v[132:135], a[164:167], a[44:47], v[132:135]
 buffer_load_dwordx4 v19, s[56:59], s29 offen offset:3072   lds
M v[132:135], a[160:163], a[40:43], v[132:135]
 s_add_u32 s29, s29, 128
 s_add_u32 s65, s65, s66
 v_sub_f32 v239, v239, v27
M v[136:139], a[160:163], a[48:51], v[136:139]
 s_mul_i32 s34, s65, 262144
 s_add_u32 s34, s34, 167772160
 s_lshl_b32 s65, s42, 4
M v[136:139], a[164:167], a[52:55], v[136:139]
 s_add_u32 m0, s23, 32768
 s_add_u32 s65, s65, s41
 s_mul_i32 s33, s65, 262144
M v[140:143], a[164:167], a[60:63], v[140:143]
 buffer_load_dwordx4 v8, s[52:55], s28 offen offset:0   lds
M v[140:143], a[160:163], a[56:59], v[140:143]
 ds_read_b64_tr_b16 a[140:141], v2 offset:57344
 ds_read_b64_tr_b16 a[142:143], v2 offset:58368
M v[144:147], a[160:163], a[64:67], v[144:147]
 s_mul_i32 s65, s20, 65536
 v_sub_f32 v240, v240, v27
M v[144:147], a[164:167], a[68:71], v[144:147]
 s_add_u32 s33, s33, s65
 s_add_u32 s33, s33, 67108864
 s_sub_u32 s65, 15, s66
M v[148:151], a[164:167], a[76:79], v[148:151]
 buffer_load_dwordx4 v9, s[52:55], s28 offen offset:1024   lds
M v[148:151], a[160:163], a[72:75], v[148:151]
 s_lshl_b32 s65, s65, 17
 v_sub_f32 v241, v241, v27
M v[152:155], a[160:163], a[80:83], v[152:155]
 s_lshl_b32 s64, s27, 21
 s_add_u32 s32, s64, s65
 s_lshl_b32 s65, s20, 15
M v[152:155], a[164:167], a[84:87], v[152:155]
 s_waitcnt lgkmcnt(4)
 s_add_u32 s32, s32, s65
 v_sub_f32 v242, v242, v27
M v[156:159], a[164:167], a[92:95], v[156:159]
 s_add_u32 s32, s32, 134217728
 ds_read_b64_tr_b16 a[144:145], v3 offset:49152
 ds_read_b64_tr_b16 a[146:147], v3 offset:50176
M v[156:159], a[160:163], a[88:91], v[156:159]
 buffer_load_dwordx4 v10, s[52:55], s28 offen offset:2048   lds
M v[188:191], a[168:171], a[88:91], v[188:191]
 ds_read_b128 a[160:163], v5 offset:20480
 ds_read_b128 a[164:167], v6 offset:20480
M v[188:191], a[172:175], a[92:95], v[188:191]
 s_and_b32 s64, s41, 7
 v_sub_f32 v243, v243, v27
M v[184:187], a[172:175], a[84:87], v[184:187]
 s_lshr_b32 s64, s101, s64
 v_sub_f32 v244, v244, v27
 v_sub_f32 v245, v245, v27
M v[184:187], a[168:171], a[80:83], v[184:187]
 s_lshr_b32 s65, s41, 3
 s_xor_b32 s64, s64, s65
 s_and_b32 s64, s64, 1
M v[180:183], a[168:171], a[72:75], v[180:183]
 buffer_load_dwordx4 v11, s[52:55], s28 offen offset:3072   lds
M v[180:183], a[172:175], a[76:79], v[180:183]
 s_add_u32 s28, s28, 524416
 ds_read_b64_tr_b16 a[148:149], v3 offset:57344
 ds_read_b64_tr_b16 a[150:151], v3 offset:58368
M v[176:179], a[172:175], a[68:71], v[176:179]
 s_lshl_b32 s92, s64, 13
 v_sub_f32 v246, v246, v27
M v[176:179], a[168:171], a[64:67], v[176:179]
 s_add_u32 s93, s93, s92
 s_add_u32 s34, s34, s92
 s_add_u32 s32, s32, s92
M v[172:175], a[168:171], a[56:59], v[172:175]
 s_add_u32 m0, s23, 147456
 s_lshl_b32 s64, s20, 1
 s_lshr_b32 s64, s101, s64
M v[172:175], a[172:175], a[60:63], v[172:175]
 buffer_load_dwordx4 v8, s[52:55], s28 offen offset:0   lds
M v[168:171], a[172:175], a[52:55], v[168:171]
 s_xor_b32 s64, s64, s65
 v_sub_f32 v247, v247, v27
M v[168:171], a[168:171], a[48:51], v[168:171]
 s_and_b32 s64, s64, 1
 v_sub_f32 v248, v248, v27
 v_sub_f32 v249, v249, v27
M v[164:167], a[168:171], a[40:43], v[164:167]
 s_lshl_b32 s64, s64, 13
 ds_read_b64_tr_b16 a[152:153], v4 offset:49152
 ds_read_b64_tr_b16 a[154:155], v4 offset:50176
M v[164:167], a[172:175], a[44:47], v[164:167]
 s_waitcnt lgkmcnt(4)
 s_add_u32 s33, s33, s64
 s_mov_b32 s31, 0x53800000
M v[160:163], a[172:175], a[36:39], v[160:163]
 buffer_load_dwordx4 v9, s[52:55], s28 offen offset:1024   lds
M v[160:163], a[168:171], a[32:35], v[160:163]
 s_mov_b32 s40, 1
 v_sub_f32 v250, v250, v27
M v[192:195], a[160:163], a[32:35], v[192:195]
 s_sub_u32 s64, s42, 10
 ds_read_b128 a[168:171], v5 offset:22528
 ds_read_b128 a[172:175], v6 offset:22528
M v[192:195], a[164:167], a[36:39], v[192:195]
 s_and_b32 s35, s64, 536870912
 v_sub_f32 v251, v251, v27
 v_sub_f32 v252, v252, v27
M v[196:199], a[164:167], a[44:47], v[196:199]
 buffer_load_dwordx4 v10, s[52:55], s28 offen offset:2048   lds
M v[196:199], a[160:163], a[40:43], v[196:199]
 ds_read_b64_tr_b16 a[156:157], v4 offset:57344
 ds_read_b64_tr_b16 a[158:159], v4 offset:58368
M v[200:203], a[160:163], a[48:51], v[200:203]
 v_sub_f32 v253, v253, v27
 v_sub_f32 v254, v254, v27
M v[200:203], a[164:167], a[52:55], v[200:203]
 v_sub_f32 v255, v255, v27
M v[204:207], a[164:167], a[60:63], v[204:207]
M v[204:207], a[160:163], a[56:59], v[204:207]
 buffer_load_dwordx4 v11, s[52:55], s28 offen offset:3072   lds
M v[208:211], a[160:163], a[64:67], v[208:211]
 s_sub_u32 s28, s28, 524288
M v[208:211], a[164:167], a[68:71], v[208:211]
M v[212:215], a[164:167], a[76:79], v[212:215]
M v[212:215], a[160:163], a[72:75], v[212:215]
M v[216:219], a[160:163], a[80:83], v[216:219]
M v[216:219], a[164:167], a[84:87], v[216:219]
 s_waitcnt lgkmcnt(2)
M v[220:223], a[164:167], a[92:95], v[220:223]
 s_waitcnt vmcnt(25) lgkmcnt(0)
M v[220:223], a[160:163], a[88:91], v[220:223]
 s_barrier
M v[252:255], a[168:171], a[88:91], v[252:255]
 ds_read_b128 a[160:163], v5 offset:32768
 ds_read_b128 a[164:167], v6 offset:32768
M v[252:255], a[172:175], a[92:95], v[252:255]
M v[248:251], a[172:175], a[84:87], v[248:251]
M v[248:251], a[168:171], a[80:83], v[248:251]
M v[244:247], a[168:171], a[72:75], v[244:247]
M v[244:247], a[172:175], a[76:79], v[244:247]
M v[240:243], a[172:175], a[68:71], v[240:243]
M v[240:243], a[168:171], a[64:67], v[240:243]
M v[236:239], a[168:171], a[56:59], v[236:239]
M v[236:239], a[172:175], a[60:63], v[236:239]
M v[232:235], a[172:175], a[52:55], v[232:235]
M v[232:235], a[168:171], a[48:51], v[232:235]
M v[228:231], a[168:171], a[40:43], v[228:231]
M v[228:231], a[172:175], a[44:47], v[228:231]
 s_waitcnt lgkmcnt(0)
M v[224:227], a[172:175], a[36:39], v[224:227]
M v[224:227], a[168:171], a[32:35], v[224:227]
M a[0:3], a[160:163], a[96:99], a[0:3]
 ds_read_b128 a[168:171], v5 offset:34816
 ds_read_b128 a[172:175], v6 offset:34816
M a[0:3], a[164:167], a[100:103], a[0:3]
 ds_read_b64_tr_b16 a[32:33], v1 offset:0
 ds_read_b64_tr_b16 a[34:35], v1 offset:1024
M a[4:7], a[164:167], a[108:111], a[4:7]
 s_add_u32 m0, s24, 16384
M a[4:7], a[160:163], a[104:107], a[4:7]
 buffer_load_dwordx4 v16, s[56:59], s29 offen offset:0   lds
M a[8:11], a[160:163], a[112:115], a[8:11]
M a[8:11], a[164:167], a[116:119], a[8:11]
M a[12:15], a[164:167], a[124:127], a[12:15]
 ds_read_b64_tr_b16 a[36:37], v1 offset:8192
 ds_read_b64_tr_b16 a[38:39], v1 offset:9216
M a[12:15], a[160:163], a[120:123], a[12:15]
M a[16:19], a[160:163], a[128:131], a[16:19]
 buffer_load_dwordx4 v17, s[56:59], s29 offen offset:1024   lds
M a[16:19], a[164:167], a[132:135], a[16:19]
M a[20:23], a[164:167], a[140:143], a[20:23]
M a[20:23], a[160:163], a[136:139], a[20:23]
 ds_read_b64_tr_b16 a[40:41], v2 offset:0
 ds_read_b64_tr_b16 a[42:43], v2 offset:1024
M a[24:27], a[160:163], a[144:147], a[24:27]
M a[24:27], a[164:167], a[148:151], a[24:27]
 s_waitcnt lgkmcnt(6)
 buffer_load_dwordx4 v18, s[56:59], s29 offen offset:2048   lds
M a[28:31], a[164:167], a[156:159], a[28:31]
M a[28:31], a[160:163], a[152:155], a[28:31]
M v[32:35], a[168:171], a[96:99], v[32:35]
 ds_read_b128 a[160:163], v5 offset:36864
 ds_read_b128 a[164:167], v6 offset:36864
M v[32:35], a[172:175], a[100:103], v[32:35]
 ds_read_b64_tr_b16 a[44:45], v2 offset:8192
 ds_read_b64_tr_b16 a[46:47], v2 offset:9216
M v[36:39], a[172:175], a[108:111], v[36:39]
 buffer_load_dwordx4 v19, s[56:59], s29 offen offset:3072   lds
M v[36:39], a[168:171], a[104:107], v[36:39]
 s_add_u32 s29, s29, 128
M v[40:43], a[168:171], a[112:115], v[40:43]
M v[40:43], a[172:175], a[116:119], v[40:43]
 ds_read_b64_tr_b16 a[48:49], v3 offset:0
 ds_read_b64_tr_b16 a[50:51], v3 offset:1024
M v[44:47], a[172:175], a[124:127], v[44:47]
 s_add_u32 m0, s23, 49152
 v_accvgpr_read_b32 v24, a0
 v_accvgpr_read_b32 v25, a1
M v[44:47], a[168:171], a[120:123], v[44:47]
 buffer_load_dwordx4 v8, s[52:55], s28 offen offset:0   lds
M v[48:51], a[168:171], a[128:131], v[48:51]
 v_accvgpr_read_b32 v26, a2
 v_accvgpr_read_b32 v27, a3
M v[48:51], a[172:175], a[132:135], v[48:51]
 v_cvt_pk_bf16_f32 v24, v24, v25
 v_cvt_pk_bf16_f32 v25, v26, v27
M v[52:55], a[172:175], a[140:143], v[52:55]
 ds_read_b64_tr_b16 a[52:53], v3 offset:8192
 ds_read_b64_tr_b16 a[54:55], v3 offset:9216
M v[52:55], a[168:171], a[136:139], v[52:55]
 v_cvt_pk_bf16_f32 v26, v32, v33
 v_cvt_pk_bf16_f32 v27, v34, v35
M v[56:59], a[168:171], a[144:147], v[56:59]
 s_add_u32 s3, s93, 0
 buffer_load_dwordx4 v9, s[52:55], s28 offen offset:1024   lds
M v[56:59], a[172:175], a[148:151], v[56:59]
 s_waitcnt lgkmcnt(6)
M v[60:63], a[172:175], a[156:159], v[60:63]
 buffer_store_dwordx4 v[24:27], v7, s[8:11], s3 offen offset:0 sc1
M v[60:63], a[168:171], a[152:155], v[60:63]
 ds_read_b64_tr_b16 a[56:57], v4 offset:0
 ds_read_b64_tr_b16 a[58:59], v4 offset:1024
M v[64:67], a[160:163], a[96:99], v[64:67]
 ds_read_b128 a[168:171], v5 offset:38912
 ds_read_b128 a[172:175], v6 offset:38912
M v[64:67], a[164:167], a[100:103], v[64:67]
 buffer_load_dwordx4 v10, s[52:55], s28 offen offset:2048   lds
M v[68:71], a[164:167], a[108:111], v[68:71]
 v_accvgpr_read_b32 v24, a4
 v_accvgpr_read_b32 v25, a5
M v[68:71], a[160:163], a[104:107], v[68:71]
 v_accvgpr_read_b32 v26, a6
 v_accvgpr_read_b32 v27, a7
M v[72:75], a[160:163], a[112:115], v[72:75]
 ds_read_b64_tr_b16 a[60:61], v4 offset:8192
 ds_read_b64_tr_b16 a[62:63], v4 offset:9216
M v[72:75], a[164:167], a[116:119], v[72:75]
 v_cvt_pk_bf16_f32 v24, v24, v25
 v_cvt_pk_bf16_f32 v25, v26, v27
M v[76:79], a[164:167], a[124:127], v[76:79]
 buffer_load_dwordx4 v11, s[52:55], s28 offen offset:3072   lds
M v[76:79], a[160:163], a[120:123], v[76:79]
 s_add_u32 s28, s28, 1048448
 v_cvt_pk_bf16_f32 v26, v36, v37
 v_cvt_pk_bf16_f32 v27, v38, v39
M v[80:83], a[160:163], a[128:131], v[80:83]
M v[80:83], a[164:167], a[132:135], v[80:83]
M v[84:87], a[164:167], a[140:143], v[84:87]
 buffer_store_dwordx4 v[24:27], v7, s[8:11], s3 offen offset:2048 sc1
M v[84:87], a[160:163], a[136:139], v[84:87]
M v[88:91], a[160:163], a[144:147], v[88:91]
M v[88:91], a[164:167], a[148:151], v[88:91]
 s_waitcnt lgkmcnt(2)
M v[92:95], a[164:167], a[156:159], v[92:95]
 s_waitcnt vmcnt(26) lgkmcnt(0)
 v_accvgpr_read_b32 v24, a8
 v_accvgpr_read_b32 v25, a9
M v[92:95], a[160:163], a[152:155], v[92:95]
 s_barrier
M v[96:99], a[168:171], a[96:99], v[96:99]
 ds_read_b128 a[160:163], v5 offset:49152
 ds_read_b128 a[164:167], v6 offset:49152
M v[96:99], a[172:175], a[100:103], v[96:99]
 v_accvgpr_read_b32 v26, a10
 v_accvgpr_read_b32 v27, a11
M v[100:103], a[172:175], a[108:111], v[100:103]
 s_add_u32 m0, s24, 32768
 ds_read_b64_tr_b16 a[64:65], v1 offset:16384
 ds_read_b64_tr_b16 a[66:67], v1 offset:17408
M v[100:103], a[168:171], a[104:107], v[100:103]
 buffer_load_dwordx4 v16, s[56:59], s29 offen offset:0   lds
M v[104:107], a[168:171], a[112:115], v[104:107]
 v_cvt_pk_bf16_f32 v24, v24, v25
 v_cvt_pk_bf16_f32 v25, v26, v27
M v[104:107], a[172:175], a[116:119], v[104:107]
 v_cvt_pk_bf16_f32 v26, v40, v41
 v_cvt_pk_bf16_f32 v27, v42, v43
M v[108:111], a[172:175], a[124:127], v[108:111]
 s_add_u32 s3, s93, 4096
 buffer_store_dwordx4 v[24:27], v7, s[8:11], s3 offen offset:0 sc1
M v[108:111], a[168:171], a[120:123], v[108:111]
 v_cvt_pk_bf16_f32 v64, v64, v65
 v_cvt_pk_bf16_f32 v65, v66, v67
M v[112:115], a[168:171], a[128:131], v[112:115]
 v_cvt_pk_bf16_f32 v66, v96, v97
 v_cvt_pk_bf16_f32 v67, v98, v99
M v[112:115], a[172:175], a[132:135], v[112:115]
 ds_read_b64_tr_b16 a[68:69], v1 offset:24576
 ds_read_b64_tr_b16 a[70:71], v1 offset:25600
M v[116:119], a[172:175], a[140:143], v[116:119]
 buffer_load_dwordx4 v17, s[56:59], s29 offen offset:1024   lds
M v[116:119], a[168:171], a[136:139], v[116:119]
 v_accvgpr_read_b32 v24, a12
 v_accvgpr_read_b32 v25, a13
M v[120:123], a[168:171], a[144:147], v[120:123]
 v_accvgpr_read_b32 v26, a14
 v_accvgpr_read_b32 v27, a15
M v[120:123], a[172:175], a[148:151], v[120:123]
 s_waitcnt lgkmcnt(4)
 v_cvt_pk_bf16_f32 v24, v24, v25
 v_cvt_pk_bf16_f32 v25, v26, v27
M v[124:127], a[172:175], a[156:159], v[124:127]
 v_cvt_pk_bf16_f32 v26, v44, v45
 v_cvt_pk_bf16_f32 v27, v46, v47
M v[124:127], a[168:171], a[152:155], v[124:127]
 buffer_store_dwordx4 v[24:27], v7, s[8:11], s3 offen offset:2048 sc1
M v[128:131], a[160:163], a[96:99], v[128:131]
 ds_read_b128 a[168:171], v5 offset:51200
 ds_read_b128 a[172:175], v6 offset:51200
M v[128:131], a[164:167], a[100:103], v[128:131]
 ds_read_b64_tr_b16 a[72:73], v2 offset:16384
 ds_read_b64_tr_b16 a[74:75], v2 offset:17408
M v[132:135], a[164:167], a[108:111], v[132:135]
 buffer_load_dwordx4 v18, s[56:59], s29 offen offset:2048   lds
M v[132:135], a[160:163], a[104:107], v[132:135]
 v_cvt_pk_bf16_f32 v68, v68, v69
 v_cvt_pk_bf16_f32 v69, v70, v71
M v[136:139], a[160:163], a[112:115], v[136:139]
 v_cvt_pk_bf16_f32 v70, v100, v101
 v_cvt_pk_bf16_f32 v71, v102, v103
M v[136:139], a[164:167], a[116:119], v[136:139]
 v_cvt_pk_bf16_f32 v72, v72, v73
 v_cvt_pk_bf16_f32 v73, v74, v75
M v[140:143], a[164:167], a[124:127], v[140:143]
 v_accvgpr_read_b32 v24, a16
 v_accvgpr_read_b32 v25, a17
M v[140:143], a[160:163], a[120:123], v[140:143]
 ds_read_b64_tr_b16 a[76:77], v2 offset:24576
 ds_read_b64_tr_b16 a[78:79], v2 offset:25600
M v[144:147], a[160:163], a[128:131], v[144:147]
 buffer_load_dwordx4 v19, s[56:59], s29 offen offset:3072   lds
M v[144:147], a[164:167], a[132:135], v[144:147]
 s_add_u32 s29, s29, 128
 v_accvgpr_read_b32 v26, a18
 v_accvgpr_read_b32 v27, a19
M v[148:151], a[164:167], a[140:143], v[148:151]
 v_cvt_pk_bf16_f32 v24, v24, v25
 v_cvt_pk_bf16_f32 v25, v26, v27
M v[148:151], a[160:163], a[136:139], v[148:151]
 v_cvt_pk_bf16_f32 v26, v48, v49
 v_cvt_pk_bf16_f32 v27, v50, v51
M v[152:155], a[160:163], a[144:147], v[152:155]
 s_add_u32 s3, s93, 16384
 buffer_store_dwordx4 v[24:27], v7, s[8:11], s3 offen offset:0 sc1
M v[152:155], a[164:167], a[148:151], v[152:155]
 s_waitcnt lgkmcnt(4)
 v_cvt_pk_bf16_f32 v74, v104, v105
 v_cvt_pk_bf16_f32 v75, v106, v107
M v[156:159], a[164:167], a[156:159], v[156:159]
 s_add_u32 m0, s23, 0
 ds_read_b64_tr_b16 a[80:81], v3 offset:16384
 ds_read_b64_tr_b16 a[82:83], v3 offset:17408
M v[156:159], a[160:163], a[152:155], v[156:159]
 buffer_load_dwordx4 v8, s[52:55], s28 offen offset:0   lds
M v[160:163], a[168:171], a[96:99], v[160:163]
 ds_read_b128 a[160:163], v5 offset:53248
 ds_read_b128 a[164:167], v6 offset:53248
M v[160:163], a[172:175], a[100:103], v[160:163]
 v_cvt_pk_bf16_f32 v76, v76, v77
 v_cvt_pk_bf16_f32 v77, v78, v79
M v[164:167], a[172:175], a[108:111], v[164:167]
 v_accvgpr_read_b32 v24, a20
 v_accvgpr_read_b32 v25, a21
M v[164:167], a[168:171], a[104:107], v[164:167]
 v_accvgpr_read_b32 v26, a22
 v_accvgpr_read_b32 v27, a23
M v[168:171], a[168:171], a[112:115], v[168:171]
 v_cvt_pk_bf16_f32 v24, v24, v25
 v_cvt_pk_bf16_f32 v25, v26, v27
M v[168:171], a[172:175], a[116:119], v[168:171]
 ds_read_b64_tr_b16 a[84:85], v3 offset:24576
 ds_read_b64_tr_b16 a[86:87], v3 offset:25600
M v[172:175], a[172:175], a[124:127], v[172:175]
 buffer_load_dwordx4 v9, s[52:55], s28 offen offset:1024   lds
M v[172:175], a[168:171], a[120:123], v[172:175]
 v_cvt_pk_bf16_f32 v26, v52, v53
 v_cvt_pk_bf16_f32 v27, v54, v55
M v[176:179], a[168:171], a[128:131], v[176:179]
 v_cvt_pk_bf16_f32 v78, v108, v109
 v_cvt_pk_bf16_f32 v79, v110, v111
M v[176:179], a[172:175], a[132:135], v[176:179]
 buffer_store_dwordx4 v[24:27], v7, s[8:11], s3 offen offset:2048 sc1
M v[180:183], a[172:175], a[140:143], v[180:183]
 v_cvt_pk_bf16_f32 v80, v80, v81
 v_cvt_pk_bf16_f32 v81, v82, v83
M v[180:183], a[168:171], a[136:139], v[180:183]
 v_cvt_pk_bf16_f32 v82, v112, v113
 v_cvt_pk_bf16_f32 v83, v114, v115
M v[184:187], a[168:171], a[144:147], v[184:187]
 ds_read_b64_tr_b16 a[88:89], v4 offset:16384
 ds_read_b64_tr_b16 a[90:91], v4 offset:17408
M v[184:187], a[172:175], a[148:151], v[184:187]
 s_waitcnt lgkmcnt(4)
 buffer_load_dwordx4 v10, s[52:55], s28 offen offset:2048   lds
M v[188:191], a[172:175], a[156:159], v[188:191]
 v_accvgpr_read_b32 v24, a24
 v_accvgpr_read_b32 v25, a25
M v[188:191], a[168:171], a[152:155], v[188:191]
 v_accvgpr_read_b32 v26, a26
 v_accvgpr_read_b32 v27, a27
M v[192:195], a[160:163], a[96:99], v[192:195]
 ds_read_b128 a[168:171], v5 offset:55296
 ds_read_b128 a[172:175], v6 offset:55296
M v[192:195], a[164:167], a[100:103], v[192:195]
 v_cvt_pk_bf16_f32 v24, v24, v25
 v_cvt_pk_bf16_f32 v25, v26, v27
M v[196:199], a[164:167], a[108:111], v[196:199]
 v_cvt_pk_bf16_f32 v26, v56, v57
 v_cvt_pk_bf16_f32 v27, v58, v59
M v[196:199], a[160:163], a[104:107], v[196:199]
 s_add_u32 s3, s93, 20480
 ds_read_b64_tr_b16 a[92:93], v4 offset:24576
 ds_read_b64_tr_b16 a[94:95], v4 offset:25600
M v[200:203], a[160:163], a[112:115], v[200:203]
 buffer_load_dwordx4 v11, s[52:55], s28 offen offset:3072   lds
M v[200:203], a[164:167], a[116:119], v[200:203]
 s_add_u32 s28, s28, 128
 v_cvt_pk_bf16_f32 v84, v84, v85
 v_cvt_pk_bf16_f32 v85, v86, v87
M v[204:207], a[164:167], a[124:127], v[204:207]
 v_cvt_pk_bf16_f32 v86, v116, v117
 v_cvt_pk_bf16_f32 v87, v118, v119
M v[204:207], a[160:163], a[120:123], v[204:207]
 v_cvt_pk_bf16_f32 v88, v88, v89
 v_cvt_pk_bf16_f32 v89, v90, v91
M v[208:211], a[160:163], a[128:131], v[208:211]
 buffer_store_dwordx4 v[24:27], v7, s[8:11], s3 offen offset:0 sc1
M v[208:211], a[164:167], a[132:135], v[208:211]
 v_cvt_pk_bf16_f32 v90, v120, v121
 v_cvt_pk_bf16_f32 v91, v122, v123
M v[212:215], a[164:167], a[140:143], v[212:215]
 v_accvgpr_read_b32 v24, a28
 v_accvgpr_read_b32 v25, a29
M v[212:215], a[160:163], a[136:139], v[212:215]
 v_accvgpr_read_b32 v26, a30
 v_accvgpr_read_b32 v27, a31
M v[216:219], a[160:163], a[144:147], v[216:219]
 v_cvt_pk_bf16_f32 v24, v24, v25
 v_cvt_pk_bf16_f32 v25, v26, v27
M v[216:219], a[164:167], a[148:151], v[216:219]
 s_waitcnt lgkmcnt(2)
 v_cvt_pk_bf16_f32 v26, v60, v61
 v_cvt_pk_bf16_f32 v27, v62, v63
M v[220:223], a[164:167], a[156:159], v[220:223]
 s_waitcnt vmcnt(27) lgkmcnt(0)
 buffer_store_dwordx4 v[24:27], v7, s[8:11], s3 offen offset:2048 sc1
M v[220:223], a[160:163], a[152:155], v[220:223]
 s_barrier
M v[224:227], a[168:171], a[96:99], v[224:227]
 ds_read_b128 a[160:163], v5 offset:0
 ds_read_b128 a[164:167], v6 offset:0
M v[224:227], a[172:175], a[100:103], v[224:227]
 v_cvt_pk_bf16_f32 v92, v92, v93
 v_cvt_pk_bf16_f32 v93, v94, v95
M v[228:231], a[172:175], a[108:111], v[228:231]
 v_cvt_pk_bf16_f32 v94, v124, v125
 v_cvt_pk_bf16_f32 v95, v126, v127
M v[228:231], a[168:171], a[104:107], v[228:231]
 v_cvt_pk_bf16_f32 v128, v128, v129
 v_cvt_pk_bf16_f32 v129, v130, v131
M v[232:235], a[168:171], a[112:115], v[232:235]
 v_cvt_pk_bf16_f32 v130, v160, v161
 v_cvt_pk_bf16_f32 v131, v162, v163
M v[232:235], a[172:175], a[116:119], v[232:235]
 v_cvt_pk_bf16_f32 v132, v132, v133
 v_cvt_pk_bf16_f32 v133, v134, v135
M v[236:239], a[172:175], a[124:127], v[236:239]
 v_cvt_pk_bf16_f32 v134, v164, v165
 v_cvt_pk_bf16_f32 v135, v166, v167
M v[236:239], a[168:171], a[120:123], v[236:239]
 v_cvt_pk_bf16_f32 v136, v136, v137
 v_cvt_pk_bf16_f32 v137, v138, v139
M v[240:243], a[168:171], a[128:131], v[240:243]
 v_cvt_pk_bf16_f32 v138, v168, v169
 v_cvt_pk_bf16_f32 v139, v170, v171
M v[240:243], a[172:175], a[132:135], v[240:243]
 v_cvt_pk_bf16_f32 v140, v140, v141
 v_cvt_pk_bf16_f32 v141, v142, v143
M v[244:247], a[172:175], a[140:143], v[244:247]
 v_cvt_pk_bf16_f32 v142, v172, v173
 v_cvt_pk_bf16_f32 v143, v174, v175
M v[244:247], a[168:171], a[136:139], v[244:247]
 v_cvt_pk_bf16_f32 v144, v144, v145
 v_cvt_pk_bf16_f32 v145, v146, v147
M v[248:251], a[168:171], a[144:147], v[248:251]
 v_cvt_pk_bf16_f32 v146, v176, v177
 v_cvt_pk_bf16_f32 v147, v178, v179
M v[248:251], a[172:175], a[148:151], v[248:251]
 s_waitcnt lgkmcnt(0)
 v_cvt_pk_bf16_f32 v148, v148, v149
 v_cvt_pk_bf16_f32 v149, v150, v151
M v[252:255], a[172:175], a[156:159], v[252:255]
 v_cvt_pk_bf16_f32 v150, v180, v181
 v_cvt_pk_bf16_f32 v151, v182, v183
M v[252:255], a[168:171], a[152:155], v[252:255]
 v_cvt_pk_bf16_f32 v152, v152, v153
 v_cvt_pk_bf16_f32 v153, v154, v155
M v[32:35], a[32:35], a[160:163], 0
 s_add_u32 m0, s23, 16384
 ds_read_b128 a[168:171], v5 offset:2048
 ds_read_b128 a[172:175], v6 offset:2048
M v[32:35], a[36:39], a[164:167], v[32:35]
 ds_read_b64_tr_b16 a[96:97], v1 offset:32768
 ds_read_b64_tr_b16 a[98:99], v1 offset:33792
M v[36:39], a[44:47], a[164:167], 0
 buffer_load_dwordx4 v8, s[52:55], s28 offen offset:0   lds
M v[36:39], a[40:43], a[160:163], v[36:39]
 v_cvt_pk_bf16_f32 v154, v184, v185
 v_cvt_pk_bf16_f32 v155, v186, v187
M v[40:43], a[48:51], a[160:163], 0
 ds_read_b64_tr_b16 a[100:101], v1 offset:40960
 ds_read_b64_tr_b16 a[102:103], v1 offset:41984
M v[40:43], a[52:55], a[164:167], v[40:43]
 buffer_load_dwordx4 v9, s[52:55], s28 offen offset:1024   lds
M v[44:47], a[60:63], a[164:167], 0
 v_cvt_pk_bf16_f32 v156, v156, v157
 v_cvt_pk_bf16_f32 v157, v158, v159
M v[44:47], a[56:59], a[160:163], v[44:47]
 ds_read_b64_tr_b16 a[104:105], v2 offset:32768
 ds_read_b64_tr_b16 a[106:107], v2 offset:33792
M v[48:51], a[64:67], a[160:163], 0
 v_cvt_pk_bf16_f32 v158, v188, v189
 v_cvt_pk_bf16_f32 v159, v190, v191
M v[48:51], a[68:71], a[164:167], v[48:51]
 v_cvt_pk_bf16_f32 v192, v192, v193
 v_cvt_pk_bf16_f32 v193, v194, v195
M v[52:55], a[76:79], a[164:167], 0
 ds_read_b64_tr_b16 a[108:109], v2 offset:40960
 ds_read_b64_tr_b16 a[110:111], v2 offset:41984
M v[52:55], a[72:75], a[160:163], v[52:55]
 buffer_load_dwordx4 v10, s[52:55], s28 offen offset:2048   lds
M v[56:59], a[80:83], a[160:163], 0
 v_cvt_pk_bf16_f32 v194, v224, v225
 v_cvt_pk_bf16_f32 v195, v226, v227
M v[56:59], a[84:87], a[164:167], v[56:59]
 s_waitcnt lgkmcnt(8)
 ds_read_b64_tr_b16 a[112:113], v3 offset:32768
 ds_read_b64_tr_b16 a[114:115], v3 offset:33792
M v[60:63], a[92:95], a[164:167], 0
 v_cvt_pk_bf16_f32 v196, v196, v197
 v_cvt_pk_bf16_f32 v197, v198, v199
M v[60:63], a[88:91], a[160:163], v[60:63]
 buffer_load_dwordx4 v11, s[52:55], s28 offen offset:3072   lds
M v[96:99], a[32:35], a[168:171], 0
 s_add_u32 s28, s28, 524160
 ds_read_b128 a[160:163], v5 offset:4096
 ds_read_b128 a[164:167], v6 offset:4096
M v[96:99], a[36:39], a[172:175], v[96:99]
 ds_read_b64_tr_b16 a[116:117], v3 offset:40960
 ds_read_b64_tr_b16 a[118:119], v3 offset:41984
M v[100:103], a[44:47], a[172:175], 0
 v_cvt_pk_bf16_f32 v198, v228, v229
 v_cvt_pk_bf16_f32 v199, v230, v231
M v[100:103], a[40:43], a[168:171], v[100:103]
 s_add_u32 m0, s24, 49152
 ds_read_b64_tr_b16 a[120:121], v4 offset:32768
 ds_read_b64_tr_b16 a[122:123], v4 offset:33792
M v[104:107], a[48:51], a[168:171], 0
 buffer_load_dwordx4 v16, s[56:59], s29 offen offset:0   lds
M v[104:107], a[52:55], a[172:175], v[104:107]
 v_cvt_pk_bf16_f32 v200, v200, v201
 v_cvt_pk_bf16_f32 v201, v202, v203
M v[108:111], a[60:63], a[172:175], 0
 ds_read_b64_tr_b16 a[124:125], v4 offset:40960
 ds_read_b64_tr_b16 a[126:127], v4 offset:41984
M v[108:111], a[56:59], a[168:171], v[108:111]
 v_cvt_pk_bf16_f32 v202, v232, v233
 v_cvt_pk_bf16_f32 v203, v234, v235
M v[112:115], a[64:67], a[168:171], 0
 v_cvt_pk_bf16_f32 v204, v204, v205
 v_cvt_pk_bf16_f32 v205, v206, v207
M v[112:115], a[68:71], a[172:175], v[112:115]
 buffer_load_dwordx4 v17, s[56:59], s29 offen offset:1024   lds
M v[116:119], a[76:79], a[172:175], 0
 v_cvt_pk_bf16_f32 v206, v236, v237
 v_cvt_pk_bf16_f32 v207, v238, v239
M v[116:119], a[72:75], a[168:171], v[116:119]
 v_cvt_pk_bf16_f32 v208, v208, v209
 v_cvt_pk_bf16_f32 v209, v210, v211
M v[120:123], a[80:83], a[168:171], 0
 v_cvt_pk_bf16_f32 v210, v240, v241
 v_cvt_pk_bf16_f32 v211, v242, v243
M v[120:123], a[84:87], a[172:175], v[120:123]
 s_waitcnt lgkmcnt(6)
 v_cvt_pk_bf16_f32 v212, v212, v213
 v_cvt_pk_bf16_f32 v213, v214, v215
M v[124:127], a[92:95], a[172:175], 0
 s_waitcnt vmcnt(21) lgkmcnt(0)
 buffer_load_dwordx4 v18, s[56:59], s29 offen offset:2048   lds
M v[124:127], a[88:91], a[168:171], v[124:127]
 s_barrier
M v[160:163], a[32:35], a[160:163], 0
 ds_read_b128 a[168:171], v5 offset:6144
 ds_read_b128 a[172:175], v6 offset:6144
M v[160:163], a[36:39], a[164:167], v[160:163]
 ds_read_b64_tr_b16 a[128:129], v1 offset:49152
 ds_read_b64_tr_b16 a[130:131], v1 offset:50176
M v[164:167], a[44:47], a[164:167], 0
 v_cvt_pk_bf16_f32 v214, v244, v245
 v_cvt_pk_bf16_f32 v215, v246, v247
M v[164:167], a[40:43], a[160:163], v[164:167]
 buffer_load_dwordx4 v19, s[56:59], s29 offen offset:3072   lds
M v[168:171], a[48:51], a[160:163], 0
 s_add_u32 s29, s29, 128
 ds_read_b64_tr_b16 a[132:133], v1 offset:57344
 ds_read_b64_tr_b16 a[134:135], v1 offset:58368
M v[168:171], a[52:55], a[164:167], v[168:171]
 v_cvt_pk_bf16_f32 v216, v216, v217
 v_cvt_pk_bf16_f32 v217, v218, v219
M v[172:175], a[60:63], a[164:167], 0
 v_cvt_pk_bf16_f32 v218, v248, v249
 v_cvt_pk_bf16_f32 v219, v250, v251
M v[172:175], a[56:59], a[160:163], v[172:175]
 s_add_u32 m0, s23, 32768
 ds_read_b64_tr_b16 a[136:137], v2 offset:49152
 ds_read_b64_tr_b16 a[138:139], v2 offset:50176
M v[176:179], a[64:67], a[160:163], 0
 buffer_load_dwordx4 v8, s[52:55], s28 offen offset:0   lds
M v[176:179], a[68:71], a[164:167], v[176:179]
 v_cvt_pk_bf16_f32 v220, v220, v221
 v_cvt_pk_bf16_f32 v221, v222, v223
M v[180:183], a[76:79], a[164:167], 0
 ds_read_b64_tr_b16 a[140:141], v2 offset:57344
 ds_read_b64_tr_b16 a[142:143], v2 offset:58368
M v[180:183], a[72:75], a[160:163], v[180:183]
 v_cvt_pk_bf16_f32 v222, v252, v253
 v_cvt_pk_bf16_f32 v223, v254, v255
M v[184:187], a[80:83], a[160:163], 0
 s_add_u32 s3, s93, 524288
 v_mov_b32 v12, 1
 v_or_b32 v15, s20, v0
M v[184:187], a[84:87], a[164:167], v[184:187]
 s_waitcnt lgkmcnt(8)
 ds_read_b64_tr_b16 a[144:145], v3 offset:49152
 ds_read_b64_tr_b16 a[146:147], v3 offset:50176
M v[188:191], a[92:95], a[164:167], 0
 buffer_load_dwordx4 v9, s[52:55], s28 offen offset:1024   lds
M v[188:191], a[88:91], a[160:163], v[188:191]
 v_min_u32 v15, 1, v15
 v_lshlrev_b32 v15, 29, v15
M v[224:227], a[32:35], a[168:171], 0
 ds_read_b128 a[160:163], v5 offset:16384
 ds_read_b128 a[164:167], v6 offset:16384
M v[224:227], a[36:39], a[172:175], v[224:227]
 ds_read_b64_tr_b16 a[148:149], v3 offset:57344
 ds_read_b64_tr_b16 a[150:151], v3 offset:58368
M v[228:231], a[44:47], a[172:175], 0
 buffer_load_dwordx4 v10, s[52:55], s28 offen offset:2048   lds
M v[228:231], a[40:43], a[168:171], v[228:231]
 ds_read_b64_tr_b16 a[152:153], v4 offset:49152
 ds_read_b64_tr_b16 a[154:155], v4 offset:50176
M v[232:235], a[48:51], a[168:171], 0
 buffer_store_dwordx4 v[64:67], v7, s[8:11], s3 offen offset:0 sc1
M v[232:235], a[52:55], a[172:175], v[232:235]
M v[236:239], a[60:63], a[172:175], 0
 ds_read_b64_tr_b16 a[156:157], v4 offset:57344
 ds_read_b64_tr_b16 a[158:159], v4 offset:58368
M v[236:239], a[56:59], a[168:171], v[236:239]
 buffer_load_dwordx4 v11, s[52:55], s28 offen offset:3072   lds
M v[240:243], a[64:67], a[168:171], 0
 s_add_u32 s28, s28, 128
M v[240:243], a[68:71], a[172:175], v[240:243]
 buffer_store_dwordx4 v[68:71], v7, s[8:11], s3 offen offset:2048 sc1
M v[244:247], a[76:79], a[172:175], 0
M v[244:247], a[72:75], a[168:171], v[244:247]
M v[248:251], a[80:83], a[168:171], 0
M v[248:251], a[84:87], a[172:175], v[248:251]
 s_waitcnt lgkmcnt(6)
M v[252:255], a[92:95], a[172:175], 0
 s_waitcnt vmcnt(14) lgkmcnt(0)
M v[252:255], a[88:91], a[168:171], v[252:255]
 s_barrier
M v[32:35], a[96:99], a[160:163], v[32:35]
 s_add_u32 m0, s23, 49152
 ds_read_b128 a[168:171], v5 offset:18432
 ds_read_b128 a[172:175], v6 offset:18432
M v[32:35], a[100:103], a[164:167], v[32:35]
 ds_read_b64_tr_b16 a[32:33], v20 offset:0
 ds_read_b64_tr_b16 a[34:35], v20 offset:1024
M v[36:39], a[108:111], a[164:167], v[36:39]
 s_mov_b32 s39, 1347
 buffer_load_dwordx4 v8, s[52:55], s28 offen offset:0   lds
M v[36:39], a[104:107], a[160:163], v[36:39]
 s_cmp_lt_u32 s42, 2
 buffer_store_dword v12, v15, s[8:11], s45 offen sc1
M v[40:43], a[112:115], a[160:163], v[40:43]
 s_cselect_b32 s39, 1284, s39
 ds_read_b64_tr_b16 a[36:37], v20 offset:8192
 ds_read_b64_tr_b16 a[38:39], v20 offset:9216
M v[40:43], a[116:119], a[164:167], v[40:43]
 s_lshl_b32 s64, s20, 15
 buffer_load_dwordx4 v9, s[52:55], s28 offen offset:1024   lds
M v[44:47], a[124:127], a[164:167], v[44:47]
 s_add_u32 s12, s64, s34
 s_add_u32 s3, s93, 528384
M v[44:47], a[120:123], a[160:163], v[44:47]
 s_add_u32 s13, s12, 4096
 ds_read_b64_tr_b16 a[40:41], v21 offset:0
 ds_read_b64_tr_b16 a[42:43], v21 offset:1024
M v[48:51], a[128:131], a[160:163], v[48:51]
 s_add_u32 s14, s12, 16384
 buffer_store_dwordx4 v[72:75], v7, s[8:11], s3 offen offset:0 sc1
M v[48:51], a[132:135], a[164:167], v[48:51]
 s_add_u32 s15, s12, 20480
M v[52:55], a[140:143], a[164:167], v[52:55]
 ds_read_b64_tr_b16 a[44:45], v21 offset:8192
 ds_read_b64_tr_b16 a[46:47], v21 offset:9216
M v[52:55], a[136:139], a[160:163], v[52:55]
 buffer_load_dwordx4 v10, s[52:55], s28 offen offset:2048   lds
M v[56:59], a[144:147], a[160:163], v[56:59]
M v[56:59], a[148:151], a[164:167], v[56:59]
 s_waitcnt lgkmcnt(8)
 ds_read_b64_tr_b16 a[48:49], v22 offset:0
 ds_read_b64_tr_b16 a[50:51], v22 offset:1024
M v[60:63], a[156:159], a[164:167], v[60:63]
M v[60:63], a[152:155], a[160:163], v[60:63]
 buffer_load_dwordx4 v11, s[52:55], s28 offen offset:3072   lds
M v[96:99], a[96:99], a[168:171], v[96:99]
 s_add_u32 s28, s28, 524160
 ds_read_b128 a[160:163], v5 offset:20480
 ds_read_b128 a[164:167], v6 offset:20480
M v[96:99], a[100:103], a[172:175], v[96:99]
 ds_read_b64_tr_b16 a[52:53], v22 offset:8192
 ds_read_b64_tr_b16 a[54:55], v22 offset:9216
M v[100:103], a[108:111], a[172:175], v[100:103]
M v[100:103], a[104:107], a[168:171], v[100:103]
 s_add_u32 m0, s24, 0
 ds_read_b64_tr_b16 a[56:57], v23 offset:0
 ds_read_b64_tr_b16 a[58:59], v23 offset:1024
M v[104:107], a[112:115], a[168:171], v[104:107]
 buffer_load_dwordx4 v16, s[56:59], s29 offen offset:0   lds
M v[104:107], a[116:119], a[172:175], v[104:107]
M v[108:111], a[124:127], a[172:175], v[108:111]
 ds_read_b64_tr_b16 a[60:61], v23 offset:8192
 ds_read_b64_tr_b16 a[62:63], v23 offset:9216
M v[108:111], a[120:123], a[168:171], v[108:111]
M v[112:115], a[128:131], a[168:171], v[112:115]
M v[112:115], a[132:135], a[172:175], v[112:115]
 buffer_load_dwordx4 v17, s[56:59], s29 offen offset:1024   lds
M v[116:119], a[140:143], a[172:175], v[116:119]
M v[116:119], a[136:139], a[168:171], v[116:119]
M v[120:123], a[144:147], a[168:171], v[120:123]
M v[120:123], a[148:151], a[172:175], v[120:123]
 s_waitcnt lgkmcnt(6)
M v[124:127], a[156:159], a[172:175], v[124:127]
 s_waitcnt lgkmcnt(0)
 buffer_load_dwordx4 v18, s[56:59], s29 offen offset:2048   lds
M v[124:127], a[152:155], a[168:171], v[124:127]
 s_barrier
M v[160:163], a[96:99], a[160:163], v[160:163]
 ds_read_b128 a[168:171], v5 offset:22528
 ds_read_b128 a[172:175], v6 offset:22528
M v[160:163], a[100:103], a[164:167], v[160:163]
 ds_read_b64_tr_b16 a[64:65], v20 offset:16384
 ds_read_b64_tr_b16 a[66:67], v20 offset:17408
M v[164:167], a[108:111], a[164:167], v[164:167]
M v[164:167], a[104:107], a[160:163], v[164:167]
 buffer_load_dwordx4 v19, s[56:59], s29 offen offset:3072   lds
M v[168:171], a[112:115], a[160:163], v[168:171]
 s_add_u32 s29, s29, 128
 ds_read_b64_tr_b16 a[68:69], v20 offset:24576
 ds_read_b64_tr_b16 a[70:71], v20 offset:25600
M v[168:171], a[116:119], a[164:167], v[168:171]
 buffer_store_dwordx4 v[76:79], v7, s[8:11], s3 offen offset:2048 sc1
M v[172:175], a[124:127], a[164:167], v[172:175]
M v[172:175], a[120:123], a[160:163], v[172:175]
 s_add_u32 m0, s23, 131072
 ds_read_b64_tr_b16 a[72:73], v21 offset:16384
 ds_read_b64_tr_b16 a[74:75], v21 offset:17408
M v[176:179], a[128:131], a[160:163], v[176:179]
 buffer_load_dwordx4 v8, s[52:55], s28 offen offset:0   lds
M v[176:179], a[132:135], a[164:167], v[176:179]
M v[180:183], a[140:143], a[164:167], v[180:183]
 ds_read_b64_tr_b16 a[76:77], v21 offset:24576
 ds_read_b64_tr_b16 a[78:79], v21 offset:25600
M v[180:183], a[136:139], a[160:163], v[180:183]
M v[184:187], a[144:147], a[160:163], v[184:187]
M v[184:187], a[148:151], a[164:167], v[184:187]
 s_waitcnt lgkmcnt(8)
 ds_read_b64_tr_b16 a[80:81], v22 offset:16384
 ds_read_b64_tr_b16 a[82:83], v22 offset:17408
M v[188:191], a[156:159], a[164:167], v[188:191]
 buffer_load_dwordx4 v9, s[52:55], s28 offen offset:1024   lds
M v[188:191], a[152:155], a[160:163], v[188:191]
M v[224:227], a[96:99], a[168:171], v[224:227]
 ds_read_b128 a[160:163], v5 offset:32768
 ds_read_b128 a[164:167], v6 offset:32768
M v[224:227], a[100:103], a[172:175], v[224:227]
 ds_read_b64_tr_b16 a[84:85], v22 offset:24576
 ds_read_b64_tr_b16 a[86:87], v22 offset:25600
M v[228:231], a[108:111], a[172:175], v[228:231]
 buffer_load_dwordx4 v10, s[52:55], s28 offen offset:2048   lds
M v[228:231], a[104:107], a[168:171], v[228:231]
 ds_read_b64_tr_b16 a[88:89], v23 offset:16384
 ds_read_b64_tr_b16 a[90:91], v23 offset:17408
M v[232:235], a[112:115], a[168:171], v[232:235]
M v[232:235], a[116:119], a[172:175], v[232:235]
M v[236:239], a[124:127], a[172:175], v[236:239]
 ds_read_b64_tr_b16 a[92:93], v23 offset:24576
 ds_read_b64_tr_b16 a[94:95], v23 offset:25600
M v[236:239], a[120:123], a[168:171], v[236:239]
 buffer_load_dwordx4 v11, s[52:55], s28 offen offset:3072   lds
M v[240:243], a[128:131], a[168:171], v[240:243]
 s_add_u32 s28, s28, 128
M v[240:243], a[132:135], a[172:175], v[240:243]
M v[244:247], a[140:143], a[172:175], v[244:247]
M v[244:247], a[136:139], a[168:171], v[244:247]
M v[248:251], a[144:147], a[168:171], v[248:251]
M v[248:251], a[148:151], a[172:175], v[248:251]
 s_waitcnt lgkmcnt(6)
M v[252:255], a[156:159], a[172:175], v[252:255]
 s_waitcnt lgkmcnt(0)
M v[252:255], a[152:155], a[168:171], v[252:255]
 s_barrier
M v[32:35], a[32:35], a[160:163], v[32:35]
 s_add_u32 m0, s23, 147456
 ds_read_b128 a[168:171], v5 offset:34816
 ds_read_b128 a[172:175], v6 offset:34816
M v[32:35], a[36:39], a[164:167], v[32:35]
 ds_read_b64_tr_b16 a[96:97], v1 offset:0
 ds_read_b64_tr_b16 a[98:99], v1 offset:1024
M v[36:39], a[44:47], a[164:167], v[36:39]
 buffer_load_dwordx4 v8, s[52:55], s28 offen offset:0   lds
M v[36:39], a[40:43], a[160:163], v[36:39]
 v_and_b32 v29, 15, v0
 v_mul_u32_u24 v30, 1792, v29
M v[40:43], a[48:51], a[160:163], v[40:43]
 s_add_u32 s3, s93, 540672
 ds_read_b64_tr_b16 a[100:101], v1 offset:8192
 ds_read_b64_tr_b16 a[102:103], v1 offset:9216
M v[40:43], a[52:55], a[164:167], v[40:43]
 buffer_load_dwordx4 v9, s[52:55], s28 offen offset:1024   lds
M v[44:47], a[60:63], a[164:167], v[44:47]
 v_lshrrev_b32 v31, 4, v0
 v_lshl_add_u32 v30, v31, 4, v30
M v[44:47], a[56:59], a[160:163], v[44:47]
 ds_read_b64_tr_b16 a[104:105], v2 offset:0
 ds_read_b64_tr_b16 a[106:107], v2 offset:1024
M v[48:51], a[64:67], a[160:163], v[48:51]
 v_lshrrev_b32 v29, 1, v29
 v_min_u32 v29, 1, v29
M v[48:51], a[68:71], a[164:167], v[48:51]
 v_lshl_or_b32 v30, v29, 29, v30
 v_or_b32 v30, s88, v30
M v[52:55], a[76:79], a[164:167], v[52:55]
 s_mul_i32 s89, s86, 3584
 ds_read_b64_tr_b16 a[108:109], v2 offset:8192
 ds_read_b64_tr_b16 a[110:111], v2 offset:9216
M v[52:55], a[72:75], a[160:163], v[52:55]
 s_mul_i32 s64, s20, 448
 buffer_load_dwordx4 v10, s[52:55], s28 offen offset:2048   lds
M v[56:59], a[80:83], a[160:163], v[56:59]
 s_add_u32 s89, s89, s64
 s_add_u32 s89, s89, 235929600
M v[56:59], a[84:87], a[164:167], v[56:59]
 s_waitcnt lgkmcnt(8)
 ds_read_b64_tr_b16 a[112:113], v3 offset:0
 ds_read_b64_tr_b16 a[114:115], v3 offset:1024
M v[60:63], a[92:95], a[164:167], v[60:63]
 buffer_store_dwordx4 v[80:83], v7, s[8:11], s3 offen offset:0 sc1
M v[60:63], a[88:91], a[160:163], v[60:63]
 buffer_load_dwordx4 v11, s[52:55], s28 offen offset:3072   lds
M v[96:99], a[32:35], a[168:171], v[96:99]
 s_add_u32 s28, s28, 524160
 ds_read_b128 a[160:163], v5 offset:36864
 ds_read_b128 a[164:167], v6 offset:36864
M v[96:99], a[36:39], a[172:175], v[96:99]
 ds_read_b64_tr_b16 a[116:117], v3 offset:8192
 ds_read_b64_tr_b16 a[118:119], v3 offset:9216
M v[100:103], a[44:47], a[172:175], v[100:103]
M v[100:103], a[40:43], a[168:171], v[100:103]
 s_add_u32 m0, s24, 16384
 ds_read_b64_tr_b16 a[120:121], v4 offset:0
 ds_read_b64_tr_b16 a[122:123], v4 offset:1024
M v[104:107], a[48:51], a[168:171], v[104:107]
 buffer_load_dwordx4 v16, s[56:59], s29 offen offset:0   lds
M v[104:107], a[52:55], a[172:175], v[104:107]
M v[108:111], a[60:63], a[172:175], v[108:111]
 ds_read_b64_tr_b16 a[124:125], v4 offset:8192
 ds_read_b64_tr_b16 a[126:127], v4 offset:9216
M v[108:111], a[56:59], a[168:171], v[108:111]
M v[112:115], a[64:67], a[168:171], v[112:115]
M v[112:115], a[68:71], a[172:175], v[112:115]
 buffer_load_dwordx4 v17, s[56:59], s29 offen offset:1024   lds
M v[116:119], a[76:79], a[172:175], v[116:119]
M v[116:119], a[72:75], a[168:171], v[116:119]
M v[120:123], a[80:83], a[168:171], v[120:123]
M v[120:123], a[84:87], a[172:175], v[120:123]
 s_waitcnt lgkmcnt(6)
M v[124:127], a[92:95], a[172:175], v[124:127]
 s_waitcnt vmcnt(28) lgkmcnt(0)
 buffer_load_dwordx4 v18, s[56:59], s29 offen offset:2048   lds
M v[124:127], a[88:91], a[168:171], v[124:127]
 s_barrier
M v[160:163], a[32:35], a[160:163], v[160:163]
 ds_read_b128 a[168:171], v5 offset:38912
 ds_read_b128 a[172:175], v6 offset:38912
M v[160:163], a[36:39], a[164:167], v[160:163]
 ds_read_b64_tr_b16 a[128:129], v1 offset:16384
 ds_read_b64_tr_b16 a[130:131], v1 offset:17408
M v[164:167], a[44:47], a[164:167], v[164:167]
M v[164:167], a[40:43], a[160:163], v[164:167]
 buffer_load_dwordx4 v19, s[56:59], s29 offen offset:3072   lds
M v[168:171], a[48:51], a[160:163], v[168:171]
 s_add_u32 s29, s29, 128
 ds_read_b64_tr_b16 a[132:133], v1 offset:24576
 ds_read_b64_tr_b16 a[134:135], v1 offset:25600
M v[168:171], a[52:55], a[164:167], v[168:171]
 buffer_store_dwordx4 v[84:87], v7, s[8:11], s3 offen offset:2048 sc1
M v[172:175], a[60:63], a[164:167], v[172:175]
M v[172:175], a[56:59], a[160:163], v[172:175]
 s_add_u32 m0, s23, 0
 ds_read_b64_tr_b16 a[136:137], v2 offset:16384
 ds_read_b64_tr_b16 a[138:139], v2 offset:17408
M v[176:179], a[64:67], a[160:163], v[176:179]
 buffer_load_dwordx4 v8, s[52:55], s28 offen offset:0   lds
M v[176:179], a[68:71], a[164:167], v[176:179]
M v[180:183], a[76:79], a[164:167], v[180:183]
 ds_read_b64_tr_b16 a[140:141], v2 offset:24576
 ds_read_b64_tr_b16 a[142:143], v2 offset:25600
M v[180:183], a[72:75], a[160:163], v[180:183]
M v[184:187], a[80:83], a[160:163], v[184:187]
M v[184:187], a[84:87], a[164:167], v[184:187]
 s_waitcnt lgkmcnt(8)
 ds_read_b64_tr_b16 a[144:145], v3 offset:16384
 ds_read_b64_tr_b16 a[146:147], v3 offset:17408
M v[188:191], a[92:95], a[164:167], v[188:191]
 buffer_load_dwordx4 v9, s[52:55], s28 offen offset:1024   lds
M v[188:191], a[88:91], a[160:163], v[188:191]
M v[224:227], a[32:35], a[168:171], v[224:227]
 ds_read_b128 a[160:163], v5 offset:49152
 ds_read_b128 a[164:167], v6 offset:49152
M v[224:227], a[36:39], a[172:175], v[224:227]
 ds_read_b64_tr_b16 a[148:149], v3 offset:24576
 ds_read_b64_tr_b16 a[150:151], v3 offset:25600
M v[228:231], a[44:47], a[172:175], v[228:231]
 buffer_load_dwordx4 v10, s[52:55], s28 offen offset:2048   lds
M v[228:231], a[40:43], a[168:171], v[228:231]
 ds_read_b64_tr_b16 a[152:153], v4 offset:16384
 ds_read_b64_tr_b16 a[154:155], v4 offset:17408
M v[232:235], a[48:51], a[168:171], v[232:235]
M v[232:235], a[52:55], a[172:175], v[232:235]
M v[236:239], a[60:63], a[172:175], v[236:239]
 ds_read_b64_tr_b16 a[156:157], v4 offset:24576
 ds_read_b64_tr_b16 a[158:159], v4 offset:25600
M v[236:239], a[56:59], a[168:171], v[236:239]
 buffer_load_dwordx4 v11, s[52:55], s28 offen offset:3072   lds
M v[240:243], a[64:67], a[168:171], v[240:243]
 s_add_u32 s28, s28, 128
M v[240:243], a[68:71], a[172:175], v[240:243]
M v[244:247], a[76:79], a[172:175], v[244:247]
M v[244:247], a[72:75], a[168:171], v[244:247]
M v[248:251], a[80:83], a[168:171], v[248:251]
M v[248:251], a[84:87], a[172:175], v[248:251]
 s_waitcnt lgkmcnt(6)
M v[252:255], a[92:95], a[172:175], v[252:255]
 s_waitcnt vmcnt(30) lgkmcnt(0)
M v[252:255], a[88:91], a[168:171], v[252:255]
 s_barrier
M v[32:35], a[96:99], a[160:163], v[32:35]
 s_add_u32 m0, s23, 16384
 ds_read_b128 a[168:171], v5 offset:51200
 ds_read_b128 a[172:175], v6 offset:51200
M v[32:35], a[100:103], a[164:167], v[32:35]
 ds_read_b64_tr_b16 a[32:33], v1 offset:32768
 ds_read_b64_tr_b16 a[34:35], v1 offset:33792
M v[36:39], a[108:111], a[164:167], v[36:39]
 buffer_load_dwordx4 v8, s[52:55], s28 offen offset:0   lds
M v[36:39], a[104:107], a[160:163], v[36:39]
 v_min_u32 v25, 15, v0
 v_lshlrev_b32 v25, 7, v25
M v[40:43], a[112:115], a[160:163], v[40:43]
 s_add_u32 s3, s93, 544768
 ds_read_b64_tr_b16 a[36:37], v1 offset:40960
 ds_read_b64_tr_b16 a[38:39], v1 offset:41984
M v[40:43], a[116:119], a[164:167], v[40:43]
 v_max_u32 v13, 1024, v25
M v[44:47], a[124:127], a[164:167], v[44:47]
 buffer_store_dwordx4 v[88:91], v7, s[8:11], s3 offen offset:0 sc1
M v[44:47], a[120:123], a[160:163], v[44:47]
 ds_read_b64_tr_b16 a[40:41], v2 offset:32768
 ds_read_b64_tr_b16 a[42:43], v2 offset:33792
M v[48:51], a[128:131], a[160:163], v[48:51]
 buffer_load_dwordx4 v9, s[52:55], s28 offen offset:1024   lds
M v[48:51], a[132:135], a[164:167], v[48:51]
M v[52:55], a[140:143], a[164:167], v[52:55]
 ds_read_b64_tr_b16 a[44:45], v2 offset:40960
 ds_read_b64_tr_b16 a[46:47], v2 offset:41984
M v[52:55], a[136:139], a[160:163], v[52:55]
M v[56:59], a[144:147], a[160:163], v[56:59]
M v[56:59], a[148:151], a[164:167], v[56:59]
 s_waitcnt lgkmcnt(8)
 ds_read_b64_tr_b16 a[48:49], v3 offset:32768
 ds_read_b64_tr_b16 a[50:51], v3 offset:33792
M v[60:63], a[156:159], a[164:167], v[60:63]
 buffer_load_dwordx4 v10, s[52:55], s28 offen offset:2048   lds
M v[60:63], a[152:155], a[160:163], v[60:63]
M v[96:99], a[96:99], a[168:171], v[96:99]
 ds_read_b128 a[160:163], v5 offset:53248
 ds_read_b128 a[164:167], v6 offset:53248
M v[96:99], a[100:103], a[172:175], v[96:99]
 ds_read_b64_tr_b16 a[52:53], v3 offset:40960
 ds_read_b64_tr_b16 a[54:55], v3 offset:41984
M v[100:103], a[108:111], a[172:175], v[100:103]
 buffer_store_dwordx4 v[92:95], v7, s[8:11], s3 offen offset:2048 sc1
M v[100:103], a[104:107], a[168:171], v[100:103]
 ds_read_b64_tr_b16 a[56:57], v4 offset:32768
 ds_read_b64_tr_b16 a[58:59], v4 offset:33792
M v[104:107], a[112:115], a[168:171], v[104:107]
M v[104:107], a[116:119], a[172:175], v[104:107]
 buffer_load_dwordx4 v11, s[52:55], s28 offen offset:3072   lds
M v[108:111], a[124:127], a[172:175], v[108:111]
 s_add_u32 s28, s28, 524160
 ds_read_b64_tr_b16 a[60:61], v4 offset:40960
 ds_read_b64_tr_b16 a[62:63], v4 offset:41984
M v[108:111], a[120:123], a[168:171], v[108:111]
M v[112:115], a[128:131], a[168:171], v[112:115]
M v[112:115], a[132:135], a[172:175], v[112:115]
M v[116:119], a[140:143], a[172:175], v[116:119]
M v[116:119], a[136:139], a[168:171], v[116:119]
M v[120:123], a[144:147], a[168:171], v[120:123]
M v[120:123], a[148:151], a[172:175], v[120:123]
 s_waitcnt lgkmcnt(6)
M v[124:127], a[156:159], a[172:175], v[124:127]
 s_waitcnt vmcnt(25) lgkmcnt(0)
M v[124:127], a[152:155], a[168:171], v[124:127]
 s_barrier
M v[160:163], a[96:99], a[160:163], v[160:163]
 ds_read_b128 a[168:171], v5 offset:55296
 ds_read_b128 a[172:175], v6 offset:55296
M v[160:163], a[100:103], a[164:167], v[160:163]
 ds_read_b64_tr_b16 a[64:65], v1 offset:49152
 ds_read_b64_tr_b16 a[66:67], v1 offset:50176
M v[164:167], a[108:111], a[164:167], v[164:167]
 buffer_store_dwordx4 a[208:211], v30, s[8:11], s89 offen offset:0 sc1
M v[164:167], a[104:107], a[160:163], v[164:167]
M v[168:171], a[112:115], a[160:163], v[168:171]
 ds_read_b64_tr_b16 a[68:69], v1 offset:57344
 ds_read_b64_tr_b16 a[70:71], v1 offset:58368
M v[168:171], a[116:119], a[164:167], v[168:171]
M v[172:175], a[124:127], a[164:167], v[172:175]
M v[172:175], a[120:123], a[160:163], v[172:175]
 ds_read_b64_tr_b16 a[72:73], v2 offset:49152
 ds_read_b64_tr_b16 a[74:75], v2 offset:50176
M v[176:179], a[128:131], a[160:163], v[176:179]
M v[176:179], a[132:135], a[164:167], v[176:179]
M v[180:183], a[140:143], a[164:167], v[180:183]
 ds_read_b64_tr_b16 a[76:77], v2 offset:57344
 ds_read_b64_tr_b16 a[78:79], v2 offset:58368
M v[180:183], a[136:139], a[160:163], v[180:183]
M v[184:187], a[144:147], a[160:163], v[184:187]
M v[184:187], a[148:151], a[164:167], v[184:187]
 s_waitcnt lgkmcnt(8)
 ds_read_b64_tr_b16 a[80:81], v3 offset:49152
 ds_read_b64_tr_b16 a[82:83], v3 offset:50176
M v[188:191], a[156:159], a[164:167], v[188:191]
 buffer_store_dwordx4 a[212:215], v30, s[8:11], s89 offen offset:64 sc1
M v[188:191], a[152:155], a[160:163], v[188:191]
M v[224:227], a[96:99], a[168:171], v[224:227]
 ds_read_b128 a[160:163], v5 offset:0
 ds_read_b128 a[164:167], v6 offset:0
M v[224:227], a[100:103], a[172:175], v[224:227]
 ds_read_b64_tr_b16 a[84:85], v3 offset:57344
 ds_read_b64_tr_b16 a[86:87], v3 offset:58368
M v[228:231], a[108:111], a[172:175], v[228:231]
M v[228:231], a[104:107], a[168:171], v[228:231]
 ds_read_b64_tr_b16 a[88:89], v4 offset:49152
 ds_read_b64_tr_b16 a[90:91], v4 offset:50176
M v[232:235], a[112:115], a[168:171], v[232:235]
M v[232:235], a[116:119], a[172:175], v[232:235]
M v[236:239], a[124:127], a[172:175], v[236:239]
 ds_read_b64_tr_b16 a[92:93], v4 offset:57344
 ds_read_b64_tr_b16 a[94:95], v4 offset:58368
M v[236:239], a[120:123], a[168:171], v[236:239]
M v[240:243], a[128:131], a[168:171], v[240:243]
M v[240:243], a[132:135], a[172:175], v[240:243]
M v[244:247], a[140:143], a[172:175], v[244:247]
M v[244:247], a[136:139], a[168:171], v[244:247]
M v[248:251], a[144:147], a[168:171], v[248:251]
M v[248:251], a[148:151], a[172:175], v[248:251]
 s_waitcnt lgkmcnt(6)
M v[252:255], a[156:159], a[172:175], v[252:255]
 s_waitcnt vmcnt(22) lgkmcnt(0)
M v[252:255], a[152:155], a[168:171], v[252:255]
 s_barrier
M v[32:35], a[32:35], a[160:163], v[32:35]
 s_add_u32 m0, s23, 32768
 ds_read_b128 a[168:171], v5 offset:2048
 ds_read_b128 a[172:175], v6 offset:2048
M v[32:35], a[36:39], a[164:167], v[32:35]
 ds_read_b64_tr_b16 a[96:97], v20 offset:0
 ds_read_b64_tr_b16 a[98:99], v20 offset:1024
M v[36:39], a[44:47], a[164:167], v[36:39]
 buffer_load_dwordx4 v16, s[56:59], s29 offen offset:0   lds
M v[36:39], a[40:43], a[160:163], v[36:39]
 buffer_store_dwordx4 a[216:219], v30, s[8:11], s89 offen offset:128 sc1
M v[40:43], a[48:51], a[160:163], v[40:43]
 ds_read_b64_tr_b16 a[100:101], v20 offset:8192
 ds_read_b64_tr_b16 a[102:103], v20 offset:9216
M v[40:43], a[52:55], a[164:167], v[40:43]
 buffer_load_dwordx4 v17, s[56:59], s29 offen offset:1024   lds
M v[44:47], a[60:63], a[164:167], v[44:47]
M v[44:47], a[56:59], a[160:163], v[44:47]
 ds_read_b64_tr_b16 a[104:105], v21 offset:0
 ds_read_b64_tr_b16 a[106:107], v21 offset:1024
M v[48:51], a[64:67], a[160:163], v[48:51]
M v[48:51], a[68:71], a[164:167], v[48:51]
 buffer_load_dwordx4 v18, s[56:59], s29 offen offset:2048   lds
M v[52:55], a[76:79], a[164:167], v[52:55]
 ds_read_b64_tr_b16 a[108:109], v21 offset:8192
 ds_read_b64_tr_b16 a[110:111], v21 offset:9216
M v[52:55], a[72:75], a[160:163], v[52:55]
 buffer_store_dwordx4 a[220:223], v30, s[8:11], s89 offen offset:192 sc1
M v[56:59], a[80:83], a[160:163], v[56:59]
M v[56:59], a[84:87], a[164:167], v[56:59]
 s_waitcnt lgkmcnt(8)
 ds_read_b64_tr_b16 a[112:113], v22 offset:0
 ds_read_b64_tr_b16 a[114:115], v22 offset:1024
M v[60:63], a[92:95], a[164:167], v[60:63]
 buffer_load_dwordx4 v19, s[56:59], s29 offen offset:3072   lds
M v[60:63], a[88:91], a[160:163], v[60:63]
 s_add_u32 s29, s29, 128
M v[96:99], a[32:35], a[168:171], v[96:99]
 ds_read_b128 a[160:163], v5 offset:4096
 ds_read_b128 a[164:167], v6 offset:4096
M v[96:99], a[36:39], a[172:175], v[96:99]
 ds_read_b64_tr_b16 a[116:117], v22 offset:8192
 ds_read_b64_tr_b16 a[118:119], v22 offset:9216
M v[100:103], a[44:47], a[172:175], v[100:103]
 s_lshl_b32 s28, s20, 13
 buffer_store_dwordx4 a[224:227], v30, s[8:11], s89 offen offset:256 sc1
M v[100:103], a[40:43], a[168:171], v[100:103]
 s_lshl_b32 s21, s27, 21
 ds_read_b64_tr_b16 a[120:121], v23 offset:0
 ds_read_b64_tr_b16 a[122:123], v23 offset:1024
M v[104:107], a[48:51], a[168:171], v[104:107]
 s_mov_b32 s22, 0
M v[104:107], a[52:55], a[172:175], v[104:107]
 s_add_u32 s21, s21, s92
M v[108:111], a[60:63], a[172:175], v[108:111]
 s_add_u32 s7, s21, 201326592
 ds_read_b64_tr_b16 a[124:125], v23 offset:8192
 ds_read_b64_tr_b16 a[126:127], v23 offset:9216
M v[108:111], a[56:59], a[168:171], v[108:111]
 s_add_u32 s38, s7, 131072
 buffer_store_dwordx4 a[228:231], v30, s[8:11], s89 offen offset:320 sc1
M v[112:115], a[64:67], a[168:171], v[112:115]
 s_sub_u32 s27, s42, 1
M v[112:115], a[68:71], a[172:175], v[112:115]
 s_mov_b32 s43, 32767
M v[116:119], a[76:79], a[172:175], v[116:119]
 s_mov_b32 s4, 0
 buffer_load_dword v24, v13, s[8:11], s46 offen sc1
M v[116:119], a[72:75], a[168:171], v[116:119]
 s_add_u32 s26, s21, 1310720
 buffer_store_dwordx4 a[232:235], v30, s[8:11], s89 offen offset:384 sc1
M v[120:123], a[80:83], a[168:171], v[120:123]
 s_lshl_b32 s64, s42, 1
 s_add_u32 s65, s64, 4
 s_add_u32 s64, s64, 2
M v[120:123], a[84:87], a[172:175], v[120:123]
 s_waitcnt lgkmcnt(6)
 s_add_u32 s3, s93, 1048576
M v[124:127], a[92:95], a[172:175], v[124:127]
 s_waitcnt vmcnt(23) lgkmcnt(0)
M v[124:127], a[88:91], a[168:171], v[124:127]
 s_barrier
M v[160:163], a[32:35], a[160:163], v[160:163]
 s_cmp_le_u32 s42, 5
 ds_read_b128 a[168:171], v5 offset:6144
 ds_read_b128 a[172:175], v6 offset:6144
M v[160:163], a[36:39], a[164:167], v[160:163]
 s_cselect_b32 s25, s65, 32767
 ds_read_b64_tr_b16 a[128:129], v20 offset:16384
 ds_read_b64_tr_b16 a[130:131], v20 offset:17408
M v[164:167], a[44:47], a[164:167], v[164:167]
 s_cselect_b32 s6, 14, s64
 buffer_store_dwordx4 v[128:131], v7, s[8:11], s3 offen offset:0 sc1
M v[164:167], a[40:43], a[160:163], v[164:167]
 s_mov_b32 s23, 0
M v[168:171], a[48:51], a[160:163], v[168:171]
 ds_read_b64_tr_b16 a[132:133], v20 offset:24576
 ds_read_b64_tr_b16 a[134:135], v20 offset:25600
M v[168:171], a[52:55], a[164:167], v[168:171]
M v[172:175], a[60:63], a[164:167], v[172:175]
 buffer_store_dwordx4 v[132:135], v7, s[8:11], s3 offen offset:2048 sc1
M v[172:175], a[56:59], a[160:163], v[172:175]
 s_add_u32 s3, s93, 1052672
 ds_read_b64_tr_b16 a[136:137], v21 offset:16384
 ds_read_b64_tr_b16 a[138:139], v21 offset:17408
M v[176:179], a[64:67], a[160:163], v[176:179]
M v[176:179], a[68:71], a[164:167], v[176:179]
M v[180:183], a[76:79], a[164:167], v[180:183]
 ds_read_b64_tr_b16 a[140:141], v21 offset:24576
 ds_read_b64_tr_b16 a[142:143], v21 offset:25600
M v[180:183], a[72:75], a[160:163], v[180:183]
 buffer_store_dwordx4 v[136:139], v7, s[8:11], s3 offen offset:0 sc1
M v[184:187], a[80:83], a[160:163], v[184:187]
M v[184:187], a[84:87], a[164:167], v[184:187]
 s_waitcnt lgkmcnt(8)
 ds_read_b64_tr_b16 a[144:145], v22 offset:16384
 ds_read_b64_tr_b16 a[146:147], v22 offset:17408
M v[188:191], a[92:95], a[164:167], v[188:191]
M v[188:191], a[88:91], a[160:163], v[188:191]
 buffer_store_dwordx4 v[140:143], v7, s[8:11], s3 offen offset:2048 sc1
M v[224:227], a[32:35], a[168:171], v[224:227]
 ds_read_b128 a[160:163], v5 offset:16384
 ds_read_b128 a[164:167], v6 offset:16384
M v[224:227], a[36:39], a[172:175], v[224:227]
 s_add_u32 s3, s93, 1064960
 ds_read_b64_tr_b16 a[148:149], v22 offset:24576
 ds_read_b64_tr_b16 a[150:151], v22 offset:25600
M v[228:231], a[44:47], a[172:175], v[228:231]
M v[228:231], a[40:43], a[168:171], v[228:231]
 ds_read_b64_tr_b16 a[152:153], v23 offset:16384
 ds_read_b64_tr_b16 a[154:155], v23 offset:17408
M v[232:235], a[48:51], a[168:171], v[232:235]
 buffer_store_dwordx4 v[144:147], v7, s[8:11], s3 offen offset:0 sc1
M v[232:235], a[52:55], a[172:175], v[232:235]
M v[236:239], a[60:63], a[172:175], v[236:239]
 ds_read_b64_tr_b16 a[156:157], v23 offset:24576
 ds_read_b64_tr_b16 a[158:159], v23 offset:25600
M v[236:239], a[56:59], a[168:171], v[236:239]
M v[240:243], a[64:67], a[168:171], v[240:243]
M v[240:243], a[68:71], a[172:175], v[240:243]
M v[244:247], a[76:79], a[172:175], v[244:247]
M v[244:247], a[72:75], a[168:171], v[244:247]
M v[248:251], a[80:83], a[168:171], v[248:251]
M v[248:251], a[84:87], a[172:175], v[248:251]
 s_waitcnt lgkmcnt(6)
M v[252:255], a[92:95], a[172:175], v[252:255]
 s_waitcnt vmcnt(23) lgkmcnt(0)
M v[252:255], a[88:91], a[168:171], v[252:255]
 s_barrier
M v[32:35], a[96:99], a[160:163], v[32:35]
 ds_read_b128 a[168:171], v5 offset:18432
 ds_read_b128 a[172:175], v6 offset:18432
M v[32:35], a[100:103], a[164:167], v[32:35]
 ds_read_b64_tr_b16 a[32:33], v1 offset:0
 ds_read_b64_tr_b16 a[34:35], v1 offset:1024
M v[36:39], a[108:111], a[164:167], v[36:39]
 v_add_u32 v10, s28, v7
 v_add_u32 v10, s28, v10
M v[36:39], a[104:107], a[160:163], v[36:39]
 v_add_u32 v11, 0x1000, v10
 s_waitcnt vmcnt(6)
 v_cmp_eq_u32 vcc, 0, v24
M v[40:43], a[112:115], a[160:163], v[40:43]
 s_lshl_b32 s64, s20, 10
 ds_read_b64_tr_b16 a[36:37], v1 offset:8192
 ds_read_b64_tr_b16 a[38:39], v1 offset:9216
M v[40:43], a[116:119], a[164:167], v[40:43]
 s_cbranch_vccnz L_f1s04
L_f1r04:
M v[44:47], a[124:127], a[164:167], v[44:47]
 s_add_u32 m0, s28, 98304
 s_nop 0
 buffer_load_dwordx4 v10, s[8:11], s21 offen offset:0 sc1 lds
M v[44:47], a[120:123], a[160:163], v[44:47]
 ds_read_b64_tr_b16 a[40:41], v2 offset:0
 ds_read_b64_tr_b16 a[42:43], v2 offset:1024
M v[48:51], a[128:131], a[160:163], v[48:51]
 buffer_store_dwordx4 v[148:151], v7, s[8:11], s3 offen offset:2048 sc1
M v[48:51], a[132:135], a[164:167], v[48:51]
M v[52:55], a[140:143], a[164:167], v[52:55]
 ds_read_b64_tr_b16 a[44:45], v2 offset:8192
 ds_read_b64_tr_b16 a[46:47], v2 offset:9216
M v[52:55], a[136:139], a[160:163], v[52:55]
 buffer_load_dwordx4 v10, s[8:11], s21 offen offset:1024 sc1 lds
M v[56:59], a[144:147], a[160:163], v[56:59]
M v[56:59], a[148:151], a[164:167], v[56:59]
 s_waitcnt lgkmcnt(8)
 ds_read_b64_tr_b16 a[48:49], v3 offset:0
 ds_read_b64_tr_b16 a[50:51], v3 offset:1024
M v[60:63], a[156:159], a[164:167], v[60:63]
M v[60:63], a[152:155], a[160:163], v[60:63]
 s_add_u32 s3, s93, 1069056
 buffer_load_dwordx4 v10, s[8:11], s21 offen offset:2048 sc1 lds
M v[96:99], a[96:99], a[168:171], v[96:99]
 ds_read_b128 a[160:163], v5 offset:20480
 ds_read_b128 a[164:167], v6 offset:20480
M v[96:99], a[100:103], a[172:175], v[96:99]
 ds_read_b64_tr_b16 a[52:53], v3 offset:8192
 ds_read_b64_tr_b16 a[54:55], v3 offset:9216
M v[100:103], a[108:111], a[172:175], v[100:103]
 buffer_store_dwordx4 v[152:155], v7, s[8:11], s3 offen offset:0 sc1
M v[100:103], a[104:107], a[168:171], v[100:103]
 ds_read_b64_tr_b16 a[56:57], v4 offset:0
 ds_read_b64_tr_b16 a[58:59], v4 offset:1024
M v[104:107], a[112:115], a[168:171], v[104:107]
 buffer_load_dwordx4 v10, s[8:11], s21 offen offset:3072 sc1 lds
M v[104:107], a[116:119], a[172:175], v[104:107]
 s_add_u32 m0, s28, 102400
M v[108:111], a[124:127], a[172:175], v[108:111]
 ds_read_b64_tr_b16 a[60:61], v4 offset:8192
 ds_read_b64_tr_b16 a[62:63], v4 offset:9216
M v[108:111], a[120:123], a[168:171], v[108:111]
M v[112:115], a[128:131], a[168:171], v[112:115]
 buffer_load_dwordx4 v11, s[8:11], s21 offen offset:0 sc1 lds
M v[112:115], a[132:135], a[172:175], v[112:115]
M v[116:119], a[140:143], a[172:175], v[116:119]
 buffer_store_dwordx4 v[156:159], v7, s[8:11], s3 offen offset:2048 sc1
M v[116:119], a[136:139], a[168:171], v[116:119]
M v[120:123], a[144:147], a[168:171], v[120:123]
 buffer_load_dwordx4 v11, s[8:11], s21 offen offset:1024 sc1 lds
M v[120:123], a[148:151], a[172:175], v[120:123]
 s_waitcnt lgkmcnt(6)
M v[124:127], a[156:159], a[172:175], v[124:127]
 s_waitcnt lgkmcnt(0)
 buffer_load_dwordx4 v11, s[8:11], s21 offen offset:2048 sc1 lds
M v[124:127], a[152:155], a[168:171], v[124:127]
 s_barrier
M v[160:163], a[96:99], a[160:163], v[160:163]
 ds_read_b128 a[168:171], v5 offset:22528
 ds_read_b128 a[172:175], v6 offset:22528
M v[160:163], a[100:103], a[164:167], v[160:163]
 ds_read_b64_tr_b16 a[64:65], v1 offset:16384
 ds_read_b64_tr_b16 a[66:67], v1 offset:17408
M v[164:167], a[108:111], a[164:167], v[164:167]
 buffer_load_dwordx4 v11, s[8:11], s21 offen offset:3072 sc1 lds
M v[164:167], a[104:107], a[160:163], v[164:167]
 s_add_u32 s24, s23, 33554432
M v[168:171], a[112:115], a[160:163], v[168:171]
 s_mov_b32 s23, s21
 ds_read_b64_tr_b16 a[68:69], v1 offset:24576
 ds_read_b64_tr_b16 a[70:71], v1 offset:25600
M v[168:171], a[116:119], a[164:167], v[168:171]
 s_add_u32 s21, s21, 65536
 s_add_u32 s3, s93, 1572864
M v[172:175], a[124:127], a[164:167], v[172:175]
 s_add_u32 s22, s22, 1
 buffer_store_dwordx4 v[192:195], v7, s[8:11], s3 offen offset:0 sc1
M v[172:175], a[120:123], a[160:163], v[172:175]
 s_cmp_eq_u32 s22, s25
 ds_read_b64_tr_b16 a[72:73], v2 offset:16384
 ds_read_b64_tr_b16 a[74:75], v2 offset:17408
M v[176:179], a[128:131], a[160:163], v[176:179]
 s_cselect_b32 s21, s26, s21
 v_subrev_u32 v5, 0x10000, v5
 v_subrev_u32 v6, 0x10000, v6
M v[176:179], a[132:135], a[164:167], v[176:179]
 s_cmp_eq_u32 s22, s43
M v[180:183], a[140:143], a[164:167], v[180:183]
 s_cselect_b32 s21, s4, s21
 ds_read_b64_tr_b16 a[76:77], v2 offset:24576
 ds_read_b64_tr_b16 a[78:79], v2 offset:25600
M v[180:183], a[136:139], a[160:163], v[180:183]
 s_cmp_eq_u32 s22, s6
M v[184:187], a[144:147], a[160:163], v[184:187]
 s_cselect_b32 s21, s7, s21
 v_mov_b32 v9, v25
 v_lshrrev_b32 v24, 4, v0
M v[184:187], a[148:151], a[164:167], v[184:187]
 s_waitcnt lgkmcnt(8)
 ds_read_b64_tr_b16 a[80:81], v3 offset:16384
 ds_read_b64_tr_b16 a[82:83], v3 offset:17408
M v[188:191], a[156:159], a[164:167], v[188:191]
 v_lshlrev_b32 v24, 2, v24
 v_and_b32 v25, 15, v0
M v[188:191], a[152:155], a[160:163], v[188:191]
 v_sub_u32 v24, v24, v25
M v[224:227], a[96:99], a[168:171], v[224:227]
 s_add_u32 s64, s64, s34
 ds_read_b128 a[160:163], v5 offset:32768
 ds_read_b128 a[164:167], v6 offset:32768
M v[224:227], a[100:103], a[172:175], v[224:227]
 s_add_u32 s52, s64, 131072
 ds_read_b64_tr_b16 a[84:85], v3 offset:24576
 ds_read_b64_tr_b16 a[86:87], v3 offset:25600
M v[228:231], a[108:111], a[172:175], v[228:231]
 s_mov_b32 s55, 0x21800000
 buffer_store_dwordx4 v[196:199], v7, s[8:11], s3 offen offset:2048 sc1
M v[228:231], a[104:107], a[168:171], v[228:231]
 s_and_b32 s65, s39, 0
 ds_read_b64_tr_b16 a[88:89], v4 offset:16384
 ds_read_b64_tr_b16 a[90:91], v4 offset:17408
M v[232:235], a[112:115], a[168:171], v[232:235]
 s_cmp_eq_u32 s20, 0
M v[232:235], a[116:119], a[172:175], v[232:235]
 s_cselect_b32 s54, s39, s65
M v[236:239], a[124:127], a[172:175], v[236:239]
 s_lshr_b32 s64, s20, 1
 ds_read_b64_tr_b16 a[92:93], v4 offset:24576
 ds_read_b64_tr_b16 a[94:95], v4 offset:25600
M v[236:239], a[120:123], a[168:171], v[236:239]
 s_lshl_b32 s64, s64, 17
M v[240:243], a[128:131], a[168:171], v[240:243]
 s_and_b32 s65, s20, 1
M v[240:243], a[132:135], a[172:175], v[240:243]
 s_lshl_b32 s65, s65, 12
M v[244:247], a[140:143], a[172:175], v[244:247]
 s_add_u32 s64, s64, s65
 v_add_u32 v14, s64, v7
 v_mov_b32 v8, 0xff800000
M v[244:247], a[136:139], a[168:171], v[244:247]
 v_cmp_lt_i32 s[16:17], 0, v24
 v_cmp_lt_i32 s[18:19], -1, v24
M v[248:251], a[144:147], a[168:171], v[248:251]
 v_cmp_lt_i32 s[48:49], -2, v24
 v_cmp_lt_i32 s[50:51], -3, v24
M v[248:251], a[148:151], a[172:175], v[248:251]
 s_waitcnt lgkmcnt(6)
M v[252:255], a[156:159], a[172:175], v[252:255]
 s_waitcnt lgkmcnt(0)
M v[252:255], a[152:155], a[168:171], v[252:255]
 s_barrier
M v[32:35], a[32:35], a[160:163], v[32:35]
 ds_read_b128 a[168:171], v5 offset:34816
 ds_read_b128 a[172:175], v6 offset:34816
M v[32:35], a[36:39], a[164:167], v[32:35]
 buffer_load_dword v24, v9, s[8:11], s46 offen sc1
M v[36:39], a[44:47], a[164:167], v[36:39]
 v_mov_b32 v1, v15
 v_add_u32 v2, 0x10000, v7
M v[36:39], a[40:43], a[160:163], v[36:39]
 v_mov_b32 v3, v10
 v_mov_b32 v4, v11
M v[40:43], a[48:51], a[160:163], v[40:43]
 s_mov_b64 s[60:61], s[76:77]
M v[40:43], a[52:55], a[164:167], v[40:43]
 s_mov_b32 s62, s78
M v[44:47], a[60:63], a[164:167], v[44:47]
 s_mov_b32 s63, 0x20000
 v_lshl_add_u32 v10, v0, 7, s95
 v_and_b32 v0, 48, v0
M v[44:47], a[56:59], a[160:163], v[44:47]
 v_lshl_add_u32 v0, v0, 24, v10
 v_mul_f32 v32, s5, v32
M v[48:51], a[64:67], a[160:163], v[48:51]
 v_mul_f32 v33, s5, v33
 v_mul_f32 v34, s5, v34
M v[48:51], a[68:71], a[164:167], v[48:51]
 v_mul_f32 v35, s5, v35
 v_mul_f32 v36, s5, v36
M v[52:55], a[76:79], a[164:167], v[52:55]
 v_mul_f32 v37, s5, v37
 v_mul_f32 v38, s5, v38
M v[52:55], a[72:75], a[160:163], v[52:55]
 v_mul_f32 v39, s5, v39
 v_cvt_pk_bf16_f32 v32, v32, v33
M v[56:59], a[80:83], a[160:163], v[56:59]
 v_cvt_pk_bf16_f32 v33, v34, v35
 v_cvt_pk_bf16_f32 v34, v36, v37
M v[56:59], a[84:87], a[164:167], v[56:59]
 s_waitcnt lgkmcnt(0)
 v_cvt_pk_bf16_f32 v35, v38, v39
 ds_write_b128 v14, v[32:35] offset:0
M v[60:63], a[92:95], a[164:167], v[60:63]
 s_add_u32 s3, s93, 1576960
 buffer_store_dwordx4 v[200:203], v7, s[8:11], s3 offen offset:0 sc1
M v[60:63], a[88:91], a[160:163], v[60:63]
 v_mul_f32 v40, s5, v40
 v_mul_f32 v41, s5, v41
M v[96:99], a[32:35], a[168:171], v[96:99]
 ds_read_b128 a[160:163], v5 offset:36864
 ds_read_b128 a[164:167], v6 offset:36864
M v[96:99], a[36:39], a[172:175], v[96:99]
 v_mul_f32 v42, s5, v42
 v_mul_f32 v43, s5, v43
M v[100:103], a[44:47], a[172:175], v[100:103]
 v_mul_f32 v44, s5, v44
 v_mul_f32 v45, s5, v45
M v[100:103], a[40:43], a[168:171], v[100:103]
 v_mul_f32 v46, s5, v46
 v_mul_f32 v47, s5, v47
M v[104:107], a[48:51], a[168:171], v[104:107]
 v_cvt_pk_bf16_f32 v40, v40, v41
 v_cvt_pk_bf16_f32 v41, v42, v43
M v[104:107], a[52:55], a[172:175], v[104:107]
 v_cvt_pk_bf16_f32 v42, v44, v45
 v_cvt_pk_bf16_f32 v43, v46, v47
M v[108:111], a[60:63], a[172:175], v[108:111]
 ds_write_b128 v14, v[40:43] offset:1024
M v[108:111], a[56:59], a[168:171], v[108:111]
 buffer_store_dwordx4 v[204:207], v7, s[8:11], s3 offen offset:2048 sc1
M v[112:115], a[64:67], a[168:171], v[112:115]
 v_mul_f32 v48, s5, v48
 v_mul_f32 v49, s5, v49
M v[112:115], a[68:71], a[172:175], v[112:115]
 v_mul_f32 v50, s5, v50
 v_mul_f32 v51, s5, v51
M v[116:119], a[76:79], a[172:175], v[116:119]
 v_mul_f32 v52, s5, v52
 v_mul_f32 v53, s5, v53
M v[116:119], a[72:75], a[168:171], v[116:119]
 v_mul_f32 v54, s5, v54
 v_mul_f32 v55, s5, v55
M v[120:123], a[80:83], a[168:171], v[120:123]
 v_cvt_pk_bf16_f32 v48, v48, v49
 v_cvt_pk_bf16_f32 v49, v50, v51
M v[120:123], a[84:87], a[172:175], v[120:123]
 s_waitcnt lgkmcnt(1)
 v_cvt_pk_bf16_f32 v50, v52, v53
 v_cvt_pk_bf16_f32 v51, v54, v55
M v[124:127], a[92:95], a[172:175], v[124:127]
 ds_write_b128 v14, v[48:51] offset:2048
M v[124:127], a[88:91], a[168:171], v[124:127]
 s_add_u32 s3, s93, 1589248
 buffer_store_dwordx4 v[208:211], v7, s[8:11], s3 offen offset:0 sc1
M v[160:163], a[32:35], a[160:163], v[160:163]
 ds_read_b128 a[168:171], v5 offset:38912
 ds_read_b128 a[172:175], v6 offset:38912
M v[160:163], a[36:39], a[164:167], v[160:163]
 v_mul_f32 v56, s5, v56
 v_mul_f32 v57, s5, v57
M v[164:167], a[44:47], a[164:167], v[164:167]
 v_mul_f32 v58, s5, v58
 v_mul_f32 v59, s5, v59
M v[164:167], a[40:43], a[160:163], v[164:167]
 v_mul_f32 v60, s5, v60
 v_mul_f32 v61, s5, v61
M v[168:171], a[48:51], a[160:163], v[168:171]
 v_mul_f32 v62, s5, v62
 v_mul_f32 v63, s5, v63
M v[168:171], a[52:55], a[164:167], v[168:171]
 v_cvt_pk_bf16_f32 v56, v56, v57
 v_cvt_pk_bf16_f32 v57, v58, v59
M v[172:175], a[60:63], a[164:167], v[172:175]
 v_cvt_pk_bf16_f32 v58, v60, v61
 v_cvt_pk_bf16_f32 v59, v62, v63
M v[172:175], a[56:59], a[160:163], v[172:175]
 s_waitcnt lgkmcnt(0)
 ds_write_b128 v14, v[56:59] offset:3072
M v[176:179], a[64:67], a[160:163], v[176:179]
 s_barrier
M v[176:179], a[68:71], a[164:167], v[176:179]
M v[180:183], a[76:79], a[164:167], v[180:183]
 s_add_u32 m0, s28, 32768
 s_nop 0
 buffer_load_dwordx4 v3, s[8:11], s21 offen offset:0 sc1 lds
M v[180:183], a[72:75], a[160:163], v[180:183]
M v[184:187], a[80:83], a[160:163], v[184:187]
 buffer_store_dwordx4 v[212:215], v7, s[8:11], s3 offen offset:2048 sc1
M v[184:187], a[84:87], a[164:167], v[184:187]
 v_mul_f32 v96, s5, v96
 v_mul_f32 v97, s5, v97
M v[188:191], a[92:95], a[164:167], v[188:191]
 buffer_load_dwordx4 v3, s[8:11], s21 offen offset:1024 sc1 lds
M v[188:191], a[88:91], a[160:163], v[188:191]
 v_mul_f32 v98, s5, v98
 v_mul_f32 v99, s5, v99
M v[224:227], a[32:35], a[168:171], v[224:227]
 v_mul_f32 v100, s5, v100
 v_mul_f32 v101, s5, v101
M v[224:227], a[36:39], a[172:175], v[224:227]
 v_mul_f32 v102, s5, v102
 v_mul_f32 v103, s5, v103
M v[228:231], a[44:47], a[172:175], v[228:231]
 buffer_load_dwordx4 v3, s[8:11], s21 offen offset:2048 sc1 lds
M v[228:231], a[40:43], a[168:171], v[228:231]
 v_cvt_pk_bf16_f32 v96, v96, v97
 v_cvt_pk_bf16_f32 v97, v98, v99
M v[232:235], a[48:51], a[168:171], v[232:235]
 v_cvt_pk_bf16_f32 v98, v100, v101
 v_cvt_pk_bf16_f32 v99, v102, v103
M v[232:235], a[52:55], a[172:175], v[232:235]
 ds_write_b128 v14, v[96:99] offset:8192
M v[236:239], a[60:63], a[172:175], v[236:239]
 s_add_u32 s3, s93, 1593344
 buffer_load_dwordx4 v3, s[8:11], s21 offen offset:3072 sc1 lds
M v[236:239], a[56:59], a[168:171], v[236:239]
 s_add_u32 m0, s28, 36864
M v[240:243], a[64:67], a[168:171], v[240:243]
 buffer_store_dwordx4 v[216:219], v7, s[8:11], s3 offen offset:0 sc1
M v[240:243], a[68:71], a[172:175], v[240:243]
 v_mul_f32 v104, s5, v104
 v_mul_f32 v105, s5, v105
M v[244:247], a[76:79], a[172:175], v[244:247]
 buffer_load_dwordx4 v4, s[8:11], s21 offen offset:0 sc1 lds
M v[244:247], a[72:75], a[168:171], v[244:247]
 v_mul_f32 v106, s5, v106
 v_mul_f32 v107, s5, v107
M v[248:251], a[80:83], a[168:171], v[248:251]
 v_mul_f32 v108, s5, v108
 v_mul_f32 v109, s5, v109
M v[248:251], a[84:87], a[172:175], v[248:251]
 v_mul_f32 v110, s5, v110
 v_mul_f32 v111, s5, v111
M v[252:255], a[92:95], a[172:175], v[252:255]
 buffer_load_dwordx4 v4, s[8:11], s21 offen offset:1024 sc1 lds
M v[252:255], a[88:91], a[168:171], v[252:255]
 buffer_load_dwordx4 v4, s[8:11], s21 offen offset:2048 sc1 lds
 buffer_load_dwordx4 v4, s[8:11], s21 offen offset:3072 sc1 lds
 s_add_u32 s24, s23, 33554432
 s_mov_b32 s23, s21
 s_add_u32 s21, s21, 65536
 s_add_u32 s22, s22, 1
 s_cmp_eq_u32 s22, s25
 s_cselect_b32 s21, s26, s21
 s_cmp_eq_u32 s22, s43
 s_cselect_b32 s21, s4, s21
 s_cmp_eq_u32 s22, s6
 s_cselect_b32 s21, s7, s21
 v_cvt_pk_bf16_f32 v104, v104, v105
 v_cvt_pk_bf16_f32 v105, v106, v107
 v_cvt_pk_bf16_f32 v106, v108, v109
 v_cvt_pk_bf16_f32 v107, v110, v111
 ds_write_b128 v14, v[104:107] offset:9216
 buffer_store_dwordx4 v[220:223], v7, s[8:11], s3 offen offset:2048 sc1
 v_pk_mul_f32 v[112:113], v[112:113], s[4:5] op_sel:[0,1] op_sel_hi:[1,1]
 v_pk_mul_f32 v[114:115], v[114:115], s[4:5] op_sel:[0,1] op_sel_hi:[1,1]
 v_pk_mul_f32 v[116:117], v[116:117], s[4:5] op_sel:[0,1] op_sel_hi:[1,1]
 v_pk_mul_f32 v[118:119], v[118:119], s[4:5] op_sel:[0,1] op_sel_hi:[1,1]
 v_cvt_pk_bf16_f32 v112, v112, v113
 v_cvt_pk_bf16_f32 v113, v114, v115
 v_cvt_pk_bf16_f32 v114, v116, v117
 v_cvt_pk_bf16_f32 v115, v118, v119
 ds_write_b128 v14, v[112:115] offset:10240
 v_pk_mul_f32 v[120:121], v[120:121], s[4:5] op_sel:[0,1] op_sel_hi:[1,1]
 v_pk_mul_f32 v[122:123], v[122:123], s[4:5] op_sel:[0,1] op_sel_hi:[1,1]
 v_pk_mul_f32 v[124:125], v[124:125], s[4:5] op_sel:[0,1] op_sel_hi:[1,1]
 v_pk_mul_f32 v[126:127], v[126:127], s[4:5] op_sel:[0,1] op_sel_hi:[1,1]
 v_cvt_pk_bf16_f32 v120, v120, v121
 v_cvt_pk_bf16_f32 v121, v122, v123
 v_cvt_pk_bf16_f32 v122, v124, v125
 v_cvt_pk_bf16_f32 v123, v126, v127
 ds_write_b128 v14, v[120:123] offset:11264
 v_pk_mul_f32 v[160:161], v[160:161], s[4:5] op_sel:[0,1] op_sel_hi:[1,1]
 v_pk_mul_f32 v[162:163], v[162:163], s[4:5] op_sel:[0,1] op_sel_hi:[1,1]
 v_pk_mul_f32 v[164:165], v[164:165], s[4:5] op_sel:[0,1] op_sel_hi:[1,1]
 v_pk_mul_f32 v[166:167], v[166:167], s[4:5] op_sel:[0,1] op_sel_hi:[1,1]
 v_cvt_pk_bf16_f32 v160, v160, v161
 v_cvt_pk_bf16_f32 v161, v162, v163
 v_cvt_pk_bf16_f32 v162, v164, v165
 v_cvt_pk_bf16_f32 v163, v166, v167
 ds_write_b128 v14, v[160:163] offset:16384
 v_pk_mul_f32 v[168:169], v[168:169], s[4:5] op_sel:[0,1] op_sel_hi:[1,1]
 v_pk_mul_f32 v[170:171], v[170:171], s[4:5] op_sel:[0,1] op_sel_hi:[1,1]
 v_pk_mul_f32 v[172:173], v[172:173], s[4:5] op_sel:[0,1] op_sel_hi:[1,1]
 v_pk_mul_f32 v[174:175], v[174:175], s[4:5] op_sel:[0,1] op_sel_hi:[1,1]
 v_cvt_pk_bf16_f32 v168, v168, v169
 v_cvt_pk_bf16_f32 v169, v170, v171
 v_cvt_pk_bf16_f32 v170, v172, v173
 v_cvt_pk_bf16_f32 v171, v174, v175
 ds_write_b128 v14, v[168:171] offset:17408
 v_pk_mul_f32 v[176:177], v[176:177], s[4:5] op_sel:[0,1] op_sel_hi:[1,1]
 v_pk_mul_f32 v[178:179], v[178:179], s[4:5] op_sel:[0,1] op_sel_hi:[1,1]
 v_pk_mul_f32 v[180:181], v[180:181], s[4:5] op_sel:[0,1] op_sel_hi:[1,1]
 v_pk_mul_f32 v[182:183], v[182:183], s[4:5] op_sel:[0,1] op_sel_hi:[1,1]
 v_cvt_pk_bf16_f32 v176, v176, v177
 v_cvt_pk_bf16_f32 v177, v178, v179
 v_cvt_pk_bf16_f32 v178, v180, v181
 v_cvt_pk_bf16_f32 v179, v182, v183
 ds_write_b128 v14, v[176:179] offset:18432
 v_pk_mul_f32 v[184:185], v[184:185], s[4:5] op_sel:[0,1] op_sel_hi:[1,1]
 v_pk_mul_f32 v[186:187], v[186:187], s[4:5] op_sel:[0,1] op_sel_hi:[1,1]
 v_pk_mul_f32 v[188:189], v[188:189], s[4:5] op_sel:[0,1] op_sel_hi:[1,1]
 v_pk_mul_f32 v[190:191], v[190:191], s[4:5] op_sel:[0,1] op_sel_hi:[1,1]
 v_cvt_pk_bf16_f32 v184, v184, v185
 v_cvt_pk_bf16_f32 v185, v186, v187
 v_cvt_pk_bf16_f32 v186, v188, v189
 v_cvt_pk_bf16_f32 v187, v190, v191
 ds_write_b128 v14, v[184:187] offset:19456
 v_pk_mul_f32 v[224:225], v[224:225], s[4:5] op_sel:[0,1] op_sel_hi:[1,1]
 v_pk_mul_f32 v[226:227], v[226:227], s[4:5] op_sel:[0,1] op_sel_hi:[1,1]
 v_pk_mul_f32 v[228:229], v[228:229], s[4:5] op_sel:[0,1] op_sel_hi:[1,1]
 v_pk_mul_f32 v[230:231], v[230:231], s[4:5] op_sel:[0,1] op_sel_hi:[1,1]
 v_cvt_pk_bf16_f32 v224, v224, v225
 v_cvt_pk_bf16_f32 v225, v226, v227
 v_cvt_pk_bf16_f32 v226, v228, v229
 v_cvt_pk_bf16_f32 v227, v230, v231
 ds_write_b128 v14, v[224:227] offset:24576
 v_pk_mul_f32 v[232:233], v[232:233], s[4:5] op_sel:[0,1] op_sel_hi:[1,1]
 v_pk_mul_f32 v[234:235], v[234:235], s[4:5] op_sel:[0,1] op_sel_hi:[1,1]
 v_pk_mul_f32 v[236:237], v[236:237], s[4:5] op_sel:[0,1] op_sel_hi:[1,1]
 v_pk_mul_f32 v[238:239], v[238:239], s[4:5] op_sel:[0,1] op_sel_hi:[1,1]
 v_cvt_pk_bf16_f32 v232, v232, v233
 v_cvt_pk_bf16_f32 v233, v234, v235
 v_cvt_pk_bf16_f32 v234, v236, v237
 v_cvt_pk_bf16_f32 v235, v238, v239
 ds_write_b128 v14, v[232:235] offset:25600
 v_pk_mul_f32 v[240:241], v[240:241], s[4:5] op_sel:[0,1] op_sel_hi:[1,1]
 v_pk_mul_f32 v[242:243], v[242:243], s[4:5] op_sel:[0,1] op_sel_hi:[1,1]
 v_pk_mul_f32 v[244:245], v[244:245], s[4:5] op_sel:[0,1] op_sel_hi:[1,1]
 v_pk_mul_f32 v[246:247], v[246:247], s[4:5] op_sel:[0,1] op_sel_hi:[1,1]
 v_cvt_pk_bf16_f32 v240, v240, v241
 v_cvt_pk_bf16_f32 v241, v242, v243
 v_cvt_pk_bf16_f32 v242, v244, v245
 v_cvt_pk_bf16_f32 v243, v246, v247
 ds_write_b128 v14, v[240:243] offset:26624
 v_pk_mul_f32 v[248:249], v[248:249], s[4:5] op_sel:[0,1] op_sel_hi:[1,1]
 v_pk_mul_f32 v[250:251], v[250:251], s[4:5] op_sel:[0,1] op_sel_hi:[1,1]
 v_pk_mul_f32 v[252:253], v[252:253], s[4:5] op_sel:[0,1] op_sel_hi:[1,1]
 v_pk_mul_f32 v[254:255], v[254:255], s[4:5] op_sel:[0,1] op_sel_hi:[1,1]
 v_cvt_pk_bf16_f32 v248, v248, v249
 v_cvt_pk_bf16_f32 v249, v250, v251
 v_cvt_pk_bf16_f32 v250, v252, v253
 v_cvt_pk_bf16_f32 v251, v254, v255
 ds_write_b128 v14, v[248:251] offset:27648
 s_waitcnt vmcnt(17) lgkmcnt(0)
 s_barrier
 ds_read_b128 a[64:67], v2 offset:32768
 ds_read_b128 a[68:71], v2 offset:33792
 ds_read_b128 a[72:75], v2 offset:34816
 ds_read_b128 a[76:79], v2 offset:35840
 ds_read_b128 a[80:83], v2 offset:36864
 ds_read_b128 a[84:87], v2 offset:37888
 ds_read_b128 a[88:91], v2 offset:38912
 ds_read_b128 a[92:95], v2 offset:39936
 s_lshl_b32 s64, s20, 13
 s_sub_u32 s65, 155648, s64
 v_add_u32 v10, s64, v7
 v_add_u32 v11, s65, v7
 ds_read_b128 a[0:3], v10 offset:0
 ds_read_b128 a[4:7], v10 offset:1024
 ds_read_b128 a[8:11], v10 offset:2048
 ds_read_b128 a[12:15], v10 offset:3072
 ds_read_b128 a[16:19], v10 offset:4096
 ds_read_b128 a[20:23], v10 offset:5120
 ds_read_b128 a[24:27], v10 offset:6144
 ds_read_b128 a[28:31], v10 offset:7168
 ds_read_b128 a[32:35], v11 offset:0
 ds_read_b128 a[36:39], v11 offset:1024
 ds_read_b128 a[40:43], v11 offset:2048
 ds_read_b128 a[44:47], v11 offset:3072
 ds_read_b128 a[48:51], v11 offset:4096
 ds_read_b128 a[52:55], v11 offset:5120
 ds_read_b128 a[56:59], v11 offset:6144
 ds_read_b128 a[60:63], v11 offset:7168
 s_waitcnt vmcnt(14)
 v_cmp_eq_u32 vcc, 0, v24
 v_mov_b32 v17, 5
 v_or_b32 v6, s35, v7
 s_cbranch_vccnz L_f1s05
L_f1r05:
 s_mov_b32 s30, s93
 s_add_u32 s29, s94, s92
 s_cmp_eq_u32 s20, 0
 s_cselect_b32 s5, 0, 0
 v_mov_b32 v32, 0xc1800000
 v_mov_b32 v33, 0xc1800000
 v_mov_b32 v34, 0xc1800000
 v_mov_b32 v35, 0xc1800000
 v_mov_b32 v36, 0xc1800000
 v_mov_b32 v37, 0xc1800000
 v_mov_b32 v38, 0xc1800000
 v_mov_b32 v39, 0xc1800000
 s_waitcnt lgkmcnt(0)
M v[64:67], a[64:67], a[0:3], v[32:35]
 ds_read_b128 a[96:99], v2 offset:40960
 v_mov_b32 v30, 0
M v[64:67], a[68:71], a[4:7], v[64:67]
 s_add_u32 m0, s28, 65536
 ds_read_b128 a[100:103], v2 offset:41984
 v_mov_b32 v31, 0
M v[64:67], a[72:75], a[8:11], v[64:67]
 buffer_load_dwordx4 v3, s[8:11], s24 offen offset:0 sc1 lds
M v[64:67], a[76:79], a[12:15], v[64:67]
 ds_read_b128 a[104:107], v2 offset:43008
M v[64:67], a[80:83], a[16:19], v[64:67]
 ds_read_b128 a[108:111], v2 offset:44032
M v[64:67], a[84:87], a[20:23], v[64:67]
 buffer_load_dwordx4 v3, s[8:11], s24 offen offset:1024 sc1 lds
M v[64:67], a[88:91], a[24:27], v[64:67]
 ds_read_b128 a[112:115], v2 offset:45056
M v[64:67], a[92:95], a[28:31], v[64:67]
 ds_read_b128 a[116:119], v2 offset:46080
M v[68:71], a[92:95], a[60:63], v[36:39]
M v[68:71], a[88:91], a[56:59], v[68:71]
 ds_read_b128 a[120:123], v2 offset:47104
M v[68:71], a[84:87], a[52:55], v[68:71]
 ds_read_b128 a[124:127], v2 offset:48128
M v[68:71], a[80:83], a[48:51], v[68:71]
 buffer_load_dwordx4 v3, s[8:11], s24 offen offset:2048 sc1 lds
M v[68:71], a[76:79], a[44:47], v[68:71]
 v_exp_f32 v18, v64
M v[68:71], a[72:75], a[40:43], v[68:71]
 v_exp_f32 v19, v65
M v[68:71], a[68:71], a[36:39], v[68:71]
 v_exp_f32 v20, v66
M v[68:71], a[64:67], a[32:35], v[68:71]
 s_waitcnt lgkmcnt(0)
 v_exp_f32 v21, v67
M v[72:75], a[96:99], a[0:3], v[32:35]
 ds_read_b128 a[64:67], v2 offset:49152
 v_add_f32 v26, v18, v19
M v[72:75], a[100:103], a[4:7], v[72:75]
 ds_read_b128 a[68:71], v2 offset:50176
 v_cvt_pk_bf16_f32 v40, v18, v19
M v[72:75], a[104:107], a[8:11], v[72:75]
 buffer_load_dwordx4 v3, s[8:11], s24 offen offset:3072 sc1 lds
M v[72:75], a[108:111], a[12:15], v[72:75]
 ds_read_b128 a[72:75], v2 offset:51200
 v_add_f32 v26, v20, v26
M v[72:75], a[112:115], a[16:19], v[72:75]
 s_add_u32 m0, s28, 69632
 ds_read_b128 a[76:79], v2 offset:52224
 v_cvt_pk_bf16_f32 v41, v20, v21
M v[72:75], a[116:119], a[20:23], v[72:75]
 buffer_load_dwordx4 v4, s[8:11], s24 offen offset:0 sc1 lds
M v[72:75], a[120:123], a[24:27], v[72:75]
 ds_read_b128 a[80:83], v2 offset:53248
 v_add_f32 v26, v21, v26
M v[72:75], a[124:127], a[28:31], v[72:75]
 ds_read_b128 a[84:87], v2 offset:54272
M v[76:79], a[124:127], a[60:63], v[36:39]
 v_exp_f32 v22, v68
M v[76:79], a[120:123], a[56:59], v[76:79]
 ds_read_b128 a[88:91], v2 offset:55296
M v[76:79], a[116:119], a[52:55], v[76:79]
 ds_read_b128 a[92:95], v2 offset:56320
M v[76:79], a[112:115], a[48:51], v[76:79]
 buffer_load_dwordx4 v4, s[8:11], s24 offen offset:1024 sc1 lds
M v[76:79], a[108:111], a[44:47], v[76:79]
 v_exp_f32 v23, v69
M v[76:79], a[104:107], a[40:43], v[76:79]
 v_exp_f32 v24, v70
M v[76:79], a[100:103], a[36:39], v[76:79]
 buffer_load_dwordx4 v4, s[8:11], s24 offen offset:2048 sc1 lds
M v[76:79], a[96:99], a[32:35], v[76:79]
 s_waitcnt lgkmcnt(0)
 v_exp_f32 v25, v71
M v[80:83], a[64:67], a[0:3], v[32:35]
 ds_read_b128 a[96:99], v2 offset:57344
 v_add_f32 v27, v22, v23
M v[80:83], a[68:71], a[4:7], v[80:83]
 ds_read_b128 a[100:103], v2 offset:58368
 v_cvt_pk_bf16_f32 v44, v22, v23
M v[80:83], a[72:75], a[8:11], v[80:83]
 v_exp_f32 v18, v72
M v[80:83], a[76:79], a[12:15], v[80:83]
 ds_read_b128 a[104:107], v2 offset:59392
 v_add_f32 v27, v24, v27
M v[80:83], a[80:83], a[16:19], v[80:83]
 ds_read_b128 a[108:111], v2 offset:60416
 v_cvt_pk_bf16_f32 v45, v24, v25
M v[80:83], a[84:87], a[20:23], v[80:83]
 buffer_load_dwordx4 v4, s[8:11], s24 offen offset:3072 sc1 lds
M v[80:83], a[88:91], a[24:27], v[80:83]
 ds_read_b128 a[112:115], v2 offset:61440
 v_add_f32 v27, v25, v27
M v[80:83], a[92:95], a[28:31], v[80:83]
 ds_read_b128 a[116:119], v2 offset:62464
M v[84:87], a[92:95], a[60:63], v[36:39]
 v_exp_f32 v19, v73
M v[84:87], a[88:91], a[56:59], v[84:87]
 ds_read_b128 a[120:123], v2 offset:63488
 v_add_f32 v26, v18, v26
M v[84:87], a[84:87], a[52:55], v[84:87]
 ds_read_b128 a[124:127], v2 offset:64512
 v_cvt_pk_bf16_f32 v42, v18, v19
M v[84:87], a[80:83], a[48:51], v[84:87]
 v_exp_f32 v20, v74
M v[84:87], a[76:79], a[44:47], v[84:87]
 v_exp_f32 v21, v75
M v[84:87], a[72:75], a[40:43], v[84:87]
 v_exp_f32 v22, v76
M v[84:87], a[68:71], a[36:39], v[84:87]
 s_waitcnt vmcnt(8) lgkmcnt(0)
 v_exp_f32 v23, v77
M v[84:87], a[64:67], a[32:35], v[84:87]
 s_barrier
M v[88:91], a[96:99], a[0:3], v[32:35]
 ds_read_b128 a[64:67], v7 offset:32768
 v_add_f32 v26, v19, v26
M v[88:91], a[100:103], a[4:7], v[88:91]
 ds_read_b128 a[68:71], v7 offset:33792
 v_add_f32 v26, v20, v26
M v[88:91], a[104:107], a[8:11], v[88:91]
 buffer_store_dword v17, v1, s[8:11], s45 offen sc1
M v[88:91], a[108:111], a[12:15], v[88:91]
 ds_read_b128 a[72:75], v7 offset:34816
 v_cvt_pk_bf16_f32 v43, v20, v21
M v[88:91], a[112:115], a[16:19], v[88:91]
 ds_read_b128 a[76:79], v7 offset:35840
 v_add_f32 v26, v21, v26
M v[88:91], a[116:119], a[20:23], v[88:91]
 v_exp_f32 v24, v78
M v[88:91], a[120:123], a[24:27], v[88:91]
 ds_read_b128 a[80:83], v7 offset:36864
 v_add_f32 v27, v22, v27
M v[88:91], a[124:127], a[28:31], v[88:91]
 ds_read_b128 a[84:87], v7 offset:37888
 v_cvt_pk_bf16_f32 v46, v22, v23
M v[92:95], a[124:127], a[60:63], v[36:39]
 v_exp_f32 v25, v79
M v[92:95], a[120:123], a[56:59], v[92:95]
 ds_read_b128 a[88:91], v7 offset:38912
 v_add_f32 v27, v23, v27
M v[92:95], a[116:119], a[52:55], v[92:95]
 ds_read_b128 a[92:95], v7 offset:39936
 v_add_f32 v27, v24, v27
M v[92:95], a[112:115], a[48:51], v[92:95]
 v_cvt_pk_bf16_f32 v47, v24, v25
 v_add_f32 v27, v25, v27
M v[92:95], a[108:111], a[44:47], v[92:95]
M v[92:95], a[104:107], a[40:43], v[92:95]
M v[92:95], a[100:103], a[36:39], v[92:95]
 s_waitcnt lgkmcnt(0)
M v[92:95], a[96:99], a[32:35], v[92:95]
 s_cmp_eq_u32 s42, 0
 s_cbranch_scc1 L_j0
M v[96:99], a[64:67], a[0:3], v[32:35]
 s_add_u32 m0, s28, 98304
 ds_read_b128 a[96:99], v7 offset:40960
M v[96:99], a[68:71], a[4:7], v[96:99]
 ds_read_b128 a[100:103], v7 offset:41984
M v[96:99], a[72:75], a[8:11], v[96:99]
 buffer_load_dwordx4 v3, s[8:11], s21 offen offset:0 sc1 lds
M v[96:99], a[76:79], a[12:15], v[96:99]
 s_cmp_eq_u32 s20, 0
 ds_read_b128 a[104:107], v7 offset:43008
M v[96:99], a[80:83], a[16:19], v[96:99]
 s_cselect_b64 s[64:65], s[16:17], 0
 ds_read_b128 a[108:111], v7 offset:44032
M v[96:99], a[84:87], a[20:23], v[96:99]
 buffer_load_dwordx4 v3, s[8:11], s21 offen offset:1024 sc1 lds
M v[96:99], a[88:91], a[24:27], v[96:99]
 s_cselect_b64 s[66:67], s[18:19], 0
 ds_read_b128 a[112:115], v7 offset:45056
M v[96:99], a[92:95], a[28:31], v[96:99]
 s_cselect_b64 s[68:69], s[48:49], 0
 ds_read_b128 a[116:119], v7 offset:46080
M v[100:103], a[92:95], a[60:63], v[36:39]
 s_cselect_b64 s[70:71], s[50:51], 0
 v_exp_f32 v18, v80
M v[100:103], a[88:91], a[56:59], v[100:103]
 s_cmp_lt_u32 s20, 1
 ds_read_b128 a[120:123], v7 offset:47104
M v[100:103], a[84:87], a[52:55], v[100:103]
 s_cselect_b64 s[78:79], -1, 0
 ds_read_b128 a[124:127], v7 offset:48128
M v[100:103], a[80:83], a[48:51], v[100:103]
 buffer_load_dwordx4 v3, s[8:11], s21 offen offset:2048 sc1 lds
M v[100:103], a[76:79], a[44:47], v[100:103]
 s_cmp_eq_u32 s20, 1
 v_exp_f32 v19, v81
M v[100:103], a[72:75], a[40:43], v[100:103]
 s_cselect_b64 s[72:73], s[16:17], s[78:79]
 v_exp_f32 v20, v82
M v[100:103], a[68:71], a[36:39], v[100:103]
 s_cselect_b64 s[74:75], s[18:19], s[78:79]
 v_exp_f32 v21, v83
M v[100:103], a[64:67], a[32:35], v[100:103]
 s_waitcnt lgkmcnt(0)
 v_exp_f32 v22, v88
M v[108:111], a[96:99], a[32:35], v[36:39]
 s_cselect_b64 s[76:77], s[48:49], s[78:79]
 ds_read_b128 a[64:67], v7 offset:49152
 v_add_f32 v26, v18, v26
M v[108:111], a[100:103], a[36:39], v[108:111]
 s_cselect_b64 s[78:79], s[50:51], s[78:79]
 ds_read_b128 a[68:71], v7 offset:50176
 v_cvt_pk_bf16_f32 v56, v18, v19
M v[108:111], a[104:107], a[40:43], v[108:111]
 buffer_load_dwordx4 v3, s[8:11], s21 offen offset:3072 sc1 lds
M v[108:111], a[108:111], a[44:47], v[108:111]
 s_add_u32 m0, s28, 102400
 ds_read_b128 a[72:75], v7 offset:51200
 v_add_f32 v26, v19, v26
M v[108:111], a[112:115], a[48:51], v[108:111]
 s_cmp_lt_u32 s20, 2
 ds_read_b128 a[76:79], v7 offset:52224
 v_add_f32 v26, v20, v26
M v[108:111], a[116:119], a[52:55], v[108:111]
 buffer_load_dwordx4 v4, s[8:11], s21 offen offset:0 sc1 lds
M v[108:111], a[120:123], a[56:59], v[108:111]
 s_cselect_b64 s[86:87], -1, 0
 ds_read_b128 a[80:83], v7 offset:53248
 v_cvt_pk_bf16_f32 v57, v20, v21
M v[108:111], a[124:127], a[60:63], v[108:111]
 s_cmp_eq_u32 s20, 2
 ds_read_b128 a[84:87], v7 offset:54272
 v_add_f32 v26, v21, v26
M v[104:107], a[124:127], a[28:31], v[32:35]
 s_cselect_b64 s[80:81], s[16:17], s[86:87]
 v_exp_f32 v23, v89
M v[104:107], a[120:123], a[24:27], v[104:107]
 s_cselect_b64 s[82:83], s[18:19], s[86:87]
 ds_read_b128 a[88:91], v7 offset:55296
 v_add_f32 v26, v22, v26
M v[104:107], a[116:119], a[20:23], v[104:107]
 s_cselect_b64 s[84:85], s[48:49], s[86:87]
 ds_read_b128 a[92:95], v7 offset:56320
 v_cvt_pk_bf16_f32 v58, v22, v23
M v[104:107], a[112:115], a[16:19], v[104:107]
 buffer_load_dwordx4 v4, s[8:11], s21 offen offset:1024 sc1 lds
M v[104:107], a[108:111], a[12:15], v[104:107]
 s_cselect_b64 s[86:87], s[50:51], s[86:87]
 v_exp_f32 v24, v90
M v[104:107], a[104:107], a[8:11], v[104:107]
 s_cmp_eq_u32 s20, 3
 v_exp_f32 v25, v91
M v[104:107], a[100:103], a[4:7], v[104:107]
 buffer_load_dwordx4 v4, s[8:11], s21 offen offset:2048 sc1 lds
M v[104:107], a[96:99], a[0:3], v[104:107]
 s_waitcnt lgkmcnt(0)
 v_exp_f32 v18, v84
M v[112:115], a[64:67], a[0:3], v[32:35]
 s_cselect_b64 s[88:89], s[16:17], -1
 ds_read_b128 a[96:99], v7 offset:57344
 v_add_f32 v26, v23, v26
M v[112:115], a[68:71], a[4:7], v[112:115]
 s_cselect_b64 s[90:91], s[18:19], -1
 ds_read_b128 a[100:103], v7 offset:58368
 v_add_f32 v26, v24, v26
M v[112:115], a[72:75], a[8:11], v[112:115]
 s_cselect_b64 s[92:93], s[48:49], -1
 v_exp_f32 v19, v85
M v[112:115], a[76:79], a[12:15], v[112:115]
 s_cselect_b64 s[94:95], s[50:51], -1
 ds_read_b128 a[104:107], v7 offset:59392
 v_cvt_pk_bf16_f32 v59, v24, v25
M v[112:115], a[80:83], a[16:19], v[112:115]
 ds_read_b128 a[108:111], v7 offset:60416
 v_add_f32 v26, v25, v26
M v[112:115], a[84:87], a[20:23], v[112:115]
 buffer_load_dwordx4 v4, s[8:11], s21 offen offset:3072 sc1 lds
M v[112:115], a[88:91], a[24:27], v[112:115]
 s_add_u32 s24, s23, 33554432
 ds_read_b128 a[112:115], v7 offset:61440
 v_add_f32 v27, v18, v27
M v[112:115], a[92:95], a[28:31], v[112:115]
 s_mov_b32 s23, s21
 ds_read_b128 a[116:119], v7 offset:62464
 v_cvt_pk_bf16_f32 v60, v18, v19
M v[116:119], a[92:95], a[60:63], v[36:39]
 s_add_u32 s21, s21, 65536
 v_exp_f32 v20, v86
M v[116:119], a[88:91], a[56:59], v[116:119]
 s_add_u32 s22, s22, 1
 ds_read_b128 a[120:123], v7 offset:63488
 v_add_f32 v27, v19, v27
M v[116:119], a[84:87], a[52:55], v[116:119]
 s_cmp_eq_u32 s22, s25
 ds_read_b128 a[124:127], v7 offset:64512
M v[116:119], a[80:83], a[48:51], v[116:119]
 s_cselect_b32 s21, s26, s21
 v_exp_f32 v21, v87
M v[116:119], a[76:79], a[44:47], v[116:119]
 s_cmp_eq_u32 s22, s43
 v_exp_f32 v22, v92
M v[116:119], a[72:75], a[40:43], v[116:119]
 s_cselect_b32 s21, s4, s21
 v_exp_f32 v23, v93
M v[116:119], a[68:71], a[36:39], v[116:119]
 s_waitcnt vmcnt(9) lgkmcnt(0)
 v_add_f32 v27, v20, v27
 v_cvt_pk_bf16_f32 v61, v20, v21
M v[116:119], a[64:67], a[32:35], v[116:119]
 s_barrier
M v[124:127], a[96:99], a[32:35], v[36:39]
 s_cmp_eq_u32 s22, s6
 ds_read_b128 a[64:67], v2 offset:0
 v_add_f32 v27, v21, v27
M v[124:127], a[100:103], a[36:39], v[124:127]
 s_cselect_b32 s21, s7, s21
 ds_read_b128 a[68:71], v2 offset:1024
 v_add_f32 v27, v22, v27
M v[124:127], a[104:107], a[40:43], v[124:127]
 v_exp_f32 v24, v94
M v[124:127], a[108:111], a[44:47], v[124:127]
 ds_read_b128 a[72:75], v2 offset:2048
 v_cvt_pk_bf16_f32 v62, v22, v23
M v[124:127], a[112:115], a[48:51], v[124:127]
 ds_read_b128 a[76:79], v2 offset:3072
 v_add_f32 v27, v23, v27
M v[124:127], a[116:119], a[52:55], v[124:127]
 v_exp_f32 v25, v95
M v[124:127], a[120:123], a[56:59], v[124:127]
 ds_read_b128 a[80:83], v2 offset:4096
 v_add_f32 v27, v24, v27
M v[124:127], a[124:127], a[60:63], v[124:127]
 ds_read_b128 a[84:87], v2 offset:5120
 v_cvt_pk_bf16_f32 v63, v24, v25
M v[120:123], a[124:127], a[28:31], v[32:35]
 v_add_f32 v27, v25, v27
M v[120:123], a[120:123], a[24:27], v[120:123]
 ds_read_b128 a[88:91], v2 offset:6144
 v_max_f32 v10, v26, v27
M v[120:123], a[116:119], a[20:23], v[120:123]
 ds_read_b128 a[92:95], v2 offset:7168
 v_min_f32 v11, v26, v27
M v[120:123], a[112:115], a[16:19], v[120:123]
 v_cmp_lt_f32 s[36:37], s31, v10
M v[120:123], a[108:111], a[12:15], v[120:123]
 v_cmp_gt_f32 vcc, s55, v11
M v[120:123], a[104:107], a[8:11], v[120:123]
M v[120:123], a[100:103], a[4:7], v[120:123]
 s_waitcnt lgkmcnt(0)
 s_or_b64 vcc, vcc, s[36:37]
M v[120:123], a[96:99], a[0:3], v[120:123]
 s_cbranch_vccnz L_st10
L_rt10:
M v[128:131], a[64:67], v[40:43], 0
 s_add_u32 m0, s28, 0
 ds_read_b128 a[96:99], v2 offset:8192
 ds_read_b128 a[100:103], v2 offset:9216
M v[128:131], a[68:71], v[56:59], v[128:131]
 buffer_load_dwordx4 v3, s[8:11], s24 offen offset:0 sc1 lds
M v[132:135], a[68:71], v[60:63], 0
 v_exp_f32 v18, v96
M v[132:135], a[64:67], v[44:47], v[132:135]
 ds_read_b128 a[104:107], v2 offset:10240
 ds_read_b128 a[108:111], v2 offset:11264
M v[140:143], a[72:75], v[44:47], 0
 buffer_load_dwordx4 v3, s[8:11], s24 offen offset:1024 sc1 lds
M v[140:143], a[76:79], v[60:63], v[140:143]
 v_exp_f32 v19, v97
M v[136:139], a[76:79], v[56:59], 0
 ds_read_b128 a[112:115], v2 offset:12288
 ds_read_b128 a[116:119], v2 offset:13312
M v[136:139], a[72:75], v[40:43], v[136:139]
 buffer_load_dwordx4 v3, s[8:11], s24 offen offset:2048 sc1 lds
M v[144:147], a[80:83], v[40:43], 0
 v_exp_f32 v20, v98
M v[144:147], a[84:87], v[56:59], v[144:147]
 ds_read_b128 a[120:123], v2 offset:14336
 ds_read_b128 a[124:127], v2 offset:15360
M v[148:151], a[84:87], v[60:63], 0
 buffer_load_dwordx4 v3, s[8:11], s24 offen offset:3072 sc1 lds
M v[148:151], a[80:83], v[44:47], v[148:151]
 s_add_u32 m0, s28, 4096
 v_exp_f32 v21, v99
M v[156:159], a[88:91], v[44:47], 0
 buffer_load_dwordx4 v4, s[8:11], s24 offen offset:0 sc1 lds
M v[156:159], a[92:95], v[60:63], v[156:159]
 v_add_f32 v30, v26, v30
 v_add_f32 v31, v27, v31
M v[152:155], a[92:95], v[56:59], 0
 v_exp_f32 v22, v104
M v[152:155], a[88:91], v[40:43], v[152:155]
 s_waitcnt lgkmcnt(0)
 v_add_f32 v28, v18, v19
 v_cvt_pk_bf16_f32 v48, v18, v19
M v[160:163], a[96:99], v[40:43], 0
 ds_read_b128 a[64:67], v2 offset:16384
 ds_read_b128 a[68:71], v2 offset:17408
M v[160:163], a[100:103], v[56:59], v[160:163]
 buffer_load_dwordx4 v4, s[8:11], s24 offen offset:1024 sc1 lds
M v[164:167], a[100:103], v[60:63], 0
 v_exp_f32 v23, v105
M v[164:167], a[96:99], v[44:47], v[164:167]
 ds_read_b128 a[72:75], v2 offset:18432
 ds_read_b128 a[76:79], v2 offset:19456
M v[172:175], a[104:107], v[44:47], 0
 buffer_load_dwordx4 v4, s[8:11], s24 offen offset:2048 sc1 lds
M v[172:175], a[108:111], v[60:63], v[172:175]
 v_add_f32 v28, v20, v28
 v_cvt_pk_bf16_f32 v49, v20, v21
M v[168:171], a[108:111], v[56:59], 0
 ds_read_b128 a[80:83], v2 offset:20480
 ds_read_b128 a[84:87], v2 offset:21504
M v[168:171], a[104:107], v[40:43], v[168:171]
 buffer_load_dwordx4 v4, s[8:11], s24 offen offset:3072 sc1 lds
M v[176:179], a[112:115], v[40:43], 0
 v_exp_f32 v24, v106
M v[176:179], a[116:119], v[56:59], v[176:179]
 s_add_u32 m0, s28, 32768
 ds_read_b128 a[88:91], v2 offset:22528
 ds_read_b128 a[92:95], v2 offset:23552
M v[180:183], a[116:119], v[60:63], 0
 buffer_load_dwordx4 v3, s[8:11], s21 offen offset:0 sc1 lds
M v[180:183], a[112:115], v[44:47], v[180:183]
 v_exp_f32 v25, v107
M v[188:191], a[120:123], v[44:47], 0
 buffer_load_dwordx4 v3, s[8:11], s21 offen offset:1024 sc1 lds
M v[188:191], a[124:127], v[60:63], v[188:191]
 v_exp_f32 v18, v100
M v[184:187], a[124:127], v[56:59], 0
 buffer_load_dwordx4 v3, s[8:11], s21 offen offset:2048 sc1 lds
M v[184:187], a[120:123], v[40:43], v[184:187]
 s_waitcnt lgkmcnt(0)
 v_add_f32 v28, v21, v28
 v_add_f32 v28, v22, v28
M v[192:195], a[64:67], v[40:43], 0
 ds_read_b128 a[96:99], v2 offset:24576
 ds_read_b128 a[100:103], v2 offset:25600
M v[192:195], a[68:71], v[56:59], v[192:195]
 buffer_load_dwordx4 v3, s[8:11], s21 offen offset:3072 sc1 lds
M v[196:199], a[68:71], v[60:63], 0
 v_exp_f32 v19, v101
M v[196:199], a[64:67], v[44:47], v[196:199]
 s_add_u32 m0, s28, 36864
 ds_read_b128 a[104:107], v2 offset:26624
 ds_read_b128 a[108:111], v2 offset:27648
M v[204:207], a[72:75], v[44:47], 0
 buffer_load_dwordx4 v4, s[8:11], s21 offen offset:0 sc1 lds
M v[204:207], a[76:79], v[60:63], v[204:207]
 v_exp_f32 v20, v102
M v[200:203], a[76:79], v[56:59], 0
 ds_read_b128 a[112:115], v2 offset:28672
 ds_read_b128 a[116:119], v2 offset:29696
M v[200:203], a[72:75], v[40:43], v[200:203]
 buffer_load_dwordx4 v4, s[8:11], s21 offen offset:1024 sc1 lds
M v[208:211], a[80:83], v[40:43], 0
 v_exp_f32 v21, v103
M v[208:211], a[84:87], v[56:59], v[208:211]
 ds_read_b128 a[120:123], v2 offset:30720
 ds_read_b128 a[124:127], v2 offset:31744
M v[212:215], a[84:87], v[60:63], 0
 buffer_load_dwordx4 v4, s[8:11], s21 offen offset:2048 sc1 lds
M v[212:215], a[80:83], v[44:47], v[212:215]
 v_cvt_pk_bf16_f32 v50, v22, v23
 v_add_f32 v28, v23, v28
M v[220:223], a[88:91], v[44:47], 0
 v_exp_f32 v22, v108
M v[220:223], a[92:95], v[60:63], v[220:223]
 buffer_load_dwordx4 v4, s[8:11], s21 offen offset:3072 sc1 lds
M v[216:219], a[92:95], v[56:59], 0
 s_waitcnt vmcnt(16) lgkmcnt(0)
 s_add_u32 s24, s23, 33554432
 s_mov_b32 s23, s21
M v[216:219], a[88:91], v[40:43], v[216:219]
 s_barrier
M v[224:227], a[96:99], v[40:43], 0
 ds_read_b128 a[64:67], v2 offset:32768
 ds_read_b128 a[68:71], v2 offset:33792
M v[224:227], a[100:103], v[56:59], v[224:227]
 s_add_u32 s21, s21, 65536
 v_add_f32 v28, v24, v28
M v[228:231], a[100:103], v[60:63], 0
 s_add_u32 s22, s22, 1
 v_exp_f32 v23, v109
M v[228:231], a[96:99], v[44:47], v[228:231]
 s_cmp_eq_u32 s22, s25
 ds_read_b128 a[72:75], v2 offset:34816
 ds_read_b128 a[76:79], v2 offset:35840
M v[236:239], a[104:107], v[44:47], 0
 s_cselect_b32 s21, s26, s21
 v_cvt_pk_bf16_f32 v51, v24, v25
 v_add_f32 v28, v25, v28
M v[236:239], a[108:111], v[60:63], v[236:239]
 s_cmp_eq_u32 s22, s43
 v_exp_f32 v24, v110
M v[232:235], a[108:111], v[56:59], 0
 s_cselect_b32 s21, s4, s21
 ds_read_b128 a[80:83], v2 offset:36864
 ds_read_b128 a[84:87], v2 offset:37888
M v[232:235], a[104:107], v[40:43], v[232:235]
 s_cmp_eq_u32 s22, s6
 v_exp_f32 v25, v111
M v[240:243], a[112:115], v[40:43], 0
 s_cselect_b32 s21, s7, s21
 v_add_f32 v29, v18, v19
 v_cvt_pk_bf16_f32 v52, v18, v19
M v[240:243], a[116:119], v[56:59], v[240:243]
 ds_read_b128 a[88:91], v2 offset:38912
 ds_read_b128 a[92:95], v2 offset:39936
M v[244:247], a[116:119], v[60:63], 0
 v_add_f32 v29, v20, v29
 v_cvt_pk_bf16_f32 v53, v20, v21
M v[244:247], a[112:115], v[44:47], v[244:247]
 v_add_f32 v29, v21, v29
 v_add_f32 v29, v22, v29
M v[252:255], a[120:123], v[44:47], 0
 v_cvt_pk_bf16_f32 v54, v22, v23
 v_add_f32 v29, v23, v29
M v[252:255], a[124:127], v[60:63], v[252:255]
 s_cmp_lg_u32 s27, 0
 v_add_f32 v29, v24, v29
 v_cvt_pk_bf16_f32 v55, v24, v25
M v[248:251], a[124:127], v[56:59], 0
 s_waitcnt lgkmcnt(0)
 v_add_f32 v29, v25, v29
M v[248:251], a[120:123], v[40:43], v[248:251]
 s_cbranch_scc1 L_loop_top
 s_branch L_p1
L_j0:
 s_cmp_eq_u32 s20, 0
 s_cselect_b64 s[64:65], s[16:17], 0
 s_cselect_b64 s[66:67], s[18:19], 0
 s_cselect_b64 s[68:69], s[48:49], 0
 s_cselect_b64 s[70:71], s[50:51], 0
 s_cmp_lt_u32 s20, 1
 s_cselect_b64 s[78:79], -1, 0
 s_cmp_eq_u32 s20, 1
 s_cselect_b64 s[72:73], s[16:17], s[78:79]
 s_cselect_b64 s[74:75], s[18:19], s[78:79]
 s_cselect_b64 s[76:77], s[48:49], s[78:79]
 s_cselect_b64 s[78:79], s[50:51], s[78:79]
 s_cmp_lt_u32 s20, 2
 s_cselect_b64 s[86:87], -1, 0
 s_cmp_eq_u32 s20, 2
 s_cselect_b64 s[80:81], s[16:17], s[86:87]
 s_cselect_b64 s[82:83], s[18:19], s[86:87]
 s_cselect_b64 s[84:85], s[48:49], s[86:87]
 s_cselect_b64 s[86:87], s[50:51], s[86:87]
 s_cmp_eq_u32 s20, 3
 s_cselect_b64 s[88:89], s[16:17], -1
 s_cselect_b64 s[90:91], s[18:19], -1
 s_cselect_b64 s[92:93], s[48:49], -1
 s_cselect_b64 s[94:95], s[50:51], -1
 v_mov_b32 v56, 0
 v_mov_b32 v57, 0
 v_mov_b32 v58, 0
 v_mov_b32 v59, 0
 v_accvgpr_write_b32 a242, 0
 v_accvgpr_write_b32 a243, 0
 v_cndmask_b32 v64, v64, v8, s[64:65]
 v_cndmask_b32 v65, v65, v8, s[66:67]
 v_cndmask_b32 v66, v66, v8, s[68:69]
 v_cndmask_b32 v67, v67, v8, s[70:71]
 v_cndmask_b32 v72, v72, v8, s[72:73]
 v_cndmask_b32 v73, v73, v8, s[74:75]
 v_cndmask_b32 v74, v74, v8, s[76:77]
 v_cndmask_b32 v75, v75, v8, s[78:79]
 v_cndmask_b32 v80, v80, v8, s[80:81]
 v_cndmask_b32 v81, v81, v8, s[82:83]
 v_cndmask_b32 v82, v82, v8, s[84:85]
 v_cndmask_b32 v83, v83, v8, s[86:87]
 v_cndmask_b32 v88, v88, v8, s[88:89]
 v_cndmask_b32 v89, v89, v8, s[90:91]
 v_cndmask_b32 v90, v90, v8, s[92:93]
 v_cndmask_b32 v91, v91, v8, s[94:95]
 s_cmp_eq_u32 s20, 3
 s_cselect_b64 s[64:65], s[16:17], 0
 s_cselect_b64 s[66:67], s[18:19], 0
 s_cselect_b64 s[68:69], s[48:49], 0
 s_cselect_b64 s[70:71], s[50:51], 0
 s_cmp_gt_u32 s20, 2
 s_cselect_b64 s[78:79], -1, 0
 s_cmp_eq_u32 s20, 2
 s_cselect_b64 s[72:73], s[16:17], s[78:79]
 s_cselect_b64 s[74:75], s[18:19], s[78:79]
 s_cselect_b64 s[76:77], s[48:49], s[78:79]
 s_cselect_b64 s[78:79], s[50:51], s[78:79]
 s_cmp_gt_u32 s20, 1
 s_cselect_b64 s[86:87], -1, 0
 s_cmp_eq_u32 s20, 1
 s_cselect_b64 s[80:81], s[16:17], s[86:87]
 s_cselect_b64 s[82:83], s[18:19], s[86:87]
 s_cselect_b64 s[84:85], s[48:49], s[86:87]
 s_cselect_b64 s[86:87], s[50:51], s[86:87]
 s_cmp_eq_u32 s20, 0
 s_cselect_b64 s[88:89], s[16:17], -1
 s_cselect_b64 s[90:91], s[18:19], -1
 s_cselect_b64 s[92:93], s[48:49], -1
 s_cselect_b64 s[94:95], s[50:51], -1
 s_add_u32 m0, s28, 98304
 v_max3_f32 v10, v64, v65, v66
 buffer_load_dwordx4 v3, s[8:11], s21 offen offset:0 sc1 lds
 v_max3_f32 v10, v67, v72, v10
 v_max3_f32 v10, v73, v74, v10
 v_max3_f32 v10, v75, v80, v10
 v_max3_f32 v10, v81, v82, v10
 v_max3_f32 v10, v83, v88, v10
 v_max3_f32 v10, v89, v90, v10
 v_max_f32 v10, v91, v10
 v_max3_f32 v11, v68, v69, v70
 v_max3_f32 v11, v71, v76, v11
 v_max3_f32 v11, v77, v78, v11
 v_max3_f32 v11, v79, v84, v11
 v_mfma_f32_32x32x16_bf16 v[128:143], v[56:59], v[56:59], 0
 buffer_load_dwordx4 v3, s[8:11], s21 offen offset:1024 sc1 lds
 v_max3_f32 v11, v85, v86, v11
 v_max3_f32 v11, v87, v92, v11
 v_max3_f32 v11, v93, v94, v11
 v_max_f32 v11, v95, v11
 v_mov_b32 v12, v10
 v_mov_b32 v13, v11
 s_nop 0
 v_permlane16_swap_b32 v12, v10
 v_permlane16_swap_b32 v13, v11
 v_max_f32 v10, v12, v10
 v_max_f32 v11, v13, v11
 v_mov_b32 v12, v10
 buffer_load_dwordx4 v3, s[8:11], s21 offen offset:2048 sc1 lds
 v_mov_b32 v13, v11
 v_mfma_f32_32x32x16_bf16 v[144:159], v[56:59], v[56:59], 0
 v_permlane32_swap_b32 v12, v10
 v_permlane32_swap_b32 v13, v11
 v_max_f32 v10, v12, v10
 v_max_f32 v11, v13, v11
 v_ceil_f32 v10, v10
 v_ceil_f32 v11, v11
 v_sub_f32 v32, v32, v10
 v_sub_f32 v33, v33, v10
 v_sub_f32 v34, v34, v10
 v_sub_f32 v35, v35, v10
 buffer_load_dwordx4 v3, s[8:11], s21 offen offset:3072 sc1 lds
 v_sub_f32 v36, v36, v11
 v_sub_f32 v37, v37, v11
 v_sub_f32 v38, v38, v11
 v_mfma_f32_32x32x16_bf16 v[160:175], v[56:59], v[56:59], 0
 v_sub_f32 v39, v39, v11
 v_sub_f32 v64, v64, v10
 v_sub_f32 v65, v65, v10
 v_sub_f32 v66, v66, v10
 v_sub_f32 v67, v67, v10
 v_sub_f32 v68, v68, v11
 v_sub_f32 v69, v69, v11
 s_add_u32 m0, s28, 102400
 v_sub_f32 v70, v70, v11
 buffer_load_dwordx4 v4, s[8:11], s21 offen offset:0 sc1 lds
 v_sub_f32 v71, v71, v11
 v_sub_f32 v72, v72, v10
 v_sub_f32 v73, v73, v10
 v_sub_f32 v74, v74, v10
 v_mfma_f32_32x32x16_bf16 v[176:191], v[56:59], v[56:59], 0
 v_sub_f32 v75, v75, v10
 v_sub_f32 v76, v76, v11
 v_sub_f32 v77, v77, v11
 v_sub_f32 v78, v78, v11
 v_sub_f32 v79, v79, v11
 v_sub_f32 v80, v80, v10
 v_sub_f32 v81, v81, v10
 buffer_load_dwordx4 v4, s[8:11], s21 offen offset:1024 sc1 lds
 v_sub_f32 v82, v82, v10
 v_sub_f32 v83, v83, v10
 v_sub_f32 v84, v84, v11
 v_sub_f32 v85, v85, v11
 v_sub_f32 v86, v86, v11
 v_sub_f32 v87, v87, v11
 v_mfma_f32_32x32x16_bf16 v[192:207], v[56:59], v[56:59], 0
 v_sub_f32 v88, v88, v10
 v_sub_f32 v89, v89, v10
 v_sub_f32 v90, v90, v10
 v_sub_f32 v91, v91, v10
 v_sub_f32 v92, v92, v11
 buffer_load_dwordx4 v4, s[8:11], s21 offen offset:2048 sc1 lds
 v_sub_f32 v93, v93, v11
 v_sub_f32 v94, v94, v11
 v_sub_f32 v95, v95, v11
 v_exp_f32 v18, v64
 v_exp_f32 v19, v65
 v_exp_f32 v20, v66
 v_add_f32 v26, v18, v19
 v_cvt_pk_bf16_f32 v40, v18, v19
 v_mfma_f32_32x32x16_bf16 v[208:223], v[56:59], v[56:59], 0
 v_exp_f32 v21, v67
 v_exp_f32 v22, v72
 v_add_f32 v26, v20, v26
 buffer_load_dwordx4 v4, s[8:11], s21 offen offset:3072 sc1 lds
 v_cvt_pk_bf16_f32 v41, v20, v21
 v_exp_f32 v23, v73
 v_add_f32 v26, v21, v26
 v_exp_f32 v24, v74
 v_add_f32 v26, v22, v26
 v_cvt_pk_bf16_f32 v42, v22, v23
 v_exp_f32 v25, v75
 v_add_f32 v26, v23, v26
 v_exp_f32 v18, v68
 v_add_f32 v26, v24, v26
 v_mfma_f32_32x32x16_bf16 v[224:239], v[56:59], v[56:59], 0
 s_add_u32 s24, s23, 33554432
 s_mov_b32 s23, s21
 s_add_u32 s21, s21, 65536
 s_add_u32 s22, s22, 1
 s_cmp_eq_u32 s22, s25
 s_cselect_b32 s21, s26, s21
 s_cmp_eq_u32 s22, s43
 s_cselect_b32 s21, s4, s21
 s_cmp_eq_u32 s22, s6
 s_cselect_b32 s21, s7, s21
 v_cvt_pk_bf16_f32 v43, v24, v25
 buffer_load_dword v5, off, s[8:11], s47 sc1
 v_exp_f32 v19, v69
 v_add_f32 v26, v25, v26
 v_mfma_f32_32x32x16_bf16 v[240:255], v[56:59], v[56:59], 0
 v_exp_f32 v20, v70
 v_add_f32 v27, v18, v19
 v_cvt_pk_bf16_f32 v44, v18, v19
 v_exp_f32 v21, v71
 v_exp_f32 v22, v76
 v_add_f32 v27, v20, v27
 v_cvt_pk_bf16_f32 v45, v20, v21
 v_exp_f32 v23, v77
 v_add_f32 v27, v21, v27
 v_exp_f32 v24, v78
 v_add_f32 v27, v22, v27
 v_cvt_pk_bf16_f32 v46, v22, v23
 v_exp_f32 v25, v79
 v_add_f32 v27, v23, v27
 v_add_f32 v27, v24, v27
 v_cvt_pk_bf16_f32 v47, v24, v25
 v_add_f32 v27, v25, v27
 v_cndmask_b32 v100, v36, v8, s[64:65]
 v_cndmask_b32 v101, v36, v8, s[66:67]
 v_cndmask_b32 v102, v36, v8, s[68:69]
 v_cndmask_b32 v103, v36, v8, s[70:71]
 v_cndmask_b32 v108, v36, v8, s[72:73]
 v_cndmask_b32 v109, v36, v8, s[74:75]
 v_cndmask_b32 v110, v36, v8, s[76:77]
 v_cndmask_b32 v111, v36, v8, s[78:79]
 v_cndmask_b32 v116, v36, v8, s[80:81]
 v_cndmask_b32 v117, v36, v8, s[82:83]
 v_cndmask_b32 v118, v36, v8, s[84:85]
 v_cndmask_b32 v119, v36, v8, s[86:87]
 v_cndmask_b32 v124, v36, v8, s[88:89]
 v_cndmask_b32 v125, v36, v8, s[90:91]
 v_cndmask_b32 v126, v36, v8, s[92:93]
 v_cndmask_b32 v127, v36, v8, s[94:95]
 s_branch L_p2
L_kv1:
 s_mov_b32 s60, s90
 s_and_b32 s61, s91, 0xffff
 s_mov_b32 s62, 3670016
 s_mov_b32 s63, 0x20000
 s_waitcnt vmcnt(4) lgkmcnt(0)
 s_barrier
 ds_read_b128 a[160:163], v5 offset:0
 ds_read_b128 a[164:167], v6 offset:0
 ds_read_b64_tr_b16 a[32:33], v1 offset:0
 ds_read_b64_tr_b16 a[34:35], v1 offset:1024
 ds_read_b64_tr_b16 a[36:37], v1 offset:8192
 ds_read_b64_tr_b16 a[38:39], v1 offset:9216
 ds_read_b64_tr_b16 a[40:41], v2 offset:0
 ds_read_b64_tr_b16 a[42:43], v2 offset:1024
 ds_read_b64_tr_b16 a[44:45], v2 offset:8192
 ds_read_b64_tr_b16 a[46:47], v2 offset:9216
 ds_read_b128 a[168:171], v5 offset:2048
 ds_read_b128 a[172:175], v6 offset:2048
 ds_read_b64_tr_b16 a[48:49], v3 offset:0
 ds_read_b64_tr_b16 a[50:51], v3 offset:1024
 ds_read_b64_tr_b16 a[52:53], v3 offset:8192
 ds_read_b64_tr_b16 a[54:55], v3 offset:9216
 ds_read_b64_tr_b16 a[56:57], v4 offset:0
 ds_read_b64_tr_b16 a[58:59], v4 offset:1024
 ds_read_b64_tr_b16 a[60:61], v4 offset:8192
 ds_read_b64_tr_b16 a[62:63], v4 offset:9216
 ds_read_b128 a[176:179], v5 offset:4096
 ds_read_b128 a[180:183], v6 offset:4096
 ds_read_b128 a[184:187], v5 offset:6144
 ds_read_b128 a[188:191], v6 offset:6144
 s_add_u32 m0, s24, 16384
 s_nop 0
 buffer_load_dwordx4 v12, s[48:51], s22 offen offset:0   lds
 buffer_load_dwordx4 v13, s[48:51], s22 offen offset:1024   lds
 buffer_load_dwordx4 v14, s[48:51], s22 offen offset:2048   lds
 buffer_load_dwordx4 v15, s[48:51], s22 offen offset:3072   lds
 s_sub_u32 s22, s22, 2097024
 s_add_u32 m0, s23, 32768
 s_nop 0
 buffer_load_dwordx4 v8, s[16:19], s21 offen offset:0  nt lds
 buffer_load_dwordx4 v9, s[16:19], s21 offen offset:1024  nt lds
 buffer_load_dwordx4 v10, s[16:19], s21 offen offset:2048  nt lds
 buffer_load_dwordx4 v11, s[16:19], s21 offen offset:3072  nt lds
 s_add_u32 s21, s21, 128
 s_waitcnt lgkmcnt(15)
M a[0:3], a[32:35], a[160:163], 0
M a[0:3], a[36:39], a[164:167], a[0:3]
 s_waitcnt lgkmcnt(14)
M a[4:7], a[44:47], a[164:167], 0
M a[4:7], a[40:43], a[160:163], a[4:7]
 s_waitcnt lgkmcnt(8)
M a[8:11], a[48:51], a[160:163], 0
M a[8:11], a[52:55], a[164:167], a[8:11]
 s_waitcnt lgkmcnt(4)
M a[12:15], a[60:63], a[164:167], 0
 s_add_u32 m0, s23, 49152
M a[12:15], a[56:59], a[160:163], a[12:15]
 buffer_load_dwordx4 v8, s[16:19], s21 offen offset:0  nt lds
M v[32:35], a[32:35], a[168:171], 0
 buffer_load_dwordx4 v9, s[16:19], s21 offen offset:1024  nt lds
M v[32:35], a[36:39], a[172:175], v[32:35]
M v[36:39], a[44:47], a[172:175], 0
 buffer_load_dwordx4 v10, s[16:19], s21 offen offset:2048  nt lds
M v[36:39], a[40:43], a[168:171], v[36:39]
M v[40:43], a[48:51], a[168:171], 0
 buffer_load_dwordx4 v11, s[16:19], s21 offen offset:3072  nt lds
M v[40:43], a[52:55], a[172:175], v[40:43]
 s_add_u32 s21, s21, 524160
M v[44:47], a[60:63], a[172:175], 0
 s_waitcnt vmcnt(12) lgkmcnt(0)
M v[44:47], a[56:59], a[168:171], v[44:47]
 s_barrier
M v[64:67], a[32:35], a[176:179], 0
 s_add_u32 m0, s24, 32768
 ds_read_b64_tr_b16 a[64:65], v1 offset:16384
 ds_read_b64_tr_b16 a[66:67], v1 offset:17408
M v[64:67], a[36:39], a[180:183], v[64:67]
 ds_read_b64_tr_b16 a[68:69], v1 offset:24576
 ds_read_b64_tr_b16 a[70:71], v1 offset:25600
M v[68:71], a[44:47], a[180:183], 0
 buffer_load_dwordx4 v12, s[48:51], s22 offen offset:0   lds
M v[68:71], a[40:43], a[176:179], v[68:71]
 ds_read_b64_tr_b16 a[72:73], v2 offset:16384
 ds_read_b64_tr_b16 a[74:75], v2 offset:17408
M v[72:75], a[48:51], a[176:179], 0
 ds_read_b64_tr_b16 a[76:77], v2 offset:24576
 ds_read_b64_tr_b16 a[78:79], v2 offset:25600
M v[72:75], a[52:55], a[180:183], v[72:75]
 buffer_load_dwordx4 v13, s[48:51], s22 offen offset:1024   lds
M v[76:79], a[60:63], a[180:183], 0
 ds_read_b64_tr_b16 a[80:81], v3 offset:16384
 ds_read_b64_tr_b16 a[82:83], v3 offset:17408
M v[76:79], a[56:59], a[176:179], v[76:79]
 ds_read_b64_tr_b16 a[84:85], v3 offset:24576
 ds_read_b64_tr_b16 a[86:87], v3 offset:25600
M v[96:99], a[32:35], a[184:187], 0
 buffer_load_dwordx4 v14, s[48:51], s22 offen offset:2048   lds
M v[96:99], a[36:39], a[188:191], v[96:99]
 ds_read_b64_tr_b16 a[88:89], v4 offset:16384
 ds_read_b64_tr_b16 a[90:91], v4 offset:17408
M v[100:103], a[44:47], a[188:191], 0
 ds_read_b64_tr_b16 a[92:93], v4 offset:24576
 ds_read_b64_tr_b16 a[94:95], v4 offset:25600
M v[100:103], a[40:43], a[184:187], v[100:103]
 buffer_load_dwordx4 v15, s[48:51], s22 offen offset:3072   lds
M v[104:107], a[48:51], a[184:187], 0
 s_add_u32 s22, s22, 2097152
 v_max3_f32 v20, |v32|, |v33|, |v34|
 v_max3_f32 v20, |v35|, |v36|, v20
M v[104:107], a[52:55], a[188:191], v[104:107]
 v_max3_f32 v20, |v37|, |v38|, v20
 v_max3_f32 v21, |v64|, |v65|, |v66|
M v[108:111], a[60:63], a[188:191], 0
 s_add_u32 m0, s23, 0
 v_max3_f32 v21, |v67|, |v68|, v21
 v_max3_f32 v21, |v69|, |v70|, v21
M v[108:111], a[56:59], a[184:187], v[108:111]
 s_waitcnt lgkmcnt(0)
 v_min_f32 v20, v20, v21
 v_mul_f32 v20, 0x41000000, v20
M a[16:19], a[64:67], a[160:163], 0
 buffer_load_dwordx4 v8, s[16:19], s21 offen offset:0  nt lds
M a[16:19], a[68:71], a[164:167], a[16:19]
 v_mov_b32 v21, v20
 v_mov_b32 v22, v20
M a[20:23], a[76:79], a[164:167], 0
 buffer_load_dwordx4 v9, s[16:19], s21 offen offset:1024  nt lds
M a[20:23], a[72:75], a[160:163], a[20:23]
 v_mov_b32 v23, v20
 v_accvgpr_write_b32 a241, v20
M a[24:27], a[80:83], a[160:163], 0
M a[24:27], a[84:87], a[164:167], a[24:27]
M a[28:31], a[92:95], a[164:167], 0
 buffer_load_dwordx4 v10, s[16:19], s21 offen offset:2048  nt lds
M a[28:31], a[88:91], a[160:163], a[28:31]
M v[48:51], a[64:67], a[168:171], v[20:23]
M v[48:51], a[68:71], a[172:175], v[48:51]
 buffer_load_dwordx4 v11, s[16:19], s21 offen offset:3072  nt lds
M v[52:55], a[76:79], a[172:175], v[20:23]
 s_add_u32 s21, s21, 128
M v[52:55], a[72:75], a[168:171], v[52:55]
M v[56:59], a[80:83], a[168:171], v[20:23]
M v[56:59], a[84:87], a[172:175], v[56:59]
M v[60:63], a[92:95], a[172:175], v[20:23]
 s_cmp_eq_u32 s42, 8
 s_cbranch_scc1 L_nut
L_nutr:
 s_waitcnt vmcnt(12)
M v[60:63], a[88:91], a[168:171], v[60:63]
 s_barrier
M v[80:83], a[64:67], a[176:179], v[20:23]
 s_add_u32 m0, s24, 49152
 ds_read_b128 a[160:163], v5 offset:16384
 ds_read_b128 a[164:167], v6 offset:16384
M v[80:83], a[68:71], a[180:183], v[80:83]
 buffer_load_dwordx4 v12, s[48:51], s22 offen offset:0   lds
M v[84:87], a[76:79], a[180:183], v[20:23]
 ds_read_b64_tr_b16 a[96:97], v1 offset:32768
 ds_read_b64_tr_b16 a[98:99], v1 offset:33792
M v[84:87], a[72:75], a[176:179], v[84:87]
M v[88:91], a[80:83], a[176:179], v[20:23]
 buffer_load_dwordx4 v13, s[48:51], s22 offen offset:1024   lds
M v[88:91], a[84:87], a[180:183], v[88:91]
 ds_read_b64_tr_b16 a[100:101], v1 offset:40960
 ds_read_b64_tr_b16 a[102:103], v1 offset:41984
M v[92:95], a[92:95], a[180:183], v[20:23]
M v[92:95], a[88:91], a[176:179], v[92:95]
M v[112:115], a[64:67], a[184:187], v[20:23]
 ds_read_b64_tr_b16 a[104:105], v2 offset:32768
 ds_read_b64_tr_b16 a[106:107], v2 offset:33792
M v[112:115], a[68:71], a[188:191], v[112:115]
 buffer_load_dwordx4 v14, s[48:51], s22 offen offset:2048   lds
M v[116:119], a[76:79], a[188:191], v[20:23]
M v[116:119], a[72:75], a[184:187], v[116:119]
 ds_read_b64_tr_b16 a[108:109], v2 offset:40960
 ds_read_b64_tr_b16 a[110:111], v2 offset:41984
M v[120:123], a[80:83], a[184:187], v[20:23]
 buffer_load_dwordx4 v15, s[48:51], s22 offen offset:3072   lds
M v[120:123], a[84:87], a[188:191], v[120:123]
 s_waitcnt lgkmcnt(8)
M v[124:127], a[92:95], a[188:191], v[20:23]
 s_sub_u32 s22, s22, 2097024
M v[124:127], a[88:91], a[184:187], v[124:127]
 s_add_u32 m0, s23, 16384
 ds_read_b64_tr_b16 a[112:113], v3 offset:32768
 ds_read_b64_tr_b16 a[114:115], v3 offset:33792
M v[128:131], a[32:35], a[160:163], v[20:23]
 ds_read_b128 a[168:171], v5 offset:18432
 ds_read_b128 a[172:175], v6 offset:18432
M v[128:131], a[36:39], a[164:167], v[128:131]
 buffer_load_dwordx4 v8, s[16:19], s21 offen offset:0  nt lds
M v[132:135], a[44:47], a[164:167], v[20:23]
 ds_read_b64_tr_b16 a[116:117], v3 offset:40960
 ds_read_b64_tr_b16 a[118:119], v3 offset:41984
M v[132:135], a[40:43], a[160:163], v[132:135]
 buffer_load_dwordx4 v9, s[16:19], s21 offen offset:1024  nt lds
M v[136:139], a[48:51], a[160:163], v[20:23]
M v[136:139], a[52:55], a[164:167], v[136:139]
 ds_read_b64_tr_b16 a[120:121], v4 offset:32768
 ds_read_b64_tr_b16 a[122:123], v4 offset:33792
M v[140:143], a[60:63], a[164:167], v[20:23]
 buffer_load_dwordx4 v10, s[16:19], s21 offen offset:2048  nt lds
M v[140:143], a[56:59], a[160:163], v[140:143]
M v[144:147], a[64:67], a[160:163], v[20:23]
 ds_read_b64_tr_b16 a[124:125], v4 offset:40960
 ds_read_b64_tr_b16 a[126:127], v4 offset:41984
M v[144:147], a[68:71], a[164:167], v[144:147]
 buffer_load_dwordx4 v11, s[16:19], s21 offen offset:3072  nt lds
M v[148:151], a[76:79], a[164:167], v[20:23]
 s_add_u32 s21, s21, 524160
M v[148:151], a[72:75], a[160:163], v[148:151]
M v[152:155], a[80:83], a[160:163], v[20:23]
M v[152:155], a[84:87], a[164:167], v[152:155]
 s_waitcnt lgkmcnt(6)
M v[156:159], a[92:95], a[164:167], v[20:23]
 s_waitcnt vmcnt(16) lgkmcnt(0)
M v[156:159], a[88:91], a[160:163], v[156:159]
 s_barrier
M v[160:163], a[32:35], a[168:171], v[20:23]
 s_add_u32 m0, s24, 0
 ds_read_b128 a[160:163], v5 offset:20480
 ds_read_b128 a[164:167], v6 offset:20480
M v[160:163], a[36:39], a[172:175], v[160:163]
 buffer_load_dwordx4 v12, s[48:51], s22 offen offset:0   lds
M v[164:167], a[44:47], a[172:175], v[20:23]
 ds_read_b64_tr_b16 a[128:129], v1 offset:49152
 ds_read_b64_tr_b16 a[130:131], v1 offset:50176
M v[164:167], a[40:43], a[168:171], v[164:167]
M v[168:171], a[48:51], a[168:171], v[20:23]
 buffer_load_dwordx4 v13, s[48:51], s22 offen offset:1024   lds
M v[168:171], a[52:55], a[172:175], v[168:171]
 ds_read_b64_tr_b16 a[132:133], v1 offset:57344
 ds_read_b64_tr_b16 a[134:135], v1 offset:58368
M v[172:175], a[60:63], a[172:175], v[20:23]
M v[172:175], a[56:59], a[168:171], v[172:175]
M v[176:179], a[64:67], a[168:171], v[20:23]
 ds_read_b64_tr_b16 a[136:137], v2 offset:49152
 ds_read_b64_tr_b16 a[138:139], v2 offset:50176
M v[176:179], a[68:71], a[172:175], v[176:179]
 buffer_load_dwordx4 v14, s[48:51], s22 offen offset:2048   lds
M v[180:183], a[76:79], a[172:175], v[20:23]
M v[180:183], a[72:75], a[168:171], v[180:183]
 ds_read_b64_tr_b16 a[140:141], v2 offset:57344
 ds_read_b64_tr_b16 a[142:143], v2 offset:58368
M v[184:187], a[80:83], a[168:171], v[20:23]
 buffer_load_dwordx4 v15, s[48:51], s22 offen offset:3072   lds
M v[184:187], a[84:87], a[172:175], v[184:187]
 s_waitcnt lgkmcnt(8)
M v[188:191], a[92:95], a[172:175], v[20:23]
 s_add_u32 s22, s22, 2097152
M v[188:191], a[88:91], a[168:171], v[188:191]
 s_add_u32 m0, s23, 32768
 ds_read_b64_tr_b16 a[144:145], v3 offset:49152
 ds_read_b64_tr_b16 a[146:147], v3 offset:50176
M v[192:195], a[32:35], a[160:163], v[20:23]
 ds_read_b128 a[168:171], v5 offset:22528
 ds_read_b128 a[172:175], v6 offset:22528
M v[192:195], a[36:39], a[164:167], v[192:195]
 buffer_load_dwordx4 v8, s[16:19], s21 offen offset:0  nt lds
M v[196:199], a[44:47], a[164:167], v[20:23]
 ds_read_b64_tr_b16 a[148:149], v3 offset:57344
 ds_read_b64_tr_b16 a[150:151], v3 offset:58368
M v[196:199], a[40:43], a[160:163], v[196:199]
 buffer_load_dwordx4 v9, s[16:19], s21 offen offset:1024  nt lds
M v[200:203], a[48:51], a[160:163], v[20:23]
M v[200:203], a[52:55], a[164:167], v[200:203]
 ds_read_b64_tr_b16 a[152:153], v4 offset:49152
 ds_read_b64_tr_b16 a[154:155], v4 offset:50176
M v[204:207], a[60:63], a[164:167], v[20:23]
 buffer_load_dwordx4 v10, s[16:19], s21 offen offset:2048  nt lds
M v[204:207], a[56:59], a[160:163], v[204:207]
M v[208:211], a[64:67], a[160:163], v[20:23]
 ds_read_b64_tr_b16 a[156:157], v4 offset:57344
 ds_read_b64_tr_b16 a[158:159], v4 offset:58368
M v[208:211], a[68:71], a[164:167], v[208:211]
 buffer_load_dwordx4 v11, s[16:19], s21 offen offset:3072  nt lds
M v[212:215], a[76:79], a[164:167], v[20:23]
 s_add_u32 s21, s21, 128
M v[212:215], a[72:75], a[160:163], v[212:215]
M v[216:219], a[80:83], a[160:163], v[20:23]
M v[216:219], a[84:87], a[164:167], v[216:219]
 s_waitcnt lgkmcnt(6)
M v[220:223], a[92:95], a[164:167], v[20:23]
 s_waitcnt vmcnt(16) lgkmcnt(0)
M v[220:223], a[88:91], a[160:163], v[220:223]
 s_barrier
M v[224:227], a[32:35], a[168:171], v[20:23]
 ds_read_b128 a[160:163], v5 offset:32768
 ds_read_b128 a[164:167], v6 offset:32768
M v[224:227], a[36:39], a[172:175], v[224:227]
 buffer_load_dword a240, v24, s[32:35], 0 offen offset:512
M v[228:231], a[44:47], a[172:175], v[20:23]
M v[228:231], a[40:43], a[168:171], v[228:231]
M v[232:235], a[48:51], a[168:171], v[20:23]
M v[232:235], a[52:55], a[172:175], v[232:235]
M v[236:239], a[60:63], a[172:175], v[20:23]
M v[236:239], a[56:59], a[168:171], v[236:239]
M v[240:243], a[64:67], a[168:171], v[20:23]
M v[240:243], a[68:71], a[172:175], v[240:243]
M v[244:247], a[76:79], a[172:175], v[20:23]
M v[244:247], a[72:75], a[168:171], v[244:247]
M v[248:251], a[80:83], a[168:171], v[20:23]
M v[248:251], a[84:87], a[172:175], v[248:251]
 s_waitcnt lgkmcnt(0)
M v[252:255], a[92:95], a[172:175], v[20:23]
M v[252:255], a[88:91], a[168:171], v[252:255]
M a[0:3], a[96:99], a[160:163], a[0:3]
 ds_read_b128 a[168:171], v5 offset:34816
 ds_read_b128 a[172:175], v6 offset:34816
M a[0:3], a[100:103], a[164:167], a[0:3]
 ds_read_b64_tr_b16 a[32:33], v1 offset:0
 ds_read_b64_tr_b16 a[34:35], v1 offset:1024
M a[4:7], a[108:111], a[164:167], a[4:7]
 s_add_u32 m0, s24, 16384
M a[4:7], a[104:107], a[160:163], a[4:7]
 buffer_load_dwordx4 v12, s[48:51], s22 offen offset:0   lds
M a[8:11], a[112:115], a[160:163], a[8:11]
M a[8:11], a[116:119], a[164:167], a[8:11]
M a[12:15], a[124:127], a[164:167], a[12:15]
 ds_read_b64_tr_b16 a[36:37], v1 offset:8192
 ds_read_b64_tr_b16 a[38:39], v1 offset:9216
M a[12:15], a[120:123], a[160:163], a[12:15]
M a[16:19], a[128:131], a[160:163], a[16:19]
 buffer_load_dwordx4 v13, s[48:51], s22 offen offset:1024   lds
M a[16:19], a[132:135], a[164:167], a[16:19]
M a[20:23], a[140:143], a[164:167], a[20:23]
M a[20:23], a[136:139], a[160:163], a[20:23]
 ds_read_b64_tr_b16 a[40:41], v2 offset:0
 ds_read_b64_tr_b16 a[42:43], v2 offset:1024
M a[24:27], a[144:147], a[160:163], a[24:27]
M a[24:27], a[148:151], a[164:167], a[24:27]
 s_waitcnt lgkmcnt(6)
M a[28:31], a[156:159], a[164:167], a[28:31]
 buffer_load_dwordx4 v14, s[48:51], s22 offen offset:2048   lds
M a[28:31], a[152:155], a[160:163], a[28:31]
M v[60:63], a[152:155], a[168:171], v[60:63]
 ds_read_b128 a[160:163], v5 offset:36864
 ds_read_b128 a[164:167], v6 offset:36864
M v[60:63], a[156:159], a[172:175], v[60:63]
 ds_read_b64_tr_b16 a[44:45], v2 offset:8192
 ds_read_b64_tr_b16 a[46:47], v2 offset:9216
M v[56:59], a[148:151], a[172:175], v[56:59]
 buffer_load_dwordx4 v15, s[48:51], s22 offen offset:3072   lds
M v[56:59], a[144:147], a[168:171], v[56:59]
 s_sub_u32 s22, s22, 2097024
M v[52:55], a[136:139], a[168:171], v[52:55]
M v[52:55], a[140:143], a[172:175], v[52:55]
 ds_read_b64_tr_b16 a[48:49], v3 offset:0
 ds_read_b64_tr_b16 a[50:51], v3 offset:1024
M v[48:51], a[132:135], a[172:175], v[48:51]
 s_add_u32 m0, s23, 49152
M v[48:51], a[128:131], a[168:171], v[48:51]
 buffer_load_dwordx4 v8, s[16:19], s21 offen offset:0  nt lds
M v[44:47], a[120:123], a[168:171], v[44:47]
M v[44:47], a[124:127], a[172:175], v[44:47]
M v[40:43], a[116:119], a[172:175], v[40:43]
 ds_read_b64_tr_b16 a[52:53], v3 offset:8192
 ds_read_b64_tr_b16 a[54:55], v3 offset:9216
M v[40:43], a[112:115], a[168:171], v[40:43]
M v[36:39], a[104:107], a[168:171], v[36:39]
 buffer_load_dwordx4 v9, s[16:19], s21 offen offset:1024  nt lds
M v[36:39], a[108:111], a[172:175], v[36:39]
 s_waitcnt lgkmcnt(6)
M v[32:35], a[100:103], a[172:175], v[32:35]
M v[32:35], a[96:99], a[168:171], v[32:35]
 ds_read_b64_tr_b16 a[56:57], v4 offset:0
 ds_read_b64_tr_b16 a[58:59], v4 offset:1024
M v[64:67], a[96:99], a[160:163], v[64:67]
 ds_read_b128 a[168:171], v5 offset:38912
 ds_read_b128 a[172:175], v6 offset:38912
M v[64:67], a[100:103], a[164:167], v[64:67]
 buffer_load_dwordx4 v10, s[16:19], s21 offen offset:2048  nt lds
M v[68:71], a[108:111], a[164:167], v[68:71]
M v[68:71], a[104:107], a[160:163], v[68:71]
M v[72:75], a[112:115], a[160:163], v[72:75]
 ds_read_b64_tr_b16 a[60:61], v4 offset:8192
 ds_read_b64_tr_b16 a[62:63], v4 offset:9216
M v[72:75], a[116:119], a[164:167], v[72:75]
M v[76:79], a[124:127], a[164:167], v[76:79]
 buffer_load_dwordx4 v11, s[16:19], s21 offen offset:3072  nt lds
M v[76:79], a[120:123], a[160:163], v[76:79]
 s_add_u32 s21, s21, 524160
M v[80:83], a[128:131], a[160:163], v[80:83]
M v[80:83], a[132:135], a[164:167], v[80:83]
M v[84:87], a[140:143], a[164:167], v[84:87]
M v[84:87], a[136:139], a[160:163], v[84:87]
M v[88:91], a[144:147], a[160:163], v[88:91]
M v[88:91], a[148:151], a[164:167], v[88:91]
 s_waitcnt lgkmcnt(2)
M v[92:95], a[156:159], a[164:167], v[92:95]
 s_waitcnt vmcnt(17) lgkmcnt(0)
M v[92:95], a[152:155], a[160:163], v[92:95]
 s_barrier
M v[124:127], a[152:155], a[168:171], v[124:127]
 ds_read_b128 a[160:163], v5 offset:49152
 ds_read_b128 a[164:167], v6 offset:49152
M v[124:127], a[156:159], a[172:175], v[124:127]
M v[120:123], a[148:151], a[172:175], v[120:123]
 s_add_u32 m0, s24, 32768
 ds_read_b64_tr_b16 a[64:65], v1 offset:16384
 ds_read_b64_tr_b16 a[66:67], v1 offset:17408
M v[120:123], a[144:147], a[168:171], v[120:123]
 buffer_load_dwordx4 v12, s[48:51], s22 offen offset:0   lds
M v[116:119], a[136:139], a[168:171], v[116:119]
M v[116:119], a[140:143], a[172:175], v[116:119]
M v[112:115], a[132:135], a[172:175], v[112:115]
M v[112:115], a[128:131], a[168:171], v[112:115]
M v[108:111], a[120:123], a[168:171], v[108:111]
M v[108:111], a[124:127], a[172:175], v[108:111]
 ds_read_b64_tr_b16 a[68:69], v1 offset:24576
 ds_read_b64_tr_b16 a[70:71], v1 offset:25600
M v[104:107], a[116:119], a[172:175], v[104:107]
 buffer_load_dwordx4 v13, s[48:51], s22 offen offset:1024   lds
M v[104:107], a[112:115], a[168:171], v[104:107]
M v[100:103], a[104:107], a[168:171], v[100:103]
M v[100:103], a[108:111], a[172:175], v[100:103]
 s_waitcnt lgkmcnt(4)
M v[96:99], a[100:103], a[172:175], v[96:99]
M v[96:99], a[96:99], a[168:171], v[96:99]
M v[128:131], a[96:99], a[160:163], v[128:131]
 ds_read_b128 a[168:171], v5 offset:51200
 ds_read_b128 a[172:175], v6 offset:51200
M v[128:131], a[100:103], a[164:167], v[128:131]
 ds_read_b64_tr_b16 a[72:73], v2 offset:16384
 ds_read_b64_tr_b16 a[74:75], v2 offset:17408
M v[132:135], a[108:111], a[164:167], v[132:135]
 buffer_load_dwordx4 v14, s[48:51], s22 offen offset:2048   lds
M v[132:135], a[104:107], a[160:163], v[132:135]
M v[136:139], a[112:115], a[160:163], v[136:139]
M v[136:139], a[116:119], a[164:167], v[136:139]
M v[140:143], a[124:127], a[164:167], v[140:143]
M v[140:143], a[120:123], a[160:163], v[140:143]
 ds_read_b64_tr_b16 a[76:77], v2 offset:24576
 ds_read_b64_tr_b16 a[78:79], v2 offset:25600
M v[144:147], a[128:131], a[160:163], v[144:147]
 buffer_load_dwordx4 v15, s[48:51], s22 offen offset:3072   lds
M v[144:147], a[132:135], a[164:167], v[144:147]
 s_add_u32 s22, s22, 2097152
M v[148:151], a[140:143], a[164:167], v[148:151]
M v[148:151], a[136:139], a[160:163], v[148:151]
M v[152:155], a[144:147], a[160:163], v[152:155]
M v[152:155], a[148:151], a[164:167], v[152:155]
 s_waitcnt lgkmcnt(4)
M v[156:159], a[156:159], a[164:167], v[156:159]
 s_add_u32 m0, s23, 0
 ds_read_b64_tr_b16 a[80:81], v3 offset:16384
 ds_read_b64_tr_b16 a[82:83], v3 offset:17408
M v[156:159], a[152:155], a[160:163], v[156:159]
 buffer_load_dwordx4 v8, s[16:19], s21 offen offset:0  nt lds
M v[188:191], a[152:155], a[168:171], v[188:191]
 ds_read_b128 a[160:163], v5 offset:53248
 ds_read_b128 a[164:167], v6 offset:53248
M v[188:191], a[156:159], a[172:175], v[188:191]
M v[184:187], a[148:151], a[172:175], v[184:187]
M v[184:187], a[144:147], a[168:171], v[184:187]
M v[180:183], a[136:139], a[168:171], v[180:183]
M v[180:183], a[140:143], a[172:175], v[180:183]
 ds_read_b64_tr_b16 a[84:85], v3 offset:24576
 ds_read_b64_tr_b16 a[86:87], v3 offset:25600
M v[176:179], a[132:135], a[172:175], v[176:179]
 buffer_load_dwordx4 v9, s[16:19], s21 offen offset:1024  nt lds
M v[176:179], a[128:131], a[168:171], v[176:179]
M v[172:175], a[120:123], a[168:171], v[172:175]
M v[172:175], a[124:127], a[172:175], v[172:175]
M v[168:171], a[116:119], a[172:175], v[168:171]
M v[168:171], a[112:115], a[168:171], v[168:171]
M v[164:167], a[104:107], a[168:171], v[164:167]
 ds_read_b64_tr_b16 a[88:89], v4 offset:16384
 ds_read_b64_tr_b16 a[90:91], v4 offset:17408
M v[164:167], a[108:111], a[172:175], v[164:167]
 s_waitcnt lgkmcnt(4)
M v[160:163], a[100:103], a[172:175], v[160:163]
 buffer_load_dwordx4 v10, s[16:19], s21 offen offset:2048  nt lds
M v[160:163], a[96:99], a[168:171], v[160:163]
M v[192:195], a[96:99], a[160:163], v[192:195]
 ds_read_b128 a[168:171], v5 offset:55296
 ds_read_b128 a[172:175], v6 offset:55296
M v[192:195], a[100:103], a[164:167], v[192:195]
M v[196:199], a[108:111], a[164:167], v[196:199]
M v[196:199], a[104:107], a[160:163], v[196:199]
 ds_read_b64_tr_b16 a[92:93], v4 offset:24576
 ds_read_b64_tr_b16 a[94:95], v4 offset:25600
M v[200:203], a[112:115], a[160:163], v[200:203]
 buffer_load_dwordx4 v11, s[16:19], s21 offen offset:3072  nt lds
M v[200:203], a[116:119], a[164:167], v[200:203]
 s_add_u32 s21, s21, 128
M v[204:207], a[124:127], a[164:167], v[204:207]
M v[204:207], a[120:123], a[160:163], v[204:207]
M v[208:211], a[128:131], a[160:163], v[208:211]
M v[208:211], a[132:135], a[164:167], v[208:211]
M v[212:215], a[140:143], a[164:167], v[212:215]
M v[212:215], a[136:139], a[160:163], v[212:215]
M v[216:219], a[144:147], a[160:163], v[216:219]
M v[216:219], a[148:151], a[164:167], v[216:219]
 s_waitcnt lgkmcnt(2)
M v[220:223], a[156:159], a[164:167], v[220:223]
 s_waitcnt vmcnt(17) lgkmcnt(0)
M v[220:223], a[152:155], a[160:163], v[220:223]
 s_barrier
M v[252:255], a[152:155], a[168:171], v[252:255]
 ds_read_b128 a[160:163], v5 offset:0
 ds_read_b128 a[164:167], v6 offset:0
M v[252:255], a[156:159], a[172:175], v[252:255]
M v[248:251], a[148:151], a[172:175], v[248:251]
M v[248:251], a[144:147], a[168:171], v[248:251]
M v[244:247], a[136:139], a[168:171], v[244:247]
M v[244:247], a[140:143], a[172:175], v[244:247]
M v[240:243], a[132:135], a[172:175], v[240:243]
M v[240:243], a[128:131], a[168:171], v[240:243]
M v[236:239], a[120:123], a[168:171], v[236:239]
M v[236:239], a[124:127], a[172:175], v[236:239]
M v[232:235], a[116:119], a[172:175], v[232:235]
M v[232:235], a[112:115], a[168:171], v[232:235]
M v[228:231], a[104:107], a[168:171], v[228:231]
M v[228:231], a[108:111], a[172:175], v[228:231]
 s_waitcnt lgkmcnt(0)
M v[224:227], a[100:103], a[172:175], v[224:227]
M v[224:227], a[96:99], a[168:171], v[224:227]
M a[0:3], a[32:35], a[160:163], a[0:3]
 ds_read_b128 a[168:171], v5 offset:2048
 ds_read_b128 a[172:175], v6 offset:2048
M a[0:3], a[36:39], a[164:167], a[0:3]
 ds_read_b64_tr_b16 a[96:97], v1 offset:32768
 ds_read_b64_tr_b16 a[98:99], v1 offset:33792
M a[4:7], a[44:47], a[164:167], a[4:7]
 s_add_u32 m0, s24, 49152
M a[4:7], a[40:43], a[160:163], a[4:7]
 buffer_load_dwordx4 v12, s[48:51], s22 offen offset:0   lds
M a[8:11], a[48:51], a[160:163], a[8:11]
M a[8:11], a[52:55], a[164:167], a[8:11]
M a[12:15], a[60:63], a[164:167], a[12:15]
 ds_read_b64_tr_b16 a[100:101], v1 offset:40960
 ds_read_b64_tr_b16 a[102:103], v1 offset:41984
M a[12:15], a[56:59], a[160:163], a[12:15]
M a[16:19], a[64:67], a[160:163], a[16:19]
 buffer_load_dwordx4 v13, s[48:51], s22 offen offset:1024   lds
M a[16:19], a[68:71], a[164:167], a[16:19]
M a[20:23], a[76:79], a[164:167], a[20:23]
M a[20:23], a[72:75], a[160:163], a[20:23]
 ds_read_b64_tr_b16 a[104:105], v2 offset:32768
 ds_read_b64_tr_b16 a[106:107], v2 offset:33792
M a[24:27], a[80:83], a[160:163], a[24:27]
M a[24:27], a[84:87], a[164:167], a[24:27]
 s_waitcnt lgkmcnt(6)
M a[28:31], a[92:95], a[164:167], a[28:31]
 buffer_load_dwordx4 v14, s[48:51], s22 offen offset:2048   lds
M a[28:31], a[88:91], a[160:163], a[28:31]
M v[60:63], a[88:91], a[168:171], v[60:63]
 ds_read_b128 a[160:163], v5 offset:4096
 ds_read_b128 a[164:167], v6 offset:4096
M v[60:63], a[92:95], a[172:175], v[60:63]
 ds_read_b64_tr_b16 a[108:109], v2 offset:40960
 ds_read_b64_tr_b16 a[110:111], v2 offset:41984
M v[56:59], a[84:87], a[172:175], v[56:59]
 buffer_load_dwordx4 v15, s[48:51], s22 offen offset:3072   lds
M v[56:59], a[80:83], a[168:171], v[56:59]
 s_sub_u32 s22, s22, 2097024
M v[52:55], a[72:75], a[168:171], v[52:55]
M v[52:55], a[76:79], a[172:175], v[52:55]
 ds_read_b64_tr_b16 a[112:113], v3 offset:32768
 ds_read_b64_tr_b16 a[114:115], v3 offset:33792
M v[48:51], a[68:71], a[172:175], v[48:51]
 s_add_u32 m0, s23, 16384
M v[48:51], a[64:67], a[168:171], v[48:51]
 buffer_load_dwordx4 v8, s[16:19], s21 offen offset:0  nt lds
M v[44:47], a[56:59], a[168:171], v[44:47]
M v[44:47], a[60:63], a[172:175], v[44:47]
M v[40:43], a[52:55], a[172:175], v[40:43]
 ds_read_b64_tr_b16 a[116:117], v3 offset:40960
 ds_read_b64_tr_b16 a[118:119], v3 offset:41984
M v[40:43], a[48:51], a[168:171], v[40:43]
M v[36:39], a[40:43], a[168:171], v[36:39]
 buffer_load_dwordx4 v9, s[16:19], s21 offen offset:1024  nt lds
M v[36:39], a[44:47], a[172:175], v[36:39]
 s_waitcnt lgkmcnt(6)
M v[32:35], a[36:39], a[172:175], v[32:35]
M v[32:35], a[32:35], a[168:171], v[32:35]
 ds_read_b64_tr_b16 a[120:121], v4 offset:32768
 ds_read_b64_tr_b16 a[122:123], v4 offset:33792
M v[64:67], a[32:35], a[160:163], v[64:67]
 ds_read_b128 a[168:171], v5 offset:6144
 ds_read_b128 a[172:175], v6 offset:6144
M v[64:67], a[36:39], a[164:167], v[64:67]
 buffer_load_dwordx4 v10, s[16:19], s21 offen offset:2048  nt lds
M v[68:71], a[44:47], a[164:167], v[68:71]
M v[68:71], a[40:43], a[160:163], v[68:71]
M v[72:75], a[48:51], a[160:163], v[72:75]
 ds_read_b64_tr_b16 a[124:125], v4 offset:40960
 ds_read_b64_tr_b16 a[126:127], v4 offset:41984
M v[72:75], a[52:55], a[164:167], v[72:75]
M v[76:79], a[60:63], a[164:167], v[76:79]
 buffer_load_dwordx4 v11, s[16:19], s21 offen offset:3072  nt lds
M v[76:79], a[56:59], a[160:163], v[76:79]
 s_add_u32 s21, s21, 524160
M v[80:83], a[64:67], a[160:163], v[80:83]
M v[80:83], a[68:71], a[164:167], v[80:83]
M v[84:87], a[76:79], a[164:167], v[84:87]
M v[84:87], a[72:75], a[160:163], v[84:87]
M v[88:91], a[80:83], a[160:163], v[88:91]
M v[88:91], a[84:87], a[164:167], v[88:91]
 s_waitcnt lgkmcnt(2)
M v[92:95], a[92:95], a[164:167], v[92:95]
 s_waitcnt vmcnt(16) lgkmcnt(0)
M v[92:95], a[88:91], a[160:163], v[92:95]
 s_barrier
M v[124:127], a[88:91], a[168:171], v[124:127]
 ds_read_b128 a[160:163], v5 offset:16384
 ds_read_b128 a[164:167], v6 offset:16384
M v[124:127], a[92:95], a[172:175], v[124:127]
M v[120:123], a[84:87], a[172:175], v[120:123]
 s_add_u32 m0, s24, 0
 ds_read_b64_tr_b16 a[128:129], v1 offset:49152
 ds_read_b64_tr_b16 a[130:131], v1 offset:50176
M v[120:123], a[80:83], a[168:171], v[120:123]
 buffer_load_dwordx4 v12, s[48:51], s22 offen offset:0   lds
M v[116:119], a[72:75], a[168:171], v[116:119]
 v_mov_b32 v26, 163808
 ds_read_b128 v[28:31], v26
M v[116:119], a[76:79], a[172:175], v[116:119]
 s_getreg_b32 s92, hwreg(20, 2, 1)
M v[112:115], a[68:71], a[172:175], v[112:115]
 s_lshl_b32 s101, s41, 2
M v[112:115], a[64:67], a[168:171], v[112:115]
 s_and_b32 s100, s42, 7
M v[108:111], a[56:59], a[168:171], v[108:111]
 s_min_u32 s100, s100, 1
M v[108:111], a[60:63], a[172:175], v[108:111]
 s_lshl_b32 s100, s100, 29
 ds_read_b64_tr_b16 a[132:133], v1 offset:57344
 ds_read_b64_tr_b16 a[134:135], v1 offset:58368
M v[104:107], a[52:55], a[172:175], v[104:107]
 buffer_load_dwordx4 v13, s[48:51], s22 offen offset:1024   lds
M v[104:107], a[48:51], a[168:171], v[104:107]
 s_or_b32 s101, s101, s100
M v[100:103], a[40:43], a[168:171], v[100:103]
 s_lshl_b32 s100, s92, 30
 s_add_u32 s100, s100, 0x4000
 s_lshl_b32 s92, s92, 1
M v[100:103], a[44:47], a[172:175], v[100:103]
 s_waitcnt lgkmcnt(5)
 s_sub_u32 s92, 1, s92
 v_or_b32 v26, s20, v0
M v[96:99], a[36:39], a[172:175], v[96:99]
 v_min_u32 v26, 1, v26
 v_lshlrev_b32 v26, 29, v26
M v[96:99], a[32:35], a[168:171], v[96:99]
 s_waitcnt lgkmcnt(2)
 v_sub_u32 v28, v28, v29
 v_sub_u32 v30, v30, v31
M v[128:131], a[32:35], a[160:163], v[128:131]
 ds_read_b128 a[168:171], v5 offset:18432
 ds_read_b128 a[172:175], v6 offset:18432
M v[128:131], a[36:39], a[164:167], v[128:131]
 ds_read_b64_tr_b16 a[136:137], v2 offset:49152
 ds_read_b64_tr_b16 a[138:139], v2 offset:50176
M v[132:135], a[44:47], a[164:167], v[132:135]
 buffer_load_dwordx4 v14, s[48:51], s22 offen offset:2048   lds
M v[132:135], a[40:43], a[160:163], v[132:135]
 v_max_i32 v28, -400, v28
 v_max_i32 v30, -400, v30
M v[136:139], a[48:51], a[160:163], v[136:139]
 v_min_i32 v28, 400, v28
 v_min_i32 v30, 400, v30
M v[136:139], a[52:55], a[164:167], v[136:139]
 v_add_u32 v28, v28, v30
 v_mul_i32_i24 v28, s92, v28
M v[140:143], a[60:63], a[164:167], v[140:143]
 v_add_u32 v28, s100, v28
M v[140:143], a[56:59], a[160:163], v[140:143]
 ds_read_b64_tr_b16 a[140:141], v2 offset:57344
 ds_read_b64_tr_b16 a[142:143], v2 offset:58368
M v[144:147], a[64:67], a[160:163], v[144:147]
 buffer_load_dwordx4 v15, s[48:51], s22 offen offset:3072   lds
M v[144:147], a[68:71], a[164:167], v[144:147]
 s_add_u32 s22, s22, 2097152
M v[148:151], a[76:79], a[164:167], v[148:151]
 buffer_store_dword v28, v26, s[12:15], s101 offen sc1
M v[148:151], a[72:75], a[160:163], v[148:151]
M v[152:155], a[80:83], a[160:163], v[152:155]
M v[152:155], a[84:87], a[164:167], v[152:155]
 s_waitcnt lgkmcnt(4)
M v[156:159], a[92:95], a[164:167], v[156:159]
 s_add_u32 m0, s23, 32768
 ds_read_b64_tr_b16 a[144:145], v3 offset:49152
 ds_read_b64_tr_b16 a[146:147], v3 offset:50176
M v[156:159], a[88:91], a[160:163], v[156:159]
 buffer_load_dwordx4 v8, s[16:19], s21 offen offset:0  nt lds
M v[188:191], a[88:91], a[168:171], v[188:191]
 ds_read_b128 a[160:163], v5 offset:20480
 ds_read_b128 a[164:167], v6 offset:20480
M v[188:191], a[92:95], a[172:175], v[188:191]
M v[184:187], a[84:87], a[172:175], v[184:187]
M v[184:187], a[80:83], a[168:171], v[184:187]
M v[180:183], a[72:75], a[168:171], v[180:183]
M v[180:183], a[76:79], a[172:175], v[180:183]
 ds_read_b64_tr_b16 a[148:149], v3 offset:57344
 ds_read_b64_tr_b16 a[150:151], v3 offset:58368
M v[176:179], a[68:71], a[172:175], v[176:179]
 buffer_load_dwordx4 v9, s[16:19], s21 offen offset:1024  nt lds
M v[176:179], a[64:67], a[168:171], v[176:179]
M v[172:175], a[56:59], a[168:171], v[172:175]
M v[172:175], a[60:63], a[172:175], v[172:175]
M v[168:171], a[52:55], a[172:175], v[168:171]
M v[168:171], a[48:51], a[168:171], v[168:171]
M v[164:167], a[40:43], a[168:171], v[164:167]
 ds_read_b64_tr_b16 a[152:153], v4 offset:49152
 ds_read_b64_tr_b16 a[154:155], v4 offset:50176
M v[164:167], a[44:47], a[172:175], v[164:167]
 s_waitcnt lgkmcnt(4)
M v[160:163], a[36:39], a[172:175], v[160:163]
 buffer_load_dwordx4 v10, s[16:19], s21 offen offset:2048  nt lds
M v[160:163], a[32:35], a[168:171], v[160:163]
M v[192:195], a[32:35], a[160:163], v[192:195]
 ds_read_b128 a[168:171], v5 offset:22528
 ds_read_b128 a[172:175], v6 offset:22528
M v[192:195], a[36:39], a[164:167], v[192:195]
M v[196:199], a[44:47], a[164:167], v[196:199]
M v[196:199], a[40:43], a[160:163], v[196:199]
 ds_read_b64_tr_b16 a[156:157], v4 offset:57344
 ds_read_b64_tr_b16 a[158:159], v4 offset:58368
M v[200:203], a[48:51], a[160:163], v[200:203]
 buffer_load_dwordx4 v11, s[16:19], s21 offen offset:3072  nt lds
M v[200:203], a[52:55], a[164:167], v[200:203]
 s_add_u32 s21, s21, 128
M v[204:207], a[60:63], a[164:167], v[204:207]
M v[204:207], a[56:59], a[160:163], v[204:207]
M v[208:211], a[64:67], a[160:163], v[208:211]
M v[208:211], a[68:71], a[164:167], v[208:211]
M v[212:215], a[76:79], a[164:167], v[212:215]
M v[212:215], a[72:75], a[160:163], v[212:215]
M v[216:219], a[80:83], a[160:163], v[216:219]
M v[216:219], a[84:87], a[164:167], v[216:219]
 s_waitcnt lgkmcnt(2)
M v[220:223], a[92:95], a[164:167], v[220:223]
 s_waitcnt vmcnt(17) lgkmcnt(0)
M v[220:223], a[88:91], a[160:163], v[220:223]
 s_barrier
M v[252:255], a[88:91], a[168:171], v[252:255]
 ds_read_b128 a[160:163], v5 offset:32768
 ds_read_b128 a[164:167], v6 offset:32768
M v[252:255], a[92:95], a[172:175], v[252:255]
M v[248:251], a[84:87], a[172:175], v[248:251]
M v[248:251], a[80:83], a[168:171], v[248:251]
M v[244:247], a[72:75], a[168:171], v[244:247]
M v[244:247], a[76:79], a[172:175], v[244:247]
M v[240:243], a[68:71], a[172:175], v[240:243]
M v[240:243], a[64:67], a[168:171], v[240:243]
M v[236:239], a[56:59], a[168:171], v[236:239]
M v[236:239], a[60:63], a[172:175], v[236:239]
M v[232:235], a[52:55], a[172:175], v[232:235]
M v[232:235], a[48:51], a[168:171], v[232:235]
M v[228:231], a[40:43], a[168:171], v[228:231]
M v[228:231], a[44:47], a[172:175], v[228:231]
 s_waitcnt lgkmcnt(0)
M v[224:227], a[36:39], a[172:175], v[224:227]
M v[224:227], a[32:35], a[168:171], v[224:227]
M a[0:3], a[96:99], a[160:163], a[0:3]
 ds_read_b128 a[168:171], v5 offset:34816
 ds_read_b128 a[172:175], v6 offset:34816
M a[0:3], a[100:103], a[164:167], a[0:3]
 ds_read_b64_tr_b16 a[32:33], v1 offset:0
 ds_read_b64_tr_b16 a[34:35], v1 offset:1024
M a[4:7], a[108:111], a[164:167], a[4:7]
 s_add_u32 m0, s24, 16384
M a[4:7], a[104:107], a[160:163], a[4:7]
 buffer_load_dwordx4 v12, s[48:51], s22 offen offset:0   lds
M a[8:11], a[112:115], a[160:163], a[8:11]
M a[8:11], a[116:119], a[164:167], a[8:11]
M a[12:15], a[124:127], a[164:167], a[12:15]
 ds_read_b64_tr_b16 a[36:37], v1 offset:8192
 ds_read_b64_tr_b16 a[38:39], v1 offset:9216
M a[12:15], a[120:123], a[160:163], a[12:15]
M a[16:19], a[128:131], a[160:163], a[16:19]
 buffer_load_dwordx4 v13, s[48:51], s22 offen offset:1024   lds
M a[16:19], a[132:135], a[164:167], a[16:19]
M a[20:23], a[140:143], a[164:167], a[20:23]
M a[20:23], a[136:139], a[160:163], a[20:23]
 ds_read_b64_tr_b16 a[40:41], v2 offset:0
 ds_read_b64_tr_b16 a[42:43], v2 offset:1024
M a[24:27], a[144:147], a[160:163], a[24:27]
M a[24:27], a[148:151], a[164:167], a[24:27]
 s_waitcnt lgkmcnt(6)
M a[28:31], a[156:159], a[164:167], a[28:31]
 buffer_load_dwordx4 v14, s[48:51], s22 offen offset:2048   lds
M a[28:31], a[152:155], a[160:163], a[28:31]
M v[60:63], a[152:155], a[168:171], v[60:63]
 ds_read_b128 a[160:163], v5 offset:36864
 ds_read_b128 a[164:167], v6 offset:36864
M v[60:63], a[156:159], a[172:175], v[60:63]
 ds_read_b64_tr_b16 a[44:45], v2 offset:8192
 ds_read_b64_tr_b16 a[46:47], v2 offset:9216
M v[56:59], a[148:151], a[172:175], v[56:59]
 buffer_load_dwordx4 v15, s[48:51], s22 offen offset:3072   lds
M v[56:59], a[144:147], a[168:171], v[56:59]
 s_sub_u32 s22, s22, 2097024
M v[52:55], a[136:139], a[168:171], v[52:55]
M v[52:55], a[140:143], a[172:175], v[52:55]
 ds_read_b64_tr_b16 a[48:49], v3 offset:0
 ds_read_b64_tr_b16 a[50:51], v3 offset:1024
M v[48:51], a[132:135], a[172:175], v[48:51]
 s_add_u32 m0, s23, 49152
M v[48:51], a[128:131], a[168:171], v[48:51]
 buffer_load_dwordx4 v8, s[16:19], s21 offen offset:0  nt lds
M v[44:47], a[120:123], a[168:171], v[44:47]
M v[44:47], a[124:127], a[172:175], v[44:47]
M v[40:43], a[116:119], a[172:175], v[40:43]
 ds_read_b64_tr_b16 a[52:53], v3 offset:8192
 ds_read_b64_tr_b16 a[54:55], v3 offset:9216
M v[40:43], a[112:115], a[168:171], v[40:43]
M v[36:39], a[104:107], a[168:171], v[36:39]
 buffer_load_dwordx4 v9, s[16:19], s21 offen offset:1024  nt lds
M v[36:39], a[108:111], a[172:175], v[36:39]
 s_waitcnt lgkmcnt(6)
M v[32:35], a[100:103], a[172:175], v[32:35]
M v[32:35], a[96:99], a[168:171], v[32:35]
 ds_read_b64_tr_b16 a[56:57], v4 offset:0
 ds_read_b64_tr_b16 a[58:59], v4 offset:1024
M v[64:67], a[96:99], a[160:163], v[64:67]
 ds_read_b128 a[168:171], v5 offset:38912
 ds_read_b128 a[172:175], v6 offset:38912
M v[64:67], a[100:103], a[164:167], v[64:67]
 buffer_load_dwordx4 v10, s[16:19], s21 offen offset:2048  nt lds
M v[68:71], a[108:111], a[164:167], v[68:71]
M v[68:71], a[104:107], a[160:163], v[68:71]
M v[72:75], a[112:115], a[160:163], v[72:75]
 ds_read_b64_tr_b16 a[60:61], v4 offset:8192
 ds_read_b64_tr_b16 a[62:63], v4 offset:9216
M v[72:75], a[116:119], a[164:167], v[72:75]
M v[76:79], a[124:127], a[164:167], v[76:79]
 buffer_load_dwordx4 v11, s[16:19], s21 offen offset:3072  nt lds
M v[76:79], a[120:123], a[160:163], v[76:79]
 s_add_u32 s21, s21, 524160
M v[80:83], a[128:131], a[160:163], v[80:83]
M v[80:83], a[132:135], a[164:167], v[80:83]
M v[84:87], a[140:143], a[164:167], v[84:87]
M v[84:87], a[136:139], a[160:163], v[84:87]
M v[88:91], a[144:147], a[160:163], v[88:91]
M v[88:91], a[148:151], a[164:167], v[88:91]
 s_waitcnt lgkmcnt(2)
M v[92:95], a[156:159], a[164:167], v[92:95]
 s_waitcnt vmcnt(17) lgkmcnt(0)
M v[92:95], a[152:155], a[160:163], v[92:95]
 s_barrier
M v[124:127], a[152:155], a[168:171], v[124:127]
 ds_read_b128 a[160:163], v5 offset:49152
 ds_read_b128 a[164:167], v6 offset:49152
M v[124:127], a[156:159], a[172:175], v[124:127]
M v[120:123], a[148:151], a[172:175], v[120:123]
 s_add_u32 m0, s24, 32768
 ds_read_b64_tr_b16 a[64:65], v1 offset:16384
 ds_read_b64_tr_b16 a[66:67], v1 offset:17408
M v[120:123], a[144:147], a[168:171], v[120:123]
 buffer_load_dwordx4 v12, s[48:51], s22 offen offset:0   lds
M v[116:119], a[136:139], a[168:171], v[116:119]
M v[116:119], a[140:143], a[172:175], v[116:119]
M v[112:115], a[132:135], a[172:175], v[112:115]
M v[112:115], a[128:131], a[168:171], v[112:115]
M v[108:111], a[120:123], a[168:171], v[108:111]
M v[108:111], a[124:127], a[172:175], v[108:111]
 ds_read_b64_tr_b16 a[68:69], v1 offset:24576
 ds_read_b64_tr_b16 a[70:71], v1 offset:25600
M v[104:107], a[116:119], a[172:175], v[104:107]
 buffer_load_dwordx4 v13, s[48:51], s22 offen offset:1024   lds
M v[104:107], a[112:115], a[168:171], v[104:107]
M v[100:103], a[104:107], a[168:171], v[100:103]
M v[100:103], a[108:111], a[172:175], v[100:103]
 s_waitcnt lgkmcnt(4)
M v[96:99], a[100:103], a[172:175], v[96:99]
M v[96:99], a[96:99], a[168:171], v[96:99]
M v[128:131], a[96:99], a[160:163], v[128:131]
 ds_read_b128 a[168:171], v5 offset:51200
 ds_read_b128 a[172:175], v6 offset:51200
M v[128:131], a[100:103], a[164:167], v[128:131]
 ds_read_b64_tr_b16 a[72:73], v2 offset:16384
 ds_read_b64_tr_b16 a[74:75], v2 offset:17408
M v[132:135], a[108:111], a[164:167], v[132:135]
 buffer_load_dwordx4 v14, s[48:51], s22 offen offset:2048   lds
M v[132:135], a[104:107], a[160:163], v[132:135]
M v[136:139], a[112:115], a[160:163], v[136:139]
M v[136:139], a[116:119], a[164:167], v[136:139]
M v[140:143], a[124:127], a[164:167], v[140:143]
M v[140:143], a[120:123], a[160:163], v[140:143]
 ds_read_b64_tr_b16 a[76:77], v2 offset:24576
 ds_read_b64_tr_b16 a[78:79], v2 offset:25600
M v[144:147], a[128:131], a[160:163], v[144:147]
 buffer_load_dwordx4 v15, s[48:51], s22 offen offset:3072   lds
M v[144:147], a[132:135], a[164:167], v[144:147]
 s_add_u32 s22, s22, 2097152
M v[148:151], a[140:143], a[164:167], v[148:151]
M v[148:151], a[136:139], a[160:163], v[148:151]
M v[152:155], a[144:147], a[160:163], v[152:155]
M v[152:155], a[148:151], a[164:167], v[152:155]
 s_waitcnt lgkmcnt(4)
M v[156:159], a[156:159], a[164:167], v[156:159]
 s_add_u32 m0, s23, 0
 ds_read_b64_tr_b16 a[80:81], v3 offset:16384
 ds_read_b64_tr_b16 a[82:83], v3 offset:17408
M v[156:159], a[152:155], a[160:163], v[156:159]
 buffer_load_dwordx4 v8, s[16:19], s21 offen offset:0  nt lds
M v[188:191], a[152:155], a[168:171], v[188:191]
 ds_read_b128 a[160:163], v5 offset:53248
 ds_read_b128 a[164:167], v6 offset:53248
M v[188:191], a[156:159], a[172:175], v[188:191]
M v[184:187], a[148:151], a[172:175], v[184:187]
M v[184:187], a[144:147], a[168:171], v[184:187]
M v[180:183], a[136:139], a[168:171], v[180:183]
M v[180:183], a[140:143], a[172:175], v[180:183]
 ds_read_b64_tr_b16 a[84:85], v3 offset:24576
 ds_read_b64_tr_b16 a[86:87], v3 offset:25600
M v[176:179], a[132:135], a[172:175], v[176:179]
 buffer_load_dwordx4 v9, s[16:19], s21 offen offset:1024  nt lds
M v[176:179], a[128:131], a[168:171], v[176:179]
M v[172:175], a[120:123], a[168:171], v[172:175]
M v[172:175], a[124:127], a[172:175], v[172:175]
M v[168:171], a[116:119], a[172:175], v[168:171]
 v_min_u32 v16, 56, v0
 v_lshlrev_b32 v16, 2, v16
M v[168:171], a[112:115], a[168:171], v[168:171]
 buffer_load_dword v17, v16, s[12:15], 0 offen offset:0 sc1
M v[164:167], a[104:107], a[168:171], v[164:167]
 ds_read_b64_tr_b16 a[88:89], v4 offset:16384
 ds_read_b64_tr_b16 a[90:91], v4 offset:17408
M v[164:167], a[108:111], a[172:175], v[164:167]
 s_waitcnt lgkmcnt(4)
M v[160:163], a[100:103], a[172:175], v[160:163]
 buffer_load_dwordx4 v10, s[16:19], s21 offen offset:2048  nt lds
M v[160:163], a[96:99], a[168:171], v[160:163]
M v[192:195], a[96:99], a[160:163], v[192:195]
 ds_read_b128 a[168:171], v5 offset:55296
 ds_read_b128 a[172:175], v6 offset:55296
M v[192:195], a[100:103], a[164:167], v[192:195]
M v[196:199], a[108:111], a[164:167], v[196:199]
M v[196:199], a[104:107], a[160:163], v[196:199]
 ds_read_b64_tr_b16 a[92:93], v4 offset:24576
 ds_read_b64_tr_b16 a[94:95], v4 offset:25600
M v[200:203], a[112:115], a[160:163], v[200:203]
 buffer_load_dwordx4 v11, s[16:19], s21 offen offset:3072  nt lds
M v[200:203], a[116:119], a[164:167], v[200:203]
 s_add_u32 s21, s21, 128
M v[204:207], a[124:127], a[164:167], v[204:207]
M v[204:207], a[120:123], a[160:163], v[204:207]
M v[208:211], a[128:131], a[160:163], v[208:211]
M v[208:211], a[132:135], a[164:167], v[208:211]
M v[212:215], a[140:143], a[164:167], v[212:215]
M v[212:215], a[136:139], a[160:163], v[212:215]
M v[216:219], a[144:147], a[160:163], v[216:219]
M v[216:219], a[148:151], a[164:167], v[216:219]
 s_waitcnt lgkmcnt(2)
M v[220:223], a[156:159], a[164:167], v[220:223]
 s_waitcnt vmcnt(17) lgkmcnt(0)
M v[220:223], a[152:155], a[160:163], v[220:223]
 s_barrier
M v[252:255], a[152:155], a[168:171], v[252:255]
 ds_read_b128 a[160:163], v5 offset:0
 ds_read_b128 a[164:167], v6 offset:0
M v[252:255], a[156:159], a[172:175], v[252:255]
M v[248:251], a[148:151], a[172:175], v[248:251]
M v[248:251], a[144:147], a[168:171], v[248:251]
M v[244:247], a[136:139], a[168:171], v[244:247]
M v[244:247], a[140:143], a[172:175], v[244:247]
M v[240:243], a[132:135], a[172:175], v[240:243]
M v[240:243], a[128:131], a[168:171], v[240:243]
M v[236:239], a[120:123], a[168:171], v[236:239]
M v[236:239], a[124:127], a[172:175], v[236:239]
M v[232:235], a[116:119], a[172:175], v[232:235]
M v[232:235], a[112:115], a[168:171], v[232:235]
M v[228:231], a[104:107], a[168:171], v[228:231]
M v[228:231], a[108:111], a[172:175], v[228:231]
 s_waitcnt lgkmcnt(0)
M v[224:227], a[100:103], a[172:175], v[224:227]
M v[224:227], a[96:99], a[168:171], v[224:227]
M a[0:3], a[32:35], a[160:163], a[0:3]
 ds_read_b128 a[168:171], v5 offset:2048
 ds_read_b128 a[172:175], v6 offset:2048
M a[0:3], a[36:39], a[164:167], a[0:3]
 ds_read_b64_tr_b16 a[96:97], v1 offset:32768
 ds_read_b64_tr_b16 a[98:99], v1 offset:33792
M a[4:7], a[44:47], a[164:167], a[4:7]
 s_add_u32 m0, s24, 49152
M a[4:7], a[40:43], a[160:163], a[4:7]
 buffer_load_dwordx4 v12, s[48:51], s22 offen offset:0   lds
M a[8:11], a[48:51], a[160:163], a[8:11]
M a[8:11], a[52:55], a[164:167], a[8:11]
M a[12:15], a[60:63], a[164:167], a[12:15]
 ds_read_b64_tr_b16 a[100:101], v1 offset:40960
 ds_read_b64_tr_b16 a[102:103], v1 offset:41984
M a[12:15], a[56:59], a[160:163], a[12:15]
M a[16:19], a[64:67], a[160:163], a[16:19]
 buffer_load_dwordx4 v13, s[48:51], s22 offen offset:1024   lds
M a[16:19], a[68:71], a[164:167], a[16:19]
M a[20:23], a[76:79], a[164:167], a[20:23]
M a[20:23], a[72:75], a[160:163], a[20:23]
 ds_read_b64_tr_b16 a[104:105], v2 offset:32768
 ds_read_b64_tr_b16 a[106:107], v2 offset:33792
M a[24:27], a[80:83], a[160:163], a[24:27]
M a[24:27], a[84:87], a[164:167], a[24:27]
 s_waitcnt lgkmcnt(6)
M a[28:31], a[92:95], a[164:167], a[28:31]
 buffer_load_dwordx4 v14, s[48:51], s22 offen offset:2048   lds
M a[28:31], a[88:91], a[160:163], a[28:31]
M v[60:63], a[88:91], a[168:171], v[60:63]
 ds_read_b128 a[160:163], v5 offset:4096
 ds_read_b128 a[164:167], v6 offset:4096
M v[60:63], a[92:95], a[172:175], v[60:63]
 ds_read_b64_tr_b16 a[108:109], v2 offset:40960
 ds_read_b64_tr_b16 a[110:111], v2 offset:41984
M v[56:59], a[84:87], a[172:175], v[56:59]
 buffer_load_dwordx4 v15, s[48:51], s22 offen offset:3072   lds
M v[56:59], a[80:83], a[168:171], v[56:59]
 s_sub_u32 s22, s22, 2097024
M v[52:55], a[72:75], a[168:171], v[52:55]
M v[52:55], a[76:79], a[172:175], v[52:55]
 ds_read_b64_tr_b16 a[112:113], v3 offset:32768
 ds_read_b64_tr_b16 a[114:115], v3 offset:33792
M v[48:51], a[68:71], a[172:175], v[48:51]
 s_add_u32 m0, s23, 16384
M v[48:51], a[64:67], a[168:171], v[48:51]
 buffer_load_dwordx4 v8, s[16:19], s21 offen offset:0  nt lds
M v[44:47], a[56:59], a[168:171], v[44:47]
M v[44:47], a[60:63], a[172:175], v[44:47]
M v[40:43], a[52:55], a[172:175], v[40:43]
 ds_read_b64_tr_b16 a[116:117], v3 offset:40960
 ds_read_b64_tr_b16 a[118:119], v3 offset:41984
M v[40:43], a[48:51], a[168:171], v[40:43]
M v[36:39], a[40:43], a[168:171], v[36:39]
 buffer_load_dwordx4 v9, s[16:19], s21 offen offset:1024  nt lds
M v[36:39], a[44:47], a[172:175], v[36:39]
 s_waitcnt lgkmcnt(6)
M v[32:35], a[36:39], a[172:175], v[32:35]
M v[32:35], a[32:35], a[168:171], v[32:35]
 ds_read_b64_tr_b16 a[120:121], v4 offset:32768
 ds_read_b64_tr_b16 a[122:123], v4 offset:33792
M v[64:67], a[32:35], a[160:163], v[64:67]
 ds_read_b128 a[168:171], v5 offset:6144
 ds_read_b128 a[172:175], v6 offset:6144
M v[64:67], a[36:39], a[164:167], v[64:67]
 buffer_load_dwordx4 v10, s[16:19], s21 offen offset:2048  nt lds
M v[68:71], a[44:47], a[164:167], v[68:71]
M v[68:71], a[40:43], a[160:163], v[68:71]
M v[72:75], a[48:51], a[160:163], v[72:75]
 ds_read_b64_tr_b16 a[124:125], v4 offset:40960
 ds_read_b64_tr_b16 a[126:127], v4 offset:41984
M v[72:75], a[52:55], a[164:167], v[72:75]
M v[76:79], a[60:63], a[164:167], v[76:79]
 buffer_load_dwordx4 v11, s[16:19], s21 offen offset:3072  nt lds
M v[76:79], a[56:59], a[160:163], v[76:79]
 s_add_u32 s21, s21, 524160
M v[80:83], a[64:67], a[160:163], v[80:83]
M v[80:83], a[68:71], a[164:167], v[80:83]
M v[84:87], a[76:79], a[164:167], v[84:87]
M v[84:87], a[72:75], a[160:163], v[84:87]
M v[88:91], a[80:83], a[160:163], v[88:91]
M v[88:91], a[84:87], a[164:167], v[88:91]
 s_waitcnt lgkmcnt(2)
M v[92:95], a[92:95], a[164:167], v[92:95]
 s_waitcnt vmcnt(17) lgkmcnt(0)
M v[92:95], a[88:91], a[160:163], v[92:95]
 s_barrier
M v[124:127], a[88:91], a[168:171], v[124:127]
 ds_read_b128 a[160:163], v5 offset:16384
 ds_read_b128 a[164:167], v6 offset:16384
M v[124:127], a[92:95], a[172:175], v[124:127]
M v[120:123], a[84:87], a[172:175], v[120:123]
 s_add_u32 m0, s24, 0
 ds_read_b64_tr_b16 a[128:129], v1 offset:49152
 ds_read_b64_tr_b16 a[130:131], v1 offset:50176
M v[120:123], a[80:83], a[168:171], v[120:123]
 buffer_load_dwordx4 v12, s[48:51], s22 offen offset:0   lds
M v[116:119], a[72:75], a[168:171], v[116:119]
M v[116:119], a[76:79], a[172:175], v[116:119]
M v[112:115], a[68:71], a[172:175], v[112:115]
M v[112:115], a[64:67], a[168:171], v[112:115]
M v[108:111], a[56:59], a[168:171], v[108:111]
M v[108:111], a[60:63], a[172:175], v[108:111]
 ds_read_b64_tr_b16 a[132:133], v1 offset:57344
 ds_read_b64_tr_b16 a[134:135], v1 offset:58368
M v[104:107], a[52:55], a[172:175], v[104:107]
 buffer_load_dwordx4 v13, s[48:51], s22 offen offset:1024   lds
M v[104:107], a[48:51], a[168:171], v[104:107]
M v[100:103], a[40:43], a[168:171], v[100:103]
M v[100:103], a[44:47], a[172:175], v[100:103]
 s_waitcnt lgkmcnt(4)
M v[96:99], a[36:39], a[172:175], v[96:99]
M v[96:99], a[32:35], a[168:171], v[96:99]
M v[128:131], a[32:35], a[160:163], v[128:131]
 ds_read_b128 a[168:171], v5 offset:18432
 ds_read_b128 a[172:175], v6 offset:18432
M v[128:131], a[36:39], a[164:167], v[128:131]
 ds_read_b64_tr_b16 a[136:137], v2 offset:49152
 ds_read_b64_tr_b16 a[138:139], v2 offset:50176
M v[132:135], a[44:47], a[164:167], v[132:135]
 buffer_load_dwordx4 v14, s[48:51], s22 offen offset:2048   lds
M v[132:135], a[40:43], a[160:163], v[132:135]
M v[136:139], a[48:51], a[160:163], v[136:139]
M v[136:139], a[52:55], a[164:167], v[136:139]
M v[140:143], a[60:63], a[164:167], v[140:143]
M v[140:143], a[56:59], a[160:163], v[140:143]
 ds_read_b64_tr_b16 a[140:141], v2 offset:57344
 ds_read_b64_tr_b16 a[142:143], v2 offset:58368
M v[144:147], a[64:67], a[160:163], v[144:147]
 buffer_load_dwordx4 v15, s[48:51], s22 offen offset:3072   lds
M v[144:147], a[68:71], a[164:167], v[144:147]
 s_add_u32 s22, s22, 2097152
M v[148:151], a[76:79], a[164:167], v[148:151]
M v[148:151], a[72:75], a[160:163], v[148:151]
M v[152:155], a[80:83], a[160:163], v[152:155]
M v[152:155], a[84:87], a[164:167], v[152:155]
 s_waitcnt lgkmcnt(4)
M v[156:159], a[92:95], a[164:167], v[156:159]
 s_add_u32 m0, s23, 32768
 ds_read_b64_tr_b16 a[144:145], v3 offset:49152
 ds_read_b64_tr_b16 a[146:147], v3 offset:50176
M v[156:159], a[88:91], a[160:163], v[156:159]
 buffer_load_dwordx4 v8, s[16:19], s21 offen offset:0  nt lds
M v[188:191], a[88:91], a[168:171], v[188:191]
 ds_read_b128 a[160:163], v5 offset:20480
 ds_read_b128 a[164:167], v6 offset:20480
M v[188:191], a[92:95], a[172:175], v[188:191]
M v[184:187], a[84:87], a[172:175], v[184:187]
M v[184:187], a[80:83], a[168:171], v[184:187]
M v[180:183], a[72:75], a[168:171], v[180:183]
M v[180:183], a[76:79], a[172:175], v[180:183]
 ds_read_b64_tr_b16 a[148:149], v3 offset:57344
 ds_read_b64_tr_b16 a[150:151], v3 offset:58368
M v[176:179], a[68:71], a[172:175], v[176:179]
 buffer_load_dwordx4 v9, s[16:19], s21 offen offset:1024  nt lds
M v[176:179], a[64:67], a[168:171], v[176:179]
M v[172:175], a[56:59], a[168:171], v[172:175]
M v[172:175], a[60:63], a[172:175], v[172:175]
M v[168:171], a[52:55], a[172:175], v[168:171]
M v[168:171], a[48:51], a[168:171], v[168:171]
M v[164:167], a[40:43], a[168:171], v[164:167]
 ds_read_b64_tr_b16 a[152:153], v4 offset:49152
 ds_read_b64_tr_b16 a[154:155], v4 offset:50176
M v[164:167], a[44:47], a[172:175], v[164:167]
 s_waitcnt lgkmcnt(4)
M v[160:163], a[36:39], a[172:175], v[160:163]
 buffer_load_dwordx4 v10, s[16:19], s21 offen offset:2048  nt lds
M v[160:163], a[32:35], a[168:171], v[160:163]
M v[192:195], a[32:35], a[160:163], v[192:195]
 ds_read_b128 a[168:171], v5 offset:22528
 ds_read_b128 a[172:175], v6 offset:22528
M v[192:195], a[36:39], a[164:167], v[192:195]
M v[196:199], a[44:47], a[164:167], v[196:199]
M v[196:199], a[40:43], a[160:163], v[196:199]
 ds_read_b64_tr_b16 a[156:157], v4 offset:57344
 ds_read_b64_tr_b16 a[158:159], v4 offset:58368
M v[200:203], a[48:51], a[160:163], v[200:203]
 buffer_load_dwordx4 v11, s[16:19], s21 offen offset:3072  nt lds
M v[200:203], a[52:55], a[164:167], v[200:203]
 s_add_u32 s21, s21, 128
M v[204:207], a[60:63], a[164:167], v[204:207]
M v[204:207], a[56:59], a[160:163], v[204:207]
M v[208:211], a[64:67], a[160:163], v[208:211]
M v[208:211], a[68:71], a[164:167], v[208:211]
M v[212:215], a[76:79], a[164:167], v[212:215]
M v[212:215], a[72:75], a[160:163], v[212:215]
M v[216:219], a[80:83], a[160:163], v[216:219]
M v[216:219], a[84:87], a[164:167], v[216:219]
 s_waitcnt lgkmcnt(2)
M v[220:223], a[92:95], a[164:167], v[220:223]
 s_waitcnt vmcnt(16) lgkmcnt(0)
M v[220:223], a[88:91], a[160:163], v[220:223]
 s_barrier
M v[252:255], a[88:91], a[168:171], v[252:255]
 ds_read_b128 a[160:163], v5 offset:32768
 ds_read_b128 a[164:167], v6 offset:32768
M v[252:255], a[92:95], a[172:175], v[252:255]
 v_cmp_eq_u32 vcc, 0, v17
M v[248:251], a[84:87], a[172:175], v[248:251]
 s_nop 0
M v[248:251], a[80:83], a[168:171], v[248:251]
 s_cbranch_vccnz L_zs1
L_zr1:
M v[244:247], a[72:75], a[168:171], v[244:247]
 buffer_load_dword a240, v24, s[32:35], 0 offen offset:1024
M v[244:247], a[76:79], a[172:175], v[244:247]
M v[240:243], a[68:71], a[172:175], v[240:243]
M v[240:243], a[64:67], a[168:171], v[240:243]
M v[236:239], a[56:59], a[168:171], v[236:239]
M v[236:239], a[60:63], a[172:175], v[236:239]
M v[232:235], a[52:55], a[172:175], v[232:235]
M v[232:235], a[48:51], a[168:171], v[232:235]
M v[228:231], a[40:43], a[168:171], v[228:231]
M v[228:231], a[44:47], a[172:175], v[228:231]
 s_waitcnt lgkmcnt(0)
M v[224:227], a[36:39], a[172:175], v[224:227]
M v[224:227], a[32:35], a[168:171], v[224:227]
M a[0:3], a[96:99], a[160:163], a[0:3]
 ds_read_b128 a[168:171], v5 offset:34816
 ds_read_b128 a[172:175], v6 offset:34816
M a[0:3], a[100:103], a[164:167], a[0:3]
 ds_read_b64_tr_b16 a[32:33], v1 offset:0
 ds_read_b64_tr_b16 a[34:35], v1 offset:1024
M a[4:7], a[108:111], a[164:167], a[4:7]
 s_add_u32 m0, s24, 16384
 v_cmp_le_u32 vcc, 0x40000000, v17
 v_and_b32 v17, 0xffff, v17
M a[4:7], a[104:107], a[160:163], a[4:7]
 buffer_load_dwordx4 v12, s[48:51], s22 offen offset:0   lds
M a[8:11], a[112:115], a[160:163], a[8:11]
 s_nop 0
M a[8:11], a[116:119], a[164:167], a[8:11]
 s_and_b32 s101, vcc_lo, 0xff
 v_add_u32 v17, v17, v17 row_ror:8 row_mask:0xf bank_mask:0xf
 s_nop 1
 v_add_u32 v17, v17, v17 row_ror:4 row_mask:0xf bank_mask:0xf
M a[12:15], a[124:127], a[164:167], a[12:15]
 ds_read_b64_tr_b16 a[36:37], v1 offset:8192
 ds_read_b64_tr_b16 a[38:39], v1 offset:9216
M a[12:15], a[120:123], a[160:163], a[12:15]
 v_add_u32 v17, v17, v17 row_ror:2 row_mask:0xf bank_mask:0xf
 s_nop 1
 v_add_u32 v17, v17, v17 row_ror:1 row_mask:0xf bank_mask:0xf
M a[16:19], a[128:131], a[160:163], a[16:19]
 buffer_load_dwordx4 v13, s[48:51], s22 offen offset:1024   lds
M a[16:19], a[132:135], a[164:167], a[16:19]
 v_cmp_lt_u32 vcc, 262144, v17
M a[20:23], a[140:143], a[164:167], a[20:23]
 s_nop 0
M a[20:23], a[136:139], a[160:163], a[20:23]
 s_nop 0
 ds_read_b64_tr_b16 a[40:41], v2 offset:0
 ds_read_b64_tr_b16 a[42:43], v2 offset:1024
M a[24:27], a[144:147], a[160:163], a[24:27]
 s_and_b32 s92, vcc_lo, 1
 s_mul_i32 s92, s92, 0xff
 s_xor_b32 s101, s101, s92
M a[24:27], a[148:151], a[164:167], a[24:27]
 s_waitcnt lgkmcnt(6)
M a[28:31], a[156:159], a[164:167], a[28:31]
 buffer_load_dwordx4 v14, s[48:51], s22 offen offset:2048   lds
M a[28:31], a[152:155], a[160:163], a[28:31]
M v[60:63], a[152:155], a[168:171], v[60:63]
 ds_read_b128 a[160:163], v5 offset:36864
 ds_read_b128 a[164:167], v6 offset:36864
M v[60:63], a[156:159], a[172:175], v[60:63]
 ds_read_b64_tr_b16 a[44:45], v2 offset:8192
 ds_read_b64_tr_b16 a[46:47], v2 offset:9216
M v[56:59], a[148:151], a[172:175], v[56:59]
 buffer_load_dwordx4 v15, s[48:51], s22 offen offset:3072   lds
M v[56:59], a[144:147], a[168:171], v[56:59]
 s_sub_u32 s22, s22, 2097024
M v[52:55], a[136:139], a[168:171], v[52:55]
M v[52:55], a[140:143], a[172:175], v[52:55]
 ds_read_b64_tr_b16 a[48:49], v3 offset:0
 ds_read_b64_tr_b16 a[50:51], v3 offset:1024
M v[48:51], a[132:135], a[172:175], v[48:51]
 s_add_u32 m0, s23, 49152
M v[48:51], a[128:131], a[168:171], v[48:51]
 buffer_load_dwordx4 v8, s[16:19], s21 offen offset:0  nt lds
M v[44:47], a[120:123], a[168:171], v[44:47]
M v[44:47], a[124:127], a[172:175], v[44:47]
M v[40:43], a[116:119], a[172:175], v[40:43]
 ds_read_b64_tr_b16 a[52:53], v3 offset:8192
 ds_read_b64_tr_b16 a[54:55], v3 offset:9216
M v[40:43], a[112:115], a[168:171], v[40:43]
M v[36:39], a[104:107], a[168:171], v[36:39]
 buffer_load_dwordx4 v9, s[16:19], s21 offen offset:1024  nt lds
M v[36:39], a[108:111], a[172:175], v[36:39]
 s_waitcnt lgkmcnt(6)
M v[32:35], a[100:103], a[172:175], v[32:35]
M v[32:35], a[96:99], a[168:171], v[32:35]
 ds_read_b64_tr_b16 a[56:57], v4 offset:0
 ds_read_b64_tr_b16 a[58:59], v4 offset:1024
M v[64:67], a[96:99], a[160:163], v[64:67]
 ds_read_b128 a[168:171], v5 offset:38912
 ds_read_b128 a[172:175], v6 offset:38912
M v[64:67], a[100:103], a[164:167], v[64:67]
 buffer_load_dwordx4 v10, s[16:19], s21 offen offset:2048  nt lds
M v[68:71], a[108:111], a[164:167], v[68:71]
M v[68:71], a[104:107], a[160:163], v[68:71]
M v[72:75], a[112:115], a[160:163], v[72:75]
 ds_read_b64_tr_b16 a[60:61], v4 offset:8192
 ds_read_b64_tr_b16 a[62:63], v4 offset:9216
M v[72:75], a[116:119], a[164:167], v[72:75]
M v[76:79], a[124:127], a[164:167], v[76:79]
 buffer_load_dwordx4 v11, s[16:19], s21 offen offset:3072  nt lds
M v[76:79], a[120:123], a[160:163], v[76:79]
 s_add_u32 s21, s21, 524160
M v[80:83], a[128:131], a[160:163], v[80:83]
M v[80:83], a[132:135], a[164:167], v[80:83]
M v[84:87], a[140:143], a[164:167], v[84:87]
M v[84:87], a[136:139], a[160:163], v[84:87]
 s_and_b32 s64, s42, 7
M v[88:91], a[144:147], a[160:163], v[88:91]
 s_lshl_b32 s72, s41, 3
 s_add_u32 s64, s64, s72
 s_lshl_b32 s64, s64, 2
M v[88:91], a[148:151], a[164:167], v[88:91]
 s_waitcnt lgkmcnt(2)
 s_add_u32 s64, s64, s20
 s_mul_i32 s67, s64, 7168
M v[92:95], a[156:159], a[164:167], v[92:95]
 s_waitcnt vmcnt(17) lgkmcnt(0)
 s_mul_i32 s86, s20, 7168
 s_add_u32 s86, s86, 131072
M v[92:95], a[152:155], a[160:163], v[92:95]
 s_barrier
M v[124:127], a[152:155], a[168:171], v[124:127]
 ds_read_b128 a[160:163], v5 offset:49152
 ds_read_b128 a[164:167], v6 offset:49152
M v[124:127], a[156:159], a[172:175], v[124:127]
M v[120:123], a[148:151], a[172:175], v[120:123]
 s_add_u32 m0, s24, 32768
 ds_read_b64_tr_b16 a[64:65], v1 offset:16384
 ds_read_b64_tr_b16 a[66:67], v1 offset:17408
M v[120:123], a[144:147], a[168:171], v[120:123]
 buffer_load_dwordx4 v12, s[48:51], s22 offen offset:0   lds
M v[116:119], a[136:139], a[168:171], v[116:119]
M v[116:119], a[140:143], a[172:175], v[116:119]
M v[112:115], a[132:135], a[172:175], v[112:115]
M v[112:115], a[128:131], a[168:171], v[112:115]
 buffer_load_dwordx4 v13, s[48:51], s22 offen offset:1024   lds
M v[108:111], a[120:123], a[168:171], v[108:111]
M v[108:111], a[124:127], a[172:175], v[108:111]
 ds_read_b64_tr_b16 a[68:69], v1 offset:24576
 ds_read_b64_tr_b16 a[70:71], v1 offset:25600
M v[104:107], a[116:119], a[172:175], v[104:107]
M v[104:107], a[112:115], a[168:171], v[104:107]
M v[100:103], a[104:107], a[168:171], v[100:103]
 buffer_load_dwordx4 v14, s[48:51], s22 offen offset:2048   lds
M v[100:103], a[108:111], a[172:175], v[100:103]
 s_waitcnt lgkmcnt(4)
M v[96:99], a[100:103], a[172:175], v[96:99]
M v[96:99], a[96:99], a[168:171], v[96:99]
M v[128:131], a[96:99], a[160:163], v[128:131]
 ds_read_b128 a[168:171], v5 offset:51200
 ds_read_b128 a[172:175], v6 offset:51200
M v[128:131], a[100:103], a[164:167], v[128:131]
 ds_read_b64_tr_b16 a[72:73], v2 offset:16384
 ds_read_b64_tr_b16 a[74:75], v2 offset:17408
M v[132:135], a[108:111], a[164:167], v[132:135]
 buffer_load_dwordx4 v15, s[48:51], s22 offen offset:3072   lds
M v[132:135], a[104:107], a[160:163], v[132:135]
 s_add_u32 s22, s22, 2097152
M v[136:139], a[112:115], a[160:163], v[136:139]
M v[136:139], a[116:119], a[164:167], v[136:139]
 s_add_u32 m0, s23, 0
M v[140:143], a[124:127], a[164:167], v[140:143]
 buffer_load_dwordx4 v8, s[16:19], s21 offen offset:0  nt lds
M v[140:143], a[120:123], a[160:163], v[140:143]
 ds_read_b64_tr_b16 a[76:77], v2 offset:24576
 ds_read_b64_tr_b16 a[78:79], v2 offset:25600
M v[144:147], a[128:131], a[160:163], v[144:147]
M v[144:147], a[132:135], a[164:167], v[144:147]
M v[148:151], a[140:143], a[164:167], v[148:151]
 buffer_load_dwordx4 v9, s[16:19], s21 offen offset:1024  nt lds
M v[148:151], a[136:139], a[160:163], v[148:151]
M v[152:155], a[144:147], a[160:163], v[152:155]
M v[152:155], a[148:151], a[164:167], v[152:155]
 s_waitcnt lgkmcnt(4)
M v[156:159], a[156:159], a[164:167], v[156:159]
 ds_read_b64_tr_b16 a[80:81], v3 offset:16384
 ds_read_b64_tr_b16 a[82:83], v3 offset:17408
M v[156:159], a[152:155], a[160:163], v[156:159]
 buffer_load_dwordx4 v10, s[16:19], s21 offen offset:2048  nt lds
M v[188:191], a[152:155], a[168:171], v[188:191]
 ds_read_b128 a[160:163], v5 offset:53248
 ds_read_b128 a[164:167], v6 offset:53248
M v[188:191], a[156:159], a[172:175], v[188:191]
M v[184:187], a[148:151], a[172:175], v[184:187]
M v[184:187], a[144:147], a[168:171], v[184:187]
M v[180:183], a[136:139], a[168:171], v[180:183]
 buffer_load_dwordx4 v11, s[16:19], s21 offen offset:3072  nt lds
M v[180:183], a[140:143], a[172:175], v[180:183]
 s_add_u32 s21, s21, 128
 ds_read_b64_tr_b16 a[84:85], v3 offset:24576
 ds_read_b64_tr_b16 a[86:87], v3 offset:25600
M v[176:179], a[132:135], a[172:175], v[176:179]
M v[176:179], a[128:131], a[168:171], v[176:179]
M v[172:175], a[120:123], a[168:171], v[172:175]
 s_add_u32 m0, s86, 0
M v[172:175], a[124:127], a[172:175], v[172:175]
 buffer_load_dwordx4 v7, s[60:63], s67 offen offset:0 nt lds
M v[168:171], a[116:119], a[172:175], v[168:171]
M v[168:171], a[112:115], a[168:171], v[168:171]
M v[164:167], a[104:107], a[168:171], v[164:167]
 ds_read_b64_tr_b16 a[88:89], v4 offset:16384
 ds_read_b64_tr_b16 a[90:91], v4 offset:17408
M v[164:167], a[108:111], a[172:175], v[164:167]
 s_waitcnt lgkmcnt(4)
M v[160:163], a[100:103], a[172:175], v[160:163]
 buffer_load_dwordx4 v7, s[60:63], s67 offen offset:1024 nt lds
M v[160:163], a[96:99], a[168:171], v[160:163]
M v[192:195], a[96:99], a[160:163], v[192:195]
 ds_read_b128 a[168:171], v5 offset:55296
 ds_read_b128 a[172:175], v6 offset:55296
M v[192:195], a[100:103], a[164:167], v[192:195]
M v[196:199], a[108:111], a[164:167], v[196:199]
 buffer_load_dwordx4 v7, s[60:63], s67 offen offset:2048 nt lds
M v[196:199], a[104:107], a[160:163], v[196:199]
 ds_read_b64_tr_b16 a[92:93], v4 offset:24576
 ds_read_b64_tr_b16 a[94:95], v4 offset:25600
M v[200:203], a[112:115], a[160:163], v[200:203]
M v[200:203], a[116:119], a[164:167], v[200:203]
M v[204:207], a[124:127], a[164:167], v[204:207]
M v[204:207], a[120:123], a[160:163], v[204:207]
 buffer_load_dwordx4 v7, s[60:63], s67 offen offset:3072 nt lds
M v[208:211], a[128:131], a[160:163], v[208:211]
 s_add_u32 s67, s67, 4096
M v[208:211], a[132:135], a[164:167], v[208:211]
M v[212:215], a[140:143], a[164:167], v[212:215]
M v[212:215], a[136:139], a[160:163], v[212:215]
M v[216:219], a[144:147], a[160:163], v[216:219]
M v[216:219], a[148:151], a[164:167], v[216:219]
 s_waitcnt lgkmcnt(2)
M v[220:223], a[156:159], a[164:167], v[220:223]
 s_waitcnt vmcnt(21) lgkmcnt(0)
M v[220:223], a[152:155], a[160:163], v[220:223]
 s_barrier
M v[252:255], a[152:155], a[168:171], v[252:255]
 ds_read_b128 a[160:163], v5 offset:0
 ds_read_b128 a[164:167], v6 offset:0
M v[252:255], a[156:159], a[172:175], v[252:255]
M v[248:251], a[148:151], a[172:175], v[248:251]
M v[248:251], a[144:147], a[168:171], v[248:251]
M v[244:247], a[136:139], a[168:171], v[244:247]
M v[244:247], a[140:143], a[172:175], v[244:247]
M v[240:243], a[132:135], a[172:175], v[240:243]
M v[240:243], a[128:131], a[168:171], v[240:243]
M v[236:239], a[120:123], a[168:171], v[236:239]
M v[236:239], a[124:127], a[172:175], v[236:239]
M v[232:235], a[116:119], a[172:175], v[232:235]
M v[232:235], a[112:115], a[168:171], v[232:235]
M v[228:231], a[104:107], a[168:171], v[228:231]
M v[228:231], a[108:111], a[172:175], v[228:231]
 s_waitcnt lgkmcnt(0)
M v[224:227], a[100:103], a[172:175], v[224:227]
M v[224:227], a[96:99], a[168:171], v[224:227]
M a[0:3], a[32:35], a[160:163], a[0:3]
 ds_read_b128 a[168:171], v5 offset:2048
 ds_read_b128 a[172:175], v6 offset:2048
M a[0:3], a[36:39], a[164:167], a[0:3]
 ds_read_b64_tr_b16 a[96:97], v1 offset:32768
 ds_read_b64_tr_b16 a[98:99], v1 offset:33792
M a[4:7], a[44:47], a[164:167], a[4:7]
 s_add_u32 m0, s24, 49152
M a[4:7], a[40:43], a[160:163], a[4:7]
 buffer_load_dwordx4 v12, s[48:51], s22 offen offset:0   lds
M a[8:11], a[48:51], a[160:163], a[8:11]
M a[8:11], a[52:55], a[164:167], a[8:11]
M a[12:15], a[60:63], a[164:167], a[12:15]
 ds_read_b64_tr_b16 a[100:101], v1 offset:40960
 ds_read_b64_tr_b16 a[102:103], v1 offset:41984
M a[12:15], a[56:59], a[160:163], a[12:15]
M a[16:19], a[64:67], a[160:163], a[16:19]
 buffer_load_dwordx4 v13, s[48:51], s22 offen offset:1024   lds
M a[16:19], a[68:71], a[164:167], a[16:19]
M a[20:23], a[76:79], a[164:167], a[20:23]
 v_mov_b32 v16, 0x3f80
M a[20:23], a[72:75], a[160:163], a[20:23]
 ds_read_b64_tr_b16 a[104:105], v2 offset:32768
 ds_read_b64_tr_b16 a[106:107], v2 offset:33792
M a[24:27], a[80:83], a[160:163], a[24:27]
 v_lshrrev_b32 v17, 8, v7
M a[24:27], a[84:87], a[164:167], a[24:27]
 s_waitcnt lgkmcnt(6)
 v_bfe_u32 v18, v7, 6, 2
M a[28:31], a[92:95], a[164:167], a[28:31]
 buffer_load_dwordx4 v14, s[48:51], s22 offen offset:2048   lds
M a[28:31], a[88:91], a[160:163], a[28:31]
 v_and_b32 v19, 16, v7
M v[60:63], a[88:91], a[168:171], v[60:63]
 ds_read_b128 a[160:163], v5 offset:4096
 ds_read_b128 a[164:167], v6 offset:4096
M v[60:63], a[92:95], a[172:175], v[60:63]
 ds_read_b64_tr_b16 a[108:109], v2 offset:40960
 ds_read_b64_tr_b16 a[110:111], v2 offset:41984
M v[56:59], a[84:87], a[172:175], v[56:59]
 buffer_load_dwordx4 v15, s[48:51], s22 offen offset:3072   lds
M v[56:59], a[80:83], a[168:171], v[56:59]
 s_sub_u32 s22, s22, 2097024
 v_lshlrev_b32 v19, v19, v16
M v[52:55], a[72:75], a[168:171], v[52:55]
 v_cmp_eq_u32 vcc, v17, v18
M v[52:55], a[76:79], a[172:175], v[52:55]
 ds_read_b64_tr_b16 a[112:113], v3 offset:32768
 ds_read_b64_tr_b16 a[114:115], v3 offset:33792
M v[48:51], a[68:71], a[172:175], v[48:51]
 s_add_u32 m0, s23, 16384
 v_and_b32 v16, 32, v7
M v[48:51], a[64:67], a[168:171], v[48:51]
 buffer_load_dwordx4 v8, s[16:19], s21 offen offset:0  nt lds
M v[44:47], a[56:59], a[168:171], v[44:47]
 v_accvgpr_write_b32 a244, 0
M v[44:47], a[60:63], a[172:175], v[44:47]
 v_accvgpr_write_b32 a245, 0
M v[40:43], a[52:55], a[172:175], v[40:43]
 ds_read_b64_tr_b16 a[116:117], v3 offset:40960
 ds_read_b64_tr_b16 a[118:119], v3 offset:41984
M v[40:43], a[48:51], a[168:171], v[40:43]
 v_cndmask_b32 v19, 0, v19, vcc
M v[36:39], a[40:43], a[168:171], v[36:39]
 buffer_load_dwordx4 v9, s[16:19], s21 offen offset:1024  nt lds
M v[36:39], a[44:47], a[172:175], v[36:39]
 s_waitcnt lgkmcnt(6)
 v_cmp_eq_u32 vcc, 0, v16
M v[32:35], a[36:39], a[172:175], v[32:35]
 v_accvgpr_write_b32 a248, 0
M v[32:35], a[32:35], a[168:171], v[32:35]
 ds_read_b64_tr_b16 a[120:121], v4 offset:32768
 ds_read_b64_tr_b16 a[122:123], v4 offset:33792
M v[64:67], a[32:35], a[160:163], v[64:67]
 ds_read_b128 a[168:171], v5 offset:6144
 ds_read_b128 a[172:175], v6 offset:6144
M v[64:67], a[36:39], a[164:167], v[64:67]
 buffer_load_dwordx4 v10, s[16:19], s21 offen offset:2048  nt lds
M v[68:71], a[44:47], a[164:167], v[68:71]
 v_accvgpr_write_b32 a249, 0
M v[68:71], a[40:43], a[160:163], v[68:71]
 v_cndmask_b32 v17, 0, v19, vcc
M v[72:75], a[48:51], a[160:163], v[72:75]
 ds_read_b64_tr_b16 a[124:125], v4 offset:40960
 ds_read_b64_tr_b16 a[126:127], v4 offset:41984
M v[72:75], a[52:55], a[164:167], v[72:75]
 v_sub_u32 v18, v19, v17
M v[76:79], a[60:63], a[164:167], v[76:79]
 buffer_load_dwordx4 v11, s[16:19], s21 offen offset:3072  nt lds
M v[76:79], a[56:59], a[160:163], v[76:79]
 s_add_u32 s21, s21, 524160
 v_accvgpr_write_b32 a246, v17
M v[80:83], a[64:67], a[160:163], v[80:83]
 v_accvgpr_write_b32 a247, v18
M v[80:83], a[68:71], a[164:167], v[80:83]
M v[84:87], a[76:79], a[164:167], v[84:87]
M v[84:87], a[72:75], a[160:163], v[84:87]
M v[88:91], a[80:83], a[160:163], v[88:91]
M v[88:91], a[84:87], a[164:167], v[88:91]
 s_waitcnt lgkmcnt(2)
M v[92:95], a[92:95], a[164:167], v[92:95]
 s_waitcnt vmcnt(20) lgkmcnt(0)
M v[92:95], a[88:91], a[160:163], v[92:95]
 s_barrier
M v[124:127], a[88:91], a[168:171], v[124:127]
 ds_read_b128 a[160:163], v5 offset:16384
 ds_read_b128 a[164:167], v6 offset:16384
M v[124:127], a[92:95], a[172:175], v[124:127]
M v[120:123], a[84:87], a[172:175], v[120:123]
 s_add_u32 m0, s24, 0
 ds_read_b64_tr_b16 a[128:129], v1 offset:49152
 ds_read_b64_tr_b16 a[130:131], v1 offset:50176
M v[120:123], a[80:83], a[168:171], v[120:123]
 buffer_load_dwordx4 v12, s[48:51], s22 offen offset:0   lds
M v[116:119], a[72:75], a[168:171], v[116:119]
M v[116:119], a[76:79], a[172:175], v[116:119]
M v[112:115], a[68:71], a[172:175], v[112:115]
M v[112:115], a[64:67], a[168:171], v[112:115]
M v[108:111], a[56:59], a[168:171], v[108:111]
 buffer_load_dwordx4 v13, s[48:51], s22 offen offset:1024   lds
M v[108:111], a[60:63], a[172:175], v[108:111]
 ds_read_b64_tr_b16 a[132:133], v1 offset:57344
 ds_read_b64_tr_b16 a[134:135], v1 offset:58368
M v[104:107], a[52:55], a[172:175], v[104:107]
M v[104:107], a[48:51], a[168:171], v[104:107]
M v[100:103], a[40:43], a[168:171], v[100:103]
M v[100:103], a[44:47], a[172:175], v[100:103]
 s_waitcnt lgkmcnt(4)
M v[96:99], a[36:39], a[172:175], v[96:99]
 buffer_load_dwordx4 v14, s[48:51], s22 offen offset:2048   lds
M v[96:99], a[32:35], a[168:171], v[96:99]
M v[128:131], a[32:35], a[160:163], v[128:131]
 ds_read_b128 a[168:171], v5 offset:18432
 ds_read_b128 a[172:175], v6 offset:18432
M v[128:131], a[36:39], a[164:167], v[128:131]
 ds_read_b64_tr_b16 a[136:137], v2 offset:49152
 ds_read_b64_tr_b16 a[138:139], v2 offset:50176
M v[132:135], a[44:47], a[164:167], v[132:135]
 buffer_load_dwordx4 v15, s[48:51], s22 offen offset:3072   lds
M v[132:135], a[40:43], a[160:163], v[132:135]
 s_add_u32 s22, s22, 2097152
M v[136:139], a[48:51], a[160:163], v[136:139]
M v[136:139], a[52:55], a[164:167], v[136:139]
M v[140:143], a[60:63], a[164:167], v[140:143]
 s_add_u32 m0, s23, 32768
M v[140:143], a[56:59], a[160:163], v[140:143]
 ds_read_b64_tr_b16 a[140:141], v2 offset:57344
 ds_read_b64_tr_b16 a[142:143], v2 offset:58368
M v[144:147], a[64:67], a[160:163], v[144:147]
 buffer_load_dwordx4 v8, s[16:19], s21 offen offset:0  nt lds
M v[144:147], a[68:71], a[164:167], v[144:147]
M v[148:151], a[76:79], a[164:167], v[148:151]
M v[148:151], a[72:75], a[160:163], v[148:151]
M v[152:155], a[80:83], a[160:163], v[152:155]
 buffer_load_dwordx4 v9, s[16:19], s21 offen offset:1024  nt lds
M v[152:155], a[84:87], a[164:167], v[152:155]
 s_waitcnt lgkmcnt(4)
M v[156:159], a[92:95], a[164:167], v[156:159]
 ds_read_b64_tr_b16 a[144:145], v3 offset:49152
 ds_read_b64_tr_b16 a[146:147], v3 offset:50176
M v[156:159], a[88:91], a[160:163], v[156:159]
M v[188:191], a[88:91], a[168:171], v[188:191]
 ds_read_b128 a[160:163], v5 offset:20480
 ds_read_b128 a[164:167], v6 offset:20480
M v[188:191], a[92:95], a[172:175], v[188:191]
M v[184:187], a[84:87], a[172:175], v[184:187]
 buffer_load_dwordx4 v10, s[16:19], s21 offen offset:2048  nt lds
M v[184:187], a[80:83], a[168:171], v[184:187]
M v[180:183], a[72:75], a[168:171], v[180:183]
M v[180:183], a[76:79], a[172:175], v[180:183]
 ds_read_b64_tr_b16 a[148:149], v3 offset:57344
 ds_read_b64_tr_b16 a[150:151], v3 offset:58368
M v[176:179], a[68:71], a[172:175], v[176:179]
M v[176:179], a[64:67], a[168:171], v[176:179]
 buffer_load_dwordx4 v11, s[16:19], s21 offen offset:3072  nt lds
M v[172:175], a[56:59], a[168:171], v[172:175]
 s_add_u32 s21, s21, 128
M v[172:175], a[60:63], a[172:175], v[172:175]
M v[168:171], a[52:55], a[172:175], v[168:171]
M v[168:171], a[48:51], a[168:171], v[168:171]
 s_add_u32 m0, s86, 4096
M v[164:167], a[40:43], a[168:171], v[164:167]
 ds_read_b64_tr_b16 a[152:153], v4 offset:49152
 ds_read_b64_tr_b16 a[154:155], v4 offset:50176
M v[164:167], a[44:47], a[172:175], v[164:167]
 s_waitcnt lgkmcnt(4)
M v[160:163], a[36:39], a[172:175], v[160:163]
 buffer_load_dwordx4 v7, s[60:63], s67 offen offset:0 nt lds
M v[160:163], a[32:35], a[168:171], v[160:163]
M v[192:195], a[32:35], a[160:163], v[192:195]
 ds_read_b128 a[168:171], v5 offset:22528
 ds_read_b128 a[172:175], v6 offset:22528
M v[192:195], a[36:39], a[164:167], v[192:195]
 buffer_load_dwordx4 v7, s[60:63], s67 offen offset:1024 nt lds
M v[196:199], a[44:47], a[164:167], v[196:199]
M v[196:199], a[40:43], a[160:163], v[196:199]
 ds_read_b64_tr_b16 a[156:157], v4 offset:57344
 ds_read_b64_tr_b16 a[158:159], v4 offset:58368
M v[200:203], a[48:51], a[160:163], v[200:203]
M v[200:203], a[52:55], a[164:167], v[200:203]
M v[204:207], a[60:63], a[164:167], v[204:207]
 buffer_load_dwordx4 v7, s[60:63], s67 offen offset:2048 nt lds
M v[204:207], a[56:59], a[160:163], v[204:207]
 s_add_u32 s67, s67, 4096
M v[208:211], a[64:67], a[160:163], v[208:211]
M v[208:211], a[68:71], a[164:167], v[208:211]
M v[212:215], a[76:79], a[164:167], v[212:215]
M v[212:215], a[72:75], a[160:163], v[212:215]
M v[216:219], a[80:83], a[160:163], v[216:219]
M v[216:219], a[84:87], a[164:167], v[216:219]
 s_waitcnt lgkmcnt(2)
M v[220:223], a[92:95], a[164:167], v[220:223]
 s_waitcnt vmcnt(23) lgkmcnt(0)
M v[220:223], a[88:91], a[160:163], v[220:223]
 s_barrier
M v[252:255], a[88:91], a[168:171], v[252:255]
 ds_read_b128 a[160:163], v5 offset:32768
 ds_read_b128 a[164:167], v6 offset:32768
M v[252:255], a[92:95], a[172:175], v[252:255]
 v_and_b32 v26, 48, v0
 v_lshlrev_b32 v26, 17, v26
M v[248:251], a[84:87], a[172:175], v[248:251]
 v_or_b32 v26, v26, v0
 v_lshl_add_u32 v26, v26, 7, s95
M v[248:251], a[80:83], a[168:171], v[248:251]
 buffer_load_dword a240, v26, s[76:79], 0 offen offset:0
M v[244:247], a[72:75], a[168:171], v[244:247]
M v[244:247], a[76:79], a[172:175], v[244:247]
M v[240:243], a[68:71], a[172:175], v[240:243]
M v[240:243], a[64:67], a[168:171], v[240:243]
M v[236:239], a[56:59], a[168:171], v[236:239]
M v[236:239], a[60:63], a[172:175], v[236:239]
M v[232:235], a[52:55], a[172:175], v[232:235]
M v[232:235], a[48:51], a[168:171], v[232:235]
M v[228:231], a[40:43], a[168:171], v[228:231]
M v[228:231], a[44:47], a[172:175], v[228:231]
 s_waitcnt lgkmcnt(0)
M v[224:227], a[36:39], a[172:175], v[224:227]
M v[224:227], a[32:35], a[168:171], v[224:227]
M a[0:3], a[96:99], a[160:163], a[0:3]
 ds_read_b128 a[168:171], v5 offset:34816
 ds_read_b128 a[172:175], v6 offset:34816
M a[0:3], a[100:103], a[164:167], a[0:3]
 ds_read_b64_tr_b16 a[32:33], v1 offset:0
 ds_read_b64_tr_b16 a[34:35], v1 offset:1024
M a[4:7], a[108:111], a[164:167], a[4:7]
 s_add_u32 m0, s24, 16384
M a[4:7], a[104:107], a[160:163], a[4:7]
 buffer_load_dwordx4 v12, s[48:51], s22 offen offset:0   lds
M a[8:11], a[112:115], a[160:163], a[8:11]
M a[8:11], a[116:119], a[164:167], a[8:11]
M a[12:15], a[124:127], a[164:167], a[12:15]
 ds_read_b64_tr_b16 a[36:37], v1 offset:8192
 ds_read_b64_tr_b16 a[38:39], v1 offset:9216
M a[12:15], a[120:123], a[160:163], a[12:15]
M a[16:19], a[128:131], a[160:163], a[16:19]
 buffer_load_dwordx4 v13, s[48:51], s22 offen offset:1024   lds
M a[16:19], a[132:135], a[164:167], a[16:19]
M a[20:23], a[140:143], a[164:167], a[20:23]
M a[20:23], a[136:139], a[160:163], a[20:23]
 ds_read_b64_tr_b16 a[40:41], v2 offset:0
 ds_read_b64_tr_b16 a[42:43], v2 offset:1024
M a[24:27], a[144:147], a[160:163], a[24:27]
M a[24:27], a[148:151], a[164:167], a[24:27]
 s_waitcnt lgkmcnt(6)
M a[28:31], a[156:159], a[164:167], a[28:31]
 buffer_load_dwordx4 v14, s[48:51], s22 offen offset:2048   lds
M a[28:31], a[152:155], a[160:163], a[28:31]
M v[60:63], a[152:155], a[168:171], v[60:63]
 ds_read_b128 a[160:163], v5 offset:36864
 ds_read_b128 a[164:167], v6 offset:36864
M v[60:63], a[156:159], a[172:175], v[60:63]
 ds_read_b64_tr_b16 a[44:45], v2 offset:8192
 ds_read_b64_tr_b16 a[46:47], v2 offset:9216
M v[56:59], a[148:151], a[172:175], v[56:59]
 buffer_load_dwordx4 v15, s[48:51], s22 offen offset:3072   lds
M v[56:59], a[144:147], a[168:171], v[56:59]
 s_sub_u32 s22, s22, 2097024
M v[52:55], a[136:139], a[168:171], v[52:55]
M v[52:55], a[140:143], a[172:175], v[52:55]
 ds_read_b64_tr_b16 a[48:49], v3 offset:0
 ds_read_b64_tr_b16 a[50:51], v3 offset:1024
M v[48:51], a[132:135], a[172:175], v[48:51]
 s_add_u32 m0, s23, 49152
M v[48:51], a[128:131], a[168:171], v[48:51]
 buffer_load_dwordx4 v8, s[16:19], s21 offen offset:0  nt lds
M v[44:47], a[120:123], a[168:171], v[44:47]
M v[44:47], a[124:127], a[172:175], v[44:47]
M v[40:43], a[116:119], a[172:175], v[40:43]
 ds_read_b64_tr_b16 a[52:53], v3 offset:8192
 ds_read_b64_tr_b16 a[54:55], v3 offset:9216
M v[40:43], a[112:115], a[168:171], v[40:43]
M v[36:39], a[104:107], a[168:171], v[36:39]
 buffer_load_dwordx4 v9, s[16:19], s21 offen offset:1024  nt lds
M v[36:39], a[108:111], a[172:175], v[36:39]
 s_waitcnt lgkmcnt(6)
M v[32:35], a[100:103], a[172:175], v[32:35]
M v[32:35], a[96:99], a[168:171], v[32:35]
 ds_read_b64_tr_b16 a[56:57], v4 offset:0
 ds_read_b64_tr_b16 a[58:59], v4 offset:1024
M v[64:67], a[96:99], a[160:163], v[64:67]
 ds_read_b128 a[168:171], v5 offset:38912
 ds_read_b128 a[172:175], v6 offset:38912
M v[64:67], a[100:103], a[164:167], v[64:67]
 buffer_load_dwordx4 v10, s[16:19], s21 offen offset:2048  nt lds
M v[68:71], a[108:111], a[164:167], v[68:71]
M v[68:71], a[104:107], a[160:163], v[68:71]
M v[72:75], a[112:115], a[160:163], v[72:75]
 ds_read_b64_tr_b16 a[60:61], v4 offset:8192
 ds_read_b64_tr_b16 a[62:63], v4 offset:9216
M v[72:75], a[116:119], a[164:167], v[72:75]
M v[76:79], a[124:127], a[164:167], v[76:79]
 buffer_load_dwordx4 v11, s[16:19], s21 offen offset:3072  nt lds
M v[76:79], a[120:123], a[160:163], v[76:79]
 s_add_u32 s21, s21, 524160
M v[80:83], a[128:131], a[160:163], v[80:83]
M v[80:83], a[132:135], a[164:167], v[80:83]
M v[84:87], a[140:143], a[164:167], v[84:87]
M v[84:87], a[136:139], a[160:163], v[84:87]
M v[88:91], a[144:147], a[160:163], v[88:91]
M v[88:91], a[148:151], a[164:167], v[88:91]
 s_waitcnt lgkmcnt(2)
M v[92:95], a[156:159], a[164:167], v[92:95]
 s_waitcnt vmcnt(20) lgkmcnt(0)
M v[92:95], a[152:155], a[160:163], v[92:95]
 s_barrier
M v[124:127], a[152:155], a[168:171], v[124:127]
 ds_read_b128 a[160:163], v5 offset:49152
 ds_read_b128 a[164:167], v6 offset:49152
M v[124:127], a[156:159], a[172:175], v[124:127]
M v[120:123], a[148:151], a[172:175], v[120:123]
 s_add_u32 m0, s24, 32768
 ds_read_b64_tr_b16 a[64:65], v1 offset:16384
 ds_read_b64_tr_b16 a[66:67], v1 offset:17408
M v[120:123], a[144:147], a[168:171], v[120:123]
 buffer_load_dwordx4 v12, s[48:51], s22 offen offset:0   lds
M v[116:119], a[136:139], a[168:171], v[116:119]
M v[116:119], a[140:143], a[172:175], v[116:119]
M v[112:115], a[132:135], a[172:175], v[112:115]
M v[112:115], a[128:131], a[168:171], v[112:115]
M v[108:111], a[120:123], a[168:171], v[108:111]
M v[108:111], a[124:127], a[172:175], v[108:111]
 ds_read_b64_tr_b16 a[68:69], v1 offset:24576
 ds_read_b64_tr_b16 a[70:71], v1 offset:25600
M v[104:107], a[116:119], a[172:175], v[104:107]
 buffer_load_dwordx4 v13, s[48:51], s22 offen offset:1024   lds
M v[104:107], a[112:115], a[168:171], v[104:107]
M v[100:103], a[104:107], a[168:171], v[100:103]
M v[100:103], a[108:111], a[172:175], v[100:103]
 s_waitcnt lgkmcnt(4)
M v[96:99], a[100:103], a[172:175], v[96:99]
M v[96:99], a[96:99], a[168:171], v[96:99]
M v[128:131], a[96:99], a[160:163], v[128:131]
 ds_read_b128 a[168:171], v5 offset:51200
 ds_read_b128 a[172:175], v6 offset:51200
M v[128:131], a[100:103], a[164:167], v[128:131]
 ds_read_b64_tr_b16 a[72:73], v2 offset:16384
 ds_read_b64_tr_b16 a[74:75], v2 offset:17408
M v[132:135], a[108:111], a[164:167], v[132:135]
 buffer_load_dwordx4 v14, s[48:51], s22 offen offset:2048   lds
M v[132:135], a[104:107], a[160:163], v[132:135]
M v[136:139], a[112:115], a[160:163], v[136:139]
M v[136:139], a[116:119], a[164:167], v[136:139]
M v[140:143], a[124:127], a[164:167], v[140:143]
M v[140:143], a[120:123], a[160:163], v[140:143]
 ds_read_b64_tr_b16 a[76:77], v2 offset:24576
 ds_read_b64_tr_b16 a[78:79], v2 offset:25600
M v[144:147], a[128:131], a[160:163], v[144:147]
 buffer_load_dwordx4 v15, s[48:51], s22 offen offset:3072   lds
M v[144:147], a[132:135], a[164:167], v[144:147]
 s_add_u32 s22, s22, 2097152
M v[148:151], a[140:143], a[164:167], v[148:151]
M v[148:151], a[136:139], a[160:163], v[148:151]
M v[152:155], a[144:147], a[160:163], v[152:155]
M v[152:155], a[148:151], a[164:167], v[152:155]
 s_waitcnt lgkmcnt(4)
M v[156:159], a[156:159], a[164:167], v[156:159]
 s_add_u32 m0, s23, 0
 ds_read_b64_tr_b16 a[80:81], v3 offset:16384
 ds_read_b64_tr_b16 a[82:83], v3 offset:17408
M v[156:159], a[152:155], a[160:163], v[156:159]
 buffer_load_dwordx4 v8, s[16:19], s21 offen offset:0  nt lds
M v[188:191], a[152:155], a[168:171], v[188:191]
 ds_read_b128 a[160:163], v5 offset:53248
 ds_read_b128 a[164:167], v6 offset:53248
M v[188:191], a[156:159], a[172:175], v[188:191]
M v[184:187], a[148:151], a[172:175], v[184:187]
M v[184:187], a[144:147], a[168:171], v[184:187]
M v[180:183], a[136:139], a[168:171], v[180:183]
M v[180:183], a[140:143], a[172:175], v[180:183]
 ds_read_b64_tr_b16 a[84:85], v3 offset:24576
 ds_read_b64_tr_b16 a[86:87], v3 offset:25600
M v[176:179], a[132:135], a[172:175], v[176:179]
 buffer_load_dwordx4 v9, s[16:19], s21 offen offset:1024  nt lds
M v[176:179], a[128:131], a[168:171], v[176:179]
M v[172:175], a[120:123], a[168:171], v[172:175]
M v[172:175], a[124:127], a[172:175], v[172:175]
M v[168:171], a[116:119], a[172:175], v[168:171]
M v[168:171], a[112:115], a[168:171], v[168:171]
M v[164:167], a[104:107], a[168:171], v[164:167]
 ds_read_b64_tr_b16 a[88:89], v4 offset:16384
 ds_read_b64_tr_b16 a[90:91], v4 offset:17408
M v[164:167], a[108:111], a[172:175], v[164:167]
 s_waitcnt lgkmcnt(4)
M v[160:163], a[100:103], a[172:175], v[160:163]
 buffer_load_dwordx4 v10, s[16:19], s21 offen offset:2048  nt lds
M v[160:163], a[96:99], a[168:171], v[160:163]
M v[192:195], a[96:99], a[160:163], v[192:195]
 ds_read_b128 a[168:171], v5 offset:55296
 ds_read_b128 a[172:175], v6 offset:55296
M v[192:195], a[100:103], a[164:167], v[192:195]
M v[196:199], a[108:111], a[164:167], v[196:199]
M v[196:199], a[104:107], a[160:163], v[196:199]
 ds_read_b64_tr_b16 a[92:93], v4 offset:24576
 ds_read_b64_tr_b16 a[94:95], v4 offset:25600
M v[200:203], a[112:115], a[160:163], v[200:203]
 buffer_load_dwordx4 v11, s[16:19], s21 offen offset:3072  nt lds
M v[200:203], a[116:119], a[164:167], v[200:203]
 s_add_u32 s21, s21, 128
M v[204:207], a[124:127], a[164:167], v[204:207]
M v[204:207], a[120:123], a[160:163], v[204:207]
M v[208:211], a[128:131], a[160:163], v[208:211]
M v[208:211], a[132:135], a[164:167], v[208:211]
M v[212:215], a[140:143], a[164:167], v[212:215]
M v[212:215], a[136:139], a[160:163], v[212:215]
M v[216:219], a[144:147], a[160:163], v[216:219]
M v[216:219], a[148:151], a[164:167], v[216:219]
 s_waitcnt lgkmcnt(2)
M v[220:223], a[156:159], a[164:167], v[220:223]
 s_waitcnt vmcnt(17) lgkmcnt(0)
M v[220:223], a[152:155], a[160:163], v[220:223]
 s_barrier
M v[252:255], a[152:155], a[168:171], v[252:255]
 ds_read_b128 a[160:163], v5 offset:0
 ds_read_b128 a[164:167], v6 offset:0
M v[252:255], a[156:159], a[172:175], v[252:255]
M v[248:251], a[148:151], a[172:175], v[248:251]
M v[248:251], a[144:147], a[168:171], v[248:251]
M v[244:247], a[136:139], a[168:171], v[244:247]
M v[244:247], a[140:143], a[172:175], v[244:247]
M v[240:243], a[132:135], a[172:175], v[240:243]
M v[240:243], a[128:131], a[168:171], v[240:243]
M v[236:239], a[120:123], a[168:171], v[236:239]
M v[236:239], a[124:127], a[172:175], v[236:239]
M v[232:235], a[116:119], a[172:175], v[232:235]
M v[232:235], a[112:115], a[168:171], v[232:235]
M v[228:231], a[104:107], a[168:171], v[228:231]
M v[228:231], a[108:111], a[172:175], v[228:231]
 s_waitcnt lgkmcnt(0)
M v[224:227], a[100:103], a[172:175], v[224:227]
M v[224:227], a[96:99], a[168:171], v[224:227]
M a[0:3], a[32:35], a[160:163], a[0:3]
 ds_read_b128 a[168:171], v5 offset:2048
 ds_read_b128 a[172:175], v6 offset:2048
M a[0:3], a[36:39], a[164:167], a[0:3]
 ds_read_b64_tr_b16 a[96:97], v1 offset:32768
 ds_read_b64_tr_b16 a[98:99], v1 offset:33792
M a[4:7], a[44:47], a[164:167], a[4:7]
 s_add_u32 m0, s24, 49152
 v_lshrrev_b32 v28, 2, v0
M a[4:7], a[40:43], a[160:163], a[4:7]
 buffer_load_dwordx4 v12, s[48:51], s22 offen offset:0   lds
M a[8:11], a[48:51], a[160:163], a[8:11]
 v_mul_u32_u24 v28, 896, v28
M a[8:11], a[52:55], a[164:167], a[8:11]
M a[12:15], a[60:63], a[164:167], a[12:15]
 ds_read_b64_tr_b16 a[100:101], v1 offset:40960
 ds_read_b64_tr_b16 a[102:103], v1 offset:41984
M a[12:15], a[56:59], a[160:163], a[12:15]
 v_and_b32 v29, 3, v0
M a[16:19], a[64:67], a[160:163], a[16:19]
 buffer_load_dwordx4 v13, s[48:51], s22 offen offset:1024   lds
M a[16:19], a[68:71], a[164:167], a[16:19]
 v_lshl_add_u32 v28, v29, 4, v28
M a[20:23], a[76:79], a[164:167], a[20:23]
M a[20:23], a[72:75], a[160:163], a[20:23]
 s_lshr_b32 s64, s20, 1
 ds_read_b64_tr_b16 a[104:105], v2 offset:32768
 ds_read_b64_tr_b16 a[106:107], v2 offset:33792
M a[24:27], a[80:83], a[160:163], a[24:27]
 s_lshl_b32 s64, s64, 6
 s_and_b32 s72, s20, 1
 s_lshl_b32 s72, s72, 3
M a[24:27], a[84:87], a[164:167], a[24:27]
 s_waitcnt lgkmcnt(6)
 s_add_u32 s64, s64, s72
 s_add_u32 s64, s64, 131072
M a[28:31], a[92:95], a[164:167], a[28:31]
 buffer_load_dwordx4 v14, s[48:51], s22 offen offset:2048   lds
M a[28:31], a[88:91], a[160:163], a[28:31]
 v_add_u32 v28, s64, v28
M v[60:63], a[88:91], a[168:171], v[60:63]
 ds_read_b128 a[160:163], v5 offset:4096
 ds_read_b128 a[164:167], v6 offset:4096
M v[60:63], a[92:95], a[172:175], v[60:63]
 s_lshl_b32 s94, s27, 21
 ds_read_b64_tr_b16 a[108:109], v2 offset:40960
 ds_read_b64_tr_b16 a[110:111], v2 offset:41984
M v[56:59], a[84:87], a[172:175], v[56:59]
 buffer_load_dwordx4 v15, s[48:51], s22 offen offset:3072   lds
M v[56:59], a[80:83], a[168:171], v[56:59]
 s_sub_u32 s22, s22, 2097024
 s_and_b32 s64, s42, 7
M v[52:55], a[72:75], a[168:171], v[52:55]
 s_lshl_b32 s64, s64, 10
M v[52:55], a[76:79], a[172:175], v[52:55]
 s_add_u32 s94, s94, s64
 ds_read_b64_tr_b16 a[112:113], v3 offset:32768
 ds_read_b64_tr_b16 a[114:115], v3 offset:33792
M v[48:51], a[68:71], a[172:175], v[48:51]
 s_add_u32 m0, s23, 16384
 s_lshl_b32 s64, s20, 14
 s_add_u32 s94, s94, s64
M v[48:51], a[64:67], a[168:171], v[48:51]
 buffer_load_dwordx4 v8, s[16:19], s21 offen offset:0  nt lds
M v[44:47], a[56:59], a[168:171], v[44:47]
 s_add_u32 s94, s94, 201326592
 ds_read_b64_tr_b16 a[192:193], v28 offset:0
M v[44:47], a[60:63], a[172:175], v[44:47]
M v[40:43], a[52:55], a[172:175], v[40:43]
 ds_read_b64_tr_b16 a[116:117], v3 offset:40960
 ds_read_b64_tr_b16 a[118:119], v3 offset:41984
M v[40:43], a[48:51], a[168:171], v[40:43]
 ds_read_b64_tr_b16 a[194:195], v28 offset:14336
M v[36:39], a[40:43], a[168:171], v[36:39]
 buffer_load_dwordx4 v9, s[16:19], s21 offen offset:1024  nt lds
M v[36:39], a[44:47], a[172:175], v[36:39]
 s_waitcnt lgkmcnt(8)
 ds_read_b64_tr_b16 a[196:197], v28 offset:128
M v[32:35], a[36:39], a[172:175], v[32:35]
M v[32:35], a[32:35], a[168:171], v[32:35]
 ds_read_b64_tr_b16 a[120:121], v4 offset:32768
 ds_read_b64_tr_b16 a[122:123], v4 offset:33792
M v[64:67], a[32:35], a[160:163], v[64:67]
 ds_read_b128 a[168:171], v5 offset:6144
 ds_read_b128 a[172:175], v6 offset:6144
M v[64:67], a[36:39], a[164:167], v[64:67]
 buffer_load_dwordx4 v10, s[16:19], s21 offen offset:2048  nt lds
M v[68:71], a[44:47], a[164:167], v[68:71]
 ds_read_b64_tr_b16 a[198:199], v28 offset:14464
M v[68:71], a[40:43], a[160:163], v[68:71]
M v[72:75], a[48:51], a[160:163], v[72:75]
 ds_read_b64_tr_b16 a[124:125], v4 offset:40960
 ds_read_b64_tr_b16 a[126:127], v4 offset:41984
M v[72:75], a[52:55], a[164:167], v[72:75]
 ds_read_b64_tr_b16 a[200:201], v28 offset:256
M v[76:79], a[60:63], a[164:167], v[76:79]
 buffer_load_dwordx4 v11, s[16:19], s21 offen offset:3072  nt lds
M v[76:79], a[56:59], a[160:163], v[76:79]
 s_add_u32 s21, s21, 524160
 ds_read_b64_tr_b16 a[202:203], v28 offset:14592
M v[80:83], a[64:67], a[160:163], v[80:83]
M v[80:83], a[68:71], a[164:167], v[80:83]
 ds_read_b64_tr_b16 a[204:205], v28 offset:384
M v[84:87], a[76:79], a[164:167], v[84:87]
M v[84:87], a[72:75], a[160:163], v[84:87]
 ds_read_b64_tr_b16 a[206:207], v28 offset:14720
M v[88:91], a[80:83], a[160:163], v[88:91]
M v[88:91], a[84:87], a[164:167], v[88:91]
 s_waitcnt lgkmcnt(7)
 ds_read_b64_tr_b16 a[208:209], v28 offset:512
M v[92:95], a[92:95], a[164:167], v[92:95]
 s_waitcnt vmcnt(16) lgkmcnt(0)
M v[92:95], a[88:91], a[160:163], v[92:95]
 s_barrier
M v[124:127], a[88:91], a[168:171], v[124:127]
 ds_read_b128 a[160:163], v5 offset:16384
 ds_read_b128 a[164:167], v6 offset:16384
M v[124:127], a[92:95], a[172:175], v[124:127]
 ds_read_b64_tr_b16 a[210:211], v28 offset:14848
M v[120:123], a[84:87], a[172:175], v[120:123]
 s_add_u32 m0, s24, 0
 ds_read_b64_tr_b16 a[128:129], v1 offset:49152
 ds_read_b64_tr_b16 a[130:131], v1 offset:50176
M v[120:123], a[80:83], a[168:171], v[120:123]
 buffer_load_dwordx4 v12, s[48:51], s22 offen offset:0   lds
M v[116:119], a[72:75], a[168:171], v[116:119]
 ds_read_b64_tr_b16 a[212:213], v28 offset:640
M v[116:119], a[76:79], a[172:175], v[116:119]
M v[112:115], a[68:71], a[172:175], v[112:115]
 ds_read_b64_tr_b16 a[214:215], v28 offset:14976
M v[112:115], a[64:67], a[168:171], v[112:115]
M v[108:111], a[56:59], a[168:171], v[108:111]
 ds_read_b64_tr_b16 a[216:217], v28 offset:768
M v[108:111], a[60:63], a[172:175], v[108:111]
 ds_read_b64_tr_b16 a[132:133], v1 offset:57344
 ds_read_b64_tr_b16 a[134:135], v1 offset:58368
M v[104:107], a[52:55], a[172:175], v[104:107]
 buffer_load_dwordx4 v13, s[48:51], s22 offen offset:1024   lds
M v[104:107], a[48:51], a[168:171], v[104:107]
 ds_read_b64_tr_b16 a[218:219], v28 offset:15104
M v[100:103], a[40:43], a[168:171], v[100:103]
M v[100:103], a[44:47], a[172:175], v[100:103]
 s_waitcnt lgkmcnt(9)
M v[96:99], a[36:39], a[172:175], v[96:99]
M v[96:99], a[32:35], a[168:171], v[96:99]
M v[128:131], a[32:35], a[160:163], v[128:131]
 ds_read_b128 a[168:171], v5 offset:18432
 ds_read_b128 a[172:175], v6 offset:18432
M v[128:131], a[36:39], a[164:167], v[128:131]
 ds_read_b64_tr_b16 a[136:137], v2 offset:49152
 ds_read_b64_tr_b16 a[138:139], v2 offset:50176
M v[132:135], a[44:47], a[164:167], v[132:135]
 buffer_load_dwordx4 v14, s[48:51], s22 offen offset:2048   lds
M v[132:135], a[40:43], a[160:163], v[132:135]
M v[136:139], a[48:51], a[160:163], v[136:139]
M v[136:139], a[52:55], a[164:167], v[136:139]
M v[140:143], a[60:63], a[164:167], v[140:143]
M v[140:143], a[56:59], a[160:163], v[140:143]
 ds_read_b64_tr_b16 a[140:141], v2 offset:57344
 ds_read_b64_tr_b16 a[142:143], v2 offset:58368
M v[144:147], a[64:67], a[160:163], v[144:147]
 buffer_load_dwordx4 v15, s[48:51], s22 offen offset:3072   lds
M v[144:147], a[68:71], a[164:167], v[144:147]
 s_add_u32 s22, s22, 2097152
M v[148:151], a[76:79], a[164:167], v[148:151]
M v[148:151], a[72:75], a[160:163], v[148:151]
M v[152:155], a[80:83], a[160:163], v[152:155]
M v[152:155], a[84:87], a[164:167], v[152:155]
 s_waitcnt lgkmcnt(4)
M v[156:159], a[92:95], a[164:167], v[156:159]
 s_add_u32 m0, s23, 32768
 ds_read_b64_tr_b16 a[144:145], v3 offset:49152
 ds_read_b64_tr_b16 a[146:147], v3 offset:50176
M v[156:159], a[88:91], a[160:163], v[156:159]
 buffer_load_dwordx4 v8, s[16:19], s21 offen offset:0  nt lds
M v[188:191], a[88:91], a[168:171], v[188:191]
 ds_read_b128 a[160:163], v5 offset:20480
 ds_read_b128 a[164:167], v6 offset:20480
M v[188:191], a[92:95], a[172:175], v[188:191]
M v[184:187], a[84:87], a[172:175], v[184:187]
M v[184:187], a[80:83], a[168:171], v[184:187]
M v[180:183], a[72:75], a[168:171], v[180:183]
M v[180:183], a[76:79], a[172:175], v[180:183]
 ds_read_b64_tr_b16 a[148:149], v3 offset:57344
 ds_read_b64_tr_b16 a[150:151], v3 offset:58368
M v[176:179], a[68:71], a[172:175], v[176:179]
 buffer_load_dwordx4 v9, s[16:19], s21 offen offset:1024  nt lds
M v[176:179], a[64:67], a[168:171], v[176:179]
M v[172:175], a[56:59], a[168:171], v[172:175]
M v[172:175], a[60:63], a[172:175], v[172:175]
M v[168:171], a[52:55], a[172:175], v[168:171]
M v[168:171], a[48:51], a[168:171], v[168:171]
M v[164:167], a[40:43], a[168:171], v[164:167]
 ds_read_b64_tr_b16 a[152:153], v4 offset:49152
 ds_read_b64_tr_b16 a[154:155], v4 offset:50176
M v[164:167], a[44:47], a[172:175], v[164:167]
 s_waitcnt lgkmcnt(4)
M v[160:163], a[36:39], a[172:175], v[160:163]
 buffer_load_dwordx4 v10, s[16:19], s21 offen offset:2048  nt lds
M v[160:163], a[32:35], a[168:171], v[160:163]
M v[192:195], a[32:35], a[160:163], v[192:195]
 ds_read_b128 a[168:171], v5 offset:22528
 ds_read_b128 a[172:175], v6 offset:22528
M v[192:195], a[36:39], a[164:167], v[192:195]
M v[196:199], a[44:47], a[164:167], v[196:199]
M v[196:199], a[40:43], a[160:163], v[196:199]
 ds_read_b64_tr_b16 a[156:157], v4 offset:57344
 ds_read_b64_tr_b16 a[158:159], v4 offset:58368
M v[200:203], a[48:51], a[160:163], v[200:203]
 buffer_load_dwordx4 v11, s[16:19], s21 offen offset:3072  nt lds
M v[200:203], a[52:55], a[164:167], v[200:203]
 s_add_u32 s21, s21, 128
M v[204:207], a[60:63], a[164:167], v[204:207]
M v[204:207], a[56:59], a[160:163], v[204:207]
M v[208:211], a[64:67], a[160:163], v[208:211]
M v[208:211], a[68:71], a[164:167], v[208:211]
M v[212:215], a[76:79], a[164:167], v[212:215]
M v[212:215], a[72:75], a[160:163], v[212:215]
M v[216:219], a[80:83], a[160:163], v[216:219]
M v[216:219], a[84:87], a[164:167], v[216:219]
 s_waitcnt lgkmcnt(2)
M v[220:223], a[92:95], a[164:167], v[220:223]
 s_waitcnt vmcnt(16) lgkmcnt(0)
M v[220:223], a[88:91], a[160:163], v[220:223]
 s_barrier
M v[252:255], a[88:91], a[168:171], v[252:255]
 ds_read_b128 a[160:163], v5 offset:32768
 ds_read_b128 a[164:167], v6 offset:32768
M v[252:255], a[92:95], a[172:175], v[252:255]
 buffer_load_dword a240, v24, s[32:35], 0 offen offset:1536
M v[248:251], a[84:87], a[172:175], v[248:251]
M v[248:251], a[80:83], a[168:171], v[248:251]
M v[244:247], a[72:75], a[168:171], v[244:247]
M v[244:247], a[76:79], a[172:175], v[244:247]
M v[240:243], a[68:71], a[172:175], v[240:243]
M v[240:243], a[64:67], a[168:171], v[240:243]
M v[236:239], a[56:59], a[168:171], v[236:239]
M v[236:239], a[60:63], a[172:175], v[236:239]
M v[232:235], a[52:55], a[172:175], v[232:235]
M v[232:235], a[48:51], a[168:171], v[232:235]
M v[228:231], a[40:43], a[168:171], v[228:231]
M v[228:231], a[44:47], a[172:175], v[228:231]
 s_waitcnt lgkmcnt(0)
M v[224:227], a[36:39], a[172:175], v[224:227]
M v[224:227], a[32:35], a[168:171], v[224:227]
M a[0:3], a[96:99], a[160:163], a[0:3]
 ds_read_b128 a[168:171], v5 offset:34816
 ds_read_b128 a[172:175], v6 offset:34816
M a[0:3], a[100:103], a[164:167], a[0:3]
 ds_read_b64_tr_b16 a[32:33], v1 offset:0
 ds_read_b64_tr_b16 a[34:35], v1 offset:1024
M a[4:7], a[108:111], a[164:167], a[4:7]
 s_add_u32 m0, s24, 16384
M a[4:7], a[104:107], a[160:163], a[4:7]
 buffer_load_dwordx4 v12, s[48:51], s22 offen offset:0   lds
M a[8:11], a[112:115], a[160:163], a[8:11]
M a[8:11], a[116:119], a[164:167], a[8:11]
M a[12:15], a[124:127], a[164:167], a[12:15]
 ds_read_b64_tr_b16 a[36:37], v1 offset:8192
 ds_read_b64_tr_b16 a[38:39], v1 offset:9216
M a[12:15], a[120:123], a[160:163], a[12:15]
M a[16:19], a[128:131], a[160:163], a[16:19]
 buffer_load_dwordx4 v13, s[48:51], s22 offen offset:1024   lds
M a[16:19], a[132:135], a[164:167], a[16:19]
M a[20:23], a[140:143], a[164:167], a[20:23]
M a[20:23], a[136:139], a[160:163], a[20:23]
 ds_read_b64_tr_b16 a[40:41], v2 offset:0
 ds_read_b64_tr_b16 a[42:43], v2 offset:1024
M a[24:27], a[144:147], a[160:163], a[24:27]
M a[24:27], a[148:151], a[164:167], a[24:27]
 s_waitcnt lgkmcnt(6)
M a[28:31], a[156:159], a[164:167], a[28:31]
 buffer_load_dwordx4 v14, s[48:51], s22 offen offset:2048   lds
M a[28:31], a[152:155], a[160:163], a[28:31]
M v[60:63], a[152:155], a[168:171], v[60:63]
 ds_read_b128 a[160:163], v5 offset:36864
 ds_read_b128 a[164:167], v6 offset:36864
M v[60:63], a[156:159], a[172:175], v[60:63]
 ds_read_b64_tr_b16 a[44:45], v2 offset:8192
 ds_read_b64_tr_b16 a[46:47], v2 offset:9216
M v[56:59], a[148:151], a[172:175], v[56:59]
 buffer_load_dwordx4 v15, s[48:51], s22 offen offset:3072   lds
M v[56:59], a[144:147], a[168:171], v[56:59]
 s_sub_u32 s22, s22, 2097024
M v[52:55], a[136:139], a[168:171], v[52:55]
M v[52:55], a[140:143], a[172:175], v[52:55]
 ds_read_b64_tr_b16 a[48:49], v3 offset:0
 ds_read_b64_tr_b16 a[50:51], v3 offset:1024
M v[48:51], a[132:135], a[172:175], v[48:51]
 s_add_u32 m0, s23, 49152
M v[48:51], a[128:131], a[168:171], v[48:51]
 buffer_load_dwordx4 v8, s[16:19], s21 offen offset:0  nt lds
M v[44:47], a[120:123], a[168:171], v[44:47]
M v[44:47], a[124:127], a[172:175], v[44:47]
M v[40:43], a[116:119], a[172:175], v[40:43]
 ds_read_b64_tr_b16 a[52:53], v3 offset:8192
 ds_read_b64_tr_b16 a[54:55], v3 offset:9216
M v[40:43], a[112:115], a[168:171], v[40:43]
M v[36:39], a[104:107], a[168:171], v[36:39]
 buffer_load_dwordx4 v9, s[16:19], s21 offen offset:1024  nt lds
M v[36:39], a[108:111], a[172:175], v[36:39]
 s_waitcnt lgkmcnt(6)
M v[32:35], a[100:103], a[172:175], v[32:35]
M v[32:35], a[96:99], a[168:171], v[32:35]
 ds_read_b64_tr_b16 a[56:57], v4 offset:0
 ds_read_b64_tr_b16 a[58:59], v4 offset:1024
M v[64:67], a[96:99], a[160:163], v[64:67]
 ds_read_b128 a[168:171], v5 offset:38912
 ds_read_b128 a[172:175], v6 offset:38912
M v[64:67], a[100:103], a[164:167], v[64:67]
 buffer_load_dwordx4 v10, s[16:19], s21 offen offset:2048  nt lds
M v[68:71], a[108:111], a[164:167], v[68:71]
M v[68:71], a[104:107], a[160:163], v[68:71]
M v[72:75], a[112:115], a[160:163], v[72:75]
 ds_read_b64_tr_b16 a[60:61], v4 offset:8192
 ds_read_b64_tr_b16 a[62:63], v4 offset:9216
M v[72:75], a[116:119], a[164:167], v[72:75]
M v[76:79], a[124:127], a[164:167], v[76:79]
 buffer_load_dwordx4 v11, s[16:19], s21 offen offset:3072  nt lds
M v[76:79], a[120:123], a[160:163], v[76:79]
 s_add_u32 s21, s21, 524160
M v[80:83], a[128:131], a[160:163], v[80:83]
M v[80:83], a[132:135], a[164:167], v[80:83]
M v[84:87], a[140:143], a[164:167], v[84:87]
M v[84:87], a[136:139], a[160:163], v[84:87]
M v[88:91], a[144:147], a[160:163], v[88:91]
M v[88:91], a[148:151], a[164:167], v[88:91]
 s_waitcnt lgkmcnt(2)
M v[92:95], a[156:159], a[164:167], v[92:95]
 s_waitcnt vmcnt(17) lgkmcnt(0)
M v[92:95], a[152:155], a[160:163], v[92:95]
 s_barrier
M v[124:127], a[152:155], a[168:171], v[124:127]
 ds_read_b128 a[160:163], v5 offset:49152
 ds_read_b128 a[164:167], v6 offset:49152
M v[124:127], a[156:159], a[172:175], v[124:127]
M v[120:123], a[148:151], a[172:175], v[120:123]
 s_add_u32 m0, s24, 32768
 ds_read_b64_tr_b16 a[64:65], v1 offset:16384
 ds_read_b64_tr_b16 a[66:67], v1 offset:17408
M v[120:123], a[144:147], a[168:171], v[120:123]
 buffer_load_dwordx4 v12, s[48:51], s22 offen offset:0   lds
M v[116:119], a[136:139], a[168:171], v[116:119]
M v[116:119], a[140:143], a[172:175], v[116:119]
M v[112:115], a[132:135], a[172:175], v[112:115]
M v[112:115], a[128:131], a[168:171], v[112:115]
M v[108:111], a[120:123], a[168:171], v[108:111]
M v[108:111], a[124:127], a[172:175], v[108:111]
 ds_read_b64_tr_b16 a[68:69], v1 offset:24576
 ds_read_b64_tr_b16 a[70:71], v1 offset:25600
M v[104:107], a[116:119], a[172:175], v[104:107]
 buffer_load_dwordx4 v13, s[48:51], s22 offen offset:1024   lds
M v[104:107], a[112:115], a[168:171], v[104:107]
M v[100:103], a[104:107], a[168:171], v[100:103]
 s_and_b32 s64, s42, 7
 s_lshl_b32 s64, s64, 2
M v[100:103], a[108:111], a[172:175], v[100:103]
 s_waitcnt lgkmcnt(4)
 s_add_u32 s64, s64, s20
M v[96:99], a[100:103], a[172:175], v[96:99]
 s_mul_i32 s64, s64, 114688
 v_bfe_u32 v28, v0, 2, 2
 v_and_b32 v29, 3, v0
M v[96:99], a[96:99], a[168:171], v[96:99]
 v_lshlrev_b32 v29, 7, v29
 v_lshl_add_u32 v28, v28, 13, v29
M v[128:131], a[96:99], a[160:163], v[128:131]
 ds_read_b128 a[168:171], v5 offset:51200
 ds_read_b128 a[172:175], v6 offset:51200
M v[128:131], a[100:103], a[164:167], v[128:131]
 ds_read_b64_tr_b16 a[72:73], v2 offset:16384
 ds_read_b64_tr_b16 a[74:75], v2 offset:17408
M v[132:135], a[108:111], a[164:167], v[132:135]
 buffer_load_dwordx4 v14, s[48:51], s22 offen offset:2048   lds
M v[132:135], a[104:107], a[160:163], v[132:135]
 v_add_u32 v23, s64, v28
 v_and_b32 v28, 48, v0
M v[136:139], a[112:115], a[160:163], v[136:139]
 v_lshl_add_u32 v23, v28, 24, v23
M v[136:139], a[116:119], a[164:167], v[136:139]
M v[140:143], a[124:127], a[164:167], v[140:143]
M v[140:143], a[120:123], a[160:163], v[140:143]
 ds_read_b64_tr_b16 a[76:77], v2 offset:24576
 ds_read_b64_tr_b16 a[78:79], v2 offset:25600
M v[144:147], a[128:131], a[160:163], v[144:147]
 buffer_load_dwordx4 v15, s[48:51], s22 offen offset:3072   lds
M v[144:147], a[132:135], a[164:167], v[144:147]
 s_add_u32 s22, s22, 2097152
M v[148:151], a[140:143], a[164:167], v[148:151]
M v[148:151], a[136:139], a[160:163], v[148:151]
M v[152:155], a[144:147], a[160:163], v[152:155]
M v[152:155], a[148:151], a[164:167], v[152:155]
 s_waitcnt lgkmcnt(4)
M v[156:159], a[156:159], a[164:167], v[156:159]
 s_add_u32 m0, s23, 0
 ds_read_b64_tr_b16 a[80:81], v3 offset:16384
 ds_read_b64_tr_b16 a[82:83], v3 offset:17408
M v[156:159], a[152:155], a[160:163], v[156:159]
 buffer_load_dwordx4 v8, s[16:19], s21 offen offset:0  nt lds
M v[188:191], a[152:155], a[168:171], v[188:191]
 ds_read_b128 a[160:163], v5 offset:53248
 ds_read_b128 a[164:167], v6 offset:53248
M v[188:191], a[156:159], a[172:175], v[188:191]
M v[184:187], a[148:151], a[172:175], v[184:187]
M v[184:187], a[144:147], a[168:171], v[184:187]
M v[180:183], a[136:139], a[168:171], v[180:183]
M v[180:183], a[140:143], a[172:175], v[180:183]
 ds_read_b64_tr_b16 a[84:85], v3 offset:24576
 ds_read_b64_tr_b16 a[86:87], v3 offset:25600
M v[176:179], a[132:135], a[172:175], v[176:179]
 buffer_load_dwordx4 v9, s[16:19], s21 offen offset:1024  nt lds
M v[176:179], a[128:131], a[168:171], v[176:179]
M v[172:175], a[120:123], a[168:171], v[172:175]
M v[172:175], a[124:127], a[172:175], v[172:175]
M v[168:171], a[116:119], a[172:175], v[168:171]
M v[168:171], a[112:115], a[168:171], v[168:171]
M v[164:167], a[104:107], a[168:171], v[164:167]
 ds_read_b64_tr_b16 a[88:89], v4 offset:16384
 ds_read_b64_tr_b16 a[90:91], v4 offset:17408
M v[164:167], a[108:111], a[172:175], v[164:167]
 s_waitcnt lgkmcnt(4)
M v[160:163], a[100:103], a[172:175], v[160:163]
 buffer_load_dwordx4 v10, s[16:19], s21 offen offset:2048  nt lds
M v[160:163], a[96:99], a[168:171], v[160:163]
M v[192:195], a[96:99], a[160:163], v[192:195]
 ds_read_b128 a[168:171], v5 offset:55296
 ds_read_b128 a[172:175], v6 offset:55296
M v[192:195], a[100:103], a[164:167], v[192:195]
M v[196:199], a[108:111], a[164:167], v[196:199]
M v[196:199], a[104:107], a[160:163], v[196:199]
 ds_read_b64_tr_b16 a[92:93], v4 offset:24576
 ds_read_b64_tr_b16 a[94:95], v4 offset:25600
M v[200:203], a[112:115], a[160:163], v[200:203]
 buffer_load_dwordx4 v11, s[16:19], s21 offen offset:3072  nt lds
M v[200:203], a[116:119], a[164:167], v[200:203]
 s_add_u32 s21, s21, 128
M v[204:207], a[124:127], a[164:167], v[204:207]
M v[204:207], a[120:123], a[160:163], v[204:207]
M v[208:211], a[128:131], a[160:163], v[208:211]
M v[208:211], a[132:135], a[164:167], v[208:211]
M v[212:215], a[140:143], a[164:167], v[212:215]
M v[212:215], a[136:139], a[160:163], v[212:215]
M v[216:219], a[144:147], a[160:163], v[216:219]
M v[216:219], a[148:151], a[164:167], v[216:219]
 s_waitcnt lgkmcnt(2)
M v[220:223], a[156:159], a[164:167], v[220:223]
 s_waitcnt vmcnt(17) lgkmcnt(0)
M v[220:223], a[152:155], a[160:163], v[220:223]
 s_barrier
M v[252:255], a[152:155], a[168:171], v[252:255]
 ds_read_b128 a[160:163], v5 offset:0
 ds_read_b128 a[164:167], v6 offset:0
M v[252:255], a[156:159], a[172:175], v[252:255]
 buffer_load_dword a240, v23, s[52:55], 0 offen offset:0
M v[248:251], a[148:151], a[172:175], v[248:251]
 v_add_u32 v23, 32768, v23
M v[248:251], a[144:147], a[168:171], v[248:251]
M v[244:247], a[136:139], a[168:171], v[244:247]
M v[244:247], a[140:143], a[172:175], v[244:247]
M v[240:243], a[132:135], a[172:175], v[240:243]
M v[240:243], a[128:131], a[168:171], v[240:243]
M v[236:239], a[120:123], a[168:171], v[236:239]
M v[236:239], a[124:127], a[172:175], v[236:239]
M v[232:235], a[116:119], a[172:175], v[232:235]
M v[232:235], a[112:115], a[168:171], v[232:235]
M v[228:231], a[104:107], a[168:171], v[228:231]
M v[228:231], a[108:111], a[172:175], v[228:231]
 s_waitcnt lgkmcnt(0)
M v[224:227], a[100:103], a[172:175], v[224:227]
M v[224:227], a[96:99], a[168:171], v[224:227]
M a[0:3], a[32:35], a[160:163], a[0:3]
 ds_read_b128 a[168:171], v5 offset:2048
 ds_read_b128 a[172:175], v6 offset:2048
M a[0:3], a[36:39], a[164:167], a[0:3]
 ds_read_b64_tr_b16 a[96:97], v1 offset:32768
 ds_read_b64_tr_b16 a[98:99], v1 offset:33792
M a[4:7], a[44:47], a[164:167], a[4:7]
 s_add_u32 m0, s24, 49152
M a[4:7], a[40:43], a[160:163], a[4:7]
 buffer_load_dwordx4 v12, s[48:51], s22 offen offset:0   lds
M a[8:11], a[48:51], a[160:163], a[8:11]
M a[8:11], a[52:55], a[164:167], a[8:11]
M a[12:15], a[60:63], a[164:167], a[12:15]
 ds_read_b64_tr_b16 a[100:101], v1 offset:40960
 ds_read_b64_tr_b16 a[102:103], v1 offset:41984
M a[12:15], a[56:59], a[160:163], a[12:15]
M a[16:19], a[64:67], a[160:163], a[16:19]
 buffer_load_dwordx4 v13, s[48:51], s22 offen offset:1024   lds
M a[16:19], a[68:71], a[164:167], a[16:19]
M a[20:23], a[76:79], a[164:167], a[20:23]
M a[20:23], a[72:75], a[160:163], a[20:23]
 ds_read_b64_tr_b16 a[104:105], v2 offset:32768
 ds_read_b64_tr_b16 a[106:107], v2 offset:33792
M a[24:27], a[80:83], a[160:163], a[24:27]
M a[24:27], a[84:87], a[164:167], a[24:27]
 s_waitcnt lgkmcnt(6)
M a[28:31], a[92:95], a[164:167], a[28:31]
 buffer_load_dwordx4 v14, s[48:51], s22 offen offset:2048   lds
M a[28:31], a[88:91], a[160:163], a[28:31]
M v[60:63], a[88:91], a[168:171], v[60:63]
 ds_read_b128 a[160:163], v5 offset:4096
 ds_read_b128 a[164:167], v6 offset:4096
M v[60:63], a[92:95], a[172:175], v[60:63]
 ds_read_b64_tr_b16 a[108:109], v2 offset:40960
 ds_read_b64_tr_b16 a[110:111], v2 offset:41984
M v[56:59], a[84:87], a[172:175], v[56:59]
 buffer_load_dwordx4 v15, s[48:51], s22 offen offset:3072   lds
M v[56:59], a[80:83], a[168:171], v[56:59]
 s_sub_u32 s22, s22, 2097024
M v[52:55], a[72:75], a[168:171], v[52:55]
M v[52:55], a[76:79], a[172:175], v[52:55]
 ds_read_b64_tr_b16 a[112:113], v3 offset:32768
 ds_read_b64_tr_b16 a[114:115], v3 offset:33792
M v[48:51], a[68:71], a[172:175], v[48:51]
 s_add_u32 m0, s23, 16384
M v[48:51], a[64:67], a[168:171], v[48:51]
 buffer_load_dwordx4 v8, s[16:19], s21 offen offset:0  nt lds
M v[44:47], a[56:59], a[168:171], v[44:47]
M v[44:47], a[60:63], a[172:175], v[44:47]
M v[40:43], a[52:55], a[172:175], v[40:43]
 ds_read_b64_tr_b16 a[116:117], v3 offset:40960
 ds_read_b64_tr_b16 a[118:119], v3 offset:41984
M v[40:43], a[48:51], a[168:171], v[40:43]
M v[36:39], a[40:43], a[168:171], v[36:39]
 buffer_load_dwordx4 v9, s[16:19], s21 offen offset:1024  nt lds
M v[36:39], a[44:47], a[172:175], v[36:39]
 s_waitcnt lgkmcnt(6)
M v[32:35], a[36:39], a[172:175], v[32:35]
M v[32:35], a[32:35], a[168:171], v[32:35]
 ds_read_b64_tr_b16 a[120:121], v4 offset:32768
 ds_read_b64_tr_b16 a[122:123], v4 offset:33792
M v[64:67], a[32:35], a[160:163], v[64:67]
 ds_read_b128 a[168:171], v5 offset:6144
 ds_read_b128 a[172:175], v6 offset:6144
M v[64:67], a[36:39], a[164:167], v[64:67]
 buffer_load_dwordx4 v10, s[16:19], s21 offen offset:2048  nt lds
M v[68:71], a[44:47], a[164:167], v[68:71]
M v[68:71], a[40:43], a[160:163], v[68:71]
M v[72:75], a[48:51], a[160:163], v[72:75]
 ds_read_b64_tr_b16 a[124:125], v4 offset:40960
 ds_read_b64_tr_b16 a[126:127], v4 offset:41984
M v[72:75], a[52:55], a[164:167], v[72:75]
M v[76:79], a[60:63], a[164:167], v[76:79]
 buffer_load_dwordx4 v11, s[16:19], s21 offen offset:3072  nt lds
M v[76:79], a[56:59], a[160:163], v[76:79]
 s_add_u32 s21, s21, 524160
M v[80:83], a[64:67], a[160:163], v[80:83]
M v[80:83], a[68:71], a[164:167], v[80:83]
M v[84:87], a[76:79], a[164:167], v[84:87]
M v[84:87], a[72:75], a[160:163], v[84:87]
M v[88:91], a[80:83], a[160:163], v[88:91]
M v[88:91], a[84:87], a[164:167], v[88:91]
 s_waitcnt lgkmcnt(2)
M v[92:95], a[92:95], a[164:167], v[92:95]
 s_waitcnt vmcnt(17) lgkmcnt(0)
M v[92:95], a[88:91], a[160:163], v[92:95]
 s_barrier
M v[124:127], a[88:91], a[168:171], v[124:127]
 ds_read_b128 a[160:163], v5 offset:16384
 ds_read_b128 a[164:167], v6 offset:16384
M v[124:127], a[92:95], a[172:175], v[124:127]
M v[120:123], a[84:87], a[172:175], v[120:123]
 s_add_u32 m0, s24, 0
 ds_read_b64_tr_b16 a[128:129], v1 offset:49152
 ds_read_b64_tr_b16 a[130:131], v1 offset:50176
M v[120:123], a[80:83], a[168:171], v[120:123]
 buffer_load_dwordx4 v12, s[48:51], s22 offen offset:0   lds
M v[116:119], a[72:75], a[168:171], v[116:119]
M v[116:119], a[76:79], a[172:175], v[116:119]
M v[112:115], a[68:71], a[172:175], v[112:115]
M v[112:115], a[64:67], a[168:171], v[112:115]
M v[108:111], a[56:59], a[168:171], v[108:111]
M v[108:111], a[60:63], a[172:175], v[108:111]
 ds_read_b64_tr_b16 a[132:133], v1 offset:57344
 ds_read_b64_tr_b16 a[134:135], v1 offset:58368
M v[104:107], a[52:55], a[172:175], v[104:107]
 buffer_load_dwordx4 v13, s[48:51], s22 offen offset:1024   lds
M v[104:107], a[48:51], a[168:171], v[104:107]
M v[100:103], a[40:43], a[168:171], v[100:103]
M v[100:103], a[44:47], a[172:175], v[100:103]
 s_waitcnt lgkmcnt(4)
M v[96:99], a[36:39], a[172:175], v[96:99]
M v[96:99], a[32:35], a[168:171], v[96:99]
M v[128:131], a[32:35], a[160:163], v[128:131]
 ds_read_b128 a[168:171], v5 offset:18432
 ds_read_b128 a[172:175], v6 offset:18432
M v[128:131], a[36:39], a[164:167], v[128:131]
 ds_read_b64_tr_b16 a[136:137], v2 offset:49152
 ds_read_b64_tr_b16 a[138:139], v2 offset:50176
M v[132:135], a[44:47], a[164:167], v[132:135]
 buffer_load_dwordx4 v14, s[48:51], s22 offen offset:2048   lds
M v[132:135], a[40:43], a[160:163], v[132:135]
M v[136:139], a[48:51], a[160:163], v[136:139]
M v[136:139], a[52:55], a[164:167], v[136:139]
M v[140:143], a[60:63], a[164:167], v[140:143]
M v[140:143], a[56:59], a[160:163], v[140:143]
 ds_read_b64_tr_b16 a[140:141], v2 offset:57344
 ds_read_b64_tr_b16 a[142:143], v2 offset:58368
M v[144:147], a[64:67], a[160:163], v[144:147]
 buffer_load_dwordx4 v15, s[48:51], s22 offen offset:3072   lds
M v[144:147], a[68:71], a[164:167], v[144:147]
 s_add_u32 s22, s22, 2097152
M v[148:151], a[76:79], a[164:167], v[148:151]
M v[148:151], a[72:75], a[160:163], v[148:151]
M v[152:155], a[80:83], a[160:163], v[152:155]
M v[152:155], a[84:87], a[164:167], v[152:155]
 s_waitcnt lgkmcnt(4)
M v[156:159], a[92:95], a[164:167], v[156:159]
 s_add_u32 m0, s23, 32768
 ds_read_b64_tr_b16 a[144:145], v3 offset:49152
 ds_read_b64_tr_b16 a[146:147], v3 offset:50176
M v[156:159], a[88:91], a[160:163], v[156:159]
 buffer_load_dwordx4 v8, s[16:19], s21 offen offset:0  nt lds
M v[188:191], a[88:91], a[168:171], v[188:191]
 ds_read_b128 a[160:163], v5 offset:20480
 ds_read_b128 a[164:167], v6 offset:20480
M v[188:191], a[92:95], a[172:175], v[188:191]
M v[184:187], a[84:87], a[172:175], v[184:187]
M v[184:187], a[80:83], a[168:171], v[184:187]
M v[180:183], a[72:75], a[168:171], v[180:183]
M v[180:183], a[76:79], a[172:175], v[180:183]
 ds_read_b64_tr_b16 a[148:149], v3 offset:57344
 ds_read_b64_tr_b16 a[150:151], v3 offset:58368
M v[176:179], a[68:71], a[172:175], v[176:179]
 buffer_load_dwordx4 v9, s[16:19], s21 offen offset:1024  nt lds
M v[176:179], a[64:67], a[168:171], v[176:179]
M v[172:175], a[56:59], a[168:171], v[172:175]
M v[172:175], a[60:63], a[172:175], v[172:175]
M v[168:171], a[52:55], a[172:175], v[168:171]
M v[168:171], a[48:51], a[168:171], v[168:171]
M v[164:167], a[40:43], a[168:171], v[164:167]
 ds_read_b64_tr_b16 a[152:153], v4 offset:49152
 ds_read_b64_tr_b16 a[154:155], v4 offset:50176
M v[164:167], a[44:47], a[172:175], v[164:167]
 s_waitcnt lgkmcnt(4)
M v[160:163], a[36:39], a[172:175], v[160:163]
 buffer_load_dwordx4 v10, s[16:19], s21 offen offset:2048  nt lds
M v[160:163], a[32:35], a[168:171], v[160:163]
M v[192:195], a[32:35], a[160:163], v[192:195]
 ds_read_b128 a[168:171], v5 offset:22528
 ds_read_b128 a[172:175], v6 offset:22528
M v[192:195], a[36:39], a[164:167], v[192:195]
M v[196:199], a[44:47], a[164:167], v[196:199]
M v[196:199], a[40:43], a[160:163], v[196:199]
 ds_read_b64_tr_b16 a[156:157], v4 offset:57344
 ds_read_b64_tr_b16 a[158:159], v4 offset:58368
M v[200:203], a[48:51], a[160:163], v[200:203]
 buffer_load_dwordx4 v11, s[16:19], s21 offen offset:3072  nt lds
M v[200:203], a[52:55], a[164:167], v[200:203]
 s_add_u32 s21, s21, 128
M v[204:207], a[60:63], a[164:167], v[204:207]
M v[204:207], a[56:59], a[160:163], v[204:207]
M v[208:211], a[64:67], a[160:163], v[208:211]
M v[208:211], a[68:71], a[164:167], v[208:211]
M v[212:215], a[76:79], a[164:167], v[212:215]
M v[212:215], a[72:75], a[160:163], v[212:215]
M v[216:219], a[80:83], a[160:163], v[216:219]
M v[216:219], a[84:87], a[164:167], v[216:219]
 s_waitcnt lgkmcnt(2)
M v[220:223], a[92:95], a[164:167], v[220:223]
 s_waitcnt vmcnt(17) lgkmcnt(0)
M v[220:223], a[88:91], a[160:163], v[220:223]
 s_barrier
M v[252:255], a[88:91], a[168:171], v[252:255]
 ds_read_b128 a[160:163], v5 offset:32768
 ds_read_b128 a[164:167], v6 offset:32768
M v[252:255], a[92:95], a[172:175], v[252:255]
 buffer_load_dword a240, v23, s[52:55], 0 offen offset:0
M v[248:251], a[84:87], a[172:175], v[248:251]
 v_add_u32 v23, 32768, v23
M v[248:251], a[80:83], a[168:171], v[248:251]
M v[244:247], a[72:75], a[168:171], v[244:247]
M v[244:247], a[76:79], a[172:175], v[244:247]
M v[240:243], a[68:71], a[172:175], v[240:243]
M v[240:243], a[64:67], a[168:171], v[240:243]
M v[236:239], a[56:59], a[168:171], v[236:239]
M v[236:239], a[60:63], a[172:175], v[236:239]
M v[232:235], a[52:55], a[172:175], v[232:235]
M v[232:235], a[48:51], a[168:171], v[232:235]
M v[228:231], a[40:43], a[168:171], v[228:231]
M v[228:231], a[44:47], a[172:175], v[228:231]
 s_waitcnt lgkmcnt(0)
M v[224:227], a[36:39], a[172:175], v[224:227]
M v[224:227], a[32:35], a[168:171], v[224:227]
M a[0:3], a[96:99], a[160:163], a[0:3]
 ds_read_b128 a[168:171], v5 offset:34816
 ds_read_b128 a[172:175], v6 offset:34816
M a[0:3], a[100:103], a[164:167], a[0:3]
 ds_read_b64_tr_b16 a[32:33], v1 offset:0
 ds_read_b64_tr_b16 a[34:35], v1 offset:1024
M a[4:7], a[108:111], a[164:167], a[4:7]
 s_add_u32 m0, s24, 16384
M a[4:7], a[104:107], a[160:163], a[4:7]
 buffer_load_dwordx4 v12, s[48:51], s22 offen offset:0   lds
M a[8:11], a[112:115], a[160:163], a[8:11]
M a[8:11], a[116:119], a[164:167], a[8:11]
M a[12:15], a[124:127], a[164:167], a[12:15]
 ds_read_b64_tr_b16 a[36:37], v1 offset:8192
 ds_read_b64_tr_b16 a[38:39], v1 offset:9216
M a[12:15], a[120:123], a[160:163], a[12:15]
M a[16:19], a[128:131], a[160:163], a[16:19]
 buffer_load_dwordx4 v13, s[48:51], s22 offen offset:1024   lds
M a[16:19], a[132:135], a[164:167], a[16:19]
M a[20:23], a[140:143], a[164:167], a[20:23]
M a[20:23], a[136:139], a[160:163], a[20:23]
 ds_read_b64_tr_b16 a[40:41], v2 offset:0
 ds_read_b64_tr_b16 a[42:43], v2 offset:1024
M a[24:27], a[144:147], a[160:163], a[24:27]
M a[24:27], a[148:151], a[164:167], a[24:27]
 s_waitcnt lgkmcnt(6)
M a[28:31], a[156:159], a[164:167], a[28:31]
 buffer_load_dwordx4 v14, s[48:51], s22 offen offset:2048   lds
M a[28:31], a[152:155], a[160:163], a[28:31]
M v[60:63], a[152:155], a[168:171], v[60:63]
 ds_read_b128 a[160:163], v5 offset:36864
 ds_read_b128 a[164:167], v6 offset:36864
M v[60:63], a[156:159], a[172:175], v[60:63]
 ds_read_b64_tr_b16 a[44:45], v2 offset:8192
 ds_read_b64_tr_b16 a[46:47], v2 offset:9216
M v[56:59], a[148:151], a[172:175], v[56:59]
 buffer_load_dwordx4 v15, s[48:51], s22 offen offset:3072   lds
M v[56:59], a[144:147], a[168:171], v[56:59]
 s_sub_u32 s22, s22, 2097024
M v[52:55], a[136:139], a[168:171], v[52:55]
M v[52:55], a[140:143], a[172:175], v[52:55]
 ds_read_b64_tr_b16 a[48:49], v3 offset:0
 ds_read_b64_tr_b16 a[50:51], v3 offset:1024
M v[48:51], a[132:135], a[172:175], v[48:51]
 s_add_u32 m0, s23, 49152
M v[48:51], a[128:131], a[168:171], v[48:51]
 buffer_load_dwordx4 v8, s[16:19], s21 offen offset:0  nt lds
M v[44:47], a[120:123], a[168:171], v[44:47]
M v[44:47], a[124:127], a[172:175], v[44:47]
M v[40:43], a[116:119], a[172:175], v[40:43]
 ds_read_b64_tr_b16 a[52:53], v3 offset:8192
 ds_read_b64_tr_b16 a[54:55], v3 offset:9216
M v[40:43], a[112:115], a[168:171], v[40:43]
M v[36:39], a[104:107], a[168:171], v[36:39]
 buffer_load_dwordx4 v9, s[16:19], s21 offen offset:1024  nt lds
M v[36:39], a[108:111], a[172:175], v[36:39]
 s_waitcnt lgkmcnt(6)
M v[32:35], a[100:103], a[172:175], v[32:35]
M v[32:35], a[96:99], a[168:171], v[32:35]
 ds_read_b64_tr_b16 a[56:57], v4 offset:0
 ds_read_b64_tr_b16 a[58:59], v4 offset:1024
M v[64:67], a[96:99], a[160:163], v[64:67]
 ds_read_b128 a[168:171], v5 offset:38912
 ds_read_b128 a[172:175], v6 offset:38912
M v[64:67], a[100:103], a[164:167], v[64:67]
 buffer_load_dwordx4 v10, s[16:19], s21 offen offset:2048  nt lds
M v[68:71], a[108:111], a[164:167], v[68:71]
M v[68:71], a[104:107], a[160:163], v[68:71]
M v[72:75], a[112:115], a[160:163], v[72:75]
 ds_read_b64_tr_b16 a[60:61], v4 offset:8192
 ds_read_b64_tr_b16 a[62:63], v4 offset:9216
M v[72:75], a[116:119], a[164:167], v[72:75]
M v[76:79], a[124:127], a[164:167], v[76:79]
 buffer_load_dwordx4 v11, s[16:19], s21 offen offset:3072  nt lds
M v[76:79], a[120:123], a[160:163], v[76:79]
 s_add_u32 s21, s21, 524160
M v[80:83], a[128:131], a[160:163], v[80:83]
M v[80:83], a[132:135], a[164:167], v[80:83]
M v[84:87], a[140:143], a[164:167], v[84:87]
M v[84:87], a[136:139], a[160:163], v[84:87]
M v[88:91], a[144:147], a[160:163], v[88:91]
M v[88:91], a[148:151], a[164:167], v[88:91]
 s_waitcnt lgkmcnt(2)
M v[92:95], a[156:159], a[164:167], v[92:95]
 s_waitcnt vmcnt(17) lgkmcnt(0)
M v[92:95], a[152:155], a[160:163], v[92:95]
 s_barrier
M v[124:127], a[152:155], a[168:171], v[124:127]
 ds_read_b128 a[160:163], v5 offset:49152
 ds_read_b128 a[164:167], v6 offset:49152
M v[124:127], a[156:159], a[172:175], v[124:127]
M v[120:123], a[148:151], a[172:175], v[120:123]
 s_add_u32 m0, s24, 32768
 ds_read_b64_tr_b16 a[64:65], v1 offset:16384
 ds_read_b64_tr_b16 a[66:67], v1 offset:17408
M v[120:123], a[144:147], a[168:171], v[120:123]
 buffer_load_dwordx4 v12, s[48:51], s22 offen offset:0   lds
M v[116:119], a[136:139], a[168:171], v[116:119]
M v[116:119], a[140:143], a[172:175], v[116:119]
M v[112:115], a[132:135], a[172:175], v[112:115]
M v[112:115], a[128:131], a[168:171], v[112:115]
M v[108:111], a[120:123], a[168:171], v[108:111]
M v[108:111], a[124:127], a[172:175], v[108:111]
 ds_read_b64_tr_b16 a[68:69], v1 offset:24576
 ds_read_b64_tr_b16 a[70:71], v1 offset:25600
M v[104:107], a[116:119], a[172:175], v[104:107]
 buffer_load_dwordx4 v13, s[48:51], s22 offen offset:1024   lds
M v[104:107], a[112:115], a[168:171], v[104:107]
M v[100:103], a[104:107], a[168:171], v[100:103]
M v[100:103], a[108:111], a[172:175], v[100:103]
 s_waitcnt lgkmcnt(4)
M v[96:99], a[100:103], a[172:175], v[96:99]
M v[96:99], a[96:99], a[168:171], v[96:99]
M v[128:131], a[96:99], a[160:163], v[128:131]
 ds_read_b128 a[168:171], v5 offset:51200
 ds_read_b128 a[172:175], v6 offset:51200
M v[128:131], a[100:103], a[164:167], v[128:131]
 ds_read_b64_tr_b16 a[72:73], v2 offset:16384
 ds_read_b64_tr_b16 a[74:75], v2 offset:17408
M v[132:135], a[108:111], a[164:167], v[132:135]
 buffer_load_dwordx4 v14, s[48:51], s22 offen offset:2048   lds
M v[132:135], a[104:107], a[160:163], v[132:135]
M v[136:139], a[112:115], a[160:163], v[136:139]
M v[136:139], a[116:119], a[164:167], v[136:139]
M v[140:143], a[124:127], a[164:167], v[140:143]
M v[140:143], a[120:123], a[160:163], v[140:143]
 ds_read_b64_tr_b16 a[76:77], v2 offset:24576
 ds_read_b64_tr_b16 a[78:79], v2 offset:25600
M v[144:147], a[128:131], a[160:163], v[144:147]
 buffer_load_dwordx4 v15, s[48:51], s22 offen offset:3072   lds
M v[144:147], a[132:135], a[164:167], v[144:147]
 s_add_u32 s22, s22, 2097152
M v[148:151], a[140:143], a[164:167], v[148:151]
M v[148:151], a[136:139], a[160:163], v[148:151]
M v[152:155], a[144:147], a[160:163], v[152:155]
M v[152:155], a[148:151], a[164:167], v[152:155]
 s_waitcnt lgkmcnt(4)
M v[156:159], a[156:159], a[164:167], v[156:159]
 s_add_u32 m0, s23, 0
 ds_read_b64_tr_b16 a[80:81], v3 offset:16384
 ds_read_b64_tr_b16 a[82:83], v3 offset:17408
M v[156:159], a[152:155], a[160:163], v[156:159]
 buffer_load_dwordx4 v8, s[16:19], s21 offen offset:0  nt lds
M v[188:191], a[152:155], a[168:171], v[188:191]
 ds_read_b128 a[160:163], v5 offset:53248
 ds_read_b128 a[164:167], v6 offset:53248
M v[188:191], a[156:159], a[172:175], v[188:191]
M v[184:187], a[148:151], a[172:175], v[184:187]
M v[184:187], a[144:147], a[168:171], v[184:187]
M v[180:183], a[136:139], a[168:171], v[180:183]
M v[180:183], a[140:143], a[172:175], v[180:183]
 ds_read_b64_tr_b16 a[84:85], v3 offset:24576
 ds_read_b64_tr_b16 a[86:87], v3 offset:25600
M v[176:179], a[132:135], a[172:175], v[176:179]
 buffer_load_dwordx4 v9, s[16:19], s21 offen offset:1024  nt lds
M v[176:179], a[128:131], a[168:171], v[176:179]
M v[172:175], a[120:123], a[168:171], v[172:175]
M v[172:175], a[124:127], a[172:175], v[172:175]
M v[168:171], a[116:119], a[172:175], v[168:171]
M v[168:171], a[112:115], a[168:171], v[168:171]
M v[164:167], a[104:107], a[168:171], v[164:167]
 ds_read_b64_tr_b16 a[88:89], v4 offset:16384
 ds_read_b64_tr_b16 a[90:91], v4 offset:17408
M v[164:167], a[108:111], a[172:175], v[164:167]
 s_waitcnt lgkmcnt(4)
M v[160:163], a[100:103], a[172:175], v[160:163]
 buffer_load_dwordx4 v10, s[16:19], s21 offen offset:2048  nt lds
M v[160:163], a[96:99], a[168:171], v[160:163]
M v[192:195], a[96:99], a[160:163], v[192:195]
 ds_read_b128 a[168:171], v5 offset:55296
 ds_read_b128 a[172:175], v6 offset:55296
M v[192:195], a[100:103], a[164:167], v[192:195]
M v[196:199], a[108:111], a[164:167], v[196:199]
M v[196:199], a[104:107], a[160:163], v[196:199]
 ds_read_b64_tr_b16 a[92:93], v4 offset:24576
 ds_read_b64_tr_b16 a[94:95], v4 offset:25600
M v[200:203], a[112:115], a[160:163], v[200:203]
 buffer_load_dwordx4 v11, s[16:19], s21 offen offset:3072  nt lds
M v[200:203], a[116:119], a[164:167], v[200:203]
 s_add_u32 s21, s21, 128
M v[204:207], a[124:127], a[164:167], v[204:207]
M v[204:207], a[120:123], a[160:163], v[204:207]
M v[208:211], a[128:131], a[160:163], v[208:211]
M v[208:211], a[132:135], a[164:167], v[208:211]
M v[212:215], a[140:143], a[164:167], v[212:215]
M v[212:215], a[136:139], a[160:163], v[212:215]
M v[216:219], a[144:147], a[160:163], v[216:219]
M v[216:219], a[148:151], a[164:167], v[216:219]
 s_waitcnt lgkmcnt(2)
M v[220:223], a[156:159], a[164:167], v[220:223]
 s_waitcnt vmcnt(17) lgkmcnt(0)
M v[220:223], a[152:155], a[160:163], v[220:223]
 s_barrier
M v[252:255], a[152:155], a[168:171], v[252:255]
 ds_read_b128 a[160:163], v5 offset:0
 ds_read_b128 a[164:167], v6 offset:0
M v[252:255], a[156:159], a[172:175], v[252:255]
 buffer_load_dword a240, v23, s[52:55], 0 offen offset:0
M v[248:251], a[148:151], a[172:175], v[248:251]
 v_add_u32 v23, 16384, v23
M v[248:251], a[144:147], a[168:171], v[248:251]
M v[244:247], a[136:139], a[168:171], v[244:247]
M v[244:247], a[140:143], a[172:175], v[244:247]
M v[240:243], a[132:135], a[172:175], v[240:243]
M v[240:243], a[128:131], a[168:171], v[240:243]
M v[236:239], a[120:123], a[168:171], v[236:239]
M v[236:239], a[124:127], a[172:175], v[236:239]
M v[232:235], a[116:119], a[172:175], v[232:235]
M v[232:235], a[112:115], a[168:171], v[232:235]
M v[228:231], a[104:107], a[168:171], v[228:231]
M v[228:231], a[108:111], a[172:175], v[228:231]
 s_waitcnt lgkmcnt(0)
M v[224:227], a[100:103], a[172:175], v[224:227]
M v[224:227], a[96:99], a[168:171], v[224:227]
M a[0:3], a[32:35], a[160:163], a[0:3]
 ds_read_b128 a[168:171], v5 offset:2048
 ds_read_b128 a[172:175], v6 offset:2048
M a[0:3], a[36:39], a[164:167], a[0:3]
 ds_read_b64_tr_b16 a[96:97], v1 offset:32768
 ds_read_b64_tr_b16 a[98:99], v1 offset:33792
M a[4:7], a[44:47], a[164:167], a[4:7]
 s_add_u32 m0, s24, 49152
 v_accvgpr_read_b32 v27, a241
M a[4:7], a[40:43], a[160:163], a[4:7]
 buffer_load_dwordx4 v12, s[48:51], s22 offen offset:0   lds
M a[8:11], a[48:51], a[160:163], a[8:11]
M a[8:11], a[52:55], a[164:167], a[8:11]
M a[12:15], a[60:63], a[164:167], a[12:15]
 ds_read_b64_tr_b16 a[100:101], v1 offset:40960
 ds_read_b64_tr_b16 a[102:103], v1 offset:41984
M a[12:15], a[56:59], a[160:163], a[12:15]
M a[16:19], a[64:67], a[160:163], a[16:19]
 buffer_load_dwordx4 v13, s[48:51], s22 offen offset:1024   lds
M a[16:19], a[68:71], a[164:167], a[16:19]
M a[20:23], a[76:79], a[164:167], a[20:23]
M a[20:23], a[72:75], a[160:163], a[20:23]
 ds_read_b64_tr_b16 a[104:105], v2 offset:32768
 ds_read_b64_tr_b16 a[106:107], v2 offset:33792
M a[24:27], a[80:83], a[160:163], a[24:27]
M a[24:27], a[84:87], a[164:167], a[24:27]
 s_waitcnt lgkmcnt(6)
M a[28:31], a[92:95], a[164:167], a[28:31]
 buffer_load_dwordx4 v14, s[48:51], s22 offen offset:2048   lds
M a[28:31], a[88:91], a[160:163], a[28:31]
M v[60:63], a[88:91], a[168:171], v[60:63]
 ds_read_b128 a[160:163], v5 offset:4096
 ds_read_b128 a[164:167], v6 offset:4096
M v[60:63], a[92:95], a[172:175], v[60:63]
 ds_read_b64_tr_b16 a[108:109], v2 offset:40960
 ds_read_b64_tr_b16 a[110:111], v2 offset:41984
M v[56:59], a[84:87], a[172:175], v[56:59]
 buffer_load_dwordx4 v15, s[48:51], s22 offen offset:3072   lds
M v[56:59], a[80:83], a[168:171], v[56:59]
 s_sub_u32 s22, s22, 2097024
M v[52:55], a[72:75], a[168:171], v[52:55]
M v[52:55], a[76:79], a[172:175], v[52:55]
 ds_read_b64_tr_b16 a[112:113], v3 offset:32768
 ds_read_b64_tr_b16 a[114:115], v3 offset:33792
M v[48:51], a[68:71], a[172:175], v[48:51]
 s_add_u32 m0, s23, 16384
M v[48:51], a[64:67], a[168:171], v[48:51]
 buffer_load_dwordx4 v8, s[16:19], s21 offen offset:0  nt lds
M v[44:47], a[56:59], a[168:171], v[44:47]
M v[44:47], a[60:63], a[172:175], v[44:47]
M v[40:43], a[52:55], a[172:175], v[40:43]
 ds_read_b64_tr_b16 a[116:117], v3 offset:40960
 ds_read_b64_tr_b16 a[118:119], v3 offset:41984
M v[40:43], a[48:51], a[168:171], v[40:43]
M v[36:39], a[40:43], a[168:171], v[36:39]
 buffer_load_dwordx4 v9, s[16:19], s21 offen offset:1024  nt lds
M v[36:39], a[44:47], a[172:175], v[36:39]
 s_waitcnt lgkmcnt(6)
M v[32:35], a[36:39], a[172:175], v[32:35]
M v[32:35], a[32:35], a[168:171], v[32:35]
 ds_read_b64_tr_b16 a[120:121], v4 offset:32768
 ds_read_b64_tr_b16 a[122:123], v4 offset:33792
M v[64:67], a[32:35], a[160:163], v[64:67]
 ds_read_b128 a[168:171], v5 offset:6144
 ds_read_b128 a[172:175], v6 offset:6144
M v[64:67], a[36:39], a[164:167], v[64:67]
 buffer_load_dwordx4 v10, s[16:19], s21 offen offset:2048  nt lds
M v[68:71], a[44:47], a[164:167], v[68:71]
M v[68:71], a[40:43], a[160:163], v[68:71]
M v[72:75], a[48:51], a[160:163], v[72:75]
 ds_read_b64_tr_b16 a[124:125], v4 offset:40960
 ds_read_b64_tr_b16 a[126:127], v4 offset:41984
M v[72:75], a[52:55], a[164:167], v[72:75]
 v_sub_f32 v48, v48, v27
 v_sub_f32 v49, v49, v27
M v[76:79], a[60:63], a[164:167], v[76:79]
 buffer_load_dwordx4 v11, s[16:19], s21 offen offset:3072  nt lds
M v[76:79], a[56:59], a[160:163], v[76:79]
 s_add_u32 s21, s21, 524160
 v_sub_f32 v50, v50, v27
 v_sub_f32 v51, v51, v27
M v[80:83], a[64:67], a[160:163], v[80:83]
 v_sub_f32 v52, v52, v27
 v_sub_f32 v53, v53, v27
M v[80:83], a[68:71], a[164:167], v[80:83]
 v_sub_f32 v54, v54, v27
 v_sub_f32 v55, v55, v27
M v[84:87], a[76:79], a[164:167], v[84:87]
 v_sub_f32 v56, v56, v27
 v_sub_f32 v57, v57, v27
M v[84:87], a[72:75], a[160:163], v[84:87]
 v_sub_f32 v58, v58, v27
 v_sub_f32 v59, v59, v27
M v[88:91], a[80:83], a[160:163], v[88:91]
 v_sub_f32 v60, v60, v27
 v_sub_f32 v61, v61, v27
M v[88:91], a[84:87], a[164:167], v[88:91]
 s_waitcnt lgkmcnt(2)
 v_sub_f32 v62, v62, v27
 v_sub_f32 v63, v63, v27
M v[92:95], a[92:95], a[164:167], v[92:95]
 s_waitcnt vmcnt(17) lgkmcnt(0)
M v[92:95], a[88:91], a[160:163], v[92:95]
 s_barrier
M v[124:127], a[88:91], a[168:171], v[124:127]
 ds_read_b128 a[160:163], v5 offset:16384
 ds_read_b128 a[164:167], v6 offset:16384
M v[124:127], a[92:95], a[172:175], v[124:127]
M v[120:123], a[84:87], a[172:175], v[120:123]
 s_add_u32 m0, s24, 0
 ds_read_b64_tr_b16 a[128:129], v1 offset:49152
 ds_read_b64_tr_b16 a[130:131], v1 offset:50176
M v[120:123], a[80:83], a[168:171], v[120:123]
 buffer_load_dwordx4 v12, s[48:51], s22 offen offset:0   lds
M v[116:119], a[72:75], a[168:171], v[116:119]
 v_sub_f32 v80, v80, v27
 v_sub_f32 v81, v81, v27
M v[116:119], a[76:79], a[172:175], v[116:119]
 v_sub_f32 v82, v82, v27
 v_sub_f32 v83, v83, v27
M v[112:115], a[68:71], a[172:175], v[112:115]
 v_sub_f32 v84, v84, v27
 v_sub_f32 v85, v85, v27
M v[112:115], a[64:67], a[168:171], v[112:115]
 v_sub_f32 v86, v86, v27
 v_sub_f32 v87, v87, v27
M v[108:111], a[56:59], a[168:171], v[108:111]
 v_sub_f32 v88, v88, v27
 v_sub_f32 v89, v89, v27
M v[108:111], a[60:63], a[172:175], v[108:111]
 ds_read_b64_tr_b16 a[132:133], v1 offset:57344
 ds_read_b64_tr_b16 a[134:135], v1 offset:58368
M v[104:107], a[52:55], a[172:175], v[104:107]
 buffer_load_dwordx4 v13, s[48:51], s22 offen offset:1024   lds
M v[104:107], a[48:51], a[168:171], v[104:107]
 v_sub_f32 v90, v90, v27
 v_sub_f32 v91, v91, v27
M v[100:103], a[40:43], a[168:171], v[100:103]
 v_sub_f32 v92, v92, v27
 v_sub_f32 v93, v93, v27
M v[100:103], a[44:47], a[172:175], v[100:103]
 s_waitcnt lgkmcnt(4)
 v_sub_f32 v94, v94, v27
 v_sub_f32 v95, v95, v27
M v[96:99], a[36:39], a[172:175], v[96:99]
M v[96:99], a[32:35], a[168:171], v[96:99]
M v[128:131], a[32:35], a[160:163], v[128:131]
 ds_read_b128 a[168:171], v5 offset:18432
 ds_read_b128 a[172:175], v6 offset:18432
M v[128:131], a[36:39], a[164:167], v[128:131]
 ds_read_b64_tr_b16 a[136:137], v2 offset:49152
 ds_read_b64_tr_b16 a[138:139], v2 offset:50176
M v[132:135], a[44:47], a[164:167], v[132:135]
 buffer_load_dwordx4 v14, s[48:51], s22 offen offset:2048   lds
M v[132:135], a[40:43], a[160:163], v[132:135]
M v[136:139], a[48:51], a[160:163], v[136:139]
 v_sub_f32 v112, v112, v27
 v_sub_f32 v113, v113, v27
M v[136:139], a[52:55], a[164:167], v[136:139]
 v_sub_f32 v114, v114, v27
 v_sub_f32 v115, v115, v27
M v[140:143], a[60:63], a[164:167], v[140:143]
 v_sub_f32 v116, v116, v27
 v_sub_f32 v117, v117, v27
M v[140:143], a[56:59], a[160:163], v[140:143]
 ds_read_b64_tr_b16 a[140:141], v2 offset:57344
 ds_read_b64_tr_b16 a[142:143], v2 offset:58368
M v[144:147], a[64:67], a[160:163], v[144:147]
 buffer_load_dwordx4 v15, s[48:51], s22 offen offset:3072   lds
M v[144:147], a[68:71], a[164:167], v[144:147]
 s_add_u32 s22, s22, 2097152
 v_sub_f32 v118, v118, v27
 v_sub_f32 v119, v119, v27
M v[148:151], a[76:79], a[164:167], v[148:151]
 v_sub_f32 v120, v120, v27
 v_sub_f32 v121, v121, v27
M v[148:151], a[72:75], a[160:163], v[148:151]
 v_sub_f32 v122, v122, v27
 v_sub_f32 v123, v123, v27
M v[152:155], a[80:83], a[160:163], v[152:155]
 v_sub_f32 v124, v124, v27
 v_sub_f32 v125, v125, v27
M v[152:155], a[84:87], a[164:167], v[152:155]
 s_waitcnt lgkmcnt(4)
 v_sub_f32 v126, v126, v27
 v_sub_f32 v127, v127, v27
M v[156:159], a[92:95], a[164:167], v[156:159]
 s_add_u32 m0, s23, 32768
 ds_read_b64_tr_b16 a[144:145], v3 offset:49152
 ds_read_b64_tr_b16 a[146:147], v3 offset:50176
M v[156:159], a[88:91], a[160:163], v[156:159]
 buffer_load_dwordx4 v8, s[16:19], s21 offen offset:0  nt lds
M v[188:191], a[88:91], a[168:171], v[188:191]
 ds_read_b128 a[160:163], v5 offset:20480
 ds_read_b128 a[164:167], v6 offset:20480
M v[188:191], a[92:95], a[172:175], v[188:191]
M v[184:187], a[84:87], a[172:175], v[184:187]
M v[184:187], a[80:83], a[168:171], v[184:187]
M v[180:183], a[72:75], a[168:171], v[180:183]
 v_sub_f32 v128, v128, v27
 v_sub_f32 v129, v129, v27
M v[180:183], a[76:79], a[172:175], v[180:183]
 ds_read_b64_tr_b16 a[148:149], v3 offset:57344
 ds_read_b64_tr_b16 a[150:151], v3 offset:58368
M v[176:179], a[68:71], a[172:175], v[176:179]
 buffer_load_dwordx4 v9, s[16:19], s21 offen offset:1024  nt lds
M v[176:179], a[64:67], a[168:171], v[176:179]
 v_sub_f32 v130, v130, v27
 v_sub_f32 v131, v131, v27
M v[172:175], a[56:59], a[168:171], v[172:175]
 v_sub_f32 v132, v132, v27
 v_sub_f32 v133, v133, v27
M v[172:175], a[60:63], a[172:175], v[172:175]
 v_sub_f32 v134, v134, v27
 v_sub_f32 v135, v135, v27
M v[168:171], a[52:55], a[172:175], v[168:171]
 v_sub_f32 v136, v136, v27
 v_sub_f32 v137, v137, v27
M v[168:171], a[48:51], a[168:171], v[168:171]
 v_sub_f32 v138, v138, v27
 v_sub_f32 v139, v139, v27
M v[164:167], a[40:43], a[168:171], v[164:167]
 ds_read_b64_tr_b16 a[152:153], v4 offset:49152
 ds_read_b64_tr_b16 a[154:155], v4 offset:50176
M v[164:167], a[44:47], a[172:175], v[164:167]
 s_waitcnt lgkmcnt(4)
 v_sub_f32 v140, v140, v27
 v_sub_f32 v141, v141, v27
M v[160:163], a[36:39], a[172:175], v[160:163]
 buffer_load_dwordx4 v10, s[16:19], s21 offen offset:2048  nt lds
M v[160:163], a[32:35], a[168:171], v[160:163]
 v_sub_f32 v142, v142, v27
 v_sub_f32 v143, v143, v27
M v[192:195], a[32:35], a[160:163], v[192:195]
 ds_read_b128 a[168:171], v5 offset:22528
 ds_read_b128 a[172:175], v6 offset:22528
M v[192:195], a[36:39], a[164:167], v[192:195]
 v_sub_f32 v144, v144, v27
 v_sub_f32 v145, v145, v27
M v[196:199], a[44:47], a[164:167], v[196:199]
 v_sub_f32 v146, v146, v27
 v_sub_f32 v147, v147, v27
M v[196:199], a[40:43], a[160:163], v[196:199]
 ds_read_b64_tr_b16 a[156:157], v4 offset:57344
 ds_read_b64_tr_b16 a[158:159], v4 offset:58368
M v[200:203], a[48:51], a[160:163], v[200:203]
 buffer_load_dwordx4 v11, s[16:19], s21 offen offset:3072  nt lds
M v[200:203], a[52:55], a[164:167], v[200:203]
 s_add_u32 s21, s21, 128
 v_sub_f32 v148, v148, v27
 v_sub_f32 v149, v149, v27
M v[204:207], a[60:63], a[164:167], v[204:207]
 v_sub_f32 v150, v150, v27
 v_sub_f32 v151, v151, v27
M v[204:207], a[56:59], a[160:163], v[204:207]
 v_sub_f32 v152, v152, v27
 v_sub_f32 v153, v153, v27
M v[208:211], a[64:67], a[160:163], v[208:211]
 v_sub_f32 v154, v154, v27
 v_sub_f32 v155, v155, v27
M v[208:211], a[68:71], a[164:167], v[208:211]
 v_sub_f32 v156, v156, v27
 v_sub_f32 v157, v157, v27
M v[212:215], a[76:79], a[164:167], v[212:215]
 v_sub_f32 v158, v158, v27
 v_sub_f32 v159, v159, v27
M v[212:215], a[72:75], a[160:163], v[212:215]
M v[216:219], a[80:83], a[160:163], v[216:219]
M v[216:219], a[84:87], a[164:167], v[216:219]
 s_waitcnt lgkmcnt(2)
M v[220:223], a[92:95], a[164:167], v[220:223]
 s_waitcnt vmcnt(17) lgkmcnt(0)
M v[220:223], a[88:91], a[160:163], v[220:223]
 s_barrier
M v[252:255], a[88:91], a[168:171], v[252:255]
 ds_read_b128 a[160:163], v5 offset:32768
 ds_read_b128 a[164:167], v6 offset:32768
M v[252:255], a[92:95], a[172:175], v[252:255]
 buffer_load_dword a240, v23, s[52:55], 0 offen offset:0
M v[248:251], a[84:87], a[172:175], v[248:251]
 v_add_u32 v23, 16384, v23
M v[248:251], a[80:83], a[168:171], v[248:251]
M v[244:247], a[72:75], a[168:171], v[244:247]
M v[244:247], a[76:79], a[172:175], v[244:247]
M v[240:243], a[68:71], a[172:175], v[240:243]
M v[240:243], a[64:67], a[168:171], v[240:243]
M v[236:239], a[56:59], a[168:171], v[236:239]
M v[236:239], a[60:63], a[172:175], v[236:239]
M v[232:235], a[52:55], a[172:175], v[232:235]
M v[232:235], a[48:51], a[168:171], v[232:235]
M v[228:231], a[40:43], a[168:171], v[228:231]
M v[228:231], a[44:47], a[172:175], v[228:231]
 s_waitcnt lgkmcnt(0)
M v[224:227], a[36:39], a[172:175], v[224:227]
M v[224:227], a[32:35], a[168:171], v[224:227]
M a[0:3], a[96:99], a[160:163], a[0:3]
 ds_read_b128 a[168:171], v5 offset:34816
 ds_read_b128 a[172:175], v6 offset:34816
M a[0:3], a[100:103], a[164:167], a[0:3]
 ds_read_b64_tr_b16 a[32:33], v1 offset:0
 ds_read_b64_tr_b16 a[34:35], v1 offset:1024
M a[4:7], a[108:111], a[164:167], a[4:7]
 s_add_u32 m0, s24, 16384
M a[4:7], a[104:107], a[160:163], a[4:7]
 buffer_load_dwordx4 v12, s[48:51], s22 offen offset:0   lds
M a[8:11], a[112:115], a[160:163], a[8:11]
M a[8:11], a[116:119], a[164:167], a[8:11]
M a[12:15], a[124:127], a[164:167], a[12:15]
 ds_read_b64_tr_b16 a[36:37], v1 offset:8192
 ds_read_b64_tr_b16 a[38:39], v1 offset:9216
M a[12:15], a[120:123], a[160:163], a[12:15]
M a[16:19], a[128:131], a[160:163], a[16:19]
 buffer_load_dwordx4 v13, s[48:51], s22 offen offset:1024   lds
M a[16:19], a[132:135], a[164:167], a[16:19]
M a[20:23], a[140:143], a[164:167], a[20:23]
M a[20:23], a[136:139], a[160:163], a[20:23]
 ds_read_b64_tr_b16 a[40:41], v2 offset:0
 ds_read_b64_tr_b16 a[42:43], v2 offset:1024
M a[24:27], a[144:147], a[160:163], a[24:27]
M a[24:27], a[148:151], a[164:167], a[24:27]
 s_waitcnt lgkmcnt(6)
M a[28:31], a[156:159], a[164:167], a[28:31]
 buffer_load_dwordx4 v14, s[48:51], s22 offen offset:2048   lds
M a[28:31], a[152:155], a[160:163], a[28:31]
M v[60:63], a[152:155], a[168:171], v[60:63]
 ds_read_b128 a[160:163], v5 offset:36864
 ds_read_b128 a[164:167], v6 offset:36864
M v[60:63], a[156:159], a[172:175], v[60:63]
 ds_read_b64_tr_b16 a[44:45], v2 offset:8192
 ds_read_b64_tr_b16 a[46:47], v2 offset:9216
M v[56:59], a[148:151], a[172:175], v[56:59]
 buffer_load_dwordx4 v15, s[48:51], s22 offen offset:3072   lds
M v[56:59], a[144:147], a[168:171], v[56:59]
 s_sub_u32 s22, s22, 2097024
M v[52:55], a[136:139], a[168:171], v[52:55]
M v[52:55], a[140:143], a[172:175], v[52:55]
 ds_read_b64_tr_b16 a[48:49], v3 offset:0
 ds_read_b64_tr_b16 a[50:51], v3 offset:1024
M v[48:51], a[132:135], a[172:175], v[48:51]
 s_add_u32 m0, s23, 49152
M v[48:51], a[128:131], a[168:171], v[48:51]
 buffer_load_dwordx4 v8, s[16:19], s21 offen offset:0  nt lds
M v[44:47], a[120:123], a[168:171], v[44:47]
M v[44:47], a[124:127], a[172:175], v[44:47]
M v[40:43], a[116:119], a[172:175], v[40:43]
 ds_read_b64_tr_b16 a[52:53], v3 offset:8192
 ds_read_b64_tr_b16 a[54:55], v3 offset:9216
M v[40:43], a[112:115], a[168:171], v[40:43]
M v[36:39], a[104:107], a[168:171], v[36:39]
 buffer_load_dwordx4 v9, s[16:19], s21 offen offset:1024  nt lds
M v[36:39], a[108:111], a[172:175], v[36:39]
 s_waitcnt lgkmcnt(6)
M v[32:35], a[100:103], a[172:175], v[32:35]
M v[32:35], a[96:99], a[168:171], v[32:35]
 ds_read_b64_tr_b16 a[56:57], v4 offset:0
 ds_read_b64_tr_b16 a[58:59], v4 offset:1024
M v[64:67], a[96:99], a[160:163], v[64:67]
 ds_read_b128 a[168:171], v5 offset:38912
 ds_read_b128 a[172:175], v6 offset:38912
M v[64:67], a[100:103], a[164:167], v[64:67]
 buffer_load_dwordx4 v10, s[16:19], s21 offen offset:2048  nt lds
M v[68:71], a[108:111], a[164:167], v[68:71]
M v[68:71], a[104:107], a[160:163], v[68:71]
M v[72:75], a[112:115], a[160:163], v[72:75]
 ds_read_b64_tr_b16 a[60:61], v4 offset:8192
 ds_read_b64_tr_b16 a[62:63], v4 offset:9216
M v[72:75], a[116:119], a[164:167], v[72:75]
M v[76:79], a[124:127], a[164:167], v[76:79]
 buffer_load_dwordx4 v11, s[16:19], s21 offen offset:3072  nt lds
M v[76:79], a[120:123], a[160:163], v[76:79]
 s_add_u32 s21, s21, 524160
M v[80:83], a[128:131], a[160:163], v[80:83]
M v[80:83], a[132:135], a[164:167], v[80:83]
M v[84:87], a[140:143], a[164:167], v[84:87]
M v[84:87], a[136:139], a[160:163], v[84:87]
M v[88:91], a[144:147], a[160:163], v[88:91]
M v[88:91], a[148:151], a[164:167], v[88:91]
 s_waitcnt lgkmcnt(2)
M v[92:95], a[156:159], a[164:167], v[92:95]
 s_waitcnt vmcnt(17) lgkmcnt(0)
M v[92:95], a[152:155], a[160:163], v[92:95]
 s_barrier
M v[124:127], a[152:155], a[168:171], v[124:127]
 ds_read_b128 a[160:163], v5 offset:49152
 ds_read_b128 a[164:167], v6 offset:49152
M v[124:127], a[156:159], a[172:175], v[124:127]
M v[120:123], a[148:151], a[172:175], v[120:123]
 s_add_u32 m0, s24, 32768
 ds_read_b64_tr_b16 a[64:65], v1 offset:16384
 ds_read_b64_tr_b16 a[66:67], v1 offset:17408
M v[120:123], a[144:147], a[168:171], v[120:123]
 buffer_load_dwordx4 v12, s[48:51], s22 offen offset:0   lds
M v[116:119], a[136:139], a[168:171], v[116:119]
M v[116:119], a[140:143], a[172:175], v[116:119]
M v[112:115], a[132:135], a[172:175], v[112:115]
M v[112:115], a[128:131], a[168:171], v[112:115]
M v[108:111], a[120:123], a[168:171], v[108:111]
M v[108:111], a[124:127], a[172:175], v[108:111]
 ds_read_b64_tr_b16 a[68:69], v1 offset:24576
 ds_read_b64_tr_b16 a[70:71], v1 offset:25600
M v[104:107], a[116:119], a[172:175], v[104:107]
 buffer_load_dwordx4 v13, s[48:51], s22 offen offset:1024   lds
M v[104:107], a[112:115], a[168:171], v[104:107]
M v[100:103], a[104:107], a[168:171], v[100:103]
M v[100:103], a[108:111], a[172:175], v[100:103]
 s_waitcnt lgkmcnt(4)
M v[96:99], a[100:103], a[172:175], v[96:99]
M v[96:99], a[96:99], a[168:171], v[96:99]
M v[128:131], a[96:99], a[160:163], v[128:131]
 ds_read_b128 a[168:171], v5 offset:51200
 ds_read_b128 a[172:175], v6 offset:51200
M v[128:131], a[100:103], a[164:167], v[128:131]
 ds_read_b64_tr_b16 a[72:73], v2 offset:16384
 ds_read_b64_tr_b16 a[74:75], v2 offset:17408
M v[132:135], a[108:111], a[164:167], v[132:135]
 buffer_load_dwordx4 v14, s[48:51], s22 offen offset:2048   lds
M v[132:135], a[104:107], a[160:163], v[132:135]
M v[136:139], a[112:115], a[160:163], v[136:139]
M v[136:139], a[116:119], a[164:167], v[136:139]
M v[140:143], a[124:127], a[164:167], v[140:143]
M v[140:143], a[120:123], a[160:163], v[140:143]
 ds_read_b64_tr_b16 a[76:77], v2 offset:24576
 ds_read_b64_tr_b16 a[78:79], v2 offset:25600
M v[144:147], a[128:131], a[160:163], v[144:147]
 buffer_load_dwordx4 v15, s[48:51], s22 offen offset:3072   lds
M v[144:147], a[132:135], a[164:167], v[144:147]
 s_add_u32 s22, s22, 2097152
M v[148:151], a[140:143], a[164:167], v[148:151]
M v[148:151], a[136:139], a[160:163], v[148:151]
M v[152:155], a[144:147], a[160:163], v[152:155]
M v[152:155], a[148:151], a[164:167], v[152:155]
 s_waitcnt lgkmcnt(4)
M v[156:159], a[156:159], a[164:167], v[156:159]
 s_add_u32 m0, s23, 0
 ds_read_b64_tr_b16 a[80:81], v3 offset:16384
 ds_read_b64_tr_b16 a[82:83], v3 offset:17408
M v[156:159], a[152:155], a[160:163], v[156:159]
 buffer_load_dwordx4 v8, s[52:55], s28 offen offset:0   lds
M v[188:191], a[152:155], a[168:171], v[188:191]
 ds_read_b128 a[160:163], v5 offset:53248
 ds_read_b128 a[164:167], v6 offset:53248
M v[188:191], a[156:159], a[172:175], v[188:191]
M v[184:187], a[148:151], a[172:175], v[184:187]
M v[184:187], a[144:147], a[168:171], v[184:187]
M v[180:183], a[136:139], a[168:171], v[180:183]
M v[180:183], a[140:143], a[172:175], v[180:183]
 ds_read_b64_tr_b16 a[84:85], v3 offset:24576
 ds_read_b64_tr_b16 a[86:87], v3 offset:25600
M v[176:179], a[132:135], a[172:175], v[176:179]
 buffer_load_dwordx4 v9, s[52:55], s28 offen offset:1024   lds
M v[176:179], a[128:131], a[168:171], v[176:179]
M v[172:175], a[120:123], a[168:171], v[172:175]
M v[172:175], a[124:127], a[172:175], v[172:175]
M v[168:171], a[116:119], a[172:175], v[168:171]
M v[168:171], a[112:115], a[168:171], v[168:171]
M v[164:167], a[104:107], a[168:171], v[164:167]
 ds_read_b64_tr_b16 a[88:89], v4 offset:16384
 ds_read_b64_tr_b16 a[90:91], v4 offset:17408
M v[164:167], a[108:111], a[172:175], v[164:167]
 s_waitcnt lgkmcnt(4)
M v[160:163], a[100:103], a[172:175], v[160:163]
 buffer_load_dwordx4 v10, s[52:55], s28 offen offset:2048   lds
M v[160:163], a[96:99], a[168:171], v[160:163]
M v[192:195], a[96:99], a[160:163], v[192:195]
 ds_read_b128 a[168:171], v5 offset:55296
 ds_read_b128 a[172:175], v6 offset:55296
M v[192:195], a[100:103], a[164:167], v[192:195]
M v[196:199], a[108:111], a[164:167], v[196:199]
M v[196:199], a[104:107], a[160:163], v[196:199]
 ds_read_b64_tr_b16 a[92:93], v4 offset:24576
 ds_read_b64_tr_b16 a[94:95], v4 offset:25600
M v[200:203], a[112:115], a[160:163], v[200:203]
 buffer_load_dwordx4 v11, s[52:55], s28 offen offset:3072   lds
M v[200:203], a[116:119], a[164:167], v[200:203]
 s_add_u32 s28, s28, 128
 v_sub_f32 v160, v160, v27
 v_sub_f32 v161, v161, v27
M v[204:207], a[124:127], a[164:167], v[204:207]
 v_sub_f32 v162, v162, v27
 v_sub_f32 v163, v163, v27
M v[204:207], a[120:123], a[160:163], v[204:207]
 v_sub_f32 v164, v164, v27
 v_sub_f32 v165, v165, v27
M v[208:211], a[128:131], a[160:163], v[208:211]
 v_sub_f32 v166, v166, v27
 v_sub_f32 v167, v167, v27
M v[208:211], a[132:135], a[164:167], v[208:211]
 v_sub_f32 v168, v168, v27
 v_sub_f32 v169, v169, v27
M v[212:215], a[140:143], a[164:167], v[212:215]
 v_sub_f32 v170, v170, v27
 v_sub_f32 v171, v171, v27
M v[212:215], a[136:139], a[160:163], v[212:215]
 v_sub_f32 v172, v172, v27
 v_sub_f32 v173, v173, v27
M v[216:219], a[144:147], a[160:163], v[216:219]
 v_sub_f32 v174, v174, v27
 v_sub_f32 v175, v175, v27
M v[216:219], a[148:151], a[164:167], v[216:219]
 s_waitcnt lgkmcnt(2)
 v_sub_f32 v176, v176, v27
 v_sub_f32 v177, v177, v27
M v[220:223], a[156:159], a[164:167], v[220:223]
 s_waitcnt vmcnt(17) lgkmcnt(0)
 v_sub_f32 v178, v178, v27
 v_sub_f32 v179, v179, v27
M v[220:223], a[152:155], a[160:163], v[220:223]
 s_barrier
M v[252:255], a[152:155], a[168:171], v[252:255]
 ds_read_b128 a[160:163], v5 offset:0
 ds_read_b128 a[164:167], v6 offset:0
M v[252:255], a[156:159], a[172:175], v[252:255]
 v_and_b32 v26, 48, v0
 v_lshlrev_b32 v26, 17, v26
M v[248:251], a[148:151], a[172:175], v[248:251]
 v_or_b32 v26, v26, v0
 v_lshl_add_u32 v26, v26, 7, s95
M v[248:251], a[144:147], a[168:171], v[248:251]
 buffer_load_dword a240, v26, s[76:79], 0 offen offset:0
M v[244:247], a[136:139], a[168:171], v[244:247]
 v_sub_f32 v180, v180, v27
 v_sub_f32 v181, v181, v27
M v[244:247], a[140:143], a[172:175], v[244:247]
 v_sub_f32 v182, v182, v27
 v_sub_f32 v183, v183, v27
M v[240:243], a[132:135], a[172:175], v[240:243]
 v_sub_f32 v184, v184, v27
 v_sub_f32 v185, v185, v27
M v[240:243], a[128:131], a[168:171], v[240:243]
 v_sub_f32 v186, v186, v27
 v_sub_f32 v187, v187, v27
M v[236:239], a[120:123], a[168:171], v[236:239]
 v_sub_f32 v188, v188, v27
 v_sub_f32 v189, v189, v27
M v[236:239], a[124:127], a[172:175], v[236:239]
 v_sub_f32 v190, v190, v27
 v_sub_f32 v191, v191, v27
M v[232:235], a[116:119], a[172:175], v[232:235]
 v_sub_f32 v192, v192, v27
 v_sub_f32 v193, v193, v27
M v[232:235], a[112:115], a[168:171], v[232:235]
 v_sub_f32 v194, v194, v27
 v_sub_f32 v195, v195, v27
M v[228:231], a[104:107], a[168:171], v[228:231]
 v_sub_f32 v196, v196, v27
 v_sub_f32 v197, v197, v27
M v[228:231], a[108:111], a[172:175], v[228:231]
 s_waitcnt lgkmcnt(0)
 v_sub_f32 v198, v198, v27
 v_sub_f32 v199, v199, v27
M v[224:227], a[100:103], a[172:175], v[224:227]
 v_sub_f32 v200, v200, v27
 v_sub_f32 v201, v201, v27
M v[224:227], a[96:99], a[168:171], v[224:227]
 v_sub_f32 v202, v202, v27
 v_sub_f32 v203, v203, v27
M a[0:3], a[32:35], a[160:163], a[0:3]
 ds_read_b128 a[168:171], v5 offset:2048
 ds_read_b128 a[172:175], v6 offset:2048
M a[0:3], a[36:39], a[164:167], a[0:3]
 ds_read_b64_tr_b16 a[96:97], v1 offset:32768
 ds_read_b64_tr_b16 a[98:99], v1 offset:33792
M a[4:7], a[44:47], a[164:167], a[4:7]
 s_add_u32 m0, s24, 49152
 v_lshrrev_b32 v28, 4, v0
 v_add_u32 v28, 0, v28
M a[4:7], a[40:43], a[160:163], a[4:7]
 buffer_load_dwordx4 v12, s[48:51], s22 offen offset:0   lds
M a[8:11], a[48:51], a[160:163], a[8:11]
 v_and_b32 v29, 7, v0
 v_xor_b32 v28, v28, v29
M a[8:11], a[52:55], a[164:167], a[8:11]
 v_lshlrev_b32 v28, 4, v28
 v_lshrrev_b32 v29, 3, v0
M a[12:15], a[60:63], a[164:167], a[12:15]
 ds_read_b64_tr_b16 a[100:101], v1 offset:40960
 ds_read_b64_tr_b16 a[102:103], v1 offset:41984
M a[12:15], a[56:59], a[160:163], a[12:15]
 buffer_load_dwordx4 v13, s[48:51], s22 offen offset:1024   lds
M a[16:19], a[64:67], a[160:163], a[16:19]
 v_mul_u32_u24 v29, 896, v29
 s_mul_i32 s64, s20, 28672
M a[16:19], a[68:71], a[164:167], a[16:19]
 buffer_load_dwordx4 v14, s[48:51], s22 offen offset:2048   lds
M a[20:23], a[76:79], a[164:167], a[20:23]
 s_add_u32 s64, s64, 0
 v_add3_u32 v16, v29, v28, s64
M a[20:23], a[72:75], a[160:163], a[20:23]
 ds_read_b64_tr_b16 a[104:105], v2 offset:32768
 ds_read_b64_tr_b16 a[106:107], v2 offset:33792
M a[24:27], a[80:83], a[160:163], a[24:27]
 v_add_u32 v18, 12288, v16
 v_lshrrev_b32 v28, 4, v0
M a[24:27], a[84:87], a[164:167], a[24:27]
 s_waitcnt lgkmcnt(6)
 v_add_u32 v28, 4, v28
 v_and_b32 v29, 7, v0
M a[28:31], a[92:95], a[164:167], a[28:31]
 buffer_load_dwordx4 v15, s[48:51], s22 offen offset:3072   lds
M a[28:31], a[88:91], a[160:163], a[28:31]
 s_sub_u32 s22, s22, 2097024
 v_xor_b32 v28, v28, v29
 v_lshlrev_b32 v28, 4, v28
M v[60:63], a[88:91], a[168:171], v[60:63]
 s_add_u32 m0, s23, 16384
 ds_read_b128 a[160:163], v5 offset:4096
 ds_read_b128 a[164:167], v6 offset:4096
M v[60:63], a[92:95], a[172:175], v[60:63]
 ds_read_b64_tr_b16 a[108:109], v2 offset:40960
 ds_read_b64_tr_b16 a[110:111], v2 offset:41984
M v[56:59], a[84:87], a[172:175], v[56:59]
 buffer_load_dwordx4 v8, s[52:55], s28 offen offset:0   lds
M v[56:59], a[80:83], a[168:171], v[56:59]
 v_lshrrev_b32 v29, 3, v0
 v_mul_u32_u24 v29, 896, v29
M v[52:55], a[72:75], a[168:171], v[52:55]
 buffer_load_dwordx4 v9, s[52:55], s28 offen offset:1024   lds
M v[52:55], a[76:79], a[172:175], v[52:55]
 ds_read_b64_tr_b16 a[112:113], v3 offset:32768
 ds_read_b64_tr_b16 a[114:115], v3 offset:33792
M v[48:51], a[68:71], a[172:175], v[48:51]
 s_mul_i32 s64, s20, 28672
 s_add_u32 s64, s64, 6144
M v[48:51], a[64:67], a[168:171], v[48:51]
 buffer_load_dwordx4 v10, s[52:55], s28 offen offset:2048   lds
M v[44:47], a[56:59], a[168:171], v[44:47]
 v_add3_u32 v17, v29, v28, s64
 v_add_u32 v19, 12288, v17
M v[44:47], a[60:63], a[172:175], v[44:47]
 v_add_u32 v20, 0x20000, v1
 v_add_u32 v21, 0x20000, v2
M v[40:43], a[52:55], a[172:175], v[40:43]
 ds_read_b64_tr_b16 a[116:117], v3 offset:40960
 ds_read_b64_tr_b16 a[118:119], v3 offset:41984
M v[40:43], a[48:51], a[168:171], v[40:43]
 buffer_load_dwordx4 v11, s[52:55], s28 offen offset:3072   lds
M v[36:39], a[40:43], a[168:171], v[36:39]
 s_add_u32 s28, s28, 1048448
 v_add_u32 v22, 0x20000, v3
 v_add_u32 v23, 0x20000, v4
M v[36:39], a[44:47], a[172:175], v[36:39]
 s_waitcnt lgkmcnt(6)
 v_sub_f32 v204, v204, v27
 v_sub_f32 v205, v205, v27
M v[32:35], a[36:39], a[172:175], v[32:35]
 s_add_u32 m0, s23, 131072
 v_sub_f32 v206, v206, v27
 v_sub_f32 v207, v207, v27
M v[32:35], a[32:35], a[168:171], v[32:35]
 ds_read_b64_tr_b16 a[120:121], v4 offset:32768
 ds_read_b64_tr_b16 a[122:123], v4 offset:33792
M v[64:67], a[32:35], a[160:163], v[64:67]
 ds_read_b128 a[168:171], v5 offset:6144
 ds_read_b128 a[172:175], v6 offset:6144
M v[64:67], a[36:39], a[164:167], v[64:67]
 buffer_load_dwordx4 v8, s[52:55], s28 offen offset:0   lds
M v[68:71], a[44:47], a[164:167], v[68:71]
 buffer_load_dwordx4 v9, s[52:55], s28 offen offset:1024   lds
M v[68:71], a[40:43], a[160:163], v[68:71]
 v_sub_f32 v208, v208, v27
 v_sub_f32 v209, v209, v27
M v[72:75], a[48:51], a[160:163], v[72:75]
 ds_read_b64_tr_b16 a[124:125], v4 offset:40960
 ds_read_b64_tr_b16 a[126:127], v4 offset:41984
M v[72:75], a[52:55], a[164:167], v[72:75]
 buffer_load_dwordx4 v10, s[52:55], s28 offen offset:2048   lds
M v[76:79], a[60:63], a[164:167], v[76:79]
 v_sub_f32 v210, v210, v27
 v_sub_f32 v211, v211, v27
M v[76:79], a[56:59], a[160:163], v[76:79]
 v_sub_f32 v212, v212, v27
 v_sub_f32 v213, v213, v27
M v[80:83], a[64:67], a[160:163], v[80:83]
 buffer_load_dwordx4 v11, s[52:55], s28 offen offset:3072   lds
M v[80:83], a[68:71], a[164:167], v[80:83]
 s_sub_u32 s28, s28, 524288
 v_sub_f32 v214, v214, v27
 v_sub_f32 v215, v215, v27
M v[84:87], a[76:79], a[164:167], v[84:87]
 v_sub_f32 v216, v216, v27
 v_sub_f32 v217, v217, v27
M v[84:87], a[72:75], a[160:163], v[84:87]
 v_sub_f32 v218, v218, v27
 v_sub_f32 v219, v219, v27
M v[88:91], a[80:83], a[160:163], v[88:91]
 v_sub_f32 v220, v220, v27
 v_sub_f32 v221, v221, v27
M v[88:91], a[84:87], a[164:167], v[88:91]
 s_waitcnt lgkmcnt(2)
 v_sub_f32 v222, v222, v27
 v_sub_f32 v223, v223, v27
M v[92:95], a[92:95], a[164:167], v[92:95]
 s_waitcnt vmcnt(21) lgkmcnt(0)
 v_sub_f32 v224, v224, v27
 v_sub_f32 v225, v225, v27
M v[92:95], a[88:91], a[160:163], v[92:95]
 s_barrier
M v[124:127], a[88:91], a[168:171], v[124:127]
 ds_read_b128 a[160:163], v5 offset:16384
 ds_read_b128 a[164:167], v6 offset:16384
M v[124:127], a[92:95], a[172:175], v[124:127]
 v_sub_f32 v226, v226, v27
 v_sub_f32 v227, v227, v27
M v[120:123], a[84:87], a[172:175], v[120:123]
 s_add_u32 m0, s24, 0
 ds_read_b64_tr_b16 a[128:129], v1 offset:49152
 ds_read_b64_tr_b16 a[130:131], v1 offset:50176
M v[120:123], a[80:83], a[168:171], v[120:123]
 buffer_load_dwordx4 v16, s[56:59], s29 offen offset:0   lds
M v[116:119], a[72:75], a[168:171], v[116:119]
 s_mul_i32 s72, s41, 16512
 v_sub_f32 v228, v228, v27
M v[116:119], a[76:79], a[172:175], v[116:119]
 s_add_u32 s46, s72, 234946560
 v_sub_f32 v229, v229, v27
 v_sub_f32 v230, v230, v27
M v[112:115], a[68:71], a[172:175], v[112:115]
 s_and_b32 s64, s41, 7
 s_lshr_b32 s64, s101, s64
 s_and_b32 s64, s64, 1
M v[112:115], a[64:67], a[168:171], v[112:115]
 buffer_load_dwordx4 v17, s[56:59], s29 offen offset:1024   lds
M v[108:111], a[56:59], a[168:171], v[108:111]
 s_lshl_b32 s64, s64, 13
 v_sub_f32 v231, v231, v27
M v[108:111], a[60:63], a[172:175], v[108:111]
 s_add_u32 s46, s46, s64
 ds_read_b64_tr_b16 a[132:133], v1 offset:57344
 ds_read_b64_tr_b16 a[134:135], v1 offset:58368
M v[104:107], a[52:55], a[172:175], v[104:107]
 s_lshl_b32 s45, s42, 7
 v_sub_f32 v232, v232, v27
 v_sub_f32 v233, v233, v27
M v[104:107], a[48:51], a[168:171], v[104:107]
 s_add_u32 s45, s45, s46
 s_sub_u32 s66, 15, s42
 s_min_u32 s66, s66, s42
M v[100:103], a[40:43], a[168:171], v[100:103]
 buffer_load_dwordx4 v18, s[56:59], s29 offen offset:2048   lds
M v[100:103], a[44:47], a[172:175], v[100:103]
 s_waitcnt lgkmcnt(4)
 s_lshl_b32 s47, s66, 7
 v_sub_f32 v234, v234, v27
M v[96:99], a[36:39], a[172:175], v[96:99]
 s_add_u32 s47, s47, s46
 v_sub_f32 v235, v235, v27
 v_sub_f32 v236, v236, v27
M v[96:99], a[32:35], a[168:171], v[96:99]
 s_add_u32 s47, s47, 2048
 v_sub_f32 v237, v237, v27
 v_sub_f32 v238, v238, v27
M v[128:131], a[32:35], a[160:163], v[128:131]
 s_lshl2_add_u32 s47, s20, s47
 ds_read_b128 a[168:171], v5 offset:18432
 ds_read_b128 a[172:175], v6 offset:18432
M v[128:131], a[36:39], a[164:167], v[128:131]
 s_lshl_b32 s65, s27, 3
 ds_read_b64_tr_b16 a[136:137], v2 offset:49152
 ds_read_b64_tr_b16 a[138:139], v2 offset:50176
M v[132:135], a[44:47], a[164:167], v[132:135]
 buffer_load_dwordx4 v19, s[56:59], s29 offen offset:3072   lds
M v[132:135], a[40:43], a[160:163], v[132:135]
 s_add_u32 s29, s29, 128
 s_add_u32 s65, s65, s66
 v_sub_f32 v239, v239, v27
M v[136:139], a[48:51], a[160:163], v[136:139]
 s_mul_i32 s34, s65, 262144
 s_add_u32 s34, s34, 167772160
 s_lshl_b32 s65, s42, 4
M v[136:139], a[52:55], a[164:167], v[136:139]
 s_add_u32 m0, s23, 32768
 s_add_u32 s65, s65, s41
 s_mul_i32 s33, s65, 262144
M v[140:143], a[60:63], a[164:167], v[140:143]
 buffer_load_dwordx4 v8, s[52:55], s28 offen offset:0   lds
M v[140:143], a[56:59], a[160:163], v[140:143]
 ds_read_b64_tr_b16 a[140:141], v2 offset:57344
 ds_read_b64_tr_b16 a[142:143], v2 offset:58368
M v[144:147], a[64:67], a[160:163], v[144:147]
 s_mul_i32 s65, s20, 65536
 v_sub_f32 v240, v240, v27
M v[144:147], a[68:71], a[164:167], v[144:147]
 s_add_u32 s33, s33, s65
 s_add_u32 s33, s33, 67108864
 s_sub_u32 s65, 15, s66
M v[148:151], a[76:79], a[164:167], v[148:151]
 buffer_load_dwordx4 v9, s[52:55], s28 offen offset:1024   lds
M v[148:151], a[72:75], a[160:163], v[148:151]
 s_lshl_b32 s65, s65, 17
 v_sub_f32 v241, v241, v27
M v[152:155], a[80:83], a[160:163], v[152:155]
 s_lshl_b32 s64, s27, 21
 s_add_u32 s32, s64, s65
 s_lshl_b32 s65, s20, 15
M v[152:155], a[84:87], a[164:167], v[152:155]
 s_waitcnt lgkmcnt(4)
 s_add_u32 s32, s32, s65
 v_sub_f32 v242, v242, v27
M v[156:159], a[92:95], a[164:167], v[156:159]
 s_add_u32 s32, s32, 134217728
 ds_read_b64_tr_b16 a[144:145], v3 offset:49152
 ds_read_b64_tr_b16 a[146:147], v3 offset:50176
M v[156:159], a[88:91], a[160:163], v[156:159]
 buffer_load_dwordx4 v10, s[52:55], s28 offen offset:2048   lds
M v[188:191], a[88:91], a[168:171], v[188:191]
 ds_read_b128 a[160:163], v5 offset:20480
 ds_read_b128 a[164:167], v6 offset:20480
M v[188:191], a[92:95], a[172:175], v[188:191]
 s_and_b32 s64, s41, 7
 v_sub_f32 v243, v243, v27
M v[184:187], a[84:87], a[172:175], v[184:187]
 s_lshr_b32 s64, s101, s64
 v_sub_f32 v244, v244, v27
 v_sub_f32 v245, v245, v27
M v[184:187], a[80:83], a[168:171], v[184:187]
 s_lshr_b32 s65, s41, 3
 s_xor_b32 s64, s64, s65
 s_and_b32 s64, s64, 1
M v[180:183], a[72:75], a[168:171], v[180:183]
 buffer_load_dwordx4 v11, s[52:55], s28 offen offset:3072   lds
M v[180:183], a[76:79], a[172:175], v[180:183]
 s_add_u32 s28, s28, 524416
 ds_read_b64_tr_b16 a[148:149], v3 offset:57344
 ds_read_b64_tr_b16 a[150:151], v3 offset:58368
M v[176:179], a[68:71], a[172:175], v[176:179]
 s_lshl_b32 s92, s64, 13
 v_sub_f32 v246, v246, v27
M v[176:179], a[64:67], a[168:171], v[176:179]
 s_add_u32 s93, s93, s92
 s_add_u32 s34, s34, s92
 s_add_u32 s32, s32, s92
M v[172:175], a[56:59], a[168:171], v[172:175]
 s_add_u32 m0, s23, 147456
 s_lshl_b32 s64, s20, 1
 s_lshr_b32 s64, s101, s64
M v[172:175], a[60:63], a[172:175], v[172:175]
 buffer_load_dwordx4 v8, s[52:55], s28 offen offset:0   lds
M v[168:171], a[52:55], a[172:175], v[168:171]
 s_xor_b32 s64, s64, s65
 v_sub_f32 v247, v247, v27
M v[168:171], a[48:51], a[168:171], v[168:171]
 s_and_b32 s64, s64, 1
 v_sub_f32 v248, v248, v27
 v_sub_f32 v249, v249, v27
M v[164:167], a[40:43], a[168:171], v[164:167]
 s_lshl_b32 s64, s64, 13
 ds_read_b64_tr_b16 a[152:153], v4 offset:49152
 ds_read_b64_tr_b16 a[154:155], v4 offset:50176
M v[164:167], a[44:47], a[172:175], v[164:167]
 s_waitcnt lgkmcnt(4)
 s_add_u32 s33, s33, s64
 s_mov_b32 s31, 0x53800000
M v[160:163], a[36:39], a[172:175], v[160:163]
 buffer_load_dwordx4 v9, s[52:55], s28 offen offset:1024   lds
M v[160:163], a[32:35], a[168:171], v[160:163]
 s_mov_b32 s40, 1
 v_sub_f32 v250, v250, v27
M v[192:195], a[32:35], a[160:163], v[192:195]
 s_sub_u32 s64, s42, 10
 ds_read_b128 a[168:171], v5 offset:22528
 ds_read_b128 a[172:175], v6 offset:22528
M v[192:195], a[36:39], a[164:167], v[192:195]
 s_and_b32 s35, s64, 536870912
 v_sub_f32 v251, v251, v27
 v_sub_f32 v252, v252, v27
M v[196:199], a[44:47], a[164:167], v[196:199]
 buffer_load_dwordx4 v10, s[52:55], s28 offen offset:2048   lds
M v[196:199], a[40:43], a[160:163], v[196:199]
 ds_read_b64_tr_b16 a[156:157], v4 offset:57344
 ds_read_b64_tr_b16 a[158:159], v4 offset:58368
M v[200:203], a[48:51], a[160:163], v[200:203]
 v_sub_f32 v253, v253, v27
 v_sub_f32 v254, v254, v27
M v[200:203], a[52:55], a[164:167], v[200:203]
 v_sub_f32 v255, v255, v27
M v[204:207], a[60:63], a[164:167], v[204:207]
M v[204:207], a[56:59], a[160:163], v[204:207]
 buffer_load_dwordx4 v11, s[52:55], s28 offen offset:3072   lds
M v[208:211], a[64:67], a[160:163], v[208:211]
 s_sub_u32 s28, s28, 524288
M v[208:211], a[68:71], a[164:167], v[208:211]
M v[212:215], a[76:79], a[164:167], v[212:215]
M v[212:215], a[72:75], a[160:163], v[212:215]
M v[216:219], a[80:83], a[160:163], v[216:219]
M v[216:219], a[84:87], a[164:167], v[216:219]
 s_waitcnt lgkmcnt(2)
M v[220:223], a[92:95], a[164:167], v[220:223]
 s_waitcnt vmcnt(25) lgkmcnt(0)
M v[220:223], a[88:91], a[160:163], v[220:223]
 s_barrier
M v[252:255], a[88:91], a[168:171], v[252:255]
 ds_read_b128 a[160:163], v5 offset:32768
 ds_read_b128 a[164:167], v6 offset:32768
M v[252:255], a[92:95], a[172:175], v[252:255]
M v[248:251], a[84:87], a[172:175], v[248:251]
M v[248:251], a[80:83], a[168:171], v[248:251]
M v[244:247], a[72:75], a[168:171], v[244:247]
M v[244:247], a[76:79], a[172:175], v[244:247]
M v[240:243], a[68:71], a[172:175], v[240:243]
M v[240:243], a[64:67], a[168:171], v[240:243]
M v[236:239], a[56:59], a[168:171], v[236:239]
M v[236:239], a[60:63], a[172:175], v[236:239]
M v[232:235], a[52:55], a[172:175], v[232:235]
M v[232:235], a[48:51], a[168:171], v[232:235]
M v[228:231], a[40:43], a[168:171], v[228:231]
M v[228:231], a[44:47], a[172:175], v[228:231]
 s_waitcnt lgkmcnt(0)
M v[224:227], a[36:39], a[172:175], v[224:227]
M v[224:227], a[32:35], a[168:171], v[224:227]
M a[0:3], a[96:99], a[160:163], a[0:3]
 ds_read_b128 a[168:171], v5 offset:34816
 ds_read_b128 a[172:175], v6 offset:34816
M a[0:3], a[100:103], a[164:167], a[0:3]
 ds_read_b64_tr_b16 a[32:33], v1 offset:0
 ds_read_b64_tr_b16 a[34:35], v1 offset:1024
M a[4:7], a[108:111], a[164:167], a[4:7]
 s_add_u32 m0, s24, 16384
M a[4:7], a[104:107], a[160:163], a[4:7]
 buffer_load_dwordx4 v16, s[56:59], s29 offen offset:0   lds
M a[8:11], a[112:115], a[160:163], a[8:11]
M a[8:11], a[116:119], a[164:167], a[8:11]
M a[12:15], a[124:127], a[164:167], a[12:15]
 ds_read_b64_tr_b16 a[36:37], v1 offset:8192
 ds_read_b64_tr_b16 a[38:39], v1 offset:9216
M a[12:15], a[120:123], a[160:163], a[12:15]
M a[16:19], a[128:131], a[160:163], a[16:19]
 buffer_load_dwordx4 v17, s[56:59], s29 offen offset:1024   lds
M a[16:19], a[132:135], a[164:167], a[16:19]
 v_accvgpr_read_b32 v24, a0
 v_accvgpr_read_b32 v25, a1
M a[20:23], a[140:143], a[164:167], a[20:23]
 v_accvgpr_read_b32 v26, a2
 v_accvgpr_read_b32 v27, a3
M a[20:23], a[136:139], a[160:163], a[20:23]
 ds_read_b64_tr_b16 a[40:41], v2 offset:0
 ds_read_b64_tr_b16 a[42:43], v2 offset:1024
M a[24:27], a[144:147], a[160:163], a[24:27]
 v_accvgpr_read_b32 v28, a4
 v_accvgpr_read_b32 v29, a5
M a[24:27], a[148:151], a[164:167], a[24:27]
 s_waitcnt lgkmcnt(6)
 buffer_load_dwordx4 v18, s[56:59], s29 offen offset:2048   lds
M a[28:31], a[156:159], a[164:167], a[28:31]
 v_accvgpr_read_b32 v30, a6
 v_accvgpr_read_b32 v31, a7
M a[28:31], a[152:155], a[160:163], a[28:31]
 v_cvt_pk_bf16_f32 v24, v24, v25
 v_cvt_pk_bf16_f32 v25, v26, v27
M v[32:35], a[96:99], a[168:171], v[32:35]
 ds_read_b128 a[160:163], v5 offset:36864
 ds_read_b128 a[164:167], v6 offset:36864
M v[32:35], a[100:103], a[172:175], v[32:35]
 ds_read_b64_tr_b16 a[44:45], v2 offset:8192
 ds_read_b64_tr_b16 a[46:47], v2 offset:9216
M v[36:39], a[108:111], a[172:175], v[36:39]
 buffer_load_dwordx4 v19, s[56:59], s29 offen offset:3072   lds
M v[36:39], a[104:107], a[168:171], v[36:39]
 s_add_u32 s29, s29, 128
 v_cvt_pk_bf16_f32 v26, v28, v29
 v_cvt_pk_bf16_f32 v27, v30, v31
M v[40:43], a[112:115], a[168:171], v[40:43]
 s_add_u32 s3, s93, 0
 buffer_store_dwordx4 v[24:27], v7, s[8:11], s3 offen offset:0 sc1
M v[40:43], a[116:119], a[172:175], v[40:43]
 ds_read_b64_tr_b16 a[48:49], v3 offset:0
 ds_read_b64_tr_b16 a[50:51], v3 offset:1024
M v[44:47], a[124:127], a[172:175], v[44:47]
 s_add_u32 m0, s23, 49152
 v_accvgpr_read_b32 v24, a8
 v_accvgpr_read_b32 v25, a9
M v[44:47], a[120:123], a[168:171], v[44:47]
 buffer_load_dwordx4 v8, s[52:55], s28 offen offset:0   lds
M v[48:51], a[128:131], a[168:171], v[48:51]
 v_accvgpr_read_b32 v26, a10
 v_accvgpr_read_b32 v27, a11
M v[48:51], a[132:135], a[172:175], v[48:51]
 v_accvgpr_read_b32 v28, a12
 v_accvgpr_read_b32 v29, a13
M v[52:55], a[140:143], a[172:175], v[52:55]
 ds_read_b64_tr_b16 a[52:53], v3 offset:8192
 ds_read_b64_tr_b16 a[54:55], v3 offset:9216
M v[52:55], a[136:139], a[168:171], v[52:55]
 v_accvgpr_read_b32 v30, a14
 v_accvgpr_read_b32 v31, a15
M v[56:59], a[144:147], a[168:171], v[56:59]
 buffer_load_dwordx4 v9, s[52:55], s28 offen offset:1024   lds
M v[56:59], a[148:151], a[172:175], v[56:59]
 s_waitcnt lgkmcnt(6)
 v_cvt_pk_bf16_f32 v24, v24, v25
 v_cvt_pk_bf16_f32 v25, v26, v27
M v[60:63], a[156:159], a[172:175], v[60:63]
 v_cvt_pk_bf16_f32 v26, v28, v29
 v_cvt_pk_bf16_f32 v27, v30, v31
M v[60:63], a[152:155], a[168:171], v[60:63]
 ds_read_b64_tr_b16 a[56:57], v4 offset:0
 ds_read_b64_tr_b16 a[58:59], v4 offset:1024
M v[64:67], a[96:99], a[160:163], v[64:67]
 ds_read_b128 a[168:171], v5 offset:38912
 ds_read_b128 a[172:175], v6 offset:38912
M v[64:67], a[100:103], a[164:167], v[64:67]
 buffer_load_dwordx4 v10, s[52:55], s28 offen offset:2048   lds
M v[68:71], a[108:111], a[164:167], v[68:71]
M v[68:71], a[104:107], a[160:163], v[68:71]
 buffer_store_dwordx4 v[24:27], v7, s[8:11], s3 offen offset:1024 sc1
M v[72:75], a[112:115], a[160:163], v[72:75]
 ds_read_b64_tr_b16 a[60:61], v4 offset:8192
 ds_read_b64_tr_b16 a[62:63], v4 offset:9216
M v[72:75], a[116:119], a[164:167], v[72:75]
 v_accvgpr_read_b32 v24, a16
 v_accvgpr_read_b32 v25, a17
M v[76:79], a[124:127], a[164:167], v[76:79]
 buffer_load_dwordx4 v11, s[52:55], s28 offen offset:3072   lds
M v[76:79], a[120:123], a[160:163], v[76:79]
 s_add_u32 s28, s28, 1048448
 v_accvgpr_read_b32 v26, a18
 v_accvgpr_read_b32 v27, a19
M v[80:83], a[128:131], a[160:163], v[80:83]
 v_accvgpr_read_b32 v28, a20
 v_accvgpr_read_b32 v29, a21
M v[80:83], a[132:135], a[164:167], v[80:83]
 v_accvgpr_read_b32 v30, a22
 v_accvgpr_read_b32 v31, a23
M v[84:87], a[140:143], a[164:167], v[84:87]
 v_cvt_pk_bf16_f32 v24, v24, v25
 v_cvt_pk_bf16_f32 v25, v26, v27
M v[84:87], a[136:139], a[160:163], v[84:87]
 v_cvt_pk_bf16_f32 v26, v28, v29
 v_cvt_pk_bf16_f32 v27, v30, v31
M v[88:91], a[144:147], a[160:163], v[88:91]
 buffer_store_dwordx4 v[24:27], v7, s[8:11], s3 offen offset:2048 sc1
M v[88:91], a[148:151], a[164:167], v[88:91]
 s_waitcnt lgkmcnt(2)
 v_accvgpr_read_b32 v24, a24
 v_accvgpr_read_b32 v25, a25
M v[92:95], a[156:159], a[164:167], v[92:95]
 s_waitcnt vmcnt(27) lgkmcnt(0)
 v_accvgpr_read_b32 v26, a26
 v_accvgpr_read_b32 v27, a27
M v[92:95], a[152:155], a[160:163], v[92:95]
 s_barrier
M v[96:99], a[96:99], a[168:171], v[96:99]
 ds_read_b128 a[160:163], v5 offset:49152
 ds_read_b128 a[164:167], v6 offset:49152
M v[96:99], a[100:103], a[172:175], v[96:99]
 v_accvgpr_read_b32 v28, a28
 v_accvgpr_read_b32 v29, a29
M v[100:103], a[108:111], a[172:175], v[100:103]
 s_add_u32 m0, s24, 32768
 ds_read_b64_tr_b16 a[64:65], v1 offset:16384
 ds_read_b64_tr_b16 a[66:67], v1 offset:17408
M v[100:103], a[104:107], a[168:171], v[100:103]
 buffer_load_dwordx4 v16, s[56:59], s29 offen offset:0   lds
M v[104:107], a[112:115], a[168:171], v[104:107]
 v_accvgpr_read_b32 v30, a30
 v_accvgpr_read_b32 v31, a31
M v[104:107], a[116:119], a[172:175], v[104:107]
 v_cvt_pk_bf16_f32 v24, v24, v25
 v_cvt_pk_bf16_f32 v25, v26, v27
M v[108:111], a[124:127], a[172:175], v[108:111]
 v_cvt_pk_bf16_f32 v26, v28, v29
 v_cvt_pk_bf16_f32 v27, v30, v31
M v[108:111], a[120:123], a[168:171], v[108:111]
 buffer_store_dwordx4 v[24:27], v7, s[8:11], s3 offen offset:3072 sc1
M v[112:115], a[128:131], a[168:171], v[112:115]
 v_cvt_pk_bf16_f32 v32, v32, v33
 v_cvt_pk_bf16_f32 v33, v34, v35
M v[112:115], a[132:135], a[172:175], v[112:115]
 ds_read_b64_tr_b16 a[68:69], v1 offset:24576
 ds_read_b64_tr_b16 a[70:71], v1 offset:25600
M v[116:119], a[140:143], a[172:175], v[116:119]
 buffer_load_dwordx4 v17, s[56:59], s29 offen offset:1024   lds
M v[116:119], a[136:139], a[168:171], v[116:119]
 v_cvt_pk_bf16_f32 v34, v36, v37
 v_cvt_pk_bf16_f32 v35, v38, v39
M v[120:123], a[144:147], a[168:171], v[120:123]
 v_accvgpr_write_b32 a4, v32
 v_accvgpr_write_b32 a5, v33
M v[120:123], a[148:151], a[172:175], v[120:123]
 s_waitcnt lgkmcnt(4)
 v_accvgpr_write_b32 a6, v34
 v_accvgpr_write_b32 a7, v35
M v[124:127], a[156:159], a[172:175], v[124:127]
 v_cvt_pk_bf16_f32 v40, v40, v41
 v_cvt_pk_bf16_f32 v41, v42, v43
M v[124:127], a[152:155], a[168:171], v[124:127]
 v_cvt_pk_bf16_f32 v42, v44, v45
 v_cvt_pk_bf16_f32 v43, v46, v47
M v[128:131], a[96:99], a[160:163], v[128:131]
 ds_read_b128 a[168:171], v5 offset:51200
 ds_read_b128 a[172:175], v6 offset:51200
M v[128:131], a[100:103], a[164:167], v[128:131]
 ds_read_b64_tr_b16 a[72:73], v2 offset:16384
 ds_read_b64_tr_b16 a[74:75], v2 offset:17408
M v[132:135], a[108:111], a[164:167], v[132:135]
 buffer_load_dwordx4 v18, s[56:59], s29 offen offset:2048   lds
M v[132:135], a[104:107], a[160:163], v[132:135]
 v_accvgpr_write_b32 a12, v40
 v_accvgpr_write_b32 a13, v41
M v[136:139], a[112:115], a[160:163], v[136:139]
 v_accvgpr_write_b32 a14, v42
 v_accvgpr_write_b32 a15, v43
M v[136:139], a[116:119], a[164:167], v[136:139]
 v_cvt_pk_bf16_f32 v48, v48, v49
 v_cvt_pk_bf16_f32 v49, v50, v51
M v[140:143], a[124:127], a[164:167], v[140:143]
 v_cvt_pk_bf16_f32 v50, v52, v53
 v_cvt_pk_bf16_f32 v51, v54, v55
M v[140:143], a[120:123], a[160:163], v[140:143]
 ds_read_b64_tr_b16 a[76:77], v2 offset:24576
 ds_read_b64_tr_b16 a[78:79], v2 offset:25600
M v[144:147], a[128:131], a[160:163], v[144:147]
 buffer_load_dwordx4 v19, s[56:59], s29 offen offset:3072   lds
M v[144:147], a[132:135], a[164:167], v[144:147]
 s_add_u32 s29, s29, 128
 v_accvgpr_write_b32 a20, v48
 v_accvgpr_write_b32 a21, v49
M v[148:151], a[140:143], a[164:167], v[148:151]
 v_accvgpr_write_b32 a22, v50
 v_accvgpr_write_b32 a23, v51
M v[148:151], a[136:139], a[160:163], v[148:151]
 v_cvt_pk_bf16_f32 v56, v56, v57
 v_cvt_pk_bf16_f32 v57, v58, v59
M v[152:155], a[144:147], a[160:163], v[152:155]
 v_cvt_pk_bf16_f32 v58, v60, v61
 v_cvt_pk_bf16_f32 v59, v62, v63
M v[152:155], a[148:151], a[164:167], v[152:155]
 s_waitcnt lgkmcnt(4)
 v_accvgpr_write_b32 a28, v56
 v_accvgpr_write_b32 a29, v57
M v[156:159], a[156:159], a[164:167], v[156:159]
 s_add_u32 m0, s23, 0
 ds_read_b64_tr_b16 a[80:81], v3 offset:16384
 ds_read_b64_tr_b16 a[82:83], v3 offset:17408
M v[156:159], a[152:155], a[160:163], v[156:159]
 buffer_load_dwordx4 v8, s[52:55], s28 offen offset:0   lds
M v[160:163], a[96:99], a[168:171], v[160:163]
 ds_read_b128 a[160:163], v5 offset:53248
 ds_read_b128 a[164:167], v6 offset:53248
M v[160:163], a[100:103], a[172:175], v[160:163]
 v_accvgpr_write_b32 a30, v58
 v_accvgpr_write_b32 a31, v59
M v[164:167], a[108:111], a[172:175], v[164:167]
 v_cvt_pk_bf16_f32 v64, v64, v65
 v_cvt_pk_bf16_f32 v65, v66, v67
M v[164:167], a[104:107], a[168:171], v[164:167]
 v_cvt_pk_bf16_f32 v66, v68, v69
 v_cvt_pk_bf16_f32 v67, v70, v71
M v[168:171], a[112:115], a[168:171], v[168:171]
 v_cvt_pk_bf16_f32 v72, v72, v73
 v_cvt_pk_bf16_f32 v73, v74, v75
M v[168:171], a[116:119], a[172:175], v[168:171]
 ds_read_b64_tr_b16 a[84:85], v3 offset:24576
 ds_read_b64_tr_b16 a[86:87], v3 offset:25600
M v[172:175], a[124:127], a[172:175], v[172:175]
 buffer_load_dwordx4 v9, s[52:55], s28 offen offset:1024   lds
M v[172:175], a[120:123], a[168:171], v[172:175]
 v_cvt_pk_bf16_f32 v74, v76, v77
 v_cvt_pk_bf16_f32 v75, v78, v79
M v[176:179], a[128:131], a[168:171], v[176:179]
 v_cvt_pk_bf16_f32 v80, v80, v81
 v_cvt_pk_bf16_f32 v81, v82, v83
M v[176:179], a[132:135], a[172:175], v[176:179]
 v_cvt_pk_bf16_f32 v82, v84, v85
 v_cvt_pk_bf16_f32 v83, v86, v87
M v[180:183], a[140:143], a[172:175], v[180:183]
 v_cvt_pk_bf16_f32 v88, v88, v89
 v_cvt_pk_bf16_f32 v89, v90, v91
M v[180:183], a[136:139], a[168:171], v[180:183]
 v_cvt_pk_bf16_f32 v90, v92, v93
 v_cvt_pk_bf16_f32 v91, v94, v95
M v[184:187], a[144:147], a[168:171], v[184:187]
 ds_read_b64_tr_b16 a[88:89], v4 offset:16384
 ds_read_b64_tr_b16 a[90:91], v4 offset:17408
M v[184:187], a[148:151], a[172:175], v[184:187]
 s_waitcnt lgkmcnt(4)
 buffer_load_dwordx4 v10, s[52:55], s28 offen offset:2048   lds
M v[188:191], a[156:159], a[172:175], v[188:191]
 v_cvt_pk_bf16_f32 v96, v96, v97
 v_cvt_pk_bf16_f32 v97, v98, v99
M v[188:191], a[152:155], a[168:171], v[188:191]
 v_cvt_pk_bf16_f32 v98, v100, v101
 v_cvt_pk_bf16_f32 v99, v102, v103
M v[192:195], a[96:99], a[160:163], v[192:195]
 ds_read_b128 a[168:171], v5 offset:55296
 ds_read_b128 a[172:175], v6 offset:55296
M v[192:195], a[100:103], a[164:167], v[192:195]
 v_cvt_pk_bf16_f32 v104, v104, v105
 v_cvt_pk_bf16_f32 v105, v106, v107
M v[196:199], a[108:111], a[164:167], v[196:199]
 v_cvt_pk_bf16_f32 v106, v108, v109
 v_cvt_pk_bf16_f32 v107, v110, v111
M v[196:199], a[104:107], a[160:163], v[196:199]
 ds_read_b64_tr_b16 a[92:93], v4 offset:24576
 ds_read_b64_tr_b16 a[94:95], v4 offset:25600
M v[200:203], a[112:115], a[160:163], v[200:203]
 buffer_load_dwordx4 v11, s[52:55], s28 offen offset:3072   lds
M v[200:203], a[116:119], a[164:167], v[200:203]
 s_add_u32 s28, s28, 128
 v_cvt_pk_bf16_f32 v112, v112, v113
 v_cvt_pk_bf16_f32 v113, v114, v115
M v[204:207], a[124:127], a[164:167], v[204:207]
 v_cvt_pk_bf16_f32 v114, v116, v117
 v_cvt_pk_bf16_f32 v115, v118, v119
M v[204:207], a[120:123], a[160:163], v[204:207]
 v_cvt_pk_bf16_f32 v120, v120, v121
 v_cvt_pk_bf16_f32 v121, v122, v123
M v[208:211], a[128:131], a[160:163], v[208:211]
 v_cvt_pk_bf16_f32 v122, v124, v125
 v_cvt_pk_bf16_f32 v123, v126, v127
M v[208:211], a[132:135], a[164:167], v[208:211]
 v_cvt_pk_bf16_f32 v128, v128, v129
 v_cvt_pk_bf16_f32 v129, v130, v131
M v[212:215], a[140:143], a[164:167], v[212:215]
 v_cvt_pk_bf16_f32 v130, v132, v133
 v_cvt_pk_bf16_f32 v131, v134, v135
M v[212:215], a[136:139], a[160:163], v[212:215]
 v_cvt_pk_bf16_f32 v136, v136, v137
 v_cvt_pk_bf16_f32 v137, v138, v139
M v[216:219], a[144:147], a[160:163], v[216:219]
 v_cvt_pk_bf16_f32 v138, v140, v141
 v_cvt_pk_bf16_f32 v139, v142, v143
M v[216:219], a[148:151], a[164:167], v[216:219]
 s_waitcnt lgkmcnt(2)
 v_cvt_pk_bf16_f32 v144, v144, v145
 v_cvt_pk_bf16_f32 v145, v146, v147
M v[220:223], a[156:159], a[164:167], v[220:223]
 s_waitcnt vmcnt(24) lgkmcnt(0)
 v_cvt_pk_bf16_f32 v146, v148, v149
 v_cvt_pk_bf16_f32 v147, v150, v151
M v[220:223], a[152:155], a[160:163], v[220:223]
 s_barrier
M v[224:227], a[96:99], a[168:171], v[224:227]
 ds_read_b128 a[160:163], v5 offset:0
 ds_read_b128 a[164:167], v6 offset:0
M v[224:227], a[100:103], a[172:175], v[224:227]
 v_cvt_pk_bf16_f32 v152, v152, v153
 v_cvt_pk_bf16_f32 v153, v154, v155
M v[228:231], a[108:111], a[172:175], v[228:231]
 v_cvt_pk_bf16_f32 v154, v156, v157
 v_cvt_pk_bf16_f32 v155, v158, v159
M v[228:231], a[104:107], a[168:171], v[228:231]
 v_cvt_pk_bf16_f32 v160, v160, v161
 v_cvt_pk_bf16_f32 v161, v162, v163
M v[232:235], a[112:115], a[168:171], v[232:235]
 v_cvt_pk_bf16_f32 v162, v164, v165
 v_cvt_pk_bf16_f32 v163, v166, v167
M v[232:235], a[116:119], a[172:175], v[232:235]
 v_cvt_pk_bf16_f32 v168, v168, v169
 v_cvt_pk_bf16_f32 v169, v170, v171
M v[236:239], a[124:127], a[172:175], v[236:239]
 v_cvt_pk_bf16_f32 v170, v172, v173
 v_cvt_pk_bf16_f32 v171, v174, v175
M v[236:239], a[120:123], a[168:171], v[236:239]
 v_cvt_pk_bf16_f32 v176, v176, v177
 v_cvt_pk_bf16_f32 v177, v178, v179
M v[240:243], a[128:131], a[168:171], v[240:243]
 v_cvt_pk_bf16_f32 v178, v180, v181
 v_cvt_pk_bf16_f32 v179, v182, v183
M v[240:243], a[132:135], a[172:175], v[240:243]
 v_cvt_pk_bf16_f32 v184, v184, v185
 v_cvt_pk_bf16_f32 v185, v186, v187
M v[244:247], a[140:143], a[172:175], v[244:247]
 v_cvt_pk_bf16_f32 v186, v188, v189
 v_cvt_pk_bf16_f32 v187, v190, v191
M v[244:247], a[136:139], a[168:171], v[244:247]
 v_cvt_pk_bf16_f32 v192, v192, v193
 v_cvt_pk_bf16_f32 v193, v194, v195
M v[248:251], a[144:147], a[168:171], v[248:251]
 v_cvt_pk_bf16_f32 v194, v196, v197
 v_cvt_pk_bf16_f32 v195, v198, v199
M v[248:251], a[148:151], a[172:175], v[248:251]
 s_waitcnt lgkmcnt(0)
 v_cvt_pk_bf16_f32 v200, v200, v201
 v_cvt_pk_bf16_f32 v201, v202, v203
M v[252:255], a[156:159], a[172:175], v[252:255]
 v_cvt_pk_bf16_f32 v202, v204, v205
 v_cvt_pk_bf16_f32 v203, v206, v207
M v[252:255], a[152:155], a[168:171], v[252:255]
 v_cvt_pk_bf16_f32 v208, v208, v209
 v_cvt_pk_bf16_f32 v209, v210, v211
M v[32:35], a[32:35], a[160:163], 0
 s_add_u32 m0, s23, 16384
 ds_read_b128 a[168:171], v5 offset:2048
 ds_read_b128 a[172:175], v6 offset:2048
M v[32:35], a[36:39], a[164:167], v[32:35]
 ds_read_b64_tr_b16 a[96:97], v1 offset:32768
 ds_read_b64_tr_b16 a[98:99], v1 offset:33792
M v[36:39], a[44:47], a[164:167], 0
 buffer_load_dwordx4 v8, s[52:55], s28 offen offset:0   lds
M v[36:39], a[40:43], a[160:163], v[36:39]
 v_cvt_pk_bf16_f32 v210, v212, v213
 v_cvt_pk_bf16_f32 v211, v214, v215
M v[40:43], a[48:51], a[160:163], 0
 ds_read_b64_tr_b16 a[100:101], v1 offset:40960
 ds_read_b64_tr_b16 a[102:103], v1 offset:41984
M v[40:43], a[52:55], a[164:167], v[40:43]
 buffer_load_dwordx4 v9, s[52:55], s28 offen offset:1024   lds
M v[44:47], a[60:63], a[164:167], 0
 v_cvt_pk_bf16_f32 v216, v216, v217
 v_cvt_pk_bf16_f32 v217, v218, v219
M v[44:47], a[56:59], a[160:163], v[44:47]
 ds_read_b64_tr_b16 a[104:105], v2 offset:32768
 ds_read_b64_tr_b16 a[106:107], v2 offset:33792
M v[48:51], a[64:67], a[160:163], 0
 v_cvt_pk_bf16_f32 v218, v220, v221
 v_cvt_pk_bf16_f32 v219, v222, v223
M v[48:51], a[68:71], a[164:167], v[48:51]
 v_cvt_pk_bf16_f32 v224, v224, v225
 v_cvt_pk_bf16_f32 v225, v226, v227
M v[52:55], a[76:79], a[164:167], 0
 ds_read_b64_tr_b16 a[108:109], v2 offset:40960
 ds_read_b64_tr_b16 a[110:111], v2 offset:41984
M v[52:55], a[72:75], a[160:163], v[52:55]
 buffer_load_dwordx4 v10, s[52:55], s28 offen offset:2048   lds
M v[56:59], a[80:83], a[160:163], 0
 v_cvt_pk_bf16_f32 v226, v228, v229
 v_cvt_pk_bf16_f32 v227, v230, v231
M v[56:59], a[84:87], a[164:167], v[56:59]
 s_waitcnt lgkmcnt(8)
 ds_read_b64_tr_b16 a[112:113], v3 offset:32768
 ds_read_b64_tr_b16 a[114:115], v3 offset:33792
M v[60:63], a[92:95], a[164:167], 0
 v_cvt_pk_bf16_f32 v232, v232, v233
 v_cvt_pk_bf16_f32 v233, v234, v235
M v[60:63], a[88:91], a[160:163], v[60:63]
 buffer_load_dwordx4 v11, s[52:55], s28 offen offset:3072   lds
M v[68:71], a[32:35], a[168:171], 0
 s_add_u32 s28, s28, 524160
 ds_read_b128 a[160:163], v5 offset:4096
 ds_read_b128 a[164:167], v6 offset:4096
M v[68:71], a[36:39], a[172:175], v[68:71]
 ds_read_b64_tr_b16 a[116:117], v3 offset:40960
 ds_read_b64_tr_b16 a[118:119], v3 offset:41984
M v[76:79], a[44:47], a[172:175], 0
 v_cvt_pk_bf16_f32 v234, v236, v237
 v_cvt_pk_bf16_f32 v235, v238, v239
M v[76:79], a[40:43], a[168:171], v[76:79]
 s_add_u32 m0, s24, 49152
 ds_read_b64_tr_b16 a[120:121], v4 offset:32768
 ds_read_b64_tr_b16 a[122:123], v4 offset:33792
M v[84:87], a[48:51], a[168:171], 0
 buffer_load_dwordx4 v16, s[56:59], s29 offen offset:0   lds
M v[84:87], a[52:55], a[172:175], v[84:87]
 v_cvt_pk_bf16_f32 v240, v240, v241
 v_cvt_pk_bf16_f32 v241, v242, v243
M v[92:95], a[60:63], a[172:175], 0
 ds_read_b64_tr_b16 a[124:125], v4 offset:40960
 ds_read_b64_tr_b16 a[126:127], v4 offset:41984
M v[92:95], a[56:59], a[168:171], v[92:95]
 v_cvt_pk_bf16_f32 v242, v244, v245
 v_cvt_pk_bf16_f32 v243, v246, v247
M v[100:103], a[64:67], a[168:171], 0
 v_cvt_pk_bf16_f32 v248, v248, v249
 v_cvt_pk_bf16_f32 v249, v250, v251
M v[100:103], a[68:71], a[172:175], v[100:103]
 buffer_load_dwordx4 v17, s[56:59], s29 offen offset:1024   lds
M v[108:111], a[76:79], a[172:175], 0
 v_cvt_pk_bf16_f32 v250, v252, v253
 v_cvt_pk_bf16_f32 v251, v254, v255
M v[108:111], a[72:75], a[168:171], v[108:111]
 s_add_u32 s3, s93, 16384
 v_mov_b32 v12, 1
 v_or_b32 v15, s20, v0
M v[116:119], a[80:83], a[168:171], 0
 v_min_u32 v15, 1, v15
 v_lshlrev_b32 v15, 29, v15
M v[116:119], a[84:87], a[172:175], v[116:119]
 s_waitcnt lgkmcnt(6)
 buffer_store_dwordx4 a[4:7], v7, s[8:11], s3 offen offset:0 sc1
M v[124:127], a[92:95], a[172:175], 0
 s_waitcnt vmcnt(17) lgkmcnt(0)
 buffer_load_dwordx4 v18, s[56:59], s29 offen offset:2048   lds
M v[124:127], a[88:91], a[168:171], v[124:127]
 s_barrier
M v[132:135], a[32:35], a[160:163], 0
 ds_read_b128 a[168:171], v5 offset:6144
 ds_read_b128 a[172:175], v6 offset:6144
M v[132:135], a[36:39], a[164:167], v[132:135]
 ds_read_b64_tr_b16 a[128:129], v1 offset:49152
 ds_read_b64_tr_b16 a[130:131], v1 offset:50176
M v[140:143], a[44:47], a[164:167], 0
M v[140:143], a[40:43], a[160:163], v[140:143]
 buffer_load_dwordx4 v19, s[56:59], s29 offen offset:3072   lds
M v[148:151], a[48:51], a[160:163], 0
 s_add_u32 s29, s29, 128
 ds_read_b64_tr_b16 a[132:133], v1 offset:57344
 ds_read_b64_tr_b16 a[134:135], v1 offset:58368
M v[148:151], a[52:55], a[164:167], v[148:151]
 buffer_store_dwordx4 a[12:15], v7, s[8:11], s3 offen offset:1024 sc1
M v[156:159], a[60:63], a[164:167], 0
M v[156:159], a[56:59], a[160:163], v[156:159]
 s_add_u32 m0, s23, 32768
 ds_read_b64_tr_b16 a[136:137], v2 offset:49152
 ds_read_b64_tr_b16 a[138:139], v2 offset:50176
M v[164:167], a[64:67], a[160:163], 0
 buffer_load_dwordx4 v8, s[52:55], s28 offen offset:0   lds
M v[164:167], a[68:71], a[164:167], v[164:167]
M v[172:175], a[76:79], a[164:167], 0
 ds_read_b64_tr_b16 a[140:141], v2 offset:57344
 ds_read_b64_tr_b16 a[142:143], v2 offset:58368
M v[172:175], a[72:75], a[160:163], v[172:175]
M v[180:183], a[80:83], a[160:163], 0
M v[180:183], a[84:87], a[164:167], v[180:183]
 s_waitcnt lgkmcnt(8)
 ds_read_b64_tr_b16 a[144:145], v3 offset:49152
 ds_read_b64_tr_b16 a[146:147], v3 offset:50176
M v[188:191], a[92:95], a[164:167], 0
 buffer_load_dwordx4 v9, s[52:55], s28 offen offset:1024   lds
M v[188:191], a[88:91], a[160:163], v[188:191]
M v[196:199], a[32:35], a[168:171], 0
 ds_read_b128 a[160:163], v5 offset:16384
 ds_read_b128 a[164:167], v6 offset:16384
M v[196:199], a[36:39], a[172:175], v[196:199]
 ds_read_b64_tr_b16 a[148:149], v3 offset:57344
 ds_read_b64_tr_b16 a[150:151], v3 offset:58368
M v[204:207], a[44:47], a[172:175], 0
 buffer_load_dwordx4 v10, s[52:55], s28 offen offset:2048   lds
M v[204:207], a[40:43], a[168:171], v[204:207]
 ds_read_b64_tr_b16 a[152:153], v4 offset:49152
 ds_read_b64_tr_b16 a[154:155], v4 offset:50176
M v[212:215], a[48:51], a[168:171], 0
M v[212:215], a[52:55], a[172:175], v[212:215]
M v[220:223], a[60:63], a[172:175], 0
 ds_read_b64_tr_b16 a[156:157], v4 offset:57344
 ds_read_b64_tr_b16 a[158:159], v4 offset:58368
M v[220:223], a[56:59], a[168:171], v[220:223]
 buffer_load_dwordx4 v11, s[52:55], s28 offen offset:3072   lds
M v[228:231], a[64:67], a[168:171], 0
 s_add_u32 s28, s28, 128
M v[228:231], a[68:71], a[172:175], v[228:231]
M v[236:239], a[76:79], a[172:175], 0
M v[236:239], a[72:75], a[168:171], v[236:239]
M v[244:247], a[80:83], a[168:171], 0
M v[244:247], a[84:87], a[172:175], v[244:247]
 s_waitcnt lgkmcnt(6)
M v[252:255], a[92:95], a[172:175], 0
 s_waitcnt lgkmcnt(0)
M v[252:255], a[88:91], a[168:171], v[252:255]
 s_barrier
M v[32:35], a[96:99], a[160:163], v[32:35]
 s_add_u32 m0, s23, 49152
 ds_read_b128 a[168:171], v5 offset:18432
 ds_read_b128 a[172:175], v6 offset:18432
M v[32:35], a[100:103], a[164:167], v[32:35]
 ds_read_b64_tr_b16 a[32:33], v20 offset:0
 ds_read_b64_tr_b16 a[34:35], v20 offset:1024
M v[36:39], a[108:111], a[164:167], v[36:39]
 s_mov_b32 s39, 1280
 buffer_load_dwordx4 v8, s[52:55], s28 offen offset:0   lds
M v[36:39], a[104:107], a[160:163], v[36:39]
 s_cmp_ge_u32 s42, 10
M v[40:43], a[112:115], a[160:163], v[40:43]
 s_cselect_b32 s64, 0xf000000, 0
 ds_read_b64_tr_b16 a[36:37], v20 offset:8192
 ds_read_b64_tr_b16 a[38:39], v20 offset:9216
M v[40:43], a[116:119], a[164:167], v[40:43]
 s_or_b32 s39, s39, s64
 buffer_load_dwordx4 v9, s[52:55], s28 offen offset:1024   lds
M v[44:47], a[124:127], a[164:167], v[44:47]
 s_lshl_b32 s64, s20, 15
M v[44:47], a[120:123], a[160:163], v[44:47]
 s_add_u32 s12, s64, s34
 ds_read_b64_tr_b16 a[40:41], v21 offset:0
 ds_read_b64_tr_b16 a[42:43], v21 offset:1024
M v[48:51], a[128:131], a[160:163], v[48:51]
 s_add_u32 s13, s12, 4096
 buffer_store_dwordx4 a[20:23], v7, s[8:11], s3 offen offset:2048 sc1
M v[48:51], a[132:135], a[164:167], v[48:51]
 s_add_u32 s14, s12, 16384
M v[52:55], a[140:143], a[164:167], v[52:55]
 s_add_u32 s15, s12, 20480
 ds_read_b64_tr_b16 a[44:45], v21 offset:8192
 ds_read_b64_tr_b16 a[46:47], v21 offset:9216
M v[52:55], a[136:139], a[160:163], v[52:55]
 buffer_load_dwordx4 v10, s[52:55], s28 offen offset:2048   lds
M v[56:59], a[144:147], a[160:163], v[56:59]
M v[56:59], a[148:151], a[164:167], v[56:59]
 s_waitcnt lgkmcnt(8)
 ds_read_b64_tr_b16 a[48:49], v22 offset:0
 ds_read_b64_tr_b16 a[50:51], v22 offset:1024
M v[60:63], a[156:159], a[164:167], v[60:63]
M v[60:63], a[152:155], a[160:163], v[60:63]
 buffer_load_dwordx4 v11, s[52:55], s28 offen offset:3072   lds
M v[68:71], a[96:99], a[168:171], v[68:71]
 s_add_u32 s28, s28, 524160
 ds_read_b128 a[160:163], v5 offset:20480
 ds_read_b128 a[164:167], v6 offset:20480
M v[68:71], a[100:103], a[172:175], v[68:71]
 ds_read_b64_tr_b16 a[52:53], v22 offset:8192
 ds_read_b64_tr_b16 a[54:55], v22 offset:9216
M v[76:79], a[108:111], a[172:175], v[76:79]
M v[76:79], a[104:107], a[168:171], v[76:79]
 s_add_u32 m0, s24, 0
 ds_read_b64_tr_b16 a[56:57], v23 offset:0
 ds_read_b64_tr_b16 a[58:59], v23 offset:1024
M v[84:87], a[112:115], a[168:171], v[84:87]
 buffer_load_dwordx4 v16, s[56:59], s29 offen offset:0   lds
M v[84:87], a[116:119], a[172:175], v[84:87]
M v[92:95], a[124:127], a[172:175], v[92:95]
 ds_read_b64_tr_b16 a[60:61], v23 offset:8192
 ds_read_b64_tr_b16 a[62:63], v23 offset:9216
M v[92:95], a[120:123], a[168:171], v[92:95]
M v[100:103], a[128:131], a[168:171], v[100:103]
M v[100:103], a[132:135], a[172:175], v[100:103]
 buffer_load_dwordx4 v17, s[56:59], s29 offen offset:1024   lds
M v[108:111], a[140:143], a[172:175], v[108:111]
M v[108:111], a[136:139], a[168:171], v[108:111]
M v[116:119], a[144:147], a[168:171], v[116:119]
M v[116:119], a[148:151], a[172:175], v[116:119]
 s_waitcnt lgkmcnt(6)
M v[124:127], a[156:159], a[172:175], v[124:127]
 s_waitcnt vmcnt(25) lgkmcnt(0)
 buffer_load_dwordx4 v18, s[56:59], s29 offen offset:2048   lds
M v[124:127], a[152:155], a[168:171], v[124:127]
 s_barrier
M v[132:135], a[96:99], a[160:163], v[132:135]
 ds_read_b128 a[168:171], v5 offset:22528
 ds_read_b128 a[172:175], v6 offset:22528
M v[132:135], a[100:103], a[164:167], v[132:135]
 ds_read_b64_tr_b16 a[64:65], v20 offset:16384
 ds_read_b64_tr_b16 a[66:67], v20 offset:17408
M v[140:143], a[108:111], a[164:167], v[140:143]
M v[140:143], a[104:107], a[160:163], v[140:143]
 buffer_load_dwordx4 v19, s[56:59], s29 offen offset:3072   lds
M v[148:151], a[112:115], a[160:163], v[148:151]
 s_add_u32 s29, s29, 128
 ds_read_b64_tr_b16 a[68:69], v20 offset:24576
 ds_read_b64_tr_b16 a[70:71], v20 offset:25600
M v[148:151], a[116:119], a[164:167], v[148:151]
 buffer_store_dwordx4 a[28:31], v7, s[8:11], s3 offen offset:3072 sc1
M v[156:159], a[124:127], a[164:167], v[156:159]
M v[156:159], a[120:123], a[160:163], v[156:159]
 s_add_u32 m0, s23, 131072
 ds_read_b64_tr_b16 a[72:73], v21 offset:16384
 ds_read_b64_tr_b16 a[74:75], v21 offset:17408
M v[164:167], a[128:131], a[160:163], v[164:167]
 buffer_load_dwordx4 v8, s[52:55], s28 offen offset:0   lds
M v[164:167], a[132:135], a[164:167], v[164:167]
M v[172:175], a[140:143], a[164:167], v[172:175]
 ds_read_b64_tr_b16 a[76:77], v21 offset:24576
 ds_read_b64_tr_b16 a[78:79], v21 offset:25600
M v[172:175], a[136:139], a[160:163], v[172:175]
M v[180:183], a[144:147], a[160:163], v[180:183]
M v[180:183], a[148:151], a[164:167], v[180:183]
 s_waitcnt lgkmcnt(8)
 ds_read_b64_tr_b16 a[80:81], v22 offset:16384
 ds_read_b64_tr_b16 a[82:83], v22 offset:17408
M v[188:191], a[156:159], a[164:167], v[188:191]
 buffer_load_dwordx4 v9, s[52:55], s28 offen offset:1024   lds
M v[188:191], a[152:155], a[160:163], v[188:191]
M v[196:199], a[96:99], a[168:171], v[196:199]
 ds_read_b128 a[160:163], v5 offset:32768
 ds_read_b128 a[164:167], v6 offset:32768
M v[196:199], a[100:103], a[172:175], v[196:199]
 ds_read_b64_tr_b16 a[84:85], v22 offset:24576
 ds_read_b64_tr_b16 a[86:87], v22 offset:25600
M v[204:207], a[108:111], a[172:175], v[204:207]
 buffer_load_dwordx4 v10, s[52:55], s28 offen offset:2048   lds
M v[204:207], a[104:107], a[168:171], v[204:207]
 ds_read_b64_tr_b16 a[88:89], v23 offset:16384
 ds_read_b64_tr_b16 a[90:91], v23 offset:17408
M v[212:215], a[112:115], a[168:171], v[212:215]
M v[212:215], a[116:119], a[172:175], v[212:215]
M v[220:223], a[124:127], a[172:175], v[220:223]
 ds_read_b64_tr_b16 a[92:93], v23 offset:24576
 ds_read_b64_tr_b16 a[94:95], v23 offset:25600
M v[220:223], a[120:123], a[168:171], v[220:223]
 buffer_load_dwordx4 v11, s[52:55], s28 offen offset:3072   lds
M v[228:231], a[128:131], a[168:171], v[228:231]
 s_add_u32 s28, s28, 128
M v[228:231], a[132:135], a[172:175], v[228:231]
M v[236:239], a[140:143], a[172:175], v[236:239]
M v[236:239], a[136:139], a[168:171], v[236:239]
M v[244:247], a[144:147], a[168:171], v[244:247]
M v[244:247], a[148:151], a[172:175], v[244:247]
 s_waitcnt lgkmcnt(6)
M v[252:255], a[156:159], a[172:175], v[252:255]
 s_waitcnt vmcnt(28) lgkmcnt(0)
M v[252:255], a[152:155], a[168:171], v[252:255]
 s_barrier
M v[32:35], a[32:35], a[160:163], v[32:35]
 s_add_u32 m0, s23, 147456
 ds_read_b128 a[168:171], v5 offset:34816
 ds_read_b128 a[172:175], v6 offset:34816
M v[32:35], a[36:39], a[164:167], v[32:35]
 ds_read_b64_tr_b16 a[96:97], v1 offset:0
 ds_read_b64_tr_b16 a[98:99], v1 offset:1024
M v[36:39], a[44:47], a[164:167], v[36:39]
 buffer_load_dwordx4 v8, s[52:55], s28 offen offset:0   lds
M v[36:39], a[40:43], a[160:163], v[36:39]
M v[40:43], a[48:51], a[160:163], v[40:43]
 ds_read_b64_tr_b16 a[100:101], v1 offset:8192
 ds_read_b64_tr_b16 a[102:103], v1 offset:9216
M v[40:43], a[52:55], a[164:167], v[40:43]
 buffer_load_dwordx4 v9, s[52:55], s28 offen offset:1024   lds
M v[44:47], a[60:63], a[164:167], v[44:47]
M v[44:47], a[56:59], a[160:163], v[44:47]
 ds_read_b64_tr_b16 a[104:105], v2 offset:0
 ds_read_b64_tr_b16 a[106:107], v2 offset:1024
M v[48:51], a[64:67], a[160:163], v[48:51]
M v[48:51], a[68:71], a[164:167], v[48:51]
M v[52:55], a[76:79], a[164:167], v[52:55]
 ds_read_b64_tr_b16 a[108:109], v2 offset:8192
 ds_read_b64_tr_b16 a[110:111], v2 offset:9216
M v[52:55], a[72:75], a[160:163], v[52:55]
 buffer_load_dwordx4 v10, s[52:55], s28 offen offset:2048   lds
M v[56:59], a[80:83], a[160:163], v[56:59]
M v[56:59], a[84:87], a[164:167], v[56:59]
 s_waitcnt lgkmcnt(8)
 ds_read_b64_tr_b16 a[112:113], v3 offset:0
 ds_read_b64_tr_b16 a[114:115], v3 offset:1024
M v[60:63], a[92:95], a[164:167], v[60:63]
M v[60:63], a[88:91], a[160:163], v[60:63]
 buffer_load_dwordx4 v11, s[52:55], s28 offen offset:3072   lds
M v[68:71], a[32:35], a[168:171], v[68:71]
 s_add_u32 s28, s28, 524160
 ds_read_b128 a[160:163], v5 offset:36864
 ds_read_b128 a[164:167], v6 offset:36864
M v[68:71], a[36:39], a[172:175], v[68:71]
 ds_read_b64_tr_b16 a[116:117], v3 offset:8192
 ds_read_b64_tr_b16 a[118:119], v3 offset:9216
M v[76:79], a[44:47], a[172:175], v[76:79]
M v[76:79], a[40:43], a[168:171], v[76:79]
 s_add_u32 m0, s24, 16384
 ds_read_b64_tr_b16 a[120:121], v4 offset:0
 ds_read_b64_tr_b16 a[122:123], v4 offset:1024
M v[84:87], a[48:51], a[168:171], v[84:87]
 buffer_load_dwordx4 v16, s[56:59], s29 offen offset:0   lds
M v[84:87], a[52:55], a[172:175], v[84:87]
M v[92:95], a[60:63], a[172:175], v[92:95]
 ds_read_b64_tr_b16 a[124:125], v4 offset:8192
 ds_read_b64_tr_b16 a[126:127], v4 offset:9216
M v[92:95], a[56:59], a[168:171], v[92:95]
M v[100:103], a[64:67], a[168:171], v[100:103]
M v[100:103], a[68:71], a[172:175], v[100:103]
 buffer_load_dwordx4 v17, s[56:59], s29 offen offset:1024   lds
M v[108:111], a[76:79], a[172:175], v[108:111]
M v[108:111], a[72:75], a[168:171], v[108:111]
M v[116:119], a[80:83], a[168:171], v[116:119]
M v[116:119], a[84:87], a[172:175], v[116:119]
 s_waitcnt lgkmcnt(6)
M v[124:127], a[92:95], a[172:175], v[124:127]
 s_waitcnt vmcnt(25) lgkmcnt(0)
 buffer_load_dwordx4 v18, s[56:59], s29 offen offset:2048   lds
M v[124:127], a[88:91], a[168:171], v[124:127]
 s_barrier
M v[132:135], a[32:35], a[160:163], v[132:135]
 ds_read_b128 a[168:171], v5 offset:38912
 ds_read_b128 a[172:175], v6 offset:38912
M v[132:135], a[36:39], a[164:167], v[132:135]
 ds_read_b64_tr_b16 a[128:129], v1 offset:16384
 ds_read_b64_tr_b16 a[130:131], v1 offset:17408
M v[140:143], a[44:47], a[164:167], v[140:143]
M v[140:143], a[40:43], a[160:163], v[140:143]
 buffer_load_dwordx4 v19, s[56:59], s29 offen offset:3072   lds
M v[148:151], a[48:51], a[160:163], v[148:151]
 s_add_u32 s29, s29, 128
 ds_read_b64_tr_b16 a[132:133], v1 offset:24576
 ds_read_b64_tr_b16 a[134:135], v1 offset:25600
M v[148:151], a[52:55], a[164:167], v[148:151]
M v[156:159], a[60:63], a[164:167], v[156:159]
M v[156:159], a[56:59], a[160:163], v[156:159]
 s_add_u32 m0, s23, 0
 ds_read_b64_tr_b16 a[136:137], v2 offset:16384
 ds_read_b64_tr_b16 a[138:139], v2 offset:17408
M v[164:167], a[64:67], a[160:163], v[164:167]
 buffer_load_dwordx4 v8, s[52:55], s28 offen offset:0   lds
M v[164:167], a[68:71], a[164:167], v[164:167]
M v[172:175], a[76:79], a[164:167], v[172:175]
 ds_read_b64_tr_b16 a[140:141], v2 offset:24576
 ds_read_b64_tr_b16 a[142:143], v2 offset:25600
M v[172:175], a[72:75], a[160:163], v[172:175]
M v[180:183], a[80:83], a[160:163], v[180:183]
M v[180:183], a[84:87], a[164:167], v[180:183]
 s_waitcnt lgkmcnt(8)
 ds_read_b64_tr_b16 a[144:145], v3 offset:16384
 ds_read_b64_tr_b16 a[146:147], v3 offset:17408
M v[188:191], a[92:95], a[164:167], v[188:191]
 buffer_load_dwordx4 v9, s[52:55], s28 offen offset:1024   lds
M v[188:191], a[88:91], a[160:163], v[188:191]
M v[196:199], a[32:35], a[168:171], v[196:199]
 ds_read_b128 a[160:163], v5 offset:49152
 ds_read_b128 a[164:167], v6 offset:49152
M v[196:199], a[36:39], a[172:175], v[196:199]
 ds_read_b64_tr_b16 a[148:149], v3 offset:24576
 ds_read_b64_tr_b16 a[150:151], v3 offset:25600
M v[204:207], a[44:47], a[172:175], v[204:207]
 buffer_load_dwordx4 v10, s[52:55], s28 offen offset:2048   lds
M v[204:207], a[40:43], a[168:171], v[204:207]
 ds_read_b64_tr_b16 a[152:153], v4 offset:16384
 ds_read_b64_tr_b16 a[154:155], v4 offset:17408
M v[212:215], a[48:51], a[168:171], v[212:215]
M v[212:215], a[52:55], a[172:175], v[212:215]
M v[220:223], a[60:63], a[172:175], v[220:223]
 ds_read_b64_tr_b16 a[156:157], v4 offset:24576
 ds_read_b64_tr_b16 a[158:159], v4 offset:25600
M v[220:223], a[56:59], a[168:171], v[220:223]
 buffer_load_dwordx4 v11, s[52:55], s28 offen offset:3072   lds
M v[228:231], a[64:67], a[168:171], v[228:231]
 s_add_u32 s28, s28, 128
M v[228:231], a[68:71], a[172:175], v[228:231]
M v[236:239], a[76:79], a[172:175], v[236:239]
M v[236:239], a[72:75], a[168:171], v[236:239]
M v[244:247], a[80:83], a[168:171], v[244:247]
M v[244:247], a[84:87], a[172:175], v[244:247]
 s_waitcnt lgkmcnt(6)
M v[252:255], a[92:95], a[172:175], v[252:255]
 s_waitcnt vmcnt(16) lgkmcnt(0)
M v[252:255], a[88:91], a[168:171], v[252:255]
 s_barrier
M v[32:35], a[96:99], a[160:163], v[32:35]
 s_add_u32 m0, s23, 16384
 ds_read_b128 a[168:171], v5 offset:51200
 ds_read_b128 a[172:175], v6 offset:51200
M v[32:35], a[100:103], a[164:167], v[32:35]
 ds_read_b64_tr_b16 a[32:33], v1 offset:32768
 ds_read_b64_tr_b16 a[34:35], v1 offset:33792
M v[36:39], a[108:111], a[164:167], v[36:39]
 buffer_load_dwordx4 v8, s[52:55], s28 offen offset:0   lds
M v[36:39], a[104:107], a[160:163], v[36:39]
 buffer_store_dword v12, v15, s[8:11], s45 offen sc1
M v[40:43], a[112:115], a[160:163], v[40:43]
 s_add_u32 s3, s93, 524288
 ds_read_b64_tr_b16 a[36:37], v1 offset:40960
 ds_read_b64_tr_b16 a[38:39], v1 offset:41984
M v[40:43], a[116:119], a[164:167], v[40:43]
 v_min_u32 v25, 15, v0
 v_lshlrev_b32 v25, 7, v25
M v[44:47], a[124:127], a[164:167], v[44:47]
 v_max_u32 v13, 1024, v25
M v[44:47], a[120:123], a[160:163], v[44:47]
 ds_read_b64_tr_b16 a[40:41], v2 offset:32768
 ds_read_b64_tr_b16 a[42:43], v2 offset:33792
M v[48:51], a[128:131], a[160:163], v[48:51]
 buffer_load_dwordx4 v9, s[52:55], s28 offen offset:1024   lds
M v[48:51], a[132:135], a[164:167], v[48:51]
 buffer_store_dwordx4 v[64:67], v7, s[8:11], s3 offen offset:0 sc1
M v[52:55], a[140:143], a[164:167], v[52:55]
 ds_read_b64_tr_b16 a[44:45], v2 offset:40960
 ds_read_b64_tr_b16 a[46:47], v2 offset:41984
M v[52:55], a[136:139], a[160:163], v[52:55]
M v[56:59], a[144:147], a[160:163], v[56:59]
M v[56:59], a[148:151], a[164:167], v[56:59]
 s_waitcnt lgkmcnt(8)
 ds_read_b64_tr_b16 a[48:49], v3 offset:32768
 ds_read_b64_tr_b16 a[50:51], v3 offset:33792
M v[60:63], a[156:159], a[164:167], v[60:63]
 buffer_load_dwordx4 v10, s[52:55], s28 offen offset:2048   lds
M v[60:63], a[152:155], a[160:163], v[60:63]
M v[68:71], a[96:99], a[168:171], v[68:71]
 ds_read_b128 a[160:163], v5 offset:53248
 ds_read_b128 a[164:167], v6 offset:53248
M v[68:71], a[100:103], a[172:175], v[68:71]
 ds_read_b64_tr_b16 a[52:53], v3 offset:40960
 ds_read_b64_tr_b16 a[54:55], v3 offset:41984
M v[76:79], a[108:111], a[172:175], v[76:79]
 buffer_store_dwordx4 v[72:75], v7, s[8:11], s3 offen offset:1024 sc1
M v[76:79], a[104:107], a[168:171], v[76:79]
 ds_read_b64_tr_b16 a[56:57], v4 offset:32768
 ds_read_b64_tr_b16 a[58:59], v4 offset:33792
M v[84:87], a[112:115], a[168:171], v[84:87]
M v[84:87], a[116:119], a[172:175], v[84:87]
 buffer_load_dwordx4 v11, s[52:55], s28 offen offset:3072   lds
M v[92:95], a[124:127], a[172:175], v[92:95]
 s_add_u32 s28, s28, 524160
 ds_read_b64_tr_b16 a[60:61], v4 offset:40960
 ds_read_b64_tr_b16 a[62:63], v4 offset:41984
M v[92:95], a[120:123], a[168:171], v[92:95]
M v[100:103], a[128:131], a[168:171], v[100:103]
M v[100:103], a[132:135], a[172:175], v[100:103]
M v[108:111], a[140:143], a[172:175], v[108:111]
M v[108:111], a[136:139], a[168:171], v[108:111]
M v[116:119], a[144:147], a[168:171], v[116:119]
M v[116:119], a[148:151], a[172:175], v[116:119]
 s_waitcnt lgkmcnt(6)
M v[124:127], a[156:159], a[172:175], v[124:127]
 s_waitcnt lgkmcnt(0)
M v[124:127], a[152:155], a[168:171], v[124:127]
 s_barrier
M v[132:135], a[96:99], a[160:163], v[132:135]
 ds_read_b128 a[168:171], v5 offset:55296
 ds_read_b128 a[172:175], v6 offset:55296
M v[132:135], a[100:103], a[164:167], v[132:135]
 ds_read_b64_tr_b16 a[64:65], v1 offset:49152
 ds_read_b64_tr_b16 a[66:67], v1 offset:50176
M v[140:143], a[108:111], a[164:167], v[140:143]
 buffer_store_dwordx4 v[80:83], v7, s[8:11], s3 offen offset:2048 sc1
M v[140:143], a[104:107], a[160:163], v[140:143]
M v[148:151], a[112:115], a[160:163], v[148:151]
 ds_read_b64_tr_b16 a[68:69], v1 offset:57344
 ds_read_b64_tr_b16 a[70:71], v1 offset:58368
M v[148:151], a[116:119], a[164:167], v[148:151]
M v[156:159], a[124:127], a[164:167], v[156:159]
M v[156:159], a[120:123], a[160:163], v[156:159]
 ds_read_b64_tr_b16 a[72:73], v2 offset:49152
 ds_read_b64_tr_b16 a[74:75], v2 offset:50176
M v[164:167], a[128:131], a[160:163], v[164:167]
M v[164:167], a[132:135], a[164:167], v[164:167]
M v[172:175], a[140:143], a[164:167], v[172:175]
 ds_read_b64_tr_b16 a[76:77], v2 offset:57344
 ds_read_b64_tr_b16 a[78:79], v2 offset:58368
M v[172:175], a[136:139], a[160:163], v[172:175]
M v[180:183], a[144:147], a[160:163], v[180:183]
M v[180:183], a[148:151], a[164:167], v[180:183]
 s_waitcnt lgkmcnt(8)
 ds_read_b64_tr_b16 a[80:81], v3 offset:49152
 ds_read_b64_tr_b16 a[82:83], v3 offset:50176
M v[188:191], a[156:159], a[164:167], v[188:191]
 buffer_store_dwordx4 v[88:91], v7, s[8:11], s3 offen offset:3072 sc1
M v[188:191], a[152:155], a[160:163], v[188:191]
M v[196:199], a[96:99], a[168:171], v[196:199]
 ds_read_b128 a[160:163], v5 offset:0
 ds_read_b128 a[164:167], v6 offset:0
M v[196:199], a[100:103], a[172:175], v[196:199]
 ds_read_b64_tr_b16 a[84:85], v3 offset:57344
 ds_read_b64_tr_b16 a[86:87], v3 offset:58368
M v[204:207], a[108:111], a[172:175], v[204:207]
M v[204:207], a[104:107], a[168:171], v[204:207]
 ds_read_b64_tr_b16 a[88:89], v4 offset:49152
 ds_read_b64_tr_b16 a[90:91], v4 offset:50176
M v[212:215], a[112:115], a[168:171], v[212:215]
M v[212:215], a[116:119], a[172:175], v[212:215]
M v[220:223], a[124:127], a[172:175], v[220:223]
 ds_read_b64_tr_b16 a[92:93], v4 offset:57344
 ds_read_b64_tr_b16 a[94:95], v4 offset:58368
M v[220:223], a[120:123], a[168:171], v[220:223]
M v[228:231], a[128:131], a[168:171], v[228:231]
M v[228:231], a[132:135], a[172:175], v[228:231]
M v[236:239], a[140:143], a[172:175], v[236:239]
M v[236:239], a[136:139], a[168:171], v[236:239]
M v[244:247], a[144:147], a[168:171], v[244:247]
M v[244:247], a[148:151], a[172:175], v[244:247]
 s_waitcnt lgkmcnt(6)
M v[252:255], a[156:159], a[172:175], v[252:255]
 s_waitcnt vmcnt(21) lgkmcnt(0)
M v[252:255], a[152:155], a[168:171], v[252:255]
 s_barrier
M v[32:35], a[32:35], a[160:163], v[32:35]
 s_add_u32 m0, s23, 32768
 ds_read_b128 a[168:171], v5 offset:2048
 ds_read_b128 a[172:175], v6 offset:2048
M v[32:35], a[36:39], a[164:167], v[32:35]
 ds_read_b64_tr_b16 a[96:97], v20 offset:0
 ds_read_b64_tr_b16 a[98:99], v20 offset:1024
M v[36:39], a[44:47], a[164:167], v[36:39]
 buffer_load_dwordx4 v16, s[56:59], s29 offen offset:0   lds
M v[36:39], a[40:43], a[160:163], v[36:39]
M v[40:43], a[48:51], a[160:163], v[40:43]
 s_add_u32 s3, s93, 540672
 ds_read_b64_tr_b16 a[100:101], v20 offset:8192
 ds_read_b64_tr_b16 a[102:103], v20 offset:9216
M v[40:43], a[52:55], a[164:167], v[40:43]
 buffer_load_dwordx4 v17, s[56:59], s29 offen offset:1024   lds
M v[44:47], a[60:63], a[164:167], v[44:47]
 buffer_store_dwordx4 v[96:99], v7, s[8:11], s3 offen offset:0 sc1
M v[44:47], a[56:59], a[160:163], v[44:47]
 ds_read_b64_tr_b16 a[104:105], v21 offset:0
 ds_read_b64_tr_b16 a[106:107], v21 offset:1024
M v[48:51], a[64:67], a[160:163], v[48:51]
M v[48:51], a[68:71], a[164:167], v[48:51]
 buffer_load_dwordx4 v18, s[56:59], s29 offen offset:2048   lds
M v[52:55], a[76:79], a[164:167], v[52:55]
 ds_read_b64_tr_b16 a[108:109], v21 offset:8192
 ds_read_b64_tr_b16 a[110:111], v21 offset:9216
M v[52:55], a[72:75], a[160:163], v[52:55]
M v[56:59], a[80:83], a[160:163], v[56:59]
M v[56:59], a[84:87], a[164:167], v[56:59]
 s_waitcnt lgkmcnt(8)
 ds_read_b64_tr_b16 a[112:113], v22 offset:0
 ds_read_b64_tr_b16 a[114:115], v22 offset:1024
M v[60:63], a[92:95], a[164:167], v[60:63]
 buffer_load_dwordx4 v19, s[56:59], s29 offen offset:3072   lds
M v[60:63], a[88:91], a[160:163], v[60:63]
 s_add_u32 s29, s29, 128
M v[68:71], a[32:35], a[168:171], v[68:71]
 ds_read_b128 a[160:163], v5 offset:4096
 ds_read_b128 a[164:167], v6 offset:4096
M v[68:71], a[36:39], a[172:175], v[68:71]
 ds_read_b64_tr_b16 a[116:117], v22 offset:8192
 ds_read_b64_tr_b16 a[118:119], v22 offset:9216
M v[76:79], a[44:47], a[172:175], v[76:79]
 s_lshl_b32 s28, s20, 13
 buffer_store_dwordx4 v[104:107], v7, s[8:11], s3 offen offset:1024 sc1
M v[76:79], a[40:43], a[168:171], v[76:79]
 s_lshl_b32 s21, s27, 21
 ds_read_b64_tr_b16 a[120:121], v23 offset:0
 ds_read_b64_tr_b16 a[122:123], v23 offset:1024
M v[84:87], a[48:51], a[168:171], v[84:87]
 s_mov_b32 s22, 0
M v[84:87], a[52:55], a[172:175], v[84:87]
 s_add_u32 s21, s21, s92
M v[92:95], a[60:63], a[172:175], v[92:95]
 s_add_u32 s7, s21, 201326592
 ds_read_b64_tr_b16 a[124:125], v23 offset:8192
 ds_read_b64_tr_b16 a[126:127], v23 offset:9216
M v[92:95], a[56:59], a[168:171], v[92:95]
 s_add_u32 s38, s7, 131072
M v[100:103], a[64:67], a[168:171], v[100:103]
 s_add_u32 s64, s42, 1
M v[100:103], a[68:71], a[172:175], v[100:103]
 s_min_u32 s64, s64, 10
M v[108:111], a[76:79], a[172:175], v[108:111]
 s_sub_u32 s27, s64, 3
 buffer_load_dword v24, v13, s[8:11], s46 offen sc1
M v[108:111], a[72:75], a[168:171], v[108:111]
 s_lshl_b32 s6, s64, 1
M v[116:119], a[80:83], a[168:171], v[116:119]
 s_sub_u32 s43, s6, 2
 s_lshl_b32 s64, s42, 17
 s_add_u32 s4, s21, s64
M v[116:119], a[84:87], a[172:175], v[116:119]
 s_waitcnt lgkmcnt(6)
 s_sub_u32 s26, 2228224, s64
 s_add_u32 s26, s26, s21
M v[124:127], a[92:95], a[172:175], v[124:127]
 s_waitcnt vmcnt(20) lgkmcnt(0)
 s_lshl_b32 s64, s42, 1
 s_sub_u32 s64, 32, s64
M v[124:127], a[88:91], a[168:171], v[124:127]
 s_barrier
M v[132:135], a[32:35], a[160:163], v[132:135]
 s_cmp_ge_u32 s42, 10
 ds_read_b128 a[168:171], v5 offset:6144
 ds_read_b128 a[172:175], v6 offset:6144
M v[132:135], a[36:39], a[164:167], v[132:135]
 s_cselect_b32 s25, s64, 32767
 ds_read_b64_tr_b16 a[128:129], v20 offset:16384
 ds_read_b64_tr_b16 a[130:131], v20 offset:17408
M v[140:143], a[44:47], a[164:167], v[140:143]
 s_mov_b32 s23, 0
 buffer_store_dwordx4 v[112:115], v7, s[8:11], s3 offen offset:2048 sc1
M v[140:143], a[40:43], a[160:163], v[140:143]
M v[148:151], a[48:51], a[160:163], v[148:151]
 ds_read_b64_tr_b16 a[132:133], v20 offset:24576
 ds_read_b64_tr_b16 a[134:135], v20 offset:25600
M v[148:151], a[52:55], a[164:167], v[148:151]
M v[156:159], a[60:63], a[164:167], v[156:159]
M v[156:159], a[56:59], a[160:163], v[156:159]
 ds_read_b64_tr_b16 a[136:137], v21 offset:16384
 ds_read_b64_tr_b16 a[138:139], v21 offset:17408
M v[164:167], a[64:67], a[160:163], v[164:167]
M v[164:167], a[68:71], a[164:167], v[164:167]
M v[172:175], a[76:79], a[164:167], v[172:175]
 ds_read_b64_tr_b16 a[140:141], v21 offset:24576
 ds_read_b64_tr_b16 a[142:143], v21 offset:25600
M v[172:175], a[72:75], a[160:163], v[172:175]
M v[180:183], a[80:83], a[160:163], v[180:183]
M v[180:183], a[84:87], a[164:167], v[180:183]
 s_waitcnt lgkmcnt(8)
 ds_read_b64_tr_b16 a[144:145], v22 offset:16384
 ds_read_b64_tr_b16 a[146:147], v22 offset:17408
M v[188:191], a[92:95], a[164:167], v[188:191]
 buffer_store_dwordx4 v[120:123], v7, s[8:11], s3 offen offset:3072 sc1
M v[188:191], a[88:91], a[160:163], v[188:191]
M v[196:199], a[32:35], a[168:171], v[196:199]
 ds_read_b128 a[160:163], v5 offset:16384
 ds_read_b128 a[164:167], v6 offset:16384
M v[196:199], a[36:39], a[172:175], v[196:199]
 ds_read_b64_tr_b16 a[148:149], v22 offset:24576
 ds_read_b64_tr_b16 a[150:151], v22 offset:25600
M v[204:207], a[44:47], a[172:175], v[204:207]
M v[204:207], a[40:43], a[168:171], v[204:207]
 ds_read_b64_tr_b16 a[152:153], v23 offset:16384
 ds_read_b64_tr_b16 a[154:155], v23 offset:17408
M v[212:215], a[48:51], a[168:171], v[212:215]
M v[212:215], a[52:55], a[172:175], v[212:215]
M v[220:223], a[60:63], a[172:175], v[220:223]
 ds_read_b64_tr_b16 a[156:157], v23 offset:24576
 ds_read_b64_tr_b16 a[158:159], v23 offset:25600
M v[220:223], a[56:59], a[168:171], v[220:223]
M v[228:231], a[64:67], a[168:171], v[228:231]
M v[228:231], a[68:71], a[172:175], v[228:231]
M v[236:239], a[76:79], a[172:175], v[236:239]
M v[236:239], a[72:75], a[168:171], v[236:239]
M v[244:247], a[80:83], a[168:171], v[244:247]
M v[244:247], a[84:87], a[172:175], v[244:247]
 s_waitcnt lgkmcnt(6)
M v[252:255], a[92:95], a[172:175], v[252:255]
 s_waitcnt vmcnt(18) lgkmcnt(0)
M v[252:255], a[88:91], a[168:171], v[252:255]
 s_barrier
M v[32:35], a[96:99], a[160:163], v[32:35]
 ds_read_b128 a[168:171], v5 offset:18432
 ds_read_b128 a[172:175], v6 offset:18432
M v[32:35], a[100:103], a[164:167], v[32:35]
 ds_read_b64_tr_b16 a[32:33], v1 offset:0
 ds_read_b64_tr_b16 a[34:35], v1 offset:1024
M v[36:39], a[108:111], a[164:167], v[36:39]
 v_add_u32 v10, s28, v7
 v_add_u32 v10, s28, v10
M v[36:39], a[104:107], a[160:163], v[36:39]
 v_add_u32 v11, 0x1000, v10
 s_waitcnt vmcnt(2)
 v_cmp_eq_u32 vcc, 0, v24
M v[40:43], a[112:115], a[160:163], v[40:43]
 s_lshl_b32 s64, s20, 10
 ds_read_b64_tr_b16 a[36:37], v1 offset:8192
 ds_read_b64_tr_b16 a[38:39], v1 offset:9216
M v[40:43], a[116:119], a[164:167], v[40:43]
 s_cbranch_vccnz L_f1s14
L_f1r14:
 s_add_u32 s3, s93, 1048576
M v[44:47], a[124:127], a[164:167], v[44:47]
 s_add_u32 m0, s28, 98304
 s_nop 0
 buffer_load_dwordx4 v10, s[8:11], s21 offen offset:0 sc1 lds
M v[44:47], a[120:123], a[160:163], v[44:47]
 ds_read_b64_tr_b16 a[40:41], v2 offset:0
 ds_read_b64_tr_b16 a[42:43], v2 offset:1024
M v[48:51], a[128:131], a[160:163], v[48:51]
 buffer_store_dwordx4 v[128:131], v7, s[8:11], s3 offen offset:0 sc1
M v[48:51], a[132:135], a[164:167], v[48:51]
M v[52:55], a[140:143], a[164:167], v[52:55]
 ds_read_b64_tr_b16 a[44:45], v2 offset:8192
 ds_read_b64_tr_b16 a[46:47], v2 offset:9216
M v[52:55], a[136:139], a[160:163], v[52:55]
 buffer_load_dwordx4 v10, s[8:11], s21 offen offset:1024 sc1 lds
M v[56:59], a[144:147], a[160:163], v[56:59]
M v[56:59], a[148:151], a[164:167], v[56:59]
 s_waitcnt lgkmcnt(8)
 ds_read_b64_tr_b16 a[48:49], v3 offset:0
 ds_read_b64_tr_b16 a[50:51], v3 offset:1024
M v[60:63], a[156:159], a[164:167], v[60:63]
M v[60:63], a[152:155], a[160:163], v[60:63]
 buffer_load_dwordx4 v10, s[8:11], s21 offen offset:2048 sc1 lds
M v[68:71], a[96:99], a[168:171], v[68:71]
 ds_read_b128 a[160:163], v5 offset:20480
 ds_read_b128 a[164:167], v6 offset:20480
M v[68:71], a[100:103], a[172:175], v[68:71]
 ds_read_b64_tr_b16 a[52:53], v3 offset:8192
 ds_read_b64_tr_b16 a[54:55], v3 offset:9216
M v[76:79], a[108:111], a[172:175], v[76:79]
 buffer_store_dwordx4 v[136:139], v7, s[8:11], s3 offen offset:1024 sc1
M v[76:79], a[104:107], a[168:171], v[76:79]
 ds_read_b64_tr_b16 a[56:57], v4 offset:0
 ds_read_b64_tr_b16 a[58:59], v4 offset:1024
M v[84:87], a[112:115], a[168:171], v[84:87]
 buffer_load_dwordx4 v10, s[8:11], s21 offen offset:3072 sc1 lds
M v[84:87], a[116:119], a[172:175], v[84:87]
 s_add_u32 m0, s28, 102400
M v[92:95], a[124:127], a[172:175], v[92:95]
 ds_read_b64_tr_b16 a[60:61], v4 offset:8192
 ds_read_b64_tr_b16 a[62:63], v4 offset:9216
M v[92:95], a[120:123], a[168:171], v[92:95]
M v[100:103], a[128:131], a[168:171], v[100:103]
 buffer_load_dwordx4 v11, s[8:11], s21 offen offset:0 sc1 lds
M v[100:103], a[132:135], a[172:175], v[100:103]
M v[108:111], a[140:143], a[172:175], v[108:111]
M v[108:111], a[136:139], a[168:171], v[108:111]
M v[116:119], a[144:147], a[168:171], v[116:119]
 buffer_load_dwordx4 v11, s[8:11], s21 offen offset:1024 sc1 lds
M v[116:119], a[148:151], a[172:175], v[116:119]
 s_waitcnt lgkmcnt(6)
M v[124:127], a[156:159], a[172:175], v[124:127]
 s_waitcnt lgkmcnt(0)
 buffer_load_dwordx4 v11, s[8:11], s21 offen offset:2048 sc1 lds
M v[124:127], a[152:155], a[168:171], v[124:127]
 s_barrier
M v[132:135], a[96:99], a[160:163], v[132:135]
 ds_read_b128 a[168:171], v5 offset:22528
 ds_read_b128 a[172:175], v6 offset:22528
M v[132:135], a[100:103], a[164:167], v[132:135]
 ds_read_b64_tr_b16 a[64:65], v1 offset:16384
 ds_read_b64_tr_b16 a[66:67], v1 offset:17408
M v[140:143], a[108:111], a[164:167], v[140:143]
 buffer_load_dwordx4 v11, s[8:11], s21 offen offset:3072 sc1 lds
M v[140:143], a[104:107], a[160:163], v[140:143]
 s_add_u32 s24, s23, 33554432
 buffer_store_dwordx4 v[144:147], v7, s[8:11], s3 offen offset:2048 sc1
M v[148:151], a[112:115], a[160:163], v[148:151]
 s_mov_b32 s23, s21
 ds_read_b64_tr_b16 a[68:69], v1 offset:24576
 ds_read_b64_tr_b16 a[70:71], v1 offset:25600
M v[148:151], a[116:119], a[164:167], v[148:151]
 s_add_u32 s21, s21, 65536
M v[156:159], a[124:127], a[164:167], v[156:159]
 s_add_u32 s22, s22, 1
M v[156:159], a[120:123], a[160:163], v[156:159]
 s_cmp_eq_u32 s22, s25
 ds_read_b64_tr_b16 a[72:73], v2 offset:16384
 ds_read_b64_tr_b16 a[74:75], v2 offset:17408
M v[164:167], a[128:131], a[160:163], v[164:167]
 s_cselect_b32 s21, s26, s21
 v_subrev_u32 v5, 0x10000, v5
 v_subrev_u32 v6, 0x10000, v6
M v[164:167], a[132:135], a[164:167], v[164:167]
 s_cmp_eq_u32 s22, s43
M v[172:175], a[140:143], a[164:167], v[172:175]
 s_cselect_b32 s21, s4, s21
 ds_read_b64_tr_b16 a[76:77], v2 offset:24576
 ds_read_b64_tr_b16 a[78:79], v2 offset:25600
M v[172:175], a[136:139], a[160:163], v[172:175]
 s_cmp_eq_u32 s22, s6
M v[180:183], a[144:147], a[160:163], v[180:183]
 s_cselect_b32 s21, s7, s21
 v_mov_b32 v9, v25
 v_lshrrev_b32 v24, 4, v0
M v[180:183], a[148:151], a[164:167], v[180:183]
 s_waitcnt lgkmcnt(8)
 ds_read_b64_tr_b16 a[80:81], v3 offset:16384
 ds_read_b64_tr_b16 a[82:83], v3 offset:17408
M v[188:191], a[156:159], a[164:167], v[188:191]
 v_lshlrev_b32 v24, 2, v24
 v_and_b32 v25, 15, v0
M v[188:191], a[152:155], a[160:163], v[188:191]
 v_sub_u32 v24, v24, v25
M v[196:199], a[96:99], a[168:171], v[196:199]
 s_add_u32 s64, s64, s34
 ds_read_b128 a[160:163], v5 offset:32768
 ds_read_b128 a[164:167], v6 offset:32768
M v[196:199], a[100:103], a[172:175], v[196:199]
 s_add_u32 s52, s64, 131072
 ds_read_b64_tr_b16 a[84:85], v3 offset:24576
 ds_read_b64_tr_b16 a[86:87], v3 offset:25600
M v[204:207], a[108:111], a[172:175], v[204:207]
 s_mov_b32 s55, 0x21800000
 buffer_store_dwordx4 v[152:155], v7, s[8:11], s3 offen offset:3072 sc1
M v[204:207], a[104:107], a[168:171], v[204:207]
 s_and_b32 s65, s39, 0xf000000
 ds_read_b64_tr_b16 a[88:89], v4 offset:16384
 ds_read_b64_tr_b16 a[90:91], v4 offset:17408
M v[212:215], a[112:115], a[168:171], v[212:215]
 s_cmp_eq_u32 s20, 0
M v[212:215], a[116:119], a[172:175], v[212:215]
 s_cselect_b32 s54, s39, s65
M v[220:223], a[124:127], a[172:175], v[220:223]
 s_lshr_b32 s64, s20, 1
 ds_read_b64_tr_b16 a[92:93], v4 offset:24576
 ds_read_b64_tr_b16 a[94:95], v4 offset:25600
M v[220:223], a[120:123], a[168:171], v[220:223]
 s_lshl_b32 s64, s64, 17
M v[228:231], a[128:131], a[168:171], v[228:231]
 s_and_b32 s65, s20, 1
M v[228:231], a[132:135], a[172:175], v[228:231]
 s_lshl_b32 s65, s65, 12
M v[236:239], a[140:143], a[172:175], v[236:239]
 s_add_u32 s64, s64, s65
 v_add_u32 v14, s64, v7
 v_mov_b32 v8, 0xff800000
M v[236:239], a[136:139], a[168:171], v[236:239]
 v_cmp_lt_i32 s[16:17], 0, v24
 v_cmp_lt_i32 s[18:19], -1, v24
M v[244:247], a[144:147], a[168:171], v[244:247]
 v_cmp_lt_i32 s[48:49], -2, v24
 v_cmp_lt_i32 s[50:51], -3, v24
M v[244:247], a[148:151], a[172:175], v[244:247]
 s_waitcnt lgkmcnt(6)
M v[252:255], a[156:159], a[172:175], v[252:255]
 s_waitcnt lgkmcnt(0)
M v[252:255], a[152:155], a[168:171], v[252:255]
 s_barrier
M v[32:35], a[32:35], a[160:163], v[32:35]
 ds_read_b128 a[168:171], v5 offset:34816
 ds_read_b128 a[172:175], v6 offset:34816
M v[32:35], a[36:39], a[164:167], v[32:35]
 buffer_load_dword v24, v9, s[8:11], s46 offen sc1
M v[36:39], a[44:47], a[164:167], v[36:39]
 v_mov_b32 v1, v15
 v_add_u32 v2, 0x10000, v7
M v[36:39], a[40:43], a[160:163], v[36:39]
 v_mov_b32 v3, v10
 v_mov_b32 v4, v11
M v[40:43], a[48:51], a[160:163], v[40:43]
 s_mov_b64 s[60:61], s[76:77]
M v[40:43], a[52:55], a[164:167], v[40:43]
 s_mov_b32 s62, s78
M v[44:47], a[60:63], a[164:167], v[44:47]
 s_mov_b32 s63, 0x20000
 v_lshl_add_u32 v10, v0, 7, s95
 v_and_b32 v0, 48, v0
M v[44:47], a[56:59], a[160:163], v[44:47]
 v_lshl_add_u32 v0, v0, 24, v10
 v_mul_f32 v32, s5, v32
M v[48:51], a[64:67], a[160:163], v[48:51]
 v_mul_f32 v33, s5, v33
 v_mul_f32 v34, s5, v34
M v[48:51], a[68:71], a[164:167], v[48:51]
 v_mul_f32 v35, s5, v35
 v_mul_f32 v36, s5, v36
M v[52:55], a[76:79], a[164:167], v[52:55]
 v_mul_f32 v37, s5, v37
 v_mul_f32 v38, s5, v38
M v[52:55], a[72:75], a[160:163], v[52:55]
 v_mul_f32 v39, s5, v39
 v_cvt_pk_bf16_f32 v32, v32, v33
M v[56:59], a[80:83], a[160:163], v[56:59]
 v_cvt_pk_bf16_f32 v33, v34, v35
 v_cvt_pk_bf16_f32 v34, v36, v37
M v[56:59], a[84:87], a[164:167], v[56:59]
 s_waitcnt lgkmcnt(0)
 v_cvt_pk_bf16_f32 v35, v38, v39
 ds_write_b128 v14, v[32:35] offset:0
M v[60:63], a[92:95], a[164:167], v[60:63]
 s_add_u32 s3, s93, 1064960
 buffer_store_dwordx4 v[160:163], v7, s[8:11], s3 offen offset:0 sc1
M v[60:63], a[88:91], a[160:163], v[60:63]
 v_mul_f32 v40, s5, v40
 v_mul_f32 v41, s5, v41
M v[68:71], a[32:35], a[168:171], v[68:71]
 ds_read_b128 a[160:163], v5 offset:36864
 ds_read_b128 a[164:167], v6 offset:36864
M v[68:71], a[36:39], a[172:175], v[68:71]
 v_mul_f32 v42, s5, v42
 v_mul_f32 v43, s5, v43
M v[76:79], a[44:47], a[172:175], v[76:79]
 v_mul_f32 v44, s5, v44
 v_mul_f32 v45, s5, v45
M v[76:79], a[40:43], a[168:171], v[76:79]
 v_mul_f32 v46, s5, v46
 v_mul_f32 v47, s5, v47
M v[84:87], a[48:51], a[168:171], v[84:87]
 v_cvt_pk_bf16_f32 v40, v40, v41
 v_cvt_pk_bf16_f32 v41, v42, v43
M v[84:87], a[52:55], a[172:175], v[84:87]
 v_cvt_pk_bf16_f32 v42, v44, v45
 v_cvt_pk_bf16_f32 v43, v46, v47
M v[92:95], a[60:63], a[172:175], v[92:95]
 ds_write_b128 v14, v[40:43] offset:1024
M v[92:95], a[56:59], a[168:171], v[92:95]
 buffer_store_dwordx4 v[168:171], v7, s[8:11], s3 offen offset:1024 sc1
M v[100:103], a[64:67], a[168:171], v[100:103]
 v_mul_f32 v48, s5, v48
 v_mul_f32 v49, s5, v49
M v[100:103], a[68:71], a[172:175], v[100:103]
 v_mul_f32 v50, s5, v50
 v_mul_f32 v51, s5, v51
M v[108:111], a[76:79], a[172:175], v[108:111]
 v_mul_f32 v52, s5, v52
 v_mul_f32 v53, s5, v53
M v[108:111], a[72:75], a[168:171], v[108:111]
 v_mul_f32 v54, s5, v54
 v_mul_f32 v55, s5, v55
M v[116:119], a[80:83], a[168:171], v[116:119]
 v_cvt_pk_bf16_f32 v48, v48, v49
 v_cvt_pk_bf16_f32 v49, v50, v51
M v[116:119], a[84:87], a[172:175], v[116:119]
 s_waitcnt lgkmcnt(1)
 v_cvt_pk_bf16_f32 v50, v52, v53
 v_cvt_pk_bf16_f32 v51, v54, v55
M v[124:127], a[92:95], a[172:175], v[124:127]
 ds_write_b128 v14, v[48:51] offset:2048
M v[124:127], a[88:91], a[168:171], v[124:127]
 buffer_store_dwordx4 v[176:179], v7, s[8:11], s3 offen offset:2048 sc1
M v[132:135], a[32:35], a[160:163], v[132:135]
 ds_read_b128 a[168:171], v5 offset:38912
 ds_read_b128 a[172:175], v6 offset:38912
M v[132:135], a[36:39], a[164:167], v[132:135]
 v_mul_f32 v56, s5, v56
 v_mul_f32 v57, s5, v57
M v[140:143], a[44:47], a[164:167], v[140:143]
 v_mul_f32 v58, s5, v58
 v_mul_f32 v59, s5, v59
M v[140:143], a[40:43], a[160:163], v[140:143]
 v_mul_f32 v60, s5, v60
 v_mul_f32 v61, s5, v61
M v[148:151], a[48:51], a[160:163], v[148:151]
 v_mul_f32 v62, s5, v62
 v_mul_f32 v63, s5, v63
M v[148:151], a[52:55], a[164:167], v[148:151]
 v_cvt_pk_bf16_f32 v56, v56, v57
 v_cvt_pk_bf16_f32 v57, v58, v59
M v[156:159], a[60:63], a[164:167], v[156:159]
 v_cvt_pk_bf16_f32 v58, v60, v61
 v_cvt_pk_bf16_f32 v59, v62, v63
M v[156:159], a[56:59], a[160:163], v[156:159]
 s_waitcnt lgkmcnt(0)
 ds_write_b128 v14, v[56:59] offset:3072
M v[164:167], a[64:67], a[160:163], v[164:167]
 s_barrier
M v[164:167], a[68:71], a[164:167], v[164:167]
M v[172:175], a[76:79], a[164:167], v[172:175]
 s_add_u32 m0, s28, 32768
 s_nop 0
 buffer_load_dwordx4 v3, s[8:11], s21 offen offset:0 sc1 lds
M v[172:175], a[72:75], a[160:163], v[172:175]
M v[180:183], a[80:83], a[160:163], v[180:183]
 buffer_store_dwordx4 v[184:187], v7, s[8:11], s3 offen offset:3072 sc1
M v[180:183], a[84:87], a[164:167], v[180:183]
 v_mul_f32 v68, s5, v68
 v_mul_f32 v69, s5, v69
M v[188:191], a[92:95], a[164:167], v[188:191]
 buffer_load_dwordx4 v3, s[8:11], s21 offen offset:1024 sc1 lds
M v[188:191], a[88:91], a[160:163], v[188:191]
 v_mul_f32 v70, s5, v70
 v_mul_f32 v71, s5, v71
M v[196:199], a[32:35], a[168:171], v[196:199]
 v_mul_f32 v76, s5, v76
 v_mul_f32 v77, s5, v77
M v[196:199], a[36:39], a[172:175], v[196:199]
 v_mul_f32 v78, s5, v78
 v_mul_f32 v79, s5, v79
M v[204:207], a[44:47], a[172:175], v[204:207]
 buffer_load_dwordx4 v3, s[8:11], s21 offen offset:2048 sc1 lds
M v[204:207], a[40:43], a[168:171], v[204:207]
 v_cvt_pk_bf16_f32 v68, v68, v69
 v_cvt_pk_bf16_f32 v69, v70, v71
M v[212:215], a[48:51], a[168:171], v[212:215]
 v_cvt_pk_bf16_f32 v70, v76, v77
 v_cvt_pk_bf16_f32 v71, v78, v79
M v[212:215], a[52:55], a[172:175], v[212:215]
 ds_write_b128 v14, v[68:71] offset:8192
 v_mul_f32 v84, s5, v84
M v[220:223], a[60:63], a[172:175], v[220:223]
 buffer_load_dwordx4 v3, s[8:11], s21 offen offset:3072 sc1 lds
M v[220:223], a[56:59], a[168:171], v[220:223]
 s_add_u32 m0, s28, 36864
 v_mul_f32 v85, s5, v85
 v_mul_f32 v86, s5, v86
M v[228:231], a[64:67], a[168:171], v[228:231]
 v_mul_f32 v87, s5, v87
 v_mul_f32 v92, s5, v92
M v[228:231], a[68:71], a[172:175], v[228:231]
 v_mul_f32 v93, s5, v93
 v_mul_f32 v94, s5, v94
M v[236:239], a[76:79], a[172:175], v[236:239]
 buffer_load_dwordx4 v4, s[8:11], s21 offen offset:0 sc1 lds
M v[236:239], a[72:75], a[168:171], v[236:239]
 v_mul_f32 v95, s5, v95
 v_cvt_pk_bf16_f32 v84, v84, v85
M v[244:247], a[80:83], a[168:171], v[244:247]
 v_cvt_pk_bf16_f32 v85, v86, v87
 v_cvt_pk_bf16_f32 v86, v92, v93
M v[244:247], a[84:87], a[172:175], v[244:247]
 v_cvt_pk_bf16_f32 v87, v94, v95
 ds_write_b128 v14, v[84:87] offset:9216
M v[252:255], a[92:95], a[172:175], v[252:255]
 buffer_load_dwordx4 v4, s[8:11], s21 offen offset:1024 sc1 lds
M v[252:255], a[88:91], a[168:171], v[252:255]
 buffer_load_dwordx4 v4, s[8:11], s21 offen offset:2048 sc1 lds
 buffer_load_dwordx4 v4, s[8:11], s21 offen offset:3072 sc1 lds
 s_add_u32 s24, s23, 33554432
 s_mov_b32 s23, s21
 s_add_u32 s21, s21, 65536
 s_add_u32 s22, s22, 1
 s_cmp_eq_u32 s22, s25
 s_cselect_b32 s21, s26, s21
 s_cmp_eq_u32 s22, s43
 s_cselect_b32 s21, s4, s21
 s_cmp_eq_u32 s22, s6
 s_cselect_b32 s21, s7, s21
 v_mul_f32 v100, s5, v100
 v_mul_f32 v101, s5, v101
 v_mul_f32 v102, s5, v102
 v_mul_f32 v103, s5, v103
 v_mul_f32 v108, s5, v108
 v_mul_f32 v109, s5, v109
 v_mul_f32 v110, s5, v110
 v_mul_f32 v111, s5, v111
 v_cvt_pk_bf16_f32 v100, v100, v101
 v_cvt_pk_bf16_f32 v101, v102, v103
 v_cvt_pk_bf16_f32 v102, v108, v109
 v_cvt_pk_bf16_f32 v103, v110, v111
 ds_write_b128 v14, v[100:103] offset:10240
 v_pk_mul_f32 v[116:117], v[116:117], s[4:5] op_sel:[0,1] op_sel_hi:[1,1]
 v_pk_mul_f32 v[118:119], v[118:119], s[4:5] op_sel:[0,1] op_sel_hi:[1,1]
 v_pk_mul_f32 v[124:125], v[124:125], s[4:5] op_sel:[0,1] op_sel_hi:[1,1]
 v_pk_mul_f32 v[126:127], v[126:127], s[4:5] op_sel:[0,1] op_sel_hi:[1,1]
 v_cvt_pk_bf16_f32 v116, v116, v117
 v_cvt_pk_bf16_f32 v117, v118, v119
 v_cvt_pk_bf16_f32 v118, v124, v125
 v_cvt_pk_bf16_f32 v119, v126, v127
 ds_write_b128 v14, v[116:119] offset:11264
 v_pk_mul_f32 v[132:133], v[132:133], s[4:5] op_sel:[0,1] op_sel_hi:[1,1]
 v_pk_mul_f32 v[134:135], v[134:135], s[4:5] op_sel:[0,1] op_sel_hi:[1,1]
 v_pk_mul_f32 v[140:141], v[140:141], s[4:5] op_sel:[0,1] op_sel_hi:[1,1]
 v_pk_mul_f32 v[142:143], v[142:143], s[4:5] op_sel:[0,1] op_sel_hi:[1,1]
 v_cvt_pk_bf16_f32 v132, v132, v133
 v_cvt_pk_bf16_f32 v133, v134, v135
 v_cvt_pk_bf16_f32 v134, v140, v141
 v_cvt_pk_bf16_f32 v135, v142, v143
 ds_write_b128 v14, v[132:135] offset:16384
 v_pk_mul_f32 v[148:149], v[148:149], s[4:5] op_sel:[0,1] op_sel_hi:[1,1]
 v_pk_mul_f32 v[150:151], v[150:151], s[4:5] op_sel:[0,1] op_sel_hi:[1,1]
 v_pk_mul_f32 v[156:157], v[156:157], s[4:5] op_sel:[0,1] op_sel_hi:[1,1]
 v_pk_mul_f32 v[158:159], v[158:159], s[4:5] op_sel:[0,1] op_sel_hi:[1,1]
 v_cvt_pk_bf16_f32 v148, v148, v149
 v_cvt_pk_bf16_f32 v149, v150, v151
 v_cvt_pk_bf16_f32 v150, v156, v157
 v_cvt_pk_bf16_f32 v151, v158, v159
 ds_write_b128 v14, v[148:151] offset:17408
 v_pk_mul_f32 v[164:165], v[164:165], s[4:5] op_sel:[0,1] op_sel_hi:[1,1]
 v_pk_mul_f32 v[166:167], v[166:167], s[4:5] op_sel:[0,1] op_sel_hi:[1,1]
 v_pk_mul_f32 v[172:173], v[172:173], s[4:5] op_sel:[0,1] op_sel_hi:[1,1]
 v_pk_mul_f32 v[174:175], v[174:175], s[4:5] op_sel:[0,1] op_sel_hi:[1,1]
 v_cvt_pk_bf16_f32 v164, v164, v165
 v_cvt_pk_bf16_f32 v165, v166, v167
 v_cvt_pk_bf16_f32 v166, v172, v173
 v_cvt_pk_bf16_f32 v167, v174, v175
 ds_write_b128 v14, v[164:167] offset:18432
 v_pk_mul_f32 v[180:181], v[180:181], s[4:5] op_sel:[0,1] op_sel_hi:[1,1]
 v_pk_mul_f32 v[182:183], v[182:183], s[4:5] op_sel:[0,1] op_sel_hi:[1,1]
 v_pk_mul_f32 v[188:189], v[188:189], s[4:5] op_sel:[0,1] op_sel_hi:[1,1]
 v_pk_mul_f32 v[190:191], v[190:191], s[4:5] op_sel:[0,1] op_sel_hi:[1,1]
 v_cvt_pk_bf16_f32 v180, v180, v181
 v_cvt_pk_bf16_f32 v181, v182, v183
 v_cvt_pk_bf16_f32 v182, v188, v189
 v_cvt_pk_bf16_f32 v183, v190, v191
 ds_write_b128 v14, v[180:183] offset:19456
 v_pk_mul_f32 v[196:197], v[196:197], s[4:5] op_sel:[0,1] op_sel_hi:[1,1]
 v_pk_mul_f32 v[198:199], v[198:199], s[4:5] op_sel:[0,1] op_sel_hi:[1,1]
 v_pk_mul_f32 v[204:205], v[204:205], s[4:5] op_sel:[0,1] op_sel_hi:[1,1]
 v_pk_mul_f32 v[206:207], v[206:207], s[4:5] op_sel:[0,1] op_sel_hi:[1,1]
 v_cvt_pk_bf16_f32 v196, v196, v197
 v_cvt_pk_bf16_f32 v197, v198, v199
 v_cvt_pk_bf16_f32 v198, v204, v205
 v_cvt_pk_bf16_f32 v199, v206, v207
 ds_write_b128 v14, v[196:199] offset:24576
 v_pk_mul_f32 v[212:213], v[212:213], s[4:5] op_sel:[0,1] op_sel_hi:[1,1]
 v_pk_mul_f32 v[214:215], v[214:215], s[4:5] op_sel:[0,1] op_sel_hi:[1,1]
 v_pk_mul_f32 v[220:221], v[220:221], s[4:5] op_sel:[0,1] op_sel_hi:[1,1]
 v_pk_mul_f32 v[222:223], v[222:223], s[4:5] op_sel:[0,1] op_sel_hi:[1,1]
 v_cvt_pk_bf16_f32 v212, v212, v213
 v_cvt_pk_bf16_f32 v213, v214, v215
 v_cvt_pk_bf16_f32 v214, v220, v221
 v_cvt_pk_bf16_f32 v215, v222, v223
 ds_write_b128 v14, v[212:215] offset:25600
 v_pk_mul_f32 v[228:229], v[228:229], s[4:5] op_sel:[0,1] op_sel_hi:[1,1]
 v_pk_mul_f32 v[230:231], v[230:231], s[4:5] op_sel:[0,1] op_sel_hi:[1,1]
 v_pk_mul_f32 v[236:237], v[236:237], s[4:5] op_sel:[0,1] op_sel_hi:[1,1]
 v_pk_mul_f32 v[238:239], v[238:239], s[4:5] op_sel:[0,1] op_sel_hi:[1,1]
 v_cvt_pk_bf16_f32 v228, v228, v229
 v_cvt_pk_bf16_f32 v229, v230, v231
 v_cvt_pk_bf16_f32 v230, v236, v237
 v_cvt_pk_bf16_f32 v231, v238, v239
 ds_write_b128 v14, v[228:231] offset:26624
 v_pk_mul_f32 v[244:245], v[244:245], s[4:5] op_sel:[0,1] op_sel_hi:[1,1]
 v_pk_mul_f32 v[246:247], v[246:247], s[4:5] op_sel:[0,1] op_sel_hi:[1,1]
 v_pk_mul_f32 v[252:253], v[252:253], s[4:5] op_sel:[0,1] op_sel_hi:[1,1]
 v_pk_mul_f32 v[254:255], v[254:255], s[4:5] op_sel:[0,1] op_sel_hi:[1,1]
 v_cvt_pk_bf16_f32 v244, v244, v245
 v_cvt_pk_bf16_f32 v245, v246, v247
 v_cvt_pk_bf16_f32 v246, v252, v253
 v_cvt_pk_bf16_f32 v247, v254, v255
 ds_write_b128 v14, v[244:247] offset:27648
 s_waitcnt vmcnt(15) lgkmcnt(0)
 s_barrier
 ds_read_b128 a[64:67], v2 offset:32768
 ds_read_b128 a[68:71], v2 offset:33792
 ds_read_b128 a[72:75], v2 offset:34816
 ds_read_b128 a[76:79], v2 offset:35840
 ds_read_b128 a[80:83], v2 offset:36864
 ds_read_b128 a[84:87], v2 offset:37888
 ds_read_b128 a[88:91], v2 offset:38912
 ds_read_b128 a[92:95], v2 offset:39936
 s_lshl_b32 s64, s20, 13
 s_sub_u32 s65, 155648, s64
 v_add_u32 v10, s64, v7
 v_add_u32 v11, s65, v7
 ds_read_b128 a[0:3], v10 offset:0
 ds_read_b128 a[4:7], v10 offset:1024
 ds_read_b128 a[8:11], v10 offset:2048
 ds_read_b128 a[12:15], v10 offset:3072
 ds_read_b128 a[16:19], v10 offset:4096
 ds_read_b128 a[20:23], v10 offset:5120
 ds_read_b128 a[24:27], v10 offset:6144
 ds_read_b128 a[28:31], v10 offset:7168
 ds_read_b128 a[32:35], v11 offset:0
 ds_read_b128 a[36:39], v11 offset:1024
 ds_read_b128 a[40:43], v11 offset:2048
 ds_read_b128 a[44:47], v11 offset:3072
 ds_read_b128 a[48:51], v11 offset:4096
 ds_read_b128 a[52:55], v11 offset:5120
 ds_read_b128 a[56:59], v11 offset:6144
 ds_read_b128 a[60:63], v11 offset:7168
 s_waitcnt vmcnt(12)
 v_cmp_eq_u32 vcc, 0, v24
 v_mov_b32 v17, 3
 v_or_b32 v6, s35, v7
 s_cbranch_vccnz L_f1s15
L_f1r15:
 s_mov_b32 s30, s93
 s_add_u32 s29, s94, s92
 s_cmp_eq_u32 s20, 0
 s_cselect_b32 s5, 5, 0
 v_mov_b32 v32, 0xc1800000
 v_mov_b32 v33, 0xc1800000
 v_mov_b32 v34, 0xc1800000
 v_mov_b32 v35, 0xc1800000
 v_mov_b32 v36, 0xc1800000
 v_mov_b32 v37, 0xc1800000
 v_mov_b32 v38, 0xc1800000
 v_mov_b32 v39, 0xc1800000
 s_waitcnt lgkmcnt(0)
M v[64:67], a[64:67], a[0:3], v[32:35]
 ds_read_b128 a[96:99], v2 offset:40960
 v_mov_b32 v30, 0
M v[64:67], a[68:71], a[4:7], v[64:67]
 s_add_u32 m0, s28, 65536
 ds_read_b128 a[100:103], v2 offset:41984
 v_mov_b32 v31, 0
M v[64:67], a[72:75], a[8:11], v[64:67]
 buffer_load_dwordx4 v3, s[8:11], s24 offen offset:0 sc1 lds
M v[64:67], a[76:79], a[12:15], v[64:67]
 ds_read_b128 a[104:107], v2 offset:43008
 v_accvgpr_write_b32 a128, v192
M v[64:67], a[80:83], a[16:19], v[64:67]
 ds_read_b128 a[108:111], v2 offset:44032
 v_accvgpr_write_b32 a129, v193
M v[64:67], a[84:87], a[20:23], v[64:67]
 buffer_load_dwordx4 v3, s[8:11], s24 offen offset:1024 sc1 lds
M v[64:67], a[88:91], a[24:27], v[64:67]
 ds_read_b128 a[112:115], v2 offset:45056
 v_accvgpr_write_b32 a130, v194
M v[64:67], a[92:95], a[28:31], v[64:67]
 ds_read_b128 a[116:119], v2 offset:46080
 v_accvgpr_write_b32 a131, v195
M v[68:71], a[92:95], a[60:63], v[36:39]
 v_accvgpr_write_b32 a132, v200
 v_accvgpr_write_b32 a133, v201
M v[68:71], a[88:91], a[56:59], v[68:71]
 ds_read_b128 a[120:123], v2 offset:47104
 v_accvgpr_write_b32 a134, v202
M v[68:71], a[84:87], a[52:55], v[68:71]
 ds_read_b128 a[124:127], v2 offset:48128
 v_accvgpr_write_b32 a135, v203
M v[68:71], a[80:83], a[48:51], v[68:71]
 buffer_load_dwordx4 v3, s[8:11], s24 offen offset:2048 sc1 lds
M v[68:71], a[76:79], a[44:47], v[68:71]
 v_accvgpr_write_b32 a136, v208
 v_accvgpr_write_b32 a137, v209
M v[68:71], a[72:75], a[40:43], v[68:71]
 v_accvgpr_write_b32 a138, v210
 v_accvgpr_write_b32 a139, v211
M v[68:71], a[68:71], a[36:39], v[68:71]
 v_exp_f32 v18, v64
M v[68:71], a[64:67], a[32:35], v[68:71]
 s_waitcnt lgkmcnt(0)
 v_exp_f32 v19, v65
M v[72:75], a[96:99], a[0:3], v[32:35]
 ds_read_b128 a[64:67], v2 offset:49152
 v_add_f32 v26, v18, v19
M v[72:75], a[100:103], a[4:7], v[72:75]
 ds_read_b128 a[68:71], v2 offset:50176
 v_cvt_pk_bf16_f32 v40, v18, v19
M v[72:75], a[104:107], a[8:11], v[72:75]
 buffer_load_dwordx4 v3, s[8:11], s24 offen offset:3072 sc1 lds
M v[72:75], a[108:111], a[12:15], v[72:75]
 ds_read_b128 a[72:75], v2 offset:51200
 v_accvgpr_write_b32 a140, v216
M v[72:75], a[112:115], a[16:19], v[72:75]
 s_add_u32 m0, s28, 69632
 ds_read_b128 a[76:79], v2 offset:52224
 v_accvgpr_write_b32 a141, v217
M v[72:75], a[116:119], a[20:23], v[72:75]
 buffer_load_dwordx4 v4, s[8:11], s24 offen offset:0 sc1 lds
M v[72:75], a[120:123], a[24:27], v[72:75]
 ds_read_b128 a[80:83], v2 offset:53248
 v_accvgpr_write_b32 a142, v218
M v[72:75], a[124:127], a[28:31], v[72:75]
 s_add_u32 s3, s32, 0
 ds_read_b128 a[84:87], v2 offset:54272
 v_accvgpr_write_b32 a143, v219
M v[76:79], a[124:127], a[60:63], v[36:39]
 buffer_store_dwordx4 a[0:3], v6, s[8:11], s3 offen offset:0 sc1
M v[76:79], a[120:123], a[56:59], v[76:79]
 ds_read_b128 a[88:91], v2 offset:55296
 v_accvgpr_write_b32 a144, v224
M v[76:79], a[116:119], a[52:55], v[76:79]
 ds_read_b128 a[92:95], v2 offset:56320
 v_accvgpr_write_b32 a145, v225
M v[76:79], a[112:115], a[48:51], v[76:79]
 buffer_load_dwordx4 v4, s[8:11], s24 offen offset:1024 sc1 lds
M v[76:79], a[108:111], a[44:47], v[76:79]
 v_exp_f32 v20, v66
M v[76:79], a[104:107], a[40:43], v[76:79]
 buffer_store_dwordx4 a[4:7], v6, s[8:11], s3 offen offset:1024 sc1
M v[76:79], a[100:103], a[36:39], v[76:79]
 v_exp_f32 v21, v67
M v[76:79], a[96:99], a[32:35], v[76:79]
 s_waitcnt lgkmcnt(0)
 v_exp_f32 v22, v68
M v[80:83], a[64:67], a[0:3], v[32:35]
 ds_read_b128 a[96:99], v2 offset:57344
 v_add_f32 v26, v20, v26
M v[80:83], a[68:71], a[4:7], v[80:83]
 ds_read_b128 a[100:103], v2 offset:58368
 v_cvt_pk_bf16_f32 v41, v20, v21
M v[80:83], a[72:75], a[8:11], v[80:83]
 buffer_load_dwordx4 v4, s[8:11], s24 offen offset:2048 sc1 lds
M v[80:83], a[76:79], a[12:15], v[80:83]
 ds_read_b128 a[104:107], v2 offset:59392
 v_add_f32 v26, v21, v26
M v[80:83], a[80:83], a[16:19], v[80:83]
 ds_read_b128 a[108:111], v2 offset:60416
 v_accvgpr_write_b32 a146, v226
M v[80:83], a[84:87], a[20:23], v[80:83]
 buffer_store_dwordx4 a[8:11], v6, s[8:11], s3 offen offset:2048 sc1
M v[80:83], a[88:91], a[24:27], v[80:83]
 ds_read_b128 a[112:115], v2 offset:61440
 v_accvgpr_write_b32 a147, v227
M v[80:83], a[92:95], a[28:31], v[80:83]
 ds_read_b128 a[116:119], v2 offset:62464
 v_accvgpr_write_b32 a148, v232
M v[84:87], a[92:95], a[60:63], v[36:39]
 buffer_load_dwordx4 v4, s[8:11], s24 offen offset:3072 sc1 lds
M v[84:87], a[88:91], a[56:59], v[84:87]
 ds_read_b128 a[120:123], v2 offset:63488
 v_accvgpr_write_b32 a149, v233
M v[84:87], a[84:87], a[52:55], v[84:87]
 ds_read_b128 a[124:127], v2 offset:64512
 v_accvgpr_write_b32 a150, v234
M v[84:87], a[80:83], a[48:51], v[84:87]
 buffer_store_dwordx4 a[12:15], v6, s[8:11], s3 offen offset:3072 sc1
M v[84:87], a[76:79], a[44:47], v[84:87]
 s_add_u32 s3, s32, 4096
 v_exp_f32 v23, v69
M v[84:87], a[72:75], a[40:43], v[84:87]
 buffer_store_dwordx4 a[16:19], v6, s[8:11], s3 offen offset:0 sc1
M v[84:87], a[68:71], a[36:39], v[84:87]
 s_waitcnt vmcnt(13) lgkmcnt(0)
 v_exp_f32 v24, v70
M v[84:87], a[64:67], a[32:35], v[84:87]
 s_barrier
M v[88:91], a[96:99], a[0:3], v[32:35]
 ds_read_b128 a[64:67], v7 offset:32768
 v_add_f32 v27, v22, v23
M v[88:91], a[100:103], a[4:7], v[88:91]
 ds_read_b128 a[68:71], v7 offset:33792
 v_cvt_pk_bf16_f32 v44, v22, v23
M v[88:91], a[104:107], a[8:11], v[88:91]
 buffer_store_dword v17, v1, s[8:11], s45 offen sc1
M v[88:91], a[108:111], a[12:15], v[88:91]
 ds_read_b128 a[72:75], v7 offset:34816
 v_accvgpr_write_b32 a151, v235
M v[88:91], a[112:115], a[16:19], v[88:91]
 ds_read_b128 a[76:79], v7 offset:35840
 v_accvgpr_write_b32 a152, v240
M v[88:91], a[116:119], a[20:23], v[88:91]
 buffer_store_dwordx4 a[20:23], v6, s[8:11], s3 offen offset:1024 sc1
M v[88:91], a[120:123], a[24:27], v[88:91]
 ds_read_b128 a[80:83], v7 offset:36864
 v_accvgpr_write_b32 a153, v241
M v[88:91], a[124:127], a[28:31], v[88:91]
 ds_read_b128 a[84:87], v7 offset:37888
 v_accvgpr_write_b32 a154, v242
M v[92:95], a[124:127], a[60:63], v[36:39]
 buffer_store_dwordx4 a[24:27], v6, s[8:11], s3 offen offset:2048 sc1
M v[92:95], a[120:123], a[56:59], v[92:95]
 ds_read_b128 a[88:91], v7 offset:38912
 v_accvgpr_write_b32 a155, v243
M v[92:95], a[116:119], a[52:55], v[92:95]
 ds_read_b128 a[92:95], v7 offset:39936
 v_accvgpr_write_b32 a156, v248
M v[92:95], a[112:115], a[48:51], v[92:95]
 buffer_store_dwordx4 a[28:31], v6, s[8:11], s3 offen offset:3072 sc1
M v[92:95], a[108:111], a[44:47], v[92:95]
 v_exp_f32 v25, v71
M v[92:95], a[104:107], a[40:43], v[92:95]
 v_exp_f32 v18, v72
M v[92:95], a[100:103], a[36:39], v[92:95]
 s_waitcnt lgkmcnt(0)
 v_exp_f32 v19, v73
M v[92:95], a[96:99], a[32:35], v[92:95]
 v_exp_f32 v20, v74
M v[96:99], a[64:67], a[0:3], v[32:35]
 s_add_u32 m0, s28, 98304
 ds_read_b128 a[96:99], v7 offset:40960
 ds_read_b128 a[100:103], v7 offset:41984
M v[96:99], a[68:71], a[4:7], v[96:99]
 buffer_load_dwordx4 v3, s[8:11], s21 offen offset:0 sc1 lds
M v[96:99], a[72:75], a[8:11], v[96:99]
 v_exp_f32 v21, v75
M v[96:99], a[76:79], a[12:15], v[96:99]
 s_add_u32 s3, s32, 16384
 ds_read_b128 a[104:107], v7 offset:43008
 ds_read_b128 a[108:111], v7 offset:44032
M v[96:99], a[80:83], a[16:19], v[96:99]
 buffer_store_dwordx4 a[32:35], v6, s[8:11], s3 offen offset:0 sc1
M v[96:99], a[84:87], a[20:23], v[96:99]
 v_exp_f32 v22, v76
M v[96:99], a[88:91], a[24:27], v[96:99]
 ds_read_b128 a[112:115], v7 offset:45056
 ds_read_b128 a[116:119], v7 offset:46080
M v[96:99], a[92:95], a[28:31], v[96:99]
 buffer_load_dwordx4 v3, s[8:11], s21 offen offset:1024 sc1 lds
M v[100:103], a[92:95], a[60:63], v[36:39]
 v_exp_f32 v23, v77
M v[100:103], a[88:91], a[56:59], v[100:103]
 ds_read_b128 a[120:123], v7 offset:47104
 ds_read_b128 a[124:127], v7 offset:48128
M v[100:103], a[84:87], a[52:55], v[100:103]
 buffer_store_dwordx4 a[36:39], v6, s[8:11], s3 offen offset:1024 sc1
M v[100:103], a[80:83], a[48:51], v[100:103]
 v_add_f32 v27, v24, v27
 v_cvt_pk_bf16_f32 v45, v24, v25
M v[100:103], a[76:79], a[44:47], v[100:103]
 buffer_load_dwordx4 v3, s[8:11], s21 offen offset:2048 sc1 lds
M v[100:103], a[72:75], a[40:43], v[100:103]
 v_add_f32 v27, v25, v27
 v_add_f32 v26, v18, v26
M v[100:103], a[68:71], a[36:39], v[100:103]
 v_exp_f32 v24, v78
M v[100:103], a[64:67], a[32:35], v[100:103]
 s_waitcnt lgkmcnt(0)
 v_exp_f32 v25, v79
M v[108:111], a[96:99], a[32:35], v[36:39]
 ds_read_b128 a[64:67], v7 offset:49152
 ds_read_b128 a[68:71], v7 offset:50176
M v[108:111], a[100:103], a[36:39], v[108:111]
 buffer_load_dwordx4 v3, s[8:11], s21 offen offset:3072 sc1 lds
M v[108:111], a[104:107], a[40:43], v[108:111]
 v_cvt_pk_bf16_f32 v42, v18, v19
 v_add_f32 v26, v19, v26
M v[108:111], a[108:111], a[44:47], v[108:111]
 ds_read_b128 a[72:75], v7 offset:51200
 ds_read_b128 a[76:79], v7 offset:52224
M v[108:111], a[112:115], a[48:51], v[108:111]
 buffer_store_dwordx4 a[40:43], v6, s[8:11], s3 offen offset:2048 sc1
M v[108:111], a[116:119], a[52:55], v[108:111]
 v_exp_f32 v18, v80
M v[108:111], a[120:123], a[56:59], v[108:111]
 s_add_u32 m0, s28, 102400
 ds_read_b128 a[80:83], v7 offset:53248
 ds_read_b128 a[84:87], v7 offset:54272
M v[108:111], a[124:127], a[60:63], v[108:111]
 buffer_load_dwordx4 v4, s[8:11], s21 offen offset:0 sc1 lds
M v[104:107], a[124:127], a[28:31], v[32:35]
 v_exp_f32 v19, v81
M v[104:107], a[120:123], a[24:27], v[104:107]
 ds_read_b128 a[88:91], v7 offset:55296
 ds_read_b128 a[92:95], v7 offset:56320
M v[104:107], a[116:119], a[20:23], v[104:107]
 buffer_store_dwordx4 a[44:47], v6, s[8:11], s3 offen offset:3072 sc1
M v[104:107], a[112:115], a[16:19], v[104:107]
 v_add_f32 v26, v20, v26
 v_cvt_pk_bf16_f32 v43, v20, v21
M v[104:107], a[108:111], a[12:15], v[104:107]
 buffer_load_dwordx4 v4, s[8:11], s21 offen offset:1024 sc1 lds
M v[104:107], a[104:107], a[8:11], v[104:107]
 s_add_u32 s3, s32, 20480
 v_add_f32 v26, v21, v26
 v_add_f32 v27, v22, v27
M v[104:107], a[100:103], a[4:7], v[104:107]
 buffer_store_dwordx4 a[48:51], v6, s[8:11], s3 offen offset:0 sc1
M v[104:107], a[96:99], a[0:3], v[104:107]
 s_waitcnt lgkmcnt(0)
 v_exp_f32 v20, v82
M v[112:115], a[64:67], a[0:3], v[32:35]
 ds_read_b128 a[96:99], v7 offset:57344
 ds_read_b128 a[100:103], v7 offset:58368
M v[112:115], a[68:71], a[4:7], v[112:115]
 buffer_load_dwordx4 v4, s[8:11], s21 offen offset:2048 sc1 lds
M v[112:115], a[72:75], a[8:11], v[112:115]
 v_exp_f32 v21, v83
M v[112:115], a[76:79], a[12:15], v[112:115]
 ds_read_b128 a[104:107], v7 offset:59392
 ds_read_b128 a[108:111], v7 offset:60416
M v[112:115], a[80:83], a[16:19], v[112:115]
 buffer_load_dwordx4 v4, s[8:11], s21 offen offset:3072 sc1 lds
M v[112:115], a[84:87], a[20:23], v[112:115]
 s_add_u32 s24, s23, 33554432
 v_cvt_pk_bf16_f32 v46, v22, v23
 v_add_f32 v27, v23, v27
M v[112:115], a[88:91], a[24:27], v[112:115]
 s_mov_b32 s23, s21
 ds_read_b128 a[112:115], v7 offset:61440
 ds_read_b128 a[116:119], v7 offset:62464
M v[112:115], a[92:95], a[28:31], v[112:115]
 buffer_store_dwordx4 a[52:55], v6, s[8:11], s3 offen offset:1024 sc1
M v[116:119], a[92:95], a[60:63], v[36:39]
 s_add_u32 s21, s21, 65536
 v_add_f32 v27, v24, v27
M v[116:119], a[88:91], a[56:59], v[116:119]
 s_add_u32 s22, s22, 1
 ds_read_b128 a[120:123], v7 offset:63488
 ds_read_b128 a[124:127], v7 offset:64512
M v[116:119], a[84:87], a[52:55], v[116:119]
 s_cmp_eq_u32 s22, s25
 v_exp_f32 v22, v88
M v[116:119], a[80:83], a[48:51], v[116:119]
 s_cselect_b32 s21, s26, s21
 v_exp_f32 v23, v89
M v[116:119], a[76:79], a[44:47], v[116:119]
 buffer_store_dwordx4 a[56:59], v6, s[8:11], s3 offen offset:2048 sc1
M v[116:119], a[72:75], a[40:43], v[116:119]
 s_cmp_eq_u32 s22, s43
 v_cvt_pk_bf16_f32 v47, v24, v25
 v_add_f32 v27, v25, v27
M v[116:119], a[68:71], a[36:39], v[116:119]
 s_waitcnt vmcnt(21) lgkmcnt(0)
 v_exp_f32 v24, v90
M v[116:119], a[64:67], a[32:35], v[116:119]
 s_barrier
M v[124:127], a[96:99], a[32:35], v[36:39]
 s_cselect_b32 s21, s4, s21
 ds_read_b128 a[64:67], v2 offset:0
 ds_read_b128 a[68:71], v2 offset:1024
M v[124:127], a[100:103], a[36:39], v[124:127]
 s_cmp_eq_u32 s22, s6
 v_exp_f32 v25, v91
M v[124:127], a[104:107], a[40:43], v[124:127]
 s_cselect_b32 s21, s7, s21
 v_add_f32 v26, v18, v26
 v_cvt_pk_bf16_f32 v56, v18, v19
M v[124:127], a[108:111], a[44:47], v[124:127]
 ds_read_b128 a[72:75], v2 offset:2048
 ds_read_b128 a[76:79], v2 offset:3072
M v[124:127], a[112:115], a[48:51], v[124:127]
 buffer_store_dwordx4 a[60:63], v6, s[8:11], s3 offen offset:3072 sc1
M v[124:127], a[116:119], a[52:55], v[124:127]
 v_add_f32 v26, v19, v26
 v_add_f32 v26, v20, v26
M v[124:127], a[120:123], a[56:59], v[124:127]
 ds_read_b128 a[80:83], v2 offset:4096
 ds_read_b128 a[84:87], v2 offset:5120
M v[124:127], a[124:127], a[60:63], v[124:127]
 v_exp_f32 v18, v84
M v[120:123], a[124:127], a[28:31], v[32:35]
 v_exp_f32 v19, v85
M v[120:123], a[120:123], a[24:27], v[120:123]
 ds_read_b128 a[88:91], v2 offset:6144
 ds_read_b128 a[92:95], v2 offset:7168
M v[120:123], a[116:119], a[20:23], v[120:123]
 v_cvt_pk_bf16_f32 v57, v20, v21
 v_add_f32 v26, v21, v26
M v[120:123], a[112:115], a[16:19], v[120:123]
 v_exp_f32 v20, v86
M v[120:123], a[108:111], a[12:15], v[120:123]
 v_exp_f32 v21, v87
M v[120:123], a[104:107], a[8:11], v[120:123]
 v_add_f32 v26, v22, v26
 v_cvt_pk_bf16_f32 v58, v22, v23
M v[120:123], a[100:103], a[4:7], v[120:123]
 s_waitcnt lgkmcnt(0)
 v_add_f32 v26, v23, v26
 v_add_f32 v26, v24, v26
M v[120:123], a[96:99], a[0:3], v[120:123]
 v_exp_f32 v22, v92
 v_cvt_pk_bf16_f32 v59, v24, v25
 v_add_f32 v26, v25, v26
 v_add_f32 v27, v18, v27
 v_cvt_pk_bf16_f32 v60, v18, v19
 v_add_f32 v27, v19, v27
 v_exp_f32 v23, v93
 v_add_f32 v27, v20, v27
 v_cvt_pk_bf16_f32 v61, v20, v21
 v_add_f32 v27, v21, v27
 v_exp_f32 v24, v94
 v_add_f32 v27, v22, v27
 v_cvt_pk_bf16_f32 v62, v22, v23
 v_exp_f32 v25, v95
 v_add_f32 v27, v23, v27
 v_add_f32 v27, v24, v27
 v_cvt_pk_bf16_f32 v63, v24, v25
 v_add_f32 v27, v25, v27
 v_max_f32 v10, v26, v27
 v_min_f32 v11, v26, v27
 v_cmp_lt_f32 s[36:37], s31, v10
 v_cmp_gt_f32 vcc, s55, v11
 s_nop 0
 s_or_b64 vcc, vcc, s[36:37]
 s_cbranch_vccnz L_st8
L_rt8:
M v[128:131], a[64:67], v[40:43], 0
 s_add_u32 m0, s28, 0
 ds_read_b128 a[96:99], v2 offset:8192
 ds_read_b128 a[100:103], v2 offset:9216
M v[128:131], a[68:71], v[56:59], v[128:131]
 buffer_load_dwordx4 v3, s[8:11], s24 offen offset:0 sc1 lds
M v[132:135], a[68:71], v[60:63], 0
 v_accvgpr_write_b32 a157, v249
 v_accvgpr_write_b32 a158, v250
M v[132:135], a[64:67], v[44:47], v[132:135]
 ds_read_b128 a[104:107], v2 offset:10240
 ds_read_b128 a[108:111], v2 offset:11264
M v[140:143], a[72:75], v[44:47], 0
 buffer_load_dwordx4 v3, s[8:11], s24 offen offset:1024 sc1 lds
M v[140:143], a[76:79], v[60:63], v[140:143]
 v_accvgpr_write_b32 a159, v251
 v_add_f32 v30, v26, v30
M v[136:139], a[76:79], v[56:59], 0
 ds_read_b128 a[112:115], v2 offset:12288
 ds_read_b128 a[116:119], v2 offset:13312
M v[136:139], a[72:75], v[40:43], v[136:139]
 buffer_load_dwordx4 v3, s[8:11], s24 offen offset:2048 sc1 lds
M v[144:147], a[80:83], v[40:43], 0
 v_exp_f32 v18, v96
M v[144:147], a[84:87], v[56:59], v[144:147]
 ds_read_b128 a[120:123], v2 offset:14336
 ds_read_b128 a[124:127], v2 offset:15360
M v[148:151], a[84:87], v[60:63], 0
 buffer_load_dwordx4 v3, s[8:11], s24 offen offset:3072 sc1 lds
M v[148:151], a[80:83], v[44:47], v[148:151]
 s_add_u32 m0, s28, 4096
 v_exp_f32 v19, v97
M v[156:159], a[88:91], v[44:47], 0
 buffer_load_dwordx4 v4, s[8:11], s24 offen offset:0 sc1 lds
M v[156:159], a[92:95], v[60:63], v[156:159]
 v_exp_f32 v20, v98
M v[152:155], a[92:95], v[56:59], 0
 v_exp_f32 v21, v99
M v[152:155], a[88:91], v[40:43], v[152:155]
 s_waitcnt lgkmcnt(0)
 v_exp_f32 v22, v104
M v[160:163], a[96:99], v[40:43], 0
 ds_read_b128 a[64:67], v2 offset:16384
 ds_read_b128 a[68:71], v2 offset:17408
M v[160:163], a[100:103], v[56:59], v[160:163]
 buffer_load_dwordx4 v4, s[8:11], s24 offen offset:1024 sc1 lds
M v[164:167], a[100:103], v[60:63], 0
 v_exp_f32 v23, v105
M v[164:167], a[96:99], v[44:47], v[164:167]
 ds_read_b128 a[72:75], v2 offset:18432
 ds_read_b128 a[76:79], v2 offset:19456
M v[172:175], a[104:107], v[44:47], 0
 buffer_load_dwordx4 v4, s[8:11], s24 offen offset:2048 sc1 lds
M v[172:175], a[108:111], v[60:63], v[172:175]
 v_add_f32 v31, v27, v31
 v_add_f32 v28, v18, v19
M v[168:171], a[108:111], v[56:59], 0
 ds_read_b128 a[80:83], v2 offset:20480
 ds_read_b128 a[84:87], v2 offset:21504
M v[168:171], a[104:107], v[40:43], v[168:171]
 buffer_load_dwordx4 v4, s[8:11], s24 offen offset:3072 sc1 lds
M v[176:179], a[112:115], v[40:43], 0
 v_exp_f32 v24, v106
M v[176:179], a[116:119], v[56:59], v[176:179]
 s_add_u32 m0, s28, 32768
 ds_read_b128 a[88:91], v2 offset:22528
 ds_read_b128 a[92:95], v2 offset:23552
M v[180:183], a[116:119], v[60:63], 0
 buffer_load_dwordx4 v3, s[8:11], s21 offen offset:0 sc1 lds
M v[180:183], a[112:115], v[44:47], v[180:183]
 v_exp_f32 v25, v107
M v[188:191], a[120:123], v[44:47], 0
 buffer_load_dwordx4 v3, s[8:11], s21 offen offset:1024 sc1 lds
M v[188:191], a[124:127], v[60:63], v[188:191]
 v_cvt_pk_bf16_f32 v48, v18, v19
 v_add_f32 v28, v20, v28
M v[184:187], a[124:127], v[56:59], 0
 buffer_load_dwordx4 v3, s[8:11], s21 offen offset:2048 sc1 lds
M v[184:187], a[120:123], v[40:43], v[184:187]
 s_waitcnt lgkmcnt(0)
 v_exp_f32 v18, v100
M v[192:195], a[64:67], v[40:43], 0
 ds_read_b128 a[96:99], v2 offset:24576
 ds_read_b128 a[100:103], v2 offset:25600
M v[192:195], a[68:71], v[56:59], v[192:195]
 buffer_load_dwordx4 v3, s[8:11], s21 offen offset:3072 sc1 lds
M v[196:199], a[68:71], v[60:63], 0
 v_exp_f32 v19, v101
M v[196:199], a[64:67], v[44:47], v[196:199]
 s_add_u32 m0, s28, 36864
 ds_read_b128 a[104:107], v2 offset:26624
 ds_read_b128 a[108:111], v2 offset:27648
M v[204:207], a[72:75], v[44:47], 0
 buffer_load_dwordx4 v4, s[8:11], s21 offen offset:0 sc1 lds
M v[204:207], a[76:79], v[60:63], v[204:207]
 v_cvt_pk_bf16_f32 v49, v20, v21
 v_add_f32 v28, v21, v28
M v[200:203], a[76:79], v[56:59], 0
 ds_read_b128 a[112:115], v2 offset:28672
 ds_read_b128 a[116:119], v2 offset:29696
M v[200:203], a[72:75], v[40:43], v[200:203]
 buffer_load_dwordx4 v4, s[8:11], s21 offen offset:1024 sc1 lds
M v[208:211], a[80:83], v[40:43], 0
 v_exp_f32 v20, v102
M v[208:211], a[84:87], v[56:59], v[208:211]
 ds_read_b128 a[120:123], v2 offset:30720
 ds_read_b128 a[124:127], v2 offset:31744
M v[212:215], a[84:87], v[60:63], 0
 buffer_load_dwordx4 v4, s[8:11], s21 offen offset:2048 sc1 lds
M v[212:215], a[80:83], v[44:47], v[212:215]
 v_exp_f32 v21, v103
M v[220:223], a[88:91], v[44:47], 0
 v_add_f32 v28, v22, v28
 v_cvt_pk_bf16_f32 v50, v22, v23
M v[220:223], a[92:95], v[60:63], v[220:223]
 buffer_load_dwordx4 v4, s[8:11], s21 offen offset:3072 sc1 lds
M v[216:219], a[92:95], v[56:59], 0
 s_waitcnt vmcnt(16) lgkmcnt(0)
 s_add_u32 s24, s23, 33554432
 s_mov_b32 s23, s21
M v[216:219], a[88:91], v[40:43], v[216:219]
 s_barrier
M v[224:227], a[96:99], v[40:43], 0
 ds_read_b128 a[64:67], v2 offset:32768
 ds_read_b128 a[68:71], v2 offset:33792
M v[224:227], a[100:103], v[56:59], v[224:227]
 s_xor_b32 s3, s47, 64
 v_mov_b32 v5, 1
M v[228:231], a[100:103], v[60:63], 0
 v_min_u32 v6, 1, v7
 v_lshlrev_b32 v6, 29, v6
M v[228:231], a[96:99], v[44:47], v[228:231]
 ds_read_b128 a[72:75], v2 offset:34816
 ds_read_b128 a[76:79], v2 offset:35840
M v[236:239], a[104:107], v[44:47], 0
 v_or_b32 v6, s35, v6
 s_add_u32 s21, s21, 65536
M v[236:239], a[108:111], v[60:63], v[236:239]
 buffer_store_dword v5, v6, s[8:11], s3 offen sc1
M v[232:235], a[108:111], v[56:59], 0
 ds_read_b128 a[80:83], v2 offset:36864
 ds_read_b128 a[84:87], v2 offset:37888
M v[232:235], a[104:107], v[40:43], v[232:235]
 s_add_u32 s22, s22, 1
 v_add_f32 v28, v23, v28
M v[240:243], a[112:115], v[40:43], 0
 s_cmp_eq_u32 s22, s25
 v_exp_f32 v22, v108
M v[240:243], a[116:119], v[56:59], v[240:243]
 s_cselect_b32 s21, s26, s21
 ds_read_b128 a[88:91], v2 offset:38912
 ds_read_b128 a[92:95], v2 offset:39936
M v[244:247], a[116:119], v[60:63], 0
 s_cmp_eq_u32 s22, s43
 v_exp_f32 v23, v109
M v[244:247], a[112:115], v[44:47], v[244:247]
 s_cselect_b32 s21, s4, s21
 v_add_f32 v28, v24, v28
 v_cvt_pk_bf16_f32 v51, v24, v25
M v[252:255], a[120:123], v[44:47], 0
 s_cmp_eq_u32 s22, s6
 v_add_f32 v28, v25, v28
 v_add_f32 v29, v18, v19
M v[252:255], a[124:127], v[60:63], v[252:255]
 s_cselect_b32 s21, s7, s21
 v_exp_f32 v24, v110
M v[248:251], a[124:127], v[56:59], 0
 s_waitcnt lgkmcnt(0)
 v_exp_f32 v25, v111
M v[248:251], a[120:123], v[40:43], v[248:251]
 v_cvt_pk_bf16_f32 v52, v18, v19
 v_add_f32 v29, v20, v29
 v_cvt_pk_bf16_f32 v53, v20, v21
 v_add_f32 v29, v21, v29
 v_add_f32 v29, v22, v29
 v_cvt_pk_bf16_f32 v54, v22, v23
 v_add_f32 v29, v23, v29
 v_add_f32 v29, v24, v29
 v_cvt_pk_bf16_f32 v55, v24, v25
 v_add_f32 v29, v25, v29
M v[64:67], a[64:67], a[0:3], v[32:35]
 s_add_u32 m0, s28, 65536
 ds_read_b128 a[96:99], v2 offset:40960
 ds_read_b128 a[100:103], v2 offset:41984
M v[64:67], a[68:71], a[4:7], v[64:67]
 buffer_load_dwordx4 v3, s[8:11], s24 offen offset:0 sc1 lds
M v[64:67], a[72:75], a[8:11], v[64:67]
 v_exp_f32 v18, v112
M v[64:67], a[76:79], a[12:15], v[64:67]
 s_add_u32 s3, s30, 1572864
 ds_read_b128 a[104:107], v2 offset:43008
 ds_read_b128 a[108:111], v2 offset:44032
M v[64:67], a[80:83], a[16:19], v[64:67]
 buffer_store_dwordx4 a[128:131], v7, s[8:11], s3 offen offset:0 sc1
M v[64:67], a[84:87], a[20:23], v[64:67]
 v_exp_f32 v19, v113
M v[64:67], a[88:91], a[24:27], v[64:67]
 ds_read_b128 a[112:115], v2 offset:45056
 ds_read_b128 a[116:119], v2 offset:46080
M v[64:67], a[92:95], a[28:31], v[64:67]
 buffer_load_dwordx4 v3, s[8:11], s24 offen offset:1024 sc1 lds
M v[68:71], a[92:95], a[60:63], v[36:39]
 v_exp_f32 v20, v114
M v[68:71], a[88:91], a[56:59], v[68:71]
 ds_read_b128 a[120:123], v2 offset:47104
 ds_read_b128 a[124:127], v2 offset:48128
M v[68:71], a[84:87], a[52:55], v[68:71]
 v_exp_f32 v21, v115
M v[68:71], a[80:83], a[48:51], v[68:71]
 v_add_f32 v28, v18, v28
 v_cvt_pk_bf16_f32 v56, v18, v19
M v[68:71], a[76:79], a[44:47], v[68:71]
 v_add_f32 v28, v19, v28
 v_add_f32 v28, v20, v28
M v[68:71], a[72:75], a[40:43], v[68:71]
 buffer_load_dwordx4 v3, s[8:11], s24 offen offset:2048 sc1 lds
M v[68:71], a[68:71], a[36:39], v[68:71]
 v_exp_f32 v22, v120
M v[68:71], a[64:67], a[32:35], v[68:71]
 s_waitcnt lgkmcnt(0)
 v_cvt_pk_bf16_f32 v57, v20, v21
 v_add_f32 v28, v21, v28
M v[76:79], a[96:99], a[32:35], v[36:39]
 ds_read_b128 a[64:67], v2 offset:49152
 ds_read_b128 a[68:71], v2 offset:50176
M v[76:79], a[100:103], a[36:39], v[76:79]
 buffer_store_dwordx4 a[132:135], v7, s[8:11], s3 offen offset:1024 sc1
M v[76:79], a[104:107], a[40:43], v[76:79]
 v_exp_f32 v23, v121
M v[76:79], a[108:111], a[44:47], v[76:79]
 ds_read_b128 a[72:75], v2 offset:51200
 ds_read_b128 a[76:79], v2 offset:52224
M v[76:79], a[112:115], a[48:51], v[76:79]
 buffer_load_dwordx4 v3, s[8:11], s24 offen offset:3072 sc1 lds
M v[76:79], a[116:119], a[52:55], v[76:79]
 v_exp_f32 v24, v122
M v[76:79], a[120:123], a[56:59], v[76:79]
 ds_read_b128 a[80:83], v2 offset:53248
 ds_read_b128 a[84:87], v2 offset:54272
M v[76:79], a[124:127], a[60:63], v[76:79]
 v_add_f32 v28, v22, v28
 v_cvt_pk_bf16_f32 v58, v22, v23
M v[72:75], a[124:127], a[28:31], v[32:35]
 v_exp_f32 v25, v123
M v[72:75], a[120:123], a[24:27], v[72:75]
 s_add_u32 m0, s28, 69632
 ds_read_b128 a[88:91], v2 offset:55296
 ds_read_b128 a[92:95], v2 offset:56320
M v[72:75], a[116:119], a[20:23], v[72:75]
 buffer_load_dwordx4 v4, s[8:11], s24 offen offset:0 sc1 lds
M v[72:75], a[112:115], a[16:19], v[72:75]
 v_add_f32 v28, v23, v28
 v_add_f32 v28, v24, v28
M v[72:75], a[108:111], a[12:15], v[72:75]
 v_exp_f32 v18, v116
M v[72:75], a[104:107], a[8:11], v[72:75]
 v_cvt_pk_bf16_f32 v59, v24, v25
 v_add_f32 v28, v25, v28
M v[72:75], a[100:103], a[4:7], v[72:75]
M v[72:75], a[96:99], a[0:3], v[72:75]
 s_waitcnt lgkmcnt(0)
 v_exp_f32 v19, v117
M v[80:83], a[64:67], a[0:3], v[32:35]
 ds_read_b128 a[96:99], v2 offset:57344
 ds_read_b128 a[100:103], v2 offset:58368
M v[80:83], a[68:71], a[4:7], v[80:83]
 buffer_store_dwordx4 a[136:139], v7, s[8:11], s3 offen offset:2048 sc1
M v[80:83], a[72:75], a[8:11], v[80:83]
 v_add_f32 v29, v18, v29
 v_cvt_pk_bf16_f32 v60, v18, v19
M v[80:83], a[76:79], a[12:15], v[80:83]
 ds_read_b128 a[104:107], v2 offset:59392
 ds_read_b128 a[108:111], v2 offset:60416
M v[80:83], a[80:83], a[16:19], v[80:83]
 buffer_load_dwordx4 v4, s[8:11], s24 offen offset:1024 sc1 lds
M v[80:83], a[84:87], a[20:23], v[80:83]
 v_exp_f32 v20, v118
M v[80:83], a[88:91], a[24:27], v[80:83]
 ds_read_b128 a[112:115], v2 offset:61440
 ds_read_b128 a[116:119], v2 offset:62464
M v[80:83], a[92:95], a[28:31], v[80:83]
 buffer_load_dwordx4 v4, s[8:11], s24 offen offset:2048 sc1 lds
M v[84:87], a[92:95], a[60:63], v[36:39]
 v_exp_f32 v21, v119
M v[84:87], a[88:91], a[56:59], v[84:87]
 ds_read_b128 a[120:123], v2 offset:63488
 ds_read_b128 a[124:127], v2 offset:64512
M v[84:87], a[84:87], a[52:55], v[84:87]
 v_exp_f32 v22, v124
M v[84:87], a[80:83], a[48:51], v[84:87]
 buffer_load_dwordx4 v4, s[8:11], s24 offen offset:3072 sc1 lds
M v[84:87], a[76:79], a[44:47], v[84:87]
 v_add_f32 v29, v19, v29
 v_add_f32 v29, v20, v29
M v[84:87], a[72:75], a[40:43], v[84:87]
 buffer_store_dwordx4 a[140:143], v7, s[8:11], s3 offen offset:3072 sc1
M v[84:87], a[68:71], a[36:39], v[84:87]
 s_waitcnt vmcnt(21) lgkmcnt(0)
 v_exp_f32 v23, v125
M v[84:87], a[64:67], a[32:35], v[84:87]
 s_barrier
M v[92:95], a[96:99], a[32:35], v[36:39]
 ds_read_b128 a[64:67], v7 offset:0
 ds_read_b128 a[68:71], v7 offset:1024
M v[92:95], a[100:103], a[36:39], v[92:95]
 v_exp_f32 v24, v126
M v[92:95], a[104:107], a[40:43], v[92:95]
 v_cvt_pk_bf16_f32 v61, v20, v21
 v_add_f32 v29, v21, v29
M v[92:95], a[108:111], a[44:47], v[92:95]
 ds_read_b128 a[72:75], v7 offset:2048
 ds_read_b128 a[76:79], v7 offset:3072
M v[92:95], a[112:115], a[48:51], v[92:95]
 v_exp_f32 v25, v127
M v[92:95], a[116:119], a[52:55], v[92:95]
 v_add_f32 v29, v22, v29
 v_cvt_pk_bf16_f32 v62, v22, v23
M v[92:95], a[120:123], a[56:59], v[92:95]
 ds_read_b128 a[80:83], v7 offset:4096
 ds_read_b128 a[84:87], v7 offset:5120
M v[92:95], a[124:127], a[60:63], v[92:95]
 v_add_f32 v29, v23, v29
 v_add_f32 v29, v24, v29
M v[88:91], a[124:127], a[28:31], v[32:35]
 v_cvt_pk_bf16_f32 v63, v24, v25
 v_add_f32 v29, v25, v29
M v[88:91], a[120:123], a[24:27], v[88:91]
 ds_read_b128 a[88:91], v7 offset:6144
 ds_read_b128 a[92:95], v7 offset:7168
M v[88:91], a[116:119], a[20:23], v[88:91]
 v_max_f32 v10, v28, v29
M v[88:91], a[112:115], a[16:19], v[88:91]
 v_cmp_lt_f32 vcc, s31, v10
M v[88:91], a[108:111], a[12:15], v[88:91]
M v[88:91], a[104:107], a[8:11], v[88:91]
M v[88:91], a[100:103], a[4:7], v[88:91]
 s_waitcnt lgkmcnt(0)
M v[88:91], a[96:99], a[0:3], v[88:91]
 s_cbranch_vccnz L_st9
L_rt9:
M v[128:131], a[64:67], v[48:51], v[128:131]
 s_add_u32 m0, s28, 98304
 ds_read_b128 a[96:99], v7 offset:8192
 ds_read_b128 a[100:103], v7 offset:9216
M v[128:131], a[68:71], v[56:59], v[128:131]
 buffer_load_dwordx4 v3, s[8:11], s21 offen offset:0 sc1 lds
M v[132:135], a[68:71], v[60:63], v[132:135]
 v_exp_f32 v18, v64
M v[132:135], a[64:67], v[52:55], v[132:135]
 s_add_u32 s3, s30, 1589248
 ds_read_b128 a[104:107], v7 offset:10240
 ds_read_b128 a[108:111], v7 offset:11264
M v[140:143], a[72:75], v[52:55], v[140:143]
 buffer_store_dwordx4 a[144:147], v7, s[8:11], s3 offen offset:0 sc1
M v[140:143], a[76:79], v[60:63], v[140:143]
 v_exp_f32 v19, v65
M v[136:139], a[76:79], v[56:59], v[136:139]
 ds_read_b128 a[112:115], v7 offset:12288
 ds_read_b128 a[116:119], v7 offset:13312
M v[136:139], a[72:75], v[48:51], v[136:139]
 buffer_load_dwordx4 v3, s[8:11], s21 offen offset:1024 sc1 lds
M v[144:147], a[80:83], v[48:51], v[144:147]
 v_exp_f32 v20, v66
M v[144:147], a[84:87], v[56:59], v[144:147]
 ds_read_b128 a[120:123], v7 offset:14336
 ds_read_b128 a[124:127], v7 offset:15360
M v[148:151], a[84:87], v[60:63], v[148:151]
 v_add_f32 v30, v28, v30
 v_add_f32 v31, v29, v31
M v[148:151], a[80:83], v[52:55], v[148:151]
 buffer_load_dwordx4 v3, s[8:11], s21 offen offset:2048 sc1 lds
M v[156:159], a[88:91], v[52:55], v[156:159]
 v_exp_f32 v21, v67
M v[156:159], a[92:95], v[60:63], v[156:159]
 v_add_f32 v26, v18, v19
 v_cvt_pk_bf16_f32 v40, v18, v19
M v[152:155], a[92:95], v[56:59], v[152:155]
 v_exp_f32 v22, v72
M v[152:155], a[88:91], v[48:51], v[152:155]
 s_waitcnt lgkmcnt(0)
 v_add_f32 v26, v20, v26
 v_cvt_pk_bf16_f32 v41, v20, v21
M v[160:163], a[96:99], v[48:51], v[160:163]
 ds_read_b128 a[64:67], v7 offset:16384
 ds_read_b128 a[68:71], v7 offset:17408
M v[160:163], a[100:103], v[56:59], v[160:163]
 buffer_store_dwordx4 a[148:151], v7, s[8:11], s3 offen offset:1024 sc1
M v[164:167], a[100:103], v[60:63], v[164:167]
 v_exp_f32 v23, v73
M v[164:167], a[96:99], v[52:55], v[164:167]
 ds_read_b128 a[72:75], v7 offset:18432
 ds_read_b128 a[76:79], v7 offset:19456
M v[172:175], a[104:107], v[52:55], v[172:175]
 buffer_load_dwordx4 v3, s[8:11], s21 offen offset:3072 sc1 lds
M v[172:175], a[108:111], v[60:63], v[172:175]
 v_add_f32 v26, v21, v26
 v_add_f32 v26, v22, v26
M v[168:171], a[108:111], v[56:59], v[168:171]
 s_add_u32 m0, s28, 102400
 ds_read_b128 a[80:83], v7 offset:20480
 ds_read_b128 a[84:87], v7 offset:21504
M v[168:171], a[104:107], v[48:51], v[168:171]
 buffer_load_dwordx4 v4, s[8:11], s21 offen offset:0 sc1 lds
M v[176:179], a[112:115], v[48:51], v[176:179]
 v_exp_f32 v24, v74
M v[176:179], a[116:119], v[56:59], v[176:179]
 ds_read_b128 a[88:91], v7 offset:22528
 ds_read_b128 a[92:95], v7 offset:23552
M v[180:183], a[116:119], v[60:63], v[180:183]
 v_exp_f32 v25, v75
M v[180:183], a[112:115], v[52:55], v[180:183]
 buffer_load_dwordx4 v4, s[8:11], s21 offen offset:1024 sc1 lds
M v[188:191], a[120:123], v[52:55], v[188:191]
 v_cvt_pk_bf16_f32 v42, v22, v23
 v_add_f32 v26, v23, v26
M v[188:191], a[124:127], v[60:63], v[188:191]
 v_exp_f32 v18, v68
M v[184:187], a[124:127], v[56:59], v[184:187]
 v_add_f32 v26, v24, v26
 v_cvt_pk_bf16_f32 v43, v24, v25
M v[184:187], a[120:123], v[48:51], v[184:187]
 s_waitcnt lgkmcnt(0)
 v_add_f32 v26, v25, v26
M v[192:195], a[64:67], v[48:51], v[192:195]
 ds_read_b128 a[96:99], v7 offset:24576
 ds_read_b128 a[100:103], v7 offset:25600
M v[192:195], a[68:71], v[56:59], v[192:195]
 buffer_store_dwordx4 a[152:155], v7, s[8:11], s3 offen offset:2048 sc1
M v[196:199], a[68:71], v[60:63], v[196:199]
 v_exp_f32 v19, v69
M v[196:199], a[64:67], v[52:55], v[196:199]
 ds_read_b128 a[104:107], v7 offset:26624
 ds_read_b128 a[108:111], v7 offset:27648
M v[204:207], a[72:75], v[52:55], v[204:207]
 buffer_load_dwordx4 v4, s[8:11], s21 offen offset:2048 sc1 lds
M v[204:207], a[76:79], v[60:63], v[204:207]
 v_exp_f32 v20, v70
M v[200:203], a[76:79], v[56:59], v[200:203]
 ds_read_b128 a[112:115], v7 offset:28672
 ds_read_b128 a[116:119], v7 offset:29696
M v[200:203], a[72:75], v[48:51], v[200:203]
 buffer_load_dwordx4 v4, s[8:11], s21 offen offset:3072 sc1 lds
M v[208:211], a[80:83], v[48:51], v[208:211]
 s_add_u32 s24, s23, 33554432
 v_exp_f32 v21, v71
M v[208:211], a[84:87], v[56:59], v[208:211]
 s_mov_b32 s23, s21
 ds_read_b128 a[120:123], v7 offset:30720
 ds_read_b128 a[124:127], v7 offset:31744
M v[212:215], a[84:87], v[60:63], v[212:215]
 s_add_u32 s21, s21, 65536
 v_add_f32 v27, v18, v19
 v_cvt_pk_bf16_f32 v44, v18, v19
M v[212:215], a[80:83], v[52:55], v[212:215]
 s_add_u32 s22, s22, 1
 v_add_f32 v27, v20, v27
 v_cvt_pk_bf16_f32 v45, v20, v21
M v[220:223], a[88:91], v[52:55], v[220:223]
 s_cmp_eq_u32 s22, s25
 v_exp_f32 v22, v76
M v[220:223], a[92:95], v[60:63], v[220:223]
 buffer_store_dwordx4 a[156:159], v7, s[8:11], s3 offen offset:3072 sc1
M v[216:219], a[92:95], v[56:59], v[216:219]
 s_waitcnt vmcnt(25) lgkmcnt(0)
 v_add_f32 v27, v21, v27
M v[216:219], a[88:91], v[48:51], v[216:219]
 s_barrier
M v[224:227], a[96:99], v[48:51], v[224:227]
 s_cselect_b32 s21, s26, s21
 ds_read_b128 a[64:67], v7 offset:32768
 ds_read_b128 a[68:71], v7 offset:33792
M v[224:227], a[100:103], v[56:59], v[224:227]
 s_cmp_eq_u32 s22, s43
 v_exp_f32 v23, v77
M v[228:231], a[100:103], v[60:63], v[228:231]
 s_cselect_b32 s21, s4, s21
 v_add_f32 v27, v22, v27
 v_cvt_pk_bf16_f32 v46, v22, v23
M v[228:231], a[96:99], v[52:55], v[228:231]
 s_cmp_eq_u32 s22, s6
 ds_read_b128 a[72:75], v7 offset:34816
 ds_read_b128 a[76:79], v7 offset:35840
M v[236:239], a[104:107], v[52:55], v[236:239]
 s_cselect_b32 s21, s7, s21
 v_exp_f32 v24, v78
M v[236:239], a[108:111], v[60:63], v[236:239]
 v_add_f32 v27, v23, v27
M v[232:235], a[108:111], v[56:59], v[232:235]
 ds_read_b128 a[80:83], v7 offset:36864
 ds_read_b128 a[84:87], v7 offset:37888
M v[232:235], a[104:107], v[48:51], v[232:235]
 v_exp_f32 v25, v79
M v[240:243], a[112:115], v[48:51], v[240:243]
 v_add_f32 v27, v24, v27
 v_cvt_pk_bf16_f32 v47, v24, v25
M v[240:243], a[116:119], v[56:59], v[240:243]
 ds_read_b128 a[88:91], v7 offset:38912
 ds_read_b128 a[92:95], v7 offset:39936
M v[244:247], a[116:119], v[60:63], v[244:247]
 v_add_f32 v27, v25, v27
M v[244:247], a[112:115], v[52:55], v[244:247]
M v[252:255], a[120:123], v[52:55], v[252:255]
M v[252:255], a[124:127], v[60:63], v[252:255]
M v[248:251], a[124:127], v[56:59], v[248:251]
 s_waitcnt lgkmcnt(0)
M v[248:251], a[120:123], v[48:51], v[248:251]
M v[96:99], a[64:67], a[0:3], v[32:35]
 s_add_u32 m0, s28, 0
 ds_read_b128 a[96:99], v7 offset:40960
M v[96:99], a[68:71], a[4:7], v[96:99]
 ds_read_b128 a[100:103], v7 offset:41984
M v[96:99], a[72:75], a[8:11], v[96:99]
 buffer_load_dword v6, v9, s[8:11], s46 offen sc1
M v[96:99], a[76:79], a[12:15], v[96:99]
 s_cmp_eq_u32 s20, 0
 ds_read_b128 a[104:107], v7 offset:43008
M v[96:99], a[80:83], a[16:19], v[96:99]
 s_cselect_b64 s[64:65], s[16:17], 0
 ds_read_b128 a[108:111], v7 offset:44032
M v[96:99], a[84:87], a[20:23], v[96:99]
 buffer_load_dwordx4 v3, s[8:11], s24 offen offset:0 sc1 lds
M v[96:99], a[88:91], a[24:27], v[96:99]
 s_cselect_b64 s[66:67], s[18:19], 0
 ds_read_b128 a[112:115], v7 offset:45056
M v[96:99], a[92:95], a[28:31], v[96:99]
 s_cselect_b64 s[68:69], s[48:49], 0
 ds_read_b128 a[116:119], v7 offset:46080
M v[100:103], a[92:95], a[60:63], v[36:39]
 buffer_load_dwordx4 v3, s[8:11], s24 offen offset:1024 sc1 lds
M v[100:103], a[88:91], a[56:59], v[100:103]
 s_cselect_b64 s[70:71], s[50:51], 0
 ds_read_b128 a[120:123], v7 offset:47104
M v[100:103], a[84:87], a[52:55], v[100:103]
 s_cmp_lt_u32 s20, 1
 ds_read_b128 a[124:127], v7 offset:48128
M v[100:103], a[80:83], a[48:51], v[100:103]
 s_cselect_b64 s[78:79], -1, 0
 v_exp_f32 v18, v80
M v[100:103], a[76:79], a[44:47], v[100:103]
 buffer_load_dwordx4 v3, s[8:11], s24 offen offset:2048 sc1 lds
M v[100:103], a[72:75], a[40:43], v[100:103]
 s_cmp_eq_u32 s20, 1
 v_exp_f32 v19, v81
M v[100:103], a[68:71], a[36:39], v[100:103]
 s_cselect_b64 s[72:73], s[16:17], s[78:79]
 v_exp_f32 v20, v82
M v[100:103], a[64:67], a[32:35], v[100:103]
 s_waitcnt lgkmcnt(0)
 v_exp_f32 v21, v83
M v[108:111], a[96:99], a[32:35], v[36:39]
 s_cselect_b64 s[74:75], s[18:19], s[78:79]
 ds_read_b128 a[64:67], v7 offset:49152
 v_add_f32 v26, v18, v26
M v[108:111], a[100:103], a[36:39], v[108:111]
 s_cselect_b64 s[76:77], s[48:49], s[78:79]
 ds_read_b128 a[68:71], v7 offset:50176
 v_cvt_pk_bf16_f32 v56, v18, v19
M v[108:111], a[104:107], a[40:43], v[108:111]
 buffer_load_dwordx4 v3, s[8:11], s24 offen offset:3072 sc1 lds
M v[108:111], a[108:111], a[44:47], v[108:111]
 s_cselect_b64 s[78:79], s[50:51], s[78:79]
 ds_read_b128 a[72:75], v7 offset:51200
 v_add_f32 v26, v19, v26
M v[108:111], a[112:115], a[48:51], v[108:111]
 s_add_u32 s3, s29, 0
 ds_read_b128 a[76:79], v7 offset:52224
 v_add_f32 v26, v20, v26
M v[108:111], a[116:119], a[52:55], v[108:111]
 buffer_store_dwordx4 a[192:195], v7, s[8:11], s3 offen sc1
M v[108:111], a[120:123], a[56:59], v[108:111]
 s_add_u32 m0, s28, 4096
 ds_read_b128 a[80:83], v7 offset:53248
 v_cvt_pk_bf16_f32 v57, v20, v21
M v[108:111], a[124:127], a[60:63], v[108:111]
 ds_read_b128 a[84:87], v7 offset:54272
 v_add_f32 v26, v21, v26
M v[104:107], a[124:127], a[28:31], v[32:35]
 buffer_load_dwordx4 v4, s[8:11], s24 offen offset:0 sc1 lds
M v[104:107], a[120:123], a[24:27], v[104:107]
 ds_read_b128 a[88:91], v7 offset:55296
M v[104:107], a[116:119], a[20:23], v[104:107]
 ds_read_b128 a[92:95], v7 offset:56320
M v[104:107], a[112:115], a[16:19], v[104:107]
 v_exp_f32 v22, v88
M v[104:107], a[108:111], a[12:15], v[104:107]
 buffer_load_dwordx4 v4, s[8:11], s24 offen offset:1024 sc1 lds
M v[104:107], a[104:107], a[8:11], v[104:107]
 v_exp_f32 v23, v89
M v[104:107], a[100:103], a[4:7], v[104:107]
 v_exp_f32 v24, v90
M v[104:107], a[96:99], a[0:3], v[104:107]
 s_waitcnt lgkmcnt(0)
 v_exp_f32 v25, v91
M v[112:115], a[64:67], a[0:3], v[32:35]
 s_add_u32 s3, s29, 65536
 ds_read_b128 a[96:99], v7 offset:57344
 v_add_f32 v26, v22, v26
M v[112:115], a[68:71], a[4:7], v[112:115]
 ds_read_b128 a[100:103], v7 offset:58368
 v_cvt_pk_bf16_f32 v58, v22, v23
M v[112:115], a[72:75], a[8:11], v[112:115]
 buffer_load_dwordx4 v4, s[8:11], s24 offen offset:2048 sc1 lds
M v[112:115], a[76:79], a[12:15], v[112:115]
 ds_read_b128 a[104:107], v7 offset:59392
 v_add_f32 v26, v23, v26
M v[112:115], a[80:83], a[16:19], v[112:115]
 ds_read_b128 a[108:111], v7 offset:60416
 v_add_f32 v26, v24, v26
M v[112:115], a[84:87], a[20:23], v[112:115]
 buffer_store_dwordx4 a[196:199], v7, s[8:11], s3 offen sc1
M v[112:115], a[88:91], a[24:27], v[112:115]
 ds_read_b128 a[112:115], v7 offset:61440
 v_cvt_pk_bf16_f32 v59, v24, v25
M v[112:115], a[92:95], a[28:31], v[112:115]
 ds_read_b128 a[116:119], v7 offset:62464
 v_add_f32 v26, v25, v26
M v[116:119], a[92:95], a[60:63], v[36:39]
 buffer_load_dwordx4 v4, s[8:11], s24 offen offset:3072 sc1 lds
M v[116:119], a[88:91], a[56:59], v[116:119]
 ds_read_b128 a[120:123], v7 offset:63488
M v[116:119], a[84:87], a[52:55], v[116:119]
 ds_read_b128 a[124:127], v7 offset:64512
M v[116:119], a[80:83], a[48:51], v[116:119]
 v_exp_f32 v18, v84
M v[116:119], a[76:79], a[44:47], v[116:119]
 v_exp_f32 v19, v85
M v[116:119], a[72:75], a[40:43], v[116:119]
 v_exp_f32 v20, v86
M v[116:119], a[68:71], a[36:39], v[116:119]
 s_waitcnt vmcnt(24) lgkmcnt(0)
 v_exp_f32 v21, v87
M v[116:119], a[64:67], a[32:35], v[116:119]
 s_barrier
M v[124:127], a[96:99], a[32:35], v[36:39]
 ds_read_b128 a[64:67], v2 offset:0
 v_add_f32 v27, v18, v27
M v[124:127], a[100:103], a[36:39], v[124:127]
 ds_read_b128 a[68:71], v2 offset:1024
 v_cvt_pk_bf16_f32 v60, v18, v19
M v[124:127], a[104:107], a[40:43], v[124:127]
 v_exp_f32 v22, v92
M v[124:127], a[108:111], a[44:47], v[124:127]
 ds_read_b128 a[72:75], v2 offset:2048
 v_add_f32 v27, v19, v27
M v[124:127], a[112:115], a[48:51], v[124:127]
 ds_read_b128 a[76:79], v2 offset:3072
 v_add_f32 v27, v20, v27
M v[124:127], a[116:119], a[52:55], v[124:127]
 v_exp_f32 v23, v93
M v[124:127], a[120:123], a[56:59], v[124:127]
 ds_read_b128 a[80:83], v2 offset:4096
 v_cvt_pk_bf16_f32 v61, v20, v21
M v[124:127], a[124:127], a[60:63], v[124:127]
 ds_read_b128 a[84:87], v2 offset:5120
 v_add_f32 v27, v21, v27
M v[120:123], a[124:127], a[28:31], v[32:35]
 v_exp_f32 v24, v94
M v[120:123], a[120:123], a[24:27], v[120:123]
 ds_read_b128 a[88:91], v2 offset:6144
 v_add_f32 v27, v22, v27
M v[120:123], a[116:119], a[20:23], v[120:123]
 ds_read_b128 a[92:95], v2 offset:7168
 v_cvt_pk_bf16_f32 v62, v22, v23
M v[120:123], a[112:115], a[16:19], v[120:123]
 v_exp_f32 v25, v95
M v[120:123], a[108:111], a[12:15], v[120:123]
 v_add_f32 v27, v23, v27
 v_add_f32 v27, v24, v27
M v[120:123], a[104:107], a[8:11], v[120:123]
 v_cvt_pk_bf16_f32 v63, v24, v25
 v_add_f32 v27, v25, v27
M v[120:123], a[100:103], a[4:7], v[120:123]
 s_waitcnt lgkmcnt(0)
M v[120:123], a[96:99], a[0:3], v[120:123]
 v_max_f32 v10, v26, v27
 v_cmp_lt_f32 vcc, s31, v10
 s_nop 0
 s_cbranch_vccnz L_st12
L_rt12:
M v[128:131], a[64:67], v[40:43], v[128:131]
 s_add_u32 m0, s28, 32768
 ds_read_b128 a[96:99], v2 offset:8192
 v_add_f32 v30, v26, v30
M v[128:131], a[68:71], v[56:59], v[128:131]
 ds_read_b128 a[100:103], v2 offset:9216
 v_add_f32 v31, v27, v31
M v[132:135], a[68:71], v[60:63], v[132:135]
 buffer_load_dwordx4 v3, s[8:11], s21 offen offset:0 sc1 lds
M v[132:135], a[64:67], v[44:47], v[132:135]
 s_add_u32 s3, s29, 131072
 ds_read_b128 a[104:107], v2 offset:10240
M v[140:143], a[72:75], v[44:47], v[140:143]
 ds_read_b128 a[108:111], v2 offset:11264
M v[140:143], a[76:79], v[60:63], v[140:143]
 buffer_load_dwordx4 v3, s[8:11], s21 offen offset:1024 sc1 lds
M v[136:139], a[76:79], v[56:59], v[136:139]
 ds_read_b128 a[112:115], v2 offset:12288
M v[136:139], a[72:75], v[40:43], v[136:139]
 ds_read_b128 a[116:119], v2 offset:13312
M v[144:147], a[80:83], v[40:43], v[144:147]
 buffer_store_dwordx4 a[200:203], v7, s[8:11], s3 offen sc1
M v[144:147], a[84:87], v[56:59], v[144:147]
 ds_read_b128 a[120:123], v2 offset:14336
M v[148:151], a[84:87], v[60:63], v[148:151]
 ds_read_b128 a[124:127], v2 offset:15360
M v[148:151], a[80:83], v[44:47], v[148:151]
 buffer_load_dwordx4 v3, s[8:11], s21 offen offset:2048 sc1 lds
M v[156:159], a[88:91], v[44:47], v[156:159]
 v_exp_f32 v18, v96
M v[156:159], a[92:95], v[60:63], v[156:159]
 v_exp_f32 v19, v97
M v[152:155], a[92:95], v[56:59], v[152:155]
 buffer_load_dwordx4 v3, s[8:11], s21 offen offset:3072 sc1 lds
M v[152:155], a[88:91], v[40:43], v[152:155]
 s_waitcnt lgkmcnt(0)
 v_exp_f32 v20, v98
M v[160:163], a[96:99], v[40:43], v[160:163]
 ds_read_b128 a[64:67], v2 offset:16384
 v_add_f32 v28, v18, v19
M v[160:163], a[100:103], v[56:59], v[160:163]
 s_add_u32 m0, s28, 36864
 ds_read_b128 a[68:71], v2 offset:17408
 v_cvt_pk_bf16_f32 v48, v18, v19
M v[164:167], a[100:103], v[60:63], v[164:167]
 buffer_load_dwordx4 v4, s[8:11], s21 offen offset:0 sc1 lds
M v[164:167], a[96:99], v[44:47], v[164:167]
 ds_read_b128 a[72:75], v2 offset:18432
M v[172:175], a[104:107], v[44:47], v[172:175]
 ds_read_b128 a[76:79], v2 offset:19456
M v[172:175], a[108:111], v[60:63], v[172:175]
 v_exp_f32 v21, v99
M v[168:171], a[108:111], v[56:59], v[168:171]
 ds_read_b128 a[80:83], v2 offset:20480
 v_add_f32 v28, v20, v28
M v[168:171], a[104:107], v[40:43], v[168:171]
 s_add_u32 s3, s29, 196608
 ds_read_b128 a[84:87], v2 offset:21504
 v_cvt_pk_bf16_f32 v49, v20, v21
M v[176:179], a[112:115], v[40:43], v[176:179]
 buffer_load_dwordx4 v4, s[8:11], s21 offen offset:1024 sc1 lds
M v[176:179], a[116:119], v[56:59], v[176:179]
 ds_read_b128 a[88:91], v2 offset:22528
 v_add_f32 v28, v21, v28
M v[180:183], a[116:119], v[60:63], v[180:183]
 ds_read_b128 a[92:95], v2 offset:23552
M v[180:183], a[112:115], v[44:47], v[180:183]
 buffer_load_dwordx4 v4, s[8:11], s21 offen offset:2048 sc1 lds
M v[188:191], a[120:123], v[44:47], v[188:191]
 buffer_store_dwordx4 a[204:207], v7, s[8:11], s3 offen sc1
M v[188:191], a[124:127], v[60:63], v[188:191]
 v_exp_f32 v22, v104
M v[184:187], a[124:127], v[56:59], v[184:187]
 v_exp_f32 v23, v105
M v[184:187], a[120:123], v[40:43], v[184:187]
 s_waitcnt lgkmcnt(0)
 v_exp_f32 v24, v106
M v[192:195], a[64:67], v[40:43], v[192:195]
 ds_read_b128 a[96:99], v2 offset:24576
 v_add_f32 v28, v22, v28
M v[192:195], a[68:71], v[56:59], v[192:195]
 ds_read_b128 a[100:103], v2 offset:25600
 v_cvt_pk_bf16_f32 v50, v22, v23
M v[196:199], a[68:71], v[60:63], v[196:199]
 buffer_load_dwordx4 v4, s[8:11], s21 offen offset:3072 sc1 lds
M v[196:199], a[64:67], v[44:47], v[196:199]
 s_add_u32 s24, s23, 33554432
 ds_read_b128 a[104:107], v2 offset:26624
 v_add_f32 v28, v23, v28
M v[204:207], a[72:75], v[44:47], v[204:207]
 s_mov_b32 s23, s21
 ds_read_b128 a[108:111], v2 offset:27648
M v[204:207], a[76:79], v[60:63], v[204:207]
 s_add_u32 s21, s21, 65536
 v_exp_f32 v25, v107
M v[200:203], a[76:79], v[56:59], v[200:203]
 s_add_u32 s22, s22, 1
 ds_read_b128 a[112:115], v2 offset:28672
 v_add_f32 v28, v24, v28
M v[200:203], a[72:75], v[40:43], v[200:203]
 s_cmp_eq_u32 s22, s25
 ds_read_b128 a[116:119], v2 offset:29696
 v_cvt_pk_bf16_f32 v51, v24, v25
M v[208:211], a[80:83], v[40:43], v[208:211]
 s_cselect_b32 s21, s26, s21
 v_exp_f32 v18, v100
M v[208:211], a[84:87], v[56:59], v[208:211]
 s_cmp_eq_u32 s22, s43
 ds_read_b128 a[120:123], v2 offset:30720
 v_add_f32 v28, v25, v28
M v[212:215], a[84:87], v[60:63], v[212:215]
 s_cselect_b32 s21, s4, s21
 ds_read_b128 a[124:127], v2 offset:31744
M v[212:215], a[80:83], v[44:47], v[212:215]
 s_cmp_eq_u32 s22, s6
 v_exp_f32 v19, v101
M v[220:223], a[88:91], v[44:47], v[220:223]
 s_cselect_b32 s21, s7, s21
 v_exp_f32 v20, v102
M v[220:223], a[92:95], v[60:63], v[220:223]
 v_exp_f32 v21, v103
M v[216:219], a[92:95], v[56:59], v[216:219]
 s_waitcnt vmcnt(21) lgkmcnt(0)
 v_exp_f32 v22, v108
M v[216:219], a[88:91], v[40:43], v[216:219]
 s_barrier
M v[224:227], a[96:99], v[40:43], v[224:227]
 ds_read_b128 a[64:67], v2 offset:32768
 v_add_f32 v29, v18, v19
M v[224:227], a[100:103], v[56:59], v[224:227]
 ds_read_b128 a[68:71], v2 offset:33792
 v_mov_b32 v17, 4
M v[228:231], a[100:103], v[60:63], v[228:231]
 s_waitcnt vmcnt(20)
 v_cmp_gt_u32 vcc, 3, v6
 v_cvt_pk_bf16_f32 v52, v18, v19
M v[228:231], a[96:99], v[44:47], v[228:231]
 ds_read_b128 a[72:75], v2 offset:34816
 v_add_f32 v29, v20, v29
M v[236:239], a[104:107], v[44:47], v[236:239]
 ds_read_b128 a[76:79], v2 offset:35840
 v_cvt_pk_bf16_f32 v53, v20, v21
M v[236:239], a[108:111], v[60:63], v[236:239]
 s_cbranch_vccnz L_f4s
L_f4r:
 v_exp_f32 v23, v109
M v[232:235], a[108:111], v[56:59], v[232:235]
 ds_read_b128 a[80:83], v2 offset:36864
 v_add_f32 v29, v21, v29
M v[232:235], a[104:107], v[40:43], v[232:235]
 ds_read_b128 a[84:87], v2 offset:37888
 v_add_f32 v29, v22, v29
M v[240:243], a[112:115], v[40:43], v[240:243]
 buffer_store_dword v17, v1, s[8:11], s45 offen sc1
M v[240:243], a[116:119], v[56:59], v[240:243]
 ds_read_b128 a[88:91], v2 offset:38912
 v_cvt_pk_bf16_f32 v54, v22, v23
M v[244:247], a[116:119], v[60:63], v[244:247]
 ds_read_b128 a[92:95], v2 offset:39936
 v_add_f32 v29, v23, v29
M v[244:247], a[112:115], v[44:47], v[244:247]
 v_exp_f32 v24, v110
M v[252:255], a[120:123], v[44:47], v[252:255]
 v_exp_f32 v25, v111
M v[252:255], a[124:127], v[60:63], v[252:255]
 v_add_f32 v29, v24, v29
 v_cvt_pk_bf16_f32 v55, v24, v25
M v[248:251], a[124:127], v[56:59], v[248:251]
 s_waitcnt lgkmcnt(0)
 v_add_f32 v29, v25, v29
M v[248:251], a[120:123], v[40:43], v[248:251]
M v[64:67], a[64:67], a[0:3], v[32:35]
 s_add_u32 m0, s28, 65536
 ds_read_b128 a[96:99], v2 offset:40960
M v[64:67], a[68:71], a[4:7], v[64:67]
 ds_read_b128 a[100:103], v2 offset:41984
M v[64:67], a[72:75], a[8:11], v[64:67]
 buffer_load_dwordx4 v3, s[8:11], s24 offen offset:0 sc1 lds
M v[64:67], a[76:79], a[12:15], v[64:67]
 s_cmp_lt_u32 s20, 2
 ds_read_b128 a[104:107], v2 offset:43008
M v[64:67], a[80:83], a[16:19], v[64:67]
 s_cselect_b64 s[86:87], -1, 0
 ds_read_b128 a[108:111], v2 offset:44032
M v[64:67], a[84:87], a[20:23], v[64:67]
 s_cmp_eq_u32 s20, 2
 v_exp_f32 v18, v112
M v[64:67], a[88:91], a[24:27], v[64:67]
 s_cselect_b64 s[80:81], s[16:17], s[86:87]
 ds_read_b128 a[112:115], v2 offset:45056
M v[64:67], a[92:95], a[28:31], v[64:67]
 s_cselect_b64 s[82:83], s[18:19], s[86:87]
 ds_read_b128 a[116:119], v2 offset:46080
M v[68:71], a[92:95], a[60:63], v[36:39]
 buffer_load_dwordx4 v3, s[8:11], s24 offen offset:1024 sc1 lds
M v[68:71], a[88:91], a[56:59], v[68:71]
 s_cselect_b64 s[84:85], s[48:49], s[86:87]
 ds_read_b128 a[120:123], v2 offset:47104
M v[68:71], a[84:87], a[52:55], v[68:71]
 s_cselect_b64 s[86:87], s[50:51], s[86:87]
 ds_read_b128 a[124:127], v2 offset:48128
M v[68:71], a[80:83], a[48:51], v[68:71]
 s_cmp_eq_u32 s20, 3
 v_exp_f32 v19, v113
M v[68:71], a[76:79], a[44:47], v[68:71]
 buffer_load_dwordx4 v3, s[8:11], s24 offen offset:2048 sc1 lds
M v[68:71], a[72:75], a[40:43], v[68:71]
 s_cselect_b64 s[88:89], s[16:17], -1
 v_exp_f32 v20, v114
M v[68:71], a[68:71], a[36:39], v[68:71]
 s_cselect_b64 s[90:91], s[18:19], -1
 v_exp_f32 v21, v115
M v[68:71], a[64:67], a[32:35], v[68:71]
 s_waitcnt lgkmcnt(0)
 v_exp_f32 v22, v120
M v[76:79], a[96:99], a[32:35], v[36:39]
 s_cselect_b64 s[92:93], s[48:49], -1
 ds_read_b128 a[64:67], v2 offset:49152
 v_add_f32 v28, v18, v28
M v[76:79], a[100:103], a[36:39], v[76:79]
 s_cselect_b64 s[94:95], s[50:51], -1
 ds_read_b128 a[68:71], v2 offset:50176
 v_cvt_pk_bf16_f32 v56, v18, v19
M v[76:79], a[104:107], a[40:43], v[76:79]
 buffer_load_dwordx4 v3, s[8:11], s24 offen offset:3072 sc1 lds
M v[76:79], a[108:111], a[44:47], v[76:79]
 s_add_u32 s3, s29, 262144
 ds_read_b128 a[72:75], v2 offset:51200
 v_add_f32 v28, v19, v28
M v[76:79], a[112:115], a[48:51], v[76:79]
 ds_read_b128 a[76:79], v2 offset:52224
 v_add_f32 v28, v20, v28
M v[76:79], a[116:119], a[52:55], v[76:79]
 buffer_store_dwordx4 a[208:211], v7, s[8:11], s3 offen sc1
M v[76:79], a[120:123], a[56:59], v[76:79]
 s_add_u32 m0, s28, 69632
 ds_read_b128 a[80:83], v2 offset:53248
 v_cvt_pk_bf16_f32 v57, v20, v21
M v[76:79], a[124:127], a[60:63], v[76:79]
 ds_read_b128 a[84:87], v2 offset:54272
 v_add_f32 v28, v21, v28
M v[72:75], a[124:127], a[28:31], v[32:35]
 buffer_load_dwordx4 v4, s[8:11], s24 offen offset:0 sc1 lds
M v[72:75], a[120:123], a[24:27], v[72:75]
 ds_read_b128 a[88:91], v2 offset:55296
M v[72:75], a[116:119], a[20:23], v[72:75]
 ds_read_b128 a[92:95], v2 offset:56320
M v[72:75], a[112:115], a[16:19], v[72:75]
 v_exp_f32 v23, v121
M v[72:75], a[108:111], a[12:15], v[72:75]
 buffer_load_dwordx4 v4, s[8:11], s24 offen offset:1024 sc1 lds
M v[72:75], a[104:107], a[8:11], v[72:75]
 v_exp_f32 v24, v122
M v[72:75], a[100:103], a[4:7], v[72:75]
 s_add_u32 s3, s29, 327680
 v_exp_f32 v25, v123
M v[72:75], a[96:99], a[0:3], v[72:75]
 s_waitcnt lgkmcnt(0)
 v_exp_f32 v18, v116
M v[80:83], a[64:67], a[0:3], v[32:35]
 ds_read_b128 a[96:99], v2 offset:57344
 v_add_f32 v28, v22, v28
M v[80:83], a[68:71], a[4:7], v[80:83]
 ds_read_b128 a[100:103], v2 offset:58368
 v_cvt_pk_bf16_f32 v58, v22, v23
M v[80:83], a[72:75], a[8:11], v[80:83]
 buffer_load_dwordx4 v4, s[8:11], s24 offen offset:2048 sc1 lds
M v[80:83], a[76:79], a[12:15], v[80:83]
 ds_read_b128 a[104:107], v2 offset:59392
 v_add_f32 v28, v23, v28
M v[80:83], a[80:83], a[16:19], v[80:83]
 ds_read_b128 a[108:111], v2 offset:60416
 v_add_f32 v28, v24, v28
M v[80:83], a[84:87], a[20:23], v[80:83]
 buffer_store_dwordx4 a[212:215], v7, s[8:11], s3 offen sc1
M v[80:83], a[88:91], a[24:27], v[80:83]
 ds_read_b128 a[112:115], v2 offset:61440
 v_cvt_pk_bf16_f32 v59, v24, v25
M v[80:83], a[92:95], a[28:31], v[80:83]
 ds_read_b128 a[116:119], v2 offset:62464
 v_add_f32 v28, v25, v28
M v[84:87], a[92:95], a[60:63], v[36:39]
 buffer_load_dwordx4 v4, s[8:11], s24 offen offset:3072 sc1 lds
M v[84:87], a[88:91], a[56:59], v[84:87]
 ds_read_b128 a[120:123], v2 offset:63488
M v[84:87], a[84:87], a[52:55], v[84:87]
 ds_read_b128 a[124:127], v2 offset:64512
M v[84:87], a[80:83], a[48:51], v[84:87]
 v_exp_f32 v19, v117
M v[84:87], a[76:79], a[44:47], v[84:87]
 v_exp_f32 v20, v118
M v[84:87], a[72:75], a[40:43], v[84:87]
 v_exp_f32 v21, v119
M v[84:87], a[68:71], a[36:39], v[84:87]
 s_waitcnt vmcnt(21) lgkmcnt(0)
 v_exp_f32 v22, v124
M v[84:87], a[64:67], a[32:35], v[84:87]
 s_barrier
M v[92:95], a[96:99], a[32:35], v[36:39]
 ds_read_b128 a[64:67], v7 offset:0
 v_add_f32 v29, v18, v29
M v[92:95], a[100:103], a[36:39], v[92:95]
 ds_read_b128 a[68:71], v7 offset:1024
 v_cvt_pk_bf16_f32 v60, v18, v19
M v[92:95], a[104:107], a[40:43], v[92:95]
 v_exp_f32 v23, v125
M v[92:95], a[108:111], a[44:47], v[92:95]
 ds_read_b128 a[72:75], v7 offset:2048
 v_add_f32 v29, v19, v29
M v[92:95], a[112:115], a[48:51], v[92:95]
 ds_read_b128 a[76:79], v7 offset:3072
 v_add_f32 v29, v20, v29
M v[92:95], a[116:119], a[52:55], v[92:95]
 v_exp_f32 v24, v126
M v[92:95], a[120:123], a[56:59], v[92:95]
 ds_read_b128 a[80:83], v7 offset:4096
 v_cvt_pk_bf16_f32 v61, v20, v21
M v[92:95], a[124:127], a[60:63], v[92:95]
 ds_read_b128 a[84:87], v7 offset:5120
 v_add_f32 v29, v21, v29
M v[88:91], a[124:127], a[28:31], v[32:35]
 v_exp_f32 v25, v127
M v[88:91], a[120:123], a[24:27], v[88:91]
 ds_read_b128 a[88:91], v7 offset:6144
 v_add_f32 v29, v22, v29
M v[88:91], a[116:119], a[20:23], v[88:91]
 ds_read_b128 a[92:95], v7 offset:7168
 v_cvt_pk_bf16_f32 v62, v22, v23
M v[88:91], a[112:115], a[16:19], v[88:91]
 v_add_f32 v29, v23, v29
 v_add_f32 v29, v24, v29
M v[88:91], a[108:111], a[12:15], v[88:91]
 v_cvt_pk_bf16_f32 v63, v24, v25
 v_add_f32 v29, v25, v29
M v[88:91], a[104:107], a[8:11], v[88:91]
M v[88:91], a[100:103], a[4:7], v[88:91]
 s_waitcnt lgkmcnt(0)
M v[88:91], a[96:99], a[0:3], v[88:91]
 v_max_f32 v10, v28, v29
 v_cmp_lt_f32 vcc, s31, v10
 s_nop 0
 s_cbranch_vccnz L_st13
L_rt13:
M v[128:131], a[64:67], v[48:51], v[128:131]
 s_add_u32 m0, s28, 98304
 ds_read_b128 a[96:99], v7 offset:8192
 v_add_f32 v30, v28, v30
M v[128:131], a[68:71], v[56:59], v[128:131]
 s_add_u32 s3, s29, 393216
 ds_read_b128 a[100:103], v7 offset:9216
 v_add_f32 v31, v29, v31
M v[132:135], a[68:71], v[60:63], v[132:135]
 buffer_load_dwordx4 v3, s[8:11], s21 offen offset:0 sc1 lds
M v[132:135], a[64:67], v[52:55], v[132:135]
 ds_read_b128 a[104:107], v7 offset:10240
M v[140:143], a[72:75], v[52:55], v[140:143]
 ds_read_b128 a[108:111], v7 offset:11264
M v[140:143], a[76:79], v[60:63], v[140:143]
 buffer_load_dwordx4 v3, s[8:11], s21 offen offset:1024 sc1 lds
M v[136:139], a[76:79], v[56:59], v[136:139]
 ds_read_b128 a[112:115], v7 offset:12288
M v[136:139], a[72:75], v[48:51], v[136:139]
 ds_read_b128 a[116:119], v7 offset:13312
M v[144:147], a[80:83], v[48:51], v[144:147]
 buffer_store_dwordx4 a[216:219], v7, s[8:11], s3 offen sc1
M v[144:147], a[84:87], v[56:59], v[144:147]
 ds_read_b128 a[120:123], v7 offset:14336
M v[148:151], a[84:87], v[60:63], v[148:151]
 ds_read_b128 a[124:127], v7 offset:15360
M v[148:151], a[80:83], v[52:55], v[148:151]
 buffer_load_dwordx4 v3, s[8:11], s21 offen offset:2048 sc1 lds
M v[156:159], a[88:91], v[52:55], v[156:159]
 v_exp_f32 v18, v64
M v[156:159], a[92:95], v[60:63], v[156:159]
 v_exp_f32 v19, v65
M v[152:155], a[92:95], v[56:59], v[152:155]
 buffer_load_dwordx4 v3, s[8:11], s21 offen offset:3072 sc1 lds
M v[152:155], a[88:91], v[48:51], v[152:155]
 s_waitcnt lgkmcnt(0)
 v_exp_f32 v20, v66
M v[160:163], a[96:99], v[48:51], v[160:163]
 ds_read_b128 a[64:67], v7 offset:16384
 v_add_f32 v26, v18, v19
M v[160:163], a[100:103], v[56:59], v[160:163]
 s_add_u32 m0, s28, 102400
 ds_read_b128 a[68:71], v7 offset:17408
 v_cvt_pk_bf16_f32 v40, v18, v19
M v[164:167], a[100:103], v[60:63], v[164:167]
 buffer_load_dwordx4 v4, s[8:11], s21 offen offset:0 sc1 lds
M v[164:167], a[96:99], v[52:55], v[164:167]
 ds_read_b128 a[72:75], v7 offset:18432
M v[172:175], a[104:107], v[52:55], v[172:175]
 ds_read_b128 a[76:79], v7 offset:19456
M v[172:175], a[108:111], v[60:63], v[172:175]
 v_exp_f32 v21, v67
M v[168:171], a[108:111], v[56:59], v[168:171]
 ds_read_b128 a[80:83], v7 offset:20480
 v_add_f32 v26, v20, v26
M v[168:171], a[104:107], v[48:51], v[168:171]
 ds_read_b128 a[84:87], v7 offset:21504
 v_cvt_pk_bf16_f32 v41, v20, v21
M v[176:179], a[112:115], v[48:51], v[176:179]
 buffer_load_dwordx4 v4, s[8:11], s21 offen offset:1024 sc1 lds
M v[176:179], a[116:119], v[56:59], v[176:179]
 ds_read_b128 a[88:91], v7 offset:22528
 v_add_f32 v26, v21, v26
M v[180:183], a[116:119], v[60:63], v[180:183]
 ds_read_b128 a[92:95], v7 offset:23552
M v[180:183], a[112:115], v[52:55], v[180:183]
 buffer_load_dwordx4 v4, s[8:11], s21 offen offset:2048 sc1 lds
M v[188:191], a[120:123], v[52:55], v[188:191]
 v_exp_f32 v22, v72
M v[188:191], a[124:127], v[60:63], v[188:191]
 v_exp_f32 v23, v73
M v[184:187], a[124:127], v[56:59], v[184:187]
 v_exp_f32 v24, v74
M v[184:187], a[120:123], v[48:51], v[184:187]
 s_waitcnt lgkmcnt(0)
 v_exp_f32 v25, v75
M v[192:195], a[64:67], v[48:51], v[192:195]
 ds_read_b128 a[96:99], v7 offset:24576
 v_add_f32 v26, v22, v26
M v[192:195], a[68:71], v[56:59], v[192:195]
 ds_read_b128 a[100:103], v7 offset:25600
 v_cvt_pk_bf16_f32 v42, v22, v23
M v[196:199], a[68:71], v[60:63], v[196:199]
 buffer_load_dwordx4 v4, s[8:11], s21 offen offset:3072 sc1 lds
M v[196:199], a[64:67], v[52:55], v[196:199]
 s_add_u32 s24, s23, 33554432
 ds_read_b128 a[104:107], v7 offset:26624
 v_add_f32 v26, v23, v26
M v[204:207], a[72:75], v[52:55], v[204:207]
 s_mov_b32 s23, s21
 ds_read_b128 a[108:111], v7 offset:27648
 v_add_f32 v26, v24, v26
M v[204:207], a[76:79], v[60:63], v[204:207]
 s_add_u32 s21, s21, 65536
 v_exp_f32 v18, v68
M v[200:203], a[76:79], v[56:59], v[200:203]
 s_add_u32 s22, s22, 1
 ds_read_b128 a[112:115], v7 offset:28672
 v_cvt_pk_bf16_f32 v43, v24, v25
M v[200:203], a[72:75], v[48:51], v[200:203]
 s_cmp_eq_u32 s22, s25
 ds_read_b128 a[116:119], v7 offset:29696
 v_add_f32 v26, v25, v26
M v[208:211], a[80:83], v[48:51], v[208:211]
 s_cselect_b32 s21, s26, s21
 v_exp_f32 v19, v69
M v[208:211], a[84:87], v[56:59], v[208:211]
 s_cmp_eq_u32 s22, s43
 ds_read_b128 a[120:123], v7 offset:30720
 v_add_f32 v27, v18, v19
M v[212:215], a[84:87], v[60:63], v[212:215]
 s_cselect_b32 s21, s4, s21
 ds_read_b128 a[124:127], v7 offset:31744
 v_cvt_pk_bf16_f32 v44, v18, v19
M v[212:215], a[80:83], v[52:55], v[212:215]
 s_cmp_eq_u32 s22, s6
 v_exp_f32 v20, v70
M v[220:223], a[88:91], v[52:55], v[220:223]
 s_cselect_b32 s21, s7, s21
 v_exp_f32 v21, v71
M v[220:223], a[92:95], v[60:63], v[220:223]
 v_exp_f32 v22, v76
M v[216:219], a[92:95], v[56:59], v[216:219]
 s_waitcnt vmcnt(20) lgkmcnt(0)
 v_add_f32 v27, v20, v27
 v_cvt_pk_bf16_f32 v45, v20, v21
M v[216:219], a[88:91], v[48:51], v[216:219]
 s_barrier
M v[224:227], a[96:99], v[48:51], v[224:227]
 ds_read_b128 a[64:67], v7 offset:32768
 v_add_f32 v27, v21, v27
M v[224:227], a[100:103], v[56:59], v[224:227]
 ds_read_b128 a[68:71], v7 offset:33792
M v[228:231], a[100:103], v[60:63], v[228:231]
 v_exp_f32 v23, v77
M v[228:231], a[96:99], v[52:55], v[228:231]
 ds_read_b128 a[72:75], v7 offset:34816
 v_add_f32 v27, v22, v27
M v[236:239], a[104:107], v[52:55], v[236:239]
 ds_read_b128 a[76:79], v7 offset:35840
 v_cvt_pk_bf16_f32 v46, v22, v23
M v[236:239], a[108:111], v[60:63], v[236:239]
 v_exp_f32 v24, v78
M v[232:235], a[108:111], v[56:59], v[232:235]
 ds_read_b128 a[80:83], v7 offset:36864
 v_add_f32 v27, v23, v27
M v[232:235], a[104:107], v[48:51], v[232:235]
 ds_read_b128 a[84:87], v7 offset:37888
M v[240:243], a[112:115], v[48:51], v[240:243]
 v_exp_f32 v25, v79
M v[240:243], a[116:119], v[56:59], v[240:243]
 ds_read_b128 a[88:91], v7 offset:38912
 v_add_f32 v27, v24, v27
M v[244:247], a[116:119], v[60:63], v[244:247]
 ds_read_b128 a[92:95], v7 offset:39936
 v_cvt_pk_bf16_f32 v47, v24, v25
M v[244:247], a[112:115], v[52:55], v[244:247]
 v_add_f32 v27, v25, v27
M v[252:255], a[120:123], v[52:55], v[252:255]
M v[252:255], a[124:127], v[60:63], v[252:255]
M v[248:251], a[124:127], v[56:59], v[248:251]
 s_waitcnt lgkmcnt(0)
M v[248:251], a[120:123], v[48:51], v[248:251]
 s_branch L_loop_mid
L_zs0:
 s_mov_b32 s64, 65536
L_zs0_l:
 s_sleep 2
 buffer_load_dword v17, v16, s[12:15], 0 offen offset:0 sc1
 s_sub_u32 s64, s64, 1
 s_cbranch_scc1 L_zs0_x
 s_waitcnt vmcnt(0)
 v_cmp_eq_u32 vcc, 0, v17
 s_nop 0
 s_cbranch_vccnz L_zs0_l
L_zs0_x:
 s_waitcnt vmcnt(0)
 s_branch L_zr0
L_zs1:
 s_mov_b32 s64, 65536
L_zs1_l:
 s_sleep 2
 buffer_load_dword v17, v16, s[12:15], 0 offen offset:0 sc1
 s_sub_u32 s64, s64, 1
 s_cbranch_scc1 L_zs1_x
 s_waitcnt vmcnt(0)
 v_cmp_eq_u32 vcc, 0, v17
 s_nop 0
 s_cbranch_vccnz L_zs1_l
L_zs1_x:
 s_waitcnt vmcnt(0)
 s_branch L_zr1
L_hs:
 s_mov_b32 s91, 65536
L_hs_l:
 buffer_load_dwordx4 v[16:19], v7, s[8:11], s67 offen offset:0 sc1
 buffer_load_dwordx4 v[20:23], v7, s[8:11], s67 offen offset:1024 sc1
 s_waitcnt vmcnt(0)
 s_sub_u32 s91, s91, 1
 s_cbranch_scc1 L_hr
 v_min3_u32 v28, v16, v17, v18
 v_min3_u32 v28, v28, v19, v20
 v_min3_u32 v28, v28, v21, v22
 v_min_u32 v28, v28, v23
 v_cmp_eq_u32 vcc, 0, v28
 s_nop 0
 s_cbranch_vccnz L_hs_l
 s_branch L_hr
L_nut:
 s_and_b32 s64, s20, 1
 s_lshl1_add_u32 s46, s41, s64
 s_lshl4_add_u32 s46, s46, s20
 s_lshl_b32 s46, s46, 9
 s_add_u32 s46, s46, 239075328
 s_add_u32 s46, s46, s6
 s_addc_u32 s47, s7, 0
 s_lshl_b32 s67, s20, 2
 s_add_u32 s67, s67, 163808
 v_mov_b32 v17, s67
 s_waitcnt lgkmcnt(0)
 s_memtime s[72:73]
 s_waitcnt lgkmcnt(0)
 s_load_dword s43, s[46:47], 0
 s_load_dword s40, s[46:47], 0x40000
 s_load_dword s26, s[46:47], 0x80000
 s_waitcnt lgkmcnt(2)
 s_memtime s[64:65]
 s_waitcnt lgkmcnt(0)
 s_sub_u32 s64, s64, s72
 s_mov_b32 s66, s64
 s_xor_b32 s46, s46, 8192
 s_add_u32 s46, s46, 0xc0000
 s_addc_u32 s47, s47, 0
 s_memtime s[72:73]
 s_waitcnt lgkmcnt(0)
 s_load_dword s43, s[46:47], 0
 s_load_dword s40, s[46:47], 0x40000
 s_load_dword s26, s[46:47], 0x80000
 s_waitcnt lgkmcnt(2)
 s_memtime s[64:65]
 s_waitcnt lgkmcnt(0)
 s_sub_u32 s64, s64, s72
 s_sub_u32 s64, s66, s64
 s_ashr_i32 s64, s64, 1
 s_add_u32 s64, s64, 4096
 v_mov_b32 v16, s64
 ds_write_b32 v17, v16
 s_waitcnt lgkmcnt(0)
 s_branch L_nutr
L_f1s04:
 s_mov_b32 s91, 65536
L_f1s04_l:
 s_sleep 2
 buffer_load_dword v24, v13, s[8:11], s46 offen sc1
 s_sub_u32 s91, s91, 1
 s_cbranch_scc1 L_f1s04_x
 s_waitcnt vmcnt(0)
 v_cmp_eq_u32 vcc, 0, v24
 s_nop 0
 s_cbranch_vccnz L_f1s04_l
L_f1s04_x:
 s_waitcnt vmcnt(0)
 s_branch L_f1r04
L_f1s05:
 s_mov_b32 s91, 65536
L_f1s05_l:
 s_sleep 2
 buffer_load_dword v24, v9, s[8:11], s46 offen sc1
 s_sub_u32 s91, s91, 1
 s_cbranch_scc1 L_f1s05_x
 s_waitcnt vmcnt(0)
 v_cmp_eq_u32 vcc, 0, v24
 s_nop 0
 s_cbranch_vccnz L_f1s05_l
L_f1s05_x:
 s_waitcnt vmcnt(0)
 s_branch L_f1r05
L_f1s14:
 s_mov_b32 s91, 65536
L_f1s14_l:
 s_sleep 2
 buffer_load_dword v24, v13, s[8:11], s46 offen sc1
 s_sub_u32 s91, s91, 1
 s_cbranch_scc1 L_f1s14_x
 s_waitcnt vmcnt(0)
 v_cmp_eq_u32 vcc, 0, v24
 s_nop 0
 s_cbranch_vccnz L_f1s14_l
L_f1s14_x:
 s_waitcnt vmcnt(0)
 s_branch L_f1r14
L_f1s15:
 s_mov_b32 s91, 65536
L_f1s15_l:
 s_sleep 2
 buffer_load_dword v24, v9, s[8:11], s46 offen sc1
 s_sub_u32 s91, s91, 1
 s_cbranch_scc1 L_f1s15_x
 s_waitcnt vmcnt(0)
 v_cmp_eq_u32 vcc, 0, v24
 s_nop 0
 s_cbranch_vccnz L_f1s15_l
L_f1s15_x:
 s_waitcnt vmcnt(0)
 s_branch L_f1r15
.p2align 6
L_loop_top:
M v[64:67], a[64:67], a[0:3], v[32:35]
 s_add_u32 m0, s28, 65536
 ds_read_b128 a[96:99], v2 offset:40960
M v[64:67], a[68:71], a[4:7], v[64:67]
 ds_read_b128 a[100:103], v2 offset:41984
M v[64:67], a[72:75], a[8:11], v[64:67]
 buffer_load_dword a240, v0, s[60:63], 0 offen offset:0
M v[64:67], a[76:79], a[12:15], v[64:67]
 ds_read_b128 a[104:107], v2 offset:43008
M v[64:67], a[80:83], a[16:19], v[64:67]
 ds_read_b128 a[108:111], v2 offset:44032
M v[64:67], a[84:87], a[20:23], v[64:67]
 buffer_load_dwordx4 v3, s[8:11], s24 offen offset:0 sc1 lds
M v[64:67], a[88:91], a[24:27], v[64:67]
 ds_read_b128 a[112:115], v2 offset:45056
M v[64:67], a[92:95], a[28:31], v[64:67]
 ds_read_b128 a[116:119], v2 offset:46080
M v[68:71], a[92:95], a[60:63], v[36:39]
 buffer_load_dwordx4 v3, s[8:11], s24 offen offset:1024 sc1 lds
M v[68:71], a[88:91], a[56:59], v[68:71]
 ds_read_b128 a[120:123], v2 offset:47104
M v[68:71], a[84:87], a[52:55], v[68:71]
 ds_read_b128 a[124:127], v2 offset:48128
M v[68:71], a[80:83], a[48:51], v[68:71]
 v_exp_f32 v18, v112
M v[68:71], a[76:79], a[44:47], v[68:71]
 buffer_load_dwordx4 v3, s[8:11], s24 offen offset:2048 sc1 lds
M v[68:71], a[72:75], a[40:43], v[68:71]
 v_exp_f32 v19, v113
M v[68:71], a[68:71], a[36:39], v[68:71]
 v_exp_f32 v20, v114
M v[68:71], a[64:67], a[32:35], v[68:71]
 s_waitcnt lgkmcnt(0)
 v_exp_f32 v21, v115
M v[76:79], a[96:99], a[32:35], v[36:39]
 ds_read_b128 a[64:67], v2 offset:49152
 v_add_f32 v28, v18, v28
M v[76:79], a[100:103], a[36:39], v[76:79]
 ds_read_b128 a[68:71], v2 offset:50176
 v_cvt_pk_bf16_f32 v56, v18, v19
M v[76:79], a[104:107], a[40:43], v[76:79]
 buffer_load_dwordx4 v3, s[8:11], s24 offen offset:3072 sc1 lds
M v[76:79], a[108:111], a[44:47], v[76:79]
 ds_read_b128 a[72:75], v2 offset:51200
 v_add_f32 v28, v19, v28
M v[76:79], a[112:115], a[48:51], v[76:79]
 ds_read_b128 a[76:79], v2 offset:52224
 v_add_f32 v28, v20, v28
M v[76:79], a[116:119], a[52:55], v[76:79]
 v_exp_f32 v22, v120
M v[76:79], a[120:123], a[56:59], v[76:79]
 s_add_u32 m0, s28, 69632
 ds_read_b128 a[80:83], v2 offset:53248
 v_cvt_pk_bf16_f32 v57, v20, v21
M v[76:79], a[124:127], a[60:63], v[76:79]
 ds_read_b128 a[84:87], v2 offset:54272
 v_add_f32 v28, v21, v28
M v[72:75], a[124:127], a[28:31], v[32:35]
 buffer_load_dwordx4 v4, s[8:11], s24 offen offset:0 sc1 lds
M v[72:75], a[120:123], a[24:27], v[72:75]
 ds_read_b128 a[88:91], v2 offset:55296
M v[72:75], a[116:119], a[20:23], v[72:75]
 ds_read_b128 a[92:95], v2 offset:56320
M v[72:75], a[112:115], a[16:19], v[72:75]
 v_exp_f32 v23, v121
M v[72:75], a[108:111], a[12:15], v[72:75]
 buffer_load_dwordx4 v4, s[8:11], s24 offen offset:1024 sc1 lds
M v[72:75], a[104:107], a[8:11], v[72:75]
 v_exp_f32 v24, v122
M v[72:75], a[100:103], a[4:7], v[72:75]
 v_exp_f32 v25, v123
M v[72:75], a[96:99], a[0:3], v[72:75]
 s_waitcnt lgkmcnt(0)
 v_exp_f32 v18, v116
M v[80:83], a[64:67], a[0:3], v[32:35]
 ds_read_b128 a[96:99], v2 offset:57344
 v_add_f32 v28, v22, v28
M v[80:83], a[68:71], a[4:7], v[80:83]
 ds_read_b128 a[100:103], v2 offset:58368
 v_cvt_pk_bf16_f32 v58, v22, v23
M v[80:83], a[72:75], a[8:11], v[80:83]
 buffer_load_dwordx4 v4, s[8:11], s24 offen offset:2048 sc1 lds
M v[80:83], a[76:79], a[12:15], v[80:83]
 ds_read_b128 a[104:107], v2 offset:59392
 v_add_f32 v28, v23, v28
M v[80:83], a[80:83], a[16:19], v[80:83]
 ds_read_b128 a[108:111], v2 offset:60416
 v_add_f32 v28, v24, v28
M v[80:83], a[84:87], a[20:23], v[80:83]
 v_exp_f32 v19, v117
M v[80:83], a[88:91], a[24:27], v[80:83]
 ds_read_b128 a[112:115], v2 offset:61440
 v_cvt_pk_bf16_f32 v59, v24, v25
M v[80:83], a[92:95], a[28:31], v[80:83]
 ds_read_b128 a[116:119], v2 offset:62464
 v_add_f32 v28, v25, v28
M v[84:87], a[92:95], a[60:63], v[36:39]
 buffer_load_dwordx4 v4, s[8:11], s24 offen offset:3072 sc1 lds
M v[84:87], a[88:91], a[56:59], v[84:87]
 ds_read_b128 a[120:123], v2 offset:63488
 v_add_f32 v29, v18, v29
M v[84:87], a[84:87], a[52:55], v[84:87]
 ds_read_b128 a[124:127], v2 offset:64512
 v_cvt_pk_bf16_f32 v60, v18, v19
M v[84:87], a[80:83], a[48:51], v[84:87]
 v_exp_f32 v20, v118
M v[84:87], a[76:79], a[44:47], v[84:87]
 v_exp_f32 v21, v119
M v[84:87], a[72:75], a[40:43], v[84:87]
 v_exp_f32 v22, v124
M v[84:87], a[68:71], a[36:39], v[84:87]
 s_waitcnt vmcnt(17) lgkmcnt(0)
 v_exp_f32 v23, v125
M v[84:87], a[64:67], a[32:35], v[84:87]
 s_barrier
M v[92:95], a[96:99], a[32:35], v[36:39]
 ds_read_b128 a[64:67], v7 offset:0
 v_add_f32 v29, v19, v29
M v[92:95], a[100:103], a[36:39], v[92:95]
 ds_read_b128 a[68:71], v7 offset:1024
 v_add_f32 v29, v20, v29
M v[92:95], a[104:107], a[40:43], v[92:95]
 v_exp_f32 v24, v126
M v[92:95], a[108:111], a[44:47], v[92:95]
 ds_read_b128 a[72:75], v7 offset:2048
 v_cvt_pk_bf16_f32 v61, v20, v21
M v[92:95], a[112:115], a[48:51], v[92:95]
 ds_read_b128 a[76:79], v7 offset:3072
 v_add_f32 v29, v21, v29
M v[92:95], a[116:119], a[52:55], v[92:95]
 v_exp_f32 v25, v127
M v[92:95], a[120:123], a[56:59], v[92:95]
 ds_read_b128 a[80:83], v7 offset:4096
 v_add_f32 v29, v22, v29
M v[92:95], a[124:127], a[60:63], v[92:95]
 ds_read_b128 a[84:87], v7 offset:5120
 v_cvt_pk_bf16_f32 v62, v22, v23
M v[88:91], a[124:127], a[28:31], v[32:35]
 v_add_f32 v29, v23, v29
 v_add_f32 v29, v24, v29
M v[88:91], a[120:123], a[24:27], v[88:91]
 ds_read_b128 a[88:91], v7 offset:6144
 v_cvt_pk_bf16_f32 v63, v24, v25
M v[88:91], a[116:119], a[20:23], v[88:91]
 ds_read_b128 a[92:95], v7 offset:7168
 v_add_f32 v29, v25, v29
M v[88:91], a[112:115], a[16:19], v[88:91]
 v_max_f32 v10, v28, v29
M v[88:91], a[108:111], a[12:15], v[88:91]
 v_cmp_lt_f32 vcc, s31, v10
M v[88:91], a[104:107], a[8:11], v[88:91]
M v[88:91], a[100:103], a[4:7], v[88:91]
 s_waitcnt lgkmcnt(0)
M v[88:91], a[96:99], a[0:3], v[88:91]
 s_cbranch_vccnz L_st1
L_rt1:
M v[128:131], a[64:67], v[48:51], v[128:131]
 s_add_u32 m0, s28, 98304
 ds_read_b128 a[96:99], v7 offset:8192
 v_add_f32 v30, v28, v30
M v[128:131], a[68:71], v[56:59], v[128:131]
 ds_read_b128 a[100:103], v7 offset:9216
 v_add_f32 v31, v29, v31
M v[132:135], a[68:71], v[60:63], v[132:135]
 buffer_load_dwordx4 v3, s[8:11], s21 offen offset:0 sc1 lds
M v[132:135], a[64:67], v[52:55], v[132:135]
 ds_read_b128 a[104:107], v7 offset:10240
M v[140:143], a[72:75], v[52:55], v[140:143]
 ds_read_b128 a[108:111], v7 offset:11264
M v[140:143], a[76:79], v[60:63], v[140:143]
 buffer_load_dwordx4 v3, s[8:11], s21 offen offset:1024 sc1 lds
M v[136:139], a[76:79], v[56:59], v[136:139]
 ds_read_b128 a[112:115], v7 offset:12288
M v[136:139], a[72:75], v[48:51], v[136:139]
 ds_read_b128 a[116:119], v7 offset:13312
M v[144:147], a[80:83], v[48:51], v[144:147]
 v_exp_f32 v18, v64
M v[144:147], a[84:87], v[56:59], v[144:147]
 ds_read_b128 a[120:123], v7 offset:14336
M v[148:151], a[84:87], v[60:63], v[148:151]
 ds_read_b128 a[124:127], v7 offset:15360
M v[148:151], a[80:83], v[52:55], v[148:151]
 buffer_load_dwordx4 v3, s[8:11], s21 offen offset:2048 sc1 lds
M v[156:159], a[88:91], v[52:55], v[156:159]
 v_exp_f32 v19, v65
M v[156:159], a[92:95], v[60:63], v[156:159]
 v_exp_f32 v20, v66
M v[152:155], a[92:95], v[56:59], v[152:155]
 buffer_load_dwordx4 v3, s[8:11], s21 offen offset:3072 sc1 lds
M v[152:155], a[88:91], v[48:51], v[152:155]
 s_waitcnt lgkmcnt(0)
 v_exp_f32 v21, v67
M v[160:163], a[96:99], v[48:51], v[160:163]
 ds_read_b128 a[64:67], v7 offset:16384
 v_add_f32 v26, v18, v19
M v[160:163], a[100:103], v[56:59], v[160:163]
 s_add_u32 m0, s28, 102400
 ds_read_b128 a[68:71], v7 offset:17408
 v_cvt_pk_bf16_f32 v40, v18, v19
M v[164:167], a[100:103], v[60:63], v[164:167]
 buffer_load_dwordx4 v4, s[8:11], s21 offen offset:0 sc1 lds
M v[164:167], a[96:99], v[52:55], v[164:167]
 ds_read_b128 a[72:75], v7 offset:18432
 v_add_f32 v26, v20, v26
M v[172:175], a[104:107], v[52:55], v[172:175]
 ds_read_b128 a[76:79], v7 offset:19456
 v_cvt_pk_bf16_f32 v41, v20, v21
M v[172:175], a[108:111], v[60:63], v[172:175]
 v_exp_f32 v22, v72
M v[168:171], a[108:111], v[56:59], v[168:171]
 ds_read_b128 a[80:83], v7 offset:20480
 v_add_f32 v26, v21, v26
M v[168:171], a[104:107], v[48:51], v[168:171]
 ds_read_b128 a[84:87], v7 offset:21504
M v[176:179], a[112:115], v[48:51], v[176:179]
 buffer_load_dwordx4 v4, s[8:11], s21 offen offset:1024 sc1 lds
M v[176:179], a[116:119], v[56:59], v[176:179]
 ds_read_b128 a[88:91], v7 offset:22528
M v[180:183], a[116:119], v[60:63], v[180:183]
 ds_read_b128 a[92:95], v7 offset:23552
M v[180:183], a[112:115], v[52:55], v[180:183]
 buffer_load_dwordx4 v4, s[8:11], s21 offen offset:2048 sc1 lds
M v[188:191], a[120:123], v[52:55], v[188:191]
 v_exp_f32 v23, v73
M v[188:191], a[124:127], v[60:63], v[188:191]
 v_exp_f32 v24, v74
M v[184:187], a[124:127], v[56:59], v[184:187]
 v_exp_f32 v25, v75
M v[184:187], a[120:123], v[48:51], v[184:187]
 s_waitcnt lgkmcnt(0)
 v_exp_f32 v18, v68
M v[192:195], a[64:67], v[48:51], v[192:195]
 ds_read_b128 a[96:99], v7 offset:24576
 v_add_f32 v26, v22, v26
M v[192:195], a[68:71], v[56:59], v[192:195]
 ds_read_b128 a[100:103], v7 offset:25600
 v_cvt_pk_bf16_f32 v42, v22, v23
M v[196:199], a[68:71], v[60:63], v[196:199]
 buffer_load_dwordx4 v4, s[8:11], s21 offen offset:3072 sc1 lds
M v[196:199], a[64:67], v[52:55], v[196:199]
 s_add_u32 s24, s23, 33554432
 ds_read_b128 a[104:107], v7 offset:26624
 v_add_f32 v26, v23, v26
M v[204:207], a[72:75], v[52:55], v[204:207]
 s_mov_b32 s23, s21
 ds_read_b128 a[108:111], v7 offset:27648
 v_add_f32 v26, v24, v26
M v[204:207], a[76:79], v[60:63], v[204:207]
 s_add_u32 s21, s21, 65536
 v_exp_f32 v19, v69
M v[200:203], a[76:79], v[56:59], v[200:203]
 s_add_u32 s22, s22, 1
 ds_read_b128 a[112:115], v7 offset:28672
 v_cvt_pk_bf16_f32 v43, v24, v25
M v[200:203], a[72:75], v[48:51], v[200:203]
 s_cmp_eq_u32 s22, s25
 ds_read_b128 a[116:119], v7 offset:29696
 v_add_f32 v26, v25, v26
M v[208:211], a[80:83], v[48:51], v[208:211]
 s_cselect_b32 s21, s26, s21
 v_exp_f32 v20, v70
M v[208:211], a[84:87], v[56:59], v[208:211]
 s_cmp_eq_u32 s22, s43
 ds_read_b128 a[120:123], v7 offset:30720
 v_add_f32 v27, v18, v19
M v[212:215], a[84:87], v[60:63], v[212:215]
 s_cselect_b32 s21, s4, s21
 ds_read_b128 a[124:127], v7 offset:31744
 v_cvt_pk_bf16_f32 v44, v18, v19
M v[212:215], a[80:83], v[52:55], v[212:215]
 s_cmp_eq_u32 s22, s6
 v_exp_f32 v21, v71
M v[220:223], a[88:91], v[52:55], v[220:223]
 s_cselect_b32 s21, s7, s21
 v_exp_f32 v22, v76
M v[220:223], a[92:95], v[60:63], v[220:223]
 v_add_f32 v27, v20, v27
 v_cvt_pk_bf16_f32 v45, v20, v21
M v[216:219], a[92:95], v[56:59], v[216:219]
 s_waitcnt vmcnt(17) lgkmcnt(0)
 v_add_f32 v27, v21, v27
M v[216:219], a[88:91], v[48:51], v[216:219]
 s_barrier
M v[224:227], a[96:99], v[48:51], v[224:227]
 ds_read_b128 a[64:67], v7 offset:32768
M v[224:227], a[100:103], v[56:59], v[224:227]
 ds_read_b128 a[68:71], v7 offset:33792
M v[228:231], a[100:103], v[60:63], v[228:231]
 v_exp_f32 v23, v77
M v[228:231], a[96:99], v[52:55], v[228:231]
 ds_read_b128 a[72:75], v7 offset:34816
 v_add_f32 v27, v22, v27
M v[236:239], a[104:107], v[52:55], v[236:239]
 ds_read_b128 a[76:79], v7 offset:35840
 v_cvt_pk_bf16_f32 v46, v22, v23
M v[236:239], a[108:111], v[60:63], v[236:239]
 v_exp_f32 v24, v78
M v[232:235], a[108:111], v[56:59], v[232:235]
 ds_read_b128 a[80:83], v7 offset:36864
 v_add_f32 v27, v23, v27
M v[232:235], a[104:107], v[48:51], v[232:235]
 ds_read_b128 a[84:87], v7 offset:37888
M v[240:243], a[112:115], v[48:51], v[240:243]
 v_exp_f32 v25, v79
M v[240:243], a[116:119], v[56:59], v[240:243]
 ds_read_b128 a[88:91], v7 offset:38912
 v_add_f32 v27, v24, v27
M v[244:247], a[116:119], v[60:63], v[244:247]
 ds_read_b128 a[92:95], v7 offset:39936
 v_cvt_pk_bf16_f32 v47, v24, v25
M v[244:247], a[112:115], v[52:55], v[244:247]
 v_add_f32 v27, v25, v27
M v[252:255], a[120:123], v[52:55], v[252:255]
M v[252:255], a[124:127], v[60:63], v[252:255]
M v[248:251], a[124:127], v[56:59], v[248:251]
 s_waitcnt lgkmcnt(0)
M v[248:251], a[120:123], v[48:51], v[248:251]
L_loop_mid:
M v[96:99], a[64:67], a[0:3], v[32:35]
 s_and_b32 s39, s54, 15
 ds_read_b128 a[96:99], v7 offset:40960
M v[96:99], a[68:71], a[4:7], v[96:99]
 s_cbranch_scc1 L_fll
L_fllr:
 ds_read_b128 a[100:103], v7 offset:41984
M v[96:99], a[72:75], a[8:11], v[96:99]
 s_lshr_b32 s54, s54, 4
 v_exp_f32 v18, v80
M v[96:99], a[76:79], a[12:15], v[96:99]
 s_add_u32 m0, s28, 0
 ds_read_b128 a[104:107], v7 offset:43008
M v[96:99], a[80:83], a[16:19], v[96:99]
 ds_read_b128 a[108:111], v7 offset:44032
M v[96:99], a[84:87], a[20:23], v[96:99]
 buffer_load_dwordx4 v3, s[8:11], s24 offen offset:0 sc1 lds
M v[96:99], a[88:91], a[24:27], v[96:99]
 ds_read_b128 a[112:115], v7 offset:45056
M v[96:99], a[92:95], a[28:31], v[96:99]
 ds_read_b128 a[116:119], v7 offset:46080
M v[100:103], a[92:95], a[60:63], v[36:39]
 v_exp_f32 v19, v81
M v[100:103], a[88:91], a[56:59], v[100:103]
 ds_read_b128 a[120:123], v7 offset:47104
 v_add_f32 v26, v18, v26
M v[100:103], a[84:87], a[52:55], v[100:103]
 ds_read_b128 a[124:127], v7 offset:48128
 v_cvt_pk_bf16_f32 v56, v18, v19
M v[100:103], a[80:83], a[48:51], v[100:103]
 buffer_load_dwordx4 v3, s[8:11], s24 offen offset:1024 sc1 lds
M v[100:103], a[76:79], a[44:47], v[100:103]
 v_exp_f32 v20, v82
M v[100:103], a[72:75], a[40:43], v[100:103]
 v_exp_f32 v21, v83
M v[100:103], a[68:71], a[36:39], v[100:103]
 buffer_load_dwordx4 v3, s[8:11], s24 offen offset:2048 sc1 lds
M v[100:103], a[64:67], a[32:35], v[100:103]
 s_waitcnt lgkmcnt(0)
 v_exp_f32 v22, v88
M v[108:111], a[96:99], a[32:35], v[36:39]
 ds_read_b128 a[64:67], v7 offset:49152
 v_add_f32 v26, v19, v26
M v[108:111], a[100:103], a[36:39], v[108:111]
 ds_read_b128 a[68:71], v7 offset:50176
 v_add_f32 v26, v20, v26
M v[108:111], a[104:107], a[40:43], v[108:111]
 v_exp_f32 v23, v89
M v[108:111], a[108:111], a[44:47], v[108:111]
 ds_read_b128 a[72:75], v7 offset:51200
 v_cvt_pk_bf16_f32 v57, v20, v21
M v[108:111], a[112:115], a[48:51], v[108:111]
 ds_read_b128 a[76:79], v7 offset:52224
 v_add_f32 v26, v21, v26
M v[108:111], a[116:119], a[52:55], v[108:111]
 buffer_load_dwordx4 v3, s[8:11], s24 offen offset:3072 sc1 lds
M v[108:111], a[120:123], a[56:59], v[108:111]
 ds_read_b128 a[80:83], v7 offset:53248
 v_add_f32 v26, v22, v26
M v[108:111], a[124:127], a[60:63], v[108:111]
 s_add_u32 m0, s28, 4096
 ds_read_b128 a[84:87], v7 offset:54272
 v_cvt_pk_bf16_f32 v58, v22, v23
M v[104:107], a[124:127], a[28:31], v[32:35]
 buffer_load_dwordx4 v4, s[8:11], s24 offen offset:0 sc1 lds
M v[104:107], a[120:123], a[24:27], v[104:107]
 ds_read_b128 a[88:91], v7 offset:55296
 v_add_f32 v26, v23, v26
M v[104:107], a[116:119], a[20:23], v[104:107]
 ds_read_b128 a[92:95], v7 offset:56320
M v[104:107], a[112:115], a[16:19], v[104:107]
 v_exp_f32 v24, v90
M v[104:107], a[108:111], a[12:15], v[104:107]
 v_exp_f32 v25, v91
M v[104:107], a[104:107], a[8:11], v[104:107]
 buffer_load_dwordx4 v4, s[8:11], s24 offen offset:1024 sc1 lds
M v[104:107], a[100:103], a[4:7], v[104:107]
 v_exp_f32 v18, v84
M v[104:107], a[96:99], a[0:3], v[104:107]
 s_waitcnt lgkmcnt(0)
 v_exp_f32 v19, v85
M v[112:115], a[64:67], a[0:3], v[32:35]
 ds_read_b128 a[96:99], v7 offset:57344
 v_add_f32 v26, v24, v26
M v[112:115], a[68:71], a[4:7], v[112:115]
 ds_read_b128 a[100:103], v7 offset:58368
 v_cvt_pk_bf16_f32 v59, v24, v25
M v[112:115], a[72:75], a[8:11], v[112:115]
 buffer_load_dwordx4 v4, s[8:11], s24 offen offset:2048 sc1 lds
M v[112:115], a[76:79], a[12:15], v[112:115]
 ds_read_b128 a[104:107], v7 offset:59392
 v_add_f32 v26, v25, v26
M v[112:115], a[80:83], a[16:19], v[112:115]
 ds_read_b128 a[108:111], v7 offset:60416
 v_add_f32 v27, v18, v27
M v[112:115], a[84:87], a[20:23], v[112:115]
 v_exp_f32 v20, v86
M v[112:115], a[88:91], a[24:27], v[112:115]
 ds_read_b128 a[112:115], v7 offset:61440
 v_cvt_pk_bf16_f32 v60, v18, v19
M v[112:115], a[92:95], a[28:31], v[112:115]
 ds_read_b128 a[116:119], v7 offset:62464
 v_add_f32 v27, v19, v27
M v[116:119], a[92:95], a[60:63], v[36:39]
 buffer_load_dwordx4 v4, s[8:11], s24 offen offset:3072 sc1 lds
M v[116:119], a[88:91], a[56:59], v[116:119]
 ds_read_b128 a[120:123], v7 offset:63488
M v[116:119], a[84:87], a[52:55], v[116:119]
 ds_read_b128 a[124:127], v7 offset:64512
M v[116:119], a[80:83], a[48:51], v[116:119]
 v_exp_f32 v21, v87
M v[116:119], a[76:79], a[44:47], v[116:119]
 v_exp_f32 v22, v92
M v[116:119], a[72:75], a[40:43], v[116:119]
 v_exp_f32 v23, v93
M v[116:119], a[68:71], a[36:39], v[116:119]
 s_waitcnt vmcnt(16) lgkmcnt(0)
 v_add_f32 v27, v20, v27
 v_cvt_pk_bf16_f32 v61, v20, v21
M v[116:119], a[64:67], a[32:35], v[116:119]
 s_barrier
M v[124:127], a[96:99], a[32:35], v[36:39]
 ds_read_b128 a[64:67], v2 offset:0
 v_add_f32 v27, v21, v27
M v[124:127], a[100:103], a[36:39], v[124:127]
 ds_read_b128 a[68:71], v2 offset:1024
 v_add_f32 v27, v22, v27
M v[124:127], a[104:107], a[40:43], v[124:127]
 v_exp_f32 v24, v94
M v[124:127], a[108:111], a[44:47], v[124:127]
 ds_read_b128 a[72:75], v2 offset:2048
 v_cvt_pk_bf16_f32 v62, v22, v23
M v[124:127], a[112:115], a[48:51], v[124:127]
 ds_read_b128 a[76:79], v2 offset:3072
 v_add_f32 v27, v23, v27
M v[124:127], a[116:119], a[52:55], v[124:127]
 v_exp_f32 v25, v95
M v[124:127], a[120:123], a[56:59], v[124:127]
 ds_read_b128 a[80:83], v2 offset:4096
 v_add_f32 v27, v24, v27
M v[124:127], a[124:127], a[60:63], v[124:127]
 ds_read_b128 a[84:87], v2 offset:5120
 v_cvt_pk_bf16_f32 v63, v24, v25
M v[120:123], a[124:127], a[28:31], v[32:35]
 v_add_f32 v27, v25, v27
M v[120:123], a[120:123], a[24:27], v[120:123]
 ds_read_b128 a[88:91], v2 offset:6144
M v[120:123], a[116:119], a[20:23], v[120:123]
 ds_read_b128 a[92:95], v2 offset:7168
 v_max_f32 v10, v26, v27
M v[120:123], a[112:115], a[16:19], v[120:123]
 v_cmp_lt_f32 vcc, s31, v10
M v[120:123], a[108:111], a[12:15], v[120:123]
M v[120:123], a[104:107], a[8:11], v[120:123]
M v[120:123], a[100:103], a[4:7], v[120:123]
 s_waitcnt lgkmcnt(0)
M v[120:123], a[96:99], a[0:3], v[120:123]
 s_cbranch_vccnz L_st0
L_rt0:
M v[128:131], a[64:67], v[40:43], v[128:131]
 s_add_u32 m0, s28, 32768
 ds_read_b128 a[96:99], v2 offset:8192
 v_add_f32 v30, v26, v30
M v[128:131], a[68:71], v[56:59], v[128:131]
 ds_read_b128 a[100:103], v2 offset:9216
 v_add_f32 v31, v27, v31
M v[132:135], a[68:71], v[60:63], v[132:135]
 buffer_load_dwordx4 v3, s[8:11], s21 offen offset:0 sc1 lds
M v[132:135], a[64:67], v[44:47], v[132:135]
 ds_read_b128 a[104:107], v2 offset:10240
M v[140:143], a[72:75], v[44:47], v[140:143]
 ds_read_b128 a[108:111], v2 offset:11264
M v[140:143], a[76:79], v[60:63], v[140:143]
 buffer_load_dwordx4 v3, s[8:11], s21 offen offset:1024 sc1 lds
M v[136:139], a[76:79], v[56:59], v[136:139]
 ds_read_b128 a[112:115], v2 offset:12288
M v[136:139], a[72:75], v[40:43], v[136:139]
 ds_read_b128 a[116:119], v2 offset:13312
M v[144:147], a[80:83], v[40:43], v[144:147]
 v_exp_f32 v18, v96
M v[144:147], a[84:87], v[56:59], v[144:147]
 ds_read_b128 a[120:123], v2 offset:14336
M v[148:151], a[84:87], v[60:63], v[148:151]
 ds_read_b128 a[124:127], v2 offset:15360
M v[148:151], a[80:83], v[44:47], v[148:151]
 buffer_load_dwordx4 v3, s[8:11], s21 offen offset:2048 sc1 lds
M v[156:159], a[88:91], v[44:47], v[156:159]
 v_exp_f32 v19, v97
M v[156:159], a[92:95], v[60:63], v[156:159]
 v_exp_f32 v20, v98
M v[152:155], a[92:95], v[56:59], v[152:155]
 buffer_load_dwordx4 v3, s[8:11], s21 offen offset:3072 sc1 lds
M v[152:155], a[88:91], v[40:43], v[152:155]
 s_waitcnt lgkmcnt(0)
 v_exp_f32 v21, v99
M v[160:163], a[96:99], v[40:43], v[160:163]
 ds_read_b128 a[64:67], v2 offset:16384
 v_add_f32 v28, v18, v19
M v[160:163], a[100:103], v[56:59], v[160:163]
 s_add_u32 m0, s28, 36864
 ds_read_b128 a[68:71], v2 offset:17408
 v_cvt_pk_bf16_f32 v48, v18, v19
M v[164:167], a[100:103], v[60:63], v[164:167]
 buffer_load_dwordx4 v4, s[8:11], s21 offen offset:0 sc1 lds
M v[164:167], a[96:99], v[44:47], v[164:167]
 ds_read_b128 a[72:75], v2 offset:18432
 v_add_f32 v28, v20, v28
M v[172:175], a[104:107], v[44:47], v[172:175]
 ds_read_b128 a[76:79], v2 offset:19456
 v_cvt_pk_bf16_f32 v49, v20, v21
M v[172:175], a[108:111], v[60:63], v[172:175]
 v_exp_f32 v22, v104
M v[168:171], a[108:111], v[56:59], v[168:171]
 ds_read_b128 a[80:83], v2 offset:20480
 v_add_f32 v28, v21, v28
M v[168:171], a[104:107], v[40:43], v[168:171]
 ds_read_b128 a[84:87], v2 offset:21504
M v[176:179], a[112:115], v[40:43], v[176:179]
 buffer_load_dwordx4 v4, s[8:11], s21 offen offset:1024 sc1 lds
M v[176:179], a[116:119], v[56:59], v[176:179]
 ds_read_b128 a[88:91], v2 offset:22528
M v[180:183], a[116:119], v[60:63], v[180:183]
 ds_read_b128 a[92:95], v2 offset:23552
M v[180:183], a[112:115], v[44:47], v[180:183]
 buffer_load_dwordx4 v4, s[8:11], s21 offen offset:2048 sc1 lds
M v[188:191], a[120:123], v[44:47], v[188:191]
 v_exp_f32 v23, v105
M v[188:191], a[124:127], v[60:63], v[188:191]
 v_exp_f32 v24, v106
M v[184:187], a[124:127], v[56:59], v[184:187]
 v_exp_f32 v25, v107
M v[184:187], a[120:123], v[40:43], v[184:187]
 s_waitcnt lgkmcnt(0)
 v_exp_f32 v18, v100
M v[192:195], a[64:67], v[40:43], v[192:195]
 ds_read_b128 a[96:99], v2 offset:24576
 v_add_f32 v28, v22, v28
M v[192:195], a[68:71], v[56:59], v[192:195]
 ds_read_b128 a[100:103], v2 offset:25600
 v_cvt_pk_bf16_f32 v50, v22, v23
M v[196:199], a[68:71], v[60:63], v[196:199]
 buffer_load_dwordx4 v4, s[8:11], s21 offen offset:3072 sc1 lds
M v[196:199], a[64:67], v[44:47], v[196:199]
 s_add_u32 s24, s23, 33554432
 ds_read_b128 a[104:107], v2 offset:26624
 v_add_f32 v28, v23, v28
M v[204:207], a[72:75], v[44:47], v[204:207]
 s_mov_b32 s23, s21
 ds_read_b128 a[108:111], v2 offset:27648
 v_add_f32 v28, v24, v28
M v[204:207], a[76:79], v[60:63], v[204:207]
 s_add_u32 s21, s21, 65536
 v_exp_f32 v19, v101
M v[200:203], a[76:79], v[56:59], v[200:203]
 s_add_u32 s22, s22, 1
 ds_read_b128 a[112:115], v2 offset:28672
 v_cvt_pk_bf16_f32 v51, v24, v25
M v[200:203], a[72:75], v[40:43], v[200:203]
 s_cmp_eq_u32 s22, s25
 ds_read_b128 a[116:119], v2 offset:29696
 v_add_f32 v28, v25, v28
M v[208:211], a[80:83], v[40:43], v[208:211]
 s_cselect_b32 s21, s26, s21
 v_exp_f32 v20, v102
M v[208:211], a[84:87], v[56:59], v[208:211]
 s_cmp_eq_u32 s22, s43
 ds_read_b128 a[120:123], v2 offset:30720
 v_add_f32 v29, v18, v19
M v[212:215], a[84:87], v[60:63], v[212:215]
 s_cselect_b32 s21, s4, s21
 ds_read_b128 a[124:127], v2 offset:31744
 v_cvt_pk_bf16_f32 v52, v18, v19
M v[212:215], a[80:83], v[44:47], v[212:215]
 s_cmp_eq_u32 s22, s6
 v_exp_f32 v21, v103
M v[220:223], a[88:91], v[44:47], v[220:223]
 s_cselect_b32 s21, s7, s21
 v_exp_f32 v22, v108
M v[220:223], a[92:95], v[60:63], v[220:223]
 v_add_f32 v29, v20, v29
 v_cvt_pk_bf16_f32 v53, v20, v21
M v[216:219], a[92:95], v[56:59], v[216:219]
 s_waitcnt vmcnt(16) lgkmcnt(0)
 v_exp_f32 v23, v109
M v[216:219], a[88:91], v[40:43], v[216:219]
 s_barrier
M v[224:227], a[96:99], v[40:43], v[224:227]
 ds_read_b128 a[64:67], v2 offset:32768
 v_add_f32 v29, v21, v29
M v[224:227], a[100:103], v[56:59], v[224:227]
 ds_read_b128 a[68:71], v2 offset:33792
 v_add_f32 v29, v22, v29
M v[228:231], a[100:103], v[60:63], v[228:231]
 v_cmp_gt_u32 vcc, s39, v6
 v_cvt_pk_bf16_f32 v54, v22, v23
M v[228:231], a[96:99], v[44:47], v[228:231]
 ds_read_b128 a[72:75], v2 offset:34816
 v_add_f32 v29, v23, v29
M v[236:239], a[104:107], v[44:47], v[236:239]
 ds_read_b128 a[76:79], v2 offset:35840
M v[236:239], a[108:111], v[60:63], v[236:239]
 s_cbranch_vccnz L_fls0
L_flr0:
 v_exp_f32 v24, v110
M v[232:235], a[108:111], v[56:59], v[232:235]
 s_and_b32 s3, s5, 15
 ds_read_b128 a[80:83], v2 offset:36864
M v[232:235], a[104:107], v[40:43], v[232:235]
 s_cbranch_scc1 L_pub3
L_pub3r:
 ds_read_b128 a[84:87], v2 offset:37888
M v[240:243], a[112:115], v[40:43], v[240:243]
 s_lshr_b32 s5, s5, 4
 v_exp_f32 v25, v111
M v[240:243], a[116:119], v[56:59], v[240:243]
 ds_read_b128 a[88:91], v2 offset:38912
 v_add_f32 v29, v24, v29
M v[244:247], a[116:119], v[60:63], v[244:247]
 ds_read_b128 a[92:95], v2 offset:39936
 v_cvt_pk_bf16_f32 v55, v24, v25
M v[244:247], a[112:115], v[44:47], v[244:247]
 v_add_f32 v29, v25, v29
M v[252:255], a[120:123], v[44:47], v[252:255]
 s_sub_u32 s27, s27, 1
M v[252:255], a[124:127], v[60:63], v[252:255]
 s_cmp_lg_u32 s27, 0
M v[248:251], a[124:127], v[56:59], v[248:251]
 s_waitcnt lgkmcnt(0)
M v[248:251], a[120:123], v[40:43], v[248:251]
 s_cbranch_scc1 L_loop_top
L_p1:
 s_cmp_eq_u32 s40, 0
 s_cbranch_scc1 L_final_h
 s_cmp_lt_u32 s42, 10
 s_cbranch_scc1 L_p1n
L_p1c:
 v_cndmask_b32 v64, v32, v8, s[64:65]
 v_cndmask_b32 v65, v32, v8, s[66:67]
 v_cndmask_b32 v66, v32, v8, s[68:69]
 v_cndmask_b32 v67, v32, v8, s[70:71]
 s_nop 1
M v[64:67], a[64:67], a[0:3], v[64:67]
 s_add_u32 m0, s28, 65536
 ds_read_b128 a[96:99], v2 offset:40960
 ds_read_b128 a[100:103], v2 offset:41984
M v[64:67], a[68:71], a[4:7], v[64:67]
 buffer_load_dwordx4 v3, s[8:11], s24 offen offset:0 sc1 lds
M v[64:67], a[72:75], a[8:11], v[64:67]
 v_exp_f32 v18, v112
M v[64:67], a[76:79], a[12:15], v[64:67]
 ds_read_b128 a[104:107], v2 offset:43008
 ds_read_b128 a[108:111], v2 offset:44032
M v[64:67], a[80:83], a[16:19], v[64:67]
 buffer_load_dwordx4 v[14:17], v7, s[8:11], s52 offen sc1
M v[64:67], a[84:87], a[20:23], v[64:67]
 s_cmp_eq_u32 s20, 3
 v_exp_f32 v19, v113
M v[64:67], a[88:91], a[24:27], v[64:67]
 s_cselect_b64 s[64:65], s[16:17], 0
 ds_read_b128 a[112:115], v2 offset:45056
 ds_read_b128 a[116:119], v2 offset:46080
M v[64:67], a[92:95], a[28:31], v[64:67]
 s_cselect_b64 s[66:67], s[18:19], 0
 v_exp_f32 v20, v114
M v[68:71], a[92:95], a[60:63], v[36:39]
 s_cselect_b64 s[68:69], s[48:49], 0
 v_add_f32 v28, v18, v28
 v_cvt_pk_bf16_f32 v56, v18, v19
M v[68:71], a[88:91], a[56:59], v[68:71]
 s_cselect_b64 s[70:71], s[50:51], 0
 ds_read_b128 a[120:123], v2 offset:47104
 ds_read_b128 a[124:127], v2 offset:48128
M v[68:71], a[84:87], a[52:55], v[68:71]
 buffer_load_dwordx4 v3, s[8:11], s24 offen offset:1024 sc1 lds
M v[68:71], a[80:83], a[48:51], v[68:71]
 v_cndmask_b32 v72, v32, v8, s[72:73]
 v_cndmask_b32 v73, v32, v8, s[74:75]
M v[68:71], a[76:79], a[44:47], v[68:71]
 v_cndmask_b32 v74, v32, v8, s[76:77]
 v_cndmask_b32 v75, v32, v8, s[78:79]
M v[68:71], a[72:75], a[40:43], v[68:71]
 buffer_load_dwordx4 a[128:131], v7, s[8:11], s12 offen offset:0 sc1
M v[68:71], a[68:71], a[36:39], v[68:71]
 buffer_load_dwordx4 a[132:135], v7, s[8:11], s12 offen offset:1024 sc1
M v[68:71], a[64:67], a[32:35], v[68:71]
 s_waitcnt lgkmcnt(0)
 v_exp_f32 v21, v115
M v[72:75], a[96:99], a[0:3], v[72:75]
 ds_read_b128 a[64:67], v2 offset:49152
 ds_read_b128 a[68:71], v2 offset:50176
M v[72:75], a[100:103], a[4:7], v[72:75]
 buffer_load_dwordx4 v3, s[8:11], s24 offen offset:2048 sc1 lds
M v[72:75], a[104:107], a[8:11], v[72:75]
 v_exp_f32 v22, v120
M v[72:75], a[108:111], a[12:15], v[72:75]
 ds_read_b128 a[72:75], v2 offset:51200
 ds_read_b128 a[76:79], v2 offset:52224
M v[72:75], a[112:115], a[16:19], v[72:75]
 buffer_load_dwordx4 v3, s[8:11], s24 offen offset:3072 sc1 lds
M v[72:75], a[116:119], a[20:23], v[72:75]
 s_cmp_gt_u32 s20, 2
 v_exp_f32 v23, v121
M v[72:75], a[120:123], a[24:27], v[72:75]
 s_cselect_b64 s[78:79], -1, 0
 ds_read_b128 a[80:83], v2 offset:53248
 ds_read_b128 a[84:87], v2 offset:54272
M v[72:75], a[124:127], a[28:31], v[72:75]
 s_cmp_eq_u32 s20, 2
 v_exp_f32 v24, v122
M v[76:79], a[124:127], a[60:63], v[36:39]
 s_cselect_b64 s[72:73], s[16:17], s[78:79]
 v_exp_f32 v25, v123
M v[76:79], a[120:123], a[56:59], v[76:79]
 s_cselect_b64 s[74:75], s[18:19], s[78:79]
 ds_read_b128 a[88:91], v2 offset:55296
 ds_read_b128 a[92:95], v2 offset:56320
M v[76:79], a[116:119], a[52:55], v[76:79]
 s_cselect_b64 s[76:77], s[48:49], s[78:79]
 v_add_f32 v28, v19, v28
 v_add_f32 v28, v20, v28
M v[76:79], a[112:115], a[48:51], v[76:79]
 s_cselect_b64 s[78:79], s[50:51], s[78:79]
 v_cndmask_b32 v80, v32, v8, s[80:81]
 v_cndmask_b32 v81, v32, v8, s[82:83]
M v[76:79], a[108:111], a[44:47], v[76:79]
 s_add_u32 m0, s28, 69632
 v_cndmask_b32 v82, v32, v8, s[84:85]
 v_cndmask_b32 v83, v32, v8, s[86:87]
M v[76:79], a[104:107], a[40:43], v[76:79]
 buffer_load_dwordx4 a[136:139], v7, s[8:11], s12 offen offset:2048 sc1
M v[76:79], a[100:103], a[36:39], v[76:79]
 buffer_load_dwordx4 v4, s[8:11], s24 offen offset:0 sc1 lds
M v[76:79], a[96:99], a[32:35], v[76:79]
 s_waitcnt lgkmcnt(0)
 v_exp_f32 v18, v116
M v[80:83], a[64:67], a[0:3], v[80:83]
 ds_read_b128 a[96:99], v2 offset:57344
 ds_read_b128 a[100:103], v2 offset:58368
M v[80:83], a[68:71], a[4:7], v[80:83]
 buffer_load_dwordx4 a[140:143], v7, s[8:11], s12 offen offset:3072 sc1
M v[80:83], a[72:75], a[8:11], v[80:83]
 buffer_load_dwordx4 v4, s[8:11], s24 offen offset:1024 sc1 lds
M v[80:83], a[76:79], a[12:15], v[80:83]
 ds_read_b128 a[104:107], v2 offset:59392
 ds_read_b128 a[108:111], v2 offset:60416
M v[80:83], a[80:83], a[16:19], v[80:83]
 buffer_load_dwordx4 a[144:147], v7, s[8:11], s13 offen offset:0 sc1
M v[80:83], a[84:87], a[20:23], v[80:83]
 s_cmp_gt_u32 s20, 1
 v_exp_f32 v19, v117
M v[80:83], a[88:91], a[24:27], v[80:83]
 s_cselect_b64 s[86:87], -1, 0
 ds_read_b128 a[112:115], v2 offset:61440
 ds_read_b128 a[116:119], v2 offset:62464
M v[80:83], a[92:95], a[28:31], v[80:83]
 s_cmp_eq_u32 s20, 1
 v_cvt_pk_bf16_f32 v57, v20, v21
 v_add_f32 v28, v21, v28
M v[84:87], a[92:95], a[60:63], v[36:39]
 s_cselect_b64 s[80:81], s[16:17], s[86:87]
 v_exp_f32 v20, v118
M v[84:87], a[88:91], a[56:59], v[84:87]
 s_cselect_b64 s[82:83], s[18:19], s[86:87]
 ds_read_b128 a[120:123], v2 offset:63488
 ds_read_b128 a[124:127], v2 offset:64512
M v[84:87], a[84:87], a[52:55], v[84:87]
 s_cselect_b64 s[84:85], s[48:49], s[86:87]
 v_exp_f32 v21, v119
M v[84:87], a[80:83], a[48:51], v[84:87]
 s_cselect_b64 s[86:87], s[50:51], s[86:87]
 v_cndmask_b32 v88, v32, v8, s[88:89]
 v_cndmask_b32 v89, v32, v8, s[90:91]
M v[84:87], a[76:79], a[44:47], v[84:87]
 v_cndmask_b32 v90, v32, v8, s[92:93]
 v_cndmask_b32 v91, v32, v8, s[94:95]
M v[84:87], a[72:75], a[40:43], v[84:87]
 buffer_load_dwordx4 v4, s[8:11], s24 offen offset:2048 sc1 lds
M v[84:87], a[68:71], a[36:39], v[84:87]
 s_waitcnt vmcnt(21) lgkmcnt(0)
 v_add_f32 v28, v22, v28
 v_cvt_pk_bf16_f32 v58, v22, v23
M v[84:87], a[64:67], a[32:35], v[84:87]
 s_barrier
M v[88:91], a[96:99], a[0:3], v[88:91]
 ds_read_b128 a[64:67], v7 offset:0
 ds_read_b128 a[68:71], v7 offset:1024
M v[88:91], a[100:103], a[4:7], v[88:91]
 s_cmp_eq_u32 s20, 0
 v_add_f32 v28, v23, v28
 v_add_f32 v28, v24, v28
M v[88:91], a[104:107], a[8:11], v[88:91]
 s_cselect_b64 s[88:89], s[16:17], -1
 v_exp_f32 v22, v124
M v[88:91], a[108:111], a[12:15], v[88:91]
 s_cselect_b64 s[90:91], s[18:19], -1
 ds_read_b128 a[72:75], v7 offset:2048
 ds_read_b128 a[76:79], v7 offset:3072
M v[88:91], a[112:115], a[16:19], v[88:91]
 s_cselect_b64 s[92:93], s[48:49], -1
 v_exp_f32 v23, v125
M v[88:91], a[116:119], a[20:23], v[88:91]
 s_cselect_b64 s[94:95], s[50:51], -1
 v_cvt_pk_bf16_f32 v59, v24, v25
 v_add_f32 v28, v25, v28
M v[88:91], a[120:123], a[24:27], v[88:91]
 ds_read_b128 a[80:83], v7 offset:4096
 ds_read_b128 a[84:87], v7 offset:5120
M v[88:91], a[124:127], a[28:31], v[88:91]
 buffer_load_dwordx4 a[148:151], v7, s[8:11], s13 offen offset:1024 sc1
M v[92:95], a[124:127], a[60:63], v[36:39]
 buffer_load_dwordx4 v4, s[8:11], s24 offen offset:3072 sc1 lds
M v[92:95], a[120:123], a[56:59], v[92:95]
 ds_read_b128 a[88:91], v7 offset:6144
 ds_read_b128 a[92:95], v7 offset:7168
M v[92:95], a[116:119], a[52:55], v[92:95]
 buffer_load_dwordx4 a[152:155], v7, s[8:11], s13 offen offset:2048 sc1
M v[92:95], a[112:115], a[48:51], v[92:95]
 v_exp_f32 v24, v126
M v[92:95], a[108:111], a[44:47], v[92:95]
 buffer_load_dwordx4 a[156:159], v7, s[8:11], s13 offen offset:3072 sc1
M v[92:95], a[104:107], a[40:43], v[92:95]
 v_exp_f32 v25, v127
M v[92:95], a[100:103], a[36:39], v[92:95]
 s_waitcnt lgkmcnt(0)
 v_add_f32 v29, v18, v29
 v_cvt_pk_bf16_f32 v60, v18, v19
M v[92:95], a[96:99], a[32:35], v[92:95]
 v_add_f32 v29, v19, v29
 v_add_f32 v29, v20, v29
 v_cvt_pk_bf16_f32 v61, v20, v21
 v_add_f32 v29, v21, v29
 v_add_f32 v29, v22, v29
 v_cvt_pk_bf16_f32 v62, v22, v23
 v_add_f32 v29, v23, v29
 v_add_f32 v29, v24, v29
 v_cvt_pk_bf16_f32 v63, v24, v25
 v_add_f32 v29, v25, v29
 v_max_f32 v10, v28, v29
 v_cmp_lt_f32 vcc, s31, v10
 s_nop 0
 s_cbranch_vccnz L_st3
L_rt3:
M v[128:131], a[64:67], v[48:51], v[128:131]
 s_add_u32 m0, s28, 98304
 ds_read_b128 a[96:99], v7 offset:8192
 ds_read_b128 a[100:103], v7 offset:9216
M v[128:131], a[68:71], v[56:59], v[128:131]
 buffer_load_dwordx4 v3, s[8:11], s21 offen offset:0 sc1 lds
M v[132:135], a[68:71], v[60:63], v[132:135]
 v_exp_f32 v18, v64
M v[132:135], a[64:67], v[52:55], v[132:135]
 ds_read_b128 a[104:107], v7 offset:10240
 ds_read_b128 a[108:111], v7 offset:11264
M v[140:143], a[72:75], v[52:55], v[140:143]
 buffer_load_dwordx4 a[160:163], v7, s[8:11], s14 offen offset:0 sc1
M v[140:143], a[76:79], v[60:63], v[140:143]
 v_cndmask_b32 v100, v36, v8, s[64:65]
 v_add_f32 v30, v28, v30
M v[136:139], a[76:79], v[56:59], v[136:139]
 ds_read_b128 a[112:115], v7 offset:12288
 ds_read_b128 a[116:119], v7 offset:13312
M v[136:139], a[72:75], v[48:51], v[136:139]
 buffer_load_dwordx4 v3, s[8:11], s21 offen offset:1024 sc1 lds
M v[144:147], a[80:83], v[48:51], v[144:147]
 v_cndmask_b32 v101, v36, v8, s[66:67]
 v_add_f32 v31, v29, v31
M v[144:147], a[84:87], v[56:59], v[144:147]
 ds_read_b128 a[120:123], v7 offset:14336
 ds_read_b128 a[124:127], v7 offset:15360
M v[148:151], a[84:87], v[60:63], v[148:151]
 buffer_load_dwordx4 a[164:167], v7, s[8:11], s14 offen offset:1024 sc1
M v[148:151], a[80:83], v[52:55], v[148:151]
 v_cndmask_b32 v102, v36, v8, s[68:69]
M v[156:159], a[88:91], v[52:55], v[156:159]
 buffer_load_dwordx4 v3, s[8:11], s21 offen offset:2048 sc1 lds
M v[156:159], a[92:95], v[60:63], v[156:159]
 v_exp_f32 v19, v65
M v[152:155], a[92:95], v[56:59], v[152:155]
 buffer_load_dwordx4 a[168:171], v7, s[8:11], s14 offen offset:2048 sc1
M v[152:155], a[88:91], v[48:51], v[152:155]
 s_waitcnt lgkmcnt(0)
 v_cndmask_b32 v103, v36, v8, s[70:71]
 v_add_f32 v26, v18, v19
M v[160:163], a[96:99], v[48:51], v[160:163]
 ds_read_b128 a[64:67], v7 offset:16384
 ds_read_b128 a[68:71], v7 offset:17408
M v[160:163], a[100:103], v[56:59], v[160:163]
 buffer_load_dwordx4 v3, s[8:11], s21 offen offset:3072 sc1 lds
M v[164:167], a[100:103], v[60:63], v[164:167]
 v_cndmask_b32 v108, v36, v8, s[72:73]
 v_cvt_pk_bf16_f32 v40, v18, v19
M v[164:167], a[96:99], v[52:55], v[164:167]
 ds_read_b128 a[72:75], v7 offset:18432
 ds_read_b128 a[76:79], v7 offset:19456
M v[172:175], a[104:107], v[52:55], v[172:175]
 buffer_load_dwordx4 a[172:175], v7, s[8:11], s14 offen offset:3072 sc1
M v[172:175], a[108:111], v[60:63], v[172:175]
 v_exp_f32 v20, v66
M v[168:171], a[108:111], v[56:59], v[168:171]
 s_add_u32 m0, s28, 102400
 ds_read_b128 a[80:83], v7 offset:20480
 ds_read_b128 a[84:87], v7 offset:21504
M v[168:171], a[104:107], v[48:51], v[168:171]
 buffer_load_dwordx4 v4, s[8:11], s21 offen offset:0 sc1 lds
M v[176:179], a[112:115], v[48:51], v[176:179]
 v_cndmask_b32 v109, v36, v8, s[74:75]
M v[176:179], a[116:119], v[56:59], v[176:179]
 ds_read_b128 a[88:91], v7 offset:22528
 ds_read_b128 a[92:95], v7 offset:23552
M v[180:183], a[116:119], v[60:63], v[180:183]
 buffer_load_dwordx4 a[176:179], v7, s[8:11], s15 offen offset:0 sc1
M v[180:183], a[112:115], v[52:55], v[180:183]
 v_cndmask_b32 v110, v36, v8, s[76:77]
M v[188:191], a[120:123], v[52:55], v[188:191]
 buffer_load_dwordx4 v4, s[8:11], s21 offen offset:1024 sc1 lds
M v[188:191], a[124:127], v[60:63], v[188:191]
 v_cndmask_b32 v111, v36, v8, s[78:79]
M v[184:187], a[124:127], v[56:59], v[184:187]
 buffer_load_dwordx4 a[180:183], v7, s[8:11], s15 offen offset:1024 sc1
M v[184:187], a[120:123], v[48:51], v[184:187]
 s_waitcnt lgkmcnt(0)
 v_exp_f32 v21, v67
M v[192:195], a[64:67], v[48:51], v[192:195]
 ds_read_b128 a[96:99], v7 offset:24576
 ds_read_b128 a[100:103], v7 offset:25600
M v[192:195], a[68:71], v[56:59], v[192:195]
 buffer_load_dwordx4 v4, s[8:11], s21 offen offset:2048 sc1 lds
M v[196:199], a[68:71], v[60:63], v[196:199]
 v_cndmask_b32 v116, v36, v8, s[80:81]
 v_add_f32 v26, v20, v26
M v[196:199], a[64:67], v[52:55], v[196:199]
 ds_read_b128 a[104:107], v7 offset:26624
 ds_read_b128 a[108:111], v7 offset:27648
M v[204:207], a[72:75], v[52:55], v[204:207]
 buffer_load_dwordx4 a[184:187], v7, s[8:11], s15 offen offset:2048 sc1
M v[204:207], a[76:79], v[60:63], v[204:207]
 v_cndmask_b32 v117, v36, v8, s[82:83]
 v_cvt_pk_bf16_f32 v41, v20, v21
M v[200:203], a[76:79], v[56:59], v[200:203]
 ds_read_b128 a[112:115], v7 offset:28672
 ds_read_b128 a[116:119], v7 offset:29696
M v[200:203], a[72:75], v[48:51], v[200:203]
 buffer_load_dwordx4 v4, s[8:11], s21 offen offset:3072 sc1 lds
M v[208:211], a[80:83], v[48:51], v[208:211]
 s_add_u32 s24, s23, 33554432
 v_cndmask_b32 v118, v36, v8, s[84:85]
 v_add_f32 v26, v21, v26
M v[208:211], a[84:87], v[56:59], v[208:211]
 s_mov_b32 s23, s21
 ds_read_b128 a[120:123], v7 offset:30720
 ds_read_b128 a[124:127], v7 offset:31744
M v[212:215], a[84:87], v[60:63], v[212:215]
 buffer_load_dwordx4 a[188:191], v7, s[8:11], s15 offen offset:3072 sc1
M v[212:215], a[80:83], v[52:55], v[212:215]
 s_add_u32 s21, s21, 65536
 v_cndmask_b32 v119, v36, v8, s[86:87]
M v[220:223], a[88:91], v[52:55], v[220:223]
 s_add_u32 s22, s22, 1
 v_exp_f32 v22, v72
M v[220:223], a[92:95], v[60:63], v[220:223]
 s_cmp_eq_u32 s22, s25
 v_exp_f32 v23, v73
M v[216:219], a[92:95], v[56:59], v[216:219]
 s_waitcnt vmcnt(33) lgkmcnt(0)
 v_exp_f32 v24, v74
M v[216:219], a[88:91], v[48:51], v[216:219]
 s_barrier
M v[224:227], a[96:99], v[48:51], v[224:227]
 s_cselect_b32 s21, s26, s21
 ds_read_b128 a[64:67], v7 offset:32768
 ds_read_b128 a[68:71], v7 offset:33792
M v[224:227], a[100:103], v[56:59], v[224:227]
 s_cmp_eq_u32 s22, s43
 v_cndmask_b32 v124, v36, v8, s[88:89]
 v_add_f32 v26, v22, v26
M v[228:231], a[100:103], v[60:63], v[228:231]
 s_cselect_b32 s21, s4, s21
 v_exp_f32 v25, v75
M v[228:231], a[96:99], v[52:55], v[228:231]
 s_cmp_eq_u32 s22, s6
 ds_read_b128 a[72:75], v7 offset:34816
 ds_read_b128 a[76:79], v7 offset:35840
M v[236:239], a[104:107], v[52:55], v[236:239]
 s_cselect_b32 s21, s7, s21
 v_cndmask_b32 v125, v36, v8, s[90:91]
 v_cvt_pk_bf16_f32 v42, v22, v23
M v[236:239], a[108:111], v[60:63], v[236:239]
 v_exp_f32 v18, v68
M v[232:235], a[108:111], v[56:59], v[232:235]
 ds_read_b128 a[80:83], v7 offset:36864
 ds_read_b128 a[84:87], v7 offset:37888
M v[232:235], a[104:107], v[48:51], v[232:235]
 v_cndmask_b32 v126, v36, v8, s[92:93]
 v_add_f32 v26, v23, v26
M v[240:243], a[112:115], v[48:51], v[240:243]
 v_exp_f32 v19, v69
M v[240:243], a[116:119], v[56:59], v[240:243]
 ds_read_b128 a[88:91], v7 offset:38912
 ds_read_b128 a[92:95], v7 offset:39936
M v[244:247], a[116:119], v[60:63], v[244:247]
 v_cndmask_b32 v127, v36, v8, s[94:95]
 v_add_f32 v26, v24, v26
M v[244:247], a[112:115], v[52:55], v[244:247]
 v_exp_f32 v20, v70
M v[252:255], a[120:123], v[52:55], v[252:255]
 v_exp_f32 v21, v71
M v[252:255], a[124:127], v[60:63], v[252:255]
 v_exp_f32 v22, v76
M v[248:251], a[124:127], v[56:59], v[248:251]
 s_waitcnt lgkmcnt(0)
 v_exp_f32 v23, v77
M v[248:251], a[120:123], v[48:51], v[248:251]
 v_cvt_pk_bf16_f32 v43, v24, v25
 v_add_f32 v26, v25, v26
 v_add_f32 v27, v18, v19
 v_cvt_pk_bf16_f32 v44, v18, v19
 v_add_f32 v27, v20, v27
 v_cvt_pk_bf16_f32 v45, v20, v21
 v_add_f32 v27, v21, v27
 v_exp_f32 v24, v78
 v_add_f32 v27, v22, v27
 v_cvt_pk_bf16_f32 v46, v22, v23
 v_exp_f32 v25, v79
 v_add_f32 v27, v23, v27
 v_add_f32 v27, v24, v27
 v_cvt_pk_bf16_f32 v47, v24, v25
 v_add_f32 v27, v25, v27
 s_waitcnt vmcnt(31)
 v_cmp_neq_f32 vcc, v32, v14
 v_cmp_neq_f32 s[64:65], v36, v15
 s_nop 0
 s_or_b64 vcc, vcc, s[64:65]
 s_cbranch_vccnz L_comb
 v_add_f32 v30, v16, v30
 v_add_f32 v31, v17, v31
M v[100:103], a[64:67], a[32:35], v[100:103]
 ds_read_b128 a[96:99], v7 offset:40960
 ds_read_b128 a[100:103], v7 offset:41984
M v[100:103], a[68:71], a[36:39], v[100:103]
 ds_read_b128 a[104:107], v7 offset:43008
M v[100:103], a[72:75], a[40:43], v[100:103]
 ds_read_b128 a[108:111], v7 offset:44032
 ds_read_b128 a[112:115], v7 offset:45056
M v[100:103], a[76:79], a[44:47], v[100:103]
 ds_read_b128 a[116:119], v7 offset:46080
M v[100:103], a[80:83], a[48:51], v[100:103]
 s_add_u32 m0, s28, 0
 ds_read_b128 a[120:123], v7 offset:47104
 ds_read_b128 a[124:127], v7 offset:48128
M v[100:103], a[84:87], a[52:55], v[100:103]
 buffer_load_dwordx4 v3, s[8:11], s24 offen offset:0 sc1 lds
M v[100:103], a[88:91], a[56:59], v[100:103]
 ds_read_b128 a[0:3], v7 offset:49152
 ds_read_b128 a[4:7], v7 offset:50176
M v[100:103], a[92:95], a[60:63], v[100:103]
 s_waitcnt lgkmcnt(2)
 ds_read_b128 a[8:11], v7 offset:51200
M v[108:111], a[124:127], a[60:63], v[108:111]
 ds_read_b128 a[12:15], v7 offset:52224
 ds_read_b128 a[16:19], v7 offset:53248
M v[108:111], a[120:123], a[56:59], v[108:111]
 buffer_load_dwordx4 v3, s[8:11], s24 offen offset:1024 sc1 lds
M v[108:111], a[116:119], a[52:55], v[108:111]
 ds_read_b128 a[20:23], v7 offset:54272
 ds_read_b128 a[24:27], v7 offset:55296
M v[108:111], a[112:115], a[48:51], v[108:111]
 ds_read_b128 a[28:31], v7 offset:56320
M v[108:111], a[108:111], a[44:47], v[108:111]
 ds_read_b128 a[192:195], v7 offset:57344
 ds_read_b128 a[196:199], v7 offset:58368
M v[108:111], a[104:107], a[40:43], v[108:111]
 v_exp_f32 v18, v80
M v[108:111], a[100:103], a[36:39], v[108:111]
 ds_read_b128 a[200:203], v7 offset:59392
 ds_read_b128 a[204:207], v7 offset:60416
M v[108:111], a[96:99], a[32:35], v[108:111]
 s_waitcnt lgkmcnt(4)
 ds_read_b128 a[208:211], v7 offset:61440
M v[116:119], a[0:3], a[32:35], v[116:119]
 ds_read_b128 a[212:215], v7 offset:62464
 ds_read_b128 a[216:219], v7 offset:63488
M v[116:119], a[4:7], a[36:39], v[116:119]
 ds_read_b128 a[220:223], v7 offset:64512
M v[116:119], a[8:11], a[40:43], v[116:119]
 buffer_load_dwordx4 v3, s[8:11], s24 offen offset:2048 sc1 lds
M v[116:119], a[12:15], a[44:47], v[116:119]
 v_exp_f32 v19, v81
M v[116:119], a[16:19], a[48:51], v[116:119]
 buffer_load_dwordx4 v3, s[8:11], s24 offen offset:3072 sc1 lds
M v[116:119], a[20:23], a[52:55], v[116:119]
 v_exp_f32 v20, v82
M v[116:119], a[24:27], a[56:59], v[116:119]
 s_add_u32 m0, s28, 4096
 v_exp_f32 v21, v83
M v[116:119], a[28:31], a[60:63], v[116:119]
 s_waitcnt lgkmcnt(0)
 v_exp_f32 v22, v88
M v[124:127], a[220:223], a[60:63], v[124:127]
 buffer_load_dwordx4 v4, s[8:11], s24 offen offset:0 sc1 lds
M v[124:127], a[216:219], a[56:59], v[124:127]
 v_exp_f32 v23, v89
M v[124:127], a[212:215], a[52:55], v[124:127]
 v_exp_f32 v24, v90
M v[124:127], a[208:211], a[48:51], v[124:127]
 v_exp_f32 v25, v91
M v[124:127], a[204:207], a[44:47], v[124:127]
 v_add_f32 v26, v18, v26
 v_cvt_pk_bf16_f32 v56, v18, v19
M v[124:127], a[200:203], a[40:43], v[124:127]
 buffer_load_dwordx4 v4, s[8:11], s24 offen offset:1024 sc1 lds
M v[124:127], a[196:199], a[36:39], v[124:127]
 v_add_f32 v26, v19, v26
 v_add_f32 v26, v20, v26
M v[124:127], a[192:195], a[32:35], v[124:127]
 s_waitcnt vmcnt(22)
 v_exp_f32 v18, v84
M v[128:131], a[246:249], a[128:131], v[128:131]
 v_exp_f32 v19, v85
M v[136:139], a[244:247], a[128:131], v[136:139]
 v_cvt_pk_bf16_f32 v57, v20, v21
 v_add_f32 v26, v21, v26
M v[144:147], a[246:249], a[132:135], v[144:147]
 buffer_load_dwordx4 v4, s[8:11], s24 offen offset:2048 sc1 lds
M v[152:155], a[244:247], a[132:135], v[152:155]
 v_exp_f32 v20, v86
M v[160:163], a[246:249], a[136:139], v[160:163]
 v_add_f32 v26, v22, v26
 v_cvt_pk_bf16_f32 v58, v22, v23
M v[168:171], a[244:247], a[136:139], v[168:171]
 v_add_f32 v26, v23, v26
 v_add_f32 v26, v24, v26
M v[176:179], a[246:249], a[140:143], v[176:179]
 v_exp_f32 v21, v87
M v[184:187], a[244:247], a[140:143], v[184:187]
 buffer_load_dwordx4 v4, s[8:11], s24 offen offset:3072 sc1 lds
M v[192:195], a[246:249], a[144:147], v[192:195]
 v_cvt_pk_bf16_f32 v59, v24, v25
 v_add_f32 v26, v25, v26
M v[200:203], a[244:247], a[144:147], v[200:203]
 v_add_f32 v27, v18, v27
 v_cvt_pk_bf16_f32 v60, v18, v19
M v[208:211], a[246:249], a[148:151], v[208:211]
 v_exp_f32 v22, v92
M v[216:219], a[244:247], a[148:151], v[216:219]
 v_add_f32 v27, v19, v27
 v_add_f32 v27, v20, v27
M v[224:227], a[246:249], a[152:155], v[224:227]
 v_cvt_pk_bf16_f32 v61, v20, v21
 v_add_f32 v27, v21, v27
M v[232:235], a[244:247], a[152:155], v[232:235]
 s_waitcnt vmcnt(8)
 v_exp_f32 v23, v93
M v[240:243], a[246:249], a[156:159], v[240:243]
 v_add_f32 v27, v22, v27
 v_cvt_pk_bf16_f32 v62, v22, v23
M v[248:251], a[244:247], a[156:159], v[248:251]
 s_barrier
M v[132:135], a[246:249], a[160:163], v[132:135]
 ds_read_b128 a[64:67], v2 offset:0
 v_add_f32 v27, v23, v27
M v[140:143], a[244:247], a[160:163], v[140:143]
 ds_read_b128 a[68:71], v2 offset:1024
M v[148:151], a[246:249], a[164:167], v[148:151]
 v_exp_f32 v24, v94
M v[156:159], a[244:247], a[164:167], v[156:159]
 ds_read_b128 a[72:75], v2 offset:2048
M v[164:167], a[246:249], a[168:171], v[164:167]
 ds_read_b128 a[76:79], v2 offset:3072
M v[172:175], a[244:247], a[168:171], v[172:175]
 v_exp_f32 v25, v95
M v[180:183], a[246:249], a[172:175], v[180:183]
 ds_read_b128 a[80:83], v2 offset:4096
 v_add_f32 v27, v24, v27
M v[188:191], a[244:247], a[172:175], v[188:191]
 ds_read_b128 a[84:87], v2 offset:5120
 v_cvt_pk_bf16_f32 v63, v24, v25
M v[196:199], a[246:249], a[176:179], v[196:199]
 v_add_f32 v27, v25, v27
M v[204:207], a[244:247], a[176:179], v[204:207]
 ds_read_b128 a[88:91], v2 offset:6144
M v[212:215], a[246:249], a[180:183], v[212:215]
 ds_read_b128 a[92:95], v2 offset:7168
 v_max_f32 v10, v26, v27
M v[220:223], a[244:247], a[180:183], v[220:223]
 v_cmp_lt_f32 vcc, s31, v10
M v[228:231], a[246:249], a[184:187], v[228:231]
M v[236:239], a[244:247], a[184:187], v[236:239]
M v[244:247], a[246:249], a[188:191], v[244:247]
 s_waitcnt lgkmcnt(0)
M v[252:255], a[244:247], a[188:191], v[252:255]
 s_cbranch_vccnz L_st14
L_rt14:
L_p3o:
M v[128:131], a[64:67], v[40:43], v[128:131]
 s_add_u32 m0, s28, 32768
 ds_read_b128 a[96:99], v2 offset:8192
 v_add_f32 v30, v26, v30
M v[128:131], a[68:71], v[56:59], v[128:131]
 ds_read_b128 a[100:103], v2 offset:9216
 v_add_f32 v31, v27, v31
M v[132:135], a[68:71], v[60:63], v[132:135]
 buffer_load_dwordx4 v3, s[8:11], s21 offen offset:0 sc1 lds
M v[132:135], a[64:67], v[44:47], v[132:135]
 ds_read_b128 a[104:107], v2 offset:10240
M v[140:143], a[72:75], v[44:47], v[140:143]
 ds_read_b128 a[108:111], v2 offset:11264
M v[140:143], a[76:79], v[60:63], v[140:143]
 buffer_load_dwordx4 v3, s[8:11], s21 offen offset:1024 sc1 lds
M v[136:139], a[76:79], v[56:59], v[136:139]
 ds_read_b128 a[112:115], v2 offset:12288
M v[136:139], a[72:75], v[40:43], v[136:139]
 ds_read_b128 a[116:119], v2 offset:13312
M v[144:147], a[80:83], v[40:43], v[144:147]
 v_exp_f32 v18, v100
M v[144:147], a[84:87], v[56:59], v[144:147]
 ds_read_b128 a[120:123], v2 offset:14336
M v[148:151], a[84:87], v[60:63], v[148:151]
 ds_read_b128 a[124:127], v2 offset:15360
M v[148:151], a[80:83], v[44:47], v[148:151]
 buffer_load_dwordx4 v3, s[8:11], s21 offen offset:2048 sc1 lds
M v[156:159], a[88:91], v[44:47], v[156:159]
 v_exp_f32 v19, v101
M v[156:159], a[92:95], v[60:63], v[156:159]
 v_exp_f32 v20, v102
M v[152:155], a[92:95], v[56:59], v[152:155]
 buffer_load_dwordx4 v3, s[8:11], s21 offen offset:3072 sc1 lds
M v[152:155], a[88:91], v[40:43], v[152:155]
 s_waitcnt lgkmcnt(0)
 v_exp_f32 v21, v103
M v[160:163], a[96:99], v[40:43], v[160:163]
 ds_read_b128 a[64:67], v2 offset:16384
 v_add_f32 v29, v18, v19
M v[160:163], a[100:103], v[56:59], v[160:163]
 s_add_u32 m0, s28, 36864
 ds_read_b128 a[68:71], v2 offset:17408
 v_cvt_pk_bf16_f32 v52, v18, v19
M v[164:167], a[100:103], v[60:63], v[164:167]
 buffer_load_dwordx4 v4, s[8:11], s21 offen offset:0 sc1 lds
M v[164:167], a[96:99], v[44:47], v[164:167]
 ds_read_b128 a[72:75], v2 offset:18432
 v_add_f32 v29, v20, v29
M v[172:175], a[104:107], v[44:47], v[172:175]
 ds_read_b128 a[76:79], v2 offset:19456
 v_cvt_pk_bf16_f32 v53, v20, v21
M v[172:175], a[108:111], v[60:63], v[172:175]
 v_exp_f32 v22, v108
M v[168:171], a[108:111], v[56:59], v[168:171]
 ds_read_b128 a[80:83], v2 offset:20480
 v_add_f32 v29, v21, v29
M v[168:171], a[104:107], v[40:43], v[168:171]
 ds_read_b128 a[84:87], v2 offset:21504
M v[176:179], a[112:115], v[40:43], v[176:179]
 buffer_load_dwordx4 v4, s[8:11], s21 offen offset:1024 sc1 lds
M v[176:179], a[116:119], v[56:59], v[176:179]
 ds_read_b128 a[88:91], v2 offset:22528
M v[180:183], a[116:119], v[60:63], v[180:183]
 ds_read_b128 a[92:95], v2 offset:23552
M v[180:183], a[112:115], v[44:47], v[180:183]
 buffer_load_dwordx4 v4, s[8:11], s21 offen offset:2048 sc1 lds
M v[188:191], a[120:123], v[44:47], v[188:191]
 v_exp_f32 v23, v109
M v[188:191], a[124:127], v[60:63], v[188:191]
 v_exp_f32 v24, v110
M v[184:187], a[124:127], v[56:59], v[184:187]
 v_exp_f32 v25, v111
M v[184:187], a[120:123], v[40:43], v[184:187]
 s_waitcnt lgkmcnt(0)
 v_exp_f32 v18, v116
M v[192:195], a[64:67], v[40:43], v[192:195]
 ds_read_b128 a[96:99], v2 offset:24576
 v_add_f32 v29, v22, v29
M v[192:195], a[68:71], v[56:59], v[192:195]
 ds_read_b128 a[100:103], v2 offset:25600
 v_cvt_pk_bf16_f32 v54, v22, v23
M v[196:199], a[68:71], v[60:63], v[196:199]
 buffer_load_dwordx4 v4, s[8:11], s21 offen offset:3072 sc1 lds
M v[196:199], a[64:67], v[44:47], v[196:199]
 s_add_u32 s24, s23, 33554432
 ds_read_b128 a[104:107], v2 offset:26624
 v_add_f32 v29, v23, v29
M v[204:207], a[72:75], v[44:47], v[204:207]
 s_mov_b32 s23, s21
 ds_read_b128 a[108:111], v2 offset:27648
 v_add_f32 v29, v24, v29
M v[204:207], a[76:79], v[60:63], v[204:207]
 s_add_u32 s21, s21, 65536
 v_exp_f32 v19, v117
M v[200:203], a[76:79], v[56:59], v[200:203]
 s_add_u32 s22, s22, 1
 ds_read_b128 a[112:115], v2 offset:28672
 v_cvt_pk_bf16_f32 v55, v24, v25
M v[200:203], a[72:75], v[40:43], v[200:203]
 s_cmp_eq_u32 s22, s25
 ds_read_b128 a[116:119], v2 offset:29696
 v_add_f32 v29, v25, v29
M v[208:211], a[80:83], v[40:43], v[208:211]
 s_cselect_b32 s21, s26, s21
 v_exp_f32 v20, v118
M v[208:211], a[84:87], v[56:59], v[208:211]
 s_cmp_eq_u32 s22, s43
 ds_read_b128 a[120:123], v2 offset:30720
 v_add_f32 v29, v18, v29
M v[212:215], a[84:87], v[60:63], v[212:215]
 s_cselect_b32 s21, s4, s21
 ds_read_b128 a[124:127], v2 offset:31744
 v_cvt_pk_bf16_f32 v48, v18, v19
M v[212:215], a[80:83], v[44:47], v[212:215]
 s_cmp_eq_u32 s22, s6
 v_exp_f32 v21, v119
M v[220:223], a[88:91], v[44:47], v[220:223]
 s_cselect_b32 s21, s7, s21
 v_exp_f32 v22, v124
M v[220:223], a[92:95], v[60:63], v[220:223]
 v_exp_f32 v23, v125
M v[216:219], a[92:95], v[56:59], v[216:219]
 s_waitcnt vmcnt(8) lgkmcnt(0)
 v_add_f32 v29, v19, v29
 v_add_f32 v29, v20, v29
M v[216:219], a[88:91], v[40:43], v[216:219]
 s_barrier
M v[224:227], a[96:99], v[40:43], v[224:227]
 ds_read_b128 a[64:67], v7 offset:0
 v_cvt_pk_bf16_f32 v49, v20, v21
M v[224:227], a[100:103], v[56:59], v[224:227]
 ds_read_b128 a[68:71], v7 offset:1024
 v_add_f32 v29, v21, v29
M v[228:231], a[100:103], v[60:63], v[228:231]
 v_exp_f32 v24, v126
M v[228:231], a[96:99], v[44:47], v[228:231]
 ds_read_b128 a[72:75], v7 offset:2048
 v_add_f32 v29, v22, v29
M v[236:239], a[104:107], v[44:47], v[236:239]
 ds_read_b128 a[76:79], v7 offset:3072
 v_cvt_pk_bf16_f32 v50, v22, v23
M v[236:239], a[108:111], v[60:63], v[236:239]
 v_exp_f32 v25, v127
M v[232:235], a[108:111], v[56:59], v[232:235]
 ds_read_b128 a[80:83], v7 offset:4096
 v_add_f32 v29, v23, v29
M v[232:235], a[104:107], v[40:43], v[232:235]
 ds_read_b128 a[84:87], v7 offset:5120
 v_add_f32 v29, v24, v29
M v[240:243], a[112:115], v[40:43], v[240:243]
 v_cvt_pk_bf16_f32 v51, v24, v25
 v_add_f32 v29, v25, v29
M v[240:243], a[116:119], v[56:59], v[240:243]
 ds_read_b128 a[88:91], v7 offset:6144
M v[244:247], a[116:119], v[60:63], v[244:247]
 ds_read_b128 a[92:95], v7 offset:7168
M v[244:247], a[112:115], v[44:47], v[244:247]
 v_cmp_lt_f32 vcc, s31, v29
M v[252:255], a[120:123], v[44:47], v[252:255]
M v[252:255], a[124:127], v[60:63], v[252:255]
M v[248:251], a[124:127], v[56:59], v[248:251]
 s_waitcnt lgkmcnt(0)
M v[248:251], a[120:123], v[40:43], v[248:251]
 s_cbranch_vccnz L_st2
L_rt2:
L_pBo:
M v[132:135], a[64:67], v[52:55], v[132:135]
 ds_read_b128 a[96:99], v7 offset:8192
 ds_read_b128 a[100:103], v7 offset:9216
M v[132:135], a[68:71], v[48:51], v[132:135]
 ds_read_b128 a[104:107], v7 offset:10240
 v_cvt_pk_bf16_f32 v128, v128, v129
 v_cvt_pk_bf16_f32 v129, v130, v131
M v[140:143], a[76:79], v[48:51], v[140:143]
 ds_read_b128 a[108:111], v7 offset:11264
 ds_read_b128 a[112:115], v7 offset:12288
 v_cvt_pk_bf16_f32 v130, v136, v137
M v[140:143], a[72:75], v[52:55], v[140:143]
 ds_read_b128 a[116:119], v7 offset:13312
 v_cvt_pk_bf16_f32 v131, v138, v139
 v_cvt_pk_bf16_f32 v144, v144, v145
M v[148:151], a[80:83], v[52:55], v[148:151]
 s_add_u32 m0, s28, 65536
 ds_read_b128 a[120:123], v7 offset:14336
 ds_read_b128 a[124:127], v7 offset:15360
M v[148:151], a[84:87], v[48:51], v[148:151]
 buffer_load_dwordx4 v3, s[8:11], s38 offen offset:0 sc1 lds
M v[156:159], a[92:95], v[48:51], v[156:159]
 ds_read_b128 a[128:131], v7 offset:16384
 ds_read_b128 a[132:135], v7 offset:17408
 v_cvt_pk_bf16_f32 v145, v146, v147
M v[156:159], a[88:91], v[52:55], v[156:159]
 s_waitcnt lgkmcnt(2)
 ds_read_b128 a[136:139], v7 offset:18432
 v_cvt_pk_bf16_f32 v146, v152, v153
 v_cvt_pk_bf16_f32 v147, v154, v155
M v[164:167], a[96:99], v[52:55], v[164:167]
 ds_read_b128 a[140:143], v7 offset:19456
 ds_read_b128 a[144:147], v7 offset:20480
 v_cvt_pk_bf16_f32 v160, v160, v161
M v[164:167], a[100:103], v[48:51], v[164:167]
 buffer_load_dwordx4 v3, s[8:11], s38 offen offset:1024 sc1 lds
M v[172:175], a[108:111], v[48:51], v[172:175]
 ds_read_b128 a[148:151], v7 offset:21504
 ds_read_b128 a[152:155], v7 offset:22528
 v_cvt_pk_bf16_f32 v161, v162, v163
M v[172:175], a[104:107], v[52:55], v[172:175]
 ds_read_b128 a[156:159], v7 offset:23552
 v_cvt_pk_bf16_f32 v162, v168, v169
 v_cvt_pk_bf16_f32 v163, v170, v171
M v[180:183], a[112:115], v[52:55], v[180:183]
 ds_read_b128 a[160:163], v7 offset:24576
 ds_read_b128 a[164:167], v7 offset:25600
 v_cvt_pk_bf16_f32 v176, v176, v177
M v[180:183], a[116:119], v[48:51], v[180:183]
 buffer_load_dwordx4 v3, s[8:11], s38 offen offset:2048 sc1 lds
M v[188:191], a[124:127], v[48:51], v[188:191]
 ds_read_b128 a[168:171], v7 offset:26624
 ds_read_b128 a[172:175], v7 offset:27648
 v_cvt_pk_bf16_f32 v177, v178, v179
M v[188:191], a[120:123], v[52:55], v[188:191]
 s_waitcnt lgkmcnt(4)
 ds_read_b128 a[176:179], v7 offset:28672
 v_cvt_pk_bf16_f32 v178, v184, v185
M v[196:199], a[128:131], v[52:55], v[196:199]
 ds_read_b128 a[180:183], v7 offset:29696
 ds_read_b128 a[184:187], v7 offset:30720
 v_cvt_pk_bf16_f32 v179, v186, v187
M v[196:199], a[132:135], v[48:51], v[196:199]
 ds_read_b128 a[188:191], v7 offset:31744
 v_cvt_pk_bf16_f32 v192, v192, v193
 v_cvt_pk_bf16_f32 v193, v194, v195
M v[204:207], a[140:143], v[48:51], v[204:207]
 buffer_load_dwordx4 v3, s[8:11], s38 offen offset:3072 sc1 lds
M v[204:207], a[136:139], v[52:55], v[204:207]
 s_add_u32 m0, s28, 69632
 v_cvt_pk_bf16_f32 v194, v200, v201
 v_cvt_pk_bf16_f32 v195, v202, v203
 v_cvt_pk_bf16_f32 v208, v208, v209
M v[212:215], a[144:147], v[52:55], v[212:215]
 buffer_load_dwordx4 v4, s[8:11], s38 offen offset:0 sc1 lds
M v[212:215], a[148:151], v[48:51], v[212:215]
 s_waitcnt lgkmcnt(0)
 v_cvt_pk_bf16_f32 v209, v210, v211
 v_cvt_pk_bf16_f32 v210, v216, v217
 v_cvt_pk_bf16_f32 v211, v218, v219
M v[220:223], a[156:159], v[48:51], v[220:223]
 s_barrier
M v[220:223], a[152:155], v[52:55], v[220:223]
 ds_read_b128 a[64:67], v2 offset:32768
 ds_read_b128 a[68:71], v2 offset:33792
 v_cvt_pk_bf16_f32 v224, v224, v225
M v[228:231], a[160:163], v[52:55], v[228:231]
 ds_read_b128 a[72:75], v2 offset:34816
 v_cvt_pk_bf16_f32 v225, v226, v227
 v_cvt_pk_bf16_f32 v226, v232, v233
M v[228:231], a[164:167], v[48:51], v[228:231]
 ds_read_b128 a[76:79], v2 offset:35840
 ds_read_b128 a[80:83], v2 offset:36864
M v[236:239], a[172:175], v[48:51], v[236:239]
 ds_read_b128 a[84:87], v2 offset:37888
 v_cvt_pk_bf16_f32 v227, v234, v235
 v_cvt_pk_bf16_f32 v240, v240, v241
M v[236:239], a[168:171], v[52:55], v[236:239]
 ds_read_b128 a[88:91], v2 offset:38912
 ds_read_b128 a[92:95], v2 offset:39936
 v_cvt_pk_bf16_f32 v241, v242, v243
M v[244:247], a[176:179], v[52:55], v[244:247]
 buffer_load_dwordx4 v4, s[8:11], s38 offen offset:1024 sc1 lds
M v[244:247], a[180:183], v[48:51], v[244:247]
 buffer_load_dwordx4 v4, s[8:11], s38 offen offset:2048 sc1 lds
M v[252:255], a[188:191], v[48:51], v[252:255]
 buffer_load_dwordx4 v4, s[8:11], s38 offen offset:3072 sc1 lds
M v[252:255], a[184:187], v[52:55], v[252:255]
 s_waitcnt lgkmcnt(0)
 s_add_u32 s38, s38, 65536
 v_cvt_pk_bf16_f32 v242, v248, v249
 v_cvt_pk_bf16_f32 v243, v250, v251
L_op1:
M v[64:67], a[64:67], v[128:131], 0
 ds_read_b128 a[96:99], v2 offset:40960
 ds_read_b128 a[100:103], v2 offset:41984
M v[64:67], a[68:71], v[144:147], v[64:67]
 ds_read_b128 a[104:107], v2 offset:43008
 v_cvt_pk_bf16_f32 v132, v132, v133
 v_cvt_pk_bf16_f32 v133, v134, v135
M v[64:67], a[72:75], v[160:163], v[64:67]
 ds_read_b128 a[108:111], v2 offset:44032
 ds_read_b128 a[112:115], v2 offset:45056
M v[64:67], a[76:79], v[176:179], v[64:67]
 ds_read_b128 a[116:119], v2 offset:46080
 v_cvt_pk_bf16_f32 v134, v140, v141
 v_cvt_pk_bf16_f32 v135, v142, v143
M v[64:67], a[80:83], v[192:195], v[64:67]
 s_add_u32 m0, s28, 0
 ds_read_b128 a[120:123], v2 offset:47104
 ds_read_b128 a[124:127], v2 offset:48128
M v[64:67], a[84:87], v[208:211], v[64:67]
 buffer_load_dwordx4 v3, s[8:11], s38 offen offset:0 sc1 lds
M v[64:67], a[88:91], v[224:227], v[64:67]
 ds_read_b128 a[128:131], v2 offset:49152
 ds_read_b128 a[132:135], v2 offset:50176
 v_cvt_pk_bf16_f32 v148, v148, v149
M v[64:67], a[92:95], v[240:243], v[64:67]
 s_waitcnt lgkmcnt(2)
 ds_read_b128 a[136:139], v2 offset:51200
 v_cvt_pk_bf16_f32 v149, v150, v151
M v[72:75], a[96:99], v[128:131], 0
 ds_read_b128 a[140:143], v2 offset:52224
 ds_read_b128 a[144:147], v2 offset:53248
M v[72:75], a[100:103], v[144:147], v[72:75]
 buffer_load_dwordx4 v3, s[8:11], s38 offen offset:1024 sc1 lds
M v[72:75], a[104:107], v[160:163], v[72:75]
 ds_read_b128 a[148:151], v2 offset:54272
 ds_read_b128 a[152:155], v2 offset:55296
 v_cvt_pk_bf16_f32 v150, v156, v157
M v[72:75], a[108:111], v[176:179], v[72:75]
 ds_read_b128 a[156:159], v2 offset:56320
 v_cvt_pk_bf16_f32 v151, v158, v159
M v[72:75], a[112:115], v[192:195], v[72:75]
 ds_read_b128 a[160:163], v2 offset:57344
 ds_read_b128 a[164:167], v2 offset:58368
 v_cvt_pk_bf16_f32 v164, v164, v165
M v[72:75], a[116:119], v[208:211], v[72:75]
 buffer_load_dwordx4 v3, s[8:11], s38 offen offset:2048 sc1 lds
M v[72:75], a[120:123], v[224:227], v[72:75]
 ds_read_b128 a[168:171], v2 offset:59392
 ds_read_b128 a[172:175], v2 offset:60416
M v[72:75], a[124:127], v[240:243], v[72:75]
 s_waitcnt lgkmcnt(4)
 ds_read_b128 a[176:179], v2 offset:61440
 v_cvt_pk_bf16_f32 v165, v166, v167
 v_cvt_pk_bf16_f32 v166, v172, v173
M v[80:83], a[128:131], v[128:131], 0
 ds_read_b128 a[180:183], v2 offset:62464
 ds_read_b128 a[184:187], v2 offset:63488
M v[80:83], a[132:135], v[144:147], v[80:83]
 ds_read_b128 a[188:191], v2 offset:64512
 v_cvt_pk_bf16_f32 v167, v174, v175
 v_cvt_pk_bf16_f32 v180, v180, v181
M v[80:83], a[136:139], v[160:163], v[80:83]
 buffer_load_dwordx4 v3, s[8:11], s38 offen offset:3072 sc1 lds
M v[80:83], a[140:143], v[176:179], v[80:83]
 s_add_u32 m0, s28, 4096
 v_cvt_pk_bf16_f32 v181, v182, v183
 v_cvt_pk_bf16_f32 v182, v188, v189
M v[80:83], a[144:147], v[192:195], v[80:83]
 buffer_load_dwordx4 v4, s[8:11], s38 offen offset:0 sc1 lds
M v[80:83], a[148:151], v[208:211], v[80:83]
 v_cvt_pk_bf16_f32 v183, v190, v191
 v_cvt_pk_bf16_f32 v196, v196, v197
M v[80:83], a[152:155], v[224:227], v[80:83]
 buffer_load_dwordx4 v4, s[8:11], s38 offen offset:1024 sc1 lds
M v[80:83], a[156:159], v[240:243], v[80:83]
 s_waitcnt lgkmcnt(0)
 v_cvt_pk_bf16_f32 v197, v198, v199
 v_cvt_pk_bf16_f32 v198, v204, v205
 v_cvt_pk_bf16_f32 v199, v206, v207
M v[88:91], a[160:163], v[128:131], 0
 v_cvt_pk_bf16_f32 v212, v212, v213
 v_cvt_pk_bf16_f32 v213, v214, v215
M v[88:91], a[164:167], v[144:147], v[88:91]
 v_cvt_pk_bf16_f32 v214, v220, v221
 v_cvt_pk_bf16_f32 v215, v222, v223
 v_cvt_pk_bf16_f32 v228, v228, v229
M v[88:91], a[168:171], v[160:163], v[88:91]
 buffer_load_dwordx4 v4, s[8:11], s38 offen offset:2048 sc1 lds
M v[88:91], a[172:175], v[176:179], v[88:91]
 v_cvt_pk_bf16_f32 v229, v230, v231
 v_cvt_pk_bf16_f32 v230, v236, v237
M v[88:91], a[176:179], v[192:195], v[88:91]
 v_cvt_pk_bf16_f32 v231, v238, v239
 v_cvt_pk_bf16_f32 v244, v244, v245
 v_cvt_pk_bf16_f32 v245, v246, v247
M v[88:91], a[180:183], v[208:211], v[88:91]
 buffer_load_dwordx4 v4, s[8:11], s38 offen offset:3072 sc1 lds
M v[88:91], a[184:187], v[224:227], v[88:91]
 v_cvt_pk_bf16_f32 v246, v252, v253
 v_cvt_pk_bf16_f32 v247, v254, v255
M v[88:91], a[188:191], v[240:243], v[88:91]
 s_add_u32 s38, s38, 65536
 v_add_f32 v31, v29, v31
 v_mov_b32 v10, v30
M v[68:71], a[64:67], v[132:135], 0
 s_add_u32 m0, s28, 131072
 v_mov_b32 v11, v31
 v_permlane16_swap_b32 v10, v30
M v[68:71], a[68:71], v[148:151], v[68:71]
 buffer_load_dwordx4 v3, s[8:11], s38 offen offset:0 sc1 lds
M v[68:71], a[72:75], v[164:167], v[68:71]
 v_permlane16_swap_b32 v11, v31
 v_add_f32 v30, v10, v30
M v[68:71], a[76:79], v[180:183], v[68:71]
 v_add_f32 v31, v11, v31
 v_mov_b32 v10, v30
M v[68:71], a[80:83], v[196:199], v[68:71]
 buffer_load_dwordx4 v3, s[8:11], s38 offen offset:1024 sc1 lds
M v[68:71], a[84:87], v[212:215], v[68:71]
 v_mov_b32 v11, v31
 v_permlane32_swap_b32 v10, v30
M v[68:71], a[88:91], v[228:231], v[68:71]
 v_permlane32_swap_b32 v11, v31
 v_add_f32 v30, v10, v30
M v[68:71], a[92:95], v[244:247], v[68:71]
 v_add_f32 v31, v11, v31
 s_lshl_b32 s64, s20, 1
M v[76:79], a[96:99], v[132:135], 0
 buffer_load_dwordx4 v3, s[8:11], s38 offen offset:2048 sc1 lds
M v[76:79], a[100:103], v[148:151], v[76:79]
 v_rcp_f32 v5, v30
 v_max3_f32 v32, |v64|, |v65|, |v66|
M v[76:79], a[104:107], v[164:167], v[76:79]
 v_rcp_f32 v6, v31
M v[76:79], a[108:111], v[180:183], v[76:79]
 buffer_load_dwordx4 v3, s[8:11], s38 offen offset:3072 sc1 lds
M v[76:79], a[112:115], v[196:199], v[76:79]
 s_lshr_b32 s64, s101, s64
 v_max3_f32 v32, |v67|, |v72|, v32
 v_max3_f32 v32, |v73|, |v74|, v32
M v[76:79], a[116:119], v[212:215], v[76:79]
 s_lshr_b32 s93, s64, 1
 s_xor_b32 s64, s64, s93
 s_and_b32 s64, s64, 1
M v[76:79], a[120:123], v[228:231], v[76:79]
 s_waitcnt vmcnt(20)
 s_lshl_b32 s64, s64, 13
 s_xor_b32 s93, s33, s64
 v_mul_f32 v32, 2.0, v32
M v[76:79], a[124:127], v[244:247], v[76:79]
 s_barrier
M v[84:87], a[128:131], v[132:135], 0
 ds_read_b128 a[64:67], v7 offset:32768
 s_add_u32 s93, s93, 32768
M v[84:87], a[132:135], v[148:151], v[84:87]
 s_add_u32 m0, s28, 135168
 ds_read_b128 a[68:71], v7 offset:33792
 v_mov_b32 v33, v32
 v_mov_b32 v34, v32
M v[84:87], a[136:139], v[164:167], v[84:87]
 buffer_load_dwordx4 v4, s[8:11], s38 offen offset:0 sc1 lds
M v[84:87], a[140:143], v[180:183], v[84:87]
 ds_read_b128 a[72:75], v7 offset:34816
 v_mov_b32 v35, v32
M v[84:87], a[144:147], v[196:199], v[84:87]
 ds_read_b128 a[76:79], v7 offset:35840
 v_max3_f32 v36, |v68|, |v69|, |v70|
M v[84:87], a[148:151], v[212:215], v[84:87]
 buffer_load_dwordx4 v4, s[8:11], s38 offen offset:1024 sc1 lds
M v[84:87], a[152:155], v[228:231], v[84:87]
 ds_read_b128 a[80:83], v7 offset:36864
M v[84:87], a[156:159], v[244:247], v[84:87]
 ds_read_b128 a[84:87], v7 offset:37888
 v_max3_f32 v36, |v71|, |v76|, v36
M v[92:95], a[160:163], v[132:135], 0
 buffer_load_dwordx4 v4, s[8:11], s38 offen offset:2048 sc1 lds
M v[92:95], a[164:167], v[148:151], v[92:95]
 ds_read_b128 a[88:91], v7 offset:38912
 v_max3_f32 v36, |v77|, |v78|, v36
M v[92:95], a[168:171], v[164:167], v[92:95]
 ds_read_b128 a[92:95], v7 offset:39936
 v_mul_f32 v36, 2.0, v36
M v[92:95], a[172:175], v[180:183], v[92:95]
 buffer_load_dwordx4 v4, s[8:11], s38 offen offset:3072 sc1 lds
M v[92:95], a[176:179], v[196:199], v[92:95]
 s_add_u32 s38, s38, 65536
 v_mov_b32 v37, v36
M v[92:95], a[180:183], v[212:215], v[92:95]
 v_mov_b32 v38, v36
 v_mov_b32 v39, v36
M v[92:95], a[184:187], v[228:231], v[92:95]
 s_waitcnt lgkmcnt(0)
 s_cmp_eq_u32 s42, 6
M v[92:95], a[188:191], v[244:247], v[92:95]
 s_cbranch_scc1 L_y1
L_y1r:
M v[96:99], a[64:67], v[128:131], v[32:35]
 s_add_u32 m0, s28, 98304
 ds_read_b128 a[96:99], v7 offset:40960
M v[96:99], a[68:71], v[144:147], v[96:99]
 ds_read_b128 a[100:103], v7 offset:41984
M v[96:99], a[72:75], v[160:163], v[96:99]
 buffer_load_dwordx4 v3, s[8:11], s38 offen offset:0 sc1 lds
M v[96:99], a[76:79], v[176:179], v[96:99]
 ds_read_b128 a[104:107], v7 offset:43008
 s_add_u32 s29, s33, 0
M v[96:99], a[80:83], v[192:195], v[96:99]
 ds_read_b128 a[108:111], v7 offset:44032
 s_add_u32 s30, s93, 0
M v[96:99], a[84:87], v[208:211], v[96:99]
 buffer_load_dwordx4 v3, s[8:11], s38 offen offset:1024 sc1 lds
M v[96:99], a[88:91], v[224:227], v[96:99]
 ds_read_b128 a[112:115], v7 offset:45056
 v_mul_f32 v28, -v32, v5
M v[96:99], a[92:95], v[240:243], v[96:99]
 ds_read_b128 a[116:119], v7 offset:46080
 v_mul_f32 v64, v5, v64
M v[100:103], a[92:95], v[244:247], v[36:39]
 buffer_load_dwordx4 v3, s[8:11], s38 offen offset:2048 sc1 lds
M v[100:103], a[88:91], v[228:231], v[100:103]
 ds_read_b128 a[120:123], v7 offset:47104
 v_mul_f32 v65, v5, v65
M v[100:103], a[84:87], v[212:215], v[100:103]
 ds_read_b128 a[124:127], v7 offset:48128
 v_mul_f32 v66, v5, v66
M v[100:103], a[80:83], v[196:199], v[100:103]
 buffer_load_dwordx4 v3, s[8:11], s38 offen offset:3072 sc1 lds
M v[100:103], a[76:79], v[180:183], v[100:103]
 s_add_u32 m0, s28, 102400
 v_mul_f32 v67, v5, v67
 v_mul_f32 v72, v5, v72
M v[100:103], a[72:75], v[164:167], v[100:103]
 buffer_load_dwordx4 v4, s[8:11], s38 offen offset:0 sc1 lds
M v[100:103], a[68:71], v[148:151], v[100:103]
 v_mul_f32 v73, v5, v73
 v_mul_f32 v74, v5, v74
M v[100:103], a[64:67], v[132:135], v[100:103]
 s_waitcnt lgkmcnt(0)
 v_mul_f32 v75, v5, v75
 v_cvt_pk_bf16_f32 v64, v64, v65
M v[108:111], a[96:99], v[132:135], v[36:39]
 ds_read_b128 a[64:67], v7 offset:49152
 v_cvt_pk_bf16_f32 v65, v66, v67
M v[108:111], a[100:103], v[148:151], v[108:111]
 ds_read_b128 a[68:71], v7 offset:50176
 v_cvt_pk_bf16_f32 v66, v72, v73
M v[108:111], a[104:107], v[164:167], v[108:111]
 buffer_load_dwordx4 v4, s[8:11], s38 offen offset:1024 sc1 lds
M v[108:111], a[108:111], v[180:183], v[108:111]
 ds_read_b128 a[72:75], v7 offset:51200
 v_cvt_pk_bf16_f32 v67, v74, v75
M v[108:111], a[112:115], v[196:199], v[108:111]
 ds_read_b128 a[76:79], v7 offset:52224
M v[108:111], a[116:119], v[212:215], v[108:111]
 buffer_load_dwordx4 v4, s[8:11], s38 offen offset:2048 sc1 lds
M v[108:111], a[120:123], v[228:231], v[108:111]
 ds_read_b128 a[80:83], v7 offset:53248
M v[108:111], a[124:127], v[244:247], v[108:111]
 ds_read_b128 a[84:87], v7 offset:54272
M v[104:107], a[124:127], v[240:243], v[32:35]
 buffer_load_dwordx4 v4, s[8:11], s38 offen offset:3072 sc1 lds
M v[104:107], a[120:123], v[224:227], v[104:107]
 s_add_u32 s38, s38, 65536
 ds_read_b128 a[88:91], v7 offset:55296
M v[104:107], a[116:119], v[208:211], v[104:107]
 ds_read_b128 a[92:95], v7 offset:56320
M v[104:107], a[112:115], v[192:195], v[104:107]
 buffer_store_dwordx4 v[64:67], v7, s[8:11], s29 offen offset:0 sc1
M v[104:107], a[108:111], v[176:179], v[104:107]
 v_mul_f32 v29, -v36, v6
 v_mul_f32 v68, v6, v68
M v[104:107], a[104:107], v[160:163], v[104:107]
 v_mul_f32 v69, v6, v69
 v_mul_f32 v70, v6, v70
M v[104:107], a[100:103], v[144:147], v[104:107]
 v_mul_f32 v71, v6, v71
 v_mul_f32 v76, v6, v76
M v[104:107], a[96:99], v[128:131], v[104:107]
 s_waitcnt lgkmcnt(0)
 v_mul_f32 v77, v6, v77
 v_mul_f32 v78, v6, v78
M v[112:115], a[64:67], v[128:131], v[32:35]
 ds_read_b128 a[96:99], v7 offset:57344
 v_mul_f32 v79, v6, v79
M v[112:115], a[68:71], v[144:147], v[112:115]
 ds_read_b128 a[100:103], v7 offset:58368
 v_cvt_pk_bf16_f32 v68, v68, v69
M v[112:115], a[72:75], v[160:163], v[112:115]
 v_cvt_pk_bf16_f32 v69, v70, v71
 v_cvt_pk_bf16_f32 v70, v76, v77
M v[112:115], a[76:79], v[176:179], v[112:115]
 ds_read_b128 a[104:107], v7 offset:59392
 v_cvt_pk_bf16_f32 v71, v78, v79
M v[112:115], a[80:83], v[192:195], v[112:115]
 ds_read_b128 a[108:111], v7 offset:60416
M v[112:115], a[84:87], v[208:211], v[112:115]
 buffer_store_dwordx4 v[68:71], v7, s[8:11], s30 offen offset:0 sc1
M v[112:115], a[88:91], v[224:227], v[112:115]
 ds_read_b128 a[112:115], v7 offset:61440
 v_mul_f32 v80, v5, v80
M v[112:115], a[92:95], v[240:243], v[112:115]
 ds_read_b128 a[116:119], v7 offset:62464
 v_mul_f32 v81, v5, v81
M v[116:119], a[92:95], v[244:247], v[36:39]
 v_mul_f32 v82, v5, v82
 v_mul_f32 v83, v5, v83
M v[116:119], a[88:91], v[228:231], v[116:119]
 ds_read_b128 a[120:123], v7 offset:63488
 v_mul_f32 v88, v5, v88
M v[116:119], a[84:87], v[212:215], v[116:119]
 ds_read_b128 a[124:127], v7 offset:64512
 v_mul_f32 v89, v5, v89
M v[116:119], a[80:83], v[196:199], v[116:119]
 v_mul_f32 v90, v5, v90
 v_mul_f32 v91, v5, v91
M v[116:119], a[76:79], v[180:183], v[116:119]
 v_cvt_pk_bf16_f32 v80, v80, v81
 v_cvt_pk_bf16_f32 v81, v82, v83
M v[116:119], a[72:75], v[164:167], v[116:119]
 v_cvt_pk_bf16_f32 v82, v88, v89
 v_cvt_pk_bf16_f32 v83, v90, v91
M v[116:119], a[68:71], v[148:151], v[116:119]
 s_waitcnt vmcnt(26) lgkmcnt(0)
M v[116:119], a[64:67], v[132:135], v[116:119]
 s_barrier
M v[124:127], a[96:99], v[132:135], v[36:39]
 ds_read_b128 a[64:67], v2 offset:0
M v[124:127], a[100:103], v[148:151], v[124:127]
 ds_read_b128 a[68:71], v2 offset:1024
M v[124:127], a[104:107], v[164:167], v[124:127]
 buffer_store_dwordx4 v[80:83], v7, s[8:11], s29 offen offset:1024 sc1
M v[124:127], a[108:111], v[180:183], v[124:127]
 ds_read_b128 a[72:75], v2 offset:2048
 v_mul_f32 v84, v6, v84
M v[124:127], a[112:115], v[196:199], v[124:127]
 ds_read_b128 a[76:79], v2 offset:3072
 v_mul_f32 v85, v6, v85
M v[124:127], a[116:119], v[212:215], v[124:127]
 v_mul_f32 v86, v6, v86
 v_mul_f32 v87, v6, v87
M v[124:127], a[120:123], v[228:231], v[124:127]
 ds_read_b128 a[80:83], v2 offset:4096
 v_mul_f32 v92, v6, v92
M v[124:127], a[124:127], v[244:247], v[124:127]
 ds_read_b128 a[84:87], v2 offset:5120
 v_mul_f32 v93, v6, v93
M v[120:123], a[124:127], v[240:243], v[32:35]
 v_mul_f32 v94, v6, v94
 v_mul_f32 v95, v6, v95
M v[120:123], a[120:123], v[224:227], v[120:123]
 ds_read_b128 a[88:91], v2 offset:6144
 v_cvt_pk_bf16_f32 v84, v84, v85
M v[120:123], a[116:119], v[208:211], v[120:123]
 ds_read_b128 a[92:95], v2 offset:7168
 v_cvt_pk_bf16_f32 v85, v86, v87
M v[120:123], a[112:115], v[192:195], v[120:123]
 v_cvt_pk_bf16_f32 v86, v92, v93
 v_cvt_pk_bf16_f32 v87, v94, v95
M v[120:123], a[108:111], v[176:179], v[120:123]
 buffer_store_dwordx4 v[84:87], v7, s[8:11], s30 offen offset:1024 sc1
M v[120:123], a[104:107], v[160:163], v[120:123]
M v[120:123], a[100:103], v[144:147], v[120:123]
 s_waitcnt lgkmcnt(0)
M v[120:123], a[96:99], v[128:131], v[120:123]
M v[64:67], a[64:67], v[128:131], v[32:35]
 s_add_u32 m0, s28, 32768
 ds_read_b128 a[96:99], v2 offset:8192
M v[64:67], a[68:71], v[144:147], v[64:67]
 ds_read_b128 a[100:103], v2 offset:9216
 s_and_b32 s79, s101, 1
M v[64:67], a[72:75], v[160:163], v[64:67]
 buffer_load_dwordx4 v3, s[8:11], s38 offen offset:0 sc1 lds
M v[64:67], a[76:79], v[176:179], v[64:67]
 ds_read_b128 a[104:107], v2 offset:10240
 s_lshl_b32 s79, s79, 13
M v[64:67], a[80:83], v[192:195], v[64:67]
 s_add_u32 s79, s79, 234946560
 ds_read_b128 a[108:111], v2 offset:11264
 s_add_u32 s29, s33, 2048
M v[64:67], a[84:87], v[208:211], v[64:67]
 buffer_load_dwordx4 v3, s[8:11], s38 offen offset:1024 sc1 lds
M v[64:67], a[88:91], v[224:227], v[64:67]
 ds_read_b128 a[112:115], v2 offset:12288
 s_add_u32 s30, s93, 2048
M v[64:67], a[92:95], v[240:243], v[64:67]
 ds_read_b128 a[116:119], v2 offset:13312
 v_fma_f32 v96, v96, v5, v28
M v[68:71], a[92:95], v[244:247], v[36:39]
 buffer_load_dwordx4 v3, s[8:11], s38 offen offset:2048 sc1 lds
M v[68:71], a[88:91], v[228:231], v[68:71]
 ds_read_b128 a[120:123], v2 offset:14336
 v_fma_f32 v97, v97, v5, v28
M v[68:71], a[84:87], v[212:215], v[68:71]
 ds_read_b128 a[124:127], v2 offset:15360
 v_fma_f32 v98, v98, v5, v28
M v[68:71], a[80:83], v[196:199], v[68:71]
 buffer_load_dwordx4 v3, s[8:11], s38 offen offset:3072 sc1 lds
M v[68:71], a[76:79], v[180:183], v[68:71]
 s_add_u32 m0, s28, 36864
 v_fma_f32 v99, v99, v5, v28
 v_fma_f32 v104, v104, v5, v28
M v[68:71], a[72:75], v[164:167], v[68:71]
 buffer_load_dwordx4 v4, s[8:11], s38 offen offset:0 sc1 lds
M v[68:71], a[68:71], v[148:151], v[68:71]
 buffer_load_dword v24, off, s[8:11], s79 sc1
M v[68:71], a[64:67], v[132:135], v[68:71]
 s_waitcnt lgkmcnt(0)
 v_lshrrev_b32 v0, 4, v7
 v_and_b32 v14, 15, v0
M v[76:79], a[96:99], v[132:135], v[36:39]
 ds_read_b128 a[64:67], v2 offset:16384
 v_lshlrev_b32 v14, 2, v14
M v[76:79], a[100:103], v[148:151], v[76:79]
 ds_read_b128 a[68:71], v2 offset:17408
 v_lshrrev_b32 v11, 4, v0
M v[76:79], a[104:107], v[164:167], v[76:79]
 buffer_load_dwordx4 v4, s[8:11], s38 offen offset:1024 sc1 lds
M v[76:79], a[108:111], v[180:183], v[76:79]
 ds_read_b128 a[72:75], v2 offset:18432
 s_mov_b32 s52, s96
M v[76:79], a[112:115], v[196:199], v[76:79]
 s_and_b32 s53, s97, 0xffff
 ds_read_b128 a[76:79], v2 offset:19456
 s_mov_b32 s54, 1835008
M v[76:79], a[116:119], v[212:215], v[76:79]
 buffer_load_dwordx4 v4, s[8:11], s38 offen offset:2048 sc1 lds
M v[76:79], a[120:123], v[228:231], v[76:79]
 ds_read_b128 a[80:83], v2 offset:20480
 s_mov_b32 s55, 0x20000
M v[76:79], a[124:127], v[244:247], v[76:79]
 s_lshr_b32 s74, s41, 3
 ds_read_b128 a[84:87], v2 offset:21504
 s_xor_b32 s74, s74, 0
M v[72:75], a[124:127], v[240:243], v[32:35]
 buffer_load_dwordx4 v4, s[8:11], s38 offen offset:3072 sc1 lds
M v[72:75], a[120:123], v[224:227], v[72:75]
 s_add_u32 s38, s38, 65536
 ds_read_b128 a[88:91], v2 offset:22528
 s_mul_i32 s67, s74, -2
M v[72:75], a[116:119], v[208:211], v[72:75]
 s_mul_i32 s74, s74, 8
 ds_read_b128 a[92:95], v2 offset:23552
 v_fma_f32 v105, v105, v5, v28
M v[72:75], a[112:115], v[192:195], v[72:75]
 s_add_u32 s74, s74, s20
 v_fma_f32 v106, v106, v5, v28
 v_fma_f32 v107, v107, v5, v28
M v[72:75], a[108:111], v[176:179], v[72:75]
 s_lshl_b32 s75, s74, 6
 v_cvt_pk_bf16_f32 v96, v96, v97
 v_cvt_pk_bf16_f32 v97, v98, v99
M v[72:75], a[104:107], v[160:163], v[72:75]
 s_add_u32 s76, s75, 256
 v_cvt_pk_bf16_f32 v98, v104, v105
 v_cvt_pk_bf16_f32 v99, v106, v107
M v[72:75], a[100:103], v[144:147], v[72:75]
 s_add_u32 s67, s67, 3
 v_add_u32 v43, 0x20000, v7
 s_sub_u32 s67, s67, s20
M v[72:75], a[96:99], v[128:131], v[72:75]
 s_waitcnt lgkmcnt(0)
 s_and_b32 s67, s67, 536870912
M v[80:83], a[64:67], v[128:131], v[32:35]
 s_or_b32 s76, s76, s67
 ds_read_b128 a[96:99], v2 offset:24576
 v_or_b32 v27, s67, v7
M v[80:83], a[68:71], v[144:147], v[80:83]
 ds_read_b128 a[100:103], v2 offset:25600
 v_add_u32 v27, 4096, v27
M v[80:83], a[72:75], v[160:163], v[80:83]
 buffer_store_dwordx4 v[96:99], v7, s[8:11], s29 offen offset:0 sc1
M v[80:83], a[76:79], v[176:179], v[80:83]
 ds_read_b128 a[104:107], v2 offset:26624
 v_fma_f32 v100, v100, v6, v29
M v[80:83], a[80:83], v[192:195], v[80:83]
 ds_read_b128 a[108:111], v2 offset:27648
 v_fma_f32 v101, v101, v6, v29
M v[80:83], a[84:87], v[208:211], v[80:83]
 v_fma_f32 v102, v102, v6, v29
 v_fma_f32 v103, v103, v6, v29
M v[80:83], a[88:91], v[224:227], v[80:83]
 ds_read_b128 a[112:115], v2 offset:28672
 v_fma_f32 v108, v108, v6, v29
M v[80:83], a[92:95], v[240:243], v[80:83]
 ds_read_b128 a[116:119], v2 offset:29696
 v_fma_f32 v109, v109, v6, v29
M v[84:87], a[92:95], v[244:247], v[36:39]
 v_fma_f32 v110, v110, v6, v29
 v_fma_f32 v111, v111, v6, v29
M v[84:87], a[88:91], v[228:231], v[84:87]
 ds_read_b128 a[120:123], v2 offset:30720
 v_cvt_pk_bf16_f32 v100, v100, v101
M v[84:87], a[84:87], v[212:215], v[84:87]
 ds_read_b128 a[124:127], v2 offset:31744
 v_cvt_pk_bf16_f32 v101, v102, v103
M v[84:87], a[80:83], v[196:199], v[84:87]
 v_cvt_pk_bf16_f32 v102, v108, v109
 v_cvt_pk_bf16_f32 v103, v110, v111
M v[84:87], a[76:79], v[180:183], v[84:87]
 buffer_store_dwordx4 v[100:103], v7, s[8:11], s30 offen offset:0 sc1
M v[84:87], a[72:75], v[164:167], v[84:87]
 v_fma_f32 v112, v112, v5, v28
 v_fma_f32 v113, v113, v5, v28
M v[84:87], a[68:71], v[148:151], v[84:87]
 s_waitcnt vmcnt(31) lgkmcnt(0)
 v_fma_f32 v114, v114, v5, v28
 v_fma_f32 v115, v115, v5, v28
M v[84:87], a[64:67], v[132:135], v[84:87]
 s_barrier
M v[92:95], a[96:99], v[132:135], v[36:39]
 ds_read_b128 a[64:67], v7 offset:0
 v_fma_f32 v120, v120, v5, v28
M v[92:95], a[100:103], v[148:151], v[92:95]
 ds_read_b128 a[68:71], v7 offset:1024
 v_fma_f32 v121, v121, v5, v28
M v[92:95], a[104:107], v[164:167], v[92:95]
 v_fma_f32 v122, v122, v5, v28
 v_fma_f32 v123, v123, v5, v28
M v[92:95], a[108:111], v[180:183], v[92:95]
 ds_read_b128 a[72:75], v7 offset:2048
 v_cvt_pk_bf16_f32 v112, v112, v113
M v[92:95], a[112:115], v[196:199], v[92:95]
 ds_read_b128 a[76:79], v7 offset:3072
 v_cvt_pk_bf16_f32 v113, v114, v115
M v[92:95], a[116:119], v[212:215], v[92:95]
 v_cvt_pk_bf16_f32 v114, v120, v121
 v_cvt_pk_bf16_f32 v115, v122, v123
M v[92:95], a[120:123], v[228:231], v[92:95]
 ds_read_b128 a[80:83], v7 offset:4096
M v[92:95], a[124:127], v[244:247], v[92:95]
 ds_read_b128 a[84:87], v7 offset:5120
M v[88:91], a[124:127], v[240:243], v[32:35]
 buffer_store_dwordx4 v[112:115], v7, s[8:11], s29 offen offset:1024 sc1
M v[88:91], a[120:123], v[224:227], v[88:91]
 ds_read_b128 a[88:91], v7 offset:6144
 v_fma_f32 v116, v116, v6, v29
M v[88:91], a[116:119], v[208:211], v[88:91]
 ds_read_b128 a[92:95], v7 offset:7168
 v_fma_f32 v117, v117, v6, v29
M v[88:91], a[112:115], v[192:195], v[88:91]
 v_fma_f32 v118, v118, v6, v29
 v_fma_f32 v119, v119, v6, v29
M v[88:91], a[108:111], v[176:179], v[88:91]
 v_fma_f32 v124, v124, v6, v29
 v_fma_f32 v125, v125, v6, v29
M v[88:91], a[104:107], v[160:163], v[88:91]
 v_fma_f32 v126, v126, v6, v29
 v_fma_f32 v127, v127, v6, v29
M v[88:91], a[100:103], v[144:147], v[88:91]
 s_waitcnt lgkmcnt(0)
 v_cvt_pk_bf16_f32 v116, v116, v117
 v_cvt_pk_bf16_f32 v117, v118, v119
M v[88:91], a[96:99], v[128:131], v[88:91]
 v_cvt_pk_bf16_f32 v118, v124, v125
 v_cvt_pk_bf16_f32 v119, v126, v127
 buffer_store_dwordx4 v[116:119], v7, s[8:11], s30 offen offset:1024 sc1
M v[96:99], a[64:67], v[128:131], v[32:35]
 ds_read_b128 a[96:99], v7 offset:8192
M v[96:99], a[68:71], v[144:147], v[96:99]
 ds_read_b128 a[100:103], v7 offset:9216
M v[96:99], a[72:75], v[160:163], v[96:99]
 s_sub_u32 s64, 15, s42
M v[96:99], a[76:79], v[176:179], v[96:99]
 s_min_u32 s64, s64, s42
 ds_read_b128 a[104:107], v7 offset:10240
 s_add_u32 s29, s33, 4096
M v[96:99], a[80:83], v[192:195], v[96:99]
 s_mul_i32 s45, s64, 33024
 ds_read_b128 a[108:111], v7 offset:11264
 s_add_u32 s30, s93, 4096
M v[96:99], a[84:87], v[208:211], v[96:99]
 s_lshl_b32 s64, s20, 6
 v_fma_f32 v64, v64, v5, v28
 v_fma_f32 v65, v65, v5, v28
M v[96:99], a[88:91], v[224:227], v[96:99]
 s_add_u32 s64, s64, s41
 ds_read_b128 a[112:115], v7 offset:12288
 v_fma_f32 v66, v66, v5, v28
M v[96:99], a[92:95], v[240:243], v[96:99]
 s_lshl2_add_u32 s45, s64, s45
 ds_read_b128 a[116:119], v7 offset:13312
 v_fma_f32 v67, v67, v5, v28
M v[100:103], a[92:95], v[244:247], v[36:39]
 s_add_u32 s45, s45, 235210752
 v_fma_f32 v72, v72, v5, v28
M v[100:103], a[88:91], v[228:231], v[100:103]
 s_movk_i32 s65, 1024
 ds_read_b128 a[120:123], v7 offset:14336
 v_fma_f32 v73, v73, v5, v28
M v[100:103], a[84:87], v[212:215], v[100:103]
 s_cmp_lt_u32 s42, 8
 ds_read_b128 a[124:127], v7 offset:15360
 v_fma_f32 v74, v74, v5, v28
M v[100:103], a[80:83], v[196:199], v[100:103]
 s_cselect_b32 s64, 16512, s65
 v_fma_f32 v75, v75, v5, v28
M v[100:103], a[76:79], v[180:183], v[100:103]
 s_cselect_b32 s65, 0, 64
 v_cvt_pk_bf16_f32 v64, v64, v65
M v[100:103], a[72:75], v[164:167], v[100:103]
 s_cselect_b32 s66, 32, 64
 v_cvt_pk_bf16_f32 v65, v66, v67
M v[100:103], a[68:71], v[148:151], v[100:103]
 s_add_u32 s3, s45, s64
 s_add_u32 s45, s45, s65
 v_lshrrev_b32 v42, 5, v7
M v[100:103], a[64:67], v[132:135], v[100:103]
 s_waitcnt lgkmcnt(0)
 v_mul_u32_u24 v42, 16512, v42
 v_and_b32 v41, 16, v7
M v[108:111], a[96:99], v[132:135], v[36:39]
 ds_read_b128 a[64:67], v7 offset:16384
 v_lshl_add_u32 v41, v41, 3, v42
M v[108:111], a[100:103], v[148:151], v[108:111]
 s_lshl_b32 s65, s20, 1
 ds_read_b128 a[68:71], v7 offset:17408
 v_cvt_pk_bf16_f32 v66, v72, v73
M v[108:111], a[104:107], v[164:167], v[108:111]
 s_lshr_b32 s65, s101, s65
 v_bfe_u32 v42, v7, 4, 1
 v_lshrrev_b32 v42, v42, s65
M v[108:111], a[108:111], v[180:183], v[108:111]
 ds_read_b128 a[72:75], v7 offset:18432
 v_and_b32 v42, 1, v42
M v[108:111], a[112:115], v[196:199], v[108:111]
 ds_read_b128 a[76:79], v7 offset:19456
 v_lshl_add_u32 v41, v42, 13, v41
M v[108:111], a[116:119], v[212:215], v[108:111]
 v_mov_b32 v42, 536870912
 v_cmp_gt_u32 vcc, s66, v7
M v[108:111], a[120:123], v[228:231], v[108:111]
 ds_read_b128 a[80:83], v7 offset:20480
 v_mov_b32 v40, 1
M v[108:111], a[124:127], v[244:247], v[108:111]
 s_nop 0
 ds_read_b128 a[84:87], v7 offset:21504
 v_cndmask_b32 v41, v42, v41, vcc
M v[104:107], a[124:127], v[240:243], v[32:35]
 v_cvt_pk_bf16_f32 v67, v74, v75
M v[104:107], a[120:123], v[224:227], v[104:107]
 ds_read_b128 a[88:91], v7 offset:22528
M v[104:107], a[116:119], v[208:211], v[104:107]
 ds_read_b128 a[92:95], v7 offset:23552
M v[104:107], a[112:115], v[192:195], v[104:107]
 buffer_store_dwordx4 v[64:67], v7, s[8:11], s29 offen offset:0 sc1
M v[104:107], a[108:111], v[176:179], v[104:107]
 v_fma_f32 v68, v68, v6, v29
 v_fma_f32 v69, v69, v6, v29
M v[104:107], a[104:107], v[160:163], v[104:107]
 v_fma_f32 v70, v70, v6, v29
 v_fma_f32 v71, v71, v6, v29
M v[104:107], a[100:103], v[144:147], v[104:107]
 v_fma_f32 v76, v76, v6, v29
 v_fma_f32 v77, v77, v6, v29
M v[104:107], a[96:99], v[128:131], v[104:107]
 s_waitcnt lgkmcnt(0)
 v_fma_f32 v78, v78, v6, v29
 v_fma_f32 v79, v79, v6, v29
M v[112:115], a[64:67], v[128:131], v[32:35]
 ds_read_b128 a[96:99], v7 offset:24576
 v_cvt_pk_bf16_f32 v68, v68, v69
M v[112:115], a[68:71], v[144:147], v[112:115]
 ds_read_b128 a[100:103], v7 offset:25600
 v_cvt_pk_bf16_f32 v69, v70, v71
M v[112:115], a[72:75], v[160:163], v[112:115]
 v_cvt_pk_bf16_f32 v70, v76, v77
 v_cvt_pk_bf16_f32 v71, v78, v79
M v[112:115], a[76:79], v[176:179], v[112:115]
 ds_read_b128 a[104:107], v7 offset:26624
M v[112:115], a[80:83], v[192:195], v[112:115]
 ds_read_b128 a[108:111], v7 offset:27648
M v[112:115], a[84:87], v[208:211], v[112:115]
 buffer_store_dwordx4 v[68:71], v7, s[8:11], s30 offen offset:0 sc1
M v[112:115], a[88:91], v[224:227], v[112:115]
 ds_read_b128 a[112:115], v7 offset:28672
 v_fma_f32 v80, v80, v5, v28
M v[112:115], a[92:95], v[240:243], v[112:115]
 ds_read_b128 a[116:119], v7 offset:29696
 v_fma_f32 v81, v81, v5, v28
M v[116:119], a[92:95], v[244:247], v[36:39]
 v_fma_f32 v82, v82, v5, v28
 v_fma_f32 v83, v83, v5, v28
M v[116:119], a[88:91], v[228:231], v[116:119]
 ds_read_b128 a[120:123], v7 offset:30720
 v_fma_f32 v88, v88, v5, v28
M v[116:119], a[84:87], v[212:215], v[116:119]
 ds_read_b128 a[124:127], v7 offset:31744
 v_fma_f32 v89, v89, v5, v28
M v[116:119], a[80:83], v[196:199], v[116:119]
 v_fma_f32 v90, v90, v5, v28
 v_fma_f32 v91, v91, v5, v28
M v[116:119], a[76:79], v[180:183], v[116:119]
 v_cvt_pk_bf16_f32 v80, v80, v81
 v_cvt_pk_bf16_f32 v81, v82, v83
M v[116:119], a[72:75], v[164:167], v[116:119]
 v_cvt_pk_bf16_f32 v82, v88, v89
 v_cvt_pk_bf16_f32 v83, v90, v91
M v[116:119], a[68:71], v[148:151], v[116:119]
 s_waitcnt vmcnt(27) lgkmcnt(0)
M v[116:119], a[64:67], v[132:135], v[116:119]
 s_barrier
M v[124:127], a[96:99], v[132:135], v[36:39]
 ds_read_b128 a[64:67], v43 offset:0
M v[124:127], a[100:103], v[148:151], v[124:127]
 ds_read_b128 a[68:71], v43 offset:1024
M v[124:127], a[104:107], v[164:167], v[124:127]
 buffer_store_dwordx4 v[80:83], v7, s[8:11], s29 offen offset:1024 sc1
M v[124:127], a[108:111], v[180:183], v[124:127]
 ds_read_b128 a[72:75], v43 offset:2048
 v_fma_f32 v84, v84, v6, v29
M v[124:127], a[112:115], v[196:199], v[124:127]
 ds_read_b128 a[76:79], v43 offset:3072
 v_fma_f32 v85, v85, v6, v29
M v[124:127], a[116:119], v[212:215], v[124:127]
 v_fma_f32 v86, v86, v6, v29
 v_fma_f32 v87, v87, v6, v29
M v[124:127], a[120:123], v[228:231], v[124:127]
 ds_read_b128 a[80:83], v43 offset:4096
 v_fma_f32 v92, v92, v6, v29
M v[124:127], a[124:127], v[244:247], v[124:127]
 ds_read_b128 a[84:87], v43 offset:5120
 v_fma_f32 v93, v93, v6, v29
M v[120:123], a[124:127], v[240:243], v[32:35]
 v_fma_f32 v94, v94, v6, v29
 v_fma_f32 v95, v95, v6, v29
M v[120:123], a[120:123], v[224:227], v[120:123]
 ds_read_b128 a[88:91], v43 offset:6144
 v_cvt_pk_bf16_f32 v84, v84, v85
M v[120:123], a[116:119], v[208:211], v[120:123]
 ds_read_b128 a[92:95], v43 offset:7168
 v_cvt_pk_bf16_f32 v85, v86, v87
M v[120:123], a[112:115], v[192:195], v[120:123]
 v_cvt_pk_bf16_f32 v86, v92, v93
 v_cvt_pk_bf16_f32 v87, v94, v95
M v[120:123], a[108:111], v[176:179], v[120:123]
 buffer_store_dwordx4 v[84:87], v7, s[8:11], s30 offen offset:1024 sc1
M v[120:123], a[104:107], v[160:163], v[120:123]
M v[120:123], a[100:103], v[144:147], v[120:123]
 s_waitcnt lgkmcnt(0)
 s_cmp_eq_u32 s42, 6
M v[120:123], a[96:99], v[128:131], v[120:123]
 s_cbranch_scc1 L_y2
L_y2r:
M v[64:67], a[64:67], v[128:131], v[32:35]
 ds_read_b128 a[96:99], v43 offset:8192
M v[64:67], a[68:71], v[144:147], v[64:67]
 ds_read_b128 a[100:103], v43 offset:9216
M v[64:67], a[72:75], v[160:163], v[64:67]
 s_waitcnt vmcnt(11)
 v_cmp_gt_u32 vcc, 1, v24
M v[64:67], a[76:79], v[176:179], v[64:67]
 s_mov_b32 s65, 234913792
 ds_read_b128 a[104:107], v43 offset:10240
 s_add_u32 s29, s33, 6144
M v[64:67], a[80:83], v[192:195], v[64:67]
 s_cbranch_vccnz L_fhs1
L_fhr1:
 ds_read_b128 a[108:111], v43 offset:11264
 s_add_u32 s30, s93, 6144
M v[64:67], a[84:87], v[208:211], v[64:67]
 buffer_load_dword v25, v14, s[8:11], s65 offen sc1
M v[64:67], a[88:91], v[224:227], v[64:67]
 ds_read_b128 a[112:115], v43 offset:12288
 v_fma_f32 v96, v96, v5, v28
M v[64:67], a[92:95], v[240:243], v[64:67]
 ds_read_b128 a[116:119], v43 offset:13312
 v_fma_f32 v97, v97, v5, v28
M v[68:71], a[92:95], v[244:247], v[36:39]
 v_fma_f32 v98, v98, v5, v28
 v_fma_f32 v99, v99, v5, v28
M v[68:71], a[88:91], v[228:231], v[68:71]
 ds_read_b128 a[120:123], v43 offset:14336
 v_fma_f32 v104, v104, v5, v28
M v[68:71], a[84:87], v[212:215], v[68:71]
 ds_read_b128 a[124:127], v43 offset:15360
 v_fma_f32 v105, v105, v5, v28
M v[68:71], a[80:83], v[196:199], v[68:71]
 v_fma_f32 v106, v106, v5, v28
 v_fma_f32 v107, v107, v5, v28
M v[68:71], a[76:79], v[180:183], v[68:71]
 v_cvt_pk_bf16_f32 v96, v96, v97
M v[68:71], a[72:75], v[164:167], v[68:71]
 v_cvt_pk_bf16_f32 v97, v98, v99
M v[68:71], a[68:71], v[148:151], v[68:71]
 v_cvt_pk_bf16_f32 v98, v104, v105
M v[68:71], a[64:67], v[132:135], v[68:71]
 s_waitcnt lgkmcnt(0)
 v_cvt_pk_bf16_f32 v99, v106, v107
M v[76:79], a[96:99], v[132:135], v[36:39]
 ds_read_b128 a[64:67], v43 offset:16384
M v[76:79], a[100:103], v[148:151], v[76:79]
 ds_read_b128 a[68:71], v43 offset:17408
M v[76:79], a[104:107], v[164:167], v[76:79]
 buffer_store_dwordx4 v[96:99], v7, s[8:11], s29 offen offset:0 sc1
M v[76:79], a[108:111], v[180:183], v[76:79]
 ds_read_b128 a[72:75], v43 offset:18432
 v_fma_f32 v100, v100, v6, v29
M v[76:79], a[112:115], v[196:199], v[76:79]
 ds_read_b128 a[76:79], v43 offset:19456
 v_fma_f32 v101, v101, v6, v29
M v[76:79], a[116:119], v[212:215], v[76:79]
 v_fma_f32 v102, v102, v6, v29
 v_fma_f32 v103, v103, v6, v29
M v[76:79], a[120:123], v[228:231], v[76:79]
 ds_read_b128 a[80:83], v43 offset:20480
 v_fma_f32 v108, v108, v6, v29
M v[76:79], a[124:127], v[244:247], v[76:79]
 ds_read_b128 a[84:87], v43 offset:21504
 v_fma_f32 v109, v109, v6, v29
M v[72:75], a[124:127], v[240:243], v[32:35]
 v_fma_f32 v110, v110, v6, v29
 v_fma_f32 v111, v111, v6, v29
M v[72:75], a[120:123], v[224:227], v[72:75]
 ds_read_b128 a[88:91], v43 offset:22528
 v_cvt_pk_bf16_f32 v100, v100, v101
M v[72:75], a[116:119], v[208:211], v[72:75]
 ds_read_b128 a[92:95], v43 offset:23552
 v_cvt_pk_bf16_f32 v101, v102, v103
M v[72:75], a[112:115], v[192:195], v[72:75]
 v_cvt_pk_bf16_f32 v102, v108, v109
M v[72:75], a[108:111], v[176:179], v[72:75]
 v_cvt_pk_bf16_f32 v103, v110, v111
M v[72:75], a[104:107], v[160:163], v[72:75]
 buffer_store_dwordx4 v[100:103], v7, s[8:11], s30 offen offset:0 sc1
M v[72:75], a[100:103], v[144:147], v[72:75]
M v[72:75], a[96:99], v[128:131], v[72:75]
 s_waitcnt lgkmcnt(0)
 v_fma_f32 v112, v112, v5, v28
M v[80:83], a[64:67], v[128:131], v[32:35]
 ds_read_b128 a[96:99], v43 offset:24576
 v_fma_f32 v113, v113, v5, v28
M v[80:83], a[68:71], v[144:147], v[80:83]
 ds_read_b128 a[100:103], v43 offset:25600
 v_fma_f32 v114, v114, v5, v28
M v[80:83], a[72:75], v[160:163], v[80:83]
 v_fma_f32 v115, v115, v5, v28
M v[80:83], a[76:79], v[176:179], v[80:83]
 ds_read_b128 a[104:107], v43 offset:26624
 v_fma_f32 v120, v120, v5, v28
M v[80:83], a[80:83], v[192:195], v[80:83]
 ds_read_b128 a[108:111], v43 offset:27648
 v_fma_f32 v121, v121, v5, v28
M v[80:83], a[84:87], v[208:211], v[80:83]
 v_fma_f32 v122, v122, v5, v28
M v[80:83], a[88:91], v[224:227], v[80:83]
 ds_read_b128 a[112:115], v43 offset:28672
 v_fma_f32 v123, v123, v5, v28
M v[80:83], a[92:95], v[240:243], v[80:83]
 ds_read_b128 a[116:119], v43 offset:29696
 v_cvt_pk_bf16_f32 v112, v112, v113
M v[84:87], a[92:95], v[244:247], v[36:39]
 v_cvt_pk_bf16_f32 v113, v114, v115
 v_cvt_pk_bf16_f32 v114, v120, v121
M v[84:87], a[88:91], v[228:231], v[84:87]
 ds_read_b128 a[120:123], v43 offset:30720
 v_cvt_pk_bf16_f32 v115, v122, v123
M v[84:87], a[84:87], v[212:215], v[84:87]
 ds_read_b128 a[124:127], v43 offset:31744
M v[84:87], a[80:83], v[196:199], v[84:87]
 buffer_store_dwordx4 v[112:115], v7, s[8:11], s29 offen offset:1024 sc1
M v[84:87], a[76:79], v[180:183], v[84:87]
 v_fma_f32 v116, v116, v6, v29
M v[84:87], a[72:75], v[164:167], v[84:87]
 v_fma_f32 v117, v117, v6, v29
M v[84:87], a[68:71], v[148:151], v[84:87]
 s_waitcnt lgkmcnt(0)
 v_fma_f32 v118, v118, v6, v29
M v[84:87], a[64:67], v[132:135], v[84:87]
 s_barrier
M v[92:95], a[96:99], v[132:135], v[36:39]
 ds_read_b128 a[64:67], v2 offset:32768
 v_fma_f32 v119, v119, v6, v29
M v[92:95], a[100:103], v[148:151], v[92:95]
 ds_read_b128 a[68:71], v2 offset:33792
 v_fma_f32 v124, v124, v6, v29
M v[92:95], a[104:107], v[164:167], v[92:95]
 v_fma_f32 v125, v125, v6, v29
 v_fma_f32 v126, v126, v6, v29
M v[92:95], a[108:111], v[180:183], v[92:95]
 ds_read_b128 a[72:75], v2 offset:34816
 v_fma_f32 v127, v127, v6, v29
M v[92:95], a[112:115], v[196:199], v[92:95]
 ds_read_b128 a[76:79], v2 offset:35840
 v_cvt_pk_bf16_f32 v116, v116, v117
M v[92:95], a[116:119], v[212:215], v[92:95]
 v_cvt_pk_bf16_f32 v117, v118, v119
M v[92:95], a[120:123], v[228:231], v[92:95]
 ds_read_b128 a[80:83], v2 offset:36864
 v_cvt_pk_bf16_f32 v118, v124, v125
M v[92:95], a[124:127], v[244:247], v[92:95]
 ds_read_b128 a[84:87], v2 offset:37888
 v_cvt_pk_bf16_f32 v119, v126, v127
M v[88:91], a[124:127], v[240:243], v[32:35]
 buffer_store_dwordx4 v[116:119], v7, s[8:11], s30 offen offset:1024 sc1
M v[88:91], a[120:123], v[224:227], v[88:91]
 ds_read_b128 a[88:91], v2 offset:38912
M v[88:91], a[116:119], v[208:211], v[88:91]
 ds_read_b128 a[92:95], v2 offset:39936
M v[88:91], a[112:115], v[192:195], v[88:91]
M v[88:91], a[108:111], v[176:179], v[88:91]
M v[88:91], a[104:107], v[160:163], v[88:91]
M v[88:91], a[100:103], v[144:147], v[88:91]
 s_waitcnt lgkmcnt(0)
M v[88:91], a[96:99], v[128:131], v[88:91]
M v[96:99], a[64:67], v[128:131], v[32:35]
 ds_read_b128 a[96:99], v2 offset:40960
M v[96:99], a[68:71], v[144:147], v[96:99]
 ds_read_b128 a[100:103], v2 offset:41984
M v[96:99], a[72:75], v[160:163], v[96:99]
M v[96:99], a[76:79], v[176:179], v[96:99]
 ds_read_b128 a[104:107], v2 offset:43008
 s_add_u32 s29, s33, 16384
M v[96:99], a[80:83], v[192:195], v[96:99]
 ds_read_b128 a[108:111], v2 offset:44032
 s_add_u32 s30, s93, 16384
M v[96:99], a[84:87], v[208:211], v[96:99]
 v_fma_f32 v64, v64, v5, v28
 v_fma_f32 v65, v65, v5, v28
M v[96:99], a[88:91], v[224:227], v[96:99]
 ds_read_b128 a[112:115], v2 offset:45056
 v_fma_f32 v66, v66, v5, v28
M v[96:99], a[92:95], v[240:243], v[96:99]
 ds_read_b128 a[116:119], v2 offset:46080
 v_fma_f32 v67, v67, v5, v28
M v[100:103], a[92:95], v[244:247], v[36:39]
 v_fma_f32 v72, v72, v5, v28
M v[100:103], a[88:91], v[228:231], v[100:103]
 ds_read_b128 a[120:123], v2 offset:47104
 v_fma_f32 v73, v73, v5, v28
M v[100:103], a[84:87], v[212:215], v[100:103]
 ds_read_b128 a[124:127], v2 offset:48128
 v_fma_f32 v74, v74, v5, v28
M v[100:103], a[80:83], v[196:199], v[100:103]
 v_fma_f32 v75, v75, v5, v28
M v[100:103], a[76:79], v[180:183], v[100:103]
 v_cvt_pk_bf16_f32 v64, v64, v65
M v[100:103], a[72:75], v[164:167], v[100:103]
 v_cvt_pk_bf16_f32 v65, v66, v67
M v[100:103], a[68:71], v[148:151], v[100:103]
 v_cvt_pk_bf16_f32 v66, v72, v73
M v[100:103], a[64:67], v[132:135], v[100:103]
 s_waitcnt lgkmcnt(0)
 v_cvt_pk_bf16_f32 v67, v74, v75
M v[108:111], a[96:99], v[132:135], v[36:39]
 ds_read_b128 a[64:67], v2 offset:49152
M v[108:111], a[100:103], v[148:151], v[108:111]
 ds_read_b128 a[68:71], v2 offset:50176
M v[108:111], a[104:107], v[164:167], v[108:111]
 buffer_store_dwordx4 v[64:67], v7, s[8:11], s29 offen offset:0 sc1
M v[108:111], a[108:111], v[180:183], v[108:111]
 ds_read_b128 a[72:75], v2 offset:51200
 v_fma_f32 v68, v68, v6, v29
M v[108:111], a[112:115], v[196:199], v[108:111]
 ds_read_b128 a[76:79], v2 offset:52224
 v_fma_f32 v69, v69, v6, v29
M v[108:111], a[116:119], v[212:215], v[108:111]
 v_fma_f32 v70, v70, v6, v29
 v_fma_f32 v71, v71, v6, v29
M v[108:111], a[120:123], v[228:231], v[108:111]
 ds_read_b128 a[80:83], v2 offset:53248
 v_fma_f32 v76, v76, v6, v29
M v[108:111], a[124:127], v[244:247], v[108:111]
 ds_read_b128 a[84:87], v2 offset:54272
 v_fma_f32 v77, v77, v6, v29
M v[104:107], a[124:127], v[240:243], v[32:35]
 v_fma_f32 v78, v78, v6, v29
 v_fma_f32 v79, v79, v6, v29
M v[104:107], a[120:123], v[224:227], v[104:107]
 ds_read_b128 a[88:91], v2 offset:55296
 v_cvt_pk_bf16_f32 v68, v68, v69
M v[104:107], a[116:119], v[208:211], v[104:107]
 ds_read_b128 a[92:95], v2 offset:56320
 v_cvt_pk_bf16_f32 v69, v70, v71
M v[104:107], a[112:115], v[192:195], v[104:107]
 v_cvt_pk_bf16_f32 v70, v76, v77
M v[104:107], a[108:111], v[176:179], v[104:107]
 v_cvt_pk_bf16_f32 v71, v78, v79
M v[104:107], a[104:107], v[160:163], v[104:107]
 buffer_store_dwordx4 v[68:71], v7, s[8:11], s30 offen offset:0 sc1
M v[104:107], a[100:103], v[144:147], v[104:107]
M v[104:107], a[96:99], v[128:131], v[104:107]
 s_waitcnt lgkmcnt(0)
 v_fma_f32 v80, v80, v5, v28
M v[112:115], a[64:67], v[128:131], v[32:35]
 ds_read_b128 a[96:99], v2 offset:57344
 v_fma_f32 v81, v81, v5, v28
M v[112:115], a[68:71], v[144:147], v[112:115]
 ds_read_b128 a[100:103], v2 offset:58368
 v_fma_f32 v82, v82, v5, v28
M v[112:115], a[72:75], v[160:163], v[112:115]
 v_fma_f32 v83, v83, v5, v28
M v[112:115], a[76:79], v[176:179], v[112:115]
 ds_read_b128 a[104:107], v2 offset:59392
 v_fma_f32 v88, v88, v5, v28
M v[112:115], a[80:83], v[192:195], v[112:115]
 ds_read_b128 a[108:111], v2 offset:60416
 v_fma_f32 v89, v89, v5, v28
M v[112:115], a[84:87], v[208:211], v[112:115]
 v_fma_f32 v90, v90, v5, v28
M v[112:115], a[88:91], v[224:227], v[112:115]
 ds_read_b128 a[112:115], v2 offset:61440
 v_fma_f32 v91, v91, v5, v28
M v[112:115], a[92:95], v[240:243], v[112:115]
 ds_read_b128 a[116:119], v2 offset:62464
 v_cvt_pk_bf16_f32 v80, v80, v81
M v[116:119], a[92:95], v[244:247], v[36:39]
 s_waitcnt vmcnt(6)
 v_readlane_b32 s84, v25, 0
 v_readlane_b32 s85, v25, 1
M v[116:119], a[88:91], v[228:231], v[116:119]
 ds_read_b128 a[120:123], v2 offset:63488
 v_mov_b32 v24, 0x3f80
M v[116:119], a[84:87], v[212:215], v[116:119]
 ds_read_b128 a[124:127], v2 offset:64512
 v_mov_b32 v25, 0x3f800000
M v[116:119], a[80:83], v[196:199], v[116:119]
 v_cvt_pk_bf16_f32 v81, v82, v83
 v_cvt_pk_bf16_f32 v82, v88, v89
M v[116:119], a[76:79], v[180:183], v[116:119]
 v_cvt_pk_bf16_f32 v83, v90, v91
M v[116:119], a[72:75], v[164:167], v[116:119]
 buffer_store_dwordx4 v[80:83], v7, s[8:11], s29 offen offset:1024 sc1
M v[116:119], a[68:71], v[148:151], v[116:119]
 s_waitcnt lgkmcnt(0)
 v_fma_f32 v84, v84, v6, v29
 v_fma_f32 v85, v85, v6, v29
M v[116:119], a[64:67], v[132:135], v[116:119]
 s_barrier
M v[124:127], a[96:99], v[132:135], v[36:39]
 ds_read_b128 a[64:67], v7 offset:32768
 v_fma_f32 v86, v86, v6, v29
M v[124:127], a[100:103], v[148:151], v[124:127]
 ds_read_b128 a[68:71], v7 offset:33792
 v_fma_f32 v87, v87, v6, v29
M v[124:127], a[104:107], v[164:167], v[124:127]
 v_fma_f32 v92, v92, v6, v29
 v_fma_f32 v93, v93, v6, v29
M v[124:127], a[108:111], v[180:183], v[124:127]
 ds_read_b128 a[72:75], v7 offset:34816
 v_fma_f32 v94, v94, v6, v29
M v[124:127], a[112:115], v[196:199], v[124:127]
 ds_read_b128 a[76:79], v7 offset:35840
 v_fma_f32 v95, v95, v6, v29
M v[124:127], a[116:119], v[212:215], v[124:127]
 s_waitcnt vmcnt(3)
 v_cvt_pk_bf16_f32 v84, v84, v85
 v_cvt_pk_bf16_f32 v85, v86, v87
M v[124:127], a[120:123], v[228:231], v[124:127]
 ds_read_b128 a[80:83], v7 offset:36864
 v_cvt_pk_bf16_f32 v86, v92, v93
M v[124:127], a[124:127], v[244:247], v[124:127]
 ds_read_b128 a[84:87], v7 offset:37888
 v_cvt_pk_bf16_f32 v87, v94, v95
M v[120:123], a[124:127], v[240:243], v[32:35]
 buffer_store_dword v40, v41, s[8:11], s45 offen sc1
M v[120:123], a[120:123], v[224:227], v[120:123]
 ds_read_b128 a[88:91], v7 offset:38912
M v[120:123], a[116:119], v[208:211], v[120:123]
 ds_read_b128 a[92:95], v7 offset:39936
M v[120:123], a[112:115], v[192:195], v[120:123]
 buffer_store_dwordx4 v[84:87], v7, s[8:11], s30 offen offset:1024 sc1
M v[120:123], a[108:111], v[176:179], v[120:123]
M v[120:123], a[104:107], v[160:163], v[120:123]
M v[120:123], a[100:103], v[144:147], v[120:123]
 s_waitcnt lgkmcnt(0)
 s_cmp_eq_u32 s42, 6
M v[120:123], a[96:99], v[128:131], v[120:123]
 s_cbranch_scc1 L_y3
L_y3r:
M v[64:67], a[64:67], v[128:131], v[32:35]
 ds_read_b128 a[96:99], v7 offset:40960
M v[64:67], a[68:71], v[144:147], v[64:67]
 ds_read_b128 a[100:103], v7 offset:41984
M v[64:67], a[72:75], v[160:163], v[64:67]
M v[64:67], a[76:79], v[176:179], v[64:67]
 ds_read_b128 a[104:107], v7 offset:43008
 s_add_u32 s29, s33, 18432
M v[64:67], a[80:83], v[192:195], v[64:67]
 ds_read_b128 a[108:111], v7 offset:44032
 s_add_u32 s30, s93, 18432
M v[64:67], a[84:87], v[208:211], v[64:67]
 v_fma_f32 v96, v96, v5, v28
 v_fma_f32 v97, v97, v5, v28
M v[64:67], a[88:91], v[224:227], v[64:67]
 ds_read_b128 a[112:115], v7 offset:45056
 v_fma_f32 v98, v98, v5, v28
M v[64:67], a[92:95], v[240:243], v[64:67]
 ds_read_b128 a[116:119], v7 offset:46080
 v_fma_f32 v99, v99, v5, v28
M v[68:71], a[92:95], v[244:247], v[36:39]
 v_fma_f32 v104, v104, v5, v28
 v_fma_f32 v105, v105, v5, v28
M v[68:71], a[88:91], v[228:231], v[68:71]
 ds_read_b128 a[120:123], v7 offset:47104
 v_fma_f32 v106, v106, v5, v28
M v[68:71], a[84:87], v[212:215], v[68:71]
 ds_read_b128 a[124:127], v7 offset:48128
 v_fma_f32 v107, v107, v5, v28
M v[68:71], a[80:83], v[196:199], v[68:71]
 v_cvt_pk_bf16_f32 v96, v96, v97
 v_cvt_pk_bf16_f32 v97, v98, v99
M v[68:71], a[76:79], v[180:183], v[68:71]
 v_cvt_pk_bf16_f32 v98, v104, v105
 v_cvt_pk_bf16_f32 v99, v106, v107
M v[68:71], a[72:75], v[164:167], v[68:71]
 buffer_store_dwordx4 v[96:99], v7, s[8:11], s29 offen offset:0 sc1
M v[68:71], a[68:71], v[148:151], v[68:71]
 v_fma_f32 v100, v100, v6, v29
 v_fma_f32 v101, v101, v6, v29
M v[68:71], a[64:67], v[132:135], v[68:71]
 s_waitcnt lgkmcnt(0)
 v_fma_f32 v102, v102, v6, v29
 v_fma_f32 v103, v103, v6, v29
M v[72:75], a[96:99], v[128:131], v[32:35]
 ds_read_b128 a[64:67], v7 offset:49152
 v_fma_f32 v108, v108, v6, v29
M v[72:75], a[100:103], v[144:147], v[72:75]
 ds_read_b128 a[68:71], v7 offset:50176
 v_fma_f32 v109, v109, v6, v29
M v[72:75], a[104:107], v[160:163], v[72:75]
 v_fma_f32 v110, v110, v6, v29
 v_fma_f32 v111, v111, v6, v29
M v[72:75], a[108:111], v[176:179], v[72:75]
 ds_read_b128 a[72:75], v7 offset:51200
 v_cvt_pk_bf16_f32 v100, v100, v101
M v[72:75], a[112:115], v[192:195], v[72:75]
 ds_read_b128 a[76:79], v7 offset:52224
 v_cvt_pk_bf16_f32 v101, v102, v103
M v[72:75], a[116:119], v[208:211], v[72:75]
 v_cvt_pk_bf16_f32 v102, v108, v109
 v_cvt_pk_bf16_f32 v103, v110, v111
M v[72:75], a[120:123], v[224:227], v[72:75]
 ds_read_b128 a[80:83], v7 offset:53248
M v[72:75], a[124:127], v[240:243], v[72:75]
 ds_read_b128 a[84:87], v7 offset:54272
M v[76:79], a[124:127], v[244:247], v[36:39]
 buffer_store_dwordx4 v[100:103], v7, s[8:11], s30 offen offset:0 sc1
M v[76:79], a[120:123], v[228:231], v[76:79]
 ds_read_b128 a[88:91], v7 offset:55296
 v_fma_f32 v112, v112, v5, v28
M v[76:79], a[116:119], v[212:215], v[76:79]
 ds_read_b128 a[92:95], v7 offset:56320
 v_fma_f32 v113, v113, v5, v28
M v[76:79], a[112:115], v[196:199], v[76:79]
 v_fma_f32 v114, v114, v5, v28
 v_fma_f32 v115, v115, v5, v28
M v[76:79], a[108:111], v[180:183], v[76:79]
 v_fma_f32 v120, v120, v5, v28
 v_fma_f32 v121, v121, v5, v28
M v[76:79], a[104:107], v[164:167], v[76:79]
 v_fma_f32 v122, v122, v5, v28
 v_fma_f32 v123, v123, v5, v28
M v[76:79], a[100:103], v[148:151], v[76:79]
 v_cvt_pk_bf16_f32 v112, v112, v113
 v_cvt_pk_bf16_f32 v113, v114, v115
M v[76:79], a[96:99], v[132:135], v[76:79]
 s_waitcnt lgkmcnt(0)
 v_cvt_pk_bf16_f32 v114, v120, v121
 v_cvt_pk_bf16_f32 v115, v122, v123
M v[80:83], a[64:67], v[128:131], v[32:35]
 ds_read_b128 a[96:99], v7 offset:57344
M v[80:83], a[68:71], v[144:147], v[80:83]
 ds_read_b128 a[100:103], v7 offset:58368
M v[80:83], a[72:75], v[160:163], v[80:83]
 buffer_store_dwordx4 v[112:115], v7, s[8:11], s29 offen offset:1024 sc1
M v[80:83], a[76:79], v[176:179], v[80:83]
 ds_read_b128 a[104:107], v7 offset:59392
 v_fma_f32 v116, v116, v6, v29
M v[80:83], a[80:83], v[192:195], v[80:83]
 ds_read_b128 a[108:111], v7 offset:60416
 v_fma_f32 v117, v117, v6, v29
M v[80:83], a[84:87], v[208:211], v[80:83]
 v_fma_f32 v118, v118, v6, v29
 v_fma_f32 v119, v119, v6, v29
M v[80:83], a[88:91], v[224:227], v[80:83]
 ds_read_b128 a[112:115], v7 offset:61440
 v_fma_f32 v124, v124, v6, v29
M v[80:83], a[92:95], v[240:243], v[80:83]
 ds_read_b128 a[116:119], v7 offset:62464
 v_fma_f32 v125, v125, v6, v29
M v[84:87], a[92:95], v[244:247], v[36:39]
 v_fma_f32 v126, v126, v6, v29
 v_fma_f32 v127, v127, v6, v29
M v[84:87], a[88:91], v[228:231], v[84:87]
 ds_read_b128 a[120:123], v7 offset:63488
 v_cvt_pk_bf16_f32 v116, v116, v117
M v[84:87], a[84:87], v[212:215], v[84:87]
 ds_read_b128 a[124:127], v7 offset:64512
 v_cvt_pk_bf16_f32 v117, v118, v119
M v[84:87], a[80:83], v[196:199], v[84:87]
 v_cvt_pk_bf16_f32 v118, v124, v125
 v_cvt_pk_bf16_f32 v119, v126, v127
M v[84:87], a[76:79], v[180:183], v[84:87]
 buffer_store_dwordx4 v[116:119], v7, s[8:11], s30 offen offset:1024 sc1
M v[84:87], a[72:75], v[164:167], v[84:87]
 s_add_u32 s29, s33, 20480
M v[84:87], a[68:71], v[148:151], v[84:87]
 s_add_u32 s30, s93, 20480
 v_fma_f32 v64, v64, v5, v28
 v_fma_f32 v65, v65, v5, v28
M v[84:87], a[64:67], v[132:135], v[84:87]
 s_waitcnt lgkmcnt(0)
 v_fma_f32 v66, v66, v5, v28
 v_fma_f32 v67, v67, v5, v28
M v[88:91], a[96:99], v[128:131], v[32:35]
 v_fma_f32 v72, v72, v5, v28
 v_fma_f32 v73, v73, v5, v28
M v[88:91], a[100:103], v[144:147], v[88:91]
 v_fma_f32 v74, v74, v5, v28
 v_fma_f32 v75, v75, v5, v28
M v[88:91], a[104:107], v[160:163], v[88:91]
 v_cvt_pk_bf16_f32 v64, v64, v65
 v_cvt_pk_bf16_f32 v65, v66, v67
M v[88:91], a[108:111], v[176:179], v[88:91]
 v_cvt_pk_bf16_f32 v66, v72, v73
 v_cvt_pk_bf16_f32 v67, v74, v75
M v[88:91], a[112:115], v[192:195], v[88:91]
 buffer_store_dwordx4 v[64:67], v7, s[8:11], s29 offen offset:0 sc1
M v[88:91], a[116:119], v[208:211], v[88:91]
 v_fma_f32 v68, v68, v6, v29
 v_fma_f32 v69, v69, v6, v29
M v[88:91], a[120:123], v[224:227], v[88:91]
 v_fma_f32 v70, v70, v6, v29
 v_fma_f32 v71, v71, v6, v29
M v[88:91], a[124:127], v[240:243], v[88:91]
 v_fma_f32 v76, v76, v6, v29
 v_fma_f32 v77, v77, v6, v29
M v[92:95], a[124:127], v[244:247], v[36:39]
 v_fma_f32 v78, v78, v6, v29
 v_fma_f32 v79, v79, v6, v29
M v[92:95], a[120:123], v[228:231], v[92:95]
 v_cvt_pk_bf16_f32 v68, v68, v69
 v_cvt_pk_bf16_f32 v69, v70, v71
M v[92:95], a[116:119], v[212:215], v[92:95]
 v_cvt_pk_bf16_f32 v70, v76, v77
 v_cvt_pk_bf16_f32 v71, v78, v79
M v[92:95], a[112:115], v[196:199], v[92:95]
 buffer_store_dwordx4 v[68:71], v7, s[8:11], s30 offen offset:0 sc1
M v[92:95], a[108:111], v[180:183], v[92:95]
M v[92:95], a[104:107], v[164:167], v[92:95]
M v[92:95], a[100:103], v[148:151], v[92:95]
M v[92:95], a[96:99], v[132:135], v[92:95]
 v_fma_f32 v80, v80, v5, v28
 v_fma_f32 v81, v81, v5, v28
 v_fma_f32 v82, v82, v5, v28
 v_fma_f32 v83, v83, v5, v28
 v_fma_f32 v88, v88, v5, v28
 v_fma_f32 v89, v89, v5, v28
 v_fma_f32 v90, v90, v5, v28
 v_fma_f32 v91, v91, v5, v28
 v_cvt_pk_bf16_f32 v80, v80, v81
 v_cvt_pk_bf16_f32 v81, v82, v83
 v_cvt_pk_bf16_f32 v82, v88, v89
 v_cvt_pk_bf16_f32 v83, v90, v91
 buffer_store_dwordx4 v[80:83], v7, s[8:11], s29 offen offset:1024 sc1
 v_fma_f32 v84, v84, v6, v29
 v_fma_f32 v85, v85, v6, v29
 v_fma_f32 v86, v86, v6, v29
 v_fma_f32 v87, v87, v6, v29
 v_fma_f32 v92, v92, v6, v29
 v_fma_f32 v93, v93, v6, v29
 v_fma_f32 v94, v94, v6, v29
 v_fma_f32 v95, v95, v6, v29
 v_cvt_pk_bf16_f32 v84, v84, v85
 v_cvt_pk_bf16_f32 v85, v86, v87
 v_cvt_pk_bf16_f32 v86, v92, v93
 v_cvt_pk_bf16_f32 v87, v94, v95
 buffer_store_dwordx4 v[84:87], v7, s[8:11], s30 offen offset:1024 sc1
 s_cmp_lt_u32 s42, 8
 s_cbranch_scc1 L_red
 s_cmp_eq_u32 s20, 3
 s_cbranch_scc1 L_vend3
 s_sub_u32 s64, 15, s42
 s_lshl_b32 s64, s64, 1
 s_lshr_b32 s65, s41, 3
 s_add_u32 s46, s64, s65
 s_mul_i32 s46, s46, 16512
 s_and_b32 s72, s41, 7
 s_lshl_b32 s66, s72, 7
 s_add_u32 s46, s46, s66
 s_add_u32 s46, s46, 235211776
 s_and_b32 s66, s41, 7
 s_lshr_b32 s66, s101, s66
 s_and_b32 s66, s66, 1
 s_lshl_b32 s66, s66, 13
 s_add_u32 s46, s46, s66
 v_and_b32 v14, 15, v0
 v_lshlrev_b32 v14, 2, v14
 buffer_load_dword v9, v14, s[8:11], s46 offen sc1
 s_mul_i32 s86, s65, 3
 s_add_u32 s86, s86, s20
 s_add_u32 s86, s86, 8
 s_mul_i32 s77, s42, 4194304
 s_mul_i32 s78, s72, 32768
 s_add_u32 s77, s77, s78
 s_add_u32 s77, s77, 67108864
 s_lshr_b32 s78, s101, s72
 s_and_b32 s78, s78, 1
 s_lshl_b32 s78, s78, 13
 s_add_u32 s77, s77, s78
 s_lshl_b32 s78, s86, 10
 s_add_u32 s77, s77, s78
 s_add_u32 s77, s77, 8192
 s_lshl_b32 s86, s86, 6
 s_lshr_b32 s73, s72, 1
 s_sub_u32 s65, 7, s73
 s_bitcmp1_b32 s72, 0
 s_cselect_b32 s73, s65, s73
 s_lshl_b32 s73, s73, 4
 s_lshl_b32 s65, s42, 7
 s_add_u32 s73, s73, s65
 v_and_b32 v10, 15, v0
 v_add_u32 v10, s73, v10
 s_mov_b32 s64, 234881088
 v_mul_u32_u24 v12, 896, v10
 v_lshl_add_u32 v12, v11, 4, v12
 v_lshrrev_b32 v13, 4, v10
 v_lshlrev_b32 v13, 5, v13
 v_and_b32 v104, 15, v10
 v_add_lshl_u32 v13, v13, v104, 2
 buffer_load_dword v15, v13, s[8:11], s64 offen sc1
 buffer_load_dwordx4 v[16:19], v12, s[56:59], s86 offen
 v_mov_b32 v48, 0
 v_mov_b32 v49, 0
 v_mov_b32 v50, 0
 v_mov_b32 v51, 0
 v_mov_b32 v52, 0
 v_mov_b32 v53, 0
 v_mov_b32 v54, 0
 v_mov_b32 v55, 0
 s_waitcnt vmcnt(3)
 buffer_store_dword v40, v41, s[8:11], s3 offen sc1
 s_waitcnt vmcnt(3)
 v_cmp_eq_u32 vcc, 1, v9
 s_mov_b32 s91, 65536
 s_mov_b32 s69, 0
 s_and_b32 s70, vcc_lo, 0xffff
 s_or_b32 s68, s70, 0xffff0000
 s_cmp_lg_u32 s70, 0
 s_cbranch_scc1 L_vk0
 s_call_b64 s[36:37], L_rpoll
L_vk0:
 s_ff1_i32_b32 s71, s70
 s_bitset0_b32 s70, s71
 s_and_b32 s72, s71, 8
 s_lshl_b32 s72, s72, 10
 s_xor_b32 s72, s72, s77
 s_mul_i32 s71, s71, 262144
 s_add_u32 s12, s71, s72
 buffer_load_dwordx4 v[128:131], v7, s[8:11], s12 offen sc1
 s_cmp_lg_u32 s70, 0
 s_cbranch_scc1 L_vk1
 s_call_b64 s[36:37], L_rpoll
L_vk1:
 s_ff1_i32_b32 s71, s70
 s_bitset0_b32 s70, s71
 s_and_b32 s72, s71, 8
 s_lshl_b32 s72, s72, 10
 s_xor_b32 s72, s72, s77
 s_mul_i32 s71, s71, 262144
 s_add_u32 s13, s71, s72
 buffer_load_dwordx4 v[132:135], v7, s[8:11], s13 offen sc1
 s_waitcnt vmcnt(3)
 v_lshlrev_b32 v32, 16, v16
 v_and_b32 v33, 0xffff0000, v16
 v_lshlrev_b32 v34, 16, v17
 v_and_b32 v35, 0xffff0000, v17
 v_lshlrev_b32 v36, 16, v18
 v_and_b32 v37, 0xffff0000, v18
 v_lshlrev_b32 v38, 16, v19
 v_and_b32 v39, 0xffff0000, v19
 v_sub_f32 v13, 1.0, v15
 v_cmp_eq_u32 s[80:81], s84, v10
 v_cmp_eq_u32 s[82:83], s85, v10
 s_nop 0
 s_or_b64 vcc, s[80:81], s[82:83]
 s_cbranch_vccnz L_moe2
L_moe_ret2:
 v_mul_f32 v32, v13, v32
 v_mul_f32 v33, v13, v33
 v_mul_f32 v34, v13, v34
 v_mul_f32 v35, v13, v35
 v_mul_f32 v36, v13, v36
 v_mul_f32 v37, v13, v37
 v_mul_f32 v38, v13, v38
 v_mul_f32 v39, v13, v39
 s_cmp_lg_u32 s70, 0
 s_cbranch_scc1 L_vk2
 s_call_b64 s[36:37], L_rpoll
L_vk2:
 s_ff1_i32_b32 s71, s70
 s_bitset0_b32 s70, s71
 s_and_b32 s72, s71, 8
 s_lshl_b32 s72, s72, 10
 s_xor_b32 s72, s72, s77
 s_mul_i32 s71, s71, 262144
 s_add_u32 s14, s71, s72
 buffer_load_dwordx4 v[136:139], v7, s[8:11], s14 offen sc1
 s_cmp_lg_u32 s70, 0
 s_cbranch_scc1 L_vk3
 s_call_b64 s[36:37], L_rpoll
L_vk3:
 s_ff1_i32_b32 s71, s70
 s_bitset0_b32 s70, s71
 s_and_b32 s72, s71, 8
 s_lshl_b32 s72, s72, 10
 s_xor_b32 s72, s72, s77
 s_mul_i32 s71, s71, 262144
 s_add_u32 s15, s71, s72
 buffer_load_dwordx4 v[140:143], v7, s[8:11], s15 offen sc1
 s_cmp_lg_u32 s70, 0
 s_cbranch_scc1 L_vk4
 s_call_b64 s[36:37], L_rpoll
L_vk4:
 s_ff1_i32_b32 s71, s70
 s_bitset0_b32 s70, s71
 s_and_b32 s72, s71, 8
 s_lshl_b32 s72, s72, 10
 s_xor_b32 s72, s72, s77
 s_mul_i32 s71, s71, 262144
 s_add_u32 s16, s71, s72
 buffer_load_dwordx4 v[144:147], v7, s[8:11], s16 offen sc1
 s_cmp_lg_u32 s70, 0
 s_cbranch_scc1 L_vk5
 s_call_b64 s[36:37], L_rpoll
L_vk5:
 s_ff1_i32_b32 s71, s70
 s_bitset0_b32 s70, s71
 s_and_b32 s72, s71, 8
 s_lshl_b32 s72, s72, 10
 s_xor_b32 s72, s72, s77
 s_mul_i32 s71, s71, 262144
 s_add_u32 s17, s71, s72
 buffer_load_dwordx4 v[148:151], v7, s[8:11], s17 offen sc1
 s_cmp_lg_u32 s70, 0
 s_cbranch_scc1 L_vk6
 s_call_b64 s[36:37], L_rpoll
L_vk6:
 s_ff1_i32_b32 s71, s70
 s_bitset0_b32 s70, s71
 s_and_b32 s72, s71, 8
 s_lshl_b32 s72, s72, 10
 s_xor_b32 s72, s72, s77
 s_mul_i32 s71, s71, 262144
 s_add_u32 s18, s71, s72
 buffer_load_dwordx4 v[152:155], v7, s[8:11], s18 offen sc1
 s_cmp_lg_u32 s70, 0
 s_cbranch_scc1 L_vk7
 s_call_b64 s[36:37], L_rpoll
L_vk7:
 s_ff1_i32_b32 s71, s70
 s_bitset0_b32 s70, s71
 s_and_b32 s72, s71, 8
 s_lshl_b32 s72, s72, 10
 s_xor_b32 s72, s72, s77
 s_mul_i32 s71, s71, 262144
 s_add_u32 s19, s71, s72
 buffer_load_dwordx4 v[156:159], v7, s[8:11], s19 offen sc1
 s_cmp_lg_u32 s70, 0
 s_cbranch_scc1 L_vk8
 s_call_b64 s[36:37], L_rpoll
L_vk8:
 s_ff1_i32_b32 s71, s70
 s_bitset0_b32 s70, s71
 s_and_b32 s72, s71, 8
 s_lshl_b32 s72, s72, 10
 s_xor_b32 s72, s72, s77
 s_mul_i32 s71, s71, 262144
 s_add_u32 s21, s71, s72
 buffer_load_dwordx4 v[160:163], v7, s[8:11], s21 offen sc1
 s_cmp_lg_u32 s70, 0
 s_cbranch_scc1 L_vk9
 s_call_b64 s[36:37], L_rpoll
L_vk9:
 s_ff1_i32_b32 s71, s70
 s_bitset0_b32 s70, s71
 s_and_b32 s72, s71, 8
 s_lshl_b32 s72, s72, 10
 s_xor_b32 s72, s72, s77
 s_mul_i32 s71, s71, 262144
 s_add_u32 s22, s71, s72
 buffer_load_dwordx4 v[164:167], v7, s[8:11], s22 offen sc1
 s_cmp_lg_u32 s70, 0
 s_cbranch_scc1 L_vk10
 s_call_b64 s[36:37], L_rpoll
L_vk10:
 s_ff1_i32_b32 s71, s70
 s_bitset0_b32 s70, s71
 s_and_b32 s72, s71, 8
 s_lshl_b32 s72, s72, 10
 s_xor_b32 s72, s72, s77
 s_mul_i32 s71, s71, 262144
 s_add_u32 s23, s71, s72
 buffer_load_dwordx4 v[168:171], v7, s[8:11], s23 offen sc1
 s_cmp_lg_u32 s70, 0
 s_cbranch_scc1 L_vk11
 s_call_b64 s[36:37], L_rpoll
L_vk11:
 s_ff1_i32_b32 s71, s70
 s_bitset0_b32 s70, s71
 s_and_b32 s72, s71, 8
 s_lshl_b32 s72, s72, 10
 s_xor_b32 s72, s72, s77
 s_mul_i32 s71, s71, 262144
 s_add_u32 s24, s71, s72
 buffer_load_dwordx4 v[172:175], v7, s[8:11], s24 offen sc1
 s_cmp_lg_u32 s70, 0
 s_cbranch_scc1 L_vk12
 s_call_b64 s[36:37], L_rpoll
L_vk12:
 s_ff1_i32_b32 s71, s70
 s_bitset0_b32 s70, s71
 s_and_b32 s72, s71, 8
 s_lshl_b32 s72, s72, 10
 s_xor_b32 s72, s72, s77
 s_mul_i32 s71, s71, 262144
 s_add_u32 s48, s71, s72
 buffer_load_dwordx4 v[176:179], v7, s[8:11], s48 offen sc1
 s_cmp_lg_u32 s70, 0
 s_cbranch_scc1 L_vk13
 s_call_b64 s[36:37], L_rpoll
L_vk13:
 s_ff1_i32_b32 s71, s70
 s_bitset0_b32 s70, s71
 s_and_b32 s72, s71, 8
 s_lshl_b32 s72, s72, 10
 s_xor_b32 s72, s72, s77
 s_mul_i32 s71, s71, 262144
 s_add_u32 s49, s71, s72
 buffer_load_dwordx4 v[180:183], v7, s[8:11], s49 offen sc1
 s_cmp_lg_u32 s70, 0
 s_cbranch_scc1 L_vk14
 s_call_b64 s[36:37], L_rpoll
L_vk14:
 s_ff1_i32_b32 s71, s70
 s_bitset0_b32 s70, s71
 s_and_b32 s72, s71, 8
 s_lshl_b32 s72, s72, 10
 s_xor_b32 s72, s72, s77
 s_mul_i32 s71, s71, 262144
 s_add_u32 s50, s71, s72
 buffer_load_dwordx4 v[184:187], v7, s[8:11], s50 offen sc1
 s_cmp_lg_u32 s70, 0
 s_cbranch_scc1 L_vk15
 s_call_b64 s[36:37], L_rpoll
L_vk15:
 s_ff1_i32_b32 s71, s70
 s_bitset0_b32 s70, s71
 s_and_b32 s72, s71, 8
 s_lshl_b32 s72, s72, 10
 s_xor_b32 s72, s72, s77
 s_mul_i32 s71, s71, 262144
 s_add_u32 s51, s71, s72
 buffer_load_dwordx4 v[188:191], v7, s[8:11], s51 offen sc1
 s_waitcnt vmcnt(15)
 v_dot2c_f32_bf16 v48, v128, v24
 v_dot2c_f32_bf16 v49, v128, v25
 v_dot2c_f32_bf16 v50, v129, v24
 v_dot2c_f32_bf16 v51, v129, v25
 v_dot2c_f32_bf16 v52, v130, v24
 v_dot2c_f32_bf16 v53, v130, v25
 v_dot2c_f32_bf16 v54, v131, v24
 v_dot2c_f32_bf16 v55, v131, v25
 s_waitcnt vmcnt(14)
 v_dot2c_f32_bf16 v48, v132, v24
 v_dot2c_f32_bf16 v49, v132, v25
 v_dot2c_f32_bf16 v50, v133, v24
 v_dot2c_f32_bf16 v51, v133, v25
 v_dot2c_f32_bf16 v52, v134, v24
 v_dot2c_f32_bf16 v53, v134, v25
 v_dot2c_f32_bf16 v54, v135, v24
 v_dot2c_f32_bf16 v55, v135, v25
 s_waitcnt vmcnt(13)
 v_dot2c_f32_bf16 v48, v136, v24
 v_dot2c_f32_bf16 v49, v136, v25
 v_dot2c_f32_bf16 v50, v137, v24
 v_dot2c_f32_bf16 v51, v137, v25
 v_dot2c_f32_bf16 v52, v138, v24
 v_dot2c_f32_bf16 v53, v138, v25
 v_dot2c_f32_bf16 v54, v139, v24
 v_dot2c_f32_bf16 v55, v139, v25
 s_waitcnt vmcnt(12)
 v_dot2c_f32_bf16 v48, v140, v24
 v_dot2c_f32_bf16 v49, v140, v25
 v_dot2c_f32_bf16 v50, v141, v24
 v_dot2c_f32_bf16 v51, v141, v25
 v_dot2c_f32_bf16 v52, v142, v24
 v_dot2c_f32_bf16 v53, v142, v25
 v_dot2c_f32_bf16 v54, v143, v24
 v_dot2c_f32_bf16 v55, v143, v25
 s_waitcnt vmcnt(11)
 v_dot2c_f32_bf16 v48, v144, v24
 v_dot2c_f32_bf16 v49, v144, v25
 v_dot2c_f32_bf16 v50, v145, v24
 v_dot2c_f32_bf16 v51, v145, v25
 v_dot2c_f32_bf16 v52, v146, v24
 v_dot2c_f32_bf16 v53, v146, v25
 v_dot2c_f32_bf16 v54, v147, v24
 v_dot2c_f32_bf16 v55, v147, v25
 s_waitcnt vmcnt(10)
 v_dot2c_f32_bf16 v48, v148, v24
 v_dot2c_f32_bf16 v49, v148, v25
 v_dot2c_f32_bf16 v50, v149, v24
 v_dot2c_f32_bf16 v51, v149, v25
 v_dot2c_f32_bf16 v52, v150, v24
 v_dot2c_f32_bf16 v53, v150, v25
 v_dot2c_f32_bf16 v54, v151, v24
 v_dot2c_f32_bf16 v55, v151, v25
 s_waitcnt vmcnt(9)
 v_dot2c_f32_bf16 v48, v152, v24
 v_dot2c_f32_bf16 v49, v152, v25
 v_dot2c_f32_bf16 v50, v153, v24
 v_dot2c_f32_bf16 v51, v153, v25
 v_dot2c_f32_bf16 v52, v154, v24
 v_dot2c_f32_bf16 v53, v154, v25
 v_dot2c_f32_bf16 v54, v155, v24
 v_dot2c_f32_bf16 v55, v155, v25
 s_waitcnt vmcnt(8)
 v_dot2c_f32_bf16 v48, v156, v24
 v_dot2c_f32_bf16 v49, v156, v25
 v_dot2c_f32_bf16 v50, v157, v24
 v_dot2c_f32_bf16 v51, v157, v25
 v_dot2c_f32_bf16 v52, v158, v24
 v_dot2c_f32_bf16 v53, v158, v25
 v_dot2c_f32_bf16 v54, v159, v24
 v_dot2c_f32_bf16 v55, v159, v25
 s_waitcnt vmcnt(7)
 v_dot2c_f32_bf16 v48, v160, v24
 v_dot2c_f32_bf16 v49, v160, v25
 v_dot2c_f32_bf16 v50, v161, v24
 v_dot2c_f32_bf16 v51, v161, v25
 v_dot2c_f32_bf16 v52, v162, v24
 v_dot2c_f32_bf16 v53, v162, v25
 v_dot2c_f32_bf16 v54, v163, v24
 v_dot2c_f32_bf16 v55, v163, v25
 s_waitcnt vmcnt(6)
 v_dot2c_f32_bf16 v48, v164, v24
 v_dot2c_f32_bf16 v49, v164, v25
 v_dot2c_f32_bf16 v50, v165, v24
 v_dot2c_f32_bf16 v51, v165, v25
 v_dot2c_f32_bf16 v52, v166, v24
 v_dot2c_f32_bf16 v53, v166, v25
 v_dot2c_f32_bf16 v54, v167, v24
 v_dot2c_f32_bf16 v55, v167, v25
 s_waitcnt vmcnt(5)
 v_dot2c_f32_bf16 v48, v168, v24
 v_dot2c_f32_bf16 v49, v168, v25
 v_dot2c_f32_bf16 v50, v169, v24
 v_dot2c_f32_bf16 v51, v169, v25
 v_dot2c_f32_bf16 v52, v170, v24
 v_dot2c_f32_bf16 v53, v170, v25
 v_dot2c_f32_bf16 v54, v171, v24
 v_dot2c_f32_bf16 v55, v171, v25
 s_waitcnt vmcnt(4)
 v_dot2c_f32_bf16 v48, v172, v24
 v_dot2c_f32_bf16 v49, v172, v25
 v_dot2c_f32_bf16 v50, v173, v24
 v_dot2c_f32_bf16 v51, v173, v25
 v_dot2c_f32_bf16 v52, v174, v24
 v_dot2c_f32_bf16 v53, v174, v25
 v_dot2c_f32_bf16 v54, v175, v24
 v_dot2c_f32_bf16 v55, v175, v25
 s_waitcnt vmcnt(3)
 v_dot2c_f32_bf16 v48, v176, v24
 v_dot2c_f32_bf16 v49, v176, v25
 v_dot2c_f32_bf16 v50, v177, v24
 v_dot2c_f32_bf16 v51, v177, v25
 v_dot2c_f32_bf16 v52, v178, v24
 v_dot2c_f32_bf16 v53, v178, v25
 v_dot2c_f32_bf16 v54, v179, v24
 v_dot2c_f32_bf16 v55, v179, v25
 s_waitcnt vmcnt(2)
 v_dot2c_f32_bf16 v48, v180, v24
 v_dot2c_f32_bf16 v49, v180, v25
 v_dot2c_f32_bf16 v50, v181, v24
 v_dot2c_f32_bf16 v51, v181, v25
 v_dot2c_f32_bf16 v52, v182, v24
 v_dot2c_f32_bf16 v53, v182, v25
 v_dot2c_f32_bf16 v54, v183, v24
 v_dot2c_f32_bf16 v55, v183, v25
 s_waitcnt vmcnt(1)
 v_dot2c_f32_bf16 v48, v184, v24
 v_dot2c_f32_bf16 v49, v184, v25
 v_dot2c_f32_bf16 v50, v185, v24
 v_dot2c_f32_bf16 v51, v185, v25
 v_dot2c_f32_bf16 v52, v186, v24
 v_dot2c_f32_bf16 v53, v186, v25
 v_dot2c_f32_bf16 v54, v187, v24
 v_dot2c_f32_bf16 v55, v187, v25
 s_waitcnt vmcnt(0)
 v_dot2c_f32_bf16 v48, v188, v24
 v_dot2c_f32_bf16 v49, v188, v25
 v_dot2c_f32_bf16 v50, v189, v24
 v_dot2c_f32_bf16 v51, v189, v25
 v_dot2c_f32_bf16 v52, v190, v24
 v_dot2c_f32_bf16 v53, v190, v25
 v_dot2c_f32_bf16 v54, v191, v24
 v_dot2c_f32_bf16 v55, v191, v25
 s_nop 1
 v_fmac_f32 v32, v15, v48
 v_fmac_f32 v33, v15, v49
 v_fmac_f32 v34, v15, v50
 v_fmac_f32 v35, v15, v51
 v_fmac_f32 v36, v15, v52
 v_fmac_f32 v37, v15, v53
 v_fmac_f32 v38, v15, v54
 v_fmac_f32 v39, v15, v55
 v_cvt_pk_bf16_f32 v16, v32, v33
 v_cvt_pk_bf16_f32 v17, v34, v35
 v_cvt_pk_bf16_f32 v18, v36, v37
 v_cvt_pk_bf16_f32 v19, v38, v39
 buffer_store_dwordx4 v[16:19], v12, s[52:55], s86 offen sc1
L_vend:
 s_endpgm
L_vend3:
 s_waitcnt vmcnt(0)
 buffer_store_dword v40, v41, s[8:11], s3 offen sc1
 s_branch L_vend
 s_waitcnt vmcnt(0)
L_p1n:
 v_cndmask_b32 v64, v32, v8, s[64:65]
 v_cndmask_b32 v65, v32, v8, s[66:67]
 v_cndmask_b32 v66, v32, v8, s[68:69]
 v_cndmask_b32 v67, v32, v8, s[70:71]
 s_nop 1
M v[64:67], a[64:67], a[0:3], v[64:67]
 s_add_u32 m0, s28, 65536
 ds_read_b128 a[96:99], v2 offset:40960
 v_cndmask_b32 v72, v32, v8, s[72:73]
M v[64:67], a[68:71], a[4:7], v[64:67]
 ds_read_b128 a[100:103], v2 offset:41984
 v_cndmask_b32 v73, v32, v8, s[74:75]
M v[64:67], a[72:75], a[8:11], v[64:67]
 buffer_load_dwordx4 v3, s[8:11], s24 offen offset:0 sc1 lds
M v[64:67], a[76:79], a[12:15], v[64:67]
 ds_read_b128 a[104:107], v2 offset:43008
 v_cndmask_b32 v74, v32, v8, s[76:77]
M v[64:67], a[80:83], a[16:19], v[64:67]
 ds_read_b128 a[108:111], v2 offset:44032
 v_cndmask_b32 v75, v32, v8, s[78:79]
M v[64:67], a[84:87], a[20:23], v[64:67]
 v_exp_f32 v18, v112
M v[64:67], a[88:91], a[24:27], v[64:67]
 ds_read_b128 a[112:115], v2 offset:45056
M v[64:67], a[92:95], a[28:31], v[64:67]
 ds_read_b128 a[116:119], v2 offset:46080
M v[68:71], a[92:95], a[60:63], v[36:39]
 buffer_load_dwordx4 v3, s[8:11], s24 offen offset:1024 sc1 lds
M v[68:71], a[88:91], a[56:59], v[68:71]
 ds_read_b128 a[120:123], v2 offset:47104
M v[68:71], a[84:87], a[52:55], v[68:71]
 ds_read_b128 a[124:127], v2 offset:48128
M v[68:71], a[80:83], a[48:51], v[68:71]
 v_exp_f32 v19, v113
M v[68:71], a[76:79], a[44:47], v[68:71]
 buffer_load_dwordx4 v3, s[8:11], s24 offen offset:2048 sc1 lds
M v[68:71], a[72:75], a[40:43], v[68:71]
 v_exp_f32 v20, v114
M v[68:71], a[68:71], a[36:39], v[68:71]
 v_exp_f32 v21, v115
M v[68:71], a[64:67], a[32:35], v[68:71]
 s_waitcnt lgkmcnt(0)
 v_exp_f32 v22, v120
M v[72:75], a[96:99], a[0:3], v[72:75]
 ds_read_b128 a[64:67], v2 offset:49152
 v_cndmask_b32 v80, v32, v8, s[80:81]
M v[72:75], a[100:103], a[4:7], v[72:75]
 ds_read_b128 a[68:71], v2 offset:50176
 v_cndmask_b32 v81, v32, v8, s[82:83]
M v[72:75], a[104:107], a[8:11], v[72:75]
 buffer_load_dwordx4 v3, s[8:11], s24 offen offset:3072 sc1 lds
M v[72:75], a[108:111], a[12:15], v[72:75]
 ds_read_b128 a[72:75], v2 offset:51200
 v_cndmask_b32 v82, v32, v8, s[84:85]
M v[72:75], a[112:115], a[16:19], v[72:75]
 ds_read_b128 a[76:79], v2 offset:52224
 v_cndmask_b32 v83, v32, v8, s[86:87]
M v[72:75], a[116:119], a[20:23], v[72:75]
 v_exp_f32 v23, v121
M v[72:75], a[120:123], a[24:27], v[72:75]
 s_add_u32 m0, s28, 69632
 ds_read_b128 a[80:83], v2 offset:53248
 v_add_f32 v28, v18, v28
M v[72:75], a[124:127], a[28:31], v[72:75]
 ds_read_b128 a[84:87], v2 offset:54272
 v_cvt_pk_bf16_f32 v56, v18, v19
M v[76:79], a[124:127], a[60:63], v[36:39]
 buffer_load_dwordx4 v4, s[8:11], s24 offen offset:0 sc1 lds
M v[76:79], a[120:123], a[56:59], v[76:79]
 ds_read_b128 a[88:91], v2 offset:55296
 v_add_f32 v28, v19, v28
M v[76:79], a[116:119], a[52:55], v[76:79]
 ds_read_b128 a[92:95], v2 offset:56320
 v_add_f32 v28, v20, v28
M v[76:79], a[112:115], a[48:51], v[76:79]
 v_exp_f32 v24, v122
M v[76:79], a[108:111], a[44:47], v[76:79]
 buffer_load_dwordx4 v4, s[8:11], s24 offen offset:1024 sc1 lds
M v[76:79], a[104:107], a[40:43], v[76:79]
 v_exp_f32 v25, v123
M v[76:79], a[100:103], a[36:39], v[76:79]
 v_exp_f32 v18, v116
M v[76:79], a[96:99], a[32:35], v[76:79]
 s_waitcnt lgkmcnt(0)
 v_exp_f32 v19, v117
M v[80:83], a[64:67], a[0:3], v[80:83]
 ds_read_b128 a[96:99], v2 offset:57344
 v_cndmask_b32 v88, v32, v8, s[88:89]
M v[80:83], a[68:71], a[4:7], v[80:83]
 ds_read_b128 a[100:103], v2 offset:58368
 v_cndmask_b32 v89, v32, v8, s[90:91]
M v[80:83], a[72:75], a[8:11], v[80:83]
 buffer_load_dwordx4 v4, s[8:11], s24 offen offset:2048 sc1 lds
M v[80:83], a[76:79], a[12:15], v[80:83]
 ds_read_b128 a[104:107], v2 offset:59392
 v_cndmask_b32 v90, v32, v8, s[92:93]
M v[80:83], a[80:83], a[16:19], v[80:83]
 ds_read_b128 a[108:111], v2 offset:60416
 v_cndmask_b32 v91, v32, v8, s[94:95]
M v[80:83], a[84:87], a[20:23], v[80:83]
 v_cvt_pk_bf16_f32 v57, v20, v21
 v_add_f32 v28, v21, v28
M v[80:83], a[88:91], a[24:27], v[80:83]
 ds_read_b128 a[112:115], v2 offset:61440
 v_add_f32 v28, v22, v28
M v[80:83], a[92:95], a[28:31], v[80:83]
 ds_read_b128 a[116:119], v2 offset:62464
 v_cvt_pk_bf16_f32 v58, v22, v23
M v[84:87], a[92:95], a[60:63], v[36:39]
 buffer_load_dwordx4 v4, s[8:11], s24 offen offset:3072 sc1 lds
M v[84:87], a[88:91], a[56:59], v[84:87]
 ds_read_b128 a[120:123], v2 offset:63488
 v_add_f32 v28, v23, v28
M v[84:87], a[84:87], a[52:55], v[84:87]
 ds_read_b128 a[124:127], v2 offset:64512
 v_add_f32 v28, v24, v28
M v[84:87], a[80:83], a[48:51], v[84:87]
 v_exp_f32 v20, v118
M v[84:87], a[76:79], a[44:47], v[84:87]
 v_exp_f32 v21, v119
M v[84:87], a[72:75], a[40:43], v[84:87]
 v_exp_f32 v22, v124
M v[84:87], a[68:71], a[36:39], v[84:87]
 s_waitcnt vmcnt(16) lgkmcnt(0)
 v_exp_f32 v23, v125
M v[84:87], a[64:67], a[32:35], v[84:87]
 s_barrier
M v[88:91], a[96:99], a[0:3], v[88:91]
 ds_read_b128 a[64:67], v7 offset:0
 v_cvt_pk_bf16_f32 v59, v24, v25
M v[88:91], a[100:103], a[4:7], v[88:91]
 ds_read_b128 a[68:71], v7 offset:1024
 v_add_f32 v28, v25, v28
M v[88:91], a[104:107], a[8:11], v[88:91]
 v_exp_f32 v24, v126
M v[88:91], a[108:111], a[12:15], v[88:91]
 ds_read_b128 a[72:75], v7 offset:2048
 v_add_f32 v29, v18, v29
M v[88:91], a[112:115], a[16:19], v[88:91]
 ds_read_b128 a[76:79], v7 offset:3072
 v_cvt_pk_bf16_f32 v60, v18, v19
M v[88:91], a[116:119], a[20:23], v[88:91]
 v_exp_f32 v25, v127
M v[88:91], a[120:123], a[24:27], v[88:91]
 ds_read_b128 a[80:83], v7 offset:4096
 v_add_f32 v29, v19, v29
M v[88:91], a[124:127], a[28:31], v[88:91]
 ds_read_b128 a[84:87], v7 offset:5120
 v_add_f32 v29, v20, v29
M v[92:95], a[124:127], a[60:63], v[36:39]
 v_cvt_pk_bf16_f32 v61, v20, v21
 v_add_f32 v29, v21, v29
M v[92:95], a[120:123], a[56:59], v[92:95]
 ds_read_b128 a[88:91], v7 offset:6144
 v_add_f32 v29, v22, v29
M v[92:95], a[116:119], a[52:55], v[92:95]
 ds_read_b128 a[92:95], v7 offset:7168
 v_cvt_pk_bf16_f32 v62, v22, v23
M v[92:95], a[112:115], a[48:51], v[92:95]
 v_add_f32 v29, v23, v29
 v_add_f32 v29, v24, v29
M v[92:95], a[108:111], a[44:47], v[92:95]
 v_cvt_pk_bf16_f32 v63, v24, v25
 v_add_f32 v29, v25, v29
M v[92:95], a[104:107], a[40:43], v[92:95]
M v[92:95], a[100:103], a[36:39], v[92:95]
 s_waitcnt lgkmcnt(0)
M v[92:95], a[96:99], a[32:35], v[92:95]
 v_max_f32 v10, v28, v29
 v_cmp_lt_f32 vcc, s31, v10
 s_nop 0
 s_cbranch_vccnz L_st5
L_rt5:
M v[128:131], a[64:67], v[48:51], v[128:131]
 s_add_u32 m0, s28, 98304
 ds_read_b128 a[96:99], v7 offset:8192
 v_add_f32 v30, v28, v30
M v[128:131], a[68:71], v[56:59], v[128:131]
 ds_read_b128 a[100:103], v7 offset:9216
 v_add_f32 v31, v29, v31
M v[132:135], a[68:71], v[60:63], v[132:135]
 buffer_load_dwordx4 v3, s[8:11], s21 offen offset:0 sc1 lds
M v[132:135], a[64:67], v[52:55], v[132:135]
 s_cmp_eq_u32 s20, 3
 ds_read_b128 a[104:107], v7 offset:10240
M v[140:143], a[72:75], v[52:55], v[140:143]
 s_cselect_b64 s[64:65], s[16:17], 0
 ds_read_b128 a[108:111], v7 offset:11264
M v[140:143], a[76:79], v[60:63], v[140:143]
 buffer_load_dwordx4 v3, s[8:11], s21 offen offset:1024 sc1 lds
M v[136:139], a[76:79], v[56:59], v[136:139]
 s_cselect_b64 s[66:67], s[18:19], 0
 ds_read_b128 a[112:115], v7 offset:12288
M v[136:139], a[72:75], v[48:51], v[136:139]
 s_cselect_b64 s[68:69], s[48:49], 0
 ds_read_b128 a[116:119], v7 offset:13312
M v[144:147], a[80:83], v[48:51], v[144:147]
 s_cselect_b64 s[70:71], s[50:51], 0
 v_exp_f32 v18, v64
M v[144:147], a[84:87], v[56:59], v[144:147]
 s_cmp_gt_u32 s20, 2
 ds_read_b128 a[120:123], v7 offset:14336
M v[148:151], a[84:87], v[60:63], v[148:151]
 s_cselect_b64 s[78:79], -1, 0
 ds_read_b128 a[124:127], v7 offset:15360
M v[148:151], a[80:83], v[52:55], v[148:151]
 buffer_load_dwordx4 v3, s[8:11], s21 offen offset:2048 sc1 lds
M v[156:159], a[88:91], v[52:55], v[156:159]
 v_exp_f32 v19, v65
M v[156:159], a[92:95], v[60:63], v[156:159]
 v_exp_f32 v20, v66
M v[152:155], a[92:95], v[56:59], v[152:155]
 buffer_load_dwordx4 v3, s[8:11], s21 offen offset:3072 sc1 lds
M v[152:155], a[88:91], v[48:51], v[152:155]
 s_waitcnt lgkmcnt(0)
 v_exp_f32 v21, v67
M v[160:163], a[96:99], v[48:51], v[160:163]
 ds_read_b128 a[64:67], v7 offset:16384
 v_add_f32 v26, v18, v19
M v[160:163], a[100:103], v[56:59], v[160:163]
 s_add_u32 m0, s28, 102400
 ds_read_b128 a[68:71], v7 offset:17408
 v_cvt_pk_bf16_f32 v40, v18, v19
M v[164:167], a[100:103], v[60:63], v[164:167]
 buffer_load_dwordx4 v4, s[8:11], s21 offen offset:0 sc1 lds
M v[164:167], a[96:99], v[52:55], v[164:167]
 s_cmp_eq_u32 s20, 2
 ds_read_b128 a[72:75], v7 offset:18432
 v_add_f32 v26, v20, v26
M v[172:175], a[104:107], v[52:55], v[172:175]
 s_cselect_b64 s[72:73], s[16:17], s[78:79]
 ds_read_b128 a[76:79], v7 offset:19456
 v_cvt_pk_bf16_f32 v41, v20, v21
M v[172:175], a[108:111], v[60:63], v[172:175]
 s_cselect_b64 s[74:75], s[18:19], s[78:79]
 v_exp_f32 v22, v72
M v[168:171], a[108:111], v[56:59], v[168:171]
 s_cselect_b64 s[76:77], s[48:49], s[78:79]
 ds_read_b128 a[80:83], v7 offset:20480
 v_add_f32 v26, v21, v26
M v[168:171], a[104:107], v[48:51], v[168:171]
 s_cselect_b64 s[78:79], s[50:51], s[78:79]
 ds_read_b128 a[84:87], v7 offset:21504
M v[176:179], a[112:115], v[48:51], v[176:179]
 buffer_load_dwordx4 v4, s[8:11], s21 offen offset:1024 sc1 lds
M v[176:179], a[116:119], v[56:59], v[176:179]
 s_cmp_gt_u32 s20, 1
 ds_read_b128 a[88:91], v7 offset:22528
M v[180:183], a[116:119], v[60:63], v[180:183]
 s_cselect_b64 s[86:87], -1, 0
 ds_read_b128 a[92:95], v7 offset:23552
M v[180:183], a[112:115], v[52:55], v[180:183]
 buffer_load_dwordx4 v4, s[8:11], s21 offen offset:2048 sc1 lds
M v[188:191], a[120:123], v[52:55], v[188:191]
 s_cmp_eq_u32 s20, 1
 v_exp_f32 v23, v73
M v[188:191], a[124:127], v[60:63], v[188:191]
 s_cselect_b64 s[80:81], s[16:17], s[86:87]
 v_exp_f32 v24, v74
M v[184:187], a[124:127], v[56:59], v[184:187]
 s_cselect_b64 s[82:83], s[18:19], s[86:87]
 v_exp_f32 v25, v75
M v[184:187], a[120:123], v[48:51], v[184:187]
 s_waitcnt lgkmcnt(0)
 v_exp_f32 v18, v68
M v[192:195], a[64:67], v[48:51], v[192:195]
 s_cselect_b64 s[84:85], s[48:49], s[86:87]
 ds_read_b128 a[96:99], v7 offset:24576
 v_add_f32 v26, v22, v26
M v[192:195], a[68:71], v[56:59], v[192:195]
 s_cselect_b64 s[86:87], s[50:51], s[86:87]
 ds_read_b128 a[100:103], v7 offset:25600
 v_cvt_pk_bf16_f32 v42, v22, v23
M v[196:199], a[68:71], v[60:63], v[196:199]
 buffer_load_dwordx4 v4, s[8:11], s21 offen offset:3072 sc1 lds
M v[196:199], a[64:67], v[52:55], v[196:199]
 s_add_u32 s24, s23, 33554432
 ds_read_b128 a[104:107], v7 offset:26624
 v_add_f32 v26, v23, v26
M v[204:207], a[72:75], v[52:55], v[204:207]
 s_mov_b32 s23, s21
 ds_read_b128 a[108:111], v7 offset:27648
 v_add_f32 v26, v24, v26
M v[204:207], a[76:79], v[60:63], v[204:207]
 s_add_u32 s21, s21, 65536
 v_exp_f32 v19, v69
M v[200:203], a[76:79], v[56:59], v[200:203]
 s_add_u32 s22, s22, 1
 ds_read_b128 a[112:115], v7 offset:28672
 v_cvt_pk_bf16_f32 v43, v24, v25
M v[200:203], a[72:75], v[48:51], v[200:203]
 s_cmp_eq_u32 s22, s25
 ds_read_b128 a[116:119], v7 offset:29696
 v_add_f32 v26, v25, v26
M v[208:211], a[80:83], v[48:51], v[208:211]
 s_cselect_b32 s21, s26, s21
 v_exp_f32 v20, v70
M v[208:211], a[84:87], v[56:59], v[208:211]
 s_cmp_eq_u32 s22, s43
 ds_read_b128 a[120:123], v7 offset:30720
 v_add_f32 v27, v18, v19
M v[212:215], a[84:87], v[60:63], v[212:215]
 s_cselect_b32 s21, s4, s21
 ds_read_b128 a[124:127], v7 offset:31744
 v_cvt_pk_bf16_f32 v44, v18, v19
M v[212:215], a[80:83], v[52:55], v[212:215]
 s_cmp_eq_u32 s22, s6
 v_exp_f32 v21, v71
M v[220:223], a[88:91], v[52:55], v[220:223]
 s_cselect_b32 s21, s7, s21
 v_exp_f32 v22, v76
M v[220:223], a[92:95], v[60:63], v[220:223]
 s_cmp_eq_u32 s20, 0
 v_exp_f32 v23, v77
M v[216:219], a[92:95], v[56:59], v[216:219]
 s_waitcnt vmcnt(16) lgkmcnt(0)
 v_exp_f32 v24, v78
M v[216:219], a[88:91], v[48:51], v[216:219]
 s_barrier
M v[224:227], a[96:99], v[48:51], v[224:227]
 s_cselect_b64 s[88:89], s[16:17], -1
 ds_read_b128 a[64:67], v7 offset:32768
 v_add_f32 v27, v20, v27
M v[224:227], a[100:103], v[56:59], v[224:227]
 s_cselect_b64 s[90:91], s[18:19], -1
 ds_read_b128 a[68:71], v7 offset:33792
 v_cvt_pk_bf16_f32 v45, v20, v21
M v[228:231], a[100:103], v[60:63], v[228:231]
 buffer_load_dword v5, off, s[8:11], s47 sc1
M v[228:231], a[96:99], v[52:55], v[228:231]
 s_cselect_b64 s[92:93], s[48:49], -1
 ds_read_b128 a[72:75], v7 offset:34816
 v_add_f32 v27, v21, v27
M v[236:239], a[104:107], v[52:55], v[236:239]
 s_cselect_b64 s[94:95], s[50:51], -1
 ds_read_b128 a[76:79], v7 offset:35840
 v_add_f32 v27, v22, v27
M v[236:239], a[108:111], v[60:63], v[236:239]
 v_cndmask_b32 v100, v36, v8, s[64:65]
 v_cndmask_b32 v101, v36, v8, s[66:67]
M v[232:235], a[108:111], v[56:59], v[232:235]
 ds_read_b128 a[80:83], v7 offset:36864
 v_cndmask_b32 v102, v36, v8, s[68:69]
M v[232:235], a[104:107], v[48:51], v[232:235]
 ds_read_b128 a[84:87], v7 offset:37888
 v_cndmask_b32 v103, v36, v8, s[70:71]
M v[240:243], a[112:115], v[48:51], v[240:243]
 v_cndmask_b32 v108, v36, v8, s[72:73]
 v_cndmask_b32 v109, v36, v8, s[74:75]
M v[240:243], a[116:119], v[56:59], v[240:243]
 ds_read_b128 a[88:91], v7 offset:38912
 v_cndmask_b32 v110, v36, v8, s[76:77]
M v[244:247], a[116:119], v[60:63], v[244:247]
 ds_read_b128 a[92:95], v7 offset:39936
 v_cndmask_b32 v111, v36, v8, s[78:79]
M v[244:247], a[112:115], v[52:55], v[244:247]
 v_cndmask_b32 v116, v36, v8, s[80:81]
 v_cndmask_b32 v117, v36, v8, s[82:83]
M v[252:255], a[120:123], v[52:55], v[252:255]
 v_cndmask_b32 v118, v36, v8, s[84:85]
 v_cndmask_b32 v119, v36, v8, s[86:87]
M v[252:255], a[124:127], v[60:63], v[252:255]
 v_cndmask_b32 v124, v36, v8, s[88:89]
 v_cndmask_b32 v125, v36, v8, s[90:91]
M v[248:251], a[124:127], v[56:59], v[248:251]
 s_waitcnt lgkmcnt(0)
 v_cndmask_b32 v126, v36, v8, s[92:93]
 v_cndmask_b32 v127, v36, v8, s[94:95]
M v[248:251], a[120:123], v[48:51], v[248:251]
 v_exp_f32 v25, v79
 v_cvt_pk_bf16_f32 v46, v22, v23
 v_add_f32 v27, v23, v27
 v_add_f32 v27, v24, v27
 v_cvt_pk_bf16_f32 v47, v24, v25
 v_add_f32 v27, v25, v27
L_p2:
M v[100:103], a[64:67], a[32:35], v[100:103]
 ds_read_b128 a[96:99], v7 offset:40960
 ds_read_b128 a[100:103], v7 offset:41984
 v_exp_f32 v18, v80
M v[100:103], a[68:71], a[36:39], v[100:103]
 ds_read_b128 a[104:107], v7 offset:43008
 v_exp_f32 v19, v81
M v[100:103], a[72:75], a[40:43], v[100:103]
 ds_read_b128 a[108:111], v7 offset:44032
 ds_read_b128 a[112:115], v7 offset:45056
 v_exp_f32 v20, v82
 v_add_f32 v26, v18, v26
M v[100:103], a[76:79], a[44:47], v[100:103]
 ds_read_b128 a[116:119], v7 offset:46080
 v_cvt_pk_bf16_f32 v56, v18, v19
 v_exp_f32 v21, v83
M v[100:103], a[80:83], a[48:51], v[100:103]
 s_add_u32 m0, s28, 0
 ds_read_b128 a[120:123], v7 offset:47104
 ds_read_b128 a[124:127], v7 offset:48128
 v_add_f32 v26, v19, v26
M v[100:103], a[84:87], a[52:55], v[100:103]
 buffer_load_dwordx4 v3, s[8:11], s24 offen offset:0 sc1 lds
M v[100:103], a[88:91], a[56:59], v[100:103]
 ds_read_b128 a[128:131], v7 offset:49152
 ds_read_b128 a[132:135], v7 offset:50176
 v_exp_f32 v22, v88
 v_add_f32 v26, v20, v26
 v_cvt_pk_bf16_f32 v57, v20, v21
M v[100:103], a[92:95], a[60:63], v[100:103]
 s_waitcnt lgkmcnt(2)
 ds_read_b128 a[136:139], v7 offset:51200
 v_exp_f32 v23, v89
 v_add_f32 v26, v21, v26
M v[108:111], a[124:127], a[60:63], v[108:111]
 ds_read_b128 a[140:143], v7 offset:52224
 ds_read_b128 a[144:147], v7 offset:53248
 v_exp_f32 v24, v90
M v[108:111], a[120:123], a[56:59], v[108:111]
 buffer_load_dwordx4 v3, s[8:11], s24 offen offset:1024 sc1 lds
M v[108:111], a[116:119], a[52:55], v[108:111]
 ds_read_b128 a[148:151], v7 offset:54272
 ds_read_b128 a[152:155], v7 offset:55296
 v_add_f32 v26, v22, v26
 v_cvt_pk_bf16_f32 v58, v22, v23
M v[108:111], a[112:115], a[48:51], v[108:111]
 ds_read_b128 a[156:159], v7 offset:56320
 v_exp_f32 v25, v91
 v_add_f32 v26, v23, v26
M v[108:111], a[108:111], a[44:47], v[108:111]
 ds_read_b128 a[160:163], v7 offset:57344
 ds_read_b128 a[164:167], v7 offset:58368
 v_exp_f32 v18, v84
M v[108:111], a[104:107], a[40:43], v[108:111]
 buffer_load_dwordx4 v3, s[8:11], s24 offen offset:2048 sc1 lds
M v[108:111], a[100:103], a[36:39], v[108:111]
 ds_read_b128 a[168:171], v7 offset:59392
 ds_read_b128 a[172:175], v7 offset:60416
 v_add_f32 v26, v24, v26
 v_cvt_pk_bf16_f32 v59, v24, v25
M v[108:111], a[96:99], a[32:35], v[108:111]
 s_waitcnt lgkmcnt(4)
 ds_read_b128 a[176:179], v7 offset:61440
 v_exp_f32 v19, v85
 v_add_f32 v26, v25, v26
M v[116:119], a[128:131], a[32:35], v[116:119]
 ds_read_b128 a[180:183], v7 offset:62464
 ds_read_b128 a[184:187], v7 offset:63488
 v_exp_f32 v20, v86
M v[116:119], a[132:135], a[36:39], v[116:119]
 ds_read_b128 a[188:191], v7 offset:64512
 v_add_f32 v27, v18, v27
 v_cvt_pk_bf16_f32 v60, v18, v19
M v[116:119], a[136:139], a[40:43], v[116:119]
 buffer_load_dwordx4 v3, s[8:11], s24 offen offset:3072 sc1 lds
M v[116:119], a[140:143], a[44:47], v[116:119]
 s_add_u32 m0, s28, 4096
 v_exp_f32 v21, v87
 v_add_f32 v27, v19, v27
 v_exp_f32 v22, v92
M v[116:119], a[144:147], a[48:51], v[116:119]
 buffer_load_dwordx4 v4, s[8:11], s24 offen offset:0 sc1 lds
M v[116:119], a[148:151], a[52:55], v[116:119]
 s_waitcnt vmcnt(14) lgkmcnt(0)
 v_add_f32 v27, v20, v27
 v_cvt_pk_bf16_f32 v61, v20, v21
 v_exp_f32 v23, v93
 v_add_f32 v27, v21, v27
M v[116:119], a[152:155], a[56:59], v[116:119]
 s_barrier
M v[116:119], a[156:159], a[60:63], v[116:119]
 ds_read_b128 a[64:67], v2 offset:0
 ds_read_b128 a[68:71], v2 offset:1024
 v_exp_f32 v24, v94
M v[124:127], a[188:191], a[60:63], v[124:127]
 ds_read_b128 a[72:75], v2 offset:2048
 v_add_f32 v27, v22, v27
 v_cvt_pk_bf16_f32 v62, v22, v23
M v[124:127], a[184:187], a[56:59], v[124:127]
 ds_read_b128 a[76:79], v2 offset:3072
 ds_read_b128 a[80:83], v2 offset:4096
 v_exp_f32 v25, v95
 v_add_f32 v27, v23, v27
M v[124:127], a[180:183], a[52:55], v[124:127]
 ds_read_b128 a[84:87], v2 offset:5120
 v_add_f32 v27, v24, v27
 v_cvt_pk_bf16_f32 v63, v24, v25
 v_add_f32 v27, v25, v27
M v[124:127], a[176:179], a[48:51], v[124:127]
 ds_read_b128 a[88:91], v2 offset:6144
 ds_read_b128 a[92:95], v2 offset:7168
 v_max_f32 v10, v26, v27
 v_cmp_lt_f32 vcc, s31, v10
M v[124:127], a[172:175], a[44:47], v[124:127]
 buffer_load_dwordx4 v4, s[8:11], s24 offen offset:1024 sc1 lds
M v[124:127], a[168:171], a[40:43], v[124:127]
 buffer_load_dwordx4 v4, s[8:11], s24 offen offset:2048 sc1 lds
M v[124:127], a[164:167], a[36:39], v[124:127]
 buffer_load_dwordx4 v4, s[8:11], s24 offen offset:3072 sc1 lds
M v[124:127], a[160:163], a[32:35], v[124:127]
 s_waitcnt lgkmcnt(0)
 s_cbranch_vccnz L_st6
L_rt6:
 s_cmp_gt_u32 s42, 5
 s_cbranch_scc1 L_p3o
L_p3k:
 s_mov_b32 s72, s32
 s_add_u32 s73, s72, 4096
 s_add_u32 s74, s72, 16384
 s_add_u32 s75, s72, 20480
 s_waitcnt vmcnt(8)
 v_cmp_ne_u32 vcc, 1, v5
 s_nop 0
 s_cbranch_vccnz L_fps1
L_fpr1:
M v[128:131], a[64:67], v[40:43], v[128:131]
 ds_read_b128 a[96:99], v2 offset:8192
 ds_read_b128 a[100:103], v2 offset:9216
M v[128:131], a[68:71], v[56:59], v[128:131]
 buffer_load_dwordx4 a[0:3], v7, s[8:11], s72 offen offset:0 sc1
M v[132:135], a[68:71], v[60:63], v[132:135]
 v_exp_f32 v18, v100
M v[132:135], a[64:67], v[44:47], v[132:135]
 ds_read_b128 a[104:107], v2 offset:10240
 ds_read_b128 a[108:111], v2 offset:11264
M v[140:143], a[72:75], v[44:47], v[140:143]
 buffer_load_dwordx4 a[4:7], v7, s[8:11], s72 offen offset:1024 sc1
M v[140:143], a[76:79], v[60:63], v[140:143]
 v_exp_f32 v19, v101
M v[136:139], a[76:79], v[56:59], v[136:139]
 ds_read_b128 a[112:115], v2 offset:12288
 ds_read_b128 a[116:119], v2 offset:13312
M v[136:139], a[72:75], v[40:43], v[136:139]
 buffer_load_dwordx4 a[8:11], v7, s[8:11], s72 offen offset:2048 sc1
M v[144:147], a[80:83], v[40:43], v[144:147]
 v_exp_f32 v20, v102
M v[144:147], a[84:87], v[56:59], v[144:147]
 ds_read_b128 a[120:123], v2 offset:14336
 ds_read_b128 a[124:127], v2 offset:15360
M v[148:151], a[84:87], v[60:63], v[148:151]
 v_exp_f32 v21, v103
M v[148:151], a[80:83], v[44:47], v[148:151]
 buffer_load_dwordx4 a[12:15], v7, s[8:11], s72 offen offset:3072 sc1
M v[156:159], a[88:91], v[44:47], v[156:159]
 v_add_f32 v30, v26, v30
 v_add_f32 v31, v27, v31
M v[156:159], a[92:95], v[60:63], v[156:159]
 v_add_f32 v29, v18, v19
 v_cvt_pk_bf16_f32 v52, v18, v19
M v[152:155], a[92:95], v[56:59], v[152:155]
 v_exp_f32 v22, v108
M v[152:155], a[88:91], v[40:43], v[152:155]
 s_waitcnt lgkmcnt(0)
 v_add_f32 v29, v20, v29
 v_cvt_pk_bf16_f32 v53, v20, v21
M v[160:163], a[96:99], v[40:43], v[160:163]
 ds_read_b128 a[64:67], v2 offset:16384
 ds_read_b128 a[68:71], v2 offset:17408
M v[160:163], a[100:103], v[56:59], v[160:163]
 buffer_load_dwordx4 a[16:19], v7, s[8:11], s73 offen offset:0 sc1
M v[164:167], a[100:103], v[60:63], v[164:167]
 v_exp_f32 v23, v109
M v[164:167], a[96:99], v[44:47], v[164:167]
 ds_read_b128 a[72:75], v2 offset:18432
 ds_read_b128 a[76:79], v2 offset:19456
M v[172:175], a[104:107], v[44:47], v[172:175]
 buffer_load_dwordx4 a[20:23], v7, s[8:11], s73 offen offset:1024 sc1
M v[172:175], a[108:111], v[60:63], v[172:175]
 v_exp_f32 v24, v110
M v[168:171], a[108:111], v[56:59], v[168:171]
 ds_read_b128 a[80:83], v2 offset:20480
 ds_read_b128 a[84:87], v2 offset:21504
M v[168:171], a[104:107], v[40:43], v[168:171]
 buffer_load_dwordx4 a[24:27], v7, s[8:11], s73 offen offset:2048 sc1
M v[176:179], a[112:115], v[40:43], v[176:179]
 v_exp_f32 v25, v111
M v[176:179], a[116:119], v[56:59], v[176:179]
 ds_read_b128 a[88:91], v2 offset:22528
 ds_read_b128 a[92:95], v2 offset:23552
M v[180:183], a[116:119], v[60:63], v[180:183]
 buffer_load_dwordx4 a[28:31], v7, s[8:11], s73 offen offset:3072 sc1
M v[180:183], a[112:115], v[44:47], v[180:183]
 v_add_f32 v29, v21, v29
 v_add_f32 v29, v22, v29
M v[188:191], a[120:123], v[44:47], v[188:191]
 v_exp_f32 v18, v116
M v[188:191], a[124:127], v[60:63], v[188:191]
 v_cvt_pk_bf16_f32 v54, v22, v23
 v_add_f32 v29, v23, v29
M v[184:187], a[124:127], v[56:59], v[184:187]
 buffer_load_dwordx4 a[32:35], v7, s[8:11], s74 offen offset:0 sc1
M v[184:187], a[120:123], v[40:43], v[184:187]
 s_waitcnt lgkmcnt(0)
 v_exp_f32 v19, v117
M v[192:195], a[64:67], v[40:43], v[192:195]
 ds_read_b128 a[96:99], v2 offset:24576
 ds_read_b128 a[100:103], v2 offset:25600
M v[192:195], a[68:71], v[56:59], v[192:195]
 buffer_load_dwordx4 a[36:39], v7, s[8:11], s74 offen offset:1024 sc1
M v[196:199], a[68:71], v[60:63], v[196:199]
 v_add_f32 v29, v24, v29
 v_cvt_pk_bf16_f32 v55, v24, v25
M v[196:199], a[64:67], v[44:47], v[196:199]
 ds_read_b128 a[104:107], v2 offset:26624
 ds_read_b128 a[108:111], v2 offset:27648
M v[204:207], a[72:75], v[44:47], v[204:207]
 v_exp_f32 v20, v118
M v[204:207], a[76:79], v[60:63], v[204:207]
 buffer_load_dwordx4 a[40:43], v7, s[8:11], s74 offen offset:2048 sc1
M v[200:203], a[76:79], v[56:59], v[200:203]
 ds_read_b128 a[112:115], v2 offset:28672
 ds_read_b128 a[116:119], v2 offset:29696
M v[200:203], a[72:75], v[40:43], v[200:203]
 v_exp_f32 v21, v119
M v[208:211], a[80:83], v[40:43], v[208:211]
 v_add_f32 v29, v25, v29
 v_add_f32 v29, v18, v29
M v[208:211], a[84:87], v[56:59], v[208:211]
 ds_read_b128 a[120:123], v2 offset:30720
 ds_read_b128 a[124:127], v2 offset:31744
M v[212:215], a[84:87], v[60:63], v[212:215]
 buffer_load_dwordx4 a[44:47], v7, s[8:11], s74 offen offset:3072 sc1
M v[212:215], a[80:83], v[44:47], v[212:215]
 v_exp_f32 v22, v124
M v[220:223], a[88:91], v[44:47], v[220:223]
 v_cvt_pk_bf16_f32 v48, v18, v19
 v_add_f32 v29, v19, v29
M v[220:223], a[92:95], v[60:63], v[220:223]
 buffer_load_dwordx4 a[48:51], v7, s[8:11], s75 offen offset:0 sc1
M v[216:219], a[92:95], v[56:59], v[216:219]
 s_waitcnt vmcnt(13) lgkmcnt(0)
 v_exp_f32 v23, v125
M v[216:219], a[88:91], v[40:43], v[216:219]
 s_barrier
M v[224:227], a[96:99], v[40:43], v[224:227]
 ds_read_b128 a[64:67], v7 offset:0
 ds_read_b128 a[68:71], v7 offset:1024
M v[224:227], a[100:103], v[56:59], v[224:227]
 buffer_load_dwordx4 a[52:55], v7, s[8:11], s75 offen offset:1024 sc1
M v[228:231], a[100:103], v[60:63], v[228:231]
 v_exp_f32 v24, v126
M v[228:231], a[96:99], v[44:47], v[228:231]
 ds_read_b128 a[72:75], v7 offset:2048
 ds_read_b128 a[76:79], v7 offset:3072
M v[236:239], a[104:107], v[44:47], v[236:239]
 buffer_load_dwordx4 a[56:59], v7, s[8:11], s75 offen offset:2048 sc1
M v[236:239], a[108:111], v[60:63], v[236:239]
 v_exp_f32 v25, v127
M v[232:235], a[108:111], v[56:59], v[232:235]
 ds_read_b128 a[80:83], v7 offset:4096
 ds_read_b128 a[84:87], v7 offset:5120
M v[232:235], a[104:107], v[40:43], v[232:235]
 v_add_f32 v29, v20, v29
 v_cvt_pk_bf16_f32 v49, v20, v21
M v[240:243], a[112:115], v[40:43], v[240:243]
 buffer_load_dwordx4 a[60:63], v7, s[8:11], s75 offen offset:3072 sc1
M v[240:243], a[116:119], v[56:59], v[240:243]
 ds_read_b128 a[88:91], v7 offset:6144
 ds_read_b128 a[92:95], v7 offset:7168
M v[244:247], a[116:119], v[60:63], v[244:247]
 v_add_f32 v29, v21, v29
 v_add_f32 v29, v22, v29
M v[244:247], a[112:115], v[44:47], v[244:247]
 v_cvt_pk_bf16_f32 v50, v22, v23
 v_add_f32 v29, v23, v29
M v[252:255], a[120:123], v[44:47], v[252:255]
 v_add_f32 v29, v24, v29
 v_cvt_pk_bf16_f32 v51, v24, v25
M v[252:255], a[124:127], v[60:63], v[252:255]
 v_add_f32 v29, v25, v29
M v[248:251], a[124:127], v[56:59], v[248:251]
 s_waitcnt lgkmcnt(0)
M v[248:251], a[120:123], v[40:43], v[248:251]
 v_cmp_lt_f32 vcc, s31, v29
 s_nop 0
 s_cbranch_vccnz L_st7
L_rt7:
M v[132:135], a[64:67], v[52:55], v[132:135]
 ds_read_b128 a[96:99], v7 offset:8192
 ds_read_b128 a[100:103], v7 offset:9216
M v[132:135], a[68:71], v[48:51], v[132:135]
 ds_read_b128 a[104:107], v7 offset:10240
 v_add_f32 v31, v29, v31
M v[140:143], a[76:79], v[48:51], v[140:143]
 s_sub_u32 s27, 5, s42
 ds_read_b128 a[108:111], v7 offset:11264
 ds_read_b128 a[112:115], v7 offset:12288
M v[140:143], a[72:75], v[52:55], v[140:143]
 s_mov_b32 s40, 0
 ds_read_b128 a[116:119], v7 offset:13312
 v_mov_b32 v10, v30
M v[148:151], a[80:83], v[52:55], v[148:151]
 s_add_u32 m0, s28, 32768
 ds_read_b128 a[120:123], v7 offset:14336
 ds_read_b128 a[124:127], v7 offset:15360
M v[148:151], a[84:87], v[48:51], v[148:151]
 buffer_load_dwordx4 v3, s[8:11], s21 offen offset:0 sc1 lds
M v[156:159], a[92:95], v[48:51], v[156:159]
 ds_read_b128 a[128:131], v7 offset:16384
 ds_read_b128 a[132:135], v7 offset:17408
M v[156:159], a[88:91], v[52:55], v[156:159]
 s_waitcnt lgkmcnt(2)
 ds_read_b128 a[136:139], v7 offset:18432
 v_mov_b32 v11, v31
M v[164:167], a[96:99], v[52:55], v[164:167]
 ds_read_b128 a[140:143], v7 offset:19456
 ds_read_b128 a[144:147], v7 offset:20480
M v[164:167], a[100:103], v[48:51], v[164:167]
 buffer_load_dwordx4 v3, s[8:11], s21 offen offset:1024 sc1 lds
M v[172:175], a[108:111], v[48:51], v[172:175]
 ds_read_b128 a[148:151], v7 offset:21504
 ds_read_b128 a[152:155], v7 offset:22528
M v[172:175], a[104:107], v[52:55], v[172:175]
 ds_read_b128 a[156:159], v7 offset:23552
 v_permlane16_swap_b32 v10, v30
M v[180:183], a[112:115], v[52:55], v[180:183]
 ds_read_b128 a[160:163], v7 offset:24576
 ds_read_b128 a[164:167], v7 offset:25600
M v[180:183], a[116:119], v[48:51], v[180:183]
 buffer_load_dwordx4 v3, s[8:11], s21 offen offset:2048 sc1 lds
M v[188:191], a[124:127], v[48:51], v[188:191]
 ds_read_b128 a[168:171], v7 offset:26624
 ds_read_b128 a[172:175], v7 offset:27648
M v[188:191], a[120:123], v[52:55], v[188:191]
 s_waitcnt lgkmcnt(4)
 ds_read_b128 a[176:179], v7 offset:28672
 v_permlane16_swap_b32 v11, v31
M v[196:199], a[128:131], v[52:55], v[196:199]
 ds_read_b128 a[180:183], v7 offset:29696
 ds_read_b128 a[184:187], v7 offset:30720
M v[196:199], a[132:135], v[48:51], v[196:199]
 ds_read_b128 a[188:191], v7 offset:31744
 v_add_f32 v30, v10, v30
M v[204:207], a[140:143], v[48:51], v[204:207]
 buffer_load_dwordx4 v3, s[8:11], s21 offen offset:3072 sc1 lds
M v[204:207], a[136:139], v[52:55], v[204:207]
 s_add_u32 m0, s28, 36864
 v_add_f32 v31, v11, v31
 v_mov_b32 v10, v30
M v[212:215], a[144:147], v[52:55], v[212:215]
 buffer_load_dwordx4 v4, s[8:11], s21 offen offset:0 sc1 lds
M v[212:215], a[148:151], v[48:51], v[212:215]
 s_waitcnt lgkmcnt(0)
 v_mov_b32 v11, v31
 v_permlane32_swap_b32 v10, v30
M v[220:223], a[156:159], v[48:51], v[220:223]
 s_barrier
M v[220:223], a[152:155], v[52:55], v[220:223]
 ds_read_b128 a[64:67], v2 offset:32768
 ds_read_b128 a[68:71], v2 offset:33792
M v[228:231], a[160:163], v[52:55], v[228:231]
 ds_read_b128 a[72:75], v2 offset:34816
 v_permlane32_swap_b32 v11, v31
M v[228:231], a[164:167], v[48:51], v[228:231]
 ds_read_b128 a[76:79], v2 offset:35840
 ds_read_b128 a[80:83], v2 offset:36864
M v[236:239], a[172:175], v[48:51], v[236:239]
 ds_read_b128 a[84:87], v2 offset:37888
 v_add_f32 v30, v10, v30
M v[236:239], a[168:171], v[52:55], v[236:239]
 ds_read_b128 a[88:91], v2 offset:38912
 ds_read_b128 a[92:95], v2 offset:39936
M v[244:247], a[176:179], v[52:55], v[244:247]
 buffer_load_dwordx4 v4, s[8:11], s21 offen offset:1024 sc1 lds
M v[244:247], a[180:183], v[48:51], v[244:247]
 buffer_load_dwordx4 v4, s[8:11], s21 offen offset:2048 sc1 lds
M v[252:255], a[188:191], v[48:51], v[252:255]
 buffer_load_dwordx4 v4, s[8:11], s21 offen offset:3072 sc1 lds
M v[252:255], a[184:187], v[52:55], v[252:255]
 s_waitcnt lgkmcnt(0)
 s_add_u32 s24, s23, 33554432
 s_mov_b32 s23, s21
 s_add_u32 s21, s21, 65536
 s_add_u32 s22, s22, 1
 s_cmp_eq_u32 s22, s25
 s_cselect_b32 s21, s26, s21
 s_cmp_eq_u32 s22, s43
 s_cselect_b32 s21, s4, s21
 s_cmp_eq_u32 s22, s6
 s_cselect_b32 s21, s7, s21
 v_add_f32 v31, v11, v31
 v_rcp_f32 v5, v30
 v_rcp_f32 v6, v31
 v_accvgpr_write_b32 a192, v5
 v_accvgpr_write_b32 a193, v6
 v_mov_b32 v30, 0
 v_mov_b32 v31, 0
 v_mov_b32 v32, 0xc1800000
 v_mov_b32 v33, 0xc1800000
 v_mov_b32 v34, 0xc1800000
 v_mov_b32 v35, 0xc1800000
 v_mov_b32 v36, 0xc1800000
 v_mov_b32 v37, 0xc1800000
 v_mov_b32 v38, 0xc1800000
 v_mov_b32 v39, 0xc1800000
 s_waitcnt vmcnt(8)
M v[64:67], a[64:67], a[0:3], v[32:35]
 ds_read_b128 a[96:99], v2 offset:40960
 v_cvt_pk_bf16_f32 v128, v128, v129
M v[64:67], a[68:71], a[4:7], v[64:67]
 ds_read_b128 a[100:103], v2 offset:41984
 v_cvt_pk_bf16_f32 v129, v130, v131
M v[64:67], a[72:75], a[8:11], v[64:67]
 buffer_load_dword v6, v9, s[8:11], s46 offen sc1
M v[64:67], a[76:79], a[12:15], v[64:67]
 ds_read_b128 a[104:107], v2 offset:43008
 v_cvt_pk_bf16_f32 v130, v136, v137
M v[64:67], a[80:83], a[16:19], v[64:67]
 s_add_u32 m0, s28, 65536
 ds_read_b128 a[108:111], v2 offset:44032
 v_cvt_pk_bf16_f32 v131, v138, v139
M v[64:67], a[84:87], a[20:23], v[64:67]
 buffer_load_dwordx4 v3, s[8:11], s24 offen offset:0 sc1 lds
M v[64:67], a[88:91], a[24:27], v[64:67]
 ds_read_b128 a[112:115], v2 offset:45056
 v_accvgpr_write_b32 a128, v128
M v[64:67], a[92:95], a[28:31], v[64:67]
 ds_read_b128 a[116:119], v2 offset:46080
 v_accvgpr_write_b32 a129, v129
M v[68:71], a[92:95], a[60:63], v[36:39]
 buffer_load_dwordx4 v3, s[8:11], s24 offen offset:1024 sc1 lds
M v[68:71], a[88:91], a[56:59], v[68:71]
 ds_read_b128 a[120:123], v2 offset:47104
 v_accvgpr_write_b32 a130, v130
M v[68:71], a[84:87], a[52:55], v[68:71]
 ds_read_b128 a[124:127], v2 offset:48128
 v_accvgpr_write_b32 a131, v131
M v[68:71], a[80:83], a[48:51], v[68:71]
 v_exp_f32 v18, v64
M v[68:71], a[76:79], a[44:47], v[68:71]
 v_exp_f32 v19, v65
M v[68:71], a[72:75], a[40:43], v[68:71]
 buffer_load_dwordx4 v3, s[8:11], s24 offen offset:2048 sc1 lds
M v[68:71], a[68:71], a[36:39], v[68:71]
 v_exp_f32 v20, v66
M v[68:71], a[64:67], a[32:35], v[68:71]
 s_waitcnt lgkmcnt(0)
 v_exp_f32 v21, v67
M v[72:75], a[96:99], a[0:3], v[32:35]
 ds_read_b128 a[64:67], v2 offset:49152
 v_add_f32 v26, v18, v19
M v[72:75], a[100:103], a[4:7], v[72:75]
 ds_read_b128 a[68:71], v2 offset:50176
 v_cvt_pk_bf16_f32 v40, v18, v19
M v[72:75], a[104:107], a[8:11], v[72:75]
 buffer_load_dwordx4 v3, s[8:11], s24 offen offset:3072 sc1 lds
M v[72:75], a[108:111], a[12:15], v[72:75]
 ds_read_b128 a[72:75], v2 offset:51200
 v_add_f32 v26, v20, v26
M v[72:75], a[112:115], a[16:19], v[72:75]
 ds_read_b128 a[76:79], v2 offset:52224
 v_cvt_pk_bf16_f32 v41, v20, v21
M v[72:75], a[116:119], a[20:23], v[72:75]
 v_exp_f32 v22, v68
M v[72:75], a[120:123], a[24:27], v[72:75]
 ds_read_b128 a[80:83], v2 offset:53248
 v_add_f32 v26, v21, v26
M v[72:75], a[124:127], a[28:31], v[72:75]
 s_add_u32 m0, s28, 69632
 ds_read_b128 a[84:87], v2 offset:54272
 v_cvt_pk_bf16_f32 v132, v132, v133
M v[76:79], a[124:127], a[60:63], v[36:39]
 buffer_load_dwordx4 v4, s[8:11], s24 offen offset:0 sc1 lds
M v[76:79], a[120:123], a[56:59], v[76:79]
 ds_read_b128 a[88:91], v2 offset:55296
 v_cvt_pk_bf16_f32 v133, v134, v135
M v[76:79], a[116:119], a[52:55], v[76:79]
 ds_read_b128 a[92:95], v2 offset:56320
 v_cvt_pk_bf16_f32 v134, v140, v141
M v[76:79], a[112:115], a[48:51], v[76:79]
 v_exp_f32 v23, v69
M v[76:79], a[108:111], a[44:47], v[76:79]
 buffer_load_dwordx4 v4, s[8:11], s24 offen offset:1024 sc1 lds
M v[76:79], a[104:107], a[40:43], v[76:79]
 v_exp_f32 v24, v70
M v[76:79], a[100:103], a[36:39], v[76:79]
 v_exp_f32 v25, v71
M v[76:79], a[96:99], a[32:35], v[76:79]
 s_waitcnt lgkmcnt(0)
 v_exp_f32 v18, v72
M v[80:83], a[64:67], a[0:3], v[32:35]
 ds_read_b128 a[96:99], v2 offset:57344
 v_add_f32 v27, v22, v23
M v[80:83], a[68:71], a[4:7], v[80:83]
 ds_read_b128 a[100:103], v2 offset:58368
 v_cvt_pk_bf16_f32 v44, v22, v23
M v[80:83], a[72:75], a[8:11], v[80:83]
 buffer_load_dwordx4 v4, s[8:11], s24 offen offset:2048 sc1 lds
M v[80:83], a[76:79], a[12:15], v[80:83]
 ds_read_b128 a[104:107], v2 offset:59392
 v_add_f32 v27, v24, v27
M v[80:83], a[80:83], a[16:19], v[80:83]
 ds_read_b128 a[108:111], v2 offset:60416
 v_cvt_pk_bf16_f32 v45, v24, v25
M v[80:83], a[84:87], a[20:23], v[80:83]
 v_exp_f32 v19, v73
M v[80:83], a[88:91], a[24:27], v[80:83]
 ds_read_b128 a[112:115], v2 offset:61440
 v_add_f32 v27, v25, v27
M v[80:83], a[92:95], a[28:31], v[80:83]
 ds_read_b128 a[116:119], v2 offset:62464
 v_add_f32 v26, v18, v26
M v[84:87], a[92:95], a[60:63], v[36:39]
 s_waitcnt vmcnt(7)
 v_cmp_gt_u32 vcc, 3, v6
 v_cvt_pk_bf16_f32 v42, v18, v19
M v[84:87], a[88:91], a[56:59], v[84:87]
 ds_read_b128 a[120:123], v2 offset:63488
 v_add_f32 v26, v19, v26
M v[84:87], a[84:87], a[52:55], v[84:87]
 ds_read_b128 a[124:127], v2 offset:64512
 v_cvt_pk_bf16_f32 v135, v142, v143
M v[84:87], a[80:83], a[48:51], v[84:87]
 s_cbranch_vccnz L_f2s
L_f2r:
 v_exp_f32 v20, v74
M v[84:87], a[76:79], a[44:47], v[84:87]
 buffer_load_dwordx4 v4, s[8:11], s24 offen offset:3072 sc1 lds
M v[84:87], a[72:75], a[40:43], v[84:87]
 v_exp_f32 v21, v75
M v[84:87], a[68:71], a[36:39], v[84:87]
 s_waitcnt lgkmcnt(0)
 v_exp_f32 v22, v76
M v[84:87], a[64:67], a[32:35], v[84:87]
 s_barrier
M v[88:91], a[96:99], a[0:3], v[32:35]
 ds_read_b128 a[64:67], v7 offset:32768
 v_add_f32 v26, v20, v26
M v[88:91], a[100:103], a[4:7], v[88:91]
 ds_read_b128 a[68:71], v7 offset:33792
 v_cvt_pk_bf16_f32 v43, v20, v21
M v[88:91], a[104:107], a[8:11], v[88:91]
 v_exp_f32 v23, v77
M v[88:91], a[108:111], a[12:15], v[88:91]
 ds_read_b128 a[72:75], v7 offset:34816
 v_add_f32 v26, v21, v26
M v[88:91], a[112:115], a[16:19], v[88:91]
 ds_read_b128 a[76:79], v7 offset:35840
 v_add_f32 v27, v22, v27
M v[88:91], a[116:119], a[20:23], v[88:91]
 v_exp_f32 v24, v78
M v[88:91], a[120:123], a[24:27], v[88:91]
 ds_read_b128 a[80:83], v7 offset:36864
 v_cvt_pk_bf16_f32 v46, v22, v23
M v[88:91], a[124:127], a[28:31], v[88:91]
 ds_read_b128 a[84:87], v7 offset:37888
 v_add_f32 v27, v23, v27
M v[92:95], a[124:127], a[60:63], v[36:39]
 v_exp_f32 v25, v79
M v[92:95], a[120:123], a[56:59], v[92:95]
 ds_read_b128 a[88:91], v7 offset:38912
 v_add_f32 v27, v24, v27
M v[92:95], a[116:119], a[52:55], v[92:95]
 ds_read_b128 a[92:95], v7 offset:39936
 v_cvt_pk_bf16_f32 v47, v24, v25
M v[92:95], a[112:115], a[48:51], v[92:95]
 v_add_f32 v27, v25, v27
 v_accvgpr_write_b32 a160, v132
M v[92:95], a[108:111], a[44:47], v[92:95]
 v_accvgpr_write_b32 a161, v133
 v_accvgpr_write_b32 a162, v134
M v[92:95], a[104:107], a[40:43], v[92:95]
 v_accvgpr_write_b32 a163, v135
 v_cvt_pk_bf16_f32 v144, v144, v145
M v[92:95], a[100:103], a[36:39], v[92:95]
 s_waitcnt lgkmcnt(0)
 v_cvt_pk_bf16_f32 v145, v146, v147
 v_cvt_pk_bf16_f32 v146, v152, v153
M v[92:95], a[96:99], a[32:35], v[92:95]
 v_cvt_pk_bf16_f32 v147, v154, v155
 v_accvgpr_write_b32 a132, v144
M v[96:99], a[64:67], a[0:3], v[32:35]
 s_add_u32 m0, s28, 98304
 ds_read_b128 a[96:99], v7 offset:40960
 v_accvgpr_write_b32 a133, v145
M v[96:99], a[68:71], a[4:7], v[96:99]
 ds_read_b128 a[100:103], v7 offset:41984
 v_accvgpr_write_b32 a134, v146
M v[96:99], a[72:75], a[8:11], v[96:99]
 buffer_load_dwordx4 v3, s[8:11], s21 offen offset:0 sc1 lds
M v[96:99], a[76:79], a[12:15], v[96:99]
 ds_read_b128 a[104:107], v7 offset:43008
 v_accvgpr_write_b32 a135, v147
M v[96:99], a[80:83], a[16:19], v[96:99]
 ds_read_b128 a[108:111], v7 offset:44032
 v_cvt_pk_bf16_f32 v148, v148, v149
M v[96:99], a[84:87], a[20:23], v[96:99]
 buffer_load_dwordx4 v3, s[8:11], s21 offen offset:1024 sc1 lds
M v[96:99], a[88:91], a[24:27], v[96:99]
 ds_read_b128 a[112:115], v7 offset:45056
 v_cvt_pk_bf16_f32 v149, v150, v151
M v[96:99], a[92:95], a[28:31], v[96:99]
 ds_read_b128 a[116:119], v7 offset:46080
 v_cvt_pk_bf16_f32 v150, v156, v157
M v[100:103], a[92:95], a[60:63], v[36:39]
 v_exp_f32 v18, v80
M v[100:103], a[88:91], a[56:59], v[100:103]
 ds_read_b128 a[120:123], v7 offset:47104
 v_cvt_pk_bf16_f32 v151, v158, v159
M v[100:103], a[84:87], a[52:55], v[100:103]
 ds_read_b128 a[124:127], v7 offset:48128
 v_accvgpr_write_b32 a164, v148
M v[100:103], a[80:83], a[48:51], v[100:103]
 buffer_load_dwordx4 v3, s[8:11], s21 offen offset:2048 sc1 lds
M v[100:103], a[76:79], a[44:47], v[100:103]
 v_exp_f32 v19, v81
M v[100:103], a[72:75], a[40:43], v[100:103]
 v_exp_f32 v20, v82
M v[100:103], a[68:71], a[36:39], v[100:103]
 v_exp_f32 v21, v83
M v[100:103], a[64:67], a[32:35], v[100:103]
 s_waitcnt lgkmcnt(0)
 v_exp_f32 v22, v88
M v[108:111], a[96:99], a[32:35], v[36:39]
 ds_read_b128 a[64:67], v7 offset:49152
 v_add_f32 v26, v18, v26
M v[108:111], a[100:103], a[36:39], v[108:111]
 ds_read_b128 a[68:71], v7 offset:50176
 v_cvt_pk_bf16_f32 v56, v18, v19
M v[108:111], a[104:107], a[40:43], v[108:111]
 buffer_load_dwordx4 v3, s[8:11], s21 offen offset:3072 sc1 lds
M v[108:111], a[108:111], a[44:47], v[108:111]
 s_add_u32 m0, s28, 102400
 ds_read_b128 a[72:75], v7 offset:51200
 v_add_f32 v26, v19, v26
M v[108:111], a[112:115], a[48:51], v[108:111]
 ds_read_b128 a[76:79], v7 offset:52224
 v_add_f32 v26, v20, v26
M v[108:111], a[116:119], a[52:55], v[108:111]
 buffer_load_dwordx4 v4, s[8:11], s21 offen offset:0 sc1 lds
M v[108:111], a[120:123], a[56:59], v[108:111]
 ds_read_b128 a[80:83], v7 offset:53248
 v_cvt_pk_bf16_f32 v57, v20, v21
M v[108:111], a[124:127], a[60:63], v[108:111]
 ds_read_b128 a[84:87], v7 offset:54272
 v_add_f32 v26, v21, v26
M v[104:107], a[124:127], a[28:31], v[32:35]
 v_exp_f32 v23, v89
M v[104:107], a[120:123], a[24:27], v[104:107]
 ds_read_b128 a[88:91], v7 offset:55296
 v_add_f32 v26, v22, v26
M v[104:107], a[116:119], a[20:23], v[104:107]
 ds_read_b128 a[92:95], v7 offset:56320
 v_cvt_pk_bf16_f32 v58, v22, v23
M v[104:107], a[112:115], a[16:19], v[104:107]
 buffer_load_dwordx4 v4, s[8:11], s21 offen offset:1024 sc1 lds
M v[104:107], a[108:111], a[12:15], v[104:107]
 v_exp_f32 v24, v90
M v[104:107], a[104:107], a[8:11], v[104:107]
 v_exp_f32 v25, v91
M v[104:107], a[100:103], a[4:7], v[104:107]
 buffer_load_dwordx4 v4, s[8:11], s21 offen offset:2048 sc1 lds
M v[104:107], a[96:99], a[0:3], v[104:107]
 s_waitcnt lgkmcnt(0)
 v_exp_f32 v18, v84
M v[112:115], a[64:67], a[0:3], v[32:35]
 ds_read_b128 a[96:99], v7 offset:57344
 v_add_f32 v26, v23, v26
M v[112:115], a[68:71], a[4:7], v[112:115]
 ds_read_b128 a[100:103], v7 offset:58368
 v_add_f32 v26, v24, v26
M v[112:115], a[72:75], a[8:11], v[112:115]
 v_exp_f32 v19, v85
M v[112:115], a[76:79], a[12:15], v[112:115]
 ds_read_b128 a[104:107], v7 offset:59392
 v_cvt_pk_bf16_f32 v59, v24, v25
M v[112:115], a[80:83], a[16:19], v[112:115]
 ds_read_b128 a[108:111], v7 offset:60416
 v_add_f32 v26, v25, v26
M v[112:115], a[84:87], a[20:23], v[112:115]
 buffer_load_dwordx4 v4, s[8:11], s21 offen offset:3072 sc1 lds
M v[112:115], a[88:91], a[24:27], v[112:115]
 s_add_u32 s24, s23, 33554432
 ds_read_b128 a[112:115], v7 offset:61440
 v_add_f32 v27, v18, v27
M v[112:115], a[92:95], a[28:31], v[112:115]
 s_mov_b32 s23, s21
 ds_read_b128 a[116:119], v7 offset:62464
 v_cvt_pk_bf16_f32 v60, v18, v19
M v[116:119], a[92:95], a[60:63], v[36:39]
 s_add_u32 s21, s21, 65536
 v_exp_f32 v20, v86
M v[116:119], a[88:91], a[56:59], v[116:119]
 s_add_u32 s22, s22, 1
 ds_read_b128 a[120:123], v7 offset:63488
 v_add_f32 v27, v19, v27
M v[116:119], a[84:87], a[52:55], v[116:119]
 s_cmp_eq_u32 s22, s25
 ds_read_b128 a[124:127], v7 offset:64512
 v_accvgpr_write_b32 a165, v149
M v[116:119], a[80:83], a[48:51], v[116:119]
 s_cselect_b32 s21, s26, s21
 v_exp_f32 v21, v87
M v[116:119], a[76:79], a[44:47], v[116:119]
 s_cmp_eq_u32 s22, s43
 v_exp_f32 v22, v92
M v[116:119], a[72:75], a[40:43], v[116:119]
 s_cselect_b32 s21, s4, s21
 v_exp_f32 v23, v93
M v[116:119], a[68:71], a[36:39], v[116:119]
 s_waitcnt vmcnt(8) lgkmcnt(0)
 v_add_f32 v27, v20, v27
 v_cvt_pk_bf16_f32 v61, v20, v21
M v[116:119], a[64:67], a[32:35], v[116:119]
 s_barrier
M v[124:127], a[96:99], a[32:35], v[36:39]
 s_cmp_eq_u32 s22, s6
 ds_read_b128 a[64:67], v2 offset:0
 v_add_f32 v27, v21, v27
M v[124:127], a[100:103], a[36:39], v[124:127]
 s_cselect_b32 s21, s7, s21
 ds_read_b128 a[68:71], v2 offset:1024
 v_add_f32 v27, v22, v27
M v[124:127], a[104:107], a[40:43], v[124:127]
 v_exp_f32 v24, v94
M v[124:127], a[108:111], a[44:47], v[124:127]
 ds_read_b128 a[72:75], v2 offset:2048
 v_cvt_pk_bf16_f32 v62, v22, v23
M v[124:127], a[112:115], a[48:51], v[124:127]
 ds_read_b128 a[76:79], v2 offset:3072
 v_add_f32 v27, v23, v27
M v[124:127], a[116:119], a[52:55], v[124:127]
 v_exp_f32 v25, v95
M v[124:127], a[120:123], a[56:59], v[124:127]
 ds_read_b128 a[80:83], v2 offset:4096
 v_add_f32 v27, v24, v27
M v[124:127], a[124:127], a[60:63], v[124:127]
 ds_read_b128 a[84:87], v2 offset:5120
 v_cvt_pk_bf16_f32 v63, v24, v25
M v[120:123], a[124:127], a[28:31], v[32:35]
 v_add_f32 v27, v25, v27
 v_accvgpr_write_b32 a166, v150
M v[120:123], a[120:123], a[24:27], v[120:123]
 ds_read_b128 a[88:91], v2 offset:6144
 v_max_f32 v10, v26, v27
M v[120:123], a[116:119], a[20:23], v[120:123]
 ds_read_b128 a[92:95], v2 offset:7168
 v_min_f32 v11, v26, v27
M v[120:123], a[112:115], a[16:19], v[120:123]
 v_cmp_lt_f32 s[36:37], s31, v10
 v_accvgpr_write_b32 a167, v151
M v[120:123], a[108:111], a[12:15], v[120:123]
 v_cmp_gt_f32 vcc, s55, v11
 v_cvt_pk_bf16_f32 v160, v160, v161
M v[120:123], a[104:107], a[8:11], v[120:123]
 v_cvt_pk_bf16_f32 v161, v162, v163
 v_cvt_pk_bf16_f32 v162, v168, v169
M v[120:123], a[100:103], a[4:7], v[120:123]
 s_waitcnt lgkmcnt(0)
 s_or_b64 vcc, vcc, s[36:37]
M v[120:123], a[96:99], a[0:3], v[120:123]
 s_cbranch_vccnz L_st11
L_rt11:
 v_cvt_pk_bf16_f32 v163, v170, v171
 v_accvgpr_write_b32 a136, v160
 v_accvgpr_write_b32 a137, v161
 v_accvgpr_write_b32 a138, v162
 v_accvgpr_write_b32 a139, v163
 v_cvt_pk_bf16_f32 v164, v164, v165
 v_cvt_pk_bf16_f32 v165, v166, v167
 v_cvt_pk_bf16_f32 v166, v172, v173
 v_cvt_pk_bf16_f32 v167, v174, v175
 v_accvgpr_write_b32 a168, v164
 v_accvgpr_write_b32 a169, v165
 v_accvgpr_write_b32 a170, v166
 v_accvgpr_write_b32 a171, v167
 v_cvt_pk_bf16_f32 v176, v176, v177
 v_cvt_pk_bf16_f32 v177, v178, v179
 v_cvt_pk_bf16_f32 v178, v184, v185
 v_cvt_pk_bf16_f32 v179, v186, v187
 v_accvgpr_write_b32 a140, v176
 v_accvgpr_write_b32 a141, v177
 v_accvgpr_write_b32 a142, v178
 v_accvgpr_write_b32 a143, v179
 v_cvt_pk_bf16_f32 v180, v180, v181
 v_cvt_pk_bf16_f32 v181, v182, v183
 v_cvt_pk_bf16_f32 v182, v188, v189
 v_cvt_pk_bf16_f32 v183, v190, v191
 v_accvgpr_write_b32 a172, v180
 v_accvgpr_write_b32 a173, v181
 v_accvgpr_write_b32 a174, v182
 v_accvgpr_write_b32 a175, v183
 v_cvt_pk_bf16_f32 v192, v192, v193
 v_cvt_pk_bf16_f32 v193, v194, v195
 v_cvt_pk_bf16_f32 v194, v200, v201
 v_cvt_pk_bf16_f32 v195, v202, v203
 v_accvgpr_write_b32 a144, v192
 v_accvgpr_write_b32 a145, v193
 v_accvgpr_write_b32 a146, v194
 v_accvgpr_write_b32 a147, v195
 v_cvt_pk_bf16_f32 v196, v196, v197
 v_cvt_pk_bf16_f32 v197, v198, v199
 v_cvt_pk_bf16_f32 v198, v204, v205
 v_cvt_pk_bf16_f32 v199, v206, v207
 v_accvgpr_write_b32 a176, v196
 v_accvgpr_write_b32 a177, v197
 v_accvgpr_write_b32 a178, v198
 v_accvgpr_write_b32 a179, v199
 v_cvt_pk_bf16_f32 v208, v208, v209
 v_cvt_pk_bf16_f32 v209, v210, v211
 v_cvt_pk_bf16_f32 v210, v216, v217
 v_cvt_pk_bf16_f32 v211, v218, v219
 v_accvgpr_write_b32 a148, v208
 v_accvgpr_write_b32 a149, v209
 v_accvgpr_write_b32 a150, v210
 v_accvgpr_write_b32 a151, v211
 v_cvt_pk_bf16_f32 v212, v212, v213
 v_cvt_pk_bf16_f32 v213, v214, v215
 v_cvt_pk_bf16_f32 v214, v220, v221
 v_cvt_pk_bf16_f32 v215, v222, v223
 v_accvgpr_write_b32 a180, v212
 v_accvgpr_write_b32 a181, v213
 v_accvgpr_write_b32 a182, v214
 v_accvgpr_write_b32 a183, v215
 v_cvt_pk_bf16_f32 v224, v224, v225
 v_cvt_pk_bf16_f32 v225, v226, v227
 v_cvt_pk_bf16_f32 v226, v232, v233
 v_cvt_pk_bf16_f32 v227, v234, v235
 v_accvgpr_write_b32 a152, v224
 v_accvgpr_write_b32 a153, v225
 v_accvgpr_write_b32 a154, v226
 v_accvgpr_write_b32 a155, v227
 v_cvt_pk_bf16_f32 v228, v228, v229
 v_cvt_pk_bf16_f32 v229, v230, v231
 v_cvt_pk_bf16_f32 v230, v236, v237
 v_cvt_pk_bf16_f32 v231, v238, v239
 v_accvgpr_write_b32 a184, v228
 v_accvgpr_write_b32 a185, v229
 v_accvgpr_write_b32 a186, v230
 v_accvgpr_write_b32 a187, v231
M v[128:131], a[64:67], v[40:43], 0
 s_add_u32 m0, s28, 0
 ds_read_b128 a[96:99], v2 offset:8192
 ds_read_b128 a[100:103], v2 offset:9216
M v[128:131], a[68:71], v[56:59], v[128:131]
 buffer_load_dwordx4 v3, s[8:11], s24 offen offset:0 sc1 lds
M v[132:135], a[68:71], v[60:63], 0
 v_cvt_pk_bf16_f32 v240, v240, v241
 v_cvt_pk_bf16_f32 v241, v242, v243
M v[132:135], a[64:67], v[44:47], v[132:135]
 ds_read_b128 a[104:107], v2 offset:10240
 ds_read_b128 a[108:111], v2 offset:11264
M v[140:143], a[72:75], v[44:47], 0
 buffer_load_dwordx4 v3, s[8:11], s24 offen offset:1024 sc1 lds
M v[140:143], a[76:79], v[60:63], v[140:143]
 v_cvt_pk_bf16_f32 v242, v248, v249
 v_cvt_pk_bf16_f32 v243, v250, v251
M v[136:139], a[76:79], v[56:59], 0
 ds_read_b128 a[112:115], v2 offset:12288
 ds_read_b128 a[116:119], v2 offset:13312
M v[136:139], a[72:75], v[40:43], v[136:139]
 buffer_load_dwordx4 v3, s[8:11], s24 offen offset:2048 sc1 lds
M v[144:147], a[80:83], v[40:43], 0
 v_accvgpr_write_b32 a156, v240
 v_accvgpr_write_b32 a157, v241
M v[144:147], a[84:87], v[56:59], v[144:147]
 ds_read_b128 a[120:123], v2 offset:14336
 ds_read_b128 a[124:127], v2 offset:15360
M v[148:151], a[84:87], v[60:63], 0
 buffer_load_dwordx4 v3, s[8:11], s24 offen offset:3072 sc1 lds
M v[148:151], a[80:83], v[44:47], v[148:151]
 s_add_u32 m0, s28, 4096
 v_accvgpr_write_b32 a158, v242
 v_accvgpr_write_b32 a159, v243
M v[156:159], a[88:91], v[44:47], 0
 buffer_load_dwordx4 v4, s[8:11], s24 offen offset:0 sc1 lds
M v[156:159], a[92:95], v[60:63], v[156:159]
 v_cvt_pk_bf16_f32 v244, v244, v245
 v_cvt_pk_bf16_f32 v245, v246, v247
M v[152:155], a[92:95], v[56:59], 0
 v_cvt_pk_bf16_f32 v246, v252, v253
 v_cvt_pk_bf16_f32 v247, v254, v255
M v[152:155], a[88:91], v[40:43], v[152:155]
 s_waitcnt lgkmcnt(0)
 v_accvgpr_write_b32 a188, v244
 v_accvgpr_write_b32 a189, v245
M v[160:163], a[96:99], v[40:43], 0
 ds_read_b128 a[64:67], v2 offset:16384
 ds_read_b128 a[68:71], v2 offset:17408
M v[160:163], a[100:103], v[56:59], v[160:163]
 buffer_load_dwordx4 v4, s[8:11], s24 offen offset:1024 sc1 lds
M v[164:167], a[100:103], v[60:63], 0
 v_accvgpr_write_b32 a190, v246
 v_accvgpr_write_b32 a191, v247
M v[164:167], a[96:99], v[44:47], v[164:167]
 ds_read_b128 a[72:75], v2 offset:18432
 ds_read_b128 a[76:79], v2 offset:19456
M v[172:175], a[104:107], v[44:47], 0
 buffer_load_dwordx4 v4, s[8:11], s24 offen offset:2048 sc1 lds
M v[172:175], a[108:111], v[60:63], v[172:175]
 v_exp_f32 v18, v96
M v[168:171], a[108:111], v[56:59], 0
 ds_read_b128 a[80:83], v2 offset:20480
 ds_read_b128 a[84:87], v2 offset:21504
M v[168:171], a[104:107], v[40:43], v[168:171]
 buffer_load_dwordx4 v4, s[8:11], s24 offen offset:3072 sc1 lds
M v[176:179], a[112:115], v[40:43], 0
 v_exp_f32 v19, v97
M v[176:179], a[116:119], v[56:59], v[176:179]
 s_add_u32 m0, s28, 32768
 ds_read_b128 a[88:91], v2 offset:22528
 ds_read_b128 a[92:95], v2 offset:23552
M v[180:183], a[116:119], v[60:63], 0
 buffer_load_dwordx4 v3, s[8:11], s21 offen offset:0 sc1 lds
M v[180:183], a[112:115], v[44:47], v[180:183]
 v_exp_f32 v20, v98
M v[188:191], a[120:123], v[44:47], 0
 buffer_load_dwordx4 v3, s[8:11], s21 offen offset:1024 sc1 lds
M v[188:191], a[124:127], v[60:63], v[188:191]
 v_exp_f32 v21, v99
M v[184:187], a[124:127], v[56:59], 0
 buffer_load_dwordx4 v3, s[8:11], s21 offen offset:2048 sc1 lds
M v[184:187], a[120:123], v[40:43], v[184:187]
 s_waitcnt lgkmcnt(0)
 v_exp_f32 v22, v104
M v[192:195], a[64:67], v[40:43], 0
 ds_read_b128 a[96:99], v2 offset:24576
 ds_read_b128 a[100:103], v2 offset:25600
M v[192:195], a[68:71], v[56:59], v[192:195]
 buffer_load_dwordx4 v3, s[8:11], s21 offen offset:3072 sc1 lds
M v[196:199], a[68:71], v[60:63], 0
 v_exp_f32 v23, v105
M v[196:199], a[64:67], v[44:47], v[196:199]
 s_add_u32 m0, s28, 36864
 ds_read_b128 a[104:107], v2 offset:26624
 ds_read_b128 a[108:111], v2 offset:27648
M v[204:207], a[72:75], v[44:47], 0
 buffer_load_dwordx4 v4, s[8:11], s21 offen offset:0 sc1 lds
M v[204:207], a[76:79], v[60:63], v[204:207]
 v_add_f32 v30, v26, v30
 v_add_f32 v31, v27, v31
M v[200:203], a[76:79], v[56:59], 0
 ds_read_b128 a[112:115], v2 offset:28672
 ds_read_b128 a[116:119], v2 offset:29696
M v[200:203], a[72:75], v[40:43], v[200:203]
 buffer_load_dwordx4 v4, s[8:11], s21 offen offset:1024 sc1 lds
M v[208:211], a[80:83], v[40:43], 0
 v_exp_f32 v24, v106
M v[208:211], a[84:87], v[56:59], v[208:211]
 ds_read_b128 a[120:123], v2 offset:30720
 ds_read_b128 a[124:127], v2 offset:31744
M v[212:215], a[84:87], v[60:63], 0
 buffer_load_dwordx4 v4, s[8:11], s21 offen offset:2048 sc1 lds
M v[212:215], a[80:83], v[44:47], v[212:215]
 v_exp_f32 v25, v107
M v[220:223], a[88:91], v[44:47], 0
 v_add_f32 v28, v18, v19
 v_cvt_pk_bf16_f32 v48, v18, v19
M v[220:223], a[92:95], v[60:63], v[220:223]
 buffer_load_dwordx4 v4, s[8:11], s21 offen offset:3072 sc1 lds
M v[216:219], a[92:95], v[56:59], 0
 s_waitcnt vmcnt(16) lgkmcnt(0)
 s_add_u32 s24, s23, 33554432
 s_mov_b32 s23, s21
M v[216:219], a[88:91], v[40:43], v[216:219]
 s_barrier
M v[224:227], a[96:99], v[40:43], 0
 ds_read_b128 a[64:67], v2 offset:32768
 ds_read_b128 a[68:71], v2 offset:33792
M v[224:227], a[100:103], v[56:59], v[224:227]
 s_add_u32 s21, s21, 65536
 v_add_f32 v28, v20, v28
M v[228:231], a[100:103], v[60:63], 0
 s_add_u32 s22, s22, 1
 v_exp_f32 v18, v100
M v[228:231], a[96:99], v[44:47], v[228:231]
 s_cmp_eq_u32 s22, s25
 ds_read_b128 a[72:75], v2 offset:34816
 ds_read_b128 a[76:79], v2 offset:35840
M v[236:239], a[104:107], v[44:47], 0
 s_cselect_b32 s21, s26, s21
 v_exp_f32 v19, v101
M v[236:239], a[108:111], v[60:63], v[236:239]
 s_cmp_eq_u32 s22, s43
 v_cvt_pk_bf16_f32 v49, v20, v21
 v_add_f32 v28, v21, v28
M v[232:235], a[108:111], v[56:59], 0
 s_cselect_b32 s21, s4, s21
 ds_read_b128 a[80:83], v2 offset:36864
 ds_read_b128 a[84:87], v2 offset:37888
M v[232:235], a[104:107], v[40:43], v[232:235]
 s_cmp_eq_u32 s22, s6
 v_exp_f32 v20, v102
M v[240:243], a[112:115], v[40:43], 0
 s_cselect_b32 s21, s7, s21
 v_exp_f32 v21, v103
M v[240:243], a[116:119], v[56:59], v[240:243]
 ds_read_b128 a[88:91], v2 offset:38912
 ds_read_b128 a[92:95], v2 offset:39936
M v[244:247], a[116:119], v[60:63], 0
 v_add_f32 v28, v22, v28
 v_cvt_pk_bf16_f32 v50, v22, v23
M v[244:247], a[112:115], v[44:47], v[244:247]
 v_add_f32 v28, v23, v28
 v_add_f32 v28, v24, v28
M v[252:255], a[120:123], v[44:47], 0
 v_exp_f32 v22, v108
M v[252:255], a[124:127], v[60:63], v[252:255]
 s_cmp_lg_u32 s27, 0
 v_exp_f32 v23, v109
M v[248:251], a[124:127], v[56:59], 0
 s_waitcnt lgkmcnt(0)
 v_cvt_pk_bf16_f32 v51, v24, v25
 v_add_f32 v28, v25, v28
M v[248:251], a[120:123], v[40:43], v[248:251]
 v_exp_f32 v24, v110
 v_add_f32 v29, v18, v19
 v_cvt_pk_bf16_f32 v52, v18, v19
 v_add_f32 v29, v20, v29
 v_cvt_pk_bf16_f32 v53, v20, v21
 v_add_f32 v29, v21, v29
 v_exp_f32 v25, v111
 v_add_f32 v29, v22, v29
 v_cvt_pk_bf16_f32 v54, v22, v23
 v_add_f32 v29, v23, v29
 v_add_f32 v29, v24, v29
 v_cvt_pk_bf16_f32 v55, v24, v25
 v_add_f32 v29, v25, v29
 s_cbranch_scc1 L_loop_top
L_final_h:
 s_waitcnt vmcnt(8)
 s_barrier
 ds_read_b128 a[64:67], v7 offset:0
 ds_read_b128 a[68:71], v7 offset:1024
 ds_read_b128 a[72:75], v7 offset:2048
 ds_read_b128 a[76:79], v7 offset:3072
 ds_read_b128 a[80:83], v7 offset:4096
 ds_read_b128 a[84:87], v7 offset:5120
 ds_read_b128 a[88:91], v7 offset:6144
 ds_read_b128 a[92:95], v7 offset:7168
 s_add_u32 m0, s28, 65536
 v_exp_f32 v18, v112
 buffer_load_dwordx4 v3, s[8:11], s38 offen offset:0 sc1 lds
 v_exp_f32 v19, v113
 v_exp_f32 v20, v114
 v_add_f32 v28, v18, v28
 v_cvt_pk_bf16_f32 v56, v18, v19
 buffer_load_dwordx4 v3, s[8:11], s38 offen offset:1024 sc1 lds
 v_exp_f32 v21, v115
 v_add_f32 v28, v19, v28
 v_exp_f32 v22, v120
 v_add_f32 v28, v20, v28
 v_cvt_pk_bf16_f32 v57, v20, v21
 buffer_load_dwordx4 v3, s[8:11], s38 offen offset:2048 sc1 lds
 v_exp_f32 v23, v121
 v_add_f32 v28, v21, v28
 v_exp_f32 v24, v122
 v_add_f32 v28, v22, v28
 v_cvt_pk_bf16_f32 v58, v22, v23
 buffer_load_dwordx4 v3, s[8:11], s38 offen offset:3072 sc1 lds
 v_exp_f32 v25, v123
 v_add_f32 v28, v23, v28
 v_exp_f32 v18, v116
 v_add_f32 v28, v24, v28
 s_add_u32 m0, s28, 69632
 v_cvt_pk_bf16_f32 v59, v24, v25
 buffer_load_dwordx4 v4, s[8:11], s38 offen offset:0 sc1 lds
 v_exp_f32 v19, v117
 v_add_f32 v28, v25, v28
 v_exp_f32 v20, v118
 v_add_f32 v29, v18, v29
 v_cvt_pk_bf16_f32 v60, v18, v19
 buffer_load_dwordx4 v4, s[8:11], s38 offen offset:1024 sc1 lds
 v_exp_f32 v21, v119
 v_add_f32 v29, v19, v29
 v_exp_f32 v22, v124
 v_add_f32 v29, v20, v29
 v_cvt_pk_bf16_f32 v61, v20, v21
 buffer_load_dwordx4 v4, s[8:11], s38 offen offset:2048 sc1 lds
 v_exp_f32 v23, v125
 v_add_f32 v29, v21, v29
 v_exp_f32 v24, v126
 v_add_f32 v29, v22, v29
 v_cvt_pk_bf16_f32 v62, v22, v23
 buffer_load_dwordx4 v4, s[8:11], s38 offen offset:3072 sc1 lds
 s_add_u32 s38, s38, 65536
 v_exp_f32 v25, v127
 v_add_f32 v29, v23, v29
 v_add_f32 v29, v24, v29
 v_cvt_pk_bf16_f32 v63, v24, v25
 v_add_f32 v29, v25, v29
 v_max_f32 v10, v28, v29
 v_cmp_lt_f32 vcc, s31, v10
 s_nop 0
 s_cbranch_vccnz L_st4
L_rt4:
 v_add_f32 v30, v28, v30
 v_add_f32 v31, v29, v31
 v_mov_b32 v12, v32
 v_mov_b32 v13, v36
 v_mov_b32 v14, v30
 v_mov_b32 v15, v31
 buffer_store_dwordx4 v[12:15], v7, s[8:11], s52 offen sc1
 s_waitcnt lgkmcnt(0)
M v[128:131], a[64:67], v[48:51], v[128:131]
 ds_read_b128 a[96:99], v7 offset:8192
M v[128:131], a[68:71], v[56:59], v[128:131]
 ds_read_b128 a[100:103], v7 offset:9216
M v[132:135], a[68:71], v[60:63], v[132:135]
M v[132:135], a[64:67], v[52:55], v[132:135]
 ds_read_b128 a[104:107], v7 offset:10240
M v[140:143], a[72:75], v[52:55], v[140:143]
 ds_read_b128 a[108:111], v7 offset:11264
M v[140:143], a[76:79], v[60:63], v[140:143]
M v[136:139], a[76:79], v[56:59], v[136:139]
 ds_read_b128 a[112:115], v7 offset:12288
M v[136:139], a[72:75], v[48:51], v[136:139]
 ds_read_b128 a[116:119], v7 offset:13312
M v[144:147], a[80:83], v[48:51], v[144:147]
M v[144:147], a[84:87], v[56:59], v[144:147]
 ds_read_b128 a[120:123], v7 offset:14336
M v[148:151], a[84:87], v[60:63], v[148:151]
 ds_read_b128 a[124:127], v7 offset:15360
M v[148:151], a[80:83], v[52:55], v[148:151]
 v_cvt_pk_bf16_f32 v128, v128, v129
 v_cvt_pk_bf16_f32 v129, v130, v131
M v[156:159], a[88:91], v[52:55], v[156:159]
 v_cvt_pk_bf16_f32 v130, v136, v137
 v_cvt_pk_bf16_f32 v131, v138, v139
M v[156:159], a[92:95], v[60:63], v[156:159]
 buffer_store_dwordx4 v[128:131], v7, s[8:11], s12 offen offset:0 sc1
M v[152:155], a[92:95], v[56:59], v[152:155]
 v_cvt_pk_bf16_f32 v132, v132, v133
 v_cvt_pk_bf16_f32 v133, v134, v135
M v[152:155], a[88:91], v[48:51], v[152:155]
 s_waitcnt lgkmcnt(0)
 v_cvt_pk_bf16_f32 v134, v140, v141
 v_cvt_pk_bf16_f32 v135, v142, v143
M v[160:163], a[96:99], v[48:51], v[160:163]
 ds_read_b128 a[64:67], v7 offset:16384
M v[160:163], a[100:103], v[56:59], v[160:163]
 ds_read_b128 a[68:71], v7 offset:17408
M v[164:167], a[100:103], v[60:63], v[164:167]
 buffer_store_dwordx4 v[132:135], v7, s[8:11], s14 offen offset:0 sc1
M v[164:167], a[96:99], v[52:55], v[164:167]
 ds_read_b128 a[72:75], v7 offset:18432
 v_cvt_pk_bf16_f32 v144, v144, v145
M v[172:175], a[104:107], v[52:55], v[172:175]
 ds_read_b128 a[76:79], v7 offset:19456
 v_cvt_pk_bf16_f32 v145, v146, v147
M v[172:175], a[108:111], v[60:63], v[172:175]
 v_cvt_pk_bf16_f32 v146, v152, v153
 v_cvt_pk_bf16_f32 v147, v154, v155
M v[168:171], a[108:111], v[56:59], v[168:171]
 ds_read_b128 a[80:83], v7 offset:20480
M v[168:171], a[104:107], v[48:51], v[168:171]
 ds_read_b128 a[84:87], v7 offset:21504
M v[176:179], a[112:115], v[48:51], v[176:179]
 buffer_store_dwordx4 v[144:147], v7, s[8:11], s12 offen offset:1024 sc1
M v[176:179], a[116:119], v[56:59], v[176:179]
 ds_read_b128 a[88:91], v7 offset:22528
 v_cvt_pk_bf16_f32 v148, v148, v149
M v[180:183], a[116:119], v[60:63], v[180:183]
 ds_read_b128 a[92:95], v7 offset:23552
 v_cvt_pk_bf16_f32 v149, v150, v151
M v[180:183], a[112:115], v[52:55], v[180:183]
 v_cvt_pk_bf16_f32 v150, v156, v157
 v_cvt_pk_bf16_f32 v151, v158, v159
M v[188:191], a[120:123], v[52:55], v[188:191]
 buffer_store_dwordx4 v[148:151], v7, s[8:11], s14 offen offset:1024 sc1
M v[188:191], a[124:127], v[60:63], v[188:191]
 v_cvt_pk_bf16_f32 v160, v160, v161
 v_cvt_pk_bf16_f32 v161, v162, v163
M v[184:187], a[124:127], v[56:59], v[184:187]
 v_cvt_pk_bf16_f32 v162, v168, v169
 v_cvt_pk_bf16_f32 v163, v170, v171
M v[184:187], a[120:123], v[48:51], v[184:187]
 s_waitcnt lgkmcnt(0)
M v[192:195], a[64:67], v[48:51], v[192:195]
 ds_read_b128 a[96:99], v7 offset:24576
M v[192:195], a[68:71], v[56:59], v[192:195]
 ds_read_b128 a[100:103], v7 offset:25600
M v[196:199], a[68:71], v[60:63], v[196:199]
 buffer_store_dwordx4 v[160:163], v7, s[8:11], s12 offen offset:2048 sc1
M v[196:199], a[64:67], v[52:55], v[196:199]
 ds_read_b128 a[104:107], v7 offset:26624
 v_cvt_pk_bf16_f32 v164, v164, v165
M v[204:207], a[72:75], v[52:55], v[204:207]
 ds_read_b128 a[108:111], v7 offset:27648
 v_cvt_pk_bf16_f32 v165, v166, v167
M v[204:207], a[76:79], v[60:63], v[204:207]
 v_cvt_pk_bf16_f32 v166, v172, v173
 v_cvt_pk_bf16_f32 v167, v174, v175
M v[200:203], a[76:79], v[56:59], v[200:203]
 ds_read_b128 a[112:115], v7 offset:28672
M v[200:203], a[72:75], v[48:51], v[200:203]
 ds_read_b128 a[116:119], v7 offset:29696
M v[208:211], a[80:83], v[48:51], v[208:211]
 buffer_store_dwordx4 v[164:167], v7, s[8:11], s14 offen offset:2048 sc1
M v[208:211], a[84:87], v[56:59], v[208:211]
 ds_read_b128 a[120:123], v7 offset:30720
 v_cvt_pk_bf16_f32 v176, v176, v177
M v[212:215], a[84:87], v[60:63], v[212:215]
 ds_read_b128 a[124:127], v7 offset:31744
 v_cvt_pk_bf16_f32 v177, v178, v179
M v[212:215], a[80:83], v[52:55], v[212:215]
 v_cvt_pk_bf16_f32 v178, v184, v185
 v_cvt_pk_bf16_f32 v179, v186, v187
M v[220:223], a[88:91], v[52:55], v[220:223]
 buffer_store_dwordx4 v[176:179], v7, s[8:11], s12 offen offset:3072 sc1
M v[220:223], a[92:95], v[60:63], v[220:223]
 v_cvt_pk_bf16_f32 v180, v180, v181
 v_cvt_pk_bf16_f32 v181, v182, v183
M v[216:219], a[92:95], v[56:59], v[216:219]
 s_waitcnt lgkmcnt(0)
 v_cvt_pk_bf16_f32 v182, v188, v189
 v_cvt_pk_bf16_f32 v183, v190, v191
M v[216:219], a[88:91], v[48:51], v[216:219]
 s_barrier
M v[224:227], a[96:99], v[48:51], v[224:227]
 ds_read_b128 a[64:67], v2 offset:32768
M v[224:227], a[100:103], v[56:59], v[224:227]
 ds_read_b128 a[68:71], v2 offset:33792
M v[228:231], a[100:103], v[60:63], v[228:231]
 buffer_store_dwordx4 v[180:183], v7, s[8:11], s14 offen offset:3072 sc1
M v[228:231], a[96:99], v[52:55], v[228:231]
 ds_read_b128 a[72:75], v2 offset:34816
 v_cvt_pk_bf16_f32 v192, v192, v193
M v[236:239], a[104:107], v[52:55], v[236:239]
 ds_read_b128 a[76:79], v2 offset:35840
 v_cvt_pk_bf16_f32 v193, v194, v195
M v[236:239], a[108:111], v[60:63], v[236:239]
 v_cvt_pk_bf16_f32 v194, v200, v201
 v_cvt_pk_bf16_f32 v195, v202, v203
M v[232:235], a[108:111], v[56:59], v[232:235]
 ds_read_b128 a[80:83], v2 offset:36864
M v[232:235], a[104:107], v[48:51], v[232:235]
 ds_read_b128 a[84:87], v2 offset:37888
M v[240:243], a[112:115], v[48:51], v[240:243]
 buffer_store_dwordx4 v[192:195], v7, s[8:11], s13 offen offset:0 sc1
M v[240:243], a[116:119], v[56:59], v[240:243]
 ds_read_b128 a[88:91], v2 offset:38912
 v_cvt_pk_bf16_f32 v196, v196, v197
M v[244:247], a[116:119], v[60:63], v[244:247]
 ds_read_b128 a[92:95], v2 offset:39936
 v_cvt_pk_bf16_f32 v197, v198, v199
M v[244:247], a[112:115], v[52:55], v[244:247]
 v_cvt_pk_bf16_f32 v198, v204, v205
 v_cvt_pk_bf16_f32 v199, v206, v207
M v[252:255], a[120:123], v[52:55], v[252:255]
 buffer_store_dwordx4 v[196:199], v7, s[8:11], s15 offen offset:0 sc1
M v[252:255], a[124:127], v[60:63], v[252:255]
 v_cvt_pk_bf16_f32 v208, v208, v209
 v_cvt_pk_bf16_f32 v209, v210, v211
M v[248:251], a[124:127], v[56:59], v[248:251]
 s_waitcnt lgkmcnt(0)
 v_cvt_pk_bf16_f32 v210, v216, v217
 v_cvt_pk_bf16_f32 v211, v218, v219
M v[248:251], a[120:123], v[48:51], v[248:251]
 buffer_store_dwordx4 v[208:211], v7, s[8:11], s13 offen offset:1024 sc1
 v_cvt_pk_bf16_f32 v212, v212, v213
 v_cvt_pk_bf16_f32 v213, v214, v215
 v_cvt_pk_bf16_f32 v214, v220, v221
 v_cvt_pk_bf16_f32 v215, v222, v223
 buffer_store_dwordx4 v[212:215], v7, s[8:11], s15 offen offset:1024 sc1
 v_cvt_pk_bf16_f32 v224, v224, v225
 v_cvt_pk_bf16_f32 v225, v226, v227
 v_cvt_pk_bf16_f32 v226, v232, v233
 v_cvt_pk_bf16_f32 v227, v234, v235
 buffer_store_dwordx4 v[224:227], v7, s[8:11], s13 offen offset:2048 sc1
 v_cvt_pk_bf16_f32 v228, v228, v229
 v_cvt_pk_bf16_f32 v229, v230, v231
 v_cvt_pk_bf16_f32 v230, v236, v237
 v_cvt_pk_bf16_f32 v231, v238, v239
 buffer_store_dwordx4 v[228:231], v7, s[8:11], s15 offen offset:2048 sc1
 v_cvt_pk_bf16_f32 v240, v240, v241
 v_cvt_pk_bf16_f32 v241, v242, v243
 v_cvt_pk_bf16_f32 v242, v248, v249
 v_cvt_pk_bf16_f32 v243, v250, v251
 buffer_store_dwordx4 v[240:243], v7, s[8:11], s13 offen offset:3072 sc1
 v_cvt_pk_bf16_f32 v244, v244, v245
 v_cvt_pk_bf16_f32 v245, v246, v247
 v_cvt_pk_bf16_f32 v246, v252, v253
 v_cvt_pk_bf16_f32 v247, v254, v255
 buffer_store_dwordx4 v[244:247], v7, s[8:11], s15 offen offset:3072 sc1
M v[64:67], a[64:67], a[128:131], 0
 ds_read_b128 a[96:99], v2 offset:40960
M v[64:67], a[68:71], a[132:135], v[64:67]
 s_add_u32 m0, s28, 0
 ds_read_b128 a[100:103], v2 offset:41984
M v[64:67], a[72:75], a[136:139], v[64:67]
 buffer_load_dwordx4 v3, s[8:11], s38 offen offset:0 sc1 lds
M v[64:67], a[76:79], a[140:143], v[64:67]
 ds_read_b128 a[104:107], v2 offset:43008
 v_accvgpr_read_b32 v5, a192
M v[64:67], a[80:83], a[144:147], v[64:67]
 ds_read_b128 a[108:111], v2 offset:44032
 v_accvgpr_read_b32 v6, a193
M v[64:67], a[84:87], a[148:151], v[64:67]
 buffer_load_dwordx4 v3, s[8:11], s38 offen offset:1024 sc1 lds
M v[64:67], a[88:91], a[152:155], v[64:67]
 ds_read_b128 a[112:115], v2 offset:45056
M v[64:67], a[92:95], a[156:159], v[64:67]
 ds_read_b128 a[116:119], v2 offset:46080
M v[68:71], a[92:95], a[188:191], 0
 buffer_load_dwordx4 v3, s[8:11], s38 offen offset:2048 sc1 lds
M v[68:71], a[88:91], a[184:187], v[68:71]
 ds_read_b128 a[120:123], v2 offset:47104
M v[68:71], a[84:87], a[180:183], v[68:71]
 ds_read_b128 a[124:127], v2 offset:48128
M v[68:71], a[80:83], a[176:179], v[68:71]
M v[68:71], a[76:79], a[172:175], v[68:71]
 buffer_load_dwordx4 v3, s[8:11], s38 offen offset:3072 sc1 lds
M v[68:71], a[72:75], a[168:171], v[68:71]
M v[68:71], a[68:71], a[164:167], v[68:71]
M v[68:71], a[64:67], a[160:163], v[68:71]
 s_waitcnt lgkmcnt(0)
M v[76:79], a[96:99], a[160:163], 0
 ds_read_b128 a[64:67], v2 offset:49152
M v[76:79], a[100:103], a[164:167], v[76:79]
 s_add_u32 m0, s28, 4096
 ds_read_b128 a[68:71], v2 offset:50176
M v[76:79], a[104:107], a[168:171], v[76:79]
 buffer_load_dwordx4 v4, s[8:11], s38 offen offset:0 sc1 lds
M v[76:79], a[108:111], a[172:175], v[76:79]
 ds_read_b128 a[72:75], v2 offset:51200
M v[76:79], a[112:115], a[176:179], v[76:79]
 s_xor_b32 s47, s47, 64
 ds_read_b128 a[76:79], v2 offset:52224
M v[76:79], a[116:119], a[180:183], v[76:79]
 v_mov_b32 v18, 1
 v_min_u32 v19, 1, v7
M v[76:79], a[120:123], a[184:187], v[76:79]
 ds_read_b128 a[80:83], v2 offset:53248
 v_lshlrev_b32 v19, 29, v19
M v[76:79], a[124:127], a[188:191], v[76:79]
 s_waitcnt vmcnt(5)
 ds_read_b128 a[84:87], v2 offset:54272
M v[72:75], a[124:127], a[156:159], 0
 buffer_store_dword v18, v19, s[8:11], s47 offen sc1
M v[72:75], a[120:123], a[152:155], v[72:75]
 ds_read_b128 a[88:91], v2 offset:55296
M v[72:75], a[116:119], a[148:151], v[72:75]
 ds_read_b128 a[92:95], v2 offset:56320
M v[72:75], a[112:115], a[144:147], v[72:75]
 buffer_load_dwordx4 v4, s[8:11], s38 offen offset:1024 sc1 lds
M v[72:75], a[108:111], a[140:143], v[72:75]
M v[72:75], a[104:107], a[136:139], v[72:75]
 buffer_load_dwordx4 v4, s[8:11], s38 offen offset:2048 sc1 lds
M v[72:75], a[100:103], a[132:135], v[72:75]
 s_lshl_b32 s64, s20, 1
 s_lshr_b32 s64, s101, s64
M v[72:75], a[96:99], a[128:131], v[72:75]
 s_waitcnt lgkmcnt(0)
 s_lshr_b32 s93, s64, 1
M v[80:83], a[64:67], a[128:131], 0
 s_xor_b32 s64, s64, s93
 ds_read_b128 a[96:99], v2 offset:57344
M v[80:83], a[68:71], a[132:135], v[80:83]
 s_and_b32 s64, s64, 1
 ds_read_b128 a[100:103], v2 offset:58368
 s_lshl_b32 s64, s64, 13
M v[80:83], a[72:75], a[136:139], v[80:83]
 buffer_load_dwordx4 v4, s[8:11], s38 offen offset:3072 sc1 lds
M v[80:83], a[76:79], a[140:143], v[80:83]
 s_add_u32 s38, s38, 65536
 ds_read_b128 a[104:107], v2 offset:59392
 s_xor_b32 s93, s33, s64
M v[80:83], a[80:83], a[144:147], v[80:83]
 s_add_u32 m0, s28, 131072
 ds_read_b128 a[108:111], v2 offset:60416
 s_add_u32 s93, s93, 32768
M v[80:83], a[84:87], a[148:151], v[80:83]
 buffer_load_dwordx4 v3, s[8:11], s38 offen offset:0 sc1 lds
M v[80:83], a[88:91], a[152:155], v[80:83]
 ds_read_b128 a[112:115], v2 offset:61440
M v[80:83], a[92:95], a[156:159], v[80:83]
 ds_read_b128 a[116:119], v2 offset:62464
 v_max3_f32 v32, |v64|, |v65|, |v66|
M v[84:87], a[92:95], a[188:191], 0
 buffer_load_dwordx4 v3, s[8:11], s38 offen offset:1024 sc1 lds
M v[84:87], a[88:91], a[184:187], v[84:87]
 ds_read_b128 a[120:123], v2 offset:63488
 v_max3_f32 v32, |v67|, |v72|, v32
M v[84:87], a[84:87], a[180:183], v[84:87]
 ds_read_b128 a[124:127], v2 offset:64512
M v[84:87], a[80:83], a[176:179], v[84:87]
 buffer_load_dwordx4 v3, s[8:11], s38 offen offset:2048 sc1 lds
M v[84:87], a[76:79], a[172:175], v[84:87]
 v_max3_f32 v32, |v73|, |v74|, v32
 v_mul_f32 v32, 2.0, v32
M v[84:87], a[72:75], a[168:171], v[84:87]
 buffer_load_dwordx4 v3, s[8:11], s38 offen offset:3072 sc1 lds
M v[84:87], a[68:71], a[164:167], v[84:87]
 s_waitcnt lgkmcnt(0)
 v_mov_b32 v33, v32
 v_mov_b32 v34, v32
M v[84:87], a[64:67], a[160:163], v[84:87]
 s_barrier
M v[92:95], a[96:99], a[160:163], 0
 ds_read_b128 a[64:67], v7 offset:32768
M v[92:95], a[100:103], a[164:167], v[92:95]
 s_add_u32 m0, s28, 135168
 ds_read_b128 a[68:71], v7 offset:33792
 v_mov_b32 v35, v32
M v[92:95], a[104:107], a[168:171], v[92:95]
 buffer_load_dwordx4 v4, s[8:11], s38 offen offset:0 sc1 lds
M v[92:95], a[108:111], a[172:175], v[92:95]
 ds_read_b128 a[72:75], v7 offset:34816
M v[92:95], a[112:115], a[176:179], v[92:95]
 ds_read_b128 a[76:79], v7 offset:35840
 v_max3_f32 v36, |v68|, |v69|, |v70|
M v[92:95], a[116:119], a[180:183], v[92:95]
 buffer_load_dwordx4 v4, s[8:11], s38 offen offset:1024 sc1 lds
M v[92:95], a[120:123], a[184:187], v[92:95]
 ds_read_b128 a[80:83], v7 offset:36864
 v_max3_f32 v36, |v71|, |v76|, v36
M v[92:95], a[124:127], a[188:191], v[92:95]
 ds_read_b128 a[84:87], v7 offset:37888
M v[88:91], a[124:127], a[156:159], 0
 buffer_load_dwordx4 v4, s[8:11], s38 offen offset:2048 sc1 lds
M v[88:91], a[120:123], a[152:155], v[88:91]
 ds_read_b128 a[88:91], v7 offset:38912
 v_max3_f32 v36, |v77|, |v78|, v36
M v[88:91], a[116:119], a[148:151], v[88:91]
 ds_read_b128 a[92:95], v7 offset:39936
 v_mul_f32 v36, 2.0, v36
M v[88:91], a[112:115], a[144:147], v[88:91]
 buffer_load_dwordx4 v4, s[8:11], s38 offen offset:3072 sc1 lds
M v[88:91], a[108:111], a[140:143], v[88:91]
 s_add_u32 s38, s38, 65536
 v_mov_b32 v37, v36
M v[88:91], a[104:107], a[136:139], v[88:91]
 v_mov_b32 v38, v36
 v_mov_b32 v39, v36
M v[88:91], a[100:103], a[132:135], v[88:91]
 s_waitcnt lgkmcnt(0)
M v[88:91], a[96:99], a[128:131], v[88:91]
M v[96:99], a[64:67], a[128:131], v[32:35]
 s_add_u32 m0, s28, 98304
 ds_read_b128 a[96:99], v7 offset:40960
M v[96:99], a[68:71], a[132:135], v[96:99]
 ds_read_b128 a[100:103], v7 offset:41984
M v[96:99], a[72:75], a[136:139], v[96:99]
 buffer_load_dwordx4 v3, s[8:11], s38 offen offset:0 sc1 lds
M v[96:99], a[76:79], a[140:143], v[96:99]
 ds_read_b128 a[104:107], v7 offset:43008
 s_add_u32 s29, s33, 0
M v[96:99], a[80:83], a[144:147], v[96:99]
 ds_read_b128 a[108:111], v7 offset:44032
 s_add_u32 s30, s93, 0
M v[96:99], a[84:87], a[148:151], v[96:99]
 buffer_load_dwordx4 v3, s[8:11], s38 offen offset:1024 sc1 lds
M v[96:99], a[88:91], a[152:155], v[96:99]
 ds_read_b128 a[112:115], v7 offset:45056
 v_mul_f32 v28, -v32, v5
M v[96:99], a[92:95], a[156:159], v[96:99]
 ds_read_b128 a[116:119], v7 offset:46080
 v_mul_f32 v64, v5, v64
M v[100:103], a[92:95], a[188:191], v[36:39]
 buffer_load_dwordx4 v3, s[8:11], s38 offen offset:2048 sc1 lds
M v[100:103], a[88:91], a[184:187], v[100:103]
 ds_read_b128 a[120:123], v7 offset:47104
 v_mul_f32 v65, v5, v65
M v[100:103], a[84:87], a[180:183], v[100:103]
 ds_read_b128 a[124:127], v7 offset:48128
 v_mul_f32 v66, v5, v66
M v[100:103], a[80:83], a[176:179], v[100:103]
 buffer_load_dwordx4 v3, s[8:11], s38 offen offset:3072 sc1 lds
M v[100:103], a[76:79], a[172:175], v[100:103]
 s_add_u32 m0, s28, 102400
 v_mul_f32 v67, v5, v67
 v_mul_f32 v72, v5, v72
M v[100:103], a[72:75], a[168:171], v[100:103]
 buffer_load_dwordx4 v4, s[8:11], s38 offen offset:0 sc1 lds
M v[100:103], a[68:71], a[164:167], v[100:103]
 v_mul_f32 v73, v5, v73
 v_mul_f32 v74, v5, v74
M v[100:103], a[64:67], a[160:163], v[100:103]
 s_waitcnt lgkmcnt(0)
 v_mul_f32 v75, v5, v75
 v_cvt_pk_bf16_f32 v64, v64, v65
M v[108:111], a[96:99], a[160:163], v[36:39]
 ds_read_b128 a[64:67], v7 offset:49152
 v_cvt_pk_bf16_f32 v65, v66, v67
M v[108:111], a[100:103], a[164:167], v[108:111]
 ds_read_b128 a[68:71], v7 offset:50176
 v_cvt_pk_bf16_f32 v66, v72, v73
M v[108:111], a[104:107], a[168:171], v[108:111]
 buffer_load_dwordx4 v4, s[8:11], s38 offen offset:1024 sc1 lds
M v[108:111], a[108:111], a[172:175], v[108:111]
 ds_read_b128 a[72:75], v7 offset:51200
 v_cvt_pk_bf16_f32 v67, v74, v75
M v[108:111], a[112:115], a[176:179], v[108:111]
 ds_read_b128 a[76:79], v7 offset:52224
M v[108:111], a[116:119], a[180:183], v[108:111]
 buffer_load_dwordx4 v4, s[8:11], s38 offen offset:2048 sc1 lds
M v[108:111], a[120:123], a[184:187], v[108:111]
 ds_read_b128 a[80:83], v7 offset:53248
M v[108:111], a[124:127], a[188:191], v[108:111]
 ds_read_b128 a[84:87], v7 offset:54272
M v[104:107], a[124:127], a[156:159], v[32:35]
 buffer_load_dwordx4 v4, s[8:11], s38 offen offset:3072 sc1 lds
M v[104:107], a[120:123], a[152:155], v[104:107]
 s_add_u32 s38, s38, 65536
 ds_read_b128 a[88:91], v7 offset:55296
M v[104:107], a[116:119], a[148:151], v[104:107]
 ds_read_b128 a[92:95], v7 offset:56320
M v[104:107], a[112:115], a[144:147], v[104:107]
 buffer_store_dwordx4 v[64:67], v7, s[8:11], s29 offen offset:0 sc1
M v[104:107], a[108:111], a[140:143], v[104:107]
 v_mul_f32 v29, -v36, v6
 v_mul_f32 v68, v6, v68
M v[104:107], a[104:107], a[136:139], v[104:107]
 v_mul_f32 v69, v6, v69
 v_mul_f32 v70, v6, v70
M v[104:107], a[100:103], a[132:135], v[104:107]
 v_mul_f32 v71, v6, v71
 v_mul_f32 v76, v6, v76
M v[104:107], a[96:99], a[128:131], v[104:107]
 s_waitcnt lgkmcnt(0)
 v_mul_f32 v77, v6, v77
 v_mul_f32 v78, v6, v78
M v[112:115], a[64:67], a[128:131], v[32:35]
 ds_read_b128 a[96:99], v7 offset:57344
 v_mul_f32 v79, v6, v79
M v[112:115], a[68:71], a[132:135], v[112:115]
 ds_read_b128 a[100:103], v7 offset:58368
 v_cvt_pk_bf16_f32 v68, v68, v69
M v[112:115], a[72:75], a[136:139], v[112:115]
 v_cvt_pk_bf16_f32 v69, v70, v71
 v_cvt_pk_bf16_f32 v70, v76, v77
M v[112:115], a[76:79], a[140:143], v[112:115]
 ds_read_b128 a[104:107], v7 offset:59392
 v_cvt_pk_bf16_f32 v71, v78, v79
M v[112:115], a[80:83], a[144:147], v[112:115]
 ds_read_b128 a[108:111], v7 offset:60416
M v[112:115], a[84:87], a[148:151], v[112:115]
 buffer_store_dwordx4 v[68:71], v7, s[8:11], s30 offen offset:0 sc1
M v[112:115], a[88:91], a[152:155], v[112:115]
 ds_read_b128 a[112:115], v7 offset:61440
 v_mul_f32 v80, v5, v80
M v[112:115], a[92:95], a[156:159], v[112:115]
 ds_read_b128 a[116:119], v7 offset:62464
 v_mul_f32 v81, v5, v81
M v[116:119], a[92:95], a[188:191], v[36:39]
 v_mul_f32 v82, v5, v82
 v_mul_f32 v83, v5, v83
M v[116:119], a[88:91], a[184:187], v[116:119]
 ds_read_b128 a[120:123], v7 offset:63488
 v_mul_f32 v88, v5, v88
M v[116:119], a[84:87], a[180:183], v[116:119]
 ds_read_b128 a[124:127], v7 offset:64512
 v_mul_f32 v89, v5, v89
M v[116:119], a[80:83], a[176:179], v[116:119]
 v_mul_f32 v90, v5, v90
 v_mul_f32 v91, v5, v91
M v[116:119], a[76:79], a[172:175], v[116:119]
 v_cvt_pk_bf16_f32 v80, v80, v81
 v_cvt_pk_bf16_f32 v81, v82, v83
M v[116:119], a[72:75], a[168:171], v[116:119]
 v_cvt_pk_bf16_f32 v82, v88, v89
 v_cvt_pk_bf16_f32 v83, v90, v91
M v[116:119], a[68:71], a[164:167], v[116:119]
 s_waitcnt lgkmcnt(0)
M v[116:119], a[64:67], a[160:163], v[116:119]
 s_barrier
M v[124:127], a[96:99], a[160:163], v[36:39]
 ds_read_b128 a[64:67], v2 offset:0
M v[124:127], a[100:103], a[164:167], v[124:127]
 ds_read_b128 a[68:71], v2 offset:1024
M v[124:127], a[104:107], a[168:171], v[124:127]
 buffer_store_dwordx4 v[80:83], v7, s[8:11], s29 offen offset:1024 sc1
M v[124:127], a[108:111], a[172:175], v[124:127]
 ds_read_b128 a[72:75], v2 offset:2048
 v_mul_f32 v84, v6, v84
M v[124:127], a[112:115], a[176:179], v[124:127]
 ds_read_b128 a[76:79], v2 offset:3072
 v_mul_f32 v85, v6, v85
M v[124:127], a[116:119], a[180:183], v[124:127]
 v_mul_f32 v86, v6, v86
 v_mul_f32 v87, v6, v87
M v[124:127], a[120:123], a[184:187], v[124:127]
 ds_read_b128 a[80:83], v2 offset:4096
 v_mul_f32 v92, v6, v92
M v[124:127], a[124:127], a[188:191], v[124:127]
 ds_read_b128 a[84:87], v2 offset:5120
 v_mul_f32 v93, v6, v93
M v[120:123], a[124:127], a[156:159], v[32:35]
 v_mul_f32 v94, v6, v94
 v_mul_f32 v95, v6, v95
M v[120:123], a[120:123], a[152:155], v[120:123]
 ds_read_b128 a[88:91], v2 offset:6144
 v_cvt_pk_bf16_f32 v84, v84, v85
M v[120:123], a[116:119], a[148:151], v[120:123]
 ds_read_b128 a[92:95], v2 offset:7168
 v_cvt_pk_bf16_f32 v85, v86, v87
M v[120:123], a[112:115], a[144:147], v[120:123]
 v_cvt_pk_bf16_f32 v86, v92, v93
 v_cvt_pk_bf16_f32 v87, v94, v95
M v[120:123], a[108:111], a[140:143], v[120:123]
 buffer_store_dwordx4 v[84:87], v7, s[8:11], s30 offen offset:1024 sc1
M v[120:123], a[104:107], a[136:139], v[120:123]
M v[120:123], a[100:103], a[132:135], v[120:123]
 s_waitcnt lgkmcnt(0)
M v[120:123], a[96:99], a[128:131], v[120:123]
M v[64:67], a[64:67], a[128:131], v[32:35]
 s_add_u32 m0, s28, 32768
 ds_read_b128 a[96:99], v2 offset:8192
M v[64:67], a[68:71], a[132:135], v[64:67]
 ds_read_b128 a[100:103], v2 offset:9216
 s_and_b32 s79, s101, 1
M v[64:67], a[72:75], a[136:139], v[64:67]
 buffer_load_dwordx4 v3, s[8:11], s38 offen offset:0 sc1 lds
M v[64:67], a[76:79], a[140:143], v[64:67]
 ds_read_b128 a[104:107], v2 offset:10240
 s_lshl_b32 s79, s79, 13
M v[64:67], a[80:83], a[144:147], v[64:67]
 s_add_u32 s79, s79, 234946560
 ds_read_b128 a[108:111], v2 offset:11264
 s_add_u32 s29, s33, 2048
M v[64:67], a[84:87], a[148:151], v[64:67]
 buffer_load_dwordx4 v3, s[8:11], s38 offen offset:1024 sc1 lds
M v[64:67], a[88:91], a[152:155], v[64:67]
 ds_read_b128 a[112:115], v2 offset:12288
 s_add_u32 s30, s93, 2048
M v[64:67], a[92:95], a[156:159], v[64:67]
 ds_read_b128 a[116:119], v2 offset:13312
 v_fma_f32 v96, v96, v5, v28
M v[68:71], a[92:95], a[188:191], v[36:39]
 buffer_load_dwordx4 v3, s[8:11], s38 offen offset:2048 sc1 lds
M v[68:71], a[88:91], a[184:187], v[68:71]
 ds_read_b128 a[120:123], v2 offset:14336
 v_fma_f32 v97, v97, v5, v28
M v[68:71], a[84:87], a[180:183], v[68:71]
 ds_read_b128 a[124:127], v2 offset:15360
 v_fma_f32 v98, v98, v5, v28
M v[68:71], a[80:83], a[176:179], v[68:71]
 buffer_load_dwordx4 v3, s[8:11], s38 offen offset:3072 sc1 lds
M v[68:71], a[76:79], a[172:175], v[68:71]
 s_add_u32 m0, s28, 36864
 v_fma_f32 v99, v99, v5, v28
 v_fma_f32 v104, v104, v5, v28
M v[68:71], a[72:75], a[168:171], v[68:71]
 buffer_load_dwordx4 v4, s[8:11], s38 offen offset:0 sc1 lds
M v[68:71], a[68:71], a[164:167], v[68:71]
 buffer_load_dword v24, off, s[8:11], s79 sc1
M v[68:71], a[64:67], a[160:163], v[68:71]
 s_waitcnt lgkmcnt(0)
 v_lshrrev_b32 v0, 4, v7
 v_and_b32 v14, 15, v0
M v[76:79], a[96:99], a[160:163], v[36:39]
 ds_read_b128 a[64:67], v2 offset:16384
 v_lshlrev_b32 v14, 2, v14
M v[76:79], a[100:103], a[164:167], v[76:79]
 ds_read_b128 a[68:71], v2 offset:17408
 v_lshrrev_b32 v11, 4, v0
M v[76:79], a[104:107], a[168:171], v[76:79]
 buffer_load_dwordx4 v4, s[8:11], s38 offen offset:1024 sc1 lds
M v[76:79], a[108:111], a[172:175], v[76:79]
 ds_read_b128 a[72:75], v2 offset:18432
 s_mov_b32 s52, s96
M v[76:79], a[112:115], a[176:179], v[76:79]
 s_and_b32 s53, s97, 0xffff
 ds_read_b128 a[76:79], v2 offset:19456
 s_mov_b32 s54, 1835008
M v[76:79], a[116:119], a[180:183], v[76:79]
 buffer_load_dwordx4 v4, s[8:11], s38 offen offset:2048 sc1 lds
M v[76:79], a[120:123], a[184:187], v[76:79]
 ds_read_b128 a[80:83], v2 offset:20480
 s_mov_b32 s55, 0x20000
M v[76:79], a[124:127], a[188:191], v[76:79]
 s_lshr_b32 s74, s41, 3
 ds_read_b128 a[84:87], v2 offset:21504
 s_xor_b32 s74, s74, 0
M v[72:75], a[124:127], a[156:159], v[32:35]
 buffer_load_dwordx4 v4, s[8:11], s38 offen offset:3072 sc1 lds
M v[72:75], a[120:123], a[152:155], v[72:75]
 s_add_u32 s38, s38, 65536
 ds_read_b128 a[88:91], v2 offset:22528
 s_mul_i32 s67, s74, -2
M v[72:75], a[116:119], a[148:151], v[72:75]
 s_mul_i32 s74, s74, 8
 ds_read_b128 a[92:95], v2 offset:23552
 v_fma_f32 v105, v105, v5, v28
M v[72:75], a[112:115], a[144:147], v[72:75]
 s_add_u32 s74, s74, s20
 v_fma_f32 v106, v106, v5, v28
 v_fma_f32 v107, v107, v5, v28
M v[72:75], a[108:111], a[140:143], v[72:75]
 s_lshl_b32 s75, s74, 6
 v_cvt_pk_bf16_f32 v96, v96, v97
 v_cvt_pk_bf16_f32 v97, v98, v99
M v[72:75], a[104:107], a[136:139], v[72:75]
 s_add_u32 s76, s75, 256
 v_cvt_pk_bf16_f32 v98, v104, v105
 v_cvt_pk_bf16_f32 v99, v106, v107
M v[72:75], a[100:103], a[132:135], v[72:75]
 s_add_u32 s67, s67, 3
 v_add_u32 v43, 0x20000, v7
 s_sub_u32 s67, s67, s20
M v[72:75], a[96:99], a[128:131], v[72:75]
 s_waitcnt lgkmcnt(0)
 s_and_b32 s67, s67, 536870912
M v[80:83], a[64:67], a[128:131], v[32:35]
 s_or_b32 s76, s76, s67
 ds_read_b128 a[96:99], v2 offset:24576
 v_or_b32 v27, s67, v7
M v[80:83], a[68:71], a[132:135], v[80:83]
 ds_read_b128 a[100:103], v2 offset:25600
 v_add_u32 v27, 4096, v27
M v[80:83], a[72:75], a[136:139], v[80:83]
 buffer_store_dwordx4 v[96:99], v7, s[8:11], s29 offen offset:0 sc1
M v[80:83], a[76:79], a[140:143], v[80:83]
 ds_read_b128 a[104:107], v2 offset:26624
 v_fma_f32 v100, v100, v6, v29
M v[80:83], a[80:83], a[144:147], v[80:83]
 ds_read_b128 a[108:111], v2 offset:27648
 v_fma_f32 v101, v101, v6, v29
M v[80:83], a[84:87], a[148:151], v[80:83]
 v_fma_f32 v102, v102, v6, v29
 v_fma_f32 v103, v103, v6, v29
M v[80:83], a[88:91], a[152:155], v[80:83]
 ds_read_b128 a[112:115], v2 offset:28672
 v_fma_f32 v108, v108, v6, v29
M v[80:83], a[92:95], a[156:159], v[80:83]
 ds_read_b128 a[116:119], v2 offset:29696
 v_fma_f32 v109, v109, v6, v29
M v[84:87], a[92:95], a[188:191], v[36:39]
 v_fma_f32 v110, v110, v6, v29
 v_fma_f32 v111, v111, v6, v29
M v[84:87], a[88:91], a[184:187], v[84:87]
 ds_read_b128 a[120:123], v2 offset:30720
 v_cvt_pk_bf16_f32 v100, v100, v101
M v[84:87], a[84:87], a[180:183], v[84:87]
 ds_read_b128 a[124:127], v2 offset:31744
 v_cvt_pk_bf16_f32 v101, v102, v103
M v[84:87], a[80:83], a[176:179], v[84:87]
 v_cvt_pk_bf16_f32 v102, v108, v109
 v_cvt_pk_bf16_f32 v103, v110, v111
M v[84:87], a[76:79], a[172:175], v[84:87]
 buffer_store_dwordx4 v[100:103], v7, s[8:11], s30 offen offset:0 sc1
M v[84:87], a[72:75], a[168:171], v[84:87]
 v_fma_f32 v112, v112, v5, v28
 v_fma_f32 v113, v113, v5, v28
M v[84:87], a[68:71], a[164:167], v[84:87]
 s_waitcnt vmcnt(31) lgkmcnt(0)
 v_fma_f32 v114, v114, v5, v28
 v_fma_f32 v115, v115, v5, v28
M v[84:87], a[64:67], a[160:163], v[84:87]
 s_barrier
M v[92:95], a[96:99], a[160:163], v[36:39]
 ds_read_b128 a[64:67], v7 offset:0
 v_fma_f32 v120, v120, v5, v28
M v[92:95], a[100:103], a[164:167], v[92:95]
 ds_read_b128 a[68:71], v7 offset:1024
 v_fma_f32 v121, v121, v5, v28
M v[92:95], a[104:107], a[168:171], v[92:95]
 v_fma_f32 v122, v122, v5, v28
 v_fma_f32 v123, v123, v5, v28
M v[92:95], a[108:111], a[172:175], v[92:95]
 ds_read_b128 a[72:75], v7 offset:2048
 v_cvt_pk_bf16_f32 v112, v112, v113
M v[92:95], a[112:115], a[176:179], v[92:95]
 ds_read_b128 a[76:79], v7 offset:3072
 v_cvt_pk_bf16_f32 v113, v114, v115
M v[92:95], a[116:119], a[180:183], v[92:95]
 v_cvt_pk_bf16_f32 v114, v120, v121
 v_cvt_pk_bf16_f32 v115, v122, v123
M v[92:95], a[120:123], a[184:187], v[92:95]
 ds_read_b128 a[80:83], v7 offset:4096
M v[92:95], a[124:127], a[188:191], v[92:95]
 ds_read_b128 a[84:87], v7 offset:5120
M v[88:91], a[124:127], a[156:159], v[32:35]
 buffer_store_dwordx4 v[112:115], v7, s[8:11], s29 offen offset:1024 sc1
M v[88:91], a[120:123], a[152:155], v[88:91]
 ds_read_b128 a[88:91], v7 offset:6144
 v_fma_f32 v116, v116, v6, v29
M v[88:91], a[116:119], a[148:151], v[88:91]
 ds_read_b128 a[92:95], v7 offset:7168
 v_fma_f32 v117, v117, v6, v29
M v[88:91], a[112:115], a[144:147], v[88:91]
 v_fma_f32 v118, v118, v6, v29
 v_fma_f32 v119, v119, v6, v29
M v[88:91], a[108:111], a[140:143], v[88:91]
 v_fma_f32 v124, v124, v6, v29
 v_fma_f32 v125, v125, v6, v29
M v[88:91], a[104:107], a[136:139], v[88:91]
 v_fma_f32 v126, v126, v6, v29
 v_fma_f32 v127, v127, v6, v29
M v[88:91], a[100:103], a[132:135], v[88:91]
 s_waitcnt lgkmcnt(0)
 v_cvt_pk_bf16_f32 v116, v116, v117
 v_cvt_pk_bf16_f32 v117, v118, v119
M v[88:91], a[96:99], a[128:131], v[88:91]
 v_cvt_pk_bf16_f32 v118, v124, v125
 v_cvt_pk_bf16_f32 v119, v126, v127
 buffer_store_dwordx4 v[116:119], v7, s[8:11], s30 offen offset:1024 sc1
M v[96:99], a[64:67], a[128:131], v[32:35]
 ds_read_b128 a[96:99], v7 offset:8192
M v[96:99], a[68:71], a[132:135], v[96:99]
 ds_read_b128 a[100:103], v7 offset:9216
M v[96:99], a[72:75], a[136:139], v[96:99]
 s_sub_u32 s64, 15, s42
M v[96:99], a[76:79], a[140:143], v[96:99]
 s_min_u32 s64, s64, s42
 ds_read_b128 a[104:107], v7 offset:10240
 s_add_u32 s29, s33, 4096
M v[96:99], a[80:83], a[144:147], v[96:99]
 s_mul_i32 s45, s64, 33024
 ds_read_b128 a[108:111], v7 offset:11264
 s_add_u32 s30, s93, 4096
M v[96:99], a[84:87], a[148:151], v[96:99]
 s_lshl_b32 s64, s20, 6
 v_fma_f32 v64, v64, v5, v28
 v_fma_f32 v65, v65, v5, v28
M v[96:99], a[88:91], a[152:155], v[96:99]
 s_add_u32 s64, s64, s41
 ds_read_b128 a[112:115], v7 offset:12288
 v_fma_f32 v66, v66, v5, v28
M v[96:99], a[92:95], a[156:159], v[96:99]
 s_lshl2_add_u32 s45, s64, s45
 ds_read_b128 a[116:119], v7 offset:13312
 v_fma_f32 v67, v67, v5, v28
M v[100:103], a[92:95], a[188:191], v[36:39]
 s_add_u32 s45, s45, 235210752
 v_fma_f32 v72, v72, v5, v28
M v[100:103], a[88:91], a[184:187], v[100:103]
 s_movk_i32 s65, 1024
 ds_read_b128 a[120:123], v7 offset:14336
 v_fma_f32 v73, v73, v5, v28
M v[100:103], a[84:87], a[180:183], v[100:103]
 s_cmp_lt_u32 s42, 8
 ds_read_b128 a[124:127], v7 offset:15360
 v_fma_f32 v74, v74, v5, v28
M v[100:103], a[80:83], a[176:179], v[100:103]
 s_cselect_b32 s64, 16512, s65
 v_fma_f32 v75, v75, v5, v28
M v[100:103], a[76:79], a[172:175], v[100:103]
 s_cselect_b32 s65, 0, 64
 v_cvt_pk_bf16_f32 v64, v64, v65
M v[100:103], a[72:75], a[168:171], v[100:103]
 s_cselect_b32 s66, 32, 64
 v_cvt_pk_bf16_f32 v65, v66, v67
M v[100:103], a[68:71], a[164:167], v[100:103]
 s_add_u32 s3, s45, s64
 s_add_u32 s45, s45, s65
 v_lshrrev_b32 v42, 5, v7
M v[100:103], a[64:67], a[160:163], v[100:103]
 s_waitcnt lgkmcnt(0)
 v_mul_u32_u24 v42, 16512, v42
 v_and_b32 v41, 16, v7
M v[108:111], a[96:99], a[160:163], v[36:39]
 ds_read_b128 a[64:67], v7 offset:16384
 v_lshl_add_u32 v41, v41, 3, v42
M v[108:111], a[100:103], a[164:167], v[108:111]
 s_lshl_b32 s65, s20, 1
 ds_read_b128 a[68:71], v7 offset:17408
 v_cvt_pk_bf16_f32 v66, v72, v73
M v[108:111], a[104:107], a[168:171], v[108:111]
 s_lshr_b32 s65, s101, s65
 v_bfe_u32 v42, v7, 4, 1
 v_lshrrev_b32 v42, v42, s65
M v[108:111], a[108:111], a[172:175], v[108:111]
 ds_read_b128 a[72:75], v7 offset:18432
 v_and_b32 v42, 1, v42
M v[108:111], a[112:115], a[176:179], v[108:111]
 ds_read_b128 a[76:79], v7 offset:19456
 v_lshl_add_u32 v41, v42, 13, v41
M v[108:111], a[116:119], a[180:183], v[108:111]
 v_mov_b32 v42, 536870912
 v_cmp_gt_u32 vcc, s66, v7
M v[108:111], a[120:123], a[184:187], v[108:111]
 ds_read_b128 a[80:83], v7 offset:20480
 v_mov_b32 v40, 1
M v[108:111], a[124:127], a[188:191], v[108:111]
 s_nop 0
 ds_read_b128 a[84:87], v7 offset:21504
 v_cndmask_b32 v41, v42, v41, vcc
M v[104:107], a[124:127], a[156:159], v[32:35]
 v_cvt_pk_bf16_f32 v67, v74, v75
M v[104:107], a[120:123], a[152:155], v[104:107]
 ds_read_b128 a[88:91], v7 offset:22528
M v[104:107], a[116:119], a[148:151], v[104:107]
 ds_read_b128 a[92:95], v7 offset:23552
M v[104:107], a[112:115], a[144:147], v[104:107]
 buffer_store_dwordx4 v[64:67], v7, s[8:11], s29 offen offset:0 sc1
M v[104:107], a[108:111], a[140:143], v[104:107]
 v_fma_f32 v68, v68, v6, v29
 v_fma_f32 v69, v69, v6, v29
M v[104:107], a[104:107], a[136:139], v[104:107]
 v_fma_f32 v70, v70, v6, v29
 v_fma_f32 v71, v71, v6, v29
M v[104:107], a[100:103], a[132:135], v[104:107]
 v_fma_f32 v76, v76, v6, v29
 v_fma_f32 v77, v77, v6, v29
M v[104:107], a[96:99], a[128:131], v[104:107]
 s_waitcnt lgkmcnt(0)
 v_fma_f32 v78, v78, v6, v29
 v_fma_f32 v79, v79, v6, v29
M v[112:115], a[64:67], a[128:131], v[32:35]
 ds_read_b128 a[96:99], v7 offset:24576
 v_cvt_pk_bf16_f32 v68, v68, v69
M v[112:115], a[68:71], a[132:135], v[112:115]
 ds_read_b128 a[100:103], v7 offset:25600
 v_cvt_pk_bf16_f32 v69, v70, v71
M v[112:115], a[72:75], a[136:139], v[112:115]
 v_cvt_pk_bf16_f32 v70, v76, v77
 v_cvt_pk_bf16_f32 v71, v78, v79
M v[112:115], a[76:79], a[140:143], v[112:115]
 ds_read_b128 a[104:107], v7 offset:26624
M v[112:115], a[80:83], a[144:147], v[112:115]
 ds_read_b128 a[108:111], v7 offset:27648
M v[112:115], a[84:87], a[148:151], v[112:115]
 buffer_store_dwordx4 v[68:71], v7, s[8:11], s30 offen offset:0 sc1
M v[112:115], a[88:91], a[152:155], v[112:115]
 ds_read_b128 a[112:115], v7 offset:28672
 v_fma_f32 v80, v80, v5, v28
M v[112:115], a[92:95], a[156:159], v[112:115]
 ds_read_b128 a[116:119], v7 offset:29696
 v_fma_f32 v81, v81, v5, v28
M v[116:119], a[92:95], a[188:191], v[36:39]
 v_fma_f32 v82, v82, v5, v28
 v_fma_f32 v83, v83, v5, v28
M v[116:119], a[88:91], a[184:187], v[116:119]
 ds_read_b128 a[120:123], v7 offset:30720
 v_fma_f32 v88, v88, v5, v28
M v[116:119], a[84:87], a[180:183], v[116:119]
 ds_read_b128 a[124:127], v7 offset:31744
 v_fma_f32 v89, v89, v5, v28
M v[116:119], a[80:83], a[176:179], v[116:119]
 v_fma_f32 v90, v90, v5, v28
 v_fma_f32 v91, v91, v5, v28
M v[116:119], a[76:79], a[172:175], v[116:119]
 v_cvt_pk_bf16_f32 v80, v80, v81
 v_cvt_pk_bf16_f32 v81, v82, v83
M v[116:119], a[72:75], a[168:171], v[116:119]
 v_cvt_pk_bf16_f32 v82, v88, v89
 v_cvt_pk_bf16_f32 v83, v90, v91
M v[116:119], a[68:71], a[164:167], v[116:119]
 s_waitcnt vmcnt(27) lgkmcnt(0)
M v[116:119], a[64:67], a[160:163], v[116:119]
 s_barrier
M v[124:127], a[96:99], a[160:163], v[36:39]
 ds_read_b128 a[64:67], v43 offset:0
M v[124:127], a[100:103], a[164:167], v[124:127]
 ds_read_b128 a[68:71], v43 offset:1024
M v[124:127], a[104:107], a[168:171], v[124:127]
 buffer_store_dwordx4 v[80:83], v7, s[8:11], s29 offen offset:1024 sc1
M v[124:127], a[108:111], a[172:175], v[124:127]
 ds_read_b128 a[72:75], v43 offset:2048
 v_fma_f32 v84, v84, v6, v29
M v[124:127], a[112:115], a[176:179], v[124:127]
 ds_read_b128 a[76:79], v43 offset:3072
 v_fma_f32 v85, v85, v6, v29
M v[124:127], a[116:119], a[180:183], v[124:127]
 v_fma_f32 v86, v86, v6, v29
 v_fma_f32 v87, v87, v6, v29
M v[124:127], a[120:123], a[184:187], v[124:127]
 ds_read_b128 a[80:83], v43 offset:4096
 v_fma_f32 v92, v92, v6, v29
M v[124:127], a[124:127], a[188:191], v[124:127]
 ds_read_b128 a[84:87], v43 offset:5120
 v_fma_f32 v93, v93, v6, v29
M v[120:123], a[124:127], a[156:159], v[32:35]
 v_fma_f32 v94, v94, v6, v29
 v_fma_f32 v95, v95, v6, v29
M v[120:123], a[120:123], a[152:155], v[120:123]
 ds_read_b128 a[88:91], v43 offset:6144
 v_cvt_pk_bf16_f32 v84, v84, v85
M v[120:123], a[116:119], a[148:151], v[120:123]
 ds_read_b128 a[92:95], v43 offset:7168
 v_cvt_pk_bf16_f32 v85, v86, v87
M v[120:123], a[112:115], a[144:147], v[120:123]
 v_cvt_pk_bf16_f32 v86, v92, v93
 v_cvt_pk_bf16_f32 v87, v94, v95
M v[120:123], a[108:111], a[140:143], v[120:123]
 buffer_store_dwordx4 v[84:87], v7, s[8:11], s30 offen offset:1024 sc1
M v[120:123], a[104:107], a[136:139], v[120:123]
M v[120:123], a[100:103], a[132:135], v[120:123]
 s_waitcnt lgkmcnt(0)
M v[120:123], a[96:99], a[128:131], v[120:123]
M v[64:67], a[64:67], a[128:131], v[32:35]
 ds_read_b128 a[96:99], v43 offset:8192
M v[64:67], a[68:71], a[132:135], v[64:67]
 ds_read_b128 a[100:103], v43 offset:9216
M v[64:67], a[72:75], a[136:139], v[64:67]
 s_waitcnt vmcnt(11)
 v_cmp_gt_u32 vcc, 1, v24
M v[64:67], a[76:79], a[140:143], v[64:67]
 s_mov_b32 s65, 234913792
 ds_read_b128 a[104:107], v43 offset:10240
 s_add_u32 s29, s33, 6144
M v[64:67], a[80:83], a[144:147], v[64:67]
 s_cbranch_vccnz L_fhs0
L_fhr0:
 ds_read_b128 a[108:111], v43 offset:11264
 s_add_u32 s30, s93, 6144
M v[64:67], a[84:87], a[148:151], v[64:67]
 buffer_load_dword v25, v14, s[8:11], s65 offen sc1
M v[64:67], a[88:91], a[152:155], v[64:67]
 ds_read_b128 a[112:115], v43 offset:12288
 v_fma_f32 v96, v96, v5, v28
M v[64:67], a[92:95], a[156:159], v[64:67]
 ds_read_b128 a[116:119], v43 offset:13312
 v_fma_f32 v97, v97, v5, v28
M v[68:71], a[92:95], a[188:191], v[36:39]
 v_fma_f32 v98, v98, v5, v28
 v_fma_f32 v99, v99, v5, v28
M v[68:71], a[88:91], a[184:187], v[68:71]
 ds_read_b128 a[120:123], v43 offset:14336
 v_fma_f32 v104, v104, v5, v28
M v[68:71], a[84:87], a[180:183], v[68:71]
 ds_read_b128 a[124:127], v43 offset:15360
 v_fma_f32 v105, v105, v5, v28
M v[68:71], a[80:83], a[176:179], v[68:71]
 v_fma_f32 v106, v106, v5, v28
 v_fma_f32 v107, v107, v5, v28
M v[68:71], a[76:79], a[172:175], v[68:71]
 v_cvt_pk_bf16_f32 v96, v96, v97
M v[68:71], a[72:75], a[168:171], v[68:71]
 v_cvt_pk_bf16_f32 v97, v98, v99
M v[68:71], a[68:71], a[164:167], v[68:71]
 v_cvt_pk_bf16_f32 v98, v104, v105
M v[68:71], a[64:67], a[160:163], v[68:71]
 s_waitcnt lgkmcnt(0)
 v_cvt_pk_bf16_f32 v99, v106, v107
M v[76:79], a[96:99], a[160:163], v[36:39]
 ds_read_b128 a[64:67], v43 offset:16384
M v[76:79], a[100:103], a[164:167], v[76:79]
 ds_read_b128 a[68:71], v43 offset:17408
M v[76:79], a[104:107], a[168:171], v[76:79]
 buffer_store_dwordx4 v[96:99], v7, s[8:11], s29 offen offset:0 sc1
M v[76:79], a[108:111], a[172:175], v[76:79]
 ds_read_b128 a[72:75], v43 offset:18432
 v_fma_f32 v100, v100, v6, v29
M v[76:79], a[112:115], a[176:179], v[76:79]
 ds_read_b128 a[76:79], v43 offset:19456
 v_fma_f32 v101, v101, v6, v29
M v[76:79], a[116:119], a[180:183], v[76:79]
 v_fma_f32 v102, v102, v6, v29
 v_fma_f32 v103, v103, v6, v29
M v[76:79], a[120:123], a[184:187], v[76:79]
 ds_read_b128 a[80:83], v43 offset:20480
 v_fma_f32 v108, v108, v6, v29
M v[76:79], a[124:127], a[188:191], v[76:79]
 ds_read_b128 a[84:87], v43 offset:21504
 v_fma_f32 v109, v109, v6, v29
M v[72:75], a[124:127], a[156:159], v[32:35]
 v_fma_f32 v110, v110, v6, v29
 v_fma_f32 v111, v111, v6, v29
M v[72:75], a[120:123], a[152:155], v[72:75]
 ds_read_b128 a[88:91], v43 offset:22528
 v_cvt_pk_bf16_f32 v100, v100, v101
M v[72:75], a[116:119], a[148:151], v[72:75]
 ds_read_b128 a[92:95], v43 offset:23552
 v_cvt_pk_bf16_f32 v101, v102, v103
M v[72:75], a[112:115], a[144:147], v[72:75]
 v_cvt_pk_bf16_f32 v102, v108, v109
M v[72:75], a[108:111], a[140:143], v[72:75]
 v_cvt_pk_bf16_f32 v103, v110, v111
M v[72:75], a[104:107], a[136:139], v[72:75]
 buffer_store_dwordx4 v[100:103], v7, s[8:11], s30 offen offset:0 sc1
M v[72:75], a[100:103], a[132:135], v[72:75]
M v[72:75], a[96:99], a[128:131], v[72:75]
 s_waitcnt lgkmcnt(0)
 v_fma_f32 v112, v112, v5, v28
M v[80:83], a[64:67], a[128:131], v[32:35]
 ds_read_b128 a[96:99], v43 offset:24576
 v_fma_f32 v113, v113, v5, v28
M v[80:83], a[68:71], a[132:135], v[80:83]
 ds_read_b128 a[100:103], v43 offset:25600
 v_fma_f32 v114, v114, v5, v28
M v[80:83], a[72:75], a[136:139], v[80:83]
 v_fma_f32 v115, v115, v5, v28
M v[80:83], a[76:79], a[140:143], v[80:83]
 ds_read_b128 a[104:107], v43 offset:26624
 v_fma_f32 v120, v120, v5, v28
M v[80:83], a[80:83], a[144:147], v[80:83]
 ds_read_b128 a[108:111], v43 offset:27648
 v_fma_f32 v121, v121, v5, v28
M v[80:83], a[84:87], a[148:151], v[80:83]
 v_fma_f32 v122, v122, v5, v28
M v[80:83], a[88:91], a[152:155], v[80:83]
 ds_read_b128 a[112:115], v43 offset:28672
 v_fma_f32 v123, v123, v5, v28
M v[80:83], a[92:95], a[156:159], v[80:83]
 ds_read_b128 a[116:119], v43 offset:29696
 v_cvt_pk_bf16_f32 v112, v112, v113
M v[84:87], a[92:95], a[188:191], v[36:39]
 v_cvt_pk_bf16_f32 v113, v114, v115
 v_cvt_pk_bf16_f32 v114, v120, v121
M v[84:87], a[88:91], a[184:187], v[84:87]
 ds_read_b128 a[120:123], v43 offset:30720
 v_cvt_pk_bf16_f32 v115, v122, v123
M v[84:87], a[84:87], a[180:183], v[84:87]
 ds_read_b128 a[124:127], v43 offset:31744
M v[84:87], a[80:83], a[176:179], v[84:87]
 buffer_store_dwordx4 v[112:115], v7, s[8:11], s29 offen offset:1024 sc1
M v[84:87], a[76:79], a[172:175], v[84:87]
 v_fma_f32 v116, v116, v6, v29
M v[84:87], a[72:75], a[168:171], v[84:87]
 v_fma_f32 v117, v117, v6, v29
M v[84:87], a[68:71], a[164:167], v[84:87]
 s_waitcnt lgkmcnt(0)
 v_fma_f32 v118, v118, v6, v29
M v[84:87], a[64:67], a[160:163], v[84:87]
 s_barrier
M v[92:95], a[96:99], a[160:163], v[36:39]
 ds_read_b128 a[64:67], v2 offset:32768
 v_fma_f32 v119, v119, v6, v29
M v[92:95], a[100:103], a[164:167], v[92:95]
 ds_read_b128 a[68:71], v2 offset:33792
 v_fma_f32 v124, v124, v6, v29
M v[92:95], a[104:107], a[168:171], v[92:95]
 v_fma_f32 v125, v125, v6, v29
 v_fma_f32 v126, v126, v6, v29
M v[92:95], a[108:111], a[172:175], v[92:95]
 ds_read_b128 a[72:75], v2 offset:34816
 v_fma_f32 v127, v127, v6, v29
M v[92:95], a[112:115], a[176:179], v[92:95]
 ds_read_b128 a[76:79], v2 offset:35840
 v_cvt_pk_bf16_f32 v116, v116, v117
M v[92:95], a[116:119], a[180:183], v[92:95]
 v_cvt_pk_bf16_f32 v117, v118, v119
M v[92:95], a[120:123], a[184:187], v[92:95]
 ds_read_b128 a[80:83], v2 offset:36864
 v_cvt_pk_bf16_f32 v118, v124, v125
M v[92:95], a[124:127], a[188:191], v[92:95]
 ds_read_b128 a[84:87], v2 offset:37888
 v_cvt_pk_bf16_f32 v119, v126, v127
M v[88:91], a[124:127], a[156:159], v[32:35]
 buffer_store_dwordx4 v[116:119], v7, s[8:11], s30 offen offset:1024 sc1
M v[88:91], a[120:123], a[152:155], v[88:91]
 ds_read_b128 a[88:91], v2 offset:38912
M v[88:91], a[116:119], a[148:151], v[88:91]
 ds_read_b128 a[92:95], v2 offset:39936
M v[88:91], a[112:115], a[144:147], v[88:91]
M v[88:91], a[108:111], a[140:143], v[88:91]
M v[88:91], a[104:107], a[136:139], v[88:91]
M v[88:91], a[100:103], a[132:135], v[88:91]
 s_waitcnt lgkmcnt(0)
M v[88:91], a[96:99], a[128:131], v[88:91]
M v[96:99], a[64:67], a[128:131], v[32:35]
 ds_read_b128 a[96:99], v2 offset:40960
M v[96:99], a[68:71], a[132:135], v[96:99]
 ds_read_b128 a[100:103], v2 offset:41984
M v[96:99], a[72:75], a[136:139], v[96:99]
M v[96:99], a[76:79], a[140:143], v[96:99]
 ds_read_b128 a[104:107], v2 offset:43008
 s_add_u32 s29, s33, 16384
M v[96:99], a[80:83], a[144:147], v[96:99]
 ds_read_b128 a[108:111], v2 offset:44032
 s_add_u32 s30, s93, 16384
M v[96:99], a[84:87], a[148:151], v[96:99]
 v_fma_f32 v64, v64, v5, v28
 v_fma_f32 v65, v65, v5, v28
M v[96:99], a[88:91], a[152:155], v[96:99]
 ds_read_b128 a[112:115], v2 offset:45056
 v_fma_f32 v66, v66, v5, v28
M v[96:99], a[92:95], a[156:159], v[96:99]
 ds_read_b128 a[116:119], v2 offset:46080
 v_fma_f32 v67, v67, v5, v28
M v[100:103], a[92:95], a[188:191], v[36:39]
 v_fma_f32 v72, v72, v5, v28
M v[100:103], a[88:91], a[184:187], v[100:103]
 ds_read_b128 a[120:123], v2 offset:47104
 v_fma_f32 v73, v73, v5, v28
M v[100:103], a[84:87], a[180:183], v[100:103]
 ds_read_b128 a[124:127], v2 offset:48128
 v_fma_f32 v74, v74, v5, v28
M v[100:103], a[80:83], a[176:179], v[100:103]
 v_fma_f32 v75, v75, v5, v28
M v[100:103], a[76:79], a[172:175], v[100:103]
 v_cvt_pk_bf16_f32 v64, v64, v65
M v[100:103], a[72:75], a[168:171], v[100:103]
 v_cvt_pk_bf16_f32 v65, v66, v67
M v[100:103], a[68:71], a[164:167], v[100:103]
 v_cvt_pk_bf16_f32 v66, v72, v73
M v[100:103], a[64:67], a[160:163], v[100:103]
 s_waitcnt lgkmcnt(0)
 v_cvt_pk_bf16_f32 v67, v74, v75
M v[108:111], a[96:99], a[160:163], v[36:39]
 ds_read_b128 a[64:67], v2 offset:49152
M v[108:111], a[100:103], a[164:167], v[108:111]
 ds_read_b128 a[68:71], v2 offset:50176
M v[108:111], a[104:107], a[168:171], v[108:111]
 buffer_store_dwordx4 v[64:67], v7, s[8:11], s29 offen offset:0 sc1
M v[108:111], a[108:111], a[172:175], v[108:111]
 ds_read_b128 a[72:75], v2 offset:51200
 v_fma_f32 v68, v68, v6, v29
M v[108:111], a[112:115], a[176:179], v[108:111]
 ds_read_b128 a[76:79], v2 offset:52224
 v_fma_f32 v69, v69, v6, v29
M v[108:111], a[116:119], a[180:183], v[108:111]
 v_fma_f32 v70, v70, v6, v29
 v_fma_f32 v71, v71, v6, v29
M v[108:111], a[120:123], a[184:187], v[108:111]
 ds_read_b128 a[80:83], v2 offset:53248
 v_fma_f32 v76, v76, v6, v29
M v[108:111], a[124:127], a[188:191], v[108:111]
 ds_read_b128 a[84:87], v2 offset:54272
 v_fma_f32 v77, v77, v6, v29
M v[104:107], a[124:127], a[156:159], v[32:35]
 v_fma_f32 v78, v78, v6, v29
 v_fma_f32 v79, v79, v6, v29
M v[104:107], a[120:123], a[152:155], v[104:107]
 ds_read_b128 a[88:91], v2 offset:55296
 v_cvt_pk_bf16_f32 v68, v68, v69
M v[104:107], a[116:119], a[148:151], v[104:107]
 ds_read_b128 a[92:95], v2 offset:56320
 v_cvt_pk_bf16_f32 v69, v70, v71
M v[104:107], a[112:115], a[144:147], v[104:107]
 v_cvt_pk_bf16_f32 v70, v76, v77
M v[104:107], a[108:111], a[140:143], v[104:107]
 v_cvt_pk_bf16_f32 v71, v78, v79
M v[104:107], a[104:107], a[136:139], v[104:107]
 buffer_store_dwordx4 v[68:71], v7, s[8:11], s30 offen offset:0 sc1
M v[104:107], a[100:103], a[132:135], v[104:107]
M v[104:107], a[96:99], a[128:131], v[104:107]
 s_waitcnt lgkmcnt(0)
 v_fma_f32 v80, v80, v5, v28
M v[112:115], a[64:67], a[128:131], v[32:35]
 ds_read_b128 a[96:99], v2 offset:57344
 v_fma_f32 v81, v81, v5, v28
M v[112:115], a[68:71], a[132:135], v[112:115]
 ds_read_b128 a[100:103], v2 offset:58368
 v_fma_f32 v82, v82, v5, v28
M v[112:115], a[72:75], a[136:139], v[112:115]
 v_fma_f32 v83, v83, v5, v28
M v[112:115], a[76:79], a[140:143], v[112:115]
 ds_read_b128 a[104:107], v2 offset:59392
 v_fma_f32 v88, v88, v5, v28
M v[112:115], a[80:83], a[144:147], v[112:115]
 ds_read_b128 a[108:111], v2 offset:60416
 v_fma_f32 v89, v89, v5, v28
M v[112:115], a[84:87], a[148:151], v[112:115]
 v_fma_f32 v90, v90, v5, v28
M v[112:115], a[88:91], a[152:155], v[112:115]
 ds_read_b128 a[112:115], v2 offset:61440
 v_fma_f32 v91, v91, v5, v28
M v[112:115], a[92:95], a[156:159], v[112:115]
 ds_read_b128 a[116:119], v2 offset:62464
 v_cvt_pk_bf16_f32 v80, v80, v81
M v[116:119], a[92:95], a[188:191], v[36:39]
 s_waitcnt vmcnt(6)
 v_readlane_b32 s84, v25, 0
 v_readlane_b32 s85, v25, 1
M v[116:119], a[88:91], a[184:187], v[116:119]
 ds_read_b128 a[120:123], v2 offset:63488
 v_mov_b32 v24, 0x3f80
M v[116:119], a[84:87], a[180:183], v[116:119]
 ds_read_b128 a[124:127], v2 offset:64512
 v_mov_b32 v25, 0x3f800000
M v[116:119], a[80:83], a[176:179], v[116:119]
 v_cvt_pk_bf16_f32 v81, v82, v83
 v_cvt_pk_bf16_f32 v82, v88, v89
M v[116:119], a[76:79], a[172:175], v[116:119]
 v_cvt_pk_bf16_f32 v83, v90, v91
M v[116:119], a[72:75], a[168:171], v[116:119]
 buffer_store_dwordx4 v[80:83], v7, s[8:11], s29 offen offset:1024 sc1
M v[116:119], a[68:71], a[164:167], v[116:119]
 s_waitcnt lgkmcnt(0)
 v_fma_f32 v84, v84, v6, v29
 v_fma_f32 v85, v85, v6, v29
M v[116:119], a[64:67], a[160:163], v[116:119]
 s_barrier
M v[124:127], a[96:99], a[160:163], v[36:39]
 ds_read_b128 a[64:67], v7 offset:32768
 v_fma_f32 v86, v86, v6, v29
M v[124:127], a[100:103], a[164:167], v[124:127]
 ds_read_b128 a[68:71], v7 offset:33792
 v_fma_f32 v87, v87, v6, v29
M v[124:127], a[104:107], a[168:171], v[124:127]
 v_fma_f32 v92, v92, v6, v29
 v_fma_f32 v93, v93, v6, v29
M v[124:127], a[108:111], a[172:175], v[124:127]
 ds_read_b128 a[72:75], v7 offset:34816
 v_fma_f32 v94, v94, v6, v29
M v[124:127], a[112:115], a[176:179], v[124:127]
 ds_read_b128 a[76:79], v7 offset:35840
 v_fma_f32 v95, v95, v6, v29
M v[124:127], a[116:119], a[180:183], v[124:127]
 s_waitcnt vmcnt(3)
 v_cvt_pk_bf16_f32 v84, v84, v85
 v_cvt_pk_bf16_f32 v85, v86, v87
M v[124:127], a[120:123], a[184:187], v[124:127]
 ds_read_b128 a[80:83], v7 offset:36864
 v_cvt_pk_bf16_f32 v86, v92, v93
M v[124:127], a[124:127], a[188:191], v[124:127]
 ds_read_b128 a[84:87], v7 offset:37888
 v_cvt_pk_bf16_f32 v87, v94, v95
M v[120:123], a[124:127], a[156:159], v[32:35]
 buffer_store_dword v40, v41, s[8:11], s45 offen sc1
M v[120:123], a[120:123], a[152:155], v[120:123]
 ds_read_b128 a[88:91], v7 offset:38912
M v[120:123], a[116:119], a[148:151], v[120:123]
 ds_read_b128 a[92:95], v7 offset:39936
M v[120:123], a[112:115], a[144:147], v[120:123]
 buffer_store_dwordx4 v[84:87], v7, s[8:11], s30 offen offset:1024 sc1
M v[120:123], a[108:111], a[140:143], v[120:123]
M v[120:123], a[104:107], a[136:139], v[120:123]
M v[120:123], a[100:103], a[132:135], v[120:123]
 s_waitcnt lgkmcnt(0)
M v[120:123], a[96:99], a[128:131], v[120:123]
M v[64:67], a[64:67], a[128:131], v[32:35]
 ds_read_b128 a[96:99], v7 offset:40960
M v[64:67], a[68:71], a[132:135], v[64:67]
 ds_read_b128 a[100:103], v7 offset:41984
M v[64:67], a[72:75], a[136:139], v[64:67]
M v[64:67], a[76:79], a[140:143], v[64:67]
 ds_read_b128 a[104:107], v7 offset:43008
 s_add_u32 s29, s33, 18432
M v[64:67], a[80:83], a[144:147], v[64:67]
 ds_read_b128 a[108:111], v7 offset:44032
 s_add_u32 s30, s93, 18432
M v[64:67], a[84:87], a[148:151], v[64:67]
 v_fma_f32 v96, v96, v5, v28
 v_fma_f32 v97, v97, v5, v28
M v[64:67], a[88:91], a[152:155], v[64:67]
 ds_read_b128 a[112:115], v7 offset:45056
 v_fma_f32 v98, v98, v5, v28
M v[64:67], a[92:95], a[156:159], v[64:67]
 ds_read_b128 a[116:119], v7 offset:46080
 v_fma_f32 v99, v99, v5, v28
M v[68:71], a[92:95], a[188:191], v[36:39]
 v_fma_f32 v104, v104, v5, v28
 v_fma_f32 v105, v105, v5, v28
M v[68:71], a[88:91], a[184:187], v[68:71]
 ds_read_b128 a[120:123], v7 offset:47104
 v_fma_f32 v106, v106, v5, v28
M v[68:71], a[84:87], a[180:183], v[68:71]
 ds_read_b128 a[124:127], v7 offset:48128
 v_fma_f32 v107, v107, v5, v28
M v[68:71], a[80:83], a[176:179], v[68:71]
 v_cvt_pk_bf16_f32 v96, v96, v97
 v_cvt_pk_bf16_f32 v97, v98, v99
M v[68:71], a[76:79], a[172:175], v[68:71]
 v_cvt_pk_bf16_f32 v98, v104, v105
 v_cvt_pk_bf16_f32 v99, v106, v107
M v[68:71], a[72:75], a[168:171], v[68:71]
 buffer_store_dwordx4 v[96:99], v7, s[8:11], s29 offen offset:0 sc1
M v[68:71], a[68:71], a[164:167], v[68:71]
 v_fma_f32 v100, v100, v6, v29
 v_fma_f32 v101, v101, v6, v29
M v[68:71], a[64:67], a[160:163], v[68:71]
 s_waitcnt lgkmcnt(0)
 v_fma_f32 v102, v102, v6, v29
 v_fma_f32 v103, v103, v6, v29
M v[72:75], a[96:99], a[128:131], v[32:35]
 ds_read_b128 a[64:67], v7 offset:49152
 v_fma_f32 v108, v108, v6, v29
M v[72:75], a[100:103], a[132:135], v[72:75]
 ds_read_b128 a[68:71], v7 offset:50176
 v_fma_f32 v109, v109, v6, v29
M v[72:75], a[104:107], a[136:139], v[72:75]
 v_fma_f32 v110, v110, v6, v29
 v_fma_f32 v111, v111, v6, v29
M v[72:75], a[108:111], a[140:143], v[72:75]
 ds_read_b128 a[72:75], v7 offset:51200
 v_cvt_pk_bf16_f32 v100, v100, v101
M v[72:75], a[112:115], a[144:147], v[72:75]
 ds_read_b128 a[76:79], v7 offset:52224
 v_cvt_pk_bf16_f32 v101, v102, v103
M v[72:75], a[116:119], a[148:151], v[72:75]
 v_cvt_pk_bf16_f32 v102, v108, v109
 v_cvt_pk_bf16_f32 v103, v110, v111
M v[72:75], a[120:123], a[152:155], v[72:75]
 ds_read_b128 a[80:83], v7 offset:53248
M v[72:75], a[124:127], a[156:159], v[72:75]
 ds_read_b128 a[84:87], v7 offset:54272
M v[76:79], a[124:127], a[188:191], v[36:39]
 buffer_store_dwordx4 v[100:103], v7, s[8:11], s30 offen offset:0 sc1
M v[76:79], a[120:123], a[184:187], v[76:79]
 ds_read_b128 a[88:91], v7 offset:55296
 v_fma_f32 v112, v112, v5, v28
M v[76:79], a[116:119], a[180:183], v[76:79]
 ds_read_b128 a[92:95], v7 offset:56320
 v_fma_f32 v113, v113, v5, v28
M v[76:79], a[112:115], a[176:179], v[76:79]
 v_fma_f32 v114, v114, v5, v28
 v_fma_f32 v115, v115, v5, v28
M v[76:79], a[108:111], a[172:175], v[76:79]
 v_fma_f32 v120, v120, v5, v28
 v_fma_f32 v121, v121, v5, v28
M v[76:79], a[104:107], a[168:171], v[76:79]
 v_fma_f32 v122, v122, v5, v28
 v_fma_f32 v123, v123, v5, v28
M v[76:79], a[100:103], a[164:167], v[76:79]
 v_cvt_pk_bf16_f32 v112, v112, v113
 v_cvt_pk_bf16_f32 v113, v114, v115
M v[76:79], a[96:99], a[160:163], v[76:79]
 s_waitcnt lgkmcnt(0)
 v_cvt_pk_bf16_f32 v114, v120, v121
 v_cvt_pk_bf16_f32 v115, v122, v123
M v[80:83], a[64:67], a[128:131], v[32:35]
 ds_read_b128 a[96:99], v7 offset:57344
M v[80:83], a[68:71], a[132:135], v[80:83]
 ds_read_b128 a[100:103], v7 offset:58368
M v[80:83], a[72:75], a[136:139], v[80:83]
 buffer_store_dwordx4 v[112:115], v7, s[8:11], s29 offen offset:1024 sc1
M v[80:83], a[76:79], a[140:143], v[80:83]
 ds_read_b128 a[104:107], v7 offset:59392
 v_fma_f32 v116, v116, v6, v29
M v[80:83], a[80:83], a[144:147], v[80:83]
 ds_read_b128 a[108:111], v7 offset:60416
 v_fma_f32 v117, v117, v6, v29
M v[80:83], a[84:87], a[148:151], v[80:83]
 v_fma_f32 v118, v118, v6, v29
 v_fma_f32 v119, v119, v6, v29
M v[80:83], a[88:91], a[152:155], v[80:83]
 ds_read_b128 a[112:115], v7 offset:61440
 v_fma_f32 v124, v124, v6, v29
M v[80:83], a[92:95], a[156:159], v[80:83]
 ds_read_b128 a[116:119], v7 offset:62464
 v_fma_f32 v125, v125, v6, v29
M v[84:87], a[92:95], a[188:191], v[36:39]
 v_fma_f32 v126, v126, v6, v29
 v_fma_f32 v127, v127, v6, v29
M v[84:87], a[88:91], a[184:187], v[84:87]
 ds_read_b128 a[120:123], v7 offset:63488
 v_cvt_pk_bf16_f32 v116, v116, v117
M v[84:87], a[84:87], a[180:183], v[84:87]
 ds_read_b128 a[124:127], v7 offset:64512
 v_cvt_pk_bf16_f32 v117, v118, v119
M v[84:87], a[80:83], a[176:179], v[84:87]
 v_cvt_pk_bf16_f32 v118, v124, v125
 v_cvt_pk_bf16_f32 v119, v126, v127
M v[84:87], a[76:79], a[172:175], v[84:87]
 buffer_store_dwordx4 v[116:119], v7, s[8:11], s30 offen offset:1024 sc1
M v[84:87], a[72:75], a[168:171], v[84:87]
 s_add_u32 s29, s33, 20480
M v[84:87], a[68:71], a[164:167], v[84:87]
 s_add_u32 s30, s93, 20480
 v_fma_f32 v64, v64, v5, v28
 v_fma_f32 v65, v65, v5, v28
M v[84:87], a[64:67], a[160:163], v[84:87]
 s_waitcnt lgkmcnt(0)
 v_fma_f32 v66, v66, v5, v28
 v_fma_f32 v67, v67, v5, v28
M v[88:91], a[96:99], a[128:131], v[32:35]
 v_fma_f32 v72, v72, v5, v28
 v_fma_f32 v73, v73, v5, v28
M v[88:91], a[100:103], a[132:135], v[88:91]
 v_fma_f32 v74, v74, v5, v28
 v_fma_f32 v75, v75, v5, v28
M v[88:91], a[104:107], a[136:139], v[88:91]
 v_cvt_pk_bf16_f32 v64, v64, v65
 v_cvt_pk_bf16_f32 v65, v66, v67
M v[88:91], a[108:111], a[140:143], v[88:91]
 v_cvt_pk_bf16_f32 v66, v72, v73
 v_cvt_pk_bf16_f32 v67, v74, v75
M v[88:91], a[112:115], a[144:147], v[88:91]
 buffer_store_dwordx4 v[64:67], v7, s[8:11], s29 offen offset:0 sc1
M v[88:91], a[116:119], a[148:151], v[88:91]
 v_fma_f32 v68, v68, v6, v29
 v_fma_f32 v69, v69, v6, v29
M v[88:91], a[120:123], a[152:155], v[88:91]
 v_fma_f32 v70, v70, v6, v29
 v_fma_f32 v71, v71, v6, v29
M v[88:91], a[124:127], a[156:159], v[88:91]
 v_fma_f32 v76, v76, v6, v29
 v_fma_f32 v77, v77, v6, v29
M v[92:95], a[124:127], a[188:191], v[36:39]
 v_fma_f32 v78, v78, v6, v29
 v_fma_f32 v79, v79, v6, v29
M v[92:95], a[120:123], a[184:187], v[92:95]
 v_cvt_pk_bf16_f32 v68, v68, v69
 v_cvt_pk_bf16_f32 v69, v70, v71
M v[92:95], a[116:119], a[180:183], v[92:95]
 v_cvt_pk_bf16_f32 v70, v76, v77
 v_cvt_pk_bf16_f32 v71, v78, v79
M v[92:95], a[112:115], a[176:179], v[92:95]
 buffer_store_dwordx4 v[68:71], v7, s[8:11], s30 offen offset:0 sc1
M v[92:95], a[108:111], a[172:175], v[92:95]
M v[92:95], a[104:107], a[168:171], v[92:95]
M v[92:95], a[100:103], a[164:167], v[92:95]
M v[92:95], a[96:99], a[160:163], v[92:95]
 v_fma_f32 v80, v80, v5, v28
 v_fma_f32 v81, v81, v5, v28
 v_fma_f32 v82, v82, v5, v28
 v_fma_f32 v83, v83, v5, v28
 v_fma_f32 v88, v88, v5, v28
 v_fma_f32 v89, v89, v5, v28
 v_fma_f32 v90, v90, v5, v28
 v_fma_f32 v91, v91, v5, v28
 v_cvt_pk_bf16_f32 v80, v80, v81
 v_cvt_pk_bf16_f32 v81, v82, v83
 v_cvt_pk_bf16_f32 v82, v88, v89
 v_cvt_pk_bf16_f32 v83, v90, v91
 buffer_store_dwordx4 v[80:83], v7, s[8:11], s29 offen offset:1024 sc1
 v_fma_f32 v84, v84, v6, v29
 v_fma_f32 v85, v85, v6, v29
 v_fma_f32 v86, v86, v6, v29
 v_fma_f32 v87, v87, v6, v29
 v_fma_f32 v92, v92, v6, v29
 v_fma_f32 v93, v93, v6, v29
 v_fma_f32 v94, v94, v6, v29
 v_fma_f32 v95, v95, v6, v29
 v_cvt_pk_bf16_f32 v84, v84, v85
 v_cvt_pk_bf16_f32 v85, v86, v87
 v_cvt_pk_bf16_f32 v86, v92, v93
 v_cvt_pk_bf16_f32 v87, v94, v95
 buffer_store_dwordx4 v[84:87], v7, s[8:11], s30 offen offset:1024 sc1
L_red:
 s_lshl_b32 s64, s42, 1
 s_lshr_b32 s65, s41, 3
 s_add_u32 s46, s64, s65
 s_mul_i32 s46, s46, 16512
 s_and_b32 s72, s41, 7
 s_lshl_b32 s66, s72, 7
 s_add_u32 s46, s46, s66
 s_add_u32 s46, s46, 235210752
 s_and_b32 s66, s41, 7
 s_lshr_b32 s66, s101, s66
 s_and_b32 s66, s66, 1
 s_lshl_b32 s66, s66, 13
 s_add_u32 s46, s46, s66
 v_and_b32 v14, 31, v0
 v_lshlrev_b32 v14, 2, v14
 buffer_load_dword v9, v14, s[8:11], s46 offen sc1
 s_mul_i32 s86, s65, 4
 s_add_u32 s86, s86, s20
 s_mul_i32 s77, s42, 4194304
 s_mul_i32 s78, s72, 32768
 s_add_u32 s77, s77, s78
 s_add_u32 s77, s77, 67108864
 s_lshr_b32 s78, s101, s72
 s_and_b32 s78, s78, 1
 s_lshl_b32 s78, s78, 13
 s_add_u32 s77, s77, s78
 s_sub_u32 s64, 15, s64
 s_sub_u32 s78, s64, 1
 s_mul_i32 s78, s78, 4194304
 s_add_u32 s78, s78, s77
 s_lshl_b32 s66, s86, 10
 s_add_u32 s78, s78, s66
 s_lshl_b32 s66, s74, 10
 s_add_u32 s77, s77, s66
 s_and_b32 s66, s66, 8192
 s_add_u32 s77, s77, s66
 s_lshl_b32 s66, s64, 7
 s_lshl_b32 s86, s86, 6
 s_lshr_b32 s73, s72, 1
 s_sub_u32 s65, 7, s73
 s_bitcmp1_b32 s72, 0
 s_cselect_b32 s73, s65, s73
 s_lshl_b32 s73, s73, 4
 s_lshl_b32 s65, s42, 7
 s_add_u32 s73, s73, s65
 v_and_b32 v10, 15, v0
 v_add_u32 v10, s73, v10
 v_add_u32 v29, s66, v10
 s_mov_b32 s64, 234881088
 v_mul_u32_u24 v12, 896, v10
 v_lshl_add_u32 v12, v11, 4, v12
 v_lshrrev_b32 v13, 4, v10
 v_lshlrev_b32 v13, 5, v13
 v_and_b32 v104, 15, v10
 v_add_lshl_u32 v13, v13, v104, 2
 buffer_load_dword v15, v13, s[8:11], s64 offen sc1
 buffer_load_dwordx4 v[16:19], v12, s[56:59], s75 offen
 buffer_load_dwordx4 v[20:23], v12, s[56:59], s76 offen
 v_mov_b32 v48, 0
 v_mov_b32 v49, 0
 v_mov_b32 v50, 0
 v_mov_b32 v51, 0
 v_mov_b32 v52, 0
 v_mov_b32 v53, 0
 v_mov_b32 v54, 0
 v_mov_b32 v55, 0
 v_mov_b32 v56, 0
 v_mov_b32 v57, 0
 v_mov_b32 v58, 0
 v_mov_b32 v59, 0
 v_mov_b32 v60, 0
 v_mov_b32 v61, 0
 v_mov_b32 v62, 0
 v_mov_b32 v63, 0
 v_mul_u32_u24 v28, 896, v29
 v_lshl_add_u32 v28, v11, 4, v28
 v_lshrrev_b32 v13, 4, v29
 v_lshlrev_b32 v13, 5, v13
 v_and_b32 v104, 15, v29
 v_add_lshl_u32 v13, v13, v104, 2
 buffer_load_dword v26, v13, s[8:11], s64 offen sc1
 buffer_load_dwordx4 v[96:99], v28, s[56:59], s86 offen
 v_mov_b32 v64, 0
 v_mov_b32 v65, 0
 v_mov_b32 v66, 0
 v_mov_b32 v67, 0
 v_mov_b32 v68, 0
 v_mov_b32 v69, 0
 v_mov_b32 v70, 0
 v_mov_b32 v71, 0
 s_waitcnt vmcnt(6)
 buffer_store_dword v40, v41, s[8:11], s3 offen sc1
 s_waitcnt vmcnt(6)
 v_cmp_eq_u32 vcc, 1, v9
 s_mov_b32 s91, 65536
 s_mov_b32 s69, 0
 s_mov_b32 s70, vcc_lo
 s_mov_b32 s68, vcc_lo
 s_cmp_lg_u32 s70, 0
 s_cbranch_scc1 L_rk0
 s_call_b64 s[36:37], L_rpoll
L_rk0:
 s_ff1_i32_b32 s71, s70
 s_bitset0_b32 s70, s71
 s_cmp_ge_u32 s71, 16
 s_cselect_b32 s72, s78, s77
 s_cselect_b32 s73, 0x1, 0
 s_cselect_b32 s87, 536870912, 0
 s_and_b32 s89, s71, 8
 s_lshl_b32 s89, s89, 10
 s_xor_b32 s72, s72, s89
 s_mul_i32 s71, s71, 262144
 s_add_u32 s71, s71, s72
 buffer_load_dwordx4 v[128:131], v7, s[8:11], s71 offen sc1
 s_or_b32 s69, s69, s73
 s_or_b32 s71, s71, s87
 buffer_load_dwordx4 v[132:135], v27, s[8:11], s71 offen sc1
 s_cmp_lg_u32 s70, 0
 s_cbranch_scc1 L_rk1
 s_call_b64 s[36:37], L_rpoll
L_rk1:
 s_ff1_i32_b32 s71, s70
 s_bitset0_b32 s70, s71
 s_cmp_ge_u32 s71, 16
 s_cselect_b32 s72, s78, s77
 s_cselect_b32 s73, 0x2, 0
 s_cselect_b32 s87, 536870912, 0
 s_and_b32 s89, s71, 8
 s_lshl_b32 s89, s89, 10
 s_xor_b32 s72, s72, s89
 s_mul_i32 s71, s71, 262144
 s_add_u32 s71, s71, s72
 buffer_load_dwordx4 v[136:139], v7, s[8:11], s71 offen sc1
 s_or_b32 s69, s69, s73
 s_or_b32 s71, s71, s87
 buffer_load_dwordx4 v[140:143], v27, s[8:11], s71 offen sc1
 s_waitcnt vmcnt(8)
 v_lshlrev_b32 v32, 16, v16
 v_and_b32 v33, 0xffff0000, v16
 v_lshlrev_b32 v34, 16, v17
 v_and_b32 v35, 0xffff0000, v17
 v_lshlrev_b32 v36, 16, v18
 v_and_b32 v37, 0xffff0000, v18
 v_lshlrev_b32 v38, 16, v19
 v_and_b32 v39, 0xffff0000, v19
 s_waitcnt vmcnt(7)
 v_lshlrev_b32 v40, 16, v20
 v_and_b32 v41, 0xffff0000, v20
 v_lshlrev_b32 v42, 16, v21
 v_and_b32 v43, 0xffff0000, v21
 v_lshlrev_b32 v44, 16, v22
 v_and_b32 v45, 0xffff0000, v22
 v_lshlrev_b32 v46, 16, v23
 v_and_b32 v47, 0xffff0000, v23
 v_sub_f32 v13, 1.0, v15
 v_cmp_eq_u32 s[80:81], s84, v10
 v_cmp_eq_u32 s[82:83], s85, v10
 s_nop 0
 s_or_b64 vcc, s[80:81], s[82:83]
 s_cbranch_vccnz L_moe0
L_moe_ret0:
 v_mul_f32 v32, v13, v32
 v_mul_f32 v33, v13, v33
 v_mul_f32 v34, v13, v34
 v_mul_f32 v35, v13, v35
 v_mul_f32 v36, v13, v36
 v_mul_f32 v37, v13, v37
 v_mul_f32 v38, v13, v38
 v_mul_f32 v39, v13, v39
 v_mul_f32 v40, v13, v40
 v_mul_f32 v41, v13, v41
 v_mul_f32 v42, v13, v42
 v_mul_f32 v43, v13, v43
 v_mul_f32 v44, v13, v44
 v_mul_f32 v45, v13, v45
 v_mul_f32 v46, v13, v46
 v_mul_f32 v47, v13, v47
 s_cmp_lg_u32 s70, 0
 s_cbranch_scc1 L_rk2
 s_call_b64 s[36:37], L_rpoll
L_rk2:
 s_ff1_i32_b32 s71, s70
 s_bitset0_b32 s70, s71
 s_cmp_ge_u32 s71, 16
 s_cselect_b32 s72, s78, s77
 s_cselect_b32 s73, 0x4, 0
 s_cselect_b32 s87, 536870912, 0
 s_and_b32 s89, s71, 8
 s_lshl_b32 s89, s89, 10
 s_xor_b32 s72, s72, s89
 s_mul_i32 s71, s71, 262144
 s_add_u32 s71, s71, s72
 buffer_load_dwordx4 v[144:147], v7, s[8:11], s71 offen sc1
 s_or_b32 s69, s69, s73
 s_or_b32 s71, s71, s87
 buffer_load_dwordx4 v[148:151], v27, s[8:11], s71 offen sc1
 s_waitcnt vmcnt(7)
 v_lshlrev_b32 v80, 16, v96
 v_and_b32 v81, 0xffff0000, v96
 v_lshlrev_b32 v82, 16, v97
 v_and_b32 v83, 0xffff0000, v97
 v_lshlrev_b32 v84, 16, v98
 v_and_b32 v85, 0xffff0000, v98
 v_lshlrev_b32 v86, 16, v99
 v_and_b32 v87, 0xffff0000, v99
 v_sub_f32 v13, 1.0, v26
 v_cmp_eq_u32 s[80:81], s84, v29
 v_cmp_eq_u32 s[82:83], s85, v29
 s_nop 0
 s_or_b64 vcc, s[80:81], s[82:83]
 s_cbranch_vccnz L_moe1
L_moe_ret1:
 v_mul_f32 v80, v13, v80
 v_mul_f32 v81, v13, v81
 v_mul_f32 v82, v13, v82
 v_mul_f32 v83, v13, v83
 v_mul_f32 v84, v13, v84
 v_mul_f32 v85, v13, v85
 v_mul_f32 v86, v13, v86
 v_mul_f32 v87, v13, v87
 s_cmp_lg_u32 s70, 0
 s_cbranch_scc1 L_rk3
 s_call_b64 s[36:37], L_rpoll
L_rk3:
 s_ff1_i32_b32 s71, s70
 s_bitset0_b32 s70, s71
 s_cmp_ge_u32 s71, 16
 s_cselect_b32 s72, s78, s77
 s_cselect_b32 s73, 0x8, 0
 s_cselect_b32 s87, 536870912, 0
 s_and_b32 s89, s71, 8
 s_lshl_b32 s89, s89, 10
 s_xor_b32 s72, s72, s89
 s_mul_i32 s71, s71, 262144
 s_add_u32 s71, s71, s72
 buffer_load_dwordx4 v[152:155], v7, s[8:11], s71 offen sc1
 s_or_b32 s69, s69, s73
 s_or_b32 s71, s71, s87
 buffer_load_dwordx4 v[156:159], v27, s[8:11], s71 offen sc1
 s_cmp_lg_u32 s70, 0
 s_cbranch_scc1 L_rk4
 s_call_b64 s[36:37], L_rpoll
L_rk4:
 s_ff1_i32_b32 s71, s70
 s_bitset0_b32 s70, s71
 s_cmp_ge_u32 s71, 16
 s_cselect_b32 s72, s78, s77
 s_cselect_b32 s73, 0x10, 0
 s_cselect_b32 s87, 536870912, 0
 s_and_b32 s89, s71, 8
 s_lshl_b32 s89, s89, 10
 s_xor_b32 s72, s72, s89
 s_mul_i32 s71, s71, 262144
 s_add_u32 s71, s71, s72
 buffer_load_dwordx4 v[160:163], v7, s[8:11], s71 offen sc1
 s_or_b32 s69, s69, s73
 s_or_b32 s71, s71, s87
 buffer_load_dwordx4 v[164:167], v27, s[8:11], s71 offen sc1
 s_cmp_lg_u32 s70, 0
 s_cbranch_scc1 L_rk5
 s_call_b64 s[36:37], L_rpoll
L_rk5:
 s_ff1_i32_b32 s71, s70
 s_bitset0_b32 s70, s71
 s_cmp_ge_u32 s71, 16
 s_cselect_b32 s72, s78, s77
 s_cselect_b32 s73, 0x20, 0
 s_cselect_b32 s87, 536870912, 0
 s_and_b32 s89, s71, 8
 s_lshl_b32 s89, s89, 10
 s_xor_b32 s72, s72, s89
 s_mul_i32 s71, s71, 262144
 s_add_u32 s71, s71, s72
 buffer_load_dwordx4 v[168:171], v7, s[8:11], s71 offen sc1
 s_or_b32 s69, s69, s73
 s_or_b32 s71, s71, s87
 buffer_load_dwordx4 v[172:175], v27, s[8:11], s71 offen sc1
 s_cmp_lg_u32 s70, 0
 s_cbranch_scc1 L_rk6
 s_call_b64 s[36:37], L_rpoll
L_rk6:
 s_ff1_i32_b32 s71, s70
 s_bitset0_b32 s70, s71
 s_cmp_ge_u32 s71, 16
 s_cselect_b32 s72, s78, s77
 s_cselect_b32 s73, 0x40, 0
 s_cselect_b32 s87, 536870912, 0
 s_and_b32 s89, s71, 8
 s_lshl_b32 s89, s89, 10
 s_xor_b32 s72, s72, s89
 s_mul_i32 s71, s71, 262144
 s_add_u32 s71, s71, s72
 buffer_load_dwordx4 v[176:179], v7, s[8:11], s71 offen sc1
 s_or_b32 s69, s69, s73
 s_or_b32 s71, s71, s87
 buffer_load_dwordx4 v[180:183], v27, s[8:11], s71 offen sc1
 s_cmp_lg_u32 s70, 0
 s_cbranch_scc1 L_rk7
 s_call_b64 s[36:37], L_rpoll
L_rk7:
 s_ff1_i32_b32 s71, s70
 s_bitset0_b32 s70, s71
 s_cmp_ge_u32 s71, 16
 s_cselect_b32 s72, s78, s77
 s_cselect_b32 s73, 0x80, 0
 s_cselect_b32 s87, 536870912, 0
 s_and_b32 s89, s71, 8
 s_lshl_b32 s89, s89, 10
 s_xor_b32 s72, s72, s89
 s_mul_i32 s71, s71, 262144
 s_add_u32 s71, s71, s72
 buffer_load_dwordx4 v[184:187], v7, s[8:11], s71 offen sc1
 s_or_b32 s69, s69, s73
 s_or_b32 s71, s71, s87
 buffer_load_dwordx4 v[188:191], v27, s[8:11], s71 offen sc1
 s_cmp_lg_u32 s70, 0
 s_cbranch_scc1 L_rk8
 s_call_b64 s[36:37], L_rpoll
L_rk8:
 s_ff1_i32_b32 s71, s70
 s_bitset0_b32 s70, s71
 s_cmp_ge_u32 s71, 16
 s_cselect_b32 s72, s78, s77
 s_cselect_b32 s73, 0x100, 0
 s_cselect_b32 s87, 536870912, 0
 s_and_b32 s89, s71, 8
 s_lshl_b32 s89, s89, 10
 s_xor_b32 s72, s72, s89
 s_mul_i32 s71, s71, 262144
 s_add_u32 s71, s71, s72
 buffer_load_dwordx4 v[192:195], v7, s[8:11], s71 offen sc1
 s_or_b32 s69, s69, s73
 s_or_b32 s71, s71, s87
 buffer_load_dwordx4 v[196:199], v27, s[8:11], s71 offen sc1
 s_waitcnt vmcnt(16)
 s_bitcmp1_b32 s69, 0
 s_cbranch_scc1 L_rx0
 v_dot2c_f32_bf16 v48, v128, v24
 v_dot2c_f32_bf16 v49, v128, v25
 v_dot2c_f32_bf16 v50, v129, v24
 v_dot2c_f32_bf16 v51, v129, v25
 v_dot2c_f32_bf16 v52, v130, v24
 v_dot2c_f32_bf16 v53, v130, v25
 v_dot2c_f32_bf16 v54, v131, v24
 v_dot2c_f32_bf16 v55, v131, v25
 v_dot2c_f32_bf16 v56, v132, v24
 v_dot2c_f32_bf16 v57, v132, v25
 v_dot2c_f32_bf16 v58, v133, v24
 v_dot2c_f32_bf16 v59, v133, v25
 v_dot2c_f32_bf16 v60, v134, v24
 v_dot2c_f32_bf16 v61, v134, v25
 v_dot2c_f32_bf16 v62, v135, v24
 v_dot2c_f32_bf16 v63, v135, v25
L_ry0:
 s_cmp_lg_u32 s70, 0
 s_cbranch_scc1 L_rk9
 s_call_b64 s[36:37], L_rpoll
L_rk9:
 s_ff1_i32_b32 s71, s70
 s_bitset0_b32 s70, s71
 s_cmp_ge_u32 s71, 16
 s_cselect_b32 s72, s78, s77
 s_cselect_b32 s73, 0x200, 0
 s_cselect_b32 s87, 536870912, 0
 s_and_b32 s89, s71, 8
 s_lshl_b32 s89, s89, 10
 s_xor_b32 s72, s72, s89
 s_mul_i32 s71, s71, 262144
 s_add_u32 s71, s71, s72
 buffer_load_dwordx4 v[200:203], v7, s[8:11], s71 offen sc1
 s_or_b32 s69, s69, s73
 s_or_b32 s71, s71, s87
 buffer_load_dwordx4 v[204:207], v27, s[8:11], s71 offen sc1
 s_waitcnt vmcnt(16)
 s_bitcmp1_b32 s69, 1
 s_cbranch_scc1 L_rx1
 v_dot2c_f32_bf16 v48, v136, v24
 v_dot2c_f32_bf16 v49, v136, v25
 v_dot2c_f32_bf16 v50, v137, v24
 v_dot2c_f32_bf16 v51, v137, v25
 v_dot2c_f32_bf16 v52, v138, v24
 v_dot2c_f32_bf16 v53, v138, v25
 v_dot2c_f32_bf16 v54, v139, v24
 v_dot2c_f32_bf16 v55, v139, v25
 v_dot2c_f32_bf16 v56, v140, v24
 v_dot2c_f32_bf16 v57, v140, v25
 v_dot2c_f32_bf16 v58, v141, v24
 v_dot2c_f32_bf16 v59, v141, v25
 v_dot2c_f32_bf16 v60, v142, v24
 v_dot2c_f32_bf16 v61, v142, v25
 v_dot2c_f32_bf16 v62, v143, v24
 v_dot2c_f32_bf16 v63, v143, v25
L_ry1:
 s_cmp_lg_u32 s70, 0
 s_cbranch_scc1 L_rk10
 s_call_b64 s[36:37], L_rpoll
L_rk10:
 s_ff1_i32_b32 s71, s70
 s_bitset0_b32 s70, s71
 s_cmp_ge_u32 s71, 16
 s_cselect_b32 s72, s78, s77
 s_cselect_b32 s73, 0x400, 0
 s_cselect_b32 s87, 536870912, 0
 s_and_b32 s89, s71, 8
 s_lshl_b32 s89, s89, 10
 s_xor_b32 s72, s72, s89
 s_mul_i32 s71, s71, 262144
 s_add_u32 s71, s71, s72
 buffer_load_dwordx4 v[208:211], v7, s[8:11], s71 offen sc1
 s_or_b32 s69, s69, s73
 s_or_b32 s71, s71, s87
 buffer_load_dwordx4 v[212:215], v27, s[8:11], s71 offen sc1
 s_waitcnt vmcnt(16)
 s_bitcmp1_b32 s69, 2
 s_cbranch_scc1 L_rx2
 v_dot2c_f32_bf16 v48, v144, v24
 v_dot2c_f32_bf16 v49, v144, v25
 v_dot2c_f32_bf16 v50, v145, v24
 v_dot2c_f32_bf16 v51, v145, v25
 v_dot2c_f32_bf16 v52, v146, v24
 v_dot2c_f32_bf16 v53, v146, v25
 v_dot2c_f32_bf16 v54, v147, v24
 v_dot2c_f32_bf16 v55, v147, v25
 v_dot2c_f32_bf16 v56, v148, v24
 v_dot2c_f32_bf16 v57, v148, v25
 v_dot2c_f32_bf16 v58, v149, v24
 v_dot2c_f32_bf16 v59, v149, v25
 v_dot2c_f32_bf16 v60, v150, v24
 v_dot2c_f32_bf16 v61, v150, v25
 v_dot2c_f32_bf16 v62, v151, v24
 v_dot2c_f32_bf16 v63, v151, v25
L_ry2:
 s_cmp_lg_u32 s70, 0
 s_cbranch_scc1 L_rk11
 s_call_b64 s[36:37], L_rpoll
L_rk11:
 s_ff1_i32_b32 s71, s70
 s_bitset0_b32 s70, s71
 s_cmp_ge_u32 s71, 16
 s_cselect_b32 s72, s78, s77
 s_cselect_b32 s73, 0x800, 0
 s_cselect_b32 s87, 536870912, 0
 s_and_b32 s89, s71, 8
 s_lshl_b32 s89, s89, 10
 s_xor_b32 s72, s72, s89
 s_mul_i32 s71, s71, 262144
 s_add_u32 s71, s71, s72
 buffer_load_dwordx4 v[216:219], v7, s[8:11], s71 offen sc1
 s_or_b32 s69, s69, s73
 s_or_b32 s71, s71, s87
 buffer_load_dwordx4 v[220:223], v27, s[8:11], s71 offen sc1
 s_waitcnt vmcnt(16)
 s_bitcmp1_b32 s69, 3
 s_cbranch_scc1 L_rx3
 v_dot2c_f32_bf16 v48, v152, v24
 v_dot2c_f32_bf16 v49, v152, v25
 v_dot2c_f32_bf16 v50, v153, v24
 v_dot2c_f32_bf16 v51, v153, v25
 v_dot2c_f32_bf16 v52, v154, v24
 v_dot2c_f32_bf16 v53, v154, v25
 v_dot2c_f32_bf16 v54, v155, v24
 v_dot2c_f32_bf16 v55, v155, v25
 v_dot2c_f32_bf16 v56, v156, v24
 v_dot2c_f32_bf16 v57, v156, v25
 v_dot2c_f32_bf16 v58, v157, v24
 v_dot2c_f32_bf16 v59, v157, v25
 v_dot2c_f32_bf16 v60, v158, v24
 v_dot2c_f32_bf16 v61, v158, v25
 v_dot2c_f32_bf16 v62, v159, v24
 v_dot2c_f32_bf16 v63, v159, v25
L_ry3:
 s_cmp_lg_u32 s70, 0
 s_cbranch_scc1 L_rk12
 s_call_b64 s[36:37], L_rpoll
L_rk12:
 s_ff1_i32_b32 s71, s70
 s_bitset0_b32 s70, s71
 s_cmp_ge_u32 s71, 16
 s_cselect_b32 s72, s78, s77
 s_cselect_b32 s73, 0x1000, 0
 s_cselect_b32 s87, 536870912, 0
 s_and_b32 s89, s71, 8
 s_lshl_b32 s89, s89, 10
 s_xor_b32 s72, s72, s89
 s_mul_i32 s71, s71, 262144
 s_add_u32 s71, s71, s72
 buffer_load_dwordx4 v[224:227], v7, s[8:11], s71 offen sc1
 s_or_b32 s69, s69, s73
 s_or_b32 s71, s71, s87
 buffer_load_dwordx4 v[228:231], v27, s[8:11], s71 offen sc1
 s_waitcnt vmcnt(16)
 s_bitcmp1_b32 s69, 4
 s_cbranch_scc1 L_rx4
 v_dot2c_f32_bf16 v48, v160, v24
 v_dot2c_f32_bf16 v49, v160, v25
 v_dot2c_f32_bf16 v50, v161, v24
 v_dot2c_f32_bf16 v51, v161, v25
 v_dot2c_f32_bf16 v52, v162, v24
 v_dot2c_f32_bf16 v53, v162, v25
 v_dot2c_f32_bf16 v54, v163, v24
 v_dot2c_f32_bf16 v55, v163, v25
 v_dot2c_f32_bf16 v56, v164, v24
 v_dot2c_f32_bf16 v57, v164, v25
 v_dot2c_f32_bf16 v58, v165, v24
 v_dot2c_f32_bf16 v59, v165, v25
 v_dot2c_f32_bf16 v60, v166, v24
 v_dot2c_f32_bf16 v61, v166, v25
 v_dot2c_f32_bf16 v62, v167, v24
 v_dot2c_f32_bf16 v63, v167, v25
L_ry4:
 s_cmp_lg_u32 s70, 0
 s_cbranch_scc1 L_rk13
 s_call_b64 s[36:37], L_rpoll
L_rk13:
 s_ff1_i32_b32 s71, s70
 s_bitset0_b32 s70, s71
 s_cmp_ge_u32 s71, 16
 s_cselect_b32 s72, s78, s77
 s_cselect_b32 s73, 0x2000, 0
 s_cselect_b32 s87, 536870912, 0
 s_and_b32 s89, s71, 8
 s_lshl_b32 s89, s89, 10
 s_xor_b32 s72, s72, s89
 s_mul_i32 s71, s71, 262144
 s_add_u32 s71, s71, s72
 buffer_load_dwordx4 v[232:235], v7, s[8:11], s71 offen sc1
 s_or_b32 s69, s69, s73
 s_or_b32 s71, s71, s87
 buffer_load_dwordx4 v[236:239], v27, s[8:11], s71 offen sc1
 s_waitcnt vmcnt(16)
 s_bitcmp1_b32 s69, 5
 s_cbranch_scc1 L_rx5
 v_dot2c_f32_bf16 v48, v168, v24
 v_dot2c_f32_bf16 v49, v168, v25
 v_dot2c_f32_bf16 v50, v169, v24
 v_dot2c_f32_bf16 v51, v169, v25
 v_dot2c_f32_bf16 v52, v170, v24
 v_dot2c_f32_bf16 v53, v170, v25
 v_dot2c_f32_bf16 v54, v171, v24
 v_dot2c_f32_bf16 v55, v171, v25
 v_dot2c_f32_bf16 v56, v172, v24
 v_dot2c_f32_bf16 v57, v172, v25
 v_dot2c_f32_bf16 v58, v173, v24
 v_dot2c_f32_bf16 v59, v173, v25
 v_dot2c_f32_bf16 v60, v174, v24
 v_dot2c_f32_bf16 v61, v174, v25
 v_dot2c_f32_bf16 v62, v175, v24
 v_dot2c_f32_bf16 v63, v175, v25
L_ry5:
 s_cmp_lg_u32 s70, 0
 s_cbranch_scc1 L_rk14
 s_call_b64 s[36:37], L_rpoll
L_rk14:
 s_ff1_i32_b32 s71, s70
 s_bitset0_b32 s70, s71
 s_cmp_ge_u32 s71, 16
 s_cselect_b32 s72, s78, s77
 s_cselect_b32 s73, 0x4000, 0
 s_cselect_b32 s87, 536870912, 0
 s_and_b32 s89, s71, 8
 s_lshl_b32 s89, s89, 10
 s_xor_b32 s72, s72, s89
 s_mul_i32 s71, s71, 262144
 s_add_u32 s71, s71, s72
 buffer_load_dwordx4 v[240:243], v7, s[8:11], s71 offen sc1
 s_or_b32 s69, s69, s73
 s_or_b32 s71, s71, s87
 buffer_load_dwordx4 v[244:247], v27, s[8:11], s71 offen sc1
 s_waitcnt vmcnt(16)
 s_bitcmp1_b32 s69, 6
 s_cbranch_scc1 L_rx6
 v_dot2c_f32_bf16 v48, v176, v24
 v_dot2c_f32_bf16 v49, v176, v25
 v_dot2c_f32_bf16 v50, v177, v24
 v_dot2c_f32_bf16 v51, v177, v25
 v_dot2c_f32_bf16 v52, v178, v24
 v_dot2c_f32_bf16 v53, v178, v25
 v_dot2c_f32_bf16 v54, v179, v24
 v_dot2c_f32_bf16 v55, v179, v25
 v_dot2c_f32_bf16 v56, v180, v24
 v_dot2c_f32_bf16 v57, v180, v25
 v_dot2c_f32_bf16 v58, v181, v24
 v_dot2c_f32_bf16 v59, v181, v25
 v_dot2c_f32_bf16 v60, v182, v24
 v_dot2c_f32_bf16 v61, v182, v25
 v_dot2c_f32_bf16 v62, v183, v24
 v_dot2c_f32_bf16 v63, v183, v25
L_ry6:
 s_cmp_lg_u32 s70, 0
 s_cbranch_scc1 L_rk15
 s_call_b64 s[36:37], L_rpoll
L_rk15:
 s_ff1_i32_b32 s71, s70
 s_bitset0_b32 s70, s71
 s_cmp_ge_u32 s71, 16
 s_cselect_b32 s72, s78, s77
 s_cselect_b32 s73, 0x8000, 0
 s_cselect_b32 s87, 536870912, 0
 s_and_b32 s89, s71, 8
 s_lshl_b32 s89, s89, 10
 s_xor_b32 s72, s72, s89
 s_mul_i32 s71, s71, 262144
 s_add_u32 s71, s71, s72
 buffer_load_dwordx4 v[248:251], v7, s[8:11], s71 offen sc1
 s_or_b32 s69, s69, s73
 s_or_b32 s71, s71, s87
 buffer_load_dwordx4 v[252:255], v27, s[8:11], s71 offen sc1
 s_waitcnt vmcnt(16)
 s_bitcmp1_b32 s69, 7
 s_cbranch_scc1 L_rx7
 v_dot2c_f32_bf16 v48, v184, v24
 v_dot2c_f32_bf16 v49, v184, v25
 v_dot2c_f32_bf16 v50, v185, v24
 v_dot2c_f32_bf16 v51, v185, v25
 v_dot2c_f32_bf16 v52, v186, v24
 v_dot2c_f32_bf16 v53, v186, v25
 v_dot2c_f32_bf16 v54, v187, v24
 v_dot2c_f32_bf16 v55, v187, v25
 v_dot2c_f32_bf16 v56, v188, v24
 v_dot2c_f32_bf16 v57, v188, v25
 v_dot2c_f32_bf16 v58, v189, v24
 v_dot2c_f32_bf16 v59, v189, v25
 v_dot2c_f32_bf16 v60, v190, v24
 v_dot2c_f32_bf16 v61, v190, v25
 v_dot2c_f32_bf16 v62, v191, v24
 v_dot2c_f32_bf16 v63, v191, v25
L_ry7:
 s_cmp_lg_u32 s70, 0
 s_cbranch_scc1 L_rk16
 s_call_b64 s[36:37], L_rpoll
L_rk16:
 s_ff1_i32_b32 s71, s70
 s_bitset0_b32 s70, s71
 s_cmp_ge_u32 s71, 16
 s_cselect_b32 s72, s78, s77
 s_cselect_b32 s73, 0x10000, 0
 s_cselect_b32 s87, 536870912, 0
 s_and_b32 s89, s71, 8
 s_lshl_b32 s89, s89, 10
 s_xor_b32 s72, s72, s89
 s_mul_i32 s71, s71, 262144
 s_add_u32 s71, s71, s72
 buffer_load_dwordx4 v[128:131], v7, s[8:11], s71 offen sc1
 s_or_b32 s69, s69, s73
 s_or_b32 s71, s71, s87
 buffer_load_dwordx4 v[132:135], v27, s[8:11], s71 offen sc1
 s_waitcnt vmcnt(16)
 s_bitcmp1_b32 s69, 8
 s_cbranch_scc1 L_rx8
 v_dot2c_f32_bf16 v48, v192, v24
 v_dot2c_f32_bf16 v49, v192, v25
 v_dot2c_f32_bf16 v50, v193, v24
 v_dot2c_f32_bf16 v51, v193, v25
 v_dot2c_f32_bf16 v52, v194, v24
 v_dot2c_f32_bf16 v53, v194, v25
 v_dot2c_f32_bf16 v54, v195, v24
 v_dot2c_f32_bf16 v55, v195, v25
 v_dot2c_f32_bf16 v56, v196, v24
 v_dot2c_f32_bf16 v57, v196, v25
 v_dot2c_f32_bf16 v58, v197, v24
 v_dot2c_f32_bf16 v59, v197, v25
 v_dot2c_f32_bf16 v60, v198, v24
 v_dot2c_f32_bf16 v61, v198, v25
 v_dot2c_f32_bf16 v62, v199, v24
 v_dot2c_f32_bf16 v63, v199, v25
L_ry8:
 s_cmp_lg_u32 s70, 0
 s_cbranch_scc1 L_rk17
 s_call_b64 s[36:37], L_rpoll
L_rk17:
 s_ff1_i32_b32 s71, s70
 s_bitset0_b32 s70, s71
 s_cmp_ge_u32 s71, 16
 s_cselect_b32 s72, s78, s77
 s_cselect_b32 s73, 0x20000, 0
 s_cselect_b32 s87, 536870912, 0
 s_and_b32 s89, s71, 8
 s_lshl_b32 s89, s89, 10
 s_xor_b32 s72, s72, s89
 s_mul_i32 s71, s71, 262144
 s_add_u32 s71, s71, s72
 buffer_load_dwordx4 v[136:139], v7, s[8:11], s71 offen sc1
 s_or_b32 s69, s69, s73
 s_or_b32 s71, s71, s87
 buffer_load_dwordx4 v[140:143], v27, s[8:11], s71 offen sc1
 s_waitcnt vmcnt(16)
 s_bitcmp1_b32 s69, 9
 s_cbranch_scc1 L_rx9
 v_dot2c_f32_bf16 v48, v200, v24
 v_dot2c_f32_bf16 v49, v200, v25
 v_dot2c_f32_bf16 v50, v201, v24
 v_dot2c_f32_bf16 v51, v201, v25
 v_dot2c_f32_bf16 v52, v202, v24
 v_dot2c_f32_bf16 v53, v202, v25
 v_dot2c_f32_bf16 v54, v203, v24
 v_dot2c_f32_bf16 v55, v203, v25
 v_dot2c_f32_bf16 v56, v204, v24
 v_dot2c_f32_bf16 v57, v204, v25
 v_dot2c_f32_bf16 v58, v205, v24
 v_dot2c_f32_bf16 v59, v205, v25
 v_dot2c_f32_bf16 v60, v206, v24
 v_dot2c_f32_bf16 v61, v206, v25
 v_dot2c_f32_bf16 v62, v207, v24
 v_dot2c_f32_bf16 v63, v207, v25
L_ry9:
 s_cmp_lg_u32 s70, 0
 s_cbranch_scc1 L_rk18
 s_call_b64 s[36:37], L_rpoll
L_rk18:
 s_ff1_i32_b32 s71, s70
 s_bitset0_b32 s70, s71
 s_cmp_ge_u32 s71, 16
 s_cselect_b32 s72, s78, s77
 s_cselect_b32 s73, 0x40000, 0
 s_cselect_b32 s87, 536870912, 0
 s_and_b32 s89, s71, 8
 s_lshl_b32 s89, s89, 10
 s_xor_b32 s72, s72, s89
 s_mul_i32 s71, s71, 262144
 s_add_u32 s71, s71, s72
 buffer_load_dwordx4 v[144:147], v7, s[8:11], s71 offen sc1
 s_or_b32 s69, s69, s73
 s_or_b32 s71, s71, s87
 buffer_load_dwordx4 v[148:151], v27, s[8:11], s71 offen sc1
 s_waitcnt vmcnt(16)
 s_bitcmp1_b32 s69, 10
 s_cbranch_scc1 L_rx10
 v_dot2c_f32_bf16 v48, v208, v24
 v_dot2c_f32_bf16 v49, v208, v25
 v_dot2c_f32_bf16 v50, v209, v24
 v_dot2c_f32_bf16 v51, v209, v25
 v_dot2c_f32_bf16 v52, v210, v24
 v_dot2c_f32_bf16 v53, v210, v25
 v_dot2c_f32_bf16 v54, v211, v24
 v_dot2c_f32_bf16 v55, v211, v25
 v_dot2c_f32_bf16 v56, v212, v24
 v_dot2c_f32_bf16 v57, v212, v25
 v_dot2c_f32_bf16 v58, v213, v24
 v_dot2c_f32_bf16 v59, v213, v25
 v_dot2c_f32_bf16 v60, v214, v24
 v_dot2c_f32_bf16 v61, v214, v25
 v_dot2c_f32_bf16 v62, v215, v24
 v_dot2c_f32_bf16 v63, v215, v25
L_ry10:
 s_cmp_lg_u32 s70, 0
 s_cbranch_scc1 L_rk19
 s_call_b64 s[36:37], L_rpoll
L_rk19:
 s_ff1_i32_b32 s71, s70
 s_bitset0_b32 s70, s71
 s_cmp_ge_u32 s71, 16
 s_cselect_b32 s72, s78, s77
 s_cselect_b32 s73, 0x80000, 0
 s_cselect_b32 s87, 536870912, 0
 s_and_b32 s89, s71, 8
 s_lshl_b32 s89, s89, 10
 s_xor_b32 s72, s72, s89
 s_mul_i32 s71, s71, 262144
 s_add_u32 s71, s71, s72
 buffer_load_dwordx4 v[152:155], v7, s[8:11], s71 offen sc1
 s_or_b32 s69, s69, s73
 s_or_b32 s71, s71, s87
 buffer_load_dwordx4 v[156:159], v27, s[8:11], s71 offen sc1
 s_waitcnt vmcnt(16)
 s_bitcmp1_b32 s69, 11
 s_cbranch_scc1 L_rx11
 v_dot2c_f32_bf16 v48, v216, v24
 v_dot2c_f32_bf16 v49, v216, v25
 v_dot2c_f32_bf16 v50, v217, v24
 v_dot2c_f32_bf16 v51, v217, v25
 v_dot2c_f32_bf16 v52, v218, v24
 v_dot2c_f32_bf16 v53, v218, v25
 v_dot2c_f32_bf16 v54, v219, v24
 v_dot2c_f32_bf16 v55, v219, v25
 v_dot2c_f32_bf16 v56, v220, v24
 v_dot2c_f32_bf16 v57, v220, v25
 v_dot2c_f32_bf16 v58, v221, v24
 v_dot2c_f32_bf16 v59, v221, v25
 v_dot2c_f32_bf16 v60, v222, v24
 v_dot2c_f32_bf16 v61, v222, v25
 v_dot2c_f32_bf16 v62, v223, v24
 v_dot2c_f32_bf16 v63, v223, v25
L_ry11:
 s_cmp_lg_u32 s70, 0
 s_cbranch_scc1 L_rk20
 s_call_b64 s[36:37], L_rpoll
L_rk20:
 s_ff1_i32_b32 s71, s70
 s_bitset0_b32 s70, s71
 s_cmp_ge_u32 s71, 16
 s_cselect_b32 s72, s78, s77
 s_cselect_b32 s73, 0x100000, 0
 s_cselect_b32 s87, 536870912, 0
 s_and_b32 s89, s71, 8
 s_lshl_b32 s89, s89, 10
 s_xor_b32 s72, s72, s89
 s_mul_i32 s71, s71, 262144
 s_add_u32 s71, s71, s72
 buffer_load_dwordx4 v[160:163], v7, s[8:11], s71 offen sc1
 s_or_b32 s69, s69, s73
 s_or_b32 s71, s71, s87
 buffer_load_dwordx4 v[164:167], v27, s[8:11], s71 offen sc1
 s_waitcnt vmcnt(16)
 s_bitcmp1_b32 s69, 12
 s_cbranch_scc1 L_rx12
 v_dot2c_f32_bf16 v48, v224, v24
 v_dot2c_f32_bf16 v49, v224, v25
 v_dot2c_f32_bf16 v50, v225, v24
 v_dot2c_f32_bf16 v51, v225, v25
 v_dot2c_f32_bf16 v52, v226, v24
 v_dot2c_f32_bf16 v53, v226, v25
 v_dot2c_f32_bf16 v54, v227, v24
 v_dot2c_f32_bf16 v55, v227, v25
 v_dot2c_f32_bf16 v56, v228, v24
 v_dot2c_f32_bf16 v57, v228, v25
 v_dot2c_f32_bf16 v58, v229, v24
 v_dot2c_f32_bf16 v59, v229, v25
 v_dot2c_f32_bf16 v60, v230, v24
 v_dot2c_f32_bf16 v61, v230, v25
 v_dot2c_f32_bf16 v62, v231, v24
 v_dot2c_f32_bf16 v63, v231, v25
L_ry12:
 s_cmp_lg_u32 s70, 0
 s_cbranch_scc1 L_rk21
 s_call_b64 s[36:37], L_rpoll
L_rk21:
 s_ff1_i32_b32 s71, s70
 s_bitset0_b32 s70, s71
 s_cmp_ge_u32 s71, 16
 s_cselect_b32 s72, s78, s77
 s_cselect_b32 s73, 0x200000, 0
 s_cselect_b32 s87, 536870912, 0
 s_and_b32 s89, s71, 8
 s_lshl_b32 s89, s89, 10
 s_xor_b32 s72, s72, s89
 s_mul_i32 s71, s71, 262144
 s_add_u32 s71, s71, s72
 buffer_load_dwordx4 v[168:171], v7, s[8:11], s71 offen sc1
 s_or_b32 s69, s69, s73
 s_or_b32 s71, s71, s87
 buffer_load_dwordx4 v[172:175], v27, s[8:11], s71 offen sc1
 s_waitcnt vmcnt(16)
 s_bitcmp1_b32 s69, 13
 s_cbranch_scc1 L_rx13
 v_dot2c_f32_bf16 v48, v232, v24
 v_dot2c_f32_bf16 v49, v232, v25
 v_dot2c_f32_bf16 v50, v233, v24
 v_dot2c_f32_bf16 v51, v233, v25
 v_dot2c_f32_bf16 v52, v234, v24
 v_dot2c_f32_bf16 v53, v234, v25
 v_dot2c_f32_bf16 v54, v235, v24
 v_dot2c_f32_bf16 v55, v235, v25
 v_dot2c_f32_bf16 v56, v236, v24
 v_dot2c_f32_bf16 v57, v236, v25
 v_dot2c_f32_bf16 v58, v237, v24
 v_dot2c_f32_bf16 v59, v237, v25
 v_dot2c_f32_bf16 v60, v238, v24
 v_dot2c_f32_bf16 v61, v238, v25
 v_dot2c_f32_bf16 v62, v239, v24
 v_dot2c_f32_bf16 v63, v239, v25
L_ry13:
 s_cmp_lg_u32 s70, 0
 s_cbranch_scc1 L_rk22
 s_call_b64 s[36:37], L_rpoll
L_rk22:
 s_ff1_i32_b32 s71, s70
 s_bitset0_b32 s70, s71
 s_cmp_ge_u32 s71, 16
 s_cselect_b32 s72, s78, s77
 s_cselect_b32 s73, 0x400000, 0
 s_cselect_b32 s87, 536870912, 0
 s_and_b32 s89, s71, 8
 s_lshl_b32 s89, s89, 10
 s_xor_b32 s72, s72, s89
 s_mul_i32 s71, s71, 262144
 s_add_u32 s71, s71, s72
 buffer_load_dwordx4 v[176:179], v7, s[8:11], s71 offen sc1
 s_or_b32 s69, s69, s73
 s_or_b32 s71, s71, s87
 buffer_load_dwordx4 v[180:183], v27, s[8:11], s71 offen sc1
 s_waitcnt vmcnt(16)
 s_bitcmp1_b32 s69, 14
 s_cbranch_scc1 L_rx14
 v_dot2c_f32_bf16 v48, v240, v24
 v_dot2c_f32_bf16 v49, v240, v25
 v_dot2c_f32_bf16 v50, v241, v24
 v_dot2c_f32_bf16 v51, v241, v25
 v_dot2c_f32_bf16 v52, v242, v24
 v_dot2c_f32_bf16 v53, v242, v25
 v_dot2c_f32_bf16 v54, v243, v24
 v_dot2c_f32_bf16 v55, v243, v25
 v_dot2c_f32_bf16 v56, v244, v24
 v_dot2c_f32_bf16 v57, v244, v25
 v_dot2c_f32_bf16 v58, v245, v24
 v_dot2c_f32_bf16 v59, v245, v25
 v_dot2c_f32_bf16 v60, v246, v24
 v_dot2c_f32_bf16 v61, v246, v25
 v_dot2c_f32_bf16 v62, v247, v24
 v_dot2c_f32_bf16 v63, v247, v25
L_ry14:
 s_cmp_lg_u32 s70, 0
 s_cbranch_scc1 L_rk23
 s_call_b64 s[36:37], L_rpoll
L_rk23:
 s_ff1_i32_b32 s71, s70
 s_bitset0_b32 s70, s71
 s_cmp_ge_u32 s71, 16
 s_cselect_b32 s72, s78, s77
 s_cselect_b32 s73, 0x800000, 0
 s_cselect_b32 s87, 536870912, 0
 s_and_b32 s89, s71, 8
 s_lshl_b32 s89, s89, 10
 s_xor_b32 s72, s72, s89
 s_mul_i32 s71, s71, 262144
 s_add_u32 s71, s71, s72
 buffer_load_dwordx4 v[184:187], v7, s[8:11], s71 offen sc1
 s_or_b32 s69, s69, s73
 s_or_b32 s71, s71, s87
 buffer_load_dwordx4 v[188:191], v27, s[8:11], s71 offen sc1
 s_waitcnt vmcnt(16)
 s_bitcmp1_b32 s69, 15
 s_cbranch_scc1 L_rx15
 v_dot2c_f32_bf16 v48, v248, v24
 v_dot2c_f32_bf16 v49, v248, v25
 v_dot2c_f32_bf16 v50, v249, v24
 v_dot2c_f32_bf16 v51, v249, v25
 v_dot2c_f32_bf16 v52, v250, v24
 v_dot2c_f32_bf16 v53, v250, v25
 v_dot2c_f32_bf16 v54, v251, v24
 v_dot2c_f32_bf16 v55, v251, v25
 v_dot2c_f32_bf16 v56, v252, v24
 v_dot2c_f32_bf16 v57, v252, v25
 v_dot2c_f32_bf16 v58, v253, v24
 v_dot2c_f32_bf16 v59, v253, v25
 v_dot2c_f32_bf16 v60, v254, v24
 v_dot2c_f32_bf16 v61, v254, v25
 v_dot2c_f32_bf16 v62, v255, v24
 v_dot2c_f32_bf16 v63, v255, v25
L_ry15:
 s_cmp_lg_u32 s70, 0
 s_cbranch_scc1 L_rk24
 s_call_b64 s[36:37], L_rpoll
L_rk24:
 s_ff1_i32_b32 s71, s70
 s_bitset0_b32 s70, s71
 s_cmp_ge_u32 s71, 16
 s_cselect_b32 s72, s78, s77
 s_cselect_b32 s73, 0x1000000, 0
 s_cselect_b32 s87, 536870912, 0
 s_and_b32 s89, s71, 8
 s_lshl_b32 s89, s89, 10
 s_xor_b32 s72, s72, s89
 s_mul_i32 s71, s71, 262144
 s_add_u32 s71, s71, s72
 buffer_load_dwordx4 v[192:195], v7, s[8:11], s71 offen sc1
 s_or_b32 s69, s69, s73
 s_or_b32 s71, s71, s87
 buffer_load_dwordx4 v[196:199], v27, s[8:11], s71 offen sc1
 s_waitcnt vmcnt(16)
 s_bitcmp0_b32 s69, 16
 s_cbranch_scc1 L_rx16
 v_dot2c_f32_bf16 v64, v128, v24
 v_dot2c_f32_bf16 v65, v128, v25
 v_dot2c_f32_bf16 v66, v129, v24
 v_dot2c_f32_bf16 v67, v129, v25
 v_dot2c_f32_bf16 v68, v130, v24
 v_dot2c_f32_bf16 v69, v130, v25
 v_dot2c_f32_bf16 v70, v131, v24
 v_dot2c_f32_bf16 v71, v131, v25
L_ry16:
 s_cmp_lg_u32 s70, 0
 s_cbranch_scc1 L_rk25
 s_call_b64 s[36:37], L_rpoll
L_rk25:
 s_ff1_i32_b32 s71, s70
 s_bitset0_b32 s70, s71
 s_cmp_ge_u32 s71, 16
 s_cselect_b32 s72, s78, s77
 s_cselect_b32 s73, 0x2000000, 0
 s_cselect_b32 s87, 536870912, 0
 s_and_b32 s89, s71, 8
 s_lshl_b32 s89, s89, 10
 s_xor_b32 s72, s72, s89
 s_mul_i32 s71, s71, 262144
 s_add_u32 s71, s71, s72
 buffer_load_dwordx4 v[200:203], v7, s[8:11], s71 offen sc1
 s_or_b32 s69, s69, s73
 s_or_b32 s71, s71, s87
 buffer_load_dwordx4 v[204:207], v27, s[8:11], s71 offen sc1
 s_waitcnt vmcnt(16)
 s_bitcmp0_b32 s69, 17
 s_cbranch_scc1 L_rx17
 v_dot2c_f32_bf16 v64, v136, v24
 v_dot2c_f32_bf16 v65, v136, v25
 v_dot2c_f32_bf16 v66, v137, v24
 v_dot2c_f32_bf16 v67, v137, v25
 v_dot2c_f32_bf16 v68, v138, v24
 v_dot2c_f32_bf16 v69, v138, v25
 v_dot2c_f32_bf16 v70, v139, v24
 v_dot2c_f32_bf16 v71, v139, v25
L_ry17:
 s_cmp_lg_u32 s70, 0
 s_cbranch_scc1 L_rk26
 s_call_b64 s[36:37], L_rpoll
L_rk26:
 s_ff1_i32_b32 s71, s70
 s_bitset0_b32 s70, s71
 s_cmp_ge_u32 s71, 16
 s_cselect_b32 s72, s78, s77
 s_cselect_b32 s73, 0x4000000, 0
 s_cselect_b32 s87, 536870912, 0
 s_and_b32 s89, s71, 8
 s_lshl_b32 s89, s89, 10
 s_xor_b32 s72, s72, s89
 s_mul_i32 s71, s71, 262144
 s_add_u32 s71, s71, s72
 buffer_load_dwordx4 v[208:211], v7, s[8:11], s71 offen sc1
 s_or_b32 s69, s69, s73
 s_or_b32 s71, s71, s87
 buffer_load_dwordx4 v[212:215], v27, s[8:11], s71 offen sc1
 s_waitcnt vmcnt(16)
 s_bitcmp0_b32 s69, 18
 s_cbranch_scc1 L_rx18
 v_dot2c_f32_bf16 v64, v144, v24
 v_dot2c_f32_bf16 v65, v144, v25
 v_dot2c_f32_bf16 v66, v145, v24
 v_dot2c_f32_bf16 v67, v145, v25
 v_dot2c_f32_bf16 v68, v146, v24
 v_dot2c_f32_bf16 v69, v146, v25
 v_dot2c_f32_bf16 v70, v147, v24
 v_dot2c_f32_bf16 v71, v147, v25
L_ry18:
 s_cmp_lg_u32 s70, 0
 s_cbranch_scc1 L_rk27
 s_call_b64 s[36:37], L_rpoll
L_rk27:
 s_ff1_i32_b32 s71, s70
 s_bitset0_b32 s70, s71
 s_cmp_ge_u32 s71, 16
 s_cselect_b32 s72, s78, s77
 s_cselect_b32 s73, 0x8000000, 0
 s_cselect_b32 s87, 536870912, 0
 s_and_b32 s89, s71, 8
 s_lshl_b32 s89, s89, 10
 s_xor_b32 s72, s72, s89
 s_mul_i32 s71, s71, 262144
 s_add_u32 s71, s71, s72
 buffer_load_dwordx4 v[216:219], v7, s[8:11], s71 offen sc1
 s_or_b32 s69, s69, s73
 s_or_b32 s71, s71, s87
 buffer_load_dwordx4 v[220:223], v27, s[8:11], s71 offen sc1
 s_waitcnt vmcnt(16)
 s_bitcmp0_b32 s69, 19
 s_cbranch_scc1 L_rx19
 v_dot2c_f32_bf16 v64, v152, v24
 v_dot2c_f32_bf16 v65, v152, v25
 v_dot2c_f32_bf16 v66, v153, v24
 v_dot2c_f32_bf16 v67, v153, v25
 v_dot2c_f32_bf16 v68, v154, v24
 v_dot2c_f32_bf16 v69, v154, v25
 v_dot2c_f32_bf16 v70, v155, v24
 v_dot2c_f32_bf16 v71, v155, v25
L_ry19:
 s_and_b32 s71, s69, 0xfffff
 s_bcnt1_i32_b32 s71, s71
 s_cmp_eq_u32 s71, 4
 s_cselect_b32 s66, 1, 0
 s_cbranch_scc0 L_rne
 v_fmac_f32 v32, v15, v48
 v_fmac_f32 v33, v15, v49
 v_fmac_f32 v34, v15, v50
 v_fmac_f32 v35, v15, v51
 v_fmac_f32 v36, v15, v52
 v_fmac_f32 v37, v15, v53
 v_fmac_f32 v38, v15, v54
 v_fmac_f32 v39, v15, v55
 v_cvt_pk_bf16_f32 v16, v32, v33
 v_cvt_pk_bf16_f32 v17, v34, v35
 v_cvt_pk_bf16_f32 v18, v36, v37
 v_cvt_pk_bf16_f32 v19, v38, v39
 buffer_store_dwordx4 v[16:19], v12, s[52:55], s75 offen sc1
 v_fmac_f32 v40, v15, v56
 v_fmac_f32 v41, v15, v57
 v_fmac_f32 v42, v15, v58
 v_fmac_f32 v43, v15, v59
 v_fmac_f32 v44, v15, v60
 v_fmac_f32 v45, v15, v61
 v_fmac_f32 v46, v15, v62
 v_fmac_f32 v47, v15, v63
 v_cvt_pk_bf16_f32 v20, v40, v41
 v_cvt_pk_bf16_f32 v21, v42, v43
 v_cvt_pk_bf16_f32 v22, v44, v45
 v_cvt_pk_bf16_f32 v23, v46, v47
 buffer_store_dwordx4 v[20:23], v12, s[52:55], s76 offen sc1
L_rne:
 s_cmp_lg_u32 s70, 0
 s_cbranch_scc1 L_rk28
 s_call_b64 s[36:37], L_rpoll
L_rk28:
 s_ff1_i32_b32 s71, s70
 s_bitset0_b32 s70, s71
 s_cmp_ge_u32 s71, 16
 s_cselect_b32 s72, s78, s77
 s_cselect_b32 s73, 0x10000000, 0
 s_cselect_b32 s87, 536870912, 0
 s_and_b32 s89, s71, 8
 s_lshl_b32 s89, s89, 10
 s_xor_b32 s72, s72, s89
 s_mul_i32 s71, s71, 262144
 s_add_u32 s71, s71, s72
 buffer_load_dwordx4 v[224:227], v7, s[8:11], s71 offen sc1
 s_or_b32 s69, s69, s73
 s_or_b32 s71, s71, s87
 buffer_load_dwordx4 v[228:231], v27, s[8:11], s71 offen sc1
 s_waitcnt vmcnt(16)
 s_bitcmp0_b32 s69, 20
 s_cbranch_scc1 L_rx20
 v_dot2c_f32_bf16 v64, v160, v24
 v_dot2c_f32_bf16 v65, v160, v25
 v_dot2c_f32_bf16 v66, v161, v24
 v_dot2c_f32_bf16 v67, v161, v25
 v_dot2c_f32_bf16 v68, v162, v24
 v_dot2c_f32_bf16 v69, v162, v25
 v_dot2c_f32_bf16 v70, v163, v24
 v_dot2c_f32_bf16 v71, v163, v25
L_ry20:
 s_cmp_lg_u32 s70, 0
 s_cbranch_scc1 L_rk29
 s_call_b64 s[36:37], L_rpoll
L_rk29:
 s_ff1_i32_b32 s71, s70
 s_bitset0_b32 s70, s71
 s_cmp_ge_u32 s71, 16
 s_cselect_b32 s72, s78, s77
 s_cselect_b32 s73, 0x20000000, 0
 s_cselect_b32 s87, 536870912, 0
 s_and_b32 s89, s71, 8
 s_lshl_b32 s89, s89, 10
 s_xor_b32 s72, s72, s89
 s_mul_i32 s71, s71, 262144
 s_add_u32 s71, s71, s72
 buffer_load_dwordx4 v[232:235], v7, s[8:11], s71 offen sc1
 s_or_b32 s69, s69, s73
 s_or_b32 s71, s71, s87
 buffer_load_dwordx4 v[236:239], v27, s[8:11], s71 offen sc1
 s_waitcnt vmcnt(16)
 s_bitcmp0_b32 s69, 21
 s_cbranch_scc1 L_rx21
 v_dot2c_f32_bf16 v64, v168, v24
 v_dot2c_f32_bf16 v65, v168, v25
 v_dot2c_f32_bf16 v66, v169, v24
 v_dot2c_f32_bf16 v67, v169, v25
 v_dot2c_f32_bf16 v68, v170, v24
 v_dot2c_f32_bf16 v69, v170, v25
 v_dot2c_f32_bf16 v70, v171, v24
 v_dot2c_f32_bf16 v71, v171, v25
L_ry21:
 s_cmp_lg_u32 s70, 0
 s_cbranch_scc1 L_rk30
 s_call_b64 s[36:37], L_rpoll
L_rk30:
 s_ff1_i32_b32 s71, s70
 s_bitset0_b32 s70, s71
 s_cmp_ge_u32 s71, 16
 s_cselect_b32 s72, s78, s77
 s_cselect_b32 s73, 0x40000000, 0
 s_cselect_b32 s87, 536870912, 0
 s_and_b32 s89, s71, 8
 s_lshl_b32 s89, s89, 10
 s_xor_b32 s72, s72, s89
 s_mul_i32 s71, s71, 262144
 s_add_u32 s71, s71, s72
 buffer_load_dwordx4 v[240:243], v7, s[8:11], s71 offen sc1
 s_or_b32 s69, s69, s73
 s_or_b32 s71, s71, s87
 buffer_load_dwordx4 v[244:247], v27, s[8:11], s71 offen sc1
 s_waitcnt vmcnt(16)
 s_bitcmp0_b32 s69, 22
 s_cbranch_scc1 L_rx22
 v_dot2c_f32_bf16 v64, v176, v24
 v_dot2c_f32_bf16 v65, v176, v25
 v_dot2c_f32_bf16 v66, v177, v24
 v_dot2c_f32_bf16 v67, v177, v25
 v_dot2c_f32_bf16 v68, v178, v24
 v_dot2c_f32_bf16 v69, v178, v25
 v_dot2c_f32_bf16 v70, v179, v24
 v_dot2c_f32_bf16 v71, v179, v25
L_ry22:
 s_cmp_lg_u32 s70, 0
 s_cbranch_scc1 L_rk31
 s_call_b64 s[36:37], L_rpoll
L_rk31:
 s_ff1_i32_b32 s71, s70
 s_bitset0_b32 s70, s71
 s_cmp_ge_u32 s71, 16
 s_cselect_b32 s72, s78, s77
 s_cselect_b32 s73, 0x80000000, 0
 s_cselect_b32 s87, 536870912, 0
 s_and_b32 s89, s71, 8
 s_lshl_b32 s89, s89, 10
 s_xor_b32 s72, s72, s89
 s_mul_i32 s71, s71, 262144
 s_add_u32 s71, s71, s72
 buffer_load_dwordx4 v[248:251], v7, s[8:11], s71 offen sc1
 s_or_b32 s69, s69, s73
 s_or_b32 s71, s71, s87
 buffer_load_dwordx4 v[252:255], v27, s[8:11], s71 offen sc1
 s_waitcnt vmcnt(16)
 s_bitcmp0_b32 s69, 23
 s_cbranch_scc1 L_rx23
 v_dot2c_f32_bf16 v64, v184, v24
 v_dot2c_f32_bf16 v65, v184, v25
 v_dot2c_f32_bf16 v66, v185, v24
 v_dot2c_f32_bf16 v67, v185, v25
 v_dot2c_f32_bf16 v68, v186, v24
 v_dot2c_f32_bf16 v69, v186, v25
 v_dot2c_f32_bf16 v70, v187, v24
 v_dot2c_f32_bf16 v71, v187, v25
L_ry23:
 s_waitcnt vmcnt(14)
 s_bitcmp0_b32 s69, 24
 s_cbranch_scc1 L_rx24
 v_dot2c_f32_bf16 v64, v192, v24
 v_dot2c_f32_bf16 v65, v192, v25
 v_dot2c_f32_bf16 v66, v193, v24
 v_dot2c_f32_bf16 v67, v193, v25
 v_dot2c_f32_bf16 v68, v194, v24
 v_dot2c_f32_bf16 v69, v194, v25
 v_dot2c_f32_bf16 v70, v195, v24
 v_dot2c_f32_bf16 v71, v195, v25
L_ry24:
 s_waitcnt vmcnt(12)
 s_bitcmp0_b32 s69, 25
 s_cbranch_scc1 L_rx25
 v_dot2c_f32_bf16 v64, v200, v24
 v_dot2c_f32_bf16 v65, v200, v25
 v_dot2c_f32_bf16 v66, v201, v24
 v_dot2c_f32_bf16 v67, v201, v25
 v_dot2c_f32_bf16 v68, v202, v24
 v_dot2c_f32_bf16 v69, v202, v25
 v_dot2c_f32_bf16 v70, v203, v24
 v_dot2c_f32_bf16 v71, v203, v25
L_ry25:
 s_waitcnt vmcnt(10)
 s_bitcmp0_b32 s69, 26
 s_cbranch_scc1 L_rx26
 v_dot2c_f32_bf16 v64, v208, v24
 v_dot2c_f32_bf16 v65, v208, v25
 v_dot2c_f32_bf16 v66, v209, v24
 v_dot2c_f32_bf16 v67, v209, v25
 v_dot2c_f32_bf16 v68, v210, v24
 v_dot2c_f32_bf16 v69, v210, v25
 v_dot2c_f32_bf16 v70, v211, v24
 v_dot2c_f32_bf16 v71, v211, v25
L_ry26:
 s_waitcnt vmcnt(8)
 s_bitcmp0_b32 s69, 27
 s_cbranch_scc1 L_rx27
 v_dot2c_f32_bf16 v64, v216, v24
 v_dot2c_f32_bf16 v65, v216, v25
 v_dot2c_f32_bf16 v66, v217, v24
 v_dot2c_f32_bf16 v67, v217, v25
 v_dot2c_f32_bf16 v68, v218, v24
 v_dot2c_f32_bf16 v69, v218, v25
 v_dot2c_f32_bf16 v70, v219, v24
 v_dot2c_f32_bf16 v71, v219, v25
L_ry27:
 s_waitcnt vmcnt(6)
 s_bitcmp0_b32 s69, 28
 s_cbranch_scc1 L_rx28
 v_dot2c_f32_bf16 v64, v224, v24
 v_dot2c_f32_bf16 v65, v224, v25
 v_dot2c_f32_bf16 v66, v225, v24
 v_dot2c_f32_bf16 v67, v225, v25
 v_dot2c_f32_bf16 v68, v226, v24
 v_dot2c_f32_bf16 v69, v226, v25
 v_dot2c_f32_bf16 v70, v227, v24
 v_dot2c_f32_bf16 v71, v227, v25
L_ry28:
 s_waitcnt vmcnt(4)
 s_bitcmp0_b32 s69, 29
 s_cbranch_scc1 L_rx29
 v_dot2c_f32_bf16 v64, v232, v24
 v_dot2c_f32_bf16 v65, v232, v25
 v_dot2c_f32_bf16 v66, v233, v24
 v_dot2c_f32_bf16 v67, v233, v25
 v_dot2c_f32_bf16 v68, v234, v24
 v_dot2c_f32_bf16 v69, v234, v25
 v_dot2c_f32_bf16 v70, v235, v24
 v_dot2c_f32_bf16 v71, v235, v25
L_ry29:
 s_waitcnt vmcnt(2)
 s_bitcmp0_b32 s69, 30
 s_cbranch_scc1 L_rx30
 v_dot2c_f32_bf16 v64, v240, v24
 v_dot2c_f32_bf16 v65, v240, v25
 v_dot2c_f32_bf16 v66, v241, v24
 v_dot2c_f32_bf16 v67, v241, v25
 v_dot2c_f32_bf16 v68, v242, v24
 v_dot2c_f32_bf16 v69, v242, v25
 v_dot2c_f32_bf16 v70, v243, v24
 v_dot2c_f32_bf16 v71, v243, v25
L_ry30:
 s_waitcnt vmcnt(0)
 s_bitcmp0_b32 s69, 31
 s_cbranch_scc1 L_rx31
 v_dot2c_f32_bf16 v64, v248, v24
 v_dot2c_f32_bf16 v65, v248, v25
 v_dot2c_f32_bf16 v66, v249, v24
 v_dot2c_f32_bf16 v67, v249, v25
 v_dot2c_f32_bf16 v68, v250, v24
 v_dot2c_f32_bf16 v69, v250, v25
 v_dot2c_f32_bf16 v70, v251, v24
 v_dot2c_f32_bf16 v71, v251, v25
L_ry31:
 s_nop 1
 v_fmac_f32 v80, v26, v64
 v_fmac_f32 v81, v26, v65
 v_fmac_f32 v82, v26, v66
 v_fmac_f32 v83, v26, v67
 v_fmac_f32 v84, v26, v68
 v_fmac_f32 v85, v26, v69
 v_fmac_f32 v86, v26, v70
 v_fmac_f32 v87, v26, v71
 v_cvt_pk_bf16_f32 v96, v80, v81
 v_cvt_pk_bf16_f32 v97, v82, v83
 v_cvt_pk_bf16_f32 v98, v84, v85
 v_cvt_pk_bf16_f32 v99, v86, v87
 buffer_store_dwordx4 v[96:99], v28, s[52:55], s86 offen sc1
 s_cmp_eq_u32 s66, 1
 s_cbranch_scc1 L_rdone
 v_fmac_f32 v32, v15, v48
 v_fmac_f32 v33, v15, v49
 v_fmac_f32 v34, v15, v50
 v_fmac_f32 v35, v15, v51
 v_fmac_f32 v36, v15, v52
 v_fmac_f32 v37, v15, v53
 v_fmac_f32 v38, v15, v54
 v_fmac_f32 v39, v15, v55
 v_cvt_pk_bf16_f32 v16, v32, v33
 v_cvt_pk_bf16_f32 v17, v34, v35
 v_cvt_pk_bf16_f32 v18, v36, v37
 v_cvt_pk_bf16_f32 v19, v38, v39
 buffer_store_dwordx4 v[16:19], v12, s[52:55], s75 offen sc1
 v_fmac_f32 v40, v15, v56
 v_fmac_f32 v41, v15, v57
 v_fmac_f32 v42, v15, v58
 v_fmac_f32 v43, v15, v59
 v_fmac_f32 v44, v15, v60
 v_fmac_f32 v45, v15, v61
 v_fmac_f32 v46, v15, v62
 v_fmac_f32 v47, v15, v63
 v_cvt_pk_bf16_f32 v20, v40, v41
 v_cvt_pk_bf16_f32 v21, v42, v43
 v_cvt_pk_bf16_f32 v22, v44, v45
 v_cvt_pk_bf16_f32 v23, v46, v47
 buffer_store_dwordx4 v[20:23], v12, s[52:55], s76 offen sc1
L_rdone:
 s_endpgm
L_rx0:
 v_dot2c_f32_bf16 v64, v128, v24
 v_dot2c_f32_bf16 v65, v128, v25
 v_dot2c_f32_bf16 v66, v129, v24
 v_dot2c_f32_bf16 v67, v129, v25
 v_dot2c_f32_bf16 v68, v130, v24
 v_dot2c_f32_bf16 v69, v130, v25
 v_dot2c_f32_bf16 v70, v131, v24
 v_dot2c_f32_bf16 v71, v131, v25
 s_branch L_ry0
L_rx1:
 v_dot2c_f32_bf16 v64, v136, v24
 v_dot2c_f32_bf16 v65, v136, v25
 v_dot2c_f32_bf16 v66, v137, v24
 v_dot2c_f32_bf16 v67, v137, v25
 v_dot2c_f32_bf16 v68, v138, v24
 v_dot2c_f32_bf16 v69, v138, v25
 v_dot2c_f32_bf16 v70, v139, v24
 v_dot2c_f32_bf16 v71, v139, v25
 s_branch L_ry1
L_rx2:
 v_dot2c_f32_bf16 v64, v144, v24
 v_dot2c_f32_bf16 v65, v144, v25
 v_dot2c_f32_bf16 v66, v145, v24
 v_dot2c_f32_bf16 v67, v145, v25
 v_dot2c_f32_bf16 v68, v146, v24
 v_dot2c_f32_bf16 v69, v146, v25
 v_dot2c_f32_bf16 v70, v147, v24
 v_dot2c_f32_bf16 v71, v147, v25
 s_branch L_ry2
L_rx3:
 v_dot2c_f32_bf16 v64, v152, v24
 v_dot2c_f32_bf16 v65, v152, v25
 v_dot2c_f32_bf16 v66, v153, v24
 v_dot2c_f32_bf16 v67, v153, v25
 v_dot2c_f32_bf16 v68, v154, v24
 v_dot2c_f32_bf16 v69, v154, v25
 v_dot2c_f32_bf16 v70, v155, v24
 v_dot2c_f32_bf16 v71, v155, v25
 s_branch L_ry3
L_rx4:
 v_dot2c_f32_bf16 v64, v160, v24
 v_dot2c_f32_bf16 v65, v160, v25
 v_dot2c_f32_bf16 v66, v161, v24
 v_dot2c_f32_bf16 v67, v161, v25
 v_dot2c_f32_bf16 v68, v162, v24
 v_dot2c_f32_bf16 v69, v162, v25
 v_dot2c_f32_bf16 v70, v163, v24
 v_dot2c_f32_bf16 v71, v163, v25
 s_branch L_ry4
L_rx5:
 v_dot2c_f32_bf16 v64, v168, v24
 v_dot2c_f32_bf16 v65, v168, v25
 v_dot2c_f32_bf16 v66, v169, v24
 v_dot2c_f32_bf16 v67, v169, v25
 v_dot2c_f32_bf16 v68, v170, v24
 v_dot2c_f32_bf16 v69, v170, v25
 v_dot2c_f32_bf16 v70, v171, v24
 v_dot2c_f32_bf16 v71, v171, v25
 s_branch L_ry5
L_rx6:
 v_dot2c_f32_bf16 v64, v176, v24
 v_dot2c_f32_bf16 v65, v176, v25
 v_dot2c_f32_bf16 v66, v177, v24
 v_dot2c_f32_bf16 v67, v177, v25
 v_dot2c_f32_bf16 v68, v178, v24
 v_dot2c_f32_bf16 v69, v178, v25
 v_dot2c_f32_bf16 v70, v179, v24
 v_dot2c_f32_bf16 v71, v179, v25
 s_branch L_ry6
L_rx7:
 v_dot2c_f32_bf16 v64, v184, v24
 v_dot2c_f32_bf16 v65, v184, v25
 v_dot2c_f32_bf16 v66, v185, v24
 v_dot2c_f32_bf16 v67, v185, v25
 v_dot2c_f32_bf16 v68, v186, v24
 v_dot2c_f32_bf16 v69, v186, v25
 v_dot2c_f32_bf16 v70, v187, v24
 v_dot2c_f32_bf16 v71, v187, v25
 s_branch L_ry7
L_rx8:
 v_dot2c_f32_bf16 v64, v192, v24
 v_dot2c_f32_bf16 v65, v192, v25
 v_dot2c_f32_bf16 v66, v193, v24
 v_dot2c_f32_bf16 v67, v193, v25
 v_dot2c_f32_bf16 v68, v194, v24
 v_dot2c_f32_bf16 v69, v194, v25
 v_dot2c_f32_bf16 v70, v195, v24
 v_dot2c_f32_bf16 v71, v195, v25
 s_branch L_ry8
L_rx9:
 v_dot2c_f32_bf16 v64, v200, v24
 v_dot2c_f32_bf16 v65, v200, v25
 v_dot2c_f32_bf16 v66, v201, v24
 v_dot2c_f32_bf16 v67, v201, v25
 v_dot2c_f32_bf16 v68, v202, v24
 v_dot2c_f32_bf16 v69, v202, v25
 v_dot2c_f32_bf16 v70, v203, v24
 v_dot2c_f32_bf16 v71, v203, v25
 s_branch L_ry9
L_rx10:
 v_dot2c_f32_bf16 v64, v208, v24
 v_dot2c_f32_bf16 v65, v208, v25
 v_dot2c_f32_bf16 v66, v209, v24
 v_dot2c_f32_bf16 v67, v209, v25
 v_dot2c_f32_bf16 v68, v210, v24
 v_dot2c_f32_bf16 v69, v210, v25
 v_dot2c_f32_bf16 v70, v211, v24
 v_dot2c_f32_bf16 v71, v211, v25
 s_branch L_ry10
L_rx11:
 v_dot2c_f32_bf16 v64, v216, v24
 v_dot2c_f32_bf16 v65, v216, v25
 v_dot2c_f32_bf16 v66, v217, v24
 v_dot2c_f32_bf16 v67, v217, v25
 v_dot2c_f32_bf16 v68, v218, v24
 v_dot2c_f32_bf16 v69, v218, v25
 v_dot2c_f32_bf16 v70, v219, v24
 v_dot2c_f32_bf16 v71, v219, v25
 s_branch L_ry11
L_rx12:
 v_dot2c_f32_bf16 v64, v224, v24
 v_dot2c_f32_bf16 v65, v224, v25
 v_dot2c_f32_bf16 v66, v225, v24
 v_dot2c_f32_bf16 v67, v225, v25
 v_dot2c_f32_bf16 v68, v226, v24
 v_dot2c_f32_bf16 v69, v226, v25
 v_dot2c_f32_bf16 v70, v227, v24
 v_dot2c_f32_bf16 v71, v227, v25
 s_branch L_ry12
L_rx13:
 v_dot2c_f32_bf16 v64, v232, v24
 v_dot2c_f32_bf16 v65, v232, v25
 v_dot2c_f32_bf16 v66, v233, v24
 v_dot2c_f32_bf16 v67, v233, v25
 v_dot2c_f32_bf16 v68, v234, v24
 v_dot2c_f32_bf16 v69, v234, v25
 v_dot2c_f32_bf16 v70, v235, v24
 v_dot2c_f32_bf16 v71, v235, v25
 s_branch L_ry13
L_rx14:
 v_dot2c_f32_bf16 v64, v240, v24
 v_dot2c_f32_bf16 v65, v240, v25
 v_dot2c_f32_bf16 v66, v241, v24
 v_dot2c_f32_bf16 v67, v241, v25
 v_dot2c_f32_bf16 v68, v242, v24
 v_dot2c_f32_bf16 v69, v242, v25
 v_dot2c_f32_bf16 v70, v243, v24
 v_dot2c_f32_bf16 v71, v243, v25
 s_branch L_ry14
L_rx15:
 v_dot2c_f32_bf16 v64, v248, v24
 v_dot2c_f32_bf16 v65, v248, v25
 v_dot2c_f32_bf16 v66, v249, v24
 v_dot2c_f32_bf16 v67, v249, v25
 v_dot2c_f32_bf16 v68, v250, v24
 v_dot2c_f32_bf16 v69, v250, v25
 v_dot2c_f32_bf16 v70, v251, v24
 v_dot2c_f32_bf16 v71, v251, v25
 s_branch L_ry15
L_rx16:
 v_dot2c_f32_bf16 v48, v128, v24
 v_dot2c_f32_bf16 v49, v128, v25
 v_dot2c_f32_bf16 v50, v129, v24
 v_dot2c_f32_bf16 v51, v129, v25
 v_dot2c_f32_bf16 v52, v130, v24
 v_dot2c_f32_bf16 v53, v130, v25
 v_dot2c_f32_bf16 v54, v131, v24
 v_dot2c_f32_bf16 v55, v131, v25
 v_dot2c_f32_bf16 v56, v132, v24
 v_dot2c_f32_bf16 v57, v132, v25
 v_dot2c_f32_bf16 v58, v133, v24
 v_dot2c_f32_bf16 v59, v133, v25
 v_dot2c_f32_bf16 v60, v134, v24
 v_dot2c_f32_bf16 v61, v134, v25
 v_dot2c_f32_bf16 v62, v135, v24
 v_dot2c_f32_bf16 v63, v135, v25
 s_branch L_ry16
L_rx17:
 v_dot2c_f32_bf16 v48, v136, v24
 v_dot2c_f32_bf16 v49, v136, v25
 v_dot2c_f32_bf16 v50, v137, v24
 v_dot2c_f32_bf16 v51, v137, v25
 v_dot2c_f32_bf16 v52, v138, v24
 v_dot2c_f32_bf16 v53, v138, v25
 v_dot2c_f32_bf16 v54, v139, v24
 v_dot2c_f32_bf16 v55, v139, v25
 v_dot2c_f32_bf16 v56, v140, v24
 v_dot2c_f32_bf16 v57, v140, v25
 v_dot2c_f32_bf16 v58, v141, v24
 v_dot2c_f32_bf16 v59, v141, v25
 v_dot2c_f32_bf16 v60, v142, v24
 v_dot2c_f32_bf16 v61, v142, v25
 v_dot2c_f32_bf16 v62, v143, v24
 v_dot2c_f32_bf16 v63, v143, v25
 s_branch L_ry17
L_rx18:
 v_dot2c_f32_bf16 v48, v144, v24
 v_dot2c_f32_bf16 v49, v144, v25
 v_dot2c_f32_bf16 v50, v145, v24
 v_dot2c_f32_bf16 v51, v145, v25
 v_dot2c_f32_bf16 v52, v146, v24
 v_dot2c_f32_bf16 v53, v146, v25
 v_dot2c_f32_bf16 v54, v147, v24
 v_dot2c_f32_bf16 v55, v147, v25
 v_dot2c_f32_bf16 v56, v148, v24
 v_dot2c_f32_bf16 v57, v148, v25
 v_dot2c_f32_bf16 v58, v149, v24
 v_dot2c_f32_bf16 v59, v149, v25
 v_dot2c_f32_bf16 v60, v150, v24
 v_dot2c_f32_bf16 v61, v150, v25
 v_dot2c_f32_bf16 v62, v151, v24
 v_dot2c_f32_bf16 v63, v151, v25
 s_branch L_ry18
L_rx19:
 v_dot2c_f32_bf16 v48, v152, v24
 v_dot2c_f32_bf16 v49, v152, v25
 v_dot2c_f32_bf16 v50, v153, v24
 v_dot2c_f32_bf16 v51, v153, v25
 v_dot2c_f32_bf16 v52, v154, v24
 v_dot2c_f32_bf16 v53, v154, v25
 v_dot2c_f32_bf16 v54, v155, v24
 v_dot2c_f32_bf16 v55, v155, v25
 v_dot2c_f32_bf16 v56, v156, v24
 v_dot2c_f32_bf16 v57, v156, v25
 v_dot2c_f32_bf16 v58, v157, v24
 v_dot2c_f32_bf16 v59, v157, v25
 v_dot2c_f32_bf16 v60, v158, v24
 v_dot2c_f32_bf16 v61, v158, v25
 v_dot2c_f32_bf16 v62, v159, v24
 v_dot2c_f32_bf16 v63, v159, v25
 s_branch L_ry19
L_rx20:
 v_dot2c_f32_bf16 v48, v160, v24
 v_dot2c_f32_bf16 v49, v160, v25
 v_dot2c_f32_bf16 v50, v161, v24
 v_dot2c_f32_bf16 v51, v161, v25
 v_dot2c_f32_bf16 v52, v162, v24
 v_dot2c_f32_bf16 v53, v162, v25
 v_dot2c_f32_bf16 v54, v163, v24
 v_dot2c_f32_bf16 v55, v163, v25
 v_dot2c_f32_bf16 v56, v164, v24
 v_dot2c_f32_bf16 v57, v164, v25
 v_dot2c_f32_bf16 v58, v165, v24
 v_dot2c_f32_bf16 v59, v165, v25
 v_dot2c_f32_bf16 v60, v166, v24
 v_dot2c_f32_bf16 v61, v166, v25
 v_dot2c_f32_bf16 v62, v167, v24
 v_dot2c_f32_bf16 v63, v167, v25
 s_branch L_ry20
L_rx21:
 v_dot2c_f32_bf16 v48, v168, v24
 v_dot2c_f32_bf16 v49, v168, v25
 v_dot2c_f32_bf16 v50, v169, v24
 v_dot2c_f32_bf16 v51, v169, v25
 v_dot2c_f32_bf16 v52, v170, v24
 v_dot2c_f32_bf16 v53, v170, v25
 v_dot2c_f32_bf16 v54, v171, v24
 v_dot2c_f32_bf16 v55, v171, v25
 v_dot2c_f32_bf16 v56, v172, v24
 v_dot2c_f32_bf16 v57, v172, v25
 v_dot2c_f32_bf16 v58, v173, v24
 v_dot2c_f32_bf16 v59, v173, v25
 v_dot2c_f32_bf16 v60, v174, v24
 v_dot2c_f32_bf16 v61, v174, v25
 v_dot2c_f32_bf16 v62, v175, v24
 v_dot2c_f32_bf16 v63, v175, v25
 s_branch L_ry21
L_rx22:
 v_dot2c_f32_bf16 v48, v176, v24
 v_dot2c_f32_bf16 v49, v176, v25
 v_dot2c_f32_bf16 v50, v177, v24
 v_dot2c_f32_bf16 v51, v177, v25
 v_dot2c_f32_bf16 v52, v178, v24
 v_dot2c_f32_bf16 v53, v178, v25
 v_dot2c_f32_bf16 v54, v179, v24
 v_dot2c_f32_bf16 v55, v179, v25
 v_dot2c_f32_bf16 v56, v180, v24
 v_dot2c_f32_bf16 v57, v180, v25
 v_dot2c_f32_bf16 v58, v181, v24
 v_dot2c_f32_bf16 v59, v181, v25
 v_dot2c_f32_bf16 v60, v182, v24
 v_dot2c_f32_bf16 v61, v182, v25
 v_dot2c_f32_bf16 v62, v183, v24
 v_dot2c_f32_bf16 v63, v183, v25
 s_branch L_ry22
L_rx23:
 v_dot2c_f32_bf16 v48, v184, v24
 v_dot2c_f32_bf16 v49, v184, v25
 v_dot2c_f32_bf16 v50, v185, v24
 v_dot2c_f32_bf16 v51, v185, v25
 v_dot2c_f32_bf16 v52, v186, v24
 v_dot2c_f32_bf16 v53, v186, v25
 v_dot2c_f32_bf16 v54, v187, v24
 v_dot2c_f32_bf16 v55, v187, v25
 v_dot2c_f32_bf16 v56, v188, v24
 v_dot2c_f32_bf16 v57, v188, v25
 v_dot2c_f32_bf16 v58, v189, v24
 v_dot2c_f32_bf16 v59, v189, v25
 v_dot2c_f32_bf16 v60, v190, v24
 v_dot2c_f32_bf16 v61, v190, v25
 v_dot2c_f32_bf16 v62, v191, v24
 v_dot2c_f32_bf16 v63, v191, v25
 s_branch L_ry23
L_rx24:
 v_dot2c_f32_bf16 v48, v192, v24
 v_dot2c_f32_bf16 v49, v192, v25
 v_dot2c_f32_bf16 v50, v193, v24
 v_dot2c_f32_bf16 v51, v193, v25
 v_dot2c_f32_bf16 v52, v194, v24
 v_dot2c_f32_bf16 v53, v194, v25
 v_dot2c_f32_bf16 v54, v195, v24
 v_dot2c_f32_bf16 v55, v195, v25
 v_dot2c_f32_bf16 v56, v196, v24
 v_dot2c_f32_bf16 v57, v196, v25
 v_dot2c_f32_bf16 v58, v197, v24
 v_dot2c_f32_bf16 v59, v197, v25
 v_dot2c_f32_bf16 v60, v198, v24
 v_dot2c_f32_bf16 v61, v198, v25
 v_dot2c_f32_bf16 v62, v199, v24
 v_dot2c_f32_bf16 v63, v199, v25
 s_branch L_ry24
L_rx25:
 v_dot2c_f32_bf16 v48, v200, v24
 v_dot2c_f32_bf16 v49, v200, v25
 v_dot2c_f32_bf16 v50, v201, v24
 v_dot2c_f32_bf16 v51, v201, v25
 v_dot2c_f32_bf16 v52, v202, v24
 v_dot2c_f32_bf16 v53, v202, v25
 v_dot2c_f32_bf16 v54, v203, v24
 v_dot2c_f32_bf16 v55, v203, v25
 v_dot2c_f32_bf16 v56, v204, v24
 v_dot2c_f32_bf16 v57, v204, v25
 v_dot2c_f32_bf16 v58, v205, v24
 v_dot2c_f32_bf16 v59, v205, v25
 v_dot2c_f32_bf16 v60, v206, v24
 v_dot2c_f32_bf16 v61, v206, v25
 v_dot2c_f32_bf16 v62, v207, v24
 v_dot2c_f32_bf16 v63, v207, v25
 s_branch L_ry25
L_rx26:
 v_dot2c_f32_bf16 v48, v208, v24
 v_dot2c_f32_bf16 v49, v208, v25
 v_dot2c_f32_bf16 v50, v209, v24
 v_dot2c_f32_bf16 v51, v209, v25
 v_dot2c_f32_bf16 v52, v210, v24
 v_dot2c_f32_bf16 v53, v210, v25
 v_dot2c_f32_bf16 v54, v211, v24
 v_dot2c_f32_bf16 v55, v211, v25
 v_dot2c_f32_bf16 v56, v212, v24
 v_dot2c_f32_bf16 v57, v212, v25
 v_dot2c_f32_bf16 v58, v213, v24
 v_dot2c_f32_bf16 v59, v213, v25
 v_dot2c_f32_bf16 v60, v214, v24
 v_dot2c_f32_bf16 v61, v214, v25
 v_dot2c_f32_bf16 v62, v215, v24
 v_dot2c_f32_bf16 v63, v215, v25
 s_branch L_ry26
L_rx27:
 v_dot2c_f32_bf16 v48, v216, v24
 v_dot2c_f32_bf16 v49, v216, v25
 v_dot2c_f32_bf16 v50, v217, v24
 v_dot2c_f32_bf16 v51, v217, v25
 v_dot2c_f32_bf16 v52, v218, v24
 v_dot2c_f32_bf16 v53, v218, v25
 v_dot2c_f32_bf16 v54, v219, v24
 v_dot2c_f32_bf16 v55, v219, v25
 v_dot2c_f32_bf16 v56, v220, v24
 v_dot2c_f32_bf16 v57, v220, v25
 v_dot2c_f32_bf16 v58, v221, v24
 v_dot2c_f32_bf16 v59, v221, v25
 v_dot2c_f32_bf16 v60, v222, v24
 v_dot2c_f32_bf16 v61, v222, v25
 v_dot2c_f32_bf16 v62, v223, v24
 v_dot2c_f32_bf16 v63, v223, v25
 s_branch L_ry27
L_rx28:
 v_dot2c_f32_bf16 v48, v224, v24
 v_dot2c_f32_bf16 v49, v224, v25
 v_dot2c_f32_bf16 v50, v225, v24
 v_dot2c_f32_bf16 v51, v225, v25
 v_dot2c_f32_bf16 v52, v226, v24
 v_dot2c_f32_bf16 v53, v226, v25
 v_dot2c_f32_bf16 v54, v227, v24
 v_dot2c_f32_bf16 v55, v227, v25
 v_dot2c_f32_bf16 v56, v228, v24
 v_dot2c_f32_bf16 v57, v228, v25
 v_dot2c_f32_bf16 v58, v229, v24
 v_dot2c_f32_bf16 v59, v229, v25
 v_dot2c_f32_bf16 v60, v230, v24
 v_dot2c_f32_bf16 v61, v230, v25
 v_dot2c_f32_bf16 v62, v231, v24
 v_dot2c_f32_bf16 v63, v231, v25
 s_branch L_ry28
L_rx29:
 v_dot2c_f32_bf16 v48, v232, v24
 v_dot2c_f32_bf16 v49, v232, v25
 v_dot2c_f32_bf16 v50, v233, v24
 v_dot2c_f32_bf16 v51, v233, v25
 v_dot2c_f32_bf16 v52, v234, v24
 v_dot2c_f32_bf16 v53, v234, v25
 v_dot2c_f32_bf16 v54, v235, v24
 v_dot2c_f32_bf16 v55, v235, v25
 v_dot2c_f32_bf16 v56, v236, v24
 v_dot2c_f32_bf16 v57, v236, v25
 v_dot2c_f32_bf16 v58, v237, v24
 v_dot2c_f32_bf16 v59, v237, v25
 v_dot2c_f32_bf16 v60, v238, v24
 v_dot2c_f32_bf16 v61, v238, v25
 v_dot2c_f32_bf16 v62, v239, v24
 v_dot2c_f32_bf16 v63, v239, v25
 s_branch L_ry29
L_rx30:
 v_dot2c_f32_bf16 v48, v240, v24
 v_dot2c_f32_bf16 v49, v240, v25
 v_dot2c_f32_bf16 v50, v241, v24
 v_dot2c_f32_bf16 v51, v241, v25
 v_dot2c_f32_bf16 v52, v242, v24
 v_dot2c_f32_bf16 v53, v242, v25
 v_dot2c_f32_bf16 v54, v243, v24
 v_dot2c_f32_bf16 v55, v243, v25
 v_dot2c_f32_bf16 v56, v244, v24
 v_dot2c_f32_bf16 v57, v244, v25
 v_dot2c_f32_bf16 v58, v245, v24
 v_dot2c_f32_bf16 v59, v245, v25
 v_dot2c_f32_bf16 v60, v246, v24
 v_dot2c_f32_bf16 v61, v246, v25
 v_dot2c_f32_bf16 v62, v247, v24
 v_dot2c_f32_bf16 v63, v247, v25
 s_branch L_ry30
L_rx31:
 v_dot2c_f32_bf16 v48, v248, v24
 v_dot2c_f32_bf16 v49, v248, v25
 v_dot2c_f32_bf16 v50, v249, v24
 v_dot2c_f32_bf16 v51, v249, v25
 v_dot2c_f32_bf16 v52, v250, v24
 v_dot2c_f32_bf16 v53, v250, v25
 v_dot2c_f32_bf16 v54, v251, v24
 v_dot2c_f32_bf16 v55, v251, v25
 v_dot2c_f32_bf16 v56, v252, v24
 v_dot2c_f32_bf16 v57, v252, v25
 v_dot2c_f32_bf16 v58, v253, v24
 v_dot2c_f32_bf16 v59, v253, v25
 v_dot2c_f32_bf16 v60, v254, v24
 v_dot2c_f32_bf16 v61, v254, v25
 v_dot2c_f32_bf16 v62, v255, v24
 v_dot2c_f32_bf16 v63, v255, v25
 s_branch L_ry31
L_rpoll0:
 s_sleep 1
L_rpoll:
 buffer_load_dword v9, v14, s[8:11], s46 offen sc1
 s_waitcnt vmcnt(0)
 v_cmp_eq_u32 vcc, 1, v9
 s_sub_u32 s91, s91, 1
 s_cselect_b32 s70, -1, 0
 s_or_b32 s70, s70, vcc_lo
 s_andn2_b32 s70, s70, s68
 s_cbranch_scc0 L_rpoll0
 s_or_b32 s68, s68, s70
 s_setpc_b64 s[36:37]
L_comb:
 buffer_load_dwordx4 v[14:17], v7, s[8:11], s52 offen sc1
 s_waitcnt vmcnt(0)
 s_nop 7
 v_sub_f32 v10, v32, v14
 v_sub_f32 v11, v36, v15
 v_max_f32 v10, 0, v10
 v_max_f32 v11, 0, v11
 v_sub_f32 v100, v100, v11
 v_sub_f32 v101, v101, v11
 v_sub_f32 v102, v102, v11
 v_sub_f32 v103, v103, v11
 v_sub_f32 v108, v108, v11
 v_sub_f32 v109, v109, v11
 v_sub_f32 v110, v110, v11
 v_sub_f32 v111, v111, v11
 v_sub_f32 v116, v116, v11
 v_sub_f32 v117, v117, v11
 v_sub_f32 v118, v118, v11
 v_sub_f32 v119, v119, v11
 v_sub_f32 v124, v124, v11
 v_sub_f32 v125, v125, v11
 v_sub_f32 v126, v126, v11
 v_sub_f32 v127, v127, v11
 v_sub_f32 v64, v64, v10
 v_sub_f32 v65, v65, v10
 v_sub_f32 v66, v66, v10
 v_sub_f32 v67, v67, v10
 v_sub_f32 v68, v68, v11
 v_sub_f32 v69, v69, v11
 v_sub_f32 v70, v70, v11
 v_sub_f32 v71, v71, v11
 v_sub_f32 v72, v72, v10
 v_sub_f32 v73, v73, v10
 v_sub_f32 v74, v74, v10
 v_sub_f32 v75, v75, v10
 v_sub_f32 v76, v76, v11
 v_sub_f32 v77, v77, v11
 v_sub_f32 v78, v78, v11
 v_sub_f32 v79, v79, v11
 v_sub_f32 v80, v80, v10
 v_sub_f32 v81, v81, v10
 v_sub_f32 v82, v82, v10
 v_sub_f32 v83, v83, v10
 v_sub_f32 v84, v84, v11
 v_sub_f32 v85, v85, v11
 v_sub_f32 v86, v86, v11
 v_sub_f32 v87, v87, v11
 v_sub_f32 v88, v88, v10
 v_sub_f32 v89, v89, v10
 v_sub_f32 v90, v90, v10
 v_sub_f32 v91, v91, v10
 v_sub_f32 v92, v92, v11
 v_sub_f32 v93, v93, v11
 v_sub_f32 v94, v94, v11
 v_sub_f32 v95, v95, v11
 v_sub_f32 v32, v32, v10
 v_sub_f32 v33, v33, v10
 v_sub_f32 v34, v34, v10
 v_sub_f32 v35, v35, v10
 v_sub_f32 v36, v36, v11
 v_sub_f32 v37, v37, v11
 v_sub_f32 v38, v38, v11
 v_sub_f32 v39, v39, v11
 v_exp_f32 v12, -v10
 v_exp_f32 v13, -v11
 v_mul_f32 v30, v12, v30
 v_mul_f32 v31, v13, v31
 v_mul_f32 v128, v12, v128
 v_mul_f32 v129, v12, v129
 v_mul_f32 v130, v12, v130
 v_mul_f32 v131, v12, v131
 v_mul_f32 v132, v13, v132
 v_mul_f32 v133, v13, v133
 v_mul_f32 v134, v13, v134
 v_mul_f32 v135, v13, v135
 v_mul_f32 v136, v12, v136
 v_mul_f32 v137, v12, v137
 v_mul_f32 v138, v12, v138
 v_mul_f32 v139, v12, v139
 v_mul_f32 v140, v13, v140
 v_mul_f32 v141, v13, v141
 v_mul_f32 v142, v13, v142
 v_mul_f32 v143, v13, v143
 v_mul_f32 v144, v12, v144
 v_mul_f32 v145, v12, v145
 v_mul_f32 v146, v12, v146
 v_mul_f32 v147, v12, v147
 v_mul_f32 v148, v13, v148
 v_mul_f32 v149, v13, v149
 v_mul_f32 v150, v13, v150
 v_mul_f32 v151, v13, v151
 v_mul_f32 v152, v12, v152
 v_mul_f32 v153, v12, v153
 v_mul_f32 v154, v12, v154
 v_mul_f32 v155, v12, v155
 v_mul_f32 v156, v13, v156
 v_mul_f32 v157, v13, v157
 v_mul_f32 v158, v13, v158
 v_mul_f32 v159, v13, v159
 v_mul_f32 v160, v12, v160
 v_mul_f32 v161, v12, v161
 v_mul_f32 v162, v12, v162
 v_mul_f32 v163, v12, v163
 v_mul_f32 v164, v13, v164
 v_mul_f32 v165, v13, v165
 v_mul_f32 v166, v13, v166
 v_mul_f32 v167, v13, v167
 v_mul_f32 v168, v12, v168
 v_mul_f32 v169, v12, v169
 v_mul_f32 v170, v12, v170
 v_mul_f32 v171, v12, v171
 v_mul_f32 v172, v13, v172
 v_mul_f32 v173, v13, v173
 v_mul_f32 v174, v13, v174
 v_mul_f32 v175, v13, v175
 v_mul_f32 v176, v12, v176
 v_mul_f32 v177, v12, v177
 v_mul_f32 v178, v12, v178
 v_mul_f32 v179, v12, v179
 v_mul_f32 v180, v13, v180
 v_mul_f32 v181, v13, v181
 v_mul_f32 v182, v13, v182
 v_mul_f32 v183, v13, v183
 v_mul_f32 v184, v12, v184
 v_mul_f32 v185, v12, v185
 v_mul_f32 v186, v12, v186
 v_mul_f32 v187, v12, v187
 v_mul_f32 v188, v13, v188
 v_mul_f32 v189, v13, v189
 v_mul_f32 v190, v13, v190
 v_mul_f32 v191, v13, v191
 v_mul_f32 v192, v12, v192
 v_mul_f32 v193, v12, v193
 v_mul_f32 v194, v12, v194
 v_mul_f32 v195, v12, v195
 v_mul_f32 v196, v13, v196
 v_mul_f32 v197, v13, v197
 v_mul_f32 v198, v13, v198
 v_mul_f32 v199, v13, v199
 v_mul_f32 v200, v12, v200
 v_mul_f32 v201, v12, v201
 v_mul_f32 v202, v12, v202
 v_mul_f32 v203, v12, v203
 v_mul_f32 v204, v13, v204
 v_mul_f32 v205, v13, v205
 v_mul_f32 v206, v13, v206
 v_mul_f32 v207, v13, v207
 v_mul_f32 v208, v12, v208
 v_mul_f32 v209, v12, v209
 v_mul_f32 v210, v12, v210
 v_mul_f32 v211, v12, v211
 v_mul_f32 v212, v13, v212
 v_mul_f32 v213, v13, v213
 v_mul_f32 v214, v13, v214
 v_mul_f32 v215, v13, v215
 v_mul_f32 v216, v12, v216
 v_mul_f32 v217, v12, v217
 v_mul_f32 v218, v12, v218
 v_mul_f32 v219, v12, v219
 v_mul_f32 v220, v13, v220
 v_mul_f32 v221, v13, v221
 v_mul_f32 v222, v13, v222
 v_mul_f32 v223, v13, v223
 v_mul_f32 v224, v12, v224
 v_mul_f32 v225, v12, v225
 v_mul_f32 v226, v12, v226
 v_mul_f32 v227, v12, v227
 v_mul_f32 v228, v13, v228
 v_mul_f32 v229, v13, v229
 v_mul_f32 v230, v13, v230
 v_mul_f32 v231, v13, v231
 v_mul_f32 v232, v12, v232
 v_mul_f32 v233, v12, v233
 v_mul_f32 v234, v12, v234
 v_mul_f32 v235, v12, v235
 v_mul_f32 v236, v13, v236
 v_mul_f32 v237, v13, v237
 v_mul_f32 v238, v13, v238
 v_mul_f32 v239, v13, v239
 v_mul_f32 v240, v12, v240
 v_mul_f32 v241, v12, v241
 v_mul_f32 v242, v12, v242
 v_mul_f32 v243, v12, v243
 v_mul_f32 v244, v13, v244
 v_mul_f32 v245, v13, v245
 v_mul_f32 v246, v13, v246
 v_mul_f32 v247, v13, v247
 v_mul_f32 v248, v12, v248
 v_mul_f32 v249, v12, v249
 v_mul_f32 v250, v12, v250
 v_mul_f32 v251, v12, v251
 v_mul_f32 v252, v13, v252
 v_mul_f32 v253, v13, v253
 v_mul_f32 v254, v13, v254
 v_mul_f32 v255, v13, v255
 v_exp_f32 v18, v64
 v_exp_f32 v19, v65
 v_exp_f32 v20, v66
 v_add_f32 v26, v18, v19
 v_cvt_pk_bf16_f32 v40, v18, v19
 v_exp_f32 v21, v67
 v_exp_f32 v22, v72
 v_add_f32 v26, v20, v26
 v_cvt_pk_bf16_f32 v41, v20, v21
 v_exp_f32 v23, v73
 v_add_f32 v26, v21, v26
 v_exp_f32 v24, v74
 v_add_f32 v26, v22, v26
 v_cvt_pk_bf16_f32 v42, v22, v23
 v_exp_f32 v25, v75
 v_add_f32 v26, v23, v26
 v_exp_f32 v18, v68
 v_add_f32 v26, v24, v26
 v_cvt_pk_bf16_f32 v43, v24, v25
 v_exp_f32 v19, v69
 v_add_f32 v26, v25, v26
 v_exp_f32 v20, v70
 v_add_f32 v27, v18, v19
 v_cvt_pk_bf16_f32 v44, v18, v19
 v_exp_f32 v21, v71
 v_exp_f32 v22, v76
 v_add_f32 v27, v20, v27
 v_cvt_pk_bf16_f32 v45, v20, v21
 v_exp_f32 v23, v77
 v_add_f32 v27, v21, v27
 v_exp_f32 v24, v78
 v_add_f32 v27, v22, v27
 v_cvt_pk_bf16_f32 v46, v22, v23
 v_exp_f32 v25, v79
 v_add_f32 v27, v23, v27
 v_add_f32 v27, v24, v27
 v_cvt_pk_bf16_f32 v47, v24, v25
 v_add_f32 v27, v25, v27
 v_sub_f32 v10, v32, v14
 v_sub_f32 v11, v36, v15
 v_cvt_i32_f32 v10, v10
 v_cvt_i32_f32 v11, v11
 v_ldexp_f32 v10, 1.0, v10
 v_ldexp_f32 v11, 1.0, v11
 v_and_b32 v10, 0xffff0000, v10
 v_and_b32 v11, 0xffff0000, v11
 v_fmac_f32 v30, v10, v16
 v_fmac_f32 v31, v11, v17
 v_lshrrev_b32 v12, 16, v10
 v_lshrrev_b32 v13, 16, v11
 v_accvgpr_read_b32 v18, a128
 v_dot2c_f32_bf16 v128, v18, v12
 v_dot2c_f32_bf16 v129, v18, v10
 v_accvgpr_read_b32 v19, a129
 v_dot2c_f32_bf16 v130, v19, v12
 v_dot2c_f32_bf16 v131, v19, v10
 v_accvgpr_read_b32 v20, a130
 v_dot2c_f32_bf16 v136, v20, v12
 v_dot2c_f32_bf16 v137, v20, v10
 v_accvgpr_read_b32 v21, a131
 v_dot2c_f32_bf16 v138, v21, v12
 v_dot2c_f32_bf16 v139, v21, v10
 v_accvgpr_read_b32 v22, a132
 v_dot2c_f32_bf16 v144, v22, v12
 v_dot2c_f32_bf16 v145, v22, v10
 v_accvgpr_read_b32 v23, a133
 v_dot2c_f32_bf16 v146, v23, v12
 v_dot2c_f32_bf16 v147, v23, v10
 v_accvgpr_read_b32 v24, a134
 v_dot2c_f32_bf16 v152, v24, v12
 v_dot2c_f32_bf16 v153, v24, v10
 v_accvgpr_read_b32 v25, a135
 v_dot2c_f32_bf16 v154, v25, v12
 v_dot2c_f32_bf16 v155, v25, v10
 v_accvgpr_read_b32 v18, a136
 v_dot2c_f32_bf16 v160, v18, v12
 v_dot2c_f32_bf16 v161, v18, v10
 v_accvgpr_read_b32 v19, a137
 v_dot2c_f32_bf16 v162, v19, v12
 v_dot2c_f32_bf16 v163, v19, v10
 v_accvgpr_read_b32 v20, a138
 v_dot2c_f32_bf16 v168, v20, v12
 v_dot2c_f32_bf16 v169, v20, v10
 v_accvgpr_read_b32 v21, a139
 v_dot2c_f32_bf16 v170, v21, v12
 v_dot2c_f32_bf16 v171, v21, v10
 v_accvgpr_read_b32 v22, a140
 v_dot2c_f32_bf16 v176, v22, v12
 v_dot2c_f32_bf16 v177, v22, v10
 v_accvgpr_read_b32 v23, a141
 v_dot2c_f32_bf16 v178, v23, v12
 v_dot2c_f32_bf16 v179, v23, v10
 v_accvgpr_read_b32 v24, a142
 v_dot2c_f32_bf16 v184, v24, v12
 v_dot2c_f32_bf16 v185, v24, v10
 v_accvgpr_read_b32 v25, a143
 v_dot2c_f32_bf16 v186, v25, v12
 v_dot2c_f32_bf16 v187, v25, v10
 v_accvgpr_read_b32 v18, a144
 v_dot2c_f32_bf16 v192, v18, v12
 v_dot2c_f32_bf16 v193, v18, v10
 v_accvgpr_read_b32 v19, a145
 v_dot2c_f32_bf16 v194, v19, v12
 v_dot2c_f32_bf16 v195, v19, v10
 v_accvgpr_read_b32 v20, a146
 v_dot2c_f32_bf16 v200, v20, v12
 v_dot2c_f32_bf16 v201, v20, v10
 v_accvgpr_read_b32 v21, a147
 v_dot2c_f32_bf16 v202, v21, v12
 v_dot2c_f32_bf16 v203, v21, v10
 v_accvgpr_read_b32 v22, a148
 v_dot2c_f32_bf16 v208, v22, v12
 v_dot2c_f32_bf16 v209, v22, v10
 v_accvgpr_read_b32 v23, a149
 v_dot2c_f32_bf16 v210, v23, v12
 v_dot2c_f32_bf16 v211, v23, v10
 v_accvgpr_read_b32 v24, a150
 v_dot2c_f32_bf16 v216, v24, v12
 v_dot2c_f32_bf16 v217, v24, v10
 v_accvgpr_read_b32 v25, a151
 v_dot2c_f32_bf16 v218, v25, v12
 v_dot2c_f32_bf16 v219, v25, v10
 v_accvgpr_read_b32 v18, a152
 v_dot2c_f32_bf16 v224, v18, v12
 v_dot2c_f32_bf16 v225, v18, v10
 v_accvgpr_read_b32 v19, a153
 v_dot2c_f32_bf16 v226, v19, v12
 v_dot2c_f32_bf16 v227, v19, v10
 v_accvgpr_read_b32 v20, a154
 v_dot2c_f32_bf16 v232, v20, v12
 v_dot2c_f32_bf16 v233, v20, v10
 v_accvgpr_read_b32 v21, a155
 v_dot2c_f32_bf16 v234, v21, v12
 v_dot2c_f32_bf16 v235, v21, v10
 v_accvgpr_read_b32 v22, a156
 v_dot2c_f32_bf16 v240, v22, v12
 v_dot2c_f32_bf16 v241, v22, v10
 v_accvgpr_read_b32 v23, a157
 v_dot2c_f32_bf16 v242, v23, v12
 v_dot2c_f32_bf16 v243, v23, v10
 v_accvgpr_read_b32 v24, a158
 v_dot2c_f32_bf16 v248, v24, v12
 v_dot2c_f32_bf16 v249, v24, v10
 v_accvgpr_read_b32 v25, a159
 v_dot2c_f32_bf16 v250, v25, v12
 v_dot2c_f32_bf16 v251, v25, v10
 v_accvgpr_read_b32 v18, a160
 v_dot2c_f32_bf16 v132, v18, v13
 v_dot2c_f32_bf16 v133, v18, v11
 v_accvgpr_read_b32 v19, a161
 v_dot2c_f32_bf16 v134, v19, v13
 v_dot2c_f32_bf16 v135, v19, v11
 v_accvgpr_read_b32 v20, a162
 v_dot2c_f32_bf16 v140, v20, v13
 v_dot2c_f32_bf16 v141, v20, v11
 v_accvgpr_read_b32 v21, a163
 v_dot2c_f32_bf16 v142, v21, v13
 v_dot2c_f32_bf16 v143, v21, v11
 v_accvgpr_read_b32 v22, a164
 v_dot2c_f32_bf16 v148, v22, v13
 v_dot2c_f32_bf16 v149, v22, v11
 v_accvgpr_read_b32 v23, a165
 v_dot2c_f32_bf16 v150, v23, v13
 v_dot2c_f32_bf16 v151, v23, v11
 v_accvgpr_read_b32 v24, a166
 v_dot2c_f32_bf16 v156, v24, v13
 v_dot2c_f32_bf16 v157, v24, v11
 v_accvgpr_read_b32 v25, a167
 v_dot2c_f32_bf16 v158, v25, v13
 v_dot2c_f32_bf16 v159, v25, v11
 v_accvgpr_read_b32 v18, a168
 v_dot2c_f32_bf16 v164, v18, v13
 v_dot2c_f32_bf16 v165, v18, v11
 v_accvgpr_read_b32 v19, a169
 v_dot2c_f32_bf16 v166, v19, v13
 v_dot2c_f32_bf16 v167, v19, v11
 v_accvgpr_read_b32 v20, a170
 v_dot2c_f32_bf16 v172, v20, v13
 v_dot2c_f32_bf16 v173, v20, v11
 v_accvgpr_read_b32 v21, a171
 v_dot2c_f32_bf16 v174, v21, v13
 v_dot2c_f32_bf16 v175, v21, v11
 v_accvgpr_read_b32 v22, a172
 v_dot2c_f32_bf16 v180, v22, v13
 v_dot2c_f32_bf16 v181, v22, v11
 v_accvgpr_read_b32 v23, a173
 v_dot2c_f32_bf16 v182, v23, v13
 v_dot2c_f32_bf16 v183, v23, v11
 v_accvgpr_read_b32 v24, a174
 v_dot2c_f32_bf16 v188, v24, v13
 v_dot2c_f32_bf16 v189, v24, v11
 v_accvgpr_read_b32 v25, a175
 v_dot2c_f32_bf16 v190, v25, v13
 v_dot2c_f32_bf16 v191, v25, v11
 v_accvgpr_read_b32 v18, a176
 v_dot2c_f32_bf16 v196, v18, v13
 v_dot2c_f32_bf16 v197, v18, v11
 v_accvgpr_read_b32 v19, a177
 v_dot2c_f32_bf16 v198, v19, v13
 v_dot2c_f32_bf16 v199, v19, v11
 v_accvgpr_read_b32 v20, a178
 v_dot2c_f32_bf16 v204, v20, v13
 v_dot2c_f32_bf16 v205, v20, v11
 v_accvgpr_read_b32 v21, a179
 v_dot2c_f32_bf16 v206, v21, v13
 v_dot2c_f32_bf16 v207, v21, v11
 v_accvgpr_read_b32 v22, a180
 v_dot2c_f32_bf16 v212, v22, v13
 v_dot2c_f32_bf16 v213, v22, v11
 v_accvgpr_read_b32 v23, a181
 v_dot2c_f32_bf16 v214, v23, v13
 v_dot2c_f32_bf16 v215, v23, v11
 v_accvgpr_read_b32 v24, a182
 v_dot2c_f32_bf16 v220, v24, v13
 v_dot2c_f32_bf16 v221, v24, v11
 v_accvgpr_read_b32 v25, a183
 v_dot2c_f32_bf16 v222, v25, v13
 v_dot2c_f32_bf16 v223, v25, v11
 v_accvgpr_read_b32 v18, a184
 v_dot2c_f32_bf16 v228, v18, v13
 v_dot2c_f32_bf16 v229, v18, v11
 v_accvgpr_read_b32 v19, a185
 v_dot2c_f32_bf16 v230, v19, v13
 v_dot2c_f32_bf16 v231, v19, v11
 v_accvgpr_read_b32 v20, a186
 v_dot2c_f32_bf16 v236, v20, v13
 v_dot2c_f32_bf16 v237, v20, v11
 v_accvgpr_read_b32 v21, a187
 v_dot2c_f32_bf16 v238, v21, v13
 v_dot2c_f32_bf16 v239, v21, v11
 v_accvgpr_read_b32 v22, a188
 v_dot2c_f32_bf16 v244, v22, v13
 v_dot2c_f32_bf16 v245, v22, v11
 v_accvgpr_read_b32 v23, a189
 v_dot2c_f32_bf16 v246, v23, v13
 v_dot2c_f32_bf16 v247, v23, v11
 v_accvgpr_read_b32 v24, a190
 v_dot2c_f32_bf16 v252, v24, v13
 v_dot2c_f32_bf16 v253, v24, v11
 v_accvgpr_read_b32 v25, a191
 v_dot2c_f32_bf16 v254, v25, v13
 v_dot2c_f32_bf16 v255, v25, v11
 s_nop 3
 s_branch L_p2
L_st0:
 s_call_b64 s[36:37], L_slow0
 s_branch L_rt0
L_st1:
 s_call_b64 s[36:37], L_slow1
 s_branch L_rt1
L_st2:
 s_call_b64 s[36:37], L_slowB
 s_branch L_rt2
L_st3:
 s_call_b64 s[36:37], L_slow1
 s_branch L_rt3
L_st4:
 s_call_b64 s[36:37], L_slow1n
 s_branch L_rt4
L_st5:
 s_call_b64 s[36:37], L_slow1
 s_branch L_rt5
L_st6:
 s_call_b64 s[36:37], L_slow0B
 s_branch L_rt6
L_st7:
 s_call_b64 s[36:37], L_slowB
 s_branch L_rt7
L_st8:
 s_call_b64 s[36:37], L_slowf
 s_branch L_rt8
L_st9:
 s_call_b64 s[36:37], L_slow1
 s_branch L_rt9
L_st10:
 s_call_b64 s[36:37], L_slowf
 s_branch L_rt10
L_st11:
 s_call_b64 s[36:37], L_slowf
 s_branch L_rt11
L_st14:
 s_call_b64 s[36:37], L_slow0B
 s_branch L_rt14
L_st12:
 s_call_b64 s[36:37], L_slow0
 s_branch L_rt12
L_st13:
 s_call_b64 s[36:37], L_slow1
 s_branch L_rt13
L_slow0:
 s_nop 7
 s_nop 3
 v_max3_f32 v10, v64, v65, v66
 v_max3_f32 v10, v67, v72, v10
 v_max3_f32 v10, v73, v74, v10
 v_max3_f32 v10, v75, v80, v10
 v_max3_f32 v10, v81, v82, v10
 v_max3_f32 v10, v83, v88, v10
 v_max3_f32 v10, v89, v90, v10
 v_max_f32 v10, v91, v10
 v_max3_f32 v11, v68, v69, v70
 v_max3_f32 v11, v71, v76, v11
 v_max3_f32 v11, v77, v78, v11
 v_max3_f32 v11, v79, v84, v11
 v_max3_f32 v11, v85, v86, v11
 v_max3_f32 v11, v87, v92, v11
 v_max3_f32 v11, v93, v94, v11
 v_max_f32 v11, v95, v11
 v_mov_b32 v12, v10
 v_mov_b32 v13, v11
 s_nop 0
 v_permlane16_swap_b32 v12, v10
 v_permlane16_swap_b32 v13, v11
 v_max_f32 v10, v12, v10
 v_max_f32 v11, v13, v11
 v_mov_b32 v12, v10
 v_mov_b32 v13, v11
 s_nop 0
 v_permlane32_swap_b32 v12, v10
 v_permlane32_swap_b32 v13, v11
 v_max_f32 v10, v12, v10
 v_max_f32 v11, v13, v11
 v_ceil_f32 v10, v10
 v_ceil_f32 v11, v11
 v_max_f32 v10, 0, v10
 v_max_f32 v11, 0, v11
 v_sub_f32 v64, v64, v10
 v_sub_f32 v65, v65, v10
 v_sub_f32 v66, v66, v10
 v_sub_f32 v67, v67, v10
 v_sub_f32 v68, v68, v11
 v_sub_f32 v69, v69, v11
 v_sub_f32 v70, v70, v11
 v_sub_f32 v71, v71, v11
 v_sub_f32 v72, v72, v10
 v_sub_f32 v73, v73, v10
 v_sub_f32 v74, v74, v10
 v_sub_f32 v75, v75, v10
 v_sub_f32 v76, v76, v11
 v_sub_f32 v77, v77, v11
 v_sub_f32 v78, v78, v11
 v_sub_f32 v79, v79, v11
 v_sub_f32 v80, v80, v10
 v_sub_f32 v81, v81, v10
 v_sub_f32 v82, v82, v10
 v_sub_f32 v83, v83, v10
 v_sub_f32 v84, v84, v11
 v_sub_f32 v85, v85, v11
 v_sub_f32 v86, v86, v11
 v_sub_f32 v87, v87, v11
 v_sub_f32 v88, v88, v10
 v_sub_f32 v89, v89, v10
 v_sub_f32 v90, v90, v10
 v_sub_f32 v91, v91, v10
 v_sub_f32 v92, v92, v11
 v_sub_f32 v93, v93, v11
 v_sub_f32 v94, v94, v11
 v_sub_f32 v95, v95, v11
 v_sub_f32 v96, v96, v10
 v_sub_f32 v97, v97, v10
 v_sub_f32 v98, v98, v10
 v_sub_f32 v99, v99, v10
 v_sub_f32 v100, v100, v11
 v_sub_f32 v101, v101, v11
 v_sub_f32 v102, v102, v11
 v_sub_f32 v103, v103, v11
 v_sub_f32 v104, v104, v10
 v_sub_f32 v105, v105, v10
 v_sub_f32 v106, v106, v10
 v_sub_f32 v107, v107, v10
 v_sub_f32 v108, v108, v11
 v_sub_f32 v109, v109, v11
 v_sub_f32 v110, v110, v11
 v_sub_f32 v111, v111, v11
 v_sub_f32 v112, v112, v10
 v_sub_f32 v113, v113, v10
 v_sub_f32 v114, v114, v10
 v_sub_f32 v115, v115, v10
 v_sub_f32 v116, v116, v11
 v_sub_f32 v117, v117, v11
 v_sub_f32 v118, v118, v11
 v_sub_f32 v119, v119, v11
 v_sub_f32 v120, v120, v10
 v_sub_f32 v121, v121, v10
 v_sub_f32 v122, v122, v10
 v_sub_f32 v123, v123, v10
 v_sub_f32 v124, v124, v11
 v_sub_f32 v125, v125, v11
 v_sub_f32 v126, v126, v11
 v_sub_f32 v127, v127, v11
 v_sub_f32 v32, v32, v10
 v_sub_f32 v33, v33, v10
 v_sub_f32 v34, v34, v10
 v_sub_f32 v35, v35, v10
 v_sub_f32 v36, v36, v11
 v_sub_f32 v37, v37, v11
 v_sub_f32 v38, v38, v11
 v_sub_f32 v39, v39, v11
 v_exp_f32 v12, -v10
 v_exp_f32 v13, -v11
 v_mul_f32 v30, v12, v30
 v_mul_f32 v31, v13, v31
 v_mul_f32 v128, v12, v128
 v_mul_f32 v129, v12, v129
 v_mul_f32 v130, v12, v130
 v_mul_f32 v131, v12, v131
 v_mul_f32 v132, v13, v132
 v_mul_f32 v133, v13, v133
 v_mul_f32 v134, v13, v134
 v_mul_f32 v135, v13, v135
 v_mul_f32 v136, v12, v136
 v_mul_f32 v137, v12, v137
 v_mul_f32 v138, v12, v138
 v_mul_f32 v139, v12, v139
 v_mul_f32 v140, v13, v140
 v_mul_f32 v141, v13, v141
 v_mul_f32 v142, v13, v142
 v_mul_f32 v143, v13, v143
 v_mul_f32 v144, v12, v144
 v_mul_f32 v145, v12, v145
 v_mul_f32 v146, v12, v146
 v_mul_f32 v147, v12, v147
 v_mul_f32 v148, v13, v148
 v_mul_f32 v149, v13, v149
 v_mul_f32 v150, v13, v150
 v_mul_f32 v151, v13, v151
 v_mul_f32 v152, v12, v152
 v_mul_f32 v153, v12, v153
 v_mul_f32 v154, v12, v154
 v_mul_f32 v155, v12, v155
 v_mul_f32 v156, v13, v156
 v_mul_f32 v157, v13, v157
 v_mul_f32 v158, v13, v158
 v_mul_f32 v159, v13, v159
 v_mul_f32 v160, v12, v160
 v_mul_f32 v161, v12, v161
 v_mul_f32 v162, v12, v162
 v_mul_f32 v163, v12, v163
 v_mul_f32 v164, v13, v164
 v_mul_f32 v165, v13, v165
 v_mul_f32 v166, v13, v166
 v_mul_f32 v167, v13, v167
 v_mul_f32 v168, v12, v168
 v_mul_f32 v169, v12, v169
 v_mul_f32 v170, v12, v170
 v_mul_f32 v171, v12, v171
 v_mul_f32 v172, v13, v172
 v_mul_f32 v173, v13, v173
 v_mul_f32 v174, v13, v174
 v_mul_f32 v175, v13, v175
 v_mul_f32 v176, v12, v176
 v_mul_f32 v177, v12, v177
 v_mul_f32 v178, v12, v178
 v_mul_f32 v179, v12, v179
 v_mul_f32 v180, v13, v180
 v_mul_f32 v181, v13, v181
 v_mul_f32 v182, v13, v182
 v_mul_f32 v183, v13, v183
 v_mul_f32 v184, v12, v184
 v_mul_f32 v185, v12, v185
 v_mul_f32 v186, v12, v186
 v_mul_f32 v187, v12, v187
 v_mul_f32 v188, v13, v188
 v_mul_f32 v189, v13, v189
 v_mul_f32 v190, v13, v190
 v_mul_f32 v191, v13, v191
 v_mul_f32 v192, v12, v192
 v_mul_f32 v193, v12, v193
 v_mul_f32 v194, v12, v194
 v_mul_f32 v195, v12, v195
 v_mul_f32 v196, v13, v196
 v_mul_f32 v197, v13, v197
 v_mul_f32 v198, v13, v198
 v_mul_f32 v199, v13, v199
 v_mul_f32 v200, v12, v200
 v_mul_f32 v201, v12, v201
 v_mul_f32 v202, v12, v202
 v_mul_f32 v203, v12, v203
 v_mul_f32 v204, v13, v204
 v_mul_f32 v205, v13, v205
 v_mul_f32 v206, v13, v206
 v_mul_f32 v207, v13, v207
 v_mul_f32 v208, v12, v208
 v_mul_f32 v209, v12, v209
 v_mul_f32 v210, v12, v210
 v_mul_f32 v211, v12, v211
 v_mul_f32 v212, v13, v212
 v_mul_f32 v213, v13, v213
 v_mul_f32 v214, v13, v214
 v_mul_f32 v215, v13, v215
 v_mul_f32 v216, v12, v216
 v_mul_f32 v217, v12, v217
 v_mul_f32 v218, v12, v218
 v_mul_f32 v219, v12, v219
 v_mul_f32 v220, v13, v220
 v_mul_f32 v221, v13, v221
 v_mul_f32 v222, v13, v222
 v_mul_f32 v223, v13, v223
 v_mul_f32 v224, v12, v224
 v_mul_f32 v225, v12, v225
 v_mul_f32 v226, v12, v226
 v_mul_f32 v227, v12, v227
 v_mul_f32 v228, v13, v228
 v_mul_f32 v229, v13, v229
 v_mul_f32 v230, v13, v230
 v_mul_f32 v231, v13, v231
 v_mul_f32 v232, v12, v232
 v_mul_f32 v233, v12, v233
 v_mul_f32 v234, v12, v234
 v_mul_f32 v235, v12, v235
 v_mul_f32 v236, v13, v236
 v_mul_f32 v237, v13, v237
 v_mul_f32 v238, v13, v238
 v_mul_f32 v239, v13, v239
 v_mul_f32 v240, v12, v240
 v_mul_f32 v241, v12, v241
 v_mul_f32 v242, v12, v242
 v_mul_f32 v243, v12, v243
 v_mul_f32 v244, v13, v244
 v_mul_f32 v245, v13, v245
 v_mul_f32 v246, v13, v246
 v_mul_f32 v247, v13, v247
 v_mul_f32 v248, v12, v248
 v_mul_f32 v249, v12, v249
 v_mul_f32 v250, v12, v250
 v_mul_f32 v251, v12, v251
 v_mul_f32 v252, v13, v252
 v_mul_f32 v253, v13, v253
 v_mul_f32 v254, v13, v254
 v_mul_f32 v255, v13, v255
 v_exp_f32 v18, v64
 v_exp_f32 v19, v65
 v_exp_f32 v20, v66
 v_add_f32 v26, v18, v19
 v_cvt_pk_bf16_f32 v40, v18, v19
 v_exp_f32 v21, v67
 v_exp_f32 v22, v72
 v_add_f32 v26, v20, v26
 v_cvt_pk_bf16_f32 v41, v20, v21
 v_exp_f32 v23, v73
 v_add_f32 v26, v21, v26
 v_exp_f32 v24, v74
 v_add_f32 v26, v22, v26
 v_cvt_pk_bf16_f32 v42, v22, v23
 v_exp_f32 v25, v75
 v_add_f32 v26, v23, v26
 v_exp_f32 v18, v68
 v_add_f32 v26, v24, v26
 v_cvt_pk_bf16_f32 v43, v24, v25
 v_exp_f32 v19, v69
 v_add_f32 v26, v25, v26
 v_exp_f32 v20, v70
 v_add_f32 v27, v18, v19
 v_cvt_pk_bf16_f32 v44, v18, v19
 v_exp_f32 v21, v71
 v_exp_f32 v22, v76
 v_add_f32 v27, v20, v27
 v_cvt_pk_bf16_f32 v45, v20, v21
 v_exp_f32 v23, v77
 v_add_f32 v27, v21, v27
 v_exp_f32 v24, v78
 v_add_f32 v27, v22, v27
 v_cvt_pk_bf16_f32 v46, v22, v23
 v_exp_f32 v25, v79
 v_add_f32 v27, v23, v27
 v_add_f32 v27, v24, v27
 v_cvt_pk_bf16_f32 v47, v24, v25
 v_add_f32 v27, v25, v27
 v_exp_f32 v18, v80
 v_exp_f32 v19, v81
 v_exp_f32 v20, v82
 v_add_f32 v26, v18, v26
 v_cvt_pk_bf16_f32 v56, v18, v19
 v_exp_f32 v21, v83
 v_add_f32 v26, v19, v26
 v_exp_f32 v22, v88
 v_add_f32 v26, v20, v26
 v_cvt_pk_bf16_f32 v57, v20, v21
 v_exp_f32 v23, v89
 v_add_f32 v26, v21, v26
 v_exp_f32 v24, v90
 v_add_f32 v26, v22, v26
 v_cvt_pk_bf16_f32 v58, v22, v23
 v_exp_f32 v25, v91
 v_add_f32 v26, v23, v26
 v_exp_f32 v18, v84
 v_add_f32 v26, v24, v26
 v_cvt_pk_bf16_f32 v59, v24, v25
 v_exp_f32 v19, v85
 v_add_f32 v26, v25, v26
 v_exp_f32 v20, v86
 v_add_f32 v27, v18, v27
 v_cvt_pk_bf16_f32 v60, v18, v19
 v_exp_f32 v21, v87
 v_add_f32 v27, v19, v27
 v_exp_f32 v22, v92
 v_add_f32 v27, v20, v27
 v_cvt_pk_bf16_f32 v61, v20, v21
 v_exp_f32 v23, v93
 v_add_f32 v27, v21, v27
 v_exp_f32 v24, v94
 v_add_f32 v27, v22, v27
 v_cvt_pk_bf16_f32 v62, v22, v23
 v_exp_f32 v25, v95
 v_add_f32 v27, v23, v27
 v_add_f32 v27, v24, v27
 v_cvt_pk_bf16_f32 v63, v24, v25
 v_add_f32 v27, v25, v27
 s_nop 3
 s_setpc_b64 s[36:37]
L_slow1:
 s_nop 7
 s_nop 3
 v_max3_f32 v10, v96, v97, v98
 v_max3_f32 v10, v99, v104, v10
 v_max3_f32 v10, v105, v106, v10
 v_max3_f32 v10, v107, v112, v10
 v_max3_f32 v10, v113, v114, v10
 v_max3_f32 v10, v115, v120, v10
 v_max3_f32 v10, v121, v122, v10
 v_max_f32 v10, v123, v10
 v_max3_f32 v11, v100, v101, v102
 v_max3_f32 v11, v103, v108, v11
 v_max3_f32 v11, v109, v110, v11
 v_max3_f32 v11, v111, v116, v11
 v_max3_f32 v11, v117, v118, v11
 v_max3_f32 v11, v119, v124, v11
 v_max3_f32 v11, v125, v126, v11
 v_max_f32 v11, v127, v11
 v_mov_b32 v12, v10
 v_mov_b32 v13, v11
 s_nop 0
 v_permlane16_swap_b32 v12, v10
 v_permlane16_swap_b32 v13, v11
 v_max_f32 v10, v12, v10
 v_max_f32 v11, v13, v11
 v_mov_b32 v12, v10
 v_mov_b32 v13, v11
 s_nop 0
 v_permlane32_swap_b32 v12, v10
 v_permlane32_swap_b32 v13, v11
 v_max_f32 v10, v12, v10
 v_max_f32 v11, v13, v11
 v_ceil_f32 v10, v10
 v_ceil_f32 v11, v11
 v_max_f32 v10, 0, v10
 v_max_f32 v11, 0, v11
 v_sub_f32 v96, v96, v10
 v_sub_f32 v97, v97, v10
 v_sub_f32 v98, v98, v10
 v_sub_f32 v99, v99, v10
 v_sub_f32 v100, v100, v11
 v_sub_f32 v101, v101, v11
 v_sub_f32 v102, v102, v11
 v_sub_f32 v103, v103, v11
 v_sub_f32 v104, v104, v10
 v_sub_f32 v105, v105, v10
 v_sub_f32 v106, v106, v10
 v_sub_f32 v107, v107, v10
 v_sub_f32 v108, v108, v11
 v_sub_f32 v109, v109, v11
 v_sub_f32 v110, v110, v11
 v_sub_f32 v111, v111, v11
 v_sub_f32 v112, v112, v10
 v_sub_f32 v113, v113, v10
 v_sub_f32 v114, v114, v10
 v_sub_f32 v115, v115, v10
 v_sub_f32 v116, v116, v11
 v_sub_f32 v117, v117, v11
 v_sub_f32 v118, v118, v11
 v_sub_f32 v119, v119, v11
 v_sub_f32 v120, v120, v10
 v_sub_f32 v121, v121, v10
 v_sub_f32 v122, v122, v10
 v_sub_f32 v123, v123, v10
 v_sub_f32 v124, v124, v11
 v_sub_f32 v125, v125, v11
 v_sub_f32 v126, v126, v11
 v_sub_f32 v127, v127, v11
 v_sub_f32 v64, v64, v10
 v_sub_f32 v65, v65, v10
 v_sub_f32 v66, v66, v10
 v_sub_f32 v67, v67, v10
 v_sub_f32 v68, v68, v11
 v_sub_f32 v69, v69, v11
 v_sub_f32 v70, v70, v11
 v_sub_f32 v71, v71, v11
 v_sub_f32 v72, v72, v10
 v_sub_f32 v73, v73, v10
 v_sub_f32 v74, v74, v10
 v_sub_f32 v75, v75, v10
 v_sub_f32 v76, v76, v11
 v_sub_f32 v77, v77, v11
 v_sub_f32 v78, v78, v11
 v_sub_f32 v79, v79, v11
 v_sub_f32 v80, v80, v10
 v_sub_f32 v81, v81, v10
 v_sub_f32 v82, v82, v10
 v_sub_f32 v83, v83, v10
 v_sub_f32 v84, v84, v11
 v_sub_f32 v85, v85, v11
 v_sub_f32 v86, v86, v11
 v_sub_f32 v87, v87, v11
 v_sub_f32 v88, v88, v10
 v_sub_f32 v89, v89, v10
 v_sub_f32 v90, v90, v10
 v_sub_f32 v91, v91, v10
 v_sub_f32 v92, v92, v11
 v_sub_f32 v93, v93, v11
 v_sub_f32 v94, v94, v11
 v_sub_f32 v95, v95, v11
 v_sub_f32 v32, v32, v10
 v_sub_f32 v33, v33, v10
 v_sub_f32 v34, v34, v10
 v_sub_f32 v35, v35, v10
 v_sub_f32 v36, v36, v11
 v_sub_f32 v37, v37, v11
 v_sub_f32 v38, v38, v11
 v_sub_f32 v39, v39, v11
 v_exp_f32 v12, -v10
 v_exp_f32 v13, -v11
 v_mul_f32 v30, v12, v30
 v_mul_f32 v31, v13, v31
 v_mul_f32 v128, v12, v128
 v_mul_f32 v129, v12, v129
 v_mul_f32 v130, v12, v130
 v_mul_f32 v131, v12, v131
 v_mul_f32 v132, v13, v132
 v_mul_f32 v133, v13, v133
 v_mul_f32 v134, v13, v134
 v_mul_f32 v135, v13, v135
 v_mul_f32 v136, v12, v136
 v_mul_f32 v137, v12, v137
 v_mul_f32 v138, v12, v138
 v_mul_f32 v139, v12, v139
 v_mul_f32 v140, v13, v140
 v_mul_f32 v141, v13, v141
 v_mul_f32 v142, v13, v142
 v_mul_f32 v143, v13, v143
 v_mul_f32 v144, v12, v144
 v_mul_f32 v145, v12, v145
 v_mul_f32 v146, v12, v146
 v_mul_f32 v147, v12, v147
 v_mul_f32 v148, v13, v148
 v_mul_f32 v149, v13, v149
 v_mul_f32 v150, v13, v150
 v_mul_f32 v151, v13, v151
 v_mul_f32 v152, v12, v152
 v_mul_f32 v153, v12, v153
 v_mul_f32 v154, v12, v154
 v_mul_f32 v155, v12, v155
 v_mul_f32 v156, v13, v156
 v_mul_f32 v157, v13, v157
 v_mul_f32 v158, v13, v158
 v_mul_f32 v159, v13, v159
 v_mul_f32 v160, v12, v160
 v_mul_f32 v161, v12, v161
 v_mul_f32 v162, v12, v162
 v_mul_f32 v163, v12, v163
 v_mul_f32 v164, v13, v164
 v_mul_f32 v165, v13, v165
 v_mul_f32 v166, v13, v166
 v_mul_f32 v167, v13, v167
 v_mul_f32 v168, v12, v168
 v_mul_f32 v169, v12, v169
 v_mul_f32 v170, v12, v170
 v_mul_f32 v171, v12, v171
 v_mul_f32 v172, v13, v172
 v_mul_f32 v173, v13, v173
 v_mul_f32 v174, v13, v174
 v_mul_f32 v175, v13, v175
 v_mul_f32 v176, v12, v176
 v_mul_f32 v177, v12, v177
 v_mul_f32 v178, v12, v178
 v_mul_f32 v179, v12, v179
 v_mul_f32 v180, v13, v180
 v_mul_f32 v181, v13, v181
 v_mul_f32 v182, v13, v182
 v_mul_f32 v183, v13, v183
 v_mul_f32 v184, v12, v184
 v_mul_f32 v185, v12, v185
 v_mul_f32 v186, v12, v186
 v_mul_f32 v187, v12, v187
 v_mul_f32 v188, v13, v188
 v_mul_f32 v189, v13, v189
 v_mul_f32 v190, v13, v190
 v_mul_f32 v191, v13, v191
 v_mul_f32 v192, v12, v192
 v_mul_f32 v193, v12, v193
 v_mul_f32 v194, v12, v194
 v_mul_f32 v195, v12, v195
 v_mul_f32 v196, v13, v196
 v_mul_f32 v197, v13, v197
 v_mul_f32 v198, v13, v198
 v_mul_f32 v199, v13, v199
 v_mul_f32 v200, v12, v200
 v_mul_f32 v201, v12, v201
 v_mul_f32 v202, v12, v202
 v_mul_f32 v203, v12, v203
 v_mul_f32 v204, v13, v204
 v_mul_f32 v205, v13, v205
 v_mul_f32 v206, v13, v206
 v_mul_f32 v207, v13, v207
 v_mul_f32 v208, v12, v208
 v_mul_f32 v209, v12, v209
 v_mul_f32 v210, v12, v210
 v_mul_f32 v211, v12, v211
 v_mul_f32 v212, v13, v212
 v_mul_f32 v213, v13, v213
 v_mul_f32 v214, v13, v214
 v_mul_f32 v215, v13, v215
 v_mul_f32 v216, v12, v216
 v_mul_f32 v217, v12, v217
 v_mul_f32 v218, v12, v218
 v_mul_f32 v219, v12, v219
 v_mul_f32 v220, v13, v220
 v_mul_f32 v221, v13, v221
 v_mul_f32 v222, v13, v222
 v_mul_f32 v223, v13, v223
 v_mul_f32 v224, v12, v224
 v_mul_f32 v225, v12, v225
 v_mul_f32 v226, v12, v226
 v_mul_f32 v227, v12, v227
 v_mul_f32 v228, v13, v228
 v_mul_f32 v229, v13, v229
 v_mul_f32 v230, v13, v230
 v_mul_f32 v231, v13, v231
 v_mul_f32 v232, v12, v232
 v_mul_f32 v233, v12, v233
 v_mul_f32 v234, v12, v234
 v_mul_f32 v235, v12, v235
 v_mul_f32 v236, v13, v236
 v_mul_f32 v237, v13, v237
 v_mul_f32 v238, v13, v238
 v_mul_f32 v239, v13, v239
 v_mul_f32 v240, v12, v240
 v_mul_f32 v241, v12, v241
 v_mul_f32 v242, v12, v242
 v_mul_f32 v243, v12, v243
 v_mul_f32 v244, v13, v244
 v_mul_f32 v245, v13, v245
 v_mul_f32 v246, v13, v246
 v_mul_f32 v247, v13, v247
 v_mul_f32 v248, v12, v248
 v_mul_f32 v249, v12, v249
 v_mul_f32 v250, v12, v250
 v_mul_f32 v251, v12, v251
 v_mul_f32 v252, v13, v252
 v_mul_f32 v253, v13, v253
 v_mul_f32 v254, v13, v254
 v_mul_f32 v255, v13, v255
 v_exp_f32 v18, v96
 v_exp_f32 v19, v97
 v_exp_f32 v20, v98
 v_add_f32 v28, v18, v19
 v_cvt_pk_bf16_f32 v48, v18, v19
 v_exp_f32 v21, v99
 v_exp_f32 v22, v104
 v_add_f32 v28, v20, v28
 v_cvt_pk_bf16_f32 v49, v20, v21
 v_exp_f32 v23, v105
 v_add_f32 v28, v21, v28
 v_exp_f32 v24, v106
 v_add_f32 v28, v22, v28
 v_cvt_pk_bf16_f32 v50, v22, v23
 v_exp_f32 v25, v107
 v_add_f32 v28, v23, v28
 v_exp_f32 v18, v100
 v_add_f32 v28, v24, v28
 v_cvt_pk_bf16_f32 v51, v24, v25
 v_exp_f32 v19, v101
 v_add_f32 v28, v25, v28
 v_exp_f32 v20, v102
 v_add_f32 v29, v18, v19
 v_cvt_pk_bf16_f32 v52, v18, v19
 v_exp_f32 v21, v103
 v_exp_f32 v22, v108
 v_add_f32 v29, v20, v29
 v_cvt_pk_bf16_f32 v53, v20, v21
 v_exp_f32 v23, v109
 v_add_f32 v29, v21, v29
 v_exp_f32 v24, v110
 v_add_f32 v29, v22, v29
 v_cvt_pk_bf16_f32 v54, v22, v23
 v_exp_f32 v25, v111
 v_add_f32 v29, v23, v29
 v_add_f32 v29, v24, v29
 v_cvt_pk_bf16_f32 v55, v24, v25
 v_add_f32 v29, v25, v29
 v_exp_f32 v18, v112
 v_exp_f32 v19, v113
 v_exp_f32 v20, v114
 v_add_f32 v28, v18, v28
 v_cvt_pk_bf16_f32 v56, v18, v19
 v_exp_f32 v21, v115
 v_add_f32 v28, v19, v28
 v_exp_f32 v22, v120
 v_add_f32 v28, v20, v28
 v_cvt_pk_bf16_f32 v57, v20, v21
 v_exp_f32 v23, v121
 v_add_f32 v28, v21, v28
 v_exp_f32 v24, v122
 v_add_f32 v28, v22, v28
 v_cvt_pk_bf16_f32 v58, v22, v23
 v_exp_f32 v25, v123
 v_add_f32 v28, v23, v28
 v_exp_f32 v18, v116
 v_add_f32 v28, v24, v28
 v_cvt_pk_bf16_f32 v59, v24, v25
 v_exp_f32 v19, v117
 v_add_f32 v28, v25, v28
 v_exp_f32 v20, v118
 v_add_f32 v29, v18, v29
 v_cvt_pk_bf16_f32 v60, v18, v19
 v_exp_f32 v21, v119
 v_add_f32 v29, v19, v29
 v_exp_f32 v22, v124
 v_add_f32 v29, v20, v29
 v_cvt_pk_bf16_f32 v61, v20, v21
 v_exp_f32 v23, v125
 v_add_f32 v29, v21, v29
 v_exp_f32 v24, v126
 v_add_f32 v29, v22, v29
 v_cvt_pk_bf16_f32 v62, v22, v23
 v_exp_f32 v25, v127
 v_add_f32 v29, v23, v29
 v_add_f32 v29, v24, v29
 v_cvt_pk_bf16_f32 v63, v24, v25
 v_add_f32 v29, v25, v29
 s_nop 3
 s_setpc_b64 s[36:37]
L_slow1n:
 s_nop 7
 s_nop 3
 v_max3_f32 v10, v96, v97, v98
 v_max3_f32 v10, v99, v104, v10
 v_max3_f32 v10, v105, v106, v10
 v_max3_f32 v10, v107, v112, v10
 v_max3_f32 v10, v113, v114, v10
 v_max3_f32 v10, v115, v120, v10
 v_max3_f32 v10, v121, v122, v10
 v_max_f32 v10, v123, v10
 v_max3_f32 v11, v100, v101, v102
 v_max3_f32 v11, v103, v108, v11
 v_max3_f32 v11, v109, v110, v11
 v_max3_f32 v11, v111, v116, v11
 v_max3_f32 v11, v117, v118, v11
 v_max3_f32 v11, v119, v124, v11
 v_max3_f32 v11, v125, v126, v11
 v_max_f32 v11, v127, v11
 v_mov_b32 v12, v10
 v_mov_b32 v13, v11
 s_nop 0
 v_permlane16_swap_b32 v12, v10
 v_permlane16_swap_b32 v13, v11
 v_max_f32 v10, v12, v10
 v_max_f32 v11, v13, v11
 v_mov_b32 v12, v10
 v_mov_b32 v13, v11
 s_nop 0
 v_permlane32_swap_b32 v12, v10
 v_permlane32_swap_b32 v13, v11
 v_max_f32 v10, v12, v10
 v_max_f32 v11, v13, v11
 v_ceil_f32 v10, v10
 v_ceil_f32 v11, v11
 v_max_f32 v10, 0, v10
 v_max_f32 v11, 0, v11
 v_sub_f32 v96, v96, v10
 v_sub_f32 v97, v97, v10
 v_sub_f32 v98, v98, v10
 v_sub_f32 v99, v99, v10
 v_sub_f32 v100, v100, v11
 v_sub_f32 v101, v101, v11
 v_sub_f32 v102, v102, v11
 v_sub_f32 v103, v103, v11
 v_sub_f32 v104, v104, v10
 v_sub_f32 v105, v105, v10
 v_sub_f32 v106, v106, v10
 v_sub_f32 v107, v107, v10
 v_sub_f32 v108, v108, v11
 v_sub_f32 v109, v109, v11
 v_sub_f32 v110, v110, v11
 v_sub_f32 v111, v111, v11
 v_sub_f32 v112, v112, v10
 v_sub_f32 v113, v113, v10
 v_sub_f32 v114, v114, v10
 v_sub_f32 v115, v115, v10
 v_sub_f32 v116, v116, v11
 v_sub_f32 v117, v117, v11
 v_sub_f32 v118, v118, v11
 v_sub_f32 v119, v119, v11
 v_sub_f32 v120, v120, v10
 v_sub_f32 v121, v121, v10
 v_sub_f32 v122, v122, v10
 v_sub_f32 v123, v123, v10
 v_sub_f32 v124, v124, v11
 v_sub_f32 v125, v125, v11
 v_sub_f32 v126, v126, v11
 v_sub_f32 v127, v127, v11
 v_sub_f32 v32, v32, v10
 v_sub_f32 v33, v33, v10
 v_sub_f32 v34, v34, v10
 v_sub_f32 v35, v35, v10
 v_sub_f32 v36, v36, v11
 v_sub_f32 v37, v37, v11
 v_sub_f32 v38, v38, v11
 v_sub_f32 v39, v39, v11
 v_exp_f32 v12, -v10
 v_exp_f32 v13, -v11
 v_mul_f32 v30, v12, v30
 v_mul_f32 v31, v13, v31
 v_mul_f32 v128, v12, v128
 v_mul_f32 v129, v12, v129
 v_mul_f32 v130, v12, v130
 v_mul_f32 v131, v12, v131
 v_mul_f32 v132, v13, v132
 v_mul_f32 v133, v13, v133
 v_mul_f32 v134, v13, v134
 v_mul_f32 v135, v13, v135
 v_mul_f32 v136, v12, v136
 v_mul_f32 v137, v12, v137
 v_mul_f32 v138, v12, v138
 v_mul_f32 v139, v12, v139
 v_mul_f32 v140, v13, v140
 v_mul_f32 v141, v13, v141
 v_mul_f32 v142, v13, v142
 v_mul_f32 v143, v13, v143
 v_mul_f32 v144, v12, v144
 v_mul_f32 v145, v12, v145
 v_mul_f32 v146, v12, v146
 v_mul_f32 v147, v12, v147
 v_mul_f32 v148, v13, v148
 v_mul_f32 v149, v13, v149
 v_mul_f32 v150, v13, v150
 v_mul_f32 v151, v13, v151
 v_mul_f32 v152, v12, v152
 v_mul_f32 v153, v12, v153
 v_mul_f32 v154, v12, v154
 v_mul_f32 v155, v12, v155
 v_mul_f32 v156, v13, v156
 v_mul_f32 v157, v13, v157
 v_mul_f32 v158, v13, v158
 v_mul_f32 v159, v13, v159
 v_mul_f32 v160, v12, v160
 v_mul_f32 v161, v12, v161
 v_mul_f32 v162, v12, v162
 v_mul_f32 v163, v12, v163
 v_mul_f32 v164, v13, v164
 v_mul_f32 v165, v13, v165
 v_mul_f32 v166, v13, v166
 v_mul_f32 v167, v13, v167
 v_mul_f32 v168, v12, v168
 v_mul_f32 v169, v12, v169
 v_mul_f32 v170, v12, v170
 v_mul_f32 v171, v12, v171
 v_mul_f32 v172, v13, v172
 v_mul_f32 v173, v13, v173
 v_mul_f32 v174, v13, v174
 v_mul_f32 v175, v13, v175
 v_mul_f32 v176, v12, v176
 v_mul_f32 v177, v12, v177
 v_mul_f32 v178, v12, v178
 v_mul_f32 v179, v12, v179
 v_mul_f32 v180, v13, v180
 v_mul_f32 v181, v13, v181
 v_mul_f32 v182, v13, v182
 v_mul_f32 v183, v13, v183
 v_mul_f32 v184, v12, v184
 v_mul_f32 v185, v12, v185
 v_mul_f32 v186, v12, v186
 v_mul_f32 v187, v12, v187
 v_mul_f32 v188, v13, v188
 v_mul_f32 v189, v13, v189
 v_mul_f32 v190, v13, v190
 v_mul_f32 v191, v13, v191
 v_mul_f32 v192, v12, v192
 v_mul_f32 v193, v12, v193
 v_mul_f32 v194, v12, v194
 v_mul_f32 v195, v12, v195
 v_mul_f32 v196, v13, v196
 v_mul_f32 v197, v13, v197
 v_mul_f32 v198, v13, v198
 v_mul_f32 v199, v13, v199
 v_mul_f32 v200, v12, v200
 v_mul_f32 v201, v12, v201
 v_mul_f32 v202, v12, v202
 v_mul_f32 v203, v12, v203
 v_mul_f32 v204, v13, v204
 v_mul_f32 v205, v13, v205
 v_mul_f32 v206, v13, v206
 v_mul_f32 v207, v13, v207
 v_mul_f32 v208, v12, v208
 v_mul_f32 v209, v12, v209
 v_mul_f32 v210, v12, v210
 v_mul_f32 v211, v12, v211
 v_mul_f32 v212, v13, v212
 v_mul_f32 v213, v13, v213
 v_mul_f32 v214, v13, v214
 v_mul_f32 v215, v13, v215
 v_mul_f32 v216, v12, v216
 v_mul_f32 v217, v12, v217
 v_mul_f32 v218, v12, v218
 v_mul_f32 v219, v12, v219
 v_mul_f32 v220, v13, v220
 v_mul_f32 v221, v13, v221
 v_mul_f32 v222, v13, v222
 v_mul_f32 v223, v13, v223
 v_mul_f32 v224, v12, v224
 v_mul_f32 v225, v12, v225
 v_mul_f32 v226, v12, v226
 v_mul_f32 v227, v12, v227
 v_mul_f32 v228, v13, v228
 v_mul_f32 v229, v13, v229
 v_mul_f32 v230, v13, v230
 v_mul_f32 v231, v13, v231
 v_mul_f32 v232, v12, v232
 v_mul_f32 v233, v12, v233
 v_mul_f32 v234, v12, v234
 v_mul_f32 v235, v12, v235
 v_mul_f32 v236, v13, v236
 v_mul_f32 v237, v13, v237
 v_mul_f32 v238, v13, v238
 v_mul_f32 v239, v13, v239
 v_mul_f32 v240, v12, v240
 v_mul_f32 v241, v12, v241
 v_mul_f32 v242, v12, v242
 v_mul_f32 v243, v12, v243
 v_mul_f32 v244, v13, v244
 v_mul_f32 v245, v13, v245
 v_mul_f32 v246, v13, v246
 v_mul_f32 v247, v13, v247
 v_mul_f32 v248, v12, v248
 v_mul_f32 v249, v12, v249
 v_mul_f32 v250, v12, v250
 v_mul_f32 v251, v12, v251
 v_mul_f32 v252, v13, v252
 v_mul_f32 v253, v13, v253
 v_mul_f32 v254, v13, v254
 v_mul_f32 v255, v13, v255
 v_exp_f32 v18, v96
 v_exp_f32 v19, v97
 v_exp_f32 v20, v98
 v_add_f32 v28, v18, v19
 v_cvt_pk_bf16_f32 v48, v18, v19
 v_exp_f32 v21, v99
 v_exp_f32 v22, v104
 v_add_f32 v28, v20, v28
 v_cvt_pk_bf16_f32 v49, v20, v21
 v_exp_f32 v23, v105
 v_add_f32 v28, v21, v28
 v_exp_f32 v24, v106
 v_add_f32 v28, v22, v28
 v_cvt_pk_bf16_f32 v50, v22, v23
 v_exp_f32 v25, v107
 v_add_f32 v28, v23, v28
 v_exp_f32 v18, v100
 v_add_f32 v28, v24, v28
 v_cvt_pk_bf16_f32 v51, v24, v25
 v_exp_f32 v19, v101
 v_add_f32 v28, v25, v28
 v_exp_f32 v20, v102
 v_add_f32 v29, v18, v19
 v_cvt_pk_bf16_f32 v52, v18, v19
 v_exp_f32 v21, v103
 v_exp_f32 v22, v108
 v_add_f32 v29, v20, v29
 v_cvt_pk_bf16_f32 v53, v20, v21
 v_exp_f32 v23, v109
 v_add_f32 v29, v21, v29
 v_exp_f32 v24, v110
 v_add_f32 v29, v22, v29
 v_cvt_pk_bf16_f32 v54, v22, v23
 v_exp_f32 v25, v111
 v_add_f32 v29, v23, v29
 v_add_f32 v29, v24, v29
 v_cvt_pk_bf16_f32 v55, v24, v25
 v_add_f32 v29, v25, v29
 v_exp_f32 v18, v112
 v_exp_f32 v19, v113
 v_exp_f32 v20, v114
 v_add_f32 v28, v18, v28
 v_cvt_pk_bf16_f32 v56, v18, v19
 v_exp_f32 v21, v115
 v_add_f32 v28, v19, v28
 v_exp_f32 v22, v120
 v_add_f32 v28, v20, v28
 v_cvt_pk_bf16_f32 v57, v20, v21
 v_exp_f32 v23, v121
 v_add_f32 v28, v21, v28
 v_exp_f32 v24, v122
 v_add_f32 v28, v22, v28
 v_cvt_pk_bf16_f32 v58, v22, v23
 v_exp_f32 v25, v123
 v_add_f32 v28, v23, v28
 v_exp_f32 v18, v116
 v_add_f32 v28, v24, v28
 v_cvt_pk_bf16_f32 v59, v24, v25
 v_exp_f32 v19, v117
 v_add_f32 v28, v25, v28
 v_exp_f32 v20, v118
 v_add_f32 v29, v18, v29
 v_cvt_pk_bf16_f32 v60, v18, v19
 v_exp_f32 v21, v119
 v_add_f32 v29, v19, v29
 v_exp_f32 v22, v124
 v_add_f32 v29, v20, v29
 v_cvt_pk_bf16_f32 v61, v20, v21
 v_exp_f32 v23, v125
 v_add_f32 v29, v21, v29
 v_exp_f32 v24, v126
 v_add_f32 v29, v22, v29
 v_cvt_pk_bf16_f32 v62, v22, v23
 v_exp_f32 v25, v127
 v_add_f32 v29, v23, v29
 v_add_f32 v29, v24, v29
 v_cvt_pk_bf16_f32 v63, v24, v25
 v_add_f32 v29, v25, v29
 s_nop 3
 s_setpc_b64 s[36:37]
L_slow0B:
 s_nop 7
 s_nop 3
 v_max3_f32 v10, v64, v65, v66
 v_max3_f32 v10, v67, v72, v10
 v_max3_f32 v10, v73, v74, v10
 v_max3_f32 v10, v75, v80, v10
 v_max3_f32 v10, v81, v82, v10
 v_max3_f32 v10, v83, v88, v10
 v_max3_f32 v10, v89, v90, v10
 v_max_f32 v10, v91, v10
 v_max3_f32 v11, v68, v69, v70
 v_max3_f32 v11, v71, v76, v11
 v_max3_f32 v11, v77, v78, v11
 v_max3_f32 v11, v79, v84, v11
 v_max3_f32 v11, v85, v86, v11
 v_max3_f32 v11, v87, v92, v11
 v_max3_f32 v11, v93, v94, v11
 v_max_f32 v11, v95, v11
 v_mov_b32 v12, v10
 v_mov_b32 v13, v11
 s_nop 0
 v_permlane16_swap_b32 v12, v10
 v_permlane16_swap_b32 v13, v11
 v_max_f32 v10, v12, v10
 v_max_f32 v11, v13, v11
 v_mov_b32 v12, v10
 v_mov_b32 v13, v11
 s_nop 0
 v_permlane32_swap_b32 v12, v10
 v_permlane32_swap_b32 v13, v11
 v_max_f32 v10, v12, v10
 v_max_f32 v11, v13, v11
 v_ceil_f32 v10, v10
 v_ceil_f32 v11, v11
 v_max_f32 v10, 0, v10
 v_max_f32 v11, 0, v11
 v_sub_f32 v64, v64, v10
 v_sub_f32 v65, v65, v10
 v_sub_f32 v66, v66, v10
 v_sub_f32 v67, v67, v10
 v_sub_f32 v68, v68, v11
 v_sub_f32 v69, v69, v11
 v_sub_f32 v70, v70, v11
 v_sub_f32 v71, v71, v11
 v_sub_f32 v72, v72, v10
 v_sub_f32 v73, v73, v10
 v_sub_f32 v74, v74, v10
 v_sub_f32 v75, v75, v10
 v_sub_f32 v76, v76, v11
 v_sub_f32 v77, v77, v11
 v_sub_f32 v78, v78, v11
 v_sub_f32 v79, v79, v11
 v_sub_f32 v80, v80, v10
 v_sub_f32 v81, v81, v10
 v_sub_f32 v82, v82, v10
 v_sub_f32 v83, v83, v10
 v_sub_f32 v84, v84, v11
 v_sub_f32 v85, v85, v11
 v_sub_f32 v86, v86, v11
 v_sub_f32 v87, v87, v11
 v_sub_f32 v88, v88, v10
 v_sub_f32 v89, v89, v10
 v_sub_f32 v90, v90, v10
 v_sub_f32 v91, v91, v10
 v_sub_f32 v92, v92, v11
 v_sub_f32 v93, v93, v11
 v_sub_f32 v94, v94, v11
 v_sub_f32 v95, v95, v11
 v_sub_f32 v100, v100, v11
 v_sub_f32 v101, v101, v11
 v_sub_f32 v102, v102, v11
 v_sub_f32 v103, v103, v11
 v_sub_f32 v108, v108, v11
 v_sub_f32 v109, v109, v11
 v_sub_f32 v110, v110, v11
 v_sub_f32 v111, v111, v11
 v_sub_f32 v116, v116, v11
 v_sub_f32 v117, v117, v11
 v_sub_f32 v118, v118, v11
 v_sub_f32 v119, v119, v11
 v_sub_f32 v124, v124, v11
 v_sub_f32 v125, v125, v11
 v_sub_f32 v126, v126, v11
 v_sub_f32 v127, v127, v11
 v_sub_f32 v32, v32, v10
 v_sub_f32 v33, v33, v10
 v_sub_f32 v34, v34, v10
 v_sub_f32 v35, v35, v10
 v_sub_f32 v36, v36, v11
 v_sub_f32 v37, v37, v11
 v_sub_f32 v38, v38, v11
 v_sub_f32 v39, v39, v11
 v_exp_f32 v12, -v10
 v_exp_f32 v13, -v11
 v_mul_f32 v30, v12, v30
 v_mul_f32 v31, v13, v31
 v_mul_f32 v128, v12, v128
 v_mul_f32 v129, v12, v129
 v_mul_f32 v130, v12, v130
 v_mul_f32 v131, v12, v131
 v_mul_f32 v132, v13, v132
 v_mul_f32 v133, v13, v133
 v_mul_f32 v134, v13, v134
 v_mul_f32 v135, v13, v135
 v_mul_f32 v136, v12, v136
 v_mul_f32 v137, v12, v137
 v_mul_f32 v138, v12, v138
 v_mul_f32 v139, v12, v139
 v_mul_f32 v140, v13, v140
 v_mul_f32 v141, v13, v141
 v_mul_f32 v142, v13, v142
 v_mul_f32 v143, v13, v143
 v_mul_f32 v144, v12, v144
 v_mul_f32 v145, v12, v145
 v_mul_f32 v146, v12, v146
 v_mul_f32 v147, v12, v147
 v_mul_f32 v148, v13, v148
 v_mul_f32 v149, v13, v149
 v_mul_f32 v150, v13, v150
 v_mul_f32 v151, v13, v151
 v_mul_f32 v152, v12, v152
 v_mul_f32 v153, v12, v153
 v_mul_f32 v154, v12, v154
 v_mul_f32 v155, v12, v155
 v_mul_f32 v156, v13, v156
 v_mul_f32 v157, v13, v157
 v_mul_f32 v158, v13, v158
 v_mul_f32 v159, v13, v159
 v_mul_f32 v160, v12, v160
 v_mul_f32 v161, v12, v161
 v_mul_f32 v162, v12, v162
 v_mul_f32 v163, v12, v163
 v_mul_f32 v164, v13, v164
 v_mul_f32 v165, v13, v165
 v_mul_f32 v166, v13, v166
 v_mul_f32 v167, v13, v167
 v_mul_f32 v168, v12, v168
 v_mul_f32 v169, v12, v169
 v_mul_f32 v170, v12, v170
 v_mul_f32 v171, v12, v171
 v_mul_f32 v172, v13, v172
 v_mul_f32 v173, v13, v173
 v_mul_f32 v174, v13, v174
 v_mul_f32 v175, v13, v175
 v_mul_f32 v176, v12, v176
 v_mul_f32 v177, v12, v177
 v_mul_f32 v178, v12, v178
 v_mul_f32 v179, v12, v179
 v_mul_f32 v180, v13, v180
 v_mul_f32 v181, v13, v181
 v_mul_f32 v182, v13, v182
 v_mul_f32 v183, v13, v183
 v_mul_f32 v184, v12, v184
 v_mul_f32 v185, v12, v185
 v_mul_f32 v186, v12, v186
 v_mul_f32 v187, v12, v187
 v_mul_f32 v188, v13, v188
 v_mul_f32 v189, v13, v189
 v_mul_f32 v190, v13, v190
 v_mul_f32 v191, v13, v191
 v_mul_f32 v192, v12, v192
 v_mul_f32 v193, v12, v193
 v_mul_f32 v194, v12, v194
 v_mul_f32 v195, v12, v195
 v_mul_f32 v196, v13, v196
 v_mul_f32 v197, v13, v197
 v_mul_f32 v198, v13, v198
 v_mul_f32 v199, v13, v199
 v_mul_f32 v200, v12, v200
 v_mul_f32 v201, v12, v201
 v_mul_f32 v202, v12, v202
 v_mul_f32 v203, v12, v203
 v_mul_f32 v204, v13, v204
 v_mul_f32 v205, v13, v205
 v_mul_f32 v206, v13, v206
 v_mul_f32 v207, v13, v207
 v_mul_f32 v208, v12, v208
 v_mul_f32 v209, v12, v209
 v_mul_f32 v210, v12, v210
 v_mul_f32 v211, v12, v211
 v_mul_f32 v212, v13, v212
 v_mul_f32 v213, v13, v213
 v_mul_f32 v214, v13, v214
 v_mul_f32 v215, v13, v215
 v_mul_f32 v216, v12, v216
 v_mul_f32 v217, v12, v217
 v_mul_f32 v218, v12, v218
 v_mul_f32 v219, v12, v219
 v_mul_f32 v220, v13, v220
 v_mul_f32 v221, v13, v221
 v_mul_f32 v222, v13, v222
 v_mul_f32 v223, v13, v223
 v_mul_f32 v224, v12, v224
 v_mul_f32 v225, v12, v225
 v_mul_f32 v226, v12, v226
 v_mul_f32 v227, v12, v227
 v_mul_f32 v228, v13, v228
 v_mul_f32 v229, v13, v229
 v_mul_f32 v230, v13, v230
 v_mul_f32 v231, v13, v231
 v_mul_f32 v232, v12, v232
 v_mul_f32 v233, v12, v233
 v_mul_f32 v234, v12, v234
 v_mul_f32 v235, v12, v235
 v_mul_f32 v236, v13, v236
 v_mul_f32 v237, v13, v237
 v_mul_f32 v238, v13, v238
 v_mul_f32 v239, v13, v239
 v_mul_f32 v240, v12, v240
 v_mul_f32 v241, v12, v241
 v_mul_f32 v242, v12, v242
 v_mul_f32 v243, v12, v243
 v_mul_f32 v244, v13, v244
 v_mul_f32 v245, v13, v245
 v_mul_f32 v246, v13, v246
 v_mul_f32 v247, v13, v247
 v_mul_f32 v248, v12, v248
 v_mul_f32 v249, v12, v249
 v_mul_f32 v250, v12, v250
 v_mul_f32 v251, v12, v251
 v_mul_f32 v252, v13, v252
 v_mul_f32 v253, v13, v253
 v_mul_f32 v254, v13, v254
 v_mul_f32 v255, v13, v255
 v_exp_f32 v18, v64
 v_exp_f32 v19, v65
 v_exp_f32 v20, v66
 v_add_f32 v26, v18, v19
 v_cvt_pk_bf16_f32 v40, v18, v19
 v_exp_f32 v21, v67
 v_exp_f32 v22, v72
 v_add_f32 v26, v20, v26
 v_cvt_pk_bf16_f32 v41, v20, v21
 v_exp_f32 v23, v73
 v_add_f32 v26, v21, v26
 v_exp_f32 v24, v74
 v_add_f32 v26, v22, v26
 v_cvt_pk_bf16_f32 v42, v22, v23
 v_exp_f32 v25, v75
 v_add_f32 v26, v23, v26
 v_exp_f32 v18, v68
 v_add_f32 v26, v24, v26
 v_cvt_pk_bf16_f32 v43, v24, v25
 v_exp_f32 v19, v69
 v_add_f32 v26, v25, v26
 v_exp_f32 v20, v70
 v_add_f32 v27, v18, v19
 v_cvt_pk_bf16_f32 v44, v18, v19
 v_exp_f32 v21, v71
 v_exp_f32 v22, v76
 v_add_f32 v27, v20, v27
 v_cvt_pk_bf16_f32 v45, v20, v21
 v_exp_f32 v23, v77
 v_add_f32 v27, v21, v27
 v_exp_f32 v24, v78
 v_add_f32 v27, v22, v27
 v_cvt_pk_bf16_f32 v46, v22, v23
 v_exp_f32 v25, v79
 v_add_f32 v27, v23, v27
 v_add_f32 v27, v24, v27
 v_cvt_pk_bf16_f32 v47, v24, v25
 v_add_f32 v27, v25, v27
 v_exp_f32 v18, v80
 v_exp_f32 v19, v81
 v_exp_f32 v20, v82
 v_add_f32 v26, v18, v26
 v_cvt_pk_bf16_f32 v56, v18, v19
 v_exp_f32 v21, v83
 v_add_f32 v26, v19, v26
 v_exp_f32 v22, v88
 v_add_f32 v26, v20, v26
 v_cvt_pk_bf16_f32 v57, v20, v21
 v_exp_f32 v23, v89
 v_add_f32 v26, v21, v26
 v_exp_f32 v24, v90
 v_add_f32 v26, v22, v26
 v_cvt_pk_bf16_f32 v58, v22, v23
 v_exp_f32 v25, v91
 v_add_f32 v26, v23, v26
 v_exp_f32 v18, v84
 v_add_f32 v26, v24, v26
 v_cvt_pk_bf16_f32 v59, v24, v25
 v_exp_f32 v19, v85
 v_add_f32 v26, v25, v26
 v_exp_f32 v20, v86
 v_add_f32 v27, v18, v27
 v_cvt_pk_bf16_f32 v60, v18, v19
 v_exp_f32 v21, v87
 v_add_f32 v27, v19, v27
 v_exp_f32 v22, v92
 v_add_f32 v27, v20, v27
 v_cvt_pk_bf16_f32 v61, v20, v21
 v_exp_f32 v23, v93
 v_add_f32 v27, v21, v27
 v_exp_f32 v24, v94
 v_add_f32 v27, v22, v27
 v_cvt_pk_bf16_f32 v62, v22, v23
 v_exp_f32 v25, v95
 v_add_f32 v27, v23, v27
 v_add_f32 v27, v24, v27
 v_cvt_pk_bf16_f32 v63, v24, v25
 v_add_f32 v27, v25, v27
 s_nop 3
 s_setpc_b64 s[36:37]
L_slowB:
 s_nop 7
 s_nop 3
 v_max3_f32 v11, v100, v101, v102
 v_max3_f32 v11, v103, v108, v11
 v_max3_f32 v11, v109, v110, v11
 v_max3_f32 v11, v111, v116, v11
 v_max3_f32 v11, v117, v118, v11
 v_max3_f32 v11, v119, v124, v11
 v_max3_f32 v11, v125, v126, v11
 v_max_f32 v11, v127, v11
 v_mov_b32 v13, v11
 s_nop 1
 v_permlane16_swap_b32 v13, v11
 v_max_f32 v11, v13, v11
 v_mov_b32 v13, v11
 s_nop 1
 v_permlane32_swap_b32 v13, v11
 v_max_f32 v11, v13, v11
 v_ceil_f32 v11, v11
 v_max_f32 v11, 0, v11
 v_sub_f32 v100, v100, v11
 v_sub_f32 v101, v101, v11
 v_sub_f32 v102, v102, v11
 v_sub_f32 v103, v103, v11
 v_sub_f32 v108, v108, v11
 v_sub_f32 v109, v109, v11
 v_sub_f32 v110, v110, v11
 v_sub_f32 v111, v111, v11
 v_sub_f32 v116, v116, v11
 v_sub_f32 v117, v117, v11
 v_sub_f32 v118, v118, v11
 v_sub_f32 v119, v119, v11
 v_sub_f32 v124, v124, v11
 v_sub_f32 v125, v125, v11
 v_sub_f32 v126, v126, v11
 v_sub_f32 v127, v127, v11
 v_sub_f32 v36, v36, v11
 v_sub_f32 v37, v37, v11
 v_sub_f32 v38, v38, v11
 v_sub_f32 v39, v39, v11
 v_exp_f32 v13, -v11
 s_nop 0
 v_mul_f32 v31, v13, v31
 v_mul_f32 v132, v13, v132
 v_mul_f32 v133, v13, v133
 v_mul_f32 v134, v13, v134
 v_mul_f32 v135, v13, v135
 v_mul_f32 v140, v13, v140
 v_mul_f32 v141, v13, v141
 v_mul_f32 v142, v13, v142
 v_mul_f32 v143, v13, v143
 v_mul_f32 v148, v13, v148
 v_mul_f32 v149, v13, v149
 v_mul_f32 v150, v13, v150
 v_mul_f32 v151, v13, v151
 v_mul_f32 v156, v13, v156
 v_mul_f32 v157, v13, v157
 v_mul_f32 v158, v13, v158
 v_mul_f32 v159, v13, v159
 v_mul_f32 v164, v13, v164
 v_mul_f32 v165, v13, v165
 v_mul_f32 v166, v13, v166
 v_mul_f32 v167, v13, v167
 v_mul_f32 v172, v13, v172
 v_mul_f32 v173, v13, v173
 v_mul_f32 v174, v13, v174
 v_mul_f32 v175, v13, v175
 v_mul_f32 v180, v13, v180
 v_mul_f32 v181, v13, v181
 v_mul_f32 v182, v13, v182
 v_mul_f32 v183, v13, v183
 v_mul_f32 v188, v13, v188
 v_mul_f32 v189, v13, v189
 v_mul_f32 v190, v13, v190
 v_mul_f32 v191, v13, v191
 v_mul_f32 v196, v13, v196
 v_mul_f32 v197, v13, v197
 v_mul_f32 v198, v13, v198
 v_mul_f32 v199, v13, v199
 v_mul_f32 v204, v13, v204
 v_mul_f32 v205, v13, v205
 v_mul_f32 v206, v13, v206
 v_mul_f32 v207, v13, v207
 v_mul_f32 v212, v13, v212
 v_mul_f32 v213, v13, v213
 v_mul_f32 v214, v13, v214
 v_mul_f32 v215, v13, v215
 v_mul_f32 v220, v13, v220
 v_mul_f32 v221, v13, v221
 v_mul_f32 v222, v13, v222
 v_mul_f32 v223, v13, v223
 v_mul_f32 v228, v13, v228
 v_mul_f32 v229, v13, v229
 v_mul_f32 v230, v13, v230
 v_mul_f32 v231, v13, v231
 v_mul_f32 v236, v13, v236
 v_mul_f32 v237, v13, v237
 v_mul_f32 v238, v13, v238
 v_mul_f32 v239, v13, v239
 v_mul_f32 v244, v13, v244
 v_mul_f32 v245, v13, v245
 v_mul_f32 v246, v13, v246
 v_mul_f32 v247, v13, v247
 v_mul_f32 v252, v13, v252
 v_mul_f32 v253, v13, v253
 v_mul_f32 v254, v13, v254
 v_mul_f32 v255, v13, v255
 v_exp_f32 v18, v100
 v_exp_f32 v19, v101
 v_exp_f32 v20, v102
 v_add_f32 v29, v18, v19
 v_cvt_pk_bf16_f32 v52, v18, v19
 v_exp_f32 v21, v103
 v_exp_f32 v22, v108
 v_add_f32 v29, v20, v29
 v_cvt_pk_bf16_f32 v53, v20, v21
 v_exp_f32 v23, v109
 v_add_f32 v29, v21, v29
 v_exp_f32 v24, v110
 v_add_f32 v29, v22, v29
 v_cvt_pk_bf16_f32 v54, v22, v23
 v_exp_f32 v25, v111
 v_add_f32 v29, v23, v29
 v_exp_f32 v18, v116
 v_add_f32 v29, v24, v29
 v_cvt_pk_bf16_f32 v55, v24, v25
 v_exp_f32 v19, v117
 v_add_f32 v29, v25, v29
 v_exp_f32 v20, v118
 v_add_f32 v29, v18, v29
 v_cvt_pk_bf16_f32 v48, v18, v19
 v_exp_f32 v21, v119
 v_add_f32 v29, v19, v29
 v_exp_f32 v22, v124
 v_add_f32 v29, v20, v29
 v_cvt_pk_bf16_f32 v49, v20, v21
 v_exp_f32 v23, v125
 v_add_f32 v29, v21, v29
 v_exp_f32 v24, v126
 v_add_f32 v29, v22, v29
 v_cvt_pk_bf16_f32 v50, v22, v23
 v_exp_f32 v25, v127
 v_add_f32 v29, v23, v29
 v_add_f32 v29, v24, v29
 v_cvt_pk_bf16_f32 v51, v24, v25
 v_add_f32 v29, v25, v29
 s_nop 3
 s_setpc_b64 s[36:37]
L_slowf:
 s_nop 7
 s_nop 3
 v_max3_f32 v10, v64, v65, v66
 v_max3_f32 v10, v67, v72, v10
 v_max3_f32 v10, v73, v74, v10
 v_max3_f32 v10, v75, v80, v10
 v_max3_f32 v10, v81, v82, v10
 v_max3_f32 v10, v83, v88, v10
 v_max3_f32 v10, v89, v90, v10
 v_max_f32 v10, v91, v10
 v_max3_f32 v11, v68, v69, v70
 v_max3_f32 v11, v71, v76, v11
 v_max3_f32 v11, v77, v78, v11
 v_max3_f32 v11, v79, v84, v11
 v_max3_f32 v11, v85, v86, v11
 v_max3_f32 v11, v87, v92, v11
 v_max3_f32 v11, v93, v94, v11
 v_max_f32 v11, v95, v11
 v_mov_b32 v12, v10
 v_mov_b32 v13, v11
 s_nop 0
 v_permlane16_swap_b32 v12, v10
 v_permlane16_swap_b32 v13, v11
 v_max_f32 v10, v12, v10
 v_max_f32 v11, v13, v11
 v_mov_b32 v12, v10
 v_mov_b32 v13, v11
 s_nop 0
 v_permlane32_swap_b32 v12, v10
 v_permlane32_swap_b32 v13, v11
 v_max_f32 v10, v12, v10
 v_max_f32 v11, v13, v11
 v_ceil_f32 v10, v10
 v_ceil_f32 v11, v11
 v_sub_f32 v64, v64, v10
 v_sub_f32 v65, v65, v10
 v_sub_f32 v66, v66, v10
 v_sub_f32 v67, v67, v10
 v_sub_f32 v68, v68, v11
 v_sub_f32 v69, v69, v11
 v_sub_f32 v70, v70, v11
 v_sub_f32 v71, v71, v11
 v_sub_f32 v72, v72, v10
 v_sub_f32 v73, v73, v10
 v_sub_f32 v74, v74, v10
 v_sub_f32 v75, v75, v10
 v_sub_f32 v76, v76, v11
 v_sub_f32 v77, v77, v11
 v_sub_f32 v78, v78, v11
 v_sub_f32 v79, v79, v11
 v_sub_f32 v80, v80, v10
 v_sub_f32 v81, v81, v10
 v_sub_f32 v82, v82, v10
 v_sub_f32 v83, v83, v10
 v_sub_f32 v84, v84, v11
 v_sub_f32 v85, v85, v11
 v_sub_f32 v86, v86, v11
 v_sub_f32 v87, v87, v11
 v_sub_f32 v88, v88, v10
 v_sub_f32 v89, v89, v10
 v_sub_f32 v90, v90, v10
 v_sub_f32 v91, v91, v10
 v_sub_f32 v92, v92, v11
 v_sub_f32 v93, v93, v11
 v_sub_f32 v94, v94, v11
 v_sub_f32 v95, v95, v11
 v_sub_f32 v96, v96, v10
 v_sub_f32 v97, v97, v10
 v_sub_f32 v98, v98, v10
 v_sub_f32 v99, v99, v10
 v_sub_f32 v100, v100, v11
 v_sub_f32 v101, v101, v11
 v_sub_f32 v102, v102, v11
 v_sub_f32 v103, v103, v11
 v_sub_f32 v104, v104, v10
 v_sub_f32 v105, v105, v10
 v_sub_f32 v106, v106, v10
 v_sub_f32 v107, v107, v10
 v_sub_f32 v108, v108, v11
 v_sub_f32 v109, v109, v11
 v_sub_f32 v110, v110, v11
 v_sub_f32 v111, v111, v11
 v_sub_f32 v112, v112, v10
 v_sub_f32 v113, v113, v10
 v_sub_f32 v114, v114, v10
 v_sub_f32 v115, v115, v10
 v_sub_f32 v116, v116, v11
 v_sub_f32 v117, v117, v11
 v_sub_f32 v118, v118, v11
 v_sub_f32 v119, v119, v11
 v_sub_f32 v120, v120, v10
 v_sub_f32 v121, v121, v10
 v_sub_f32 v122, v122, v10
 v_sub_f32 v123, v123, v10
 v_sub_f32 v124, v124, v11
 v_sub_f32 v125, v125, v11
 v_sub_f32 v126, v126, v11
 v_sub_f32 v127, v127, v11
 v_sub_f32 v32, v32, v10
 v_sub_f32 v33, v33, v10
 v_sub_f32 v34, v34, v10
 v_sub_f32 v35, v35, v10
 v_sub_f32 v36, v36, v11
 v_sub_f32 v37, v37, v11
 v_sub_f32 v38, v38, v11
 v_sub_f32 v39, v39, v11
 v_exp_f32 v18, v64
 v_exp_f32 v19, v65
 v_exp_f32 v20, v66
 v_add_f32 v26, v18, v19
 v_cvt_pk_bf16_f32 v40, v18, v19
 v_exp_f32 v21, v67
 v_exp_f32 v22, v72
 v_add_f32 v26, v20, v26
 v_cvt_pk_bf16_f32 v41, v20, v21
 v_exp_f32 v23, v73
 v_add_f32 v26, v21, v26
 v_exp_f32 v24, v74
 v_add_f32 v26, v22, v26
 v_cvt_pk_bf16_f32 v42, v22, v23
 v_exp_f32 v25, v75
 v_add_f32 v26, v23, v26
 v_exp_f32 v18, v68
 v_add_f32 v26, v24, v26
 v_cvt_pk_bf16_f32 v43, v24, v25
 v_exp_f32 v19, v69
 v_add_f32 v26, v25, v26
 v_exp_f32 v20, v70
 v_add_f32 v27, v18, v19
 v_cvt_pk_bf16_f32 v44, v18, v19
 v_exp_f32 v21, v71
 v_exp_f32 v22, v76
 v_add_f32 v27, v20, v27
 v_cvt_pk_bf16_f32 v45, v20, v21
 v_exp_f32 v23, v77
 v_add_f32 v27, v21, v27
 v_exp_f32 v24, v78
 v_add_f32 v27, v22, v27
 v_cvt_pk_bf16_f32 v46, v22, v23
 v_exp_f32 v25, v79
 v_add_f32 v27, v23, v27
 v_add_f32 v27, v24, v27
 v_cvt_pk_bf16_f32 v47, v24, v25
 v_add_f32 v27, v25, v27
 v_exp_f32 v18, v80
 v_exp_f32 v19, v81
 v_exp_f32 v20, v82
 v_add_f32 v26, v18, v26
 v_cvt_pk_bf16_f32 v56, v18, v19
 v_exp_f32 v21, v83
 v_add_f32 v26, v19, v26
 v_exp_f32 v22, v88
 v_add_f32 v26, v20, v26
 v_cvt_pk_bf16_f32 v57, v20, v21
 v_exp_f32 v23, v89
 v_add_f32 v26, v21, v26
 v_exp_f32 v24, v90
 v_add_f32 v26, v22, v26
 v_cvt_pk_bf16_f32 v58, v22, v23
 v_exp_f32 v25, v91
 v_add_f32 v26, v23, v26
 v_exp_f32 v18, v84
 v_add_f32 v26, v24, v26
 v_cvt_pk_bf16_f32 v59, v24, v25
 v_exp_f32 v19, v85
 v_add_f32 v26, v25, v26
 v_exp_f32 v20, v86
 v_add_f32 v27, v18, v27
 v_cvt_pk_bf16_f32 v60, v18, v19
 v_exp_f32 v21, v87
 v_add_f32 v27, v19, v27
 v_exp_f32 v22, v92
 v_add_f32 v27, v20, v27
 v_cvt_pk_bf16_f32 v61, v20, v21
 v_exp_f32 v23, v93
 v_add_f32 v27, v21, v27
 v_exp_f32 v24, v94
 v_add_f32 v27, v22, v27
 v_cvt_pk_bf16_f32 v62, v22, v23
 v_exp_f32 v25, v95
 v_add_f32 v27, v23, v27
 v_add_f32 v27, v24, v27
 v_cvt_pk_bf16_f32 v63, v24, v25
 v_add_f32 v27, v25, v27
 s_nop 3
 s_setpc_b64 s[36:37]
L_moe0:
 s_lshl_b32 s88, s75, 1
 s_call_b64 s[36:37], L_moe
 v_add_f32 v32, v108, v32
 v_add_f32 v33, v109, v33
 v_add_f32 v34, v110, v34
 v_add_f32 v35, v111, v35
 v_add_f32 v36, v112, v36
 v_add_f32 v37, v113, v37
 v_add_f32 v38, v114, v38
 v_add_f32 v39, v115, v39
 v_add_f32 v40, v116, v40
 v_add_f32 v41, v117, v41
 v_add_f32 v42, v118, v42
 v_add_f32 v43, v119, v43
 v_add_f32 v44, v120, v44
 v_add_f32 v45, v121, v45
 v_add_f32 v46, v122, v46
 v_add_f32 v47, v123, v47
 s_mov_b64 exec, -1
 s_branch L_moe_ret0
L_moe1:
 s_lshl_b32 s88, s86, 1
 s_call_b64 s[36:37], L_moe
 v_add_f32 v80, v108, v80
 v_add_f32 v81, v109, v81
 v_add_f32 v82, v110, v82
 v_add_f32 v83, v111, v83
 v_add_f32 v84, v112, v84
 v_add_f32 v85, v113, v85
 v_add_f32 v86, v114, v86
 v_add_f32 v87, v115, v87
 s_mov_b64 exec, -1
 s_branch L_moe_ret1
L_moe2:
 s_lshl_b32 s88, s86, 1
 s_call_b64 s[36:37], L_moe
 v_add_f32 v32, v108, v32
 v_add_f32 v33, v109, v33
 v_add_f32 v34, v110, v34
 v_add_f32 v35, v111, v35
 v_add_f32 v36, v112, v36
 v_add_f32 v37, v113, v37
 v_add_f32 v38, v114, v38
 v_add_f32 v39, v115, v39
 s_mov_b64 exec, -1
 s_branch L_moe_ret2
L_moe:
 v_min_u32 v104, 27, v0
 v_lshlrev_b32 v104, 2, v104
 s_mov_b32 s64, 235475456
 s_mov_b32 s65, 65536
 s_mov_b32 exec_lo, 0xffffffff
 s_mov_b32 exec_hi, 0xffffffff
L_pfy:
 buffer_load_dword v105, v104, s[8:11], s64 offen sc1
 s_sub_u32 s65, s65, 1
 s_cbranch_scc1 L_pfy_x
 s_waitcnt vmcnt(0)
 v_cmp_ne_u32 vcc, 1, v105
 s_nop 0
 s_cbranch_vccz L_pfy_x
 s_sleep 2
 s_branch L_pfy
L_pfy_x:
 s_waitcnt vmcnt(0)
 s_mov_b64 exec, -1
 s_or_b64 exec, s[80:81], s[82:83]
 v_mov_b32 v104, 1792
 v_cndmask_b32 v104, v104, 0, s[80:81]
 v_lshl_add_u32 v104, v11, 5, v104
 s_add_u32 s88, s88, 234921984
 buffer_load_dwordx4 v[108:111], v104, s[8:11], s88 offen sc1
 buffer_load_dwordx4 v[112:115], v104, s[8:11], s88 offen offset:16 sc1
 buffer_load_dwordx4 v[116:119], v104, s[8:11], s88 offen offset:512 sc1
 buffer_load_dwordx4 v[120:123], v104, s[8:11], s88 offen offset:528 sc1
 s_waitcnt vmcnt(0)
 s_setpc_b64 s[36:37]
L_y1:
 s_lshl_b32 s89, s41, 1
 s_add_u32 s89, s89, s20
 s_cmp_ge_u32 s20, 2
 s_cselect_b32 s89, 28, s89
 s_cmp_ge_u32 s89, 28
 s_cbranch_scc1 L_y1r
 v_lshrrev_b32 v50, 4, v7
 v_lshrrev_b32 v51, 3, v50
 v_lshrrev_b32 v52, v51, s101
 v_and_b32 v53, 1, v52
 v_mul_u32_u24 v51, 16512, v51
 v_and_b32 v52, 7, v50
 v_lshl_add_u32 v51, v52, 7, v51
 v_lshl_add_u32 v51, v53, 13, v51
 s_mov_b32 s90, 234946560
 s_mov_b32 s88, 235078656
 s_mov_b32 s91, 65536
L_yp:
 buffer_load_dword v52, v51, s[8:11], s90 offen sc1
 buffer_load_dword v53, v51, s[8:11], s88 offen sc1
 s_waitcnt vmcnt(0)
 v_min_u32 v52, v52, v53
 v_cmp_gt_u32 vcc, 4, v52
 s_sub_u32 s91, s91, 1
 s_cbranch_scc1 L_ypx
 s_cbranch_vccnz L_yp
L_ypx:
 s_cmp_lt_u32 s89, 14
 s_cselect_b32 s90, 8, 12
 s_add_u32 s90, s90, 234913792
 buffer_load_dword v53, off, s[8:11], s90 sc1
 v_lshrrev_b32 v51, 3, v50
 v_mul_u32_u24 v51, 3584, v51
 v_and_b32 v52, 7, v50
 v_lshl_add_u32 v51, v52, 4, v51
 s_lshl_b32 s88, s89, 7
 s_add_u32 s90, s88, 234921984
 s_add_u32 s88, s88, 235929600
 buffer_load_dwordx4 v[136:139], v51, s[8:11], s88 offen sc1
 s_add_u32 s88, s88, 28672
 buffer_load_dwordx4 v[140:143], v51, s[8:11], s88 offen sc1
 s_add_u32 s88, s88, 28672
 buffer_load_dwordx4 v[152:155], v51, s[8:11], s88 offen sc1
 s_add_u32 s88, s88, 28672
 buffer_load_dwordx4 v[156:159], v51, s[8:11], s88 offen sc1
 s_add_u32 s88, s88, 28672
 buffer_load_dwordx4 v[168:171], v51, s[8:11], s88 offen sc1
 s_add_u32 s88, s88, 28672
 buffer_load_dwordx4 v[172:175], v51, s[8:11], s88 offen sc1
 s_add_u32 s88, s88, 28672
 buffer_load_dwordx4 v[184:187], v51, s[8:11], s88 offen sc1
 s_add_u32 s88, s88, 28672
 buffer_load_dwordx4 v[188:191], v51, s[8:11], s88 offen sc1
 s_add_u32 s88, s88, 28672
 buffer_load_dwordx4 v[200:203], v51, s[8:11], s88 offen sc1
 s_add_u32 s88, s88, 28672
 buffer_load_dwordx4 v[204:207], v51, s[8:11], s88 offen sc1
 s_add_u32 s88, s88, 28672
 buffer_load_dwordx4 v[216:219], v51, s[8:11], s88 offen sc1
 s_add_u32 s88, s88, 28672
 buffer_load_dwordx4 v[220:223], v51, s[8:11], s88 offen sc1
 s_add_u32 s88, s88, 28672
 buffer_load_dwordx4 v[232:235], v51, s[8:11], s88 offen sc1
 s_add_u32 s88, s88, 28672
 buffer_load_dwordx4 v[236:239], v51, s[8:11], s88 offen sc1
 s_add_u32 s88, s88, 28672
 s_branch L_y1r
L_y2:
 s_cmp_ge_u32 s89, 28
 s_cbranch_scc1 L_y2r
 s_waitcnt vmcnt(24)
 s_waitcnt vmcnt(12)
 v_add_f32 v136, v140, v136
 v_add_f32 v137, v141, v137
 v_add_f32 v138, v142, v138
 v_add_f32 v139, v143, v139
 s_waitcnt vmcnt(11)
 v_add_f32 v136, v152, v136
 v_add_f32 v137, v153, v137
 v_add_f32 v138, v154, v138
 v_add_f32 v139, v155, v139
 s_waitcnt vmcnt(10)
 v_add_f32 v136, v156, v136
 v_add_f32 v137, v157, v137
 v_add_f32 v138, v158, v138
 v_add_f32 v139, v159, v139
 s_waitcnt vmcnt(9)
 v_add_f32 v136, v168, v136
 v_add_f32 v137, v169, v137
 v_add_f32 v138, v170, v138
 v_add_f32 v139, v171, v139
 s_waitcnt vmcnt(8)
 v_add_f32 v136, v172, v136
 v_add_f32 v137, v173, v137
 v_add_f32 v138, v174, v138
 v_add_f32 v139, v175, v139
 s_waitcnt vmcnt(7)
 v_add_f32 v136, v184, v136
 v_add_f32 v137, v185, v137
 v_add_f32 v138, v186, v138
 v_add_f32 v139, v187, v139
 s_waitcnt vmcnt(6)
 v_add_f32 v136, v188, v136
 v_add_f32 v137, v189, v137
 v_add_f32 v138, v190, v138
 v_add_f32 v139, v191, v139
 s_waitcnt vmcnt(5)
 v_add_f32 v136, v200, v136
 v_add_f32 v137, v201, v137
 v_add_f32 v138, v202, v138
 v_add_f32 v139, v203, v139
 s_waitcnt vmcnt(4)
 v_add_f32 v136, v204, v136
 v_add_f32 v137, v205, v137
 v_add_f32 v138, v206, v138
 v_add_f32 v139, v207, v139
 s_waitcnt vmcnt(3)
 v_add_f32 v136, v216, v136
 v_add_f32 v137, v217, v137
 v_add_f32 v138, v218, v138
 v_add_f32 v139, v219, v139
 s_waitcnt vmcnt(2)
 v_add_f32 v136, v220, v136
 v_add_f32 v137, v221, v137
 v_add_f32 v138, v222, v138
 v_add_f32 v139, v223, v139
 s_waitcnt vmcnt(1)
 v_add_f32 v136, v232, v136
 v_add_f32 v137, v233, v137
 v_add_f32 v138, v234, v138
 v_add_f32 v139, v235, v139
 s_waitcnt vmcnt(0)
 v_add_f32 v136, v236, v136
 v_add_f32 v137, v237, v137
 v_add_f32 v138, v238, v138
 v_add_f32 v139, v239, v139
 v_add_f32 v136, v136, v136 row_ror:8 row_mask:0xf bank_mask:0xf
 v_add_f32 v137, v137, v137 row_ror:8 row_mask:0xf bank_mask:0xf
 v_add_f32 v138, v138, v138 row_ror:8 row_mask:0xf bank_mask:0xf
 v_add_f32 v139, v139, v139 row_ror:8 row_mask:0xf bank_mask:0xf
 v_mov_b32 v140, v136
 v_mov_b32 v141, v137
 v_mov_b32 v142, v138
 v_mov_b32 v143, v139
 v_permlane16_swap_b32 v140, v136
 v_permlane16_swap_b32 v141, v137
 v_permlane16_swap_b32 v142, v138
 v_permlane16_swap_b32 v143, v139
 v_add_f32 v136, v140, v136
 v_add_f32 v137, v141, v137
 v_add_f32 v138, v142, v138
 v_add_f32 v139, v143, v139
 v_mov_b32 v140, v136
 v_mov_b32 v141, v137
 v_mov_b32 v142, v138
 v_mov_b32 v143, v139
 v_permlane32_swap_b32 v140, v136
 v_permlane32_swap_b32 v141, v137
 v_permlane32_swap_b32 v142, v138
 v_permlane32_swap_b32 v143, v139
 v_add_f32 v136, v140, v136
 v_add_f32 v137, v141, v137
 v_add_f32 v138, v142, v138
 v_add_f32 v139, v143, v139
 v_cvt_pk_bf16_f32 v51, v136, v137
 v_lshlrev_b32 v136, 16, v51
 v_and_b32 v137, 0xffff0000, v51
 v_cvt_pk_bf16_f32 v51, v138, v139
 v_lshlrev_b32 v138, 16, v51
 v_and_b32 v139, 0xffff0000, v51
 v_mul_f32 v136, v53, v136
 v_mul_f32 v137, v53, v137
 v_mul_f32 v138, v53, v138
 v_mul_f32 v139, v53, v139
 v_cvt_pk_bf16_f32 v51, v136, v137
 v_lshlrev_b32 v136, 16, v51
 v_and_b32 v137, 0xffff0000, v51
 v_cvt_pk_bf16_f32 v51, v138, v139
 v_lshlrev_b32 v138, 16, v51
 v_and_b32 v139, 0xffff0000, v51
 s_mov_b64 exec, 0xff
 buffer_store_dwordx4 v[136:139], v7, s[8:11], s90 offen sc1
 s_mov_b64 exec, -1
 s_branch L_y2r
L_y3:
 s_cmp_ge_u32 s89, 28
 s_cbranch_scc1 L_y3r
 v_mov_b32 v52, 1
 s_lshl_b32 s89, s89, 2
 s_add_u32 s89, s89, 235475456
 s_mov_b64 exec, 1
 s_waitcnt vmcnt(5)
 buffer_store_dword v52, off, s[8:11], s89 sc1
 s_mov_b64 exec, -1
 s_branch L_y3r
L_fll:
 s_cmp_lg_u32 s39, 15
 s_cbranch_scc1 L_fll1
 v_mov_b32 v9, 0
 s_mov_b32 s46, s47
 s_mov_b32 s39, 1
L_fll1:
 buffer_load_dword v6, v9, s[8:11], s46 offen sc1
 s_branch L_fllr
L_pub3:
 v_mov_b32 v17, s3
 buffer_store_dword v17, v1, s[8:11], s45 offen sc1
 s_branch L_pub3r
L_fhs0:
 s_mov_b32 s91, 65536
L_fhs0_l:
 s_sleep 2
 buffer_load_dword v24, off, s[8:11], s79 sc1
 s_sub_u32 s91, s91, 1
 s_cbranch_scc1 L_fhs0_x
 s_waitcnt vmcnt(0)
 v_cmp_gt_u32 vcc, 1, v24
 s_nop 0
 s_cbranch_vccnz L_fhs0_l
L_fhs0_x:
 s_waitcnt vmcnt(0)
 s_branch L_fhr0
L_fhs1:
 s_mov_b32 s91, 65536
L_fhs1_l:
 s_sleep 2
 buffer_load_dword v24, off, s[8:11], s79 sc1
 s_sub_u32 s91, s91, 1
 s_cbranch_scc1 L_fhs1_x
 s_waitcnt vmcnt(0)
 v_cmp_gt_u32 vcc, 1, v24
 s_nop 0
 s_cbranch_vccnz L_fhs1_l
L_fhs1_x:
 s_waitcnt vmcnt(0)
 s_branch L_fhr1
L_fps1:
 s_mov_b32 s53, 65536
L_fps1_l:
 s_sleep 2
 buffer_load_dword v5, off, s[8:11], s47 sc1
 s_sub_u32 s53, s53, 1
 s_cbranch_scc1 L_fps1_x
 s_waitcnt vmcnt(0)
 v_cmp_ne_u32 vcc, 1, v5
 s_nop 0
 s_cbranch_vccnz L_fps1_l
L_fps1_x:
 s_waitcnt vmcnt(0)
 s_branch L_fpr1
L_f4s:
 s_mov_b32 s53, 65536
L_f4s_l:
 s_sleep 2
 buffer_load_dword v6, v9, s[8:11], s46 offen sc1
 s_sub_u32 s53, s53, 1
 s_cbranch_scc1 L_f4s_x
 s_waitcnt vmcnt(0)
 v_cmp_gt_u32 vcc, 3, v6
 s_nop 0
 s_cbranch_vccnz L_f4s_l
L_f4s_x:
 s_waitcnt vmcnt(0)
 s_branch L_f4r
L_f2s:
 s_mov_b32 s53, 65536
L_f2s_l:
 s_sleep 2
 buffer_load_dword v6, v9, s[8:11], s46 offen sc1
 s_sub_u32 s53, s53, 1
 s_cbranch_scc1 L_f2s_x
 s_waitcnt vmcnt(0)
 v_cmp_gt_u32 vcc, 3, v6
 s_nop 0
 s_cbranch_vccnz L_f2s_l
L_f2s_x:
 s_waitcnt vmcnt(0)
 s_branch L_f2r
L_fls0:
 s_mov_b32 s53, 65536
L_fls0_l:
 s_sleep 2
 buffer_load_dword v6, v9, s[8:11], s46 offen sc1
 s_sub_u32 s53, s53, 1
 s_cbranch_scc1 L_fls0_x
 s_waitcnt vmcnt(0)
 v_cmp_gt_u32 vcc, s39, v6
 s_nop 0
 s_cbranch_vccnz L_fls0_l
L_fls0_x:
 s_waitcnt vmcnt(0)
 s_branch L_flr0
L_code_end:
.section .rodata,"a"
.p2align 6
.amdhsa_kernel gated_mix__compressed_kv_cla__moe_arch_mod__prompt_kernel
  .amdhsa_next_free_vgpr 512
  .amdhsa_next_free_sgpr 102
  .amdhsa_accum_offset 256
  .amdhsa_group_segment_fixed_size 0
  .amdhsa_kernarg_size 120
  .amdhsa_user_sgpr_count 2
  .amdhsa_user_sgpr_kernarg_segment_ptr 1
  .amdhsa_system_sgpr_workgroup_id_x 1
  .amdhsa_float_denorm_mode_32 3
.end_amdhsa_kernel
```
